```python
import torch

def _softmax(x, axis=-1):
    return torch.softmax(x, dim=axis)
def _gelu(x):
    return torch.nn.functional.gelu(x, approximate="tanh")
def _silu(x):
    return torch.nn.functional.silu(x)
def _sigmoid(x):
    return torch.sigmoid(x)
def _layernorm(x, axis=-1, eps=1e-5):
    m = x.mean(dim=axis, keepdim=True)
    v = x.var(dim=axis, keepdim=True, unbiased=False)
    return (x - m) / torch.sqrt(v + eps)
def _scatter_add(tgt, idx, src, axis=0):
    return tgt.clone().index_add_(axis, idx, src)
def _segment_sum(src, seg, n):
    out = torch.zeros((n,) + src.shape[1:], dtype=src.dtype)
    return out.index_add_(0, seg, src)
def _pad(x, pw):
    flat = tuple(v for pair in reversed(pw) for v in pair)
    return torch.nn.functional.pad(x, flat)

kernel_name = 'recurrent_scan__ssm_conv_h3__mixer_token_mlp__prompt'

def setup_inputs():

    _w = (lambda a: (lambda t: t.to(torch.bfloat16) if t.is_floating_point() else t)(torch.as_tensor(a)))
    def _A_setup():
        B, S, D = 1, 2048, 576
        ks = 4
        return {
            "q": _w((lambda *s: torch.randn(*s, dtype=torch.bfloat16) * 0.05)(B, S, D)),
            "k": _w((lambda *s: torch.randn(*s, dtype=torch.bfloat16) * 0.8)(B, S, D)),
            "v": _w((lambda *s: torch.randn(*s, dtype=torch.bfloat16) * 0.8)(B, S, D)),
            "shift_k": _w((lambda *s: torch.randn(*s, dtype=torch.bfloat16) * 0.8)(D, ks) * 0.5),
            "ssm_k": _w((lambda *s: torch.randn(*s, dtype=torch.bfloat16) * 0.8)(D, S) * (1.0 / S ** 0.5)),
            "ssm_D": _w((lambda *s: torch.randn(*s, dtype=torch.bfloat16) * 0.8)(D)),
        }
    _A_in = _A_setup()

    def _B_setup():
        B, S, D, F = 1, 2048, 576, 4608
        return {
            "x": _w((lambda *s: torch.randn(*s, dtype=torch.bfloat16) * 0.05)(B, S, D)),
            "w1": _w((lambda *s: torch.randn(*s, dtype=torch.bfloat16) * 0.8)(S, F) * (S ** -0.5)),
            "b1": _w((lambda *s: torch.randn(*s, dtype=torch.bfloat16) * 12.8)(F) * 0.02),
            "w2": _w((lambda *s: torch.randn(*s, dtype=torch.bfloat16) * 0.2)(F, S) * (F ** -0.5)),
            "b2": _w((lambda *s: torch.randn(*s, dtype=torch.bfloat16) * 3.2)(S) * 0.02),
        }
    _B_in = _B_setup()

    return {
        "A_q": _A_in["q"],
        "A_k": _A_in["k"],
        "A_v": _A_in["v"],
        "A_shift_k": _A_in["shift_k"],
        "A_ssm_k": _A_in["ssm_k"],
        "A_ssm_D": _A_in["ssm_D"],
        "B_x": _B_in["x"],
        "B_w1": _B_in["w1"],
        "B_b1": _B_in["b1"],
        "B_w2": _B_in["w2"],
        "B_b2": _B_in["b2"],
    }

def reference(A_q, A_k, A_v, A_shift_k, A_ssm_k, A_ssm_D, B_x, B_w1, B_b1, B_w2, B_b2):
    def _A_ref(q, k, v, shift_k, ssm_k, ssm_D):
        B, S, D = q.shape
        ks = shift_k.shape[-1]
        k_pad = _pad(k, ((0, 0), (ks - 1, 0), (0, 0)))
        k_shift = torch.zeros_like(k)
        for t in range(ks):
            k_shift = k_shift + k_pad[:, t:t + S, :] * shift_k[:, ks - 1 - t][None, None, :]
        kv = k_shift * v
        L = 2 * S
        kv_pad = _pad(kv, ((0, 0), (0, S), (0, 0)))
        kf_pad = _pad(ssm_k, ((0, 0), (0, S)))
        kv_f = (lambda x, axes=(-2,-1): torch.fft.rfft2(x.float(), dim=axes))(kv_pad[:, None, :, :], axes=(1, 2))
        kf_f = (lambda x, axes=(-2,-1): torch.fft.rfft2(x.float(), dim=axes))(kf_pad[:, None, :], axes=(1, 2))
        kf_f = (lambda x, *d: x.permute(*d))(kf_f, 1, 2, 0)
        y_f = kv_f * kf_f[None, :, :, :]
        y = (lambda x, s, axes=(-2,-1): torch.fft.irfft2(x, s=s, dim=axes).to(torch.bfloat16))(y_f, (1, L), axes=(1, 2))[:, 0, :S, :]
        y = y + kv * ssm_D[None, None, :]
        return q * y

    def _B_ref(x, w1, b1, w2, b2):
        B, S, D = x.shape
        h = _layernorm(x, axis=-1)
        u = torch.einsum("bsd,sf->bdf", h, w1) + b1
        u = _gelu(u)
        y = torch.einsum("bdf,fs->bds", u, w2) + b2
        return (lambda x, *d: x.permute(*d))(y, 0, 2, 1)

    x = A_q
    xn = _layernorm(x, axis=-1)
    s = _A_ref(xn, A_k, A_v, A_shift_k, A_ssm_k, A_ssm_D)
    g = _silu(_B_ref(xn, B_w1, B_b1, B_w2, B_b2))
    return x + s * g
```

```asm
; @launch grid=(256,1,1) block=(256,1,1) lds=163840
.amdgcn_target "amdgcn-amd-amdhsa--gfx950"
.text
.globl recurrent_scan__ssm_conv_h3__mixer_token_mlp__prompt_kernel
.p2align 8
.type recurrent_scan__ssm_conv_h3__mixer_token_mlp__prompt_kernel,@function
recurrent_scan__ssm_conv_h3__mixer_token_mlp__prompt_kernel:
    s_cmp_lt_u32 s2, 256
    s_cbranch_scc0 L_exit
    s_load_dwordx2 s[56:57], s[0:1], 0
    s_load_dwordx2 s[48:49], s[0:1], 8
    s_load_dwordx2 s[52:53], s[0:1], 16
    s_load_dwordx2 s[60:61], s[0:1], 24
    s_load_dwordx16 s[16:31], s[0:1], 0
    s_load_dwordx8 s[32:39], s[0:1], 64
    s_load_dwordx4 s[40:43], s[0:1], 96
    s_memrealtime s[12:13]
    v_lshrrev_b32 v1, 6, v0
    v_and_b32 v2, 63, v0
    s_getpc_b64 s[6:7]
L_pc:
    s_lshr_b32 s4, s2, 1
    s_and_b32 s4, s4, 124
    v_add_u32 v22, s4, v1
    v_lshl_add_u32 v22, v2, 7, v22
    v_lshlrev_b32 v22, 7, v22
    v_min_u32 v22, L_end-L_pc-4, v22
    s_mov_b64 exec, 31
    global_load_dword v255, v22, s[6:7]
    s_mov_b64 exec, -1
    v_readfirstlane_b32 s3, v1
    s_and_b32 s4, s2, 7
    s_lshr_b32 s5, s2, 3
    s_lshl_b32 s4, s4, 5
    s_add_u32 s68, s4, s5
    v_lshrrev_b32 v3, 5, v0
    v_and_b32 v4, 31, v0
    v_mul_u32_u24 v5, 1152, v3
    v_mad_u32_u24 v5, v4, 12, v5
    s_mul_i32 s15, s68, 9216
    s_mul_i32 s4, s3, 3072
    s_add_u32 s5, s4, s15
    s_sub_u32 s5, s5, 3456
    v_lshlrev_b32 v6, 4, v2
    v_add_u32 v7, s5, v6
    v_add_u32 v58, 1024, v7
    s_add_u32 s4, s4, 114688
    s_lshl_b32 s5, s3, 11
    s_add_u32 s11, s5, s15
    s_add_u32 s5, s5, 127360
    s_mov_b32 m0, s4
    s_mov_b32 s58, 2359296
    s_mov_b32 s59, 0x20000
    s_mov_b32 s50, 2359296
    s_mov_b32 s51, 0x20000
    s_mov_b32 s54, 2359296
    s_mov_b32 s55, 0x20000
    s_mov_b32 s62, 4608
    s_mov_b32 s63, 0x20000
    v_lshlrev_b32 v59, 3, v0
    s_movk_i32 s10, 4096
    s_waitcnt lgkmcnt(0)
    buffer_load_dwordx3 v[8:10], v5, s[56:59], s15 offen offset:0
    buffer_load_dwordx3 v[12:14], v5, s[56:59], s15 offen offset:384
    buffer_load_dwordx3 v[16:18], v5, s[56:59], s15 offen offset:768
    buffer_load_dwordx4 v7, s[48:51], 0 offen lds
    s_add_u32 m0, s4, 1024
    s_cmp_eq_u32 s3, 3
    buffer_load_dwordx4 v58, s[48:51], 0 offen lds
    buffer_load_dwordx4 v58, s[48:51], 0 offen offset:1024 lds
    s_cbranch_scc1 L_xld
L_nox:
    s_mov_b32 m0, s5
    buffer_load_dwordx2 v[98:99], v59, s[60:63], 0 offen
    buffer_load_dwordx4 v6, s[52:55], s11 offen lds
    buffer_load_dwordx4 v6, s[52:55], s11 offen offset:1024 lds
    buffer_load_dwordx2 v[100:101], v59, s[60:63], 0 offen offset:2048
    buffer_load_dwordx2 v[102:103], v59, s[60:63], s10 offen
    s_mov_b32 s64, s40
    s_and_b32 s65, s41, 0xffff
    s_mov_b32 s66, 256
    s_mov_b32 s67, 0x20000
    s_or_b32 s12, s12, 1
    v_or_b32 v22, s2, v0
    v_lshlrev_b32 v22, 8, v22
    v_mov_b32 v23, s12
    buffer_store_dword v23, v22, s[64:67], 0 offen sc1
    s_mov_b32 s44, s42
    s_and_b32 s45, s43, 0xffff
    s_mov_b32 s46, 57606144
    s_mov_b32 s47, 0x20000
    s_and_b32 s5, s2, 7
    s_lshr_b32 s6, s2, 3
    s_lshr_b32 s7, s6, 2
    s_lshr_b32 s8, s3, 1
    s_lshl1_add_u32 s9, s7, s8
    s_cmp_ge_u32 s9, 10
    s_addc_u32 s14, s9, 0
    s_cmp_ge_u32 s9, 3
    s_addc_u32 s14, s14, 0
    s_lshl3_add_u32 s8, s8, 3
    s_cmp_eq_u32 s7, 7
    s_cselect_b32 s14, s8, s14
    s_and_b32 s4, s5, 1
    s_lshl4_add_u32 s71, s4, s14
    s_lshr_b32 s13, s5, 1
    s_mov_b32 s72, s13
    s_and_b32 s101, s6, 3
    s_lshl_b32 s73, s3, 12
    s_mov_b32 s52, s34
    s_and_b32 s53, s35, 0xffff
    s_mov_b32 s54, 18874368
    s_mov_b32 s55, 0x20000
    s_cmp_lt_u32 s6, 27
    s_cbranch_scc0 L_aux
    s_branch L_org
L_exit:
    s_endpgm
L_xld:
    s_mov_b64 exec, 0xffffff
    buffer_load_dwordx4 v58, s[48:51], 0 offen offset:2048 lds
    s_mov_b64 exec, -1
    s_mov_b32 m0, s5
    s_nop 0
    buffer_load_dwordx4 v6, s[52:55], s11 offen offset:2048 lds
    s_branch L_nox
L_nw_G:
    s_mov_b32 s5, 0
L_nl_G:
    buffer_load_dword v45, v44, s[64:67], 0 offen sc1
    s_waitcnt vmcnt(0)
    v_readfirstlane_b32 s68, v45
    s_nop 1
    s_cmp_lg_u32 s68, 0
    s_cbranch_scc1 L_ng_G
    s_add_u32 s5, s5, 1
    s_cmp_lt_u32 s5, 100000
    s_cbranch_scc1 L_nl_G
    s_branch L_ng_G
L_rs_p1G:
    s_mov_b32 s5, 0
L_rt_p1G:
    s_mov_b64 exec, vcc
    buffer_load_dword v29, v28, s[44:47], 0 offen sc1
    s_waitcnt vmcnt(0)
    v_cmp_ne_u32 vcc, s68, v29
    s_cbranch_vccz L_rx_p1G
    s_add_u32 s5, s5, 1
    s_cmp_lt_u32 s5, 100000
    s_cbranch_scc1 L_rt_p1G
L_rx_p1G:
    s_mov_b64 exec, -1
    s_branch L_ok_p1G
L_rs_p5:
    s_mov_b32 s5, 0
L_rt_p5:
    s_mov_b64 exec, vcc
    buffer_load_dword v29, v28, s[44:47], 0 offen sc1
    s_waitcnt vmcnt(0)
    v_cmp_ne_u32 vcc, s68, v29
    s_cbranch_vccz L_rx_p5
    s_add_u32 s5, s5, 1
    s_cmp_lt_u32 s5, 100000
    s_cbranch_scc1 L_rt_p5
L_rx_p5:
    s_mov_b64 exec, -1
    s_branch L_ok_p5
L_nw_X:
    s_mov_b32 s5, 0
L_nl_X:
    buffer_load_dword v45, v44, s[64:67], 0 offen sc1
    s_waitcnt vmcnt(0)
    v_readfirstlane_b32 s68, v45
    s_nop 1
    s_cmp_lg_u32 s68, 0
    s_cbranch_scc1 L_ng_X
    s_add_u32 s5, s5, 1
    s_cmp_lt_u32 s5, 100000
    s_cbranch_scc1 L_nl_X
    s_branch L_ng_X
L_rs_p1X:
    s_mov_b32 s5, 0
L_rt_p1X:
    s_mov_b64 exec, vcc
    buffer_load_dword v29, v28, s[44:47], 0 offen sc1
    s_waitcnt vmcnt(0)
    v_cmp_ne_u32 vcc, s68, v29
    s_cbranch_vccz L_rx_p1X
    s_add_u32 s5, s5, 1
    s_cmp_lt_u32 s5, 100000
    s_cbranch_scc1 L_rt_p1X
L_rx_p1X:
    s_mov_b64 exec, -1
    s_branch L_ok_p1X
L_rs_p2G:
    s_mov_b32 s5, 0
L_rt_p2G:
    s_mov_b64 exec, vcc
    v_mov_b32 v16, 0
    buffer_atomic_add v16, v15, s[44:47], 0 offen sc0 sc1
    s_waitcnt vmcnt(0)
    v_cmp_ne_u32 vcc, v13, v16
    s_cbranch_vccz L_rx_p2G
    s_add_u32 s5, s5, 1
    s_cmp_lt_u32 s5, 100000
    s_cbranch_scc1 L_rt_p2G
L_rx_p2G:
    s_mov_b64 exec, -1
    s_branch L_ok_p2G
L_xs_a:
    s_mov_b32 s5, 0
L_xt_a:
    buffer_load_dwordx4 v[40:43], v136, s[44:47], s34 offen offset:0 sc1
    buffer_load_dwordx4 v[44:47], v136, s[44:47], s34 offen offset:1024 sc1
    buffer_load_dwordx4 v[48:51], v136, s[44:47], s34 offen offset:2048 sc1
    s_waitcnt vmcnt(0)
    v_bitop3_b32 v43, v43, v47, s68 bitop3:0x7e
    v_bitop3_b32 v43, v43, v51, s68 bitop3:0xf6
    v_cmp_ne_u32 vcc, 0, v43
    s_cbranch_vccz L_xo_a
    s_add_u32 s5, s5, 1
    s_cmp_lt_u32 s5, 100000
    s_cbranch_scc1 L_xt_a
    s_branch L_xo_a
L_as_b:
    s_mov_b32 s5, 0
L_at_b:
    v_mov_b32 v141, 0
    buffer_atomic_add v141, v139, s[44:47], s11 offen offset:2060 sc0 sc1
    s_waitcnt vmcnt(0)
    v_cmp_ne_u32 vcc, v140, v141
    s_cbranch_vccz L_ao_b
    s_add_u32 s5, s5, 1
    s_cmp_lt_u32 s5, 100000
    s_cbranch_scc1 L_at_b
    s_branch L_ao_b
L_xs_b:
    s_mov_b32 s5, 0
L_xt_b:
    buffer_load_dwordx4 v[56:59], v136, s[44:47], s11 offen offset:0 sc1
    buffer_load_dwordx4 v[60:63], v136, s[44:47], s11 offen offset:1024 sc1
    buffer_load_dwordx4 v[64:67], v136, s[44:47], s11 offen offset:2048 sc1
    s_waitcnt vmcnt(0)
    v_bitop3_b32 v59, v59, v63, s68 bitop3:0x7e
    v_bitop3_b32 v59, v59, v67, s68 bitop3:0xf6
    v_cmp_ne_u32 vcc, 0, v59
    s_cbranch_vccz L_xo_b
    s_add_u32 s5, s5, 1
    s_cmp_lt_u32 s5, 100000
    s_cbranch_scc1 L_xt_b
    s_branch L_xo_b
L_xs_z:
    s_mov_b32 s5, 0
L_xt_z:
    buffer_load_dwordx4 v[72:75], v136, s[44:47], s12 offen offset:0 sc1
    buffer_load_dwordx4 v[76:79], v136, s[44:47], s12 offen offset:1024 sc1
    buffer_load_dwordx4 v[80:83], v136, s[44:47], s12 offen offset:2048 sc1
    s_waitcnt vmcnt(0)
    v_bitop3_b32 v75, v75, v79, s68 bitop3:0x7e
    v_bitop3_b32 v75, v75, v83, s68 bitop3:0xf6
    v_cmp_ne_u32 vcc, 0, v75
    s_cbranch_vccz L_xo_z
    s_add_u32 s5, s5, 1
    s_cmp_lt_u32 s5, 100000
    s_cbranch_scc1 L_xt_z
    s_branch L_xo_z
L_rs_p3:
    s_mov_b32 s5, 0
L_rt_p3:
    s_mov_b64 exec, vcc
    buffer_load_dword v189, v188, s[44:47], 0 offen sc1
    s_waitcnt vmcnt(0)
    v_cmp_ne_u32 vcc, s68, v189
    s_cbranch_vccz L_rx_p3
    s_add_u32 s5, s5, 1
    s_cmp_lt_u32 s5, 100000
    s_cbranch_scc1 L_rt_p3
L_rx_p3:
    s_mov_b64 exec, -1
    s_branch L_ok_p3
L_xs_8:
    s_mov_b32 s5, 0
L_xt_8:
    buffer_load_dwordx4 v[204:207], v136, s[44:47], s35 offen offset:0 sc1
    buffer_load_dwordx4 v[208:211], v136, s[44:47], s35 offen offset:1024 sc1
    buffer_load_dwordx4 v[212:215], v136, s[44:47], s35 offen offset:2048 sc1
    buffer_load_dwordx4 v[216:219], v136, s[44:47], s35 offen offset:3072 sc1
    s_waitcnt vmcnt(0)
    v_bitop3_b32 v207, v207, v211, s36 bitop3:0x7e
    v_bitop3_b32 v207, v207, v215, s36 bitop3:0xf6
    v_bitop3_b32 v207, v207, v219, s36 bitop3:0xf6
    v_cmp_ne_u32 vcc, 0, v207
    s_cbranch_vccz L_xo_8
    s_add_u32 s5, s5, 1
    s_cmp_lt_u32 s5, 100000
    s_cbranch_scc1 L_xt_8
    s_branch L_xo_8
L_rs_p2X:
    s_mov_b32 s5, 0
L_rt_p2X:
    s_mov_b64 exec, vcc
    v_mov_b32 v29, 0
    buffer_atomic_add v29, v28, s[44:47], 0 offen sc0 sc1
    s_waitcnt vmcnt(0)
    v_cmp_ne_u32 vcc, v13, v29
    s_cbranch_vccz L_rx_p2X
    s_add_u32 s5, s5, 1
    s_cmp_lt_u32 s5, 100000
    s_cbranch_scc1 L_rt_p2X
L_rx_p2X:
    s_mov_b64 exec, -1
    s_branch L_ok_p2X
L_wc_G:
    s_cmp_eq_u32 s3, 0
    s_cbranch_scc1 L_pl_G_0
    s_cmp_eq_u32 s3, 1
    s_cbranch_scc1 L_pl_G_1
    s_cmp_eq_u32 s3, 2
    s_cbranch_scc1 L_pl_G_2
    s_branch L_pl_G_3
L_wc_X:
    s_cmp_eq_u32 s3, 0
    s_cbranch_scc1 L_pl_X_0
    s_cmp_eq_u32 s3, 1
    s_cbranch_scc1 L_pl_X_1
    s_cmp_eq_u32 s3, 2
    s_cbranch_scc1 L_pl_X_2
    s_branch L_pl_X_3
L_wc_D:
    s_cmp_eq_u32 s3, 0
    s_cbranch_scc1 L_pl_D_0
    s_cmp_eq_u32 s3, 1
    s_cbranch_scc1 L_pl_D_1
    s_cmp_eq_u32 s3, 2
    s_cbranch_scc1 L_pl_D_2
    s_branch L_wret
L_wret:
    s_setpc_b64 s[82:83]
.p2align 12
L_org:
    s_mul_i32 s7, s6, 21846
    s_lshr_b32 s7, s7, 16
    s_mul_i32 s8, s7, 3
    s_sub_u32 s12, s6, s8
    s_mul_i32 s8, s13, 9
    s_add_u32 s69, s8, s7
    s_lshl1_add_u32 s70, s12, s4
    s_mul_i32 s8, s69, 6
    s_add_u32 s75, s8, s70
    s_mov_b32 s48, s30
    s_and_b32 s49, s31, 0xffff
    s_mov_b32 s50, 18874368
    s_mov_b32 s51, 0x20000
    s_add_u32 s12, s12, s7
    s_mul_i32 s8, s12, 21846
    s_lshr_b32 s8, s8, 16
    s_mul_i32 s8, s8, 3
    s_sub_u32 s12, s12, s8
    s_mul_i32 s4, s4, 1179648
    s_mul_i32 s7, s12, 65538
    s_lshr_b32 s7, s7, 16
    s_mul_i32 s7, s7, 73728
    s_add_u32 s5, s4, 0
    s_add_u32 s18, s7, s5
    s_add_u32 s8, s5, 221184
    s_add_u32 s19, s18, 73728
    s_cmp_eq_u32 s19, s8
    s_cselect_b32 s19, s5, s19
    s_add_u32 s20, s19, 73728
    s_cmp_eq_u32 s20, s8
    s_cselect_b32 s20, s5, s20
    s_mul_i32 s7, s12, 65538
    s_lshr_b32 s7, s7, 16
    s_mul_i32 s7, s7, 73728
    s_add_u32 s5, s4, 221184
    s_add_u32 s21, s7, s5
    s_add_u32 s8, s5, 221184
    s_add_u32 s22, s21, 73728
    s_cmp_eq_u32 s22, s8
    s_cselect_b32 s22, s5, s22
    s_add_u32 s23, s22, 73728
    s_cmp_eq_u32 s23, s8
    s_cselect_b32 s23, s5, s23
    s_mul_i32 s7, s12, 87384
    s_lshr_b32 s7, s7, 16
    s_mul_i32 s7, s7, 73728
    s_add_u32 s5, s4, 442368
    s_add_u32 s24, s7, s5
    s_add_u32 s8, s5, 294912
    s_add_u32 s25, s24, 73728
    s_cmp_eq_u32 s25, s8
    s_cselect_b32 s25, s5, s25
    s_add_u32 s26, s25, 73728
    s_cmp_eq_u32 s26, s8
    s_cselect_b32 s26, s5, s26
    s_add_u32 s27, s26, 73728
    s_cmp_eq_u32 s27, s8
    s_cselect_b32 s27, s5, s27
    s_mul_i32 s7, s12, 131076
    s_lshr_b32 s7, s7, 16
    s_mul_i32 s7, s7, 73728
    s_add_u32 s5, s4, 737280
    s_add_u32 s76, s7, s5
    s_add_u32 s8, s5, 442368
    s_add_u32 s77, s76, 73728
    s_cmp_eq_u32 s77, s8
    s_cselect_b32 s77, s5, s77
    s_add_u32 s78, s77, 73728
    s_cmp_eq_u32 s78, s8
    s_cselect_b32 s78, s5, s78
    s_add_u32 s79, s78, 73728
    s_cmp_eq_u32 s79, s8
    s_cselect_b32 s79, s5, s79
    s_add_u32 s80, s79, 73728
    s_cmp_eq_u32 s80, s8
    s_cselect_b32 s80, s5, s80
    s_add_u32 s81, s80, 73728
    s_cmp_eq_u32 s81, s8
    s_cselect_b32 s81, s5, s81
    v_lshrrev_b32 v24, 4, v2
    v_and_b32 v25, 15, v2
    v_lshlrev_b32 v26, 1, v24
    v_xor_b32 v25, v25, v26
    v_mul_u32_u24 v24, 9216, v24
    v_lshl_add_u32 v24, v25, 4, v24
    s_mul_i32 s7, s3, 147456
    s_lshl_b32 s8, s69, 8
    s_add_u32 s7, s7, s8
    v_add_u32 v148, s7, v24
    v_add_u32 v149, 35840, v148
    v_xor_b32 v24, 128, v148
    v_add_u32 v150, 71680, v24
    v_add_u32 v151, 35840, v150
    v_bfe_u32 v140, v2, 2, 2
    v_lshrrev_b32 v141, 4, v2
    v_lshl_add_u32 v142, v141, 3, v140
    v_lshlrev_b32 v142, 8, v142
    v_and_b32 v143, 3, v2
    v_lshl_add_u32 v142, v143, 3, v142
    v_and_b32 v141, 1, v141
    v_lshl_add_u32 v140, v141, 2, v140
    s_lshl_b32 s7, s3, 1
    v_xor_b32 v140, s7, v140
    v_lshl_add_u32 v152, v140, 5, v142
    v_xor_b32 v153, 32, v152
    v_add_u32 v154, 0x10000, v152
    v_add_u32 v155, 0x10000, v153
    v_and_b32 v24, 15, v2
    v_lshrrev_b32 v25, 4, v2
    v_mul_u32_u24 v26, 17408, v25
    v_lshl_add_u32 v26, v24, 4, v26
    v_mul_u32_u24 v25, 1536, v25
    v_lshl_add_u32 v25, v24, 4, v25
    v_add_u32 v159, 81920, v25
    v_add_u32 v250, 36864, v159
    s_mul_i32 s7, s3, 18432
    s_xor_b32 s8, s70, 1
    s_mul_i32 s8, s8, 1536
    s_add_u32 s7, s7, s8
    v_lshlrev_b32 v246, 4, v2
    v_add_u32 v156, s7, v246
    v_lshrrev_b32 v25, 5, v2
    v_mul_u32_u24 v25, 7680, v25
    v_add_u32 v157, v156, v25
    v_add_u32 v158, 7680, v156
    s_mul_i32 s74, s3, 3072
    s_add_u32 s74, s74, 81920
    v_mov_b32 v245, v26
    s_mov_b32 s9, 144896
    s_mov_b32 s11, 114688
    s_waitcnt vmcnt(9)
    v_and_b32 v21, 0xffff0000, v8
    s_add_u32 m0, s73, 81920
    s_lshl_b32 s14, s18, 3
    buffer_load_dwordx4 v148, s[48:51], s14 offen offset:0 lds
    v_lshlrev_b32 v20, 16, v8
    v_and_b32 v23, 0xffff0000, v9
    v_lshlrev_b32 v22, 16, v9
    v_and_b32 v25, 0xffff0000, v10
    v_lshlrev_b32 v24, 16, v10
    v_and_b32 v27, 0xffff0000, v12
    v_lshlrev_b32 v26, 16, v12
    v_and_b32 v29, 0xffff0000, v13
    v_lshlrev_b32 v28, 16, v13
    v_and_b32 v31, 0xffff0000, v14
    v_lshlrev_b32 v30, 16, v14
    v_and_b32 v33, 0xffff0000, v16
    v_lshlrev_b32 v32, 16, v16
    v_and_b32 v35, 0xffff0000, v17
    v_lshlrev_b32 v34, 16, v17
    v_and_b32 v37, 0xffff0000, v18
    v_lshlrev_b32 v36, 16, v18
    v_pk_add_f32 v[38:39], v[20:21], v[22:23]
    v_pk_add_f32 v[40:41], v[24:25], v[26:27]
    v_pk_add_f32 v[42:43], v[28:29], v[30:31]
    v_pk_add_f32 v[44:45], v[32:33], v[34:35]
    v_pk_add_f32 v[38:39], v[38:39], v[40:41]
    v_pk_add_f32 v[42:43], v[42:43], v[44:45]
    v_pk_add_f32 v[38:39], v[38:39], v[36:37]
    v_pk_add_f32 v[38:39], v[38:39], v[42:43]
    v_add_f32 v56, v38, v39
    buffer_load_dwordx4 v149, s[48:51], s14 offen offset:1024 lds
    s_nop 0
    v_add_f32_dpp v56, v56, v56 row_ror:8 row_mask:0xf bank_mask:0xf
    s_nop 1
    v_add_f32_dpp v56, v56, v56 row_ror:4 row_mask:0xf bank_mask:0xf
    s_nop 1
    v_add_f32_dpp v56, v56, v56 row_ror:2 row_mask:0xf bank_mask:0xf
    s_nop 1
    v_add_f32_dpp v56, v56, v56 row_ror:1 row_mask:0xf bank_mask:0xf
    v_mov_b32 v57, v56
    s_nop 1
    v_permlane16_swap_b32 v56, v57
    v_add_f32 v56, v56, v57
    v_mul_f32 v56, 0x3ae38e39, v56
    v_pk_add_f32 v[20:21], v[20:21], v[56:57] op_sel_hi:[1,0] neg_lo:[0,1] neg_hi:[0,1]
    v_pk_add_f32 v[22:23], v[22:23], v[56:57] op_sel_hi:[1,0] neg_lo:[0,1] neg_hi:[0,1]
    v_pk_add_f32 v[24:25], v[24:25], v[56:57] op_sel_hi:[1,0] neg_lo:[0,1] neg_hi:[0,1]
    v_pk_add_f32 v[26:27], v[26:27], v[56:57] op_sel_hi:[1,0] neg_lo:[0,1] neg_hi:[0,1]
    v_pk_add_f32 v[28:29], v[28:29], v[56:57] op_sel_hi:[1,0] neg_lo:[0,1] neg_hi:[0,1]
    v_pk_add_f32 v[30:31], v[30:31], v[56:57] op_sel_hi:[1,0] neg_lo:[0,1] neg_hi:[0,1]
    v_pk_add_f32 v[32:33], v[32:33], v[56:57] op_sel_hi:[1,0] neg_lo:[0,1] neg_hi:[0,1]
    v_pk_add_f32 v[34:35], v[34:35], v[56:57] op_sel_hi:[1,0] neg_lo:[0,1] neg_hi:[0,1]
    v_pk_add_f32 v[36:37], v[36:37], v[56:57] op_sel_hi:[1,0] neg_lo:[0,1] neg_hi:[0,1]
    v_pk_mul_f32 v[38:39], v[20:21], v[20:21]
    v_pk_mul_f32 v[40:41], v[22:23], v[22:23]
    v_pk_fma_f32 v[38:39], v[24:25], v[24:25], v[38:39]
    v_pk_fma_f32 v[40:41], v[26:27], v[26:27], v[40:41]
    v_pk_fma_f32 v[38:39], v[28:29], v[28:29], v[38:39]
    v_pk_fma_f32 v[40:41], v[30:31], v[30:31], v[40:41]
    v_pk_fma_f32 v[38:39], v[32:33], v[32:33], v[38:39]
    v_pk_fma_f32 v[40:41], v[34:35], v[34:35], v[40:41]
    v_pk_fma_f32 v[38:39], v[36:37], v[36:37], v[38:39]
    buffer_load_dwordx4 v150, s[48:51], s14 offen offset:2048 lds
    v_pk_add_f32 v[38:39], v[38:39], v[40:41]
    v_add_f32 v18, v38, v39
    s_nop 1
    v_add_f32_dpp v18, v18, v18 row_ror:8 row_mask:0xf bank_mask:0xf
    s_nop 1
    v_add_f32_dpp v18, v18, v18 row_ror:4 row_mask:0xf bank_mask:0xf
    s_nop 1
    v_add_f32_dpp v18, v18, v18 row_ror:2 row_mask:0xf bank_mask:0xf
    s_nop 1
    v_add_f32_dpp v18, v18, v18 row_ror:1 row_mask:0xf bank_mask:0xf
    v_mov_b32 v19, v18
    s_nop 1
    v_permlane16_swap_b32 v18, v19
    v_add_f32 v18, v18, v19
    v_mul_f32 v18, 0x3ae38e39, v18
    v_cvt_pk_bf16_f32 v38, v56, v18
    v_lshlrev_b32 v106, 16, v38
    v_and_b32 v38, 0xffff0000, v38
    v_add_f32 v38, 0x3727c5ac, v38
    v_sub_f32 v56, v56, v106
    v_cvt_pk_bf16_f32 v38, v38, v38
    v_lshlrev_b32 v38, 16, v38
    v_sqrt_f32 v38, v38
    s_nop 0
    v_cvt_pk_bf16_f32 v38, v38, v38
    v_lshlrev_b32 v38, 16, v38
    v_rcp_f32 v107, v38
    s_nop 0
    v_mul_f32 v56, v56, v107
    v_mul_f32 v18, v18, v107
    v_mul_f32 v18, v18, v107
    v_cvt_pk_bf16_f32 v38, v56, v18
    v_lshlrev_b32 v39, 16, v38
    buffer_load_dwordx4 v151, s[48:51], s14 offen offset:3072 lds
    v_and_b32 v38, 0xffff0000, v38
    v_add_f32 v38, 0x3727c5ac, v38
    v_sub_f32 v56, v56, v39
    v_cvt_pk_bf16_f32 v38, v38, v38
    v_lshlrev_b32 v38, 16, v38
    v_sqrt_f32 v38, v38
    s_nop 0
    v_cvt_pk_bf16_f32 v38, v38, v38
    v_lshlrev_b32 v38, 16, v38
    v_rcp_f32 v38, v38
    s_nop 0
    v_mul_f32 v18, v107, v38
    v_mul_f32 v56, v56, v38
    v_pk_fma_f32 v[20:21], v[20:21], v[18:19], v[56:57] op_sel_hi:[1,0,0]
    v_pk_fma_f32 v[22:23], v[22:23], v[18:19], v[56:57] op_sel_hi:[1,0,0]
    v_pk_fma_f32 v[24:25], v[24:25], v[18:19], v[56:57] op_sel_hi:[1,0,0]
    v_pk_fma_f32 v[26:27], v[26:27], v[18:19], v[56:57] op_sel_hi:[1,0,0]
    v_pk_fma_f32 v[28:29], v[28:29], v[18:19], v[56:57] op_sel_hi:[1,0,0]
    v_pk_fma_f32 v[30:31], v[30:31], v[18:19], v[56:57] op_sel_hi:[1,0,0]
    v_pk_fma_f32 v[32:33], v[32:33], v[18:19], v[56:57] op_sel_hi:[1,0,0]
    v_pk_fma_f32 v[34:35], v[34:35], v[18:19], v[56:57] op_sel_hi:[1,0,0]
    v_pk_fma_f32 v[36:37], v[36:37], v[18:19], v[56:57] op_sel_hi:[1,0,0]
    v_cvt_pk_bf16_f32 v8, v20, v21
    v_cvt_pk_bf16_f32 v9, v22, v23
    v_cvt_pk_bf16_f32 v10, v24, v25
    v_cvt_pk_bf16_f32 v11, v26, v27
    v_cvt_pk_bf16_f32 v12, v28, v29
    v_cvt_pk_bf16_f32 v13, v30, v31
    v_cvt_pk_bf16_f32 v14, v32, v33
    v_cvt_pk_bf16_f32 v15, v34, v35
    v_cvt_pk_bf16_f32 v16, v36, v37
    v_lshrrev_b32 v3, 5, v0
    v_and_b32 v1, 31, v0
    v_mul_u32_u24 v17, 1216, v3
    v_mad_u32_u24 v17, v1, 12, v17
    v_add_u32 v17, 144896, v17
    ds_write_b32 v17, v8 offset:0
    ds_write_b32 v17, v9 offset:4
    ds_write_b32 v17, v10 offset:8
    ds_write_b32 v17, v11 offset:384
    ds_write_b32 v17, v12 offset:388
    ds_write_b32 v17, v13 offset:392
    ds_write_b32 v17, v14 offset:768
    ds_write_b32 v17, v15 offset:772
    ds_write_b32 v17, v16 offset:776
    v_lshlrev_b32 v3, 3, v3
    s_lshl_b32 s5, s68, 6
    s_add_u32 s5, s5, 12386304
    v_cmp_eq_u32 vcc, 0, v1
    v_mov_b32 v18, 0x40000000
    s_nop 0
    v_cndmask_b32 v3, v18, v3, vcc
    buffer_store_dwordx2 v[106:107], v3, s[44:47], s5 offen sc1
    v_lshrrev_b32 v19, 4, v0
    v_and_b32 v17, 3, v2
    v_lshlrev_b32 v17, 3, v17
    v_lshl_add_u32 v19, v19, 5, v17
    v_bfe_u32 v6, v2, 2, 2
    v_mul_u32_u24 v17, 1216, v6
    v_mul_u32_u24 v6, 1152, v6
    v_add3_u32 v17, v17, v19, s9
    v_add3_u32 v6, v6, v19, s11
    v_lshlrev_b32 v19, 4, v0
    s_add_u32 s7, s15, 4096
    s_add_u32 s8, s15, 8192
    s_cmp_eq_u32 s3, 0
    s_cselect_b32 s8, s8, 0x40000000
    v_add_u32 v18, 2359296, v19
    v_mov_b32 v44, 0
    s_waitcnt lgkmcnt(0)
    s_barrier
    ds_read_b64_tr_b16 v[20:21], v17 offset:0
    ds_read_b64_tr_b16 v[22:23], v17 offset:4864
    ds_read_b64_tr_b16 v[24:25], v17 offset:512
    ds_read_b64_tr_b16 v[26:27], v17 offset:5376
    ds_read_b64_tr_b16 v[28:29], v17 offset:1024
    ds_read_b64_tr_b16 v[30:31], v17 offset:5888
    s_bfe_u32 s6, s68, 0x20001
    s_lshl_b32 s6, s6, 6
    s_lshr_b32 s9, s68, 3
    s_lshl_b32 s9, s9, 1
    s_add_u32 s6, s6, s9
    s_and_b32 s9, s68, 1
    s_add_u32 s6, s6, s9
    s_lshr_b32 s4, s6, 2
    s_lshl_b32 s4, s4, 7
    s_and_b32 s5, s6, 3
    s_lshl2_add_u32 s4, s5, s4
    s_add_u32 s4, s4, 12533760
    v_min_u32 v1, 1, v0
    v_lshlrev_b32 v1, 30, v1
    v_add_u32 v1, s4, v1
    s_waitcnt lgkmcnt(4)
    buffer_store_dwordx4 v[20:23], v19, s[44:47], s15 offen sc1
    s_waitcnt lgkmcnt(2)
    buffer_store_dwordx4 v[24:27], v19, s[44:47], s7 offen sc1
    s_waitcnt lgkmcnt(0)
    buffer_store_dwordx4 v[28:31], v19, s[44:47], s8 offen sc1
    buffer_load_dword v45, v44, s[64:67], 0 offen sc1
    s_waitcnt vmcnt(10)
    s_barrier
    ds_read_b64_tr_b16 v[60:61], v6 offset:0
    ds_read_b64_tr_b16 v[62:63], v6 offset:4608
    ds_read_b64_tr_b16 v[64:65], v6 offset:9216
    ds_read_b64_tr_b16 v[66:67], v6 offset:12672
    ds_read_b64_tr_b16 v[68:69], v6 offset:17280
    ds_read_b64_tr_b16 v[70:71], v6 offset:512
    ds_read_b64_tr_b16 v[72:73], v6 offset:5120
    ds_read_b64_tr_b16 v[74:75], v6 offset:9728
    ds_read_b64_tr_b16 v[76:77], v6 offset:13184
    ds_read_b64_tr_b16 v[78:79], v6 offset:17792
    v_alignbit_b32 v114, v99, v99, 16
    v_alignbit_b32 v115, v98, v98, 16
    s_waitcnt lgkmcnt(5)
    v_alignbit_b32 v108, v61, v60, 16
    v_alignbit_b32 v109, v62, v61, 16
    v_alignbit_b32 v110, v63, v62, 16
    v_alignbit_b32 v111, v64, v63, 16
    v_alignbit_b32 v112, v65, v64, 16
    v_dot2_f32_bf16 v116, v60, v114, 0
    ds_read_b64_tr_b16 v[80:81], v6 offset:1024
    v_dot2_f32_bf16 v117, v108, v114, 0
    v_dot2_f32_bf16 v118, v61, v114, 0
    v_dot2_f32_bf16 v119, v109, v114, 0
    v_dot2_f32_bf16 v120, v62, v114, 0
    ds_read_b64_tr_b16 v[82:83], v6 offset:5632
    v_dot2_f32_bf16 v121, v110, v114, 0
    v_dot2_f32_bf16 v122, v63, v114, 0
    v_dot2_f32_bf16 v123, v111, v114, 0
    v_dot2_f32_bf16 v116, v61, v115, v116
    v_dot2_f32_bf16 v117, v109, v115, v117
    ds_read_b64_tr_b16 v[84:85], v6 offset:10240
    v_dot2_f32_bf16 v118, v62, v115, v118
    v_dot2_f32_bf16 v119, v110, v115, v119
    v_dot2_f32_bf16 v120, v63, v115, v120
    v_dot2_f32_bf16 v121, v111, v115, v121
    v_dot2_f32_bf16 v122, v64, v115, v122
    ds_read_b64_tr_b16 v[86:87], v6 offset:13696
    v_dot2_f32_bf16 v123, v112, v115, v123
    v_and_b32 v133, 0xffff0000, v66
    v_lshlrev_b32 v132, 16, v66
    v_and_b32 v135, 0xffff0000, v67
    v_lshlrev_b32 v134, 16, v67
    ds_read_b64_tr_b16 v[88:89], v6 offset:18304
    v_and_b32 v137, 0xffff0000, v68
    v_lshlrev_b32 v136, 16, v68
    v_and_b32 v139, 0xffff0000, v69
    v_lshlrev_b32 v138, 16, v69
    v_pk_mul_f32 v[116:117], v[116:117], v[132:133]
    v_pk_mul_f32 v[118:119], v[118:119], v[134:135]
    v_pk_mul_f32 v[120:121], v[120:121], v[136:137]
    v_pk_mul_f32 v[122:123], v[122:123], v[138:139]
    v_cvt_pk_bf16_f32 v160, v123, v122
    v_cvt_pk_bf16_f32 v161, v121, v120
    v_cvt_pk_bf16_f32 v162, v119, v118
    v_cvt_pk_bf16_f32 v163, v117, v116
    buffer_store_dwordx4 v[160:163], v18, s[44:47], s15 offen sc1
    v_alignbit_b32 v114, v101, v101, 16
    v_alignbit_b32 v115, v100, v100, 16
    s_waitcnt lgkmcnt(5)
    v_alignbit_b32 v108, v71, v70, 16
    v_alignbit_b32 v109, v72, v71, 16
    v_alignbit_b32 v110, v73, v72, 16
    v_alignbit_b32 v111, v74, v73, 16
    v_alignbit_b32 v112, v75, v74, 16
    v_dot2_f32_bf16 v124, v70, v114, 0
    v_dot2_f32_bf16 v125, v108, v114, 0
    v_dot2_f32_bf16 v126, v71, v114, 0
    v_dot2_f32_bf16 v127, v109, v114, 0
    v_dot2_f32_bf16 v128, v72, v114, 0
    v_dot2_f32_bf16 v129, v110, v114, 0
    v_dot2_f32_bf16 v130, v73, v114, 0
    v_dot2_f32_bf16 v131, v111, v114, 0
    v_dot2_f32_bf16 v124, v71, v115, v124
    v_dot2_f32_bf16 v125, v109, v115, v125
    v_dot2_f32_bf16 v126, v72, v115, v126
    v_dot2_f32_bf16 v127, v110, v115, v127
    v_dot2_f32_bf16 v128, v73, v115, v128
    v_dot2_f32_bf16 v129, v111, v115, v129
    v_dot2_f32_bf16 v130, v74, v115, v130
    v_dot2_f32_bf16 v131, v112, v115, v131
    v_and_b32 v133, 0xffff0000, v76
    v_lshlrev_b32 v132, 16, v76
    v_and_b32 v135, 0xffff0000, v77
    v_lshlrev_b32 v134, 16, v77
    v_and_b32 v137, 0xffff0000, v78
    v_lshlrev_b32 v136, 16, v78
    v_and_b32 v139, 0xffff0000, v79
    v_lshlrev_b32 v138, 16, v79
    v_pk_mul_f32 v[124:125], v[124:125], v[132:133]
    v_pk_mul_f32 v[126:127], v[126:127], v[134:135]
    v_pk_mul_f32 v[128:129], v[128:129], v[136:137]
    v_pk_mul_f32 v[130:131], v[130:131], v[138:139]
    v_cvt_pk_bf16_f32 v164, v131, v130
    v_cvt_pk_bf16_f32 v165, v129, v128
    v_cvt_pk_bf16_f32 v166, v127, v126
    v_cvt_pk_bf16_f32 v167, v125, v124
    buffer_store_dwordx4 v[164:167], v18, s[44:47], s7 offen sc1
    v_alignbit_b32 v114, v103, v103, 16
    v_alignbit_b32 v115, v102, v102, 16
    s_waitcnt lgkmcnt(0)
    v_alignbit_b32 v108, v81, v80, 16
    v_alignbit_b32 v109, v82, v81, 16
    v_alignbit_b32 v110, v83, v82, 16
    v_alignbit_b32 v111, v84, v83, 16
    v_alignbit_b32 v112, v85, v84, 16
    v_dot2_f32_bf16 v116, v80, v114, 0
    v_dot2_f32_bf16 v117, v108, v114, 0
    v_dot2_f32_bf16 v118, v81, v114, 0
    v_dot2_f32_bf16 v119, v109, v114, 0
    v_dot2_f32_bf16 v120, v82, v114, 0
    v_dot2_f32_bf16 v121, v110, v114, 0
    v_dot2_f32_bf16 v122, v83, v114, 0
    v_dot2_f32_bf16 v123, v111, v114, 0
    v_dot2_f32_bf16 v116, v81, v115, v116
    v_dot2_f32_bf16 v117, v109, v115, v117
    v_dot2_f32_bf16 v118, v82, v115, v118
    v_dot2_f32_bf16 v119, v110, v115, v119
    v_dot2_f32_bf16 v120, v83, v115, v120
    v_dot2_f32_bf16 v121, v111, v115, v121
    v_dot2_f32_bf16 v122, v84, v115, v122
    v_dot2_f32_bf16 v123, v112, v115, v123
    v_and_b32 v133, 0xffff0000, v86
    v_lshlrev_b32 v132, 16, v86
    v_and_b32 v135, 0xffff0000, v87
    v_lshlrev_b32 v134, 16, v87
    v_and_b32 v137, 0xffff0000, v88
    v_lshlrev_b32 v136, 16, v88
    v_and_b32 v139, 0xffff0000, v89
    v_lshlrev_b32 v138, 16, v89
    v_pk_mul_f32 v[116:117], v[116:117], v[132:133]
    v_pk_mul_f32 v[118:119], v[118:119], v[134:135]
    v_pk_mul_f32 v[120:121], v[120:121], v[136:137]
    v_pk_mul_f32 v[122:123], v[122:123], v[138:139]
    v_cvt_pk_bf16_f32 v168, v123, v122
    v_cvt_pk_bf16_f32 v169, v121, v120
    v_cvt_pk_bf16_f32 v170, v119, v118
    v_cvt_pk_bf16_f32 v171, v117, v116
    buffer_store_dwordx4 v[168:171], v18, s[44:47], s8 offen sc1
    s_add_u32 m0, s73, 98304
    s_lshl_b32 s14, s19, 3
    buffer_load_dwordx4 v148, s[48:51], s14 offen offset:0 lds
    buffer_load_dwordx4 v149, s[48:51], s14 offen offset:1024 lds
    buffer_load_dwordx4 v150, s[48:51], s14 offen offset:2048 lds
    buffer_load_dwordx4 v151, s[48:51], s14 offen offset:3072 lds
    s_add_u32 m0, s73, 0
    s_lshl_b32 s14, s20, 3
    buffer_load_dwordx4 v148, s[48:51], s14 offen offset:0 lds
    buffer_load_dwordx4 v149, s[48:51], s14 offen offset:1024 lds
    buffer_load_dwordx4 v150, s[48:51], s14 offen offset:2048 lds
    buffer_load_dwordx4 v151, s[48:51], s14 offen offset:3072 lds
    s_add_u32 m0, s73, 16384
    s_lshl_b32 s14, s21, 3
    buffer_load_dwordx4 v148, s[48:51], s14 offen offset:0 lds
    buffer_load_dwordx4 v149, s[48:51], s14 offen offset:1024 lds
    s_waitcnt vmcnt(13)
    v_readfirstlane_b32 s68, v45
    s_nop 1
    s_cmp_eq_u32 s68, 0
    s_cbranch_scc1 L_nw_G
L_ng_G:
    s_barrier
    v_mov_b32 v3, s68
    buffer_store_dword v3, v1, s[44:47], 0 offen sc1
    s_mov_b64 exec, 0
    s_call_b64 s[82:83], L_wc_G
    s_mov_b64 exec, -1
    v_add_u32 v1, 65536, v1
    s_waitcnt vmcnt(11)
    s_barrier
    buffer_store_dword v3, v1, s[44:47], 0 offen sc1
L_segG:
L_pl_G_0:
    s_cbranch_execz L_pl_G_4
    buffer_load_dwordx4 v150, s[48:51], s14 offen offset:2048 lds
    buffer_load_dwordx4 v151, s[48:51], s14 offen offset:3072 lds
    s_add_u32 m0, s73, 32768
    s_lshl_b32 s14, s22, 3
    buffer_load_dwordx4 v148, s[48:51], s14 offen offset:0 lds
    buffer_load_dwordx4 v149, s[48:51], s14 offen offset:1024 lds
    buffer_load_dwordx4 v150, s[48:51], s14 offen offset:2048 lds
    buffer_load_dwordx4 v151, s[48:51], s14 offen offset:3072 lds
    s_add_u32 m0, s73, 49152
    s_lshl_b32 s14, s23, 3
    buffer_load_dwordx4 v148, s[48:51], s14 offen offset:0 lds
    buffer_load_dwordx4 v149, s[48:51], s14 offen offset:1024 lds
    buffer_load_dwordx4 v150, s[48:51], s14 offen offset:2048 lds
    buffer_load_dwordx4 v151, s[48:51], s14 offen offset:3072 lds
    s_add_u32 m0, s73, 65536
    s_lshl_b32 s14, s24, 3
    buffer_load_dwordx4 v148, s[48:51], s14 offen offset:0 lds
    buffer_load_dwordx4 v149, s[48:51], s14 offen offset:1024 lds
    buffer_load_dwordx4 v150, s[48:51], s14 offen offset:2048 lds
    buffer_load_dwordx4 v151, s[48:51], s14 offen offset:3072 lds
    s_mov_b64 exec, 0
    s_call_b64 s[82:83], L_wc_D
    s_mov_b64 exec, -1
    s_mov_b32 s56, s32
    s_and_b32 s57, s33, 0xffff
    s_mov_b32 s58, 9216
    s_mov_b32 s59, 0x20000
    s_mov_b32 s60, s36
    s_and_b32 s61, s37, 0xffff
    s_mov_b32 s62, 4096
    s_mov_b32 s63, 0x20000
    s_waitcnt lgkmcnt(0)
    s_barrier
    ds_read_b64_tr_b16 a[0:1], v154 offset:16384
    ds_read_b64_tr_b16 a[2:3], v154 offset:17408
    ds_read_b64_tr_b16 a[4:5], v155 offset:16384
    ds_read_b64_tr_b16 a[6:7], v155 offset:17408
    ds_read_b64_tr_b16 a[8:9], v154 offset:24576
    ds_read_b64_tr_b16 a[10:11], v154 offset:25600
    ds_read_b64_tr_b16 a[12:13], v155 offset:24576
    ds_read_b64_tr_b16 a[14:15], v155 offset:25600
    s_and_b32 s4, s70, 1
    s_lshl1_add_u32 s4, s3, s4
    s_lshl_b32 s4, s4, 5
    v_min_u32 v28, 31, v2
    v_add_u32 v28, s4, v28
    v_and_b32 v29, 3, v28
    v_lshrrev_b32 v28, 2, v28
    v_lshlrev_b32 v28, 7, v28
    v_lshl_add_u32 v28, v29, 2, v28
    v_add_u32 v28, 12533760, v28
    s_waitcnt vmcnt(22) lgkmcnt(0)
    s_barrier
    ds_read_b64_tr_b16 a[16:17], v154 offset:32768
    ds_read_b64_tr_b16 a[18:19], v154 offset:33792
    ds_read_b64_tr_b16 a[20:21], v155 offset:32768
    ds_read_b64_tr_b16 a[22:23], v155 offset:33792
    ds_read_b64_tr_b16 a[24:25], v154 offset:40960
    ds_read_b64_tr_b16 a[26:27], v154 offset:41984
    ds_read_b64_tr_b16 a[28:29], v155 offset:40960
    ds_read_b64_tr_b16 a[30:31], v155 offset:41984
    v_lshrrev_b32 v24, 4, v2
    v_lshlrev_b32 v25, 3, v24
    s_lshl_b32 s7, s69, 8
    s_lshl_b32 s8, s3, 6
    s_add_u32 s7, s7, s8
    buffer_load_dwordx2 v[144:145], v25, s[56:59], s7 offen
    buffer_load_dwordx2 v[146:147], v25, s[56:59], s7 offen offset:32
    s_waitcnt vmcnt(20) lgkmcnt(0)
    s_barrier
    ds_read_b64_tr_b16 a[32:33], v152 offset:0
    ds_read_b64_tr_b16 a[34:35], v152 offset:1024
    ds_read_b64_tr_b16 a[36:37], v153 offset:0
    ds_read_b64_tr_b16 a[38:39], v153 offset:1024
    ds_read_b64_tr_b16 a[40:41], v152 offset:8192
    ds_read_b64_tr_b16 a[42:43], v152 offset:9216
    ds_read_b64_tr_b16 a[44:45], v153 offset:8192
    ds_read_b64_tr_b16 a[46:47], v153 offset:9216
    s_waitcnt vmcnt(14) lgkmcnt(0)
    s_barrier
    ds_read_b64_tr_b16 a[48:49], v152 offset:16384
    s_add_u32 m0, s73, 0
    s_lshl_b32 s14, s25, 3
    ds_read_b64_tr_b16 a[50:51], v152 offset:17408
    buffer_load_dwordx4 v148, s[48:51], s14 offen offset:0 lds
    ds_read_b64_tr_b16 a[52:53], v153 offset:16384
    ds_read_b64_tr_b16 a[54:55], v153 offset:17408
    buffer_load_dwordx4 v149, s[48:51], s14 offen offset:1024 lds
    ds_read_b64_tr_b16 a[56:57], v152 offset:24576
    buffer_load_dwordx4 v150, s[48:51], s14 offen offset:2048 lds
    ds_read_b64_tr_b16 a[58:59], v152 offset:25600
    ds_read_b64_tr_b16 a[60:61], v153 offset:24576
    buffer_load_dwordx4 v151, s[48:51], s14 offen offset:3072 lds
    ds_read_b64_tr_b16 a[62:63], v153 offset:25600
    buffer_load_dword v29, v28, s[44:47], 0 offen sc1
    s_waitcnt vmcnt(15) lgkmcnt(0)
    s_barrier
    ds_read_b64_tr_b16 a[64:65], v152 offset:32768
    s_add_u32 m0, s73, 16384
    s_lshl_b32 s14, s26, 3
    ds_read_b64_tr_b16 a[66:67], v152 offset:33792
    buffer_load_dwordx4 v148, s[48:51], s14 offen offset:0 lds
    ds_read_b64_tr_b16 a[68:69], v153 offset:32768
    ds_read_b64_tr_b16 a[70:71], v153 offset:33792
    buffer_load_dwordx4 v149, s[48:51], s14 offen offset:1024 lds
    ds_read_b64_tr_b16 a[72:73], v152 offset:40960
    buffer_load_dwordx4 v150, s[48:51], s14 offen offset:2048 lds
    ds_read_b64_tr_b16 a[74:75], v152 offset:41984
    ds_read_b64_tr_b16 a[76:77], v153 offset:40960
    buffer_load_dwordx4 v151, s[48:51], s14 offen offset:3072 lds
    ds_read_b64_tr_b16 a[78:79], v153 offset:41984
    s_waitcnt vmcnt(15) lgkmcnt(0)
    s_barrier
    ds_read_b64_tr_b16 a[80:81], v152 offset:49152
    s_add_u32 m0, s73, 32768
    s_lshl_b32 s14, s27, 3
    ds_read_b64_tr_b16 a[82:83], v152 offset:50176
    buffer_load_dwordx4 v148, s[48:51], s14 offen offset:0 lds
    ds_read_b64_tr_b16 a[84:85], v153 offset:49152
    ds_read_b64_tr_b16 a[86:87], v153 offset:50176
    buffer_load_dwordx4 v149, s[48:51], s14 offen offset:1024 lds
    ds_read_b64_tr_b16 a[88:89], v152 offset:57344
    buffer_load_dwordx4 v150, s[48:51], s14 offen offset:2048 lds
    ds_read_b64_tr_b16 a[90:91], v152 offset:58368
    ds_read_b64_tr_b16 a[92:93], v153 offset:57344
L_pl_G_1:
    s_cbranch_execz L_pl_G_5
    buffer_load_dwordx4 v151, s[48:51], s14 offen offset:3072 lds
    ds_read_b64_tr_b16 a[94:95], v153 offset:58368
    s_waitcnt vmcnt(8)
    v_cmp_ne_u32 vcc, s68, v29
    s_cbranch_vccnz L_rs_p1G
L_ok_p1G:
    s_add_u32 m0, s74, 0
    s_nop 0
    buffer_load_dwordx4 v156, s[44:47], s18 offen offset:0 sc1 lds
    buffer_load_dwordx4 v157, s[44:47], s18 offen offset:1024 sc1 lds
    buffer_load_dwordx4 v158, s[44:47], s18 offen offset:2048 sc1 lds
    s_add_u32 m0, s74, 12288
    s_nop 0
    buffer_load_dwordx4 v156, s[44:47], s19 offen offset:0 sc1 lds
    buffer_load_dwordx4 v157, s[44:47], s19 offen offset:1024 sc1 lds
    buffer_load_dwordx4 v158, s[44:47], s19 offen offset:2048 sc1 lds
    s_add_u32 m0, s74, 24576
    s_nop 0
    buffer_load_dwordx4 v156, s[44:47], s20 offen offset:0 sc1 lds
    buffer_load_dwordx4 v157, s[44:47], s20 offen offset:1024 sc1 lds
    buffer_load_dwordx4 v158, s[44:47], s20 offen offset:2048 sc1 lds
    s_add_u32 m0, s74, 36864
    s_nop 0
    buffer_load_dwordx4 v156, s[44:47], s21 offen offset:0 sc1 lds
    buffer_load_dwordx4 v157, s[44:47], s21 offen offset:1024 sc1 lds
    buffer_load_dwordx4 v158, s[44:47], s21 offen offset:2048 sc1 lds
    s_waitcnt vmcnt(9) lgkmcnt(0)
    s_barrier
    ds_read_b128 v[80:83], v159 offset:0
    ds_read_b128 v[84:87], v159 offset:6144
    ds_read_b128 v[88:91], v159 offset:256
    ds_read_b128 v[92:95], v159 offset:6400
    ds_read_b128 v[96:99], v159 offset:512
    ds_read_b128 v[100:103], v159 offset:6656
    s_waitcnt lgkmcnt(0)
    v_mfma_f32_16x16x32_bf16 v[192:195], a[0:3], v[80:83], 0
    v_mfma_f32_16x16x32_bf16 v[192:195], a[8:11], v[84:87], v[192:195]
    ds_read_b128 v[104:107], v159 offset:768
    v_mfma_f32_16x16x32_bf16 v[196:199], a[12:15], v[84:87], 0
    ds_read_b128 v[108:111], v159 offset:6912
    v_mfma_f32_16x16x32_bf16 v[196:199], a[4:7], v[80:83], v[196:199]
    ds_read_b128 v[112:115], v159 offset:1024
    v_mfma_f32_16x16x32_bf16 v[204:207], a[4:7], v[88:91], 0
    ds_read_b128 v[116:119], v159 offset:7168
    v_mfma_f32_16x16x32_bf16 v[204:207], a[12:15], v[92:95], v[204:207]
    ds_read_b128 v[120:123], v159 offset:1280
    v_mfma_f32_16x16x32_bf16 v[200:203], a[8:11], v[92:95], 0
    ds_read_b128 v[124:127], v159 offset:7424
    v_and_b32 v24, 15, v2
    s_lshl_b32 s7, s71, 6
    v_add_u32 v24, s7, v24
    s_and_b32 s8, s3, 1
    s_lshl_b32 s4, s8, 5
    v_add_u32 v25, s4, v24
    v_lshlrev_b32 v26, 3, v25
    v_mul_u32_u24 v25, 1152, v25
    v_bfe_u32 v31, v2, 4, 1
    v_lshl_add_u32 v25, v31, 5, v25
    v_lshrrev_b32 v31, 5, v2
    v_lshl_add_u32 v25, v31, 4, v25
    s_bfe_u32 s7, s2, 0x20003
    s_mul_i32 s7, s7, 288
    s_lshl_b32 s4, s72, 6
    s_add_u32 s4, s4, s7
    v_add_u32 v252, s4, v25
    s_xor_b32 s8, s3, s72
    s_and_b32 s4, s72, 1
    s_lshl1_add_u32 s4, s4, s8
    v_lshl_add_u32 v24, s4, 4, v24
    s_add_u32 s7, s7, 256
    s_cmp_lt_u32 s8, 2
    s_cselect_b32 s7, s7, 0x40000000
    v_lshlrev_b32 v18, 3, v24
    v_mul_u32_u24 v24, 1152, v24
    v_lshrrev_b32 v31, 4, v2
    v_mfma_f32_16x16x32_bf16 v[200:203], a[0:3], v[88:91], v[200:203]
    v_mfma_f32_16x16x32_bf16 v[208:211], a[0:3], v[96:99], 0
    v_mfma_f32_16x16x32_bf16 v[208:211], a[8:11], v[100:103], v[208:211]
    v_mfma_f32_16x16x32_bf16 v[212:215], a[12:15], v[100:103], 0
    v_mfma_f32_16x16x32_bf16 v[212:215], a[4:7], v[96:99], v[212:215]
    s_waitcnt lgkmcnt(0)
    v_mfma_f32_16x16x32_bf16 v[220:223], a[4:7], v[104:107], 0
    s_waitcnt vmcnt(6)
    s_barrier
    v_mfma_f32_16x16x32_bf16 v[220:223], a[12:15], v[108:111], v[220:223]
    ds_read_b128 v[80:83], v159 offset:12288
    s_add_u32 m0, s74, 49152
    v_mfma_f32_16x16x32_bf16 v[216:219], a[8:11], v[108:111], 0
    ds_read_b128 v[84:87], v159 offset:18432
    v_mfma_f32_16x16x32_bf16 v[216:219], a[0:3], v[104:107], v[216:219]
    ds_read_b128 v[88:91], v159 offset:12544
    buffer_load_dwordx4 v156, s[44:47], s22 offen offset:0 sc1 lds
    v_mfma_f32_16x16x32_bf16 v[224:227], a[0:3], v[112:115], 0
    ds_read_b128 v[92:95], v159 offset:18688
    v_mfma_f32_16x16x32_bf16 v[224:227], a[8:11], v[116:119], v[224:227]
    ds_read_b128 v[96:99], v159 offset:12800
    v_mfma_f32_16x16x32_bf16 v[228:231], a[12:15], v[116:119], 0
    ds_read_b128 v[100:103], v159 offset:18944
    buffer_load_dwordx4 v157, s[44:47], s22 offen offset:1024 sc1 lds
    v_lshl_add_u32 v24, v31, 3, v24
    v_add_u32 v253, s7, v24
    v_lshrrev_b32 v24, 3, v2
    v_and_b32 v25, 7, v2
    v_bfe_u32 v31, v2, 4, 2
    v_lshlrev_b32 v31, 1, v31
    v_xor_b32 v25, v25, v31
    v_lshlrev_b32 v24, 12, v24
    v_lshl_add_u32 v24, v25, 4, v24
    s_mul_i32 s7, s72, 36
    s_bitcmp1_b32 s3, 0
    s_addc_u32 s7, s7, 0
    s_lshl_b32 s7, s7, 17
    s_lshl_b32 s8, s71, 7
    s_add_u32 s7, s7, s8
    v_add_u32 v4, s7, v24
    v_add_u32 v5, 31744, v4
    v_add_u32 v6, 31744, v5
    v_add_u32 v7, 31744, v6
    v_lshrrev_b32 v24, 2, v2
    v_lshlrev_b32 v24, 7, v24
    v_and_b32 v25, 3, v2
    v_lshl_add_u32 v24, v25, 3, v24
    s_and_b32 s7, s73, 8192
    v_add_u32 v24, s7, v24
    v_bfe_u32 v31, v2, 3, 2
    s_and_b32 s7, s3, 1
    v_mfma_f32_16x16x32_bf16 v[228:231], a[4:7], v[112:115], v[228:231]
    ds_read_b64_tr_b16 a[96:97], v154 offset:0
    v_mfma_f32_16x16x32_bf16 v[236:239], a[4:7], v[120:123], 0
    ds_read_b64_tr_b16 a[98:99], v154 offset:1024
    v_mfma_f32_16x16x32_bf16 v[236:239], a[12:15], v[124:127], v[236:239]
    buffer_load_dwordx4 v158, s[44:47], s22 offen offset:2048 sc1 lds
    v_mfma_f32_16x16x32_bf16 v[232:235], a[8:11], v[124:127], 0
    ds_read_b64_tr_b16 a[100:101], v155 offset:0
    v_mfma_f32_16x16x32_bf16 v[232:235], a[0:3], v[120:123], v[232:235]
    ds_read_b64_tr_b16 a[102:103], v155 offset:1024
    s_waitcnt lgkmcnt(4)
    v_mfma_f32_16x16x32_bf16 v[192:195], a[16:19], v[80:83], v[192:195]
    s_add_u32 m0, s74, 61440
    v_mfma_f32_16x16x32_bf16 v[192:195], a[24:27], v[84:87], v[192:195]
    ds_read_b128 v[104:107], v159 offset:13056
    v_mfma_f32_16x16x32_bf16 v[196:199], a[28:31], v[84:87], v[196:199]
    ds_read_b128 v[108:111], v159 offset:19200
    v_mfma_f32_16x16x32_bf16 v[196:199], a[20:23], v[80:83], v[196:199]
    ds_read_b128 v[112:115], v159 offset:13312
    buffer_load_dwordx4 v156, s[44:47], s23 offen offset:0 sc1 lds
    v_mfma_f32_16x16x32_bf16 v[204:207], a[20:23], v[88:91], v[204:207]
    ds_read_b128 v[116:119], v159 offset:19456
    v_mfma_f32_16x16x32_bf16 v[204:207], a[28:31], v[92:95], v[204:207]
    ds_read_b128 v[120:123], v159 offset:13568
    v_mfma_f32_16x16x32_bf16 v[200:203], a[24:27], v[92:95], v[200:203]
    ds_read_b128 v[124:127], v159 offset:19712
    buffer_load_dwordx4 v157, s[44:47], s23 offen offset:1024 sc1 lds
    s_lshl_b32 s7, s7, 1
    v_xor_b32 v31, s7, v31
    v_lshl_add_u32 v10, v31, 5, v24
    v_xor_b32 v11, 32, v10
    s_mul_i32 s84, s101, 16
    s_lshr_b32 s84, s84, 2
    s_add_u32 s84, s84, 0
    s_add_u32 s85, s84, 1
    s_cmp_eq_u32 s85, 16
    s_cselect_b32 s85, 0, s85
    s_add_u32 s86, s85, 1
    s_cmp_eq_u32 s86, 16
    s_cselect_b32 s86, 0, s86
    s_add_u32 s87, s86, 1
    s_cmp_eq_u32 s87, 16
    s_cselect_b32 s87, 0, s87
    s_add_u32 s88, s87, 1
    s_cmp_eq_u32 s88, 16
    s_cselect_b32 s88, 0, s88
    s_add_u32 s89, s88, 1
    s_cmp_eq_u32 s89, 16
    s_cselect_b32 s89, 0, s89
    s_add_u32 s90, s89, 1
    s_cmp_eq_u32 s90, 16
    s_cselect_b32 s90, 0, s90
    s_add_u32 s91, s90, 1
    s_cmp_eq_u32 s91, 16
    s_cselect_b32 s91, 0, s91
    s_add_u32 s92, s91, 1
    s_cmp_eq_u32 s92, 16
    s_cselect_b32 s92, 0, s92
    s_add_u32 s93, s92, 1
    s_cmp_eq_u32 s93, 16
    s_cselect_b32 s93, 0, s93
    s_add_u32 s94, s93, 1
    s_cmp_eq_u32 s94, 16
    s_cselect_b32 s94, 0, s94
    s_add_u32 s95, s94, 1
    s_cmp_eq_u32 s95, 16
    s_cselect_b32 s95, 0, s95
    s_add_u32 s96, s95, 1
    s_cmp_eq_u32 s96, 16
    s_cselect_b32 s96, 0, s96
    s_add_u32 s97, s96, 1
    s_cmp_eq_u32 s97, 16
    s_cselect_b32 s97, 0, s97
    s_add_u32 s98, s97, 1
    s_cmp_eq_u32 s98, 16
    s_cselect_b32 s98, 0, s98
    s_add_u32 s99, s98, 1
    s_cmp_eq_u32 s99, 16
    s_cselect_b32 s99, 0, s99
    s_mul_i32 s100, s101, 2
    s_lshr_b32 s100, s100, 2
    s_add_u32 s100, s100, 16
    s_add_u32 s101, s100, 1
    s_cmp_eq_u32 s101, 18
    s_cselect_b32 s101, 16, s101
    s_mul_i32 s7, s70, 6
    s_add_u32 s7, s7, 0
    s_mul_i32 s8, s7, 7282
    s_lshr_b32 s8, s8, 16
    v_mfma_f32_16x16x32_bf16 v[200:203], a[16:19], v[88:91], v[200:203]
    ds_read_b64_tr_b16 a[104:105], v154 offset:8192
    v_mfma_f32_16x16x32_bf16 v[208:211], a[16:19], v[96:99], v[208:211]
    ds_read_b64_tr_b16 a[106:107], v154 offset:9216
    v_mfma_f32_16x16x32_bf16 v[208:211], a[24:27], v[100:103], v[208:211]
    buffer_load_dwordx4 v158, s[44:47], s23 offen offset:2048 sc1 lds
    v_mfma_f32_16x16x32_bf16 v[212:215], a[28:31], v[100:103], v[212:215]
    ds_read_b64_tr_b16 a[108:109], v155 offset:8192
    v_mfma_f32_16x16x32_bf16 v[212:215], a[20:23], v[96:99], v[212:215]
    ds_read_b64_tr_b16 a[110:111], v155 offset:9216
    s_waitcnt lgkmcnt(4)
    v_mfma_f32_16x16x32_bf16 v[220:223], a[20:23], v[104:107], v[220:223]
    s_waitcnt vmcnt(9)
    s_barrier
    v_mfma_f32_16x16x32_bf16 v[220:223], a[28:31], v[108:111], v[220:223]
    ds_read_b128 v[80:83], v159 offset:24576
    s_add_u32 m0, s74, 0
    v_mfma_f32_16x16x32_bf16 v[216:219], a[24:27], v[108:111], v[216:219]
    ds_read_b128 v[84:87], v159 offset:30720
    v_mfma_f32_16x16x32_bf16 v[216:219], a[16:19], v[104:107], v[216:219]
    ds_read_b128 v[88:91], v159 offset:24832
    buffer_load_dwordx4 v156, s[44:47], s24 offen offset:0 sc1 lds
    v_mfma_f32_16x16x32_bf16 v[224:227], a[16:19], v[112:115], v[224:227]
    ds_read_b128 v[92:95], v159 offset:30976
    v_mfma_f32_16x16x32_bf16 v[224:227], a[24:27], v[116:119], v[224:227]
    ds_read_b128 v[96:99], v159 offset:25088
    v_mfma_f32_16x16x32_bf16 v[228:231], a[28:31], v[116:119], v[228:231]
    ds_read_b128 v[100:103], v159 offset:31232
    buffer_load_dwordx4 v157, s[44:47], s24 offen offset:1024 sc1 lds
    s_mul_i32 s5, s8, 9
    s_sub_u32 s7, s7, s5
    s_lshl_b32 s7, s7, 2
    s_mov_b32 s4, 0xeca86420
    s_mov_b32 s5, 3
    s_lshr_b64 s[4:5], s[4:5], s7
    s_and_b32 s4, s4, 15
    s_lshl4_add_u32 s4, s8, s4
    v_lshl_add_u32 v240, s4, 8, v245
    s_mul_i32 s7, s70, 6
    s_add_u32 s7, s7, 1
    s_mul_i32 s8, s7, 7282
    s_lshr_b32 s8, s8, 16
    s_mul_i32 s5, s8, 9
    s_sub_u32 s7, s7, s5
    s_lshl_b32 s7, s7, 2
    s_mov_b32 s4, 0xeca86420
    s_mov_b32 s5, 3
    s_lshr_b64 s[4:5], s[4:5], s7
    s_and_b32 s4, s4, 15
    s_lshl4_add_u32 s4, s8, s4
    v_lshl_add_u32 v241, s4, 8, v245
    s_mul_i32 s7, s70, 6
    s_add_u32 s7, s7, 2
    s_mul_i32 s8, s7, 7282
    s_lshr_b32 s8, s8, 16
    s_mul_i32 s5, s8, 9
    v_mfma_f32_16x16x32_bf16 v[228:231], a[20:23], v[112:115], v[228:231]
    ds_read_b64_tr_b16 a[112:113], v152 offset:0
    v_mfma_f32_16x16x32_bf16 v[236:239], a[20:23], v[120:123], v[236:239]
    ds_read_b64_tr_b16 a[114:115], v152 offset:1024
    v_mfma_f32_16x16x32_bf16 v[236:239], a[28:31], v[124:127], v[236:239]
    buffer_load_dwordx4 v158, s[44:47], s24 offen offset:2048 sc1 lds
    v_mfma_f32_16x16x32_bf16 v[232:235], a[24:27], v[124:127], v[232:235]
    ds_read_b64_tr_b16 a[116:117], v153 offset:0
    v_mfma_f32_16x16x32_bf16 v[232:235], a[16:19], v[120:123], v[232:235]
    ds_read_b64_tr_b16 a[118:119], v153 offset:1024
    s_waitcnt lgkmcnt(4)
    v_mfma_f32_16x16x32_bf16 v[192:195], a[32:35], v[80:83], v[192:195]
    s_add_u32 m0, s74, 12288
    v_mfma_f32_16x16x32_bf16 v[192:195], a[40:43], v[84:87], v[192:195]
    ds_read_b128 v[104:107], v159 offset:25344
    v_mfma_f32_16x16x32_bf16 v[196:199], a[44:47], v[84:87], v[196:199]
    ds_read_b128 v[108:111], v159 offset:31488
    v_mfma_f32_16x16x32_bf16 v[196:199], a[36:39], v[80:83], v[196:199]
    ds_read_b128 v[112:115], v159 offset:25600
    buffer_load_dwordx4 v156, s[44:47], s25 offen offset:0 sc1 lds
    v_mfma_f32_16x16x32_bf16 v[204:207], a[36:39], v[88:91], v[204:207]
    ds_read_b128 v[116:119], v159 offset:31744
    v_mfma_f32_16x16x32_bf16 v[204:207], a[44:47], v[92:95], v[204:207]
    ds_read_b128 v[120:123], v159 offset:25856
    v_mfma_f32_16x16x32_bf16 v[200:203], a[40:43], v[92:95], v[200:203]
    ds_read_b128 v[124:127], v159 offset:32000
    buffer_load_dwordx4 v157, s[44:47], s25 offen offset:1024 sc1 lds
    s_sub_u32 s7, s7, s5
    s_lshl_b32 s7, s7, 2
    s_mov_b32 s4, 0xeca86420
    s_mov_b32 s5, 3
    s_lshr_b64 s[4:5], s[4:5], s7
    s_and_b32 s4, s4, 15
    s_lshl4_add_u32 s4, s8, s4
    v_lshl_add_u32 v242, s4, 8, v245
    s_mul_i32 s7, s70, 6
    s_add_u32 s7, s7, 3
    s_mul_i32 s8, s7, 7282
    s_lshr_b32 s8, s8, 16
    s_mul_i32 s5, s8, 9
    s_sub_u32 s7, s7, s5
    s_lshl_b32 s7, s7, 2
    s_mov_b32 s4, 0xeca86420
    s_mov_b32 s5, 3
    s_lshr_b64 s[4:5], s[4:5], s7
    s_and_b32 s4, s4, 15
    s_lshl4_add_u32 s4, s8, s4
    v_lshl_add_u32 v243, s4, 8, v245
    s_mul_i32 s7, s70, 6
    s_add_u32 s7, s7, 4
    s_mul_i32 s8, s7, 7282
    s_lshr_b32 s8, s8, 16
    s_mul_i32 s5, s8, 9
    v_mfma_f32_16x16x32_bf16 v[200:203], a[32:35], v[88:91], v[200:203]
    ds_read_b64_tr_b16 a[120:121], v152 offset:8192
    v_mfma_f32_16x16x32_bf16 v[208:211], a[32:35], v[96:99], v[208:211]
    ds_read_b64_tr_b16 a[122:123], v152 offset:9216
    v_mfma_f32_16x16x32_bf16 v[208:211], a[40:43], v[100:103], v[208:211]
    buffer_load_dwordx4 v158, s[44:47], s25 offen offset:2048 sc1 lds
    v_mfma_f32_16x16x32_bf16 v[212:215], a[44:47], v[100:103], v[212:215]
    ds_read_b64_tr_b16 a[124:125], v153 offset:8192
    v_mfma_f32_16x16x32_bf16 v[212:215], a[36:39], v[96:99], v[212:215]
    ds_read_b64_tr_b16 a[126:127], v153 offset:9216
    s_waitcnt lgkmcnt(4)
    v_mfma_f32_16x16x32_bf16 v[220:223], a[36:39], v[104:107], v[220:223]
    s_waitcnt vmcnt(12)
    s_barrier
    v_mfma_f32_16x16x32_bf16 v[220:223], a[44:47], v[108:111], v[220:223]
    ds_read_b128 v[80:83], v250 offset:0
    s_add_u32 m0, s74, 24576
    v_mfma_f32_16x16x32_bf16 v[216:219], a[40:43], v[108:111], v[216:219]
    ds_read_b128 v[84:87], v250 offset:6144
    v_mfma_f32_16x16x32_bf16 v[216:219], a[32:35], v[104:107], v[216:219]
    ds_read_b128 v[88:91], v250 offset:256
    buffer_load_dwordx4 v156, s[44:47], s26 offen offset:0 sc1 lds
    v_mfma_f32_16x16x32_bf16 v[224:227], a[32:35], v[112:115], v[224:227]
    ds_read_b128 v[92:95], v250 offset:6400
    v_mfma_f32_16x16x32_bf16 v[224:227], a[40:43], v[116:119], v[224:227]
    ds_read_b128 v[96:99], v250 offset:512
    v_mfma_f32_16x16x32_bf16 v[228:231], a[44:47], v[116:119], v[228:231]
    ds_read_b128 v[100:103], v250 offset:6656
    buffer_load_dwordx4 v157, s[44:47], s26 offen offset:1024 sc1 lds
    s_sub_u32 s7, s7, s5
    s_lshl_b32 s7, s7, 2
    s_mov_b32 s4, 0xeca86420
    s_mov_b32 s5, 3
    s_lshr_b64 s[4:5], s[4:5], s7
    s_and_b32 s4, s4, 15
    s_lshl4_add_u32 s4, s8, s4
    v_lshl_add_u32 v244, s4, 8, v245
    s_mul_i32 s7, s70, 6
    s_add_u32 s7, s7, 5
    s_mul_i32 s8, s7, 7282
    s_lshr_b32 s8, s8, 16
    s_mul_i32 s5, s8, 9
    s_sub_u32 s7, s7, s5
    s_lshl_b32 s7, s7, 2
    s_mov_b32 s4, 0xeca86420
    s_mov_b32 s5, 3
    s_lshr_b64 s[4:5], s[4:5], s7
    s_and_b32 s4, s4, 15
    s_lshl4_add_u32 s4, s8, s4
    v_lshl_add_u32 v245, s4, 8, v245
    s_xor_b32 s7, s75, 1
    s_lshl2_add_u32 s7, s7, s3
    s_mul_i32 s9, s7, 6144
    s_add_u32 s9, s9, 28065792
    s_lshl_b32 s7, s7, 7
    s_add_u32 s6, s7, 33374208
    s_lshl2_add_u32 s7, s75, s3
    s_mul_i32 s10, s7, 6144
    s_add_u32 s10, s10, 28065792
    s_lshl_b32 s7, s7, 7
    v_mfma_f32_16x16x32_bf16 v[228:231], a[36:39], v[112:115], v[228:231]
    ds_read_b64_tr_b16 a[128:129], v152 offset:16384
    v_mfma_f32_16x16x32_bf16 v[236:239], a[36:39], v[120:123], v[236:239]
    ds_read_b64_tr_b16 a[130:131], v152 offset:17408
    v_mfma_f32_16x16x32_bf16 v[236:239], a[44:47], v[124:127], v[236:239]
    buffer_load_dwordx4 v158, s[44:47], s26 offen offset:2048 sc1 lds
    v_mfma_f32_16x16x32_bf16 v[232:235], a[40:43], v[124:127], v[232:235]
    ds_read_b64_tr_b16 a[132:133], v153 offset:16384
    v_mfma_f32_16x16x32_bf16 v[232:235], a[32:35], v[120:123], v[232:235]
    ds_read_b64_tr_b16 a[134:135], v153 offset:17408
    s_waitcnt lgkmcnt(4)
    v_mfma_f32_16x16x32_bf16 v[192:195], a[48:51], v[80:83], v[192:195]
    s_add_u32 m0, s73, 49152
    s_lshl_b32 s14, s76, 3
    v_mfma_f32_16x16x32_bf16 v[192:195], a[56:59], v[84:87], v[192:195]
    ds_read_b128 v[104:107], v250 offset:768
    v_mfma_f32_16x16x32_bf16 v[196:199], a[60:63], v[84:87], v[196:199]
    ds_read_b128 v[108:111], v250 offset:6912
    buffer_load_dwordx4 v148, s[48:51], s14 offen offset:0 lds
    v_mfma_f32_16x16x32_bf16 v[196:199], a[52:55], v[80:83], v[196:199]
    ds_read_b128 v[112:115], v250 offset:1024
    v_mfma_f32_16x16x32_bf16 v[204:207], a[52:55], v[88:91], v[204:207]
    ds_read_b128 v[116:119], v250 offset:7168
    buffer_load_dwordx4 v149, s[48:51], s14 offen offset:1024 lds
    v_mfma_f32_16x16x32_bf16 v[204:207], a[60:63], v[92:95], v[204:207]
    ds_read_b128 v[120:123], v250 offset:1280
    v_mfma_f32_16x16x32_bf16 v[200:203], a[56:59], v[92:95], v[200:203]
    ds_read_b128 v[124:127], v250 offset:7424
    s_add_u32 s7, s7, 33374208
    v_mov_b32 v28, s7
    v_add_u32 v247, 3072, v246
    v_cmp_eq_u32 vcc, 0, v2
    v_mov_b32 v248, 0x40000000
    s_nop 0
    v_cndmask_b32 v248, v248, 0, vcc
    v_mov_b32 v249, s68
    v_and_b32 v129, 0xffff0000, v144
    v_lshlrev_b32 v128, 16, v144
    v_and_b32 v131, 0xffff0000, v145
    v_lshlrev_b32 v130, 16, v145
    v_and_b32 v133, 0xffff0000, v146
    v_lshlrev_b32 v132, 16, v146
    v_and_b32 v135, 0xffff0000, v147
    v_lshlrev_b32 v134, 16, v147
    s_mul_i32 s4, s70, 43691
    s_lshr_b32 s4, s4, 16
    s_mul_i32 s5, s70, 21846
    s_lshr_b32 s5, s5, 16
    s_mul_i32 s5, s5, 3
    s_sub_u32 s5, s70, s5
    s_lshl2_add_u32 s4, s72, s4
    s_lshl_b32 s4, s4, 9
    s_mul_i32 s7, s72, 9
    s_sub_u32 s7, s69, s7
    s_lshl3_add_u32 s4, s7, s4
    v_mfma_f32_16x16x32_bf16 v[200:203], a[48:51], v[88:91], v[200:203]
    ds_read_b64_tr_b16 a[136:137], v152 offset:24576
    buffer_load_dwordx4 v150, s[48:51], s14 offen offset:2048 lds
    v_mfma_f32_16x16x32_bf16 v[208:211], a[48:51], v[96:99], v[208:211]
    ds_read_b64_tr_b16 a[138:139], v152 offset:25600
    v_mfma_f32_16x16x32_bf16 v[208:211], a[56:59], v[100:103], v[208:211]
    buffer_load_dwordx4 v151, s[48:51], s14 offen offset:3072 lds
    v_mfma_f32_16x16x32_bf16 v[212:215], a[60:63], v[100:103], v[212:215]
    ds_read_b64_tr_b16 a[140:141], v153 offset:24576
    v_mfma_f32_16x16x32_bf16 v[212:215], a[52:55], v[96:99], v[212:215]
    ds_read_b64_tr_b16 a[142:143], v153 offset:25600
    s_waitcnt lgkmcnt(4)
    v_mfma_f32_16x16x32_bf16 v[220:223], a[52:55], v[104:107], v[220:223]
    s_waitcnt vmcnt(16)
    s_barrier
    v_mfma_f32_16x16x32_bf16 v[220:223], a[60:63], v[108:111], v[220:223]
    ds_read_b128 v[80:83], v250 offset:12288
    s_add_u32 m0, s74, 36864
    v_mfma_f32_16x16x32_bf16 v[216:219], a[56:59], v[108:111], v[216:219]
    ds_read_b128 v[84:87], v250 offset:18432
    v_mfma_f32_16x16x32_bf16 v[216:219], a[48:51], v[104:107], v[216:219]
    ds_read_b128 v[88:91], v250 offset:12544
    buffer_load_dwordx4 v156, s[44:47], s27 offen offset:0 sc1 lds
    v_mfma_f32_16x16x32_bf16 v[224:227], a[48:51], v[112:115], v[224:227]
    ds_read_b128 v[92:95], v250 offset:18688
    v_mfma_f32_16x16x32_bf16 v[224:227], a[56:59], v[116:119], v[224:227]
    ds_read_b128 v[96:99], v250 offset:12800
    v_mfma_f32_16x16x32_bf16 v[228:231], a[60:63], v[116:119], v[228:231]
    ds_read_b128 v[100:103], v250 offset:18944
    buffer_load_dwordx4 v157, s[44:47], s27 offen offset:1024 sc1 lds
    s_add_u32 s4, s4, 12566528
    s_cmp_eq_u32 s5, 1
    s_cselect_b32 s7, 8, 4
    s_cmp_lg_u32 s5, 0
    s_cselect_b32 s5, 4, 0
    v_lshlrev_b32 v17, 7, v0
    v_add_u32 v17, s4, v17
    v_cmp_gt_u32 vcc, 4, v0
    v_mov_b32 v24, s5
    s_nop 0
    v_cndmask_b32 v24, 0, v24, vcc
    v_add_u32 v17, v17, v24
    v_cmp_gt_u32 vcc, s7, v0
    v_mov_b32 v24, 0x40000000
    s_nop 0
    v_cndmask_b32 v17, v24, v17, vcc
    s_bfe_u32 s4, s2, 0x20003
    s_lshl2_add_u32 s4, s72, s4
    s_lshl_b32 s4, s4, 2
    s_lshr_b32 s5, s2, 4
    s_and_b32 s5, s5, 2
    s_add_u32 s4, s4, s5
    s_and_b32 s5, s2, 1
    s_add_u32 s4, s4, s5
    s_lshl_b32 s4, s4, 7
    s_add_u32 s4, s4, 12566528
    v_lshl_add_u32 v15, v2, 2, s4
    s_cmp_eq_u32 s3, 0
    s_cselect_b32 s4, 18, 0
    v_cmp_gt_u32 vcc, s4, v2
    v_mov_b32 v13, 0x40000000
    v_mfma_f32_16x16x32_bf16 v[228:231], a[52:55], v[112:115], v[228:231]
    ds_read_b64_tr_b16 a[144:145], v152 offset:32768
    v_mfma_f32_16x16x32_bf16 v[236:239], a[52:55], v[120:123], v[236:239]
    ds_read_b64_tr_b16 a[146:147], v152 offset:33792
    v_mfma_f32_16x16x32_bf16 v[236:239], a[60:63], v[124:127], v[236:239]
    buffer_load_dwordx4 v158, s[44:47], s27 offen offset:2048 sc1 lds
    v_mfma_f32_16x16x32_bf16 v[232:235], a[56:59], v[124:127], v[232:235]
    ds_read_b64_tr_b16 a[148:149], v153 offset:32768
    v_mfma_f32_16x16x32_bf16 v[232:235], a[48:51], v[120:123], v[232:235]
    ds_read_b64_tr_b16 a[150:151], v153 offset:33792
    s_waitcnt lgkmcnt(4)
    v_mfma_f32_16x16x32_bf16 v[192:195], a[64:67], v[80:83], v[192:195]
    s_add_u32 m0, s73, 65536
    s_lshl_b32 s14, s77, 3
    v_mfma_f32_16x16x32_bf16 v[192:195], a[72:75], v[84:87], v[192:195]
    ds_read_b128 v[104:107], v250 offset:13056
    v_mfma_f32_16x16x32_bf16 v[196:199], a[76:79], v[84:87], v[196:199]
    ds_read_b128 v[108:111], v250 offset:19200
    buffer_load_dwordx4 v148, s[48:51], s14 offen offset:0 lds
    v_mfma_f32_16x16x32_bf16 v[196:199], a[68:71], v[80:83], v[196:199]
    ds_read_b128 v[112:115], v250 offset:13312
    v_mfma_f32_16x16x32_bf16 v[204:207], a[68:71], v[88:91], v[204:207]
    ds_read_b128 v[116:119], v250 offset:19456
    buffer_load_dwordx4 v149, s[48:51], s14 offen offset:1024 lds
    v_mfma_f32_16x16x32_bf16 v[204:207], a[76:79], v[92:95], v[204:207]
    ds_read_b128 v[120:123], v250 offset:13568
    v_mfma_f32_16x16x32_bf16 v[200:203], a[72:75], v[92:95], v[200:203]
    ds_read_b128 v[124:127], v250 offset:19712
    v_cndmask_b32 v15, v13, v15, vcc
    v_mov_b32 v13, s68
    v_cndmask_b32 v13, 0, v13, vcc
    v_and_b32 v24, 15, v2
    v_lshrrev_b32 v25, 4, v2
    v_mul_u32_u24 v25, 17408, v25
    v_lshl_add_u32 v24, v24, 4, v25
    s_mul_i32 s7, s72, 36
    s_and_b32 s8, s3, 1
    s_add_u32 s7, s7, s8
    s_mul_i32 s7, s7, 69632
    s_bfe_u32 s8, s2, 0x20003
    s_lshl_b32 s8, s8, 12
    s_add_u32 s7, s7, s8
    s_add_u32 s7, s7, 12795904
    v_add_u32 v23, s7, v24
    s_xor_b32 s7, s72, 0
    v_lshl_add_u32 v19, s7, 10, v23
    s_xor_b32 s7, s72, 1
    v_lshl_add_u32 v20, s7, 10, v23
    s_xor_b32 s7, s72, 2
    v_lshl_add_u32 v21, s7, 10, v23
    s_xor_b32 s7, s72, 3
    v_lshl_add_u32 v22, s7, 10, v23
    v_lshlrev_b32 v14, 4, v2
    v_add_u32 v14, 98304, v14
    v_add_u32 v1, 0x10000, v14
    v_mfma_f32_16x16x32_bf16 v[200:203], a[64:67], v[88:91], v[200:203]
    ds_read_b64_tr_b16 a[152:153], v152 offset:40960
    buffer_load_dwordx4 v150, s[48:51], s14 offen offset:2048 lds
    v_mfma_f32_16x16x32_bf16 v[208:211], a[64:67], v[96:99], v[208:211]
    ds_read_b64_tr_b16 a[154:155], v152 offset:41984
    v_mfma_f32_16x16x32_bf16 v[208:211], a[72:75], v[100:103], v[208:211]
    buffer_load_dwordx4 v151, s[48:51], s14 offen offset:3072 lds
    v_mfma_f32_16x16x32_bf16 v[212:215], a[76:79], v[100:103], v[212:215]
    ds_read_b64_tr_b16 a[156:157], v153 offset:40960
    v_mfma_f32_16x16x32_bf16 v[212:215], a[68:71], v[96:99], v[212:215]
    ds_read_b64_tr_b16 a[158:159], v153 offset:41984
    s_waitcnt lgkmcnt(4)
    v_mfma_f32_16x16x32_bf16 v[220:223], a[68:71], v[104:107], v[220:223]
    s_waitcnt vmcnt(20)
    s_barrier
    v_mfma_f32_16x16x32_bf16 v[220:223], a[76:79], v[108:111], v[220:223]
    ds_read_b128 v[80:83], v250 offset:24576
    s_add_u32 m0, s74, 49152
    v_mfma_f32_16x16x32_bf16 v[216:219], a[72:75], v[108:111], v[216:219]
    ds_read_b128 v[84:87], v250 offset:30720
    v_mfma_f32_16x16x32_bf16 v[216:219], a[64:67], v[104:107], v[216:219]
    ds_read_b128 v[88:91], v250 offset:24832
    buffer_load_dwordx4 v156, s[44:47], s76 offen offset:0 sc1 lds
    v_mfma_f32_16x16x32_bf16 v[224:227], a[64:67], v[112:115], v[224:227]
    ds_read_b128 v[92:95], v250 offset:30976
    v_mfma_f32_16x16x32_bf16 v[224:227], a[72:75], v[116:119], v[224:227]
    ds_read_b128 v[96:99], v250 offset:25088
    v_mfma_f32_16x16x32_bf16 v[228:231], a[76:79], v[116:119], v[228:231]
    ds_read_b128 v[100:103], v250 offset:31232
    buffer_load_dwordx4 v157, s[44:47], s76 offen offset:1024 sc1 lds
    s_mov_b32 s56, s16
    s_and_b32 s57, s17, 0xffff
    s_mov_b32 s58, 2359296
    s_mov_b32 s59, 0x20000
    s_mov_b32 s40, 18432
    s_mov_b32 s42, 12386304
    s_mov_b32 s64, s38
    s_and_b32 s65, s39, 0xffff
    s_mov_b32 s66, 2359296
    s_mov_b32 s67, 0x20000
    v_lshlrev_b32 v136, 4, v2
    s_mul_i32 s7, s72, 36
    s_bitcmp1_b32 s3, 0
    s_addc_u32 s7, s7, 0
    s_lshl_b32 s7, s7, 17
    v_subrev_u32 v184, s7, v4
    v_subrev_u32 v185, s7, v5
    s_bfe_u32 s4, s2, 0x20003
    s_mul_i32 s4, s4, 9
    s_lshl1_add_u32 s7, s72, s4
    s_and_b32 s8, s3, 1
    s_add_u32 s7, s7, s8
    s_lshl_b32 s37, s7, 16
    s_add_u32 s37, s37, 4718592
    s_add_u32 s4, s4, 8
    s_lshl_b32 s16, s4, 16
    s_add_u32 s16, s16, 4718592
    v_mfma_f32_16x16x32_bf16 v[228:231], a[68:71], v[112:115], v[228:231]
    v_mfma_f32_16x16x32_bf16 v[236:239], a[68:71], v[120:123], v[236:239]
    v_mfma_f32_16x16x32_bf16 v[236:239], a[76:79], v[124:127], v[236:239]
    buffer_load_dwordx4 v158, s[44:47], s76 offen offset:2048 sc1 lds
    v_mfma_f32_16x16x32_bf16 v[232:235], a[72:75], v[124:127], v[232:235]
    v_mfma_f32_16x16x32_bf16 v[232:235], a[64:67], v[120:123], v[232:235]
    s_waitcnt lgkmcnt(0)
    v_mfma_f32_16x16x32_bf16 v[192:195], a[80:83], v[80:83], v[192:195]
    s_add_u32 m0, s73, 0
    s_lshl_b32 s14, s78, 3
    v_mfma_f32_16x16x32_bf16 v[192:195], a[88:91], v[84:87], v[192:195]
    ds_read_b128 v[104:107], v250 offset:25344
    v_mfma_f32_16x16x32_bf16 v[196:199], a[92:95], v[84:87], v[196:199]
    ds_read_b128 v[108:111], v250 offset:31488
    buffer_load_dwordx4 v148, s[48:51], s14 offen offset:0 lds
    v_mfma_f32_16x16x32_bf16 v[196:199], a[84:87], v[80:83], v[196:199]
    ds_read_b128 v[112:115], v250 offset:25600
    v_mfma_f32_16x16x32_bf16 v[204:207], a[84:87], v[88:91], v[204:207]
    ds_read_b128 v[116:119], v250 offset:31744
    buffer_load_dwordx4 v149, s[48:51], s14 offen offset:1024 lds
    v_mfma_f32_16x16x32_bf16 v[204:207], a[92:95], v[92:95], v[204:207]
    ds_read_b128 v[120:123], v250 offset:25856
    v_mfma_f32_16x16x32_bf16 v[200:203], a[88:91], v[92:95], v[200:203]
    ds_read_b128 v[124:127], v250 offset:32000
    s_sub_u32 s4, s4, s7
    s_lshl_b32 s4, s4, 7
    s_lshl_b32 s7, s7, 7
    s_add_u32 s7, s7, 12582912
    v_bfe_u32 v24, v2, 2, 1
    v_mul_u32_u24 v24, s4, v24
    v_and_b32 v25, 3, v2
    v_lshl_add_u32 v24, v25, 2, v24
    v_add_u32 v188, s7, v24
    s_lshl2_add_u32 s7, s2, s3
    s_mul_i32 s8, s7, 3072
    s_add_u32 s34, s8, 40828928
    s_add_u32 s11, s8, 43974656
    s_add_u32 s12, s8, 47120384
    s_lshl_b32 s35, s7, 12
    s_add_u32 s35, s35, 50266112
L_pl_G_2:
    s_cbranch_execz L_pl_G_6
    s_xor_b32 s8, s7, 8
    s_mul_i32 s8, s8, 3072
    s_add_u32 s30, s8, 40828928
    s_xor_b32 s8, s7, 16
    s_mul_i32 s8, s8, 3072
    s_add_u32 s15, s8, 43974656
    s_xor_b32 s8, s7, 24
    s_mul_i32 s8, s8, 3072
    s_add_u32 s31, s8, 47120384
    s_andn2_b32 s7, s7, 24
    v_mfma_f32_16x16x32_bf16 v[200:203], a[80:83], v[88:91], v[200:203]
    buffer_load_dwordx4 v150, s[48:51], s14 offen offset:2048 lds
    v_mfma_f32_16x16x32_bf16 v[208:211], a[80:83], v[96:99], v[208:211]
    v_mfma_f32_16x16x32_bf16 v[208:211], a[88:91], v[100:103], v[208:211]
    buffer_load_dwordx4 v151, s[48:51], s14 offen offset:3072 lds
    v_mfma_f32_16x16x32_bf16 v[212:215], a[92:95], v[100:103], v[212:215]
    v_mfma_f32_16x16x32_bf16 v[212:215], a[84:87], v[96:99], v[212:215]
    s_waitcnt lgkmcnt(0)
    v_mfma_f32_16x16x32_bf16 v[220:223], a[84:87], v[104:107], v[220:223]
    s_waitcnt vmcnt(14)
    s_barrier
    v_mfma_f32_16x16x32_bf16 v[220:223], a[92:95], v[108:111], v[220:223]
    ds_read_b128 v[80:83], v159 offset:0
    s_add_u32 m0, s74, 61440
    v_mfma_f32_16x16x32_bf16 v[216:219], a[88:91], v[108:111], v[216:219]
    ds_read_b128 v[84:87], v159 offset:6144
    v_mfma_f32_16x16x32_bf16 v[216:219], a[80:83], v[104:107], v[216:219]
    ds_read_b128 v[88:91], v159 offset:256
    buffer_load_dwordx4 v156, s[44:47], s77 offen offset:0 sc1 lds
    v_mfma_f32_16x16x32_bf16 v[224:227], a[80:83], v[112:115], v[224:227]
    ds_read_b128 v[92:95], v159 offset:6400
    v_mfma_f32_16x16x32_bf16 v[224:227], a[88:91], v[116:119], v[224:227]
    ds_read_b128 v[96:99], v159 offset:512
    v_mfma_f32_16x16x32_bf16 v[228:231], a[92:95], v[116:119], v[228:231]
    ds_read_b128 v[100:103], v159 offset:6656
    buffer_load_dwordx4 v157, s[44:47], s77 offen offset:1024 sc1 lds
    s_lshl3_add_u32 s7, s3, s7
    s_lshl2_add_u32 s8, s7, s72
    s_lshl_b32 s8, s8, 10
    s_add_u32 s32, s8, 50266112
    s_xor_b32 s8, s8, 4096
    s_add_u32 s33, s8, 50266112
    s_xor_b32 s8, s3, s72
    s_cmp_lt_u32 s8, 2
    s_cselect_b32 s35, s35, 0x40000000
    s_cselect_b32 s16, s16, 0x40000000
    s_cselect_b32 s36, s68, 0
    s_mov_b32 s38, 0xbfb8aa3b
    s_and_b32 s8, s8, 1
    s_mul_i32 s41, s8, 96
    s_and_b32 s43, s73, 4096
    v_lshlrev_b32 v24, 10, v2
    v_add_u32 v24, s35, v24
    s_add_u32 s7, s34, 2048
    v_mov_b32 v25, s36
    v_cmp_gt_u32 vcc, 4, v2
    s_nop 1
    v_cndmask_b32 v138, 0, v25, vcc
    v_mov_b32 v25, 0x40000000
    v_cndmask_b32 v137, v25, v24, vcc
    v_writelane_b32 v137, s7, 4
    v_writelane_b32 v138, s68, 4
    v_min_u32 v139, 1, v2
    v_lshlrev_b32 v139, 30, v139
    v_mov_b32 v140, 0
    v_writelane_b32 v140, s68, 0
    v_mfma_f32_16x16x32_bf16 v[228:231], a[84:87], v[112:115], v[228:231]
    ds_read_b64_tr_b16 a[160:161], v152 offset:49152
    v_mfma_f32_16x16x32_bf16 v[236:239], a[84:87], v[120:123], v[236:239]
    ds_read_b64_tr_b16 a[162:163], v152 offset:50176
    v_mfma_f32_16x16x32_bf16 v[236:239], a[92:95], v[124:127], v[236:239]
    buffer_load_dwordx4 v158, s[44:47], s77 offen offset:2048 sc1 lds
    v_mfma_f32_16x16x32_bf16 v[232:235], a[88:91], v[124:127], v[232:235]
    ds_read_b64_tr_b16 a[164:165], v153 offset:49152
    v_mfma_f32_16x16x32_bf16 v[232:235], a[80:83], v[120:123], v[232:235]
    ds_read_b64_tr_b16 a[166:167], v153 offset:50176
    s_waitcnt lgkmcnt(4)
    v_mfma_f32_16x16x32_bf16 v[192:195], a[96:99], v[80:83], v[192:195]
    s_add_u32 m0, s73, 16384
    s_lshl_b32 s14, s79, 3
    v_mfma_f32_16x16x32_bf16 v[192:195], a[104:107], v[84:87], v[192:195]
    ds_read_b128 v[104:107], v159 offset:768
    v_mfma_f32_16x16x32_bf16 v[196:199], a[108:111], v[84:87], v[196:199]
    ds_read_b128 v[108:111], v159 offset:6912
    buffer_load_dwordx4 v148, s[48:51], s14 offen offset:0 lds
    v_mfma_f32_16x16x32_bf16 v[196:199], a[100:103], v[80:83], v[196:199]
    ds_read_b128 v[112:115], v159 offset:1024
    v_mfma_f32_16x16x32_bf16 v[204:207], a[100:103], v[88:91], v[204:207]
    ds_read_b128 v[116:119], v159 offset:7168
    buffer_load_dwordx4 v149, s[48:51], s14 offen offset:1024 lds
    v_mfma_f32_16x16x32_bf16 v[204:207], a[108:111], v[92:95], v[204:207]
    ds_read_b128 v[120:123], v159 offset:1280
    v_mfma_f32_16x16x32_bf16 v[200:203], a[104:107], v[92:95], v[200:203]
    ds_read_b128 v[124:127], v159 offset:7424
    v_mfma_f32_16x16x32_bf16 v[200:203], a[96:99], v[88:91], v[200:203]
    ds_read_b64_tr_b16 a[168:169], v152 offset:57344
    buffer_load_dwordx4 v150, s[48:51], s14 offen offset:2048 lds
    v_mfma_f32_16x16x32_bf16 v[208:211], a[96:99], v[96:99], v[208:211]
    ds_read_b64_tr_b16 a[170:171], v152 offset:58368
    v_mfma_f32_16x16x32_bf16 v[208:211], a[104:107], v[100:103], v[208:211]
    buffer_load_dwordx4 v151, s[48:51], s14 offen offset:3072 lds
    v_mfma_f32_16x16x32_bf16 v[212:215], a[108:111], v[100:103], v[212:215]
    ds_read_b64_tr_b16 a[172:173], v153 offset:57344
    v_mfma_f32_16x16x32_bf16 v[212:215], a[100:103], v[96:99], v[212:215]
    ds_read_b64_tr_b16 a[174:175], v153 offset:58368
    s_waitcnt lgkmcnt(4)
    v_mfma_f32_16x16x32_bf16 v[220:223], a[100:103], v[104:107], v[220:223]
    s_waitcnt vmcnt(14)
    s_barrier
    v_mfma_f32_16x16x32_bf16 v[220:223], a[108:111], v[108:111], v[220:223]
    ds_read_b128 v[80:83], v159 offset:12288
    s_add_u32 m0, s74, 0
    v_mfma_f32_16x16x32_bf16 v[216:219], a[104:107], v[108:111], v[216:219]
    ds_read_b128 v[84:87], v159 offset:18432
    v_mfma_f32_16x16x32_bf16 v[216:219], a[96:99], v[104:107], v[216:219]
    ds_read_b128 v[88:91], v159 offset:12544
    buffer_load_dwordx4 v156, s[44:47], s78 offen offset:0 sc1 lds
    v_mfma_f32_16x16x32_bf16 v[224:227], a[96:99], v[112:115], v[224:227]
    ds_read_b128 v[92:95], v159 offset:18688
    v_mfma_f32_16x16x32_bf16 v[224:227], a[104:107], v[116:119], v[224:227]
    ds_read_b128 v[96:99], v159 offset:12800
    v_mfma_f32_16x16x32_bf16 v[228:231], a[108:111], v[116:119], v[228:231]
    ds_read_b128 v[100:103], v159 offset:18944
    buffer_load_dwordx4 v157, s[44:47], s78 offen offset:1024 sc1 lds
    v_mfma_f32_16x16x32_bf16 v[228:231], a[100:103], v[112:115], v[228:231]
    ds_read_b64_tr_b16 a[176:177], v154 offset:0
    v_mfma_f32_16x16x32_bf16 v[236:239], a[100:103], v[120:123], v[236:239]
    ds_read_b64_tr_b16 a[178:179], v154 offset:1024
    v_mfma_f32_16x16x32_bf16 v[236:239], a[108:111], v[124:127], v[236:239]
    buffer_load_dwordx4 v158, s[44:47], s78 offen offset:2048 sc1 lds
    v_mfma_f32_16x16x32_bf16 v[232:235], a[104:107], v[124:127], v[232:235]
    ds_read_b64_tr_b16 a[180:181], v155 offset:0
    v_mfma_f32_16x16x32_bf16 v[232:235], a[96:99], v[120:123], v[232:235]
    ds_read_b64_tr_b16 a[182:183], v155 offset:1024
    s_waitcnt lgkmcnt(4)
    v_mfma_f32_16x16x32_bf16 v[192:195], a[112:115], v[80:83], v[192:195]
    s_add_u32 m0, s73, 32768
    s_lshl_b32 s14, s80, 3
    v_mfma_f32_16x16x32_bf16 v[192:195], a[120:123], v[84:87], v[192:195]
    ds_read_b128 v[104:107], v159 offset:13056
    v_mfma_f32_16x16x32_bf16 v[196:199], a[124:127], v[84:87], v[196:199]
    ds_read_b128 v[108:111], v159 offset:19200
    buffer_load_dwordx4 v148, s[48:51], s14 offen offset:0 lds
    v_mfma_f32_16x16x32_bf16 v[196:199], a[116:119], v[80:83], v[196:199]
    ds_read_b128 v[112:115], v159 offset:13312
    v_mfma_f32_16x16x32_bf16 v[204:207], a[116:119], v[88:91], v[204:207]
    ds_read_b128 v[116:119], v159 offset:19456
    buffer_load_dwordx4 v149, s[48:51], s14 offen offset:1024 lds
    v_mfma_f32_16x16x32_bf16 v[204:207], a[124:127], v[92:95], v[204:207]
    ds_read_b128 v[120:123], v159 offset:13568
    v_mfma_f32_16x16x32_bf16 v[200:203], a[120:123], v[92:95], v[200:203]
    ds_read_b128 v[124:127], v159 offset:19712
    v_mfma_f32_16x16x32_bf16 v[200:203], a[112:115], v[88:91], v[200:203]
    ds_read_b64_tr_b16 a[184:185], v154 offset:8192
    buffer_load_dwordx4 v150, s[48:51], s14 offen offset:2048 lds
    v_mfma_f32_16x16x32_bf16 v[208:211], a[112:115], v[96:99], v[208:211]
    ds_read_b64_tr_b16 a[186:187], v154 offset:9216
    v_mfma_f32_16x16x32_bf16 v[208:211], a[120:123], v[100:103], v[208:211]
    buffer_load_dwordx4 v151, s[48:51], s14 offen offset:3072 lds
    v_mfma_f32_16x16x32_bf16 v[212:215], a[124:127], v[100:103], v[212:215]
    ds_read_b64_tr_b16 a[188:189], v155 offset:8192
    v_mfma_f32_16x16x32_bf16 v[212:215], a[116:119], v[96:99], v[212:215]
    ds_read_b64_tr_b16 a[190:191], v155 offset:9216
    s_waitcnt lgkmcnt(4)
    v_mfma_f32_16x16x32_bf16 v[220:223], a[116:119], v[104:107], v[220:223]
    s_waitcnt vmcnt(14)
    s_barrier
    v_mfma_f32_16x16x32_bf16 v[220:223], a[124:127], v[108:111], v[220:223]
    ds_read_b128 v[80:83], v159 offset:24576
    s_add_u32 m0, s74, 12288
    v_mfma_f32_16x16x32_bf16 v[216:219], a[120:123], v[108:111], v[216:219]
    ds_read_b128 v[84:87], v159 offset:30720
    v_mfma_f32_16x16x32_bf16 v[216:219], a[112:115], v[104:107], v[216:219]
    ds_read_b128 v[88:91], v159 offset:24832
    buffer_load_dwordx4 v156, s[44:47], s79 offen offset:0 sc1 lds
    v_mfma_f32_16x16x32_bf16 v[224:227], a[112:115], v[112:115], v[224:227]
    ds_read_b128 v[92:95], v159 offset:30976
    v_mfma_f32_16x16x32_bf16 v[224:227], a[120:123], v[116:119], v[224:227]
    ds_read_b128 v[96:99], v159 offset:25088
    v_mfma_f32_16x16x32_bf16 v[228:231], a[124:127], v[116:119], v[228:231]
    ds_read_b128 v[100:103], v159 offset:31232
    buffer_load_dwordx4 v157, s[44:47], s79 offen offset:1024 sc1 lds
    v_mfma_f32_16x16x32_bf16 v[228:231], a[116:119], v[112:115], v[228:231]
    ds_read_b64_tr_b16 a[192:193], v152 offset:0
    v_mfma_f32_16x16x32_bf16 v[236:239], a[116:119], v[120:123], v[236:239]
    ds_read_b64_tr_b16 a[194:195], v152 offset:1024
    v_mfma_f32_16x16x32_bf16 v[236:239], a[124:127], v[124:127], v[236:239]
    buffer_load_dwordx4 v158, s[44:47], s79 offen offset:2048 sc1 lds
    v_mfma_f32_16x16x32_bf16 v[232:235], a[120:123], v[124:127], v[232:235]
    ds_read_b64_tr_b16 a[196:197], v153 offset:0
    v_mfma_f32_16x16x32_bf16 v[232:235], a[112:115], v[120:123], v[232:235]
    ds_read_b64_tr_b16 a[198:199], v153 offset:1024
    s_waitcnt lgkmcnt(4)
    v_mfma_f32_16x16x32_bf16 v[192:195], a[128:131], v[80:83], v[192:195]
    s_add_u32 m0, s73, 49152
    s_lshl_b32 s14, s81, 3
    v_mfma_f32_16x16x32_bf16 v[192:195], a[136:139], v[84:87], v[192:195]
    ds_read_b128 v[104:107], v159 offset:25344
    v_mfma_f32_16x16x32_bf16 v[196:199], a[140:143], v[84:87], v[196:199]
    ds_read_b128 v[108:111], v159 offset:31488
    buffer_load_dwordx4 v148, s[48:51], s14 offen offset:0 lds
    v_mfma_f32_16x16x32_bf16 v[196:199], a[132:135], v[80:83], v[196:199]
    ds_read_b128 v[112:115], v159 offset:25600
    v_mfma_f32_16x16x32_bf16 v[204:207], a[132:135], v[88:91], v[204:207]
    ds_read_b128 v[116:119], v159 offset:31744
    buffer_load_dwordx4 v149, s[48:51], s14 offen offset:1024 lds
    v_mfma_f32_16x16x32_bf16 v[204:207], a[140:143], v[92:95], v[204:207]
    ds_read_b128 v[120:123], v159 offset:25856
    v_mfma_f32_16x16x32_bf16 v[200:203], a[136:139], v[92:95], v[200:203]
    ds_read_b128 v[124:127], v159 offset:32000
    v_mfma_f32_16x16x32_bf16 v[200:203], a[128:131], v[88:91], v[200:203]
    ds_read_b64_tr_b16 a[200:201], v152 offset:8192
    buffer_load_dwordx4 v150, s[48:51], s14 offen offset:2048 lds
    v_mfma_f32_16x16x32_bf16 v[208:211], a[128:131], v[96:99], v[208:211]
    ds_read_b64_tr_b16 a[202:203], v152 offset:9216
    v_mfma_f32_16x16x32_bf16 v[208:211], a[136:139], v[100:103], v[208:211]
    buffer_load_dwordx4 v151, s[48:51], s14 offen offset:3072 lds
    v_mfma_f32_16x16x32_bf16 v[212:215], a[140:143], v[100:103], v[212:215]
    ds_read_b64_tr_b16 a[204:205], v153 offset:8192
    v_mfma_f32_16x16x32_bf16 v[212:215], a[132:135], v[96:99], v[212:215]
    ds_read_b64_tr_b16 a[206:207], v153 offset:9216
    s_waitcnt lgkmcnt(4)
    v_mfma_f32_16x16x32_bf16 v[220:223], a[132:135], v[104:107], v[220:223]
    s_waitcnt vmcnt(14)
    s_barrier
    v_mfma_f32_16x16x32_bf16 v[220:223], a[140:143], v[108:111], v[220:223]
    ds_read_b128 v[80:83], v250 offset:0
    s_add_u32 m0, s74, 24576
    v_mfma_f32_16x16x32_bf16 v[216:219], a[136:139], v[108:111], v[216:219]
    ds_read_b128 v[84:87], v250 offset:6144
    v_mfma_f32_16x16x32_bf16 v[216:219], a[128:131], v[104:107], v[216:219]
    ds_read_b128 v[88:91], v250 offset:256
    buffer_load_dwordx4 v156, s[44:47], s80 offen offset:0 sc1 lds
    v_mfma_f32_16x16x32_bf16 v[224:227], a[128:131], v[112:115], v[224:227]
    ds_read_b128 v[92:95], v250 offset:6400
    v_mfma_f32_16x16x32_bf16 v[224:227], a[136:139], v[116:119], v[224:227]
    ds_read_b128 v[96:99], v250 offset:512
    v_mfma_f32_16x16x32_bf16 v[228:231], a[140:143], v[116:119], v[228:231]
    ds_read_b128 v[100:103], v250 offset:6656
    buffer_load_dwordx4 v157, s[44:47], s80 offen offset:1024 sc1 lds
    v_mfma_f32_16x16x32_bf16 v[228:231], a[132:135], v[112:115], v[228:231]
    ds_read_b64_tr_b16 a[208:209], v152 offset:16384
    v_mfma_f32_16x16x32_bf16 v[236:239], a[132:135], v[120:123], v[236:239]
    ds_read_b64_tr_b16 a[210:211], v152 offset:17408
    v_mfma_f32_16x16x32_bf16 v[236:239], a[140:143], v[124:127], v[236:239]
    buffer_load_dwordx4 v158, s[44:47], s80 offen offset:2048 sc1 lds
    v_mfma_f32_16x16x32_bf16 v[232:235], a[136:139], v[124:127], v[232:235]
    ds_read_b64_tr_b16 a[212:213], v153 offset:16384
    v_mfma_f32_16x16x32_bf16 v[232:235], a[128:131], v[120:123], v[232:235]
    ds_read_b64_tr_b16 a[214:215], v153 offset:17408
    s_waitcnt lgkmcnt(4)
    v_mfma_f32_16x16x32_bf16 v[192:195], a[144:147], v[80:83], v[192:195]
    s_add_u32 m0, s73, 65536
    s_lshl_b32 s14, s84, 18
    v_mfma_f32_16x16x32_bf16 v[192:195], a[152:155], v[84:87], v[192:195]
    ds_read_b128 v[104:107], v250 offset:768
    v_mfma_f32_16x16x32_bf16 v[196:199], a[156:159], v[84:87], v[196:199]
    ds_read_b128 v[108:111], v250 offset:6912
    buffer_load_dwordx4 v4, s[52:55], s14 offen offset:0 lds
    v_mfma_f32_16x16x32_bf16 v[196:199], a[148:151], v[80:83], v[196:199]
    ds_read_b128 v[112:115], v250 offset:1024
    v_mfma_f32_16x16x32_bf16 v[204:207], a[148:151], v[88:91], v[204:207]
    ds_read_b128 v[116:119], v250 offset:7168
    buffer_load_dwordx4 v5, s[52:55], s14 offen offset:1024 lds
    v_mfma_f32_16x16x32_bf16 v[204:207], a[156:159], v[92:95], v[204:207]
    ds_read_b128 v[120:123], v250 offset:1280
    v_mfma_f32_16x16x32_bf16 v[200:203], a[152:155], v[92:95], v[200:203]
    ds_read_b128 v[124:127], v250 offset:7424
    v_mfma_f32_16x16x32_bf16 v[200:203], a[144:147], v[88:91], v[200:203]
    ds_read_b64_tr_b16 a[216:217], v152 offset:24576
    buffer_load_dwordx4 v6, s[52:55], s14 offen offset:2048 lds
    v_mfma_f32_16x16x32_bf16 v[208:211], a[144:147], v[96:99], v[208:211]
    ds_read_b64_tr_b16 a[218:219], v152 offset:25600
    v_mfma_f32_16x16x32_bf16 v[208:211], a[152:155], v[100:103], v[208:211]
    buffer_load_dwordx4 v7, s[52:55], s14 offen offset:3072 lds
    v_mfma_f32_16x16x32_bf16 v[212:215], a[156:159], v[100:103], v[212:215]
    ds_read_b64_tr_b16 a[220:221], v153 offset:24576
    v_mfma_f32_16x16x32_bf16 v[212:215], a[148:151], v[96:99], v[212:215]
    ds_read_b64_tr_b16 a[222:223], v153 offset:25600
    s_waitcnt lgkmcnt(4)
    v_mfma_f32_16x16x32_bf16 v[220:223], a[148:151], v[104:107], v[220:223]
    s_waitcnt vmcnt(14)
    s_barrier
    v_mfma_f32_16x16x32_bf16 v[220:223], a[156:159], v[108:111], v[220:223]
    ds_read_b128 v[80:83], v250 offset:12288
    v_mfma_f32_16x16x32_bf16 v[216:219], a[152:155], v[108:111], v[216:219]
    ds_read_b128 v[84:87], v250 offset:18432
    v_mfma_f32_16x16x32_bf16 v[216:219], a[144:147], v[104:107], v[216:219]
    ds_read_b128 v[88:91], v250 offset:12544
    v_mfma_f32_16x16x32_bf16 v[224:227], a[144:147], v[112:115], v[224:227]
    ds_read_b128 v[92:95], v250 offset:18688
    v_mfma_f32_16x16x32_bf16 v[224:227], a[152:155], v[116:119], v[224:227]
    ds_read_b128 v[96:99], v250 offset:12800
    v_mfma_f32_16x16x32_bf16 v[228:231], a[156:159], v[116:119], v[228:231]
    ds_read_b128 v[100:103], v250 offset:18944
    v_mfma_f32_16x16x32_bf16 v[228:231], a[148:151], v[112:115], v[228:231]
    ds_read_b64_tr_b16 a[224:225], v152 offset:32768
    v_mfma_f32_16x16x32_bf16 v[236:239], a[148:151], v[120:123], v[236:239]
    ds_read_b64_tr_b16 a[226:227], v152 offset:33792
    v_mfma_f32_16x16x32_bf16 v[236:239], a[156:159], v[124:127], v[236:239]
    v_mfma_f32_16x16x32_bf16 v[232:235], a[152:155], v[124:127], v[232:235]
    ds_read_b64_tr_b16 a[228:229], v153 offset:32768
    v_mfma_f32_16x16x32_bf16 v[232:235], a[144:147], v[120:123], v[232:235]
    ds_read_b64_tr_b16 a[230:231], v153 offset:33792
    s_waitcnt lgkmcnt(4)
    v_mfma_f32_16x16x32_bf16 v[192:195], a[160:163], v[80:83], v[192:195]
    v_mfma_f32_16x16x32_bf16 v[192:195], a[168:171], v[84:87], v[192:195]
    ds_read_b128 v[104:107], v250 offset:13056
    v_mfma_f32_16x16x32_bf16 v[196:199], a[172:175], v[84:87], v[196:199]
    ds_read_b128 v[108:111], v250 offset:19200
    v_mfma_f32_16x16x32_bf16 v[196:199], a[164:167], v[80:83], v[196:199]
    ds_read_b128 v[112:115], v250 offset:13312
    v_mfma_f32_16x16x32_bf16 v[204:207], a[164:167], v[88:91], v[204:207]
    ds_read_b128 v[116:119], v250 offset:19456
    v_mfma_f32_16x16x32_bf16 v[204:207], a[172:175], v[92:95], v[204:207]
    ds_read_b128 v[120:123], v250 offset:13568
    v_mfma_f32_16x16x32_bf16 v[200:203], a[168:171], v[92:95], v[200:203]
    ds_read_b128 v[124:127], v250 offset:19712
    v_mfma_f32_16x16x32_bf16 v[200:203], a[160:163], v[88:91], v[200:203]
    ds_read_b64_tr_b16 a[232:233], v152 offset:40960
    v_mfma_f32_16x16x32_bf16 v[208:211], a[160:163], v[96:99], v[208:211]
    ds_read_b64_tr_b16 a[234:235], v152 offset:41984
    v_mfma_f32_16x16x32_bf16 v[208:211], a[168:171], v[100:103], v[208:211]
    v_mfma_f32_16x16x32_bf16 v[212:215], a[172:175], v[100:103], v[212:215]
    ds_read_b64_tr_b16 a[236:237], v153 offset:40960
    v_mfma_f32_16x16x32_bf16 v[212:215], a[164:167], v[96:99], v[212:215]
    ds_read_b64_tr_b16 a[238:239], v153 offset:41984
    s_waitcnt lgkmcnt(4)
    v_mfma_f32_16x16x32_bf16 v[220:223], a[164:167], v[104:107], v[220:223]
    s_waitcnt vmcnt(7)
    s_barrier
    v_mfma_f32_16x16x32_bf16 v[220:223], a[172:175], v[108:111], v[220:223]
    ds_read_b128 v[80:83], v250 offset:24576
    v_mfma_f32_16x16x32_bf16 v[216:219], a[168:171], v[108:111], v[216:219]
    ds_read_b128 v[84:87], v250 offset:30720
    v_mfma_f32_16x16x32_bf16 v[216:219], a[160:163], v[104:107], v[216:219]
    ds_read_b128 v[88:91], v250 offset:24832
    v_mfma_f32_16x16x32_bf16 v[224:227], a[160:163], v[112:115], v[224:227]
    ds_read_b128 v[92:95], v250 offset:30976
    v_mfma_f32_16x16x32_bf16 v[224:227], a[168:171], v[116:119], v[224:227]
    ds_read_b128 v[96:99], v250 offset:25088
    v_mfma_f32_16x16x32_bf16 v[228:231], a[172:175], v[116:119], v[228:231]
    ds_read_b128 v[100:103], v250 offset:31232
    v_mfma_f32_16x16x32_bf16 v[228:231], a[164:167], v[112:115], v[228:231]
    ds_read_b64_tr_b16 a[240:241], v152 offset:49152
    v_mfma_f32_16x16x32_bf16 v[236:239], a[164:167], v[120:123], v[236:239]
    ds_read_b64_tr_b16 a[242:243], v152 offset:50176
    v_mfma_f32_16x16x32_bf16 v[236:239], a[172:175], v[124:127], v[236:239]
    v_mfma_f32_16x16x32_bf16 v[232:235], a[168:171], v[124:127], v[232:235]
    ds_read_b64_tr_b16 a[244:245], v153 offset:49152
    v_mfma_f32_16x16x32_bf16 v[232:235], a[160:163], v[120:123], v[232:235]
    ds_read_b64_tr_b16 a[246:247], v153 offset:50176
    s_waitcnt lgkmcnt(4)
    v_mfma_f32_16x16x32_bf16 v[192:195], a[176:179], v[80:83], v[192:195]
    v_mfma_f32_16x16x32_bf16 v[192:195], a[184:187], v[84:87], v[192:195]
    ds_read_b128 v[104:107], v250 offset:25344
    v_mfma_f32_16x16x32_bf16 v[196:199], a[188:191], v[84:87], v[196:199]
    ds_read_b128 v[108:111], v250 offset:31488
    v_mfma_f32_16x16x32_bf16 v[196:199], a[180:183], v[80:83], v[196:199]
    ds_read_b128 v[112:115], v250 offset:25600
    v_mfma_f32_16x16x32_bf16 v[204:207], a[180:183], v[88:91], v[204:207]
    ds_read_b128 v[116:119], v250 offset:31744
    v_mfma_f32_16x16x32_bf16 v[204:207], a[188:191], v[92:95], v[204:207]
    ds_read_b128 v[120:123], v250 offset:25856
    v_mfma_f32_16x16x32_bf16 v[200:203], a[184:187], v[92:95], v[200:203]
    ds_read_b128 v[124:127], v250 offset:32000
    v_mfma_f32_16x16x32_bf16 v[200:203], a[176:179], v[88:91], v[200:203]
    ds_read_b64_tr_b16 a[248:249], v152 offset:57344
    v_mfma_f32_16x16x32_bf16 v[208:211], a[176:179], v[96:99], v[208:211]
    ds_read_b64_tr_b16 a[250:251], v152 offset:58368
    v_mfma_f32_16x16x32_bf16 v[208:211], a[184:187], v[100:103], v[208:211]
    v_mfma_f32_16x16x32_bf16 v[212:215], a[188:191], v[100:103], v[212:215]
    ds_read_b64_tr_b16 a[252:253], v153 offset:57344
    v_mfma_f32_16x16x32_bf16 v[212:215], a[180:183], v[96:99], v[212:215]
    ds_read_b64_tr_b16 a[254:255], v153 offset:58368
    s_waitcnt lgkmcnt(4)
    v_mfma_f32_16x16x32_bf16 v[220:223], a[180:183], v[104:107], v[220:223]
    s_barrier
    v_mfma_f32_16x16x32_bf16 v[220:223], a[188:191], v[108:111], v[220:223]
    ds_read_b128 v[80:83], v159 offset:0
    s_add_u32 m0, s74, 36864
    v_mfma_f32_16x16x32_bf16 v[216:219], a[184:187], v[108:111], v[216:219]
    ds_read_b128 v[84:87], v159 offset:6144
    v_mfma_f32_16x16x32_bf16 v[216:219], a[176:179], v[104:107], v[216:219]
    ds_read_b128 v[88:91], v159 offset:256
    buffer_load_dwordx4 v156, s[44:47], s81 offen offset:0 sc1 lds
    v_mfma_f32_16x16x32_bf16 v[224:227], a[176:179], v[112:115], v[224:227]
    ds_read_b128 v[92:95], v159 offset:6400
    v_mfma_f32_16x16x32_bf16 v[224:227], a[184:187], v[116:119], v[224:227]
    ds_read_b128 v[96:99], v159 offset:512
    v_mfma_f32_16x16x32_bf16 v[228:231], a[188:191], v[116:119], v[228:231]
    ds_read_b128 v[100:103], v159 offset:6656
    buffer_load_dwordx4 v157, s[44:47], s81 offen offset:1024 sc1 lds
    v_mfma_f32_16x16x32_bf16 v[228:231], a[180:183], v[112:115], v[228:231]
    v_mfma_f32_16x16x32_bf16 v[236:239], a[180:183], v[120:123], v[236:239]
    v_mfma_f32_16x16x32_bf16 v[236:239], a[188:191], v[124:127], v[236:239]
    buffer_load_dwordx4 v158, s[44:47], s81 offen offset:2048 sc1 lds
    v_mfma_f32_16x16x32_bf16 v[232:235], a[184:187], v[124:127], v[232:235]
    v_mfma_f32_16x16x32_bf16 v[232:235], a[176:179], v[120:123], v[232:235]
    s_waitcnt lgkmcnt(0)
    v_mfma_f32_16x16x32_bf16 v[192:195], a[192:195], v[80:83], v[192:195]
    s_and_b32 s13, s70, 1
    s_mul_i32 s13, s13, 3072
    v_mfma_f32_16x16x32_bf16 v[192:195], a[200:203], v[84:87], v[192:195]
    ds_read_b128 v[104:107], v159 offset:768
    s_sub_u32 s13, s13, 1536
    v_mfma_f32_16x16x32_bf16 v[196:199], a[204:207], v[84:87], v[196:199]
    ds_read_b128 v[108:111], v159 offset:6912
    v_add_u32 v156, s13, v156
    v_mfma_f32_16x16x32_bf16 v[196:199], a[196:199], v[80:83], v[196:199]
    ds_read_b128 v[112:115], v159 offset:1024
    v_mfma_f32_16x16x32_bf16 v[204:207], a[196:199], v[88:91], v[204:207]
    ds_read_b128 v[116:119], v159 offset:7168
    v_add_u32 v157, s13, v157
    v_mfma_f32_16x16x32_bf16 v[204:207], a[204:207], v[92:95], v[204:207]
    ds_read_b128 v[120:123], v159 offset:1280
    v_add_u32 v158, s13, v158
    v_mfma_f32_16x16x32_bf16 v[200:203], a[200:203], v[92:95], v[200:203]
    ds_read_b128 v[124:127], v159 offset:7424
    s_add_u32 m0, s74, 49152
    v_mfma_f32_16x16x32_bf16 v[200:203], a[192:195], v[88:91], v[200:203]
    v_mfma_f32_16x16x32_bf16 v[208:211], a[192:195], v[96:99], v[208:211]
    buffer_load_dwordx4 v156, s[44:47], s18 offen offset:0 sc1 lds
    v_mfma_f32_16x16x32_bf16 v[208:211], a[200:203], v[100:103], v[208:211]
    buffer_load_dwordx4 v157, s[44:47], s18 offen offset:1024 sc1 lds
    v_mfma_f32_16x16x32_bf16 v[212:215], a[204:207], v[100:103], v[212:215]
    buffer_load_dwordx4 v158, s[44:47], s18 offen offset:2048 sc1 lds
    v_mfma_f32_16x16x32_bf16 v[212:215], a[196:199], v[96:99], v[212:215]
    s_waitcnt lgkmcnt(0)
    v_mfma_f32_16x16x32_bf16 v[220:223], a[196:199], v[104:107], v[220:223]
    s_barrier
    v_mfma_f32_16x16x32_bf16 v[220:223], a[204:207], v[108:111], v[220:223]
    ds_read_b128 v[80:83], v159 offset:12288
    s_add_u32 m0, s74, 61440
    v_mfma_f32_16x16x32_bf16 v[216:219], a[200:203], v[108:111], v[216:219]
    ds_read_b128 v[84:87], v159 offset:18432
    v_mfma_f32_16x16x32_bf16 v[216:219], a[192:195], v[104:107], v[216:219]
    ds_read_b128 v[88:91], v159 offset:12544
    buffer_load_dwordx4 v156, s[44:47], s19 offen offset:0 sc1 lds
    v_mfma_f32_16x16x32_bf16 v[224:227], a[192:195], v[112:115], v[224:227]
    ds_read_b128 v[92:95], v159 offset:18688
    v_mfma_f32_16x16x32_bf16 v[224:227], a[200:203], v[116:119], v[224:227]
    ds_read_b128 v[96:99], v159 offset:12800
    v_mfma_f32_16x16x32_bf16 v[228:231], a[204:207], v[116:119], v[228:231]
    ds_read_b128 v[100:103], v159 offset:18944
    buffer_load_dwordx4 v157, s[44:47], s19 offen offset:1024 sc1 lds
    v_mfma_f32_16x16x32_bf16 v[228:231], a[196:199], v[112:115], v[228:231]
    v_mfma_f32_16x16x32_bf16 v[236:239], a[196:199], v[120:123], v[236:239]
    v_mfma_f32_16x16x32_bf16 v[236:239], a[204:207], v[124:127], v[236:239]
    buffer_load_dwordx4 v158, s[44:47], s19 offen offset:2048 sc1 lds
    v_mfma_f32_16x16x32_bf16 v[232:235], a[200:203], v[124:127], v[232:235]
    v_mfma_f32_16x16x32_bf16 v[232:235], a[192:195], v[120:123], v[232:235]
    s_waitcnt lgkmcnt(0)
    v_mfma_f32_16x16x32_bf16 v[192:195], a[208:211], v[80:83], v[192:195]
    s_add_u32 m0, s74, 0
    v_mfma_f32_16x16x32_bf16 v[192:195], a[216:219], v[84:87], v[192:195]
    ds_read_b128 v[104:107], v159 offset:13056
    v_mfma_f32_16x16x32_bf16 v[196:199], a[220:223], v[84:87], v[196:199]
    ds_read_b128 v[108:111], v159 offset:19200
    v_mfma_f32_16x16x32_bf16 v[196:199], a[212:215], v[80:83], v[196:199]
    ds_read_b128 v[112:115], v159 offset:13312
    buffer_load_dwordx4 v156, s[44:47], s20 offen offset:0 sc1 lds
    v_mfma_f32_16x16x32_bf16 v[204:207], a[212:215], v[88:91], v[204:207]
    ds_read_b128 v[116:119], v159 offset:19456
    v_mfma_f32_16x16x32_bf16 v[204:207], a[220:223], v[92:95], v[204:207]
    ds_read_b128 v[120:123], v159 offset:13568
    v_mfma_f32_16x16x32_bf16 v[200:203], a[216:219], v[92:95], v[200:203]
    ds_read_b128 v[124:127], v159 offset:19712
    buffer_load_dwordx4 v157, s[44:47], s20 offen offset:1024 sc1 lds
    v_mfma_f32_16x16x32_bf16 v[200:203], a[208:211], v[88:91], v[200:203]
    v_mfma_f32_16x16x32_bf16 v[208:211], a[208:211], v[96:99], v[208:211]
    v_mfma_f32_16x16x32_bf16 v[208:211], a[216:219], v[100:103], v[208:211]
    buffer_load_dwordx4 v158, s[44:47], s20 offen offset:2048 sc1 lds
    v_mfma_f32_16x16x32_bf16 v[212:215], a[220:223], v[100:103], v[212:215]
    v_mfma_f32_16x16x32_bf16 v[212:215], a[212:215], v[96:99], v[212:215]
    s_waitcnt lgkmcnt(0)
    v_mfma_f32_16x16x32_bf16 v[220:223], a[212:215], v[104:107], v[220:223]
    s_waitcnt vmcnt(16)
    s_barrier
    v_mfma_f32_16x16x32_bf16 v[220:223], a[220:223], v[108:111], v[220:223]
    ds_read_b128 v[80:83], v159 offset:24576
    s_add_u32 m0, s74, 12288
    v_mfma_f32_16x16x32_bf16 v[216:219], a[216:219], v[108:111], v[216:219]
    ds_read_b128 v[84:87], v159 offset:30720
    v_mfma_f32_16x16x32_bf16 v[216:219], a[208:211], v[104:107], v[216:219]
    ds_read_b128 v[88:91], v159 offset:24832
    buffer_load_dwordx4 v156, s[44:47], s21 offen offset:0 sc1 lds
    v_mfma_f32_16x16x32_bf16 v[224:227], a[208:211], v[112:115], v[224:227]
    ds_read_b128 v[92:95], v159 offset:30976
    v_mfma_f32_16x16x32_bf16 v[224:227], a[216:219], v[116:119], v[224:227]
    ds_read_b128 v[96:99], v159 offset:25088
    v_mfma_f32_16x16x32_bf16 v[228:231], a[220:223], v[116:119], v[228:231]
    ds_read_b128 v[100:103], v159 offset:31232
    buffer_load_dwordx4 v157, s[44:47], s21 offen offset:1024 sc1 lds
    v_mfma_f32_16x16x32_bf16 v[228:231], a[212:215], v[112:115], v[228:231]
    v_mfma_f32_16x16x32_bf16 v[236:239], a[212:215], v[120:123], v[236:239]
    v_mfma_f32_16x16x32_bf16 v[236:239], a[220:223], v[124:127], v[236:239]
    buffer_load_dwordx4 v158, s[44:47], s21 offen offset:2048 sc1 lds
    v_mfma_f32_16x16x32_bf16 v[232:235], a[216:219], v[124:127], v[232:235]
    v_mfma_f32_16x16x32_bf16 v[232:235], a[208:211], v[120:123], v[232:235]
    s_waitcnt lgkmcnt(0)
    v_mfma_f32_16x16x32_bf16 v[192:195], a[224:227], v[80:83], v[192:195]
    s_add_u32 m0, s73, 0
    s_lshl_b32 s14, s85, 18
    v_mfma_f32_16x16x32_bf16 v[192:195], a[232:235], v[84:87], v[192:195]
    ds_read_b128 v[104:107], v159 offset:25344
    v_mfma_f32_16x16x32_bf16 v[196:199], a[236:239], v[84:87], v[196:199]
    ds_read_b128 v[108:111], v159 offset:31488
    buffer_load_dwordx4 v4, s[52:55], s14 offen offset:0 lds
    v_mfma_f32_16x16x32_bf16 v[196:199], a[228:231], v[80:83], v[196:199]
    ds_read_b128 v[112:115], v159 offset:25600
    v_mfma_f32_16x16x32_bf16 v[204:207], a[228:231], v[88:91], v[204:207]
    ds_read_b128 v[116:119], v159 offset:31744
    buffer_load_dwordx4 v5, s[52:55], s14 offen offset:1024 lds
    v_mfma_f32_16x16x32_bf16 v[204:207], a[236:239], v[92:95], v[204:207]
    ds_read_b128 v[120:123], v159 offset:25856
    v_mfma_f32_16x16x32_bf16 v[200:203], a[232:235], v[92:95], v[200:203]
    ds_read_b128 v[124:127], v159 offset:32000
    v_mfma_f32_16x16x32_bf16 v[200:203], a[224:227], v[88:91], v[200:203]
    buffer_load_dwordx4 v6, s[52:55], s14 offen offset:2048 lds
    v_mfma_f32_16x16x32_bf16 v[208:211], a[224:227], v[96:99], v[208:211]
    v_mfma_f32_16x16x32_bf16 v[208:211], a[232:235], v[100:103], v[208:211]
    buffer_load_dwordx4 v7, s[52:55], s14 offen offset:3072 lds
    v_mfma_f32_16x16x32_bf16 v[212:215], a[236:239], v[100:103], v[212:215]
    v_mfma_f32_16x16x32_bf16 v[212:215], a[228:231], v[96:99], v[212:215]
    s_waitcnt lgkmcnt(0)
    v_mfma_f32_16x16x32_bf16 v[220:223], a[228:231], v[104:107], v[220:223]
    s_waitcnt vmcnt(16)
    s_barrier
    v_mfma_f32_16x16x32_bf16 v[220:223], a[236:239], v[108:111], v[220:223]
    ds_read_b128 v[80:83], v250 offset:0
    v_mfma_f32_16x16x32_bf16 v[216:219], a[232:235], v[108:111], v[216:219]
    ds_read_b128 v[84:87], v250 offset:6144
    v_mfma_f32_16x16x32_bf16 v[216:219], a[224:227], v[104:107], v[216:219]
    ds_read_b128 v[88:91], v250 offset:256
    v_mfma_f32_16x16x32_bf16 v[224:227], a[224:227], v[112:115], v[224:227]
    ds_read_b128 v[92:95], v250 offset:6400
    v_mfma_f32_16x16x32_bf16 v[224:227], a[232:235], v[116:119], v[224:227]
    ds_read_b128 v[96:99], v250 offset:512
    v_mfma_f32_16x16x32_bf16 v[228:231], a[236:239], v[116:119], v[228:231]
    ds_read_b128 v[100:103], v250 offset:6656
    v_mfma_f32_16x16x32_bf16 v[228:231], a[228:231], v[112:115], v[228:231]
    v_mfma_f32_16x16x32_bf16 v[236:239], a[228:231], v[120:123], v[236:239]
    v_mfma_f32_16x16x32_bf16 v[236:239], a[236:239], v[124:127], v[236:239]
    v_mfma_f32_16x16x32_bf16 v[232:235], a[232:235], v[124:127], v[232:235]
    v_mfma_f32_16x16x32_bf16 v[232:235], a[224:227], v[120:123], v[232:235]
    s_waitcnt lgkmcnt(0)
    v_mfma_f32_16x16x32_bf16 v[192:195], a[240:243], v[80:83], v[192:195]
L_pl_G_3:
    s_cbranch_execz L_wret
    v_mfma_f32_16x16x32_bf16 v[192:195], a[248:251], v[84:87], v[192:195]
    ds_read_b128 v[104:107], v250 offset:768
    v_mfma_f32_16x16x32_bf16 v[196:199], a[252:255], v[84:87], v[196:199]
    ds_read_b128 v[108:111], v250 offset:6912
    v_mfma_f32_16x16x32_bf16 v[196:199], a[244:247], v[80:83], v[196:199]
    ds_read_b128 v[112:115], v250 offset:1024
    v_mfma_f32_16x16x32_bf16 v[204:207], a[244:247], v[88:91], v[204:207]
    ds_read_b128 v[116:119], v250 offset:7168
    v_mfma_f32_16x16x32_bf16 v[204:207], a[252:255], v[92:95], v[204:207]
    ds_read_b128 v[120:123], v250 offset:1280
    v_mfma_f32_16x16x32_bf16 v[200:203], a[248:251], v[92:95], v[200:203]
    ds_read_b128 v[124:127], v250 offset:7424
    v_mfma_f32_16x16x32_bf16 v[200:203], a[240:243], v[88:91], v[200:203]
    v_mfma_f32_16x16x32_bf16 v[208:211], a[240:243], v[96:99], v[208:211]
    v_mfma_f32_16x16x32_bf16 v[208:211], a[248:251], v[100:103], v[208:211]
    v_mfma_f32_16x16x32_bf16 v[212:215], a[252:255], v[100:103], v[212:215]
    v_mfma_f32_16x16x32_bf16 v[212:215], a[244:247], v[96:99], v[212:215]
    s_waitcnt lgkmcnt(0)
    v_mfma_f32_16x16x32_bf16 v[220:223], a[244:247], v[104:107], v[220:223]
    s_waitcnt vmcnt(13)
    s_barrier
    v_mfma_f32_16x16x32_bf16 v[220:223], a[252:255], v[108:111], v[220:223]
    ds_read_b128 v[80:83], v250 offset:12288
    v_mfma_f32_16x16x32_bf16 v[216:219], a[248:251], v[108:111], v[216:219]
    ds_read_b128 v[84:87], v250 offset:18432
    v_mfma_f32_16x16x32_bf16 v[216:219], a[240:243], v[104:107], v[216:219]
    ds_read_b128 v[88:91], v250 offset:12544
    v_mfma_f32_16x16x32_bf16 v[224:227], a[240:243], v[112:115], v[224:227]
    ds_read_b128 v[92:95], v250 offset:18688
    v_mfma_f32_16x16x32_bf16 v[224:227], a[248:251], v[116:119], v[224:227]
    ds_read_b128 v[96:99], v250 offset:12800
    v_mfma_f32_16x16x32_bf16 v[228:231], a[252:255], v[116:119], v[228:231]
    ds_read_b128 v[100:103], v250 offset:18944
    v_mfma_f32_16x16x32_bf16 v[228:231], a[244:247], v[112:115], v[228:231]
    v_mfma_f32_16x16x32_bf16 v[236:239], a[244:247], v[120:123], v[236:239]
    v_mfma_f32_16x16x32_bf16 v[236:239], a[252:255], v[124:127], v[236:239]
    v_mfma_f32_16x16x32_bf16 v[232:235], a[248:251], v[124:127], v[232:235]
    v_mfma_f32_16x16x32_bf16 v[232:235], a[240:243], v[120:123], v[232:235]
    s_waitcnt lgkmcnt(0)
    v_mfma_f32_16x16x32_bf16 v[32:35], a[0:3], v[80:83], v[128:131]
    v_mfma_f32_16x16x32_bf16 v[32:35], a[8:11], v[84:87], v[32:35]
    ds_read_b128 v[104:107], v250 offset:13056
    v_mfma_f32_16x16x32_bf16 v[36:39], a[12:15], v[84:87], v[132:135]
    ds_read_b128 v[108:111], v250 offset:19200
    v_mfma_f32_16x16x32_bf16 v[36:39], a[4:7], v[80:83], v[36:39]
    ds_read_b128 v[112:115], v250 offset:13312
    v_mfma_f32_16x16x32_bf16 v[44:47], a[4:7], v[88:91], v[132:135]
    ds_read_b128 v[116:119], v250 offset:19456
    v_mfma_f32_16x16x32_bf16 v[44:47], a[12:15], v[92:95], v[44:47]
    ds_read_b128 v[120:123], v250 offset:13568
    v_mfma_f32_16x16x32_bf16 v[40:43], a[8:11], v[92:95], v[128:131]
    ds_read_b128 v[124:127], v250 offset:19712
    v_mfma_f32_16x16x32_bf16 v[40:43], a[0:3], v[88:91], v[40:43]
    v_mfma_f32_16x16x32_bf16 v[48:51], a[0:3], v[96:99], v[128:131]
    v_mfma_f32_16x16x32_bf16 v[48:51], a[8:11], v[100:103], v[48:51]
    v_mfma_f32_16x16x32_bf16 v[52:55], a[12:15], v[100:103], v[132:135]
    v_mfma_f32_16x16x32_bf16 v[52:55], a[4:7], v[96:99], v[52:55]
    s_waitcnt lgkmcnt(0)
    v_mfma_f32_16x16x32_bf16 v[60:63], a[4:7], v[104:107], v[132:135]
    s_waitcnt vmcnt(10)
    s_barrier
    v_mfma_f32_16x16x32_bf16 v[60:63], a[12:15], v[108:111], v[60:63]
    ds_read_b128 v[80:83], v250 offset:24576
    s_add_u32 m0, s74, 24576
    v_cvt_pk_bf16_f32 v192, v192, v193
    v_mfma_f32_16x16x32_bf16 v[56:59], a[8:11], v[108:111], v[128:131]
    ds_read_b128 v[84:87], v250 offset:30720
    v_mfma_f32_16x16x32_bf16 v[56:59], a[0:3], v[104:107], v[56:59]
    ds_read_b128 v[88:91], v250 offset:24832
    buffer_load_dwordx4 v156, s[44:47], s22 offen offset:0 sc1 lds
    v_mfma_f32_16x16x32_bf16 v[64:67], a[0:3], v[112:115], v[128:131]
    ds_read_b128 v[92:95], v250 offset:30976
    v_cvt_pk_bf16_f32 v193, v194, v195
    v_mfma_f32_16x16x32_bf16 v[64:67], a[8:11], v[116:119], v[64:67]
    ds_read_b128 v[96:99], v250 offset:25088
    v_cvt_pk_bf16_f32 v194, v196, v197
    v_mfma_f32_16x16x32_bf16 v[68:71], a[12:15], v[116:119], v[132:135]
    ds_read_b128 v[100:103], v250 offset:31232
    buffer_load_dwordx4 v157, s[44:47], s22 offen offset:1024 sc1 lds
    v_mfma_f32_16x16x32_bf16 v[68:71], a[4:7], v[112:115], v[68:71]
    v_mfma_f32_16x16x32_bf16 v[76:79], a[4:7], v[120:123], v[132:135]
    v_cvt_pk_bf16_f32 v195, v198, v199
    v_mfma_f32_16x16x32_bf16 v[76:79], a[12:15], v[124:127], v[76:79]
    buffer_load_dwordx4 v158, s[44:47], s22 offen offset:2048 sc1 lds
    v_mfma_f32_16x16x32_bf16 v[72:75], a[8:11], v[124:127], v[128:131]
    buffer_store_dwordx4 v[192:195], v246, s[44:47], s9 offen offset:0 sc1
    v_mfma_f32_16x16x32_bf16 v[72:75], a[0:3], v[120:123], v[72:75]
    s_waitcnt lgkmcnt(0)
    v_mfma_f32_16x16x32_bf16 v[32:35], a[16:19], v[80:83], v[32:35]
    s_add_u32 m0, s74, 36864
    v_mfma_f32_16x16x32_bf16 v[32:35], a[24:27], v[84:87], v[32:35]
    ds_read_b128 v[104:107], v250 offset:25344
    v_cvt_pk_bf16_f32 v200, v200, v201
    v_mfma_f32_16x16x32_bf16 v[36:39], a[28:31], v[84:87], v[36:39]
    ds_read_b128 v[108:111], v250 offset:31488
    v_mfma_f32_16x16x32_bf16 v[36:39], a[20:23], v[80:83], v[36:39]
    ds_read_b128 v[112:115], v250 offset:25600
    buffer_load_dwordx4 v156, s[44:47], s23 offen offset:0 sc1 lds
    v_mfma_f32_16x16x32_bf16 v[44:47], a[20:23], v[88:91], v[44:47]
    ds_read_b128 v[116:119], v250 offset:31744
    v_cvt_pk_bf16_f32 v201, v202, v203
    v_mfma_f32_16x16x32_bf16 v[44:47], a[28:31], v[92:95], v[44:47]
    ds_read_b128 v[120:123], v250 offset:25856
    v_cvt_pk_bf16_f32 v202, v204, v205
    v_mfma_f32_16x16x32_bf16 v[40:43], a[24:27], v[92:95], v[40:43]
    ds_read_b128 v[124:127], v250 offset:32000
    buffer_load_dwordx4 v157, s[44:47], s23 offen offset:1024 sc1 lds
    v_mfma_f32_16x16x32_bf16 v[40:43], a[16:19], v[88:91], v[40:43]
    v_mfma_f32_16x16x32_bf16 v[48:51], a[16:19], v[96:99], v[48:51]
    v_cvt_pk_bf16_f32 v203, v206, v207
    v_mfma_f32_16x16x32_bf16 v[48:51], a[24:27], v[100:103], v[48:51]
    buffer_load_dwordx4 v158, s[44:47], s23 offen offset:2048 sc1 lds
    v_mfma_f32_16x16x32_bf16 v[52:55], a[28:31], v[100:103], v[52:55]
    buffer_store_dwordx4 v[200:203], v246, s[44:47], s9 offen offset:1024 sc1
    v_mfma_f32_16x16x32_bf16 v[52:55], a[20:23], v[96:99], v[52:55]
    s_waitcnt lgkmcnt(0)
    v_mfma_f32_16x16x32_bf16 v[60:63], a[20:23], v[104:107], v[60:63]
    s_waitcnt vmcnt(15)
    s_barrier
    v_mfma_f32_16x16x32_bf16 v[60:63], a[28:31], v[108:111], v[60:63]
    ds_read_b128 v[80:83], v159 offset:0
    s_add_u32 m0, s74, 49152
    v_cvt_pk_bf16_f32 v208, v208, v209
    v_mfma_f32_16x16x32_bf16 v[56:59], a[24:27], v[108:111], v[56:59]
    ds_read_b128 v[84:87], v159 offset:6144
    v_mfma_f32_16x16x32_bf16 v[56:59], a[16:19], v[104:107], v[56:59]
    ds_read_b128 v[88:91], v159 offset:256
    buffer_load_dwordx4 v156, s[44:47], s24 offen offset:0 sc1 lds
    v_mfma_f32_16x16x32_bf16 v[64:67], a[16:19], v[112:115], v[64:67]
    ds_read_b128 v[92:95], v159 offset:6400
    v_cvt_pk_bf16_f32 v209, v210, v211
    v_mfma_f32_16x16x32_bf16 v[64:67], a[24:27], v[116:119], v[64:67]
    ds_read_b128 v[96:99], v159 offset:512
    v_cvt_pk_bf16_f32 v210, v212, v213
    v_mfma_f32_16x16x32_bf16 v[68:71], a[28:31], v[116:119], v[68:71]
    ds_read_b128 v[100:103], v159 offset:6656
    buffer_load_dwordx4 v157, s[44:47], s24 offen offset:1024 sc1 lds
    v_mfma_f32_16x16x32_bf16 v[68:71], a[20:23], v[112:115], v[68:71]
    v_add_u32 v10, 65536, v10
    v_mfma_f32_16x16x32_bf16 v[76:79], a[20:23], v[120:123], v[76:79]
    ds_read_b64_tr_b16 a[0:1], v10 offset:0
    v_cvt_pk_bf16_f32 v211, v214, v215
    v_mfma_f32_16x16x32_bf16 v[76:79], a[28:31], v[124:127], v[76:79]
    ds_read_b64_tr_b16 a[2:3], v10 offset:2048
    buffer_load_dwordx4 v158, s[44:47], s24 offen offset:2048 sc1 lds
    v_mfma_f32_16x16x32_bf16 v[72:75], a[24:27], v[124:127], v[72:75]
    buffer_store_dwordx4 v[208:211], v246, s[44:47], s9 offen offset:2048 sc1
    ds_read_b64_tr_b16 a[8:9], v10 offset:4096
    v_mfma_f32_16x16x32_bf16 v[72:75], a[16:19], v[120:123], v[72:75]
    ds_read_b64_tr_b16 a[10:11], v10 offset:6144
    s_waitcnt lgkmcnt(4)
    v_mfma_f32_16x16x32_bf16 v[32:35], a[32:35], v[80:83], v[32:35]
    s_add_u32 m0, s74, 61440
    v_mfma_f32_16x16x32_bf16 v[32:35], a[40:43], v[84:87], v[32:35]
    ds_read_b128 v[104:107], v159 offset:768
    v_cvt_pk_bf16_f32 v216, v216, v217
    v_mfma_f32_16x16x32_bf16 v[36:39], a[44:47], v[84:87], v[36:39]
    ds_read_b128 v[108:111], v159 offset:6912
    v_mfma_f32_16x16x32_bf16 v[36:39], a[36:39], v[80:83], v[36:39]
    ds_read_b128 v[112:115], v159 offset:1024
    buffer_load_dwordx4 v156, s[44:47], s25 offen offset:0 sc1 lds
    v_mfma_f32_16x16x32_bf16 v[44:47], a[36:39], v[88:91], v[44:47]
    ds_read_b128 v[116:119], v159 offset:7168
    v_cvt_pk_bf16_f32 v217, v218, v219
    v_mfma_f32_16x16x32_bf16 v[44:47], a[44:47], v[92:95], v[44:47]
    ds_read_b128 v[120:123], v159 offset:1280
    v_cvt_pk_bf16_f32 v218, v220, v221
    v_mfma_f32_16x16x32_bf16 v[40:43], a[40:43], v[92:95], v[40:43]
    ds_read_b128 v[124:127], v159 offset:7424
    buffer_load_dwordx4 v157, s[44:47], s25 offen offset:1024 sc1 lds
    v_mfma_f32_16x16x32_bf16 v[40:43], a[32:35], v[88:91], v[40:43]
    v_add_u32 v11, 65536, v11
    v_mfma_f32_16x16x32_bf16 v[48:51], a[32:35], v[96:99], v[48:51]
    ds_read_b64_tr_b16 a[4:5], v11 offset:0
    v_cvt_pk_bf16_f32 v219, v222, v223
    v_mfma_f32_16x16x32_bf16 v[48:51], a[40:43], v[100:103], v[48:51]
    ds_read_b64_tr_b16 a[6:7], v11 offset:2048
    buffer_load_dwordx4 v158, s[44:47], s25 offen offset:2048 sc1 lds
    v_mfma_f32_16x16x32_bf16 v[52:55], a[44:47], v[100:103], v[52:55]
    buffer_store_dwordx4 v[216:219], v247, s[44:47], s9 offen offset:0 sc1
    ds_read_b64_tr_b16 a[12:13], v11 offset:4096
    v_mfma_f32_16x16x32_bf16 v[52:55], a[36:39], v[96:99], v[52:55]
    ds_read_b64_tr_b16 a[14:15], v11 offset:6144
    s_waitcnt lgkmcnt(4)
    v_mfma_f32_16x16x32_bf16 v[60:63], a[36:39], v[104:107], v[60:63]
    s_waitcnt vmcnt(16)
    s_barrier
    v_mfma_f32_16x16x32_bf16 v[60:63], a[44:47], v[108:111], v[60:63]
    ds_read_b128 v[80:83], v159 offset:12288
    s_add_u32 m0, s74, 0
    v_cvt_pk_bf16_f32 v224, v224, v225
    v_mfma_f32_16x16x32_bf16 v[56:59], a[40:43], v[108:111], v[56:59]
    ds_read_b128 v[84:87], v159 offset:18432
    v_mfma_f32_16x16x32_bf16 v[56:59], a[32:35], v[104:107], v[56:59]
    ds_read_b128 v[88:91], v159 offset:12544
    buffer_load_dwordx4 v156, s[44:47], s26 offen offset:0 sc1 lds
    v_mfma_f32_16x16x32_bf16 v[64:67], a[32:35], v[112:115], v[64:67]
    ds_read_b128 v[92:95], v159 offset:18688
    v_cvt_pk_bf16_f32 v225, v226, v227
    v_mfma_f32_16x16x32_bf16 v[64:67], a[40:43], v[116:119], v[64:67]
    ds_read_b128 v[96:99], v159 offset:12800
    v_cvt_pk_bf16_f32 v226, v228, v229
    v_mfma_f32_16x16x32_bf16 v[68:71], a[44:47], v[116:119], v[68:71]
    ds_read_b128 v[100:103], v159 offset:18944
    buffer_load_dwordx4 v157, s[44:47], s26 offen offset:1024 sc1 lds
    v_mfma_f32_16x16x32_bf16 v[68:71], a[36:39], v[112:115], v[68:71]
    v_add_u32 v10, -65536, v10
    v_mfma_f32_16x16x32_bf16 v[76:79], a[36:39], v[120:123], v[76:79]
    ds_read_b64_tr_b16 a[16:17], v10 offset:0
    v_cvt_pk_bf16_f32 v227, v230, v231
    v_mfma_f32_16x16x32_bf16 v[76:79], a[44:47], v[124:127], v[76:79]
    ds_read_b64_tr_b16 a[18:19], v10 offset:2048
    buffer_load_dwordx4 v158, s[44:47], s26 offen offset:2048 sc1 lds
    v_mfma_f32_16x16x32_bf16 v[72:75], a[40:43], v[124:127], v[72:75]
    buffer_store_dwordx4 v[224:227], v247, s[44:47], s9 offen offset:1024 sc1
    ds_read_b64_tr_b16 a[24:25], v10 offset:4096
    v_mfma_f32_16x16x32_bf16 v[72:75], a[32:35], v[120:123], v[72:75]
    ds_read_b64_tr_b16 a[26:27], v10 offset:6144
    s_waitcnt lgkmcnt(4)
    v_mfma_f32_16x16x32_bf16 v[32:35], a[48:51], v[80:83], v[32:35]
    v_mfma_f32_16x16x32_bf16 v[32:35], a[56:59], v[84:87], v[32:35]
    ds_read_b128 v[104:107], v159 offset:13056
    v_cvt_pk_bf16_f32 v232, v232, v233
    v_mfma_f32_16x16x32_bf16 v[36:39], a[60:63], v[84:87], v[36:39]
    ds_read_b128 v[108:111], v159 offset:19200
    v_mfma_f32_16x16x32_bf16 v[36:39], a[52:55], v[80:83], v[36:39]
    ds_read_b128 v[112:115], v159 offset:13312
    v_cvt_pk_bf16_f32 v233, v234, v235
    v_mfma_f32_16x16x32_bf16 v[44:47], a[52:55], v[88:91], v[44:47]
    ds_read_b128 v[116:119], v159 offset:19456
    v_mfma_f32_16x16x32_bf16 v[44:47], a[60:63], v[92:95], v[44:47]
    ds_read_b128 v[120:123], v159 offset:13568
    v_mfma_f32_16x16x32_bf16 v[40:43], a[56:59], v[92:95], v[40:43]
    ds_read_b128 v[124:127], v159 offset:19712
    v_cvt_pk_bf16_f32 v234, v236, v237
    v_mfma_f32_16x16x32_bf16 v[40:43], a[48:51], v[88:91], v[40:43]
    v_add_u32 v11, -65536, v11
    v_mfma_f32_16x16x32_bf16 v[48:51], a[48:51], v[96:99], v[48:51]
    ds_read_b64_tr_b16 a[20:21], v11 offset:0
    v_cvt_pk_bf16_f32 v235, v238, v239
    v_mfma_f32_16x16x32_bf16 v[48:51], a[56:59], v[100:103], v[48:51]
    ds_read_b64_tr_b16 a[22:23], v11 offset:2048
    v_mfma_f32_16x16x32_bf16 v[52:55], a[60:63], v[100:103], v[52:55]
    buffer_store_dwordx4 v[232:235], v247, s[44:47], s9 offen offset:2048 sc1
    ds_read_b64_tr_b16 a[28:29], v11 offset:4096
    v_mfma_f32_16x16x32_bf16 v[52:55], a[52:55], v[96:99], v[52:55]
    ds_read_b64_tr_b16 a[30:31], v11 offset:6144
    s_waitcnt lgkmcnt(4)
    v_mfma_f32_16x16x32_bf16 v[60:63], a[52:55], v[104:107], v[60:63]
    s_waitcnt vmcnt(18)
    s_barrier
    v_mfma_f32_16x16x32_bf16 v[60:63], a[60:63], v[108:111], v[60:63]
    ds_read_b128 v[80:83], v159 offset:24576
    s_add_u32 m0, s74, 12288
    v_mfma_f32_16x16x32_bf16 v[56:59], a[56:59], v[108:111], v[56:59]
    ds_read_b128 v[84:87], v159 offset:30720
    v_mfma_f32_16x16x32_bf16 v[56:59], a[48:51], v[104:107], v[56:59]
    ds_read_b128 v[88:91], v159 offset:24832
    buffer_load_dwordx4 v156, s[44:47], s27 offen offset:0 sc1 lds
    v_mfma_f32_16x16x32_bf16 v[64:67], a[48:51], v[112:115], v[64:67]
    ds_read_b128 v[92:95], v159 offset:30976
    v_mfma_f32_16x16x32_bf16 v[64:67], a[56:59], v[116:119], v[64:67]
    ds_read_b128 v[96:99], v159 offset:25088
    v_mfma_f32_16x16x32_bf16 v[68:71], a[60:63], v[116:119], v[68:71]
    ds_read_b128 v[100:103], v159 offset:31232
    buffer_load_dwordx4 v157, s[44:47], s27 offen offset:1024 sc1 lds
    v_mfma_f32_16x16x32_bf16 v[68:71], a[52:55], v[112:115], v[68:71]
    v_mfma_f32_16x16x32_bf16 v[76:79], a[52:55], v[120:123], v[76:79]
    v_mfma_f32_16x16x32_bf16 v[76:79], a[60:63], v[124:127], v[76:79]
    buffer_load_dwordx4 v158, s[44:47], s27 offen offset:2048 sc1 lds
    v_mfma_f32_16x16x32_bf16 v[72:75], a[56:59], v[124:127], v[72:75]
    v_mfma_f32_16x16x32_bf16 v[72:75], a[48:51], v[120:123], v[72:75]
    s_waitcnt lgkmcnt(0)
    v_mfma_f32_16x16x32_bf16 v[32:35], a[64:67], v[80:83], v[32:35]
    s_add_u32 m0, s73, 16384
    s_lshl_b32 s14, s86, 18
    v_mfma_f32_16x16x32_bf16 v[32:35], a[72:75], v[84:87], v[32:35]
    ds_read_b128 v[104:107], v159 offset:25344
    v_mfma_f32_16x16x32_bf16 v[36:39], a[76:79], v[84:87], v[36:39]
    ds_read_b128 v[108:111], v159 offset:31488
    buffer_load_dwordx4 v4, s[52:55], s14 offen offset:0 lds
    v_mfma_f32_16x16x32_bf16 v[36:39], a[68:71], v[80:83], v[36:39]
    ds_read_b128 v[112:115], v159 offset:25600
    v_mfma_f32_16x16x32_bf16 v[44:47], a[68:71], v[88:91], v[44:47]
    ds_read_b128 v[116:119], v159 offset:31744
    buffer_load_dwordx4 v5, s[52:55], s14 offen offset:1024 lds
    v_mfma_f32_16x16x32_bf16 v[44:47], a[76:79], v[92:95], v[44:47]
    ds_read_b128 v[120:123], v159 offset:25856
    v_mfma_f32_16x16x32_bf16 v[40:43], a[72:75], v[92:95], v[40:43]
    ds_read_b128 v[124:127], v159 offset:32000
    v_mfma_f32_16x16x32_bf16 v[40:43], a[64:67], v[88:91], v[40:43]
    buffer_load_dwordx4 v6, s[52:55], s14 offen offset:2048 lds
    v_mfma_f32_16x16x32_bf16 v[48:51], a[64:67], v[96:99], v[48:51]
    v_mfma_f32_16x16x32_bf16 v[48:51], a[72:75], v[100:103], v[48:51]
    buffer_load_dwordx4 v7, s[52:55], s14 offen offset:3072 lds
    v_mfma_f32_16x16x32_bf16 v[52:55], a[76:79], v[100:103], v[52:55]
    v_mfma_f32_16x16x32_bf16 v[52:55], a[68:71], v[96:99], v[52:55]
    s_waitcnt lgkmcnt(0)
    v_mfma_f32_16x16x32_bf16 v[60:63], a[68:71], v[104:107], v[60:63]
    s_waitcnt vmcnt(21)
    s_barrier
    v_mfma_f32_16x16x32_bf16 v[60:63], a[76:79], v[108:111], v[60:63]
    ds_read_b128 v[80:83], v250 offset:0
    v_mfma_f32_16x16x32_bf16 v[56:59], a[72:75], v[108:111], v[56:59]
    ds_read_b128 v[84:87], v250 offset:6144
    v_mfma_f32_16x16x32_bf16 v[56:59], a[64:67], v[104:107], v[56:59]
    ds_read_b128 v[88:91], v250 offset:256
    v_mfma_f32_16x16x32_bf16 v[64:67], a[64:67], v[112:115], v[64:67]
    ds_read_b128 v[92:95], v250 offset:6400
    v_mfma_f32_16x16x32_bf16 v[64:67], a[72:75], v[116:119], v[64:67]
    ds_read_b128 v[96:99], v250 offset:512
    v_mfma_f32_16x16x32_bf16 v[68:71], a[76:79], v[116:119], v[68:71]
    ds_read_b128 v[100:103], v250 offset:6656
    v_mfma_f32_16x16x32_bf16 v[68:71], a[68:71], v[112:115], v[68:71]
    v_mfma_f32_16x16x32_bf16 v[76:79], a[68:71], v[120:123], v[76:79]
    v_mfma_f32_16x16x32_bf16 v[76:79], a[76:79], v[124:127], v[76:79]
    v_mfma_f32_16x16x32_bf16 v[72:75], a[72:75], v[124:127], v[72:75]
    v_mfma_f32_16x16x32_bf16 v[72:75], a[64:67], v[120:123], v[72:75]
    s_waitcnt lgkmcnt(0)
    v_mfma_f32_16x16x32_bf16 v[32:35], a[80:83], v[80:83], v[32:35]
    v_mfma_f32_16x16x32_bf16 v[32:35], a[88:91], v[84:87], v[32:35]
    ds_read_b128 v[104:107], v250 offset:768
    v_mfma_f32_16x16x32_bf16 v[36:39], a[92:95], v[84:87], v[36:39]
    ds_read_b128 v[108:111], v250 offset:6912
    v_mfma_f32_16x16x32_bf16 v[36:39], a[84:87], v[80:83], v[36:39]
    ds_read_b128 v[112:115], v250 offset:1024
    v_mfma_f32_16x16x32_bf16 v[44:47], a[84:87], v[88:91], v[44:47]
    ds_read_b128 v[116:119], v250 offset:7168
    v_mfma_f32_16x16x32_bf16 v[44:47], a[92:95], v[92:95], v[44:47]
    ds_read_b128 v[120:123], v250 offset:1280
    v_mfma_f32_16x16x32_bf16 v[40:43], a[88:91], v[92:95], v[40:43]
    ds_read_b128 v[124:127], v250 offset:7424
    v_mfma_f32_16x16x32_bf16 v[40:43], a[80:83], v[88:91], v[40:43]
    v_mfma_f32_16x16x32_bf16 v[48:51], a[80:83], v[96:99], v[48:51]
    v_mfma_f32_16x16x32_bf16 v[48:51], a[88:91], v[100:103], v[48:51]
    v_mfma_f32_16x16x32_bf16 v[52:55], a[92:95], v[100:103], v[52:55]
    v_mfma_f32_16x16x32_bf16 v[52:55], a[84:87], v[96:99], v[52:55]
    s_waitcnt lgkmcnt(0)
    v_mfma_f32_16x16x32_bf16 v[60:63], a[84:87], v[104:107], v[60:63]
    s_waitcnt vmcnt(17)
    s_barrier
    v_mfma_f32_16x16x32_bf16 v[60:63], a[92:95], v[108:111], v[60:63]
    ds_read_b128 v[80:83], v250 offset:12288
    v_mfma_f32_16x16x32_bf16 v[56:59], a[88:91], v[108:111], v[56:59]
    ds_read_b128 v[84:87], v250 offset:18432
    v_mfma_f32_16x16x32_bf16 v[56:59], a[80:83], v[104:107], v[56:59]
    ds_read_b128 v[88:91], v250 offset:12544
    v_mfma_f32_16x16x32_bf16 v[64:67], a[80:83], v[112:115], v[64:67]
    ds_read_b128 v[92:95], v250 offset:18688
    v_mfma_f32_16x16x32_bf16 v[64:67], a[88:91], v[116:119], v[64:67]
    ds_read_b128 v[96:99], v250 offset:12800
    v_mfma_f32_16x16x32_bf16 v[68:71], a[92:95], v[116:119], v[68:71]
    ds_read_b128 v[100:103], v250 offset:18944
    v_mfma_f32_16x16x32_bf16 v[68:71], a[84:87], v[112:115], v[68:71]
    v_mfma_f32_16x16x32_bf16 v[76:79], a[84:87], v[120:123], v[76:79]
    v_mfma_f32_16x16x32_bf16 v[76:79], a[92:95], v[124:127], v[76:79]
    v_mfma_f32_16x16x32_bf16 v[72:75], a[88:91], v[124:127], v[72:75]
    v_mfma_f32_16x16x32_bf16 v[72:75], a[80:83], v[120:123], v[72:75]
    s_waitcnt lgkmcnt(0)
    v_mfma_f32_16x16x32_bf16 v[32:35], a[96:99], v[80:83], v[32:35]
    v_mfma_f32_16x16x32_bf16 v[32:35], a[104:107], v[84:87], v[32:35]
    ds_read_b128 v[104:107], v250 offset:13056
    v_mfma_f32_16x16x32_bf16 v[36:39], a[108:111], v[84:87], v[36:39]
    ds_read_b128 v[108:111], v250 offset:19200
    v_mfma_f32_16x16x32_bf16 v[36:39], a[100:103], v[80:83], v[36:39]
    ds_read_b128 v[112:115], v250 offset:13312
    v_mfma_f32_16x16x32_bf16 v[44:47], a[100:103], v[88:91], v[44:47]
    ds_read_b128 v[116:119], v250 offset:19456
    v_mfma_f32_16x16x32_bf16 v[44:47], a[108:111], v[92:95], v[44:47]
    ds_read_b128 v[120:123], v250 offset:13568
    v_mfma_f32_16x16x32_bf16 v[40:43], a[104:107], v[92:95], v[40:43]
    ds_read_b128 v[124:127], v250 offset:19712
    v_mfma_f32_16x16x32_bf16 v[40:43], a[96:99], v[88:91], v[40:43]
    s_waitcnt vmcnt(7)
    buffer_store_dword v249, v248, s[44:47], s6 offen sc1
    v_mfma_f32_16x16x32_bf16 v[48:51], a[96:99], v[96:99], v[48:51]
    v_mfma_f32_16x16x32_bf16 v[48:51], a[104:107], v[100:103], v[48:51]
    v_mfma_f32_16x16x32_bf16 v[52:55], a[108:111], v[100:103], v[52:55]
    v_mfma_f32_16x16x32_bf16 v[52:55], a[100:103], v[96:99], v[52:55]
    s_waitcnt lgkmcnt(0)
    v_mfma_f32_16x16x32_bf16 v[60:63], a[100:103], v[104:107], v[60:63]
    s_barrier
    v_mfma_f32_16x16x32_bf16 v[60:63], a[108:111], v[108:111], v[60:63]
    ds_read_b128 v[80:83], v250 offset:24576
    s_add_u32 m0, s74, 24576
    v_mfma_f32_16x16x32_bf16 v[56:59], a[104:107], v[108:111], v[56:59]
    ds_read_b128 v[84:87], v250 offset:30720
    v_mfma_f32_16x16x32_bf16 v[56:59], a[96:99], v[104:107], v[56:59]
    ds_read_b128 v[88:91], v250 offset:24832
    buffer_load_dwordx4 v156, s[44:47], s76 offen offset:0 sc1 lds
    v_mfma_f32_16x16x32_bf16 v[64:67], a[96:99], v[112:115], v[64:67]
    ds_read_b128 v[92:95], v250 offset:30976
    v_mfma_f32_16x16x32_bf16 v[64:67], a[104:107], v[116:119], v[64:67]
    ds_read_b128 v[96:99], v250 offset:25088
    v_mfma_f32_16x16x32_bf16 v[68:71], a[108:111], v[116:119], v[68:71]
    ds_read_b128 v[100:103], v250 offset:31232
    buffer_load_dwordx4 v157, s[44:47], s76 offen offset:1024 sc1 lds
    v_mfma_f32_16x16x32_bf16 v[68:71], a[100:103], v[112:115], v[68:71]
    v_mfma_f32_16x16x32_bf16 v[76:79], a[100:103], v[120:123], v[76:79]
    v_mfma_f32_16x16x32_bf16 v[76:79], a[108:111], v[124:127], v[76:79]
    buffer_load_dwordx4 v158, s[44:47], s76 offen offset:2048 sc1 lds
    v_mfma_f32_16x16x32_bf16 v[72:75], a[104:107], v[124:127], v[72:75]
    v_mfma_f32_16x16x32_bf16 v[72:75], a[96:99], v[120:123], v[72:75]
    s_waitcnt lgkmcnt(0)
    v_mfma_f32_16x16x32_bf16 v[32:35], a[112:115], v[80:83], v[32:35]
    s_add_u32 m0, s74, 36864
    v_mfma_f32_16x16x32_bf16 v[32:35], a[120:123], v[84:87], v[32:35]
    ds_read_b128 v[104:107], v250 offset:25344
    v_mfma_f32_16x16x32_bf16 v[36:39], a[124:127], v[84:87], v[36:39]
    ds_read_b128 v[108:111], v250 offset:31488
    v_mfma_f32_16x16x32_bf16 v[36:39], a[116:119], v[80:83], v[36:39]
    ds_read_b128 v[112:115], v250 offset:25600
    buffer_load_dwordx4 v156, s[44:47], s77 offen offset:0 sc1 lds
    v_mfma_f32_16x16x32_bf16 v[44:47], a[116:119], v[88:91], v[44:47]
    ds_read_b128 v[116:119], v250 offset:31744
    v_mfma_f32_16x16x32_bf16 v[44:47], a[124:127], v[92:95], v[44:47]
    ds_read_b128 v[120:123], v250 offset:25856
    v_mfma_f32_16x16x32_bf16 v[40:43], a[120:123], v[92:95], v[40:43]
    ds_read_b128 v[124:127], v250 offset:32000
    buffer_load_dwordx4 v157, s[44:47], s77 offen offset:1024 sc1 lds
    v_mfma_f32_16x16x32_bf16 v[40:43], a[112:115], v[88:91], v[40:43]
    v_mfma_f32_16x16x32_bf16 v[48:51], a[112:115], v[96:99], v[48:51]
    v_mfma_f32_16x16x32_bf16 v[48:51], a[120:123], v[100:103], v[48:51]
    buffer_load_dwordx4 v158, s[44:47], s77 offen offset:2048 sc1 lds
    v_mfma_f32_16x16x32_bf16 v[52:55], a[124:127], v[100:103], v[52:55]
    v_mfma_f32_16x16x32_bf16 v[52:55], a[116:119], v[96:99], v[52:55]
    s_waitcnt lgkmcnt(0)
    v_mfma_f32_16x16x32_bf16 v[60:63], a[116:119], v[104:107], v[60:63]
    s_barrier
    v_mfma_f32_16x16x32_bf16 v[60:63], a[124:127], v[108:111], v[60:63]
    ds_read_b128 v[80:83], v159 offset:0
    s_add_u32 m0, s74, 49152
    v_mfma_f32_16x16x32_bf16 v[56:59], a[120:123], v[108:111], v[56:59]
    ds_read_b128 v[84:87], v159 offset:6144
    v_mfma_f32_16x16x32_bf16 v[56:59], a[112:115], v[104:107], v[56:59]
    ds_read_b128 v[88:91], v159 offset:256
    buffer_load_dwordx4 v156, s[44:47], s78 offen offset:0 sc1 lds
    v_mfma_f32_16x16x32_bf16 v[64:67], a[112:115], v[112:115], v[64:67]
    ds_read_b128 v[92:95], v159 offset:6400
    v_mfma_f32_16x16x32_bf16 v[64:67], a[120:123], v[116:119], v[64:67]
    ds_read_b128 v[96:99], v159 offset:512
    v_mfma_f32_16x16x32_bf16 v[68:71], a[124:127], v[116:119], v[68:71]
    ds_read_b128 v[100:103], v159 offset:6656
    buffer_load_dwordx4 v157, s[44:47], s78 offen offset:1024 sc1 lds
    v_mfma_f32_16x16x32_bf16 v[68:71], a[116:119], v[112:115], v[68:71]
    v_mfma_f32_16x16x32_bf16 v[76:79], a[116:119], v[120:123], v[76:79]
    v_mfma_f32_16x16x32_bf16 v[76:79], a[124:127], v[124:127], v[76:79]
    buffer_load_dwordx4 v158, s[44:47], s78 offen offset:2048 sc1 lds
    v_mfma_f32_16x16x32_bf16 v[72:75], a[120:123], v[124:127], v[72:75]
    v_mfma_f32_16x16x32_bf16 v[72:75], a[112:115], v[120:123], v[72:75]
    s_waitcnt lgkmcnt(0)
    v_mfma_f32_16x16x32_bf16 v[32:35], a[128:131], v[80:83], v[32:35]
    s_add_u32 m0, s74, 61440
    v_mfma_f32_16x16x32_bf16 v[32:35], a[136:139], v[84:87], v[32:35]
    ds_read_b128 v[104:107], v159 offset:768
    v_mfma_f32_16x16x32_bf16 v[36:39], a[140:143], v[84:87], v[36:39]
    ds_read_b128 v[108:111], v159 offset:6912
    v_mfma_f32_16x16x32_bf16 v[36:39], a[132:135], v[80:83], v[36:39]
    ds_read_b128 v[112:115], v159 offset:1024
    buffer_load_dwordx4 v156, s[44:47], s79 offen offset:0 sc1 lds
    v_mfma_f32_16x16x32_bf16 v[44:47], a[132:135], v[88:91], v[44:47]
    ds_read_b128 v[116:119], v159 offset:7168
    v_mfma_f32_16x16x32_bf16 v[44:47], a[140:143], v[92:95], v[44:47]
    ds_read_b128 v[120:123], v159 offset:1280
    v_mfma_f32_16x16x32_bf16 v[40:43], a[136:139], v[92:95], v[40:43]
    ds_read_b128 v[124:127], v159 offset:7424
    buffer_load_dwordx4 v157, s[44:47], s79 offen offset:1024 sc1 lds
    v_mfma_f32_16x16x32_bf16 v[40:43], a[128:131], v[88:91], v[40:43]
    v_mfma_f32_16x16x32_bf16 v[48:51], a[128:131], v[96:99], v[48:51]
    v_mfma_f32_16x16x32_bf16 v[48:51], a[136:139], v[100:103], v[48:51]
    buffer_load_dwordx4 v158, s[44:47], s79 offen offset:2048 sc1 lds
    v_mfma_f32_16x16x32_bf16 v[52:55], a[140:143], v[100:103], v[52:55]
    v_mfma_f32_16x16x32_bf16 v[52:55], a[132:135], v[96:99], v[52:55]
    s_waitcnt lgkmcnt(0)
    v_mfma_f32_16x16x32_bf16 v[60:63], a[132:135], v[104:107], v[60:63]
    s_waitcnt vmcnt(13)
    s_barrier
    v_mfma_f32_16x16x32_bf16 v[60:63], a[140:143], v[108:111], v[60:63]
    ds_read_b128 v[80:83], v159 offset:12288
    s_add_u32 m0, s74, 0
    v_mfma_f32_16x16x32_bf16 v[56:59], a[136:139], v[108:111], v[56:59]
    ds_read_b128 v[84:87], v159 offset:18432
    v_mfma_f32_16x16x32_bf16 v[56:59], a[128:131], v[104:107], v[56:59]
    ds_read_b128 v[88:91], v159 offset:12544
    buffer_load_dwordx4 v156, s[44:47], s80 offen offset:0 sc1 lds
    v_mfma_f32_16x16x32_bf16 v[64:67], a[128:131], v[112:115], v[64:67]
    ds_read_b128 v[92:95], v159 offset:18688
    v_mfma_f32_16x16x32_bf16 v[64:67], a[136:139], v[116:119], v[64:67]
    ds_read_b128 v[96:99], v159 offset:12800
    buffer_load_dword v29, v28, s[44:47], 0 offen sc1
    v_mfma_f32_16x16x32_bf16 v[68:71], a[140:143], v[116:119], v[68:71]
    ds_read_b128 v[100:103], v159 offset:18944
    buffer_load_dwordx4 v157, s[44:47], s80 offen offset:1024 sc1 lds
    v_mfma_f32_16x16x32_bf16 v[68:71], a[132:135], v[112:115], v[68:71]
    ds_read_b64_tr_b16 a[32:33], v10 offset:16384
    v_mfma_f32_16x16x32_bf16 v[76:79], a[132:135], v[120:123], v[76:79]
    ds_read_b64_tr_b16 a[34:35], v10 offset:18432
    v_mfma_f32_16x16x32_bf16 v[76:79], a[140:143], v[124:127], v[76:79]
    buffer_load_dwordx4 v158, s[44:47], s80 offen offset:2048 sc1 lds
    v_mfma_f32_16x16x32_bf16 v[72:75], a[136:139], v[124:127], v[72:75]
    ds_read_b64_tr_b16 a[40:41], v10 offset:20480
    v_mfma_f32_16x16x32_bf16 v[72:75], a[128:131], v[120:123], v[72:75]
    ds_read_b64_tr_b16 a[42:43], v10 offset:22528
    s_waitcnt lgkmcnt(4)
    v_mfma_f32_16x16x32_bf16 v[32:35], a[144:147], v[80:83], v[32:35]
    s_add_u32 m0, s73, 32768
    s_lshl_b32 s14, s87, 18
    v_mfma_f32_16x16x32_bf16 v[32:35], a[152:155], v[84:87], v[32:35]
    ds_read_b128 v[104:107], v159 offset:13056
    v_mfma_f32_16x16x32_bf16 v[36:39], a[156:159], v[84:87], v[36:39]
    ds_read_b128 v[108:111], v159 offset:19200
    buffer_load_dwordx4 v4, s[52:55], s14 offen offset:0 lds
    v_mfma_f32_16x16x32_bf16 v[36:39], a[148:151], v[80:83], v[36:39]
    ds_read_b128 v[112:115], v159 offset:13312
    v_mfma_f32_16x16x32_bf16 v[44:47], a[148:151], v[88:91], v[44:47]
    ds_read_b128 v[116:119], v159 offset:19456
    buffer_load_dwordx4 v5, s[52:55], s14 offen offset:1024 lds
    v_mfma_f32_16x16x32_bf16 v[44:47], a[156:159], v[92:95], v[44:47]
    ds_read_b128 v[120:123], v159 offset:13568
    v_mfma_f32_16x16x32_bf16 v[40:43], a[152:155], v[92:95], v[40:43]
    ds_read_b128 v[124:127], v159 offset:19712
    v_mfma_f32_16x16x32_bf16 v[40:43], a[144:147], v[88:91], v[40:43]
    ds_read_b64_tr_b16 a[36:37], v11 offset:16384
    buffer_load_dwordx4 v6, s[52:55], s14 offen offset:2048 lds
    v_mfma_f32_16x16x32_bf16 v[48:51], a[144:147], v[96:99], v[48:51]
    ds_read_b64_tr_b16 a[38:39], v11 offset:18432
    v_mfma_f32_16x16x32_bf16 v[48:51], a[152:155], v[100:103], v[48:51]
    buffer_load_dwordx4 v7, s[52:55], s14 offen offset:3072 lds
    v_mfma_f32_16x16x32_bf16 v[52:55], a[156:159], v[100:103], v[52:55]
    ds_read_b64_tr_b16 a[44:45], v11 offset:20480
    v_mfma_f32_16x16x32_bf16 v[52:55], a[148:151], v[96:99], v[52:55]
    ds_read_b64_tr_b16 a[46:47], v11 offset:22528
    s_waitcnt lgkmcnt(4)
    v_mfma_f32_16x16x32_bf16 v[60:63], a[148:151], v[104:107], v[60:63]
L_pl_G_4:
    s_cbranch_execz L_wret
    s_waitcnt vmcnt(17)
    s_barrier
    v_mfma_f32_16x16x32_bf16 v[60:63], a[156:159], v[108:111], v[60:63]
    ds_read_b128 v[80:83], v159 offset:24576
    v_mfma_f32_16x16x32_bf16 v[56:59], a[152:155], v[108:111], v[56:59]
    ds_read_b128 v[84:87], v159 offset:30720
    v_mfma_f32_16x16x32_bf16 v[56:59], a[144:147], v[104:107], v[56:59]
    ds_read_b128 v[88:91], v159 offset:24832
    v_mfma_f32_16x16x32_bf16 v[64:67], a[144:147], v[112:115], v[64:67]
    ds_read_b128 v[92:95], v159 offset:30976
    v_mfma_f32_16x16x32_bf16 v[64:67], a[152:155], v[116:119], v[64:67]
    ds_read_b128 v[96:99], v159 offset:25088
    v_mfma_f32_16x16x32_bf16 v[68:71], a[156:159], v[116:119], v[68:71]
    ds_read_b128 v[100:103], v159 offset:31232
    v_mfma_f32_16x16x32_bf16 v[68:71], a[148:151], v[112:115], v[68:71]
    v_mfma_f32_16x16x32_bf16 v[76:79], a[148:151], v[120:123], v[76:79]
    v_mfma_f32_16x16x32_bf16 v[76:79], a[156:159], v[124:127], v[76:79]
    v_mfma_f32_16x16x32_bf16 v[72:75], a[152:155], v[124:127], v[72:75]
    v_mfma_f32_16x16x32_bf16 v[72:75], a[144:147], v[120:123], v[72:75]
    s_waitcnt lgkmcnt(0)
    v_mfma_f32_16x16x32_bf16 v[32:35], a[160:163], v[80:83], v[32:35]
    v_mfma_f32_16x16x32_bf16 v[32:35], a[168:171], v[84:87], v[32:35]
    ds_read_b128 v[104:107], v159 offset:25344
    v_mfma_f32_16x16x32_bf16 v[36:39], a[172:175], v[84:87], v[36:39]
    ds_read_b128 v[108:111], v159 offset:31488
    v_mfma_f32_16x16x32_bf16 v[36:39], a[164:167], v[80:83], v[36:39]
    ds_read_b128 v[112:115], v159 offset:25600
    v_mfma_f32_16x16x32_bf16 v[44:47], a[164:167], v[88:91], v[44:47]
    ds_read_b128 v[116:119], v159 offset:31744
    v_mfma_f32_16x16x32_bf16 v[44:47], a[172:175], v[92:95], v[44:47]
    ds_read_b128 v[120:123], v159 offset:25856
    v_mfma_f32_16x16x32_bf16 v[40:43], a[168:171], v[92:95], v[40:43]
    ds_read_b128 v[124:127], v159 offset:32000
    v_mfma_f32_16x16x32_bf16 v[40:43], a[160:163], v[88:91], v[40:43]
    v_mfma_f32_16x16x32_bf16 v[48:51], a[160:163], v[96:99], v[48:51]
    v_mfma_f32_16x16x32_bf16 v[48:51], a[168:171], v[100:103], v[48:51]
    v_mfma_f32_16x16x32_bf16 v[52:55], a[172:175], v[100:103], v[52:55]
    v_mfma_f32_16x16x32_bf16 v[52:55], a[164:167], v[96:99], v[52:55]
    s_waitcnt lgkmcnt(0)
    v_mfma_f32_16x16x32_bf16 v[60:63], a[164:167], v[104:107], v[60:63]
    s_waitcnt vmcnt(14)
    s_barrier
    v_mfma_f32_16x16x32_bf16 v[60:63], a[172:175], v[108:111], v[60:63]
    ds_read_b128 v[80:83], v250 offset:0
    s_waitcnt vmcnt(6)
    v_mfma_f32_16x16x32_bf16 v[56:59], a[168:171], v[108:111], v[56:59]
    ds_read_b128 v[84:87], v250 offset:6144
    v_cmp_ne_u32 vcc, s68, v29
    v_mfma_f32_16x16x32_bf16 v[56:59], a[160:163], v[104:107], v[56:59]
    ds_read_b128 v[88:91], v250 offset:256
    v_mfma_f32_16x16x32_bf16 v[64:67], a[160:163], v[112:115], v[64:67]
    ds_read_b128 v[92:95], v250 offset:6400
    v_mfma_f32_16x16x32_bf16 v[64:67], a[168:171], v[116:119], v[64:67]
    ds_read_b128 v[96:99], v250 offset:512
    s_cbranch_vccnz L_rs_p5
L_ok_p5:
    v_mfma_f32_16x16x32_bf16 v[68:71], a[172:175], v[116:119], v[68:71]
    ds_read_b128 v[100:103], v250 offset:6656
    buffer_load_dwordx4 v[160:163], v246, s[44:47], s10 offen offset:0 sc1
    v_mfma_f32_16x16x32_bf16 v[68:71], a[164:167], v[112:115], v[68:71]
    v_mfma_f32_16x16x32_bf16 v[76:79], a[164:167], v[120:123], v[76:79]
    v_mfma_f32_16x16x32_bf16 v[76:79], a[172:175], v[124:127], v[76:79]
    buffer_load_dwordx4 v[164:167], v246, s[44:47], s10 offen offset:1024 sc1
    v_mfma_f32_16x16x32_bf16 v[72:75], a[168:171], v[124:127], v[72:75]
    buffer_load_dwordx4 v[168:171], v246, s[44:47], s10 offen offset:2048 sc1
    v_mfma_f32_16x16x32_bf16 v[72:75], a[160:163], v[120:123], v[72:75]
    s_waitcnt lgkmcnt(0)
    v_mfma_f32_16x16x32_bf16 v[32:35], a[176:179], v[80:83], v[32:35]
    v_mfma_f32_16x16x32_bf16 v[32:35], a[184:187], v[84:87], v[32:35]
    ds_read_b128 v[104:107], v250 offset:768
    v_mfma_f32_16x16x32_bf16 v[36:39], a[188:191], v[84:87], v[36:39]
    ds_read_b128 v[108:111], v250 offset:6912
    buffer_load_dwordx4 v[172:175], v247, s[44:47], s10 offen offset:0 sc1
    v_mfma_f32_16x16x32_bf16 v[36:39], a[180:183], v[80:83], v[36:39]
    ds_read_b128 v[112:115], v250 offset:1024
    v_mfma_f32_16x16x32_bf16 v[44:47], a[180:183], v[88:91], v[44:47]
    ds_read_b128 v[116:119], v250 offset:7168
    v_mfma_f32_16x16x32_bf16 v[44:47], a[188:191], v[92:95], v[44:47]
    ds_read_b128 v[120:123], v250 offset:1280
    buffer_load_dwordx4 v[176:179], v247, s[44:47], s10 offen offset:1024 sc1
    v_mfma_f32_16x16x32_bf16 v[40:43], a[184:187], v[92:95], v[40:43]
    ds_read_b128 v[124:127], v250 offset:7424
    v_mfma_f32_16x16x32_bf16 v[40:43], a[176:179], v[88:91], v[40:43]
    v_mfma_f32_16x16x32_bf16 v[48:51], a[176:179], v[96:99], v[48:51]
    v_mfma_f32_16x16x32_bf16 v[48:51], a[184:187], v[100:103], v[48:51]
    v_mfma_f32_16x16x32_bf16 v[52:55], a[188:191], v[100:103], v[52:55]
    buffer_load_dwordx4 v[180:183], v247, s[44:47], s10 offen offset:2048 sc1
    v_mfma_f32_16x16x32_bf16 v[52:55], a[180:183], v[96:99], v[52:55]
    s_waitcnt lgkmcnt(0)
    v_mfma_f32_16x16x32_bf16 v[60:63], a[180:183], v[104:107], v[60:63]
    s_barrier
    v_mfma_f32_16x16x32_bf16 v[60:63], a[188:191], v[108:111], v[60:63]
    ds_read_b128 v[80:83], v250 offset:12288
    s_add_u32 m0, s74, 12288
    v_mfma_f32_16x16x32_bf16 v[56:59], a[184:187], v[108:111], v[56:59]
    ds_read_b128 v[84:87], v250 offset:18432
    v_mfma_f32_16x16x32_bf16 v[56:59], a[176:179], v[104:107], v[56:59]
    ds_read_b128 v[88:91], v250 offset:12544
    buffer_load_dwordx4 v156, s[44:47], s81 offen offset:0 sc1 lds
    v_mfma_f32_16x16x32_bf16 v[64:67], a[176:179], v[112:115], v[64:67]
    ds_read_b128 v[92:95], v250 offset:18688
    v_mfma_f32_16x16x32_bf16 v[64:67], a[184:187], v[116:119], v[64:67]
    ds_read_b128 v[96:99], v250 offset:12800
    v_mfma_f32_16x16x32_bf16 v[68:71], a[188:191], v[116:119], v[68:71]
    ds_read_b128 v[100:103], v250 offset:18944
    buffer_load_dwordx4 v157, s[44:47], s81 offen offset:1024 sc1 lds
    v_mfma_f32_16x16x32_bf16 v[68:71], a[180:183], v[112:115], v[68:71]
    v_mfma_f32_16x16x32_bf16 v[76:79], a[180:183], v[120:123], v[76:79]
    v_mfma_f32_16x16x32_bf16 v[76:79], a[188:191], v[124:127], v[76:79]
    buffer_load_dwordx4 v158, s[44:47], s81 offen offset:2048 sc1 lds
    v_mfma_f32_16x16x32_bf16 v[72:75], a[184:187], v[124:127], v[72:75]
    v_mfma_f32_16x16x32_bf16 v[72:75], a[176:179], v[120:123], v[72:75]
    s_waitcnt lgkmcnt(0)
    v_mfma_f32_16x16x32_bf16 v[32:35], a[192:195], v[80:83], v[32:35]
    s_add_u32 m0, s73, 49152
    s_lshl_b32 s14, s88, 18
    v_mfma_f32_16x16x32_bf16 v[32:35], a[200:203], v[84:87], v[32:35]
    ds_read_b128 v[104:107], v250 offset:13056
    v_mfma_f32_16x16x32_bf16 v[36:39], a[204:207], v[84:87], v[36:39]
    ds_read_b128 v[108:111], v250 offset:19200
    buffer_load_dwordx4 v4, s[52:55], s14 offen offset:0 lds
    v_mfma_f32_16x16x32_bf16 v[36:39], a[196:199], v[80:83], v[36:39]
    ds_read_b128 v[112:115], v250 offset:13312
    v_mfma_f32_16x16x32_bf16 v[44:47], a[196:199], v[88:91], v[44:47]
    ds_read_b128 v[116:119], v250 offset:19456
    buffer_load_dwordx4 v5, s[52:55], s14 offen offset:1024 lds
    v_mfma_f32_16x16x32_bf16 v[44:47], a[204:207], v[92:95], v[44:47]
    ds_read_b128 v[120:123], v250 offset:13568
    v_mfma_f32_16x16x32_bf16 v[40:43], a[200:203], v[92:95], v[40:43]
    ds_read_b128 v[124:127], v250 offset:19712
    v_mfma_f32_16x16x32_bf16 v[40:43], a[192:195], v[88:91], v[40:43]
    buffer_load_dwordx4 v6, s[52:55], s14 offen offset:2048 lds
    v_mfma_f32_16x16x32_bf16 v[48:51], a[192:195], v[96:99], v[48:51]
    v_mfma_f32_16x16x32_bf16 v[48:51], a[200:203], v[100:103], v[48:51]
    buffer_load_dwordx4 v7, s[52:55], s14 offen offset:3072 lds
    v_mfma_f32_16x16x32_bf16 v[52:55], a[204:207], v[100:103], v[52:55]
    v_mfma_f32_16x16x32_bf16 v[52:55], a[196:199], v[96:99], v[52:55]
    s_waitcnt lgkmcnt(0)
    v_mfma_f32_16x16x32_bf16 v[60:63], a[196:199], v[104:107], v[60:63]
    s_barrier
    v_mfma_f32_16x16x32_bf16 v[60:63], a[204:207], v[108:111], v[60:63]
    ds_read_b128 v[80:83], v250 offset:24576
    v_mfma_f32_16x16x32_bf16 v[56:59], a[200:203], v[108:111], v[56:59]
    ds_read_b128 v[84:87], v250 offset:30720
    v_mfma_f32_16x16x32_bf16 v[56:59], a[192:195], v[104:107], v[56:59]
    ds_read_b128 v[88:91], v250 offset:24832
    v_mfma_f32_16x16x32_bf16 v[64:67], a[192:195], v[112:115], v[64:67]
    ds_read_b128 v[92:95], v250 offset:30976
    v_mfma_f32_16x16x32_bf16 v[64:67], a[200:203], v[116:119], v[64:67]
    ds_read_b128 v[96:99], v250 offset:25088
    v_mfma_f32_16x16x32_bf16 v[68:71], a[204:207], v[116:119], v[68:71]
    ds_read_b128 v[100:103], v250 offset:31232
    s_waitcnt vmcnt(7)
    v_mfma_f32_16x16x32_bf16 v[68:71], a[196:199], v[112:115], v[68:71]
    v_mfma_f32_16x16x32_bf16 v[76:79], a[196:199], v[120:123], v[76:79]
    v_mfma_f32_16x16x32_bf16 v[76:79], a[204:207], v[124:127], v[76:79]
    v_mfma_f32_16x16x32_bf16 v[72:75], a[200:203], v[124:127], v[72:75]
    v_mfma_f32_16x16x32_bf16 v[72:75], a[192:195], v[120:123], v[72:75]
    s_waitcnt lgkmcnt(0)
    v_mfma_f32_16x16x32_bf16 v[32:35], a[208:211], v[80:83], v[32:35]
    s_add_u32 m0, s73, 65536
    s_lshl_b32 s14, s89, 18
    v_mfma_f32_16x16x32_bf16 v[32:35], a[216:219], v[84:87], v[32:35]
    ds_read_b128 v[104:107], v250 offset:25344
    v_mfma_f32_16x16x32_bf16 v[36:39], a[220:223], v[84:87], v[36:39]
    ds_read_b128 v[108:111], v250 offset:31488
    buffer_load_dwordx4 v4, s[52:55], s14 offen offset:0 lds
    v_and_b32 v193, 0xffff0000, v172
    v_lshlrev_b32 v192, 16, v172
    v_mfma_f32_16x16x32_bf16 v[36:39], a[212:215], v[80:83], v[36:39]
    ds_read_b128 v[112:115], v250 offset:25600
    v_and_b32 v195, 0xffff0000, v173
    v_lshlrev_b32 v194, 16, v173
    v_mfma_f32_16x16x32_bf16 v[44:47], a[212:215], v[88:91], v[44:47]
    ds_read_b128 v[116:119], v250 offset:31744
    buffer_load_dwordx4 v5, s[52:55], s14 offen offset:1024 lds
    v_add_f32 v56, v56, v192
    v_mfma_f32_16x16x32_bf16 v[44:47], a[220:223], v[92:95], v[44:47]
    ds_read_b128 v[120:123], v250 offset:25856
    v_add_f32 v57, v57, v193
    v_add_f32 v58, v58, v194
    v_mfma_f32_16x16x32_bf16 v[40:43], a[216:219], v[92:95], v[40:43]
    ds_read_b128 v[124:127], v250 offset:32000
    v_add_f32 v59, v59, v195
    v_and_b32 v197, 0xffff0000, v174
    v_mfma_f32_16x16x32_bf16 v[40:43], a[208:211], v[88:91], v[40:43]
    buffer_load_dwordx4 v6, s[52:55], s14 offen offset:2048 lds
    v_lshlrev_b32 v196, 16, v174
    v_and_b32 v199, 0xffff0000, v175
    v_mfma_f32_16x16x32_bf16 v[48:51], a[208:211], v[96:99], v[48:51]
    v_lshlrev_b32 v198, 16, v175
    v_add_f32 v60, v60, v196
    v_mfma_f32_16x16x32_bf16 v[48:51], a[216:219], v[100:103], v[48:51]
    buffer_load_dwordx4 v7, s[52:55], s14 offen offset:3072 lds
    v_add_f32 v61, v61, v197
    v_mfma_f32_16x16x32_bf16 v[52:55], a[220:223], v[100:103], v[52:55]
    v_add_f32 v62, v62, v198
    v_add_f32 v63, v63, v199
    v_mfma_f32_16x16x32_bf16 v[52:55], a[212:215], v[96:99], v[52:55]
    s_waitcnt lgkmcnt(0)
    v_mfma_f32_16x16x32_bf16 v[60:63], a[212:215], v[104:107], v[60:63]
    s_barrier
    v_mfma_f32_16x16x32_bf16 v[60:63], a[220:223], v[108:111], v[60:63]
    ds_read_b128 v[80:83], v159 offset:0
    v_mfma_f32_16x16x32_bf16 v[56:59], a[216:219], v[108:111], v[56:59]
    ds_read_b128 v[84:87], v159 offset:6144
    v_and_b32 v193, 0xffff0000, v160
    v_lshlrev_b32 v192, 16, v160
    v_mfma_f32_16x16x32_bf16 v[56:59], a[208:211], v[104:107], v[56:59]
    ds_read_b128 v[88:91], v159 offset:256
    v_and_b32 v195, 0xffff0000, v161
    v_lshlrev_b32 v194, 16, v161
    v_mfma_f32_16x16x32_bf16 v[64:67], a[208:211], v[112:115], v[64:67]
    ds_read_b128 v[92:95], v159 offset:6400
    v_add_f32 v32, v32, v192
    v_mfma_f32_16x16x32_bf16 v[64:67], a[216:219], v[116:119], v[64:67]
    ds_read_b128 v[96:99], v159 offset:512
    v_add_f32 v33, v33, v193
    v_add_f32 v34, v34, v194
    v_mfma_f32_16x16x32_bf16 v[68:71], a[220:223], v[116:119], v[68:71]
    ds_read_b128 v[100:103], v159 offset:6656
    v_add_f32 v35, v35, v195
    v_and_b32 v197, 0xffff0000, v162
    v_mfma_f32_16x16x32_bf16 v[68:71], a[212:215], v[112:115], v[68:71]
    ds_read_b64_tr_b16 a[48:49], v10 offset:32768
    v_lshlrev_b32 v196, 16, v162
    v_and_b32 v199, 0xffff0000, v163
    v_mfma_f32_16x16x32_bf16 v[76:79], a[212:215], v[120:123], v[76:79]
    ds_read_b64_tr_b16 a[50:51], v10 offset:34816
    v_lshlrev_b32 v198, 16, v163
    v_mfma_f32_16x16x32_bf16 v[76:79], a[220:223], v[124:127], v[76:79]
    v_add_f32 v36, v36, v196
    v_add_f32 v37, v37, v197
    v_mfma_f32_16x16x32_bf16 v[72:75], a[216:219], v[124:127], v[72:75]
    ds_read_b64_tr_b16 a[56:57], v10 offset:36864
    v_add_f32 v38, v38, v198
    v_add_f32 v39, v39, v199
    v_mfma_f32_16x16x32_bf16 v[72:75], a[208:211], v[120:123], v[72:75]
    ds_read_b64_tr_b16 a[58:59], v10 offset:38912
    s_waitcnt lgkmcnt(4)
    v_mfma_f32_16x16x32_bf16 v[32:35], a[224:227], v[80:83], v[32:35]
    s_add_u32 m0, s73, 0
    s_lshl_b32 s14, s90, 18
    v_mfma_f32_16x16x32_bf16 v[32:35], a[232:235], v[84:87], v[32:35]
    ds_read_b128 v[104:107], v159 offset:768
    v_mfma_f32_16x16x32_bf16 v[36:39], a[236:239], v[84:87], v[36:39]
    ds_read_b128 v[108:111], v159 offset:6912
    buffer_load_dwordx4 v4, s[52:55], s14 offen offset:0 lds
    v_and_b32 v193, 0xffff0000, v176
    v_lshlrev_b32 v192, 16, v176
    v_mfma_f32_16x16x32_bf16 v[36:39], a[228:231], v[80:83], v[36:39]
    ds_read_b128 v[112:115], v159 offset:1024
    v_and_b32 v195, 0xffff0000, v177
    v_lshlrev_b32 v194, 16, v177
    v_mfma_f32_16x16x32_bf16 v[44:47], a[228:231], v[88:91], v[44:47]
    ds_read_b128 v[116:119], v159 offset:7168
    buffer_load_dwordx4 v5, s[52:55], s14 offen offset:1024 lds
    v_add_f32 v64, v64, v192
    v_mfma_f32_16x16x32_bf16 v[44:47], a[236:239], v[92:95], v[44:47]
    ds_read_b128 v[120:123], v159 offset:1280
    v_add_f32 v65, v65, v193
    v_add_f32 v66, v66, v194
    v_mfma_f32_16x16x32_bf16 v[40:43], a[232:235], v[92:95], v[40:43]
    ds_read_b128 v[124:127], v159 offset:7424
    v_add_f32 v67, v67, v195
    v_and_b32 v197, 0xffff0000, v178
    v_mfma_f32_16x16x32_bf16 v[40:43], a[224:227], v[88:91], v[40:43]
    ds_read_b64_tr_b16 a[52:53], v11 offset:32768
    buffer_load_dwordx4 v6, s[52:55], s14 offen offset:2048 lds
    v_lshlrev_b32 v196, 16, v178
    v_and_b32 v199, 0xffff0000, v179
    v_mfma_f32_16x16x32_bf16 v[48:51], a[224:227], v[96:99], v[48:51]
    ds_read_b64_tr_b16 a[54:55], v11 offset:34816
    v_lshlrev_b32 v198, 16, v179
    v_mfma_f32_16x16x32_bf16 v[48:51], a[232:235], v[100:103], v[48:51]
    buffer_load_dwordx4 v7, s[52:55], s14 offen offset:3072 lds
    v_add_f32 v68, v68, v196
    v_add_f32 v69, v69, v197
    v_mfma_f32_16x16x32_bf16 v[52:55], a[236:239], v[100:103], v[52:55]
    ds_read_b64_tr_b16 a[60:61], v11 offset:36864
    v_add_f32 v70, v70, v198
    v_add_f32 v71, v71, v199
    v_mfma_f32_16x16x32_bf16 v[52:55], a[228:231], v[96:99], v[52:55]
    ds_read_b64_tr_b16 a[62:63], v11 offset:38912
    s_waitcnt lgkmcnt(4)
    v_mfma_f32_16x16x32_bf16 v[60:63], a[228:231], v[104:107], v[60:63]
    s_waitcnt vmcnt(12)
    s_barrier
    v_mfma_f32_16x16x32_bf16 v[60:63], a[236:239], v[108:111], v[60:63]
    ds_read_b128 v[80:83], v159 offset:12288
    v_mfma_f32_16x16x32_bf16 v[56:59], a[232:235], v[108:111], v[56:59]
    ds_read_b128 v[84:87], v159 offset:18432
    v_and_b32 v193, 0xffff0000, v164
    v_lshlrev_b32 v192, 16, v164
    v_mfma_f32_16x16x32_bf16 v[56:59], a[224:227], v[104:107], v[56:59]
    ds_read_b128 v[88:91], v159 offset:12544
    v_and_b32 v195, 0xffff0000, v165
    v_lshlrev_b32 v194, 16, v165
    v_mfma_f32_16x16x32_bf16 v[64:67], a[224:227], v[112:115], v[64:67]
    ds_read_b128 v[92:95], v159 offset:18688
    v_add_f32 v40, v40, v192
    v_mfma_f32_16x16x32_bf16 v[64:67], a[232:235], v[116:119], v[64:67]
    ds_read_b128 v[96:99], v159 offset:12800
    v_add_f32 v41, v41, v193
    v_add_f32 v42, v42, v194
    v_mfma_f32_16x16x32_bf16 v[68:71], a[236:239], v[116:119], v[68:71]
    ds_read_b128 v[100:103], v159 offset:18944
    v_add_f32 v43, v43, v195
    v_mfma_f32_16x16x32_bf16 v[68:71], a[228:231], v[112:115], v[68:71]
    v_and_b32 v197, 0xffff0000, v166
    v_lshlrev_b32 v196, 16, v166
    v_mfma_f32_16x16x32_bf16 v[76:79], a[228:231], v[120:123], v[76:79]
    v_and_b32 v199, 0xffff0000, v167
    v_lshlrev_b32 v198, 16, v167
    v_mfma_f32_16x16x32_bf16 v[76:79], a[236:239], v[124:127], v[76:79]
    v_add_f32 v44, v44, v196
    v_add_f32 v45, v45, v197
    v_mfma_f32_16x16x32_bf16 v[72:75], a[232:235], v[124:127], v[72:75]
    v_add_f32 v46, v46, v198
    v_add_f32 v47, v47, v199
    v_mfma_f32_16x16x32_bf16 v[72:75], a[224:227], v[120:123], v[72:75]
    s_waitcnt lgkmcnt(0)
    v_mfma_f32_16x16x32_bf16 v[32:35], a[240:243], v[80:83], v[32:35]
    s_add_u32 m0, s73, 16384
    s_lshl_b32 s14, s91, 18
    v_mfma_f32_16x16x32_bf16 v[32:35], a[248:251], v[84:87], v[32:35]
    ds_read_b128 v[104:107], v159 offset:13056
    v_mfma_f32_16x16x32_bf16 v[36:39], a[252:255], v[84:87], v[36:39]
    ds_read_b128 v[108:111], v159 offset:19200
    buffer_load_dwordx4 v4, s[52:55], s14 offen offset:0 lds
    v_and_b32 v193, 0xffff0000, v180
    v_lshlrev_b32 v192, 16, v180
    v_mfma_f32_16x16x32_bf16 v[36:39], a[244:247], v[80:83], v[36:39]
    ds_read_b128 v[112:115], v159 offset:13312
    v_and_b32 v195, 0xffff0000, v181
    v_lshlrev_b32 v194, 16, v181
    v_mfma_f32_16x16x32_bf16 v[44:47], a[244:247], v[88:91], v[44:47]
    ds_read_b128 v[116:119], v159 offset:19456
    buffer_load_dwordx4 v5, s[52:55], s14 offen offset:1024 lds
    v_add_f32 v72, v72, v192
    v_mfma_f32_16x16x32_bf16 v[44:47], a[252:255], v[92:95], v[44:47]
    ds_read_b128 v[120:123], v159 offset:13568
    v_add_f32 v73, v73, v193
    v_add_f32 v74, v74, v194
    v_mfma_f32_16x16x32_bf16 v[40:43], a[248:251], v[92:95], v[40:43]
    ds_read_b128 v[124:127], v159 offset:19712
    v_add_f32 v75, v75, v195
    v_and_b32 v197, 0xffff0000, v182
    v_mfma_f32_16x16x32_bf16 v[40:43], a[240:243], v[88:91], v[40:43]
    buffer_load_dwordx4 v6, s[52:55], s14 offen offset:2048 lds
    v_lshlrev_b32 v196, 16, v182
    v_and_b32 v199, 0xffff0000, v183
    v_mfma_f32_16x16x32_bf16 v[48:51], a[240:243], v[96:99], v[48:51]
    v_lshlrev_b32 v198, 16, v183
    v_add_f32 v76, v76, v196
    v_mfma_f32_16x16x32_bf16 v[48:51], a[248:251], v[100:103], v[48:51]
    buffer_load_dwordx4 v7, s[52:55], s14 offen offset:3072 lds
    v_add_f32 v77, v77, v197
    v_mfma_f32_16x16x32_bf16 v[52:55], a[252:255], v[100:103], v[52:55]
    v_add_f32 v78, v78, v198
    v_add_f32 v79, v79, v199
    v_mfma_f32_16x16x32_bf16 v[52:55], a[244:247], v[96:99], v[52:55]
    s_waitcnt lgkmcnt(0)
    v_mfma_f32_16x16x32_bf16 v[60:63], a[244:247], v[104:107], v[60:63]
    s_barrier
    v_mfma_f32_16x16x32_bf16 v[60:63], a[252:255], v[108:111], v[60:63]
    s_add_u32 m0, s73, 131072
    s_lshl_b32 s14, s92, 18
    v_mfma_f32_16x16x32_bf16 v[56:59], a[248:251], v[108:111], v[56:59]
    buffer_load_dwordx4 v4, s[52:55], s14 offen offset:0 lds
    v_and_b32 v193, 0xffff0000, v168
    v_lshlrev_b32 v192, 16, v168
    v_mfma_f32_16x16x32_bf16 v[56:59], a[240:243], v[104:107], v[56:59]
    buffer_load_dwordx4 v5, s[52:55], s14 offen offset:1024 lds
    v_and_b32 v195, 0xffff0000, v169
    v_lshlrev_b32 v194, 16, v169
    v_mfma_f32_16x16x32_bf16 v[64:67], a[240:243], v[112:115], v[64:67]
    buffer_load_dwordx4 v6, s[52:55], s14 offen offset:2048 lds
    v_add_f32 v48, v48, v192
    v_mfma_f32_16x16x32_bf16 v[64:67], a[248:251], v[116:119], v[64:67]
    buffer_load_dwordx4 v7, s[52:55], s14 offen offset:3072 lds
    v_add_f32 v49, v49, v193
    v_add_f32 v50, v50, v194
    v_mfma_f32_16x16x32_bf16 v[68:71], a[252:255], v[116:119], v[68:71]
    s_add_u32 m0, s73, 147456
    s_lshl_b32 s14, s93, 18
    v_add_f32 v51, v51, v195
    v_and_b32 v197, 0xffff0000, v170
    v_mfma_f32_16x16x32_bf16 v[68:71], a[244:247], v[112:115], v[68:71]
    buffer_load_dwordx4 v4, s[52:55], s14 offen offset:0 lds
    v_lshlrev_b32 v196, 16, v170
    v_and_b32 v199, 0xffff0000, v171
    v_mfma_f32_16x16x32_bf16 v[76:79], a[244:247], v[120:123], v[76:79]
    buffer_load_dwordx4 v5, s[52:55], s14 offen offset:1024 lds
    v_lshlrev_b32 v198, 16, v171
    v_mfma_f32_16x16x32_bf16 v[76:79], a[252:255], v[124:127], v[76:79]
    buffer_load_dwordx4 v6, s[52:55], s14 offen offset:2048 lds
    v_add_f32 v52, v52, v196
    v_add_f32 v53, v53, v197
    v_mfma_f32_16x16x32_bf16 v[72:75], a[248:251], v[124:127], v[72:75]
    buffer_load_dwordx4 v7, s[52:55], s14 offen offset:3072 lds
    v_add_f32 v54, v54, v198
    v_add_f32 v55, v55, v199
    v_mfma_f32_16x16x32_bf16 v[72:75], a[240:243], v[120:123], v[72:75]
    s_waitcnt lgkmcnt(0)
    v_mov_b32 v88, 0xc0135761
    s_mov_b32 s10, 0xbdd2d3e8
    s_lshl_b32 s9, s69, 2
    s_add_u32 s9, s9, s3
    s_mul_i32 s9, s9, 69632
    s_add_u32 s9, s9, 12795904
    v_pk_mul_f32 v[160:161], v[32:33], v[32:33]
    v_pk_mul_f32 v[162:163], v[34:35], v[34:35]
    v_pk_mul_f32 v[164:165], v[36:37], v[36:37]
    v_pk_mul_f32 v[166:167], v[38:39], v[38:39]
    v_pk_mul_f32 v[168:169], v[40:41], v[40:41]
    v_pk_mul_f32 v[170:171], v[42:43], v[42:43]
    v_pk_mul_f32 v[172:173], v[44:45], v[44:45]
    v_pk_mul_f32 v[174:175], v[46:47], v[46:47]
    v_pk_fma_f32 v[160:161], v[160:161], s[10:11], v[88:89] op_sel_hi:[1,0,0]
    v_pk_fma_f32 v[162:163], v[162:163], s[10:11], v[88:89] op_sel_hi:[1,0,0]
    v_pk_fma_f32 v[164:165], v[164:165], s[10:11], v[88:89] op_sel_hi:[1,0,0]
    v_pk_fma_f32 v[166:167], v[166:167], s[10:11], v[88:89] op_sel_hi:[1,0,0]
    v_pk_fma_f32 v[168:169], v[168:169], s[10:11], v[88:89] op_sel_hi:[1,0,0]
    v_pk_fma_f32 v[170:171], v[170:171], s[10:11], v[88:89] op_sel_hi:[1,0,0]
    v_pk_fma_f32 v[172:173], v[172:173], s[10:11], v[88:89] op_sel_hi:[1,0,0]
    v_pk_fma_f32 v[174:175], v[174:175], s[10:11], v[88:89] op_sel_hi:[1,0,0]
    v_pk_mul_f32 v[160:161], v[160:161], v[32:33]
    v_pk_mul_f32 v[162:163], v[162:163], v[34:35]
    v_pk_mul_f32 v[164:165], v[164:165], v[36:37]
    v_pk_mul_f32 v[166:167], v[166:167], v[38:39]
    v_pk_mul_f32 v[168:169], v[168:169], v[40:41]
    v_pk_mul_f32 v[170:171], v[170:171], v[42:43]
    v_pk_mul_f32 v[172:173], v[172:173], v[44:45]
    v_pk_mul_f32 v[174:175], v[174:175], v[46:47]
    v_exp_f32 v160, v160
    v_exp_f32 v161, v161
    v_exp_f32 v162, v162
    v_exp_f32 v163, v163
    v_exp_f32 v164, v164
    v_exp_f32 v165, v165
    v_exp_f32 v166, v166
    v_exp_f32 v167, v167
    v_exp_f32 v168, v168
    v_exp_f32 v169, v169
    v_exp_f32 v170, v170
    v_exp_f32 v171, v171
    v_exp_f32 v172, v172
    v_exp_f32 v173, v173
    v_exp_f32 v174, v174
    v_exp_f32 v175, v175
    v_pk_add_f32 v[160:161], v[160:161], 1.0 op_sel_hi:[1,0]
    v_pk_add_f32 v[162:163], v[162:163], 1.0 op_sel_hi:[1,0]
    v_pk_add_f32 v[164:165], v[164:165], 1.0 op_sel_hi:[1,0]
    v_pk_add_f32 v[166:167], v[166:167], 1.0 op_sel_hi:[1,0]
    v_pk_add_f32 v[168:169], v[168:169], 1.0 op_sel_hi:[1,0]
    v_pk_add_f32 v[170:171], v[170:171], 1.0 op_sel_hi:[1,0]
    v_pk_add_f32 v[172:173], v[172:173], 1.0 op_sel_hi:[1,0]
    v_pk_add_f32 v[174:175], v[174:175], 1.0 op_sel_hi:[1,0]
    v_rcp_f32 v160, v160
    v_rcp_f32 v161, v161
    v_rcp_f32 v162, v162
    v_rcp_f32 v163, v163
    v_rcp_f32 v164, v164
    v_rcp_f32 v165, v165
    v_rcp_f32 v166, v166
    v_rcp_f32 v167, v167
    v_rcp_f32 v168, v168
    v_rcp_f32 v169, v169
    v_rcp_f32 v170, v170
    v_rcp_f32 v171, v171
    v_rcp_f32 v172, v172
    v_rcp_f32 v173, v173
    v_rcp_f32 v174, v174
    v_rcp_f32 v175, v175
    v_pk_mul_f32 v[32:33], v[32:33], v[160:161]
    v_pk_mul_f32 v[34:35], v[34:35], v[162:163]
    v_pk_mul_f32 v[36:37], v[36:37], v[164:165]
    v_pk_mul_f32 v[38:39], v[38:39], v[166:167]
    v_pk_mul_f32 v[40:41], v[40:41], v[168:169]
    v_pk_mul_f32 v[42:43], v[42:43], v[170:171]
    v_pk_mul_f32 v[44:45], v[44:45], v[172:173]
    v_pk_mul_f32 v[46:47], v[46:47], v[174:175]
    v_cvt_pk_bf16_f32 v96, v32, v33
    v_cvt_pk_bf16_f32 v97, v34, v35
    v_cvt_pk_bf16_f32 v98, v36, v37
    v_cvt_pk_bf16_f32 v99, v38, v39
    v_cvt_pk_bf16_f32 v100, v40, v41
    v_cvt_pk_bf16_f32 v101, v42, v43
    v_cvt_pk_bf16_f32 v102, v44, v45
    v_cvt_pk_bf16_f32 v103, v46, v47
    buffer_store_dwordx4 v[96:99], v240, s[44:47], s9 offen sc1
    buffer_store_dwordx4 v[100:103], v241, s[44:47], s9 offen sc1
    v_pk_mul_f32 v[160:161], v[48:49], v[48:49]
    v_pk_mul_f32 v[162:163], v[50:51], v[50:51]
    v_pk_mul_f32 v[164:165], v[52:53], v[52:53]
    v_pk_mul_f32 v[166:167], v[54:55], v[54:55]
    v_pk_mul_f32 v[168:169], v[56:57], v[56:57]
    v_pk_mul_f32 v[170:171], v[58:59], v[58:59]
    v_pk_mul_f32 v[172:173], v[60:61], v[60:61]
    v_pk_mul_f32 v[174:175], v[62:63], v[62:63]
    v_pk_fma_f32 v[160:161], v[160:161], s[10:11], v[88:89] op_sel_hi:[1,0,0]
    v_pk_fma_f32 v[162:163], v[162:163], s[10:11], v[88:89] op_sel_hi:[1,0,0]
    v_pk_fma_f32 v[164:165], v[164:165], s[10:11], v[88:89] op_sel_hi:[1,0,0]
    v_pk_fma_f32 v[166:167], v[166:167], s[10:11], v[88:89] op_sel_hi:[1,0,0]
    v_pk_fma_f32 v[168:169], v[168:169], s[10:11], v[88:89] op_sel_hi:[1,0,0]
    v_pk_fma_f32 v[170:171], v[170:171], s[10:11], v[88:89] op_sel_hi:[1,0,0]
    v_pk_fma_f32 v[172:173], v[172:173], s[10:11], v[88:89] op_sel_hi:[1,0,0]
    v_pk_fma_f32 v[174:175], v[174:175], s[10:11], v[88:89] op_sel_hi:[1,0,0]
    v_pk_mul_f32 v[160:161], v[160:161], v[48:49]
    v_pk_mul_f32 v[162:163], v[162:163], v[50:51]
    v_pk_mul_f32 v[164:165], v[164:165], v[52:53]
    v_pk_mul_f32 v[166:167], v[166:167], v[54:55]
    v_pk_mul_f32 v[168:169], v[168:169], v[56:57]
    v_pk_mul_f32 v[170:171], v[170:171], v[58:59]
    v_pk_mul_f32 v[172:173], v[172:173], v[60:61]
    v_pk_mul_f32 v[174:175], v[174:175], v[62:63]
    v_exp_f32 v160, v160
    v_exp_f32 v161, v161
    v_exp_f32 v162, v162
    v_exp_f32 v163, v163
    v_exp_f32 v164, v164
    v_exp_f32 v165, v165
    v_exp_f32 v166, v166
    v_exp_f32 v167, v167
    v_exp_f32 v168, v168
    v_exp_f32 v169, v169
    v_exp_f32 v170, v170
    v_exp_f32 v171, v171
    v_exp_f32 v172, v172
    v_exp_f32 v173, v173
    v_exp_f32 v174, v174
    v_exp_f32 v175, v175
    v_pk_add_f32 v[160:161], v[160:161], 1.0 op_sel_hi:[1,0]
    v_pk_add_f32 v[162:163], v[162:163], 1.0 op_sel_hi:[1,0]
    v_pk_add_f32 v[164:165], v[164:165], 1.0 op_sel_hi:[1,0]
    v_pk_add_f32 v[166:167], v[166:167], 1.0 op_sel_hi:[1,0]
    v_pk_add_f32 v[168:169], v[168:169], 1.0 op_sel_hi:[1,0]
    v_pk_add_f32 v[170:171], v[170:171], 1.0 op_sel_hi:[1,0]
    v_pk_add_f32 v[172:173], v[172:173], 1.0 op_sel_hi:[1,0]
    v_pk_add_f32 v[174:175], v[174:175], 1.0 op_sel_hi:[1,0]
    v_rcp_f32 v160, v160
    v_rcp_f32 v161, v161
    v_rcp_f32 v162, v162
    v_rcp_f32 v163, v163
    v_rcp_f32 v164, v164
    v_rcp_f32 v165, v165
    v_rcp_f32 v166, v166
    v_rcp_f32 v167, v167
    v_rcp_f32 v168, v168
    v_rcp_f32 v169, v169
    v_rcp_f32 v170, v170
    v_rcp_f32 v171, v171
    v_rcp_f32 v172, v172
    v_rcp_f32 v173, v173
    v_rcp_f32 v174, v174
    v_rcp_f32 v175, v175
    v_pk_mul_f32 v[48:49], v[48:49], v[160:161]
    v_pk_mul_f32 v[50:51], v[50:51], v[162:163]
    v_pk_mul_f32 v[52:53], v[52:53], v[164:165]
    v_pk_mul_f32 v[54:55], v[54:55], v[166:167]
    v_pk_mul_f32 v[56:57], v[56:57], v[168:169]
    v_pk_mul_f32 v[58:59], v[58:59], v[170:171]
    v_pk_mul_f32 v[60:61], v[60:61], v[172:173]
    v_pk_mul_f32 v[62:63], v[62:63], v[174:175]
    v_cvt_pk_bf16_f32 v104, v48, v49
    v_cvt_pk_bf16_f32 v105, v50, v51
    v_cvt_pk_bf16_f32 v106, v52, v53
    v_cvt_pk_bf16_f32 v107, v54, v55
    v_cvt_pk_bf16_f32 v108, v56, v57
    v_cvt_pk_bf16_f32 v109, v58, v59
    v_cvt_pk_bf16_f32 v110, v60, v61
    v_cvt_pk_bf16_f32 v111, v62, v63
    buffer_store_dwordx4 v[104:107], v242, s[44:47], s9 offen sc1
    buffer_store_dwordx4 v[108:111], v243, s[44:47], s9 offen sc1
    v_pk_mul_f32 v[160:161], v[64:65], v[64:65]
    v_pk_mul_f32 v[162:163], v[66:67], v[66:67]
    v_pk_mul_f32 v[164:165], v[68:69], v[68:69]
    v_pk_mul_f32 v[166:167], v[70:71], v[70:71]
    v_pk_mul_f32 v[168:169], v[72:73], v[72:73]
    v_pk_mul_f32 v[170:171], v[74:75], v[74:75]
    v_pk_mul_f32 v[172:173], v[76:77], v[76:77]
    v_pk_mul_f32 v[174:175], v[78:79], v[78:79]
    v_pk_fma_f32 v[160:161], v[160:161], s[10:11], v[88:89] op_sel_hi:[1,0,0]
    v_pk_fma_f32 v[162:163], v[162:163], s[10:11], v[88:89] op_sel_hi:[1,0,0]
    v_pk_fma_f32 v[164:165], v[164:165], s[10:11], v[88:89] op_sel_hi:[1,0,0]
    v_pk_fma_f32 v[166:167], v[166:167], s[10:11], v[88:89] op_sel_hi:[1,0,0]
    v_pk_fma_f32 v[168:169], v[168:169], s[10:11], v[88:89] op_sel_hi:[1,0,0]
    v_pk_fma_f32 v[170:171], v[170:171], s[10:11], v[88:89] op_sel_hi:[1,0,0]
    v_pk_fma_f32 v[172:173], v[172:173], s[10:11], v[88:89] op_sel_hi:[1,0,0]
    v_pk_fma_f32 v[174:175], v[174:175], s[10:11], v[88:89] op_sel_hi:[1,0,0]
    v_pk_mul_f32 v[160:161], v[160:161], v[64:65]
    v_pk_mul_f32 v[162:163], v[162:163], v[66:67]
    v_pk_mul_f32 v[164:165], v[164:165], v[68:69]
    v_pk_mul_f32 v[166:167], v[166:167], v[70:71]
    v_pk_mul_f32 v[168:169], v[168:169], v[72:73]
    v_pk_mul_f32 v[170:171], v[170:171], v[74:75]
    v_pk_mul_f32 v[172:173], v[172:173], v[76:77]
L_pl_G_5:
    s_cbranch_execz L_wret
    v_pk_mul_f32 v[174:175], v[174:175], v[78:79]
    v_exp_f32 v160, v160
    v_exp_f32 v161, v161
    v_exp_f32 v162, v162
    v_exp_f32 v163, v163
    v_exp_f32 v164, v164
    v_exp_f32 v165, v165
    v_exp_f32 v166, v166
    v_exp_f32 v167, v167
    v_exp_f32 v168, v168
    v_exp_f32 v169, v169
    v_exp_f32 v170, v170
    v_exp_f32 v171, v171
    v_exp_f32 v172, v172
    v_exp_f32 v173, v173
    v_exp_f32 v174, v174
    v_exp_f32 v175, v175
    v_pk_add_f32 v[160:161], v[160:161], 1.0 op_sel_hi:[1,0]
    v_pk_add_f32 v[162:163], v[162:163], 1.0 op_sel_hi:[1,0]
    v_pk_add_f32 v[164:165], v[164:165], 1.0 op_sel_hi:[1,0]
    v_pk_add_f32 v[166:167], v[166:167], 1.0 op_sel_hi:[1,0]
    v_pk_add_f32 v[168:169], v[168:169], 1.0 op_sel_hi:[1,0]
    v_pk_add_f32 v[170:171], v[170:171], 1.0 op_sel_hi:[1,0]
    v_pk_add_f32 v[172:173], v[172:173], 1.0 op_sel_hi:[1,0]
    v_pk_add_f32 v[174:175], v[174:175], 1.0 op_sel_hi:[1,0]
    v_rcp_f32 v160, v160
    v_rcp_f32 v161, v161
    v_rcp_f32 v162, v162
    v_rcp_f32 v163, v163
    v_rcp_f32 v164, v164
    v_rcp_f32 v165, v165
    v_rcp_f32 v166, v166
    v_rcp_f32 v167, v167
    v_rcp_f32 v168, v168
    v_rcp_f32 v169, v169
    v_rcp_f32 v170, v170
    v_rcp_f32 v171, v171
    v_rcp_f32 v172, v172
    v_rcp_f32 v173, v173
    v_rcp_f32 v174, v174
    v_rcp_f32 v175, v175
    v_pk_mul_f32 v[64:65], v[64:65], v[160:161]
    v_pk_mul_f32 v[66:67], v[66:67], v[162:163]
    v_pk_mul_f32 v[68:69], v[68:69], v[164:165]
    v_pk_mul_f32 v[70:71], v[70:71], v[166:167]
    v_pk_mul_f32 v[72:73], v[72:73], v[168:169]
    v_pk_mul_f32 v[74:75], v[74:75], v[170:171]
    v_pk_mul_f32 v[76:77], v[76:77], v[172:173]
    v_pk_mul_f32 v[78:79], v[78:79], v[174:175]
    v_cvt_pk_bf16_f32 v112, v64, v65
    v_cvt_pk_bf16_f32 v113, v66, v67
    v_cvt_pk_bf16_f32 v114, v68, v69
    v_cvt_pk_bf16_f32 v115, v70, v71
    v_cvt_pk_bf16_f32 v116, v72, v73
    v_cvt_pk_bf16_f32 v117, v74, v75
    v_cvt_pk_bf16_f32 v118, v76, v77
    v_cvt_pk_bf16_f32 v119, v78, v79
    buffer_store_dwordx4 v[112:115], v244, s[44:47], s9 offen sc1
    buffer_store_dwordx4 v[116:119], v245, s[44:47], s9 offen sc1
    s_waitcnt vmcnt(0)
    s_barrier
    buffer_store_dword v249, v17, s[44:47], 0 offen sc1
    ds_read_b64_tr_b16 a[64:65], v10 offset:49152
    s_add_u32 m0, s73, 32768
    s_lshl_b32 s14, s94, 18
    ds_read_b64_tr_b16 a[66:67], v10 offset:51200
    ds_read_b64_tr_b16 a[72:73], v10 offset:53248
    ds_read_b64_tr_b16 a[74:75], v10 offset:55296
    ds_read_b64_tr_b16 a[68:69], v11 offset:49152
    buffer_load_dwordx4 v4, s[52:55], s14 offen offset:0 lds
    ds_read_b64_tr_b16 a[70:71], v11 offset:51200
    ds_read_b64_tr_b16 a[76:77], v11 offset:53248
    ds_read_b64_tr_b16 a[78:79], v11 offset:55296
    v_add_u32 v10, 65536, v10
    ds_read_b64_tr_b16 a[80:81], v10 offset:0
    ds_read_b64_tr_b16 a[82:83], v10 offset:2048
    buffer_load_dwordx4 v5, s[52:55], s14 offen offset:1024 lds
    ds_read_b64_tr_b16 a[88:89], v10 offset:4096
    ds_read_b64_tr_b16 a[90:91], v10 offset:6144
    v_add_u32 v11, 65536, v11
    ds_read_b64_tr_b16 a[84:85], v11 offset:0
    ds_read_b64_tr_b16 a[86:87], v11 offset:2048
    ds_read_b64_tr_b16 a[92:93], v11 offset:4096
    buffer_load_dwordx4 v6, s[52:55], s14 offen offset:2048 lds
    ds_read_b64_tr_b16 a[94:95], v11 offset:6144
    v_add_u32 v10, -65536, v10
    ds_read_b64_tr_b16 a[96:97], v10 offset:0
    ds_read_b64_tr_b16 a[98:99], v10 offset:2048
    ds_read_b64_tr_b16 a[104:105], v10 offset:4096
    ds_read_b64_tr_b16 a[106:107], v10 offset:6144
    buffer_load_dwordx4 v7, s[52:55], s14 offen offset:3072 lds
    v_add_u32 v11, -65536, v11
    ds_read_b64_tr_b16 a[100:101], v11 offset:0
    ds_read_b64_tr_b16 a[102:103], v11 offset:2048
    ds_read_b64_tr_b16 a[108:109], v11 offset:4096
    ds_read_b64_tr_b16 a[110:111], v11 offset:6144
    ds_read_b64_tr_b16 a[112:113], v10 offset:16384
    s_add_u32 m0, s73, 81920
    s_lshl_b32 s14, s95, 18
    ds_read_b64_tr_b16 a[114:115], v10 offset:18432
    ds_read_b64_tr_b16 a[120:121], v10 offset:20480
    ds_read_b64_tr_b16 a[122:123], v10 offset:22528
    ds_read_b64_tr_b16 a[116:117], v11 offset:16384
    buffer_load_dwordx4 v4, s[52:55], s14 offen offset:0 lds
    ds_read_b64_tr_b16 a[118:119], v11 offset:18432
    ds_read_b64_tr_b16 a[124:125], v11 offset:20480
    ds_read_b64_tr_b16 a[126:127], v11 offset:22528
    v_add_u32 v10, 131072, v10
    ds_read_b64_tr_b16 a[128:129], v10 offset:0
    ds_read_b64_tr_b16 a[130:131], v10 offset:2048
    buffer_load_dwordx4 v5, s[52:55], s14 offen offset:1024 lds
    ds_read_b64_tr_b16 a[136:137], v10 offset:4096
    ds_read_b64_tr_b16 a[138:139], v10 offset:6144
    v_add_u32 v11, 131072, v11
    ds_read_b64_tr_b16 a[132:133], v11 offset:0
    ds_read_b64_tr_b16 a[134:135], v11 offset:2048
    ds_read_b64_tr_b16 a[140:141], v11 offset:4096
    buffer_load_dwordx4 v6, s[52:55], s14 offen offset:2048 lds
    ds_read_b64_tr_b16 a[142:143], v11 offset:6144
    ds_read_b64_tr_b16 a[144:145], v10 offset:16384
    ds_read_b64_tr_b16 a[146:147], v10 offset:18432
    ds_read_b64_tr_b16 a[152:153], v10 offset:20480
    ds_read_b64_tr_b16 a[154:155], v10 offset:22528
    buffer_load_dwordx4 v7, s[52:55], s14 offen offset:3072 lds
    ds_read_b64_tr_b16 a[148:149], v11 offset:16384
    ds_read_b64_tr_b16 a[150:151], v11 offset:18432
    ds_read_b64_tr_b16 a[156:157], v11 offset:20480
    ds_read_b64_tr_b16 a[158:159], v11 offset:22528
    s_bitcmp1_b32 s3, 1
    s_cselect_b32 s18, s85, s84
    s_mul_i32 s18, s18, 139264
    s_cselect_b32 s19, s87, s86
    s_mul_i32 s19, s19, 139264
    s_cselect_b32 s20, s89, s88
    s_mul_i32 s20, s20, 139264
    s_cselect_b32 s21, s91, s90
    s_mul_i32 s21, s21, 139264
    s_cselect_b32 s22, s93, s92
    s_mul_i32 s22, s22, 139264
    s_cselect_b32 s23, s95, s94
    s_mul_i32 s23, s23, 139264
    s_cselect_b32 s24, s97, s96
    s_mul_i32 s24, s24, 139264
    s_cselect_b32 s25, s99, s98
    s_mul_i32 s25, s25, 139264
    s_cselect_b32 s26, s101, s100
    s_mul_i32 s26, s26, 139264
    s_waitcnt lgkmcnt(0)
    s_barrier
    s_add_u32 m0, s73, 0
    s_lshl_b32 s14, s96, 18
    buffer_load_dwordx4 v4, s[52:55], s14 offen offset:0 lds
    buffer_load_dwordx4 v5, s[52:55], s14 offen offset:1024 lds
    buffer_load_dwordx4 v6, s[52:55], s14 offen offset:2048 lds
    buffer_load_dwordx4 v7, s[52:55], s14 offen offset:3072 lds
    s_add_u32 m0, s73, 16384
    s_lshl_b32 s14, s97, 18
    buffer_load_dwordx4 v4, s[52:55], s14 offen offset:0 lds
    buffer_load_dwordx4 v5, s[52:55], s14 offen offset:1024 lds
    buffer_load_dwordx4 v6, s[52:55], s14 offen offset:2048 lds
    buffer_load_dwordx4 v7, s[52:55], s14 offen offset:3072 lds
    s_add_u32 m0, s73, 49152
    s_lshl_b32 s14, s98, 18
    buffer_load_dwordx4 v4, s[52:55], s14 offen offset:0 lds
    buffer_load_dwordx4 v5, s[52:55], s14 offen offset:1024 lds
    buffer_load_dwordx4 v6, s[52:55], s14 offen offset:2048 lds
    buffer_load_dwordx4 v7, s[52:55], s14 offen offset:3072 lds
    s_add_u32 m0, s73, 65536
    s_lshl_b32 s14, s99, 18
    buffer_load_dwordx4 v4, s[52:55], s14 offen offset:0 lds
    buffer_load_dwordx4 v5, s[52:55], s14 offen offset:1024 lds
    buffer_load_dwordx4 v6, s[52:55], s14 offen offset:2048 lds
    buffer_load_dwordx4 v7, s[52:55], s14 offen offset:3072 lds
    v_mov_b32 v16, 0
    buffer_atomic_add v16, v15, s[44:47], 0 offen sc0 sc1
L_DG:
    s_waitcnt vmcnt(0)
    v_cmp_ne_u32 vcc, v13, v16
    s_cbranch_vccnz L_rs_p2G
L_ok_p2G:
    s_barrier
    s_add_u32 m0, s73, 97536
    s_nop 0
    buffer_load_dwordx4 v23, s[44:47], s18 offen offset:768 sc1 lds
    s_add_u32 m0, s73, 99328
    s_nop 0
    buffer_load_dwordx4 v20, s[44:47], s18 offen offset:0 sc1 lds
    s_add_u32 m0, s73, 99840
    s_nop 0
    buffer_load_dwordx4 v20, s[44:47], s18 offen offset:512 sc1 lds
    s_add_u32 m0, s73, 100608
    s_nop 0
    buffer_load_dwordx4 v23, s[44:47], s19 offen offset:768 sc1 lds
    s_add_u32 m0, s73, 114688
    s_nop 0
    buffer_load_dwordx4 v20, s[44:47], s19 offen offset:0 sc1 lds
    s_add_u32 m0, s73, 115200
    s_nop 0
    buffer_load_dwordx4 v20, s[44:47], s19 offen offset:512 sc1 lds
    s_add_u32 m0, s73, 115968
    s_nop 0
    buffer_load_dwordx4 v23, s[44:47], s20 offen offset:768 sc1 lds
    s_add_u32 m0, s73, 117760
    s_nop 0
    buffer_load_dwordx4 v20, s[44:47], s20 offen offset:0 sc1 lds
    v_mov_b32 v195, s68
    v_mov_b32 v199, s68
    v_mov_b32 v202, s68
    v_mov_b32 v203, s68
    s_waitcnt vmcnt(4)
    s_barrier
    ds_read_b128 v[104:107], v14 offset:0
    ds_read_b128 v[108:111], v14 offset:4096
    ds_read_b128 v[112:115], v14 offset:8192
    ds_read_b128 v[116:119], v14 offset:12288
    s_waitcnt lgkmcnt(2)
    v_mfma_f32_16x16x32_bf16 v[32:35], v[104:107], a[0:3], 0
    s_add_u32 m0, s73, 130560
    v_mfma_f32_16x16x32_bf16 v[32:35], v[108:111], a[8:11], v[32:35]
    buffer_load_dwordx4 v20, s[44:47], s20 offen offset:512 sc1 lds
    s_waitcnt lgkmcnt(0)
    v_mfma_f32_16x16x32_bf16 v[32:35], v[112:115], a[16:19], v[32:35]
    ds_read_b128 v[120:123], v14 offset:1024
    v_mfma_f32_16x16x32_bf16 v[32:35], v[116:119], a[24:27], v[32:35]
    ds_read_b128 v[124:127], v14 offset:5120
    v_mfma_f32_16x16x32_bf16 v[36:39], v[116:119], a[28:31], 0
    ds_read_b128 v[128:131], v14 offset:9216
    v_mfma_f32_16x16x32_bf16 v[36:39], v[112:115], a[20:23], v[36:39]
    ds_read_b128 v[132:135], v14 offset:13312
    v_mfma_f32_16x16x32_bf16 v[36:39], v[108:111], a[12:15], v[36:39]
    s_add_u32 m0, s73, 131328
    v_mfma_f32_16x16x32_bf16 v[36:39], v[104:107], a[4:7], v[36:39]
    buffer_load_dwordx4 v23, s[44:47], s21 offen offset:768 sc1 lds
    s_waitcnt lgkmcnt(2)
    v_mfma_f32_16x16x32_bf16 v[44:47], v[120:123], a[4:7], 0
    s_add_u32 m0, s73, 133120
    v_mfma_f32_16x16x32_bf16 v[44:47], v[124:127], a[12:15], v[44:47]
    buffer_load_dwordx4 v20, s[44:47], s21 offen offset:0 sc1 lds
    s_waitcnt lgkmcnt(0)
    v_mfma_f32_16x16x32_bf16 v[44:47], v[128:131], a[20:23], v[44:47]
    ds_read_b128 v[104:107], v14 offset:2048
    v_mfma_f32_16x16x32_bf16 v[44:47], v[132:135], a[28:31], v[44:47]
    ds_read_b128 v[108:111], v14 offset:6144
    v_mfma_f32_16x16x32_bf16 v[40:43], v[132:135], a[24:27], 0
    ds_read_b128 v[112:115], v14 offset:10240
    v_mfma_f32_16x16x32_bf16 v[40:43], v[128:131], a[16:19], v[40:43]
    ds_read_b128 v[116:119], v14 offset:14336
    v_mfma_f32_16x16x32_bf16 v[40:43], v[124:127], a[8:11], v[40:43]
    s_add_u32 m0, s73, 133632
    v_mfma_f32_16x16x32_bf16 v[40:43], v[120:123], a[0:3], v[40:43]
    buffer_load_dwordx4 v20, s[44:47], s21 offen offset:512 sc1 lds
    s_waitcnt lgkmcnt(2)
    v_mfma_f32_16x16x32_bf16 v[48:51], v[104:107], a[0:3], 0
    s_add_u32 m0, s73, 146688
    v_mfma_f32_16x16x32_bf16 v[48:51], v[108:111], a[8:11], v[48:51]
    buffer_load_dwordx4 v23, s[44:47], s22 offen offset:768 sc1 lds
    s_waitcnt lgkmcnt(0)
    v_mfma_f32_16x16x32_bf16 v[48:51], v[112:115], a[16:19], v[48:51]
    ds_read_b128 v[120:123], v14 offset:3072
    v_mfma_f32_16x16x32_bf16 v[48:51], v[116:119], a[24:27], v[48:51]
    ds_read_b128 v[124:127], v14 offset:7168
    v_mfma_f32_16x16x32_bf16 v[52:55], v[116:119], a[28:31], 0
    ds_read_b128 v[128:131], v14 offset:11264
    v_mfma_f32_16x16x32_bf16 v[52:55], v[112:115], a[20:23], v[52:55]
    ds_read_b128 v[132:135], v14 offset:15360
    v_mfma_f32_16x16x32_bf16 v[52:55], v[108:111], a[12:15], v[52:55]
    s_add_u32 m0, s73, 148480
    v_mfma_f32_16x16x32_bf16 v[52:55], v[104:107], a[4:7], v[52:55]
    buffer_load_dwordx4 v20, s[44:47], s22 offen offset:0 sc1 lds
    s_waitcnt lgkmcnt(2)
    v_mfma_f32_16x16x32_bf16 v[36:39], v[120:123], a[36:39], v[36:39]
    s_add_u32 m0, s73, 148992
    v_mfma_f32_16x16x32_bf16 v[36:39], v[124:127], a[44:47], v[36:39]
    buffer_load_dwordx4 v20, s[44:47], s22 offen offset:512 sc1 lds
    s_waitcnt lgkmcnt(0)
    v_mfma_f32_16x16x32_bf16 v[36:39], v[128:131], a[52:55], v[36:39]
    s_waitcnt vmcnt(7)
    s_barrier
    v_mfma_f32_16x16x32_bf16 v[36:39], v[132:135], a[60:63], v[36:39]
    ds_read_b128 v[104:107], v14 offset:16384
    v_add_u32 v10, -131072, v10
    v_mfma_f32_16x16x32_bf16 v[32:35], v[132:135], a[56:59], v[32:35]
    ds_read_b128 v[108:111], v14 offset:20480
    v_mfma_f32_16x16x32_bf16 v[32:35], v[128:131], a[48:51], v[32:35]
    ds_read_b128 v[112:115], v14 offset:24576
    ds_read_b64_tr_b16 a[160:161], v10 offset:32768
    v_mfma_f32_16x16x32_bf16 v[32:35], v[124:127], a[40:43], v[32:35]
    ds_read_b128 v[116:119], v14 offset:28672
    s_add_u32 m0, s73, 149760
    v_mfma_f32_16x16x32_bf16 v[32:35], v[120:123], a[32:35], v[32:35]
    buffer_load_dwordx4 v23, s[44:47], s23 offen offset:768 sc1 lds
    ds_read_b64_tr_b16 a[162:163], v10 offset:34816
    s_waitcnt lgkmcnt(4)
    v_mfma_f32_16x16x32_bf16 v[40:43], v[104:107], a[32:35], v[40:43]
    s_add_u32 m0, s73, 98304
    ds_read_b64_tr_b16 a[168:169], v10 offset:36864
    v_mfma_f32_16x16x32_bf16 v[40:43], v[108:111], a[40:43], v[40:43]
    buffer_load_dwordx4 v20, s[44:47], s23 offen offset:0 sc1 lds
    ds_read_b64_tr_b16 a[170:171], v10 offset:38912
    s_waitcnt lgkmcnt(3)
    v_mfma_f32_16x16x32_bf16 v[40:43], v[112:115], a[48:51], v[40:43]
    ds_read_b128 v[120:123], v14 offset:17408
    v_mfma_f32_16x16x32_bf16 v[40:43], v[116:119], a[56:59], v[40:43]
    ds_read_b128 v[124:127], v14 offset:21504
    v_add_u32 v11, -131072, v11
    v_mfma_f32_16x16x32_bf16 v[44:47], v[116:119], a[60:63], v[44:47]
    ds_read_b128 v[128:131], v14 offset:25600
    v_mfma_f32_16x16x32_bf16 v[44:47], v[112:115], a[52:55], v[44:47]
    ds_read_b128 v[132:135], v14 offset:29696
    v_mfma_f32_16x16x32_bf16 v[44:47], v[108:111], a[44:47], v[44:47]
    s_add_u32 m0, s73, 98816
    ds_read_b64_tr_b16 a[164:165], v11 offset:32768
    v_mfma_f32_16x16x32_bf16 v[44:47], v[104:107], a[36:39], v[44:47]
    buffer_load_dwordx4 v20, s[44:47], s23 offen offset:512 sc1 lds
    ds_read_b64_tr_b16 a[166:167], v11 offset:34816
    s_waitcnt lgkmcnt(4)
    v_mfma_f32_16x16x32_bf16 v[52:55], v[120:123], a[36:39], v[52:55]
    s_add_u32 m0, s73, 99584
    ds_read_b64_tr_b16 a[172:173], v11 offset:36864
    v_mfma_f32_16x16x32_bf16 v[52:55], v[124:127], a[44:47], v[52:55]
    buffer_load_dwordx4 v23, s[44:47], s24 offen offset:768 sc1 lds
    ds_read_b64_tr_b16 a[174:175], v11 offset:38912
    s_waitcnt lgkmcnt(4)
    v_mfma_f32_16x16x32_bf16 v[52:55], v[128:131], a[52:55], v[52:55]
    ds_read_b128 v[104:107], v14 offset:18432
    v_mfma_f32_16x16x32_bf16 v[52:55], v[132:135], a[60:63], v[52:55]
    ds_read_b128 v[108:111], v14 offset:22528
    v_add_u32 v10, 65536, v10
    v_mfma_f32_16x16x32_bf16 v[48:51], v[132:135], a[56:59], v[48:51]
    ds_read_b128 v[112:115], v14 offset:26624
    v_mfma_f32_16x16x32_bf16 v[48:51], v[128:131], a[48:51], v[48:51]
    ds_read_b128 v[116:119], v14 offset:30720
    v_mfma_f32_16x16x32_bf16 v[48:51], v[124:127], a[40:43], v[48:51]
    s_add_u32 m0, s73, 101376
    ds_read_b64_tr_b16 a[176:177], v10 offset:16384
    v_mfma_f32_16x16x32_bf16 v[48:51], v[120:123], a[32:35], v[48:51]
    buffer_load_dwordx4 v20, s[44:47], s24 offen offset:0 sc1 lds
    ds_read_b64_tr_b16 a[178:179], v10 offset:18432
    s_waitcnt lgkmcnt(4)
    v_mfma_f32_16x16x32_bf16 v[32:35], v[104:107], a[64:67], v[32:35]
    ds_read_b64_tr_b16 a[184:185], v10 offset:20480
    v_mfma_f32_16x16x32_bf16 v[32:35], v[108:111], a[72:75], v[32:35]
    ds_read_b64_tr_b16 a[186:187], v10 offset:22528
    s_waitcnt lgkmcnt(4)
    v_mfma_f32_16x16x32_bf16 v[32:35], v[112:115], a[80:83], v[32:35]
    ds_read_b128 v[120:123], v14 offset:19456
    v_mfma_f32_16x16x32_bf16 v[32:35], v[116:119], a[88:91], v[32:35]
    ds_read_b128 v[124:127], v14 offset:23552
    v_add_u32 v11, 65536, v11
    v_mfma_f32_16x16x32_bf16 v[36:39], v[116:119], a[92:95], v[36:39]
    ds_read_b128 v[128:131], v14 offset:27648
    v_mfma_f32_16x16x32_bf16 v[36:39], v[112:115], a[84:87], v[36:39]
    ds_read_b128 v[132:135], v14 offset:31744
    v_mfma_f32_16x16x32_bf16 v[36:39], v[108:111], a[76:79], v[36:39]
    ds_read_b64_tr_b16 a[180:181], v11 offset:16384
    v_mfma_f32_16x16x32_bf16 v[36:39], v[104:107], a[68:71], v[36:39]
    ds_read_b64_tr_b16 a[182:183], v11 offset:18432
    s_waitcnt lgkmcnt(4)
    v_mfma_f32_16x16x32_bf16 v[44:47], v[120:123], a[68:71], v[44:47]
    ds_read_b64_tr_b16 a[188:189], v11 offset:20480
    v_mfma_f32_16x16x32_bf16 v[44:47], v[124:127], a[76:79], v[44:47]
    ds_read_b64_tr_b16 a[190:191], v11 offset:22528
    s_waitcnt lgkmcnt(4)
    v_mfma_f32_16x16x32_bf16 v[44:47], v[128:131], a[84:87], v[44:47]
    s_waitcnt vmcnt(8) lgkmcnt(0)
    s_barrier
    v_mfma_f32_16x16x32_bf16 v[44:47], v[132:135], a[92:95], v[44:47]
    ds_read_b128 v[104:107], v14 offset:32768
    s_lshl_b32 s14, s100, 18
    s_add_u32 m0, s73, 32768
    v_add_u32 v10, -65536, v10
    v_mfma_f32_16x16x32_bf16 v[40:43], v[132:135], a[88:91], v[40:43]
    ds_read_b128 v[108:111], v14 offset:36864
    buffer_load_dwordx4 v4, s[52:55], s14 offen offset:0 lds
    v_mfma_f32_16x16x32_bf16 v[40:43], v[128:131], a[80:83], v[40:43]
    ds_read_b128 v[112:115], v14 offset:40960
    ds_read_b64_tr_b16 a[192:193], v10 offset:0
    v_mfma_f32_16x16x32_bf16 v[40:43], v[124:127], a[72:75], v[40:43]
    ds_read_b128 v[116:119], v14 offset:45056
    v_mfma_f32_16x16x32_bf16 v[40:43], v[120:123], a[64:67], v[40:43]
    ds_read_b64_tr_b16 a[194:195], v10 offset:2048
    s_waitcnt lgkmcnt(4)
    v_mfma_f32_16x16x32_bf16 v[48:51], v[104:107], a[64:67], v[48:51]
    s_add_u32 m0, s73, 114176
    ds_read_b64_tr_b16 a[200:201], v10 offset:4096
    v_mfma_f32_16x16x32_bf16 v[48:51], v[108:111], a[72:75], v[48:51]
    buffer_load_dwordx4 v20, s[44:47], s24 offen offset:512 sc1 lds
    ds_read_b64_tr_b16 a[202:203], v10 offset:6144
    s_waitcnt lgkmcnt(3)
    v_mfma_f32_16x16x32_bf16 v[48:51], v[112:115], a[80:83], v[48:51]
    ds_read_b128 v[120:123], v14 offset:33792
    s_add_u32 m0, s73, 32768
    v_lshrrev_b32 v30, 2, v26
    v_mfma_f32_16x16x32_bf16 v[48:51], v[116:119], a[88:91], v[48:51]
    ds_read_b128 v[124:127], v14 offset:37888
    buffer_load_dwordx4 v5, s[52:55], s14 offen offset:1024 lds
    v_mfma_f32_16x16x32_bf16 v[52:55], v[116:119], a[92:95], v[52:55]
    ds_read_b128 v[128:131], v14 offset:41984
    v_add_u32 v11, -65536, v11
    v_mfma_f32_16x16x32_bf16 v[52:55], v[112:115], a[84:87], v[52:55]
    ds_read_b128 v[132:135], v14 offset:46080
    v_mfma_f32_16x16x32_bf16 v[52:55], v[108:111], a[76:79], v[52:55]
    s_add_u32 m0, s73, 114944
    ds_read_b64_tr_b16 a[196:197], v11 offset:0
    v_mfma_f32_16x16x32_bf16 v[52:55], v[104:107], a[68:71], v[52:55]
    buffer_load_dwordx4 v23, s[44:47], s25 offen offset:768 sc1 lds
    ds_read_b64_tr_b16 a[198:199], v11 offset:2048
    s_waitcnt lgkmcnt(4)
    v_mfma_f32_16x16x32_bf16 v[36:39], v[120:123], a[100:103], v[36:39]
    s_add_u32 m0, s73, 116736
    ds_read_b64_tr_b16 a[204:205], v11 offset:4096
    v_mfma_f32_16x16x32_bf16 v[36:39], v[124:127], a[108:111], v[36:39]
    buffer_load_dwordx4 v20, s[44:47], s25 offen offset:0 sc1 lds
    ds_read_b64_tr_b16 a[206:207], v11 offset:6144
    s_waitcnt lgkmcnt(4)
    v_mfma_f32_16x16x32_bf16 v[36:39], v[128:131], a[116:119], v[36:39]
    ds_read_b128 v[104:107], v14 offset:34816
    s_add_u32 m0, s73, 32768
    v_lshrrev_b32 v31, 2, v18
    v_mfma_f32_16x16x32_bf16 v[36:39], v[132:135], a[124:127], v[36:39]
    ds_read_b128 v[108:111], v14 offset:38912
    buffer_load_dwordx4 v6, s[52:55], s14 offen offset:2048 lds
    v_mfma_f32_16x16x32_bf16 v[32:35], v[132:135], a[120:123], v[32:35]
    ds_read_b128 v[112:115], v14 offset:43008
    v_mfma_f32_16x16x32_bf16 v[32:35], v[128:131], a[112:115], v[32:35]
    ds_read_b128 v[116:119], v14 offset:47104
    v_mfma_f32_16x16x32_bf16 v[32:35], v[124:127], a[104:107], v[32:35]
    s_add_u32 m0, s73, 117248
    ds_read_b64_tr_b16 a[208:209], v10 offset:16384
    v_mfma_f32_16x16x32_bf16 v[32:35], v[120:123], a[96:99], v[32:35]
    buffer_load_dwordx4 v20, s[44:47], s25 offen offset:512 sc1 lds
    ds_read_b64_tr_b16 a[210:211], v10 offset:18432
    s_waitcnt lgkmcnt(4)
    v_mfma_f32_16x16x32_bf16 v[40:43], v[104:107], a[96:99], v[40:43]
    ds_read_b64_tr_b16 a[216:217], v10 offset:20480
    buffer_load_ushort v102, v30, s[60:63], 0 offen offset:0
    s_add_u32 m0, s73, 32768
    v_mfma_f32_16x16x32_bf16 v[40:43], v[108:111], a[104:107], v[40:43]
    ds_read_b64_tr_b16 a[218:219], v10 offset:22528
    buffer_load_dwordx4 v7, s[52:55], s14 offen offset:3072 lds
    s_waitcnt lgkmcnt(4)
    v_mfma_f32_16x16x32_bf16 v[40:43], v[112:115], a[112:115], v[40:43]
    ds_read_b128 v[120:123], v14 offset:35840
    v_mfma_f32_16x16x32_bf16 v[40:43], v[116:119], a[120:123], v[40:43]
    ds_read_b128 v[124:127], v14 offset:39936
    v_mfma_f32_16x16x32_bf16 v[44:47], v[116:119], a[124:127], v[44:47]
    ds_read_b128 v[128:131], v14 offset:44032
    v_mfma_f32_16x16x32_bf16 v[44:47], v[112:115], a[116:119], v[44:47]
    ds_read_b128 v[132:135], v14 offset:48128
    v_mfma_f32_16x16x32_bf16 v[44:47], v[108:111], a[108:111], v[44:47]
    ds_read_b64_tr_b16 a[212:213], v11 offset:16384
    buffer_load_ushort v103, v30, s[60:63], 0 offen offset:32
    v_mfma_f32_16x16x32_bf16 v[44:47], v[104:107], a[100:103], v[44:47]
    ds_read_b64_tr_b16 a[214:215], v11 offset:18432
    s_waitcnt lgkmcnt(4)
    v_mfma_f32_16x16x32_bf16 v[52:55], v[120:123], a[100:103], v[52:55]
    ds_read_b64_tr_b16 a[220:221], v11 offset:20480
    v_mfma_f32_16x16x32_bf16 v[52:55], v[124:127], a[108:111], v[52:55]
    ds_read_b64_tr_b16 a[222:223], v11 offset:22528
    s_waitcnt lgkmcnt(4)
    v_mfma_f32_16x16x32_bf16 v[52:55], v[128:131], a[116:119], v[52:55]
    s_waitcnt vmcnt(14) lgkmcnt(0)
    s_barrier
    v_mfma_f32_16x16x32_bf16 v[52:55], v[132:135], a[124:127], v[52:55]
    ds_read_b128 v[104:107], v14 offset:49152
    s_lshl_b32 s14, s101, 18
    ds_read_b64_tr_b16 a[224:225], v10 offset:49152
    s_add_u32 m0, s73, 81920
    v_mfma_f32_16x16x32_bf16 v[48:51], v[132:135], a[120:123], v[48:51]
    ds_read_b128 v[108:111], v14 offset:53248
    buffer_load_dwordx4 v4, s[52:55], s14 offen offset:0 lds
    v_mfma_f32_16x16x32_bf16 v[48:51], v[128:131], a[112:115], v[48:51]
    ds_read_b128 v[112:115], v14 offset:57344
    buffer_load_ushort v27, v31, s[60:63], 0 offen offset:0
    v_mfma_f32_16x16x32_bf16 v[48:51], v[124:127], a[104:107], v[48:51]
    ds_read_b128 v[116:119], v14 offset:61440
    v_mfma_f32_16x16x32_bf16 v[48:51], v[120:123], a[96:99], v[48:51]
    ds_read_b64_tr_b16 a[226:227], v10 offset:51200
    s_waitcnt lgkmcnt(3)
    v_mfma_f32_16x16x32_bf16 v[32:35], v[104:107], a[128:131], v[32:35]
    s_add_u32 m0, s73, 130304
    ds_read_b64_tr_b16 a[232:233], v10 offset:53248
    v_mfma_f32_16x16x32_bf16 v[32:35], v[108:111], a[136:139], v[32:35]
    buffer_load_dwordx4 v23, s[44:47], s26 offen offset:768 sc1 lds
    ds_read_b64_tr_b16 a[234:235], v10 offset:55296
    s_waitcnt lgkmcnt(3)
    v_mfma_f32_16x16x32_bf16 v[32:35], v[112:115], a[144:147], v[32:35]
    ds_read_b128 v[120:123], v14 offset:50176
    s_add_u32 m0, s73, 81920
    v_mfma_f32_16x16x32_bf16 v[32:35], v[116:119], a[152:155], v[32:35]
    ds_read_b128 v[124:127], v14 offset:54272
    buffer_load_dwordx4 v5, s[52:55], s14 offen offset:1024 lds
    v_mfma_f32_16x16x32_bf16 v[36:39], v[116:119], a[156:159], v[36:39]
    ds_read_b128 v[128:131], v14 offset:58368
    v_mfma_f32_16x16x32_bf16 v[36:39], v[112:115], a[148:151], v[36:39]
    ds_read_b128 v[132:135], v14 offset:62464
    v_mfma_f32_16x16x32_bf16 v[36:39], v[108:111], a[140:143], v[36:39]
    s_add_u32 m0, s73, 132096
    ds_read_b64_tr_b16 a[228:229], v11 offset:49152
    v_mfma_f32_16x16x32_bf16 v[36:39], v[104:107], a[132:135], v[36:39]
    buffer_load_dwordx4 v20, s[44:47], s26 offen offset:0 sc1 lds
    ds_read_b64_tr_b16 a[230:231], v11 offset:51200
    s_waitcnt lgkmcnt(4)
    v_mfma_f32_16x16x32_bf16 v[44:47], v[120:123], a[132:135], v[44:47]
    ds_read_b64_tr_b16 a[236:237], v11 offset:53248
    buffer_load_dwordx4 v[88:91], v252, s[56:59], 0 offen
    s_add_u32 m0, s73, 132608
    v_mfma_f32_16x16x32_bf16 v[44:47], v[124:127], a[140:143], v[44:47]
    buffer_load_dwordx4 v20, s[44:47], s26 offen offset:512 sc1 lds
    ds_read_b64_tr_b16 a[238:239], v11 offset:55296
    s_waitcnt lgkmcnt(4)
    v_mfma_f32_16x16x32_bf16 v[44:47], v[128:131], a[148:151], v[44:47]
    ds_read_b128 v[104:107], v14 offset:51200
    s_add_u32 m0, s73, 81920
    v_add_u32 v10, 65536, v10
    v_mfma_f32_16x16x32_bf16 v[44:47], v[132:135], a[156:159], v[44:47]
    ds_read_b128 v[108:111], v14 offset:55296
    buffer_load_dwordx4 v6, s[52:55], s14 offen offset:2048 lds
    v_mfma_f32_16x16x32_bf16 v[40:43], v[132:135], a[152:155], v[40:43]
    ds_read_b128 v[112:115], v14 offset:59392
    v_mfma_f32_16x16x32_bf16 v[40:43], v[128:131], a[144:147], v[40:43]
    ds_read_b128 v[116:119], v14 offset:63488
    v_mfma_f32_16x16x32_bf16 v[40:43], v[124:127], a[136:139], v[40:43]
    s_add_u32 m0, s73, 134144
    ds_read_b64_tr_b16 a[240:241], v10 offset:0
    v_mfma_f32_16x16x32_bf16 v[40:43], v[120:123], a[128:131], v[40:43]
    buffer_load_dwordx4 v21, s[44:47], s18 offen offset:0 sc1 lds
    ds_read_b64_tr_b16 a[242:243], v10 offset:2048
    s_waitcnt lgkmcnt(4)
    v_mfma_f32_16x16x32_bf16 v[48:51], v[104:107], a[128:131], v[48:51]
    ds_read_b64_tr_b16 a[248:249], v10 offset:4096
    s_add_u32 m0, s73, 81920
    v_mfma_f32_16x16x32_bf16 v[48:51], v[108:111], a[136:139], v[48:51]
    ds_read_b64_tr_b16 a[250:251], v10 offset:6144
    buffer_load_dwordx4 v7, s[52:55], s14 offen offset:3072 lds
    s_waitcnt lgkmcnt(4)
    v_mfma_f32_16x16x32_bf16 v[48:51], v[112:115], a[144:147], v[48:51]
    ds_read_b128 v[120:123], v14 offset:52224
    v_add_u32 v11, 65536, v11
    v_mfma_f32_16x16x32_bf16 v[48:51], v[116:119], a[152:155], v[48:51]
    ds_read_b128 v[124:127], v14 offset:56320
    v_mfma_f32_16x16x32_bf16 v[52:55], v[116:119], a[156:159], v[52:55]
    ds_read_b128 v[128:131], v14 offset:60416
    v_mfma_f32_16x16x32_bf16 v[52:55], v[112:115], a[148:151], v[52:55]
    ds_read_b128 v[132:135], v14 offset:64512
    v_mfma_f32_16x16x32_bf16 v[52:55], v[108:111], a[140:143], v[52:55]
    ds_read_b64_tr_b16 a[244:245], v11 offset:0
    v_mfma_f32_16x16x32_bf16 v[52:55], v[104:107], a[132:135], v[52:55]
    ds_read_b64_tr_b16 a[246:247], v11 offset:2048
    s_waitcnt lgkmcnt(4)
    v_mfma_f32_16x16x32_bf16 v[36:39], v[120:123], a[164:167], v[36:39]
    ds_read_b64_tr_b16 a[252:253], v11 offset:4096
    buffer_load_dwordx4 v[92:95], v252, s[56:59], s40 offen
    v_mfma_f32_16x16x32_bf16 v[36:39], v[124:127], a[172:175], v[36:39]
    ds_read_b64_tr_b16 a[254:255], v11 offset:6144
    s_waitcnt lgkmcnt(4)
    v_mfma_f32_16x16x32_bf16 v[36:39], v[128:131], a[180:183], v[36:39]
    s_waitcnt vmcnt(12) lgkmcnt(0)
    s_barrier
    v_mfma_f32_16x16x32_bf16 v[36:39], v[132:135], a[188:191], v[36:39]
    ds_read_b128 v[104:107], v14 offset:0
    v_mfma_f32_16x16x32_bf16 v[32:35], v[132:135], a[184:187], v[32:35]
    ds_read_b128 v[108:111], v14 offset:4096
    v_add_u32 v10, -65536, v10
    v_mfma_f32_16x16x32_bf16 v[32:35], v[128:131], a[176:179], v[32:35]
    ds_read_b128 v[112:115], v14 offset:8192
    v_mfma_f32_16x16x32_bf16 v[32:35], v[124:127], a[168:171], v[32:35]
    ds_read_b128 v[116:119], v14 offset:12288
    v_mfma_f32_16x16x32_bf16 v[32:35], v[120:123], a[160:163], v[32:35]
    ds_read_b64_tr_b16 v[220:221], v10 offset:32768
    s_waitcnt lgkmcnt(3)
    v_mfma_f32_16x16x32_bf16 v[40:43], v[104:107], a[160:163], v[40:43]
L_pl_G_6:
    s_cbranch_execz L_wret
    s_add_u32 m0, s73, 146944
    v_mfma_f32_16x16x32_bf16 v[40:43], v[108:111], a[168:171], v[40:43]
    buffer_load_dwordx4 v21, s[44:47], s18 offen offset:512 sc1 lds
    ds_read_b64_tr_b16 v[222:223], v10 offset:34816
    s_waitcnt lgkmcnt(2)
    v_mfma_f32_16x16x32_bf16 v[40:43], v[112:115], a[176:179], v[40:43]
    ds_read_b128 v[120:123], v14 offset:1024
    v_mfma_f32_16x16x32_bf16 v[40:43], v[116:119], a[184:187], v[40:43]
    ds_read_b128 v[124:127], v14 offset:5120
    v_mfma_f32_16x16x32_bf16 v[44:47], v[116:119], a[188:191], v[44:47]
    ds_read_b128 v[128:131], v14 offset:9216
    v_mfma_f32_16x16x32_bf16 v[44:47], v[112:115], a[180:183], v[44:47]
    ds_read_b128 v[132:135], v14 offset:13312
    v_mfma_f32_16x16x32_bf16 v[44:47], v[108:111], a[172:175], v[44:47]
    s_add_u32 m0, s73, 148480
    ds_read_b64_tr_b16 v[228:229], v10 offset:36864
    v_mfma_f32_16x16x32_bf16 v[44:47], v[104:107], a[164:167], v[44:47]
    buffer_load_dwordx4 v21, s[44:47], s19 offen offset:0 sc1 lds
    s_waitcnt lgkmcnt(3)
    v_mfma_f32_16x16x32_bf16 v[52:55], v[120:123], a[164:167], v[52:55]
    ds_read_b64_tr_b16 v[230:231], v10 offset:38912
    buffer_load_dwordx2 v[142:143], v253, s[56:59], 0 offen
    s_add_u32 m0, s73, 148992
    v_mfma_f32_16x16x32_bf16 v[52:55], v[124:127], a[172:175], v[52:55]
    buffer_load_dwordx4 v21, s[44:47], s19 offen offset:512 sc1 lds
    s_waitcnt lgkmcnt(2)
    v_mfma_f32_16x16x32_bf16 v[52:55], v[128:131], a[180:183], v[52:55]
    ds_read_b128 v[104:107], v14 offset:2048
    v_mfma_f32_16x16x32_bf16 v[52:55], v[132:135], a[188:191], v[52:55]
    ds_read_b128 v[108:111], v14 offset:6144
    v_mfma_f32_16x16x32_bf16 v[48:51], v[132:135], a[184:187], v[48:51]
    ds_read_b128 v[112:115], v14 offset:10240
    v_add_u32 v11, -65536, v11
    v_mfma_f32_16x16x32_bf16 v[48:51], v[128:131], a[176:179], v[48:51]
    ds_read_b128 v[116:119], v14 offset:14336
    v_mfma_f32_16x16x32_bf16 v[48:51], v[124:127], a[168:171], v[48:51]
    s_add_u32 m0, s73, 150528
    v_mfma_f32_16x16x32_bf16 v[48:51], v[120:123], a[160:163], v[48:51]
    buffer_load_dwordx4 v21, s[44:47], s20 offen offset:0 sc1 lds
    ds_read_b64_tr_b16 v[224:225], v11 offset:32768
    s_waitcnt lgkmcnt(3)
    v_mfma_f32_16x16x32_bf16 v[32:35], v[104:107], a[192:195], v[32:35]
    v_mfma_f32_16x16x32_bf16 v[32:35], v[108:111], a[200:203], v[32:35]
    ds_read_b64_tr_b16 v[226:227], v11 offset:34816
    s_waitcnt vmcnt(14)
    s_waitcnt lgkmcnt(2)
    v_mfma_f32_16x16x32_bf16 v[32:35], v[112:115], a[208:211], v[32:35]
    ds_read_b128 v[120:123], v14 offset:3072
    v_mfma_f32_16x16x32_bf16 v[32:35], v[116:119], a[216:219], v[32:35]
    ds_read_b128 v[124:127], v14 offset:7168
    v_mfma_f32_16x16x32_bf16 v[36:39], v[116:119], a[220:223], v[36:39]
    ds_read_b128 v[128:131], v14 offset:11264
    v_lshlrev_b32 v72, 16, v102
    v_mfma_f32_16x16x32_bf16 v[36:39], v[112:115], a[212:215], v[36:39]
    ds_read_b128 v[132:135], v14 offset:15360
    v_mfma_f32_16x16x32_bf16 v[36:39], v[108:111], a[204:207], v[36:39]
    ds_read_b64_tr_b16 v[232:233], v11 offset:36864
    v_lshlrev_b32 v73, 16, v102
    v_mfma_f32_16x16x32_bf16 v[36:39], v[104:107], a[196:199], v[36:39]
    s_waitcnt lgkmcnt(3)
    v_mfma_f32_16x16x32_bf16 v[44:47], v[120:123], a[196:199], v[44:47]
    ds_read_b64_tr_b16 v[234:235], v11 offset:38912
    buffer_load_dwordx2 v[96:97], v26, s[44:47], s42 offen offset:0 sc1
    v_mfma_f32_16x16x32_bf16 v[44:47], v[124:127], a[204:207], v[44:47]
    v_lshlrev_b32 v74, 16, v102
    s_waitcnt lgkmcnt(2)
    v_mfma_f32_16x16x32_bf16 v[44:47], v[128:131], a[212:215], v[44:47]
    s_waitcnt vmcnt(7) lgkmcnt(0)
    s_barrier
    v_mfma_f32_16x16x32_bf16 v[44:47], v[132:135], a[220:223], v[44:47]
    ds_read_b128 v[104:107], v14 offset:16384
    v_lshlrev_b32 v75, 16, v102
    v_mfma_f32_16x16x32_bf16 v[40:43], v[132:135], a[216:219], v[40:43]
    ds_read_b128 v[108:111], v14 offset:20480
    v_add_u32 v10, 65536, v10
    v_mfma_f32_16x16x32_bf16 v[40:43], v[128:131], a[208:211], v[40:43]
    ds_read_b128 v[112:115], v14 offset:24576
    v_mfma_f32_16x16x32_bf16 v[40:43], v[124:127], a[200:203], v[40:43]
    ds_read_b128 v[116:119], v14 offset:28672
    v_lshlrev_b32 v76, 16, v103
    v_mfma_f32_16x16x32_bf16 v[40:43], v[120:123], a[192:195], v[40:43]
    ds_read_b64_tr_b16 v[236:237], v10 offset:16384
    s_waitcnt lgkmcnt(3)
    v_mfma_f32_16x16x32_bf16 v[48:51], v[104:107], a[192:195], v[48:51]
    s_add_u32 m0, s73, 97792
    v_lshlrev_b32 v77, 16, v103
    v_mfma_f32_16x16x32_bf16 v[48:51], v[108:111], a[200:203], v[48:51]
    buffer_load_dwordx4 v21, s[44:47], s20 offen offset:512 sc1 lds
    ds_read_b64_tr_b16 v[238:239], v10 offset:18432
    s_waitcnt lgkmcnt(2)
    v_mfma_f32_16x16x32_bf16 v[48:51], v[112:115], a[208:211], v[48:51]
    ds_read_b128 v[120:123], v14 offset:17408
    v_mfma_f32_16x16x32_bf16 v[48:51], v[116:119], a[216:219], v[48:51]
    ds_read_b128 v[124:127], v14 offset:21504
    v_mfma_f32_16x16x32_bf16 v[52:55], v[116:119], a[220:223], v[52:55]
    ds_read_b128 v[128:131], v14 offset:25600
    v_lshlrev_b32 v78, 16, v103
    v_mfma_f32_16x16x32_bf16 v[52:55], v[112:115], a[212:215], v[52:55]
    ds_read_b128 v[132:135], v14 offset:29696
    v_mfma_f32_16x16x32_bf16 v[52:55], v[108:111], a[204:207], v[52:55]
    ds_read_b64_tr_b16 v[244:245], v10 offset:20480
    s_add_u32 m0, s73, 99328
    v_lshlrev_b32 v79, 16, v103
    v_mfma_f32_16x16x32_bf16 v[52:55], v[104:107], a[196:199], v[52:55]
    buffer_load_dwordx4 v21, s[44:47], s21 offen offset:0 sc1 lds
    s_waitcnt lgkmcnt(3)
    v_mfma_f32_16x16x32_bf16 v[36:39], v[120:123], a[228:231], v[36:39]
    ds_read_b64_tr_b16 v[246:247], v10 offset:22528
    buffer_load_dwordx2 v[98:99], v26, s[44:47], s42 offen offset:128 sc1
    s_add_u32 m0, s73, 99840
    v_mfma_f32_16x16x32_bf16 v[36:39], v[124:127], a[236:239], v[36:39]
    buffer_load_dwordx4 v21, s[44:47], s21 offen offset:512 sc1 lds
    s_waitcnt lgkmcnt(2)
    v_mfma_f32_16x16x32_bf16 v[36:39], v[128:131], a[244:247], v[36:39]
    ds_read_b128 v[104:107], v14 offset:18432
    v_lshlrev_b32 v80, 16, v102
    v_mfma_f32_16x16x32_bf16 v[36:39], v[132:135], a[252:255], v[36:39]
    ds_read_b128 v[108:111], v14 offset:22528
    v_lshlrev_b32 v81, 16, v102
    v_mfma_f32_16x16x32_bf16 v[32:35], v[132:135], a[248:251], v[32:35]
    ds_read_b128 v[112:115], v14 offset:26624
    v_add_u32 v11, 65536, v11
    v_mfma_f32_16x16x32_bf16 v[32:35], v[128:131], a[240:243], v[32:35]
    ds_read_b128 v[116:119], v14 offset:30720
    v_mfma_f32_16x16x32_bf16 v[32:35], v[124:127], a[232:235], v[32:35]
    s_add_u32 m0, s73, 101376
    v_lshlrev_b32 v82, 16, v102
    v_mfma_f32_16x16x32_bf16 v[32:35], v[120:123], a[224:227], v[32:35]
    buffer_load_dwordx4 v21, s[44:47], s22 offen offset:0 sc1 lds
    ds_read_b64_tr_b16 v[240:241], v11 offset:16384
    s_waitcnt lgkmcnt(3)
    v_mfma_f32_16x16x32_bf16 v[40:43], v[104:107], a[224:227], v[40:43]
    v_lshlrev_b32 v83, 16, v102
    v_mfma_f32_16x16x32_bf16 v[40:43], v[108:111], a[232:235], v[40:43]
    ds_read_b64_tr_b16 v[242:243], v11 offset:18432
    s_waitcnt lgkmcnt(2)
    v_mfma_f32_16x16x32_bf16 v[40:43], v[112:115], a[240:243], v[40:43]
    ds_read_b128 v[120:123], v14 offset:19456
    v_mfma_f32_16x16x32_bf16 v[40:43], v[116:119], a[248:251], v[40:43]
    ds_read_b128 v[124:127], v14 offset:23552
    v_mfma_f32_16x16x32_bf16 v[44:47], v[116:119], a[252:255], v[44:47]
    ds_read_b128 v[128:131], v14 offset:27648
    v_lshlrev_b32 v84, 16, v103
    v_mfma_f32_16x16x32_bf16 v[44:47], v[112:115], a[244:247], v[44:47]
    ds_read_b128 v[132:135], v14 offset:31744
    v_mfma_f32_16x16x32_bf16 v[44:47], v[108:111], a[236:239], v[44:47]
    ds_read_b64_tr_b16 v[248:249], v11 offset:20480
    v_lshlrev_b32 v85, 16, v103
    v_mfma_f32_16x16x32_bf16 v[44:47], v[104:107], a[228:231], v[44:47]
    s_waitcnt lgkmcnt(3)
    v_mfma_f32_16x16x32_bf16 v[52:55], v[120:123], a[228:231], v[52:55]
    ds_read_b64_tr_b16 v[250:251], v11 offset:22528
    buffer_load_dwordx2 v[100:101], v18, s[44:47], s42 offen offset:0 sc1
    v_mfma_f32_16x16x32_bf16 v[52:55], v[124:127], a[236:239], v[52:55]
    v_lshlrev_b32 v86, 16, v103
    s_waitcnt lgkmcnt(2)
    v_mfma_f32_16x16x32_bf16 v[52:55], v[128:131], a[244:247], v[52:55]
    s_waitcnt lgkmcnt(0)
    s_barrier
    v_mfma_f32_16x16x32_bf16 v[52:55], v[132:135], a[252:255], v[52:55]
    ds_read_b128 v[104:107], v14 offset:32768
    v_mfma_f32_16x16x32_bf16 v[48:51], v[132:135], a[248:251], v[48:51]
    ds_read_b128 v[108:111], v14 offset:36864
    v_lshlrev_b32 v87, 16, v103
    v_mfma_f32_16x16x32_bf16 v[48:51], v[128:131], a[240:243], v[48:51]
    ds_read_b128 v[112:115], v14 offset:40960
    v_mfma_f32_16x16x32_bf16 v[48:51], v[124:127], a[232:235], v[48:51]
    ds_read_b128 v[116:119], v14 offset:45056
    v_lshlrev_b32 v27, 16, v27
    v_mfma_f32_16x16x32_bf16 v[48:51], v[120:123], a[224:227], v[48:51]
L_Dc:
L_pl_D_0:
    s_cbranch_execz L_wret
    s_waitcnt lgkmcnt(2)
    v_mfma_f32_16x16x32_bf16 v[32:35], v[104:107], v[220:223], v[32:35]
    s_add_u32 m0, s73, 114176
    v_mfma_f32_16x16x32_bf16 v[32:35], v[108:111], v[228:231], v[32:35]
    buffer_load_dwordx4 v21, s[44:47], s22 offen offset:512 sc1 lds
    s_waitcnt lgkmcnt(0)
    v_mfma_f32_16x16x32_bf16 v[32:35], v[112:115], v[236:239], v[32:35]
    ds_read_b128 v[120:123], v14 offset:33792
    v_mfma_f32_16x16x32_bf16 v[32:35], v[116:119], v[244:247], v[32:35]
    ds_read_b128 v[124:127], v14 offset:37888
    v_mfma_f32_16x16x32_bf16 v[36:39], v[116:119], v[248:251], v[36:39]
    ds_read_b128 v[128:131], v14 offset:41984
    buffer_load_dword v189, v188, s[44:47], 0 offen sc1
    v_mfma_f32_16x16x32_bf16 v[36:39], v[112:115], v[240:243], v[36:39]
    ds_read_b128 v[132:135], v14 offset:46080
    v_mfma_f32_16x16x32_bf16 v[36:39], v[108:111], v[232:235], v[36:39]
    s_add_u32 m0, s73, 115712
    v_mfma_f32_16x16x32_bf16 v[36:39], v[104:107], v[224:227], v[36:39]
    buffer_load_dwordx4 v21, s[44:47], s23 offen offset:0 sc1 lds
    s_waitcnt lgkmcnt(2)
    v_mfma_f32_16x16x32_bf16 v[44:47], v[120:123], v[224:227], v[44:47]
    s_add_u32 m0, s73, 116224
    v_mfma_f32_16x16x32_bf16 v[44:47], v[124:127], v[232:235], v[44:47]
    buffer_load_dwordx4 v21, s[44:47], s23 offen offset:512 sc1 lds
    s_waitcnt lgkmcnt(0)
    v_mfma_f32_16x16x32_bf16 v[44:47], v[128:131], v[240:243], v[44:47]
    ds_read_b128 v[104:107], v14 offset:34816
    v_mfma_f32_16x16x32_bf16 v[44:47], v[132:135], v[248:251], v[44:47]
    ds_read_b128 v[108:111], v14 offset:38912
    v_mfma_f32_16x16x32_bf16 v[40:43], v[132:135], v[244:247], v[40:43]
    ds_read_b128 v[112:115], v14 offset:43008
    v_mfma_f32_16x16x32_bf16 v[40:43], v[128:131], v[236:239], v[40:43]
    ds_read_b128 v[116:119], v14 offset:47104
    v_mfma_f32_16x16x32_bf16 v[40:43], v[124:127], v[228:231], v[40:43]
    s_add_u32 m0, s73, 117760
    v_mfma_f32_16x16x32_bf16 v[40:43], v[120:123], v[220:223], v[40:43]
    buffer_load_dwordx4 v21, s[44:47], s24 offen offset:0 sc1 lds
    s_waitcnt lgkmcnt(2)
    v_mfma_f32_16x16x32_bf16 v[48:51], v[104:107], v[220:223], v[48:51]
    v_mfma_f32_16x16x32_bf16 v[48:51], v[108:111], v[228:231], v[48:51]
    s_waitcnt lgkmcnt(0)
    v_mfma_f32_16x16x32_bf16 v[48:51], v[112:115], v[236:239], v[48:51]
    ds_read_b128 v[120:123], v14 offset:35840
    v_mfma_f32_16x16x32_bf16 v[48:51], v[116:119], v[244:247], v[48:51]
    ds_read_b128 v[124:127], v14 offset:39936
    v_mfma_f32_16x16x32_bf16 v[52:55], v[116:119], v[248:251], v[52:55]
    ds_read_b128 v[128:131], v14 offset:44032
    v_mfma_f32_16x16x32_bf16 v[52:55], v[112:115], v[240:243], v[52:55]
    ds_read_b128 v[132:135], v14 offset:48128
    v_mfma_f32_16x16x32_bf16 v[52:55], v[108:111], v[232:235], v[52:55]
    v_mfma_f32_16x16x32_bf16 v[52:55], v[104:107], v[224:227], v[52:55]
    s_waitcnt lgkmcnt(2)
    v_mfma_f32_16x16x32_bf16 v[60:63], v[120:123], a[4:7], 0
    v_mfma_f32_16x16x32_bf16 v[60:63], v[124:127], a[12:15], v[60:63]
    s_waitcnt lgkmcnt(0)
    v_mfma_f32_16x16x32_bf16 v[60:63], v[128:131], a[20:23], v[60:63]
    s_waitcnt vmcnt(12)
    s_barrier
    v_mfma_f32_16x16x32_bf16 v[60:63], v[132:135], a[28:31], v[60:63]
    ds_read_b128 v[104:107], v14 offset:49152
    v_mfma_f32_16x16x32_bf16 v[56:59], v[132:135], a[24:27], 0
    ds_read_b128 v[108:111], v14 offset:53248
    v_mfma_f32_16x16x32_bf16 v[56:59], v[128:131], a[16:19], v[56:59]
    ds_read_b128 v[112:115], v14 offset:57344
    v_cvt_pk_bf16_f32 v192, v32, v33
    v_mfma_f32_16x16x32_bf16 v[56:59], v[124:127], a[8:11], v[56:59]
    ds_read_b128 v[116:119], v14 offset:61440
    v_mfma_f32_16x16x32_bf16 v[56:59], v[120:123], a[0:3], v[56:59]
    s_waitcnt lgkmcnt(2)
    v_mfma_f32_16x16x32_bf16 v[64:67], v[104:107], a[0:3], 0
    s_add_u32 m0, s73, 130560
    v_mfma_f32_16x16x32_bf16 v[64:67], v[108:111], a[8:11], v[64:67]
    buffer_load_dwordx4 v21, s[44:47], s24 offen offset:512 sc1 lds
    s_waitcnt lgkmcnt(0)
    v_mfma_f32_16x16x32_bf16 v[64:67], v[112:115], a[16:19], v[64:67]
    ds_read_b128 v[120:123], v14 offset:50176
    v_cvt_pk_bf16_f32 v193, v34, v35
    v_mfma_f32_16x16x32_bf16 v[64:67], v[116:119], a[24:27], v[64:67]
    ds_read_b128 v[124:127], v14 offset:54272
    v_mfma_f32_16x16x32_bf16 v[68:71], v[116:119], a[28:31], 0
    ds_read_b128 v[128:131], v14 offset:58368
    v_mfma_f32_16x16x32_bf16 v[68:71], v[112:115], a[20:23], v[68:71]
    buffer_store_dwordx4 v[192:195], v136, s[44:47], s32 offen sc1
    ds_read_b128 v[132:135], v14 offset:62464
    v_mfma_f32_16x16x32_bf16 v[68:71], v[108:111], a[12:15], v[68:71]
    s_add_u32 m0, s73, 132096
    v_mfma_f32_16x16x32_bf16 v[68:71], v[104:107], a[4:7], v[68:71]
    buffer_load_dwordx4 v21, s[44:47], s25 offen offset:0 sc1 lds
    s_waitcnt lgkmcnt(2)
    v_mfma_f32_16x16x32_bf16 v[60:63], v[120:123], a[36:39], v[60:63]
    s_add_u32 m0, s73, 132608
    v_mfma_f32_16x16x32_bf16 v[60:63], v[124:127], a[44:47], v[60:63]
    buffer_load_dwordx4 v21, s[44:47], s25 offen offset:512 sc1 lds
    s_waitcnt lgkmcnt(0)
    v_mfma_f32_16x16x32_bf16 v[60:63], v[128:131], a[52:55], v[60:63]
    ds_read_b128 v[104:107], v14 offset:51200
    v_mfma_f32_16x16x32_bf16 v[60:63], v[132:135], a[60:63], v[60:63]
    ds_read_b128 v[108:111], v14 offset:55296
    v_mfma_f32_16x16x32_bf16 v[56:59], v[132:135], a[56:59], v[56:59]
    ds_read_b128 v[112:115], v14 offset:59392
    v_mfma_f32_16x16x32_bf16 v[56:59], v[128:131], a[48:51], v[56:59]
    ds_read_b128 v[116:119], v14 offset:63488
    v_mfma_f32_16x16x32_bf16 v[56:59], v[124:127], a[40:43], v[56:59]
    s_add_u32 m0, s73, 134144
    v_cvt_pk_bf16_f32 v196, v36, v37
    v_mfma_f32_16x16x32_bf16 v[56:59], v[120:123], a[32:35], v[56:59]
    buffer_load_dwordx4 v21, s[44:47], s26 offen offset:0 sc1 lds
    s_waitcnt lgkmcnt(2)
    v_mfma_f32_16x16x32_bf16 v[64:67], v[104:107], a[32:35], v[64:67]
    v_mfma_f32_16x16x32_bf16 v[64:67], v[108:111], a[40:43], v[64:67]
    s_waitcnt lgkmcnt(0)
    v_mfma_f32_16x16x32_bf16 v[64:67], v[112:115], a[48:51], v[64:67]
    ds_read_b128 v[120:123], v14 offset:52224
    v_cvt_pk_bf16_f32 v197, v38, v39
    v_mfma_f32_16x16x32_bf16 v[64:67], v[116:119], a[56:59], v[64:67]
    ds_read_b128 v[124:127], v14 offset:56320
    v_mfma_f32_16x16x32_bf16 v[68:71], v[116:119], a[60:63], v[68:71]
    ds_read_b128 v[128:131], v14 offset:60416
    v_mfma_f32_16x16x32_bf16 v[68:71], v[112:115], a[52:55], v[68:71]
    ds_read_b128 v[132:135], v14 offset:64512
    v_mfma_f32_16x16x32_bf16 v[68:71], v[108:111], a[44:47], v[68:71]
    buffer_store_dwordx4 v[196:199], v136, s[44:47], s33 offen sc1
    v_mfma_f32_16x16x32_bf16 v[68:71], v[104:107], a[36:39], v[68:71]
    s_waitcnt lgkmcnt(2)
    v_mfma_f32_16x16x32_bf16 v[60:63], v[120:123], a[68:71], v[60:63]
    v_mfma_f32_16x16x32_bf16 v[60:63], v[124:127], a[76:79], v[60:63]
    s_waitcnt lgkmcnt(0)
    v_mfma_f32_16x16x32_bf16 v[60:63], v[128:131], a[84:87], v[60:63]
    s_waitcnt vmcnt(12)
    s_barrier
    v_mfma_f32_16x16x32_bf16 v[60:63], v[132:135], a[92:95], v[60:63]
    ds_read_b128 v[104:107], v14 offset:0
    v_mfma_f32_16x16x32_bf16 v[56:59], v[132:135], a[88:91], v[56:59]
    ds_read_b128 v[108:111], v14 offset:4096
    v_mfma_f32_16x16x32_bf16 v[56:59], v[128:131], a[80:83], v[56:59]
    ds_read_b128 v[112:115], v14 offset:8192
    v_cvt_pk_bf16_f32 v192, v40, v41
    v_mfma_f32_16x16x32_bf16 v[56:59], v[124:127], a[72:75], v[56:59]
    ds_read_b128 v[116:119], v14 offset:12288
    v_mfma_f32_16x16x32_bf16 v[56:59], v[120:123], a[64:67], v[56:59]
    s_waitcnt lgkmcnt(2)
    v_mfma_f32_16x16x32_bf16 v[64:67], v[104:107], a[64:67], v[64:67]
    s_add_u32 m0, s73, 146944
    v_cvt_pk_bf16_f32 v193, v42, v43
    s_waitcnt vmcnt(11)
    v_mfma_f32_16x16x32_bf16 v[64:67], v[108:111], a[72:75], v[64:67]
    buffer_load_dwordx4 v21, s[44:47], s26 offen offset:512 sc1 lds
    s_waitcnt lgkmcnt(0)
    v_mfma_f32_16x16x32_bf16 v[64:67], v[112:115], a[80:83], v[64:67]
    ds_read_b128 v[120:123], v14 offset:1024
    v_mul_f32 v96, v96, v97
    v_mfma_f32_16x16x32_bf16 v[64:67], v[116:119], a[88:91], v[64:67]
    ds_read_b128 v[124:127], v14 offset:5120
    v_cvt_pk_bf16_f32 v194, v44, v45
    v_mfma_f32_16x16x32_bf16 v[68:71], v[116:119], a[92:95], v[68:71]
    ds_read_b128 v[128:131], v14 offset:9216
    v_mul_f32 v98, v98, v99
    v_mfma_f32_16x16x32_bf16 v[68:71], v[112:115], a[84:87], v[68:71]
    ds_read_b128 v[132:135], v14 offset:13312
    v_mul_f32 v100, v100, v101
    v_mfma_f32_16x16x32_bf16 v[68:71], v[108:111], a[76:79], v[68:71]
    buffer_store_dwordx4 v[192:195], v136, s[44:47], s30 offen offset:0 sc1
    s_add_u32 m0, s73, 148480
    v_permlane16_swap_b32 v88, v90
    v_mfma_f32_16x16x32_bf16 v[68:71], v[104:107], a[68:71], v[68:71]
    buffer_load_dwordx4 v22, s[44:47], s18 offen offset:0 sc1 lds
    s_waitcnt lgkmcnt(2)
    v_mfma_f32_16x16x32_bf16 v[60:63], v[120:123], a[100:103], v[60:63]
    s_add_u32 m0, s73, 148992
    v_permlane16_swap_b32 v89, v91
    v_permlane16_swap_b32 v92, v94
    v_mfma_f32_16x16x32_bf16 v[60:63], v[124:127], a[108:111], v[60:63]
    buffer_load_dwordx4 v22, s[44:47], s18 offen offset:512 sc1 lds
    s_waitcnt vmcnt(13)
    s_waitcnt lgkmcnt(0)
    v_mfma_f32_16x16x32_bf16 v[60:63], v[128:131], a[116:119], v[60:63]
    ds_read_b128 v[104:107], v14 offset:2048
    v_permlane16_swap_b32 v93, v95
    v_mfma_f32_16x16x32_bf16 v[60:63], v[132:135], a[124:127], v[60:63]
    ds_read_b128 v[108:111], v14 offset:6144
    v_cmp_ne_u32 vcc, s68, v189
    v_mfma_f32_16x16x32_bf16 v[56:59], v[132:135], a[120:123], v[56:59]
    ds_read_b128 v[112:115], v14 offset:10240
    v_and_b32 v145, 0xffff0000, v88
    v_mfma_f32_16x16x32_bf16 v[56:59], v[128:131], a[112:115], v[56:59]
    ds_read_b128 v[116:119], v14 offset:14336
    v_cvt_pk_bf16_f32 v196, v46, v47
    v_mfma_f32_16x16x32_bf16 v[56:59], v[124:127], a[104:107], v[56:59]
    s_add_u32 m0, s73, 150528
    s_cbranch_vccnz L_rs_p3
L_ok_p3:
    v_lshlrev_b32 v144, 16, v88
    v_mfma_f32_16x16x32_bf16 v[56:59], v[120:123], a[96:99], v[56:59]
    buffer_load_dwordx4 v22, s[44:47], s19 offen offset:0 sc1 lds
    s_waitcnt lgkmcnt(2)
    v_mfma_f32_16x16x32_bf16 v[64:67], v[104:107], a[96:99], v[64:67]
    s_add_u32 m0, s73, 81920
    v_cvt_pk_bf16_f32 v197, v48, v49
    v_and_b32 v147, 0xffff0000, v89
    v_mfma_f32_16x16x32_bf16 v[64:67], v[108:111], a[104:107], v[64:67]
    buffer_load_dwordx4 v184, s[44:47], s37 offen offset:0 sc1 lds
    s_waitcnt lgkmcnt(0)
    v_mfma_f32_16x16x32_bf16 v[64:67], v[112:115], a[112:115], v[64:67]
    ds_read_b128 v[120:123], v14 offset:3072
    buffer_load_dwordx4 v185, s[44:47], s37 offen offset:1024 sc1 lds
    v_mfma_f32_16x16x32_bf16 v[64:67], v[116:119], a[120:123], v[64:67]
    ds_read_b128 v[124:127], v14 offset:7168
    s_add_u32 m0, s73, 83968
    v_cvt_pk_bf16_f32 v198, v50, v51
    v_mfma_f32_16x16x32_bf16 v[68:71], v[116:119], a[124:127], v[68:71]
    ds_read_b128 v[128:131], v14 offset:11264
    buffer_load_dwordx4 v184, s[44:47], s16 offen offset:0 sc1 lds
    v_mfma_f32_16x16x32_bf16 v[68:71], v[112:115], a[116:119], v[68:71]
    ds_read_b128 v[132:135], v14 offset:15360
    buffer_load_dwordx4 v185, s[44:47], s16 offen offset:1024 sc1 lds
    v_mfma_f32_16x16x32_bf16 v[68:71], v[108:111], a[108:111], v[68:71]
    buffer_store_dwordx4 v[196:199], v136, s[44:47], s30 offen offset:1024 sc1
    v_lshlrev_b32 v146, 16, v89
    v_and_b32 v149, 0xffff0000, v92
    v_lshlrev_b32 v148, 16, v92
    v_mfma_f32_16x16x32_bf16 v[68:71], v[104:107], a[100:103], v[68:71]
    s_waitcnt lgkmcnt(2)
    v_mfma_f32_16x16x32_bf16 v[60:63], v[120:123], a[132:135], v[60:63]
    v_and_b32 v151, 0xffff0000, v93
    v_mfma_f32_16x16x32_bf16 v[60:63], v[124:127], a[140:143], v[60:63]
    v_lshlrev_b32 v150, 16, v93
    s_waitcnt lgkmcnt(0)
    v_mfma_f32_16x16x32_bf16 v[60:63], v[128:131], a[148:151], v[60:63]
    s_waitcnt vmcnt(16)
    s_barrier
    v_mfma_f32_16x16x32_bf16 v[60:63], v[132:135], a[156:159], v[60:63]
    ds_read_b128 v[104:107], v14 offset:16384
    v_and_b32 v153, 0xffff0000, v90
    v_mfma_f32_16x16x32_bf16 v[56:59], v[132:135], a[152:155], v[56:59]
    ds_read_b128 v[108:111], v14 offset:20480
    v_lshlrev_b32 v152, 16, v90
    v_mfma_f32_16x16x32_bf16 v[56:59], v[128:131], a[144:147], v[56:59]
    ds_read_b128 v[112:115], v14 offset:24576
    v_cvt_pk_bf16_f32 v200, v52, v53
    v_mfma_f32_16x16x32_bf16 v[56:59], v[124:127], a[136:139], v[56:59]
    ds_read_b128 v[116:119], v14 offset:28672
    v_and_b32 v155, 0xffff0000, v91
    v_mfma_f32_16x16x32_bf16 v[56:59], v[120:123], a[128:131], v[56:59]
    s_waitcnt lgkmcnt(2)
    v_mfma_f32_16x16x32_bf16 v[64:67], v[104:107], a[128:131], v[64:67]
    s_add_u32 m0, s73, 97792
    v_lshlrev_b32 v154, 16, v91
    v_mfma_f32_16x16x32_bf16 v[64:67], v[108:111], a[136:139], v[64:67]
    buffer_load_dwordx4 v22, s[44:47], s19 offen offset:512 sc1 lds
    s_waitcnt lgkmcnt(0)
    v_mfma_f32_16x16x32_bf16 v[64:67], v[112:115], a[144:147], v[64:67]
    ds_read_b128 v[120:123], v14 offset:17408
    v_cvt_pk_bf16_f32 v201, v54, v55
    v_mfma_f32_16x16x32_bf16 v[64:67], v[116:119], a[152:155], v[64:67]
    ds_read_b128 v[124:127], v14 offset:21504
    v_and_b32 v157, 0xffff0000, v94
    v_mfma_f32_16x16x32_bf16 v[68:71], v[116:119], a[156:159], v[68:71]
    ds_read_b128 v[128:131], v14 offset:25600
    v_lshlrev_b32 v156, 16, v94
    v_mfma_f32_16x16x32_bf16 v[68:71], v[112:115], a[148:151], v[68:71]
    buffer_store_dwordx4 v[200:203], v136, s[44:47], s30 offen offset:2048 sc1
    ds_read_b128 v[132:135], v14 offset:29696
    v_and_b32 v159, 0xffff0000, v95
    v_mfma_f32_16x16x32_bf16 v[68:71], v[108:111], a[140:143], v[68:71]
    s_add_u32 m0, s73, 99328
    v_lshlrev_b32 v158, 16, v95
    v_mfma_f32_16x16x32_bf16 v[68:71], v[104:107], a[132:135], v[68:71]
    buffer_load_dwordx4 v22, s[44:47], s20 offen offset:0 sc1 lds
    s_waitcnt lgkmcnt(2)
    v_mfma_f32_16x16x32_bf16 v[60:63], v[120:123], a[164:167], v[60:63]
    s_add_u32 m0, s73, 99840
    v_and_b32 v161, 0xffff0000, v142
    v_mfma_f32_16x16x32_bf16 v[60:63], v[124:127], a[172:175], v[60:63]
    buffer_load_dwordx4 v22, s[44:47], s20 offen offset:512 sc1 lds
    s_waitcnt lgkmcnt(0)
    v_mfma_f32_16x16x32_bf16 v[60:63], v[128:131], a[180:183], v[60:63]
    ds_read_b128 v[104:107], v14 offset:18432
    v_lshlrev_b32 v160, 16, v142
    v_mfma_f32_16x16x32_bf16 v[60:63], v[132:135], a[188:191], v[60:63]
    ds_read_b128 v[108:111], v14 offset:22528
    v_mfma_f32_16x16x32_bf16 v[56:59], v[132:135], a[184:187], v[56:59]
    ds_read_b128 v[112:115], v14 offset:26624
    v_and_b32 v163, 0xffff0000, v143
    v_mfma_f32_16x16x32_bf16 v[56:59], v[128:131], a[176:179], v[56:59]
    ds_read_b128 v[116:119], v14 offset:30720
    v_lshlrev_b32 v162, 16, v143
    v_mfma_f32_16x16x32_bf16 v[56:59], v[124:127], a[168:171], v[56:59]
    s_add_u32 m0, s73, 101376
    v_mfma_f32_16x16x32_bf16 v[56:59], v[120:123], a[160:163], v[56:59]
    buffer_load_dwordx4 v22, s[44:47], s21 offen offset:0 sc1 lds
    s_waitcnt lgkmcnt(2)
    v_mfma_f32_16x16x32_bf16 v[64:67], v[104:107], a[160:163], v[64:67]
    v_fma_f32 v164, v144, v97, -v96
    v_mfma_f32_16x16x32_bf16 v[64:67], v[108:111], a[168:171], v[64:67]
    v_fma_f32 v165, v145, v97, -v96
    s_waitcnt lgkmcnt(0)
    v_mfma_f32_16x16x32_bf16 v[64:67], v[112:115], a[176:179], v[64:67]
    ds_read_b128 v[120:123], v14 offset:19456
    v_fma_f32 v166, v146, v97, -v96
    v_mfma_f32_16x16x32_bf16 v[64:67], v[116:119], a[184:187], v[64:67]
    ds_read_b128 v[124:127], v14 offset:23552
    v_mfma_f32_16x16x32_bf16 v[68:71], v[116:119], a[188:191], v[68:71]
    ds_read_b128 v[128:131], v14 offset:27648
    v_fma_f32 v167, v147, v97, -v96
    v_mfma_f32_16x16x32_bf16 v[68:71], v[112:115], a[180:183], v[68:71]
    ds_read_b128 v[132:135], v14 offset:31744
    v_mfma_f32_16x16x32_bf16 v[68:71], v[108:111], a[172:175], v[68:71]
    v_fma_f32 v168, v148, v99, -v98
    v_mfma_f32_16x16x32_bf16 v[68:71], v[104:107], a[164:167], v[68:71]
    v_fma_f32 v169, v149, v99, -v98
    s_waitcnt lgkmcnt(2)
    v_mfma_f32_16x16x32_bf16 v[60:63], v[120:123], a[196:199], v[60:63]
    v_mfma_f32_16x16x32_bf16 v[60:63], v[124:127], a[204:207], v[60:63]
    v_fma_f32 v170, v150, v99, -v98
    s_waitcnt lgkmcnt(0)
    v_mfma_f32_16x16x32_bf16 v[60:63], v[128:131], a[212:215], v[60:63]
    s_waitcnt vmcnt(16)
    s_barrier
    v_mfma_f32_16x16x32_bf16 v[60:63], v[132:135], a[220:223], v[60:63]
    ds_read_b128 v[104:107], v14 offset:32768
    v_fma_f32 v171, v151, v99, -v98
    v_mfma_f32_16x16x32_bf16 v[56:59], v[132:135], a[216:219], v[56:59]
    ds_read_b128 v[108:111], v14 offset:36864
    v_fma_f32 v172, v152, v97, -v96
    v_mfma_f32_16x16x32_bf16 v[56:59], v[128:131], a[208:211], v[56:59]
    ds_read_b128 v[112:115], v14 offset:40960
    v_mfma_f32_16x16x32_bf16 v[56:59], v[124:127], a[200:203], v[56:59]
    ds_read_b128 v[116:119], v14 offset:45056
    v_fma_f32 v173, v153, v97, -v96
    v_mfma_f32_16x16x32_bf16 v[56:59], v[120:123], a[192:195], v[56:59]
    s_waitcnt lgkmcnt(2)
    v_mfma_f32_16x16x32_bf16 v[64:67], v[104:107], a[192:195], v[64:67]
    s_add_u32 m0, s73, 114176
    v_fma_f32 v174, v154, v97, -v96
    v_mfma_f32_16x16x32_bf16 v[64:67], v[108:111], a[200:203], v[64:67]
    buffer_load_dwordx4 v22, s[44:47], s21 offen offset:512 sc1 lds
    s_waitcnt lgkmcnt(0)
    v_mfma_f32_16x16x32_bf16 v[64:67], v[112:115], a[208:211], v[64:67]
    ds_read_b128 v[120:123], v14 offset:33792
    v_fma_f32 v175, v155, v97, -v96
    v_mfma_f32_16x16x32_bf16 v[64:67], v[116:119], a[216:219], v[64:67]
    ds_read_b128 v[124:127], v14 offset:37888
    v_fma_f32 v176, v156, v99, -v98
    v_mfma_f32_16x16x32_bf16 v[68:71], v[116:119], a[220:223], v[68:71]
    ds_read_b128 v[128:131], v14 offset:41984
    v_mfma_f32_16x16x32_bf16 v[68:71], v[112:115], a[212:215], v[68:71]
    ds_read_b128 v[132:135], v14 offset:46080
    v_fma_f32 v177, v157, v99, -v98
    v_mfma_f32_16x16x32_bf16 v[68:71], v[108:111], a[204:207], v[68:71]
    s_add_u32 m0, s73, 115712
    v_fma_f32 v178, v158, v99, -v98
    v_mfma_f32_16x16x32_bf16 v[68:71], v[104:107], a[196:199], v[68:71]
    buffer_load_dwordx4 v22, s[44:47], s22 offen offset:0 sc1 lds
    s_waitcnt lgkmcnt(2)
    v_mfma_f32_16x16x32_bf16 v[60:63], v[120:123], a[228:231], v[60:63]
    s_add_u32 m0, s73, 116224
    v_fma_f32 v179, v159, v99, -v98
    v_mfma_f32_16x16x32_bf16 v[60:63], v[124:127], a[236:239], v[60:63]
    buffer_load_dwordx4 v22, s[44:47], s22 offen offset:512 sc1 lds
    s_waitcnt lgkmcnt(0)
    v_mfma_f32_16x16x32_bf16 v[60:63], v[128:131], a[244:247], v[60:63]
    ds_read_b128 v[104:107], v14 offset:34816
    v_fma_f32 v180, v160, v101, -v100
    v_mfma_f32_16x16x32_bf16 v[60:63], v[132:135], a[252:255], v[60:63]
    ds_read_b128 v[108:111], v14 offset:38912
    v_fma_f32 v181, v161, v101, -v100
    v_mfma_f32_16x16x32_bf16 v[56:59], v[132:135], a[248:251], v[56:59]
    ds_read_b128 v[112:115], v14 offset:43008
    v_mfma_f32_16x16x32_bf16 v[56:59], v[128:131], a[240:243], v[56:59]
    ds_read_b128 v[116:119], v14 offset:47104
    v_fma_f32 v182, v162, v101, -v100
    v_mfma_f32_16x16x32_bf16 v[56:59], v[124:127], a[232:235], v[56:59]
    s_add_u32 m0, s73, 117760
    v_fma_f32 v183, v163, v101, -v100
    v_mfma_f32_16x16x32_bf16 v[56:59], v[120:123], a[224:227], v[56:59]
    buffer_load_dwordx4 v22, s[44:47], s23 offen offset:0 sc1 lds
    s_waitcnt lgkmcnt(2)
    v_mfma_f32_16x16x32_bf16 v[64:67], v[104:107], a[224:227], v[64:67]
    v_mfma_f32_16x16x32_bf16 v[64:67], v[108:111], a[232:235], v[64:67]
    s_waitcnt lgkmcnt(0)
    v_mfma_f32_16x16x32_bf16 v[64:67], v[112:115], a[240:243], v[64:67]
    ds_read_b128 v[120:123], v14 offset:35840
    v_mfma_f32_16x16x32_bf16 v[64:67], v[116:119], a[248:251], v[64:67]
    ds_read_b128 v[124:127], v14 offset:39936
    v_mfma_f32_16x16x32_bf16 v[68:71], v[116:119], a[252:255], v[68:71]
    ds_read_b128 v[128:131], v14 offset:44032
    v_mfma_f32_16x16x32_bf16 v[68:71], v[112:115], a[244:247], v[68:71]
    ds_read_b128 v[132:135], v14 offset:48128
    v_mfma_f32_16x16x32_bf16 v[68:71], v[108:111], a[236:239], v[68:71]
    v_mfma_f32_16x16x32_bf16 v[68:71], v[104:107], a[228:231], v[68:71]
    s_waitcnt lgkmcnt(2)
    v_mfma_f32_16x16x32_bf16 v[60:63], v[120:123], v[224:227], v[60:63]
    v_mfma_f32_16x16x32_bf16 v[60:63], v[124:127], v[232:235], v[60:63]
    s_waitcnt lgkmcnt(0)
    v_mfma_f32_16x16x32_bf16 v[60:63], v[128:131], v[240:243], v[60:63]
L_pl_D_1:
    s_cbranch_execz L_wret
    s_waitcnt vmcnt(10)
    s_barrier
    v_mfma_f32_16x16x32_bf16 v[60:63], v[132:135], v[248:251], v[60:63]
    ds_read_b128 v[104:107], v14 offset:49152
    v_mfma_f32_16x16x32_bf16 v[56:59], v[132:135], v[244:247], v[56:59]
    ds_read_b128 v[108:111], v14 offset:53248
    v_mfma_f32_16x16x32_bf16 v[56:59], v[128:131], v[236:239], v[56:59]
    ds_read_b128 v[112:115], v14 offset:57344
    v_mfma_f32_16x16x32_bf16 v[56:59], v[124:127], v[228:231], v[56:59]
    ds_read_b128 v[116:119], v14 offset:61440
    v_mfma_f32_16x16x32_bf16 v[56:59], v[120:123], v[220:223], v[56:59]
    s_waitcnt lgkmcnt(2)
    v_mfma_f32_16x16x32_bf16 v[64:67], v[104:107], v[220:223], v[64:67]
    s_add_u32 m0, s73, 130560
    v_xor_b32 v186, s41, v10
    v_add_u32 v186, s43, v186
    v_mfma_f32_16x16x32_bf16 v[64:67], v[108:111], v[228:231], v[64:67]
    buffer_load_dwordx4 v22, s[44:47], s23 offen offset:512 sc1 lds
    ds_read_b64_tr_b16 v[12:13], v10 offset:16384
    s_waitcnt lgkmcnt(1)
    v_mfma_f32_16x16x32_bf16 v[64:67], v[112:115], v[236:239], v[64:67]
    ds_read_b128 v[120:123], v14 offset:50176
    v_mfma_f32_16x16x32_bf16 v[64:67], v[116:119], v[244:247], v[64:67]
    ds_read_b128 v[124:127], v14 offset:54272
    v_mfma_f32_16x16x32_bf16 v[68:71], v[116:119], v[248:251], v[68:71]
    ds_read_b128 v[128:131], v14 offset:58368
    ds_read_b64_tr_b16 v[24:25], v11 offset:16384
    v_mfma_f32_16x16x32_bf16 v[68:71], v[112:115], v[240:243], v[68:71]
    ds_read_b128 v[132:135], v14 offset:62464
    ds_read_b64_tr_b16 v[28:29], v10 offset:20480
    v_mfma_f32_16x16x32_bf16 v[68:71], v[108:111], v[232:235], v[68:71]
    s_add_u32 m0, s73, 132096
    ds_read_b64_tr_b16 v[190:191], v11 offset:20480
    v_mfma_f32_16x16x32_bf16 v[68:71], v[104:107], v[224:227], v[68:71]
    buffer_load_dwordx4 v22, s[44:47], s24 offen offset:0 sc1 lds
    ds_read_b64_tr_b16 v[142:143], v186 offset:18432
    s_waitcnt lgkmcnt(6)
    v_mfma_f32_16x16x32_bf16 v[76:79], v[120:123], a[4:7], v[76:79]
    s_add_u32 m0, s73, 132608
    s_waitcnt lgkmcnt(0)
    v_mfma_f32_16x16x32_bf16 v[76:79], v[124:127], a[12:15], v[76:79]
    buffer_load_dwordx4 v22, s[44:47], s24 offen offset:512 sc1 lds
    v_mfma_f32_16x16x32_bf16 v[76:79], v[128:131], a[20:23], v[76:79]
    ds_read_b128 v[104:107], v14 offset:51200
    v_and_b32 v9, 0xffff0000, v12
    v_mfma_f32_16x16x32_bf16 v[76:79], v[132:135], a[28:31], v[76:79]
    ds_read_b128 v[108:111], v14 offset:55296
    v_mfma_f32_16x16x32_bf16 v[72:75], v[132:135], a[24:27], v[72:75]
    ds_read_b128 v[112:115], v14 offset:59392
    v_lshlrev_b32 v8, 16, v12
    v_mfma_f32_16x16x32_bf16 v[72:75], v[128:131], a[16:19], v[72:75]
    ds_read_b128 v[116:119], v14 offset:63488
    v_cvt_pk_bf16_f32 v192, v56, v57
    v_mfma_f32_16x16x32_bf16 v[72:75], v[124:127], a[8:11], v[72:75]
    s_add_u32 m0, s73, 134144
    v_mul_f32 v165, v165, v9
    v_mfma_f32_16x16x32_bf16 v[72:75], v[120:123], a[0:3], v[72:75]
    buffer_load_dwordx4 v22, s[44:47], s25 offen offset:0 sc1 lds
    s_waitcnt lgkmcnt(2)
    v_mfma_f32_16x16x32_bf16 v[80:83], v[104:107], a[0:3], v[80:83]
    v_cvt_pk_bf16_f32 v193, v58, v59
    v_mul_f32 v164, v164, v8
    v_mfma_f32_16x16x32_bf16 v[80:83], v[108:111], a[8:11], v[80:83]
    v_and_b32 v31, 0xffff0000, v13
    s_waitcnt lgkmcnt(0)
    v_mfma_f32_16x16x32_bf16 v[80:83], v[112:115], a[16:19], v[80:83]
    ds_read_b128 v[120:123], v14 offset:52224
    v_lshlrev_b32 v30, 16, v13
    v_mfma_f32_16x16x32_bf16 v[80:83], v[116:119], a[24:27], v[80:83]
    ds_read_b128 v[124:127], v14 offset:56320
    v_cvt_pk_bf16_f32 v194, v60, v61
    v_mfma_f32_16x16x32_bf16 v[84:87], v[116:119], a[28:31], v[84:87]
    ds_read_b128 v[128:131], v14 offset:60416
    v_mfma_f32_16x16x32_bf16 v[84:87], v[112:115], a[20:23], v[84:87]
    ds_read_b128 v[132:135], v14 offset:64512
    v_mul_f32 v167, v167, v31
    v_mfma_f32_16x16x32_bf16 v[84:87], v[108:111], a[12:15], v[84:87]
    buffer_store_dwordx4 v[192:195], v136, s[44:47], s15 offen offset:0 sc1
    v_mul_f32 v166, v166, v30
    v_mfma_f32_16x16x32_bf16 v[84:87], v[104:107], a[4:7], v[84:87]
    s_waitcnt lgkmcnt(2)
    v_mfma_f32_16x16x32_bf16 v[76:79], v[120:123], a[36:39], v[76:79]
    v_and_b32 v9, 0xffff0000, v24
    v_mfma_f32_16x16x32_bf16 v[76:79], v[124:127], a[44:47], v[76:79]
    s_waitcnt lgkmcnt(0)
    v_mfma_f32_16x16x32_bf16 v[76:79], v[128:131], a[52:55], v[76:79]
    s_waitcnt vmcnt(9)
    s_barrier
    v_lshlrev_b32 v8, 16, v24
    v_mfma_f32_16x16x32_bf16 v[76:79], v[132:135], a[60:63], v[76:79]
    ds_read_b128 v[104:107], v14 offset:0
    v_mfma_f32_16x16x32_bf16 v[72:75], v[132:135], a[56:59], v[72:75]
    ds_read_b128 v[108:111], v14 offset:4096
    v_mul_f32 v169, v169, v9
    v_mfma_f32_16x16x32_bf16 v[72:75], v[128:131], a[48:51], v[72:75]
    ds_read_b128 v[112:115], v14 offset:8192
    v_cvt_pk_bf16_f32 v196, v62, v63
    v_mfma_f32_16x16x32_bf16 v[72:75], v[124:127], a[40:43], v[72:75]
    ds_read_b128 v[116:119], v14 offset:12288
    v_mul_f32 v168, v168, v8
    v_mfma_f32_16x16x32_bf16 v[72:75], v[120:123], a[32:35], v[72:75]
    v_and_b32 v31, 0xffff0000, v25
    s_waitcnt lgkmcnt(2)
    v_mfma_f32_16x16x32_bf16 v[80:83], v[104:107], a[32:35], v[80:83]
    s_add_u32 m0, s73, 146944
    v_cvt_pk_bf16_f32 v197, v64, v65
    v_lshlrev_b32 v30, 16, v25
    v_mfma_f32_16x16x32_bf16 v[80:83], v[108:111], a[40:43], v[80:83]
    buffer_load_dwordx4 v22, s[44:47], s25 offen offset:512 sc1 lds
    s_waitcnt lgkmcnt(0)
    v_mfma_f32_16x16x32_bf16 v[80:83], v[112:115], a[48:51], v[80:83]
    ds_read_b128 v[120:123], v14 offset:1024
    v_mul_f32 v171, v171, v31
    v_mfma_f32_16x16x32_bf16 v[80:83], v[116:119], a[56:59], v[80:83]
    ds_read_b128 v[124:127], v14 offset:5120
    v_cvt_pk_bf16_f32 v198, v66, v67
    v_mfma_f32_16x16x32_bf16 v[84:87], v[116:119], a[60:63], v[84:87]
    ds_read_b128 v[128:131], v14 offset:9216
    v_mul_f32 v170, v170, v30
    v_mfma_f32_16x16x32_bf16 v[84:87], v[112:115], a[52:55], v[84:87]
    ds_read_b128 v[132:135], v14 offset:13312
    v_mfma_f32_16x16x32_bf16 v[84:87], v[108:111], a[44:47], v[84:87]
    buffer_store_dwordx4 v[196:199], v136, s[44:47], s15 offen offset:1024 sc1
    s_add_u32 m0, s73, 148480
    v_and_b32 v9, 0xffff0000, v28
    v_mfma_f32_16x16x32_bf16 v[84:87], v[104:107], a[36:39], v[84:87]
    buffer_load_dwordx4 v22, s[44:47], s26 offen offset:0 sc1 lds
    s_waitcnt lgkmcnt(2)
    v_mfma_f32_16x16x32_bf16 v[76:79], v[120:123], a[68:71], v[76:79]
    s_add_u32 m0, s73, 148992
    v_lshlrev_b32 v8, 16, v28
    v_mfma_f32_16x16x32_bf16 v[76:79], v[124:127], a[76:79], v[76:79]
    buffer_load_dwordx4 v22, s[44:47], s26 offen offset:512 sc1 lds
    s_waitcnt lgkmcnt(0)
    v_mfma_f32_16x16x32_bf16 v[76:79], v[128:131], a[84:87], v[76:79]
    ds_read_b128 v[104:107], v14 offset:2048
    v_mul_f32 v173, v173, v9
    v_mfma_f32_16x16x32_bf16 v[76:79], v[132:135], a[92:95], v[76:79]
    ds_read_b128 v[108:111], v14 offset:6144
    v_mfma_f32_16x16x32_bf16 v[72:75], v[132:135], a[88:91], v[72:75]
    ds_read_b128 v[112:115], v14 offset:10240
    v_mul_f32 v172, v172, v8
    v_mfma_f32_16x16x32_bf16 v[72:75], v[128:131], a[80:83], v[72:75]
    ds_read_b128 v[116:119], v14 offset:14336
    v_and_b32 v31, 0xffff0000, v29
    v_mfma_f32_16x16x32_bf16 v[72:75], v[124:127], a[72:75], v[72:75]
    s_add_u32 m0, s73, 150528
    v_cvt_pk_bf16_f32 v200, v68, v69
    v_mfma_f32_16x16x32_bf16 v[72:75], v[120:123], a[64:67], v[72:75]
    buffer_load_dwordx4 v19, s[44:47], s18 offen offset:0 sc1 lds
    s_waitcnt lgkmcnt(2)
    v_mfma_f32_16x16x32_bf16 v[80:83], v[104:107], a[64:67], v[80:83]
    v_lshlrev_b32 v30, 16, v29
    v_mul_f32 v175, v175, v31
    v_mfma_f32_16x16x32_bf16 v[80:83], v[108:111], a[72:75], v[80:83]
    buffer_load_dwordx4 v[40:43], v136, s[44:47], s34 offen offset:0 sc1
    s_waitcnt lgkmcnt(0)
    v_mfma_f32_16x16x32_bf16 v[80:83], v[112:115], a[80:83], v[80:83]
    ds_read_b128 v[120:123], v14 offset:3072
    v_cvt_pk_bf16_f32 v201, v70, v71
    v_mfma_f32_16x16x32_bf16 v[80:83], v[116:119], a[88:91], v[80:83]
    ds_read_b128 v[124:127], v14 offset:7168
    v_mul_f32 v174, v174, v30
    v_mfma_f32_16x16x32_bf16 v[84:87], v[116:119], a[92:95], v[84:87]
    ds_read_b128 v[128:131], v14 offset:11264
    v_and_b32 v9, 0xffff0000, v190
    v_mfma_f32_16x16x32_bf16 v[84:87], v[112:115], a[84:87], v[84:87]
    ds_read_b128 v[132:135], v14 offset:15360
    buffer_load_dwordx4 v[44:47], v136, s[44:47], s34 offen offset:1024 sc1
    v_mfma_f32_16x16x32_bf16 v[84:87], v[108:111], a[76:79], v[84:87]
    buffer_store_dwordx4 v[200:203], v136, s[44:47], s15 offen offset:2048 sc1
    v_lshlrev_b32 v8, 16, v190
    v_mfma_f32_16x16x32_bf16 v[84:87], v[104:107], a[68:71], v[84:87]
    s_waitcnt lgkmcnt(2)
    v_mfma_f32_16x16x32_bf16 v[76:79], v[120:123], a[100:103], v[76:79]
    buffer_load_dwordx4 v[48:51], v136, s[44:47], s34 offen offset:2048 sc1
    v_mul_f32 v177, v177, v9
    v_mfma_f32_16x16x32_bf16 v[76:79], v[124:127], a[108:111], v[76:79]
    s_waitcnt lgkmcnt(0)
    v_mfma_f32_16x16x32_bf16 v[76:79], v[128:131], a[116:119], v[76:79]
    s_waitcnt vmcnt(14)
    s_barrier
    v_mul_f32 v176, v176, v8
    v_mfma_f32_16x16x32_bf16 v[76:79], v[132:135], a[124:127], v[76:79]
    ds_read_b128 v[104:107], v14 offset:16384
    v_and_b32 v31, 0xffff0000, v191
    v_mfma_f32_16x16x32_bf16 v[72:75], v[132:135], a[120:123], v[72:75]
    ds_read_b128 v[108:111], v14 offset:20480
    buffer_load_dwordx4 v[204:207], v136, s[44:47], s35 offen offset:0 sc1
    v_mfma_f32_16x16x32_bf16 v[72:75], v[128:131], a[112:115], v[72:75]
    ds_read_b128 v[112:115], v14 offset:24576
    v_lshlrev_b32 v30, 16, v191
    v_mfma_f32_16x16x32_bf16 v[72:75], v[124:127], a[104:107], v[72:75]
    ds_read_b128 v[116:119], v14 offset:28672
    v_mul_f32 v179, v179, v31
    v_mfma_f32_16x16x32_bf16 v[72:75], v[120:123], a[96:99], v[72:75]
    buffer_load_dwordx4 v[208:211], v136, s[44:47], s35 offen offset:1024 sc1
    s_waitcnt lgkmcnt(2)
    v_mfma_f32_16x16x32_bf16 v[80:83], v[104:107], a[96:99], v[80:83]
    v_mfma_f32_16x16x32_bf16 v[80:83], v[108:111], a[104:107], v[80:83]
    v_mul_f32 v178, v178, v30
    s_waitcnt lgkmcnt(0)
    v_mfma_f32_16x16x32_bf16 v[80:83], v[112:115], a[112:115], v[80:83]
    ds_read_b128 v[120:123], v14 offset:17408
    buffer_load_dwordx4 v[212:215], v136, s[44:47], s35 offen offset:2048 sc1
    v_mfma_f32_16x16x32_bf16 v[80:83], v[116:119], a[120:123], v[80:83]
    ds_read_b128 v[124:127], v14 offset:21504
    v_and_b32 v9, 0xffff0000, v142
    v_mfma_f32_16x16x32_bf16 v[84:87], v[116:119], a[124:127], v[84:87]
    ds_read_b128 v[128:131], v14 offset:25600
    v_lshlrev_b32 v8, 16, v142
    v_mfma_f32_16x16x32_bf16 v[84:87], v[112:115], a[116:119], v[84:87]
    ds_read_b128 v[132:135], v14 offset:29696
    v_mfma_f32_16x16x32_bf16 v[84:87], v[108:111], a[108:111], v[84:87]
    buffer_load_dwordx4 v[216:219], v136, s[44:47], s35 offen offset:3072 sc1
    v_mul_f32 v181, v181, v9
    v_mfma_f32_16x16x32_bf16 v[84:87], v[104:107], a[100:103], v[84:87]
    s_waitcnt lgkmcnt(2)
    v_mfma_f32_16x16x32_bf16 v[76:79], v[120:123], a[132:135], v[76:79]
    v_mul_f32 v180, v180, v8
    v_mfma_f32_16x16x32_bf16 v[76:79], v[124:127], a[140:143], v[76:79]
    v_and_b32 v31, 0xffff0000, v143
    s_waitcnt lgkmcnt(0)
    v_mfma_f32_16x16x32_bf16 v[76:79], v[128:131], a[148:151], v[76:79]
    ds_read_b128 v[104:107], v14 offset:18432
    v_mfma_f32_16x16x32_bf16 v[76:79], v[132:135], a[156:159], v[76:79]
    ds_read_b128 v[108:111], v14 offset:22528
    v_lshlrev_b32 v30, 16, v143
    v_mfma_f32_16x16x32_bf16 v[72:75], v[132:135], a[152:155], v[72:75]
    ds_read_b128 v[112:115], v14 offset:26624
    v_mfma_f32_16x16x32_bf16 v[72:75], v[128:131], a[144:147], v[72:75]
    ds_read_b128 v[116:119], v14 offset:30720
    v_mul_f32 v183, v183, v31
    v_mfma_f32_16x16x32_bf16 v[72:75], v[124:127], a[136:139], v[72:75]
    v_mfma_f32_16x16x32_bf16 v[72:75], v[120:123], a[128:131], v[72:75]
    v_mul_f32 v182, v182, v30
    s_waitcnt lgkmcnt(2)
    v_mfma_f32_16x16x32_bf16 v[80:83], v[104:107], a[128:131], v[80:83]
    v_mfma_f32_16x16x32_bf16 v[80:83], v[108:111], a[136:139], v[80:83]
    s_waitcnt lgkmcnt(0)
    v_mfma_f32_16x16x32_bf16 v[80:83], v[112:115], a[144:147], v[80:83]
    ds_read_b128 v[120:123], v14 offset:19456
    v_mfma_f32_16x16x32_bf16 v[80:83], v[116:119], a[152:155], v[80:83]
    ds_read_b128 v[124:127], v14 offset:23552
    v_mfma_f32_16x16x32_bf16 v[84:87], v[116:119], a[156:159], v[84:87]
    ds_read_b128 v[128:131], v14 offset:27648
    v_mfma_f32_16x16x32_bf16 v[84:87], v[112:115], a[148:151], v[84:87]
    ds_read_b128 v[132:135], v14 offset:31744
    v_mfma_f32_16x16x32_bf16 v[84:87], v[108:111], a[140:143], v[84:87]
    v_mfma_f32_16x16x32_bf16 v[84:87], v[104:107], a[132:135], v[84:87]
    s_waitcnt lgkmcnt(2)
    v_mfma_f32_16x16x32_bf16 v[76:79], v[120:123], a[164:167], v[76:79]
    s_add_u32 m0, s73, 97792
    v_mfma_f32_16x16x32_bf16 v[76:79], v[124:127], a[172:175], v[76:79]
    buffer_load_dwordx4 v19, s[44:47], s18 offen offset:512 sc1 lds
    s_waitcnt lgkmcnt(0)
    v_mfma_f32_16x16x32_bf16 v[76:79], v[128:131], a[180:183], v[76:79]
    s_waitcnt vmcnt(15)
    s_barrier
    v_mfma_f32_16x16x32_bf16 v[76:79], v[132:135], a[188:191], v[76:79]
    ds_read_b128 v[104:107], v14 offset:32768
    v_mfma_f32_16x16x32_bf16 v[72:75], v[132:135], a[184:187], v[72:75]
    ds_read_b128 v[108:111], v14 offset:36864
    v_mfma_f32_16x16x32_bf16 v[72:75], v[128:131], a[176:179], v[72:75]
    ds_read_b128 v[112:115], v14 offset:40960
    v_mfma_f32_16x16x32_bf16 v[72:75], v[124:127], a[168:171], v[72:75]
    ds_read_b128 v[116:119], v14 offset:45056
    s_add_u32 m0, s73, 99328
    v_mfma_f32_16x16x32_bf16 v[72:75], v[120:123], a[160:163], v[72:75]
    buffer_load_dwordx4 v19, s[44:47], s19 offen offset:0 sc1 lds
    s_waitcnt lgkmcnt(2)
    v_mfma_f32_16x16x32_bf16 v[80:83], v[104:107], a[160:163], v[80:83]
    s_add_u32 m0, s73, 99840
    v_mov_b32 v141, 0
    v_mfma_f32_16x16x32_bf16 v[80:83], v[108:111], a[168:171], v[80:83]
    buffer_load_dwordx4 v19, s[44:47], s19 offen offset:512 sc1 lds
    s_waitcnt lgkmcnt(0)
    v_mfma_f32_16x16x32_bf16 v[80:83], v[112:115], a[176:179], v[80:83]
    ds_read_b128 v[120:123], v14 offset:33792
    v_mfma_f32_16x16x32_bf16 v[80:83], v[116:119], a[184:187], v[80:83]
    ds_read_b128 v[124:127], v14 offset:37888
    buffer_atomic_add v141, v139, s[44:47], s11 offen offset:2060 sc0 sc1
    v_mfma_f32_16x16x32_bf16 v[84:87], v[116:119], a[188:191], v[84:87]
    ds_read_b128 v[128:131], v14 offset:41984
    v_mfma_f32_16x16x32_bf16 v[84:87], v[112:115], a[180:183], v[84:87]
    ds_read_b128 v[132:135], v14 offset:46080
    v_mfma_f32_16x16x32_bf16 v[84:87], v[108:111], a[172:175], v[84:87]
    s_add_u32 m0, s73, 101376
    v_mfma_f32_16x16x32_bf16 v[84:87], v[104:107], a[164:167], v[84:87]
    buffer_load_dwordx4 v19, s[44:47], s20 offen offset:0 sc1 lds
    s_waitcnt lgkmcnt(2)
    v_mfma_f32_16x16x32_bf16 v[76:79], v[120:123], a[196:199], v[76:79]
    s_add_u32 m0, s73, 114176
    v_mfma_f32_16x16x32_bf16 v[76:79], v[124:127], a[204:207], v[76:79]
    buffer_load_dwordx4 v19, s[44:47], s20 offen offset:512 sc1 lds
    s_waitcnt lgkmcnt(0)
    v_mfma_f32_16x16x32_bf16 v[76:79], v[128:131], a[212:215], v[76:79]
    ds_read_b128 v[104:107], v14 offset:34816
    v_mfma_f32_16x16x32_bf16 v[76:79], v[132:135], a[220:223], v[76:79]
    ds_read_b128 v[108:111], v14 offset:38912
    v_mfma_f32_16x16x32_bf16 v[72:75], v[132:135], a[216:219], v[72:75]
    ds_read_b128 v[112:115], v14 offset:43008
    v_mfma_f32_16x16x32_bf16 v[72:75], v[128:131], a[208:211], v[72:75]
    ds_read_b128 v[116:119], v14 offset:47104
    v_mfma_f32_16x16x32_bf16 v[72:75], v[124:127], a[200:203], v[72:75]
    s_add_u32 m0, s73, 115712
    v_mfma_f32_16x16x32_bf16 v[72:75], v[120:123], a[192:195], v[72:75]
    buffer_load_dwordx4 v19, s[44:47], s21 offen offset:0 sc1 lds
    s_waitcnt lgkmcnt(2)
    v_mfma_f32_16x16x32_bf16 v[80:83], v[104:107], a[192:195], v[80:83]
    s_add_u32 m0, s73, 116224
    v_mfma_f32_16x16x32_bf16 v[80:83], v[108:111], a[200:203], v[80:83]
    buffer_load_dwordx4 v19, s[44:47], s21 offen offset:512 sc1 lds
    s_waitcnt lgkmcnt(0)
    v_mfma_f32_16x16x32_bf16 v[80:83], v[112:115], a[208:211], v[80:83]
    ds_read_b128 v[120:123], v14 offset:35840
    v_mfma_f32_16x16x32_bf16 v[80:83], v[116:119], a[216:219], v[80:83]
    ds_read_b128 v[124:127], v14 offset:39936
    v_mfma_f32_16x16x32_bf16 v[84:87], v[116:119], a[220:223], v[84:87]
    ds_read_b128 v[128:131], v14 offset:44032
    v_mfma_f32_16x16x32_bf16 v[84:87], v[112:115], a[212:215], v[84:87]
    ds_read_b128 v[132:135], v14 offset:48128
    v_mfma_f32_16x16x32_bf16 v[84:87], v[108:111], a[204:207], v[84:87]
    s_add_u32 m0, s73, 117760
    v_mfma_f32_16x16x32_bf16 v[84:87], v[104:107], a[196:199], v[84:87]
    buffer_load_dwordx4 v19, s[44:47], s22 offen offset:0 sc1 lds
    s_waitcnt lgkmcnt(2)
    v_mfma_f32_16x16x32_bf16 v[76:79], v[120:123], a[228:231], v[76:79]
    v_mfma_f32_16x16x32_bf16 v[76:79], v[124:127], a[236:239], v[76:79]
    s_waitcnt lgkmcnt(0)
    v_mfma_f32_16x16x32_bf16 v[76:79], v[128:131], a[244:247], v[76:79]
    s_waitcnt vmcnt(17)
    s_barrier
    v_mfma_f32_16x16x32_bf16 v[76:79], v[132:135], a[252:255], v[76:79]
    ds_read_b128 v[104:107], v14 offset:49152
    v_mfma_f32_16x16x32_bf16 v[72:75], v[132:135], a[248:251], v[72:75]
    ds_read_b128 v[108:111], v14 offset:53248
    v_mfma_f32_16x16x32_bf16 v[72:75], v[128:131], a[240:243], v[72:75]
    ds_read_b128 v[112:115], v14 offset:57344
    v_mfma_f32_16x16x32_bf16 v[72:75], v[124:127], a[232:235], v[72:75]
    ds_read_b128 v[116:119], v14 offset:61440
    v_mfma_f32_16x16x32_bf16 v[72:75], v[120:123], a[224:227], v[72:75]
    s_waitcnt lgkmcnt(2)
    v_mfma_f32_16x16x32_bf16 v[80:83], v[104:107], a[224:227], v[80:83]
    s_add_u32 m0, s73, 130560
    v_mfma_f32_16x16x32_bf16 v[80:83], v[108:111], a[232:235], v[80:83]
    buffer_load_dwordx4 v19, s[44:47], s22 offen offset:512 sc1 lds
    s_waitcnt lgkmcnt(0)
    v_mfma_f32_16x16x32_bf16 v[80:83], v[112:115], a[240:243], v[80:83]
    ds_read_b128 v[120:123], v14 offset:50176
    v_mfma_f32_16x16x32_bf16 v[80:83], v[116:119], a[248:251], v[80:83]
    ds_read_b128 v[124:127], v14 offset:54272
    v_mfma_f32_16x16x32_bf16 v[84:87], v[116:119], a[252:255], v[84:87]
    ds_read_b128 v[128:131], v14 offset:58368
    v_mfma_f32_16x16x32_bf16 v[84:87], v[112:115], a[244:247], v[84:87]
    ds_read_b128 v[132:135], v14 offset:62464
    v_mfma_f32_16x16x32_bf16 v[84:87], v[108:111], a[236:239], v[84:87]
    s_add_u32 m0, s73, 132096
    v_mfma_f32_16x16x32_bf16 v[84:87], v[104:107], a[228:231], v[84:87]
    buffer_load_dwordx4 v19, s[44:47], s23 offen offset:0 sc1 lds
    s_waitcnt lgkmcnt(2)
    v_mfma_f32_16x16x32_bf16 v[76:79], v[120:123], v[224:227], v[76:79]
    s_add_u32 m0, s73, 132608
    s_waitcnt vmcnt(15)
    v_bitop3_b32 v43, v43, v47, s68 bitop3:0x7e
    v_bitop3_b32 v43, v43, v51, s68 bitop3:0xf6
    v_cmp_ne_u32 vcc, 0, v43
    v_mfma_f32_16x16x32_bf16 v[76:79], v[124:127], v[232:235], v[76:79]
    buffer_load_dwordx4 v19, s[44:47], s23 offen offset:512 sc1 lds
    s_waitcnt lgkmcnt(0)
    v_mfma_f32_16x16x32_bf16 v[76:79], v[128:131], v[240:243], v[76:79]
    ds_read_b128 v[104:107], v14 offset:51200
    s_cbranch_vccnz L_xs_a
L_xo_a:
    v_and_b32 v89, 0xffff0000, v40
    v_mfma_f32_16x16x32_bf16 v[76:79], v[132:135], v[248:251], v[76:79]
    ds_read_b128 v[108:111], v14 offset:55296
    v_lshlrev_b32 v88, 16, v40
    v_mfma_f32_16x16x32_bf16 v[72:75], v[132:135], v[244:247], v[72:75]
    ds_read_b128 v[112:115], v14 offset:59392
    v_and_b32 v91, 0xffff0000, v41
    v_mfma_f32_16x16x32_bf16 v[72:75], v[128:131], v[236:239], v[72:75]
    ds_read_b128 v[116:119], v14 offset:63488
    v_lshlrev_b32 v90, 16, v41
    v_mfma_f32_16x16x32_bf16 v[72:75], v[124:127], v[228:231], v[72:75]
    s_add_u32 m0, s73, 134144
    v_and_b32 v93, 0xffff0000, v42
    v_lshlrev_b32 v92, 16, v42
    v_mfma_f32_16x16x32_bf16 v[72:75], v[120:123], v[220:223], v[72:75]
    buffer_load_dwordx4 v19, s[44:47], s24 offen offset:0 sc1 lds
    s_waitcnt lgkmcnt(2)
    v_mfma_f32_16x16x32_bf16 v[80:83], v[104:107], v[220:223], v[80:83]
    s_waitcnt vmcnt(9)
    v_and_b32 v95, 0xffff0000, v44
    v_lshlrev_b32 v94, 16, v44
    v_mfma_f32_16x16x32_bf16 v[80:83], v[108:111], v[228:231], v[80:83]
    v_and_b32 v97, 0xffff0000, v45
    v_cmp_ne_u32 vcc, v140, v141
    s_waitcnt lgkmcnt(0)
    v_mfma_f32_16x16x32_bf16 v[80:83], v[112:115], v[236:239], v[80:83]
    ds_read_b128 v[120:123], v14 offset:52224
    v_lshlrev_b32 v96, 16, v45
    v_mfma_f32_16x16x32_bf16 v[80:83], v[116:119], v[244:247], v[80:83]
    ds_read_b128 v[124:127], v14 offset:56320
    s_cbranch_vccnz L_as_b
L_ao_b:
    v_and_b32 v99, 0xffff0000, v46
    v_lshlrev_b32 v98, 16, v46
    v_mfma_f32_16x16x32_bf16 v[84:87], v[116:119], v[248:251], v[84:87]
    ds_read_b128 v[128:131], v14 offset:60416
    buffer_load_dwordx4 v[56:59], v136, s[44:47], s11 offen offset:0 sc1
    v_and_b32 v101, 0xffff0000, v48
    v_mfma_f32_16x16x32_bf16 v[84:87], v[112:115], v[240:243], v[84:87]
    ds_read_b128 v[132:135], v14 offset:64512
    buffer_load_dwordx4 v[60:63], v136, s[44:47], s11 offen offset:1024 sc1
    v_lshlrev_b32 v100, 16, v48
    v_mfma_f32_16x16x32_bf16 v[84:87], v[108:111], v[232:235], v[84:87]
    v_and_b32 v103, 0xffff0000, v49
    v_lshlrev_b32 v102, 16, v49
    v_mfma_f32_16x16x32_bf16 v[84:87], v[104:107], v[224:227], v[84:87]
    buffer_load_dwordx4 v[64:67], v136, s[44:47], s11 offen offset:2048 sc1
    s_waitcnt lgkmcnt(2)
    v_mfma_f32_16x16x32_bf16 v[92:95], v[120:123], a[4:7], v[92:95]
    v_mfma_f32_16x16x32_bf16 v[92:95], v[124:127], a[12:15], v[92:95]
    s_waitcnt lgkmcnt(0)
    v_mfma_f32_16x16x32_bf16 v[92:95], v[128:131], a[20:23], v[92:95]
    s_waitcnt vmcnt(11)
    s_barrier
    v_mfma_f32_16x16x32_bf16 v[92:95], v[132:135], a[28:31], v[92:95]
    ds_read_b128 v[104:107], v14 offset:0
    v_mfma_f32_16x16x32_bf16 v[88:91], v[132:135], a[24:27], v[88:91]
    ds_read_b128 v[108:111], v14 offset:4096
    v_cvt_pk_bf16_f32 v192, v72, v73
    v_mfma_f32_16x16x32_bf16 v[88:91], v[128:131], a[16:19], v[88:91]
    ds_read_b128 v[112:115], v14 offset:8192
    v_cvt_pk_bf16_f32 v193, v74, v75
    v_mfma_f32_16x16x32_bf16 v[88:91], v[124:127], a[8:11], v[88:91]
    ds_read_b128 v[116:119], v14 offset:12288
    v_cvt_pk_bf16_f32 v194, v76, v77
    v_mfma_f32_16x16x32_bf16 v[88:91], v[120:123], a[0:3], v[88:91]
    buffer_store_dwordx4 v[192:195], v136, s[44:47], s31 offen offset:0 sc1
    s_waitcnt lgkmcnt(2)
    v_mfma_f32_16x16x32_bf16 v[96:99], v[104:107], a[0:3], v[96:99]
    s_add_u32 m0, s73, 146944
    v_cvt_pk_bf16_f32 v196, v78, v79
    v_cvt_pk_bf16_f32 v197, v80, v81
    v_mfma_f32_16x16x32_bf16 v[96:99], v[108:111], a[8:11], v[96:99]
    buffer_load_dwordx4 v19, s[44:47], s24 offen offset:512 sc1 lds
    s_waitcnt lgkmcnt(0)
    v_mfma_f32_16x16x32_bf16 v[96:99], v[112:115], a[16:19], v[96:99]
    ds_read_b128 v[120:123], v14 offset:1024
    v_cvt_pk_bf16_f32 v198, v82, v83
    v_mfma_f32_16x16x32_bf16 v[96:99], v[116:119], a[24:27], v[96:99]
    buffer_store_dwordx4 v[196:199], v136, s[44:47], s31 offen offset:1024 sc1
    ds_read_b128 v[124:127], v14 offset:5120
    v_bitop3_b32 v207, v207, v211, s36 bitop3:0x7e
    v_bitop3_b32 v207, v207, v215, s36 bitop3:0xf6
    v_mfma_f32_16x16x32_bf16 v[100:103], v[116:119], a[28:31], v[100:103]
    ds_read_b128 v[128:131], v14 offset:9216
    v_cvt_pk_bf16_f32 v200, v84, v85
    v_mfma_f32_16x16x32_bf16 v[100:103], v[112:115], a[20:23], v[100:103]
    ds_read_b128 v[132:135], v14 offset:13312
    v_cvt_pk_bf16_f32 v201, v86, v87
    v_mfma_f32_16x16x32_bf16 v[100:103], v[108:111], a[12:15], v[100:103]
    buffer_store_dwordx4 v[200:203], v136, s[44:47], s31 offen offset:2048 sc1
    s_add_u32 m0, s73, 148480
    v_bitop3_b32 v207, v207, v219, s36 bitop3:0xf6
    v_cmp_ne_u32 vcc, 0, v207
    v_mfma_f32_16x16x32_bf16 v[100:103], v[104:107], a[4:7], v[100:103]
    buffer_load_dwordx4 v19, s[44:47], s25 offen offset:0 sc1 lds
    s_waitcnt lgkmcnt(2)
    v_mfma_f32_16x16x32_bf16 v[92:95], v[120:123], a[36:39], v[92:95]
    s_add_u32 m0, s73, 148992
    s_cbranch_vccnz L_xs_8
L_xo_8:
    v_mfma_f32_16x16x32_bf16 v[92:95], v[124:127], a[44:47], v[92:95]
    buffer_load_dwordx4 v19, s[44:47], s25 offen offset:512 sc1 lds
    s_waitcnt lgkmcnt(0)
    v_mfma_f32_16x16x32_bf16 v[92:95], v[128:131], a[52:55], v[92:95]
    ds_read_b128 v[104:107], v14 offset:2048
    v_and_b32 v33, 0xffff0000, v204
    v_mfma_f32_16x16x32_bf16 v[92:95], v[132:135], a[60:63], v[92:95]
    ds_read_b128 v[108:111], v14 offset:6144
    v_lshlrev_b32 v32, 16, v204
    v_mfma_f32_16x16x32_bf16 v[88:91], v[132:135], a[56:59], v[88:91]
    ds_read_b128 v[112:115], v14 offset:10240
    v_and_b32 v35, 0xffff0000, v205
    v_mfma_f32_16x16x32_bf16 v[88:91], v[128:131], a[48:51], v[88:91]
    ds_read_b128 v[116:119], v14 offset:14336
    v_mfma_f32_16x16x32_bf16 v[88:91], v[124:127], a[40:43], v[88:91]
    s_add_u32 m0, s73, 150528
    v_lshlrev_b32 v34, 16, v205
    v_mfma_f32_16x16x32_bf16 v[88:91], v[120:123], a[32:35], v[88:91]
    buffer_load_dwordx4 v19, s[44:47], s26 offen offset:0 sc1 lds
    s_waitcnt lgkmcnt(2)
    v_mfma_f32_16x16x32_bf16 v[96:99], v[104:107], a[32:35], v[96:99]
    v_add_f32 v32, v32, v27
    v_mfma_f32_16x16x32_bf16 v[96:99], v[108:111], a[40:43], v[96:99]
    v_add_f32 v33, v33, v27
    s_waitcnt lgkmcnt(0)
    v_mfma_f32_16x16x32_bf16 v[96:99], v[112:115], a[48:51], v[96:99]
    ds_read_b128 v[120:123], v14 offset:3072
    v_add_f32 v34, v34, v27
    v_mfma_f32_16x16x32_bf16 v[96:99], v[116:119], a[56:59], v[96:99]
    ds_read_b128 v[124:127], v14 offset:7168
    v_mfma_f32_16x16x32_bf16 v[100:103], v[116:119], a[60:63], v[100:103]
    ds_read_b128 v[128:131], v14 offset:11264
    v_add_f32 v35, v35, v27
    v_mfma_f32_16x16x32_bf16 v[100:103], v[112:115], a[52:55], v[100:103]
    ds_read_b128 v[132:135], v14 offset:15360
    v_and_b32 v37, 0xffff0000, v208
    v_mfma_f32_16x16x32_bf16 v[100:103], v[108:111], a[44:47], v[100:103]
    v_mfma_f32_16x16x32_bf16 v[100:103], v[104:107], a[36:39], v[100:103]
    v_lshlrev_b32 v36, 16, v208
    s_waitcnt lgkmcnt(2)
    v_mfma_f32_16x16x32_bf16 v[92:95], v[120:123], a[68:71], v[92:95]
    v_and_b32 v39, 0xffff0000, v209
    v_mfma_f32_16x16x32_bf16 v[92:95], v[124:127], a[76:79], v[92:95]
    s_waitcnt lgkmcnt(0)
    v_mfma_f32_16x16x32_bf16 v[92:95], v[128:131], a[84:87], v[92:95]
    s_waitcnt vmcnt(14)
    s_barrier
    v_lshlrev_b32 v38, 16, v209
    v_mfma_f32_16x16x32_bf16 v[92:95], v[132:135], a[92:95], v[92:95]
    ds_read_b128 v[104:107], v14 offset:16384
    v_add_f32 v32, v32, v36
    v_mfma_f32_16x16x32_bf16 v[88:91], v[132:135], a[88:91], v[88:91]
    ds_read_b128 v[108:111], v14 offset:20480
    v_mfma_f32_16x16x32_bf16 v[88:91], v[128:131], a[80:83], v[88:91]
    ds_read_b128 v[112:115], v14 offset:24576
    v_add_f32 v33, v33, v37
    v_mfma_f32_16x16x32_bf16 v[88:91], v[124:127], a[72:75], v[88:91]
    ds_read_b128 v[116:119], v14 offset:28672
    v_add_f32 v34, v34, v38
    v_mfma_f32_16x16x32_bf16 v[88:91], v[120:123], a[64:67], v[88:91]
    s_waitcnt lgkmcnt(2)
    v_mfma_f32_16x16x32_bf16 v[96:99], v[104:107], a[64:67], v[96:99]
    s_add_u32 m0, s73, 97792
    v_add_f32 v35, v35, v39
    v_mfma_f32_16x16x32_bf16 v[96:99], v[108:111], a[72:75], v[96:99]
    buffer_load_dwordx4 v19, s[44:47], s26 offen offset:512 sc1 lds
    s_waitcnt lgkmcnt(0)
    v_mfma_f32_16x16x32_bf16 v[96:99], v[112:115], a[80:83], v[96:99]
    ds_read_b128 v[120:123], v14 offset:17408
    v_and_b32 v37, 0xffff0000, v212
    v_mfma_f32_16x16x32_bf16 v[96:99], v[116:119], a[88:91], v[96:99]
    ds_read_b128 v[124:127], v14 offset:21504
    v_lshlrev_b32 v36, 16, v212
    v_mfma_f32_16x16x32_bf16 v[100:103], v[116:119], a[92:95], v[100:103]
    ds_read_b128 v[128:131], v14 offset:25600
    v_and_b32 v39, 0xffff0000, v213
    v_mfma_f32_16x16x32_bf16 v[100:103], v[112:115], a[84:87], v[100:103]
    ds_read_b128 v[132:135], v14 offset:29696
    v_mfma_f32_16x16x32_bf16 v[100:103], v[108:111], a[76:79], v[100:103]
    v_lshlrev_b32 v38, 16, v213
    v_mfma_f32_16x16x32_bf16 v[100:103], v[104:107], a[68:71], v[100:103]
    v_add_f32 v32, v32, v36
    s_waitcnt lgkmcnt(2)
    v_mfma_f32_16x16x32_bf16 v[92:95], v[120:123], a[100:103], v[92:95]
    v_mfma_f32_16x16x32_bf16 v[92:95], v[124:127], a[108:111], v[92:95]
    v_add_f32 v33, v33, v37
    s_waitcnt lgkmcnt(0)
    v_mfma_f32_16x16x32_bf16 v[92:95], v[128:131], a[116:119], v[92:95]
    ds_read_b128 v[104:107], v14 offset:18432
    v_add_f32 v34, v34, v38
    v_mfma_f32_16x16x32_bf16 v[92:95], v[132:135], a[124:127], v[92:95]
    ds_read_b128 v[108:111], v14 offset:22528
    v_add_f32 v35, v35, v39
    v_mfma_f32_16x16x32_bf16 v[88:91], v[132:135], a[120:123], v[88:91]
    ds_read_b128 v[112:115], v14 offset:26624
    v_and_b32 v37, 0xffff0000, v216
    v_mfma_f32_16x16x32_bf16 v[88:91], v[128:131], a[112:115], v[88:91]
    ds_read_b128 v[116:119], v14 offset:30720
    v_lshlrev_b32 v36, 16, v216
    v_mfma_f32_16x16x32_bf16 v[88:91], v[124:127], a[104:107], v[88:91]
    v_and_b32 v39, 0xffff0000, v217
    v_lshlrev_b32 v38, 16, v217
    v_mfma_f32_16x16x32_bf16 v[88:91], v[120:123], a[96:99], v[88:91]
    v_add_f32 v32, v32, v36
    s_waitcnt lgkmcnt(2)
    v_mfma_f32_16x16x32_bf16 v[96:99], v[104:107], a[96:99], v[96:99]
    v_add_f32 v33, v33, v37
    v_add_f32 v34, v34, v38
    v_mfma_f32_16x16x32_bf16 v[96:99], v[108:111], a[104:107], v[96:99]
L_pl_D_2:
    s_cbranch_execz L_wret
    v_add_f32 v35, v35, v39
    s_waitcnt lgkmcnt(0)
    v_mfma_f32_16x16x32_bf16 v[96:99], v[112:115], a[112:115], v[96:99]
    ds_read_b128 v[120:123], v14 offset:19456
    v_mul_f32 v36, s38, v32
    v_mfma_f32_16x16x32_bf16 v[96:99], v[116:119], a[120:123], v[96:99]
    ds_read_b128 v[124:127], v14 offset:23552
    v_mul_f32 v37, s38, v33
    v_mfma_f32_16x16x32_bf16 v[100:103], v[116:119], a[124:127], v[100:103]
    ds_read_b128 v[128:131], v14 offset:27648
    v_mul_f32 v38, s38, v34
    v_mfma_f32_16x16x32_bf16 v[100:103], v[112:115], a[116:119], v[100:103]
    ds_read_b128 v[132:135], v14 offset:31744
    v_mul_f32 v39, s38, v35
    v_mfma_f32_16x16x32_bf16 v[100:103], v[108:111], a[108:111], v[100:103]
    v_exp_f32 v36, v36
    v_mfma_f32_16x16x32_bf16 v[100:103], v[104:107], a[100:103], v[100:103]
    s_waitcnt lgkmcnt(2)
    v_mfma_f32_16x16x32_bf16 v[92:95], v[120:123], a[132:135], v[92:95]
    v_exp_f32 v37, v37
    v_mfma_f32_16x16x32_bf16 v[92:95], v[124:127], a[140:143], v[92:95]
    s_waitcnt lgkmcnt(0)
    v_mfma_f32_16x16x32_bf16 v[92:95], v[128:131], a[148:151], v[92:95]
    s_waitcnt vmcnt(11)
    s_barrier
    v_mfma_f32_16x16x32_bf16 v[92:95], v[132:135], a[156:159], v[92:95]
    ds_read_b128 v[104:107], v14 offset:32768
    v_mfma_f32_16x16x32_bf16 v[88:91], v[132:135], a[152:155], v[88:91]
    ds_read_b128 v[108:111], v14 offset:36864
    v_exp_f32 v38, v38
    v_mfma_f32_16x16x32_bf16 v[88:91], v[128:131], a[144:147], v[88:91]
    ds_read_b128 v[112:115], v14 offset:40960
    v_exp_f32 v39, v39
    v_mfma_f32_16x16x32_bf16 v[88:91], v[124:127], a[136:139], v[88:91]
    ds_read_b128 v[116:119], v14 offset:45056
    v_mul_f32 v180, v180, v32
    v_mfma_f32_16x16x32_bf16 v[88:91], v[120:123], a[128:131], v[88:91]
    v_mul_f32 v181, v181, v33
    s_waitcnt lgkmcnt(2)
    v_mfma_f32_16x16x32_bf16 v[96:99], v[104:107], a[128:131], v[96:99]
    v_mul_f32 v182, v182, v34
    v_mul_f32 v183, v183, v35
    v_mfma_f32_16x16x32_bf16 v[96:99], v[108:111], a[136:139], v[96:99]
    v_add_f32 v36, 1.0, v36
    s_waitcnt lgkmcnt(0)
    v_mfma_f32_16x16x32_bf16 v[96:99], v[112:115], a[144:147], v[96:99]
    ds_read_b128 v[120:123], v14 offset:33792
    v_add_f32 v37, 1.0, v37
    v_mfma_f32_16x16x32_bf16 v[96:99], v[116:119], a[152:155], v[96:99]
    ds_read_b128 v[124:127], v14 offset:37888
    v_add_f32 v38, 1.0, v38
    v_mfma_f32_16x16x32_bf16 v[100:103], v[116:119], a[156:159], v[100:103]
    ds_read_b128 v[128:131], v14 offset:41984
    v_add_f32 v39, 1.0, v39
    v_mfma_f32_16x16x32_bf16 v[100:103], v[112:115], a[148:151], v[100:103]
    ds_read_b128 v[132:135], v14 offset:46080
    v_rcp_f32 v36, v36
    v_mfma_f32_16x16x32_bf16 v[100:103], v[108:111], a[140:143], v[100:103]
    v_rcp_f32 v37, v37
    v_mfma_f32_16x16x32_bf16 v[100:103], v[104:107], a[132:135], v[100:103]
    v_rcp_f32 v38, v38
    s_waitcnt lgkmcnt(2)
    v_mfma_f32_16x16x32_bf16 v[92:95], v[120:123], a[164:167], v[92:95]
    s_waitcnt vmcnt(8)
    v_rcp_f32 v39, v39
    v_mfma_f32_16x16x32_bf16 v[92:95], v[124:127], a[172:175], v[92:95]
    v_bitop3_b32 v59, v59, v63, s68 bitop3:0x7e
    s_waitcnt lgkmcnt(0)
    v_mfma_f32_16x16x32_bf16 v[92:95], v[128:131], a[180:183], v[92:95]
    ds_read_b128 v[104:107], v14 offset:34816
    v_bitop3_b32 v59, v59, v67, s68 bitop3:0xf6
    v_mfma_f32_16x16x32_bf16 v[92:95], v[132:135], a[188:191], v[92:95]
    ds_read_b128 v[108:111], v14 offset:38912
    v_cmp_ne_u32 vcc, 0, v59
    v_mfma_f32_16x16x32_bf16 v[88:91], v[132:135], a[184:187], v[88:91]
    ds_read_b128 v[112:115], v14 offset:43008
    v_fma_f32 v180, v180, v36, v160
    v_mfma_f32_16x16x32_bf16 v[88:91], v[128:131], a[176:179], v[88:91]
    ds_read_b128 v[116:119], v14 offset:47104
    buffer_load_dwordx4 v[72:75], v136, s[44:47], s12 offen offset:0 sc1
    s_cbranch_vccnz L_xs_b
L_xo_b:
    v_mfma_f32_16x16x32_bf16 v[88:91], v[124:127], a[168:171], v[88:91]
    v_and_b32 v41, 0xffff0000, v56
    v_lshlrev_b32 v40, 16, v56
    v_mfma_f32_16x16x32_bf16 v[88:91], v[120:123], a[160:163], v[88:91]
    buffer_load_dwordx4 v[76:79], v136, s[44:47], s12 offen offset:1024 sc1
    s_waitcnt lgkmcnt(2)
    v_mfma_f32_16x16x32_bf16 v[96:99], v[104:107], a[160:163], v[96:99]
    v_and_b32 v43, 0xffff0000, v57
    v_fma_f32 v181, v181, v37, v161
    v_mfma_f32_16x16x32_bf16 v[96:99], v[108:111], a[168:171], v[96:99]
    v_lshlrev_b32 v42, 16, v57
    s_waitcnt lgkmcnt(0)
    v_mfma_f32_16x16x32_bf16 v[96:99], v[112:115], a[176:179], v[96:99]
    ds_read_b128 v[120:123], v14 offset:35840
    buffer_load_dwordx4 v[80:83], v136, s[44:47], s12 offen offset:2048 sc1
    v_mfma_f32_16x16x32_bf16 v[96:99], v[116:119], a[184:187], v[96:99]
    ds_read_b128 v[124:127], v14 offset:39936
    v_and_b32 v45, 0xffff0000, v58
    v_mfma_f32_16x16x32_bf16 v[100:103], v[116:119], a[188:191], v[100:103]
    ds_read_b128 v[128:131], v14 offset:44032
    v_lshlrev_b32 v44, 16, v58
    v_mfma_f32_16x16x32_bf16 v[100:103], v[112:115], a[180:183], v[100:103]
    ds_read_b128 v[132:135], v14 offset:48128
    v_and_b32 v47, 0xffff0000, v60
    v_mfma_f32_16x16x32_bf16 v[100:103], v[108:111], a[172:175], v[100:103]
    v_lshlrev_b32 v46, 16, v60
    v_fma_f32 v182, v182, v38, v162
    v_mfma_f32_16x16x32_bf16 v[100:103], v[104:107], a[164:167], v[100:103]
    v_and_b32 v49, 0xffff0000, v61
    s_waitcnt lgkmcnt(2)
    v_mfma_f32_16x16x32_bf16 v[92:95], v[120:123], a[196:199], v[92:95]
    v_lshlrev_b32 v48, 16, v61
    v_fma_f32 v183, v183, v39, v163
    v_mfma_f32_16x16x32_bf16 v[92:95], v[124:127], a[204:207], v[92:95]
    v_and_b32 v51, 0xffff0000, v62
    s_waitcnt lgkmcnt(0)
    v_mfma_f32_16x16x32_bf16 v[92:95], v[128:131], a[212:215], v[92:95]
    s_waitcnt vmcnt(4)
    s_barrier
    v_lshlrev_b32 v50, 16, v62
    v_mfma_f32_16x16x32_bf16 v[92:95], v[132:135], a[220:223], v[92:95]
    ds_read_b128 v[104:107], v14 offset:49152
    v_cvt_pk_bf16_f32 v142, v180, v181
    v_mfma_f32_16x16x32_bf16 v[88:91], v[132:135], a[216:219], v[88:91]
    ds_read_b128 v[108:111], v14 offset:53248
    v_and_b32 v53, 0xffff0000, v64
    v_mfma_f32_16x16x32_bf16 v[88:91], v[128:131], a[208:211], v[88:91]
    ds_read_b128 v[112:115], v14 offset:57344
    v_lshlrev_b32 v52, 16, v64
    v_mfma_f32_16x16x32_bf16 v[88:91], v[124:127], a[200:203], v[88:91]
    ds_read_b128 v[116:119], v14 offset:61440
    v_and_b32 v55, 0xffff0000, v65
    v_mfma_f32_16x16x32_bf16 v[88:91], v[120:123], a[192:195], v[88:91]
    v_lshlrev_b32 v54, 16, v65
    v_cvt_pk_bf16_f32 v143, v182, v183
    s_waitcnt lgkmcnt(2)
    v_mfma_f32_16x16x32_bf16 v[96:99], v[104:107], a[192:195], v[96:99]
    v_mfma_f32_16x16x32_bf16 v[96:99], v[108:111], a[200:203], v[96:99]
    s_waitcnt lgkmcnt(0)
    v_mfma_f32_16x16x32_bf16 v[96:99], v[112:115], a[208:211], v[96:99]
    ds_read_b128 v[120:123], v14 offset:50176
    v_add_f32 v92, v92, v44
    v_add_f32 v93, v93, v45
    v_mfma_f32_16x16x32_bf16 v[96:99], v[116:119], a[216:219], v[96:99]
    ds_read_b128 v[124:127], v14 offset:54272
    v_add_f32 v94, v94, v46
    v_mfma_f32_16x16x32_bf16 v[100:103], v[116:119], a[220:223], v[100:103]
    ds_read_b128 v[128:131], v14 offset:58368
    v_add_f32 v95, v95, v47
    v_add_f32 v88, v88, v40
    v_mfma_f32_16x16x32_bf16 v[100:103], v[112:115], a[212:215], v[100:103]
    ds_read_b128 v[132:135], v14 offset:62464
    v_add_f32 v89, v89, v41
    v_mfma_f32_16x16x32_bf16 v[100:103], v[108:111], a[204:207], v[100:103]
    v_add_f32 v90, v90, v42
    v_add_f32 v91, v91, v43
    v_mfma_f32_16x16x32_bf16 v[100:103], v[104:107], a[196:199], v[100:103]
    s_waitcnt lgkmcnt(2)
    v_mfma_f32_16x16x32_bf16 v[92:95], v[120:123], a[228:231], v[92:95]
    v_mfma_f32_16x16x32_bf16 v[92:95], v[124:127], a[236:239], v[92:95]
    s_waitcnt lgkmcnt(0)
    v_mfma_f32_16x16x32_bf16 v[92:95], v[128:131], a[244:247], v[92:95]
    ds_read_b128 v[104:107], v14 offset:51200
    v_add_f32 v96, v96, v48
    v_add_f32 v97, v97, v49
    v_mfma_f32_16x16x32_bf16 v[92:95], v[132:135], a[252:255], v[92:95]
    ds_read_b128 v[108:111], v14 offset:55296
    v_add_f32 v98, v98, v50
    v_mfma_f32_16x16x32_bf16 v[88:91], v[132:135], a[248:251], v[88:91]
    ds_read_b128 v[112:115], v14 offset:59392
    v_add_f32 v99, v99, v51
    v_add_f32 v100, v100, v52
    v_mfma_f32_16x16x32_bf16 v[88:91], v[128:131], a[240:243], v[88:91]
    ds_read_b128 v[116:119], v14 offset:63488
    v_add_f32 v101, v101, v53
    v_mfma_f32_16x16x32_bf16 v[88:91], v[124:127], a[232:235], v[88:91]
    v_add_f32 v102, v102, v54
    v_add_f32 v103, v103, v55
    v_mfma_f32_16x16x32_bf16 v[88:91], v[120:123], a[224:227], v[88:91]
    s_waitcnt lgkmcnt(2)
    v_mfma_f32_16x16x32_bf16 v[96:99], v[104:107], a[224:227], v[96:99]
    v_mfma_f32_16x16x32_bf16 v[96:99], v[108:111], a[232:235], v[96:99]
    s_waitcnt lgkmcnt(0)
    v_mfma_f32_16x16x32_bf16 v[96:99], v[112:115], a[240:243], v[96:99]
    ds_read_b128 v[120:123], v14 offset:52224
    v_mfma_f32_16x16x32_bf16 v[96:99], v[116:119], a[248:251], v[96:99]
    ds_read_b128 v[124:127], v14 offset:56320
    v_mfma_f32_16x16x32_bf16 v[100:103], v[116:119], a[252:255], v[100:103]
    buffer_store_dwordx2 v[142:143], v253, s[64:67], 0 offen sc1
    ds_read_b128 v[128:131], v14 offset:60416
    v_mfma_f32_16x16x32_bf16 v[100:103], v[112:115], a[244:247], v[100:103]
    ds_read_b128 v[132:135], v14 offset:64512
    v_mfma_f32_16x16x32_bf16 v[100:103], v[108:111], a[236:239], v[100:103]
    v_mfma_f32_16x16x32_bf16 v[100:103], v[104:107], a[228:231], v[100:103]
    s_waitcnt lgkmcnt(2)
    v_mfma_f32_16x16x32_bf16 v[92:95], v[120:123], v[224:227], v[92:95]
    v_mfma_f32_16x16x32_bf16 v[92:95], v[124:127], v[232:235], v[92:95]
    s_waitcnt lgkmcnt(0)
    v_mfma_f32_16x16x32_bf16 v[92:95], v[128:131], v[240:243], v[92:95]
    s_waitcnt vmcnt(4)
    s_barrier
    v_mfma_f32_16x16x32_bf16 v[92:95], v[132:135], v[248:251], v[92:95]
    ds_read_b128 v[104:107], v14 offset:0
    v_mfma_f32_16x16x32_bf16 v[88:91], v[132:135], v[244:247], v[88:91]
    ds_read_b128 v[108:111], v14 offset:4096
    v_mfma_f32_16x16x32_bf16 v[88:91], v[128:131], v[236:239], v[88:91]
    ds_read_b128 v[112:115], v14 offset:8192
    v_mfma_f32_16x16x32_bf16 v[88:91], v[124:127], v[228:231], v[88:91]
    ds_read_b128 v[116:119], v14 offset:12288
    v_mfma_f32_16x16x32_bf16 v[88:91], v[120:123], v[220:223], v[88:91]
    s_waitcnt lgkmcnt(2)
    v_mfma_f32_16x16x32_bf16 v[96:99], v[104:107], v[220:223], v[96:99]
    v_mfma_f32_16x16x32_bf16 v[96:99], v[108:111], v[228:231], v[96:99]
    s_waitcnt lgkmcnt(0)
    v_mfma_f32_16x16x32_bf16 v[96:99], v[112:115], v[236:239], v[96:99]
    v_mfma_f32_16x16x32_bf16 v[96:99], v[116:119], v[244:247], v[96:99]
    v_mfma_f32_16x16x32_bf16 v[100:103], v[116:119], v[248:251], v[100:103]
    v_mfma_f32_16x16x32_bf16 v[100:103], v[112:115], v[240:243], v[100:103]
    v_mfma_f32_16x16x32_bf16 v[100:103], v[108:111], v[232:235], v[100:103]
    v_mfma_f32_16x16x32_bf16 v[100:103], v[104:107], v[224:227], v[100:103]
    s_waitcnt vmcnt(1)
    v_bitop3_b32 v75, v75, v79, s68 bitop3:0x7e
    v_bitop3_b32 v75, v75, v83, s68 bitop3:0xf6
    v_cmp_ne_u32 vcc, 0, v75
    s_cbranch_vccnz L_xs_z
L_xo_z:
    v_and_b32 v41, 0xffff0000, v72
    v_lshlrev_b32 v40, 16, v72
    v_and_b32 v43, 0xffff0000, v73
    v_lshlrev_b32 v42, 16, v73
    v_and_b32 v45, 0xffff0000, v74
    v_lshlrev_b32 v44, 16, v74
    v_and_b32 v47, 0xffff0000, v76
    v_lshlrev_b32 v46, 16, v76
    v_and_b32 v49, 0xffff0000, v77
    v_lshlrev_b32 v48, 16, v77
    v_and_b32 v51, 0xffff0000, v78
    v_lshlrev_b32 v50, 16, v78
    v_and_b32 v53, 0xffff0000, v80
    v_lshlrev_b32 v52, 16, v80
    v_and_b32 v55, 0xffff0000, v81
    v_lshlrev_b32 v54, 16, v81
    v_pk_add_f32 v[88:89], v[88:89], v[40:41]
    v_pk_add_f32 v[90:91], v[90:91], v[42:43]
    v_pk_add_f32 v[96:97], v[96:97], v[48:49]
    v_pk_add_f32 v[98:99], v[98:99], v[50:51]
    v_pk_mul_f32 v[56:57], v[88:89], s[38:39] op_sel_hi:[1,0]
    v_pk_mul_f32 v[58:59], v[90:91], s[38:39] op_sel_hi:[1,0]
    v_pk_mul_f32 v[64:65], v[96:97], s[38:39] op_sel_hi:[1,0]
    v_pk_mul_f32 v[66:67], v[98:99], s[38:39] op_sel_hi:[1,0]
    v_exp_f32 v56, v56
    v_exp_f32 v57, v57
    v_exp_f32 v58, v58
    v_exp_f32 v59, v59
    v_exp_f32 v64, v64
    v_exp_f32 v65, v65
    v_exp_f32 v66, v66
    v_exp_f32 v67, v67
    v_pk_mul_f32 v[164:165], v[164:165], v[88:89]
    v_pk_mul_f32 v[166:167], v[166:167], v[90:91]
    v_pk_mul_f32 v[172:173], v[172:173], v[96:97]
    v_pk_mul_f32 v[174:175], v[174:175], v[98:99]
    v_pk_add_f32 v[56:57], v[56:57], 1.0 op_sel_hi:[1,0]
    v_pk_add_f32 v[58:59], v[58:59], 1.0 op_sel_hi:[1,0]
    v_pk_add_f32 v[64:65], v[64:65], 1.0 op_sel_hi:[1,0]
    v_pk_add_f32 v[66:67], v[66:67], 1.0 op_sel_hi:[1,0]
    v_rcp_f32 v56, v56
    v_rcp_f32 v57, v57
    v_rcp_f32 v58, v58
    v_rcp_f32 v59, v59
    v_rcp_f32 v64, v64
    v_rcp_f32 v65, v65
    v_rcp_f32 v66, v66
    v_rcp_f32 v67, v67
    v_pk_fma_f32 v[164:165], v[164:165], v[56:57], v[144:145]
    v_pk_fma_f32 v[166:167], v[166:167], v[58:59], v[146:147]
    v_pk_fma_f32 v[172:173], v[172:173], v[64:65], v[152:153]
    v_pk_fma_f32 v[174:175], v[174:175], v[66:67], v[154:155]
    v_cvt_pk_bf16_f32 v88, v164, v165
    v_cvt_pk_bf16_f32 v90, v172, v173
    v_cvt_pk_bf16_f32 v89, v166, v167
    v_cvt_pk_bf16_f32 v91, v174, v175
    v_permlane16_swap_b32 v88, v90
    s_nop 0
    v_permlane16_swap_b32 v89, v91
    buffer_store_dwordx4 v[88:91], v252, s[64:67], 0 offen sc1
    v_pk_add_f32 v[92:93], v[92:93], v[44:45]
    v_pk_add_f32 v[94:95], v[94:95], v[46:47]
    v_pk_add_f32 v[100:101], v[100:101], v[52:53]
    v_pk_add_f32 v[102:103], v[102:103], v[54:55]
    v_pk_mul_f32 v[60:61], v[92:93], s[38:39] op_sel_hi:[1,0]
    v_pk_mul_f32 v[62:63], v[94:95], s[38:39] op_sel_hi:[1,0]
    v_pk_mul_f32 v[68:69], v[100:101], s[38:39] op_sel_hi:[1,0]
    v_pk_mul_f32 v[70:71], v[102:103], s[38:39] op_sel_hi:[1,0]
    v_exp_f32 v60, v60
    v_exp_f32 v61, v61
    v_exp_f32 v62, v62
    v_exp_f32 v63, v63
    v_exp_f32 v68, v68
    v_exp_f32 v69, v69
    v_exp_f32 v70, v70
    v_exp_f32 v71, v71
    v_pk_mul_f32 v[168:169], v[168:169], v[92:93]
    v_pk_mul_f32 v[170:171], v[170:171], v[94:95]
    v_pk_mul_f32 v[176:177], v[176:177], v[100:101]
    v_pk_mul_f32 v[178:179], v[178:179], v[102:103]
    v_pk_add_f32 v[60:61], v[60:61], 1.0 op_sel_hi:[1,0]
    v_pk_add_f32 v[62:63], v[62:63], 1.0 op_sel_hi:[1,0]
    v_pk_add_f32 v[68:69], v[68:69], 1.0 op_sel_hi:[1,0]
    v_pk_add_f32 v[70:71], v[70:71], 1.0 op_sel_hi:[1,0]
    v_rcp_f32 v60, v60
    v_rcp_f32 v61, v61
    v_rcp_f32 v62, v62
    v_rcp_f32 v63, v63
    v_rcp_f32 v68, v68
    v_rcp_f32 v69, v69
    v_rcp_f32 v70, v70
    v_rcp_f32 v71, v71
    v_pk_fma_f32 v[168:169], v[168:169], v[60:61], v[148:149]
    v_pk_fma_f32 v[170:171], v[170:171], v[62:63], v[150:151]
    v_pk_fma_f32 v[176:177], v[176:177], v[68:69], v[156:157]
    v_pk_fma_f32 v[178:179], v[178:179], v[70:71], v[158:159]
    v_cvt_pk_bf16_f32 v92, v168, v169
    v_cvt_pk_bf16_f32 v94, v176, v177
    v_cvt_pk_bf16_f32 v93, v170, v171
    v_cvt_pk_bf16_f32 v95, v178, v179
    v_permlane16_swap_b32 v92, v94
    s_nop 0
    v_permlane16_swap_b32 v93, v95
    buffer_store_dwordx4 v[92:95], v252, s[64:67], s40 offen sc1
    s_endpgm
L_segE:
.p2align 12
L_aux:
    s_mul_i32 s84, s101, 16
    s_lshr_b32 s84, s84, 2
    s_add_u32 s84, s84, 0
    s_add_u32 s85, s84, 1
    s_cmp_eq_u32 s85, 16
    s_cselect_b32 s85, 0, s85
    s_add_u32 s86, s85, 1
    s_cmp_eq_u32 s86, 16
    s_cselect_b32 s86, 0, s86
    s_add_u32 s87, s86, 1
    s_cmp_eq_u32 s87, 16
    s_cselect_b32 s87, 0, s87
    s_add_u32 s88, s87, 1
    s_cmp_eq_u32 s88, 16
    s_cselect_b32 s88, 0, s88
    s_add_u32 s89, s88, 1
    s_cmp_eq_u32 s89, 16
    s_cselect_b32 s89, 0, s89
    s_add_u32 s90, s89, 1
    s_cmp_eq_u32 s90, 16
    s_cselect_b32 s90, 0, s90
    s_add_u32 s91, s90, 1
    s_cmp_eq_u32 s91, 16
    s_cselect_b32 s91, 0, s91
    s_add_u32 s92, s91, 1
    s_cmp_eq_u32 s92, 16
    s_cselect_b32 s92, 0, s92
    s_add_u32 s93, s92, 1
    s_cmp_eq_u32 s93, 16
    s_cselect_b32 s93, 0, s93
    s_add_u32 s94, s93, 1
    s_cmp_eq_u32 s94, 16
    s_cselect_b32 s94, 0, s94
    s_add_u32 s95, s94, 1
    s_cmp_eq_u32 s95, 16
    s_cselect_b32 s95, 0, s95
    s_add_u32 s96, s95, 1
    s_cmp_eq_u32 s96, 16
    s_cselect_b32 s96, 0, s96
    s_add_u32 s97, s96, 1
    s_cmp_eq_u32 s97, 16
    s_cselect_b32 s97, 0, s97
    s_add_u32 s98, s97, 1
    s_cmp_eq_u32 s98, 16
    s_cselect_b32 s98, 0, s98
    s_add_u32 s99, s98, 1
    s_cmp_eq_u32 s99, 16
    s_cselect_b32 s99, 0, s99
    s_mul_i32 s100, s101, 2
    s_lshr_b32 s100, s100, 2
    s_add_u32 s100, s100, 16
    s_add_u32 s101, s100, 1
    s_cmp_eq_u32 s101, 18
    s_cselect_b32 s101, 16, s101
    s_lshl2_add_u32 s7, s5, s6
    s_add_u32 s7, s7, 188
    s_add_u32 s8, s5, 248
    s_cmp_eq_u32 s6, 27
    s_cselect_b32 s75, s8, s7
    s_mov_b32 s48, s24
    s_and_b32 s49, s25, 0xffff
    s_mov_b32 s50, 2359296
    s_mov_b32 s51, 0x20000
    v_lshlrev_b32 v240, 4, v2
    s_mul_i32 s74, s3, 16640
    s_add_u32 s74, s74, 73728
    s_sub_u32 s69, s75, 216
    s_lshl_b32 s70, s69, 4
    s_add_u32 s70, s70, s3
    s_lshl_b32 s12, s70, 12
    s_lshl_b32 s70, s70, 1
    v_lshrrev_b32 v242, 5, v2
    v_and_b32 v243, 31, v2
    v_lshlrev_b32 v242, 14, v242
    v_lshl_add_u32 v242, v243, 7, v242
    s_add_u32 s13, s12, 32768
    s_mov_b32 s9, 144896
    s_mov_b32 s11, 114688
    s_waitcnt vmcnt(9)
    v_and_b32 v21, 0xffff0000, v8
    v_lshlrev_b32 v20, 16, v8
    v_and_b32 v23, 0xffff0000, v9
    v_lshlrev_b32 v22, 16, v9
    v_and_b32 v25, 0xffff0000, v10
    v_lshlrev_b32 v24, 16, v10
    v_and_b32 v27, 0xffff0000, v12
    v_lshlrev_b32 v26, 16, v12
    v_and_b32 v29, 0xffff0000, v13
    v_lshlrev_b32 v28, 16, v13
    v_and_b32 v31, 0xffff0000, v14
    v_lshlrev_b32 v30, 16, v14
    v_and_b32 v33, 0xffff0000, v16
    v_lshlrev_b32 v32, 16, v16
    v_and_b32 v35, 0xffff0000, v17
    v_lshlrev_b32 v34, 16, v17
    v_and_b32 v37, 0xffff0000, v18
    v_lshlrev_b32 v36, 16, v18
    v_pk_add_f32 v[38:39], v[20:21], v[22:23]
    v_pk_add_f32 v[40:41], v[24:25], v[26:27]
    v_pk_add_f32 v[42:43], v[28:29], v[30:31]
    v_pk_add_f32 v[44:45], v[32:33], v[34:35]
    v_pk_add_f32 v[38:39], v[38:39], v[40:41]
    v_pk_add_f32 v[42:43], v[42:43], v[44:45]
    v_pk_add_f32 v[38:39], v[38:39], v[36:37]
    v_pk_add_f32 v[38:39], v[38:39], v[42:43]
    v_add_f32 v56, v38, v39
    s_nop 1
    v_add_f32_dpp v56, v56, v56 row_ror:8 row_mask:0xf bank_mask:0xf
    s_nop 1
    v_add_f32_dpp v56, v56, v56 row_ror:4 row_mask:0xf bank_mask:0xf
    s_nop 1
    v_add_f32_dpp v56, v56, v56 row_ror:2 row_mask:0xf bank_mask:0xf
    s_nop 1
    v_add_f32_dpp v56, v56, v56 row_ror:1 row_mask:0xf bank_mask:0xf
    v_mov_b32 v57, v56
    s_nop 1
    v_permlane16_swap_b32 v56, v57
    v_add_f32 v56, v56, v57
    v_mul_f32 v56, 0x3ae38e39, v56
    v_pk_add_f32 v[20:21], v[20:21], v[56:57] op_sel_hi:[1,0] neg_lo:[0,1] neg_hi:[0,1]
    v_pk_add_f32 v[22:23], v[22:23], v[56:57] op_sel_hi:[1,0] neg_lo:[0,1] neg_hi:[0,1]
    v_pk_add_f32 v[24:25], v[24:25], v[56:57] op_sel_hi:[1,0] neg_lo:[0,1] neg_hi:[0,1]
    v_pk_add_f32 v[26:27], v[26:27], v[56:57] op_sel_hi:[1,0] neg_lo:[0,1] neg_hi:[0,1]
    v_pk_add_f32 v[28:29], v[28:29], v[56:57] op_sel_hi:[1,0] neg_lo:[0,1] neg_hi:[0,1]
    v_pk_add_f32 v[30:31], v[30:31], v[56:57] op_sel_hi:[1,0] neg_lo:[0,1] neg_hi:[0,1]
    v_pk_add_f32 v[32:33], v[32:33], v[56:57] op_sel_hi:[1,0] neg_lo:[0,1] neg_hi:[0,1]
    v_pk_add_f32 v[34:35], v[34:35], v[56:57] op_sel_hi:[1,0] neg_lo:[0,1] neg_hi:[0,1]
    v_pk_add_f32 v[36:37], v[36:37], v[56:57] op_sel_hi:[1,0] neg_lo:[0,1] neg_hi:[0,1]
    v_pk_mul_f32 v[38:39], v[20:21], v[20:21]
    v_pk_mul_f32 v[40:41], v[22:23], v[22:23]
    v_pk_fma_f32 v[38:39], v[24:25], v[24:25], v[38:39]
    v_pk_fma_f32 v[40:41], v[26:27], v[26:27], v[40:41]
    v_pk_fma_f32 v[38:39], v[28:29], v[28:29], v[38:39]
    v_pk_fma_f32 v[40:41], v[30:31], v[30:31], v[40:41]
    v_pk_fma_f32 v[38:39], v[32:33], v[32:33], v[38:39]
    v_pk_fma_f32 v[40:41], v[34:35], v[34:35], v[40:41]
    v_pk_fma_f32 v[38:39], v[36:37], v[36:37], v[38:39]
    v_pk_add_f32 v[38:39], v[38:39], v[40:41]
    v_add_f32 v18, v38, v39
    s_nop 1
    v_add_f32_dpp v18, v18, v18 row_ror:8 row_mask:0xf bank_mask:0xf
    s_nop 1
    v_add_f32_dpp v18, v18, v18 row_ror:4 row_mask:0xf bank_mask:0xf
    s_nop 1
    v_add_f32_dpp v18, v18, v18 row_ror:2 row_mask:0xf bank_mask:0xf
    s_nop 1
    v_add_f32_dpp v18, v18, v18 row_ror:1 row_mask:0xf bank_mask:0xf
    v_mov_b32 v19, v18
    s_nop 1
    v_permlane16_swap_b32 v18, v19
    v_add_f32 v18, v18, v19
    v_mul_f32 v18, 0x3ae38e39, v18
    v_cvt_pk_bf16_f32 v38, v56, v18
    v_lshlrev_b32 v106, 16, v38
    v_and_b32 v38, 0xffff0000, v38
    v_add_f32 v38, 0x3727c5ac, v38
    v_sub_f32 v56, v56, v106
    v_cvt_pk_bf16_f32 v38, v38, v38
    v_lshlrev_b32 v38, 16, v38
    v_sqrt_f32 v38, v38
    s_nop 0
    v_cvt_pk_bf16_f32 v38, v38, v38
    v_lshlrev_b32 v38, 16, v38
    v_rcp_f32 v107, v38
    s_nop 0
    v_mul_f32 v56, v56, v107
    v_mul_f32 v18, v18, v107
    v_mul_f32 v18, v18, v107
    v_cvt_pk_bf16_f32 v38, v56, v18
    v_lshlrev_b32 v39, 16, v38
    v_and_b32 v38, 0xffff0000, v38
    v_add_f32 v38, 0x3727c5ac, v38
    v_sub_f32 v56, v56, v39
    v_cvt_pk_bf16_f32 v38, v38, v38
    v_lshlrev_b32 v38, 16, v38
    v_sqrt_f32 v38, v38
    s_nop 0
    v_cvt_pk_bf16_f32 v38, v38, v38
    v_lshlrev_b32 v38, 16, v38
    v_rcp_f32 v38, v38
    s_nop 0
    v_mul_f32 v18, v107, v38
    v_mul_f32 v56, v56, v38
    v_pk_fma_f32 v[20:21], v[20:21], v[18:19], v[56:57] op_sel_hi:[1,0,0]
    v_pk_fma_f32 v[22:23], v[22:23], v[18:19], v[56:57] op_sel_hi:[1,0,0]
    v_pk_fma_f32 v[24:25], v[24:25], v[18:19], v[56:57] op_sel_hi:[1,0,0]
    v_pk_fma_f32 v[26:27], v[26:27], v[18:19], v[56:57] op_sel_hi:[1,0,0]
    v_pk_fma_f32 v[28:29], v[28:29], v[18:19], v[56:57] op_sel_hi:[1,0,0]
    v_pk_fma_f32 v[30:31], v[30:31], v[18:19], v[56:57] op_sel_hi:[1,0,0]
    v_pk_fma_f32 v[32:33], v[32:33], v[18:19], v[56:57] op_sel_hi:[1,0,0]
    v_pk_fma_f32 v[34:35], v[34:35], v[18:19], v[56:57] op_sel_hi:[1,0,0]
    v_pk_fma_f32 v[36:37], v[36:37], v[18:19], v[56:57] op_sel_hi:[1,0,0]
    v_cvt_pk_bf16_f32 v8, v20, v21
    v_cvt_pk_bf16_f32 v9, v22, v23
    v_cvt_pk_bf16_f32 v10, v24, v25
    v_cvt_pk_bf16_f32 v11, v26, v27
    v_cvt_pk_bf16_f32 v12, v28, v29
    v_cvt_pk_bf16_f32 v13, v30, v31
    v_cvt_pk_bf16_f32 v14, v32, v33
    v_cvt_pk_bf16_f32 v15, v34, v35
    v_cvt_pk_bf16_f32 v16, v36, v37
    v_lshrrev_b32 v3, 5, v0
    v_and_b32 v1, 31, v0
    v_mul_u32_u24 v17, 1216, v3
    v_mad_u32_u24 v17, v1, 12, v17
    v_add_u32 v17, 144896, v17
    ds_write_b32 v17, v8 offset:0
    ds_write_b32 v17, v9 offset:4
    ds_write_b32 v17, v10 offset:8
    ds_write_b32 v17, v11 offset:384
    ds_write_b32 v17, v12 offset:388
    ds_write_b32 v17, v13 offset:392
    ds_write_b32 v17, v14 offset:768
    ds_write_b32 v17, v15 offset:772
    ds_write_b32 v17, v16 offset:776
    v_lshlrev_b32 v3, 3, v3
    s_lshl_b32 s5, s68, 6
    s_add_u32 s5, s5, 12386304
    v_cmp_eq_u32 vcc, 0, v1
    v_mov_b32 v18, 0x40000000
    s_nop 0
    v_cndmask_b32 v3, v18, v3, vcc
    buffer_store_dwordx2 v[106:107], v3, s[44:47], s5 offen sc1
    v_lshrrev_b32 v19, 4, v0
    v_and_b32 v17, 3, v2
    v_lshlrev_b32 v17, 3, v17
    v_lshl_add_u32 v19, v19, 5, v17
    v_bfe_u32 v6, v2, 2, 2
    v_mul_u32_u24 v17, 1216, v6
    v_mul_u32_u24 v6, 1152, v6
    v_add3_u32 v17, v17, v19, s9
    v_add3_u32 v6, v6, v19, s11
    v_lshlrev_b32 v19, 4, v0
    s_add_u32 s7, s15, 4096
    s_add_u32 s8, s15, 8192
    s_cmp_eq_u32 s3, 0
    s_cselect_b32 s8, s8, 0x40000000
    v_add_u32 v18, 2359296, v19
    v_mov_b32 v44, 0
    s_waitcnt lgkmcnt(0)
    s_barrier
    ds_read_b64_tr_b16 v[20:21], v17 offset:0
    ds_read_b64_tr_b16 v[22:23], v17 offset:4864
    ds_read_b64_tr_b16 v[24:25], v17 offset:512
    ds_read_b64_tr_b16 v[26:27], v17 offset:5376
    ds_read_b64_tr_b16 v[28:29], v17 offset:1024
    ds_read_b64_tr_b16 v[30:31], v17 offset:5888
    s_bfe_u32 s6, s68, 0x20001
    s_lshl_b32 s6, s6, 6
    s_lshr_b32 s9, s68, 3
    s_lshl_b32 s9, s9, 1
    s_add_u32 s6, s6, s9
    s_and_b32 s9, s68, 1
    s_add_u32 s6, s6, s9
    s_lshr_b32 s4, s6, 2
    s_lshl_b32 s4, s4, 7
    s_and_b32 s5, s6, 3
    s_lshl2_add_u32 s4, s5, s4
    s_add_u32 s4, s4, 12533760
    v_min_u32 v1, 1, v0
    v_lshlrev_b32 v1, 30, v1
    v_add_u32 v1, s4, v1
    s_waitcnt lgkmcnt(4)
    buffer_store_dwordx4 v[20:23], v19, s[44:47], s15 offen sc1
    s_waitcnt lgkmcnt(2)
    buffer_store_dwordx4 v[24:27], v19, s[44:47], s7 offen sc1
    s_waitcnt lgkmcnt(0)
    buffer_store_dwordx4 v[28:31], v19, s[44:47], s8 offen sc1
    buffer_load_dword v45, v44, s[64:67], 0 offen sc1
    s_waitcnt vmcnt(6)
    s_barrier
    ds_read_b64_tr_b16 v[60:61], v6 offset:0
    ds_read_b64_tr_b16 v[62:63], v6 offset:4608
    ds_read_b64_tr_b16 v[64:65], v6 offset:9216
    ds_read_b64_tr_b16 v[66:67], v6 offset:12672
    ds_read_b64_tr_b16 v[68:69], v6 offset:17280
    ds_read_b64_tr_b16 v[70:71], v6 offset:512
    ds_read_b64_tr_b16 v[72:73], v6 offset:5120
    ds_read_b64_tr_b16 v[74:75], v6 offset:9728
    ds_read_b64_tr_b16 v[76:77], v6 offset:13184
    ds_read_b64_tr_b16 v[78:79], v6 offset:17792
    v_alignbit_b32 v114, v99, v99, 16
    v_alignbit_b32 v115, v98, v98, 16
    s_waitcnt lgkmcnt(5)
    v_alignbit_b32 v108, v61, v60, 16
    v_alignbit_b32 v109, v62, v61, 16
    v_alignbit_b32 v110, v63, v62, 16
    v_alignbit_b32 v111, v64, v63, 16
    v_alignbit_b32 v112, v65, v64, 16
    v_dot2_f32_bf16 v116, v60, v114, 0
    ds_read_b64_tr_b16 v[80:81], v6 offset:1024
    v_dot2_f32_bf16 v117, v108, v114, 0
    v_dot2_f32_bf16 v118, v61, v114, 0
    v_dot2_f32_bf16 v119, v109, v114, 0
    v_dot2_f32_bf16 v120, v62, v114, 0
    ds_read_b64_tr_b16 v[82:83], v6 offset:5632
    v_dot2_f32_bf16 v121, v110, v114, 0
    v_dot2_f32_bf16 v122, v63, v114, 0
    v_dot2_f32_bf16 v123, v111, v114, 0
    v_dot2_f32_bf16 v116, v61, v115, v116
    v_dot2_f32_bf16 v117, v109, v115, v117
    ds_read_b64_tr_b16 v[84:85], v6 offset:10240
    v_dot2_f32_bf16 v118, v62, v115, v118
    v_dot2_f32_bf16 v119, v110, v115, v119
    v_dot2_f32_bf16 v120, v63, v115, v120
    v_dot2_f32_bf16 v121, v111, v115, v121
    v_dot2_f32_bf16 v122, v64, v115, v122
    ds_read_b64_tr_b16 v[86:87], v6 offset:13696
    v_dot2_f32_bf16 v123, v112, v115, v123
    v_and_b32 v133, 0xffff0000, v66
    v_lshlrev_b32 v132, 16, v66
    v_and_b32 v135, 0xffff0000, v67
    v_lshlrev_b32 v134, 16, v67
    ds_read_b64_tr_b16 v[88:89], v6 offset:18304
    v_and_b32 v137, 0xffff0000, v68
    v_lshlrev_b32 v136, 16, v68
    v_and_b32 v139, 0xffff0000, v69
    v_lshlrev_b32 v138, 16, v69
    v_pk_mul_f32 v[116:117], v[116:117], v[132:133]
    v_pk_mul_f32 v[118:119], v[118:119], v[134:135]
    v_pk_mul_f32 v[120:121], v[120:121], v[136:137]
    v_pk_mul_f32 v[122:123], v[122:123], v[138:139]
    v_cvt_pk_bf16_f32 v160, v123, v122
    v_cvt_pk_bf16_f32 v161, v121, v120
    v_cvt_pk_bf16_f32 v162, v119, v118
    v_cvt_pk_bf16_f32 v163, v117, v116
    buffer_store_dwordx4 v[160:163], v18, s[44:47], s15 offen sc1
    v_alignbit_b32 v114, v101, v101, 16
    v_alignbit_b32 v115, v100, v100, 16
    s_waitcnt lgkmcnt(5)
    v_alignbit_b32 v108, v71, v70, 16
    v_alignbit_b32 v109, v72, v71, 16
    v_alignbit_b32 v110, v73, v72, 16
    v_alignbit_b32 v111, v74, v73, 16
    v_alignbit_b32 v112, v75, v74, 16
    v_dot2_f32_bf16 v124, v70, v114, 0
    v_dot2_f32_bf16 v125, v108, v114, 0
    v_dot2_f32_bf16 v126, v71, v114, 0
    v_dot2_f32_bf16 v127, v109, v114, 0
    v_dot2_f32_bf16 v128, v72, v114, 0
    v_dot2_f32_bf16 v129, v110, v114, 0
    v_dot2_f32_bf16 v130, v73, v114, 0
    v_dot2_f32_bf16 v131, v111, v114, 0
    v_dot2_f32_bf16 v124, v71, v115, v124
    v_dot2_f32_bf16 v125, v109, v115, v125
    v_dot2_f32_bf16 v126, v72, v115, v126
    v_dot2_f32_bf16 v127, v110, v115, v127
    v_dot2_f32_bf16 v128, v73, v115, v128
    v_dot2_f32_bf16 v129, v111, v115, v129
    v_dot2_f32_bf16 v130, v74, v115, v130
    v_dot2_f32_bf16 v131, v112, v115, v131
    v_and_b32 v133, 0xffff0000, v76
    v_lshlrev_b32 v132, 16, v76
    v_and_b32 v135, 0xffff0000, v77
    v_lshlrev_b32 v134, 16, v77
    v_and_b32 v137, 0xffff0000, v78
    v_lshlrev_b32 v136, 16, v78
    v_and_b32 v139, 0xffff0000, v79
    v_lshlrev_b32 v138, 16, v79
    v_pk_mul_f32 v[124:125], v[124:125], v[132:133]
    v_pk_mul_f32 v[126:127], v[126:127], v[134:135]
    v_pk_mul_f32 v[128:129], v[128:129], v[136:137]
    v_pk_mul_f32 v[130:131], v[130:131], v[138:139]
    v_cvt_pk_bf16_f32 v164, v131, v130
    v_cvt_pk_bf16_f32 v165, v129, v128
    v_cvt_pk_bf16_f32 v166, v127, v126
    v_cvt_pk_bf16_f32 v167, v125, v124
    buffer_store_dwordx4 v[164:167], v18, s[44:47], s7 offen sc1
    v_alignbit_b32 v114, v103, v103, 16
    v_alignbit_b32 v115, v102, v102, 16
    s_waitcnt lgkmcnt(0)
    v_alignbit_b32 v108, v81, v80, 16
    v_alignbit_b32 v109, v82, v81, 16
    v_alignbit_b32 v110, v83, v82, 16
    v_alignbit_b32 v111, v84, v83, 16
    v_alignbit_b32 v112, v85, v84, 16
    v_dot2_f32_bf16 v116, v80, v114, 0
    v_dot2_f32_bf16 v117, v108, v114, 0
    v_dot2_f32_bf16 v118, v81, v114, 0
    v_dot2_f32_bf16 v119, v109, v114, 0
    v_dot2_f32_bf16 v120, v82, v114, 0
    v_dot2_f32_bf16 v121, v110, v114, 0
    v_dot2_f32_bf16 v122, v83, v114, 0
    v_dot2_f32_bf16 v123, v111, v114, 0
    v_dot2_f32_bf16 v116, v81, v115, v116
    v_dot2_f32_bf16 v117, v109, v115, v117
    v_dot2_f32_bf16 v118, v82, v115, v118
    v_dot2_f32_bf16 v119, v110, v115, v119
    v_dot2_f32_bf16 v120, v83, v115, v120
    v_dot2_f32_bf16 v121, v111, v115, v121
    v_dot2_f32_bf16 v122, v84, v115, v122
    v_dot2_f32_bf16 v123, v112, v115, v123
    v_and_b32 v133, 0xffff0000, v86
    v_lshlrev_b32 v132, 16, v86
    v_and_b32 v135, 0xffff0000, v87
    v_lshlrev_b32 v134, 16, v87
    v_and_b32 v137, 0xffff0000, v88
    v_lshlrev_b32 v136, 16, v88
    v_and_b32 v139, 0xffff0000, v89
    v_lshlrev_b32 v138, 16, v89
    v_pk_mul_f32 v[116:117], v[116:117], v[132:133]
    v_pk_mul_f32 v[118:119], v[118:119], v[134:135]
    v_pk_mul_f32 v[120:121], v[120:121], v[136:137]
    v_pk_mul_f32 v[122:123], v[122:123], v[138:139]
    v_cvt_pk_bf16_f32 v168, v123, v122
    v_cvt_pk_bf16_f32 v169, v121, v120
    v_cvt_pk_bf16_f32 v170, v119, v118
    v_cvt_pk_bf16_f32 v171, v117, v116
    buffer_store_dwordx4 v[168:171], v18, s[44:47], s8 offen sc1
    s_mov_b64 exec, 0
    s_call_b64 s[82:83], L_wc_X
    s_mov_b64 exec, -1
    s_waitcnt vmcnt(3)
    v_readfirstlane_b32 s68, v45
    s_nop 1
    s_cmp_eq_u32 s68, 0
    s_cbranch_scc1 L_nw_X
L_ng_X:
    s_barrier
    v_mov_b32 v3, s68
    buffer_store_dword v3, v1, s[44:47], 0 offen sc1
    v_add_u32 v1, 65536, v1
    s_waitcnt vmcnt(1)
    s_barrier
    buffer_store_dword v3, v1, s[44:47], 0 offen sc1
    s_mov_b64 exec, 0
    s_call_b64 s[82:83], L_wc_D
    s_mov_b64 exec, -1
L_segX:
L_pl_X_0:
    s_cbranch_execz L_pl_X_4
    s_add_u32 m0, s74, 32
    s_add_u32 s13, s12, 0
    buffer_load_dwordx4 v240, s[48:51], s13 offen offset:0 lds
    buffer_load_dwordx4 v240, s[48:51], s13 offen offset:1024 lds
    buffer_load_dwordx4 v240, s[48:51], s13 offen offset:2048 lds
    buffer_load_dwordx4 v240, s[48:51], s13 offen offset:3072 lds
    s_mov_b32 s60, s36
    s_and_b32 s61, s37, 0xffff
    s_mov_b32 s62, 4096
    s_mov_b32 s63, 0x20000
    v_and_b32 v24, 15, v2
    s_lshl_b32 s7, s71, 6
    v_add_u32 v24, s7, v24
    s_and_b32 s8, s3, 1
    s_lshl_b32 s4, s8, 5
    v_add_u32 v25, s4, v24
    v_lshlrev_b32 v26, 3, v25
    v_mul_u32_u24 v25, 1152, v25
    v_bfe_u32 v31, v2, 4, 1
    v_lshl_add_u32 v25, v31, 5, v25
    v_lshrrev_b32 v31, 5, v2
    v_lshl_add_u32 v25, v31, 4, v25
    s_bfe_u32 s7, s2, 0x20003
    s_mul_i32 s7, s7, 288
    s_lshl_b32 s4, s72, 6
    s_add_u32 s4, s4, s7
    v_add_u32 v252, s4, v25
    s_xor_b32 s8, s3, s72
    s_and_b32 s4, s72, 1
    s_lshl1_add_u32 s4, s4, s8
    v_lshl_add_u32 v24, s4, 4, v24
    s_add_u32 s7, s7, 256
    s_cmp_lt_u32 s8, 2
    s_cselect_b32 s7, s7, 0x40000000
    v_lshlrev_b32 v18, 3, v24
    v_mul_u32_u24 v24, 1152, v24
    v_lshrrev_b32 v31, 4, v2
    v_lshl_add_u32 v24, v31, 3, v24
    v_add_u32 v253, s7, v24
    v_lshrrev_b32 v24, 3, v2
    v_and_b32 v25, 7, v2
    v_bfe_u32 v31, v2, 4, 2
    v_lshlrev_b32 v31, 1, v31
    v_xor_b32 v25, v25, v31
    v_lshlrev_b32 v24, 12, v24
    v_lshl_add_u32 v24, v25, 4, v24
    s_mul_i32 s7, s72, 36
    s_bitcmp1_b32 s3, 0
    s_addc_u32 s7, s7, 0
    s_lshl_b32 s7, s7, 17
    s_lshl_b32 s8, s71, 7
    s_add_u32 s7, s7, s8
    v_add_u32 v4, s7, v24
    v_add_u32 v5, 31744, v4
    v_add_u32 v6, 31744, v5
    v_add_u32 v7, 31744, v6
    v_lshrrev_b32 v24, 2, v2
    v_lshlrev_b32 v24, 7, v24
    v_and_b32 v25, 3, v2
    v_lshl_add_u32 v24, v25, 3, v24
    s_and_b32 s7, s73, 8192
    v_add_u32 v24, s7, v24
    v_bfe_u32 v31, v2, 3, 2
    s_and_b32 s7, s3, 1
    s_lshl_b32 s7, s7, 1
    v_xor_b32 v31, s7, v31
    v_lshl_add_u32 v10, v31, 5, v24
    v_xor_b32 v11, 32, v10
    v_and_b32 v24, 15, v2
    v_lshrrev_b32 v25, 4, v2
    v_mul_u32_u24 v25, 17408, v25
    v_lshl_add_u32 v24, v24, 4, v25
    s_mul_i32 s7, s72, 36
    s_and_b32 s8, s3, 1
    s_add_u32 s7, s7, s8
    s_mul_i32 s7, s7, 69632
    s_bfe_u32 s8, s2, 0x20003
    s_lshl_b32 s8, s8, 12
    s_add_u32 s7, s7, s8
    s_add_u32 s7, s7, 12795904
    v_add_u32 v23, s7, v24
    s_xor_b32 s7, s72, 0
    v_lshl_add_u32 v19, s7, 10, v23
    s_xor_b32 s7, s72, 1
    v_lshl_add_u32 v20, s7, 10, v23
    s_xor_b32 s7, s72, 2
    v_lshl_add_u32 v21, s7, 10, v23
    s_xor_b32 s7, s72, 3
    v_lshl_add_u32 v22, s7, 10, v23
    v_lshlrev_b32 v14, 4, v2
    v_add_u32 v14, 98304, v14
    v_add_u32 v1, 0x10000, v14
    s_cmp_lt_u32 s75, 252
    s_cbranch_scc0 L_idle
    s_mov_b32 s56, s26
    s_and_b32 s57, s27, 0xffff
    s_mov_b32 s58, 1152
    s_mov_b32 s59, 0x20000
    s_bitcmp1_b32 s3, 1
    s_cselect_b32 s18, s85, s84
    s_mul_i32 s18, s18, 139264
    s_cselect_b32 s19, s87, s86
    s_mul_i32 s19, s19, 139264
    s_cselect_b32 s20, s89, s88
    s_mul_i32 s20, s20, 139264
    s_cselect_b32 s21, s91, s90
    s_mul_i32 s21, s21, 139264
    s_cselect_b32 s22, s93, s92
    s_mul_i32 s22, s22, 139264
    s_cselect_b32 s23, s95, s94
    s_mul_i32 s23, s23, 139264
    s_cselect_b32 s24, s97, s96
    s_mul_i32 s24, s24, 139264
    s_cselect_b32 s25, s99, s98
    s_mul_i32 s25, s25, 139264
    s_cselect_b32 s26, s101, s100
    s_mul_i32 s26, s26, 139264
    v_mov_b32 v9, 0
    buffer_load_ushort v9, v9, s[56:59], s70 offen
    s_lshl_b32 s4, s3, 6
    v_min_u32 v28, 63, v2
    v_add_u32 v28, s4, v28
    v_and_b32 v29, 3, v28
    v_lshrrev_b32 v28, 2, v28
    v_lshlrev_b32 v28, 7, v28
    v_lshl_add_u32 v28, v29, 2, v28
    v_add_u32 v28, 12599296, v28
    v_add_u32 v241, s74, v240
    v_cmp_eq_u32 vcc, 0, v2
    v_mov_b32 v196, 4136
    s_nop 0
    v_cndmask_b32 v196, v196, 30, vcc
    v_add_u32 v242, s74, v196
    v_bfe_u32 v196, v2, 3, 2
    v_mul_u32_u24 v196, 4160, v196
    v_and_b32 v197, 7, v2
    v_lshl_add_u32 v196, v197, 2, v196
    v_add_u32 v200, s74, v196
    v_mov_b32 v196, 0
    v_mov_b32 v197, 0
    v_mov_b32 v198, 0
    v_mov_b32 v199, 0
    ds_write_b32 v200, v196
    v_lshlrev_b32 v201, 4, v0
    ds_write_b128 v201, v[196:199]
    ds_write_b128 v201, v[196:199] offset:36864
    s_waitcnt vmcnt(1)
    ds_read_b128 v[212:215], v241 offset:32
    ds_read_b32 v216, v241 offset:48
    ds_read_b128 v[218:221], v241 offset:1056
    ds_read_b32 v222, v241 offset:1072
    ds_read_b128 v[224:227], v241 offset:2080
    ds_read_b32 v228, v241 offset:2096
    ds_read_b128 v[230:233], v241 offset:3104
    ds_read_b32 v234, v241 offset:3120
    v_lshrrev_b32 v202, 3, v2
    v_and_b32 v203, 7, v2
    v_lshrrev_b32 v204, 1, v202
    v_xor_b32 v203, v203, v204
    v_mul_u32_u24 v202, 9216, v202
    v_lshl_add_u32 v24, v203, 4, v202
    v_xor_b32 v25, 64, v24
    v_and_b32 v202, 15, v2
    v_add_u32 v202, 1, v202
    v_and_b32 v203, 1, v202
    v_mul_u32_u24 v203, 4160, v203
    v_lshrrev_b32 v202, 1, v202
    v_lshl_add_u32 v203, v202, 2, v203
    v_lshrrev_b32 v204, 4, v2
    v_lshl_add_u32 v203, v204, 4, v203
    v_add_u32 v236, s74, v203
    v_add_u32 v237, 1024, v236
    v_add_u32 v238, 1024, v237
    v_add_u32 v239, 1024, v238
    s_waitcnt lgkmcnt(0)
    s_waitcnt vmcnt(0)
    v_lshlrev_b32 v9, 16, v9
    v_lshlrev_b32 v208, 16, v212
    v_add_f32 v9, v9, v208
    v_cvt_pk_bf16_f32 v9, v9, v9
    ds_write_b16 v242, v9 offset:4160
    ds_write_b16 v242, v9 offset:2
    v_alignbit_b32 v212, v213, v212, 16
    v_alignbit_b32 v213, v214, v213, 16
    v_alignbit_b32 v214, v215, v214, 16
    v_alignbit_b32 v215, v216, v215, 16
    ds_write_b128 v241, v[212:215] offset:4192
    v_alignbit_b32 v218, v219, v218, 16
    v_alignbit_b32 v219, v220, v219, 16
    v_alignbit_b32 v220, v221, v220, 16
    v_alignbit_b32 v221, v222, v221, 16
    ds_write_b128 v241, v[218:221] offset:5216
    v_alignbit_b32 v224, v225, v224, 16
    v_alignbit_b32 v225, v226, v225, 16
    v_alignbit_b32 v226, v227, v226, 16
    v_alignbit_b32 v227, v228, v227, 16
    ds_write_b128 v241, v[224:227] offset:6240
    v_alignbit_b32 v230, v231, v230, 16
    v_alignbit_b32 v231, v232, v231, 16
    v_alignbit_b32 v232, v233, v232, 16
    v_alignbit_b32 v233, v234, v233, 16
    ds_write_b128 v241, v[230:233] offset:7264
    v_and_b32 v202, 15, v2
    v_lshlrev_b32 v202, 1, v202
    v_sub_u32 v202, v202, v204
    v_add_u32 v202, 17, v202
    v_bfe_u32 v203, v202, 1, 3
    v_xor_b32 v203, s3, v203
    v_lshlrev_b32 v203, 4, v203
    v_lshl_add_u32 v244, v202, 7, v203
    v_and_b32 v202, 15, v2
    v_lshlrev_b32 v202, 1, v202
    v_sub_u32 v202, v202, v204
    v_add_u32 v202, 13, v202
    v_bfe_u32 v203, v202, 1, 3
    v_xor_b32 v203, s3, v203
    v_lshlrev_b32 v203, 4, v203
    v_lshl_add_u32 v245, v202, 7, v203
    v_and_b32 v202, 15, v2
    v_lshlrev_b32 v202, 1, v202
    v_sub_u32 v202, v202, v204
    v_add_u32 v202, 9, v202
    v_bfe_u32 v203, v202, 1, 3
    v_xor_b32 v203, s3, v203
    v_lshlrev_b32 v203, 4, v203
    v_lshl_add_u32 v246, v202, 7, v203
    v_and_b32 v202, 15, v2
    v_lshlrev_b32 v202, 1, v202
    v_sub_u32 v202, v202, v204
    v_add_u32 v202, 5, v202
    v_bfe_u32 v203, v202, 1, 3
    v_xor_b32 v203, s3, v203
    v_lshlrev_b32 v203, 4, v203
    v_lshl_add_u32 v247, v202, 7, v203
    v_and_b32 v202, 15, v2
    v_lshlrev_b32 v202, 5, v202
    v_lshl_add_u32 v8, v204, 3, v202
    s_mul_i32 s7, s3, 589824
    s_lshl_b32 s8, s69, 8
L_pl_X_1:
    s_cbranch_execz L_pl_X_5
    s_add_u32 s7, s7, s8
    s_add_u32 s7, s7, 2359296
    s_lshl_b32 s9, s3, 13
    s_add_u32 s9, s9, 4096
    ds_read2_b32 v[64:65], v236 offset0:0 offset1:1
    ds_read2_b32 v[66:67], v236 offset0:2 offset1:3
    ds_read2_b32 v[68:69], v236 offset0:128 offset1:129
    ds_read2_b32 v[70:71], v236 offset0:130 offset1:131
    ds_read2_b32 v[72:73], v237 offset0:0 offset1:1
    ds_read2_b32 v[74:75], v237 offset0:2 offset1:3
    ds_read2_b32 v[76:77], v237 offset0:128 offset1:129
    ds_read2_b32 v[78:79], v237 offset0:130 offset1:131
    ds_read2_b32 v[80:81], v238 offset0:0 offset1:1
    ds_read2_b32 v[82:83], v238 offset0:2 offset1:3
    ds_read2_b32 v[84:85], v238 offset0:128 offset1:129
    ds_read2_b32 v[86:87], v238 offset0:130 offset1:131
    ds_read2_b32 v[88:89], v239 offset0:0 offset1:1
    ds_read2_b32 v[90:91], v239 offset0:2 offset1:3
    ds_read2_b32 v[92:93], v239 offset0:128 offset1:129
    ds_read2_b32 v[94:95], v239 offset0:130 offset1:131
    buffer_load_dword v29, v28, s[44:47], 0 offen sc1
    v_add_u32 v10, 131072, v10
    v_add_u32 v11, 131072, v11
    s_waitcnt vmcnt(0)
    v_cmp_ne_u32 vcc, s68, v29
    s_cbranch_vccnz L_rs_p1X
L_ok_p1X:
    s_barrier
    s_add_u32 m0, s9, 0
    s_add_u32 s13, s7, 0
    buffer_load_dwordx4 v24, s[44:47], s13 offen sc1 lds
    s_add_u32 m0, s9, 1024
    s_add_u32 s13, s7, 73728
    buffer_load_dwordx4 v25, s[44:47], s13 offen sc1 lds
    s_add_u32 m0, s9, 2048
    s_add_u32 s13, s7, 147456
    buffer_load_dwordx4 v24, s[44:47], s13 offen sc1 lds
    s_add_u32 m0, s9, 3072
    s_add_u32 s13, s7, 221184
    buffer_load_dwordx4 v25, s[44:47], s13 offen sc1 lds
    s_add_u32 m0, s9, 4096
    s_add_u32 s13, s7, 294912
    buffer_load_dwordx4 v24, s[44:47], s13 offen sc1 lds
    s_add_u32 m0, s9, 5120
    s_add_u32 s13, s7, 368640
    buffer_load_dwordx4 v25, s[44:47], s13 offen sc1 lds
    s_add_u32 m0, s9, 6144
    s_add_u32 s13, s7, 442368
    buffer_load_dwordx4 v24, s[44:47], s13 offen sc1 lds
    s_add_u32 m0, s9, 7168
    s_add_u32 s13, s7, 516096
    buffer_load_dwordx4 v25, s[44:47], s13 offen sc1 lds
    s_waitcnt vmcnt(0) lgkmcnt(0)
    s_barrier
    ds_read_b128 v[96:99], v244 offset:2048
    ds_read_b128 v[100:103], v244 offset:6144
    ds_read_b128 v[104:107], v244 offset:10240
    ds_read_b128 v[108:111], v244 offset:14336
    ds_read_b128 v[112:115], v244 offset:18432
    ds_read_b128 v[116:119], v244 offset:22528
    ds_read_b128 v[120:123], v244 offset:26624
    ds_read_b128 v[124:127], v244 offset:30720
    s_waitcnt lgkmcnt(0)
    v_mfma_f32_16x16x32_bf16 v[32:35], v[64:67], v[96:99], 0
    s_lshl_b32 s14, s84, 18
    ds_read_b128 v[160:163], v245 offset:2048
    v_mfma_f32_16x16x32_bf16 v[36:39], v[68:71], v[96:99], 0
    s_add_u32 m0, s73, 147456
    v_mfma_f32_16x16x32_bf16 v[36:39], v[64:67], v[100:103], v[36:39]
    buffer_load_dwordx4 v4, s[52:55], s14 offen offset:0 lds
    ds_read2_b32 v[128:129], v236 offset0:16 offset1:17
    v_mfma_f32_16x16x32_bf16 v[40:43], v[64:67], v[104:107], 0
    ds_read2_b32 v[130:131], v236 offset0:18 offset1:19
    v_mfma_f32_16x16x32_bf16 v[40:43], v[68:71], v[100:103], v[40:43]
    v_mfma_f32_16x16x32_bf16 v[40:43], v[72:75], v[96:99], v[40:43]
    ds_read_b128 v[164:167], v245 offset:6144
    v_mfma_f32_16x16x32_bf16 v[44:47], v[76:79], v[96:99], 0
    ds_read2_b32 v[132:133], v236 offset0:144 offset1:145
    v_mfma_f32_16x16x32_bf16 v[44:47], v[72:75], v[100:103], v[44:47]
    v_mfma_f32_16x16x32_bf16 v[44:47], v[68:71], v[104:107], v[44:47]
    ds_read2_b32 v[134:135], v236 offset0:146 offset1:147
    v_mfma_f32_16x16x32_bf16 v[44:47], v[64:67], v[108:111], v[44:47]
    ds_read_b128 v[168:171], v245 offset:10240
    v_mfma_f32_16x16x32_bf16 v[48:51], v[64:67], v[112:115], 0
    ds_read2_b32 v[136:137], v237 offset0:16 offset1:17
    v_mfma_f32_16x16x32_bf16 v[48:51], v[68:71], v[108:111], v[48:51]
    v_mfma_f32_16x16x32_bf16 v[48:51], v[72:75], v[104:107], v[48:51]
    s_add_u32 m0, s73, 147456
    ds_read2_b32 v[138:139], v237 offset0:18 offset1:19
    v_mfma_f32_16x16x32_bf16 v[48:51], v[76:79], v[100:103], v[48:51]
    buffer_load_dwordx4 v5, s[52:55], s14 offen offset:1024 lds
    ds_read_b128 v[172:175], v245 offset:14336
    v_mfma_f32_16x16x32_bf16 v[48:51], v[80:83], v[96:99], v[48:51]
    v_mfma_f32_16x16x32_bf16 v[52:55], v[84:87], v[96:99], 0
    ds_read2_b32 v[140:141], v237 offset0:144 offset1:145
    v_mfma_f32_16x16x32_bf16 v[52:55], v[80:83], v[100:103], v[52:55]
    ds_read2_b32 v[142:143], v237 offset0:146 offset1:147
    v_mfma_f32_16x16x32_bf16 v[52:55], v[76:79], v[104:107], v[52:55]
    v_mfma_f32_16x16x32_bf16 v[52:55], v[72:75], v[108:111], v[52:55]
    ds_read_b128 v[176:179], v245 offset:18432
    v_mfma_f32_16x16x32_bf16 v[52:55], v[68:71], v[112:115], v[52:55]
    ds_read2_b32 v[144:145], v238 offset0:16 offset1:17
    v_mfma_f32_16x16x32_bf16 v[52:55], v[64:67], v[116:119], v[52:55]
    v_mfma_f32_16x16x32_bf16 v[56:59], v[64:67], v[120:123], 0
    ds_read2_b32 v[146:147], v238 offset0:18 offset1:19
    v_mfma_f32_16x16x32_bf16 v[56:59], v[68:71], v[116:119], v[56:59]
    ds_read_b128 v[180:183], v245 offset:22528
    v_mfma_f32_16x16x32_bf16 v[56:59], v[72:75], v[112:115], v[56:59]
    v_mfma_f32_16x16x32_bf16 v[56:59], v[76:79], v[108:111], v[56:59]
    s_add_u32 m0, s73, 147456
    ds_read2_b32 v[148:149], v238 offset0:144 offset1:145
    v_mfma_f32_16x16x32_bf16 v[56:59], v[80:83], v[104:107], v[56:59]
    buffer_load_dwordx4 v6, s[52:55], s14 offen offset:2048 lds
    ds_read2_b32 v[150:151], v238 offset0:146 offset1:147
    v_mfma_f32_16x16x32_bf16 v[56:59], v[84:87], v[100:103], v[56:59]
    ds_read_b128 v[184:187], v245 offset:26624
    v_mfma_f32_16x16x32_bf16 v[56:59], v[88:91], v[96:99], v[56:59]
    v_mfma_f32_16x16x32_bf16 v[60:63], v[92:95], v[96:99], 0
    ds_read2_b32 v[152:153], v239 offset0:16 offset1:17
    v_mfma_f32_16x16x32_bf16 v[60:63], v[88:91], v[100:103], v[60:63]
    ds_read2_b32 v[154:155], v239 offset0:18 offset1:19
    v_mfma_f32_16x16x32_bf16 v[60:63], v[84:87], v[104:107], v[60:63]
    v_mfma_f32_16x16x32_bf16 v[60:63], v[80:83], v[108:111], v[60:63]
    ds_read_b128 v[188:191], v245 offset:30720
    v_mfma_f32_16x16x32_bf16 v[60:63], v[76:79], v[112:115], v[60:63]
    ds_read2_b32 v[156:157], v239 offset0:144 offset1:145
    v_mfma_f32_16x16x32_bf16 v[60:63], v[72:75], v[116:119], v[60:63]
    v_mfma_f32_16x16x32_bf16 v[60:63], v[68:71], v[120:123], v[60:63]
    ds_read2_b32 v[158:159], v239 offset0:146 offset1:147
    v_mfma_f32_16x16x32_bf16 v[60:63], v[64:67], v[124:127], v[60:63]
    s_waitcnt lgkmcnt(12)
    v_mfma_f32_16x16x32_bf16 v[32:35], v[128:131], v[160:163], v[32:35]
    s_add_u32 m0, s73, 147456
    ds_read_b128 v[96:99], v246 offset:2048
    v_mfma_f32_16x16x32_bf16 v[36:39], v[132:135], v[160:163], v[36:39]
    buffer_load_dwordx4 v7, s[52:55], s14 offen offset:3072 lds
    v_mfma_f32_16x16x32_bf16 v[36:39], v[128:131], v[164:167], v[36:39]
    ds_read2_b32 v[64:65], v236 offset0:32 offset1:33
    v_mfma_f32_16x16x32_bf16 v[40:43], v[128:131], v[168:171], v[40:43]
    s_add_u32 s13, s12, 16384
    ds_read2_b32 v[66:67], v236 offset0:34 offset1:35
    v_mfma_f32_16x16x32_bf16 v[40:43], v[132:135], v[164:167], v[40:43]
    v_mfma_f32_16x16x32_bf16 v[40:43], v[136:139], v[160:163], v[40:43]
    s_add_u32 m0, s74, 8352
    ds_read_b128 v[100:103], v246 offset:6144
    v_mfma_f32_16x16x32_bf16 v[44:47], v[140:143], v[160:163], v[44:47]
    buffer_load_dwordx4 v240, s[48:51], s13 offen offset:0 lds
    ds_read2_b32 v[68:69], v236 offset0:160 offset1:161
    v_mfma_f32_16x16x32_bf16 v[44:47], v[136:139], v[164:167], v[44:47]
    v_mfma_f32_16x16x32_bf16 v[44:47], v[132:135], v[168:171], v[44:47]
    ds_read2_b32 v[70:71], v236 offset0:162 offset1:163
    v_mfma_f32_16x16x32_bf16 v[44:47], v[128:131], v[172:175], v[44:47]
    ds_read_b128 v[104:107], v246 offset:10240
    s_waitcnt lgkmcnt(7)
    v_mfma_f32_16x16x32_bf16 v[48:51], v[128:131], v[176:179], v[48:51]
    ds_read2_b32 v[72:73], v237 offset0:32 offset1:33
    v_mfma_f32_16x16x32_bf16 v[48:51], v[132:135], v[172:175], v[48:51]
    v_mfma_f32_16x16x32_bf16 v[48:51], v[136:139], v[168:171], v[48:51]
    ds_read2_b32 v[74:75], v237 offset0:34 offset1:35
    v_mfma_f32_16x16x32_bf16 v[48:51], v[140:143], v[164:167], v[48:51]
    s_add_u32 m0, s74, 8352
    ds_read_b128 v[108:111], v246 offset:14336
    v_mfma_f32_16x16x32_bf16 v[48:51], v[144:147], v[160:163], v[48:51]
    buffer_load_dwordx4 v240, s[48:51], s13 offen offset:1024 lds
    v_mfma_f32_16x16x32_bf16 v[52:55], v[148:151], v[160:163], v[52:55]
    ds_read2_b32 v[76:77], v237 offset0:160 offset1:161
    v_mfma_f32_16x16x32_bf16 v[52:55], v[144:147], v[164:167], v[52:55]
    ds_read2_b32 v[78:79], v237 offset0:162 offset1:163
    v_mfma_f32_16x16x32_bf16 v[52:55], v[140:143], v[168:171], v[52:55]
    v_mfma_f32_16x16x32_bf16 v[52:55], v[136:139], v[172:175], v[52:55]
    ds_read_b128 v[112:115], v246 offset:18432
    v_mfma_f32_16x16x32_bf16 v[52:55], v[132:135], v[176:179], v[52:55]
    ds_read2_b32 v[80:81], v238 offset0:32 offset1:33
    v_mfma_f32_16x16x32_bf16 v[52:55], v[128:131], v[180:183], v[52:55]
    v_mfma_f32_16x16x32_bf16 v[56:59], v[128:131], v[184:187], v[56:59]
    s_add_u32 m0, s74, 8352
    ds_read2_b32 v[82:83], v238 offset0:34 offset1:35
    v_mfma_f32_16x16x32_bf16 v[56:59], v[132:135], v[180:183], v[56:59]
    buffer_load_dwordx4 v240, s[48:51], s13 offen offset:2048 lds
    ds_read_b128 v[116:119], v246 offset:22528
    v_mfma_f32_16x16x32_bf16 v[56:59], v[136:139], v[176:179], v[56:59]
    v_mfma_f32_16x16x32_bf16 v[56:59], v[140:143], v[172:175], v[56:59]
    ds_read2_b32 v[84:85], v238 offset0:160 offset1:161
    v_mfma_f32_16x16x32_bf16 v[56:59], v[144:147], v[168:171], v[56:59]
    ds_read2_b32 v[86:87], v238 offset0:162 offset1:163
    v_mfma_f32_16x16x32_bf16 v[56:59], v[148:151], v[164:167], v[56:59]
    ds_read_b128 v[120:123], v246 offset:26624
    v_mfma_f32_16x16x32_bf16 v[56:59], v[152:155], v[160:163], v[56:59]
    v_mfma_f32_16x16x32_bf16 v[60:63], v[156:159], v[160:163], v[60:63]
    ds_read2_b32 v[88:89], v239 offset0:32 offset1:33
    v_mfma_f32_16x16x32_bf16 v[60:63], v[152:155], v[164:167], v[60:63]
    s_add_u32 m0, s74, 8352
    ds_read2_b32 v[90:91], v239 offset0:34 offset1:35
    v_mfma_f32_16x16x32_bf16 v[60:63], v[148:151], v[168:171], v[60:63]
    buffer_load_dwordx4 v240, s[48:51], s13 offen offset:3072 lds
    v_mfma_f32_16x16x32_bf16 v[60:63], v[144:147], v[172:175], v[60:63]
    ds_read_b128 v[124:127], v246 offset:30720
    v_mfma_f32_16x16x32_bf16 v[60:63], v[140:143], v[176:179], v[60:63]
    ds_read2_b32 v[92:93], v239 offset0:160 offset1:161
    v_mfma_f32_16x16x32_bf16 v[60:63], v[136:139], v[180:183], v[60:63]
    v_mfma_f32_16x16x32_bf16 v[60:63], v[132:135], v[184:187], v[60:63]
    ds_read2_b32 v[94:95], v239 offset0:162 offset1:163
    v_mfma_f32_16x16x32_bf16 v[60:63], v[128:131], v[188:191], v[60:63]
    s_waitcnt lgkmcnt(12)
    v_mfma_f32_16x16x32_bf16 v[32:35], v[64:67], v[96:99], v[32:35]
    s_lshl_b32 s14, s85, 18
    ds_read_b128 v[160:163], v247 offset:2048
    v_mfma_f32_16x16x32_bf16 v[36:39], v[68:71], v[96:99], v[36:39]
    s_add_u32 m0, s73, 49152
    v_mfma_f32_16x16x32_bf16 v[36:39], v[64:67], v[100:103], v[36:39]
    buffer_load_dwordx4 v4, s[52:55], s14 offen offset:0 lds
    ds_read2_b32 v[128:129], v236 offset0:48 offset1:49
    v_mfma_f32_16x16x32_bf16 v[40:43], v[64:67], v[104:107], v[40:43]
    ds_read2_b32 v[130:131], v236 offset0:50 offset1:51
    v_mfma_f32_16x16x32_bf16 v[40:43], v[68:71], v[100:103], v[40:43]
    v_mfma_f32_16x16x32_bf16 v[40:43], v[72:75], v[96:99], v[40:43]
    ds_read_b128 v[164:167], v247 offset:6144
    v_mfma_f32_16x16x32_bf16 v[44:47], v[76:79], v[96:99], v[44:47]
    ds_read2_b32 v[132:133], v236 offset0:176 offset1:177
    v_mfma_f32_16x16x32_bf16 v[44:47], v[72:75], v[100:103], v[44:47]
    ds_read2_b32 v[134:135], v236 offset0:178 offset1:179
    v_mfma_f32_16x16x32_bf16 v[44:47], v[68:71], v[104:107], v[44:47]
    ds_read_b128 v[168:171], v247 offset:10240
    v_mfma_f32_16x16x32_bf16 v[44:47], v[64:67], v[108:111], v[44:47]
    v_mov_b32 v9, 8
    buffer_load_ushort v9, v9, s[56:59], s70 offen
    s_waitcnt lgkmcnt(7)
    v_mfma_f32_16x16x32_bf16 v[48:51], v[64:67], v[112:115], v[48:51]
    ds_read2_b32 v[136:137], v237 offset0:48 offset1:49
    v_mfma_f32_16x16x32_bf16 v[48:51], v[68:71], v[108:111], v[48:51]
    v_mfma_f32_16x16x32_bf16 v[48:51], v[72:75], v[104:107], v[48:51]
    s_add_u32 m0, s73, 49152
    ds_read2_b32 v[138:139], v237 offset0:50 offset1:51
    v_mfma_f32_16x16x32_bf16 v[48:51], v[76:79], v[100:103], v[48:51]
    buffer_load_dwordx4 v5, s[52:55], s14 offen offset:1024 lds
    ds_read_b128 v[172:175], v247 offset:14336
    v_mfma_f32_16x16x32_bf16 v[48:51], v[80:83], v[96:99], v[48:51]
    v_mfma_f32_16x16x32_bf16 v[52:55], v[84:87], v[96:99], v[52:55]
    ds_read2_b32 v[140:141], v237 offset0:176 offset1:177
    v_mfma_f32_16x16x32_bf16 v[52:55], v[80:83], v[100:103], v[52:55]
    ds_read2_b32 v[142:143], v237 offset0:178 offset1:179
    v_mfma_f32_16x16x32_bf16 v[52:55], v[76:79], v[104:107], v[52:55]
    v_mfma_f32_16x16x32_bf16 v[52:55], v[72:75], v[108:111], v[52:55]
    ds_read_b128 v[176:179], v247 offset:18432
    v_mfma_f32_16x16x32_bf16 v[52:55], v[68:71], v[112:115], v[52:55]
    ds_read2_b32 v[144:145], v238 offset0:48 offset1:49
    v_mfma_f32_16x16x32_bf16 v[52:55], v[64:67], v[116:119], v[52:55]
    v_mfma_f32_16x16x32_bf16 v[56:59], v[64:67], v[120:123], v[56:59]
    ds_read2_b32 v[146:147], v238 offset0:50 offset1:51
    v_mfma_f32_16x16x32_bf16 v[56:59], v[68:71], v[116:119], v[56:59]
    ds_read_b128 v[180:183], v247 offset:22528
    v_mfma_f32_16x16x32_bf16 v[56:59], v[72:75], v[112:115], v[56:59]
    v_mfma_f32_16x16x32_bf16 v[56:59], v[76:79], v[108:111], v[56:59]
    s_add_u32 m0, s73, 49152
    ds_read2_b32 v[148:149], v238 offset0:176 offset1:177
    v_mfma_f32_16x16x32_bf16 v[56:59], v[80:83], v[104:107], v[56:59]
    buffer_load_dwordx4 v6, s[52:55], s14 offen offset:2048 lds
    ds_read2_b32 v[150:151], v238 offset0:178 offset1:179
    v_mfma_f32_16x16x32_bf16 v[56:59], v[84:87], v[100:103], v[56:59]
    ds_read_b128 v[184:187], v247 offset:26624
    v_mfma_f32_16x16x32_bf16 v[56:59], v[88:91], v[96:99], v[56:59]
    v_mfma_f32_16x16x32_bf16 v[60:63], v[92:95], v[96:99], v[60:63]
    ds_read2_b32 v[152:153], v239 offset0:48 offset1:49
    v_mfma_f32_16x16x32_bf16 v[60:63], v[88:91], v[100:103], v[60:63]
    ds_read2_b32 v[154:155], v239 offset0:50 offset1:51
    v_mfma_f32_16x16x32_bf16 v[60:63], v[84:87], v[104:107], v[60:63]
    v_mfma_f32_16x16x32_bf16 v[60:63], v[80:83], v[108:111], v[60:63]
    ds_read_b128 v[188:191], v247 offset:30720
    v_mfma_f32_16x16x32_bf16 v[60:63], v[76:79], v[112:115], v[60:63]
    ds_read2_b32 v[156:157], v239 offset0:176 offset1:177
    v_mfma_f32_16x16x32_bf16 v[60:63], v[72:75], v[116:119], v[60:63]
    v_mfma_f32_16x16x32_bf16 v[60:63], v[68:71], v[120:123], v[60:63]
    ds_read2_b32 v[158:159], v239 offset0:178 offset1:179
    v_mfma_f32_16x16x32_bf16 v[60:63], v[64:67], v[124:127], v[60:63]
    s_waitcnt lgkmcnt(12)
    v_mfma_f32_16x16x32_bf16 v[32:35], v[128:131], v[160:163], v[32:35]
    s_add_u32 m0, s73, 49152
    ds_read_b128 v[96:99], v244 offset:0
    v_mfma_f32_16x16x32_bf16 v[36:39], v[132:135], v[160:163], v[36:39]
    buffer_load_dwordx4 v7, s[52:55], s14 offen offset:3072 lds
    ds_read2_b32 v[64:65], v236 offset0:64 offset1:65
    v_mfma_f32_16x16x32_bf16 v[36:39], v[128:131], v[164:167], v[36:39]
    ds_read2_b32 v[66:67], v236 offset0:66 offset1:67
    v_mfma_f32_16x16x32_bf16 v[40:43], v[128:131], v[168:171], v[40:43]
    ds_read_b128 v[100:103], v244 offset:4096
    v_mfma_f32_16x16x32_bf16 v[40:43], v[132:135], v[164:167], v[40:43]
    ds_read2_b32 v[68:69], v236 offset0:192 offset1:193
    v_mfma_f32_16x16x32_bf16 v[40:43], v[136:139], v[160:163], v[40:43]
    ds_read2_b32 v[70:71], v236 offset0:194 offset1:195
    v_mfma_f32_16x16x32_bf16 v[44:47], v[140:143], v[160:163], v[44:47]
    ds_read_b128 v[104:107], v244 offset:8192
    v_mfma_f32_16x16x32_bf16 v[44:47], v[136:139], v[164:167], v[44:47]
    ds_read2_b32 v[72:73], v237 offset0:64 offset1:65
    v_mfma_f32_16x16x32_bf16 v[44:47], v[132:135], v[168:171], v[44:47]
    ds_read2_b32 v[74:75], v237 offset0:66 offset1:67
    v_mfma_f32_16x16x32_bf16 v[44:47], v[128:131], v[172:175], v[44:47]
    ds_read_b128 v[108:111], v244 offset:12288
    s_waitcnt lgkmcnt(10)
    v_mfma_f32_16x16x32_bf16 v[48:51], v[128:131], v[176:179], v[48:51]
    ds_read2_b32 v[76:77], v237 offset0:192 offset1:193
    v_mfma_f32_16x16x32_bf16 v[48:51], v[132:135], v[172:175], v[48:51]
    ds_read2_b32 v[78:79], v237 offset0:194 offset1:195
    v_mfma_f32_16x16x32_bf16 v[48:51], v[136:139], v[168:171], v[48:51]
    ds_read_b128 v[112:115], v244 offset:16384
    v_mfma_f32_16x16x32_bf16 v[48:51], v[140:143], v[164:167], v[48:51]
    ds_read2_b32 v[80:81], v238 offset0:64 offset1:65
    v_mfma_f32_16x16x32_bf16 v[48:51], v[144:147], v[160:163], v[48:51]
    ds_read2_b32 v[82:83], v238 offset0:66 offset1:67
    v_mfma_f32_16x16x32_bf16 v[52:55], v[148:151], v[160:163], v[52:55]
    ds_read_b128 v[116:119], v244 offset:20480
    v_mfma_f32_16x16x32_bf16 v[52:55], v[144:147], v[164:167], v[52:55]
    ds_read2_b32 v[84:85], v238 offset0:192 offset1:193
    v_mfma_f32_16x16x32_bf16 v[52:55], v[140:143], v[168:171], v[52:55]
    s_waitcnt vmcnt(5)
    ds_read2_b32 v[86:87], v238 offset0:194 offset1:195
    v_mfma_f32_16x16x32_bf16 v[52:55], v[136:139], v[172:175], v[52:55]
    ds_read_b128 v[120:123], v244 offset:24576
    v_mfma_f32_16x16x32_bf16 v[52:55], v[132:135], v[176:179], v[52:55]
    ds_read_b128 v[212:215], v241 offset:8352
    v_mfma_f32_16x16x32_bf16 v[52:55], v[128:131], v[180:183], v[52:55]
    ds_read2_b32 v[88:89], v239 offset0:64 offset1:65
    v_mfma_f32_16x16x32_bf16 v[56:59], v[128:131], v[184:187], v[56:59]
    ds_read_b32 v216, v241 offset:8368
    s_barrier
    v_mfma_f32_16x16x32_bf16 v[56:59], v[132:135], v[180:183], v[56:59]
    ds_read_b128 v[218:221], v241 offset:9376
    v_mfma_f32_16x16x32_bf16 v[56:59], v[136:139], v[176:179], v[56:59]
    ds_read_b64_tr_b16 a[0:1], v10 offset:16384
    v_mfma_f32_16x16x32_bf16 v[56:59], v[140:143], v[172:175], v[56:59]
    ds_read_b64_tr_b16 a[2:3], v10 offset:18432
    v_mfma_f32_16x16x32_bf16 v[56:59], v[144:147], v[168:171], v[56:59]
    ds_read_b64_tr_b16 a[8:9], v10 offset:20480
    v_mfma_f32_16x16x32_bf16 v[56:59], v[148:151], v[164:167], v[56:59]
    ds_read_b32 v222, v241 offset:9392
    v_mfma_f32_16x16x32_bf16 v[56:59], v[152:155], v[160:163], v[56:59]
    ds_read_b64_tr_b16 a[10:11], v10 offset:22528
    v_mfma_f32_16x16x32_bf16 v[60:63], v[156:159], v[160:163], v[60:63]
    ds_read_b64_tr_b16 a[4:5], v11 offset:16384
    v_mfma_f32_16x16x32_bf16 v[60:63], v[152:155], v[164:167], v[60:63]
    ds_read_b128 v[224:227], v241 offset:10400
    ds_read2_b32 v[90:91], v239 offset0:66 offset1:67
    v_mfma_f32_16x16x32_bf16 v[60:63], v[148:151], v[168:171], v[60:63]
    ds_read_b64_tr_b16 a[6:7], v11 offset:18432
    v_mfma_f32_16x16x32_bf16 v[60:63], v[144:147], v[172:175], v[60:63]
    ds_read_b64_tr_b16 a[12:13], v11 offset:20480
    ds_read_b128 v[124:127], v244 offset:28672
    v_mfma_f32_16x16x32_bf16 v[60:63], v[140:143], v[176:179], v[60:63]
    ds_read_b32 v228, v241 offset:10416
    ds_read2_b32 v[92:93], v239 offset0:192 offset1:193
    v_mfma_f32_16x16x32_bf16 v[60:63], v[136:139], v[180:183], v[60:63]
    ds_read_b64_tr_b16 a[14:15], v11 offset:22528
    v_mfma_f32_16x16x32_bf16 v[60:63], v[132:135], v[184:187], v[60:63]
    ds_read_b128 v[230:233], v241 offset:11424
    ds_read2_b32 v[94:95], v239 offset0:194 offset1:195
    v_mfma_f32_16x16x32_bf16 v[60:63], v[128:131], v[188:191], v[60:63]
    ds_read_b32 v234, v241 offset:11440
    s_waitcnt lgkmcnt(15)
    v_mfma_f32_16x16x32_bf16 v[32:35], v[64:67], v[96:99], v[32:35]
    ds_read_b128 v[160:163], v245 offset:0
    s_waitcnt lgkmcnt(4)
    s_barrier
    v_mfma_f32_16x16x32_bf16 v[36:39], v[68:71], v[96:99], v[36:39]
    v_mfma_f32_16x16x32_bf16 v[36:39], v[64:67], v[100:103], v[36:39]
    ds_read2_b32 v[128:129], v236 offset0:80 offset1:81
    v_mfma_f32_16x16x32_bf16 v[40:43], v[64:67], v[104:107], v[40:43]
    s_lshl_b32 s14, s86, 18
    ds_read2_b32 v[130:131], v236 offset0:82 offset1:83
    v_mfma_f32_16x16x32_bf16 v[40:43], v[68:71], v[100:103], v[40:43]
    s_add_u32 m0, s73, 147456
    s_waitcnt lgkmcnt(3)
    v_mfma_f32_16x16x32_bf16 v[40:43], v[72:75], v[96:99], v[40:43]
    buffer_load_dwordx4 v4, s[52:55], s14 offen offset:0 lds
    ds_read_b128 v[164:167], v245 offset:4096
    v_mfma_f32_16x16x32_bf16 v[44:47], v[76:79], v[96:99], v[44:47]
    s_waitcnt vmcnt(4)
    ds_read2_b32 v[132:133], v236 offset0:208 offset1:209
    v_mfma_f32_16x16x32_bf16 v[44:47], v[72:75], v[100:103], v[44:47]
    v_mfma_f32_16x16x32_bf16 v[44:47], v[68:71], v[104:107], v[44:47]
    ds_read2_b32 v[134:135], v236 offset0:210 offset1:211
    v_lshlrev_b32 v9, 16, v9
    v_mfma_f32_16x16x32_bf16 v[44:47], v[64:67], v[108:111], v[44:47]
    ds_read_b128 v[168:171], v245 offset:8192
    v_mfma_f32_16x16x32_bf16 v[48:51], v[64:67], v[112:115], v[48:51]
    ds_read2_b32 v[136:137], v237 offset0:80 offset1:81
    v_lshlrev_b32 v208, 16, v212
    v_mfma_f32_16x16x32_bf16 v[48:51], v[68:71], v[108:111], v[48:51]
    v_mfma_f32_16x16x32_bf16 v[48:51], v[72:75], v[104:107], v[48:51]
    ds_read2_b32 v[138:139], v237 offset0:82 offset1:83
    v_add_f32 v9, v9, v208
    v_mfma_f32_16x16x32_bf16 v[48:51], v[76:79], v[100:103], v[48:51]
    ds_read_b128 v[172:175], v245 offset:12288
    v_cvt_pk_bf16_f32 v9, v9, v9
    v_mfma_f32_16x16x32_bf16 v[48:51], v[80:83], v[96:99], v[48:51]
    ds_read2_b32 v[140:141], v237 offset0:208 offset1:209
    v_mfma_f32_16x16x32_bf16 v[52:55], v[84:87], v[96:99], v[52:55]
    ds_write_b16 v242, v9 offset:12480
    v_mfma_f32_16x16x32_bf16 v[52:55], v[80:83], v[100:103], v[52:55]
    s_add_u32 m0, s73, 147456
    ds_read2_b32 v[142:143], v237 offset0:210 offset1:211
    v_mfma_f32_16x16x32_bf16 v[52:55], v[76:79], v[104:107], v[52:55]
    buffer_load_dwordx4 v5, s[52:55], s14 offen offset:1024 lds
    ds_read_b128 v[176:179], v245 offset:16384
    v_mfma_f32_16x16x32_bf16 v[52:55], v[72:75], v[108:111], v[52:55]
    ds_write_b16 v242, v9 offset:8322
    v_mfma_f32_16x16x32_bf16 v[52:55], v[68:71], v[112:115], v[52:55]
    ds_read2_b32 v[144:145], v238 offset0:80 offset1:81
    v_alignbit_b32 v212, v213, v212, 16
    v_mfma_f32_16x16x32_bf16 v[52:55], v[64:67], v[116:119], v[52:55]
    v_alignbit_b32 v213, v214, v213, 16
    v_mfma_f32_16x16x32_bf16 v[56:59], v[64:67], v[120:123], v[56:59]
    ds_read2_b32 v[146:147], v238 offset0:82 offset1:83
    v_mfma_f32_16x16x32_bf16 v[56:59], v[68:71], v[116:119], v[56:59]
    ds_read_b128 v[180:183], v245 offset:20480
    v_alignbit_b32 v214, v215, v214, 16
    v_mfma_f32_16x16x32_bf16 v[56:59], v[72:75], v[112:115], v[56:59]
    v_mfma_f32_16x16x32_bf16 v[56:59], v[76:79], v[108:111], v[56:59]
    ds_read2_b32 v[148:149], v238 offset0:208 offset1:209
    v_alignbit_b32 v215, v216, v215, 16
    v_mfma_f32_16x16x32_bf16 v[56:59], v[80:83], v[104:107], v[56:59]
    ds_read2_b32 v[150:151], v238 offset0:210 offset1:211
    v_mfma_f32_16x16x32_bf16 v[56:59], v[84:87], v[100:103], v[56:59]
    ds_write_b128 v241, v[212:215] offset:12512
    v_mfma_f32_16x16x32_bf16 v[56:59], v[88:91], v[96:99], v[56:59]
    ds_read_b128 v[184:187], v245 offset:24576
    v_mfma_f32_16x16x32_bf16 v[60:63], v[92:95], v[96:99], v[60:63]
    ds_read2_b32 v[152:153], v239 offset0:80 offset1:81
    s_add_u32 m0, s73, 147456
    v_alignbit_b32 v218, v219, v218, 16
    v_mfma_f32_16x16x32_bf16 v[60:63], v[88:91], v[100:103], v[60:63]
    buffer_load_dwordx4 v6, s[52:55], s14 offen offset:2048 lds
    v_alignbit_b32 v219, v220, v219, 16
    v_mfma_f32_16x16x32_bf16 v[60:63], v[84:87], v[104:107], v[60:63]
    ds_read2_b32 v[154:155], v239 offset0:82 offset1:83
    v_mfma_f32_16x16x32_bf16 v[60:63], v[80:83], v[108:111], v[60:63]
    ds_read_b128 v[188:191], v245 offset:28672
    v_alignbit_b32 v220, v221, v220, 16
    v_mfma_f32_16x16x32_bf16 v[60:63], v[76:79], v[112:115], v[60:63]
    ds_read2_b32 v[156:157], v239 offset0:208 offset1:209
    v_mfma_f32_16x16x32_bf16 v[60:63], v[72:75], v[116:119], v[60:63]
    ds_read2_b32 v[158:159], v239 offset0:210 offset1:211
    v_alignbit_b32 v221, v222, v221, 16
    v_mfma_f32_16x16x32_bf16 v[60:63], v[68:71], v[120:123], v[60:63]
    ds_write_b128 v241, v[218:221] offset:13536
    v_mfma_f32_16x16x32_bf16 v[60:63], v[64:67], v[124:127], v[60:63]
    s_waitcnt lgkmcnt(15)
    v_mfma_f32_16x16x32_bf16 v[32:35], v[128:131], v[160:163], v[32:35]
    ds_read_b128 v[96:99], v246 offset:0
    v_mfma_f32_16x16x32_bf16 v[36:39], v[132:135], v[160:163], v[36:39]
    ds_read2_b32 v[64:65], v236 offset0:96 offset1:97
    v_alignbit_b32 v224, v225, v224, 16
    v_mfma_f32_16x16x32_bf16 v[36:39], v[128:131], v[164:167], v[36:39]
    ds_read2_b32 v[66:67], v236 offset0:98 offset1:99
    v_mfma_f32_16x16x32_bf16 v[40:43], v[128:131], v[168:171], v[40:43]
    s_add_u32 m0, s73, 147456
    ds_read_b128 v[100:103], v246 offset:4096
    v_mfma_f32_16x16x32_bf16 v[40:43], v[132:135], v[164:167], v[40:43]
    buffer_load_dwordx4 v7, s[52:55], s14 offen offset:3072 lds
    ds_read2_b32 v[68:69], v236 offset0:224 offset1:225
    v_mfma_f32_16x16x32_bf16 v[40:43], v[136:139], v[160:163], v[40:43]
    ds_read2_b32 v[70:71], v236 offset0:226 offset1:227
    v_alignbit_b32 v225, v226, v225, 16
    v_mfma_f32_16x16x32_bf16 v[44:47], v[140:143], v[160:163], v[44:47]
    ds_read_b128 v[104:107], v246 offset:8192
    v_mfma_f32_16x16x32_bf16 v[44:47], v[136:139], v[164:167], v[44:47]
    ds_read2_b32 v[72:73], v237 offset0:96 offset1:97
    v_mfma_f32_16x16x32_bf16 v[44:47], v[132:135], v[168:171], v[44:47]
    ds_read2_b32 v[74:75], v237 offset0:98 offset1:99
    v_mfma_f32_16x16x32_bf16 v[44:47], v[128:131], v[172:175], v[44:47]
    v_alignbit_b32 v226, v227, v226, 16
    s_waitcnt lgkmcnt(10)
    v_mfma_f32_16x16x32_bf16 v[48:51], v[128:131], v[176:179], v[48:51]
    ds_read_b128 v[108:111], v246 offset:12288
    v_mfma_f32_16x16x32_bf16 v[48:51], v[132:135], v[172:175], v[48:51]
    ds_read2_b32 v[76:77], v237 offset0:224 offset1:225
    v_mfma_f32_16x16x32_bf16 v[48:51], v[136:139], v[168:171], v[48:51]
    ds_read2_b32 v[78:79], v237 offset0:226 offset1:227
    v_alignbit_b32 v227, v228, v227, 16
    v_mfma_f32_16x16x32_bf16 v[48:51], v[140:143], v[164:167], v[48:51]
    ds_read_b128 v[112:115], v246 offset:16384
    v_mfma_f32_16x16x32_bf16 v[48:51], v[144:147], v[160:163], v[48:51]
    ds_read2_b32 v[80:81], v238 offset0:96 offset1:97
    v_mfma_f32_16x16x32_bf16 v[52:55], v[148:151], v[160:163], v[52:55]
    ds_read2_b32 v[82:83], v238 offset0:98 offset1:99
    v_mfma_f32_16x16x32_bf16 v[52:55], v[144:147], v[164:167], v[52:55]
    ds_write_b128 v241, v[224:227] offset:14560
    v_mfma_f32_16x16x32_bf16 v[52:55], v[140:143], v[168:171], v[52:55]
    ds_read_b128 v[116:119], v246 offset:20480
    v_mfma_f32_16x16x32_bf16 v[52:55], v[136:139], v[172:175], v[52:55]
    ds_read2_b32 v[84:85], v238 offset0:224 offset1:225
    v_mfma_f32_16x16x32_bf16 v[52:55], v[132:135], v[176:179], v[52:55]
    ds_read2_b32 v[86:87], v238 offset0:226 offset1:227
    v_alignbit_b32 v230, v231, v230, 16
    v_mfma_f32_16x16x32_bf16 v[52:55], v[128:131], v[180:183], v[52:55]
    ds_read_b128 v[120:123], v246 offset:24576
    v_mfma_f32_16x16x32_bf16 v[56:59], v[128:131], v[184:187], v[56:59]
    ds_read2_b32 v[88:89], v239 offset0:96 offset1:97
    s_waitcnt vmcnt(4)
    s_barrier
    v_mfma_f32_16x16x32_bf16 v[56:59], v[132:135], v[180:183], v[56:59]
    ds_read2_b32 v[90:91], v239 offset0:98 offset1:99
    v_add_u32 v10, -131072, v10
    v_mfma_f32_16x16x32_bf16 v[56:59], v[136:139], v[176:179], v[56:59]
    ds_read_b64_tr_b16 a[16:17], v10 offset:49152
    v_alignbit_b32 v231, v232, v231, 16
    v_mfma_f32_16x16x32_bf16 v[56:59], v[140:143], v[172:175], v[56:59]
    ds_read_b128 v[124:127], v246 offset:28672
    v_mfma_f32_16x16x32_bf16 v[56:59], v[144:147], v[168:171], v[56:59]
    ds_read_b64_tr_b16 a[18:19], v10 offset:51200
    v_mfma_f32_16x16x32_bf16 v[56:59], v[148:151], v[164:167], v[56:59]
    ds_read_b64_tr_b16 a[24:25], v10 offset:53248
    v_mfma_f32_16x16x32_bf16 v[56:59], v[152:155], v[160:163], v[56:59]
    ds_read_b64_tr_b16 a[26:27], v10 offset:55296
    v_alignbit_b32 v232, v233, v232, 16
    v_mfma_f32_16x16x32_bf16 v[60:63], v[156:159], v[160:163], v[60:63]
    ds_read2_b32 v[92:93], v239 offset0:224 offset1:225
    v_add_u32 v11, -131072, v11
    v_mfma_f32_16x16x32_bf16 v[60:63], v[152:155], v[164:167], v[60:63]
    ds_read_b64_tr_b16 a[20:21], v11 offset:49152
    v_mfma_f32_16x16x32_bf16 v[60:63], v[148:151], v[168:171], v[60:63]
    ds_read2_b32 v[94:95], v239 offset0:226 offset1:227
    v_alignbit_b32 v233, v234, v233, 16
    v_mfma_f32_16x16x32_bf16 v[60:63], v[144:147], v[172:175], v[60:63]
    ds_read_b64_tr_b16 a[22:23], v11 offset:51200
    v_mfma_f32_16x16x32_bf16 v[60:63], v[140:143], v[176:179], v[60:63]
    ds_read_b64_tr_b16 a[28:29], v11 offset:53248
    v_mfma_f32_16x16x32_bf16 v[60:63], v[136:139], v[180:183], v[60:63]
    ds_read_b64_tr_b16 a[30:31], v11 offset:55296
    v_mfma_f32_16x16x32_bf16 v[60:63], v[132:135], v[184:187], v[60:63]
    ds_write_b128 v241, v[230:233] offset:15584
    v_mfma_f32_16x16x32_bf16 v[60:63], v[128:131], v[188:191], v[60:63]
L_pl_X_2:
    s_cbranch_execz L_pl_X_6
    s_waitcnt lgkmcnt(15)
    v_mfma_f32_16x16x32_bf16 v[32:35], v[64:67], v[96:99], v[32:35]
    ds_read_b128 v[160:163], v247 offset:0
    s_waitcnt lgkmcnt(2)
    s_barrier
    v_mfma_f32_16x16x32_bf16 v[36:39], v[68:71], v[96:99], v[36:39]
    v_mfma_f32_16x16x32_bf16 v[36:39], v[64:67], v[100:103], v[36:39]
    ds_read_b128 v[164:167], v247 offset:4096
    v_mfma_f32_16x16x32_bf16 v[40:43], v[64:67], v[104:107], v[40:43]
    s_lshl_b32 s14, s87, 18
    ds_read_b128 v[168:171], v247 offset:8192
    v_mfma_f32_16x16x32_bf16 v[40:43], v[68:71], v[100:103], v[40:43]
    s_add_u32 m0, s73, 49152
    ds_read_b128 v[172:175], v247 offset:12288
    v_mfma_f32_16x16x32_bf16 v[40:43], v[72:75], v[96:99], v[40:43]
    buffer_load_dwordx4 v4, s[52:55], s14 offen offset:0 lds
    v_mfma_f32_16x16x32_bf16 v[44:47], v[76:79], v[96:99], v[44:47]
    ds_read_b128 v[176:179], v247 offset:16384
    v_mfma_f32_16x16x32_bf16 v[44:47], v[72:75], v[100:103], v[44:47]
    ds_read_b128 v[180:183], v247 offset:20480
    v_mfma_f32_16x16x32_bf16 v[44:47], v[68:71], v[104:107], v[44:47]
    v_mfma_f32_16x16x32_bf16 v[44:47], v[64:67], v[108:111], v[44:47]
    ds_read_b128 v[184:187], v247 offset:24576
    v_mfma_f32_16x16x32_bf16 v[48:51], v[64:67], v[112:115], v[48:51]
    ds_read_b128 v[188:191], v247 offset:28672
    v_mfma_f32_16x16x32_bf16 v[48:51], v[68:71], v[108:111], v[48:51]
    ds_read2_b32 v[128:129], v236 offset0:112 offset1:113
    v_mfma_f32_16x16x32_bf16 v[48:51], v[72:75], v[104:107], v[48:51]
    v_mfma_f32_16x16x32_bf16 v[48:51], v[76:79], v[100:103], v[48:51]
    ds_read2_b32 v[130:131], v236 offset0:114 offset1:115
    v_mfma_f32_16x16x32_bf16 v[48:51], v[80:83], v[96:99], v[48:51]
    ds_read2_b32 v[132:133], v236 offset0:240 offset1:241
    v_mfma_f32_16x16x32_bf16 v[52:55], v[84:87], v[96:99], v[52:55]
    ds_read2_b32 v[134:135], v236 offset0:242 offset1:243
    v_mfma_f32_16x16x32_bf16 v[52:55], v[80:83], v[100:103], v[52:55]
    s_add_u32 m0, s73, 49152
    ds_read2_b32 v[136:137], v237 offset0:112 offset1:113
    v_mfma_f32_16x16x32_bf16 v[52:55], v[76:79], v[104:107], v[52:55]
    buffer_load_dwordx4 v5, s[52:55], s14 offen offset:1024 lds
    ds_read2_b32 v[138:139], v237 offset0:114 offset1:115
    v_mfma_f32_16x16x32_bf16 v[52:55], v[72:75], v[108:111], v[52:55]
    s_add_u32 s6, s12, 4718592
    ds_read2_b32 v[140:141], v237 offset0:240 offset1:241
    v_mfma_f32_16x16x32_bf16 v[52:55], v[68:71], v[112:115], v[52:55]
    ds_read2_b32 v[142:143], v237 offset0:242 offset1:243
    v_mfma_f32_16x16x32_bf16 v[52:55], v[64:67], v[116:119], v[52:55]
    ds_read2_b32 v[144:145], v238 offset0:112 offset1:113
    v_xor_b32 v244, 64, v244
    v_mfma_f32_16x16x32_bf16 v[56:59], v[64:67], v[120:123], v[56:59]
    v_mfma_f32_16x16x32_bf16 v[56:59], v[68:71], v[116:119], v[56:59]
    ds_read2_b32 v[146:147], v238 offset0:114 offset1:115
    v_mfma_f32_16x16x32_bf16 v[56:59], v[72:75], v[112:115], v[56:59]
    ds_read2_b32 v[148:149], v238 offset0:240 offset1:241
    v_mfma_f32_16x16x32_bf16 v[56:59], v[76:79], v[108:111], v[56:59]
    ds_read2_b32 v[150:151], v238 offset0:242 offset1:243
    v_xor_b32 v245, 64, v245
    v_mfma_f32_16x16x32_bf16 v[56:59], v[80:83], v[104:107], v[56:59]
    ds_read2_b32 v[152:153], v239 offset0:112 offset1:113
    v_mfma_f32_16x16x32_bf16 v[56:59], v[84:87], v[100:103], v[56:59]
    ds_read2_b32 v[154:155], v239 offset0:114 offset1:115
    v_mfma_f32_16x16x32_bf16 v[56:59], v[88:91], v[96:99], v[56:59]
    ds_read2_b32 v[156:157], v239 offset0:240 offset1:241
    v_mfma_f32_16x16x32_bf16 v[60:63], v[92:95], v[96:99], v[60:63]
    s_add_u32 m0, s73, 49152
    ds_read2_b32 v[158:159], v239 offset0:242 offset1:243
    v_mfma_f32_16x16x32_bf16 v[60:63], v[88:91], v[100:103], v[60:63]
    buffer_load_dwordx4 v6, s[52:55], s14 offen offset:2048 lds
    v_xor_b32 v246, 64, v246
    v_mfma_f32_16x16x32_bf16 v[60:63], v[84:87], v[104:107], v[60:63]
    v_add_u32 v236, 8320, v236
    v_mfma_f32_16x16x32_bf16 v[60:63], v[80:83], v[108:111], v[60:63]
    v_add_u32 v237, 8320, v237
    v_mfma_f32_16x16x32_bf16 v[60:63], v[76:79], v[112:115], v[60:63]
    v_mfma_f32_16x16x32_bf16 v[60:63], v[72:75], v[116:119], v[60:63]
    v_xor_b32 v247, 64, v247
    v_add_u32 v238, 8320, v238
    v_mfma_f32_16x16x32_bf16 v[60:63], v[68:71], v[120:123], v[60:63]
    v_mfma_f32_16x16x32_bf16 v[60:63], v[64:67], v[124:127], v[60:63]
    v_add_u32 v239, 8320, v239
    s_waitcnt lgkmcnt(0)
    v_mfma_f32_16x16x32_bf16 v[60:63], v[128:131], v[188:191], v[60:63]
    ds_read_b128 v[96:99], v244 offset:2048
    v_mfma_f32_16x16x32_bf16 v[60:63], v[132:135], v[184:187], v[60:63]
    ds_read2_b32 v[64:65], v236 offset0:0 offset1:1
    v_mfma_f32_16x16x32_bf16 v[60:63], v[136:139], v[180:183], v[60:63]
    ds_read2_b32 v[66:67], v236 offset0:2 offset1:3
    v_mfma_f32_16x16x32_bf16 v[60:63], v[140:143], v[176:179], v[60:63]
    s_add_u32 m0, s73, 49152
    ds_read_b128 v[100:103], v244 offset:6144
    v_mfma_f32_16x16x32_bf16 v[60:63], v[144:147], v[172:175], v[60:63]
    buffer_load_dwordx4 v7, s[52:55], s14 offen offset:3072 lds
    ds_read2_b32 v[68:69], v236 offset0:128 offset1:129
    v_mfma_f32_16x16x32_bf16 v[60:63], v[148:151], v[168:171], v[60:63]
    ds_read2_b32 v[70:71], v236 offset0:130 offset1:131
    v_mfma_f32_16x16x32_bf16 v[60:63], v[152:155], v[164:167], v[60:63]
    ds_read_b128 v[104:107], v244 offset:10240
    v_mfma_f32_16x16x32_bf16 v[60:63], v[156:159], v[160:163], v[60:63]
    ds_read2_b32 v[72:73], v237 offset0:0 offset1:1
    v_mfma_f32_16x16x32_bf16 v[56:59], v[128:131], v[184:187], v[56:59]
    ds_read2_b32 v[74:75], v237 offset0:2 offset1:3
    v_mfma_f32_16x16x32_bf16 v[56:59], v[132:135], v[180:183], v[56:59]
    ds_read_b128 v[108:111], v244 offset:14336
    v_mfma_f32_16x16x32_bf16 v[56:59], v[136:139], v[176:179], v[56:59]
    ds_read2_b32 v[76:77], v237 offset0:128 offset1:129
    v_mfma_f32_16x16x32_bf16 v[56:59], v[140:143], v[172:175], v[56:59]
    ds_read2_b32 v[78:79], v237 offset0:130 offset1:131
    v_mfma_f32_16x16x32_bf16 v[56:59], v[144:147], v[168:171], v[56:59]
    ds_read_b128 v[112:115], v244 offset:18432
    v_mfma_f32_16x16x32_bf16 v[56:59], v[148:151], v[164:167], v[56:59]
    ds_read2_b32 v[80:81], v238 offset0:0 offset1:1
    v_cvt_pk_bf16_f32 v206, v60, v61
    v_mfma_f32_16x16x32_bf16 v[56:59], v[152:155], v[160:163], v[56:59]
    ds_read2_b32 v[82:83], v238 offset0:2 offset1:3
    v_mfma_f32_16x16x32_bf16 v[52:55], v[128:131], v[180:183], v[52:55]
    ds_read_b128 v[116:119], v244 offset:22528
    v_mfma_f32_16x16x32_bf16 v[52:55], v[132:135], v[176:179], v[52:55]
    ds_read2_b32 v[84:85], v238 offset0:128 offset1:129
    v_cvt_pk_bf16_f32 v207, v62, v63
    v_mfma_f32_16x16x32_bf16 v[52:55], v[136:139], v[172:175], v[52:55]
    ds_read2_b32 v[86:87], v238 offset0:130 offset1:131
    v_mfma_f32_16x16x32_bf16 v[52:55], v[140:143], v[168:171], v[52:55]
    buffer_store_dwordx2 v[206:207], v8, s[44:47], s6 offen offset:3584 sc1
    ds_read_b128 v[120:123], v244 offset:26624
    v_mfma_f32_16x16x32_bf16 v[52:55], v[144:147], v[164:167], v[52:55]
    ds_read2_b32 v[88:89], v239 offset0:0 offset1:1
    v_mfma_f32_16x16x32_bf16 v[52:55], v[148:151], v[160:163], v[52:55]
    ds_read2_b32 v[90:91], v239 offset0:2 offset1:3
    v_mfma_f32_16x16x32_bf16 v[48:51], v[128:131], v[176:179], v[48:51]
    s_waitcnt vmcnt(5)
    s_barrier
    v_cvt_pk_bf16_f32 v204, v56, v57
    v_mfma_f32_16x16x32_bf16 v[48:51], v[132:135], v[172:175], v[48:51]
    ds_read_b128 v[124:127], v244 offset:30720
    v_add_u32 v10, 131072, v10
    v_mfma_f32_16x16x32_bf16 v[48:51], v[136:139], v[168:171], v[48:51]
    ds_read_b64_tr_b16 a[32:33], v10 offset:16384
    v_mfma_f32_16x16x32_bf16 v[48:51], v[140:143], v[164:167], v[48:51]
    ds_read2_b32 v[92:93], v239 offset0:128 offset1:129
    v_cvt_pk_bf16_f32 v205, v58, v59
    v_mfma_f32_16x16x32_bf16 v[48:51], v[144:147], v[160:163], v[48:51]
    ds_read_b64_tr_b16 a[34:35], v10 offset:18432
    v_mfma_f32_16x16x32_bf16 v[44:47], v[128:131], v[172:175], v[44:47]
    buffer_store_dwordx2 v[204:205], v8, s[44:47], s6 offen offset:3072 sc1
    ds_read_b64_tr_b16 a[40:41], v10 offset:20480
    v_mfma_f32_16x16x32_bf16 v[44:47], v[132:135], v[168:171], v[44:47]
    ds_read_b64_tr_b16 a[42:43], v10 offset:22528
    v_mfma_f32_16x16x32_bf16 v[44:47], v[136:139], v[164:167], v[44:47]
    ds_read2_b32 v[94:95], v239 offset0:130 offset1:131
    v_add_u32 v11, 131072, v11
    v_mfma_f32_16x16x32_bf16 v[44:47], v[140:143], v[160:163], v[44:47]
    ds_read_b64_tr_b16 a[36:37], v11 offset:16384
    v_cvt_pk_bf16_f32 v202, v52, v53
    v_mfma_f32_16x16x32_bf16 v[40:43], v[128:131], v[168:171], v[40:43]
    v_mfma_f32_16x16x32_bf16 v[40:43], v[132:135], v[164:167], v[40:43]
    ds_read_b64_tr_b16 a[38:39], v11 offset:18432
    v_mfma_f32_16x16x32_bf16 v[40:43], v[136:139], v[160:163], v[40:43]
    ds_read_b64_tr_b16 a[44:45], v11 offset:20480
    v_cvt_pk_bf16_f32 v203, v54, v55
    v_mfma_f32_16x16x32_bf16 v[36:39], v[128:131], v[164:167], v[36:39]
    ds_read_b64_tr_b16 a[46:47], v11 offset:22528
    v_mfma_f32_16x16x32_bf16 v[36:39], v[132:135], v[160:163], v[36:39]
    buffer_store_dwordx2 v[202:203], v8, s[44:47], s6 offen offset:2560 sc1
    v_mfma_f32_16x16x32_bf16 v[32:35], v[128:131], v[160:163], v[32:35]
    s_waitcnt lgkmcnt(4)
    v_mfma_f32_16x16x32_bf16 v[60:63], v[64:67], v[124:127], 0
    ds_read_b128 v[160:163], v245 offset:2048
    s_waitcnt lgkmcnt(1)
    s_barrier
    v_mfma_f32_16x16x32_bf16 v[60:63], v[68:71], v[120:123], v[60:63]
    v_cvt_pk_bf16_f32 v200, v48, v49
    v_mfma_f32_16x16x32_bf16 v[60:63], v[72:75], v[116:119], v[60:63]
    ds_read2_b32 v[128:129], v236 offset0:16 offset1:17
    v_mfma_f32_16x16x32_bf16 v[60:63], v[76:79], v[112:115], v[60:63]
    ds_read2_b32 v[130:131], v236 offset0:18 offset1:19
    s_lshl_b32 s14, s88, 18
    v_cvt_pk_bf16_f32 v201, v50, v51
    v_mfma_f32_16x16x32_bf16 v[60:63], v[80:83], v[108:111], v[60:63]
    s_add_u32 m0, s73, 147456
    v_mfma_f32_16x16x32_bf16 v[60:63], v[84:87], v[104:107], v[60:63]
    buffer_load_dwordx4 v4, s[52:55], s14 offen offset:0 lds
    ds_read_b128 v[164:167], v245 offset:6144
    v_mfma_f32_16x16x32_bf16 v[60:63], v[88:91], v[100:103], v[60:63]
    buffer_store_dwordx2 v[200:201], v8, s[44:47], s6 offen offset:2048 sc1
    ds_read2_b32 v[132:133], v236 offset0:144 offset1:145
    v_mfma_f32_16x16x32_bf16 v[60:63], v[92:95], v[96:99], v[60:63]
    v_cvt_pk_bf16_f32 v198, v44, v45
    v_mfma_f32_16x16x32_bf16 v[56:59], v[64:67], v[120:123], 0
    ds_read2_b32 v[134:135], v236 offset0:146 offset1:147
    v_mfma_f32_16x16x32_bf16 v[56:59], v[68:71], v[116:119], v[56:59]
    ds_read_b128 v[168:171], v245 offset:10240
    v_mfma_f32_16x16x32_bf16 v[56:59], v[72:75], v[112:115], v[56:59]
    ds_read2_b32 v[136:137], v237 offset0:16 offset1:17
    v_cvt_pk_bf16_f32 v199, v46, v47
    v_mfma_f32_16x16x32_bf16 v[56:59], v[76:79], v[108:111], v[56:59]
    v_mfma_f32_16x16x32_bf16 v[56:59], v[80:83], v[104:107], v[56:59]
    buffer_store_dwordx2 v[198:199], v8, s[44:47], s6 offen offset:1536 sc1
    ds_read2_b32 v[138:139], v237 offset0:18 offset1:19
    v_mfma_f32_16x16x32_bf16 v[56:59], v[84:87], v[100:103], v[56:59]
    ds_read_b128 v[172:175], v245 offset:14336
    v_mfma_f32_16x16x32_bf16 v[56:59], v[88:91], v[96:99], v[56:59]
    v_cvt_pk_bf16_f32 v196, v40, v41
    v_mfma_f32_16x16x32_bf16 v[52:55], v[64:67], v[116:119], 0
    ds_read2_b32 v[140:141], v237 offset0:144 offset1:145
    v_mfma_f32_16x16x32_bf16 v[52:55], v[68:71], v[112:115], v[52:55]
    ds_read2_b32 v[142:143], v237 offset0:146 offset1:147
    s_add_u32 m0, s73, 147456
    v_cvt_pk_bf16_f32 v197, v42, v43
    v_mfma_f32_16x16x32_bf16 v[52:55], v[72:75], v[108:111], v[52:55]
    buffer_load_dwordx4 v5, s[52:55], s14 offen offset:1024 lds
    v_mfma_f32_16x16x32_bf16 v[52:55], v[76:79], v[104:107], v[52:55]
    buffer_store_dwordx2 v[196:197], v8, s[44:47], s6 offen offset:1024 sc1
    ds_read_b128 v[176:179], v245 offset:18432
    v_mfma_f32_16x16x32_bf16 v[52:55], v[80:83], v[100:103], v[52:55]
    ds_read2_b32 v[144:145], v238 offset0:16 offset1:17
    v_mfma_f32_16x16x32_bf16 v[52:55], v[84:87], v[96:99], v[52:55]
    v_mfma_f32_16x16x32_bf16 v[48:51], v[64:67], v[112:115], 0
    ds_read2_b32 v[146:147], v238 offset0:18 offset1:19
    v_cvt_pk_bf16_f32 v194, v36, v37
    v_mfma_f32_16x16x32_bf16 v[48:51], v[68:71], v[108:111], v[48:51]
    ds_read_b128 v[180:183], v245 offset:22528
    v_mfma_f32_16x16x32_bf16 v[48:51], v[72:75], v[104:107], v[48:51]
    v_cvt_pk_bf16_f32 v195, v38, v39
    v_mfma_f32_16x16x32_bf16 v[48:51], v[76:79], v[100:103], v[48:51]
    ds_read2_b32 v[148:149], v238 offset0:144 offset1:145
    v_mfma_f32_16x16x32_bf16 v[48:51], v[80:83], v[96:99], v[48:51]
    buffer_store_dwordx2 v[194:195], v8, s[44:47], s6 offen offset:512 sc1
    ds_read2_b32 v[150:151], v238 offset0:146 offset1:147
    v_mfma_f32_16x16x32_bf16 v[44:47], v[64:67], v[108:111], 0
    ds_read_b128 v[184:187], v245 offset:26624
    v_mfma_f32_16x16x32_bf16 v[44:47], v[68:71], v[104:107], v[44:47]
    v_cvt_pk_bf16_f32 v192, v32, v33
    v_mfma_f32_16x16x32_bf16 v[44:47], v[72:75], v[100:103], v[44:47]
    s_add_u32 m0, s73, 147456
    ds_read2_b32 v[152:153], v239 offset0:16 offset1:17
    v_mfma_f32_16x16x32_bf16 v[44:47], v[76:79], v[96:99], v[44:47]
    buffer_load_dwordx4 v6, s[52:55], s14 offen offset:2048 lds
    v_cvt_pk_bf16_f32 v193, v34, v35
    v_mfma_f32_16x16x32_bf16 v[40:43], v[64:67], v[104:107], 0
    ds_read2_b32 v[154:155], v239 offset0:18 offset1:19
    v_mfma_f32_16x16x32_bf16 v[40:43], v[68:71], v[100:103], v[40:43]
    buffer_store_dwordx2 v[192:193], v8, s[44:47], s6 offen offset:0 sc1
    ds_read_b128 v[188:191], v245 offset:30720
    v_mfma_f32_16x16x32_bf16 v[40:43], v[72:75], v[96:99], v[40:43]
    ds_read2_b32 v[156:157], v239 offset0:144 offset1:145
    v_mfma_f32_16x16x32_bf16 v[36:39], v[64:67], v[100:103], 0
    v_mfma_f32_16x16x32_bf16 v[36:39], v[68:71], v[96:99], v[36:39]
    ds_read2_b32 v[158:159], v239 offset0:146 offset1:147
    v_mfma_f32_16x16x32_bf16 v[32:35], v[64:67], v[96:99], 0
    s_waitcnt lgkmcnt(12)
    v_mfma_f32_16x16x32_bf16 v[32:35], v[128:131], v[160:163], v[32:35]
    ds_read_b128 v[96:99], v246 offset:2048
    v_mfma_f32_16x16x32_bf16 v[36:39], v[132:135], v[160:163], v[36:39]
    v_mfma_f32_16x16x32_bf16 v[36:39], v[128:131], v[164:167], v[36:39]
    ds_read2_b32 v[64:65], v236 offset0:32 offset1:33
    v_mfma_f32_16x16x32_bf16 v[40:43], v[128:131], v[168:171], v[40:43]
    s_add_u32 m0, s73, 147456
    ds_read2_b32 v[66:67], v236 offset0:34 offset1:35
    s_add_u32 s13, s12, 32768
    v_mfma_f32_16x16x32_bf16 v[40:43], v[132:135], v[164:167], v[40:43]
    buffer_load_dwordx4 v7, s[52:55], s14 offen offset:3072 lds
    ds_read_b128 v[100:103], v246 offset:6144
    v_mfma_f32_16x16x32_bf16 v[40:43], v[136:139], v[160:163], v[40:43]
    s_add_u32 m0, s74, 32
    ds_read2_b32 v[68:69], v236 offset0:160 offset1:161
    v_mfma_f32_16x16x32_bf16 v[44:47], v[140:143], v[160:163], v[44:47]
    buffer_load_dwordx4 v240, s[48:51], s13 offen offset:0 lds
    ds_read2_b32 v[70:71], v236 offset0:162 offset1:163
    v_mfma_f32_16x16x32_bf16 v[44:47], v[136:139], v[164:167], v[44:47]
    ds_read_b128 v[104:107], v246 offset:10240
    v_mfma_f32_16x16x32_bf16 v[44:47], v[132:135], v[168:171], v[44:47]
    ds_read2_b32 v[72:73], v237 offset0:32 offset1:33
    v_mfma_f32_16x16x32_bf16 v[44:47], v[128:131], v[172:175], v[44:47]
    ds_read2_b32 v[74:75], v237 offset0:34 offset1:35
    s_waitcnt lgkmcnt(9)
    v_mfma_f32_16x16x32_bf16 v[48:51], v[128:131], v[176:179], v[48:51]
    ds_read_b128 v[108:111], v246 offset:14336
    v_mfma_f32_16x16x32_bf16 v[48:51], v[132:135], v[172:175], v[48:51]
    ds_read2_b32 v[76:77], v237 offset0:160 offset1:161
    v_mfma_f32_16x16x32_bf16 v[48:51], v[136:139], v[168:171], v[48:51]
    ds_read2_b32 v[78:79], v237 offset0:162 offset1:163
    v_mfma_f32_16x16x32_bf16 v[48:51], v[140:143], v[164:167], v[48:51]
    s_add_u32 m0, s74, 32
    ds_read_b128 v[112:115], v246 offset:18432
    v_mfma_f32_16x16x32_bf16 v[48:51], v[144:147], v[160:163], v[48:51]
    s_waitcnt vmcnt(13)
    s_barrier
    buffer_load_dwordx4 v240, s[48:51], s13 offen offset:1024 lds
    v_mfma_f32_16x16x32_bf16 v[52:55], v[148:151], v[160:163], v[52:55]
    ds_read2_b32 v[80:81], v238 offset0:32 offset1:33
    v_add_u32 v10, -131072, v10
    v_mfma_f32_16x16x32_bf16 v[52:55], v[144:147], v[164:167], v[52:55]
    ds_read_b64_tr_b16 a[48:49], v10 offset:49152
    v_mfma_f32_16x16x32_bf16 v[52:55], v[140:143], v[168:171], v[52:55]
    ds_read_b64_tr_b16 a[50:51], v10 offset:51200
    v_mfma_f32_16x16x32_bf16 v[52:55], v[136:139], v[172:175], v[52:55]
    ds_read2_b32 v[82:83], v238 offset0:34 offset1:35
    v_mfma_f32_16x16x32_bf16 v[52:55], v[132:135], v[176:179], v[52:55]
    ds_read_b64_tr_b16 a[56:57], v10 offset:53248
    v_mfma_f32_16x16x32_bf16 v[52:55], v[128:131], v[180:183], v[52:55]
    ds_read_b64_tr_b16 a[58:59], v10 offset:55296
    v_mfma_f32_16x16x32_bf16 v[56:59], v[128:131], v[184:187], v[56:59]
    v_add_u32 v11, -131072, v11
    s_add_u32 m0, s74, 32
    v_mfma_f32_16x16x32_bf16 v[56:59], v[132:135], v[180:183], v[56:59]
    ds_read_b64_tr_b16 a[52:53], v11 offset:49152
    buffer_load_dwordx4 v240, s[48:51], s13 offen offset:2048 lds
    v_mfma_f32_16x16x32_bf16 v[56:59], v[136:139], v[176:179], v[56:59]
    ds_read_b64_tr_b16 a[54:55], v11 offset:51200
    v_mfma_f32_16x16x32_bf16 v[56:59], v[140:143], v[172:175], v[56:59]
    ds_read_b128 v[116:119], v246 offset:22528
    v_mfma_f32_16x16x32_bf16 v[56:59], v[144:147], v[168:171], v[56:59]
    ds_read_b64_tr_b16 a[60:61], v11 offset:53248
    v_mfma_f32_16x16x32_bf16 v[56:59], v[148:151], v[164:167], v[56:59]
    ds_read_b64_tr_b16 a[62:63], v11 offset:55296
    v_mfma_f32_16x16x32_bf16 v[56:59], v[152:155], v[160:163], v[56:59]
    ds_read2_b32 v[84:85], v238 offset0:160 offset1:161
    v_mfma_f32_16x16x32_bf16 v[60:63], v[156:159], v[160:163], v[60:63]
    ds_read2_b32 v[86:87], v238 offset0:162 offset1:163
    v_mfma_f32_16x16x32_bf16 v[60:63], v[152:155], v[164:167], v[60:63]
    s_add_u32 m0, s74, 32
    ds_read_b128 v[120:123], v246 offset:26624
    v_mfma_f32_16x16x32_bf16 v[60:63], v[148:151], v[168:171], v[60:63]
    buffer_load_dwordx4 v240, s[48:51], s13 offen offset:3072 lds
    ds_read2_b32 v[88:89], v239 offset0:32 offset1:33
    v_mfma_f32_16x16x32_bf16 v[60:63], v[144:147], v[172:175], v[60:63]
    ds_read2_b32 v[90:91], v239 offset0:34 offset1:35
    v_mfma_f32_16x16x32_bf16 v[60:63], v[140:143], v[176:179], v[60:63]
    ds_read_b128 v[124:127], v246 offset:30720
    v_mfma_f32_16x16x32_bf16 v[60:63], v[136:139], v[180:183], v[60:63]
    ds_read2_b32 v[92:93], v239 offset0:160 offset1:161
    v_mfma_f32_16x16x32_bf16 v[60:63], v[132:135], v[184:187], v[60:63]
    ds_read2_b32 v[94:95], v239 offset0:162 offset1:163
    v_mfma_f32_16x16x32_bf16 v[60:63], v[128:131], v[188:191], v[60:63]
    s_waitcnt lgkmcnt(15)
    v_mfma_f32_16x16x32_bf16 v[32:35], v[64:67], v[96:99], v[32:35]
    ds_read_b128 v[160:163], v247 offset:2048
    v_mfma_f32_16x16x32_bf16 v[36:39], v[68:71], v[96:99], v[36:39]
    v_mfma_f32_16x16x32_bf16 v[36:39], v[64:67], v[100:103], v[36:39]
    ds_read2_b32 v[128:129], v236 offset0:48 offset1:49
    v_mfma_f32_16x16x32_bf16 v[40:43], v[64:67], v[104:107], v[40:43]
    ds_read2_b32 v[130:131], v236 offset0:50 offset1:51
    v_mfma_f32_16x16x32_bf16 v[40:43], v[68:71], v[100:103], v[40:43]
    v_mfma_f32_16x16x32_bf16 v[40:43], v[72:75], v[96:99], v[40:43]
    ds_read_b128 v[164:167], v247 offset:6144
    v_mfma_f32_16x16x32_bf16 v[44:47], v[76:79], v[96:99], v[44:47]
    ds_read2_b32 v[132:133], v236 offset0:176 offset1:177
    v_mfma_f32_16x16x32_bf16 v[44:47], v[72:75], v[100:103], v[44:47]
    ds_read2_b32 v[134:135], v236 offset0:178 offset1:179
    s_waitcnt lgkmcnt(14)
    s_barrier
    v_mfma_f32_16x16x32_bf16 v[44:47], v[68:71], v[104:107], v[44:47]
    ds_read_b128 v[168:171], v247 offset:10240
    v_mfma_f32_16x16x32_bf16 v[44:47], v[64:67], v[108:111], v[44:47]
    v_mov_b32 v9, 16
    buffer_load_ushort v9, v9, s[56:59], s70 offen
    s_waitcnt lgkmcnt(7)
    v_mfma_f32_16x16x32_bf16 v[48:51], v[64:67], v[112:115], v[48:51]
    ds_read2_b32 v[136:137], v237 offset0:48 offset1:49
    v_mfma_f32_16x16x32_bf16 v[48:51], v[68:71], v[108:111], v[48:51]
    v_mfma_f32_16x16x32_bf16 v[48:51], v[72:75], v[104:107], v[48:51]
    ds_read2_b32 v[138:139], v237 offset0:50 offset1:51
    v_mfma_f32_16x16x32_bf16 v[48:51], v[76:79], v[100:103], v[48:51]
    ds_read_b128 v[172:175], v247 offset:14336
    v_mfma_f32_16x16x32_bf16 v[48:51], v[80:83], v[96:99], v[48:51]
    v_mfma_f32_16x16x32_bf16 v[52:55], v[84:87], v[96:99], v[52:55]
    ds_read2_b32 v[140:141], v237 offset0:176 offset1:177
    v_mfma_f32_16x16x32_bf16 v[52:55], v[80:83], v[100:103], v[52:55]
    ds_read2_b32 v[142:143], v237 offset0:178 offset1:179
    v_mfma_f32_16x16x32_bf16 v[52:55], v[76:79], v[104:107], v[52:55]
    v_mfma_f32_16x16x32_bf16 v[52:55], v[72:75], v[108:111], v[52:55]
    ds_read_b128 v[176:179], v247 offset:18432
    v_mfma_f32_16x16x32_bf16 v[52:55], v[68:71], v[112:115], v[52:55]
    ds_read2_b32 v[144:145], v238 offset0:48 offset1:49
    v_mfma_f32_16x16x32_bf16 v[52:55], v[64:67], v[116:119], v[52:55]
    v_mfma_f32_16x16x32_bf16 v[56:59], v[64:67], v[120:123], v[56:59]
    ds_read2_b32 v[146:147], v238 offset0:50 offset1:51
    v_mfma_f32_16x16x32_bf16 v[56:59], v[68:71], v[116:119], v[56:59]
    ds_read_b128 v[180:183], v247 offset:22528
    v_mfma_f32_16x16x32_bf16 v[56:59], v[72:75], v[112:115], v[56:59]
    v_mfma_f32_16x16x32_bf16 v[56:59], v[76:79], v[108:111], v[56:59]
    ds_read2_b32 v[148:149], v238 offset0:176 offset1:177
    v_mfma_f32_16x16x32_bf16 v[56:59], v[80:83], v[104:107], v[56:59]
    ds_read2_b32 v[150:151], v238 offset0:178 offset1:179
    v_mfma_f32_16x16x32_bf16 v[56:59], v[84:87], v[100:103], v[56:59]
    ds_read_b128 v[184:187], v247 offset:26624
    v_mfma_f32_16x16x32_bf16 v[56:59], v[88:91], v[96:99], v[56:59]
    v_mfma_f32_16x16x32_bf16 v[60:63], v[92:95], v[96:99], v[60:63]
    ds_read2_b32 v[152:153], v239 offset0:48 offset1:49
    v_mfma_f32_16x16x32_bf16 v[60:63], v[88:91], v[100:103], v[60:63]
    ds_read2_b32 v[154:155], v239 offset0:50 offset1:51
    v_mfma_f32_16x16x32_bf16 v[60:63], v[84:87], v[104:107], v[60:63]
    v_mfma_f32_16x16x32_bf16 v[60:63], v[80:83], v[108:111], v[60:63]
    ds_read_b128 v[188:191], v247 offset:30720
    v_mfma_f32_16x16x32_bf16 v[60:63], v[76:79], v[112:115], v[60:63]
    ds_read2_b32 v[156:157], v239 offset0:176 offset1:177
    v_mfma_f32_16x16x32_bf16 v[60:63], v[72:75], v[116:119], v[60:63]
    v_mfma_f32_16x16x32_bf16 v[60:63], v[68:71], v[120:123], v[60:63]
    ds_read2_b32 v[158:159], v239 offset0:178 offset1:179
    v_mfma_f32_16x16x32_bf16 v[60:63], v[64:67], v[124:127], v[60:63]
    s_waitcnt lgkmcnt(12)
    v_mfma_f32_16x16x32_bf16 v[32:35], v[128:131], v[160:163], v[32:35]
    ds_read_b128 v[96:99], v244 offset:0
    v_mfma_f32_16x16x32_bf16 v[36:39], v[132:135], v[160:163], v[36:39]
    ds_read2_b32 v[64:65], v236 offset0:64 offset1:65
    v_mfma_f32_16x16x32_bf16 v[36:39], v[128:131], v[164:167], v[36:39]
    ds_read2_b32 v[66:67], v236 offset0:66 offset1:67
    v_mfma_f32_16x16x32_bf16 v[40:43], v[128:131], v[168:171], v[40:43]
    ds_read_b128 v[100:103], v244 offset:4096
    v_mfma_f32_16x16x32_bf16 v[40:43], v[132:135], v[164:167], v[40:43]
    ds_read2_b32 v[68:69], v236 offset0:192 offset1:193
    v_mfma_f32_16x16x32_bf16 v[40:43], v[136:139], v[160:163], v[40:43]
    ds_read2_b32 v[70:71], v236 offset0:194 offset1:195
    v_mfma_f32_16x16x32_bf16 v[44:47], v[140:143], v[160:163], v[44:47]
    ds_read_b128 v[104:107], v244 offset:8192
    v_mfma_f32_16x16x32_bf16 v[44:47], v[136:139], v[164:167], v[44:47]
    ds_read2_b32 v[72:73], v237 offset0:64 offset1:65
    s_add_u32 m0, s9, 36864
    s_add_u32 s13, s7, 128
    v_mfma_f32_16x16x32_bf16 v[44:47], v[132:135], v[168:171], v[44:47]
    buffer_load_dwordx4 v24, s[44:47], s13 offen sc1 lds
    ds_read2_b32 v[74:75], v237 offset0:66 offset1:67
    v_mfma_f32_16x16x32_bf16 v[44:47], v[128:131], v[172:175], v[44:47]
    ds_read_b128 v[108:111], v244 offset:12288
    s_waitcnt lgkmcnt(10)
    v_mfma_f32_16x16x32_bf16 v[48:51], v[128:131], v[176:179], v[48:51]
    ds_read2_b32 v[76:77], v237 offset0:192 offset1:193
    v_mfma_f32_16x16x32_bf16 v[48:51], v[132:135], v[172:175], v[48:51]
    ds_read2_b32 v[78:79], v237 offset0:194 offset1:195
    v_mfma_f32_16x16x32_bf16 v[48:51], v[136:139], v[168:171], v[48:51]
    ds_read_b128 v[112:115], v244 offset:16384
    v_mfma_f32_16x16x32_bf16 v[48:51], v[140:143], v[164:167], v[48:51]
    ds_read2_b32 v[80:81], v238 offset0:64 offset1:65
    v_mfma_f32_16x16x32_bf16 v[48:51], v[144:147], v[160:163], v[48:51]
    ds_read2_b32 v[82:83], v238 offset0:66 offset1:67
    v_mfma_f32_16x16x32_bf16 v[52:55], v[148:151], v[160:163], v[52:55]
    ds_read_b128 v[116:119], v244 offset:20480
    v_mfma_f32_16x16x32_bf16 v[52:55], v[144:147], v[164:167], v[52:55]
    ds_read2_b32 v[84:85], v238 offset0:192 offset1:193
    s_add_u32 m0, s9, 37888
    s_add_u32 s13, s7, 73856
    v_mfma_f32_16x16x32_bf16 v[52:55], v[140:143], v[168:171], v[52:55]
    buffer_load_dwordx4 v25, s[44:47], s13 offen sc1 lds
    ds_read2_b32 v[86:87], v238 offset0:194 offset1:195
    s_waitcnt vmcnt(3)
    v_mfma_f32_16x16x32_bf16 v[52:55], v[136:139], v[172:175], v[52:55]
    ds_read_b128 v[120:123], v244 offset:24576
    v_mfma_f32_16x16x32_bf16 v[52:55], v[132:135], v[176:179], v[52:55]
    ds_read_b128 v[212:215], v241 offset:32
    v_mfma_f32_16x16x32_bf16 v[52:55], v[128:131], v[180:183], v[52:55]
    ds_read2_b32 v[88:89], v239 offset0:64 offset1:65
    v_mfma_f32_16x16x32_bf16 v[56:59], v[128:131], v[184:187], v[56:59]
    ds_read_b32 v216, v241 offset:48
    s_barrier
    v_mfma_f32_16x16x32_bf16 v[56:59], v[132:135], v[180:183], v[56:59]
    ds_read_b128 v[218:221], v241 offset:1056
    v_add_u32 v10, 131072, v10
    v_mfma_f32_16x16x32_bf16 v[56:59], v[136:139], v[176:179], v[56:59]
    ds_read_b64_tr_b16 a[64:65], v10 offset:16384
    v_mfma_f32_16x16x32_bf16 v[56:59], v[140:143], v[172:175], v[56:59]
    ds_read_b32 v222, v241 offset:1072
    v_mfma_f32_16x16x32_bf16 v[56:59], v[144:147], v[168:171], v[56:59]
    ds_read_b64_tr_b16 a[66:67], v10 offset:18432
    s_add_u32 m0, s9, 38912
    s_add_u32 s13, s7, 147584
    v_mfma_f32_16x16x32_bf16 v[56:59], v[148:151], v[164:167], v[56:59]
    ds_read_b64_tr_b16 a[72:73], v10 offset:20480
    buffer_load_dwordx4 v24, s[44:47], s13 offen sc1 lds
    v_mfma_f32_16x16x32_bf16 v[56:59], v[152:155], v[160:163], v[56:59]
    ds_read_b64_tr_b16 a[74:75], v10 offset:22528
    v_mfma_f32_16x16x32_bf16 v[60:63], v[156:159], v[160:163], v[60:63]
    ds_read_b128 v[224:227], v241 offset:2080
    v_add_u32 v11, 131072, v11
    v_mfma_f32_16x16x32_bf16 v[60:63], v[152:155], v[164:167], v[60:63]
    ds_read_b64_tr_b16 a[68:69], v11 offset:16384
    ds_read2_b32 v[90:91], v239 offset0:66 offset1:67
    v_mfma_f32_16x16x32_bf16 v[60:63], v[148:151], v[168:171], v[60:63]
    ds_read_b32 v228, v241 offset:2096
    v_mfma_f32_16x16x32_bf16 v[60:63], v[144:147], v[172:175], v[60:63]
    ds_read_b64_tr_b16 a[70:71], v11 offset:18432
    ds_read_b128 v[124:127], v244 offset:28672
    v_mfma_f32_16x16x32_bf16 v[60:63], v[140:143], v[176:179], v[60:63]
    ds_read_b64_tr_b16 a[76:77], v11 offset:20480
    ds_read2_b32 v[92:93], v239 offset0:192 offset1:193
    v_mfma_f32_16x16x32_bf16 v[60:63], v[136:139], v[180:183], v[60:63]
    ds_read_b64_tr_b16 a[78:79], v11 offset:22528
    ds_read2_b32 v[94:95], v239 offset0:194 offset1:195
    v_mfma_f32_16x16x32_bf16 v[60:63], v[132:135], v[184:187], v[60:63]
    ds_read_b128 v[230:233], v241 offset:3104
    s_add_u32 m0, s9, 39936
    s_add_u32 s13, s7, 221312
    v_mfma_f32_16x16x32_bf16 v[60:63], v[128:131], v[188:191], v[60:63]
    buffer_load_dwordx4 v25, s[44:47], s13 offen sc1 lds
    ds_read_b32 v234, v241 offset:3120
    s_waitcnt lgkmcnt(15)
    v_mfma_f32_16x16x32_bf16 v[32:35], v[64:67], v[96:99], v[32:35]
    ds_read_b128 v[160:163], v245 offset:0
    s_waitcnt lgkmcnt(4)
    s_barrier
    v_mfma_f32_16x16x32_bf16 v[36:39], v[68:71], v[96:99], v[36:39]
    v_mfma_f32_16x16x32_bf16 v[36:39], v[64:67], v[100:103], v[36:39]
    ds_read2_b32 v[128:129], v236 offset0:80 offset1:81
    v_mfma_f32_16x16x32_bf16 v[40:43], v[64:67], v[104:107], v[40:43]
    s_lshl_b32 s14, s89, 18
    ds_read2_b32 v[130:131], v236 offset0:82 offset1:83
    v_mfma_f32_16x16x32_bf16 v[40:43], v[68:71], v[100:103], v[40:43]
    s_add_u32 m0, s73, 147456
    s_waitcnt lgkmcnt(3)
    v_mfma_f32_16x16x32_bf16 v[40:43], v[72:75], v[96:99], v[40:43]
    buffer_load_dwordx4 v4, s[52:55], s14 offen offset:0 lds
    ds_read_b128 v[164:167], v245 offset:4096
    v_mfma_f32_16x16x32_bf16 v[44:47], v[76:79], v[96:99], v[44:47]
    s_waitcnt vmcnt(5)
    ds_read2_b32 v[132:133], v236 offset0:208 offset1:209
    v_mfma_f32_16x16x32_bf16 v[44:47], v[72:75], v[100:103], v[44:47]
    ds_read2_b32 v[134:135], v236 offset0:210 offset1:211
    s_add_u32 m0, s9, 40960
    s_add_u32 s13, s7, 295040
    v_mfma_f32_16x16x32_bf16 v[44:47], v[68:71], v[104:107], v[44:47]
    buffer_load_dwordx4 v24, s[44:47], s13 offen sc1 lds
    v_lshlrev_b32 v9, 16, v9
    v_mfma_f32_16x16x32_bf16 v[44:47], v[64:67], v[108:111], v[44:47]
    ds_read_b128 v[168:171], v245 offset:8192
    v_mfma_f32_16x16x32_bf16 v[48:51], v[64:67], v[112:115], v[48:51]
    ds_read2_b32 v[136:137], v237 offset0:80 offset1:81
    v_lshlrev_b32 v208, 16, v212
    v_mfma_f32_16x16x32_bf16 v[48:51], v[68:71], v[108:111], v[48:51]
    v_mfma_f32_16x16x32_bf16 v[48:51], v[72:75], v[104:107], v[48:51]
    ds_read2_b32 v[138:139], v237 offset0:82 offset1:83
    v_add_f32 v9, v9, v208
    v_mfma_f32_16x16x32_bf16 v[48:51], v[76:79], v[100:103], v[48:51]
    ds_read_b128 v[172:175], v245 offset:12288
    v_cvt_pk_bf16_f32 v9, v9, v9
L_pl_X_3:
    s_cbranch_execz L_pl_X_7
    v_mfma_f32_16x16x32_bf16 v[48:51], v[80:83], v[96:99], v[48:51]
    ds_write_b16 v242, v9 offset:4160
    v_mfma_f32_16x16x32_bf16 v[52:55], v[84:87], v[96:99], v[52:55]
    ds_write_b16 v242, v9 offset:2
    v_mfma_f32_16x16x32_bf16 v[52:55], v[80:83], v[100:103], v[52:55]
    s_add_u32 m0, s73, 147456
    ds_read2_b32 v[140:141], v237 offset0:208 offset1:209
    v_mfma_f32_16x16x32_bf16 v[52:55], v[76:79], v[104:107], v[52:55]
    buffer_load_dwordx4 v5, s[52:55], s14 offen offset:1024 lds
    ds_read2_b32 v[142:143], v237 offset0:210 offset1:211
    v_mfma_f32_16x16x32_bf16 v[52:55], v[72:75], v[108:111], v[52:55]
    ds_read_b128 v[176:179], v245 offset:16384
    s_add_u32 m0, s9, 41984
    s_add_u32 s13, s7, 368768
    v_mfma_f32_16x16x32_bf16 v[52:55], v[68:71], v[112:115], v[52:55]
    buffer_load_dwordx4 v25, s[44:47], s13 offen sc1 lds
    v_alignbit_b32 v212, v213, v212, 16
    v_mfma_f32_16x16x32_bf16 v[52:55], v[64:67], v[116:119], v[52:55]
    ds_read2_b32 v[144:145], v238 offset0:80 offset1:81
    v_alignbit_b32 v213, v214, v213, 16
    v_mfma_f32_16x16x32_bf16 v[56:59], v[64:67], v[120:123], v[56:59]
    ds_read2_b32 v[146:147], v238 offset0:82 offset1:83
    v_mfma_f32_16x16x32_bf16 v[56:59], v[68:71], v[116:119], v[56:59]
    ds_read_b128 v[180:183], v245 offset:20480
    v_alignbit_b32 v214, v215, v214, 16
    v_mfma_f32_16x16x32_bf16 v[56:59], v[72:75], v[112:115], v[56:59]
    v_mfma_f32_16x16x32_bf16 v[56:59], v[76:79], v[108:111], v[56:59]
    ds_read2_b32 v[148:149], v238 offset0:208 offset1:209
    v_alignbit_b32 v215, v216, v215, 16
    v_mfma_f32_16x16x32_bf16 v[56:59], v[80:83], v[104:107], v[56:59]
    ds_read2_b32 v[150:151], v238 offset0:210 offset1:211
    s_add_u32 m0, s9, 43008
    s_add_u32 s13, s7, 442496
    v_mfma_f32_16x16x32_bf16 v[56:59], v[84:87], v[100:103], v[56:59]
    buffer_load_dwordx4 v24, s[44:47], s13 offen sc1 lds
    ds_read_b128 v[184:187], v245 offset:24576
    v_mfma_f32_16x16x32_bf16 v[56:59], v[88:91], v[96:99], v[56:59]
    ds_write_b128 v241, v[212:215] offset:4192
    v_mfma_f32_16x16x32_bf16 v[60:63], v[92:95], v[96:99], v[60:63]
    ds_read2_b32 v[152:153], v239 offset0:80 offset1:81
    s_add_u32 m0, s73, 147456
    v_alignbit_b32 v218, v219, v218, 16
    v_mfma_f32_16x16x32_bf16 v[60:63], v[88:91], v[100:103], v[60:63]
    buffer_load_dwordx4 v6, s[52:55], s14 offen offset:2048 lds
    v_alignbit_b32 v219, v220, v219, 16
    v_mfma_f32_16x16x32_bf16 v[60:63], v[84:87], v[104:107], v[60:63]
    ds_read2_b32 v[154:155], v239 offset0:82 offset1:83
    v_mfma_f32_16x16x32_bf16 v[60:63], v[80:83], v[108:111], v[60:63]
    ds_read_b128 v[188:191], v245 offset:28672
    v_alignbit_b32 v220, v221, v220, 16
    v_mfma_f32_16x16x32_bf16 v[60:63], v[76:79], v[112:115], v[60:63]
    ds_read2_b32 v[156:157], v239 offset0:208 offset1:209
    v_alignbit_b32 v221, v222, v221, 16
    v_mfma_f32_16x16x32_bf16 v[60:63], v[72:75], v[116:119], v[60:63]
    ds_write_b128 v241, v[218:221] offset:5216
    v_mfma_f32_16x16x32_bf16 v[60:63], v[68:71], v[120:123], v[60:63]
    ds_read2_b32 v[158:159], v239 offset0:210 offset1:211
    s_add_u32 m0, s9, 44032
    s_add_u32 s13, s7, 516224
    v_mfma_f32_16x16x32_bf16 v[60:63], v[64:67], v[124:127], v[60:63]
    buffer_load_dwordx4 v25, s[44:47], s13 offen sc1 lds
    s_waitcnt lgkmcnt(14)
    v_mfma_f32_16x16x32_bf16 v[32:35], v[128:131], v[160:163], v[32:35]
    ds_read_b128 v[96:99], v246 offset:0
    v_mfma_f32_16x16x32_bf16 v[36:39], v[132:135], v[160:163], v[36:39]
    v_alignbit_b32 v224, v225, v224, 16
    v_mfma_f32_16x16x32_bf16 v[36:39], v[128:131], v[164:167], v[36:39]
    ds_read2_b32 v[64:65], v236 offset0:96 offset1:97
    v_mfma_f32_16x16x32_bf16 v[40:43], v[128:131], v[168:171], v[40:43]
    s_add_u32 m0, s73, 147456
    ds_read2_b32 v[66:67], v236 offset0:98 offset1:99
    v_mfma_f32_16x16x32_bf16 v[40:43], v[132:135], v[164:167], v[40:43]
    buffer_load_dwordx4 v7, s[52:55], s14 offen offset:3072 lds
    v_mfma_f32_16x16x32_bf16 v[40:43], v[136:139], v[160:163], v[40:43]
    ds_read_b128 v[100:103], v246 offset:4096
    v_alignbit_b32 v225, v226, v225, 16
    v_mfma_f32_16x16x32_bf16 v[44:47], v[140:143], v[160:163], v[44:47]
    ds_read2_b32 v[68:69], v236 offset0:224 offset1:225
    v_mfma_f32_16x16x32_bf16 v[44:47], v[136:139], v[164:167], v[44:47]
    ds_read2_b32 v[70:71], v236 offset0:226 offset1:227
    v_mfma_f32_16x16x32_bf16 v[44:47], v[132:135], v[168:171], v[44:47]
    ds_read_b128 v[104:107], v246 offset:8192
    v_mfma_f32_16x16x32_bf16 v[44:47], v[128:131], v[172:175], v[44:47]
    v_alignbit_b32 v226, v227, v226, 16
    s_waitcnt lgkmcnt(7)
    v_mfma_f32_16x16x32_bf16 v[48:51], v[128:131], v[176:179], v[48:51]
    ds_read2_b32 v[72:73], v237 offset0:96 offset1:97
    v_mfma_f32_16x16x32_bf16 v[48:51], v[132:135], v[172:175], v[48:51]
    v_mfma_f32_16x16x32_bf16 v[48:51], v[136:139], v[168:171], v[48:51]
    ds_read2_b32 v[74:75], v237 offset0:98 offset1:99
    v_alignbit_b32 v227, v228, v227, 16
    v_mfma_f32_16x16x32_bf16 v[48:51], v[140:143], v[164:167], v[48:51]
    ds_read_b128 v[108:111], v246 offset:12288
    v_mfma_f32_16x16x32_bf16 v[48:51], v[144:147], v[160:163], v[48:51]
    v_mfma_f32_16x16x32_bf16 v[52:55], v[148:151], v[160:163], v[52:55]
    ds_read2_b32 v[76:77], v237 offset0:224 offset1:225
    v_mfma_f32_16x16x32_bf16 v[52:55], v[144:147], v[164:167], v[52:55]
    ds_write_b128 v241, v[224:227] offset:6240
    v_mfma_f32_16x16x32_bf16 v[52:55], v[140:143], v[168:171], v[52:55]
    ds_read2_b32 v[78:79], v237 offset0:226 offset1:227
    v_mfma_f32_16x16x32_bf16 v[52:55], v[136:139], v[172:175], v[52:55]
    ds_read_b128 v[112:115], v246 offset:16384
    v_mfma_f32_16x16x32_bf16 v[52:55], v[132:135], v[176:179], v[52:55]
    ds_read2_b32 v[80:81], v238 offset0:96 offset1:97
    v_alignbit_b32 v230, v231, v230, 16
    v_mfma_f32_16x16x32_bf16 v[52:55], v[128:131], v[180:183], v[52:55]
    v_mfma_f32_16x16x32_bf16 v[56:59], v[128:131], v[184:187], v[56:59]
    ds_read2_b32 v[82:83], v238 offset0:98 offset1:99
    v_mfma_f32_16x16x32_bf16 v[56:59], v[132:135], v[180:183], v[56:59]
    ds_read_b128 v[116:119], v246 offset:20480
    v_mfma_f32_16x16x32_bf16 v[56:59], v[136:139], v[176:179], v[56:59]
    v_alignbit_b32 v231, v232, v231, 16
    v_mfma_f32_16x16x32_bf16 v[56:59], v[140:143], v[172:175], v[56:59]
    ds_read2_b32 v[84:85], v238 offset0:224 offset1:225
    v_mfma_f32_16x16x32_bf16 v[56:59], v[144:147], v[168:171], v[56:59]
    ds_read2_b32 v[86:87], v238 offset0:226 offset1:227
    v_mfma_f32_16x16x32_bf16 v[56:59], v[148:151], v[164:167], v[56:59]
    ds_read_b128 v[120:123], v246 offset:24576
    v_mfma_f32_16x16x32_bf16 v[56:59], v[152:155], v[160:163], v[56:59]
    v_alignbit_b32 v232, v233, v232, 16
    v_mfma_f32_16x16x32_bf16 v[60:63], v[156:159], v[160:163], v[60:63]
    ds_read2_b32 v[88:89], v239 offset0:96 offset1:97
    v_mfma_f32_16x16x32_bf16 v[60:63], v[152:155], v[164:167], v[60:63]
    ds_read2_b32 v[90:91], v239 offset0:98 offset1:99
    v_mfma_f32_16x16x32_bf16 v[60:63], v[148:151], v[168:171], v[60:63]
    v_alignbit_b32 v233, v234, v233, 16
    v_mfma_f32_16x16x32_bf16 v[60:63], v[144:147], v[172:175], v[60:63]
    ds_read_b128 v[124:127], v246 offset:28672
    v_mfma_f32_16x16x32_bf16 v[60:63], v[140:143], v[176:179], v[60:63]
    ds_read2_b32 v[92:93], v239 offset0:224 offset1:225
    v_mfma_f32_16x16x32_bf16 v[60:63], v[136:139], v[180:183], v[60:63]
    ds_read2_b32 v[94:95], v239 offset0:226 offset1:227
    v_mfma_f32_16x16x32_bf16 v[60:63], v[132:135], v[184:187], v[60:63]
    ds_write_b128 v241, v[230:233] offset:7264
    v_mfma_f32_16x16x32_bf16 v[60:63], v[128:131], v[188:191], v[60:63]
    s_waitcnt lgkmcnt(13)
    v_mfma_f32_16x16x32_bf16 v[32:35], v[64:67], v[96:99], v[32:35]
    ds_read_b128 v[160:163], v247 offset:0
    v_mfma_f32_16x16x32_bf16 v[36:39], v[68:71], v[96:99], v[36:39]
    v_mfma_f32_16x16x32_bf16 v[36:39], v[64:67], v[100:103], v[36:39]
    ds_read_b128 v[164:167], v247 offset:4096
    v_mfma_f32_16x16x32_bf16 v[40:43], v[64:67], v[104:107], v[40:43]
    ds_read_b128 v[168:171], v247 offset:8192
    v_mfma_f32_16x16x32_bf16 v[40:43], v[68:71], v[100:103], v[40:43]
    ds_read_b128 v[172:175], v247 offset:12288
    v_mfma_f32_16x16x32_bf16 v[40:43], v[72:75], v[96:99], v[40:43]
    v_mfma_f32_16x16x32_bf16 v[44:47], v[76:79], v[96:99], v[44:47]
    ds_read_b128 v[176:179], v247 offset:16384
    v_mfma_f32_16x16x32_bf16 v[44:47], v[72:75], v[100:103], v[44:47]
    ds_read_b128 v[180:183], v247 offset:20480
    v_mfma_f32_16x16x32_bf16 v[44:47], v[68:71], v[104:107], v[44:47]
    v_mfma_f32_16x16x32_bf16 v[44:47], v[64:67], v[108:111], v[44:47]
    ds_read_b128 v[184:187], v247 offset:24576
    s_waitcnt lgkmcnt(8)
    v_mfma_f32_16x16x32_bf16 v[48:51], v[64:67], v[112:115], v[48:51]
    ds_read_b128 v[188:191], v247 offset:28672
    v_mfma_f32_16x16x32_bf16 v[48:51], v[68:71], v[108:111], v[48:51]
    ds_read2_b32 v[128:129], v236 offset0:112 offset1:113
    v_mfma_f32_16x16x32_bf16 v[48:51], v[72:75], v[104:107], v[48:51]
    v_mfma_f32_16x16x32_bf16 v[48:51], v[76:79], v[100:103], v[48:51]
    ds_read2_b32 v[130:131], v236 offset0:114 offset1:115
    v_mfma_f32_16x16x32_bf16 v[48:51], v[80:83], v[96:99], v[48:51]
    ds_read2_b32 v[132:133], v236 offset0:240 offset1:241
    v_mfma_f32_16x16x32_bf16 v[52:55], v[84:87], v[96:99], v[52:55]
    ds_read2_b32 v[134:135], v236 offset0:242 offset1:243
    v_mfma_f32_16x16x32_bf16 v[52:55], v[80:83], v[100:103], v[52:55]
    ds_read2_b32 v[136:137], v237 offset0:112 offset1:113
    v_mfma_f32_16x16x32_bf16 v[52:55], v[76:79], v[104:107], v[52:55]
    ds_read2_b32 v[138:139], v237 offset0:114 offset1:115
    v_mfma_f32_16x16x32_bf16 v[52:55], v[72:75], v[108:111], v[52:55]
    s_add_u32 s6, s12, 4734976
    ds_read2_b32 v[140:141], v237 offset0:240 offset1:241
    v_mfma_f32_16x16x32_bf16 v[52:55], v[68:71], v[112:115], v[52:55]
    ds_read2_b32 v[142:143], v237 offset0:242 offset1:243
    v_xor_b32 v244, 64, v244
    v_mfma_f32_16x16x32_bf16 v[52:55], v[64:67], v[116:119], v[52:55]
    ds_read2_b32 v[144:145], v238 offset0:112 offset1:113
    v_mfma_f32_16x16x32_bf16 v[56:59], v[64:67], v[120:123], v[56:59]
    v_xor_b32 v245, 64, v245
    v_mfma_f32_16x16x32_bf16 v[56:59], v[68:71], v[116:119], v[56:59]
    ds_read2_b32 v[146:147], v238 offset0:114 offset1:115
    v_mfma_f32_16x16x32_bf16 v[56:59], v[72:75], v[112:115], v[56:59]
    ds_read2_b32 v[148:149], v238 offset0:240 offset1:241
    v_xor_b32 v246, 64, v246
    v_mfma_f32_16x16x32_bf16 v[56:59], v[76:79], v[108:111], v[56:59]
    ds_read2_b32 v[150:151], v238 offset0:242 offset1:243
    v_mfma_f32_16x16x32_bf16 v[56:59], v[80:83], v[104:107], v[56:59]
    ds_read2_b32 v[152:153], v239 offset0:112 offset1:113
    v_xor_b32 v247, 64, v247
    v_mfma_f32_16x16x32_bf16 v[56:59], v[84:87], v[100:103], v[56:59]
    ds_read2_b32 v[154:155], v239 offset0:114 offset1:115
    v_mfma_f32_16x16x32_bf16 v[56:59], v[88:91], v[96:99], v[56:59]
    ds_read2_b32 v[156:157], v239 offset0:240 offset1:241
    v_mfma_f32_16x16x32_bf16 v[60:63], v[92:95], v[96:99], v[60:63]
    ds_read2_b32 v[158:159], v239 offset0:242 offset1:243
    v_add_u32 v244, 36864, v244
    v_mfma_f32_16x16x32_bf16 v[60:63], v[88:91], v[100:103], v[60:63]
    v_add_u32 v236, -8320, v236
    v_mfma_f32_16x16x32_bf16 v[60:63], v[84:87], v[104:107], v[60:63]
    v_add_u32 v245, 36864, v245
    v_mfma_f32_16x16x32_bf16 v[60:63], v[80:83], v[108:111], v[60:63]
    v_add_u32 v237, -8320, v237
    v_mfma_f32_16x16x32_bf16 v[60:63], v[76:79], v[112:115], v[60:63]
    s_waitcnt vmcnt(1)
    s_barrier
    v_add_u32 v246, 36864, v246
    v_mfma_f32_16x16x32_bf16 v[60:63], v[72:75], v[116:119], v[60:63]
    v_add_u32 v238, -8320, v238
    v_mfma_f32_16x16x32_bf16 v[60:63], v[68:71], v[120:123], v[60:63]
    v_add_u32 v247, 36864, v247
    v_mfma_f32_16x16x32_bf16 v[60:63], v[64:67], v[124:127], v[60:63]
    v_add_u32 v239, -8320, v239
    s_waitcnt lgkmcnt(0)
    v_mfma_f32_16x16x32_bf16 v[60:63], v[128:131], v[188:191], v[60:63]
    ds_read_b128 v[96:99], v244 offset:2048
    v_mfma_f32_16x16x32_bf16 v[60:63], v[132:135], v[184:187], v[60:63]
    ds_read2_b32 v[64:65], v236 offset0:0 offset1:1
    v_mfma_f32_16x16x32_bf16 v[60:63], v[136:139], v[180:183], v[60:63]
    ds_read2_b32 v[66:67], v236 offset0:2 offset1:3
    v_mfma_f32_16x16x32_bf16 v[60:63], v[140:143], v[176:179], v[60:63]
    ds_read_b128 v[100:103], v244 offset:6144
    v_mfma_f32_16x16x32_bf16 v[60:63], v[144:147], v[172:175], v[60:63]
    ds_read2_b32 v[68:69], v236 offset0:128 offset1:129
    v_mfma_f32_16x16x32_bf16 v[60:63], v[148:151], v[168:171], v[60:63]
    ds_read2_b32 v[70:71], v236 offset0:130 offset1:131
    v_mfma_f32_16x16x32_bf16 v[60:63], v[152:155], v[164:167], v[60:63]
    ds_read_b128 v[104:107], v244 offset:10240
    v_mfma_f32_16x16x32_bf16 v[60:63], v[156:159], v[160:163], v[60:63]
    ds_read2_b32 v[72:73], v237 offset0:0 offset1:1
    v_mfma_f32_16x16x32_bf16 v[56:59], v[128:131], v[184:187], v[56:59]
    ds_read2_b32 v[74:75], v237 offset0:2 offset1:3
    v_mfma_f32_16x16x32_bf16 v[56:59], v[132:135], v[180:183], v[56:59]
    ds_read_b128 v[108:111], v244 offset:14336
    v_mfma_f32_16x16x32_bf16 v[56:59], v[136:139], v[176:179], v[56:59]
    ds_read2_b32 v[76:77], v237 offset0:128 offset1:129
    v_mfma_f32_16x16x32_bf16 v[56:59], v[140:143], v[172:175], v[56:59]
    ds_read2_b32 v[78:79], v237 offset0:130 offset1:131
    v_mfma_f32_16x16x32_bf16 v[56:59], v[144:147], v[168:171], v[56:59]
    ds_read_b128 v[112:115], v244 offset:18432
    v_mfma_f32_16x16x32_bf16 v[56:59], v[148:151], v[164:167], v[56:59]
    ds_read2_b32 v[80:81], v238 offset0:0 offset1:1
    v_cvt_pk_bf16_f32 v206, v60, v61
    v_mfma_f32_16x16x32_bf16 v[56:59], v[152:155], v[160:163], v[56:59]
    ds_read2_b32 v[82:83], v238 offset0:2 offset1:3
    v_mfma_f32_16x16x32_bf16 v[52:55], v[128:131], v[180:183], v[52:55]
    ds_read_b128 v[116:119], v244 offset:22528
    v_mfma_f32_16x16x32_bf16 v[52:55], v[132:135], v[176:179], v[52:55]
    ds_read2_b32 v[84:85], v238 offset0:128 offset1:129
    v_cvt_pk_bf16_f32 v207, v62, v63
    v_mfma_f32_16x16x32_bf16 v[52:55], v[136:139], v[172:175], v[52:55]
    ds_read2_b32 v[86:87], v238 offset0:130 offset1:131
    v_mfma_f32_16x16x32_bf16 v[52:55], v[140:143], v[168:171], v[52:55]
    buffer_store_dwordx2 v[206:207], v8, s[44:47], s6 offen offset:3584 sc1
    ds_read_b128 v[120:123], v244 offset:26624
    v_mfma_f32_16x16x32_bf16 v[52:55], v[144:147], v[164:167], v[52:55]
    ds_read2_b32 v[88:89], v239 offset0:0 offset1:1
    v_mfma_f32_16x16x32_bf16 v[52:55], v[148:151], v[160:163], v[52:55]
    ds_read2_b32 v[90:91], v239 offset0:2 offset1:3
    v_mfma_f32_16x16x32_bf16 v[48:51], v[128:131], v[176:179], v[48:51]
    s_waitcnt vmcnt(1)
    s_barrier
    v_cvt_pk_bf16_f32 v204, v56, v57
    v_mfma_f32_16x16x32_bf16 v[48:51], v[132:135], v[172:175], v[48:51]
    ds_read_b128 v[124:127], v244 offset:30720
    v_mfma_f32_16x16x32_bf16 v[48:51], v[136:139], v[168:171], v[48:51]
    ds_read_b64_tr_b16 a[80:81], v10 offset:16384
    v_mfma_f32_16x16x32_bf16 v[48:51], v[140:143], v[164:167], v[48:51]
    ds_read_b64_tr_b16 a[82:83], v10 offset:18432
    v_cvt_pk_bf16_f32 v205, v58, v59
    v_mfma_f32_16x16x32_bf16 v[48:51], v[144:147], v[160:163], v[48:51]
    ds_read_b64_tr_b16 a[88:89], v10 offset:20480
    v_mfma_f32_16x16x32_bf16 v[44:47], v[128:131], v[172:175], v[44:47]
    buffer_store_dwordx2 v[204:205], v8, s[44:47], s6 offen offset:3072 sc1
    ds_read2_b32 v[92:93], v239 offset0:128 offset1:129
    v_mfma_f32_16x16x32_bf16 v[44:47], v[132:135], v[168:171], v[44:47]
    ds_read_b64_tr_b16 a[90:91], v10 offset:22528
    v_mfma_f32_16x16x32_bf16 v[44:47], v[136:139], v[164:167], v[44:47]
    ds_read_b64_tr_b16 a[84:85], v11 offset:16384
    ds_read2_b32 v[94:95], v239 offset0:130 offset1:131
    v_mfma_f32_16x16x32_bf16 v[44:47], v[140:143], v[160:163], v[44:47]
    v_cvt_pk_bf16_f32 v202, v52, v53
    v_mfma_f32_16x16x32_bf16 v[40:43], v[128:131], v[168:171], v[40:43]
    ds_read_b64_tr_b16 a[86:87], v11 offset:18432
    v_mfma_f32_16x16x32_bf16 v[40:43], v[132:135], v[164:167], v[40:43]
    ds_read_b64_tr_b16 a[92:93], v11 offset:20480
    v_mfma_f32_16x16x32_bf16 v[40:43], v[136:139], v[160:163], v[40:43]
    v_cvt_pk_bf16_f32 v203, v54, v55
    v_mfma_f32_16x16x32_bf16 v[36:39], v[128:131], v[164:167], v[36:39]
    ds_read_b64_tr_b16 a[94:95], v11 offset:22528
    v_mfma_f32_16x16x32_bf16 v[36:39], v[132:135], v[160:163], v[36:39]
    buffer_store_dwordx2 v[202:203], v8, s[44:47], s6 offen offset:2560 sc1
    v_mfma_f32_16x16x32_bf16 v[32:35], v[128:131], v[160:163], v[32:35]
    s_waitcnt lgkmcnt(3)
    v_mfma_f32_16x16x32_bf16 v[60:63], v[64:67], v[124:127], 0
    ds_read_b128 v[160:163], v245 offset:2048
    s_waitcnt lgkmcnt(1)
    s_barrier
    v_mfma_f32_16x16x32_bf16 v[60:63], v[68:71], v[120:123], v[60:63]
    v_cvt_pk_bf16_f32 v200, v48, v49
    v_mfma_f32_16x16x32_bf16 v[60:63], v[72:75], v[116:119], v[60:63]
    ds_read2_b32 v[128:129], v236 offset0:16 offset1:17
    v_mfma_f32_16x16x32_bf16 v[60:63], v[76:79], v[112:115], v[60:63]
    ds_read2_b32 v[130:131], v236 offset0:18 offset1:19
    s_lshl_b32 s14, s90, 18
    v_cvt_pk_bf16_f32 v201, v50, v51
    v_mfma_f32_16x16x32_bf16 v[60:63], v[80:83], v[108:111], v[60:63]
    s_add_u32 m0, s73, 147456
    v_mfma_f32_16x16x32_bf16 v[60:63], v[84:87], v[104:107], v[60:63]
    buffer_load_dwordx4 v4, s[52:55], s14 offen offset:0 lds
    ds_read_b128 v[164:167], v245 offset:6144
    v_mfma_f32_16x16x32_bf16 v[60:63], v[88:91], v[100:103], v[60:63]
    buffer_store_dwordx2 v[200:201], v8, s[44:47], s6 offen offset:2048 sc1
    ds_read2_b32 v[132:133], v236 offset0:144 offset1:145
    v_mfma_f32_16x16x32_bf16 v[60:63], v[92:95], v[96:99], v[60:63]
    v_cvt_pk_bf16_f32 v198, v44, v45
    v_mfma_f32_16x16x32_bf16 v[56:59], v[64:67], v[120:123], 0
    ds_read2_b32 v[134:135], v236 offset0:146 offset1:147
    v_mfma_f32_16x16x32_bf16 v[56:59], v[68:71], v[116:119], v[56:59]
    ds_read_b128 v[168:171], v245 offset:10240
    v_mfma_f32_16x16x32_bf16 v[56:59], v[72:75], v[112:115], v[56:59]
    ds_read2_b32 v[136:137], v237 offset0:16 offset1:17
    v_cvt_pk_bf16_f32 v199, v46, v47
    v_mfma_f32_16x16x32_bf16 v[56:59], v[76:79], v[108:111], v[56:59]
    v_mfma_f32_16x16x32_bf16 v[56:59], v[80:83], v[104:107], v[56:59]
    buffer_store_dwordx2 v[198:199], v8, s[44:47], s6 offen offset:1536 sc1
    ds_read2_b32 v[138:139], v237 offset0:18 offset1:19
    v_mfma_f32_16x16x32_bf16 v[56:59], v[84:87], v[100:103], v[56:59]
    ds_read_b128 v[172:175], v245 offset:14336
    v_mfma_f32_16x16x32_bf16 v[56:59], v[88:91], v[96:99], v[56:59]
    v_cvt_pk_bf16_f32 v196, v40, v41
    v_mfma_f32_16x16x32_bf16 v[52:55], v[64:67], v[116:119], 0
    ds_read2_b32 v[140:141], v237 offset0:144 offset1:145
    v_mfma_f32_16x16x32_bf16 v[52:55], v[68:71], v[112:115], v[52:55]
    ds_read2_b32 v[142:143], v237 offset0:146 offset1:147
    s_add_u32 m0, s73, 147456
    v_cvt_pk_bf16_f32 v197, v42, v43
    v_mfma_f32_16x16x32_bf16 v[52:55], v[72:75], v[108:111], v[52:55]
    buffer_load_dwordx4 v5, s[52:55], s14 offen offset:1024 lds
    v_mfma_f32_16x16x32_bf16 v[52:55], v[76:79], v[104:107], v[52:55]
    buffer_store_dwordx2 v[196:197], v8, s[44:47], s6 offen offset:1024 sc1
    ds_read_b128 v[176:179], v245 offset:18432
    v_mfma_f32_16x16x32_bf16 v[52:55], v[80:83], v[100:103], v[52:55]
    ds_read2_b32 v[144:145], v238 offset0:16 offset1:17
    v_mfma_f32_16x16x32_bf16 v[52:55], v[84:87], v[96:99], v[52:55]
    v_mfma_f32_16x16x32_bf16 v[48:51], v[64:67], v[112:115], 0
    ds_read2_b32 v[146:147], v238 offset0:18 offset1:19
    v_cvt_pk_bf16_f32 v194, v36, v37
    v_mfma_f32_16x16x32_bf16 v[48:51], v[68:71], v[108:111], v[48:51]
    ds_read_b128 v[180:183], v245 offset:22528
    v_mfma_f32_16x16x32_bf16 v[48:51], v[72:75], v[104:107], v[48:51]
    v_cvt_pk_bf16_f32 v195, v38, v39
    v_mfma_f32_16x16x32_bf16 v[48:51], v[76:79], v[100:103], v[48:51]
    ds_read2_b32 v[148:149], v238 offset0:144 offset1:145
    v_mfma_f32_16x16x32_bf16 v[48:51], v[80:83], v[96:99], v[48:51]
    buffer_store_dwordx2 v[194:195], v8, s[44:47], s6 offen offset:512 sc1
    ds_read2_b32 v[150:151], v238 offset0:146 offset1:147
    v_mfma_f32_16x16x32_bf16 v[44:47], v[64:67], v[108:111], 0
    ds_read_b128 v[184:187], v245 offset:26624
    v_mfma_f32_16x16x32_bf16 v[44:47], v[68:71], v[104:107], v[44:47]
    v_cvt_pk_bf16_f32 v192, v32, v33
    v_mfma_f32_16x16x32_bf16 v[44:47], v[72:75], v[100:103], v[44:47]
    s_add_u32 m0, s73, 147456
    ds_read2_b32 v[152:153], v239 offset0:16 offset1:17
    v_mfma_f32_16x16x32_bf16 v[44:47], v[76:79], v[96:99], v[44:47]
    buffer_load_dwordx4 v6, s[52:55], s14 offen offset:2048 lds
    v_cvt_pk_bf16_f32 v193, v34, v35
    v_mfma_f32_16x16x32_bf16 v[40:43], v[64:67], v[104:107], 0
    ds_read2_b32 v[154:155], v239 offset0:18 offset1:19
    v_mfma_f32_16x16x32_bf16 v[40:43], v[68:71], v[100:103], v[40:43]
    buffer_store_dwordx2 v[192:193], v8, s[44:47], s6 offen offset:0 sc1
    ds_read_b128 v[188:191], v245 offset:30720
    v_mfma_f32_16x16x32_bf16 v[40:43], v[72:75], v[96:99], v[40:43]
    ds_read2_b32 v[156:157], v239 offset0:144 offset1:145
    v_mfma_f32_16x16x32_bf16 v[36:39], v[64:67], v[100:103], 0
    v_mfma_f32_16x16x32_bf16 v[36:39], v[68:71], v[96:99], v[36:39]
    ds_read2_b32 v[158:159], v239 offset0:146 offset1:147
    v_mfma_f32_16x16x32_bf16 v[32:35], v[64:67], v[96:99], 0
    s_waitcnt lgkmcnt(12)
    v_mfma_f32_16x16x32_bf16 v[32:35], v[128:131], v[160:163], v[32:35]
    ds_read_b128 v[96:99], v246 offset:2048
    v_mfma_f32_16x16x32_bf16 v[36:39], v[132:135], v[160:163], v[36:39]
    v_mfma_f32_16x16x32_bf16 v[36:39], v[128:131], v[164:167], v[36:39]
    ds_read2_b32 v[64:65], v236 offset0:32 offset1:33
    v_mfma_f32_16x16x32_bf16 v[40:43], v[128:131], v[168:171], v[40:43]
    s_barrier
    s_add_u32 m0, s73, 147456
    s_add_u32 s13, s12, 49152
    v_mfma_f32_16x16x32_bf16 v[40:43], v[132:135], v[164:167], v[40:43]
    buffer_load_dwordx4 v7, s[52:55], s14 offen offset:3072 lds
    ds_read2_b32 v[66:67], v236 offset0:34 offset1:35
    v_mfma_f32_16x16x32_bf16 v[40:43], v[136:139], v[160:163], v[40:43]
    s_add_u32 m0, s74, 8352
    ds_read_b128 v[100:103], v246 offset:6144
    v_mfma_f32_16x16x32_bf16 v[44:47], v[140:143], v[160:163], v[44:47]
    buffer_load_dwordx4 v240, s[48:51], s13 offen offset:0 lds
    ds_read2_b32 v[68:69], v236 offset0:160 offset1:161
    v_mfma_f32_16x16x32_bf16 v[44:47], v[136:139], v[164:167], v[44:47]
    v_mfma_f32_16x16x32_bf16 v[44:47], v[132:135], v[168:171], v[44:47]
    ds_read2_b32 v[70:71], v236 offset0:162 offset1:163
    v_mfma_f32_16x16x32_bf16 v[44:47], v[128:131], v[172:175], v[44:47]
    ds_read_b128 v[104:107], v246 offset:10240
    s_waitcnt lgkmcnt(7)
    v_mfma_f32_16x16x32_bf16 v[48:51], v[128:131], v[176:179], v[48:51]
    ds_read2_b32 v[72:73], v237 offset0:32 offset1:33
    v_mfma_f32_16x16x32_bf16 v[48:51], v[132:135], v[172:175], v[48:51]
    v_mfma_f32_16x16x32_bf16 v[48:51], v[136:139], v[168:171], v[48:51]
    ds_read2_b32 v[74:75], v237 offset0:34 offset1:35
    v_mfma_f32_16x16x32_bf16 v[48:51], v[140:143], v[164:167], v[48:51]
    s_add_u32 m0, s74, 8352
    ds_read_b128 v[108:111], v246 offset:14336
    v_mfma_f32_16x16x32_bf16 v[48:51], v[144:147], v[160:163], v[48:51]
    buffer_load_dwordx4 v240, s[48:51], s13 offen offset:1024 lds
    v_mfma_f32_16x16x32_bf16 v[52:55], v[148:151], v[160:163], v[52:55]
    ds_read2_b32 v[76:77], v237 offset0:160 offset1:161
    v_mfma_f32_16x16x32_bf16 v[52:55], v[144:147], v[164:167], v[52:55]
    ds_read2_b32 v[78:79], v237 offset0:162 offset1:163
    v_mfma_f32_16x16x32_bf16 v[52:55], v[140:143], v[168:171], v[52:55]
    v_mfma_f32_16x16x32_bf16 v[52:55], v[136:139], v[172:175], v[52:55]
    s_lshl_b32 s14, s91, 18
    ds_read_b128 v[112:115], v246 offset:18432
    v_mfma_f32_16x16x32_bf16 v[52:55], v[132:135], v[176:179], v[52:55]
    s_add_u32 m0, s73, 0
    ds_read2_b32 v[80:81], v238 offset0:32 offset1:33
    v_mfma_f32_16x16x32_bf16 v[52:55], v[128:131], v[180:183], v[52:55]
    buffer_load_dwordx4 v4, s[52:55], s14 offen offset:0 lds
    v_mfma_f32_16x16x32_bf16 v[56:59], v[128:131], v[184:187], v[56:59]
    s_add_u32 m0, s74, 8352
    ds_read2_b32 v[82:83], v238 offset0:34 offset1:35
    v_mfma_f32_16x16x32_bf16 v[56:59], v[132:135], v[180:183], v[56:59]
    buffer_load_dwordx4 v240, s[48:51], s13 offen offset:2048 lds
    ds_read_b128 v[116:119], v246 offset:22528
    v_mfma_f32_16x16x32_bf16 v[56:59], v[136:139], v[176:179], v[56:59]
    v_mfma_f32_16x16x32_bf16 v[56:59], v[140:143], v[172:175], v[56:59]
    ds_read2_b32 v[84:85], v238 offset0:160 offset1:161
    v_mfma_f32_16x16x32_bf16 v[56:59], v[144:147], v[168:171], v[56:59]
    ds_read2_b32 v[86:87], v238 offset0:162 offset1:163
    v_mfma_f32_16x16x32_bf16 v[56:59], v[148:151], v[164:167], v[56:59]
    ds_read_b128 v[120:123], v246 offset:26624
    v_mfma_f32_16x16x32_bf16 v[56:59], v[152:155], v[160:163], v[56:59]
    v_mfma_f32_16x16x32_bf16 v[60:63], v[156:159], v[160:163], v[60:63]
    ds_read2_b32 v[88:89], v239 offset0:32 offset1:33
    v_mfma_f32_16x16x32_bf16 v[60:63], v[152:155], v[164:167], v[60:63]
    ds_read2_b32 v[90:91], v239 offset0:34 offset1:35
    v_mfma_f32_16x16x32_bf16 v[60:63], v[148:151], v[168:171], v[60:63]
    s_add_u32 m0, s73, 0
    v_mfma_f32_16x16x32_bf16 v[60:63], v[144:147], v[172:175], v[60:63]
    buffer_load_dwordx4 v5, s[52:55], s14 offen offset:1024 lds
    ds_read_b128 v[124:127], v246 offset:30720
    v_mfma_f32_16x16x32_bf16 v[60:63], v[140:143], v[176:179], v[60:63]
    s_add_u32 m0, s74, 8352
    ds_read2_b32 v[92:93], v239 offset0:160 offset1:161
    v_mfma_f32_16x16x32_bf16 v[60:63], v[136:139], v[180:183], v[60:63]
    buffer_load_dwordx4 v240, s[48:51], s13 offen offset:3072 lds
    v_mfma_f32_16x16x32_bf16 v[60:63], v[132:135], v[184:187], v[60:63]
    ds_read2_b32 v[94:95], v239 offset0:162 offset1:163
    v_mfma_f32_16x16x32_bf16 v[60:63], v[128:131], v[188:191], v[60:63]
    s_waitcnt lgkmcnt(12)
    v_mfma_f32_16x16x32_bf16 v[32:35], v[64:67], v[96:99], v[32:35]
    ds_read_b128 v[160:163], v247 offset:2048
    v_mfma_f32_16x16x32_bf16 v[36:39], v[68:71], v[96:99], v[36:39]
    v_mfma_f32_16x16x32_bf16 v[36:39], v[64:67], v[100:103], v[36:39]
    ds_read2_b32 v[128:129], v236 offset0:48 offset1:49
    v_mfma_f32_16x16x32_bf16 v[40:43], v[64:67], v[104:107], v[40:43]
    ds_read2_b32 v[130:131], v236 offset0:50 offset1:51
    v_mfma_f32_16x16x32_bf16 v[40:43], v[68:71], v[100:103], v[40:43]
    v_mfma_f32_16x16x32_bf16 v[40:43], v[72:75], v[96:99], v[40:43]
    ds_read_b128 v[164:167], v247 offset:6144
    v_mfma_f32_16x16x32_bf16 v[44:47], v[76:79], v[96:99], v[44:47]
    s_add_u32 m0, s73, 0
    ds_read2_b32 v[132:133], v236 offset0:176 offset1:177
    v_mfma_f32_16x16x32_bf16 v[44:47], v[72:75], v[100:103], v[44:47]
    buffer_load_dwordx4 v6, s[52:55], s14 offen offset:2048 lds
    ds_read2_b32 v[134:135], v236 offset0:178 offset1:179
    v_mfma_f32_16x16x32_bf16 v[44:47], v[68:71], v[104:107], v[44:47]
    ds_read_b128 v[168:171], v247 offset:10240
    v_mfma_f32_16x16x32_bf16 v[44:47], v[64:67], v[108:111], v[44:47]
    v_mov_b32 v9, 24
    buffer_load_ushort v9, v9, s[56:59], s70 offen
    s_waitcnt lgkmcnt(7)
    v_mfma_f32_16x16x32_bf16 v[48:51], v[64:67], v[112:115], v[48:51]
    ds_read2_b32 v[136:137], v237 offset0:48 offset1:49
    v_mfma_f32_16x16x32_bf16 v[48:51], v[68:71], v[108:111], v[48:51]
    v_mfma_f32_16x16x32_bf16 v[48:51], v[72:75], v[104:107], v[48:51]
    ds_read2_b32 v[138:139], v237 offset0:50 offset1:51
    v_mfma_f32_16x16x32_bf16 v[48:51], v[76:79], v[100:103], v[48:51]
    ds_read_b128 v[172:175], v247 offset:14336
    v_mfma_f32_16x16x32_bf16 v[48:51], v[80:83], v[96:99], v[48:51]
    v_mfma_f32_16x16x32_bf16 v[52:55], v[84:87], v[96:99], v[52:55]
    ds_read2_b32 v[140:141], v237 offset0:176 offset1:177
    v_mfma_f32_16x16x32_bf16 v[52:55], v[80:83], v[100:103], v[52:55]
    ds_read2_b32 v[142:143], v237 offset0:178 offset1:179
    v_mfma_f32_16x16x32_bf16 v[52:55], v[76:79], v[104:107], v[52:55]
    v_mfma_f32_16x16x32_bf16 v[52:55], v[72:75], v[108:111], v[52:55]
    s_add_u32 m0, s73, 0
    ds_read_b128 v[176:179], v247 offset:18432
    v_mfma_f32_16x16x32_bf16 v[52:55], v[68:71], v[112:115], v[52:55]
    buffer_load_dwordx4 v7, s[52:55], s14 offen offset:3072 lds
    ds_read2_b32 v[144:145], v238 offset0:48 offset1:49
    v_mfma_f32_16x16x32_bf16 v[52:55], v[64:67], v[116:119], v[52:55]
    v_mfma_f32_16x16x32_bf16 v[56:59], v[64:67], v[120:123], v[56:59]
    ds_read2_b32 v[146:147], v238 offset0:50 offset1:51
    v_mfma_f32_16x16x32_bf16 v[56:59], v[68:71], v[116:119], v[56:59]
    ds_read_b128 v[180:183], v247 offset:22528
    v_mfma_f32_16x16x32_bf16 v[56:59], v[72:75], v[112:115], v[56:59]
    v_mfma_f32_16x16x32_bf16 v[56:59], v[76:79], v[108:111], v[56:59]
    ds_read2_b32 v[148:149], v238 offset0:176 offset1:177
    v_mfma_f32_16x16x32_bf16 v[56:59], v[80:83], v[104:107], v[56:59]
    ds_read2_b32 v[150:151], v238 offset0:178 offset1:179
    v_mfma_f32_16x16x32_bf16 v[56:59], v[84:87], v[100:103], v[56:59]
    ds_read_b128 v[184:187], v247 offset:26624
    v_mfma_f32_16x16x32_bf16 v[56:59], v[88:91], v[96:99], v[56:59]
    v_mfma_f32_16x16x32_bf16 v[60:63], v[92:95], v[96:99], v[60:63]
    s_lshl_b32 s14, s92, 18
    ds_read2_b32 v[152:153], v239 offset0:48 offset1:49
    v_mfma_f32_16x16x32_bf16 v[60:63], v[88:91], v[100:103], v[60:63]
    s_add_u32 m0, s73, 16384
    ds_read2_b32 v[154:155], v239 offset0:50 offset1:51
    v_mfma_f32_16x16x32_bf16 v[60:63], v[84:87], v[104:107], v[60:63]
    buffer_load_dwordx4 v4, s[52:55], s14 offen offset:0 lds
    v_mfma_f32_16x16x32_bf16 v[60:63], v[80:83], v[108:111], v[60:63]
    ds_read_b128 v[188:191], v247 offset:30720
    v_mfma_f32_16x16x32_bf16 v[60:63], v[76:79], v[112:115], v[60:63]
    ds_read2_b32 v[156:157], v239 offset0:176 offset1:177
    v_mfma_f32_16x16x32_bf16 v[60:63], v[72:75], v[116:119], v[60:63]
    v_mfma_f32_16x16x32_bf16 v[60:63], v[68:71], v[120:123], v[60:63]
    ds_read2_b32 v[158:159], v239 offset0:178 offset1:179
L_pl_X_4:
    s_cbranch_execz L_wret
    v_mfma_f32_16x16x32_bf16 v[60:63], v[64:67], v[124:127], v[60:63]
    s_waitcnt lgkmcnt(12)
    v_mfma_f32_16x16x32_bf16 v[32:35], v[128:131], v[160:163], v[32:35]
    ds_read_b128 v[96:99], v244 offset:0
    v_mfma_f32_16x16x32_bf16 v[36:39], v[132:135], v[160:163], v[36:39]
    ds_read2_b32 v[64:65], v236 offset0:64 offset1:65
    v_mfma_f32_16x16x32_bf16 v[36:39], v[128:131], v[164:167], v[36:39]
    ds_read2_b32 v[66:67], v236 offset0:66 offset1:67
    v_mfma_f32_16x16x32_bf16 v[40:43], v[128:131], v[168:171], v[40:43]
    ds_read_b128 v[100:103], v244 offset:4096
    v_mfma_f32_16x16x32_bf16 v[40:43], v[132:135], v[164:167], v[40:43]
    ds_read2_b32 v[68:69], v236 offset0:192 offset1:193
    v_mfma_f32_16x16x32_bf16 v[40:43], v[136:139], v[160:163], v[40:43]
    s_add_u32 m0, s73, 16384
    ds_read2_b32 v[70:71], v236 offset0:194 offset1:195
    v_mfma_f32_16x16x32_bf16 v[44:47], v[140:143], v[160:163], v[44:47]
    buffer_load_dwordx4 v5, s[52:55], s14 offen offset:1024 lds
    ds_read_b128 v[104:107], v244 offset:8192
    v_mfma_f32_16x16x32_bf16 v[44:47], v[136:139], v[164:167], v[44:47]
    ds_read2_b32 v[72:73], v237 offset0:64 offset1:65
    s_waitcnt vmcnt(11)
    s_barrier
    v_mfma_f32_16x16x32_bf16 v[44:47], v[132:135], v[168:171], v[44:47]
    ds_read_b64_tr_b16 a[96:97], v10 offset:16384
    v_mfma_f32_16x16x32_bf16 v[44:47], v[128:131], v[172:175], v[44:47]
    ds_read2_b32 v[74:75], v237 offset0:66 offset1:67
    s_waitcnt lgkmcnt(10)
    v_mfma_f32_16x16x32_bf16 v[48:51], v[128:131], v[176:179], v[48:51]
    ds_read_b64_tr_b16 a[98:99], v10 offset:18432
    v_mfma_f32_16x16x32_bf16 v[48:51], v[132:135], v[172:175], v[48:51]
    ds_read_b64_tr_b16 a[104:105], v10 offset:20480
    v_mfma_f32_16x16x32_bf16 v[48:51], v[136:139], v[168:171], v[48:51]
    ds_read_b64_tr_b16 a[106:107], v10 offset:22528
    v_mfma_f32_16x16x32_bf16 v[48:51], v[140:143], v[164:167], v[48:51]
    ds_read_b128 v[108:111], v244 offset:12288
    v_mfma_f32_16x16x32_bf16 v[48:51], v[144:147], v[160:163], v[48:51]
    ds_read_b64_tr_b16 a[100:101], v11 offset:16384
    v_mfma_f32_16x16x32_bf16 v[52:55], v[148:151], v[160:163], v[52:55]
    ds_read_b64_tr_b16 a[102:103], v11 offset:18432
    ds_read2_b32 v[76:77], v237 offset0:192 offset1:193
    v_mfma_f32_16x16x32_bf16 v[52:55], v[144:147], v[164:167], v[52:55]
    ds_read2_b32 v[78:79], v237 offset0:194 offset1:195
    v_mfma_f32_16x16x32_bf16 v[52:55], v[140:143], v[168:171], v[52:55]
    ds_read_b64_tr_b16 a[108:109], v11 offset:20480
    s_add_u32 m0, s73, 16384
    s_waitcnt vmcnt(5)
    v_mfma_f32_16x16x32_bf16 v[52:55], v[136:139], v[172:175], v[52:55]
    ds_read_b64_tr_b16 a[110:111], v11 offset:22528
    buffer_load_dwordx4 v6, s[52:55], s14 offen offset:2048 lds
    ds_read_b128 v[112:115], v244 offset:16384
    v_mfma_f32_16x16x32_bf16 v[52:55], v[132:135], v[176:179], v[52:55]
    ds_read_b128 v[212:215], v241 offset:8352
    ds_read2_b32 v[80:81], v238 offset0:64 offset1:65
    v_mfma_f32_16x16x32_bf16 v[52:55], v[128:131], v[180:183], v[52:55]
    ds_read2_b32 v[82:83], v238 offset0:66 offset1:67
    v_mfma_f32_16x16x32_bf16 v[56:59], v[128:131], v[184:187], v[56:59]
    ds_read_b32 v216, v241 offset:8368
    v_mfma_f32_16x16x32_bf16 v[56:59], v[132:135], v[180:183], v[56:59]
    ds_read_b128 v[116:119], v244 offset:20480
    v_mfma_f32_16x16x32_bf16 v[56:59], v[136:139], v[176:179], v[56:59]
    ds_read_b128 v[218:221], v241 offset:9376
    v_mfma_f32_16x16x32_bf16 v[56:59], v[140:143], v[172:175], v[56:59]
    ds_read2_b32 v[84:85], v238 offset0:192 offset1:193
    v_mfma_f32_16x16x32_bf16 v[56:59], v[144:147], v[168:171], v[56:59]
    ds_read2_b32 v[86:87], v238 offset0:194 offset1:195
    v_mfma_f32_16x16x32_bf16 v[56:59], v[148:151], v[164:167], v[56:59]
    ds_read_b32 v222, v241 offset:9392
    v_mfma_f32_16x16x32_bf16 v[56:59], v[152:155], v[160:163], v[56:59]
    ds_read_b128 v[120:123], v244 offset:24576
    v_mfma_f32_16x16x32_bf16 v[60:63], v[156:159], v[160:163], v[60:63]
    ds_read_b128 v[224:227], v241 offset:10400
    s_add_u32 m0, s73, 16384
    ds_read2_b32 v[88:89], v239 offset0:64 offset1:65
    v_mfma_f32_16x16x32_bf16 v[60:63], v[152:155], v[164:167], v[60:63]
    buffer_load_dwordx4 v7, s[52:55], s14 offen offset:3072 lds
    ds_read2_b32 v[90:91], v239 offset0:66 offset1:67
    v_mfma_f32_16x16x32_bf16 v[60:63], v[148:151], v[168:171], v[60:63]
    ds_read_b32 v228, v241 offset:10416
    v_mfma_f32_16x16x32_bf16 v[60:63], v[144:147], v[172:175], v[60:63]
    ds_read_b128 v[124:127], v244 offset:28672
    v_mfma_f32_16x16x32_bf16 v[60:63], v[140:143], v[176:179], v[60:63]
    ds_read_b128 v[230:233], v241 offset:11424
    v_mfma_f32_16x16x32_bf16 v[60:63], v[136:139], v[180:183], v[60:63]
    ds_read2_b32 v[92:93], v239 offset0:192 offset1:193
    v_mfma_f32_16x16x32_bf16 v[60:63], v[132:135], v[184:187], v[60:63]
    ds_read_b32 v234, v241 offset:11440
    ds_read2_b32 v[94:95], v239 offset0:194 offset1:195
    v_mfma_f32_16x16x32_bf16 v[60:63], v[128:131], v[188:191], v[60:63]
    s_waitcnt lgkmcnt(15)
    v_mfma_f32_16x16x32_bf16 v[32:35], v[64:67], v[96:99], v[32:35]
    ds_read_b128 v[160:163], v245 offset:0
    v_mfma_f32_16x16x32_bf16 v[36:39], v[68:71], v[96:99], v[36:39]
    ds_read2_b32 v[128:129], v236 offset0:80 offset1:81
    v_mfma_f32_16x16x32_bf16 v[36:39], v[64:67], v[100:103], v[36:39]
    ds_read2_b32 v[130:131], v236 offset0:82 offset1:83
    v_mfma_f32_16x16x32_bf16 v[40:43], v[64:67], v[104:107], v[40:43]
    ds_read_b128 v[164:167], v245 offset:4096
    s_barrier
    v_mfma_f32_16x16x32_bf16 v[40:43], v[68:71], v[100:103], v[40:43]
    s_waitcnt lgkmcnt(5)
    ds_read2_b32 v[132:133], v236 offset0:208 offset1:209
    v_mfma_f32_16x16x32_bf16 v[40:43], v[72:75], v[96:99], v[40:43]
    ds_read2_b32 v[134:135], v236 offset0:210 offset1:211
    v_mfma_f32_16x16x32_bf16 v[44:47], v[76:79], v[96:99], v[44:47]
    s_waitcnt vmcnt(5)
    ds_read_b128 v[168:171], v245 offset:8192
    v_mfma_f32_16x16x32_bf16 v[44:47], v[72:75], v[100:103], v[44:47]
    s_lshl_b32 s14, s93, 18
    ds_read2_b32 v[136:137], v237 offset0:80 offset1:81
    v_mfma_f32_16x16x32_bf16 v[44:47], v[68:71], v[104:107], v[44:47]
    ds_read2_b32 v[138:139], v237 offset0:82 offset1:83
    s_add_u32 m0, s73, 147456
    v_lshlrev_b32 v9, 16, v9
    v_mfma_f32_16x16x32_bf16 v[44:47], v[64:67], v[108:111], v[44:47]
    buffer_load_dwordx4 v4, s[52:55], s14 offen offset:0 lds
    ds_read_b128 v[172:175], v245 offset:12288
    s_waitcnt lgkmcnt(10)
    v_mfma_f32_16x16x32_bf16 v[48:51], v[64:67], v[112:115], v[48:51]
    ds_read2_b32 v[140:141], v237 offset0:208 offset1:209
    v_lshlrev_b32 v208, 16, v212
    v_mfma_f32_16x16x32_bf16 v[48:51], v[68:71], v[108:111], v[48:51]
    ds_read2_b32 v[142:143], v237 offset0:210 offset1:211
    v_mfma_f32_16x16x32_bf16 v[48:51], v[72:75], v[104:107], v[48:51]
    ds_read_b128 v[176:179], v245 offset:16384
    v_add_f32 v9, v9, v208
    v_mfma_f32_16x16x32_bf16 v[48:51], v[76:79], v[100:103], v[48:51]
    ds_read2_b32 v[144:145], v238 offset0:80 offset1:81
    v_cvt_pk_bf16_f32 v9, v9, v9
    v_mfma_f32_16x16x32_bf16 v[48:51], v[80:83], v[96:99], v[48:51]
    ds_read2_b32 v[146:147], v238 offset0:82 offset1:83
    v_mfma_f32_16x16x32_bf16 v[52:55], v[84:87], v[96:99], v[52:55]
    ds_write_b16 v242, v9 offset:12480
    v_mfma_f32_16x16x32_bf16 v[52:55], v[80:83], v[100:103], v[52:55]
    ds_read_b128 v[180:183], v245 offset:20480
    v_mfma_f32_16x16x32_bf16 v[52:55], v[76:79], v[104:107], v[52:55]
    ds_write_b16 v242, v9 offset:8322
    v_mfma_f32_16x16x32_bf16 v[52:55], v[72:75], v[108:111], v[52:55]
    ds_read2_b32 v[148:149], v238 offset0:208 offset1:209
    v_mfma_f32_16x16x32_bf16 v[52:55], v[68:71], v[112:115], v[52:55]
    ds_read2_b32 v[150:151], v238 offset0:210 offset1:211
    s_add_u32 m0, s73, 147456
    v_alignbit_b32 v212, v213, v212, 16
    v_mfma_f32_16x16x32_bf16 v[52:55], v[64:67], v[116:119], v[52:55]
    buffer_load_dwordx4 v5, s[52:55], s14 offen offset:1024 lds
    v_alignbit_b32 v213, v214, v213, 16
    v_mfma_f32_16x16x32_bf16 v[56:59], v[64:67], v[120:123], v[56:59]
    ds_read_b128 v[184:187], v245 offset:24576
    v_mfma_f32_16x16x32_bf16 v[56:59], v[68:71], v[116:119], v[56:59]
    ds_read2_b32 v[152:153], v239 offset0:80 offset1:81
    v_alignbit_b32 v214, v215, v214, 16
    v_mfma_f32_16x16x32_bf16 v[56:59], v[72:75], v[112:115], v[56:59]
    ds_read2_b32 v[154:155], v239 offset0:82 offset1:83
    v_alignbit_b32 v215, v216, v215, 16
    v_mfma_f32_16x16x32_bf16 v[56:59], v[76:79], v[108:111], v[56:59]
    ds_write_b128 v241, v[212:215] offset:12512
    v_mfma_f32_16x16x32_bf16 v[56:59], v[80:83], v[104:107], v[56:59]
    ds_read_b128 v[188:191], v245 offset:28672
    s_waitcnt vmcnt(6)
    s_barrier
    v_mfma_f32_16x16x32_bf16 v[56:59], v[84:87], v[100:103], v[56:59]
    v_add_u32 v10, -131072, v10
    v_alignbit_b32 v218, v219, v218, 16
    v_mfma_f32_16x16x32_bf16 v[56:59], v[88:91], v[96:99], v[56:59]
    ds_read_b64_tr_b16 a[112:113], v10 offset:0
    v_alignbit_b32 v219, v220, v219, 16
    v_mfma_f32_16x16x32_bf16 v[60:63], v[92:95], v[96:99], v[60:63]
    ds_read_b64_tr_b16 a[114:115], v10 offset:2048
    v_alignbit_b32 v220, v221, v220, 16
    v_mfma_f32_16x16x32_bf16 v[60:63], v[88:91], v[100:103], v[60:63]
    ds_read_b64_tr_b16 a[120:121], v10 offset:4096
    v_alignbit_b32 v221, v222, v221, 16
    v_mfma_f32_16x16x32_bf16 v[60:63], v[84:87], v[104:107], v[60:63]
    ds_write_b128 v241, v[218:221] offset:13536
    v_mfma_f32_16x16x32_bf16 v[60:63], v[80:83], v[108:111], v[60:63]
    ds_read_b64_tr_b16 a[122:123], v10 offset:6144
    s_add_u32 m0, s73, 147456
    v_mfma_f32_16x16x32_bf16 v[60:63], v[76:79], v[112:115], v[60:63]
    v_add_u32 v11, -131072, v11
    buffer_load_dwordx4 v6, s[52:55], s14 offen offset:2048 lds
    ds_read2_b32 v[156:157], v239 offset0:208 offset1:209
    v_mfma_f32_16x16x32_bf16 v[60:63], v[72:75], v[116:119], v[60:63]
    ds_read_b64_tr_b16 a[116:117], v11 offset:0
    v_mfma_f32_16x16x32_bf16 v[60:63], v[68:71], v[120:123], v[60:63]
    ds_read_b64_tr_b16 a[118:119], v11 offset:2048
    ds_read2_b32 v[158:159], v239 offset0:210 offset1:211
    v_mfma_f32_16x16x32_bf16 v[60:63], v[64:67], v[124:127], v[60:63]
    ds_read_b64_tr_b16 a[124:125], v11 offset:4096
    s_waitcnt lgkmcnt(15)
    v_mfma_f32_16x16x32_bf16 v[32:35], v[128:131], v[160:163], v[32:35]
    ds_read_b64_tr_b16 a[126:127], v11 offset:6144
    v_mfma_f32_16x16x32_bf16 v[36:39], v[132:135], v[160:163], v[36:39]
    ds_read_b128 v[96:99], v246 offset:0
    v_alignbit_b32 v224, v225, v224, 16
    v_mfma_f32_16x16x32_bf16 v[36:39], v[128:131], v[164:167], v[36:39]
    ds_read2_b32 v[64:65], v236 offset0:96 offset1:97
    v_mfma_f32_16x16x32_bf16 v[40:43], v[128:131], v[168:171], v[40:43]
    ds_read2_b32 v[66:67], v236 offset0:98 offset1:99
    v_mfma_f32_16x16x32_bf16 v[40:43], v[132:135], v[164:167], v[40:43]
    v_mfma_f32_16x16x32_bf16 v[40:43], v[136:139], v[160:163], v[40:43]
    ds_read_b128 v[100:103], v246 offset:4096
    v_alignbit_b32 v225, v226, v225, 16
    v_mfma_f32_16x16x32_bf16 v[44:47], v[140:143], v[160:163], v[44:47]
    ds_read2_b32 v[68:69], v236 offset0:224 offset1:225
    v_mfma_f32_16x16x32_bf16 v[44:47], v[136:139], v[164:167], v[44:47]
    s_add_u32 m0, s73, 147456
    ds_read2_b32 v[70:71], v236 offset0:226 offset1:227
    v_mfma_f32_16x16x32_bf16 v[44:47], v[132:135], v[168:171], v[44:47]
    buffer_load_dwordx4 v7, s[52:55], s14 offen offset:3072 lds
    ds_read_b128 v[104:107], v246 offset:8192
    v_mfma_f32_16x16x32_bf16 v[44:47], v[128:131], v[172:175], v[44:47]
    v_alignbit_b32 v226, v227, v226, 16
    s_waitcnt lgkmcnt(9)
    v_mfma_f32_16x16x32_bf16 v[48:51], v[128:131], v[176:179], v[48:51]
    ds_read2_b32 v[72:73], v237 offset0:96 offset1:97
    v_mfma_f32_16x16x32_bf16 v[48:51], v[132:135], v[172:175], v[48:51]
    v_mfma_f32_16x16x32_bf16 v[48:51], v[136:139], v[168:171], v[48:51]
    ds_read2_b32 v[74:75], v237 offset0:98 offset1:99
    v_alignbit_b32 v227, v228, v227, 16
    v_mfma_f32_16x16x32_bf16 v[48:51], v[140:143], v[164:167], v[48:51]
    ds_read_b128 v[108:111], v246 offset:12288
    v_mfma_f32_16x16x32_bf16 v[48:51], v[144:147], v[160:163], v[48:51]
    s_waitcnt lgkmcnt(10)
    s_barrier
    v_mfma_f32_16x16x32_bf16 v[52:55], v[148:151], v[160:163], v[52:55]
    ds_read2_b32 v[76:77], v237 offset0:224 offset1:225
    v_mfma_f32_16x16x32_bf16 v[52:55], v[144:147], v[164:167], v[52:55]
    ds_write_b128 v241, v[224:227] offset:14560
    v_mfma_f32_16x16x32_bf16 v[52:55], v[140:143], v[168:171], v[52:55]
    ds_read2_b32 v[78:79], v237 offset0:226 offset1:227
    v_mfma_f32_16x16x32_bf16 v[52:55], v[136:139], v[172:175], v[52:55]
    s_lshl_b32 s14, s94, 18
    ds_read_b128 v[112:115], v246 offset:16384
    v_mfma_f32_16x16x32_bf16 v[52:55], v[132:135], v[176:179], v[52:55]
    ds_read2_b32 v[80:81], v238 offset0:96 offset1:97
    s_add_u32 m0, s73, 0
    v_alignbit_b32 v230, v231, v230, 16
    v_mfma_f32_16x16x32_bf16 v[52:55], v[128:131], v[180:183], v[52:55]
    buffer_load_dwordx4 v4, s[52:55], s14 offen offset:0 lds
    v_mfma_f32_16x16x32_bf16 v[56:59], v[128:131], v[184:187], v[56:59]
    ds_read2_b32 v[82:83], v238 offset0:98 offset1:99
    v_mfma_f32_16x16x32_bf16 v[56:59], v[132:135], v[180:183], v[56:59]
    ds_read_b128 v[116:119], v246 offset:20480
    v_mfma_f32_16x16x32_bf16 v[56:59], v[136:139], v[176:179], v[56:59]
    v_alignbit_b32 v231, v232, v231, 16
    v_mfma_f32_16x16x32_bf16 v[56:59], v[140:143], v[172:175], v[56:59]
    ds_read2_b32 v[84:85], v238 offset0:224 offset1:225
    v_mfma_f32_16x16x32_bf16 v[56:59], v[144:147], v[168:171], v[56:59]
    ds_read2_b32 v[86:87], v238 offset0:226 offset1:227
    v_mfma_f32_16x16x32_bf16 v[56:59], v[148:151], v[164:167], v[56:59]
    ds_read_b128 v[120:123], v246 offset:24576
    v_mfma_f32_16x16x32_bf16 v[56:59], v[152:155], v[160:163], v[56:59]
    v_alignbit_b32 v232, v233, v232, 16
    v_mfma_f32_16x16x32_bf16 v[60:63], v[156:159], v[160:163], v[60:63]
    ds_read2_b32 v[88:89], v239 offset0:96 offset1:97
    v_mfma_f32_16x16x32_bf16 v[60:63], v[152:155], v[164:167], v[60:63]
    ds_read2_b32 v[90:91], v239 offset0:98 offset1:99
    v_mfma_f32_16x16x32_bf16 v[60:63], v[148:151], v[168:171], v[60:63]
    s_add_u32 m0, s73, 0
    v_alignbit_b32 v233, v234, v233, 16
    v_mfma_f32_16x16x32_bf16 v[60:63], v[144:147], v[172:175], v[60:63]
    buffer_load_dwordx4 v5, s[52:55], s14 offen offset:1024 lds
    ds_read_b128 v[124:127], v246 offset:28672
    v_mfma_f32_16x16x32_bf16 v[60:63], v[140:143], v[176:179], v[60:63]
    ds_read2_b32 v[92:93], v239 offset0:224 offset1:225
    v_mfma_f32_16x16x32_bf16 v[60:63], v[136:139], v[180:183], v[60:63]
    ds_read2_b32 v[94:95], v239 offset0:226 offset1:227
    v_mfma_f32_16x16x32_bf16 v[60:63], v[132:135], v[184:187], v[60:63]
    ds_write_b128 v241, v[230:233] offset:15584
    v_mfma_f32_16x16x32_bf16 v[60:63], v[128:131], v[188:191], v[60:63]
    s_waitcnt lgkmcnt(13)
    v_mfma_f32_16x16x32_bf16 v[32:35], v[64:67], v[96:99], v[32:35]
    ds_read_b128 v[160:163], v247 offset:0
    s_waitcnt vmcnt(6)
    s_barrier
    v_mfma_f32_16x16x32_bf16 v[36:39], v[68:71], v[96:99], v[36:39]
    ds_read_b64_tr_b16 a[128:129], v10 offset:16384
    v_mfma_f32_16x16x32_bf16 v[36:39], v[64:67], v[100:103], v[36:39]
    ds_read_b64_tr_b16 a[130:131], v10 offset:18432
    ds_read_b128 v[164:167], v247 offset:4096
    v_mfma_f32_16x16x32_bf16 v[40:43], v[64:67], v[104:107], v[40:43]
    ds_read_b128 v[168:171], v247 offset:8192
    v_mfma_f32_16x16x32_bf16 v[40:43], v[68:71], v[100:103], v[40:43]
    ds_read_b64_tr_b16 a[136:137], v10 offset:20480
    ds_read_b128 v[172:175], v247 offset:12288
    v_mfma_f32_16x16x32_bf16 v[40:43], v[72:75], v[96:99], v[40:43]
    ds_read_b64_tr_b16 a[138:139], v10 offset:22528
    v_mfma_f32_16x16x32_bf16 v[44:47], v[76:79], v[96:99], v[44:47]
    s_add_u32 m0, s73, 0
    ds_read_b128 v[176:179], v247 offset:16384
    v_mfma_f32_16x16x32_bf16 v[44:47], v[72:75], v[100:103], v[44:47]
    ds_read_b64_tr_b16 a[132:133], v11 offset:16384
    buffer_load_dwordx4 v6, s[52:55], s14 offen offset:2048 lds
    ds_read_b128 v[180:183], v247 offset:20480
    v_mfma_f32_16x16x32_bf16 v[44:47], v[68:71], v[104:107], v[44:47]
    ds_read_b64_tr_b16 a[134:135], v11 offset:18432
    v_mfma_f32_16x16x32_bf16 v[44:47], v[64:67], v[108:111], v[44:47]
    ds_read_b128 v[184:187], v247 offset:24576
    s_waitcnt lgkmcnt(14)
    v_mfma_f32_16x16x32_bf16 v[48:51], v[64:67], v[112:115], v[48:51]
    ds_read_b64_tr_b16 a[140:141], v11 offset:20480
    ds_read_b128 v[188:191], v247 offset:28672
    v_mfma_f32_16x16x32_bf16 v[48:51], v[68:71], v[108:111], v[48:51]
    ds_read_b64_tr_b16 a[142:143], v11 offset:22528
    v_mfma_f32_16x16x32_bf16 v[48:51], v[72:75], v[104:107], v[48:51]
    ds_read2_b32 v[128:129], v236 offset0:112 offset1:113
    v_mfma_f32_16x16x32_bf16 v[48:51], v[76:79], v[100:103], v[48:51]
    ds_read2_b32 v[130:131], v236 offset0:114 offset1:115
    v_mfma_f32_16x16x32_bf16 v[48:51], v[80:83], v[96:99], v[48:51]
    ds_read2_b32 v[132:133], v236 offset0:240 offset1:241
    v_mfma_f32_16x16x32_bf16 v[52:55], v[84:87], v[96:99], v[52:55]
    ds_read2_b32 v[134:135], v236 offset0:242 offset1:243
    v_mfma_f32_16x16x32_bf16 v[52:55], v[80:83], v[100:103], v[52:55]
    ds_read2_b32 v[136:137], v237 offset0:112 offset1:113
    v_mfma_f32_16x16x32_bf16 v[52:55], v[76:79], v[104:107], v[52:55]
    ds_read2_b32 v[138:139], v237 offset0:114 offset1:115
    v_mfma_f32_16x16x32_bf16 v[52:55], v[72:75], v[108:111], v[52:55]
    s_add_u32 m0, s73, 0
    ds_read2_b32 v[140:141], v237 offset0:240 offset1:241
    s_add_u32 s6, s12, 4751360
    v_mfma_f32_16x16x32_bf16 v[52:55], v[68:71], v[112:115], v[52:55]
    buffer_load_dwordx4 v7, s[52:55], s14 offen offset:3072 lds
    ds_read2_b32 v[142:143], v237 offset0:242 offset1:243
    v_mfma_f32_16x16x32_bf16 v[52:55], v[64:67], v[116:119], v[52:55]
    ds_read2_b32 v[144:145], v238 offset0:112 offset1:113
    v_xor_b32 v244, 64, v244
    v_mfma_f32_16x16x32_bf16 v[56:59], v[64:67], v[120:123], v[56:59]
    v_mfma_f32_16x16x32_bf16 v[56:59], v[68:71], v[116:119], v[56:59]
    ds_read2_b32 v[146:147], v238 offset0:114 offset1:115
    v_mfma_f32_16x16x32_bf16 v[56:59], v[72:75], v[112:115], v[56:59]
    ds_read2_b32 v[148:149], v238 offset0:240 offset1:241
    v_mfma_f32_16x16x32_bf16 v[56:59], v[76:79], v[108:111], v[56:59]
    ds_read2_b32 v[150:151], v238 offset0:242 offset1:243
    v_xor_b32 v245, 64, v245
    v_mfma_f32_16x16x32_bf16 v[56:59], v[80:83], v[104:107], v[56:59]
    ds_read2_b32 v[152:153], v239 offset0:112 offset1:113
    s_waitcnt lgkmcnt(13)
    s_barrier
    v_mfma_f32_16x16x32_bf16 v[56:59], v[84:87], v[100:103], v[56:59]
    ds_read2_b32 v[154:155], v239 offset0:114 offset1:115
    v_mfma_f32_16x16x32_bf16 v[56:59], v[88:91], v[96:99], v[56:59]
    ds_read2_b32 v[156:157], v239 offset0:240 offset1:241
    v_mfma_f32_16x16x32_bf16 v[60:63], v[92:95], v[96:99], v[60:63]
    s_lshl_b32 s14, s95, 18
    ds_read2_b32 v[158:159], v239 offset0:242 offset1:243
    v_mfma_f32_16x16x32_bf16 v[60:63], v[88:91], v[100:103], v[60:63]
    s_add_u32 m0, s73, 16384
    v_xor_b32 v246, 64, v246
    v_add_u32 v236, 8320, v236
    v_mfma_f32_16x16x32_bf16 v[60:63], v[84:87], v[104:107], v[60:63]
    buffer_load_dwordx4 v4, s[52:55], s14 offen offset:0 lds
    v_mfma_f32_16x16x32_bf16 v[60:63], v[80:83], v[108:111], v[60:63]
    v_add_u32 v237, 8320, v237
    v_mfma_f32_16x16x32_bf16 v[60:63], v[76:79], v[112:115], v[60:63]
    v_mfma_f32_16x16x32_bf16 v[60:63], v[72:75], v[116:119], v[60:63]
    v_xor_b32 v247, 64, v247
    v_add_u32 v238, 8320, v238
    v_mfma_f32_16x16x32_bf16 v[60:63], v[68:71], v[120:123], v[60:63]
    v_mfma_f32_16x16x32_bf16 v[60:63], v[64:67], v[124:127], v[60:63]
    v_add_u32 v239, 8320, v239
    s_waitcnt lgkmcnt(0)
    v_mfma_f32_16x16x32_bf16 v[60:63], v[128:131], v[188:191], v[60:63]
    ds_read_b128 v[96:99], v244 offset:2048
    v_mfma_f32_16x16x32_bf16 v[60:63], v[132:135], v[184:187], v[60:63]
    ds_read2_b32 v[64:65], v236 offset0:0 offset1:1
    v_mfma_f32_16x16x32_bf16 v[60:63], v[136:139], v[180:183], v[60:63]
    ds_read2_b32 v[66:67], v236 offset0:2 offset1:3
    v_mfma_f32_16x16x32_bf16 v[60:63], v[140:143], v[176:179], v[60:63]
    ds_read_b128 v[100:103], v244 offset:6144
    v_mfma_f32_16x16x32_bf16 v[60:63], v[144:147], v[172:175], v[60:63]
    ds_read2_b32 v[68:69], v236 offset0:128 offset1:129
    v_mfma_f32_16x16x32_bf16 v[60:63], v[148:151], v[168:171], v[60:63]
    s_add_u32 m0, s73, 16384
    ds_read2_b32 v[70:71], v236 offset0:130 offset1:131
    v_mfma_f32_16x16x32_bf16 v[60:63], v[152:155], v[164:167], v[60:63]
    buffer_load_dwordx4 v5, s[52:55], s14 offen offset:1024 lds
    ds_read_b128 v[104:107], v244 offset:10240
    v_mfma_f32_16x16x32_bf16 v[60:63], v[156:159], v[160:163], v[60:63]
    ds_read2_b32 v[72:73], v237 offset0:0 offset1:1
    v_mfma_f32_16x16x32_bf16 v[56:59], v[128:131], v[184:187], v[56:59]
    ds_read2_b32 v[74:75], v237 offset0:2 offset1:3
    v_mfma_f32_16x16x32_bf16 v[56:59], v[132:135], v[180:183], v[56:59]
    ds_read_b128 v[108:111], v244 offset:14336
    v_mfma_f32_16x16x32_bf16 v[56:59], v[136:139], v[176:179], v[56:59]
    ds_read2_b32 v[76:77], v237 offset0:128 offset1:129
    v_mfma_f32_16x16x32_bf16 v[56:59], v[140:143], v[172:175], v[56:59]
    ds_read2_b32 v[78:79], v237 offset0:130 offset1:131
    v_mfma_f32_16x16x32_bf16 v[56:59], v[144:147], v[168:171], v[56:59]
    ds_read_b128 v[112:115], v244 offset:18432
    v_mfma_f32_16x16x32_bf16 v[56:59], v[148:151], v[164:167], v[56:59]
    ds_read2_b32 v[80:81], v238 offset0:0 offset1:1
    v_cvt_pk_bf16_f32 v206, v60, v61
    v_mfma_f32_16x16x32_bf16 v[56:59], v[152:155], v[160:163], v[56:59]
    ds_read2_b32 v[82:83], v238 offset0:2 offset1:3
    s_waitcnt vmcnt(6)
    s_barrier
    v_mfma_f32_16x16x32_bf16 v[52:55], v[128:131], v[180:183], v[52:55]
    ds_read_b128 v[116:119], v244 offset:22528
    v_add_u32 v10, 131072, v10
    v_mfma_f32_16x16x32_bf16 v[52:55], v[132:135], v[176:179], v[52:55]
    ds_read_b64_tr_b16 a[144:145], v10 offset:16384
    v_cvt_pk_bf16_f32 v207, v62, v63
    v_mfma_f32_16x16x32_bf16 v[52:55], v[136:139], v[172:175], v[52:55]
    ds_read_b64_tr_b16 a[146:147], v10 offset:18432
    s_add_u32 m0, s73, 16384
    v_mfma_f32_16x16x32_bf16 v[52:55], v[140:143], v[168:171], v[52:55]
    buffer_load_dwordx4 v6, s[52:55], s14 offen offset:2048 lds
    ds_read2_b32 v[84:85], v238 offset0:128 offset1:129
    v_mfma_f32_16x16x32_bf16 v[52:55], v[144:147], v[164:167], v[52:55]
    buffer_store_dwordx2 v[206:207], v8, s[44:47], s6 offen offset:3584 sc1
    ds_read_b64_tr_b16 a[152:153], v10 offset:20480
    v_mfma_f32_16x16x32_bf16 v[52:55], v[148:151], v[160:163], v[52:55]
    ds_read_b64_tr_b16 a[154:155], v10 offset:22528
    v_mfma_f32_16x16x32_bf16 v[48:51], v[128:131], v[176:179], v[48:51]
    ds_read2_b32 v[86:87], v238 offset0:130 offset1:131
    v_add_u32 v11, 131072, v11
    v_cvt_pk_bf16_f32 v204, v56, v57
    v_mfma_f32_16x16x32_bf16 v[48:51], v[132:135], v[172:175], v[48:51]
    ds_read_b64_tr_b16 a[148:149], v11 offset:16384
    ds_read_b128 v[120:123], v244 offset:26624
    v_mfma_f32_16x16x32_bf16 v[48:51], v[136:139], v[168:171], v[48:51]
    ds_read_b64_tr_b16 a[150:151], v11 offset:18432
    ds_read2_b32 v[88:89], v239 offset0:0 offset1:1
    v_mfma_f32_16x16x32_bf16 v[48:51], v[140:143], v[164:167], v[48:51]
    ds_read2_b32 v[90:91], v239 offset0:2 offset1:3
    v_cvt_pk_bf16_f32 v205, v58, v59
    v_mfma_f32_16x16x32_bf16 v[48:51], v[144:147], v[160:163], v[48:51]
    ds_read_b64_tr_b16 a[156:157], v11 offset:20480
    ds_read_b128 v[124:127], v244 offset:30720
    v_mfma_f32_16x16x32_bf16 v[44:47], v[128:131], v[172:175], v[44:47]
    buffer_store_dwordx2 v[204:205], v8, s[44:47], s6 offen offset:3072 sc1
    ds_read_b64_tr_b16 a[158:159], v11 offset:22528
    v_mfma_f32_16x16x32_bf16 v[44:47], v[132:135], v[168:171], v[44:47]
    ds_read2_b32 v[92:93], v239 offset0:128 offset1:129
    v_mfma_f32_16x16x32_bf16 v[44:47], v[136:139], v[164:167], v[44:47]
    s_add_u32 m0, s73, 16384
    ds_read2_b32 v[94:95], v239 offset0:130 offset1:131
    v_mfma_f32_16x16x32_bf16 v[44:47], v[140:143], v[160:163], v[44:47]
    buffer_load_dwordx4 v7, s[52:55], s14 offen offset:3072 lds
    v_cvt_pk_bf16_f32 v202, v52, v53
    v_mfma_f32_16x16x32_bf16 v[40:43], v[128:131], v[168:171], v[40:43]
    v_mfma_f32_16x16x32_bf16 v[40:43], v[132:135], v[164:167], v[40:43]
    v_mfma_f32_16x16x32_bf16 v[40:43], v[136:139], v[160:163], v[40:43]
    v_cvt_pk_bf16_f32 v203, v54, v55
    v_mfma_f32_16x16x32_bf16 v[36:39], v[128:131], v[164:167], v[36:39]
    v_mfma_f32_16x16x32_bf16 v[36:39], v[132:135], v[160:163], v[36:39]
    buffer_store_dwordx2 v[202:203], v8, s[44:47], s6 offen offset:2560 sc1
    v_mfma_f32_16x16x32_bf16 v[32:35], v[128:131], v[160:163], v[32:35]
    s_waitcnt lgkmcnt(0)
    v_mfma_f32_16x16x32_bf16 v[60:63], v[64:67], v[124:127], 0
    ds_read_b128 v[160:163], v245 offset:2048
    v_mfma_f32_16x16x32_bf16 v[60:63], v[68:71], v[120:123], v[60:63]
    v_cvt_pk_bf16_f32 v200, v48, v49
    v_mfma_f32_16x16x32_bf16 v[60:63], v[72:75], v[116:119], v[60:63]
    ds_read2_b32 v[128:129], v236 offset0:16 offset1:17
    v_mfma_f32_16x16x32_bf16 v[60:63], v[76:79], v[112:115], v[60:63]
    s_barrier
    v_cvt_pk_bf16_f32 v201, v50, v51
    v_mfma_f32_16x16x32_bf16 v[60:63], v[80:83], v[108:111], v[60:63]
    ds_read2_b32 v[130:131], v236 offset0:18 offset1:19
    v_mfma_f32_16x16x32_bf16 v[60:63], v[84:87], v[104:107], v[60:63]
    buffer_store_dwordx2 v[200:201], v8, s[44:47], s6 offen offset:2048 sc1
    ds_read_b128 v[164:167], v245 offset:6144
    v_mfma_f32_16x16x32_bf16 v[60:63], v[88:91], v[100:103], v[60:63]
    ds_read2_b32 v[132:133], v236 offset0:144 offset1:145
    v_mfma_f32_16x16x32_bf16 v[60:63], v[92:95], v[96:99], v[60:63]
    ds_read2_b32 v[134:135], v236 offset0:146 offset1:147
    s_lshl_b32 s14, s96, 18
    v_cvt_pk_bf16_f32 v198, v44, v45
    v_mfma_f32_16x16x32_bf16 v[56:59], v[64:67], v[120:123], 0
    s_add_u32 m0, s73, 147456
    ds_read_b128 v[168:171], v245 offset:10240
    v_mfma_f32_16x16x32_bf16 v[56:59], v[68:71], v[116:119], v[56:59]
    buffer_load_dwordx4 v4, s[52:55], s14 offen offset:0 lds
    ds_read2_b32 v[136:137], v237 offset0:16 offset1:17
    v_mfma_f32_16x16x32_bf16 v[56:59], v[72:75], v[112:115], v[56:59]
    ds_read2_b32 v[138:139], v237 offset0:18 offset1:19
    v_cvt_pk_bf16_f32 v199, v46, v47
    v_mfma_f32_16x16x32_bf16 v[56:59], v[76:79], v[108:111], v[56:59]
    ds_read_b128 v[172:175], v245 offset:14336
    v_mfma_f32_16x16x32_bf16 v[56:59], v[80:83], v[104:107], v[56:59]
    buffer_store_dwordx2 v[198:199], v8, s[44:47], s6 offen offset:1536 sc1
    ds_read2_b32 v[140:141], v237 offset0:144 offset1:145
    v_mfma_f32_16x16x32_bf16 v[56:59], v[84:87], v[100:103], v[56:59]
    ds_read2_b32 v[142:143], v237 offset0:146 offset1:147
    v_mfma_f32_16x16x32_bf16 v[56:59], v[88:91], v[96:99], v[56:59]
    ds_read_b128 v[176:179], v245 offset:18432
    v_cvt_pk_bf16_f32 v196, v40, v41
    v_mfma_f32_16x16x32_bf16 v[52:55], v[64:67], v[116:119], 0
    ds_read2_b32 v[144:145], v238 offset0:16 offset1:17
    v_mfma_f32_16x16x32_bf16 v[52:55], v[68:71], v[112:115], v[52:55]
    ds_read2_b32 v[146:147], v238 offset0:18 offset1:19
    v_cvt_pk_bf16_f32 v197, v42, v43
    v_mfma_f32_16x16x32_bf16 v[52:55], v[72:75], v[108:111], v[52:55]
    ds_read_b128 v[180:183], v245 offset:22528
    v_mfma_f32_16x16x32_bf16 v[52:55], v[76:79], v[104:107], v[52:55]
    buffer_store_dwordx2 v[196:197], v8, s[44:47], s6 offen offset:1024 sc1
    ds_read2_b32 v[148:149], v238 offset0:144 offset1:145
    v_mfma_f32_16x16x32_bf16 v[52:55], v[80:83], v[100:103], v[52:55]
    s_add_u32 m0, s73, 147456
    ds_read2_b32 v[150:151], v238 offset0:146 offset1:147
    v_mfma_f32_16x16x32_bf16 v[52:55], v[84:87], v[96:99], v[52:55]
    buffer_load_dwordx4 v5, s[52:55], s14 offen offset:1024 lds
    ds_read_b128 v[184:187], v245 offset:26624
    v_mfma_f32_16x16x32_bf16 v[48:51], v[64:67], v[112:115], 0
    ds_read2_b32 v[152:153], v239 offset0:16 offset1:17
    v_cvt_pk_bf16_f32 v194, v36, v37
    v_mfma_f32_16x16x32_bf16 v[48:51], v[68:71], v[108:111], v[48:51]
    ds_read2_b32 v[154:155], v239 offset0:18 offset1:19
    v_mfma_f32_16x16x32_bf16 v[48:51], v[72:75], v[104:107], v[48:51]
    ds_read_b128 v[188:191], v245 offset:30720
    v_cvt_pk_bf16_f32 v195, v38, v39
    v_mfma_f32_16x16x32_bf16 v[48:51], v[76:79], v[100:103], v[48:51]
    ds_read2_b32 v[156:157], v239 offset0:144 offset1:145
    v_mfma_f32_16x16x32_bf16 v[48:51], v[80:83], v[96:99], v[48:51]
    buffer_store_dwordx2 v[194:195], v8, s[44:47], s6 offen offset:512 sc1
    s_waitcnt vmcnt(13)
    s_barrier
    v_mfma_f32_16x16x32_bf16 v[44:47], v[64:67], v[108:111], 0
    v_add_u32 v10, -131072, v10
    v_cvt_pk_bf16_f32 v192, v32, v33
    v_mfma_f32_16x16x32_bf16 v[44:47], v[68:71], v[104:107], v[44:47]
    ds_read_b64_tr_b16 a[160:161], v10 offset:0
    v_mfma_f32_16x16x32_bf16 v[44:47], v[72:75], v[100:103], v[44:47]
    ds_read_b64_tr_b16 a[162:163], v10 offset:2048
    v_mfma_f32_16x16x32_bf16 v[44:47], v[76:79], v[96:99], v[44:47]
    ds_read_b64_tr_b16 a[168:169], v10 offset:4096
    v_cvt_pk_bf16_f32 v193, v34, v35
    v_mfma_f32_16x16x32_bf16 v[40:43], v[64:67], v[104:107], 0
    ds_read2_b32 v[158:159], v239 offset0:146 offset1:147
    v_mfma_f32_16x16x32_bf16 v[40:43], v[68:71], v[100:103], v[40:43]
    buffer_store_dwordx2 v[192:193], v8, s[44:47], s6 offen offset:0 sc1
    ds_read_b64_tr_b16 a[170:171], v10 offset:6144
    s_add_u32 m0, s73, 147456
    v_mfma_f32_16x16x32_bf16 v[40:43], v[72:75], v[96:99], v[40:43]
L_pl_X_5:
    s_cbranch_execz L_wret
    v_add_u32 v11, -131072, v11
    buffer_load_dwordx4 v6, s[52:55], s14 offen offset:2048 lds
    v_mfma_f32_16x16x32_bf16 v[36:39], v[64:67], v[100:103], 0
    ds_read_b64_tr_b16 a[164:165], v11 offset:0
    v_mfma_f32_16x16x32_bf16 v[36:39], v[68:71], v[96:99], v[36:39]
    ds_read_b64_tr_b16 a[166:167], v11 offset:2048
    v_mfma_f32_16x16x32_bf16 v[32:35], v[64:67], v[96:99], 0
    ds_read_b64_tr_b16 a[172:173], v11 offset:4096
    s_waitcnt lgkmcnt(15)
    v_mfma_f32_16x16x32_bf16 v[32:35], v[128:131], v[160:163], v[32:35]
    ds_read_b64_tr_b16 a[174:175], v11 offset:6144
    v_mfma_f32_16x16x32_bf16 v[36:39], v[132:135], v[160:163], v[36:39]
    ds_read_b128 v[96:99], v246 offset:2048
    v_mfma_f32_16x16x32_bf16 v[36:39], v[128:131], v[164:167], v[36:39]
    ds_read2_b32 v[64:65], v236 offset0:32 offset1:33
    v_mfma_f32_16x16x32_bf16 v[40:43], v[128:131], v[168:171], v[40:43]
    ds_read2_b32 v[66:67], v236 offset0:34 offset1:35
    v_mfma_f32_16x16x32_bf16 v[40:43], v[132:135], v[164:167], v[40:43]
    v_mfma_f32_16x16x32_bf16 v[40:43], v[136:139], v[160:163], v[40:43]
    ds_read_b128 v[100:103], v246 offset:6144
    v_mfma_f32_16x16x32_bf16 v[44:47], v[140:143], v[160:163], v[44:47]
    ds_read2_b32 v[68:69], v236 offset0:160 offset1:161
    v_mfma_f32_16x16x32_bf16 v[44:47], v[136:139], v[164:167], v[44:47]
    s_add_u32 m0, s73, 147456
    v_mfma_f32_16x16x32_bf16 v[44:47], v[132:135], v[168:171], v[44:47]
    buffer_load_dwordx4 v7, s[52:55], s14 offen offset:3072 lds
    ds_read2_b32 v[70:71], v236 offset0:162 offset1:163
    v_mfma_f32_16x16x32_bf16 v[44:47], v[128:131], v[172:175], v[44:47]
    ds_read_b128 v[104:107], v246 offset:10240
    s_waitcnt lgkmcnt(12)
    v_mfma_f32_16x16x32_bf16 v[48:51], v[128:131], v[176:179], v[48:51]
    ds_read2_b32 v[72:73], v237 offset0:32 offset1:33
    v_mfma_f32_16x16x32_bf16 v[48:51], v[132:135], v[172:175], v[48:51]
    v_mfma_f32_16x16x32_bf16 v[48:51], v[136:139], v[168:171], v[48:51]
    ds_read2_b32 v[74:75], v237 offset0:34 offset1:35
    v_mfma_f32_16x16x32_bf16 v[48:51], v[140:143], v[164:167], v[48:51]
    ds_read_b128 v[108:111], v246 offset:14336
    v_mfma_f32_16x16x32_bf16 v[48:51], v[144:147], v[160:163], v[48:51]
    s_waitcnt lgkmcnt(10)
    s_barrier
    v_mfma_f32_16x16x32_bf16 v[52:55], v[148:151], v[160:163], v[52:55]
    ds_read2_b32 v[76:77], v237 offset0:160 offset1:161
    v_mfma_f32_16x16x32_bf16 v[52:55], v[144:147], v[164:167], v[52:55]
    ds_read2_b32 v[78:79], v237 offset0:162 offset1:163
    v_mfma_f32_16x16x32_bf16 v[52:55], v[140:143], v[168:171], v[52:55]
    v_mfma_f32_16x16x32_bf16 v[52:55], v[136:139], v[172:175], v[52:55]
    s_lshl_b32 s14, s97, 18
    ds_read_b128 v[112:115], v246 offset:18432
    v_mfma_f32_16x16x32_bf16 v[52:55], v[132:135], v[176:179], v[52:55]
    s_add_u32 m0, s73, 0
    ds_read2_b32 v[80:81], v238 offset0:32 offset1:33
    v_mfma_f32_16x16x32_bf16 v[52:55], v[128:131], v[180:183], v[52:55]
    buffer_load_dwordx4 v4, s[52:55], s14 offen offset:0 lds
    v_mfma_f32_16x16x32_bf16 v[56:59], v[128:131], v[184:187], v[56:59]
    ds_read2_b32 v[82:83], v238 offset0:34 offset1:35
    v_mfma_f32_16x16x32_bf16 v[56:59], v[132:135], v[180:183], v[56:59]
    ds_read_b128 v[116:119], v246 offset:22528
    v_mfma_f32_16x16x32_bf16 v[56:59], v[136:139], v[176:179], v[56:59]
    v_mfma_f32_16x16x32_bf16 v[56:59], v[140:143], v[172:175], v[56:59]
    ds_read2_b32 v[84:85], v238 offset0:160 offset1:161
    v_mfma_f32_16x16x32_bf16 v[56:59], v[144:147], v[168:171], v[56:59]
    ds_read2_b32 v[86:87], v238 offset0:162 offset1:163
    v_mfma_f32_16x16x32_bf16 v[56:59], v[148:151], v[164:167], v[56:59]
    ds_read_b128 v[120:123], v246 offset:26624
    v_mfma_f32_16x16x32_bf16 v[56:59], v[152:155], v[160:163], v[56:59]
    v_mfma_f32_16x16x32_bf16 v[60:63], v[156:159], v[160:163], v[60:63]
    ds_read2_b32 v[88:89], v239 offset0:32 offset1:33
    v_mfma_f32_16x16x32_bf16 v[60:63], v[152:155], v[164:167], v[60:63]
    ds_read2_b32 v[90:91], v239 offset0:34 offset1:35
    v_mfma_f32_16x16x32_bf16 v[60:63], v[148:151], v[168:171], v[60:63]
    s_add_u32 m0, s73, 0
    v_mfma_f32_16x16x32_bf16 v[60:63], v[144:147], v[172:175], v[60:63]
    buffer_load_dwordx4 v5, s[52:55], s14 offen offset:1024 lds
    ds_read_b128 v[124:127], v246 offset:30720
    v_mfma_f32_16x16x32_bf16 v[60:63], v[140:143], v[176:179], v[60:63]
    ds_read2_b32 v[92:93], v239 offset0:160 offset1:161
    v_mfma_f32_16x16x32_bf16 v[60:63], v[136:139], v[180:183], v[60:63]
    v_mfma_f32_16x16x32_bf16 v[60:63], v[132:135], v[184:187], v[60:63]
    ds_read2_b32 v[94:95], v239 offset0:162 offset1:163
    v_mfma_f32_16x16x32_bf16 v[60:63], v[128:131], v[188:191], v[60:63]
    s_waitcnt lgkmcnt(12)
    v_mfma_f32_16x16x32_bf16 v[32:35], v[64:67], v[96:99], v[32:35]
    ds_read_b128 v[160:163], v247 offset:2048
    s_waitcnt vmcnt(12)
    s_barrier
    v_mfma_f32_16x16x32_bf16 v[36:39], v[68:71], v[96:99], v[36:39]
    ds_read_b64_tr_b16 a[176:177], v10 offset:16384
    v_mfma_f32_16x16x32_bf16 v[36:39], v[64:67], v[100:103], v[36:39]
    ds_read_b64_tr_b16 a[178:179], v10 offset:18432
    v_mfma_f32_16x16x32_bf16 v[40:43], v[64:67], v[104:107], v[40:43]
    ds_read2_b32 v[128:129], v236 offset0:48 offset1:49
    v_mfma_f32_16x16x32_bf16 v[40:43], v[68:71], v[100:103], v[40:43]
    ds_read_b64_tr_b16 a[184:185], v10 offset:20480
    v_mfma_f32_16x16x32_bf16 v[40:43], v[72:75], v[96:99], v[40:43]
    ds_read_b64_tr_b16 a[186:187], v10 offset:22528
    v_mfma_f32_16x16x32_bf16 v[44:47], v[76:79], v[96:99], v[44:47]
    s_add_u32 m0, s73, 0
    ds_read2_b32 v[130:131], v236 offset0:50 offset1:51
    v_mfma_f32_16x16x32_bf16 v[44:47], v[72:75], v[100:103], v[44:47]
    ds_read_b64_tr_b16 a[180:181], v11 offset:16384
    buffer_load_dwordx4 v6, s[52:55], s14 offen offset:2048 lds
    v_mfma_f32_16x16x32_bf16 v[44:47], v[68:71], v[104:107], v[44:47]
    ds_read_b64_tr_b16 a[182:183], v11 offset:18432
    v_mfma_f32_16x16x32_bf16 v[44:47], v[64:67], v[108:111], v[44:47]
    ds_read_b128 v[164:167], v247 offset:6144
    s_waitcnt lgkmcnt(10)
    v_mfma_f32_16x16x32_bf16 v[48:51], v[64:67], v[112:115], v[48:51]
    ds_read_b64_tr_b16 a[188:189], v11 offset:20480
    v_mfma_f32_16x16x32_bf16 v[48:51], v[68:71], v[108:111], v[48:51]
    ds_read_b64_tr_b16 a[190:191], v11 offset:22528
    v_mfma_f32_16x16x32_bf16 v[48:51], v[72:75], v[104:107], v[48:51]
    ds_read2_b32 v[132:133], v236 offset0:176 offset1:177
    v_mfma_f32_16x16x32_bf16 v[48:51], v[76:79], v[100:103], v[48:51]
    ds_read2_b32 v[134:135], v236 offset0:178 offset1:179
    v_mfma_f32_16x16x32_bf16 v[48:51], v[80:83], v[96:99], v[48:51]
    ds_read_b128 v[168:171], v247 offset:10240
    v_mfma_f32_16x16x32_bf16 v[52:55], v[84:87], v[96:99], v[52:55]
    ds_read2_b32 v[136:137], v237 offset0:48 offset1:49
    v_mfma_f32_16x16x32_bf16 v[52:55], v[80:83], v[100:103], v[52:55]
    ds_read2_b32 v[138:139], v237 offset0:50 offset1:51
    v_mfma_f32_16x16x32_bf16 v[52:55], v[76:79], v[104:107], v[52:55]
    ds_read_b128 v[172:175], v247 offset:14336
    v_mfma_f32_16x16x32_bf16 v[52:55], v[72:75], v[108:111], v[52:55]
    s_add_u32 m0, s73, 0
    ds_read2_b32 v[140:141], v237 offset0:176 offset1:177
    v_mfma_f32_16x16x32_bf16 v[52:55], v[68:71], v[112:115], v[52:55]
    buffer_load_dwordx4 v7, s[52:55], s14 offen offset:3072 lds
    ds_read2_b32 v[142:143], v237 offset0:178 offset1:179
    v_mfma_f32_16x16x32_bf16 v[52:55], v[64:67], v[116:119], v[52:55]
    ds_read_b128 v[176:179], v247 offset:18432
    v_mfma_f32_16x16x32_bf16 v[56:59], v[64:67], v[120:123], v[56:59]
    ds_read2_b32 v[144:145], v238 offset0:48 offset1:49
    v_mfma_f32_16x16x32_bf16 v[56:59], v[68:71], v[116:119], v[56:59]
    ds_read2_b32 v[146:147], v238 offset0:50 offset1:51
    v_mfma_f32_16x16x32_bf16 v[56:59], v[72:75], v[112:115], v[56:59]
    ds_read_b128 v[180:183], v247 offset:22528
    v_mfma_f32_16x16x32_bf16 v[56:59], v[76:79], v[108:111], v[56:59]
    ds_read2_b32 v[148:149], v238 offset0:176 offset1:177
    v_mfma_f32_16x16x32_bf16 v[56:59], v[80:83], v[104:107], v[56:59]
    ds_read2_b32 v[150:151], v238 offset0:178 offset1:179
    s_waitcnt lgkmcnt(14)
    s_barrier
    v_mfma_f32_16x16x32_bf16 v[56:59], v[84:87], v[100:103], v[56:59]
    ds_read_b128 v[184:187], v247 offset:26624
    v_mfma_f32_16x16x32_bf16 v[56:59], v[88:91], v[96:99], v[56:59]
    v_mfma_f32_16x16x32_bf16 v[60:63], v[92:95], v[96:99], v[60:63]
    s_lshl_b32 s14, s98, 18
    ds_read2_b32 v[152:153], v239 offset0:48 offset1:49
    v_mfma_f32_16x16x32_bf16 v[60:63], v[88:91], v[100:103], v[60:63]
    s_add_u32 m0, s73, 16384
    ds_read2_b32 v[154:155], v239 offset0:50 offset1:51
    v_mfma_f32_16x16x32_bf16 v[60:63], v[84:87], v[104:107], v[60:63]
    buffer_load_dwordx4 v4, s[52:55], s14 offen offset:0 lds
    v_mfma_f32_16x16x32_bf16 v[60:63], v[80:83], v[108:111], v[60:63]
    ds_read_b128 v[188:191], v247 offset:30720
    v_mfma_f32_16x16x32_bf16 v[60:63], v[76:79], v[112:115], v[60:63]
    ds_read2_b32 v[156:157], v239 offset0:176 offset1:177
    v_mfma_f32_16x16x32_bf16 v[60:63], v[72:75], v[116:119], v[60:63]
    v_mfma_f32_16x16x32_bf16 v[60:63], v[68:71], v[120:123], v[60:63]
    ds_read2_b32 v[158:159], v239 offset0:178 offset1:179
    v_mfma_f32_16x16x32_bf16 v[60:63], v[64:67], v[124:127], v[60:63]
    s_waitcnt lgkmcnt(12)
    v_mfma_f32_16x16x32_bf16 v[32:35], v[128:131], v[160:163], v[32:35]
    ds_read_b128 v[96:99], v244 offset:0
    v_mfma_f32_16x16x32_bf16 v[36:39], v[132:135], v[160:163], v[36:39]
    v_mfma_f32_16x16x32_bf16 v[36:39], v[128:131], v[164:167], v[36:39]
    ds_read2_b32 v[64:65], v236 offset0:64 offset1:65
    v_mfma_f32_16x16x32_bf16 v[40:43], v[128:131], v[168:171], v[40:43]
    ds_read2_b32 v[66:67], v236 offset0:66 offset1:67
    v_mfma_f32_16x16x32_bf16 v[40:43], v[132:135], v[164:167], v[40:43]
    v_mfma_f32_16x16x32_bf16 v[40:43], v[136:139], v[160:163], v[40:43]
    s_add_u32 m0, s73, 16384
    ds_read_b128 v[100:103], v244 offset:4096
    v_mfma_f32_16x16x32_bf16 v[44:47], v[140:143], v[160:163], v[44:47]
    buffer_load_dwordx4 v5, s[52:55], s14 offen offset:1024 lds
    ds_read2_b32 v[68:69], v236 offset0:192 offset1:193
    v_mfma_f32_16x16x32_bf16 v[44:47], v[136:139], v[164:167], v[44:47]
    v_mfma_f32_16x16x32_bf16 v[44:47], v[132:135], v[168:171], v[44:47]
    ds_read2_b32 v[70:71], v236 offset0:194 offset1:195
    v_mfma_f32_16x16x32_bf16 v[44:47], v[128:131], v[172:175], v[44:47]
    ds_read_b128 v[104:107], v244 offset:8192
    s_waitcnt lgkmcnt(7)
    v_mfma_f32_16x16x32_bf16 v[48:51], v[128:131], v[176:179], v[48:51]
    ds_read2_b32 v[72:73], v237 offset0:64 offset1:65
    v_mfma_f32_16x16x32_bf16 v[48:51], v[132:135], v[172:175], v[48:51]
    ds_read2_b32 v[74:75], v237 offset0:66 offset1:67
    v_mfma_f32_16x16x32_bf16 v[48:51], v[136:139], v[168:171], v[48:51]
    ds_read_b128 v[108:111], v244 offset:12288
    v_mfma_f32_16x16x32_bf16 v[48:51], v[140:143], v[164:167], v[48:51]
    ds_read2_b32 v[76:77], v237 offset0:192 offset1:193
    v_mfma_f32_16x16x32_bf16 v[48:51], v[144:147], v[160:163], v[48:51]
    ds_read2_b32 v[78:79], v237 offset0:194 offset1:195
    s_waitcnt vmcnt(6)
    s_barrier
    v_mfma_f32_16x16x32_bf16 v[52:55], v[148:151], v[160:163], v[52:55]
    ds_read_b128 v[112:115], v244 offset:16384
    v_add_u32 v10, 131072, v10
    v_mfma_f32_16x16x32_bf16 v[52:55], v[144:147], v[164:167], v[52:55]
    ds_read_b64_tr_b16 a[192:193], v10 offset:16384
    v_mfma_f32_16x16x32_bf16 v[52:55], v[140:143], v[168:171], v[52:55]
    ds_read_b64_tr_b16 a[194:195], v10 offset:18432
    s_add_u32 m0, s73, 16384
    v_mfma_f32_16x16x32_bf16 v[52:55], v[136:139], v[172:175], v[52:55]
    buffer_load_dwordx4 v6, s[52:55], s14 offen offset:2048 lds
    ds_read2_b32 v[80:81], v238 offset0:64 offset1:65
    v_mfma_f32_16x16x32_bf16 v[52:55], v[132:135], v[176:179], v[52:55]
    ds_read_b64_tr_b16 a[200:201], v10 offset:20480
    v_mfma_f32_16x16x32_bf16 v[52:55], v[128:131], v[180:183], v[52:55]
    ds_read_b64_tr_b16 a[202:203], v10 offset:22528
    v_mfma_f32_16x16x32_bf16 v[56:59], v[128:131], v[184:187], v[56:59]
    ds_read2_b32 v[82:83], v238 offset0:66 offset1:67
    v_add_u32 v11, 131072, v11
    v_mfma_f32_16x16x32_bf16 v[56:59], v[132:135], v[180:183], v[56:59]
    ds_read_b64_tr_b16 a[196:197], v11 offset:16384
    v_mfma_f32_16x16x32_bf16 v[56:59], v[136:139], v[176:179], v[56:59]
    ds_read_b64_tr_b16 a[198:199], v11 offset:18432
    v_mfma_f32_16x16x32_bf16 v[56:59], v[140:143], v[172:175], v[56:59]
    ds_read_b128 v[116:119], v244 offset:20480
    v_mfma_f32_16x16x32_bf16 v[56:59], v[144:147], v[168:171], v[56:59]
    ds_read_b64_tr_b16 a[204:205], v11 offset:20480
    v_mfma_f32_16x16x32_bf16 v[56:59], v[148:151], v[164:167], v[56:59]
    ds_read_b64_tr_b16 a[206:207], v11 offset:22528
    v_mfma_f32_16x16x32_bf16 v[56:59], v[152:155], v[160:163], v[56:59]
    ds_read2_b32 v[84:85], v238 offset0:192 offset1:193
    v_mfma_f32_16x16x32_bf16 v[60:63], v[156:159], v[160:163], v[60:63]
    s_add_u32 m0, s73, 16384
    ds_read2_b32 v[86:87], v238 offset0:194 offset1:195
    v_mfma_f32_16x16x32_bf16 v[60:63], v[152:155], v[164:167], v[60:63]
    buffer_load_dwordx4 v7, s[52:55], s14 offen offset:3072 lds
    ds_read_b128 v[120:123], v244 offset:24576
    v_mfma_f32_16x16x32_bf16 v[60:63], v[148:151], v[168:171], v[60:63]
    ds_read2_b32 v[88:89], v239 offset0:64 offset1:65
    v_mfma_f32_16x16x32_bf16 v[60:63], v[144:147], v[172:175], v[60:63]
    ds_read2_b32 v[90:91], v239 offset0:66 offset1:67
    v_mfma_f32_16x16x32_bf16 v[60:63], v[140:143], v[176:179], v[60:63]
    ds_read_b128 v[124:127], v244 offset:28672
    v_mfma_f32_16x16x32_bf16 v[60:63], v[136:139], v[180:183], v[60:63]
    ds_read2_b32 v[92:93], v239 offset0:192 offset1:193
    v_mfma_f32_16x16x32_bf16 v[60:63], v[132:135], v[184:187], v[60:63]
    ds_read2_b32 v[94:95], v239 offset0:194 offset1:195
    v_mfma_f32_16x16x32_bf16 v[60:63], v[128:131], v[188:191], v[60:63]
    s_waitcnt lgkmcnt(15)
    v_mfma_f32_16x16x32_bf16 v[32:35], v[64:67], v[96:99], v[32:35]
    ds_read_b128 v[160:163], v245 offset:0
    v_mfma_f32_16x16x32_bf16 v[36:39], v[68:71], v[96:99], v[36:39]
    v_mfma_f32_16x16x32_bf16 v[36:39], v[64:67], v[100:103], v[36:39]
    ds_read2_b32 v[128:129], v236 offset0:80 offset1:81
    v_mfma_f32_16x16x32_bf16 v[40:43], v[64:67], v[104:107], v[40:43]
    ds_read2_b32 v[130:131], v236 offset0:82 offset1:83
    s_waitcnt lgkmcnt(11)
    s_barrier
    v_mfma_f32_16x16x32_bf16 v[40:43], v[68:71], v[100:103], v[40:43]
    v_mfma_f32_16x16x32_bf16 v[40:43], v[72:75], v[96:99], v[40:43]
    ds_read_b128 v[164:167], v245 offset:4096
    v_mfma_f32_16x16x32_bf16 v[44:47], v[76:79], v[96:99], v[44:47]
    ds_read2_b32 v[132:133], v236 offset0:208 offset1:209
    v_mfma_f32_16x16x32_bf16 v[44:47], v[72:75], v[100:103], v[44:47]
    s_lshl_b32 s14, s99, 18
    v_mfma_f32_16x16x32_bf16 v[44:47], v[68:71], v[104:107], v[44:47]
    s_add_u32 m0, s73, 147456
    ds_read2_b32 v[134:135], v236 offset0:210 offset1:211
    v_mfma_f32_16x16x32_bf16 v[44:47], v[64:67], v[108:111], v[44:47]
    buffer_load_dwordx4 v4, s[52:55], s14 offen offset:0 lds
    ds_read_b128 v[168:171], v245 offset:8192
    s_waitcnt lgkmcnt(7)
    v_mfma_f32_16x16x32_bf16 v[48:51], v[64:67], v[112:115], v[48:51]
    ds_read2_b32 v[136:137], v237 offset0:80 offset1:81
    v_mfma_f32_16x16x32_bf16 v[48:51], v[68:71], v[108:111], v[48:51]
    v_mfma_f32_16x16x32_bf16 v[48:51], v[72:75], v[104:107], v[48:51]
    ds_read2_b32 v[138:139], v237 offset0:82 offset1:83
    v_mfma_f32_16x16x32_bf16 v[48:51], v[76:79], v[100:103], v[48:51]
    ds_read_b128 v[172:175], v245 offset:12288
    v_mfma_f32_16x16x32_bf16 v[48:51], v[80:83], v[96:99], v[48:51]
    ds_read2_b32 v[140:141], v237 offset0:208 offset1:209
    v_mfma_f32_16x16x32_bf16 v[52:55], v[84:87], v[96:99], v[52:55]
    ds_read2_b32 v[142:143], v237 offset0:210 offset1:211
    v_mfma_f32_16x16x32_bf16 v[52:55], v[80:83], v[100:103], v[52:55]
    ds_read_b128 v[176:179], v245 offset:16384
    v_mfma_f32_16x16x32_bf16 v[52:55], v[76:79], v[104:107], v[52:55]
    ds_read2_b32 v[144:145], v238 offset0:80 offset1:81
    v_mfma_f32_16x16x32_bf16 v[52:55], v[72:75], v[108:111], v[52:55]
    ds_read2_b32 v[146:147], v238 offset0:82 offset1:83
    v_mfma_f32_16x16x32_bf16 v[52:55], v[68:71], v[112:115], v[52:55]
    s_add_u32 m0, s73, 147456
    ds_read_b128 v[180:183], v245 offset:20480
    v_mfma_f32_16x16x32_bf16 v[52:55], v[64:67], v[116:119], v[52:55]
    buffer_load_dwordx4 v5, s[52:55], s14 offen offset:1024 lds
    ds_read2_b32 v[148:149], v238 offset0:208 offset1:209
    v_mfma_f32_16x16x32_bf16 v[56:59], v[64:67], v[120:123], v[56:59]
    ds_read2_b32 v[150:151], v238 offset0:210 offset1:211
    v_mfma_f32_16x16x32_bf16 v[56:59], v[68:71], v[116:119], v[56:59]
    ds_read_b128 v[184:187], v245 offset:24576
    v_mfma_f32_16x16x32_bf16 v[56:59], v[72:75], v[112:115], v[56:59]
    ds_read2_b32 v[152:153], v239 offset0:80 offset1:81
    v_mfma_f32_16x16x32_bf16 v[56:59], v[76:79], v[108:111], v[56:59]
    ds_read2_b32 v[154:155], v239 offset0:82 offset1:83
    v_mfma_f32_16x16x32_bf16 v[56:59], v[80:83], v[104:107], v[56:59]
    ds_read_b128 v[188:191], v245 offset:28672
    s_waitcnt vmcnt(6)
    s_barrier
    v_mfma_f32_16x16x32_bf16 v[56:59], v[84:87], v[100:103], v[56:59]
    ds_read2_b32 v[156:157], v239 offset0:208 offset1:209
    v_add_u32 v10, -131072, v10
    v_mfma_f32_16x16x32_bf16 v[56:59], v[88:91], v[96:99], v[56:59]
    ds_read_b64_tr_b16 a[208:209], v10 offset:0
    v_mfma_f32_16x16x32_bf16 v[60:63], v[92:95], v[96:99], v[60:63]
    ds_read_b64_tr_b16 a[210:211], v10 offset:2048
    v_mfma_f32_16x16x32_bf16 v[60:63], v[88:91], v[100:103], v[60:63]
    ds_read_b64_tr_b16 a[216:217], v10 offset:4096
    v_mfma_f32_16x16x32_bf16 v[60:63], v[84:87], v[104:107], v[60:63]
    ds_read2_b32 v[158:159], v239 offset0:210 offset1:211
    v_mfma_f32_16x16x32_bf16 v[60:63], v[80:83], v[108:111], v[60:63]
    ds_read_b64_tr_b16 a[218:219], v10 offset:6144
    s_add_u32 m0, s73, 147456
    v_mfma_f32_16x16x32_bf16 v[60:63], v[76:79], v[112:115], v[60:63]
    v_add_u32 v11, -131072, v11
    buffer_load_dwordx4 v6, s[52:55], s14 offen offset:2048 lds
    v_mfma_f32_16x16x32_bf16 v[60:63], v[72:75], v[116:119], v[60:63]
    ds_read_b64_tr_b16 a[212:213], v11 offset:0
    v_mfma_f32_16x16x32_bf16 v[60:63], v[68:71], v[120:123], v[60:63]
    ds_read_b64_tr_b16 a[214:215], v11 offset:2048
    v_mfma_f32_16x16x32_bf16 v[60:63], v[64:67], v[124:127], v[60:63]
    ds_read_b64_tr_b16 a[220:221], v11 offset:4096
    s_waitcnt lgkmcnt(15)
    v_mfma_f32_16x16x32_bf16 v[32:35], v[128:131], v[160:163], v[32:35]
    ds_read_b64_tr_b16 a[222:223], v11 offset:6144
    v_mfma_f32_16x16x32_bf16 v[36:39], v[132:135], v[160:163], v[36:39]
    ds_read_b128 v[96:99], v246 offset:0
    v_mfma_f32_16x16x32_bf16 v[36:39], v[128:131], v[164:167], v[36:39]
    ds_read2_b32 v[64:65], v236 offset0:96 offset1:97
    v_mfma_f32_16x16x32_bf16 v[40:43], v[128:131], v[168:171], v[40:43]
    ds_read2_b32 v[66:67], v236 offset0:98 offset1:99
    v_mfma_f32_16x16x32_bf16 v[40:43], v[132:135], v[164:167], v[40:43]
    v_mfma_f32_16x16x32_bf16 v[40:43], v[136:139], v[160:163], v[40:43]
    ds_read_b128 v[100:103], v246 offset:4096
    v_mfma_f32_16x16x32_bf16 v[44:47], v[140:143], v[160:163], v[44:47]
    ds_read2_b32 v[68:69], v236 offset0:224 offset1:225
    v_mfma_f32_16x16x32_bf16 v[44:47], v[136:139], v[164:167], v[44:47]
    s_add_u32 m0, s73, 147456
    v_mfma_f32_16x16x32_bf16 v[44:47], v[132:135], v[168:171], v[44:47]
    buffer_load_dwordx4 v7, s[52:55], s14 offen offset:3072 lds
    ds_read2_b32 v[70:71], v236 offset0:226 offset1:227
    v_mfma_f32_16x16x32_bf16 v[44:47], v[128:131], v[172:175], v[44:47]
    ds_read_b128 v[104:107], v246 offset:8192
    s_waitcnt lgkmcnt(12)
    v_mfma_f32_16x16x32_bf16 v[48:51], v[128:131], v[176:179], v[48:51]
    ds_read2_b32 v[72:73], v237 offset0:96 offset1:97
    v_mfma_f32_16x16x32_bf16 v[48:51], v[132:135], v[172:175], v[48:51]
    v_mfma_f32_16x16x32_bf16 v[48:51], v[136:139], v[168:171], v[48:51]
    ds_read2_b32 v[74:75], v237 offset0:98 offset1:99
    v_mfma_f32_16x16x32_bf16 v[48:51], v[140:143], v[164:167], v[48:51]
    ds_read_b128 v[108:111], v246 offset:12288
    v_mfma_f32_16x16x32_bf16 v[48:51], v[144:147], v[160:163], v[48:51]
    s_waitcnt lgkmcnt(10)
    s_barrier
    v_mfma_f32_16x16x32_bf16 v[52:55], v[148:151], v[160:163], v[52:55]
    ds_read2_b32 v[76:77], v237 offset0:224 offset1:225
    v_mfma_f32_16x16x32_bf16 v[52:55], v[144:147], v[164:167], v[52:55]
    ds_read2_b32 v[78:79], v237 offset0:226 offset1:227
    v_mfma_f32_16x16x32_bf16 v[52:55], v[140:143], v[168:171], v[52:55]
    v_mfma_f32_16x16x32_bf16 v[52:55], v[136:139], v[172:175], v[52:55]
    s_lshl_b32 s14, s100, 18
    ds_read_b128 v[112:115], v246 offset:16384
    v_mfma_f32_16x16x32_bf16 v[52:55], v[132:135], v[176:179], v[52:55]
    s_add_u32 m0, s73, 0
    ds_read2_b32 v[80:81], v238 offset0:96 offset1:97
    v_mfma_f32_16x16x32_bf16 v[52:55], v[128:131], v[180:183], v[52:55]
    buffer_load_dwordx4 v4, s[52:55], s14 offen offset:0 lds
    v_mfma_f32_16x16x32_bf16 v[56:59], v[128:131], v[184:187], v[56:59]
    ds_read2_b32 v[82:83], v238 offset0:98 offset1:99
    v_mfma_f32_16x16x32_bf16 v[56:59], v[132:135], v[180:183], v[56:59]
    ds_read_b128 v[116:119], v246 offset:20480
    v_mfma_f32_16x16x32_bf16 v[56:59], v[136:139], v[176:179], v[56:59]
    v_mfma_f32_16x16x32_bf16 v[56:59], v[140:143], v[172:175], v[56:59]
    ds_read2_b32 v[84:85], v238 offset0:224 offset1:225
    v_mfma_f32_16x16x32_bf16 v[56:59], v[144:147], v[168:171], v[56:59]
    ds_read2_b32 v[86:87], v238 offset0:226 offset1:227
    v_mfma_f32_16x16x32_bf16 v[56:59], v[148:151], v[164:167], v[56:59]
    ds_read_b128 v[120:123], v246 offset:24576
    v_mfma_f32_16x16x32_bf16 v[56:59], v[152:155], v[160:163], v[56:59]
    v_mfma_f32_16x16x32_bf16 v[60:63], v[156:159], v[160:163], v[60:63]
    ds_read2_b32 v[88:89], v239 offset0:96 offset1:97
    v_mfma_f32_16x16x32_bf16 v[60:63], v[152:155], v[164:167], v[60:63]
    s_add_u32 m0, s73, 0
    ds_read2_b32 v[90:91], v239 offset0:98 offset1:99
    v_mfma_f32_16x16x32_bf16 v[60:63], v[148:151], v[168:171], v[60:63]
    buffer_load_dwordx4 v5, s[52:55], s14 offen offset:1024 lds
    v_mfma_f32_16x16x32_bf16 v[60:63], v[144:147], v[172:175], v[60:63]
    ds_read_b128 v[124:127], v246 offset:28672
    v_mfma_f32_16x16x32_bf16 v[60:63], v[140:143], v[176:179], v[60:63]
    ds_read2_b32 v[92:93], v239 offset0:224 offset1:225
    v_mfma_f32_16x16x32_bf16 v[60:63], v[136:139], v[180:183], v[60:63]
    v_mfma_f32_16x16x32_bf16 v[60:63], v[132:135], v[184:187], v[60:63]
    ds_read2_b32 v[94:95], v239 offset0:226 offset1:227
    v_mfma_f32_16x16x32_bf16 v[60:63], v[128:131], v[188:191], v[60:63]
    s_waitcnt lgkmcnt(12)
    v_mfma_f32_16x16x32_bf16 v[32:35], v[64:67], v[96:99], v[32:35]
    ds_read_b128 v[160:163], v247 offset:0
    s_waitcnt vmcnt(6)
    s_barrier
    v_mfma_f32_16x16x32_bf16 v[36:39], v[68:71], v[96:99], v[36:39]
    ds_read_b64_tr_b16 a[224:225], v10 offset:16384
    s_bfe_u32 s4, s2, 0x20003
    v_mfma_f32_16x16x32_bf16 v[36:39], v[64:67], v[100:103], v[36:39]
    ds_read_b64_tr_b16 a[226:227], v10 offset:18432
    ds_read_b128 v[164:167], v247 offset:4096
    v_mfma_f32_16x16x32_bf16 v[40:43], v[64:67], v[104:107], v[40:43]
    s_lshl2_add_u32 s4, s72, s4
    ds_read_b128 v[168:171], v247 offset:8192
    v_mfma_f32_16x16x32_bf16 v[40:43], v[68:71], v[100:103], v[40:43]
    ds_read_b64_tr_b16 a[232:233], v10 offset:20480
    s_add_u32 m0, s73, 0
    ds_read_b128 v[172:175], v247 offset:12288
    v_mfma_f32_16x16x32_bf16 v[40:43], v[72:75], v[96:99], v[40:43]
    ds_read_b64_tr_b16 a[234:235], v10 offset:22528
    buffer_load_dwordx4 v6, s[52:55], s14 offen offset:2048 lds
    s_lshl_b32 s4, s4, 2
    v_mfma_f32_16x16x32_bf16 v[44:47], v[76:79], v[96:99], v[44:47]
    ds_read_b128 v[176:179], v247 offset:16384
    v_mfma_f32_16x16x32_bf16 v[44:47], v[72:75], v[100:103], v[44:47]
    ds_read_b64_tr_b16 a[228:229], v11 offset:16384
    s_lshr_b32 s5, s2, 4
    ds_read_b128 v[180:183], v247 offset:20480
    v_mfma_f32_16x16x32_bf16 v[44:47], v[68:71], v[104:107], v[44:47]
    ds_read_b64_tr_b16 a[230:231], v11 offset:18432
    v_mfma_f32_16x16x32_bf16 v[44:47], v[64:67], v[108:111], v[44:47]
    s_and_b32 s5, s5, 2
    ds_read_b128 v[184:187], v247 offset:24576
    s_waitcnt lgkmcnt(13)
    v_mfma_f32_16x16x32_bf16 v[48:51], v[64:67], v[112:115], v[48:51]
    ds_read_b64_tr_b16 a[236:237], v11 offset:20480
    ds_read_b128 v[188:191], v247 offset:28672
    v_mfma_f32_16x16x32_bf16 v[48:51], v[68:71], v[108:111], v[48:51]
    ds_read_b64_tr_b16 a[238:239], v11 offset:22528
    s_add_u32 s4, s4, s5
    v_mfma_f32_16x16x32_bf16 v[48:51], v[72:75], v[104:107], v[48:51]
    ds_read2_b32 v[128:129], v236 offset0:112 offset1:113
    v_mfma_f32_16x16x32_bf16 v[48:51], v[76:79], v[100:103], v[48:51]
    s_and_b32 s5, s2, 1
    ds_read2_b32 v[130:131], v236 offset0:114 offset1:115
    v_mfma_f32_16x16x32_bf16 v[48:51], v[80:83], v[96:99], v[48:51]
    ds_read2_b32 v[132:133], v236 offset0:240 offset1:241
    v_mfma_f32_16x16x32_bf16 v[52:55], v[84:87], v[96:99], v[52:55]
    s_add_u32 m0, s73, 0
    ds_read2_b32 v[134:135], v236 offset0:242 offset1:243
    s_add_u32 s4, s4, s5
    v_mfma_f32_16x16x32_bf16 v[52:55], v[80:83], v[100:103], v[52:55]
    buffer_load_dwordx4 v7, s[52:55], s14 offen offset:3072 lds
    ds_read2_b32 v[136:137], v237 offset0:112 offset1:113
    v_mfma_f32_16x16x32_bf16 v[52:55], v[76:79], v[104:107], v[52:55]
    s_lshl_b32 s4, s4, 7
    ds_read2_b32 v[138:139], v237 offset0:114 offset1:115
    v_mfma_f32_16x16x32_bf16 v[52:55], v[72:75], v[108:111], v[52:55]
    s_add_u32 s4, s4, 12566528
    ds_read2_b32 v[140:141], v237 offset0:240 offset1:241
    s_add_u32 s6, s12, 4767744
    v_mfma_f32_16x16x32_bf16 v[52:55], v[68:71], v[112:115], v[52:55]
    ds_read2_b32 v[142:143], v237 offset0:242 offset1:243
    v_mfma_f32_16x16x32_bf16 v[52:55], v[64:67], v[116:119], v[52:55]
    ds_read2_b32 v[144:145], v238 offset0:112 offset1:113
    v_lshl_add_u32 v28, v2, 2, s4
    v_mfma_f32_16x16x32_bf16 v[56:59], v[64:67], v[120:123], v[56:59]
    s_waitcnt lgkmcnt(9)
    s_barrier
    v_mfma_f32_16x16x32_bf16 v[56:59], v[68:71], v[116:119], v[56:59]
    ds_read2_b32 v[146:147], v238 offset0:114 offset1:115
    s_cmp_eq_u32 s3, 0
    s_cselect_b32 s4, 18, 0
    v_mfma_f32_16x16x32_bf16 v[56:59], v[72:75], v[112:115], v[56:59]
    ds_read2_b32 v[148:149], v238 offset0:240 offset1:241
    v_mfma_f32_16x16x32_bf16 v[56:59], v[76:79], v[108:111], v[56:59]
    ds_read2_b32 v[150:151], v238 offset0:242 offset1:243
    v_cmp_gt_u32 vcc, s4, v2
    v_mfma_f32_16x16x32_bf16 v[56:59], v[80:83], v[104:107], v[56:59]
    s_lshl_b32 s14, s101, 18
    ds_read2_b32 v[152:153], v239 offset0:112 offset1:113
    v_mfma_f32_16x16x32_bf16 v[56:59], v[84:87], v[100:103], v[56:59]
    ds_read2_b32 v[154:155], v239 offset0:114 offset1:115
    s_add_u32 m0, s73, 16384
    v_mov_b32 v13, 0x40000000
    v_mfma_f32_16x16x32_bf16 v[56:59], v[88:91], v[96:99], v[56:59]
    buffer_load_dwordx4 v4, s[52:55], s14 offen offset:0 lds
    ds_read2_b32 v[156:157], v239 offset0:240 offset1:241
    v_mfma_f32_16x16x32_bf16 v[60:63], v[92:95], v[96:99], v[60:63]
    ds_read2_b32 v[158:159], v239 offset0:242 offset1:243
    v_cndmask_b32 v28, v13, v28, vcc
    v_mfma_f32_16x16x32_bf16 v[60:63], v[88:91], v[100:103], v[60:63]
    v_mfma_f32_16x16x32_bf16 v[60:63], v[84:87], v[104:107], v[60:63]
    v_mov_b32 v13, s68
    v_mfma_f32_16x16x32_bf16 v[60:63], v[80:83], v[108:111], v[60:63]
    v_mfma_f32_16x16x32_bf16 v[60:63], v[76:79], v[112:115], v[60:63]
    v_cndmask_b32 v13, 0, v13, vcc
    v_mfma_f32_16x16x32_bf16 v[60:63], v[72:75], v[116:119], v[60:63]
    v_mfma_f32_16x16x32_bf16 v[60:63], v[68:71], v[120:123], v[60:63]
    v_mfma_f32_16x16x32_bf16 v[60:63], v[64:67], v[124:127], v[60:63]
    s_waitcnt lgkmcnt(0)
    v_mfma_f32_16x16x32_bf16 v[60:63], v[128:131], v[188:191], v[60:63]
    v_mfma_f32_16x16x32_bf16 v[60:63], v[132:135], v[184:187], v[60:63]
    s_add_u32 m0, s73, 16384
    v_mfma_f32_16x16x32_bf16 v[60:63], v[136:139], v[180:183], v[60:63]
    buffer_load_dwordx4 v5, s[52:55], s14 offen offset:1024 lds
    v_mfma_f32_16x16x32_bf16 v[60:63], v[140:143], v[176:179], v[60:63]
    v_mfma_f32_16x16x32_bf16 v[60:63], v[144:147], v[172:175], v[60:63]
    v_mfma_f32_16x16x32_bf16 v[60:63], v[148:151], v[168:171], v[60:63]
    v_mfma_f32_16x16x32_bf16 v[60:63], v[152:155], v[164:167], v[60:63]
    v_mfma_f32_16x16x32_bf16 v[60:63], v[156:159], v[160:163], v[60:63]
    v_mfma_f32_16x16x32_bf16 v[56:59], v[128:131], v[184:187], v[56:59]
    v_mfma_f32_16x16x32_bf16 v[56:59], v[132:135], v[180:183], v[56:59]
    v_mfma_f32_16x16x32_bf16 v[56:59], v[136:139], v[176:179], v[56:59]
    v_mfma_f32_16x16x32_bf16 v[56:59], v[140:143], v[172:175], v[56:59]
    s_add_u32 m0, s73, 16384
    v_mfma_f32_16x16x32_bf16 v[56:59], v[144:147], v[168:171], v[56:59]
    buffer_load_dwordx4 v6, s[52:55], s14 offen offset:2048 lds
    v_mfma_f32_16x16x32_bf16 v[56:59], v[148:151], v[164:167], v[56:59]
    v_cvt_pk_bf16_f32 v206, v60, v61
    v_mfma_f32_16x16x32_bf16 v[56:59], v[152:155], v[160:163], v[56:59]
    s_waitcnt vmcnt(7)
    s_barrier
    v_mfma_f32_16x16x32_bf16 v[52:55], v[128:131], v[180:183], v[52:55]
    v_add_u32 v10, 131072, v10
    v_mfma_f32_16x16x32_bf16 v[52:55], v[132:135], v[176:179], v[52:55]
    ds_read_b64_tr_b16 a[240:241], v10 offset:16384
    v_cvt_pk_bf16_f32 v207, v62, v63
    v_mfma_f32_16x16x32_bf16 v[52:55], v[136:139], v[172:175], v[52:55]
    ds_read_b64_tr_b16 a[242:243], v10 offset:18432
    v_mfma_f32_16x16x32_bf16 v[52:55], v[140:143], v[168:171], v[52:55]
    buffer_store_dwordx2 v[206:207], v8, s[44:47], s6 offen offset:3584 sc1
    v_mfma_f32_16x16x32_bf16 v[52:55], v[144:147], v[164:167], v[52:55]
    ds_read_b64_tr_b16 a[248:249], v10 offset:20480
    v_mfma_f32_16x16x32_bf16 v[52:55], v[148:151], v[160:163], v[52:55]
    ds_read_b64_tr_b16 a[250:251], v10 offset:22528
    v_mfma_f32_16x16x32_bf16 v[48:51], v[128:131], v[176:179], v[48:51]
    v_add_u32 v11, 131072, v11
    v_cvt_pk_bf16_f32 v204, v56, v57
    v_mfma_f32_16x16x32_bf16 v[48:51], v[132:135], v[172:175], v[48:51]
    ds_read_b64_tr_b16 a[244:245], v11 offset:16384
    s_add_u32 m0, s73, 16384
    v_mfma_f32_16x16x32_bf16 v[48:51], v[136:139], v[168:171], v[48:51]
    ds_read_b64_tr_b16 a[246:247], v11 offset:18432
    buffer_load_dwordx4 v7, s[52:55], s14 offen offset:3072 lds
    v_mfma_f32_16x16x32_bf16 v[48:51], v[140:143], v[164:167], v[48:51]
    v_cvt_pk_bf16_f32 v205, v58, v59
L_pl_X_6:
    s_cbranch_execz L_wret
    v_mfma_f32_16x16x32_bf16 v[48:51], v[144:147], v[160:163], v[48:51]
    ds_read_b64_tr_b16 a[252:253], v11 offset:20480
    v_mfma_f32_16x16x32_bf16 v[44:47], v[128:131], v[172:175], v[44:47]
    buffer_store_dwordx2 v[204:205], v8, s[44:47], s6 offen offset:3072 sc1
    ds_read_b64_tr_b16 a[254:255], v11 offset:22528
    v_mfma_f32_16x16x32_bf16 v[44:47], v[132:135], v[168:171], v[44:47]
    v_mfma_f32_16x16x32_bf16 v[44:47], v[136:139], v[164:167], v[44:47]
    v_mfma_f32_16x16x32_bf16 v[44:47], v[140:143], v[160:163], v[44:47]
    v_cvt_pk_bf16_f32 v202, v52, v53
    v_mfma_f32_16x16x32_bf16 v[40:43], v[128:131], v[168:171], v[40:43]
    v_mfma_f32_16x16x32_bf16 v[40:43], v[132:135], v[164:167], v[40:43]
    v_mfma_f32_16x16x32_bf16 v[40:43], v[136:139], v[160:163], v[40:43]
    v_cvt_pk_bf16_f32 v203, v54, v55
    v_mfma_f32_16x16x32_bf16 v[36:39], v[128:131], v[164:167], v[36:39]
    v_mfma_f32_16x16x32_bf16 v[36:39], v[132:135], v[160:163], v[36:39]
    buffer_store_dwordx2 v[202:203], v8, s[44:47], s6 offen offset:2560 sc1
    v_mfma_f32_16x16x32_bf16 v[32:35], v[128:131], v[160:163], v[32:35]
    v_mov_b32 v29, 0
    buffer_atomic_add v29, v28, s[44:47], 0 offen sc0 sc1
    v_cvt_pk_bf16_f32 v200, v48, v49
    v_cvt_pk_bf16_f32 v201, v50, v51
    buffer_store_dwordx2 v[200:201], v8, s[44:47], s6 offen offset:2048 sc1
    v_cvt_pk_bf16_f32 v198, v44, v45
    v_cvt_pk_bf16_f32 v199, v46, v47
    buffer_store_dwordx2 v[198:199], v8, s[44:47], s6 offen offset:1536 sc1
    v_cvt_pk_bf16_f32 v196, v40, v41
    v_cvt_pk_bf16_f32 v197, v42, v43
    buffer_store_dwordx2 v[196:197], v8, s[44:47], s6 offen offset:1024 sc1
    v_cvt_pk_bf16_f32 v194, v36, v37
    v_cvt_pk_bf16_f32 v195, v38, v39
    buffer_store_dwordx2 v[194:195], v8, s[44:47], s6 offen offset:512 sc1
    v_cvt_pk_bf16_f32 v192, v32, v33
    v_cvt_pk_bf16_f32 v193, v34, v35
    buffer_store_dwordx2 v[192:193], v8, s[44:47], s6 offen offset:0 sc1
    v_add_u32 v10, -131072, v10
    v_add_u32 v11, -131072, v11
    s_waitcnt lgkmcnt(0)
    s_barrier
L_DX:
    s_waitcnt vmcnt(0)
    v_cmp_ne_u32 vcc, v13, v29
    s_cbranch_vccnz L_rs_p2X
L_ok_p2X:
    s_barrier
    s_add_u32 m0, s73, 97536
    s_nop 0
    buffer_load_dwordx4 v23, s[44:47], s18 offen offset:768 sc1 lds
    s_add_u32 m0, s73, 99328
    s_nop 0
    buffer_load_dwordx4 v20, s[44:47], s18 offen offset:0 sc1 lds
    s_add_u32 m0, s73, 99840
    s_nop 0
    buffer_load_dwordx4 v20, s[44:47], s18 offen offset:512 sc1 lds
    s_add_u32 m0, s73, 100608
    s_nop 0
    buffer_load_dwordx4 v23, s[44:47], s19 offen offset:768 sc1 lds
    s_add_u32 m0, s73, 114688
    s_nop 0
    buffer_load_dwordx4 v20, s[44:47], s19 offen offset:0 sc1 lds
    s_add_u32 m0, s73, 115200
    s_nop 0
    buffer_load_dwordx4 v20, s[44:47], s19 offen offset:512 sc1 lds
    s_add_u32 m0, s73, 115968
    s_nop 0
    buffer_load_dwordx4 v23, s[44:47], s20 offen offset:768 sc1 lds
    s_add_u32 m0, s73, 117760
    s_nop 0
    buffer_load_dwordx4 v20, s[44:47], s20 offen offset:0 sc1 lds
    s_mov_b32 s56, s16
    s_and_b32 s57, s17, 0xffff
    s_mov_b32 s58, 2359296
    s_mov_b32 s59, 0x20000
    s_mov_b32 s40, 18432
    s_mov_b32 s42, 12386304
    s_mov_b32 s64, s38
    s_and_b32 s65, s39, 0xffff
    s_mov_b32 s66, 2359296
    s_mov_b32 s67, 0x20000
    v_lshlrev_b32 v136, 4, v2
    s_mul_i32 s7, s72, 36
    s_bitcmp1_b32 s3, 0
    s_addc_u32 s7, s7, 0
    s_lshl_b32 s7, s7, 17
    v_subrev_u32 v184, s7, v4
    v_subrev_u32 v185, s7, v5
    s_bfe_u32 s4, s2, 0x20003
    s_mul_i32 s4, s4, 9
    s_lshl1_add_u32 s7, s72, s4
    s_and_b32 s8, s3, 1
    s_add_u32 s7, s7, s8
    s_lshl_b32 s37, s7, 16
    s_add_u32 s37, s37, 4718592
    s_add_u32 s4, s4, 8
    s_lshl_b32 s16, s4, 16
    s_add_u32 s16, s16, 4718592
    s_sub_u32 s4, s4, s7
    s_lshl_b32 s4, s4, 7
    s_lshl_b32 s7, s7, 7
    s_add_u32 s7, s7, 12582912
    v_bfe_u32 v24, v2, 2, 1
    v_mul_u32_u24 v24, s4, v24
    v_and_b32 v25, 3, v2
    v_lshl_add_u32 v24, v25, 2, v24
    v_add_u32 v188, s7, v24
    s_lshl2_add_u32 s7, s2, s3
    s_mul_i32 s8, s7, 3072
    s_add_u32 s34, s8, 40828928
    s_add_u32 s11, s8, 43974656
    s_add_u32 s12, s8, 47120384
    s_lshl_b32 s35, s7, 12
    s_add_u32 s35, s35, 50266112
    s_xor_b32 s8, s7, 8
    s_mul_i32 s8, s8, 3072
    s_add_u32 s30, s8, 40828928
    s_xor_b32 s8, s7, 16
    s_mul_i32 s8, s8, 3072
    s_add_u32 s15, s8, 43974656
    s_xor_b32 s8, s7, 24
    s_mul_i32 s8, s8, 3072
    s_add_u32 s31, s8, 47120384
    s_andn2_b32 s7, s7, 24
    s_lshl3_add_u32 s7, s3, s7
    s_lshl2_add_u32 s8, s7, s72
    s_lshl_b32 s8, s8, 10
    s_add_u32 s32, s8, 50266112
    s_xor_b32 s8, s8, 4096
    s_add_u32 s33, s8, 50266112
    s_xor_b32 s8, s3, s72
    s_cmp_lt_u32 s8, 2
    s_cselect_b32 s35, s35, 0x40000000
    s_cselect_b32 s16, s16, 0x40000000
    s_cselect_b32 s36, s68, 0
    s_mov_b32 s38, 0xbfb8aa3b
    s_and_b32 s8, s8, 1
    s_mul_i32 s41, s8, 96
    s_and_b32 s43, s73, 4096
    v_lshlrev_b32 v24, 10, v2
    v_add_u32 v24, s35, v24
    s_add_u32 s7, s34, 2048
    v_mov_b32 v25, s36
    v_cmp_gt_u32 vcc, 4, v2
    s_nop 1
    v_cndmask_b32 v138, 0, v25, vcc
    v_mov_b32 v25, 0x40000000
    v_cndmask_b32 v137, v25, v24, vcc
    v_writelane_b32 v137, s7, 4
    v_writelane_b32 v138, s68, 4
    v_min_u32 v139, 1, v2
    v_lshlrev_b32 v139, 30, v139
    v_mov_b32 v140, 0
    v_writelane_b32 v140, s68, 0
    v_mov_b32 v195, s68
    v_mov_b32 v199, s68
    v_mov_b32 v202, s68
    v_mov_b32 v203, s68
    s_waitcnt vmcnt(4)
    s_barrier
    ds_read_b128 v[104:107], v14 offset:0
    ds_read_b128 v[108:111], v14 offset:4096
    ds_read_b128 v[112:115], v14 offset:8192
    ds_read_b128 v[116:119], v14 offset:12288
    s_waitcnt lgkmcnt(2)
    v_mfma_f32_16x16x32_bf16 v[32:35], v[104:107], a[0:3], 0
    s_add_u32 m0, s73, 130560
    s_sub_u32 s4, s75, 216
    s_lshl_b32 s7, s4, 7
    v_mfma_f32_16x16x32_bf16 v[32:35], v[108:111], a[8:11], v[32:35]
    buffer_load_dwordx4 v20, s[44:47], s20 offen offset:512 sc1 lds
    s_waitcnt lgkmcnt(0)
    v_mfma_f32_16x16x32_bf16 v[32:35], v[112:115], a[16:19], v[32:35]
    ds_read_b128 v[120:123], v14 offset:1024
    s_lshl2_add_u32 s7, s3, s7
    s_add_u32 s7, s7, 12582912
    v_mfma_f32_16x16x32_bf16 v[32:35], v[116:119], a[24:27], v[32:35]
    ds_read_b128 v[124:127], v14 offset:5120
    v_mfma_f32_16x16x32_bf16 v[36:39], v[116:119], a[28:31], 0
    ds_read_b128 v[128:131], v14 offset:9216
    s_cmp_lt_u32 s4, 36
    s_cselect_b32 s7, s7, 0x40000000
    v_mfma_f32_16x16x32_bf16 v[36:39], v[112:115], a[20:23], v[36:39]
    ds_read_b128 v[132:135], v14 offset:13312
    v_min_u32 v28, 1, v2
    v_mfma_f32_16x16x32_bf16 v[36:39], v[108:111], a[12:15], v[36:39]
    s_add_u32 m0, s73, 131328
    v_lshlrev_b32 v28, 30, v28
    v_mov_b32 v29, s68
    v_mfma_f32_16x16x32_bf16 v[36:39], v[104:107], a[4:7], v[36:39]
    buffer_load_dwordx4 v23, s[44:47], s21 offen offset:768 sc1 lds
    s_waitcnt lgkmcnt(2)
    v_mfma_f32_16x16x32_bf16 v[44:47], v[120:123], a[4:7], 0
    buffer_store_dword v29, v28, s[44:47], s7 offen sc1
    s_add_u32 m0, s73, 133120
    v_mfma_f32_16x16x32_bf16 v[44:47], v[124:127], a[12:15], v[44:47]
    buffer_load_dwordx4 v20, s[44:47], s21 offen offset:0 sc1 lds
    s_waitcnt lgkmcnt(0)
    v_mfma_f32_16x16x32_bf16 v[44:47], v[128:131], a[20:23], v[44:47]
    ds_read_b128 v[104:107], v14 offset:2048
    v_mfma_f32_16x16x32_bf16 v[44:47], v[132:135], a[28:31], v[44:47]
    ds_read_b128 v[108:111], v14 offset:6144
    v_mfma_f32_16x16x32_bf16 v[40:43], v[132:135], a[24:27], 0
    ds_read_b128 v[112:115], v14 offset:10240
    v_mfma_f32_16x16x32_bf16 v[40:43], v[128:131], a[16:19], v[40:43]
    ds_read_b128 v[116:119], v14 offset:14336
    v_mfma_f32_16x16x32_bf16 v[40:43], v[124:127], a[8:11], v[40:43]
    s_add_u32 m0, s73, 133632
    v_mfma_f32_16x16x32_bf16 v[40:43], v[120:123], a[0:3], v[40:43]
    buffer_load_dwordx4 v20, s[44:47], s21 offen offset:512 sc1 lds
    s_waitcnt lgkmcnt(2)
    v_mfma_f32_16x16x32_bf16 v[48:51], v[104:107], a[0:3], 0
    s_add_u32 m0, s73, 146688
    v_mfma_f32_16x16x32_bf16 v[48:51], v[108:111], a[8:11], v[48:51]
    buffer_load_dwordx4 v23, s[44:47], s22 offen offset:768 sc1 lds
    s_waitcnt lgkmcnt(0)
    v_mfma_f32_16x16x32_bf16 v[48:51], v[112:115], a[16:19], v[48:51]
    ds_read_b128 v[120:123], v14 offset:3072
    v_mfma_f32_16x16x32_bf16 v[48:51], v[116:119], a[24:27], v[48:51]
    ds_read_b128 v[124:127], v14 offset:7168
    v_mfma_f32_16x16x32_bf16 v[52:55], v[116:119], a[28:31], 0
    ds_read_b128 v[128:131], v14 offset:11264
    v_mfma_f32_16x16x32_bf16 v[52:55], v[112:115], a[20:23], v[52:55]
    ds_read_b128 v[132:135], v14 offset:15360
    v_mfma_f32_16x16x32_bf16 v[52:55], v[108:111], a[12:15], v[52:55]
    s_add_u32 m0, s73, 148480
    v_mfma_f32_16x16x32_bf16 v[52:55], v[104:107], a[4:7], v[52:55]
    buffer_load_dwordx4 v20, s[44:47], s22 offen offset:0 sc1 lds
    s_waitcnt lgkmcnt(2)
    v_mfma_f32_16x16x32_bf16 v[36:39], v[120:123], a[36:39], v[36:39]
    s_add_u32 m0, s73, 148992
    v_mfma_f32_16x16x32_bf16 v[36:39], v[124:127], a[44:47], v[36:39]
    buffer_load_dwordx4 v20, s[44:47], s22 offen offset:512 sc1 lds
    s_waitcnt lgkmcnt(0)
    v_mfma_f32_16x16x32_bf16 v[36:39], v[128:131], a[52:55], v[36:39]
    s_waitcnt vmcnt(8)
    s_barrier
    v_mfma_f32_16x16x32_bf16 v[36:39], v[132:135], a[60:63], v[36:39]
    ds_read_b128 v[104:107], v14 offset:16384
    v_mfma_f32_16x16x32_bf16 v[32:35], v[132:135], a[56:59], v[32:35]
    ds_read_b128 v[108:111], v14 offset:20480
    v_mfma_f32_16x16x32_bf16 v[32:35], v[128:131], a[48:51], v[32:35]
    ds_read_b128 v[112:115], v14 offset:24576
    v_mfma_f32_16x16x32_bf16 v[32:35], v[124:127], a[40:43], v[32:35]
    ds_read_b128 v[116:119], v14 offset:28672
    s_add_u32 m0, s73, 149760
    v_mfma_f32_16x16x32_bf16 v[32:35], v[120:123], a[32:35], v[32:35]
    buffer_load_dwordx4 v23, s[44:47], s23 offen offset:768 sc1 lds
    ds_read_b64_tr_b16 v[220:221], v10 offset:0
    s_waitcnt lgkmcnt(3)
    v_mfma_f32_16x16x32_bf16 v[40:43], v[104:107], a[32:35], v[40:43]
    s_add_u32 m0, s73, 98304
    ds_read_b64_tr_b16 v[222:223], v10 offset:2048
    v_mfma_f32_16x16x32_bf16 v[40:43], v[108:111], a[40:43], v[40:43]
    buffer_load_dwordx4 v20, s[44:47], s23 offen offset:0 sc1 lds
    s_waitcnt lgkmcnt(2)
    v_mfma_f32_16x16x32_bf16 v[40:43], v[112:115], a[48:51], v[40:43]
    ds_read_b128 v[120:123], v14 offset:17408
    v_mfma_f32_16x16x32_bf16 v[40:43], v[116:119], a[56:59], v[40:43]
    ds_read_b128 v[124:127], v14 offset:21504
    v_mfma_f32_16x16x32_bf16 v[44:47], v[116:119], a[60:63], v[44:47]
    ds_read_b128 v[128:131], v14 offset:25600
    v_mfma_f32_16x16x32_bf16 v[44:47], v[112:115], a[52:55], v[44:47]
    ds_read_b128 v[132:135], v14 offset:29696
    v_mfma_f32_16x16x32_bf16 v[44:47], v[108:111], a[44:47], v[44:47]
    s_add_u32 m0, s73, 98816
    ds_read_b64_tr_b16 v[228:229], v10 offset:4096
    v_mfma_f32_16x16x32_bf16 v[44:47], v[104:107], a[36:39], v[44:47]
    buffer_load_dwordx4 v20, s[44:47], s23 offen offset:512 sc1 lds
    s_waitcnt lgkmcnt(3)
    v_mfma_f32_16x16x32_bf16 v[52:55], v[120:123], a[36:39], v[52:55]
    s_add_u32 m0, s73, 99584
    ds_read_b64_tr_b16 v[230:231], v10 offset:6144
    v_mfma_f32_16x16x32_bf16 v[52:55], v[124:127], a[44:47], v[52:55]
    buffer_load_dwordx4 v23, s[44:47], s24 offen offset:768 sc1 lds
    s_waitcnt lgkmcnt(2)
    v_mfma_f32_16x16x32_bf16 v[52:55], v[128:131], a[52:55], v[52:55]
    ds_read_b128 v[104:107], v14 offset:18432
    v_mfma_f32_16x16x32_bf16 v[52:55], v[132:135], a[60:63], v[52:55]
    ds_read_b128 v[108:111], v14 offset:22528
    v_mfma_f32_16x16x32_bf16 v[48:51], v[132:135], a[56:59], v[48:51]
    ds_read_b128 v[112:115], v14 offset:26624
    v_mfma_f32_16x16x32_bf16 v[48:51], v[128:131], a[48:51], v[48:51]
    ds_read_b128 v[116:119], v14 offset:30720
    v_mfma_f32_16x16x32_bf16 v[48:51], v[124:127], a[40:43], v[48:51]
    s_add_u32 m0, s73, 101376
    ds_read_b64_tr_b16 v[224:225], v11 offset:0
    v_mfma_f32_16x16x32_bf16 v[48:51], v[120:123], a[32:35], v[48:51]
    buffer_load_dwordx4 v20, s[44:47], s24 offen offset:0 sc1 lds
    s_waitcnt lgkmcnt(3)
    v_mfma_f32_16x16x32_bf16 v[32:35], v[104:107], a[64:67], v[32:35]
    ds_read_b64_tr_b16 v[226:227], v11 offset:2048
    v_mfma_f32_16x16x32_bf16 v[32:35], v[108:111], a[72:75], v[32:35]
    s_waitcnt lgkmcnt(2)
    v_mfma_f32_16x16x32_bf16 v[32:35], v[112:115], a[80:83], v[32:35]
    ds_read_b128 v[120:123], v14 offset:19456
    v_mfma_f32_16x16x32_bf16 v[32:35], v[116:119], a[88:91], v[32:35]
    ds_read_b128 v[124:127], v14 offset:23552
    v_mfma_f32_16x16x32_bf16 v[36:39], v[116:119], a[92:95], v[36:39]
    ds_read_b128 v[128:131], v14 offset:27648
    v_mfma_f32_16x16x32_bf16 v[36:39], v[112:115], a[84:87], v[36:39]
    ds_read_b128 v[132:135], v14 offset:31744
    v_mfma_f32_16x16x32_bf16 v[36:39], v[108:111], a[76:79], v[36:39]
    ds_read_b64_tr_b16 v[232:233], v11 offset:4096
    v_mfma_f32_16x16x32_bf16 v[36:39], v[104:107], a[68:71], v[36:39]
    s_waitcnt lgkmcnt(3)
    v_mfma_f32_16x16x32_bf16 v[44:47], v[120:123], a[68:71], v[44:47]
    ds_read_b64_tr_b16 v[234:235], v11 offset:6144
    v_mfma_f32_16x16x32_bf16 v[44:47], v[124:127], a[76:79], v[44:47]
    s_waitcnt lgkmcnt(2)
    v_mfma_f32_16x16x32_bf16 v[44:47], v[128:131], a[84:87], v[44:47]
    s_waitcnt vmcnt(8) lgkmcnt(0)
    s_barrier
    v_mfma_f32_16x16x32_bf16 v[44:47], v[132:135], a[92:95], v[44:47]
    ds_read_b128 v[104:107], v14 offset:32768
    v_mfma_f32_16x16x32_bf16 v[40:43], v[132:135], a[88:91], v[40:43]
    ds_read_b128 v[108:111], v14 offset:36864
    v_mfma_f32_16x16x32_bf16 v[40:43], v[128:131], a[80:83], v[40:43]
    ds_read_b128 v[112:115], v14 offset:40960
    v_mfma_f32_16x16x32_bf16 v[40:43], v[124:127], a[72:75], v[40:43]
    ds_read_b128 v[116:119], v14 offset:45056
    v_mfma_f32_16x16x32_bf16 v[40:43], v[120:123], a[64:67], v[40:43]
    ds_read_b64_tr_b16 v[236:237], v10 offset:16384
    s_waitcnt lgkmcnt(3)
    v_mfma_f32_16x16x32_bf16 v[48:51], v[104:107], a[64:67], v[48:51]
    s_add_u32 m0, s73, 114176
    ds_read_b64_tr_b16 v[238:239], v10 offset:18432
    v_mfma_f32_16x16x32_bf16 v[48:51], v[108:111], a[72:75], v[48:51]
    buffer_load_dwordx4 v20, s[44:47], s24 offen offset:512 sc1 lds
    s_waitcnt lgkmcnt(2)
    v_mfma_f32_16x16x32_bf16 v[48:51], v[112:115], a[80:83], v[48:51]
    ds_read_b128 v[120:123], v14 offset:33792
    v_mfma_f32_16x16x32_bf16 v[48:51], v[116:119], a[88:91], v[48:51]
    ds_read_b128 v[124:127], v14 offset:37888
    v_lshrrev_b32 v30, 2, v26
    v_mfma_f32_16x16x32_bf16 v[52:55], v[116:119], a[92:95], v[52:55]
    ds_read_b128 v[128:131], v14 offset:41984
    v_mfma_f32_16x16x32_bf16 v[52:55], v[112:115], a[84:87], v[52:55]
    ds_read_b128 v[132:135], v14 offset:46080
    v_mfma_f32_16x16x32_bf16 v[52:55], v[108:111], a[76:79], v[52:55]
    s_add_u32 m0, s73, 114944
    ds_read_b64_tr_b16 v[244:245], v10 offset:20480
    v_mfma_f32_16x16x32_bf16 v[52:55], v[104:107], a[68:71], v[52:55]
    buffer_load_dwordx4 v23, s[44:47], s25 offen offset:768 sc1 lds
    s_waitcnt lgkmcnt(3)
    v_mfma_f32_16x16x32_bf16 v[36:39], v[120:123], a[100:103], v[36:39]
    s_add_u32 m0, s73, 116736
    ds_read_b64_tr_b16 v[246:247], v10 offset:22528
    v_mfma_f32_16x16x32_bf16 v[36:39], v[124:127], a[108:111], v[36:39]
    buffer_load_dwordx4 v20, s[44:47], s25 offen offset:0 sc1 lds
    s_waitcnt lgkmcnt(2)
    v_mfma_f32_16x16x32_bf16 v[36:39], v[128:131], a[116:119], v[36:39]
    ds_read_b128 v[104:107], v14 offset:34816
    v_lshrrev_b32 v31, 2, v18
    v_mfma_f32_16x16x32_bf16 v[36:39], v[132:135], a[124:127], v[36:39]
    ds_read_b128 v[108:111], v14 offset:38912
    v_mfma_f32_16x16x32_bf16 v[32:35], v[132:135], a[120:123], v[32:35]
    ds_read_b128 v[112:115], v14 offset:43008
    v_mfma_f32_16x16x32_bf16 v[32:35], v[128:131], a[112:115], v[32:35]
    ds_read_b128 v[116:119], v14 offset:47104
    v_mfma_f32_16x16x32_bf16 v[32:35], v[124:127], a[104:107], v[32:35]
    s_add_u32 m0, s73, 117248
    ds_read_b64_tr_b16 v[240:241], v11 offset:16384
    v_mfma_f32_16x16x32_bf16 v[32:35], v[120:123], a[96:99], v[32:35]
    buffer_load_dwordx4 v20, s[44:47], s25 offen offset:512 sc1 lds
    s_waitcnt lgkmcnt(3)
    v_mfma_f32_16x16x32_bf16 v[40:43], v[104:107], a[96:99], v[40:43]
    ds_read_b64_tr_b16 v[242:243], v11 offset:18432
    buffer_load_ushort v102, v30, s[60:63], 0 offen offset:0
    v_mfma_f32_16x16x32_bf16 v[40:43], v[108:111], a[104:107], v[40:43]
    s_waitcnt lgkmcnt(2)
    v_mfma_f32_16x16x32_bf16 v[40:43], v[112:115], a[112:115], v[40:43]
    ds_read_b128 v[120:123], v14 offset:35840
    v_mfma_f32_16x16x32_bf16 v[40:43], v[116:119], a[120:123], v[40:43]
    ds_read_b128 v[124:127], v14 offset:39936
    v_mfma_f32_16x16x32_bf16 v[44:47], v[116:119], a[124:127], v[44:47]
    ds_read_b128 v[128:131], v14 offset:44032
    v_mfma_f32_16x16x32_bf16 v[44:47], v[112:115], a[116:119], v[44:47]
    ds_read_b128 v[132:135], v14 offset:48128
    v_mfma_f32_16x16x32_bf16 v[44:47], v[108:111], a[108:111], v[44:47]
    ds_read_b64_tr_b16 v[248:249], v11 offset:20480
    buffer_load_ushort v103, v30, s[60:63], 0 offen offset:32
    v_mfma_f32_16x16x32_bf16 v[44:47], v[104:107], a[100:103], v[44:47]
    s_waitcnt lgkmcnt(3)
    v_mfma_f32_16x16x32_bf16 v[52:55], v[120:123], a[100:103], v[52:55]
    ds_read_b64_tr_b16 v[250:251], v11 offset:22528
    v_mfma_f32_16x16x32_bf16 v[52:55], v[124:127], a[108:111], v[52:55]
    s_waitcnt lgkmcnt(2)
    v_mfma_f32_16x16x32_bf16 v[52:55], v[128:131], a[116:119], v[52:55]
    s_waitcnt vmcnt(10) lgkmcnt(0)
    s_barrier
    v_mfma_f32_16x16x32_bf16 v[52:55], v[132:135], a[124:127], v[52:55]
    ds_read_b128 v[104:107], v14 offset:49152
    v_mfma_f32_16x16x32_bf16 v[48:51], v[132:135], a[120:123], v[48:51]
    ds_read_b128 v[108:111], v14 offset:53248
    buffer_load_ushort v27, v31, s[60:63], 0 offen offset:0
    v_mfma_f32_16x16x32_bf16 v[48:51], v[128:131], a[112:115], v[48:51]
    ds_read_b128 v[112:115], v14 offset:57344
    v_mfma_f32_16x16x32_bf16 v[48:51], v[124:127], a[104:107], v[48:51]
    ds_read_b128 v[116:119], v14 offset:61440
    v_mfma_f32_16x16x32_bf16 v[48:51], v[120:123], a[96:99], v[48:51]
    s_waitcnt lgkmcnt(2)
    v_mfma_f32_16x16x32_bf16 v[32:35], v[104:107], a[128:131], v[32:35]
    s_add_u32 m0, s73, 130304
    v_mfma_f32_16x16x32_bf16 v[32:35], v[108:111], a[136:139], v[32:35]
    buffer_load_dwordx4 v23, s[44:47], s26 offen offset:768 sc1 lds
    s_waitcnt lgkmcnt(0)
    v_mfma_f32_16x16x32_bf16 v[32:35], v[112:115], a[144:147], v[32:35]
    ds_read_b128 v[120:123], v14 offset:50176
    v_mfma_f32_16x16x32_bf16 v[32:35], v[116:119], a[152:155], v[32:35]
    ds_read_b128 v[124:127], v14 offset:54272
    v_mfma_f32_16x16x32_bf16 v[36:39], v[116:119], a[156:159], v[36:39]
    ds_read_b128 v[128:131], v14 offset:58368
    v_mfma_f32_16x16x32_bf16 v[36:39], v[112:115], a[148:151], v[36:39]
    ds_read_b128 v[132:135], v14 offset:62464
    v_mfma_f32_16x16x32_bf16 v[36:39], v[108:111], a[140:143], v[36:39]
    s_add_u32 m0, s73, 132096
    v_mfma_f32_16x16x32_bf16 v[36:39], v[104:107], a[132:135], v[36:39]
    buffer_load_dwordx4 v20, s[44:47], s26 offen offset:0 sc1 lds
    s_waitcnt lgkmcnt(2)
    v_mfma_f32_16x16x32_bf16 v[44:47], v[120:123], a[132:135], v[44:47]
    s_add_u32 m0, s73, 132608
    buffer_load_dwordx4 v[88:91], v252, s[56:59], 0 offen
    v_mfma_f32_16x16x32_bf16 v[44:47], v[124:127], a[140:143], v[44:47]
    buffer_load_dwordx4 v20, s[44:47], s26 offen offset:512 sc1 lds
    s_waitcnt lgkmcnt(0)
    v_mfma_f32_16x16x32_bf16 v[44:47], v[128:131], a[148:151], v[44:47]
    ds_read_b128 v[104:107], v14 offset:51200
    v_mfma_f32_16x16x32_bf16 v[44:47], v[132:135], a[156:159], v[44:47]
    ds_read_b128 v[108:111], v14 offset:55296
    v_mfma_f32_16x16x32_bf16 v[40:43], v[132:135], a[152:155], v[40:43]
    ds_read_b128 v[112:115], v14 offset:59392
    v_mfma_f32_16x16x32_bf16 v[40:43], v[128:131], a[144:147], v[40:43]
    ds_read_b128 v[116:119], v14 offset:63488
    v_mfma_f32_16x16x32_bf16 v[40:43], v[124:127], a[136:139], v[40:43]
    s_add_u32 m0, s73, 134144
    v_mfma_f32_16x16x32_bf16 v[40:43], v[120:123], a[128:131], v[40:43]
    buffer_load_dwordx4 v21, s[44:47], s18 offen offset:0 sc1 lds
    s_waitcnt lgkmcnt(2)
    v_mfma_f32_16x16x32_bf16 v[48:51], v[104:107], a[128:131], v[48:51]
    v_mfma_f32_16x16x32_bf16 v[48:51], v[108:111], a[136:139], v[48:51]
    s_waitcnt lgkmcnt(0)
    v_mfma_f32_16x16x32_bf16 v[48:51], v[112:115], a[144:147], v[48:51]
    ds_read_b128 v[120:123], v14 offset:52224
    v_mfma_f32_16x16x32_bf16 v[48:51], v[116:119], a[152:155], v[48:51]
    ds_read_b128 v[124:127], v14 offset:56320
    v_mfma_f32_16x16x32_bf16 v[52:55], v[116:119], a[156:159], v[52:55]
    ds_read_b128 v[128:131], v14 offset:60416
    v_mfma_f32_16x16x32_bf16 v[52:55], v[112:115], a[148:151], v[52:55]
    ds_read_b128 v[132:135], v14 offset:64512
    v_mfma_f32_16x16x32_bf16 v[52:55], v[108:111], a[140:143], v[52:55]
    v_mfma_f32_16x16x32_bf16 v[52:55], v[104:107], a[132:135], v[52:55]
    s_waitcnt lgkmcnt(2)
    v_mfma_f32_16x16x32_bf16 v[36:39], v[120:123], a[164:167], v[36:39]
    buffer_load_dwordx4 v[92:95], v252, s[56:59], s40 offen
    v_mfma_f32_16x16x32_bf16 v[36:39], v[124:127], a[172:175], v[36:39]
    s_waitcnt lgkmcnt(0)
    v_mfma_f32_16x16x32_bf16 v[36:39], v[128:131], a[180:183], v[36:39]
    s_waitcnt vmcnt(13)
    s_barrier
    v_mfma_f32_16x16x32_bf16 v[36:39], v[132:135], a[188:191], v[36:39]
    ds_read_b128 v[104:107], v14 offset:0
    v_mfma_f32_16x16x32_bf16 v[32:35], v[132:135], a[184:187], v[32:35]
    ds_read_b128 v[108:111], v14 offset:4096
    v_mfma_f32_16x16x32_bf16 v[32:35], v[128:131], a[176:179], v[32:35]
    ds_read_b128 v[112:115], v14 offset:8192
    v_mfma_f32_16x16x32_bf16 v[32:35], v[124:127], a[168:171], v[32:35]
    ds_read_b128 v[116:119], v14 offset:12288
    v_mfma_f32_16x16x32_bf16 v[32:35], v[120:123], a[160:163], v[32:35]
    s_waitcnt lgkmcnt(2)
    v_mfma_f32_16x16x32_bf16 v[40:43], v[104:107], a[160:163], v[40:43]
    s_add_u32 m0, s73, 146944
    v_mfma_f32_16x16x32_bf16 v[40:43], v[108:111], a[168:171], v[40:43]
    buffer_load_dwordx4 v21, s[44:47], s18 offen offset:512 sc1 lds
    s_waitcnt lgkmcnt(0)
    v_mfma_f32_16x16x32_bf16 v[40:43], v[112:115], a[176:179], v[40:43]
    ds_read_b128 v[120:123], v14 offset:1024
    v_mfma_f32_16x16x32_bf16 v[40:43], v[116:119], a[184:187], v[40:43]
    ds_read_b128 v[124:127], v14 offset:5120
    v_mfma_f32_16x16x32_bf16 v[44:47], v[116:119], a[188:191], v[44:47]
    ds_read_b128 v[128:131], v14 offset:9216
    v_mfma_f32_16x16x32_bf16 v[44:47], v[112:115], a[180:183], v[44:47]
    ds_read_b128 v[132:135], v14 offset:13312
    v_mfma_f32_16x16x32_bf16 v[44:47], v[108:111], a[172:175], v[44:47]
    s_add_u32 m0, s73, 148480
    v_mfma_f32_16x16x32_bf16 v[44:47], v[104:107], a[164:167], v[44:47]
    buffer_load_dwordx4 v21, s[44:47], s19 offen offset:0 sc1 lds
    s_waitcnt lgkmcnt(2)
    v_mfma_f32_16x16x32_bf16 v[52:55], v[120:123], a[164:167], v[52:55]
    s_add_u32 m0, s73, 148992
    buffer_load_dwordx2 v[142:143], v253, s[56:59], 0 offen
    v_mfma_f32_16x16x32_bf16 v[52:55], v[124:127], a[172:175], v[52:55]
    buffer_load_dwordx4 v21, s[44:47], s19 offen offset:512 sc1 lds
    s_waitcnt lgkmcnt(0)
    v_mfma_f32_16x16x32_bf16 v[52:55], v[128:131], a[180:183], v[52:55]
    ds_read_b128 v[104:107], v14 offset:2048
    v_mfma_f32_16x16x32_bf16 v[52:55], v[132:135], a[188:191], v[52:55]
    ds_read_b128 v[108:111], v14 offset:6144
    v_mfma_f32_16x16x32_bf16 v[48:51], v[132:135], a[184:187], v[48:51]
    ds_read_b128 v[112:115], v14 offset:10240
    v_mfma_f32_16x16x32_bf16 v[48:51], v[128:131], a[176:179], v[48:51]
    ds_read_b128 v[116:119], v14 offset:14336
    v_mfma_f32_16x16x32_bf16 v[48:51], v[124:127], a[168:171], v[48:51]
    s_add_u32 m0, s73, 150528
    v_mfma_f32_16x16x32_bf16 v[48:51], v[120:123], a[160:163], v[48:51]
    buffer_load_dwordx4 v21, s[44:47], s20 offen offset:0 sc1 lds
    s_waitcnt lgkmcnt(2)
    v_mfma_f32_16x16x32_bf16 v[32:35], v[104:107], a[192:195], v[32:35]
    v_mfma_f32_16x16x32_bf16 v[32:35], v[108:111], a[200:203], v[32:35]
    s_waitcnt vmcnt(11)
    s_waitcnt lgkmcnt(0)
    v_mfma_f32_16x16x32_bf16 v[32:35], v[112:115], a[208:211], v[32:35]
    ds_read_b128 v[120:123], v14 offset:3072
    v_mfma_f32_16x16x32_bf16 v[32:35], v[116:119], a[216:219], v[32:35]
    ds_read_b128 v[124:127], v14 offset:7168
    v_mfma_f32_16x16x32_bf16 v[36:39], v[116:119], a[220:223], v[36:39]
    ds_read_b128 v[128:131], v14 offset:11264
    v_lshlrev_b32 v72, 16, v102
    v_mfma_f32_16x16x32_bf16 v[36:39], v[112:115], a[212:215], v[36:39]
    ds_read_b128 v[132:135], v14 offset:15360
    v_mfma_f32_16x16x32_bf16 v[36:39], v[108:111], a[204:207], v[36:39]
    v_lshlrev_b32 v73, 16, v102
    v_mfma_f32_16x16x32_bf16 v[36:39], v[104:107], a[196:199], v[36:39]
    buffer_load_dwordx2 v[96:97], v26, s[44:47], s42 offen offset:0 sc1
    s_waitcnt lgkmcnt(2)
    v_mfma_f32_16x16x32_bf16 v[44:47], v[120:123], a[196:199], v[44:47]
    v_mfma_f32_16x16x32_bf16 v[44:47], v[124:127], a[204:207], v[44:47]
    v_lshlrev_b32 v74, 16, v102
    s_waitcnt lgkmcnt(0)
    v_mfma_f32_16x16x32_bf16 v[44:47], v[128:131], a[212:215], v[44:47]
    s_barrier
    v_mfma_f32_16x16x32_bf16 v[44:47], v[132:135], a[220:223], v[44:47]
    ds_read_b128 v[104:107], v14 offset:16384
    v_mfma_f32_16x16x32_bf16 v[40:43], v[132:135], a[216:219], v[40:43]
    ds_read_b128 v[108:111], v14 offset:20480
    v_lshlrev_b32 v75, 16, v102
    v_mfma_f32_16x16x32_bf16 v[40:43], v[128:131], a[208:211], v[40:43]
    ds_read_b128 v[112:115], v14 offset:24576
    v_mfma_f32_16x16x32_bf16 v[40:43], v[124:127], a[200:203], v[40:43]
    ds_read_b128 v[116:119], v14 offset:28672
    v_lshlrev_b32 v76, 16, v103
    v_mfma_f32_16x16x32_bf16 v[40:43], v[120:123], a[192:195], v[40:43]
    s_waitcnt lgkmcnt(2)
    v_mfma_f32_16x16x32_bf16 v[48:51], v[104:107], a[192:195], v[48:51]
    s_add_u32 m0, s73, 97792
    v_lshlrev_b32 v77, 16, v103
    v_mfma_f32_16x16x32_bf16 v[48:51], v[108:111], a[200:203], v[48:51]
    buffer_load_dwordx4 v21, s[44:47], s20 offen offset:512 sc1 lds
    s_waitcnt lgkmcnt(0)
    v_mfma_f32_16x16x32_bf16 v[48:51], v[112:115], a[208:211], v[48:51]
    ds_read_b128 v[120:123], v14 offset:17408
    v_mfma_f32_16x16x32_bf16 v[48:51], v[116:119], a[216:219], v[48:51]
    ds_read_b128 v[124:127], v14 offset:21504
    v_mfma_f32_16x16x32_bf16 v[52:55], v[116:119], a[220:223], v[52:55]
    ds_read_b128 v[128:131], v14 offset:25600
    v_lshlrev_b32 v78, 16, v103
    v_mfma_f32_16x16x32_bf16 v[52:55], v[112:115], a[212:215], v[52:55]
    ds_read_b128 v[132:135], v14 offset:29696
    v_mfma_f32_16x16x32_bf16 v[52:55], v[108:111], a[204:207], v[52:55]
    s_add_u32 m0, s73, 99328
    v_lshlrev_b32 v79, 16, v103
    v_mfma_f32_16x16x32_bf16 v[52:55], v[104:107], a[196:199], v[52:55]
    buffer_load_dwordx4 v21, s[44:47], s21 offen offset:0 sc1 lds
    s_waitcnt lgkmcnt(2)
    v_mfma_f32_16x16x32_bf16 v[36:39], v[120:123], a[228:231], v[36:39]
    buffer_load_dwordx2 v[98:99], v26, s[44:47], s42 offen offset:128 sc1
    s_add_u32 m0, s73, 99840
    v_lshlrev_b32 v80, 16, v102
    v_mfma_f32_16x16x32_bf16 v[36:39], v[124:127], a[236:239], v[36:39]
    buffer_load_dwordx4 v21, s[44:47], s21 offen offset:512 sc1 lds
    s_waitcnt lgkmcnt(0)
    v_mfma_f32_16x16x32_bf16 v[36:39], v[128:131], a[244:247], v[36:39]
    ds_read_b128 v[104:107], v14 offset:18432
    v_mfma_f32_16x16x32_bf16 v[36:39], v[132:135], a[252:255], v[36:39]
    ds_read_b128 v[108:111], v14 offset:22528
    v_mfma_f32_16x16x32_bf16 v[32:35], v[132:135], a[248:251], v[32:35]
    ds_read_b128 v[112:115], v14 offset:26624
    v_lshlrev_b32 v81, 16, v102
    v_mfma_f32_16x16x32_bf16 v[32:35], v[128:131], a[240:243], v[32:35]
    ds_read_b128 v[116:119], v14 offset:30720
    v_mfma_f32_16x16x32_bf16 v[32:35], v[124:127], a[232:235], v[32:35]
    s_add_u32 m0, s73, 101376
    v_lshlrev_b32 v82, 16, v102
    v_mfma_f32_16x16x32_bf16 v[32:35], v[120:123], a[224:227], v[32:35]
    buffer_load_dwordx4 v21, s[44:47], s22 offen offset:0 sc1 lds
    s_waitcnt lgkmcnt(2)
    v_mfma_f32_16x16x32_bf16 v[40:43], v[104:107], a[224:227], v[40:43]
    v_mfma_f32_16x16x32_bf16 v[40:43], v[108:111], a[232:235], v[40:43]
L_pl_X_7:
    s_cbranch_execz L_wret
    v_lshlrev_b32 v83, 16, v102
    s_waitcnt lgkmcnt(0)
    v_mfma_f32_16x16x32_bf16 v[40:43], v[112:115], a[240:243], v[40:43]
    ds_read_b128 v[120:123], v14 offset:19456
    v_mfma_f32_16x16x32_bf16 v[40:43], v[116:119], a[248:251], v[40:43]
    ds_read_b128 v[124:127], v14 offset:23552
    v_mfma_f32_16x16x32_bf16 v[44:47], v[116:119], a[252:255], v[44:47]
    ds_read_b128 v[128:131], v14 offset:27648
    v_lshlrev_b32 v84, 16, v103
    v_mfma_f32_16x16x32_bf16 v[44:47], v[112:115], a[244:247], v[44:47]
    ds_read_b128 v[132:135], v14 offset:31744
    v_mfma_f32_16x16x32_bf16 v[44:47], v[108:111], a[236:239], v[44:47]
    v_lshlrev_b32 v85, 16, v103
    v_mfma_f32_16x16x32_bf16 v[44:47], v[104:107], a[228:231], v[44:47]
    buffer_load_dwordx2 v[100:101], v18, s[44:47], s42 offen offset:0 sc1
    s_waitcnt lgkmcnt(2)
    v_mfma_f32_16x16x32_bf16 v[52:55], v[120:123], a[228:231], v[52:55]
    v_mfma_f32_16x16x32_bf16 v[52:55], v[124:127], a[236:239], v[52:55]
    v_lshlrev_b32 v86, 16, v103
    s_waitcnt lgkmcnt(0)
    v_mfma_f32_16x16x32_bf16 v[52:55], v[128:131], a[244:247], v[52:55]
    s_waitcnt vmcnt(13)
    s_barrier
    v_mfma_f32_16x16x32_bf16 v[52:55], v[132:135], a[252:255], v[52:55]
    ds_read_b128 v[104:107], v14 offset:32768
    v_lshlrev_b32 v87, 16, v103
    v_mfma_f32_16x16x32_bf16 v[48:51], v[132:135], a[248:251], v[48:51]
    ds_read_b128 v[108:111], v14 offset:36864
    v_add_u32 v10, 65536, v10
    v_mfma_f32_16x16x32_bf16 v[48:51], v[128:131], a[240:243], v[48:51]
    ds_read_b128 v[112:115], v14 offset:40960
    v_mfma_f32_16x16x32_bf16 v[48:51], v[124:127], a[232:235], v[48:51]
    ds_read_b128 v[116:119], v14 offset:45056
    v_add_u32 v11, 65536, v11
    v_mfma_f32_16x16x32_bf16 v[48:51], v[120:123], a[224:227], v[48:51]
    v_lshlrev_b32 v27, 16, v27
    s_branch L_Dc
L_idle:
    s_waitcnt vmcnt(0)
    s_barrier
    s_bitcmp1_b32 s3, 1
    s_cselect_b32 s18, s85, s84
    s_mul_i32 s18, s18, 139264
    s_cselect_b32 s19, s87, s86
    s_mul_i32 s19, s19, 139264
    s_cselect_b32 s20, s89, s88
    s_mul_i32 s20, s20, 139264
    s_cselect_b32 s21, s91, s90
    s_mul_i32 s21, s21, 139264
    s_cselect_b32 s22, s93, s92
    s_mul_i32 s22, s22, 139264
    s_cselect_b32 s23, s95, s94
    s_mul_i32 s23, s23, 139264
    s_cselect_b32 s24, s97, s96
    s_mul_i32 s24, s24, 139264
    s_cselect_b32 s25, s99, s98
    s_mul_i32 s25, s25, 139264
    s_cselect_b32 s26, s101, s100
    s_mul_i32 s26, s26, 139264
    s_add_u32 m0, s73, 32768
    s_lshl_b32 s14, s84, 18
    buffer_load_dwordx4 v4, s[52:55], s14 offen offset:0 lds
    buffer_load_dwordx4 v5, s[52:55], s14 offen offset:1024 lds
    buffer_load_dwordx4 v6, s[52:55], s14 offen offset:2048 lds
    buffer_load_dwordx4 v7, s[52:55], s14 offen offset:3072 lds
    s_add_u32 m0, s73, 49152
    s_lshl_b32 s14, s85, 18
    buffer_load_dwordx4 v4, s[52:55], s14 offen offset:0 lds
    buffer_load_dwordx4 v5, s[52:55], s14 offen offset:1024 lds
    buffer_load_dwordx4 v6, s[52:55], s14 offen offset:2048 lds
    buffer_load_dwordx4 v7, s[52:55], s14 offen offset:3072 lds
    s_add_u32 m0, s73, 65536
    s_lshl_b32 s14, s86, 18
    buffer_load_dwordx4 v4, s[52:55], s14 offen offset:0 lds
    buffer_load_dwordx4 v5, s[52:55], s14 offen offset:1024 lds
    buffer_load_dwordx4 v6, s[52:55], s14 offen offset:2048 lds
    buffer_load_dwordx4 v7, s[52:55], s14 offen offset:3072 lds
    s_add_u32 m0, s73, 81920
    s_lshl_b32 s14, s87, 18
    buffer_load_dwordx4 v4, s[52:55], s14 offen offset:0 lds
    buffer_load_dwordx4 v5, s[52:55], s14 offen offset:1024 lds
    buffer_load_dwordx4 v6, s[52:55], s14 offen offset:2048 lds
    buffer_load_dwordx4 v7, s[52:55], s14 offen offset:3072 lds
    s_add_u32 m0, s73, 98304
    s_lshl_b32 s14, s88, 18
    buffer_load_dwordx4 v4, s[52:55], s14 offen offset:0 lds
    buffer_load_dwordx4 v5, s[52:55], s14 offen offset:1024 lds
    buffer_load_dwordx4 v6, s[52:55], s14 offen offset:2048 lds
    buffer_load_dwordx4 v7, s[52:55], s14 offen offset:3072 lds
    s_add_u32 m0, s73, 114688
    s_lshl_b32 s14, s89, 18
    buffer_load_dwordx4 v4, s[52:55], s14 offen offset:0 lds
    buffer_load_dwordx4 v5, s[52:55], s14 offen offset:1024 lds
    buffer_load_dwordx4 v6, s[52:55], s14 offen offset:2048 lds
    buffer_load_dwordx4 v7, s[52:55], s14 offen offset:3072 lds
    s_add_u32 m0, s73, 131072
    s_lshl_b32 s14, s90, 18
    buffer_load_dwordx4 v4, s[52:55], s14 offen offset:0 lds
    buffer_load_dwordx4 v5, s[52:55], s14 offen offset:1024 lds
    buffer_load_dwordx4 v6, s[52:55], s14 offen offset:2048 lds
    buffer_load_dwordx4 v7, s[52:55], s14 offen offset:3072 lds
    s_add_u32 m0, s73, 147456
    s_lshl_b32 s14, s91, 18
    buffer_load_dwordx4 v4, s[52:55], s14 offen offset:0 lds
    buffer_load_dwordx4 v5, s[52:55], s14 offen offset:1024 lds
    buffer_load_dwordx4 v6, s[52:55], s14 offen offset:2048 lds
    buffer_load_dwordx4 v7, s[52:55], s14 offen offset:3072 lds
    s_waitcnt vmcnt(28)
    s_barrier
    ds_read_b64_tr_b16 a[0:1], v10 offset:32768
    ds_read_b64_tr_b16 a[2:3], v10 offset:34816
    ds_read_b64_tr_b16 a[8:9], v10 offset:36864
    ds_read_b64_tr_b16 a[10:11], v10 offset:38912
    ds_read_b64_tr_b16 a[4:5], v11 offset:32768
    ds_read_b64_tr_b16 a[6:7], v11 offset:34816
    ds_read_b64_tr_b16 a[12:13], v11 offset:36864
    ds_read_b64_tr_b16 a[14:15], v11 offset:38912
    s_waitcnt vmcnt(24) lgkmcnt(0)
    s_barrier
    ds_read_b64_tr_b16 a[16:17], v10 offset:49152
    s_add_u32 m0, s73, 32768
    s_lshl_b32 s14, s92, 18
    ds_read_b64_tr_b16 a[18:19], v10 offset:51200
    buffer_load_dwordx4 v4, s[52:55], s14 offen offset:0 lds
    ds_read_b64_tr_b16 a[24:25], v10 offset:53248
    ds_read_b64_tr_b16 a[26:27], v10 offset:55296
    buffer_load_dwordx4 v5, s[52:55], s14 offen offset:1024 lds
    ds_read_b64_tr_b16 a[20:21], v11 offset:49152
    buffer_load_dwordx4 v6, s[52:55], s14 offen offset:2048 lds
    ds_read_b64_tr_b16 a[22:23], v11 offset:51200
    ds_read_b64_tr_b16 a[28:29], v11 offset:53248
    buffer_load_dwordx4 v7, s[52:55], s14 offen offset:3072 lds
    ds_read_b64_tr_b16 a[30:31], v11 offset:55296
    s_waitcnt vmcnt(24) lgkmcnt(0)
    s_barrier
    v_add_u32 v10, 65536, v10
    ds_read_b64_tr_b16 a[32:33], v10 offset:0
    s_add_u32 m0, s73, 49152
    s_lshl_b32 s14, s93, 18
    ds_read_b64_tr_b16 a[34:35], v10 offset:2048
    buffer_load_dwordx4 v4, s[52:55], s14 offen offset:0 lds
    ds_read_b64_tr_b16 a[40:41], v10 offset:4096
    ds_read_b64_tr_b16 a[42:43], v10 offset:6144
    buffer_load_dwordx4 v5, s[52:55], s14 offen offset:1024 lds
    v_add_u32 v11, 65536, v11
    ds_read_b64_tr_b16 a[36:37], v11 offset:0
    buffer_load_dwordx4 v6, s[52:55], s14 offen offset:2048 lds
    ds_read_b64_tr_b16 a[38:39], v11 offset:2048
    ds_read_b64_tr_b16 a[44:45], v11 offset:4096
    buffer_load_dwordx4 v7, s[52:55], s14 offen offset:3072 lds
    ds_read_b64_tr_b16 a[46:47], v11 offset:6144
    s_waitcnt vmcnt(24) lgkmcnt(0)
    s_barrier
    ds_read_b64_tr_b16 a[48:49], v10 offset:16384
    s_add_u32 m0, s73, 65536
    s_lshl_b32 s14, s94, 18
    ds_read_b64_tr_b16 a[50:51], v10 offset:18432
    buffer_load_dwordx4 v4, s[52:55], s14 offen offset:0 lds
    ds_read_b64_tr_b16 a[56:57], v10 offset:20480
    ds_read_b64_tr_b16 a[58:59], v10 offset:22528
    buffer_load_dwordx4 v5, s[52:55], s14 offen offset:1024 lds
    ds_read_b64_tr_b16 a[52:53], v11 offset:16384
    buffer_load_dwordx4 v6, s[52:55], s14 offen offset:2048 lds
    ds_read_b64_tr_b16 a[54:55], v11 offset:18432
    ds_read_b64_tr_b16 a[60:61], v11 offset:20480
    buffer_load_dwordx4 v7, s[52:55], s14 offen offset:3072 lds
    ds_read_b64_tr_b16 a[62:63], v11 offset:22528
    s_waitcnt vmcnt(24) lgkmcnt(0)
    s_barrier
    ds_read_b64_tr_b16 a[64:65], v10 offset:32768
    s_add_u32 m0, s73, 81920
    s_lshl_b32 s14, s95, 18
    ds_read_b64_tr_b16 a[66:67], v10 offset:34816
    buffer_load_dwordx4 v4, s[52:55], s14 offen offset:0 lds
    ds_read_b64_tr_b16 a[72:73], v10 offset:36864
    ds_read_b64_tr_b16 a[74:75], v10 offset:38912
    buffer_load_dwordx4 v5, s[52:55], s14 offen offset:1024 lds
    ds_read_b64_tr_b16 a[68:69], v11 offset:32768
    buffer_load_dwordx4 v6, s[52:55], s14 offen offset:2048 lds
    ds_read_b64_tr_b16 a[70:71], v11 offset:34816
    ds_read_b64_tr_b16 a[76:77], v11 offset:36864
    buffer_load_dwordx4 v7, s[52:55], s14 offen offset:3072 lds
    ds_read_b64_tr_b16 a[78:79], v11 offset:38912
    s_waitcnt vmcnt(24) lgkmcnt(0)
    s_barrier
    ds_read_b64_tr_b16 a[80:81], v10 offset:49152
    s_add_u32 m0, s73, 98304
    s_lshl_b32 s14, s96, 18
    ds_read_b64_tr_b16 a[82:83], v10 offset:51200
    buffer_load_dwordx4 v4, s[52:55], s14 offen offset:0 lds
    ds_read_b64_tr_b16 a[88:89], v10 offset:53248
    ds_read_b64_tr_b16 a[90:91], v10 offset:55296
    buffer_load_dwordx4 v5, s[52:55], s14 offen offset:1024 lds
    ds_read_b64_tr_b16 a[84:85], v11 offset:49152
    buffer_load_dwordx4 v6, s[52:55], s14 offen offset:2048 lds
    ds_read_b64_tr_b16 a[86:87], v11 offset:51200
    ds_read_b64_tr_b16 a[92:93], v11 offset:53248
    buffer_load_dwordx4 v7, s[52:55], s14 offen offset:3072 lds
    ds_read_b64_tr_b16 a[94:95], v11 offset:55296
    s_waitcnt vmcnt(24) lgkmcnt(0)
    s_barrier
    v_add_u32 v10, 65536, v10
    ds_read_b64_tr_b16 a[96:97], v10 offset:0
    s_add_u32 m0, s73, 114688
    s_lshl_b32 s14, s97, 18
    ds_read_b64_tr_b16 a[98:99], v10 offset:2048
    buffer_load_dwordx4 v4, s[52:55], s14 offen offset:0 lds
    ds_read_b64_tr_b16 a[104:105], v10 offset:4096
    ds_read_b64_tr_b16 a[106:107], v10 offset:6144
    buffer_load_dwordx4 v5, s[52:55], s14 offen offset:1024 lds
    v_add_u32 v11, 65536, v11
    ds_read_b64_tr_b16 a[100:101], v11 offset:0
    buffer_load_dwordx4 v6, s[52:55], s14 offen offset:2048 lds
    ds_read_b64_tr_b16 a[102:103], v11 offset:2048
    ds_read_b64_tr_b16 a[108:109], v11 offset:4096
    buffer_load_dwordx4 v7, s[52:55], s14 offen offset:3072 lds
    ds_read_b64_tr_b16 a[110:111], v11 offset:6144
    s_waitcnt vmcnt(24) lgkmcnt(0)
    s_barrier
    ds_read_b64_tr_b16 a[112:113], v10 offset:16384
    s_add_u32 m0, s73, 131072
    s_lshl_b32 s14, s98, 18
    ds_read_b64_tr_b16 a[114:115], v10 offset:18432
    buffer_load_dwordx4 v4, s[52:55], s14 offen offset:0 lds
    ds_read_b64_tr_b16 a[120:121], v10 offset:20480
    ds_read_b64_tr_b16 a[122:123], v10 offset:22528
    buffer_load_dwordx4 v5, s[52:55], s14 offen offset:1024 lds
    ds_read_b64_tr_b16 a[116:117], v11 offset:16384
    buffer_load_dwordx4 v6, s[52:55], s14 offen offset:2048 lds
    ds_read_b64_tr_b16 a[118:119], v11 offset:18432
    ds_read_b64_tr_b16 a[124:125], v11 offset:20480
    buffer_load_dwordx4 v7, s[52:55], s14 offen offset:3072 lds
    ds_read_b64_tr_b16 a[126:127], v11 offset:22528
    s_waitcnt vmcnt(24) lgkmcnt(0)
    s_barrier
    v_add_u32 v10, -131072, v10
    ds_read_b64_tr_b16 a[128:129], v10 offset:32768
    s_add_u32 m0, s73, 147456
    s_lshl_b32 s14, s99, 18
    ds_read_b64_tr_b16 a[130:131], v10 offset:34816
    buffer_load_dwordx4 v4, s[52:55], s14 offen offset:0 lds
    ds_read_b64_tr_b16 a[136:137], v10 offset:36864
    ds_read_b64_tr_b16 a[138:139], v10 offset:38912
    buffer_load_dwordx4 v5, s[52:55], s14 offen offset:1024 lds
    v_add_u32 v11, -131072, v11
    ds_read_b64_tr_b16 a[132:133], v11 offset:32768
    buffer_load_dwordx4 v6, s[52:55], s14 offen offset:2048 lds
    ds_read_b64_tr_b16 a[134:135], v11 offset:34816
    ds_read_b64_tr_b16 a[140:141], v11 offset:36864
    buffer_load_dwordx4 v7, s[52:55], s14 offen offset:3072 lds
    ds_read_b64_tr_b16 a[142:143], v11 offset:38912
    s_waitcnt vmcnt(24) lgkmcnt(0)
    s_barrier
    ds_read_b64_tr_b16 a[144:145], v10 offset:49152
    s_add_u32 m0, s73, 0
    s_lshl_b32 s14, s100, 18
    ds_read_b64_tr_b16 a[146:147], v10 offset:51200
    buffer_load_dwordx4 v4, s[52:55], s14 offen offset:0 lds
    ds_read_b64_tr_b16 a[152:153], v10 offset:53248
    ds_read_b64_tr_b16 a[154:155], v10 offset:55296
    buffer_load_dwordx4 v5, s[52:55], s14 offen offset:1024 lds
    ds_read_b64_tr_b16 a[148:149], v11 offset:49152
    buffer_load_dwordx4 v6, s[52:55], s14 offen offset:2048 lds
    ds_read_b64_tr_b16 a[150:151], v11 offset:51200
    ds_read_b64_tr_b16 a[156:157], v11 offset:53248
    buffer_load_dwordx4 v7, s[52:55], s14 offen offset:3072 lds
    ds_read_b64_tr_b16 a[158:159], v11 offset:55296
    s_waitcnt vmcnt(24) lgkmcnt(0)
    s_barrier
    v_add_u32 v10, 65536, v10
    ds_read_b64_tr_b16 a[160:161], v10 offset:0
    s_add_u32 m0, s73, 16384
    s_lshl_b32 s14, s101, 18
    ds_read_b64_tr_b16 a[162:163], v10 offset:2048
    buffer_load_dwordx4 v4, s[52:55], s14 offen offset:0 lds
    ds_read_b64_tr_b16 a[168:169], v10 offset:4096
    ds_read_b64_tr_b16 a[170:171], v10 offset:6144
    buffer_load_dwordx4 v5, s[52:55], s14 offen offset:1024 lds
    v_add_u32 v11, 65536, v11
    ds_read_b64_tr_b16 a[164:165], v11 offset:0
    buffer_load_dwordx4 v6, s[52:55], s14 offen offset:2048 lds
    ds_read_b64_tr_b16 a[166:167], v11 offset:2048
    ds_read_b64_tr_b16 a[172:173], v11 offset:4096
    buffer_load_dwordx4 v7, s[52:55], s14 offen offset:3072 lds
    ds_read_b64_tr_b16 a[174:175], v11 offset:6144
    s_waitcnt vmcnt(24) lgkmcnt(0)
    s_barrier
    ds_read_b64_tr_b16 a[176:177], v10 offset:16384
    ds_read_b64_tr_b16 a[178:179], v10 offset:18432
    ds_read_b64_tr_b16 a[184:185], v10 offset:20480
    ds_read_b64_tr_b16 a[186:187], v10 offset:22528
    ds_read_b64_tr_b16 a[180:181], v11 offset:16384
    ds_read_b64_tr_b16 a[182:183], v11 offset:18432
    ds_read_b64_tr_b16 a[188:189], v11 offset:20480
    ds_read_b64_tr_b16 a[190:191], v11 offset:22528
    s_waitcnt vmcnt(20) lgkmcnt(0)
    s_barrier
    ds_read_b64_tr_b16 a[192:193], v10 offset:32768
    ds_read_b64_tr_b16 a[194:195], v10 offset:34816
    ds_read_b64_tr_b16 a[200:201], v10 offset:36864
    ds_read_b64_tr_b16 a[202:203], v10 offset:38912
    ds_read_b64_tr_b16 a[196:197], v11 offset:32768
    ds_read_b64_tr_b16 a[198:199], v11 offset:34816
    ds_read_b64_tr_b16 a[204:205], v11 offset:36864
    ds_read_b64_tr_b16 a[206:207], v11 offset:38912
    s_waitcnt vmcnt(16) lgkmcnt(0)
    s_barrier
    ds_read_b64_tr_b16 a[208:209], v10 offset:49152
    ds_read_b64_tr_b16 a[210:211], v10 offset:51200
    ds_read_b64_tr_b16 a[216:217], v10 offset:53248
    ds_read_b64_tr_b16 a[218:219], v10 offset:55296
    ds_read_b64_tr_b16 a[212:213], v11 offset:49152
    ds_read_b64_tr_b16 a[214:215], v11 offset:51200
    ds_read_b64_tr_b16 a[220:221], v11 offset:53248
    ds_read_b64_tr_b16 a[222:223], v11 offset:55296
    s_waitcnt vmcnt(12) lgkmcnt(0)
    s_barrier
    v_add_u32 v10, 65536, v10
    ds_read_b64_tr_b16 a[224:225], v10 offset:0
    ds_read_b64_tr_b16 a[226:227], v10 offset:2048
    ds_read_b64_tr_b16 a[232:233], v10 offset:4096
    ds_read_b64_tr_b16 a[234:235], v10 offset:6144
    v_add_u32 v11, 65536, v11
    ds_read_b64_tr_b16 a[228:229], v11 offset:0
    ds_read_b64_tr_b16 a[230:231], v11 offset:2048
    ds_read_b64_tr_b16 a[236:237], v11 offset:4096
    ds_read_b64_tr_b16 a[238:239], v11 offset:6144
    s_waitcnt vmcnt(8) lgkmcnt(0)
    s_barrier
    ds_read_b64_tr_b16 a[240:241], v10 offset:16384
    ds_read_b64_tr_b16 a[242:243], v10 offset:18432
    ds_read_b64_tr_b16 a[248:249], v10 offset:20480
    ds_read_b64_tr_b16 a[250:251], v10 offset:22528
    ds_read_b64_tr_b16 a[244:245], v11 offset:16384
    ds_read_b64_tr_b16 a[246:247], v11 offset:18432
    ds_read_b64_tr_b16 a[252:253], v11 offset:20480
    ds_read_b64_tr_b16 a[254:255], v11 offset:22528
    s_waitcnt lgkmcnt(0)
    s_barrier
    v_add_u32 v10, -131072, v10
    v_add_u32 v11, -131072, v11
    s_mov_b64 exec, 0
    s_call_b64 s[82:83], L_wc_D
    s_mov_b64 exec, -1
    s_bfe_u32 s4, s2, 0x20003
    s_lshl2_add_u32 s4, s72, s4
    s_lshl_b32 s4, s4, 2
    s_lshr_b32 s5, s2, 4
    s_and_b32 s5, s5, 2
    s_add_u32 s4, s4, s5
    s_and_b32 s5, s2, 1
    s_add_u32 s4, s4, s5
    s_lshl_b32 s4, s4, 7
    s_add_u32 s4, s4, 12566528
    v_lshl_add_u32 v28, v2, 2, s4
    s_cmp_eq_u32 s3, 0
    s_cselect_b32 s4, 18, 0
    v_cmp_gt_u32 vcc, s4, v2
    v_mov_b32 v13, 0x40000000
    s_nop 0
    v_cndmask_b32 v28, v13, v28, vcc
    v_mov_b32 v13, s68
    v_cndmask_b32 v13, 0, v13, vcc
    s_mov_b32 s5, 0
L_iw:
    s_sleep 16
    v_mov_b32 v29, 0
    buffer_atomic_add v29, v28, s[44:47], 0 offen sc0 sc1
    s_waitcnt vmcnt(0)
    v_cmp_eq_u32 vcc, 0, v13
    s_nop 1
    s_mov_b64 s[6:7], vcc
    v_cmp_ne_u32 vcc, v13, v29
    s_nop 1
    s_andn2_b64 s[8:9], exec, vcc
    s_andn2_b64 s[8:9], s[8:9], s[6:7]
    s_cbranch_scc1 L_ix
    s_cmp_eq_u64 s[6:7], exec
    s_cbranch_scc1 L_ix
    s_add_u32 s5, s5, 1
    s_cmp_lt_u32 s5, 100000
    s_cbranch_scc1 L_iw
L_ix:
    v_mov_b32 v29, 0
    buffer_atomic_add v29, v28, s[44:47], 0 offen sc0 sc1
    s_branch L_DX
L_end:
.section .rodata,"a"
.p2align 6
.amdhsa_kernel recurrent_scan__ssm_conv_h3__mixer_token_mlp__prompt_kernel
  .amdhsa_next_free_vgpr 512
  .amdhsa_next_free_sgpr 102
  .amdhsa_accum_offset 256
  .amdhsa_group_segment_fixed_size 0
  .amdhsa_kernarg_size 112
  .amdhsa_user_sgpr_count 2
  .amdhsa_user_sgpr_kernarg_segment_ptr 1
  .amdhsa_system_sgpr_workgroup_id_x 1
  .amdhsa_float_denorm_mode_32 3
.end_amdhsa_kernel
```

```asm
; @launch grid=(256,1,1) block=(256,1,1) lds=163840
.amdgcn_target "amdgcn-amd-amdhsa--gfx950"
.text
.globl recurrent_scan__ssm_conv_h3__mixer_token_mlp__prompt_kernel
.p2align 8
.type recurrent_scan__ssm_conv_h3__mixer_token_mlp__prompt_kernel,@function
recurrent_scan__ssm_conv_h3__mixer_token_mlp__prompt_kernel:
    s_cmp_lt_u32 s2, 256
    s_cbranch_scc0 L_exit
    s_load_dwordx2 s[56:57], s[0:1], 0
    s_load_dwordx2 s[48:49], s[0:1], 8
    s_load_dwordx2 s[52:53], s[0:1], 16
    s_load_dwordx2 s[60:61], s[0:1], 24
    s_load_dwordx16 s[16:31], s[0:1], 0
    s_load_dwordx8 s[32:39], s[0:1], 64
    s_load_dwordx4 s[40:43], s[0:1], 96
    s_memrealtime s[12:13]
    v_lshrrev_b32 v1, 6, v0
    v_and_b32 v2, 63, v0
    s_getpc_b64 s[6:7]
L_pc:
    s_lshr_b32 s4, s2, 1
    s_and_b32 s4, s4, 124
    v_add_u32 v22, s4, v1
    v_lshl_add_u32 v22, v2, 7, v22
    v_lshlrev_b32 v22, 7, v22
    v_min_u32 v22, L_end-L_pc-4, v22
    s_mov_b64 exec, 31
    global_load_dword v255, v22, s[6:7]
    s_mov_b64 exec, -1
    v_readfirstlane_b32 s3, v1
    s_and_b32 s4, s2, 7
    s_lshr_b32 s5, s2, 3
    s_lshl_b32 s4, s4, 5
    s_add_u32 s68, s4, s5
    v_lshrrev_b32 v3, 5, v0
    v_and_b32 v4, 31, v0
    v_mul_u32_u24 v5, 1152, v3
    v_mad_u32_u24 v5, v4, 12, v5
    s_mul_i32 s15, s68, 9216
    s_mul_i32 s4, s3, 3072
    s_add_u32 s5, s4, s15
    s_sub_u32 s5, s5, 3456
    v_lshlrev_b32 v6, 4, v2
    v_add_u32 v7, s5, v6
    v_add_u32 v58, 1024, v7
    s_add_u32 s4, s4, 114688
    s_lshl_b32 s5, s3, 11
    s_add_u32 s11, s5, s15
    s_add_u32 s5, s5, 127360
    s_mov_b32 m0, s4
    s_mov_b32 s58, 2359296
    s_mov_b32 s59, 0x20000
    s_mov_b32 s50, 2359296
    s_mov_b32 s51, 0x20000
    s_mov_b32 s54, 2359296
    s_mov_b32 s55, 0x20000
    s_mov_b32 s62, 4608
    s_mov_b32 s63, 0x20000
    v_lshlrev_b32 v59, 3, v0
    s_movk_i32 s10, 4096
    s_waitcnt lgkmcnt(0)
    buffer_load_dwordx3 v[8:10], v5, s[56:59], s15 offen offset:0
    buffer_load_dwordx3 v[12:14], v5, s[56:59], s15 offen offset:384
    buffer_load_dwordx3 v[16:18], v5, s[56:59], s15 offen offset:768
    buffer_load_dwordx4 v7, s[48:51], 0 offen lds
    s_add_u32 m0, s4, 1024
    s_cmp_eq_u32 s3, 3
    buffer_load_dwordx4 v58, s[48:51], 0 offen lds
    buffer_load_dwordx4 v58, s[48:51], 0 offen offset:1024 lds
    s_cbranch_scc1 L_xld
L_nox:
    s_mov_b32 m0, s5
    buffer_load_dwordx2 v[98:99], v59, s[60:63], 0 offen
    buffer_load_dwordx4 v6, s[52:55], s11 offen lds
    buffer_load_dwordx4 v6, s[52:55], s11 offen offset:1024 lds
    buffer_load_dwordx2 v[100:101], v59, s[60:63], 0 offen offset:2048
    buffer_load_dwordx2 v[102:103], v59, s[60:63], s10 offen
    s_mov_b32 s64, s40
    s_and_b32 s65, s41, 0xffff
    s_mov_b32 s66, 256
    s_mov_b32 s67, 0x20000
    s_or_b32 s12, s12, 1
    v_or_b32 v22, s2, v0
    v_lshlrev_b32 v22, 8, v22
    v_mov_b32 v23, s12
    buffer_store_dword v23, v22, s[64:67], 0 offen sc1
    s_mov_b32 s44, s42
    s_and_b32 s45, s43, 0xffff
    s_mov_b32 s46, 57606144
    s_mov_b32 s47, 0x20000
    s_and_b32 s5, s2, 7
    s_lshr_b32 s6, s2, 3
    s_lshr_b32 s7, s6, 2
    s_lshr_b32 s8, s3, 1
    s_lshl1_add_u32 s9, s7, s8
    s_cmp_ge_u32 s9, 10
    s_addc_u32 s14, s9, 0
    s_cmp_ge_u32 s9, 3
    s_addc_u32 s14, s14, 0
    s_lshl3_add_u32 s8, s8, 3
    s_cmp_eq_u32 s7, 7
    s_cselect_b32 s14, s8, s14
    s_and_b32 s4, s5, 1
    s_lshl4_add_u32 s71, s4, s14
    s_lshr_b32 s13, s5, 1
    s_mov_b32 s72, s13
    s_and_b32 s101, s6, 3
    s_lshl_b32 s73, s3, 12
    s_mov_b32 s52, s34
    s_and_b32 s53, s35, 0xffff
    s_mov_b32 s54, 18874368
    s_mov_b32 s55, 0x20000
    s_cmp_lt_u32 s6, 27
    s_cbranch_scc0 L_aux
    s_branch L_org
L_exit:
    s_endpgm
L_xld:
    s_mov_b64 exec, 0xffffff
    buffer_load_dwordx4 v58, s[48:51], 0 offen offset:2048 lds
    s_mov_b64 exec, -1
    s_mov_b32 m0, s5
    s_nop 0
    buffer_load_dwordx4 v6, s[52:55], s11 offen offset:2048 lds
    s_branch L_nox
L_nw_G:
    s_mov_b32 s5, 0
L_nl_G:
    buffer_load_dword v45, v44, s[64:67], 0 offen sc1
    s_waitcnt vmcnt(0)
    v_readfirstlane_b32 s68, v45
    s_nop 1
    s_cmp_lg_u32 s68, 0
    s_cbranch_scc1 L_ng_G
    s_add_u32 s5, s5, 1
    s_cmp_lt_u32 s5, 100000
    s_cbranch_scc1 L_nl_G
    s_branch L_ng_G
L_rs_p1G:
    s_mov_b32 s5, 0
L_rt_p1G:
    s_mov_b64 exec, vcc
    buffer_load_dword v29, v28, s[44:47], 0 offen sc1
    s_waitcnt vmcnt(0)
    v_cmp_ne_u32 vcc, s68, v29
    s_cbranch_vccz L_rx_p1G
    s_add_u32 s5, s5, 1
    s_cmp_lt_u32 s5, 100000
    s_cbranch_scc1 L_rt_p1G
L_rx_p1G:
    s_mov_b64 exec, -1
    s_branch L_ok_p1G
L_rs_p5:
    s_mov_b32 s5, 0
L_rt_p5:
    s_mov_b64 exec, vcc
    v_mov_b32 v29, 0
    buffer_atomic_add v29, v28, s[44:47], 0 offen sc0 sc1
    s_waitcnt vmcnt(0)
    v_cmp_ne_u32 vcc, v12, v29
    s_cbranch_vccz L_rx_p5
    s_add_u32 s5, s5, 1
    s_cmp_lt_u32 s5, 100000
    s_cbranch_scc1 L_rt_p5
L_rx_p5:
    s_mov_b64 exec, -1
    s_branch L_ok_p5
L_nw_X:
    s_mov_b32 s5, 0
L_nl_X:
    buffer_load_dword v45, v44, s[64:67], 0 offen sc1
    s_waitcnt vmcnt(0)
    v_readfirstlane_b32 s68, v45
    s_nop 1
    s_cmp_lg_u32 s68, 0
    s_cbranch_scc1 L_ng_X
    s_add_u32 s5, s5, 1
    s_cmp_lt_u32 s5, 100000
    s_cbranch_scc1 L_nl_X
    s_branch L_ng_X
L_rs_p1X:
    s_mov_b32 s5, 0
L_rt_p1X:
    s_mov_b64 exec, vcc
    buffer_load_dword v29, v28, s[44:47], 0 offen sc1
    s_waitcnt vmcnt(0)
    v_cmp_ne_u32 vcc, s68, v29
    s_cbranch_vccz L_rx_p1X
    s_add_u32 s5, s5, 1
    s_cmp_lt_u32 s5, 100000
    s_cbranch_scc1 L_rt_p1X
L_rx_p1X:
    s_mov_b64 exec, -1
    s_branch L_ok_p1X
L_rs_p2G:
    s_mov_b32 s5, 0
L_rt_p2G:
    s_mov_b64 exec, vcc
    v_mov_b32 v16, 0
    buffer_atomic_add v16, v15, s[44:47], 0 offen sc0 sc1
    s_waitcnt vmcnt(0)
    v_cmp_ne_u32 vcc, v13, v16
    s_cbranch_vccz L_rx_p2G
    s_add_u32 s5, s5, 1
    s_cmp_lt_u32 s5, 100000
    s_cbranch_scc1 L_rt_p2G
L_rx_p2G:
    s_mov_b64 exec, -1
    s_branch L_ok_p2G
L_xs_a:
    s_mov_b32 s5, 0
L_xt_a:
    buffer_load_dwordx4 v[40:43], v136, s[44:47], s34 offen offset:0 sc1
    buffer_load_dwordx4 v[44:47], v136, s[44:47], s34 offen offset:1024 sc1
    buffer_load_dwordx4 v[48:51], v136, s[44:47], s34 offen offset:2048 sc1
    s_waitcnt vmcnt(0)
    v_bitop3_b32 v43, v43, v47, s68 bitop3:0x7e
    v_bitop3_b32 v43, v43, v51, s68 bitop3:0xf6
    v_cmp_ne_u32 vcc, 0, v43
    s_cbranch_vccz L_xo_a
    s_add_u32 s5, s5, 1
    s_cmp_lt_u32 s5, 100000
    s_cbranch_scc1 L_xt_a
    s_branch L_xo_a
L_as_b:
    s_mov_b32 s5, 0
L_at_b:
    v_mov_b32 v141, 0
    buffer_atomic_add v141, v139, s[44:47], s11 offen offset:2060 sc0 sc1
    s_waitcnt vmcnt(0)
    v_cmp_ne_u32 vcc, v140, v141
    s_cbranch_vccz L_ao_b
    s_add_u32 s5, s5, 1
    s_cmp_lt_u32 s5, 100000
    s_cbranch_scc1 L_at_b
    s_branch L_ao_b
L_xs_b:
    s_mov_b32 s5, 0
L_xt_b:
    buffer_load_dwordx4 v[56:59], v136, s[44:47], s11 offen offset:0 sc1
    buffer_load_dwordx4 v[60:63], v136, s[44:47], s11 offen offset:1024 sc1
    buffer_load_dwordx4 v[64:67], v136, s[44:47], s11 offen offset:2048 sc1
    s_waitcnt vmcnt(0)
    v_bitop3_b32 v59, v59, v63, s68 bitop3:0x7e
    v_bitop3_b32 v59, v59, v67, s68 bitop3:0xf6
    v_cmp_ne_u32 vcc, 0, v59
    s_cbranch_vccz L_xo_b
    s_add_u32 s5, s5, 1
    s_cmp_lt_u32 s5, 100000
    s_cbranch_scc1 L_xt_b
    s_branch L_xo_b
L_xs_z:
    s_mov_b32 s5, 0
L_xt_z:
    buffer_load_dwordx4 v[72:75], v136, s[44:47], s12 offen offset:0 sc1
    buffer_load_dwordx4 v[76:79], v136, s[44:47], s12 offen offset:1024 sc1
    buffer_load_dwordx4 v[80:83], v136, s[44:47], s12 offen offset:2048 sc1
    s_waitcnt vmcnt(0)
    v_bitop3_b32 v75, v75, v79, s68 bitop3:0x7e
    v_bitop3_b32 v75, v75, v83, s68 bitop3:0xf6
    v_cmp_ne_u32 vcc, 0, v75
    s_cbranch_vccz L_xo_z
    s_add_u32 s5, s5, 1
    s_cmp_lt_u32 s5, 100000
    s_cbranch_scc1 L_xt_z
    s_branch L_xo_z
L_rs_p3:
    s_mov_b32 s5, 0
L_rt_p3:
    s_mov_b64 exec, vcc
    buffer_load_dword v189, v188, s[44:47], 0 offen sc1
    s_waitcnt vmcnt(0)
    v_cmp_ne_u32 vcc, s68, v189
    s_cbranch_vccz L_rx_p3
    s_add_u32 s5, s5, 1
    s_cmp_lt_u32 s5, 100000
    s_cbranch_scc1 L_rt_p3
L_rx_p3:
    s_mov_b64 exec, -1
    s_branch L_ok_p3
L_xs_8:
    s_mov_b32 s5, 0
L_xt_8:
    buffer_load_dwordx4 v[204:207], v136, s[44:47], s35 offen offset:0 sc1
    buffer_load_dwordx4 v[208:211], v136, s[44:47], s35 offen offset:1024 sc1
    buffer_load_dwordx4 v[212:215], v136, s[44:47], s35 offen offset:2048 sc1
    buffer_load_dwordx4 v[216:219], v136, s[44:47], s35 offen offset:3072 sc1
    s_waitcnt vmcnt(0)
    v_bitop3_b32 v207, v207, v211, s36 bitop3:0x7e
    v_bitop3_b32 v207, v207, v215, s36 bitop3:0xf6
    v_bitop3_b32 v207, v207, v219, s36 bitop3:0xf6
    v_cmp_ne_u32 vcc, 0, v207
    s_cbranch_vccz L_xo_8
    s_add_u32 s5, s5, 1
    s_cmp_lt_u32 s5, 100000
    s_cbranch_scc1 L_xt_8
    s_branch L_xo_8
L_rs_p2X:
    s_mov_b32 s5, 0
L_rt_p2X:
    s_mov_b64 exec, vcc
    v_mov_b32 v29, 0
    buffer_atomic_add v29, v28, s[44:47], 0 offen sc0 sc1
    s_waitcnt vmcnt(0)
    v_cmp_ne_u32 vcc, v13, v29
    s_cbranch_vccz L_rx_p2X
    s_add_u32 s5, s5, 1
    s_cmp_lt_u32 s5, 100000
    s_cbranch_scc1 L_rt_p2X
L_rx_p2X:
    s_mov_b64 exec, -1
    s_branch L_ok_p2X
L_wc_G:
    s_cmp_eq_u32 s3, 0
    s_cbranch_scc1 L_pl_G_0
    s_cmp_eq_u32 s3, 1
    s_cbranch_scc1 L_pl_G_1
    s_cmp_eq_u32 s3, 2
    s_cbranch_scc1 L_pl_G_2
    s_branch L_pl_G_3
L_wc_X:
    s_cmp_eq_u32 s3, 0
    s_cbranch_scc1 L_pl_X_0
    s_cmp_eq_u32 s3, 1
    s_cbranch_scc1 L_pl_X_1
    s_cmp_eq_u32 s3, 2
    s_cbranch_scc1 L_pl_X_2
    s_branch L_pl_X_3
L_wc_D:
    s_cmp_eq_u32 s3, 0
    s_cbranch_scc1 L_pl_D_0
    s_cmp_eq_u32 s3, 1
    s_cbranch_scc1 L_pl_D_1
    s_cmp_eq_u32 s3, 2
    s_cbranch_scc1 L_pl_D_2
    s_branch L_wret
L_wret:
    s_setpc_b64 s[82:83]
.p2align 12
L_org:
    s_mul_i32 s7, s6, 21846
    s_lshr_b32 s7, s7, 16
    s_mul_i32 s8, s7, 3
    s_sub_u32 s12, s6, s8
    s_mul_i32 s8, s13, 9
    s_add_u32 s69, s8, s7
    s_lshl1_add_u32 s70, s12, s4
    s_mul_i32 s8, s69, 6
    s_add_u32 s75, s8, s70
    s_mov_b32 s48, s30
    s_and_b32 s49, s31, 0xffff
    s_mov_b32 s50, 18874368
    s_mov_b32 s51, 0x20000
    s_add_u32 s12, s12, s7
    s_mul_i32 s8, s12, 21846
    s_lshr_b32 s8, s8, 16
    s_mul_i32 s8, s8, 3
    s_sub_u32 s12, s12, s8
    s_mul_i32 s4, s4, 1179648
    s_mul_i32 s7, s12, 65538
    s_lshr_b32 s7, s7, 16
    s_mul_i32 s7, s7, 73728
    s_add_u32 s5, s4, 0
    s_add_u32 s18, s7, s5
    s_add_u32 s8, s5, 221184
    s_add_u32 s19, s18, 73728
    s_cmp_eq_u32 s19, s8
    s_cselect_b32 s19, s5, s19
    s_add_u32 s20, s19, 73728
    s_cmp_eq_u32 s20, s8
    s_cselect_b32 s20, s5, s20
    s_mul_i32 s7, s12, 65538
    s_lshr_b32 s7, s7, 16
    s_mul_i32 s7, s7, 73728
    s_add_u32 s5, s4, 221184
    s_add_u32 s21, s7, s5
    s_add_u32 s8, s5, 221184
    s_add_u32 s22, s21, 73728
    s_cmp_eq_u32 s22, s8
    s_cselect_b32 s22, s5, s22
    s_add_u32 s23, s22, 73728
    s_cmp_eq_u32 s23, s8
    s_cselect_b32 s23, s5, s23
    s_mul_i32 s7, s12, 87384
    s_lshr_b32 s7, s7, 16
    s_mul_i32 s7, s7, 73728
    s_add_u32 s5, s4, 442368
    s_add_u32 s24, s7, s5
    s_add_u32 s8, s5, 294912
    s_add_u32 s25, s24, 73728
    s_cmp_eq_u32 s25, s8
    s_cselect_b32 s25, s5, s25
    s_add_u32 s26, s25, 73728
    s_cmp_eq_u32 s26, s8
    s_cselect_b32 s26, s5, s26
    s_add_u32 s27, s26, 73728
    s_cmp_eq_u32 s27, s8
    s_cselect_b32 s27, s5, s27
    s_mul_i32 s7, s12, 131076
    s_lshr_b32 s7, s7, 16
    s_mul_i32 s7, s7, 73728
    s_add_u32 s5, s4, 737280
    s_add_u32 s76, s7, s5
    s_add_u32 s8, s5, 442368
    s_add_u32 s77, s76, 73728
    s_cmp_eq_u32 s77, s8
    s_cselect_b32 s77, s5, s77
    s_add_u32 s78, s77, 73728
    s_cmp_eq_u32 s78, s8
    s_cselect_b32 s78, s5, s78
    s_add_u32 s79, s78, 73728
    s_cmp_eq_u32 s79, s8
    s_cselect_b32 s79, s5, s79
    s_add_u32 s80, s79, 73728
    s_cmp_eq_u32 s80, s8
    s_cselect_b32 s80, s5, s80
    s_add_u32 s81, s80, 73728
    s_cmp_eq_u32 s81, s8
    s_cselect_b32 s81, s5, s81
    v_lshrrev_b32 v24, 4, v2
    v_and_b32 v25, 15, v2
    v_lshlrev_b32 v26, 1, v24
    v_xor_b32 v25, v25, v26
    v_mul_u32_u24 v24, 9216, v24
    v_lshl_add_u32 v24, v25, 4, v24
    s_mul_i32 s7, s3, 147456
    s_lshl_b32 s8, s69, 8
    s_add_u32 s7, s7, s8
    v_add_u32 v148, s7, v24
    v_add_u32 v149, 35840, v148
    v_xor_b32 v24, 128, v148
    v_add_u32 v150, 71680, v24
    v_add_u32 v151, 35840, v150
    v_bfe_u32 v140, v2, 2, 2
    v_lshrrev_b32 v141, 4, v2
    v_lshl_add_u32 v142, v141, 3, v140
    v_lshlrev_b32 v142, 8, v142
    v_and_b32 v143, 3, v2
    v_lshl_add_u32 v142, v143, 3, v142
    v_and_b32 v141, 1, v141
    v_lshl_add_u32 v140, v141, 2, v140
    s_lshl_b32 s7, s3, 1
    v_xor_b32 v140, s7, v140
    v_lshl_add_u32 v152, v140, 5, v142
    v_xor_b32 v153, 32, v152
    v_add_u32 v154, 0x10000, v152
    v_add_u32 v155, 0x10000, v153
    v_and_b32 v24, 15, v2
    v_lshrrev_b32 v25, 4, v2
    v_mul_u32_u24 v26, 17408, v25
    v_lshl_add_u32 v26, v24, 4, v26
    v_mul_u32_u24 v25, 1536, v25
    v_lshl_add_u32 v25, v24, 4, v25
    v_add_u32 v159, 81920, v25
    v_add_u32 v250, 36864, v159
    s_mul_i32 s7, s3, 18432
    s_xor_b32 s8, s70, 1
    s_mul_i32 s8, s8, 1536
    s_add_u32 s7, s7, s8
    v_lshlrev_b32 v246, 4, v2
    v_add_u32 v156, s7, v246
    v_lshrrev_b32 v25, 5, v2
    v_mul_u32_u24 v25, 7680, v25
    v_add_u32 v157, v156, v25
    v_add_u32 v158, 7680, v156
    s_mul_i32 s74, s3, 3072
    s_add_u32 s74, s74, 81920
    v_mov_b32 v245, v26
    s_mov_b32 s9, 144896
    s_mov_b32 s11, 114688
    s_waitcnt vmcnt(9)
    v_and_b32 v21, 0xffff0000, v8
    s_add_u32 m0, s73, 81920
    s_lshl_b32 s14, s18, 3
    buffer_load_dwordx4 v148, s[48:51], s14 offen offset:0 lds
    v_lshlrev_b32 v20, 16, v8
    v_and_b32 v23, 0xffff0000, v9
    v_lshlrev_b32 v22, 16, v9
    v_and_b32 v25, 0xffff0000, v10
    v_lshlrev_b32 v24, 16, v10
    v_and_b32 v27, 0xffff0000, v12
    v_lshlrev_b32 v26, 16, v12
    v_and_b32 v29, 0xffff0000, v13
    v_lshlrev_b32 v28, 16, v13
    v_and_b32 v31, 0xffff0000, v14
    v_lshlrev_b32 v30, 16, v14
    v_and_b32 v33, 0xffff0000, v16
    v_lshlrev_b32 v32, 16, v16
    v_and_b32 v35, 0xffff0000, v17
    v_lshlrev_b32 v34, 16, v17
    v_and_b32 v37, 0xffff0000, v18
    v_lshlrev_b32 v36, 16, v18
    v_pk_add_f32 v[38:39], v[20:21], v[22:23]
    v_pk_add_f32 v[40:41], v[24:25], v[26:27]
    v_pk_add_f32 v[42:43], v[28:29], v[30:31]
    v_pk_add_f32 v[44:45], v[32:33], v[34:35]
    v_pk_add_f32 v[38:39], v[38:39], v[40:41]
    v_pk_add_f32 v[42:43], v[42:43], v[44:45]
    v_pk_add_f32 v[38:39], v[38:39], v[36:37]
    v_pk_add_f32 v[38:39], v[38:39], v[42:43]
    v_add_f32 v56, v38, v39
    buffer_load_dwordx4 v149, s[48:51], s14 offen offset:1024 lds
    s_nop 0
    v_add_f32_dpp v56, v56, v56 row_ror:8 row_mask:0xf bank_mask:0xf
    s_nop 1
    v_add_f32_dpp v56, v56, v56 row_ror:4 row_mask:0xf bank_mask:0xf
    s_nop 1
    v_add_f32_dpp v56, v56, v56 row_ror:2 row_mask:0xf bank_mask:0xf
    s_nop 1
    v_add_f32_dpp v56, v56, v56 row_ror:1 row_mask:0xf bank_mask:0xf
    v_mov_b32 v57, v56
    s_nop 1
    v_permlane16_swap_b32 v56, v57
    v_add_f32 v56, v56, v57
    v_mul_f32 v56, 0x3ae38e39, v56
    v_pk_add_f32 v[20:21], v[20:21], v[56:57] op_sel_hi:[1,0] neg_lo:[0,1] neg_hi:[0,1]
    v_pk_add_f32 v[22:23], v[22:23], v[56:57] op_sel_hi:[1,0] neg_lo:[0,1] neg_hi:[0,1]
    v_pk_add_f32 v[24:25], v[24:25], v[56:57] op_sel_hi:[1,0] neg_lo:[0,1] neg_hi:[0,1]
    v_pk_add_f32 v[26:27], v[26:27], v[56:57] op_sel_hi:[1,0] neg_lo:[0,1] neg_hi:[0,1]
    v_pk_add_f32 v[28:29], v[28:29], v[56:57] op_sel_hi:[1,0] neg_lo:[0,1] neg_hi:[0,1]
    v_pk_add_f32 v[30:31], v[30:31], v[56:57] op_sel_hi:[1,0] neg_lo:[0,1] neg_hi:[0,1]
    v_pk_add_f32 v[32:33], v[32:33], v[56:57] op_sel_hi:[1,0] neg_lo:[0,1] neg_hi:[0,1]
    v_pk_add_f32 v[34:35], v[34:35], v[56:57] op_sel_hi:[1,0] neg_lo:[0,1] neg_hi:[0,1]
    v_pk_add_f32 v[36:37], v[36:37], v[56:57] op_sel_hi:[1,0] neg_lo:[0,1] neg_hi:[0,1]
    v_pk_mul_f32 v[38:39], v[20:21], v[20:21]
    v_pk_mul_f32 v[40:41], v[22:23], v[22:23]
    v_pk_fma_f32 v[38:39], v[24:25], v[24:25], v[38:39]
    v_pk_fma_f32 v[40:41], v[26:27], v[26:27], v[40:41]
    v_pk_fma_f32 v[38:39], v[28:29], v[28:29], v[38:39]
    v_pk_fma_f32 v[40:41], v[30:31], v[30:31], v[40:41]
    v_pk_fma_f32 v[38:39], v[32:33], v[32:33], v[38:39]
    v_pk_fma_f32 v[40:41], v[34:35], v[34:35], v[40:41]
    v_pk_fma_f32 v[38:39], v[36:37], v[36:37], v[38:39]
    buffer_load_dwordx4 v150, s[48:51], s14 offen offset:2048 lds
    v_pk_add_f32 v[38:39], v[38:39], v[40:41]
    v_add_f32 v18, v38, v39
    s_nop 1
    v_add_f32_dpp v18, v18, v18 row_ror:8 row_mask:0xf bank_mask:0xf
    s_nop 1
    v_add_f32_dpp v18, v18, v18 row_ror:4 row_mask:0xf bank_mask:0xf
    s_nop 1
    v_add_f32_dpp v18, v18, v18 row_ror:2 row_mask:0xf bank_mask:0xf
    s_nop 1
    v_add_f32_dpp v18, v18, v18 row_ror:1 row_mask:0xf bank_mask:0xf
    v_mov_b32 v19, v18
    s_nop 1
    v_permlane16_swap_b32 v18, v19
    v_add_f32 v18, v18, v19
    v_mul_f32 v18, 0x3ae38e39, v18
    v_cvt_pk_bf16_f32 v38, v56, v18
    v_lshlrev_b32 v106, 16, v38
    v_and_b32 v38, 0xffff0000, v38
    v_add_f32 v38, 0x3727c5ac, v38
    v_sub_f32 v56, v56, v106
    v_cvt_pk_bf16_f32 v38, v38, v38
    v_lshlrev_b32 v38, 16, v38
    v_sqrt_f32 v38, v38
    s_nop 0
    v_cvt_pk_bf16_f32 v38, v38, v38
    v_lshlrev_b32 v38, 16, v38
    v_rcp_f32 v107, v38
    s_nop 0
    v_mul_f32 v56, v56, v107
    v_mul_f32 v18, v18, v107
    v_mul_f32 v18, v18, v107
    v_cvt_pk_bf16_f32 v38, v56, v18
    v_lshlrev_b32 v39, 16, v38
    buffer_load_dwordx4 v151, s[48:51], s14 offen offset:3072 lds
    v_and_b32 v38, 0xffff0000, v38
    v_add_f32 v38, 0x3727c5ac, v38
    v_sub_f32 v56, v56, v39
    v_cvt_pk_bf16_f32 v38, v38, v38
    v_lshlrev_b32 v38, 16, v38
    v_sqrt_f32 v38, v38
    s_nop 0
    v_cvt_pk_bf16_f32 v38, v38, v38
    v_lshlrev_b32 v38, 16, v38
    v_rcp_f32 v38, v38
    s_nop 0
    v_mul_f32 v18, v107, v38
    v_mul_f32 v56, v56, v38
    v_pk_fma_f32 v[20:21], v[20:21], v[18:19], v[56:57] op_sel_hi:[1,0,0]
    v_pk_fma_f32 v[22:23], v[22:23], v[18:19], v[56:57] op_sel_hi:[1,0,0]
    v_pk_fma_f32 v[24:25], v[24:25], v[18:19], v[56:57] op_sel_hi:[1,0,0]
    v_pk_fma_f32 v[26:27], v[26:27], v[18:19], v[56:57] op_sel_hi:[1,0,0]
    v_pk_fma_f32 v[28:29], v[28:29], v[18:19], v[56:57] op_sel_hi:[1,0,0]
    v_pk_fma_f32 v[30:31], v[30:31], v[18:19], v[56:57] op_sel_hi:[1,0,0]
    v_pk_fma_f32 v[32:33], v[32:33], v[18:19], v[56:57] op_sel_hi:[1,0,0]
    v_pk_fma_f32 v[34:35], v[34:35], v[18:19], v[56:57] op_sel_hi:[1,0,0]
    v_pk_fma_f32 v[36:37], v[36:37], v[18:19], v[56:57] op_sel_hi:[1,0,0]
    v_cvt_pk_bf16_f32 v8, v20, v21
    v_cvt_pk_bf16_f32 v9, v22, v23
    v_cvt_pk_bf16_f32 v10, v24, v25
    v_cvt_pk_bf16_f32 v11, v26, v27
    v_cvt_pk_bf16_f32 v12, v28, v29
    v_cvt_pk_bf16_f32 v13, v30, v31
    v_cvt_pk_bf16_f32 v14, v32, v33
    v_cvt_pk_bf16_f32 v15, v34, v35
    v_cvt_pk_bf16_f32 v16, v36, v37
    v_lshrrev_b32 v3, 5, v0
    v_and_b32 v1, 31, v0
    v_mul_u32_u24 v17, 1216, v3
    v_mad_u32_u24 v17, v1, 12, v17
    v_add_u32 v17, 144896, v17
    ds_write_b32 v17, v8 offset:0
    ds_write_b32 v17, v9 offset:4
    ds_write_b32 v17, v10 offset:8
    ds_write_b32 v17, v11 offset:384
    ds_write_b32 v17, v12 offset:388
    ds_write_b32 v17, v13 offset:392
    ds_write_b32 v17, v14 offset:768
    ds_write_b32 v17, v15 offset:772
    ds_write_b32 v17, v16 offset:776
    v_lshlrev_b32 v3, 3, v3
    s_lshl_b32 s5, s68, 6
    s_add_u32 s5, s5, 12386304
    v_cmp_eq_u32 vcc, 0, v1
    v_mov_b32 v18, 0x40000000
    s_nop 0
    v_cndmask_b32 v3, v18, v3, vcc
    buffer_store_dwordx2 v[106:107], v3, s[44:47], s5 offen sc1
    v_lshrrev_b32 v19, 4, v0
    v_and_b32 v17, 3, v2
    v_lshlrev_b32 v17, 3, v17
    v_lshl_add_u32 v19, v19, 5, v17
    v_bfe_u32 v6, v2, 2, 2
    v_mul_u32_u24 v17, 1216, v6
    v_mul_u32_u24 v6, 1152, v6
    v_add3_u32 v17, v17, v19, s9
    v_add3_u32 v6, v6, v19, s11
    v_lshlrev_b32 v19, 4, v0
    s_add_u32 s7, s15, 4096
    s_add_u32 s8, s15, 8192
    s_cmp_eq_u32 s3, 0
    s_cselect_b32 s8, s8, 0x40000000
    v_add_u32 v18, 2359296, v19
    v_mov_b32 v44, 0
    s_waitcnt lgkmcnt(0)
    s_barrier
    ds_read_b64_tr_b16 v[20:21], v17 offset:0
    ds_read_b64_tr_b16 v[22:23], v17 offset:4864
    ds_read_b64_tr_b16 v[24:25], v17 offset:512
    ds_read_b64_tr_b16 v[26:27], v17 offset:5376
    ds_read_b64_tr_b16 v[28:29], v17 offset:1024
    ds_read_b64_tr_b16 v[30:31], v17 offset:5888
    s_bfe_u32 s6, s68, 0x20001
    s_lshl_b32 s6, s6, 6
    s_lshr_b32 s9, s68, 3
    s_lshl_b32 s9, s9, 1
    s_add_u32 s6, s6, s9
    s_and_b32 s9, s68, 1
    s_add_u32 s6, s6, s9
    s_lshr_b32 s4, s6, 2
    s_lshl_b32 s4, s4, 7
    s_and_b32 s5, s6, 3
    s_lshl2_add_u32 s4, s5, s4
    s_add_u32 s4, s4, 12533760
    v_min_u32 v1, 1, v0
    v_lshlrev_b32 v1, 30, v1
    v_add_u32 v1, s4, v1
    s_waitcnt lgkmcnt(4)
    buffer_store_dwordx4 v[20:23], v19, s[44:47], s15 offen sc1
    s_waitcnt lgkmcnt(2)
    buffer_store_dwordx4 v[24:27], v19, s[44:47], s7 offen sc1
    s_waitcnt lgkmcnt(0)
    buffer_store_dwordx4 v[28:31], v19, s[44:47], s8 offen sc1
    buffer_load_dword v45, v44, s[64:67], 0 offen sc1
    s_waitcnt vmcnt(10)
    s_barrier
    ds_read_b64_tr_b16 v[60:61], v6 offset:0
    ds_read_b64_tr_b16 v[62:63], v6 offset:4608
    ds_read_b64_tr_b16 v[64:65], v6 offset:9216
    ds_read_b64_tr_b16 v[66:67], v6 offset:12672
    ds_read_b64_tr_b16 v[68:69], v6 offset:17280
    ds_read_b64_tr_b16 v[70:71], v6 offset:512
    ds_read_b64_tr_b16 v[72:73], v6 offset:5120
    ds_read_b64_tr_b16 v[74:75], v6 offset:9728
    ds_read_b64_tr_b16 v[76:77], v6 offset:13184
    ds_read_b64_tr_b16 v[78:79], v6 offset:17792
    v_alignbit_b32 v114, v99, v99, 16
    v_alignbit_b32 v115, v98, v98, 16
    s_waitcnt lgkmcnt(5)
    v_alignbit_b32 v108, v61, v60, 16
    v_alignbit_b32 v109, v62, v61, 16
    v_alignbit_b32 v110, v63, v62, 16
    v_alignbit_b32 v111, v64, v63, 16
    v_alignbit_b32 v112, v65, v64, 16
    v_dot2_f32_bf16 v116, v60, v114, 0
    ds_read_b64_tr_b16 v[80:81], v6 offset:1024
    v_dot2_f32_bf16 v117, v108, v114, 0
    v_dot2_f32_bf16 v118, v61, v114, 0
    v_dot2_f32_bf16 v119, v109, v114, 0
    v_dot2_f32_bf16 v120, v62, v114, 0
    ds_read_b64_tr_b16 v[82:83], v6 offset:5632
    v_dot2_f32_bf16 v121, v110, v114, 0
    v_dot2_f32_bf16 v122, v63, v114, 0
    v_dot2_f32_bf16 v123, v111, v114, 0
    v_dot2_f32_bf16 v116, v61, v115, v116
    v_dot2_f32_bf16 v117, v109, v115, v117
    ds_read_b64_tr_b16 v[84:85], v6 offset:10240
    v_dot2_f32_bf16 v118, v62, v115, v118
    v_dot2_f32_bf16 v119, v110, v115, v119
    v_dot2_f32_bf16 v120, v63, v115, v120
    v_dot2_f32_bf16 v121, v111, v115, v121
    v_dot2_f32_bf16 v122, v64, v115, v122
    ds_read_b64_tr_b16 v[86:87], v6 offset:13696
    v_dot2_f32_bf16 v123, v112, v115, v123
    v_and_b32 v133, 0xffff0000, v66
    v_lshlrev_b32 v132, 16, v66
    v_and_b32 v135, 0xffff0000, v67
    v_lshlrev_b32 v134, 16, v67
    ds_read_b64_tr_b16 v[88:89], v6 offset:18304
    v_and_b32 v137, 0xffff0000, v68
    v_lshlrev_b32 v136, 16, v68
    v_and_b32 v139, 0xffff0000, v69
    v_lshlrev_b32 v138, 16, v69
    v_pk_mul_f32 v[116:117], v[116:117], v[132:133]
    v_pk_mul_f32 v[118:119], v[118:119], v[134:135]
    v_pk_mul_f32 v[120:121], v[120:121], v[136:137]
    v_pk_mul_f32 v[122:123], v[122:123], v[138:139]
    v_cvt_pk_bf16_f32 v160, v123, v122
    v_cvt_pk_bf16_f32 v161, v121, v120
    v_cvt_pk_bf16_f32 v162, v119, v118
    v_cvt_pk_bf16_f32 v163, v117, v116
    buffer_store_dwordx4 v[160:163], v18, s[44:47], s15 offen sc1
    v_alignbit_b32 v114, v101, v101, 16
    v_alignbit_b32 v115, v100, v100, 16
    s_waitcnt lgkmcnt(5)
    v_alignbit_b32 v108, v71, v70, 16
    v_alignbit_b32 v109, v72, v71, 16
    v_alignbit_b32 v110, v73, v72, 16
    v_alignbit_b32 v111, v74, v73, 16
    v_alignbit_b32 v112, v75, v74, 16
    v_dot2_f32_bf16 v124, v70, v114, 0
    v_dot2_f32_bf16 v125, v108, v114, 0
    v_dot2_f32_bf16 v126, v71, v114, 0
    v_dot2_f32_bf16 v127, v109, v114, 0
    v_dot2_f32_bf16 v128, v72, v114, 0
    v_dot2_f32_bf16 v129, v110, v114, 0
    v_dot2_f32_bf16 v130, v73, v114, 0
    v_dot2_f32_bf16 v131, v111, v114, 0
    v_dot2_f32_bf16 v124, v71, v115, v124
    v_dot2_f32_bf16 v125, v109, v115, v125
    v_dot2_f32_bf16 v126, v72, v115, v126
    v_dot2_f32_bf16 v127, v110, v115, v127
    v_dot2_f32_bf16 v128, v73, v115, v128
    v_dot2_f32_bf16 v129, v111, v115, v129
    v_dot2_f32_bf16 v130, v74, v115, v130
    v_dot2_f32_bf16 v131, v112, v115, v131
    v_and_b32 v133, 0xffff0000, v76
    v_lshlrev_b32 v132, 16, v76
    v_and_b32 v135, 0xffff0000, v77
    v_lshlrev_b32 v134, 16, v77
    v_and_b32 v137, 0xffff0000, v78
    v_lshlrev_b32 v136, 16, v78
    v_and_b32 v139, 0xffff0000, v79
    v_lshlrev_b32 v138, 16, v79
    v_pk_mul_f32 v[124:125], v[124:125], v[132:133]
    v_pk_mul_f32 v[126:127], v[126:127], v[134:135]
    v_pk_mul_f32 v[128:129], v[128:129], v[136:137]
    v_pk_mul_f32 v[130:131], v[130:131], v[138:139]
    v_cvt_pk_bf16_f32 v164, v131, v130
    v_cvt_pk_bf16_f32 v165, v129, v128
    v_cvt_pk_bf16_f32 v166, v127, v126
    v_cvt_pk_bf16_f32 v167, v125, v124
    buffer_store_dwordx4 v[164:167], v18, s[44:47], s7 offen sc1
    v_alignbit_b32 v114, v103, v103, 16
    v_alignbit_b32 v115, v102, v102, 16
    s_waitcnt lgkmcnt(0)
    v_alignbit_b32 v108, v81, v80, 16
    v_alignbit_b32 v109, v82, v81, 16
    v_alignbit_b32 v110, v83, v82, 16
    v_alignbit_b32 v111, v84, v83, 16
    v_alignbit_b32 v112, v85, v84, 16
    v_dot2_f32_bf16 v116, v80, v114, 0
    v_dot2_f32_bf16 v117, v108, v114, 0
    v_dot2_f32_bf16 v118, v81, v114, 0
    v_dot2_f32_bf16 v119, v109, v114, 0
    v_dot2_f32_bf16 v120, v82, v114, 0
    v_dot2_f32_bf16 v121, v110, v114, 0
    v_dot2_f32_bf16 v122, v83, v114, 0
    v_dot2_f32_bf16 v123, v111, v114, 0
    v_dot2_f32_bf16 v116, v81, v115, v116
    v_dot2_f32_bf16 v117, v109, v115, v117
    v_dot2_f32_bf16 v118, v82, v115, v118
    v_dot2_f32_bf16 v119, v110, v115, v119
    v_dot2_f32_bf16 v120, v83, v115, v120
    v_dot2_f32_bf16 v121, v111, v115, v121
    v_dot2_f32_bf16 v122, v84, v115, v122
    v_dot2_f32_bf16 v123, v112, v115, v123
    v_and_b32 v133, 0xffff0000, v86
    v_lshlrev_b32 v132, 16, v86
    v_and_b32 v135, 0xffff0000, v87
    v_lshlrev_b32 v134, 16, v87
    v_and_b32 v137, 0xffff0000, v88
    v_lshlrev_b32 v136, 16, v88
    v_and_b32 v139, 0xffff0000, v89
    v_lshlrev_b32 v138, 16, v89
    v_pk_mul_f32 v[116:117], v[116:117], v[132:133]
    v_pk_mul_f32 v[118:119], v[118:119], v[134:135]
    v_pk_mul_f32 v[120:121], v[120:121], v[136:137]
    v_pk_mul_f32 v[122:123], v[122:123], v[138:139]
    v_cvt_pk_bf16_f32 v168, v123, v122
    v_cvt_pk_bf16_f32 v169, v121, v120
    v_cvt_pk_bf16_f32 v170, v119, v118
    v_cvt_pk_bf16_f32 v171, v117, v116
    buffer_store_dwordx4 v[168:171], v18, s[44:47], s8 offen sc1
    s_add_u32 m0, s73, 98304
    s_lshl_b32 s14, s19, 3
    buffer_load_dwordx4 v148, s[48:51], s14 offen offset:0 lds
    buffer_load_dwordx4 v149, s[48:51], s14 offen offset:1024 lds
    buffer_load_dwordx4 v150, s[48:51], s14 offen offset:2048 lds
    buffer_load_dwordx4 v151, s[48:51], s14 offen offset:3072 lds
    s_add_u32 m0, s73, 0
    s_lshl_b32 s14, s20, 3
    buffer_load_dwordx4 v148, s[48:51], s14 offen offset:0 lds
    buffer_load_dwordx4 v149, s[48:51], s14 offen offset:1024 lds
    buffer_load_dwordx4 v150, s[48:51], s14 offen offset:2048 lds
    buffer_load_dwordx4 v151, s[48:51], s14 offen offset:3072 lds
    s_add_u32 m0, s73, 16384
    s_lshl_b32 s14, s21, 3
    buffer_load_dwordx4 v148, s[48:51], s14 offen offset:0 lds
    buffer_load_dwordx4 v149, s[48:51], s14 offen offset:1024 lds
    s_waitcnt vmcnt(13)
    v_readfirstlane_b32 s68, v45
    s_nop 1
    s_cmp_eq_u32 s68, 0
    s_cbranch_scc1 L_nw_G
L_ng_G:
    s_barrier
    v_mov_b32 v3, s68
    buffer_store_dword v3, v1, s[44:47], 0 offen sc1
    s_mov_b64 exec, 0
    s_call_b64 s[82:83], L_wc_G
    s_mov_b64 exec, -1
    v_add_u32 v1, 65536, v1
    s_waitcnt vmcnt(11)
    s_barrier
    buffer_store_dword v3, v1, s[44:47], 0 offen sc1
L_segG:
L_pl_G_0:
    s_cbranch_execz L_pl_G_4
    buffer_load_dwordx4 v150, s[48:51], s14 offen offset:2048 lds
    buffer_load_dwordx4 v151, s[48:51], s14 offen offset:3072 lds
    s_add_u32 m0, s73, 32768
    s_lshl_b32 s14, s22, 3
    buffer_load_dwordx4 v148, s[48:51], s14 offen offset:0 lds
    buffer_load_dwordx4 v149, s[48:51], s14 offen offset:1024 lds
    buffer_load_dwordx4 v150, s[48:51], s14 offen offset:2048 lds
    buffer_load_dwordx4 v151, s[48:51], s14 offen offset:3072 lds
    s_add_u32 m0, s73, 49152
    s_lshl_b32 s14, s23, 3
    buffer_load_dwordx4 v148, s[48:51], s14 offen offset:0 lds
    buffer_load_dwordx4 v149, s[48:51], s14 offen offset:1024 lds
    buffer_load_dwordx4 v150, s[48:51], s14 offen offset:2048 lds
    buffer_load_dwordx4 v151, s[48:51], s14 offen offset:3072 lds
    s_add_u32 m0, s73, 65536
    s_lshl_b32 s14, s24, 3
    buffer_load_dwordx4 v148, s[48:51], s14 offen offset:0 lds
    buffer_load_dwordx4 v149, s[48:51], s14 offen offset:1024 lds
    buffer_load_dwordx4 v150, s[48:51], s14 offen offset:2048 lds
    buffer_load_dwordx4 v151, s[48:51], s14 offen offset:3072 lds
    s_mov_b64 exec, 0
    s_call_b64 s[82:83], L_wc_D
    s_mov_b64 exec, -1
    s_mov_b32 s56, s32
    s_and_b32 s57, s33, 0xffff
    s_mov_b32 s58, 9216
    s_mov_b32 s59, 0x20000
    s_mov_b32 s60, s36
    s_and_b32 s61, s37, 0xffff
    s_mov_b32 s62, 4096
    s_mov_b32 s63, 0x20000
    s_waitcnt lgkmcnt(0)
    s_barrier
    ds_read_b64_tr_b16 a[0:1], v154 offset:16384
    ds_read_b64_tr_b16 a[2:3], v154 offset:17408
    ds_read_b64_tr_b16 a[4:5], v155 offset:16384
    ds_read_b64_tr_b16 a[6:7], v155 offset:17408
    ds_read_b64_tr_b16 a[8:9], v154 offset:24576
    ds_read_b64_tr_b16 a[10:11], v154 offset:25600
    ds_read_b64_tr_b16 a[12:13], v155 offset:24576
    ds_read_b64_tr_b16 a[14:15], v155 offset:25600
    s_and_b32 s4, s70, 1
    s_lshl1_add_u32 s4, s3, s4
    s_lshl_b32 s4, s4, 5
    v_min_u32 v28, 31, v2
    v_add_u32 v28, s4, v28
    v_and_b32 v29, 3, v28
    v_lshrrev_b32 v28, 2, v28
    v_lshlrev_b32 v28, 7, v28
    v_lshl_add_u32 v28, v29, 2, v28
    v_add_u32 v28, 12533760, v28
    s_waitcnt vmcnt(22) lgkmcnt(0)
    s_barrier
    ds_read_b64_tr_b16 a[16:17], v154 offset:32768
    ds_read_b64_tr_b16 a[18:19], v154 offset:33792
    ds_read_b64_tr_b16 a[20:21], v155 offset:32768
    ds_read_b64_tr_b16 a[22:23], v155 offset:33792
    ds_read_b64_tr_b16 a[24:25], v154 offset:40960
    ds_read_b64_tr_b16 a[26:27], v154 offset:41984
    ds_read_b64_tr_b16 a[28:29], v155 offset:40960
    ds_read_b64_tr_b16 a[30:31], v155 offset:41984
    v_lshrrev_b32 v24, 4, v2
    v_lshlrev_b32 v25, 3, v24
    s_lshl_b32 s7, s69, 8
    s_lshl_b32 s8, s3, 6
    s_add_u32 s7, s7, s8
    buffer_load_dwordx2 v[144:145], v25, s[56:59], s7 offen
    buffer_load_dwordx2 v[146:147], v25, s[56:59], s7 offen offset:32
    s_waitcnt vmcnt(20) lgkmcnt(0)
    s_barrier
    ds_read_b64_tr_b16 a[32:33], v152 offset:0
    ds_read_b64_tr_b16 a[34:35], v152 offset:1024
    ds_read_b64_tr_b16 a[36:37], v153 offset:0
    ds_read_b64_tr_b16 a[38:39], v153 offset:1024
    ds_read_b64_tr_b16 a[40:41], v152 offset:8192
    ds_read_b64_tr_b16 a[42:43], v152 offset:9216
    ds_read_b64_tr_b16 a[44:45], v153 offset:8192
    ds_read_b64_tr_b16 a[46:47], v153 offset:9216
    s_waitcnt vmcnt(14) lgkmcnt(0)
    s_barrier
    ds_read_b64_tr_b16 a[48:49], v152 offset:16384
    s_add_u32 m0, s73, 0
    s_lshl_b32 s14, s25, 3
    ds_read_b64_tr_b16 a[50:51], v152 offset:17408
    buffer_load_dwordx4 v148, s[48:51], s14 offen offset:0 lds
    ds_read_b64_tr_b16 a[52:53], v153 offset:16384
    ds_read_b64_tr_b16 a[54:55], v153 offset:17408
    buffer_load_dwordx4 v149, s[48:51], s14 offen offset:1024 lds
    ds_read_b64_tr_b16 a[56:57], v152 offset:24576
    buffer_load_dwordx4 v150, s[48:51], s14 offen offset:2048 lds
    ds_read_b64_tr_b16 a[58:59], v152 offset:25600
    ds_read_b64_tr_b16 a[60:61], v153 offset:24576
    buffer_load_dwordx4 v151, s[48:51], s14 offen offset:3072 lds
    ds_read_b64_tr_b16 a[62:63], v153 offset:25600
    buffer_load_dword v29, v28, s[44:47], 0 offen sc1
    s_waitcnt vmcnt(15) lgkmcnt(0)
    s_barrier
    ds_read_b64_tr_b16 a[64:65], v152 offset:32768
    s_add_u32 m0, s73, 16384
    s_lshl_b32 s14, s26, 3
    ds_read_b64_tr_b16 a[66:67], v152 offset:33792
    buffer_load_dwordx4 v148, s[48:51], s14 offen offset:0 lds
    ds_read_b64_tr_b16 a[68:69], v153 offset:32768
    ds_read_b64_tr_b16 a[70:71], v153 offset:33792
    buffer_load_dwordx4 v149, s[48:51], s14 offen offset:1024 lds
    ds_read_b64_tr_b16 a[72:73], v152 offset:40960
    buffer_load_dwordx4 v150, s[48:51], s14 offen offset:2048 lds
    ds_read_b64_tr_b16 a[74:75], v152 offset:41984
    ds_read_b64_tr_b16 a[76:77], v153 offset:40960
    buffer_load_dwordx4 v151, s[48:51], s14 offen offset:3072 lds
    ds_read_b64_tr_b16 a[78:79], v153 offset:41984
    s_waitcnt vmcnt(15) lgkmcnt(0)
    s_barrier
    ds_read_b64_tr_b16 a[80:81], v152 offset:49152
    s_add_u32 m0, s73, 32768
    s_lshl_b32 s14, s27, 3
    ds_read_b64_tr_b16 a[82:83], v152 offset:50176
    buffer_load_dwordx4 v148, s[48:51], s14 offen offset:0 lds
    ds_read_b64_tr_b16 a[84:85], v153 offset:49152
    ds_read_b64_tr_b16 a[86:87], v153 offset:50176
    buffer_load_dwordx4 v149, s[48:51], s14 offen offset:1024 lds
    ds_read_b64_tr_b16 a[88:89], v152 offset:57344
    buffer_load_dwordx4 v150, s[48:51], s14 offen offset:2048 lds
    ds_read_b64_tr_b16 a[90:91], v152 offset:58368
    ds_read_b64_tr_b16 a[92:93], v153 offset:57344
L_pl_G_1:
    s_cbranch_execz L_pl_G_5
    buffer_load_dwordx4 v151, s[48:51], s14 offen offset:3072 lds
    ds_read_b64_tr_b16 a[94:95], v153 offset:58368
    s_waitcnt vmcnt(8)
    v_cmp_ne_u32 vcc, s68, v29
    s_cbranch_vccnz L_rs_p1G
L_ok_p1G:
    s_add_u32 m0, s74, 0
    s_nop 0
    buffer_load_dwordx4 v156, s[44:47], s18 offen offset:0 sc1 lds
    buffer_load_dwordx4 v157, s[44:47], s18 offen offset:1024 sc1 lds
    buffer_load_dwordx4 v158, s[44:47], s18 offen offset:2048 sc1 lds
    s_add_u32 m0, s74, 12288
    s_nop 0
    buffer_load_dwordx4 v156, s[44:47], s19 offen offset:0 sc1 lds
    buffer_load_dwordx4 v157, s[44:47], s19 offen offset:1024 sc1 lds
    buffer_load_dwordx4 v158, s[44:47], s19 offen offset:2048 sc1 lds
    s_add_u32 m0, s74, 24576
    s_nop 0
    buffer_load_dwordx4 v156, s[44:47], s20 offen offset:0 sc1 lds
    buffer_load_dwordx4 v157, s[44:47], s20 offen offset:1024 sc1 lds
    buffer_load_dwordx4 v158, s[44:47], s20 offen offset:2048 sc1 lds
    s_add_u32 m0, s74, 36864
    s_nop 0
    buffer_load_dwordx4 v156, s[44:47], s21 offen offset:0 sc1 lds
    buffer_load_dwordx4 v157, s[44:47], s21 offen offset:1024 sc1 lds
    buffer_load_dwordx4 v158, s[44:47], s21 offen offset:2048 sc1 lds
    s_waitcnt vmcnt(9) lgkmcnt(0)
    s_barrier
    ds_read_b128 v[80:83], v159 offset:0
    ds_read_b128 v[84:87], v159 offset:6144
    ds_read_b128 v[88:91], v159 offset:256
    ds_read_b128 v[92:95], v159 offset:6400
    ds_read_b128 v[96:99], v159 offset:512
    ds_read_b128 v[100:103], v159 offset:6656
    s_waitcnt lgkmcnt(0)
    v_mfma_f32_16x16x32_bf16 v[192:195], a[0:3], v[80:83], 0
    v_mfma_f32_16x16x32_bf16 v[192:195], a[8:11], v[84:87], v[192:195]
    ds_read_b128 v[104:107], v159 offset:768
    v_mfma_f32_16x16x32_bf16 v[196:199], a[12:15], v[84:87], 0
    ds_read_b128 v[108:111], v159 offset:6912
    v_mfma_f32_16x16x32_bf16 v[196:199], a[4:7], v[80:83], v[196:199]
    ds_read_b128 v[112:115], v159 offset:1024
    v_mfma_f32_16x16x32_bf16 v[204:207], a[4:7], v[88:91], 0
    ds_read_b128 v[116:119], v159 offset:7168
    v_mfma_f32_16x16x32_bf16 v[204:207], a[12:15], v[92:95], v[204:207]
    ds_read_b128 v[120:123], v159 offset:1280
    v_mfma_f32_16x16x32_bf16 v[200:203], a[8:11], v[92:95], 0
    ds_read_b128 v[124:127], v159 offset:7424
    v_and_b32 v24, 15, v2
    s_lshl_b32 s7, s71, 6
    v_add_u32 v24, s7, v24
    s_and_b32 s8, s3, 1
    s_lshl_b32 s4, s8, 5
    v_add_u32 v25, s4, v24
    v_lshlrev_b32 v26, 3, v25
    v_mul_u32_u24 v25, 1152, v25
    v_bfe_u32 v31, v2, 4, 1
    v_lshl_add_u32 v25, v31, 5, v25
    v_lshrrev_b32 v31, 5, v2
    v_lshl_add_u32 v25, v31, 4, v25
    s_bfe_u32 s7, s2, 0x20003
    s_mul_i32 s7, s7, 288
    s_lshl_b32 s4, s72, 6
    s_add_u32 s4, s4, s7
    v_add_u32 v252, s4, v25
    s_xor_b32 s8, s3, s72
    s_and_b32 s4, s72, 1
    s_lshl1_add_u32 s4, s4, s8
    v_lshl_add_u32 v24, s4, 4, v24
    s_add_u32 s7, s7, 256
    s_cmp_lt_u32 s8, 2
    s_cselect_b32 s7, s7, 0x40000000
    v_lshlrev_b32 v18, 3, v24
    v_mul_u32_u24 v24, 1152, v24
    v_lshrrev_b32 v31, 4, v2
    v_mfma_f32_16x16x32_bf16 v[200:203], a[0:3], v[88:91], v[200:203]
    v_mfma_f32_16x16x32_bf16 v[208:211], a[0:3], v[96:99], 0
    v_mfma_f32_16x16x32_bf16 v[208:211], a[8:11], v[100:103], v[208:211]
    v_mfma_f32_16x16x32_bf16 v[212:215], a[12:15], v[100:103], 0
    v_mfma_f32_16x16x32_bf16 v[212:215], a[4:7], v[96:99], v[212:215]
    s_waitcnt lgkmcnt(0)
    v_mfma_f32_16x16x32_bf16 v[220:223], a[4:7], v[104:107], 0
    s_waitcnt vmcnt(6)
    s_barrier
    v_mfma_f32_16x16x32_bf16 v[220:223], a[12:15], v[108:111], v[220:223]
    ds_read_b128 v[80:83], v159 offset:12288
    s_add_u32 m0, s74, 49152
    v_mfma_f32_16x16x32_bf16 v[216:219], a[8:11], v[108:111], 0
    ds_read_b128 v[84:87], v159 offset:18432
    v_mfma_f32_16x16x32_bf16 v[216:219], a[0:3], v[104:107], v[216:219]
    ds_read_b128 v[88:91], v159 offset:12544
    buffer_load_dwordx4 v156, s[44:47], s22 offen offset:0 sc1 lds
    v_mfma_f32_16x16x32_bf16 v[224:227], a[0:3], v[112:115], 0
    ds_read_b128 v[92:95], v159 offset:18688
    v_mfma_f32_16x16x32_bf16 v[224:227], a[8:11], v[116:119], v[224:227]
    ds_read_b128 v[96:99], v159 offset:12800
    v_mfma_f32_16x16x32_bf16 v[228:231], a[12:15], v[116:119], 0
    ds_read_b128 v[100:103], v159 offset:18944
    buffer_load_dwordx4 v157, s[44:47], s22 offen offset:1024 sc1 lds
    v_lshl_add_u32 v24, v31, 3, v24
    v_add_u32 v253, s7, v24
    v_lshrrev_b32 v24, 3, v2
    v_and_b32 v25, 7, v2
    v_bfe_u32 v31, v2, 4, 2
    v_lshlrev_b32 v31, 1, v31
    v_xor_b32 v25, v25, v31
    v_lshlrev_b32 v24, 12, v24
    v_lshl_add_u32 v24, v25, 4, v24
    s_mul_i32 s7, s72, 36
    s_bitcmp1_b32 s3, 0
    s_addc_u32 s7, s7, 0
    s_lshl_b32 s7, s7, 17
    s_lshl_b32 s8, s71, 7
    s_add_u32 s7, s7, s8
    v_add_u32 v4, s7, v24
    v_add_u32 v5, 31744, v4
    v_add_u32 v6, 31744, v5
    v_add_u32 v7, 31744, v6
    v_lshrrev_b32 v24, 2, v2
    v_lshlrev_b32 v24, 7, v24
    v_and_b32 v25, 3, v2
    v_lshl_add_u32 v24, v25, 3, v24
    s_and_b32 s7, s73, 8192
    v_add_u32 v24, s7, v24
    v_bfe_u32 v31, v2, 3, 2
    s_and_b32 s7, s3, 1
    s_lshl_b32 s7, s7, 1
    v_mfma_f32_16x16x32_bf16 v[228:231], a[4:7], v[112:115], v[228:231]
    ds_read_b64_tr_b16 a[96:97], v154 offset:0
    v_mfma_f32_16x16x32_bf16 v[236:239], a[4:7], v[120:123], 0
    ds_read_b64_tr_b16 a[98:99], v154 offset:1024
    v_mfma_f32_16x16x32_bf16 v[236:239], a[12:15], v[124:127], v[236:239]
    buffer_load_dwordx4 v158, s[44:47], s22 offen offset:2048 sc1 lds
    v_mfma_f32_16x16x32_bf16 v[232:235], a[8:11], v[124:127], 0
    ds_read_b64_tr_b16 a[100:101], v155 offset:0
    v_mfma_f32_16x16x32_bf16 v[232:235], a[0:3], v[120:123], v[232:235]
    ds_read_b64_tr_b16 a[102:103], v155 offset:1024
    s_waitcnt lgkmcnt(4)
    v_mfma_f32_16x16x32_bf16 v[192:195], a[16:19], v[80:83], v[192:195]
    s_add_u32 m0, s74, 61440
    v_mfma_f32_16x16x32_bf16 v[192:195], a[24:27], v[84:87], v[192:195]
    ds_read_b128 v[104:107], v159 offset:13056
    v_mfma_f32_16x16x32_bf16 v[196:199], a[28:31], v[84:87], v[196:199]
    ds_read_b128 v[108:111], v159 offset:19200
    v_mfma_f32_16x16x32_bf16 v[196:199], a[20:23], v[80:83], v[196:199]
    ds_read_b128 v[112:115], v159 offset:13312
    buffer_load_dwordx4 v156, s[44:47], s23 offen offset:0 sc1 lds
    v_mfma_f32_16x16x32_bf16 v[204:207], a[20:23], v[88:91], v[204:207]
    ds_read_b128 v[116:119], v159 offset:19456
    v_mfma_f32_16x16x32_bf16 v[204:207], a[28:31], v[92:95], v[204:207]
    ds_read_b128 v[120:123], v159 offset:13568
    v_mfma_f32_16x16x32_bf16 v[200:203], a[24:27], v[92:95], v[200:203]
    ds_read_b128 v[124:127], v159 offset:19712
    buffer_load_dwordx4 v157, s[44:47], s23 offen offset:1024 sc1 lds
    v_xor_b32 v31, s7, v31
    v_lshl_add_u32 v10, v31, 5, v24
    v_xor_b32 v11, 32, v10
    s_mul_i32 s84, s101, 14
    s_lshr_b32 s84, s84, 2
    s_add_u32 s84, s84, 0
    s_add_u32 s85, s84, 1
    s_cmp_eq_u32 s85, 14
    s_cselect_b32 s85, 0, s85
    s_add_u32 s86, s85, 1
    s_cmp_eq_u32 s86, 14
    s_cselect_b32 s86, 0, s86
    s_add_u32 s87, s86, 1
    s_cmp_eq_u32 s87, 14
    s_cselect_b32 s87, 0, s87
    s_add_u32 s88, s87, 1
    s_cmp_eq_u32 s88, 14
    s_cselect_b32 s88, 0, s88
    s_add_u32 s89, s88, 1
    s_cmp_eq_u32 s89, 14
    s_cselect_b32 s89, 0, s89
    s_add_u32 s90, s89, 1
    s_cmp_eq_u32 s90, 14
    s_cselect_b32 s90, 0, s90
    s_add_u32 s91, s90, 1
    s_cmp_eq_u32 s91, 14
    s_cselect_b32 s91, 0, s91
    s_add_u32 s92, s91, 1
    s_cmp_eq_u32 s92, 14
    s_cselect_b32 s92, 0, s92
    s_add_u32 s93, s92, 1
    s_cmp_eq_u32 s93, 14
    s_cselect_b32 s93, 0, s93
    s_add_u32 s94, s93, 1
    s_cmp_eq_u32 s94, 14
    s_cselect_b32 s94, 0, s94
    s_add_u32 s95, s94, 1
    s_cmp_eq_u32 s95, 14
    s_cselect_b32 s95, 0, s95
    s_add_u32 s96, s95, 1
    s_cmp_eq_u32 s96, 14
    s_cselect_b32 s96, 0, s96
    s_add_u32 s97, s96, 1
    s_cmp_eq_u32 s97, 14
    s_cselect_b32 s97, 0, s97
    s_mul_i32 s98, s101, 4
    s_lshr_b32 s98, s98, 2
    s_add_u32 s98, s98, 14
    s_add_u32 s99, s98, 1
    s_cmp_eq_u32 s99, 18
    s_cselect_b32 s99, 14, s99
    s_add_u32 s100, s99, 1
    s_cmp_eq_u32 s100, 18
    s_cselect_b32 s100, 14, s100
    s_add_u32 s101, s100, 1
    s_cmp_eq_u32 s101, 18
    s_cselect_b32 s101, 14, s101
    s_mul_i32 s7, s70, 6
    s_add_u32 s7, s7, 0
    s_mul_i32 s8, s7, 7282
    s_lshr_b32 s8, s8, 16
    s_mul_i32 s5, s8, 9
    v_mfma_f32_16x16x32_bf16 v[200:203], a[16:19], v[88:91], v[200:203]
    ds_read_b64_tr_b16 a[104:105], v154 offset:8192
    v_mfma_f32_16x16x32_bf16 v[208:211], a[16:19], v[96:99], v[208:211]
    ds_read_b64_tr_b16 a[106:107], v154 offset:9216
    v_mfma_f32_16x16x32_bf16 v[208:211], a[24:27], v[100:103], v[208:211]
    buffer_load_dwordx4 v158, s[44:47], s23 offen offset:2048 sc1 lds
    v_mfma_f32_16x16x32_bf16 v[212:215], a[28:31], v[100:103], v[212:215]
    ds_read_b64_tr_b16 a[108:109], v155 offset:8192
    v_mfma_f32_16x16x32_bf16 v[212:215], a[20:23], v[96:99], v[212:215]
    ds_read_b64_tr_b16 a[110:111], v155 offset:9216
    s_waitcnt lgkmcnt(4)
    v_mfma_f32_16x16x32_bf16 v[220:223], a[20:23], v[104:107], v[220:223]
    s_waitcnt vmcnt(9)
    s_barrier
    v_mfma_f32_16x16x32_bf16 v[220:223], a[28:31], v[108:111], v[220:223]
    ds_read_b128 v[80:83], v159 offset:24576
    s_add_u32 m0, s74, 0
    v_mfma_f32_16x16x32_bf16 v[216:219], a[24:27], v[108:111], v[216:219]
    ds_read_b128 v[84:87], v159 offset:30720
    v_mfma_f32_16x16x32_bf16 v[216:219], a[16:19], v[104:107], v[216:219]
    ds_read_b128 v[88:91], v159 offset:24832
    buffer_load_dwordx4 v156, s[44:47], s24 offen offset:0 sc1 lds
    v_mfma_f32_16x16x32_bf16 v[224:227], a[16:19], v[112:115], v[224:227]
    ds_read_b128 v[92:95], v159 offset:30976
    v_mfma_f32_16x16x32_bf16 v[224:227], a[24:27], v[116:119], v[224:227]
    ds_read_b128 v[96:99], v159 offset:25088
    v_mfma_f32_16x16x32_bf16 v[228:231], a[28:31], v[116:119], v[228:231]
    ds_read_b128 v[100:103], v159 offset:31232
    buffer_load_dwordx4 v157, s[44:47], s24 offen offset:1024 sc1 lds
    s_sub_u32 s7, s7, s5
    s_lshl_b32 s7, s7, 2
    s_mov_b32 s4, 0xeca86420
    s_mov_b32 s5, 3
    s_lshr_b64 s[4:5], s[4:5], s7
    s_and_b32 s4, s4, 15
    s_lshl4_add_u32 s4, s8, s4
    v_lshl_add_u32 v240, s4, 8, v245
    s_mul_i32 s7, s70, 6
    s_add_u32 s7, s7, 1
    s_mul_i32 s8, s7, 7282
    s_lshr_b32 s8, s8, 16
    s_mul_i32 s5, s8, 9
    s_sub_u32 s7, s7, s5
    s_lshl_b32 s7, s7, 2
    s_mov_b32 s4, 0xeca86420
    s_mov_b32 s5, 3
    s_lshr_b64 s[4:5], s[4:5], s7
    s_and_b32 s4, s4, 15
    s_lshl4_add_u32 s4, s8, s4
    v_lshl_add_u32 v241, s4, 8, v245
    s_mul_i32 s7, s70, 6
    s_add_u32 s7, s7, 2
    s_mul_i32 s8, s7, 7282
    s_lshr_b32 s8, s8, 16
    s_mul_i32 s5, s8, 9
    v_mfma_f32_16x16x32_bf16 v[228:231], a[20:23], v[112:115], v[228:231]
    ds_read_b64_tr_b16 a[112:113], v152 offset:0
    v_mfma_f32_16x16x32_bf16 v[236:239], a[20:23], v[120:123], v[236:239]
    ds_read_b64_tr_b16 a[114:115], v152 offset:1024
    v_mfma_f32_16x16x32_bf16 v[236:239], a[28:31], v[124:127], v[236:239]
    buffer_load_dwordx4 v158, s[44:47], s24 offen offset:2048 sc1 lds
    v_mfma_f32_16x16x32_bf16 v[232:235], a[24:27], v[124:127], v[232:235]
    ds_read_b64_tr_b16 a[116:117], v153 offset:0
    v_mfma_f32_16x16x32_bf16 v[232:235], a[16:19], v[120:123], v[232:235]
    ds_read_b64_tr_b16 a[118:119], v153 offset:1024
    s_waitcnt lgkmcnt(4)
    v_mfma_f32_16x16x32_bf16 v[192:195], a[32:35], v[80:83], v[192:195]
    s_add_u32 m0, s74, 12288
    v_mfma_f32_16x16x32_bf16 v[192:195], a[40:43], v[84:87], v[192:195]
    ds_read_b128 v[104:107], v159 offset:25344
    v_mfma_f32_16x16x32_bf16 v[196:199], a[44:47], v[84:87], v[196:199]
    ds_read_b128 v[108:111], v159 offset:31488
    v_mfma_f32_16x16x32_bf16 v[196:199], a[36:39], v[80:83], v[196:199]
    ds_read_b128 v[112:115], v159 offset:25600
    buffer_load_dwordx4 v156, s[44:47], s25 offen offset:0 sc1 lds
    v_mfma_f32_16x16x32_bf16 v[204:207], a[36:39], v[88:91], v[204:207]
    ds_read_b128 v[116:119], v159 offset:31744
    v_mfma_f32_16x16x32_bf16 v[204:207], a[44:47], v[92:95], v[204:207]
    ds_read_b128 v[120:123], v159 offset:25856
    v_mfma_f32_16x16x32_bf16 v[200:203], a[40:43], v[92:95], v[200:203]
    ds_read_b128 v[124:127], v159 offset:32000
    buffer_load_dwordx4 v157, s[44:47], s25 offen offset:1024 sc1 lds
    s_sub_u32 s7, s7, s5
    s_lshl_b32 s7, s7, 2
    s_mov_b32 s4, 0xeca86420
    s_mov_b32 s5, 3
    s_lshr_b64 s[4:5], s[4:5], s7
    s_and_b32 s4, s4, 15
    s_lshl4_add_u32 s4, s8, s4
    v_lshl_add_u32 v242, s4, 8, v245
    s_mul_i32 s7, s70, 6
    s_add_u32 s7, s7, 3
    s_mul_i32 s8, s7, 7282
    s_lshr_b32 s8, s8, 16
    s_mul_i32 s5, s8, 9
    s_sub_u32 s7, s7, s5
    s_lshl_b32 s7, s7, 2
    s_mov_b32 s4, 0xeca86420
    s_mov_b32 s5, 3
    s_lshr_b64 s[4:5], s[4:5], s7
    s_and_b32 s4, s4, 15
    s_lshl4_add_u32 s4, s8, s4
    v_lshl_add_u32 v243, s4, 8, v245
    s_mul_i32 s7, s70, 6
    s_add_u32 s7, s7, 4
    s_mul_i32 s8, s7, 7282
    s_lshr_b32 s8, s8, 16
    s_mul_i32 s5, s8, 9
    s_sub_u32 s7, s7, s5
    v_mfma_f32_16x16x32_bf16 v[200:203], a[32:35], v[88:91], v[200:203]
    ds_read_b64_tr_b16 a[120:121], v152 offset:8192
    v_mfma_f32_16x16x32_bf16 v[208:211], a[32:35], v[96:99], v[208:211]
    ds_read_b64_tr_b16 a[122:123], v152 offset:9216
    v_mfma_f32_16x16x32_bf16 v[208:211], a[40:43], v[100:103], v[208:211]
    buffer_load_dwordx4 v158, s[44:47], s25 offen offset:2048 sc1 lds
    v_mfma_f32_16x16x32_bf16 v[212:215], a[44:47], v[100:103], v[212:215]
    ds_read_b64_tr_b16 a[124:125], v153 offset:8192
    v_mfma_f32_16x16x32_bf16 v[212:215], a[36:39], v[96:99], v[212:215]
    ds_read_b64_tr_b16 a[126:127], v153 offset:9216
    s_waitcnt lgkmcnt(4)
    v_mfma_f32_16x16x32_bf16 v[220:223], a[36:39], v[104:107], v[220:223]
    s_waitcnt vmcnt(12)
    s_barrier
    v_mfma_f32_16x16x32_bf16 v[220:223], a[44:47], v[108:111], v[220:223]
    ds_read_b128 v[80:83], v250 offset:0
    s_add_u32 m0, s74, 24576
    v_mfma_f32_16x16x32_bf16 v[216:219], a[40:43], v[108:111], v[216:219]
    ds_read_b128 v[84:87], v250 offset:6144
    v_mfma_f32_16x16x32_bf16 v[216:219], a[32:35], v[104:107], v[216:219]
    ds_read_b128 v[88:91], v250 offset:256
    buffer_load_dwordx4 v156, s[44:47], s26 offen offset:0 sc1 lds
    v_mfma_f32_16x16x32_bf16 v[224:227], a[32:35], v[112:115], v[224:227]
    ds_read_b128 v[92:95], v250 offset:6400
    v_mfma_f32_16x16x32_bf16 v[224:227], a[40:43], v[116:119], v[224:227]
    ds_read_b128 v[96:99], v250 offset:512
    v_mfma_f32_16x16x32_bf16 v[228:231], a[44:47], v[116:119], v[228:231]
    ds_read_b128 v[100:103], v250 offset:6656
    buffer_load_dwordx4 v157, s[44:47], s26 offen offset:1024 sc1 lds
    s_lshl_b32 s7, s7, 2
    s_mov_b32 s4, 0xeca86420
    s_mov_b32 s5, 3
    s_lshr_b64 s[4:5], s[4:5], s7
    s_and_b32 s4, s4, 15
    s_lshl4_add_u32 s4, s8, s4
    v_lshl_add_u32 v244, s4, 8, v245
    s_mul_i32 s7, s70, 6
    s_add_u32 s7, s7, 5
    s_mul_i32 s8, s7, 7282
    s_lshr_b32 s8, s8, 16
    s_mul_i32 s5, s8, 9
    s_sub_u32 s7, s7, s5
    s_lshl_b32 s7, s7, 2
    s_mov_b32 s4, 0xeca86420
    s_mov_b32 s5, 3
    s_lshr_b64 s[4:5], s[4:5], s7
    s_and_b32 s4, s4, 15
    s_lshl4_add_u32 s4, s8, s4
    v_lshl_add_u32 v245, s4, 8, v245
    s_xor_b32 s7, s75, 1
    s_lshl2_add_u32 s7, s7, s3
    s_mul_i32 s9, s7, 6144
    s_add_u32 s9, s9, 28065792
    s_lshl_b32 s7, s7, 7
    s_add_u32 s6, s7, 33374208
    s_lshl2_add_u32 s7, s75, s3
    s_mul_i32 s10, s7, 6144
    s_add_u32 s10, s10, 28065792
    s_lshl_b32 s7, s7, 7
    s_add_u32 s7, s7, 33374208
    v_mov_b32 v28, s7
    v_mfma_f32_16x16x32_bf16 v[228:231], a[36:39], v[112:115], v[228:231]
    ds_read_b64_tr_b16 a[128:129], v152 offset:16384
    v_mfma_f32_16x16x32_bf16 v[236:239], a[36:39], v[120:123], v[236:239]
    ds_read_b64_tr_b16 a[130:131], v152 offset:17408
    v_mfma_f32_16x16x32_bf16 v[236:239], a[44:47], v[124:127], v[236:239]
    buffer_load_dwordx4 v158, s[44:47], s26 offen offset:2048 sc1 lds
    v_mfma_f32_16x16x32_bf16 v[232:235], a[40:43], v[124:127], v[232:235]
    ds_read_b64_tr_b16 a[132:133], v153 offset:16384
    v_mfma_f32_16x16x32_bf16 v[232:235], a[32:35], v[120:123], v[232:235]
    ds_read_b64_tr_b16 a[134:135], v153 offset:17408
    s_waitcnt lgkmcnt(4)
    v_mfma_f32_16x16x32_bf16 v[192:195], a[48:51], v[80:83], v[192:195]
    s_add_u32 m0, s73, 49152
    s_lshl_b32 s14, s76, 3
    v_mfma_f32_16x16x32_bf16 v[192:195], a[56:59], v[84:87], v[192:195]
    ds_read_b128 v[104:107], v250 offset:768
    v_mfma_f32_16x16x32_bf16 v[196:199], a[60:63], v[84:87], v[196:199]
    ds_read_b128 v[108:111], v250 offset:6912
    buffer_load_dwordx4 v148, s[48:51], s14 offen offset:0 lds
    v_mfma_f32_16x16x32_bf16 v[196:199], a[52:55], v[80:83], v[196:199]
    ds_read_b128 v[112:115], v250 offset:1024
    v_mfma_f32_16x16x32_bf16 v[204:207], a[52:55], v[88:91], v[204:207]
    ds_read_b128 v[116:119], v250 offset:7168
    buffer_load_dwordx4 v149, s[48:51], s14 offen offset:1024 lds
    v_mfma_f32_16x16x32_bf16 v[204:207], a[60:63], v[92:95], v[204:207]
    ds_read_b128 v[120:123], v250 offset:1280
    v_mfma_f32_16x16x32_bf16 v[200:203], a[56:59], v[92:95], v[200:203]
    ds_read_b128 v[124:127], v250 offset:7424
    v_add_u32 v247, 3072, v246
    v_cmp_eq_u32 vcc, 0, v2
    v_mov_b32 v248, 0x40000000
    s_nop 0
    v_cndmask_b32 v248, v248, 0, vcc
    v_mov_b32 v249, s68
    v_add_u32 v28, v28, v248
    v_cndmask_b32 v12, 0, v249, vcc
    v_and_b32 v129, 0xffff0000, v144
    v_lshlrev_b32 v128, 16, v144
    v_and_b32 v131, 0xffff0000, v145
    v_lshlrev_b32 v130, 16, v145
    v_and_b32 v133, 0xffff0000, v146
    v_lshlrev_b32 v132, 16, v146
    v_and_b32 v135, 0xffff0000, v147
    v_lshlrev_b32 v134, 16, v147
    s_mul_i32 s4, s70, 43691
    s_lshr_b32 s4, s4, 16
    s_mul_i32 s5, s70, 21846
    s_lshr_b32 s5, s5, 16
    s_mul_i32 s5, s5, 3
    s_sub_u32 s5, s70, s5
    s_lshl2_add_u32 s4, s72, s4
    s_lshl_b32 s4, s4, 9
    s_mul_i32 s7, s72, 9
    s_sub_u32 s7, s69, s7
    v_mfma_f32_16x16x32_bf16 v[200:203], a[48:51], v[88:91], v[200:203]
    ds_read_b64_tr_b16 a[136:137], v152 offset:24576
    buffer_load_dwordx4 v150, s[48:51], s14 offen offset:2048 lds
    v_mfma_f32_16x16x32_bf16 v[208:211], a[48:51], v[96:99], v[208:211]
    ds_read_b64_tr_b16 a[138:139], v152 offset:25600
    v_mfma_f32_16x16x32_bf16 v[208:211], a[56:59], v[100:103], v[208:211]
    buffer_load_dwordx4 v151, s[48:51], s14 offen offset:3072 lds
    v_mfma_f32_16x16x32_bf16 v[212:215], a[60:63], v[100:103], v[212:215]
    ds_read_b64_tr_b16 a[140:141], v153 offset:24576
    v_mfma_f32_16x16x32_bf16 v[212:215], a[52:55], v[96:99], v[212:215]
    ds_read_b64_tr_b16 a[142:143], v153 offset:25600
    s_waitcnt lgkmcnt(4)
    v_mfma_f32_16x16x32_bf16 v[220:223], a[52:55], v[104:107], v[220:223]
    s_waitcnt vmcnt(16)
    s_barrier
    v_mfma_f32_16x16x32_bf16 v[220:223], a[60:63], v[108:111], v[220:223]
    ds_read_b128 v[80:83], v250 offset:12288
    s_add_u32 m0, s74, 36864
    v_mfma_f32_16x16x32_bf16 v[216:219], a[56:59], v[108:111], v[216:219]
    ds_read_b128 v[84:87], v250 offset:18432
    v_mfma_f32_16x16x32_bf16 v[216:219], a[48:51], v[104:107], v[216:219]
    ds_read_b128 v[88:91], v250 offset:12544
    buffer_load_dwordx4 v156, s[44:47], s27 offen offset:0 sc1 lds
    v_mfma_f32_16x16x32_bf16 v[224:227], a[48:51], v[112:115], v[224:227]
    ds_read_b128 v[92:95], v250 offset:18688
    v_mfma_f32_16x16x32_bf16 v[224:227], a[56:59], v[116:119], v[224:227]
    ds_read_b128 v[96:99], v250 offset:12800
    v_mfma_f32_16x16x32_bf16 v[228:231], a[60:63], v[116:119], v[228:231]
    ds_read_b128 v[100:103], v250 offset:18944
    buffer_load_dwordx4 v157, s[44:47], s27 offen offset:1024 sc1 lds
    s_lshl3_add_u32 s4, s7, s4
    s_add_u32 s4, s4, 12566528
    s_cmp_eq_u32 s5, 1
    s_cselect_b32 s7, 8, 4
    s_cmp_lg_u32 s5, 0
    s_cselect_b32 s5, 4, 0
    v_lshlrev_b32 v17, 7, v0
    v_add_u32 v17, s4, v17
    v_cmp_gt_u32 vcc, 4, v0
    v_mov_b32 v24, s5
    s_nop 0
    v_cndmask_b32 v24, 0, v24, vcc
    v_add_u32 v17, v17, v24
    v_cmp_gt_u32 vcc, s7, v0
    v_mov_b32 v24, 0x40000000
    s_nop 0
    v_cndmask_b32 v17, v24, v17, vcc
    s_bfe_u32 s4, s2, 0x20003
    s_lshl2_add_u32 s4, s72, s4
    s_lshl_b32 s4, s4, 2
    s_lshr_b32 s5, s2, 4
    s_and_b32 s5, s5, 2
    s_add_u32 s4, s4, s5
    s_and_b32 s5, s2, 1
    s_add_u32 s4, s4, s5
    s_lshl_b32 s4, s4, 7
    s_add_u32 s4, s4, 12566528
    v_lshl_add_u32 v15, v2, 2, s4
    s_cmp_eq_u32 s3, 0
    s_cselect_b32 s4, 18, 0
    v_cmp_gt_u32 vcc, s4, v2
    v_mov_b32 v13, 0x40000000
    v_mfma_f32_16x16x32_bf16 v[228:231], a[52:55], v[112:115], v[228:231]
    ds_read_b64_tr_b16 a[144:145], v152 offset:32768
    v_mfma_f32_16x16x32_bf16 v[236:239], a[52:55], v[120:123], v[236:239]
    ds_read_b64_tr_b16 a[146:147], v152 offset:33792
    v_mfma_f32_16x16x32_bf16 v[236:239], a[60:63], v[124:127], v[236:239]
    buffer_load_dwordx4 v158, s[44:47], s27 offen offset:2048 sc1 lds
    v_mfma_f32_16x16x32_bf16 v[232:235], a[56:59], v[124:127], v[232:235]
    ds_read_b64_tr_b16 a[148:149], v153 offset:32768
    v_mfma_f32_16x16x32_bf16 v[232:235], a[48:51], v[120:123], v[232:235]
    ds_read_b64_tr_b16 a[150:151], v153 offset:33792
    s_waitcnt lgkmcnt(4)
    v_mfma_f32_16x16x32_bf16 v[192:195], a[64:67], v[80:83], v[192:195]
    s_add_u32 m0, s73, 65536
    s_lshl_b32 s14, s77, 3
    v_mfma_f32_16x16x32_bf16 v[192:195], a[72:75], v[84:87], v[192:195]
    ds_read_b128 v[104:107], v250 offset:13056
    v_mfma_f32_16x16x32_bf16 v[196:199], a[76:79], v[84:87], v[196:199]
    ds_read_b128 v[108:111], v250 offset:19200
    buffer_load_dwordx4 v148, s[48:51], s14 offen offset:0 lds
    v_mfma_f32_16x16x32_bf16 v[196:199], a[68:71], v[80:83], v[196:199]
    ds_read_b128 v[112:115], v250 offset:13312
    v_mfma_f32_16x16x32_bf16 v[204:207], a[68:71], v[88:91], v[204:207]
    ds_read_b128 v[116:119], v250 offset:19456
    buffer_load_dwordx4 v149, s[48:51], s14 offen offset:1024 lds
    v_mfma_f32_16x16x32_bf16 v[204:207], a[76:79], v[92:95], v[204:207]
    ds_read_b128 v[120:123], v250 offset:13568
    v_mfma_f32_16x16x32_bf16 v[200:203], a[72:75], v[92:95], v[200:203]
    ds_read_b128 v[124:127], v250 offset:19712
    v_cndmask_b32 v15, v13, v15, vcc
    v_mov_b32 v13, s68
    v_cndmask_b32 v13, 0, v13, vcc
    v_and_b32 v24, 15, v2
    v_lshrrev_b32 v25, 4, v2
    v_mul_u32_u24 v25, 17408, v25
    v_lshl_add_u32 v24, v24, 4, v25
    s_mul_i32 s7, s72, 36
    s_and_b32 s8, s3, 1
    s_add_u32 s7, s7, s8
    s_mul_i32 s7, s7, 69632
    s_bfe_u32 s8, s2, 0x20003
    s_lshl_b32 s8, s8, 12
    s_add_u32 s7, s7, s8
    s_add_u32 s7, s7, 12795904
    v_add_u32 v23, s7, v24
    s_xor_b32 s7, s72, 0
    v_lshl_add_u32 v19, s7, 10, v23
    s_xor_b32 s7, s72, 1
    v_lshl_add_u32 v20, s7, 10, v23
    s_xor_b32 s7, s72, 2
    v_lshl_add_u32 v21, s7, 10, v23
    s_xor_b32 s7, s72, 3
    v_lshl_add_u32 v22, s7, 10, v23
    v_lshlrev_b32 v14, 4, v2
    v_add_u32 v14, 98304, v14
    v_mfma_f32_16x16x32_bf16 v[200:203], a[64:67], v[88:91], v[200:203]
    ds_read_b64_tr_b16 a[152:153], v152 offset:40960
    buffer_load_dwordx4 v150, s[48:51], s14 offen offset:2048 lds
    v_mfma_f32_16x16x32_bf16 v[208:211], a[64:67], v[96:99], v[208:211]
    ds_read_b64_tr_b16 a[154:155], v152 offset:41984
    v_mfma_f32_16x16x32_bf16 v[208:211], a[72:75], v[100:103], v[208:211]
    buffer_load_dwordx4 v151, s[48:51], s14 offen offset:3072 lds
    v_mfma_f32_16x16x32_bf16 v[212:215], a[76:79], v[100:103], v[212:215]
    ds_read_b64_tr_b16 a[156:157], v153 offset:40960
    v_mfma_f32_16x16x32_bf16 v[212:215], a[68:71], v[96:99], v[212:215]
    ds_read_b64_tr_b16 a[158:159], v153 offset:41984
    s_waitcnt lgkmcnt(4)
    v_mfma_f32_16x16x32_bf16 v[220:223], a[68:71], v[104:107], v[220:223]
    s_waitcnt vmcnt(20)
    s_barrier
    v_mfma_f32_16x16x32_bf16 v[220:223], a[76:79], v[108:111], v[220:223]
    ds_read_b128 v[80:83], v250 offset:24576
    s_add_u32 m0, s74, 49152
    v_mfma_f32_16x16x32_bf16 v[216:219], a[72:75], v[108:111], v[216:219]
    ds_read_b128 v[84:87], v250 offset:30720
    v_mfma_f32_16x16x32_bf16 v[216:219], a[64:67], v[104:107], v[216:219]
    ds_read_b128 v[88:91], v250 offset:24832
    buffer_load_dwordx4 v156, s[44:47], s76 offen offset:0 sc1 lds
    v_mfma_f32_16x16x32_bf16 v[224:227], a[64:67], v[112:115], v[224:227]
    ds_read_b128 v[92:95], v250 offset:30976
    v_mfma_f32_16x16x32_bf16 v[224:227], a[72:75], v[116:119], v[224:227]
    ds_read_b128 v[96:99], v250 offset:25088
    v_mfma_f32_16x16x32_bf16 v[228:231], a[76:79], v[116:119], v[228:231]
    ds_read_b128 v[100:103], v250 offset:31232
    buffer_load_dwordx4 v157, s[44:47], s76 offen offset:1024 sc1 lds
    v_add_u32 v1, 0x10000, v14
    s_mov_b32 s56, s16
    s_and_b32 s57, s17, 0xffff
    s_mov_b32 s58, 2359296
    s_mov_b32 s59, 0x20000
    s_mov_b32 s40, 18432
    s_mov_b32 s42, 12386304
    s_mov_b32 s64, s38
    s_and_b32 s65, s39, 0xffff
    s_mov_b32 s66, 2359296
    s_mov_b32 s67, 0x20000
    v_lshlrev_b32 v136, 4, v2
    s_mul_i32 s7, s72, 36
    s_bitcmp1_b32 s3, 0
    s_addc_u32 s7, s7, 0
    s_lshl_b32 s7, s7, 17
    v_subrev_u32 v184, s7, v4
    v_subrev_u32 v185, s7, v5
    s_bfe_u32 s4, s2, 0x20003
    s_mul_i32 s4, s4, 9
    s_lshl1_add_u32 s7, s72, s4
    s_and_b32 s8, s3, 1
    s_add_u32 s7, s7, s8
    s_lshl_b32 s37, s7, 16
    s_add_u32 s37, s37, 4718592
    s_add_u32 s4, s4, 8
    s_lshl_b32 s16, s4, 16
    v_mfma_f32_16x16x32_bf16 v[228:231], a[68:71], v[112:115], v[228:231]
    v_mfma_f32_16x16x32_bf16 v[236:239], a[68:71], v[120:123], v[236:239]
    v_mfma_f32_16x16x32_bf16 v[236:239], a[76:79], v[124:127], v[236:239]
    buffer_load_dwordx4 v158, s[44:47], s76 offen offset:2048 sc1 lds
    v_mfma_f32_16x16x32_bf16 v[232:235], a[72:75], v[124:127], v[232:235]
    v_mfma_f32_16x16x32_bf16 v[232:235], a[64:67], v[120:123], v[232:235]
    s_waitcnt lgkmcnt(0)
    v_mfma_f32_16x16x32_bf16 v[192:195], a[80:83], v[80:83], v[192:195]
    s_add_u32 m0, s73, 0
    s_lshl_b32 s14, s78, 3
    v_mfma_f32_16x16x32_bf16 v[192:195], a[88:91], v[84:87], v[192:195]
    ds_read_b128 v[104:107], v250 offset:25344
    v_mfma_f32_16x16x32_bf16 v[196:199], a[92:95], v[84:87], v[196:199]
    ds_read_b128 v[108:111], v250 offset:31488
    buffer_load_dwordx4 v148, s[48:51], s14 offen offset:0 lds
    v_mfma_f32_16x16x32_bf16 v[196:199], a[84:87], v[80:83], v[196:199]
    ds_read_b128 v[112:115], v250 offset:25600
    v_mfma_f32_16x16x32_bf16 v[204:207], a[84:87], v[88:91], v[204:207]
    ds_read_b128 v[116:119], v250 offset:31744
    buffer_load_dwordx4 v149, s[48:51], s14 offen offset:1024 lds
    v_mfma_f32_16x16x32_bf16 v[204:207], a[92:95], v[92:95], v[204:207]
    ds_read_b128 v[120:123], v250 offset:25856
    v_mfma_f32_16x16x32_bf16 v[200:203], a[88:91], v[92:95], v[200:203]
    ds_read_b128 v[124:127], v250 offset:32000
    s_add_u32 s16, s16, 4718592
    s_sub_u32 s4, s4, s7
    s_lshl_b32 s4, s4, 7
    s_lshl_b32 s7, s7, 7
    s_add_u32 s7, s7, 12582912
    v_bfe_u32 v24, v2, 2, 1
    v_mul_u32_u24 v24, s4, v24
    v_and_b32 v25, 3, v2
    v_lshl_add_u32 v24, v25, 2, v24
    v_add_u32 v188, s7, v24
    s_lshl2_add_u32 s7, s2, s3
    s_mul_i32 s8, s7, 3072
    s_add_u32 s34, s8, 40828928
    s_add_u32 s11, s8, 43974656
    s_add_u32 s12, s8, 47120384
L_pl_G_2:
    s_cbranch_execz L_pl_G_6
    s_lshl_b32 s35, s7, 12
    s_add_u32 s35, s35, 50266112
    s_xor_b32 s8, s7, 8
    s_mul_i32 s8, s8, 3072
    s_add_u32 s30, s8, 40828928
    s_xor_b32 s8, s7, 16
    s_mul_i32 s8, s8, 3072
    s_add_u32 s15, s8, 43974656
    s_xor_b32 s8, s7, 24
    s_mul_i32 s8, s8, 3072
    s_add_u32 s31, s8, 47120384
    s_andn2_b32 s7, s7, 24
    v_mfma_f32_16x16x32_bf16 v[200:203], a[80:83], v[88:91], v[200:203]
    buffer_load_dwordx4 v150, s[48:51], s14 offen offset:2048 lds
    v_mfma_f32_16x16x32_bf16 v[208:211], a[80:83], v[96:99], v[208:211]
    v_mfma_f32_16x16x32_bf16 v[208:211], a[88:91], v[100:103], v[208:211]
    buffer_load_dwordx4 v151, s[48:51], s14 offen offset:3072 lds
    v_mfma_f32_16x16x32_bf16 v[212:215], a[92:95], v[100:103], v[212:215]
    v_mfma_f32_16x16x32_bf16 v[212:215], a[84:87], v[96:99], v[212:215]
    s_waitcnt lgkmcnt(0)
    v_mfma_f32_16x16x32_bf16 v[220:223], a[84:87], v[104:107], v[220:223]
    s_waitcnt vmcnt(14)
    s_barrier
    v_mfma_f32_16x16x32_bf16 v[220:223], a[92:95], v[108:111], v[220:223]
    ds_read_b128 v[80:83], v159 offset:0
    s_add_u32 m0, s74, 61440
    v_mfma_f32_16x16x32_bf16 v[216:219], a[88:91], v[108:111], v[216:219]
    ds_read_b128 v[84:87], v159 offset:6144
    v_mfma_f32_16x16x32_bf16 v[216:219], a[80:83], v[104:107], v[216:219]
    ds_read_b128 v[88:91], v159 offset:256
    buffer_load_dwordx4 v156, s[44:47], s77 offen offset:0 sc1 lds
    v_mfma_f32_16x16x32_bf16 v[224:227], a[80:83], v[112:115], v[224:227]
    ds_read_b128 v[92:95], v159 offset:6400
    v_mfma_f32_16x16x32_bf16 v[224:227], a[88:91], v[116:119], v[224:227]
    ds_read_b128 v[96:99], v159 offset:512
    v_mfma_f32_16x16x32_bf16 v[228:231], a[92:95], v[116:119], v[228:231]
    ds_read_b128 v[100:103], v159 offset:6656
    buffer_load_dwordx4 v157, s[44:47], s77 offen offset:1024 sc1 lds
    s_lshl3_add_u32 s7, s3, s7
    s_lshl2_add_u32 s8, s7, s72
    s_lshl_b32 s8, s8, 10
    s_add_u32 s32, s8, 50266112
    s_xor_b32 s8, s8, 4096
    s_add_u32 s33, s8, 50266112
    s_xor_b32 s8, s3, s72
    s_cmp_lt_u32 s8, 2
    s_cselect_b32 s35, s35, 0x40000000
    s_cselect_b32 s16, s16, 0x40000000
    s_cselect_b32 s36, s68, 0
    s_mov_b32 s38, 0xbfb8aa3b
    s_and_b32 s8, s8, 1
    s_mul_i32 s41, s8, 96
    s_and_b32 s43, s73, 4096
    v_lshlrev_b32 v24, 10, v2
    v_add_u32 v24, s35, v24
    s_add_u32 s7, s34, 2048
    v_mov_b32 v25, s36
    v_cmp_gt_u32 vcc, 4, v2
    s_nop 1
    v_cndmask_b32 v138, 0, v25, vcc
    v_mov_b32 v25, 0x40000000
    v_cndmask_b32 v137, v25, v24, vcc
    v_writelane_b32 v137, s7, 4
    v_writelane_b32 v138, s68, 4
    v_min_u32 v139, 1, v2
    v_lshlrev_b32 v139, 30, v139
    v_mov_b32 v140, 0
    v_writelane_b32 v140, s68, 0
    v_mfma_f32_16x16x32_bf16 v[228:231], a[84:87], v[112:115], v[228:231]
    ds_read_b64_tr_b16 a[160:161], v152 offset:49152
    v_mfma_f32_16x16x32_bf16 v[236:239], a[84:87], v[120:123], v[236:239]
    ds_read_b64_tr_b16 a[162:163], v152 offset:50176
    v_mfma_f32_16x16x32_bf16 v[236:239], a[92:95], v[124:127], v[236:239]
    buffer_load_dwordx4 v158, s[44:47], s77 offen offset:2048 sc1 lds
    v_mfma_f32_16x16x32_bf16 v[232:235], a[88:91], v[124:127], v[232:235]
    ds_read_b64_tr_b16 a[164:165], v153 offset:49152
    v_mfma_f32_16x16x32_bf16 v[232:235], a[80:83], v[120:123], v[232:235]
    ds_read_b64_tr_b16 a[166:167], v153 offset:50176
    s_waitcnt lgkmcnt(4)
    v_mfma_f32_16x16x32_bf16 v[192:195], a[96:99], v[80:83], v[192:195]
    s_add_u32 m0, s73, 16384
    s_lshl_b32 s14, s79, 3
    v_mfma_f32_16x16x32_bf16 v[192:195], a[104:107], v[84:87], v[192:195]
    ds_read_b128 v[104:107], v159 offset:768
    v_mfma_f32_16x16x32_bf16 v[196:199], a[108:111], v[84:87], v[196:199]
    ds_read_b128 v[108:111], v159 offset:6912
    buffer_load_dwordx4 v148, s[48:51], s14 offen offset:0 lds
    v_mfma_f32_16x16x32_bf16 v[196:199], a[100:103], v[80:83], v[196:199]
    ds_read_b128 v[112:115], v159 offset:1024
    v_mfma_f32_16x16x32_bf16 v[204:207], a[100:103], v[88:91], v[204:207]
    ds_read_b128 v[116:119], v159 offset:7168
    buffer_load_dwordx4 v149, s[48:51], s14 offen offset:1024 lds
    v_mfma_f32_16x16x32_bf16 v[204:207], a[108:111], v[92:95], v[204:207]
    ds_read_b128 v[120:123], v159 offset:1280
    v_mfma_f32_16x16x32_bf16 v[200:203], a[104:107], v[92:95], v[200:203]
    ds_read_b128 v[124:127], v159 offset:7424
    v_mfma_f32_16x16x32_bf16 v[200:203], a[96:99], v[88:91], v[200:203]
    ds_read_b64_tr_b16 a[168:169], v152 offset:57344
    buffer_load_dwordx4 v150, s[48:51], s14 offen offset:2048 lds
    v_mfma_f32_16x16x32_bf16 v[208:211], a[96:99], v[96:99], v[208:211]
    ds_read_b64_tr_b16 a[170:171], v152 offset:58368
    v_mfma_f32_16x16x32_bf16 v[208:211], a[104:107], v[100:103], v[208:211]
    buffer_load_dwordx4 v151, s[48:51], s14 offen offset:3072 lds
    v_mfma_f32_16x16x32_bf16 v[212:215], a[108:111], v[100:103], v[212:215]
    ds_read_b64_tr_b16 a[172:173], v153 offset:57344
    v_mfma_f32_16x16x32_bf16 v[212:215], a[100:103], v[96:99], v[212:215]
    ds_read_b64_tr_b16 a[174:175], v153 offset:58368
    s_waitcnt lgkmcnt(4)
    v_mfma_f32_16x16x32_bf16 v[220:223], a[100:103], v[104:107], v[220:223]
    s_waitcnt vmcnt(14)
    s_barrier
    v_mfma_f32_16x16x32_bf16 v[220:223], a[108:111], v[108:111], v[220:223]
    ds_read_b128 v[80:83], v159 offset:12288
    s_add_u32 m0, s74, 0
    v_mfma_f32_16x16x32_bf16 v[216:219], a[104:107], v[108:111], v[216:219]
    ds_read_b128 v[84:87], v159 offset:18432
    v_mfma_f32_16x16x32_bf16 v[216:219], a[96:99], v[104:107], v[216:219]
    ds_read_b128 v[88:91], v159 offset:12544
    buffer_load_dwordx4 v156, s[44:47], s78 offen offset:0 sc1 lds
    v_mfma_f32_16x16x32_bf16 v[224:227], a[96:99], v[112:115], v[224:227]
    ds_read_b128 v[92:95], v159 offset:18688
    v_mfma_f32_16x16x32_bf16 v[224:227], a[104:107], v[116:119], v[224:227]
    ds_read_b128 v[96:99], v159 offset:12800
    v_mfma_f32_16x16x32_bf16 v[228:231], a[108:111], v[116:119], v[228:231]
    ds_read_b128 v[100:103], v159 offset:18944
    buffer_load_dwordx4 v157, s[44:47], s78 offen offset:1024 sc1 lds
    v_mfma_f32_16x16x32_bf16 v[228:231], a[100:103], v[112:115], v[228:231]
    ds_read_b64_tr_b16 a[176:177], v154 offset:0
    v_mfma_f32_16x16x32_bf16 v[236:239], a[100:103], v[120:123], v[236:239]
    ds_read_b64_tr_b16 a[178:179], v154 offset:1024
    v_mfma_f32_16x16x32_bf16 v[236:239], a[108:111], v[124:127], v[236:239]
    buffer_load_dwordx4 v158, s[44:47], s78 offen offset:2048 sc1 lds
    v_mfma_f32_16x16x32_bf16 v[232:235], a[104:107], v[124:127], v[232:235]
    ds_read_b64_tr_b16 a[180:181], v155 offset:0
    v_mfma_f32_16x16x32_bf16 v[232:235], a[96:99], v[120:123], v[232:235]
    ds_read_b64_tr_b16 a[182:183], v155 offset:1024
    s_waitcnt lgkmcnt(4)
    v_mfma_f32_16x16x32_bf16 v[192:195], a[112:115], v[80:83], v[192:195]
    s_add_u32 m0, s73, 32768
    s_lshl_b32 s14, s80, 3
    v_mfma_f32_16x16x32_bf16 v[192:195], a[120:123], v[84:87], v[192:195]
    ds_read_b128 v[104:107], v159 offset:13056
    v_mfma_f32_16x16x32_bf16 v[196:199], a[124:127], v[84:87], v[196:199]
    ds_read_b128 v[108:111], v159 offset:19200
    buffer_load_dwordx4 v148, s[48:51], s14 offen offset:0 lds
    v_mfma_f32_16x16x32_bf16 v[196:199], a[116:119], v[80:83], v[196:199]
    ds_read_b128 v[112:115], v159 offset:13312
    v_mfma_f32_16x16x32_bf16 v[204:207], a[116:119], v[88:91], v[204:207]
    ds_read_b128 v[116:119], v159 offset:19456
    buffer_load_dwordx4 v149, s[48:51], s14 offen offset:1024 lds
    v_mfma_f32_16x16x32_bf16 v[204:207], a[124:127], v[92:95], v[204:207]
    ds_read_b128 v[120:123], v159 offset:13568
    v_mfma_f32_16x16x32_bf16 v[200:203], a[120:123], v[92:95], v[200:203]
    ds_read_b128 v[124:127], v159 offset:19712
    v_mfma_f32_16x16x32_bf16 v[200:203], a[112:115], v[88:91], v[200:203]
    ds_read_b64_tr_b16 a[184:185], v154 offset:8192
    buffer_load_dwordx4 v150, s[48:51], s14 offen offset:2048 lds
    v_mfma_f32_16x16x32_bf16 v[208:211], a[112:115], v[96:99], v[208:211]
    ds_read_b64_tr_b16 a[186:187], v154 offset:9216
    v_mfma_f32_16x16x32_bf16 v[208:211], a[120:123], v[100:103], v[208:211]
    buffer_load_dwordx4 v151, s[48:51], s14 offen offset:3072 lds
    v_mfma_f32_16x16x32_bf16 v[212:215], a[124:127], v[100:103], v[212:215]
    ds_read_b64_tr_b16 a[188:189], v155 offset:8192
    v_mfma_f32_16x16x32_bf16 v[212:215], a[116:119], v[96:99], v[212:215]
    ds_read_b64_tr_b16 a[190:191], v155 offset:9216
    s_waitcnt lgkmcnt(4)
    v_mfma_f32_16x16x32_bf16 v[220:223], a[116:119], v[104:107], v[220:223]
    s_waitcnt vmcnt(14)
    s_barrier
    v_mfma_f32_16x16x32_bf16 v[220:223], a[124:127], v[108:111], v[220:223]
    ds_read_b128 v[80:83], v159 offset:24576
    s_add_u32 m0, s74, 12288
    v_mfma_f32_16x16x32_bf16 v[216:219], a[120:123], v[108:111], v[216:219]
    ds_read_b128 v[84:87], v159 offset:30720
    v_mfma_f32_16x16x32_bf16 v[216:219], a[112:115], v[104:107], v[216:219]
    ds_read_b128 v[88:91], v159 offset:24832
    buffer_load_dwordx4 v156, s[44:47], s79 offen offset:0 sc1 lds
    v_mfma_f32_16x16x32_bf16 v[224:227], a[112:115], v[112:115], v[224:227]
    ds_read_b128 v[92:95], v159 offset:30976
    v_mfma_f32_16x16x32_bf16 v[224:227], a[120:123], v[116:119], v[224:227]
    ds_read_b128 v[96:99], v159 offset:25088
    v_mfma_f32_16x16x32_bf16 v[228:231], a[124:127], v[116:119], v[228:231]
    ds_read_b128 v[100:103], v159 offset:31232
    buffer_load_dwordx4 v157, s[44:47], s79 offen offset:1024 sc1 lds
    v_mfma_f32_16x16x32_bf16 v[228:231], a[116:119], v[112:115], v[228:231]
    ds_read_b64_tr_b16 a[192:193], v152 offset:0
    v_mfma_f32_16x16x32_bf16 v[236:239], a[116:119], v[120:123], v[236:239]
    ds_read_b64_tr_b16 a[194:195], v152 offset:1024
    v_mfma_f32_16x16x32_bf16 v[236:239], a[124:127], v[124:127], v[236:239]
    buffer_load_dwordx4 v158, s[44:47], s79 offen offset:2048 sc1 lds
    v_mfma_f32_16x16x32_bf16 v[232:235], a[120:123], v[124:127], v[232:235]
    ds_read_b64_tr_b16 a[196:197], v153 offset:0
    v_mfma_f32_16x16x32_bf16 v[232:235], a[112:115], v[120:123], v[232:235]
    ds_read_b64_tr_b16 a[198:199], v153 offset:1024
    s_waitcnt lgkmcnt(4)
    v_mfma_f32_16x16x32_bf16 v[192:195], a[128:131], v[80:83], v[192:195]
    s_add_u32 m0, s73, 49152
    s_lshl_b32 s14, s81, 3
    v_mfma_f32_16x16x32_bf16 v[192:195], a[136:139], v[84:87], v[192:195]
    ds_read_b128 v[104:107], v159 offset:25344
    v_mfma_f32_16x16x32_bf16 v[196:199], a[140:143], v[84:87], v[196:199]
    ds_read_b128 v[108:111], v159 offset:31488
    buffer_load_dwordx4 v148, s[48:51], s14 offen offset:0 lds
    v_mfma_f32_16x16x32_bf16 v[196:199], a[132:135], v[80:83], v[196:199]
    ds_read_b128 v[112:115], v159 offset:25600
    v_mfma_f32_16x16x32_bf16 v[204:207], a[132:135], v[88:91], v[204:207]
    ds_read_b128 v[116:119], v159 offset:31744
    buffer_load_dwordx4 v149, s[48:51], s14 offen offset:1024 lds
    v_mfma_f32_16x16x32_bf16 v[204:207], a[140:143], v[92:95], v[204:207]
    ds_read_b128 v[120:123], v159 offset:25856
    v_mfma_f32_16x16x32_bf16 v[200:203], a[136:139], v[92:95], v[200:203]
    ds_read_b128 v[124:127], v159 offset:32000
    v_mfma_f32_16x16x32_bf16 v[200:203], a[128:131], v[88:91], v[200:203]
    ds_read_b64_tr_b16 a[200:201], v152 offset:8192
    buffer_load_dwordx4 v150, s[48:51], s14 offen offset:2048 lds
    v_mfma_f32_16x16x32_bf16 v[208:211], a[128:131], v[96:99], v[208:211]
    ds_read_b64_tr_b16 a[202:203], v152 offset:9216
    v_mfma_f32_16x16x32_bf16 v[208:211], a[136:139], v[100:103], v[208:211]
    buffer_load_dwordx4 v151, s[48:51], s14 offen offset:3072 lds
    v_mfma_f32_16x16x32_bf16 v[212:215], a[140:143], v[100:103], v[212:215]
    ds_read_b64_tr_b16 a[204:205], v153 offset:8192
    v_mfma_f32_16x16x32_bf16 v[212:215], a[132:135], v[96:99], v[212:215]
    ds_read_b64_tr_b16 a[206:207], v153 offset:9216
    s_waitcnt lgkmcnt(4)
    v_mfma_f32_16x16x32_bf16 v[220:223], a[132:135], v[104:107], v[220:223]
    s_waitcnt vmcnt(14)
    s_barrier
    v_mfma_f32_16x16x32_bf16 v[220:223], a[140:143], v[108:111], v[220:223]
    ds_read_b128 v[80:83], v250 offset:0
    s_add_u32 m0, s74, 24576
    v_mfma_f32_16x16x32_bf16 v[216:219], a[136:139], v[108:111], v[216:219]
    ds_read_b128 v[84:87], v250 offset:6144
    v_mfma_f32_16x16x32_bf16 v[216:219], a[128:131], v[104:107], v[216:219]
    ds_read_b128 v[88:91], v250 offset:256
    buffer_load_dwordx4 v156, s[44:47], s80 offen offset:0 sc1 lds
    v_mfma_f32_16x16x32_bf16 v[224:227], a[128:131], v[112:115], v[224:227]
    ds_read_b128 v[92:95], v250 offset:6400
    v_mfma_f32_16x16x32_bf16 v[224:227], a[136:139], v[116:119], v[224:227]
    ds_read_b128 v[96:99], v250 offset:512
    v_mfma_f32_16x16x32_bf16 v[228:231], a[140:143], v[116:119], v[228:231]
    ds_read_b128 v[100:103], v250 offset:6656
    buffer_load_dwordx4 v157, s[44:47], s80 offen offset:1024 sc1 lds
    v_mfma_f32_16x16x32_bf16 v[228:231], a[132:135], v[112:115], v[228:231]
    ds_read_b64_tr_b16 a[208:209], v152 offset:16384
    v_mfma_f32_16x16x32_bf16 v[236:239], a[132:135], v[120:123], v[236:239]
    ds_read_b64_tr_b16 a[210:211], v152 offset:17408
    v_mfma_f32_16x16x32_bf16 v[236:239], a[140:143], v[124:127], v[236:239]
    buffer_load_dwordx4 v158, s[44:47], s80 offen offset:2048 sc1 lds
    v_mfma_f32_16x16x32_bf16 v[232:235], a[136:139], v[124:127], v[232:235]
    ds_read_b64_tr_b16 a[212:213], v153 offset:16384
    v_mfma_f32_16x16x32_bf16 v[232:235], a[128:131], v[120:123], v[232:235]
    ds_read_b64_tr_b16 a[214:215], v153 offset:17408
    s_waitcnt lgkmcnt(4)
    v_mfma_f32_16x16x32_bf16 v[192:195], a[144:147], v[80:83], v[192:195]
    s_add_u32 m0, s73, 65536
    s_lshl_b32 s14, s84, 18
    v_mfma_f32_16x16x32_bf16 v[192:195], a[152:155], v[84:87], v[192:195]
    ds_read_b128 v[104:107], v250 offset:768
    v_mfma_f32_16x16x32_bf16 v[196:199], a[156:159], v[84:87], v[196:199]
    ds_read_b128 v[108:111], v250 offset:6912
    buffer_load_dwordx4 v4, s[52:55], s14 offen offset:0 lds
    v_mfma_f32_16x16x32_bf16 v[196:199], a[148:151], v[80:83], v[196:199]
    ds_read_b128 v[112:115], v250 offset:1024
    v_mfma_f32_16x16x32_bf16 v[204:207], a[148:151], v[88:91], v[204:207]
    ds_read_b128 v[116:119], v250 offset:7168
    buffer_load_dwordx4 v5, s[52:55], s14 offen offset:1024 lds
    v_mfma_f32_16x16x32_bf16 v[204:207], a[156:159], v[92:95], v[204:207]
    ds_read_b128 v[120:123], v250 offset:1280
    v_mfma_f32_16x16x32_bf16 v[200:203], a[152:155], v[92:95], v[200:203]
    ds_read_b128 v[124:127], v250 offset:7424
    v_mfma_f32_16x16x32_bf16 v[200:203], a[144:147], v[88:91], v[200:203]
    ds_read_b64_tr_b16 a[216:217], v152 offset:24576
    buffer_load_dwordx4 v6, s[52:55], s14 offen offset:2048 lds
    v_mfma_f32_16x16x32_bf16 v[208:211], a[144:147], v[96:99], v[208:211]
    ds_read_b64_tr_b16 a[218:219], v152 offset:25600
    v_mfma_f32_16x16x32_bf16 v[208:211], a[152:155], v[100:103], v[208:211]
    buffer_load_dwordx4 v7, s[52:55], s14 offen offset:3072 lds
    v_mfma_f32_16x16x32_bf16 v[212:215], a[156:159], v[100:103], v[212:215]
    ds_read_b64_tr_b16 a[220:221], v153 offset:24576
    v_mfma_f32_16x16x32_bf16 v[212:215], a[148:151], v[96:99], v[212:215]
    ds_read_b64_tr_b16 a[222:223], v153 offset:25600
    s_waitcnt lgkmcnt(4)
    v_mfma_f32_16x16x32_bf16 v[220:223], a[148:151], v[104:107], v[220:223]
    s_waitcnt vmcnt(14)
    s_barrier
    v_mfma_f32_16x16x32_bf16 v[220:223], a[156:159], v[108:111], v[220:223]
    ds_read_b128 v[80:83], v250 offset:12288
    v_mfma_f32_16x16x32_bf16 v[216:219], a[152:155], v[108:111], v[216:219]
    ds_read_b128 v[84:87], v250 offset:18432
    v_mfma_f32_16x16x32_bf16 v[216:219], a[144:147], v[104:107], v[216:219]
    ds_read_b128 v[88:91], v250 offset:12544
    v_mfma_f32_16x16x32_bf16 v[224:227], a[144:147], v[112:115], v[224:227]
    ds_read_b128 v[92:95], v250 offset:18688
    v_mfma_f32_16x16x32_bf16 v[224:227], a[152:155], v[116:119], v[224:227]
    ds_read_b128 v[96:99], v250 offset:12800
    v_mfma_f32_16x16x32_bf16 v[228:231], a[156:159], v[116:119], v[228:231]
    ds_read_b128 v[100:103], v250 offset:18944
    v_mfma_f32_16x16x32_bf16 v[228:231], a[148:151], v[112:115], v[228:231]
    ds_read_b64_tr_b16 a[224:225], v152 offset:32768
    v_mfma_f32_16x16x32_bf16 v[236:239], a[148:151], v[120:123], v[236:239]
    ds_read_b64_tr_b16 a[226:227], v152 offset:33792
    v_mfma_f32_16x16x32_bf16 v[236:239], a[156:159], v[124:127], v[236:239]
    v_mfma_f32_16x16x32_bf16 v[232:235], a[152:155], v[124:127], v[232:235]
    ds_read_b64_tr_b16 a[228:229], v153 offset:32768
    v_mfma_f32_16x16x32_bf16 v[232:235], a[144:147], v[120:123], v[232:235]
    ds_read_b64_tr_b16 a[230:231], v153 offset:33792
    s_waitcnt lgkmcnt(4)
    v_mfma_f32_16x16x32_bf16 v[192:195], a[160:163], v[80:83], v[192:195]
    v_mfma_f32_16x16x32_bf16 v[192:195], a[168:171], v[84:87], v[192:195]
    ds_read_b128 v[104:107], v250 offset:13056
    v_mfma_f32_16x16x32_bf16 v[196:199], a[172:175], v[84:87], v[196:199]
    ds_read_b128 v[108:111], v250 offset:19200
    v_mfma_f32_16x16x32_bf16 v[196:199], a[164:167], v[80:83], v[196:199]
    ds_read_b128 v[112:115], v250 offset:13312
    v_mfma_f32_16x16x32_bf16 v[204:207], a[164:167], v[88:91], v[204:207]
    ds_read_b128 v[116:119], v250 offset:19456
    v_mfma_f32_16x16x32_bf16 v[204:207], a[172:175], v[92:95], v[204:207]
    ds_read_b128 v[120:123], v250 offset:13568
    v_mfma_f32_16x16x32_bf16 v[200:203], a[168:171], v[92:95], v[200:203]
    ds_read_b128 v[124:127], v250 offset:19712
    v_mfma_f32_16x16x32_bf16 v[200:203], a[160:163], v[88:91], v[200:203]
    ds_read_b64_tr_b16 a[232:233], v152 offset:40960
    v_mfma_f32_16x16x32_bf16 v[208:211], a[160:163], v[96:99], v[208:211]
    ds_read_b64_tr_b16 a[234:235], v152 offset:41984
    v_mfma_f32_16x16x32_bf16 v[208:211], a[168:171], v[100:103], v[208:211]
    v_mfma_f32_16x16x32_bf16 v[212:215], a[172:175], v[100:103], v[212:215]
    ds_read_b64_tr_b16 a[236:237], v153 offset:40960
    v_mfma_f32_16x16x32_bf16 v[212:215], a[164:167], v[96:99], v[212:215]
    ds_read_b64_tr_b16 a[238:239], v153 offset:41984
    s_waitcnt lgkmcnt(4)
    v_mfma_f32_16x16x32_bf16 v[220:223], a[164:167], v[104:107], v[220:223]
    s_waitcnt vmcnt(7)
    s_barrier
    v_mfma_f32_16x16x32_bf16 v[220:223], a[172:175], v[108:111], v[220:223]
    ds_read_b128 v[80:83], v250 offset:24576
    v_mfma_f32_16x16x32_bf16 v[216:219], a[168:171], v[108:111], v[216:219]
    ds_read_b128 v[84:87], v250 offset:30720
    v_mfma_f32_16x16x32_bf16 v[216:219], a[160:163], v[104:107], v[216:219]
    ds_read_b128 v[88:91], v250 offset:24832
    v_mfma_f32_16x16x32_bf16 v[224:227], a[160:163], v[112:115], v[224:227]
    ds_read_b128 v[92:95], v250 offset:30976
    v_mfma_f32_16x16x32_bf16 v[224:227], a[168:171], v[116:119], v[224:227]
    ds_read_b128 v[96:99], v250 offset:25088
    v_mfma_f32_16x16x32_bf16 v[228:231], a[172:175], v[116:119], v[228:231]
    ds_read_b128 v[100:103], v250 offset:31232
    v_mfma_f32_16x16x32_bf16 v[228:231], a[164:167], v[112:115], v[228:231]
    ds_read_b64_tr_b16 a[240:241], v152 offset:49152
    v_mfma_f32_16x16x32_bf16 v[236:239], a[164:167], v[120:123], v[236:239]
    ds_read_b64_tr_b16 a[242:243], v152 offset:50176
    v_mfma_f32_16x16x32_bf16 v[236:239], a[172:175], v[124:127], v[236:239]
    v_mfma_f32_16x16x32_bf16 v[232:235], a[168:171], v[124:127], v[232:235]
    ds_read_b64_tr_b16 a[244:245], v153 offset:49152
    v_mfma_f32_16x16x32_bf16 v[232:235], a[160:163], v[120:123], v[232:235]
    ds_read_b64_tr_b16 a[246:247], v153 offset:50176
    s_waitcnt lgkmcnt(4)
    v_mfma_f32_16x16x32_bf16 v[192:195], a[176:179], v[80:83], v[192:195]
    v_mfma_f32_16x16x32_bf16 v[192:195], a[184:187], v[84:87], v[192:195]
    ds_read_b128 v[104:107], v250 offset:25344
    v_mfma_f32_16x16x32_bf16 v[196:199], a[188:191], v[84:87], v[196:199]
    ds_read_b128 v[108:111], v250 offset:31488
    v_mfma_f32_16x16x32_bf16 v[196:199], a[180:183], v[80:83], v[196:199]
    ds_read_b128 v[112:115], v250 offset:25600
    v_mfma_f32_16x16x32_bf16 v[204:207], a[180:183], v[88:91], v[204:207]
    ds_read_b128 v[116:119], v250 offset:31744
    v_mfma_f32_16x16x32_bf16 v[204:207], a[188:191], v[92:95], v[204:207]
    ds_read_b128 v[120:123], v250 offset:25856
    v_mfma_f32_16x16x32_bf16 v[200:203], a[184:187], v[92:95], v[200:203]
    ds_read_b128 v[124:127], v250 offset:32000
    v_mfma_f32_16x16x32_bf16 v[200:203], a[176:179], v[88:91], v[200:203]
    ds_read_b64_tr_b16 a[248:249], v152 offset:57344
    v_mfma_f32_16x16x32_bf16 v[208:211], a[176:179], v[96:99], v[208:211]
    ds_read_b64_tr_b16 a[250:251], v152 offset:58368
    v_mfma_f32_16x16x32_bf16 v[208:211], a[184:187], v[100:103], v[208:211]
    v_mfma_f32_16x16x32_bf16 v[212:215], a[188:191], v[100:103], v[212:215]
    ds_read_b64_tr_b16 a[252:253], v153 offset:57344
    v_mfma_f32_16x16x32_bf16 v[212:215], a[180:183], v[96:99], v[212:215]
    ds_read_b64_tr_b16 a[254:255], v153 offset:58368
    s_waitcnt lgkmcnt(4)
    v_mfma_f32_16x16x32_bf16 v[220:223], a[180:183], v[104:107], v[220:223]
    s_barrier
    v_mfma_f32_16x16x32_bf16 v[220:223], a[188:191], v[108:111], v[220:223]
    ds_read_b128 v[80:83], v159 offset:0
    s_add_u32 m0, s74, 36864
    v_mfma_f32_16x16x32_bf16 v[216:219], a[184:187], v[108:111], v[216:219]
    ds_read_b128 v[84:87], v159 offset:6144
    v_mfma_f32_16x16x32_bf16 v[216:219], a[176:179], v[104:107], v[216:219]
    ds_read_b128 v[88:91], v159 offset:256
    buffer_load_dwordx4 v156, s[44:47], s81 offen offset:0 sc1 lds
    v_mfma_f32_16x16x32_bf16 v[224:227], a[176:179], v[112:115], v[224:227]
    ds_read_b128 v[92:95], v159 offset:6400
    v_mfma_f32_16x16x32_bf16 v[224:227], a[184:187], v[116:119], v[224:227]
    ds_read_b128 v[96:99], v159 offset:512
    v_mfma_f32_16x16x32_bf16 v[228:231], a[188:191], v[116:119], v[228:231]
    ds_read_b128 v[100:103], v159 offset:6656
    buffer_load_dwordx4 v157, s[44:47], s81 offen offset:1024 sc1 lds
    v_mfma_f32_16x16x32_bf16 v[228:231], a[180:183], v[112:115], v[228:231]
    v_mfma_f32_16x16x32_bf16 v[236:239], a[180:183], v[120:123], v[236:239]
    v_mfma_f32_16x16x32_bf16 v[236:239], a[188:191], v[124:127], v[236:239]
    buffer_load_dwordx4 v158, s[44:47], s81 offen offset:2048 sc1 lds
    v_mfma_f32_16x16x32_bf16 v[232:235], a[184:187], v[124:127], v[232:235]
    v_mfma_f32_16x16x32_bf16 v[232:235], a[176:179], v[120:123], v[232:235]
    s_waitcnt lgkmcnt(0)
    v_mfma_f32_16x16x32_bf16 v[192:195], a[192:195], v[80:83], v[192:195]
    s_and_b32 s13, s70, 1
    s_mul_i32 s13, s13, 3072
    v_mfma_f32_16x16x32_bf16 v[192:195], a[200:203], v[84:87], v[192:195]
    ds_read_b128 v[104:107], v159 offset:768
    s_sub_u32 s13, s13, 1536
    v_mfma_f32_16x16x32_bf16 v[196:199], a[204:207], v[84:87], v[196:199]
    ds_read_b128 v[108:111], v159 offset:6912
    v_add_u32 v156, s13, v156
    v_mfma_f32_16x16x32_bf16 v[196:199], a[196:199], v[80:83], v[196:199]
    ds_read_b128 v[112:115], v159 offset:1024
    v_mfma_f32_16x16x32_bf16 v[204:207], a[196:199], v[88:91], v[204:207]
    ds_read_b128 v[116:119], v159 offset:7168
    v_add_u32 v157, s13, v157
    v_mfma_f32_16x16x32_bf16 v[204:207], a[204:207], v[92:95], v[204:207]
    ds_read_b128 v[120:123], v159 offset:1280
    v_add_u32 v158, s13, v158
    v_mfma_f32_16x16x32_bf16 v[200:203], a[200:203], v[92:95], v[200:203]
    ds_read_b128 v[124:127], v159 offset:7424
    s_add_u32 m0, s74, 49152
    v_mfma_f32_16x16x32_bf16 v[200:203], a[192:195], v[88:91], v[200:203]
    v_mfma_f32_16x16x32_bf16 v[208:211], a[192:195], v[96:99], v[208:211]
    buffer_load_dwordx4 v156, s[44:47], s18 offen offset:0 sc1 lds
    v_mfma_f32_16x16x32_bf16 v[208:211], a[200:203], v[100:103], v[208:211]
    buffer_load_dwordx4 v157, s[44:47], s18 offen offset:1024 sc1 lds
    v_mfma_f32_16x16x32_bf16 v[212:215], a[204:207], v[100:103], v[212:215]
    buffer_load_dwordx4 v158, s[44:47], s18 offen offset:2048 sc1 lds
    v_mfma_f32_16x16x32_bf16 v[212:215], a[196:199], v[96:99], v[212:215]
    s_waitcnt lgkmcnt(0)
    v_mfma_f32_16x16x32_bf16 v[220:223], a[196:199], v[104:107], v[220:223]
    s_barrier
    v_mfma_f32_16x16x32_bf16 v[220:223], a[204:207], v[108:111], v[220:223]
    ds_read_b128 v[80:83], v159 offset:12288
    s_add_u32 m0, s74, 61440
    v_mfma_f32_16x16x32_bf16 v[216:219], a[200:203], v[108:111], v[216:219]
    ds_read_b128 v[84:87], v159 offset:18432
    v_mfma_f32_16x16x32_bf16 v[216:219], a[192:195], v[104:107], v[216:219]
    ds_read_b128 v[88:91], v159 offset:12544
    buffer_load_dwordx4 v156, s[44:47], s19 offen offset:0 sc1 lds
    v_mfma_f32_16x16x32_bf16 v[224:227], a[192:195], v[112:115], v[224:227]
    ds_read_b128 v[92:95], v159 offset:18688
    v_mfma_f32_16x16x32_bf16 v[224:227], a[200:203], v[116:119], v[224:227]
    ds_read_b128 v[96:99], v159 offset:12800
    v_mfma_f32_16x16x32_bf16 v[228:231], a[204:207], v[116:119], v[228:231]
    ds_read_b128 v[100:103], v159 offset:18944
    buffer_load_dwordx4 v157, s[44:47], s19 offen offset:1024 sc1 lds
    v_mfma_f32_16x16x32_bf16 v[228:231], a[196:199], v[112:115], v[228:231]
    v_mfma_f32_16x16x32_bf16 v[236:239], a[196:199], v[120:123], v[236:239]
    v_mfma_f32_16x16x32_bf16 v[236:239], a[204:207], v[124:127], v[236:239]
    buffer_load_dwordx4 v158, s[44:47], s19 offen offset:2048 sc1 lds
    v_mfma_f32_16x16x32_bf16 v[232:235], a[200:203], v[124:127], v[232:235]
    v_mfma_f32_16x16x32_bf16 v[232:235], a[192:195], v[120:123], v[232:235]
    s_waitcnt lgkmcnt(0)
    v_mfma_f32_16x16x32_bf16 v[192:195], a[208:211], v[80:83], v[192:195]
    s_add_u32 m0, s74, 0
    v_mfma_f32_16x16x32_bf16 v[192:195], a[216:219], v[84:87], v[192:195]
    ds_read_b128 v[104:107], v159 offset:13056
    v_mfma_f32_16x16x32_bf16 v[196:199], a[220:223], v[84:87], v[196:199]
    ds_read_b128 v[108:111], v159 offset:19200
    v_mfma_f32_16x16x32_bf16 v[196:199], a[212:215], v[80:83], v[196:199]
    ds_read_b128 v[112:115], v159 offset:13312
    buffer_load_dwordx4 v156, s[44:47], s20 offen offset:0 sc1 lds
    v_mfma_f32_16x16x32_bf16 v[204:207], a[212:215], v[88:91], v[204:207]
    ds_read_b128 v[116:119], v159 offset:19456
    v_mfma_f32_16x16x32_bf16 v[204:207], a[220:223], v[92:95], v[204:207]
    ds_read_b128 v[120:123], v159 offset:13568
    v_mfma_f32_16x16x32_bf16 v[200:203], a[216:219], v[92:95], v[200:203]
    ds_read_b128 v[124:127], v159 offset:19712
    buffer_load_dwordx4 v157, s[44:47], s20 offen offset:1024 sc1 lds
    v_mfma_f32_16x16x32_bf16 v[200:203], a[208:211], v[88:91], v[200:203]
    v_mfma_f32_16x16x32_bf16 v[208:211], a[208:211], v[96:99], v[208:211]
    v_mfma_f32_16x16x32_bf16 v[208:211], a[216:219], v[100:103], v[208:211]
    buffer_load_dwordx4 v158, s[44:47], s20 offen offset:2048 sc1 lds
    v_mfma_f32_16x16x32_bf16 v[212:215], a[220:223], v[100:103], v[212:215]
    v_mfma_f32_16x16x32_bf16 v[212:215], a[212:215], v[96:99], v[212:215]
    s_waitcnt lgkmcnt(0)
    v_mfma_f32_16x16x32_bf16 v[220:223], a[212:215], v[104:107], v[220:223]
    s_waitcnt vmcnt(16)
    s_barrier
    v_mfma_f32_16x16x32_bf16 v[220:223], a[220:223], v[108:111], v[220:223]
    ds_read_b128 v[80:83], v159 offset:24576
    s_add_u32 m0, s74, 12288
    v_mfma_f32_16x16x32_bf16 v[216:219], a[216:219], v[108:111], v[216:219]
    ds_read_b128 v[84:87], v159 offset:30720
    v_mfma_f32_16x16x32_bf16 v[216:219], a[208:211], v[104:107], v[216:219]
    ds_read_b128 v[88:91], v159 offset:24832
    buffer_load_dwordx4 v156, s[44:47], s21 offen offset:0 sc1 lds
    v_mfma_f32_16x16x32_bf16 v[224:227], a[208:211], v[112:115], v[224:227]
    ds_read_b128 v[92:95], v159 offset:30976
    v_mfma_f32_16x16x32_bf16 v[224:227], a[216:219], v[116:119], v[224:227]
    ds_read_b128 v[96:99], v159 offset:25088
    v_mfma_f32_16x16x32_bf16 v[228:231], a[220:223], v[116:119], v[228:231]
    ds_read_b128 v[100:103], v159 offset:31232
    buffer_load_dwordx4 v157, s[44:47], s21 offen offset:1024 sc1 lds
    v_mfma_f32_16x16x32_bf16 v[228:231], a[212:215], v[112:115], v[228:231]
    v_mfma_f32_16x16x32_bf16 v[236:239], a[212:215], v[120:123], v[236:239]
    v_mfma_f32_16x16x32_bf16 v[236:239], a[220:223], v[124:127], v[236:239]
    buffer_load_dwordx4 v158, s[44:47], s21 offen offset:2048 sc1 lds
    v_mfma_f32_16x16x32_bf16 v[232:235], a[216:219], v[124:127], v[232:235]
    v_mfma_f32_16x16x32_bf16 v[232:235], a[208:211], v[120:123], v[232:235]
    s_waitcnt lgkmcnt(0)
    v_mfma_f32_16x16x32_bf16 v[192:195], a[224:227], v[80:83], v[192:195]
    s_add_u32 m0, s73, 0
    s_lshl_b32 s14, s85, 18
    v_mfma_f32_16x16x32_bf16 v[192:195], a[232:235], v[84:87], v[192:195]
    ds_read_b128 v[104:107], v159 offset:25344
    v_mfma_f32_16x16x32_bf16 v[196:199], a[236:239], v[84:87], v[196:199]
    ds_read_b128 v[108:111], v159 offset:31488
    buffer_load_dwordx4 v4, s[52:55], s14 offen offset:0 lds
    v_mfma_f32_16x16x32_bf16 v[196:199], a[228:231], v[80:83], v[196:199]
    ds_read_b128 v[112:115], v159 offset:25600
    v_mfma_f32_16x16x32_bf16 v[204:207], a[228:231], v[88:91], v[204:207]
    ds_read_b128 v[116:119], v159 offset:31744
    buffer_load_dwordx4 v5, s[52:55], s14 offen offset:1024 lds
    v_mfma_f32_16x16x32_bf16 v[204:207], a[236:239], v[92:95], v[204:207]
    ds_read_b128 v[120:123], v159 offset:25856
    v_mfma_f32_16x16x32_bf16 v[200:203], a[232:235], v[92:95], v[200:203]
    ds_read_b128 v[124:127], v159 offset:32000
    v_mfma_f32_16x16x32_bf16 v[200:203], a[224:227], v[88:91], v[200:203]
    buffer_load_dwordx4 v6, s[52:55], s14 offen offset:2048 lds
    v_mfma_f32_16x16x32_bf16 v[208:211], a[224:227], v[96:99], v[208:211]
    v_mfma_f32_16x16x32_bf16 v[208:211], a[232:235], v[100:103], v[208:211]
    buffer_load_dwordx4 v7, s[52:55], s14 offen offset:3072 lds
    v_mfma_f32_16x16x32_bf16 v[212:215], a[236:239], v[100:103], v[212:215]
    v_mfma_f32_16x16x32_bf16 v[212:215], a[228:231], v[96:99], v[212:215]
    s_waitcnt lgkmcnt(0)
    v_mfma_f32_16x16x32_bf16 v[220:223], a[228:231], v[104:107], v[220:223]
    s_waitcnt vmcnt(16)
    s_barrier
    v_mfma_f32_16x16x32_bf16 v[220:223], a[236:239], v[108:111], v[220:223]
    ds_read_b128 v[80:83], v250 offset:0
    v_mfma_f32_16x16x32_bf16 v[216:219], a[232:235], v[108:111], v[216:219]
    ds_read_b128 v[84:87], v250 offset:6144
    v_mfma_f32_16x16x32_bf16 v[216:219], a[224:227], v[104:107], v[216:219]
    ds_read_b128 v[88:91], v250 offset:256
    v_mfma_f32_16x16x32_bf16 v[224:227], a[224:227], v[112:115], v[224:227]
    ds_read_b128 v[92:95], v250 offset:6400
    v_mfma_f32_16x16x32_bf16 v[224:227], a[232:235], v[116:119], v[224:227]
    ds_read_b128 v[96:99], v250 offset:512
    v_mfma_f32_16x16x32_bf16 v[228:231], a[236:239], v[116:119], v[228:231]
    ds_read_b128 v[100:103], v250 offset:6656
    v_mfma_f32_16x16x32_bf16 v[228:231], a[228:231], v[112:115], v[228:231]
    v_mfma_f32_16x16x32_bf16 v[236:239], a[228:231], v[120:123], v[236:239]
    v_mfma_f32_16x16x32_bf16 v[236:239], a[236:239], v[124:127], v[236:239]
    v_mfma_f32_16x16x32_bf16 v[232:235], a[232:235], v[124:127], v[232:235]
    v_mfma_f32_16x16x32_bf16 v[232:235], a[224:227], v[120:123], v[232:235]
    s_waitcnt lgkmcnt(0)
L_pl_G_3:
    s_cbranch_execz L_wret
    v_mfma_f32_16x16x32_bf16 v[192:195], a[240:243], v[80:83], v[192:195]
    v_mfma_f32_16x16x32_bf16 v[192:195], a[248:251], v[84:87], v[192:195]
    ds_read_b128 v[104:107], v250 offset:768
    v_mfma_f32_16x16x32_bf16 v[196:199], a[252:255], v[84:87], v[196:199]
    ds_read_b128 v[108:111], v250 offset:6912
    v_mfma_f32_16x16x32_bf16 v[196:199], a[244:247], v[80:83], v[196:199]
    ds_read_b128 v[112:115], v250 offset:1024
    v_mfma_f32_16x16x32_bf16 v[204:207], a[244:247], v[88:91], v[204:207]
    ds_read_b128 v[116:119], v250 offset:7168
    v_mfma_f32_16x16x32_bf16 v[204:207], a[252:255], v[92:95], v[204:207]
    ds_read_b128 v[120:123], v250 offset:1280
    v_mfma_f32_16x16x32_bf16 v[200:203], a[248:251], v[92:95], v[200:203]
    ds_read_b128 v[124:127], v250 offset:7424
    v_mfma_f32_16x16x32_bf16 v[200:203], a[240:243], v[88:91], v[200:203]
    v_mfma_f32_16x16x32_bf16 v[208:211], a[240:243], v[96:99], v[208:211]
    v_mfma_f32_16x16x32_bf16 v[208:211], a[248:251], v[100:103], v[208:211]
    v_mfma_f32_16x16x32_bf16 v[212:215], a[252:255], v[100:103], v[212:215]
    v_mfma_f32_16x16x32_bf16 v[212:215], a[244:247], v[96:99], v[212:215]
    s_waitcnt lgkmcnt(0)
    v_mfma_f32_16x16x32_bf16 v[220:223], a[244:247], v[104:107], v[220:223]
    s_waitcnt vmcnt(13)
    s_barrier
    v_mfma_f32_16x16x32_bf16 v[220:223], a[252:255], v[108:111], v[220:223]
    ds_read_b128 v[80:83], v250 offset:12288
    v_mfma_f32_16x16x32_bf16 v[216:219], a[248:251], v[108:111], v[216:219]
    ds_read_b128 v[84:87], v250 offset:18432
    v_mfma_f32_16x16x32_bf16 v[216:219], a[240:243], v[104:107], v[216:219]
    ds_read_b128 v[88:91], v250 offset:12544
    v_mfma_f32_16x16x32_bf16 v[224:227], a[240:243], v[112:115], v[224:227]
    ds_read_b128 v[92:95], v250 offset:18688
    v_cvt_pk_bf16_f32 v192, v192, v193
    v_mfma_f32_16x16x32_bf16 v[224:227], a[248:251], v[116:119], v[224:227]
    ds_read_b128 v[96:99], v250 offset:12800
    v_mfma_f32_16x16x32_bf16 v[228:231], a[252:255], v[116:119], v[228:231]
    ds_read_b128 v[100:103], v250 offset:18944
    v_cvt_pk_bf16_f32 v193, v194, v195
    v_mfma_f32_16x16x32_bf16 v[228:231], a[244:247], v[112:115], v[228:231]
    v_mfma_f32_16x16x32_bf16 v[236:239], a[244:247], v[120:123], v[236:239]
    v_cvt_pk_bf16_f32 v194, v196, v197
    v_mfma_f32_16x16x32_bf16 v[236:239], a[252:255], v[124:127], v[236:239]
    v_cvt_pk_bf16_f32 v195, v198, v199
    v_mfma_f32_16x16x32_bf16 v[232:235], a[248:251], v[124:127], v[232:235]
    v_mfma_f32_16x16x32_bf16 v[232:235], a[240:243], v[120:123], v[232:235]
    buffer_store_dwordx4 v[192:195], v246, s[44:47], s9 offen offset:0 sc1
    s_waitcnt lgkmcnt(0)
    v_mfma_f32_16x16x32_bf16 v[32:35], a[0:3], v[80:83], v[128:131]
    v_mfma_f32_16x16x32_bf16 v[32:35], a[8:11], v[84:87], v[32:35]
    ds_read_b128 v[104:107], v250 offset:13056
    v_cvt_pk_bf16_f32 v200, v200, v201
    v_mfma_f32_16x16x32_bf16 v[36:39], a[12:15], v[84:87], v[132:135]
    ds_read_b128 v[108:111], v250 offset:19200
    v_mfma_f32_16x16x32_bf16 v[36:39], a[4:7], v[80:83], v[36:39]
    ds_read_b128 v[112:115], v250 offset:13312
    v_cvt_pk_bf16_f32 v201, v202, v203
    v_mfma_f32_16x16x32_bf16 v[44:47], a[4:7], v[88:91], v[132:135]
    ds_read_b128 v[116:119], v250 offset:19456
    v_mfma_f32_16x16x32_bf16 v[44:47], a[12:15], v[92:95], v[44:47]
    ds_read_b128 v[120:123], v250 offset:13568
    v_mfma_f32_16x16x32_bf16 v[40:43], a[8:11], v[92:95], v[128:131]
    ds_read_b128 v[124:127], v250 offset:19712
    v_cvt_pk_bf16_f32 v202, v204, v205
    v_mfma_f32_16x16x32_bf16 v[40:43], a[0:3], v[88:91], v[40:43]
    v_mfma_f32_16x16x32_bf16 v[48:51], a[0:3], v[96:99], v[128:131]
    v_cvt_pk_bf16_f32 v203, v206, v207
    v_mfma_f32_16x16x32_bf16 v[48:51], a[8:11], v[100:103], v[48:51]
    v_mfma_f32_16x16x32_bf16 v[52:55], a[12:15], v[100:103], v[132:135]
    buffer_store_dwordx4 v[200:203], v246, s[44:47], s9 offen offset:1024 sc1
    v_mfma_f32_16x16x32_bf16 v[52:55], a[4:7], v[96:99], v[52:55]
    s_waitcnt lgkmcnt(0)
    v_mfma_f32_16x16x32_bf16 v[60:63], a[4:7], v[104:107], v[132:135]
    s_waitcnt vmcnt(12)
    s_barrier
    v_mfma_f32_16x16x32_bf16 v[60:63], a[12:15], v[108:111], v[60:63]
    ds_read_b128 v[80:83], v250 offset:24576
    s_add_u32 m0, s74, 24576
    v_cvt_pk_bf16_f32 v208, v208, v209
    v_mfma_f32_16x16x32_bf16 v[56:59], a[8:11], v[108:111], v[128:131]
    ds_read_b128 v[84:87], v250 offset:30720
    v_mfma_f32_16x16x32_bf16 v[56:59], a[0:3], v[104:107], v[56:59]
    ds_read_b128 v[88:91], v250 offset:24832
    buffer_load_dwordx4 v156, s[44:47], s22 offen offset:0 sc1 lds
    v_mfma_f32_16x16x32_bf16 v[64:67], a[0:3], v[112:115], v[128:131]
    ds_read_b128 v[92:95], v250 offset:30976
    v_cvt_pk_bf16_f32 v209, v210, v211
    v_mfma_f32_16x16x32_bf16 v[64:67], a[8:11], v[116:119], v[64:67]
    ds_read_b128 v[96:99], v250 offset:25088
    v_cvt_pk_bf16_f32 v210, v212, v213
    v_mfma_f32_16x16x32_bf16 v[68:71], a[12:15], v[116:119], v[132:135]
    ds_read_b128 v[100:103], v250 offset:31232
    buffer_load_dwordx4 v157, s[44:47], s22 offen offset:1024 sc1 lds
    v_mfma_f32_16x16x32_bf16 v[68:71], a[4:7], v[112:115], v[68:71]
    v_mfma_f32_16x16x32_bf16 v[76:79], a[4:7], v[120:123], v[132:135]
    v_cvt_pk_bf16_f32 v211, v214, v215
    v_mfma_f32_16x16x32_bf16 v[76:79], a[12:15], v[124:127], v[76:79]
    buffer_load_dwordx4 v158, s[44:47], s22 offen offset:2048 sc1 lds
    v_mfma_f32_16x16x32_bf16 v[72:75], a[8:11], v[124:127], v[128:131]
    buffer_store_dwordx4 v[208:211], v246, s[44:47], s9 offen offset:2048 sc1
    v_mfma_f32_16x16x32_bf16 v[72:75], a[0:3], v[120:123], v[72:75]
    s_waitcnt lgkmcnt(0)
    v_mfma_f32_16x16x32_bf16 v[32:35], a[16:19], v[80:83], v[32:35]
    s_add_u32 m0, s74, 36864
    v_mfma_f32_16x16x32_bf16 v[32:35], a[24:27], v[84:87], v[32:35]
    ds_read_b128 v[104:107], v250 offset:25344
    v_cvt_pk_bf16_f32 v216, v216, v217
    v_mfma_f32_16x16x32_bf16 v[36:39], a[28:31], v[84:87], v[36:39]
    ds_read_b128 v[108:111], v250 offset:31488
    v_mfma_f32_16x16x32_bf16 v[36:39], a[20:23], v[80:83], v[36:39]
    ds_read_b128 v[112:115], v250 offset:25600
    buffer_load_dwordx4 v156, s[44:47], s23 offen offset:0 sc1 lds
    v_mfma_f32_16x16x32_bf16 v[44:47], a[20:23], v[88:91], v[44:47]
    ds_read_b128 v[116:119], v250 offset:31744
    v_cvt_pk_bf16_f32 v217, v218, v219
    v_mfma_f32_16x16x32_bf16 v[44:47], a[28:31], v[92:95], v[44:47]
    ds_read_b128 v[120:123], v250 offset:25856
    v_cvt_pk_bf16_f32 v218, v220, v221
    v_mfma_f32_16x16x32_bf16 v[40:43], a[24:27], v[92:95], v[40:43]
    ds_read_b128 v[124:127], v250 offset:32000
    buffer_load_dwordx4 v157, s[44:47], s23 offen offset:1024 sc1 lds
    v_mfma_f32_16x16x32_bf16 v[40:43], a[16:19], v[88:91], v[40:43]
    v_mfma_f32_16x16x32_bf16 v[48:51], a[16:19], v[96:99], v[48:51]
    v_cvt_pk_bf16_f32 v219, v222, v223
    v_mfma_f32_16x16x32_bf16 v[48:51], a[24:27], v[100:103], v[48:51]
    buffer_load_dwordx4 v158, s[44:47], s23 offen offset:2048 sc1 lds
    v_mfma_f32_16x16x32_bf16 v[52:55], a[28:31], v[100:103], v[52:55]
    buffer_store_dwordx4 v[216:219], v247, s[44:47], s9 offen offset:0 sc1
    v_mfma_f32_16x16x32_bf16 v[52:55], a[20:23], v[96:99], v[52:55]
    s_waitcnt lgkmcnt(0)
    v_mfma_f32_16x16x32_bf16 v[60:63], a[20:23], v[104:107], v[60:63]
    s_waitcnt vmcnt(17)
    s_barrier
    v_mfma_f32_16x16x32_bf16 v[60:63], a[28:31], v[108:111], v[60:63]
    ds_read_b128 v[80:83], v159 offset:0
    s_add_u32 m0, s74, 49152
    v_cvt_pk_bf16_f32 v224, v224, v225
    v_mfma_f32_16x16x32_bf16 v[56:59], a[24:27], v[108:111], v[56:59]
    ds_read_b128 v[84:87], v159 offset:6144
    v_mfma_f32_16x16x32_bf16 v[56:59], a[16:19], v[104:107], v[56:59]
    ds_read_b128 v[88:91], v159 offset:256
    buffer_load_dwordx4 v156, s[44:47], s24 offen offset:0 sc1 lds
    v_mfma_f32_16x16x32_bf16 v[64:67], a[16:19], v[112:115], v[64:67]
    ds_read_b128 v[92:95], v159 offset:6400
    v_cvt_pk_bf16_f32 v225, v226, v227
    v_mfma_f32_16x16x32_bf16 v[64:67], a[24:27], v[116:119], v[64:67]
    ds_read_b128 v[96:99], v159 offset:512
    v_cvt_pk_bf16_f32 v226, v228, v229
    v_mfma_f32_16x16x32_bf16 v[68:71], a[28:31], v[116:119], v[68:71]
    ds_read_b128 v[100:103], v159 offset:6656
    buffer_load_dwordx4 v157, s[44:47], s24 offen offset:1024 sc1 lds
    v_mfma_f32_16x16x32_bf16 v[68:71], a[20:23], v[112:115], v[68:71]
    v_add_u32 v10, 65536, v10
    v_mfma_f32_16x16x32_bf16 v[76:79], a[20:23], v[120:123], v[76:79]
    ds_read_b64_tr_b16 a[0:1], v10 offset:0
    v_cvt_pk_bf16_f32 v227, v230, v231
    v_mfma_f32_16x16x32_bf16 v[76:79], a[28:31], v[124:127], v[76:79]
    ds_read_b64_tr_b16 a[2:3], v10 offset:2048
    buffer_load_dwordx4 v158, s[44:47], s24 offen offset:2048 sc1 lds
    v_mfma_f32_16x16x32_bf16 v[72:75], a[24:27], v[124:127], v[72:75]
    buffer_store_dwordx4 v[224:227], v247, s[44:47], s9 offen offset:1024 sc1
    ds_read_b64_tr_b16 a[8:9], v10 offset:4096
    v_mfma_f32_16x16x32_bf16 v[72:75], a[16:19], v[120:123], v[72:75]
    ds_read_b64_tr_b16 a[10:11], v10 offset:6144
    s_waitcnt lgkmcnt(4)
    v_mfma_f32_16x16x32_bf16 v[32:35], a[32:35], v[80:83], v[32:35]
    s_add_u32 m0, s74, 61440
    v_mfma_f32_16x16x32_bf16 v[32:35], a[40:43], v[84:87], v[32:35]
    ds_read_b128 v[104:107], v159 offset:768
    v_cvt_pk_bf16_f32 v232, v232, v233
    v_mfma_f32_16x16x32_bf16 v[36:39], a[44:47], v[84:87], v[36:39]
    ds_read_b128 v[108:111], v159 offset:6912
    v_mfma_f32_16x16x32_bf16 v[36:39], a[36:39], v[80:83], v[36:39]
    ds_read_b128 v[112:115], v159 offset:1024
    buffer_load_dwordx4 v156, s[44:47], s25 offen offset:0 sc1 lds
    v_mfma_f32_16x16x32_bf16 v[44:47], a[36:39], v[88:91], v[44:47]
    ds_read_b128 v[116:119], v159 offset:7168
    v_cvt_pk_bf16_f32 v233, v234, v235
    v_mfma_f32_16x16x32_bf16 v[44:47], a[44:47], v[92:95], v[44:47]
    ds_read_b128 v[120:123], v159 offset:1280
    v_cvt_pk_bf16_f32 v234, v236, v237
    v_mfma_f32_16x16x32_bf16 v[40:43], a[40:43], v[92:95], v[40:43]
    ds_read_b128 v[124:127], v159 offset:7424
    buffer_load_dwordx4 v157, s[44:47], s25 offen offset:1024 sc1 lds
    v_mfma_f32_16x16x32_bf16 v[40:43], a[32:35], v[88:91], v[40:43]
    v_add_u32 v11, 65536, v11
    v_mfma_f32_16x16x32_bf16 v[48:51], a[32:35], v[96:99], v[48:51]
    ds_read_b64_tr_b16 a[4:5], v11 offset:0
    v_cvt_pk_bf16_f32 v235, v238, v239
    v_mfma_f32_16x16x32_bf16 v[48:51], a[40:43], v[100:103], v[48:51]
    ds_read_b64_tr_b16 a[6:7], v11 offset:2048
    buffer_load_dwordx4 v158, s[44:47], s25 offen offset:2048 sc1 lds
    v_mfma_f32_16x16x32_bf16 v[52:55], a[44:47], v[100:103], v[52:55]
    buffer_store_dwordx4 v[232:235], v247, s[44:47], s9 offen offset:2048 sc1
    ds_read_b64_tr_b16 a[12:13], v11 offset:4096
    v_mfma_f32_16x16x32_bf16 v[52:55], a[36:39], v[96:99], v[52:55]
    ds_read_b64_tr_b16 a[14:15], v11 offset:6144
    s_waitcnt lgkmcnt(4)
    v_mfma_f32_16x16x32_bf16 v[60:63], a[36:39], v[104:107], v[60:63]
    s_waitcnt vmcnt(18)
    s_barrier
    v_mfma_f32_16x16x32_bf16 v[60:63], a[44:47], v[108:111], v[60:63]
    ds_read_b128 v[80:83], v159 offset:12288
    s_add_u32 m0, s74, 0
    v_mfma_f32_16x16x32_bf16 v[56:59], a[40:43], v[108:111], v[56:59]
    ds_read_b128 v[84:87], v159 offset:18432
    v_mfma_f32_16x16x32_bf16 v[56:59], a[32:35], v[104:107], v[56:59]
    ds_read_b128 v[88:91], v159 offset:12544
    buffer_load_dwordx4 v156, s[44:47], s26 offen offset:0 sc1 lds
    v_mfma_f32_16x16x32_bf16 v[64:67], a[32:35], v[112:115], v[64:67]
    ds_read_b128 v[92:95], v159 offset:18688
    v_mfma_f32_16x16x32_bf16 v[64:67], a[40:43], v[116:119], v[64:67]
    ds_read_b128 v[96:99], v159 offset:12800
    v_mfma_f32_16x16x32_bf16 v[68:71], a[44:47], v[116:119], v[68:71]
    ds_read_b128 v[100:103], v159 offset:18944
    buffer_load_dwordx4 v157, s[44:47], s26 offen offset:1024 sc1 lds
    v_mfma_f32_16x16x32_bf16 v[68:71], a[36:39], v[112:115], v[68:71]
    v_add_u32 v10, -65536, v10
    v_mfma_f32_16x16x32_bf16 v[76:79], a[36:39], v[120:123], v[76:79]
    ds_read_b64_tr_b16 a[16:17], v10 offset:0
    v_mfma_f32_16x16x32_bf16 v[76:79], a[44:47], v[124:127], v[76:79]
    ds_read_b64_tr_b16 a[18:19], v10 offset:2048
    buffer_load_dwordx4 v158, s[44:47], s26 offen offset:2048 sc1 lds
    v_mfma_f32_16x16x32_bf16 v[72:75], a[40:43], v[124:127], v[72:75]
    ds_read_b64_tr_b16 a[24:25], v10 offset:4096
    v_mfma_f32_16x16x32_bf16 v[72:75], a[32:35], v[120:123], v[72:75]
    ds_read_b64_tr_b16 a[26:27], v10 offset:6144
    s_waitcnt lgkmcnt(4)
    v_mfma_f32_16x16x32_bf16 v[32:35], a[48:51], v[80:83], v[32:35]
    v_mfma_f32_16x16x32_bf16 v[32:35], a[56:59], v[84:87], v[32:35]
    ds_read_b128 v[104:107], v159 offset:13056
    v_mfma_f32_16x16x32_bf16 v[36:39], a[60:63], v[84:87], v[36:39]
    ds_read_b128 v[108:111], v159 offset:19200
    v_mfma_f32_16x16x32_bf16 v[36:39], a[52:55], v[80:83], v[36:39]
    ds_read_b128 v[112:115], v159 offset:13312
    v_mfma_f32_16x16x32_bf16 v[44:47], a[52:55], v[88:91], v[44:47]
    ds_read_b128 v[116:119], v159 offset:19456
    v_mfma_f32_16x16x32_bf16 v[44:47], a[60:63], v[92:95], v[44:47]
    ds_read_b128 v[120:123], v159 offset:13568
    v_mfma_f32_16x16x32_bf16 v[40:43], a[56:59], v[92:95], v[40:43]
    ds_read_b128 v[124:127], v159 offset:19712
    v_mfma_f32_16x16x32_bf16 v[40:43], a[48:51], v[88:91], v[40:43]
    v_add_u32 v11, -65536, v11
    v_mfma_f32_16x16x32_bf16 v[48:51], a[48:51], v[96:99], v[48:51]
    ds_read_b64_tr_b16 a[20:21], v11 offset:0
    v_mfma_f32_16x16x32_bf16 v[48:51], a[56:59], v[100:103], v[48:51]
    ds_read_b64_tr_b16 a[22:23], v11 offset:2048
    v_mfma_f32_16x16x32_bf16 v[52:55], a[60:63], v[100:103], v[52:55]
    ds_read_b64_tr_b16 a[28:29], v11 offset:4096
    v_mfma_f32_16x16x32_bf16 v[52:55], a[52:55], v[96:99], v[52:55]
    ds_read_b64_tr_b16 a[30:31], v11 offset:6144
    s_waitcnt lgkmcnt(4)
    v_mfma_f32_16x16x32_bf16 v[60:63], a[52:55], v[104:107], v[60:63]
    s_waitcnt vmcnt(16)
    s_barrier
    v_mfma_f32_16x16x32_bf16 v[60:63], a[60:63], v[108:111], v[60:63]
    ds_read_b128 v[80:83], v159 offset:24576
    s_add_u32 m0, s74, 12288
    v_mfma_f32_16x16x32_bf16 v[56:59], a[56:59], v[108:111], v[56:59]
    ds_read_b128 v[84:87], v159 offset:30720
    v_mfma_f32_16x16x32_bf16 v[56:59], a[48:51], v[104:107], v[56:59]
    ds_read_b128 v[88:91], v159 offset:24832
    buffer_load_dwordx4 v156, s[44:47], s27 offen offset:0 sc1 lds
    v_mfma_f32_16x16x32_bf16 v[64:67], a[48:51], v[112:115], v[64:67]
    ds_read_b128 v[92:95], v159 offset:30976
    v_mfma_f32_16x16x32_bf16 v[64:67], a[56:59], v[116:119], v[64:67]
    ds_read_b128 v[96:99], v159 offset:25088
    v_mfma_f32_16x16x32_bf16 v[68:71], a[60:63], v[116:119], v[68:71]
    ds_read_b128 v[100:103], v159 offset:31232
    buffer_load_dwordx4 v157, s[44:47], s27 offen offset:1024 sc1 lds
    v_mfma_f32_16x16x32_bf16 v[68:71], a[52:55], v[112:115], v[68:71]
    v_mfma_f32_16x16x32_bf16 v[76:79], a[52:55], v[120:123], v[76:79]
    v_mfma_f32_16x16x32_bf16 v[76:79], a[60:63], v[124:127], v[76:79]
    buffer_load_dwordx4 v158, s[44:47], s27 offen offset:2048 sc1 lds
    v_mfma_f32_16x16x32_bf16 v[72:75], a[56:59], v[124:127], v[72:75]
    v_mfma_f32_16x16x32_bf16 v[72:75], a[48:51], v[120:123], v[72:75]
    s_waitcnt lgkmcnt(0)
    v_mfma_f32_16x16x32_bf16 v[32:35], a[64:67], v[80:83], v[32:35]
    s_add_u32 m0, s73, 16384
    s_lshl_b32 s14, s86, 18
    v_mfma_f32_16x16x32_bf16 v[32:35], a[72:75], v[84:87], v[32:35]
    ds_read_b128 v[104:107], v159 offset:25344
    v_mfma_f32_16x16x32_bf16 v[36:39], a[76:79], v[84:87], v[36:39]
    ds_read_b128 v[108:111], v159 offset:31488
    buffer_load_dwordx4 v4, s[52:55], s14 offen offset:0 lds
    v_mfma_f32_16x16x32_bf16 v[36:39], a[68:71], v[80:83], v[36:39]
    ds_read_b128 v[112:115], v159 offset:25600
    v_mfma_f32_16x16x32_bf16 v[44:47], a[68:71], v[88:91], v[44:47]
    ds_read_b128 v[116:119], v159 offset:31744
    buffer_load_dwordx4 v5, s[52:55], s14 offen offset:1024 lds
    v_mfma_f32_16x16x32_bf16 v[44:47], a[76:79], v[92:95], v[44:47]
    ds_read_b128 v[120:123], v159 offset:25856
    v_mfma_f32_16x16x32_bf16 v[40:43], a[72:75], v[92:95], v[40:43]
    ds_read_b128 v[124:127], v159 offset:32000
    v_mfma_f32_16x16x32_bf16 v[40:43], a[64:67], v[88:91], v[40:43]
    buffer_load_dwordx4 v6, s[52:55], s14 offen offset:2048 lds
    v_mfma_f32_16x16x32_bf16 v[48:51], a[64:67], v[96:99], v[48:51]
    v_mfma_f32_16x16x32_bf16 v[48:51], a[72:75], v[100:103], v[48:51]
    buffer_load_dwordx4 v7, s[52:55], s14 offen offset:3072 lds
    v_mfma_f32_16x16x32_bf16 v[52:55], a[76:79], v[100:103], v[52:55]
    v_mfma_f32_16x16x32_bf16 v[52:55], a[68:71], v[96:99], v[52:55]
    s_waitcnt lgkmcnt(0)
    v_mfma_f32_16x16x32_bf16 v[60:63], a[68:71], v[104:107], v[60:63]
    s_waitcnt vmcnt(19)
    s_barrier
    v_mfma_f32_16x16x32_bf16 v[60:63], a[76:79], v[108:111], v[60:63]
    ds_read_b128 v[80:83], v250 offset:0
    v_mfma_f32_16x16x32_bf16 v[56:59], a[72:75], v[108:111], v[56:59]
    ds_read_b128 v[84:87], v250 offset:6144
    v_mfma_f32_16x16x32_bf16 v[56:59], a[64:67], v[104:107], v[56:59]
    ds_read_b128 v[88:91], v250 offset:256
    v_mfma_f32_16x16x32_bf16 v[64:67], a[64:67], v[112:115], v[64:67]
    ds_read_b128 v[92:95], v250 offset:6400
    v_mfma_f32_16x16x32_bf16 v[64:67], a[72:75], v[116:119], v[64:67]
    ds_read_b128 v[96:99], v250 offset:512
    v_mfma_f32_16x16x32_bf16 v[68:71], a[76:79], v[116:119], v[68:71]
    ds_read_b128 v[100:103], v250 offset:6656
    v_mfma_f32_16x16x32_bf16 v[68:71], a[68:71], v[112:115], v[68:71]
    v_mfma_f32_16x16x32_bf16 v[76:79], a[68:71], v[120:123], v[76:79]
    v_mfma_f32_16x16x32_bf16 v[76:79], a[76:79], v[124:127], v[76:79]
    v_mfma_f32_16x16x32_bf16 v[72:75], a[72:75], v[124:127], v[72:75]
    v_mfma_f32_16x16x32_bf16 v[72:75], a[64:67], v[120:123], v[72:75]
    s_waitcnt lgkmcnt(0)
    v_mfma_f32_16x16x32_bf16 v[32:35], a[80:83], v[80:83], v[32:35]
    v_mfma_f32_16x16x32_bf16 v[32:35], a[88:91], v[84:87], v[32:35]
    ds_read_b128 v[104:107], v250 offset:768
    v_mfma_f32_16x16x32_bf16 v[36:39], a[92:95], v[84:87], v[36:39]
    ds_read_b128 v[108:111], v250 offset:6912
    v_mfma_f32_16x16x32_bf16 v[36:39], a[84:87], v[80:83], v[36:39]
    ds_read_b128 v[112:115], v250 offset:1024
    v_mfma_f32_16x16x32_bf16 v[44:47], a[84:87], v[88:91], v[44:47]
    ds_read_b128 v[116:119], v250 offset:7168
    v_mfma_f32_16x16x32_bf16 v[44:47], a[92:95], v[92:95], v[44:47]
    ds_read_b128 v[120:123], v250 offset:1280
    v_mfma_f32_16x16x32_bf16 v[40:43], a[88:91], v[92:95], v[40:43]
    ds_read_b128 v[124:127], v250 offset:7424
    v_mfma_f32_16x16x32_bf16 v[40:43], a[80:83], v[88:91], v[40:43]
    s_waitcnt vmcnt(10)
    buffer_store_dword v249, v248, s[44:47], s6 offen sc1
    v_mfma_f32_16x16x32_bf16 v[48:51], a[80:83], v[96:99], v[48:51]
    v_mfma_f32_16x16x32_bf16 v[48:51], a[88:91], v[100:103], v[48:51]
    v_mfma_f32_16x16x32_bf16 v[52:55], a[92:95], v[100:103], v[52:55]
    v_mfma_f32_16x16x32_bf16 v[52:55], a[84:87], v[96:99], v[52:55]
    s_waitcnt lgkmcnt(0)
    v_mfma_f32_16x16x32_bf16 v[60:63], a[84:87], v[104:107], v[60:63]
    s_barrier
    v_mfma_f32_16x16x32_bf16 v[60:63], a[92:95], v[108:111], v[60:63]
    ds_read_b128 v[80:83], v250 offset:12288
    v_mfma_f32_16x16x32_bf16 v[56:59], a[88:91], v[108:111], v[56:59]
    ds_read_b128 v[84:87], v250 offset:18432
    v_mfma_f32_16x16x32_bf16 v[56:59], a[80:83], v[104:107], v[56:59]
    ds_read_b128 v[88:91], v250 offset:12544
    v_mfma_f32_16x16x32_bf16 v[64:67], a[80:83], v[112:115], v[64:67]
    ds_read_b128 v[92:95], v250 offset:18688
    v_mfma_f32_16x16x32_bf16 v[64:67], a[88:91], v[116:119], v[64:67]
    ds_read_b128 v[96:99], v250 offset:12800
    v_mfma_f32_16x16x32_bf16 v[68:71], a[92:95], v[116:119], v[68:71]
    ds_read_b128 v[100:103], v250 offset:18944
    v_mfma_f32_16x16x32_bf16 v[68:71], a[84:87], v[112:115], v[68:71]
    v_mfma_f32_16x16x32_bf16 v[76:79], a[84:87], v[120:123], v[76:79]
    v_mfma_f32_16x16x32_bf16 v[76:79], a[92:95], v[124:127], v[76:79]
    v_mfma_f32_16x16x32_bf16 v[72:75], a[88:91], v[124:127], v[72:75]
    v_mfma_f32_16x16x32_bf16 v[72:75], a[80:83], v[120:123], v[72:75]
    s_waitcnt lgkmcnt(0)
    v_mfma_f32_16x16x32_bf16 v[32:35], a[96:99], v[80:83], v[32:35]
    v_mfma_f32_16x16x32_bf16 v[32:35], a[104:107], v[84:87], v[32:35]
    ds_read_b128 v[104:107], v250 offset:13056
    v_mfma_f32_16x16x32_bf16 v[36:39], a[108:111], v[84:87], v[36:39]
    ds_read_b128 v[108:111], v250 offset:19200
    v_mfma_f32_16x16x32_bf16 v[36:39], a[100:103], v[80:83], v[36:39]
    ds_read_b128 v[112:115], v250 offset:13312
    v_mfma_f32_16x16x32_bf16 v[44:47], a[100:103], v[88:91], v[44:47]
    ds_read_b128 v[116:119], v250 offset:19456
    v_mfma_f32_16x16x32_bf16 v[44:47], a[108:111], v[92:95], v[44:47]
    ds_read_b128 v[120:123], v250 offset:13568
    v_mfma_f32_16x16x32_bf16 v[40:43], a[104:107], v[92:95], v[40:43]
    ds_read_b128 v[124:127], v250 offset:19712
    v_mfma_f32_16x16x32_bf16 v[40:43], a[96:99], v[88:91], v[40:43]
    v_mfma_f32_16x16x32_bf16 v[48:51], a[96:99], v[96:99], v[48:51]
    v_mfma_f32_16x16x32_bf16 v[48:51], a[104:107], v[100:103], v[48:51]
    v_mfma_f32_16x16x32_bf16 v[52:55], a[108:111], v[100:103], v[52:55]
    v_mfma_f32_16x16x32_bf16 v[52:55], a[100:103], v[96:99], v[52:55]
    s_waitcnt lgkmcnt(0)
    v_mfma_f32_16x16x32_bf16 v[60:63], a[100:103], v[104:107], v[60:63]
    s_barrier
    v_mfma_f32_16x16x32_bf16 v[60:63], a[108:111], v[108:111], v[60:63]
    ds_read_b128 v[80:83], v250 offset:24576
    s_add_u32 m0, s74, 24576
    v_mfma_f32_16x16x32_bf16 v[56:59], a[104:107], v[108:111], v[56:59]
    ds_read_b128 v[84:87], v250 offset:30720
    v_mfma_f32_16x16x32_bf16 v[56:59], a[96:99], v[104:107], v[56:59]
    ds_read_b128 v[88:91], v250 offset:24832
    buffer_load_dwordx4 v156, s[44:47], s76 offen offset:0 sc1 lds
    v_mfma_f32_16x16x32_bf16 v[64:67], a[96:99], v[112:115], v[64:67]
    ds_read_b128 v[92:95], v250 offset:30976
    v_mfma_f32_16x16x32_bf16 v[64:67], a[104:107], v[116:119], v[64:67]
    ds_read_b128 v[96:99], v250 offset:25088
    v_mfma_f32_16x16x32_bf16 v[68:71], a[108:111], v[116:119], v[68:71]
    ds_read_b128 v[100:103], v250 offset:31232
    buffer_load_dwordx4 v157, s[44:47], s76 offen offset:1024 sc1 lds
    v_mfma_f32_16x16x32_bf16 v[68:71], a[100:103], v[112:115], v[68:71]
    v_mfma_f32_16x16x32_bf16 v[76:79], a[100:103], v[120:123], v[76:79]
    v_mfma_f32_16x16x32_bf16 v[76:79], a[108:111], v[124:127], v[76:79]
    buffer_load_dwordx4 v158, s[44:47], s76 offen offset:2048 sc1 lds
    v_mfma_f32_16x16x32_bf16 v[72:75], a[104:107], v[124:127], v[72:75]
    v_mfma_f32_16x16x32_bf16 v[72:75], a[96:99], v[120:123], v[72:75]
    s_waitcnt lgkmcnt(0)
    v_mfma_f32_16x16x32_bf16 v[32:35], a[112:115], v[80:83], v[32:35]
    s_add_u32 m0, s74, 36864
    v_mfma_f32_16x16x32_bf16 v[32:35], a[120:123], v[84:87], v[32:35]
    ds_read_b128 v[104:107], v250 offset:25344
    v_mfma_f32_16x16x32_bf16 v[36:39], a[124:127], v[84:87], v[36:39]
    ds_read_b128 v[108:111], v250 offset:31488
    v_mfma_f32_16x16x32_bf16 v[36:39], a[116:119], v[80:83], v[36:39]
    ds_read_b128 v[112:115], v250 offset:25600
    buffer_load_dwordx4 v156, s[44:47], s77 offen offset:0 sc1 lds
    v_mfma_f32_16x16x32_bf16 v[44:47], a[116:119], v[88:91], v[44:47]
    ds_read_b128 v[116:119], v250 offset:31744
    v_mfma_f32_16x16x32_bf16 v[44:47], a[124:127], v[92:95], v[44:47]
    ds_read_b128 v[120:123], v250 offset:25856
    v_mfma_f32_16x16x32_bf16 v[40:43], a[120:123], v[92:95], v[40:43]
    ds_read_b128 v[124:127], v250 offset:32000
    buffer_load_dwordx4 v157, s[44:47], s77 offen offset:1024 sc1 lds
    v_mfma_f32_16x16x32_bf16 v[40:43], a[112:115], v[88:91], v[40:43]
    v_mfma_f32_16x16x32_bf16 v[48:51], a[112:115], v[96:99], v[48:51]
    v_mfma_f32_16x16x32_bf16 v[48:51], a[120:123], v[100:103], v[48:51]
    buffer_load_dwordx4 v158, s[44:47], s77 offen offset:2048 sc1 lds
    v_mfma_f32_16x16x32_bf16 v[52:55], a[124:127], v[100:103], v[52:55]
    v_mfma_f32_16x16x32_bf16 v[52:55], a[116:119], v[96:99], v[52:55]
    s_waitcnt lgkmcnt(0)
    v_mfma_f32_16x16x32_bf16 v[60:63], a[116:119], v[104:107], v[60:63]
    s_waitcnt vmcnt(14)
    s_barrier
    v_mfma_f32_16x16x32_bf16 v[60:63], a[124:127], v[108:111], v[60:63]
    ds_read_b128 v[80:83], v159 offset:0
    s_add_u32 m0, s74, 49152
    v_mfma_f32_16x16x32_bf16 v[56:59], a[120:123], v[108:111], v[56:59]
    ds_read_b128 v[84:87], v159 offset:6144
    v_mov_b32 v29, 0
    v_mfma_f32_16x16x32_bf16 v[56:59], a[112:115], v[104:107], v[56:59]
    ds_read_b128 v[88:91], v159 offset:256
    buffer_load_dwordx4 v156, s[44:47], s78 offen offset:0 sc1 lds
    v_mfma_f32_16x16x32_bf16 v[64:67], a[112:115], v[112:115], v[64:67]
    ds_read_b128 v[92:95], v159 offset:6400
    v_mfma_f32_16x16x32_bf16 v[64:67], a[120:123], v[116:119], v[64:67]
    ds_read_b128 v[96:99], v159 offset:512
    v_mfma_f32_16x16x32_bf16 v[68:71], a[124:127], v[116:119], v[68:71]
    ds_read_b128 v[100:103], v159 offset:6656
    buffer_load_dwordx4 v157, s[44:47], s78 offen offset:1024 sc1 lds
    v_mfma_f32_16x16x32_bf16 v[68:71], a[116:119], v[112:115], v[68:71]
    v_mfma_f32_16x16x32_bf16 v[76:79], a[116:119], v[120:123], v[76:79]
    buffer_atomic_add v29, v28, s[44:47], 0 offen sc0 sc1
    v_mfma_f32_16x16x32_bf16 v[76:79], a[124:127], v[124:127], v[76:79]
    buffer_load_dwordx4 v158, s[44:47], s78 offen offset:2048 sc1 lds
    v_mfma_f32_16x16x32_bf16 v[72:75], a[120:123], v[124:127], v[72:75]
    v_mfma_f32_16x16x32_bf16 v[72:75], a[112:115], v[120:123], v[72:75]
    s_waitcnt lgkmcnt(0)
    v_mfma_f32_16x16x32_bf16 v[32:35], a[128:131], v[80:83], v[32:35]
    s_add_u32 m0, s74, 61440
    v_mfma_f32_16x16x32_bf16 v[32:35], a[136:139], v[84:87], v[32:35]
    ds_read_b128 v[104:107], v159 offset:768
    v_mfma_f32_16x16x32_bf16 v[36:39], a[140:143], v[84:87], v[36:39]
    ds_read_b128 v[108:111], v159 offset:6912
    v_mfma_f32_16x16x32_bf16 v[36:39], a[132:135], v[80:83], v[36:39]
    ds_read_b128 v[112:115], v159 offset:1024
    buffer_load_dwordx4 v156, s[44:47], s79 offen offset:0 sc1 lds
    v_mfma_f32_16x16x32_bf16 v[44:47], a[132:135], v[88:91], v[44:47]
    ds_read_b128 v[116:119], v159 offset:7168
    v_mfma_f32_16x16x32_bf16 v[44:47], a[140:143], v[92:95], v[44:47]
    ds_read_b128 v[120:123], v159 offset:1280
    v_mfma_f32_16x16x32_bf16 v[40:43], a[136:139], v[92:95], v[40:43]
    ds_read_b128 v[124:127], v159 offset:7424
    buffer_load_dwordx4 v157, s[44:47], s79 offen offset:1024 sc1 lds
    v_mfma_f32_16x16x32_bf16 v[40:43], a[128:131], v[88:91], v[40:43]
    v_mfma_f32_16x16x32_bf16 v[48:51], a[128:131], v[96:99], v[48:51]
    v_mfma_f32_16x16x32_bf16 v[48:51], a[136:139], v[100:103], v[48:51]
    buffer_load_dwordx4 v158, s[44:47], s79 offen offset:2048 sc1 lds
    v_mfma_f32_16x16x32_bf16 v[52:55], a[140:143], v[100:103], v[52:55]
    v_mfma_f32_16x16x32_bf16 v[52:55], a[132:135], v[96:99], v[52:55]
    s_waitcnt lgkmcnt(0)
    v_mfma_f32_16x16x32_bf16 v[60:63], a[132:135], v[104:107], v[60:63]
    s_waitcnt vmcnt(14)
    s_barrier
    v_mfma_f32_16x16x32_bf16 v[60:63], a[140:143], v[108:111], v[60:63]
    ds_read_b128 v[80:83], v159 offset:12288
    s_add_u32 m0, s74, 0
    v_mfma_f32_16x16x32_bf16 v[56:59], a[136:139], v[108:111], v[56:59]
    ds_read_b128 v[84:87], v159 offset:18432
    v_mfma_f32_16x16x32_bf16 v[56:59], a[128:131], v[104:107], v[56:59]
    ds_read_b128 v[88:91], v159 offset:12544
    buffer_load_dwordx4 v156, s[44:47], s80 offen offset:0 sc1 lds
    v_mfma_f32_16x16x32_bf16 v[64:67], a[128:131], v[112:115], v[64:67]
    ds_read_b128 v[92:95], v159 offset:18688
    v_mfma_f32_16x16x32_bf16 v[64:67], a[136:139], v[116:119], v[64:67]
    ds_read_b128 v[96:99], v159 offset:12800
    v_mfma_f32_16x16x32_bf16 v[68:71], a[140:143], v[116:119], v[68:71]
    ds_read_b128 v[100:103], v159 offset:18944
    buffer_load_dwordx4 v157, s[44:47], s80 offen offset:1024 sc1 lds
    v_mfma_f32_16x16x32_bf16 v[68:71], a[132:135], v[112:115], v[68:71]
    ds_read_b64_tr_b16 a[32:33], v10 offset:16384
    v_mfma_f32_16x16x32_bf16 v[76:79], a[132:135], v[120:123], v[76:79]
    ds_read_b64_tr_b16 a[34:35], v10 offset:18432
    v_mfma_f32_16x16x32_bf16 v[76:79], a[140:143], v[124:127], v[76:79]
    buffer_load_dwordx4 v158, s[44:47], s80 offen offset:2048 sc1 lds
    v_mfma_f32_16x16x32_bf16 v[72:75], a[136:139], v[124:127], v[72:75]
    ds_read_b64_tr_b16 a[40:41], v10 offset:20480
    v_mfma_f32_16x16x32_bf16 v[72:75], a[128:131], v[120:123], v[72:75]
    ds_read_b64_tr_b16 a[42:43], v10 offset:22528
    s_waitcnt lgkmcnt(4)
    v_mfma_f32_16x16x32_bf16 v[32:35], a[144:147], v[80:83], v[32:35]
    s_add_u32 m0, s73, 32768
    s_lshl_b32 s14, s87, 18
    v_mfma_f32_16x16x32_bf16 v[32:35], a[152:155], v[84:87], v[32:35]
    ds_read_b128 v[104:107], v159 offset:13056
    v_mfma_f32_16x16x32_bf16 v[36:39], a[156:159], v[84:87], v[36:39]
    ds_read_b128 v[108:111], v159 offset:19200
    buffer_load_dwordx4 v4, s[52:55], s14 offen offset:0 lds
    v_mfma_f32_16x16x32_bf16 v[36:39], a[148:151], v[80:83], v[36:39]
    ds_read_b128 v[112:115], v159 offset:13312
    v_mfma_f32_16x16x32_bf16 v[44:47], a[148:151], v[88:91], v[44:47]
    ds_read_b128 v[116:119], v159 offset:19456
    buffer_load_dwordx4 v5, s[52:55], s14 offen offset:1024 lds
    v_mfma_f32_16x16x32_bf16 v[44:47], a[156:159], v[92:95], v[44:47]
    ds_read_b128 v[120:123], v159 offset:13568
    v_mfma_f32_16x16x32_bf16 v[40:43], a[152:155], v[92:95], v[40:43]
    ds_read_b128 v[124:127], v159 offset:19712
    v_mfma_f32_16x16x32_bf16 v[40:43], a[144:147], v[88:91], v[40:43]
    ds_read_b64_tr_b16 a[36:37], v11 offset:16384
    buffer_load_dwordx4 v6, s[52:55], s14 offen offset:2048 lds
    v_mfma_f32_16x16x32_bf16 v[48:51], a[144:147], v[96:99], v[48:51]
    ds_read_b64_tr_b16 a[38:39], v11 offset:18432
    v_mfma_f32_16x16x32_bf16 v[48:51], a[152:155], v[100:103], v[48:51]
    buffer_load_dwordx4 v7, s[52:55], s14 offen offset:3072 lds
    v_mfma_f32_16x16x32_bf16 v[52:55], a[156:159], v[100:103], v[52:55]
    ds_read_b64_tr_b16 a[44:45], v11 offset:20480
    v_mfma_f32_16x16x32_bf16 v[52:55], a[148:151], v[96:99], v[52:55]
    ds_read_b64_tr_b16 a[46:47], v11 offset:22528
L_pl_G_4:
    s_cbranch_execz L_wret
    s_waitcnt lgkmcnt(4)
    v_mfma_f32_16x16x32_bf16 v[60:63], a[148:151], v[104:107], v[60:63]
    s_waitcnt vmcnt(17)
    s_barrier
    v_mfma_f32_16x16x32_bf16 v[60:63], a[156:159], v[108:111], v[60:63]
    ds_read_b128 v[80:83], v159 offset:24576
    v_mfma_f32_16x16x32_bf16 v[56:59], a[152:155], v[108:111], v[56:59]
    ds_read_b128 v[84:87], v159 offset:30720
    v_mfma_f32_16x16x32_bf16 v[56:59], a[144:147], v[104:107], v[56:59]
    ds_read_b128 v[88:91], v159 offset:24832
    v_mfma_f32_16x16x32_bf16 v[64:67], a[144:147], v[112:115], v[64:67]
    ds_read_b128 v[92:95], v159 offset:30976
    v_mfma_f32_16x16x32_bf16 v[64:67], a[152:155], v[116:119], v[64:67]
    ds_read_b128 v[96:99], v159 offset:25088
    v_mfma_f32_16x16x32_bf16 v[68:71], a[156:159], v[116:119], v[68:71]
    ds_read_b128 v[100:103], v159 offset:31232
    v_mfma_f32_16x16x32_bf16 v[68:71], a[148:151], v[112:115], v[68:71]
    v_mfma_f32_16x16x32_bf16 v[76:79], a[148:151], v[120:123], v[76:79]
    v_mfma_f32_16x16x32_bf16 v[76:79], a[156:159], v[124:127], v[76:79]
    v_mfma_f32_16x16x32_bf16 v[72:75], a[152:155], v[124:127], v[72:75]
    v_mfma_f32_16x16x32_bf16 v[72:75], a[144:147], v[120:123], v[72:75]
    s_waitcnt lgkmcnt(0)
    v_mfma_f32_16x16x32_bf16 v[32:35], a[160:163], v[80:83], v[32:35]
    v_mfma_f32_16x16x32_bf16 v[32:35], a[168:171], v[84:87], v[32:35]
    ds_read_b128 v[104:107], v159 offset:25344
    s_waitcnt vmcnt(11)
    v_mfma_f32_16x16x32_bf16 v[36:39], a[172:175], v[84:87], v[36:39]
    ds_read_b128 v[108:111], v159 offset:31488
    v_mfma_f32_16x16x32_bf16 v[36:39], a[164:167], v[80:83], v[36:39]
    ds_read_b128 v[112:115], v159 offset:25600
    v_cmp_ne_u32 vcc, v12, v29
    v_mfma_f32_16x16x32_bf16 v[44:47], a[164:167], v[88:91], v[44:47]
    ds_read_b128 v[116:119], v159 offset:31744
    v_mfma_f32_16x16x32_bf16 v[44:47], a[172:175], v[92:95], v[44:47]
    ds_read_b128 v[120:123], v159 offset:25856
    s_cbranch_vccnz L_rs_p5
L_ok_p5:
    v_mfma_f32_16x16x32_bf16 v[40:43], a[168:171], v[92:95], v[40:43]
    ds_read_b128 v[124:127], v159 offset:32000
    v_mfma_f32_16x16x32_bf16 v[40:43], a[160:163], v[88:91], v[40:43]
    buffer_load_dwordx4 v[160:163], v246, s[44:47], s10 offen offset:0 sc1
    v_mfma_f32_16x16x32_bf16 v[48:51], a[160:163], v[96:99], v[48:51]
    v_mfma_f32_16x16x32_bf16 v[48:51], a[168:171], v[100:103], v[48:51]
    buffer_load_dwordx4 v[164:167], v246, s[44:47], s10 offen offset:1024 sc1
    v_mfma_f32_16x16x32_bf16 v[52:55], a[172:175], v[100:103], v[52:55]
    buffer_load_dwordx4 v[168:171], v246, s[44:47], s10 offen offset:2048 sc1
    v_mfma_f32_16x16x32_bf16 v[52:55], a[164:167], v[96:99], v[52:55]
    s_waitcnt lgkmcnt(0)
    v_mfma_f32_16x16x32_bf16 v[60:63], a[164:167], v[104:107], v[60:63]
    s_barrier
    v_mfma_f32_16x16x32_bf16 v[60:63], a[172:175], v[108:111], v[60:63]
    ds_read_b128 v[80:83], v250 offset:0
    v_mfma_f32_16x16x32_bf16 v[56:59], a[168:171], v[108:111], v[56:59]
    ds_read_b128 v[84:87], v250 offset:6144
    buffer_load_dwordx4 v[172:175], v247, s[44:47], s10 offen offset:0 sc1
    v_mfma_f32_16x16x32_bf16 v[56:59], a[160:163], v[104:107], v[56:59]
    ds_read_b128 v[88:91], v250 offset:256
    v_mfma_f32_16x16x32_bf16 v[64:67], a[160:163], v[112:115], v[64:67]
    ds_read_b128 v[92:95], v250 offset:6400
    v_mfma_f32_16x16x32_bf16 v[64:67], a[168:171], v[116:119], v[64:67]
    ds_read_b128 v[96:99], v250 offset:512
    v_mfma_f32_16x16x32_bf16 v[68:71], a[172:175], v[116:119], v[68:71]
    ds_read_b128 v[100:103], v250 offset:6656
    buffer_load_dwordx4 v[176:179], v247, s[44:47], s10 offen offset:1024 sc1
    v_mfma_f32_16x16x32_bf16 v[68:71], a[164:167], v[112:115], v[68:71]
    v_mfma_f32_16x16x32_bf16 v[76:79], a[164:167], v[120:123], v[76:79]
    v_mfma_f32_16x16x32_bf16 v[76:79], a[172:175], v[124:127], v[76:79]
    v_mfma_f32_16x16x32_bf16 v[72:75], a[168:171], v[124:127], v[72:75]
    buffer_load_dwordx4 v[180:183], v247, s[44:47], s10 offen offset:2048 sc1
    v_mfma_f32_16x16x32_bf16 v[72:75], a[160:163], v[120:123], v[72:75]
    s_waitcnt lgkmcnt(0)
    v_mfma_f32_16x16x32_bf16 v[32:35], a[176:179], v[80:83], v[32:35]
    v_mfma_f32_16x16x32_bf16 v[32:35], a[184:187], v[84:87], v[32:35]
    ds_read_b128 v[104:107], v250 offset:768
    v_mfma_f32_16x16x32_bf16 v[36:39], a[188:191], v[84:87], v[36:39]
    ds_read_b128 v[108:111], v250 offset:6912
    v_mfma_f32_16x16x32_bf16 v[36:39], a[180:183], v[80:83], v[36:39]
    ds_read_b128 v[112:115], v250 offset:1024
    v_mfma_f32_16x16x32_bf16 v[44:47], a[180:183], v[88:91], v[44:47]
    ds_read_b128 v[116:119], v250 offset:7168
    v_mfma_f32_16x16x32_bf16 v[44:47], a[188:191], v[92:95], v[44:47]
    ds_read_b128 v[120:123], v250 offset:1280
    v_mfma_f32_16x16x32_bf16 v[40:43], a[184:187], v[92:95], v[40:43]
    ds_read_b128 v[124:127], v250 offset:7424
    v_mfma_f32_16x16x32_bf16 v[40:43], a[176:179], v[88:91], v[40:43]
    v_mfma_f32_16x16x32_bf16 v[48:51], a[176:179], v[96:99], v[48:51]
    v_mfma_f32_16x16x32_bf16 v[48:51], a[184:187], v[100:103], v[48:51]
    v_mfma_f32_16x16x32_bf16 v[52:55], a[188:191], v[100:103], v[52:55]
    v_mfma_f32_16x16x32_bf16 v[52:55], a[180:183], v[96:99], v[52:55]
    s_waitcnt lgkmcnt(0)
    v_mfma_f32_16x16x32_bf16 v[60:63], a[180:183], v[104:107], v[60:63]
    s_waitcnt vmcnt(16)
    s_barrier
    v_mfma_f32_16x16x32_bf16 v[60:63], a[188:191], v[108:111], v[60:63]
    ds_read_b128 v[80:83], v250 offset:12288
    s_add_u32 m0, s74, 12288
    v_mfma_f32_16x16x32_bf16 v[56:59], a[184:187], v[108:111], v[56:59]
    ds_read_b128 v[84:87], v250 offset:18432
    v_mfma_f32_16x16x32_bf16 v[56:59], a[176:179], v[104:107], v[56:59]
    ds_read_b128 v[88:91], v250 offset:12544
    buffer_load_dwordx4 v156, s[44:47], s81 offen offset:0 sc1 lds
    v_mfma_f32_16x16x32_bf16 v[64:67], a[176:179], v[112:115], v[64:67]
    ds_read_b128 v[92:95], v250 offset:18688
    v_mfma_f32_16x16x32_bf16 v[64:67], a[184:187], v[116:119], v[64:67]
    ds_read_b128 v[96:99], v250 offset:12800
    v_mfma_f32_16x16x32_bf16 v[68:71], a[188:191], v[116:119], v[68:71]
    ds_read_b128 v[100:103], v250 offset:18944
    buffer_load_dwordx4 v157, s[44:47], s81 offen offset:1024 sc1 lds
    v_mfma_f32_16x16x32_bf16 v[68:71], a[180:183], v[112:115], v[68:71]
    v_mfma_f32_16x16x32_bf16 v[76:79], a[180:183], v[120:123], v[76:79]
    v_mfma_f32_16x16x32_bf16 v[76:79], a[188:191], v[124:127], v[76:79]
    buffer_load_dwordx4 v158, s[44:47], s81 offen offset:2048 sc1 lds
    v_mfma_f32_16x16x32_bf16 v[72:75], a[184:187], v[124:127], v[72:75]
    v_mfma_f32_16x16x32_bf16 v[72:75], a[176:179], v[120:123], v[72:75]
    s_waitcnt lgkmcnt(0)
    v_mfma_f32_16x16x32_bf16 v[32:35], a[192:195], v[80:83], v[32:35]
    s_add_u32 m0, s73, 49152
    s_lshl_b32 s14, s88, 18
    v_mfma_f32_16x16x32_bf16 v[32:35], a[200:203], v[84:87], v[32:35]
    ds_read_b128 v[104:107], v250 offset:13056
    v_mfma_f32_16x16x32_bf16 v[36:39], a[204:207], v[84:87], v[36:39]
    ds_read_b128 v[108:111], v250 offset:19200
    buffer_load_dwordx4 v4, s[52:55], s14 offen offset:0 lds
    v_mfma_f32_16x16x32_bf16 v[36:39], a[196:199], v[80:83], v[36:39]
    ds_read_b128 v[112:115], v250 offset:13312
    v_mfma_f32_16x16x32_bf16 v[44:47], a[196:199], v[88:91], v[44:47]
    ds_read_b128 v[116:119], v250 offset:19456
    buffer_load_dwordx4 v5, s[52:55], s14 offen offset:1024 lds
    v_mfma_f32_16x16x32_bf16 v[44:47], a[204:207], v[92:95], v[44:47]
    ds_read_b128 v[120:123], v250 offset:13568
    v_mfma_f32_16x16x32_bf16 v[40:43], a[200:203], v[92:95], v[40:43]
    ds_read_b128 v[124:127], v250 offset:19712
    v_mfma_f32_16x16x32_bf16 v[40:43], a[192:195], v[88:91], v[40:43]
    buffer_load_dwordx4 v6, s[52:55], s14 offen offset:2048 lds
    v_mfma_f32_16x16x32_bf16 v[48:51], a[192:195], v[96:99], v[48:51]
    v_mfma_f32_16x16x32_bf16 v[48:51], a[200:203], v[100:103], v[48:51]
    buffer_load_dwordx4 v7, s[52:55], s14 offen offset:3072 lds
    v_mfma_f32_16x16x32_bf16 v[52:55], a[204:207], v[100:103], v[52:55]
    v_mfma_f32_16x16x32_bf16 v[52:55], a[196:199], v[96:99], v[52:55]
    s_waitcnt lgkmcnt(0)
    v_mfma_f32_16x16x32_bf16 v[60:63], a[196:199], v[104:107], v[60:63]
    s_waitcnt vmcnt(20)
    s_barrier
    v_mfma_f32_16x16x32_bf16 v[60:63], a[204:207], v[108:111], v[60:63]
    ds_read_b128 v[80:83], v250 offset:24576
    v_mfma_f32_16x16x32_bf16 v[56:59], a[200:203], v[108:111], v[56:59]
    ds_read_b128 v[84:87], v250 offset:30720
    v_mfma_f32_16x16x32_bf16 v[56:59], a[192:195], v[104:107], v[56:59]
    ds_read_b128 v[88:91], v250 offset:24832
    v_mfma_f32_16x16x32_bf16 v[64:67], a[192:195], v[112:115], v[64:67]
    ds_read_b128 v[92:95], v250 offset:30976
    v_mfma_f32_16x16x32_bf16 v[64:67], a[200:203], v[116:119], v[64:67]
    ds_read_b128 v[96:99], v250 offset:25088
    v_mfma_f32_16x16x32_bf16 v[68:71], a[204:207], v[116:119], v[68:71]
    ds_read_b128 v[100:103], v250 offset:31232
    s_waitcnt vmcnt(7)
    v_mfma_f32_16x16x32_bf16 v[68:71], a[196:199], v[112:115], v[68:71]
    v_mfma_f32_16x16x32_bf16 v[76:79], a[196:199], v[120:123], v[76:79]
    v_mfma_f32_16x16x32_bf16 v[76:79], a[204:207], v[124:127], v[76:79]
    v_mfma_f32_16x16x32_bf16 v[72:75], a[200:203], v[124:127], v[72:75]
    v_mfma_f32_16x16x32_bf16 v[72:75], a[192:195], v[120:123], v[72:75]
    s_waitcnt lgkmcnt(0)
    v_mfma_f32_16x16x32_bf16 v[32:35], a[208:211], v[80:83], v[32:35]
    s_add_u32 m0, s73, 65536
    s_lshl_b32 s14, s89, 18
    v_mfma_f32_16x16x32_bf16 v[32:35], a[216:219], v[84:87], v[32:35]
    ds_read_b128 v[104:107], v250 offset:25344
    v_mfma_f32_16x16x32_bf16 v[36:39], a[220:223], v[84:87], v[36:39]
    ds_read_b128 v[108:111], v250 offset:31488
    buffer_load_dwordx4 v4, s[52:55], s14 offen offset:0 lds
    v_and_b32 v193, 0xffff0000, v172
    v_lshlrev_b32 v192, 16, v172
    v_mfma_f32_16x16x32_bf16 v[36:39], a[212:215], v[80:83], v[36:39]
    ds_read_b128 v[112:115], v250 offset:25600
    v_and_b32 v195, 0xffff0000, v173
    v_lshlrev_b32 v194, 16, v173
    v_mfma_f32_16x16x32_bf16 v[44:47], a[212:215], v[88:91], v[44:47]
    ds_read_b128 v[116:119], v250 offset:31744
    buffer_load_dwordx4 v5, s[52:55], s14 offen offset:1024 lds
    v_add_f32 v56, v56, v192
    v_mfma_f32_16x16x32_bf16 v[44:47], a[220:223], v[92:95], v[44:47]
    ds_read_b128 v[120:123], v250 offset:25856
    v_add_f32 v57, v57, v193
    v_add_f32 v58, v58, v194
    v_mfma_f32_16x16x32_bf16 v[40:43], a[216:219], v[92:95], v[40:43]
    ds_read_b128 v[124:127], v250 offset:32000
    v_add_f32 v59, v59, v195
    v_and_b32 v197, 0xffff0000, v174
    v_mfma_f32_16x16x32_bf16 v[40:43], a[208:211], v[88:91], v[40:43]
    buffer_load_dwordx4 v6, s[52:55], s14 offen offset:2048 lds
    v_lshlrev_b32 v196, 16, v174
    v_and_b32 v199, 0xffff0000, v175
    v_mfma_f32_16x16x32_bf16 v[48:51], a[208:211], v[96:99], v[48:51]
    v_lshlrev_b32 v198, 16, v175
    v_add_f32 v60, v60, v196
    v_mfma_f32_16x16x32_bf16 v[48:51], a[216:219], v[100:103], v[48:51]
    buffer_load_dwordx4 v7, s[52:55], s14 offen offset:3072 lds
    v_add_f32 v61, v61, v197
    v_mfma_f32_16x16x32_bf16 v[52:55], a[220:223], v[100:103], v[52:55]
    v_add_f32 v62, v62, v198
    v_add_f32 v63, v63, v199
    v_mfma_f32_16x16x32_bf16 v[52:55], a[212:215], v[96:99], v[52:55]
    s_waitcnt lgkmcnt(0)
    v_mfma_f32_16x16x32_bf16 v[60:63], a[212:215], v[104:107], v[60:63]
    s_barrier
    v_mfma_f32_16x16x32_bf16 v[60:63], a[220:223], v[108:111], v[60:63]
    ds_read_b128 v[80:83], v159 offset:0
    v_mfma_f32_16x16x32_bf16 v[56:59], a[216:219], v[108:111], v[56:59]
    ds_read_b128 v[84:87], v159 offset:6144
    v_and_b32 v193, 0xffff0000, v160
    v_lshlrev_b32 v192, 16, v160
    v_mfma_f32_16x16x32_bf16 v[56:59], a[208:211], v[104:107], v[56:59]
    ds_read_b128 v[88:91], v159 offset:256
    v_and_b32 v195, 0xffff0000, v161
    v_lshlrev_b32 v194, 16, v161
    v_mfma_f32_16x16x32_bf16 v[64:67], a[208:211], v[112:115], v[64:67]
    ds_read_b128 v[92:95], v159 offset:6400
    v_add_f32 v32, v32, v192
    v_mfma_f32_16x16x32_bf16 v[64:67], a[216:219], v[116:119], v[64:67]
    ds_read_b128 v[96:99], v159 offset:512
    v_add_f32 v33, v33, v193
    v_add_f32 v34, v34, v194
    v_mfma_f32_16x16x32_bf16 v[68:71], a[220:223], v[116:119], v[68:71]
    ds_read_b128 v[100:103], v159 offset:6656
    v_add_f32 v35, v35, v195
    v_and_b32 v197, 0xffff0000, v162
    v_mfma_f32_16x16x32_bf16 v[68:71], a[212:215], v[112:115], v[68:71]
    ds_read_b64_tr_b16 a[48:49], v10 offset:32768
    v_lshlrev_b32 v196, 16, v162
    v_and_b32 v199, 0xffff0000, v163
    v_mfma_f32_16x16x32_bf16 v[76:79], a[212:215], v[120:123], v[76:79]
    ds_read_b64_tr_b16 a[50:51], v10 offset:34816
    v_lshlrev_b32 v198, 16, v163
    v_mfma_f32_16x16x32_bf16 v[76:79], a[220:223], v[124:127], v[76:79]
    v_add_f32 v36, v36, v196
    v_add_f32 v37, v37, v197
    v_mfma_f32_16x16x32_bf16 v[72:75], a[216:219], v[124:127], v[72:75]
    ds_read_b64_tr_b16 a[56:57], v10 offset:36864
    v_add_f32 v38, v38, v198
    v_add_f32 v39, v39, v199
    v_mfma_f32_16x16x32_bf16 v[72:75], a[208:211], v[120:123], v[72:75]
    ds_read_b64_tr_b16 a[58:59], v10 offset:38912
    s_waitcnt lgkmcnt(4)
    v_mfma_f32_16x16x32_bf16 v[32:35], a[224:227], v[80:83], v[32:35]
    s_add_u32 m0, s73, 0
    s_lshl_b32 s14, s90, 18
    v_mfma_f32_16x16x32_bf16 v[32:35], a[232:235], v[84:87], v[32:35]
    ds_read_b128 v[104:107], v159 offset:768
    v_mfma_f32_16x16x32_bf16 v[36:39], a[236:239], v[84:87], v[36:39]
    ds_read_b128 v[108:111], v159 offset:6912
    buffer_load_dwordx4 v4, s[52:55], s14 offen offset:0 lds
    v_and_b32 v193, 0xffff0000, v176
    v_lshlrev_b32 v192, 16, v176
    v_mfma_f32_16x16x32_bf16 v[36:39], a[228:231], v[80:83], v[36:39]
    ds_read_b128 v[112:115], v159 offset:1024
    v_and_b32 v195, 0xffff0000, v177
    v_lshlrev_b32 v194, 16, v177
    v_mfma_f32_16x16x32_bf16 v[44:47], a[228:231], v[88:91], v[44:47]
    ds_read_b128 v[116:119], v159 offset:7168
    buffer_load_dwordx4 v5, s[52:55], s14 offen offset:1024 lds
    v_add_f32 v64, v64, v192
    v_mfma_f32_16x16x32_bf16 v[44:47], a[236:239], v[92:95], v[44:47]
    ds_read_b128 v[120:123], v159 offset:1280
    v_add_f32 v65, v65, v193
    v_add_f32 v66, v66, v194
    v_mfma_f32_16x16x32_bf16 v[40:43], a[232:235], v[92:95], v[40:43]
    ds_read_b128 v[124:127], v159 offset:7424
    v_add_f32 v67, v67, v195
    v_and_b32 v197, 0xffff0000, v178
    v_mfma_f32_16x16x32_bf16 v[40:43], a[224:227], v[88:91], v[40:43]
    ds_read_b64_tr_b16 a[52:53], v11 offset:32768
    buffer_load_dwordx4 v6, s[52:55], s14 offen offset:2048 lds
    v_lshlrev_b32 v196, 16, v178
    v_and_b32 v199, 0xffff0000, v179
    v_mfma_f32_16x16x32_bf16 v[48:51], a[224:227], v[96:99], v[48:51]
    ds_read_b64_tr_b16 a[54:55], v11 offset:34816
    v_lshlrev_b32 v198, 16, v179
    v_mfma_f32_16x16x32_bf16 v[48:51], a[232:235], v[100:103], v[48:51]
    buffer_load_dwordx4 v7, s[52:55], s14 offen offset:3072 lds
    v_add_f32 v68, v68, v196
    v_add_f32 v69, v69, v197
    v_mfma_f32_16x16x32_bf16 v[52:55], a[236:239], v[100:103], v[52:55]
    ds_read_b64_tr_b16 a[60:61], v11 offset:36864
    v_add_f32 v70, v70, v198
    v_add_f32 v71, v71, v199
    v_mfma_f32_16x16x32_bf16 v[52:55], a[228:231], v[96:99], v[52:55]
    ds_read_b64_tr_b16 a[62:63], v11 offset:38912
    s_waitcnt lgkmcnt(4)
    v_mfma_f32_16x16x32_bf16 v[60:63], a[228:231], v[104:107], v[60:63]
    s_waitcnt vmcnt(12)
    s_barrier
    v_mfma_f32_16x16x32_bf16 v[60:63], a[236:239], v[108:111], v[60:63]
    ds_read_b128 v[80:83], v159 offset:12288
    v_mfma_f32_16x16x32_bf16 v[56:59], a[232:235], v[108:111], v[56:59]
    ds_read_b128 v[84:87], v159 offset:18432
    v_and_b32 v193, 0xffff0000, v164
    v_lshlrev_b32 v192, 16, v164
    v_mfma_f32_16x16x32_bf16 v[56:59], a[224:227], v[104:107], v[56:59]
    ds_read_b128 v[88:91], v159 offset:12544
    v_and_b32 v195, 0xffff0000, v165
    v_lshlrev_b32 v194, 16, v165
    v_mfma_f32_16x16x32_bf16 v[64:67], a[224:227], v[112:115], v[64:67]
    ds_read_b128 v[92:95], v159 offset:18688
    v_add_f32 v40, v40, v192
    v_mfma_f32_16x16x32_bf16 v[64:67], a[232:235], v[116:119], v[64:67]
    ds_read_b128 v[96:99], v159 offset:12800
    v_add_f32 v41, v41, v193
    v_add_f32 v42, v42, v194
    v_mfma_f32_16x16x32_bf16 v[68:71], a[236:239], v[116:119], v[68:71]
    ds_read_b128 v[100:103], v159 offset:18944
    v_add_f32 v43, v43, v195
    v_mfma_f32_16x16x32_bf16 v[68:71], a[228:231], v[112:115], v[68:71]
    v_and_b32 v197, 0xffff0000, v166
    v_lshlrev_b32 v196, 16, v166
    v_mfma_f32_16x16x32_bf16 v[76:79], a[228:231], v[120:123], v[76:79]
    v_and_b32 v199, 0xffff0000, v167
    v_lshlrev_b32 v198, 16, v167
    v_mfma_f32_16x16x32_bf16 v[76:79], a[236:239], v[124:127], v[76:79]
    v_add_f32 v44, v44, v196
    v_add_f32 v45, v45, v197
    v_mfma_f32_16x16x32_bf16 v[72:75], a[232:235], v[124:127], v[72:75]
    v_add_f32 v46, v46, v198
    v_add_f32 v47, v47, v199
    v_mfma_f32_16x16x32_bf16 v[72:75], a[224:227], v[120:123], v[72:75]
    s_waitcnt lgkmcnt(0)
    v_mfma_f32_16x16x32_bf16 v[32:35], a[240:243], v[80:83], v[32:35]
    s_add_u32 m0, s73, 16384
    s_lshl_b32 s14, s91, 18
    v_mfma_f32_16x16x32_bf16 v[32:35], a[248:251], v[84:87], v[32:35]
    ds_read_b128 v[104:107], v159 offset:13056
    v_mfma_f32_16x16x32_bf16 v[36:39], a[252:255], v[84:87], v[36:39]
    ds_read_b128 v[108:111], v159 offset:19200
    buffer_load_dwordx4 v4, s[52:55], s14 offen offset:0 lds
    v_and_b32 v193, 0xffff0000, v180
    v_lshlrev_b32 v192, 16, v180
    v_mfma_f32_16x16x32_bf16 v[36:39], a[244:247], v[80:83], v[36:39]
    ds_read_b128 v[112:115], v159 offset:13312
    v_and_b32 v195, 0xffff0000, v181
    v_lshlrev_b32 v194, 16, v181
    v_mfma_f32_16x16x32_bf16 v[44:47], a[244:247], v[88:91], v[44:47]
    ds_read_b128 v[116:119], v159 offset:19456
    buffer_load_dwordx4 v5, s[52:55], s14 offen offset:1024 lds
    v_add_f32 v72, v72, v192
    v_mfma_f32_16x16x32_bf16 v[44:47], a[252:255], v[92:95], v[44:47]
    ds_read_b128 v[120:123], v159 offset:13568
    v_add_f32 v73, v73, v193
    v_add_f32 v74, v74, v194
    v_mfma_f32_16x16x32_bf16 v[40:43], a[248:251], v[92:95], v[40:43]
    ds_read_b128 v[124:127], v159 offset:19712
    v_add_f32 v75, v75, v195
    v_and_b32 v197, 0xffff0000, v182
    v_mfma_f32_16x16x32_bf16 v[40:43], a[240:243], v[88:91], v[40:43]
    buffer_load_dwordx4 v6, s[52:55], s14 offen offset:2048 lds
    v_lshlrev_b32 v196, 16, v182
    v_and_b32 v199, 0xffff0000, v183
    v_mfma_f32_16x16x32_bf16 v[48:51], a[240:243], v[96:99], v[48:51]
    v_lshlrev_b32 v198, 16, v183
    v_add_f32 v76, v76, v196
    v_mfma_f32_16x16x32_bf16 v[48:51], a[248:251], v[100:103], v[48:51]
    buffer_load_dwordx4 v7, s[52:55], s14 offen offset:3072 lds
    v_add_f32 v77, v77, v197
    v_mfma_f32_16x16x32_bf16 v[52:55], a[252:255], v[100:103], v[52:55]
    v_add_f32 v78, v78, v198
    v_add_f32 v79, v79, v199
    v_mfma_f32_16x16x32_bf16 v[52:55], a[244:247], v[96:99], v[52:55]
    s_waitcnt lgkmcnt(0)
    v_mfma_f32_16x16x32_bf16 v[60:63], a[244:247], v[104:107], v[60:63]
    s_barrier
    v_mfma_f32_16x16x32_bf16 v[60:63], a[252:255], v[108:111], v[60:63]
    s_add_u32 m0, s73, 131072
    s_lshl_b32 s14, s92, 18
    v_mfma_f32_16x16x32_bf16 v[56:59], a[248:251], v[108:111], v[56:59]
    buffer_load_dwordx4 v4, s[52:55], s14 offen offset:0 lds
    v_and_b32 v193, 0xffff0000, v168
    v_lshlrev_b32 v192, 16, v168
    v_mfma_f32_16x16x32_bf16 v[56:59], a[240:243], v[104:107], v[56:59]
    buffer_load_dwordx4 v5, s[52:55], s14 offen offset:1024 lds
    v_and_b32 v195, 0xffff0000, v169
    v_lshlrev_b32 v194, 16, v169
    v_mfma_f32_16x16x32_bf16 v[64:67], a[240:243], v[112:115], v[64:67]
    buffer_load_dwordx4 v6, s[52:55], s14 offen offset:2048 lds
    v_add_f32 v48, v48, v192
    v_mfma_f32_16x16x32_bf16 v[64:67], a[248:251], v[116:119], v[64:67]
    buffer_load_dwordx4 v7, s[52:55], s14 offen offset:3072 lds
    v_add_f32 v49, v49, v193
    v_add_f32 v50, v50, v194
    v_mfma_f32_16x16x32_bf16 v[68:71], a[252:255], v[116:119], v[68:71]
    s_add_u32 m0, s73, 147456
    s_lshl_b32 s14, s93, 18
    v_add_f32 v51, v51, v195
    v_and_b32 v197, 0xffff0000, v170
    v_mfma_f32_16x16x32_bf16 v[68:71], a[244:247], v[112:115], v[68:71]
    buffer_load_dwordx4 v4, s[52:55], s14 offen offset:0 lds
    v_lshlrev_b32 v196, 16, v170
    v_and_b32 v199, 0xffff0000, v171
    v_mfma_f32_16x16x32_bf16 v[76:79], a[244:247], v[120:123], v[76:79]
    buffer_load_dwordx4 v5, s[52:55], s14 offen offset:1024 lds
    v_lshlrev_b32 v198, 16, v171
    v_mfma_f32_16x16x32_bf16 v[76:79], a[252:255], v[124:127], v[76:79]
    buffer_load_dwordx4 v6, s[52:55], s14 offen offset:2048 lds
    v_add_f32 v52, v52, v196
    v_add_f32 v53, v53, v197
    v_mfma_f32_16x16x32_bf16 v[72:75], a[248:251], v[124:127], v[72:75]
    buffer_load_dwordx4 v7, s[52:55], s14 offen offset:3072 lds
    v_add_f32 v54, v54, v198
    v_add_f32 v55, v55, v199
    v_mfma_f32_16x16x32_bf16 v[72:75], a[240:243], v[120:123], v[72:75]
    s_waitcnt lgkmcnt(0)
    v_mov_b32 v88, 0xc0135761
    s_mov_b32 s10, 0xbdd2d3e8
    s_lshl_b32 s9, s69, 2
    s_add_u32 s9, s9, s3
    s_mul_i32 s9, s9, 69632
    s_add_u32 s9, s9, 12795904
    v_pk_mul_f32 v[160:161], v[32:33], v[32:33]
    v_pk_mul_f32 v[162:163], v[34:35], v[34:35]
    v_pk_mul_f32 v[164:165], v[36:37], v[36:37]
    v_pk_mul_f32 v[166:167], v[38:39], v[38:39]
    v_pk_mul_f32 v[168:169], v[40:41], v[40:41]
    v_pk_mul_f32 v[170:171], v[42:43], v[42:43]
    v_pk_mul_f32 v[172:173], v[44:45], v[44:45]
    v_pk_mul_f32 v[174:175], v[46:47], v[46:47]
    v_pk_fma_f32 v[160:161], v[160:161], s[10:11], v[88:89] op_sel_hi:[1,0,0]
    v_pk_fma_f32 v[162:163], v[162:163], s[10:11], v[88:89] op_sel_hi:[1,0,0]
    v_pk_fma_f32 v[164:165], v[164:165], s[10:11], v[88:89] op_sel_hi:[1,0,0]
    v_pk_fma_f32 v[166:167], v[166:167], s[10:11], v[88:89] op_sel_hi:[1,0,0]
    v_pk_fma_f32 v[168:169], v[168:169], s[10:11], v[88:89] op_sel_hi:[1,0,0]
    v_pk_fma_f32 v[170:171], v[170:171], s[10:11], v[88:89] op_sel_hi:[1,0,0]
    v_pk_fma_f32 v[172:173], v[172:173], s[10:11], v[88:89] op_sel_hi:[1,0,0]
    v_pk_fma_f32 v[174:175], v[174:175], s[10:11], v[88:89] op_sel_hi:[1,0,0]
    v_pk_mul_f32 v[160:161], v[160:161], v[32:33]
    v_pk_mul_f32 v[162:163], v[162:163], v[34:35]
    v_pk_mul_f32 v[164:165], v[164:165], v[36:37]
    v_pk_mul_f32 v[166:167], v[166:167], v[38:39]
    v_pk_mul_f32 v[168:169], v[168:169], v[40:41]
    v_pk_mul_f32 v[170:171], v[170:171], v[42:43]
    v_pk_mul_f32 v[172:173], v[172:173], v[44:45]
    v_pk_mul_f32 v[174:175], v[174:175], v[46:47]
    v_exp_f32 v160, v160
    v_exp_f32 v161, v161
    v_exp_f32 v162, v162
    v_exp_f32 v163, v163
    v_exp_f32 v164, v164
    v_exp_f32 v165, v165
    v_exp_f32 v166, v166
    v_exp_f32 v167, v167
    v_exp_f32 v168, v168
    v_exp_f32 v169, v169
    v_exp_f32 v170, v170
    v_exp_f32 v171, v171
    v_exp_f32 v172, v172
    v_exp_f32 v173, v173
    v_exp_f32 v174, v174
    v_exp_f32 v175, v175
    v_pk_add_f32 v[160:161], v[160:161], 1.0 op_sel_hi:[1,0]
    v_pk_add_f32 v[162:163], v[162:163], 1.0 op_sel_hi:[1,0]
    v_pk_add_f32 v[164:165], v[164:165], 1.0 op_sel_hi:[1,0]
    v_pk_add_f32 v[166:167], v[166:167], 1.0 op_sel_hi:[1,0]
    v_pk_add_f32 v[168:169], v[168:169], 1.0 op_sel_hi:[1,0]
    v_pk_add_f32 v[170:171], v[170:171], 1.0 op_sel_hi:[1,0]
    v_pk_add_f32 v[172:173], v[172:173], 1.0 op_sel_hi:[1,0]
    v_pk_add_f32 v[174:175], v[174:175], 1.0 op_sel_hi:[1,0]
    v_rcp_f32 v160, v160
    v_rcp_f32 v161, v161
    v_rcp_f32 v162, v162
    v_rcp_f32 v163, v163
    v_rcp_f32 v164, v164
    v_rcp_f32 v165, v165
    v_rcp_f32 v166, v166
    v_rcp_f32 v167, v167
    v_rcp_f32 v168, v168
    v_rcp_f32 v169, v169
    v_rcp_f32 v170, v170
    v_rcp_f32 v171, v171
    v_rcp_f32 v172, v172
    v_rcp_f32 v173, v173
    v_rcp_f32 v174, v174
    v_rcp_f32 v175, v175
    v_pk_mul_f32 v[32:33], v[32:33], v[160:161]
    v_pk_mul_f32 v[34:35], v[34:35], v[162:163]
    v_pk_mul_f32 v[36:37], v[36:37], v[164:165]
    v_pk_mul_f32 v[38:39], v[38:39], v[166:167]
    v_pk_mul_f32 v[40:41], v[40:41], v[168:169]
    v_pk_mul_f32 v[42:43], v[42:43], v[170:171]
    v_pk_mul_f32 v[44:45], v[44:45], v[172:173]
    v_pk_mul_f32 v[46:47], v[46:47], v[174:175]
    v_cvt_pk_bf16_f32 v96, v32, v33
    v_cvt_pk_bf16_f32 v97, v34, v35
    v_cvt_pk_bf16_f32 v98, v36, v37
    v_cvt_pk_bf16_f32 v99, v38, v39
    v_cvt_pk_bf16_f32 v100, v40, v41
    v_cvt_pk_bf16_f32 v101, v42, v43
    v_cvt_pk_bf16_f32 v102, v44, v45
    v_cvt_pk_bf16_f32 v103, v46, v47
    buffer_store_dwordx4 v[96:99], v240, s[44:47], s9 offen sc1
    buffer_store_dwordx4 v[100:103], v241, s[44:47], s9 offen sc1
    v_pk_mul_f32 v[160:161], v[48:49], v[48:49]
    v_pk_mul_f32 v[162:163], v[50:51], v[50:51]
    v_pk_mul_f32 v[164:165], v[52:53], v[52:53]
    v_pk_mul_f32 v[166:167], v[54:55], v[54:55]
    v_pk_mul_f32 v[168:169], v[56:57], v[56:57]
    v_pk_mul_f32 v[170:171], v[58:59], v[58:59]
    v_pk_mul_f32 v[172:173], v[60:61], v[60:61]
    v_pk_mul_f32 v[174:175], v[62:63], v[62:63]
    v_pk_fma_f32 v[160:161], v[160:161], s[10:11], v[88:89] op_sel_hi:[1,0,0]
    v_pk_fma_f32 v[162:163], v[162:163], s[10:11], v[88:89] op_sel_hi:[1,0,0]
    v_pk_fma_f32 v[164:165], v[164:165], s[10:11], v[88:89] op_sel_hi:[1,0,0]
    v_pk_fma_f32 v[166:167], v[166:167], s[10:11], v[88:89] op_sel_hi:[1,0,0]
    v_pk_fma_f32 v[168:169], v[168:169], s[10:11], v[88:89] op_sel_hi:[1,0,0]
    v_pk_fma_f32 v[170:171], v[170:171], s[10:11], v[88:89] op_sel_hi:[1,0,0]
    v_pk_fma_f32 v[172:173], v[172:173], s[10:11], v[88:89] op_sel_hi:[1,0,0]
    v_pk_fma_f32 v[174:175], v[174:175], s[10:11], v[88:89] op_sel_hi:[1,0,0]
    v_pk_mul_f32 v[160:161], v[160:161], v[48:49]
    v_pk_mul_f32 v[162:163], v[162:163], v[50:51]
    v_pk_mul_f32 v[164:165], v[164:165], v[52:53]
    v_pk_mul_f32 v[166:167], v[166:167], v[54:55]
    v_pk_mul_f32 v[168:169], v[168:169], v[56:57]
    v_pk_mul_f32 v[170:171], v[170:171], v[58:59]
    v_pk_mul_f32 v[172:173], v[172:173], v[60:61]
    v_pk_mul_f32 v[174:175], v[174:175], v[62:63]
    v_exp_f32 v160, v160
    v_exp_f32 v161, v161
    v_exp_f32 v162, v162
    v_exp_f32 v163, v163
    v_exp_f32 v164, v164
    v_exp_f32 v165, v165
    v_exp_f32 v166, v166
    v_exp_f32 v167, v167
    v_exp_f32 v168, v168
    v_exp_f32 v169, v169
    v_exp_f32 v170, v170
    v_exp_f32 v171, v171
    v_exp_f32 v172, v172
    v_exp_f32 v173, v173
    v_exp_f32 v174, v174
    v_exp_f32 v175, v175
    v_pk_add_f32 v[160:161], v[160:161], 1.0 op_sel_hi:[1,0]
    v_pk_add_f32 v[162:163], v[162:163], 1.0 op_sel_hi:[1,0]
    v_pk_add_f32 v[164:165], v[164:165], 1.0 op_sel_hi:[1,0]
    v_pk_add_f32 v[166:167], v[166:167], 1.0 op_sel_hi:[1,0]
    v_pk_add_f32 v[168:169], v[168:169], 1.0 op_sel_hi:[1,0]
    v_pk_add_f32 v[170:171], v[170:171], 1.0 op_sel_hi:[1,0]
    v_pk_add_f32 v[172:173], v[172:173], 1.0 op_sel_hi:[1,0]
    v_pk_add_f32 v[174:175], v[174:175], 1.0 op_sel_hi:[1,0]
    v_rcp_f32 v160, v160
    v_rcp_f32 v161, v161
    v_rcp_f32 v162, v162
    v_rcp_f32 v163, v163
    v_rcp_f32 v164, v164
    v_rcp_f32 v165, v165
    v_rcp_f32 v166, v166
    v_rcp_f32 v167, v167
    v_rcp_f32 v168, v168
    v_rcp_f32 v169, v169
    v_rcp_f32 v170, v170
    v_rcp_f32 v171, v171
    v_rcp_f32 v172, v172
    v_rcp_f32 v173, v173
    v_rcp_f32 v174, v174
    v_rcp_f32 v175, v175
    v_pk_mul_f32 v[48:49], v[48:49], v[160:161]
    v_pk_mul_f32 v[50:51], v[50:51], v[162:163]
    v_pk_mul_f32 v[52:53], v[52:53], v[164:165]
    v_pk_mul_f32 v[54:55], v[54:55], v[166:167]
    v_pk_mul_f32 v[56:57], v[56:57], v[168:169]
    v_pk_mul_f32 v[58:59], v[58:59], v[170:171]
    v_pk_mul_f32 v[60:61], v[60:61], v[172:173]
    v_pk_mul_f32 v[62:63], v[62:63], v[174:175]
    v_cvt_pk_bf16_f32 v104, v48, v49
    v_cvt_pk_bf16_f32 v105, v50, v51
    v_cvt_pk_bf16_f32 v106, v52, v53
    v_cvt_pk_bf16_f32 v107, v54, v55
    v_cvt_pk_bf16_f32 v108, v56, v57
    v_cvt_pk_bf16_f32 v109, v58, v59
    v_cvt_pk_bf16_f32 v110, v60, v61
    v_cvt_pk_bf16_f32 v111, v62, v63
    buffer_store_dwordx4 v[104:107], v242, s[44:47], s9 offen sc1
    buffer_store_dwordx4 v[108:111], v243, s[44:47], s9 offen sc1
    v_pk_mul_f32 v[160:161], v[64:65], v[64:65]
    v_pk_mul_f32 v[162:163], v[66:67], v[66:67]
    v_pk_mul_f32 v[164:165], v[68:69], v[68:69]
    v_pk_mul_f32 v[166:167], v[70:71], v[70:71]
    v_pk_mul_f32 v[168:169], v[72:73], v[72:73]
    v_pk_mul_f32 v[170:171], v[74:75], v[74:75]
    v_pk_mul_f32 v[172:173], v[76:77], v[76:77]
    v_pk_mul_f32 v[174:175], v[78:79], v[78:79]
    v_pk_fma_f32 v[160:161], v[160:161], s[10:11], v[88:89] op_sel_hi:[1,0,0]
    v_pk_fma_f32 v[162:163], v[162:163], s[10:11], v[88:89] op_sel_hi:[1,0,0]
    v_pk_fma_f32 v[164:165], v[164:165], s[10:11], v[88:89] op_sel_hi:[1,0,0]
    v_pk_fma_f32 v[166:167], v[166:167], s[10:11], v[88:89] op_sel_hi:[1,0,0]
    v_pk_fma_f32 v[168:169], v[168:169], s[10:11], v[88:89] op_sel_hi:[1,0,0]
    v_pk_fma_f32 v[170:171], v[170:171], s[10:11], v[88:89] op_sel_hi:[1,0,0]
    v_pk_fma_f32 v[172:173], v[172:173], s[10:11], v[88:89] op_sel_hi:[1,0,0]
    v_pk_fma_f32 v[174:175], v[174:175], s[10:11], v[88:89] op_sel_hi:[1,0,0]
    v_pk_mul_f32 v[160:161], v[160:161], v[64:65]
    v_pk_mul_f32 v[162:163], v[162:163], v[66:67]
    v_pk_mul_f32 v[164:165], v[164:165], v[68:69]
    v_pk_mul_f32 v[166:167], v[166:167], v[70:71]
    v_pk_mul_f32 v[168:169], v[168:169], v[72:73]
L_pl_G_5:
    s_cbranch_execz L_wret
    v_pk_mul_f32 v[170:171], v[170:171], v[74:75]
    v_pk_mul_f32 v[172:173], v[172:173], v[76:77]
    v_pk_mul_f32 v[174:175], v[174:175], v[78:79]
    v_exp_f32 v160, v160
    v_exp_f32 v161, v161
    v_exp_f32 v162, v162
    v_exp_f32 v163, v163
    v_exp_f32 v164, v164
    v_exp_f32 v165, v165
    v_exp_f32 v166, v166
    v_exp_f32 v167, v167
    v_exp_f32 v168, v168
    v_exp_f32 v169, v169
    v_exp_f32 v170, v170
    v_exp_f32 v171, v171
    v_exp_f32 v172, v172
    v_exp_f32 v173, v173
    v_exp_f32 v174, v174
    v_exp_f32 v175, v175
    v_pk_add_f32 v[160:161], v[160:161], 1.0 op_sel_hi:[1,0]
    v_pk_add_f32 v[162:163], v[162:163], 1.0 op_sel_hi:[1,0]
    v_pk_add_f32 v[164:165], v[164:165], 1.0 op_sel_hi:[1,0]
    v_pk_add_f32 v[166:167], v[166:167], 1.0 op_sel_hi:[1,0]
    v_pk_add_f32 v[168:169], v[168:169], 1.0 op_sel_hi:[1,0]
    v_pk_add_f32 v[170:171], v[170:171], 1.0 op_sel_hi:[1,0]
    v_pk_add_f32 v[172:173], v[172:173], 1.0 op_sel_hi:[1,0]
    v_pk_add_f32 v[174:175], v[174:175], 1.0 op_sel_hi:[1,0]
    v_rcp_f32 v160, v160
    v_rcp_f32 v161, v161
    v_rcp_f32 v162, v162
    v_rcp_f32 v163, v163
    v_rcp_f32 v164, v164
    v_rcp_f32 v165, v165
    v_rcp_f32 v166, v166
    v_rcp_f32 v167, v167
    v_rcp_f32 v168, v168
    v_rcp_f32 v169, v169
    v_rcp_f32 v170, v170
    v_rcp_f32 v171, v171
    v_rcp_f32 v172, v172
    v_rcp_f32 v173, v173
    v_rcp_f32 v174, v174
    v_rcp_f32 v175, v175
    v_pk_mul_f32 v[64:65], v[64:65], v[160:161]
    v_pk_mul_f32 v[66:67], v[66:67], v[162:163]
    v_pk_mul_f32 v[68:69], v[68:69], v[164:165]
    v_pk_mul_f32 v[70:71], v[70:71], v[166:167]
    v_pk_mul_f32 v[72:73], v[72:73], v[168:169]
    v_pk_mul_f32 v[74:75], v[74:75], v[170:171]
    v_pk_mul_f32 v[76:77], v[76:77], v[172:173]
    v_pk_mul_f32 v[78:79], v[78:79], v[174:175]
    v_cvt_pk_bf16_f32 v112, v64, v65
    v_cvt_pk_bf16_f32 v113, v66, v67
    v_cvt_pk_bf16_f32 v114, v68, v69
    v_cvt_pk_bf16_f32 v115, v70, v71
    v_cvt_pk_bf16_f32 v116, v72, v73
    v_cvt_pk_bf16_f32 v117, v74, v75
    v_cvt_pk_bf16_f32 v118, v76, v77
    v_cvt_pk_bf16_f32 v119, v78, v79
    buffer_store_dwordx4 v[112:115], v244, s[44:47], s9 offen sc1
    buffer_store_dwordx4 v[116:119], v245, s[44:47], s9 offen sc1
    s_waitcnt vmcnt(0)
    s_barrier
    buffer_store_dword v249, v17, s[44:47], 0 offen sc1
    ds_read_b64_tr_b16 a[64:65], v10 offset:49152
    s_add_u32 m0, s73, 32768
    s_lshl_b32 s14, s94, 18
    ds_read_b64_tr_b16 a[66:67], v10 offset:51200
    ds_read_b64_tr_b16 a[72:73], v10 offset:53248
    ds_read_b64_tr_b16 a[74:75], v10 offset:55296
    ds_read_b64_tr_b16 a[68:69], v11 offset:49152
    buffer_load_dwordx4 v4, s[52:55], s14 offen offset:0 lds
    ds_read_b64_tr_b16 a[70:71], v11 offset:51200
    ds_read_b64_tr_b16 a[76:77], v11 offset:53248
    ds_read_b64_tr_b16 a[78:79], v11 offset:55296
    v_add_u32 v10, 65536, v10
    ds_read_b64_tr_b16 a[80:81], v10 offset:0
    ds_read_b64_tr_b16 a[82:83], v10 offset:2048
    buffer_load_dwordx4 v5, s[52:55], s14 offen offset:1024 lds
    ds_read_b64_tr_b16 a[88:89], v10 offset:4096
    ds_read_b64_tr_b16 a[90:91], v10 offset:6144
    v_add_u32 v11, 65536, v11
    ds_read_b64_tr_b16 a[84:85], v11 offset:0
    ds_read_b64_tr_b16 a[86:87], v11 offset:2048
    ds_read_b64_tr_b16 a[92:93], v11 offset:4096
    buffer_load_dwordx4 v6, s[52:55], s14 offen offset:2048 lds
    ds_read_b64_tr_b16 a[94:95], v11 offset:6144
    v_add_u32 v10, -65536, v10
    ds_read_b64_tr_b16 a[96:97], v10 offset:0
    ds_read_b64_tr_b16 a[98:99], v10 offset:2048
    ds_read_b64_tr_b16 a[104:105], v10 offset:4096
    ds_read_b64_tr_b16 a[106:107], v10 offset:6144
    buffer_load_dwordx4 v7, s[52:55], s14 offen offset:3072 lds
    v_add_u32 v11, -65536, v11
    ds_read_b64_tr_b16 a[100:101], v11 offset:0
    ds_read_b64_tr_b16 a[102:103], v11 offset:2048
    ds_read_b64_tr_b16 a[108:109], v11 offset:4096
    ds_read_b64_tr_b16 a[110:111], v11 offset:6144
    ds_read_b64_tr_b16 a[112:113], v10 offset:16384
    s_add_u32 m0, s73, 81920
    s_lshl_b32 s14, s95, 18
    ds_read_b64_tr_b16 a[114:115], v10 offset:18432
    ds_read_b64_tr_b16 a[120:121], v10 offset:20480
    ds_read_b64_tr_b16 a[122:123], v10 offset:22528
    ds_read_b64_tr_b16 a[116:117], v11 offset:16384
    buffer_load_dwordx4 v4, s[52:55], s14 offen offset:0 lds
    ds_read_b64_tr_b16 a[118:119], v11 offset:18432
    ds_read_b64_tr_b16 a[124:125], v11 offset:20480
    ds_read_b64_tr_b16 a[126:127], v11 offset:22528
    v_add_u32 v10, 131072, v10
    ds_read_b64_tr_b16 a[128:129], v10 offset:0
    ds_read_b64_tr_b16 a[130:131], v10 offset:2048
    buffer_load_dwordx4 v5, s[52:55], s14 offen offset:1024 lds
    ds_read_b64_tr_b16 a[136:137], v10 offset:4096
    ds_read_b64_tr_b16 a[138:139], v10 offset:6144
    v_add_u32 v11, 131072, v11
    ds_read_b64_tr_b16 a[132:133], v11 offset:0
    ds_read_b64_tr_b16 a[134:135], v11 offset:2048
    ds_read_b64_tr_b16 a[140:141], v11 offset:4096
    buffer_load_dwordx4 v6, s[52:55], s14 offen offset:2048 lds
    ds_read_b64_tr_b16 a[142:143], v11 offset:6144
    ds_read_b64_tr_b16 a[144:145], v10 offset:16384
    ds_read_b64_tr_b16 a[146:147], v10 offset:18432
    ds_read_b64_tr_b16 a[152:153], v10 offset:20480
    ds_read_b64_tr_b16 a[154:155], v10 offset:22528
    buffer_load_dwordx4 v7, s[52:55], s14 offen offset:3072 lds
    ds_read_b64_tr_b16 a[148:149], v11 offset:16384
    ds_read_b64_tr_b16 a[150:151], v11 offset:18432
    ds_read_b64_tr_b16 a[156:157], v11 offset:20480
    ds_read_b64_tr_b16 a[158:159], v11 offset:22528
    s_bitcmp1_b32 s3, 1
    s_cselect_b32 s18, s85, s84
    s_mul_i32 s18, s18, 139264
    s_cselect_b32 s19, s87, s86
    s_mul_i32 s19, s19, 139264
    s_cselect_b32 s20, s89, s88
    s_mul_i32 s20, s20, 139264
    s_cselect_b32 s21, s91, s90
    s_mul_i32 s21, s21, 139264
    s_cselect_b32 s22, s93, s92
    s_mul_i32 s22, s22, 139264
    s_cselect_b32 s23, s95, s94
    s_mul_i32 s23, s23, 139264
    s_cselect_b32 s24, s97, s96
    s_mul_i32 s24, s24, 139264
    s_cselect_b32 s25, s99, s98
    s_mul_i32 s25, s25, 139264
    s_cselect_b32 s26, s101, s100
    s_mul_i32 s26, s26, 139264
    s_waitcnt lgkmcnt(0)
    s_barrier
    s_add_u32 m0, s73, 0
    s_lshl_b32 s14, s96, 18
    buffer_load_dwordx4 v4, s[52:55], s14 offen offset:0 lds
    buffer_load_dwordx4 v5, s[52:55], s14 offen offset:1024 lds
    buffer_load_dwordx4 v6, s[52:55], s14 offen offset:2048 lds
    buffer_load_dwordx4 v7, s[52:55], s14 offen offset:3072 lds
    s_add_u32 m0, s73, 16384
    s_lshl_b32 s14, s97, 18
    buffer_load_dwordx4 v4, s[52:55], s14 offen offset:0 lds
    buffer_load_dwordx4 v5, s[52:55], s14 offen offset:1024 lds
    buffer_load_dwordx4 v6, s[52:55], s14 offen offset:2048 lds
    buffer_load_dwordx4 v7, s[52:55], s14 offen offset:3072 lds
    v_mov_b32 v16, 0
    buffer_atomic_add v16, v15, s[44:47], 0 offen sc0 sc1
    s_add_u32 m0, s73, 49152
    s_lshl_b32 s14, s98, 18
    buffer_load_dwordx4 v4, s[52:55], s14 offen offset:0 lds
    buffer_load_dwordx4 v5, s[52:55], s14 offen offset:1024 lds
    buffer_load_dwordx4 v6, s[52:55], s14 offen offset:2048 lds
    buffer_load_dwordx4 v7, s[52:55], s14 offen offset:3072 lds
    s_add_u32 m0, s73, 65536
    s_lshl_b32 s14, s99, 18
    buffer_load_dwordx4 v4, s[52:55], s14 offen offset:0 lds
    buffer_load_dwordx4 v5, s[52:55], s14 offen offset:1024 lds
    buffer_load_dwordx4 v6, s[52:55], s14 offen offset:2048 lds
    buffer_load_dwordx4 v7, s[52:55], s14 offen offset:3072 lds
L_DG:
    s_waitcnt vmcnt(8)
    v_cmp_ne_u32 vcc, v13, v16
    s_cbranch_vccnz L_rs_p2G
L_ok_p2G:
    s_barrier
    s_add_u32 m0, s73, 97536
    s_nop 0
    buffer_load_dwordx4 v23, s[44:47], s18 offen offset:768 sc1 lds
    s_add_u32 m0, s73, 99328
    s_nop 0
    buffer_load_dwordx4 v20, s[44:47], s18 offen offset:0 sc1 lds
    s_add_u32 m0, s73, 99840
    s_nop 0
    buffer_load_dwordx4 v20, s[44:47], s18 offen offset:512 sc1 lds
    s_add_u32 m0, s73, 100608
    s_nop 0
    buffer_load_dwordx4 v23, s[44:47], s19 offen offset:768 sc1 lds
    s_add_u32 m0, s73, 114688
    s_nop 0
    buffer_load_dwordx4 v20, s[44:47], s19 offen offset:0 sc1 lds
    s_add_u32 m0, s73, 115200
    s_nop 0
    buffer_load_dwordx4 v20, s[44:47], s19 offen offset:512 sc1 lds
    s_add_u32 m0, s73, 115968
    s_nop 0
    buffer_load_dwordx4 v23, s[44:47], s20 offen offset:768 sc1 lds
    s_add_u32 m0, s73, 117760
    s_nop 0
    buffer_load_dwordx4 v20, s[44:47], s20 offen offset:0 sc1 lds
    v_mov_b32 v195, s68
    v_mov_b32 v199, s68
    v_mov_b32 v202, s68
    v_mov_b32 v203, s68
    s_waitcnt vmcnt(4)
    s_barrier
    ds_read_b128 v[104:107], v14 offset:0
    ds_read_b128 v[108:111], v14 offset:4096
    ds_read_b128 v[112:115], v14 offset:8192
    ds_read_b128 v[116:119], v14 offset:12288
    s_waitcnt lgkmcnt(2)
    v_mfma_f32_16x16x32_bf16 v[32:35], v[104:107], a[0:3], 0
    s_add_u32 m0, s73, 130560
    v_mfma_f32_16x16x32_bf16 v[32:35], v[108:111], a[8:11], v[32:35]
    buffer_load_dwordx4 v20, s[44:47], s20 offen offset:512 sc1 lds
    s_waitcnt lgkmcnt(0)
    v_mfma_f32_16x16x32_bf16 v[32:35], v[112:115], a[16:19], v[32:35]
    ds_read_b128 v[120:123], v14 offset:1024
    v_mfma_f32_16x16x32_bf16 v[32:35], v[116:119], a[24:27], v[32:35]
    ds_read_b128 v[124:127], v14 offset:5120
    v_mfma_f32_16x16x32_bf16 v[36:39], v[116:119], a[28:31], 0
    ds_read_b128 v[128:131], v14 offset:9216
    v_mfma_f32_16x16x32_bf16 v[36:39], v[112:115], a[20:23], v[36:39]
    ds_read_b128 v[132:135], v14 offset:13312
    v_mfma_f32_16x16x32_bf16 v[36:39], v[108:111], a[12:15], v[36:39]
    s_add_u32 m0, s73, 131328
    v_mfma_f32_16x16x32_bf16 v[36:39], v[104:107], a[4:7], v[36:39]
    buffer_load_dwordx4 v23, s[44:47], s21 offen offset:768 sc1 lds
    s_waitcnt lgkmcnt(2)
    v_mfma_f32_16x16x32_bf16 v[44:47], v[120:123], a[4:7], 0
    s_add_u32 m0, s73, 133120
    v_mfma_f32_16x16x32_bf16 v[44:47], v[124:127], a[12:15], v[44:47]
    buffer_load_dwordx4 v20, s[44:47], s21 offen offset:0 sc1 lds
    s_waitcnt lgkmcnt(0)
    v_mfma_f32_16x16x32_bf16 v[44:47], v[128:131], a[20:23], v[44:47]
    ds_read_b128 v[104:107], v14 offset:2048
    v_mfma_f32_16x16x32_bf16 v[44:47], v[132:135], a[28:31], v[44:47]
    ds_read_b128 v[108:111], v14 offset:6144
    v_mfma_f32_16x16x32_bf16 v[40:43], v[132:135], a[24:27], 0
    ds_read_b128 v[112:115], v14 offset:10240
    v_mfma_f32_16x16x32_bf16 v[40:43], v[128:131], a[16:19], v[40:43]
    ds_read_b128 v[116:119], v14 offset:14336
    v_mfma_f32_16x16x32_bf16 v[40:43], v[124:127], a[8:11], v[40:43]
    s_add_u32 m0, s73, 133632
    v_mfma_f32_16x16x32_bf16 v[40:43], v[120:123], a[0:3], v[40:43]
    buffer_load_dwordx4 v20, s[44:47], s21 offen offset:512 sc1 lds
    s_waitcnt lgkmcnt(2)
    v_mfma_f32_16x16x32_bf16 v[48:51], v[104:107], a[0:3], 0
    s_add_u32 m0, s73, 146688
    v_mfma_f32_16x16x32_bf16 v[48:51], v[108:111], a[8:11], v[48:51]
    buffer_load_dwordx4 v23, s[44:47], s22 offen offset:768 sc1 lds
    s_waitcnt lgkmcnt(0)
    v_mfma_f32_16x16x32_bf16 v[48:51], v[112:115], a[16:19], v[48:51]
    ds_read_b128 v[120:123], v14 offset:3072
    v_mfma_f32_16x16x32_bf16 v[48:51], v[116:119], a[24:27], v[48:51]
    ds_read_b128 v[124:127], v14 offset:7168
    v_mfma_f32_16x16x32_bf16 v[52:55], v[116:119], a[28:31], 0
    ds_read_b128 v[128:131], v14 offset:11264
    v_mfma_f32_16x16x32_bf16 v[52:55], v[112:115], a[20:23], v[52:55]
    ds_read_b128 v[132:135], v14 offset:15360
    v_mfma_f32_16x16x32_bf16 v[52:55], v[108:111], a[12:15], v[52:55]
    s_add_u32 m0, s73, 148480
    v_mfma_f32_16x16x32_bf16 v[52:55], v[104:107], a[4:7], v[52:55]
    buffer_load_dwordx4 v20, s[44:47], s22 offen offset:0 sc1 lds
    s_waitcnt lgkmcnt(2)
    v_mfma_f32_16x16x32_bf16 v[36:39], v[120:123], a[36:39], v[36:39]
    s_add_u32 m0, s73, 148992
    v_mfma_f32_16x16x32_bf16 v[36:39], v[124:127], a[44:47], v[36:39]
    buffer_load_dwordx4 v20, s[44:47], s22 offen offset:512 sc1 lds
    s_waitcnt lgkmcnt(0)
    v_mfma_f32_16x16x32_bf16 v[36:39], v[128:131], a[52:55], v[36:39]
    s_waitcnt vmcnt(7)
    s_barrier
    v_mfma_f32_16x16x32_bf16 v[36:39], v[132:135], a[60:63], v[36:39]
    ds_read_b128 v[104:107], v14 offset:16384
    v_add_u32 v10, -131072, v10
    v_mfma_f32_16x16x32_bf16 v[32:35], v[132:135], a[56:59], v[32:35]
    ds_read_b128 v[108:111], v14 offset:20480
    v_mfma_f32_16x16x32_bf16 v[32:35], v[128:131], a[48:51], v[32:35]
    ds_read_b128 v[112:115], v14 offset:24576
    ds_read_b64_tr_b16 a[160:161], v10 offset:32768
    v_mfma_f32_16x16x32_bf16 v[32:35], v[124:127], a[40:43], v[32:35]
    ds_read_b128 v[116:119], v14 offset:28672
    s_add_u32 m0, s73, 149760
    v_mfma_f32_16x16x32_bf16 v[32:35], v[120:123], a[32:35], v[32:35]
    buffer_load_dwordx4 v23, s[44:47], s23 offen offset:768 sc1 lds
    ds_read_b64_tr_b16 a[162:163], v10 offset:34816
    s_waitcnt lgkmcnt(4)
    v_mfma_f32_16x16x32_bf16 v[40:43], v[104:107], a[32:35], v[40:43]
    s_add_u32 m0, s73, 98304
    ds_read_b64_tr_b16 a[168:169], v10 offset:36864
    v_mfma_f32_16x16x32_bf16 v[40:43], v[108:111], a[40:43], v[40:43]
    buffer_load_dwordx4 v20, s[44:47], s23 offen offset:0 sc1 lds
    ds_read_b64_tr_b16 a[170:171], v10 offset:38912
    s_waitcnt lgkmcnt(3)
    v_mfma_f32_16x16x32_bf16 v[40:43], v[112:115], a[48:51], v[40:43]
    ds_read_b128 v[120:123], v14 offset:17408
    v_mfma_f32_16x16x32_bf16 v[40:43], v[116:119], a[56:59], v[40:43]
    ds_read_b128 v[124:127], v14 offset:21504
    v_add_u32 v11, -131072, v11
    v_mfma_f32_16x16x32_bf16 v[44:47], v[116:119], a[60:63], v[44:47]
    ds_read_b128 v[128:131], v14 offset:25600
    v_mfma_f32_16x16x32_bf16 v[44:47], v[112:115], a[52:55], v[44:47]
    ds_read_b128 v[132:135], v14 offset:29696
    v_mfma_f32_16x16x32_bf16 v[44:47], v[108:111], a[44:47], v[44:47]
    s_add_u32 m0, s73, 98816
    ds_read_b64_tr_b16 a[164:165], v11 offset:32768
    v_mfma_f32_16x16x32_bf16 v[44:47], v[104:107], a[36:39], v[44:47]
    buffer_load_dwordx4 v20, s[44:47], s23 offen offset:512 sc1 lds
    ds_read_b64_tr_b16 a[166:167], v11 offset:34816
    s_waitcnt lgkmcnt(4)
    v_mfma_f32_16x16x32_bf16 v[52:55], v[120:123], a[36:39], v[52:55]
    s_add_u32 m0, s73, 99584
    ds_read_b64_tr_b16 a[172:173], v11 offset:36864
    v_mfma_f32_16x16x32_bf16 v[52:55], v[124:127], a[44:47], v[52:55]
    buffer_load_dwordx4 v23, s[44:47], s24 offen offset:768 sc1 lds
    ds_read_b64_tr_b16 a[174:175], v11 offset:38912
    s_waitcnt lgkmcnt(4)
    v_mfma_f32_16x16x32_bf16 v[52:55], v[128:131], a[52:55], v[52:55]
    ds_read_b128 v[104:107], v14 offset:18432
    v_mfma_f32_16x16x32_bf16 v[52:55], v[132:135], a[60:63], v[52:55]
    ds_read_b128 v[108:111], v14 offset:22528
    v_add_u32 v10, 65536, v10
    v_mfma_f32_16x16x32_bf16 v[48:51], v[132:135], a[56:59], v[48:51]
    ds_read_b128 v[112:115], v14 offset:26624
    v_mfma_f32_16x16x32_bf16 v[48:51], v[128:131], a[48:51], v[48:51]
    ds_read_b128 v[116:119], v14 offset:30720
    v_mfma_f32_16x16x32_bf16 v[48:51], v[124:127], a[40:43], v[48:51]
    s_add_u32 m0, s73, 101376
    ds_read_b64_tr_b16 a[176:177], v10 offset:16384
    v_mfma_f32_16x16x32_bf16 v[48:51], v[120:123], a[32:35], v[48:51]
    buffer_load_dwordx4 v20, s[44:47], s24 offen offset:0 sc1 lds
    ds_read_b64_tr_b16 a[178:179], v10 offset:18432
    s_waitcnt lgkmcnt(4)
    v_mfma_f32_16x16x32_bf16 v[32:35], v[104:107], a[64:67], v[32:35]
    ds_read_b64_tr_b16 a[184:185], v10 offset:20480
    v_mfma_f32_16x16x32_bf16 v[32:35], v[108:111], a[72:75], v[32:35]
    ds_read_b64_tr_b16 a[186:187], v10 offset:22528
    s_waitcnt lgkmcnt(4)
    v_mfma_f32_16x16x32_bf16 v[32:35], v[112:115], a[80:83], v[32:35]
    ds_read_b128 v[120:123], v14 offset:19456
    v_mfma_f32_16x16x32_bf16 v[32:35], v[116:119], a[88:91], v[32:35]
    ds_read_b128 v[124:127], v14 offset:23552
    v_add_u32 v11, 65536, v11
    v_mfma_f32_16x16x32_bf16 v[36:39], v[116:119], a[92:95], v[36:39]
    ds_read_b128 v[128:131], v14 offset:27648
    v_mfma_f32_16x16x32_bf16 v[36:39], v[112:115], a[84:87], v[36:39]
    ds_read_b128 v[132:135], v14 offset:31744
    v_mfma_f32_16x16x32_bf16 v[36:39], v[108:111], a[76:79], v[36:39]
    ds_read_b64_tr_b16 a[180:181], v11 offset:16384
    v_mfma_f32_16x16x32_bf16 v[36:39], v[104:107], a[68:71], v[36:39]
    ds_read_b64_tr_b16 a[182:183], v11 offset:18432
    s_waitcnt lgkmcnt(4)
    v_mfma_f32_16x16x32_bf16 v[44:47], v[120:123], a[68:71], v[44:47]
    ds_read_b64_tr_b16 a[188:189], v11 offset:20480
    v_mfma_f32_16x16x32_bf16 v[44:47], v[124:127], a[76:79], v[44:47]
    ds_read_b64_tr_b16 a[190:191], v11 offset:22528
    s_waitcnt lgkmcnt(4)
    v_mfma_f32_16x16x32_bf16 v[44:47], v[128:131], a[84:87], v[44:47]
    s_waitcnt vmcnt(8) lgkmcnt(0)
    s_barrier
    v_mfma_f32_16x16x32_bf16 v[44:47], v[132:135], a[92:95], v[44:47]
    ds_read_b128 v[104:107], v14 offset:32768
    s_lshl_b32 s14, s100, 18
    s_add_u32 m0, s73, 32768
    v_add_u32 v10, -65536, v10
    v_mfma_f32_16x16x32_bf16 v[40:43], v[132:135], a[88:91], v[40:43]
    ds_read_b128 v[108:111], v14 offset:36864
    buffer_load_dwordx4 v4, s[52:55], s14 offen offset:0 lds
    v_mfma_f32_16x16x32_bf16 v[40:43], v[128:131], a[80:83], v[40:43]
    ds_read_b128 v[112:115], v14 offset:40960
    ds_read_b64_tr_b16 a[192:193], v10 offset:0
    v_mfma_f32_16x16x32_bf16 v[40:43], v[124:127], a[72:75], v[40:43]
    ds_read_b128 v[116:119], v14 offset:45056
    v_mfma_f32_16x16x32_bf16 v[40:43], v[120:123], a[64:67], v[40:43]
    ds_read_b64_tr_b16 a[194:195], v10 offset:2048
    s_waitcnt lgkmcnt(4)
    v_mfma_f32_16x16x32_bf16 v[48:51], v[104:107], a[64:67], v[48:51]
    s_add_u32 m0, s73, 114176
    ds_read_b64_tr_b16 a[200:201], v10 offset:4096
    v_mfma_f32_16x16x32_bf16 v[48:51], v[108:111], a[72:75], v[48:51]
    buffer_load_dwordx4 v20, s[44:47], s24 offen offset:512 sc1 lds
    ds_read_b64_tr_b16 a[202:203], v10 offset:6144
    s_waitcnt lgkmcnt(3)
    v_mfma_f32_16x16x32_bf16 v[48:51], v[112:115], a[80:83], v[48:51]
    ds_read_b128 v[120:123], v14 offset:33792
    s_add_u32 m0, s73, 32768
    v_lshrrev_b32 v30, 2, v26
    v_mfma_f32_16x16x32_bf16 v[48:51], v[116:119], a[88:91], v[48:51]
    ds_read_b128 v[124:127], v14 offset:37888
    buffer_load_dwordx4 v5, s[52:55], s14 offen offset:1024 lds
    v_mfma_f32_16x16x32_bf16 v[52:55], v[116:119], a[92:95], v[52:55]
    ds_read_b128 v[128:131], v14 offset:41984
    v_add_u32 v11, -65536, v11
    v_mfma_f32_16x16x32_bf16 v[52:55], v[112:115], a[84:87], v[52:55]
    ds_read_b128 v[132:135], v14 offset:46080
    v_mfma_f32_16x16x32_bf16 v[52:55], v[108:111], a[76:79], v[52:55]
    s_add_u32 m0, s73, 114944
    ds_read_b64_tr_b16 a[196:197], v11 offset:0
    v_mfma_f32_16x16x32_bf16 v[52:55], v[104:107], a[68:71], v[52:55]
    buffer_load_dwordx4 v23, s[44:47], s25 offen offset:768 sc1 lds
    ds_read_b64_tr_b16 a[198:199], v11 offset:2048
    s_waitcnt lgkmcnt(4)
    v_mfma_f32_16x16x32_bf16 v[36:39], v[120:123], a[100:103], v[36:39]
    s_add_u32 m0, s73, 116736
    ds_read_b64_tr_b16 a[204:205], v11 offset:4096
    v_mfma_f32_16x16x32_bf16 v[36:39], v[124:127], a[108:111], v[36:39]
    buffer_load_dwordx4 v20, s[44:47], s25 offen offset:0 sc1 lds
    ds_read_b64_tr_b16 a[206:207], v11 offset:6144
    s_waitcnt lgkmcnt(4)
    v_mfma_f32_16x16x32_bf16 v[36:39], v[128:131], a[116:119], v[36:39]
    ds_read_b128 v[104:107], v14 offset:34816
    s_add_u32 m0, s73, 32768
    v_lshrrev_b32 v31, 2, v18
    v_mfma_f32_16x16x32_bf16 v[36:39], v[132:135], a[124:127], v[36:39]
    ds_read_b128 v[108:111], v14 offset:38912
    buffer_load_dwordx4 v6, s[52:55], s14 offen offset:2048 lds
    v_mfma_f32_16x16x32_bf16 v[32:35], v[132:135], a[120:123], v[32:35]
    ds_read_b128 v[112:115], v14 offset:43008
    v_mfma_f32_16x16x32_bf16 v[32:35], v[128:131], a[112:115], v[32:35]
    ds_read_b128 v[116:119], v14 offset:47104
    v_mfma_f32_16x16x32_bf16 v[32:35], v[124:127], a[104:107], v[32:35]
    s_add_u32 m0, s73, 117248
    ds_read_b64_tr_b16 a[208:209], v10 offset:16384
    v_mfma_f32_16x16x32_bf16 v[32:35], v[120:123], a[96:99], v[32:35]
    buffer_load_dwordx4 v20, s[44:47], s25 offen offset:512 sc1 lds
    ds_read_b64_tr_b16 a[210:211], v10 offset:18432
    s_waitcnt lgkmcnt(4)
    v_mfma_f32_16x16x32_bf16 v[40:43], v[104:107], a[96:99], v[40:43]
    ds_read_b64_tr_b16 a[216:217], v10 offset:20480
    buffer_load_ushort v102, v30, s[60:63], 0 offen offset:0
    s_add_u32 m0, s73, 32768
    v_mfma_f32_16x16x32_bf16 v[40:43], v[108:111], a[104:107], v[40:43]
    ds_read_b64_tr_b16 a[218:219], v10 offset:22528
    buffer_load_dwordx4 v7, s[52:55], s14 offen offset:3072 lds
    s_waitcnt lgkmcnt(4)
    v_mfma_f32_16x16x32_bf16 v[40:43], v[112:115], a[112:115], v[40:43]
    ds_read_b128 v[120:123], v14 offset:35840
    v_mfma_f32_16x16x32_bf16 v[40:43], v[116:119], a[120:123], v[40:43]
    ds_read_b128 v[124:127], v14 offset:39936
    v_mfma_f32_16x16x32_bf16 v[44:47], v[116:119], a[124:127], v[44:47]
    ds_read_b128 v[128:131], v14 offset:44032
    v_mfma_f32_16x16x32_bf16 v[44:47], v[112:115], a[116:119], v[44:47]
    ds_read_b128 v[132:135], v14 offset:48128
    v_mfma_f32_16x16x32_bf16 v[44:47], v[108:111], a[108:111], v[44:47]
    ds_read_b64_tr_b16 a[212:213], v11 offset:16384
    buffer_load_ushort v103, v30, s[60:63], 0 offen offset:32
    v_mfma_f32_16x16x32_bf16 v[44:47], v[104:107], a[100:103], v[44:47]
    ds_read_b64_tr_b16 a[214:215], v11 offset:18432
    s_waitcnt lgkmcnt(4)
    v_mfma_f32_16x16x32_bf16 v[52:55], v[120:123], a[100:103], v[52:55]
    ds_read_b64_tr_b16 a[220:221], v11 offset:20480
    v_mfma_f32_16x16x32_bf16 v[52:55], v[124:127], a[108:111], v[52:55]
    ds_read_b64_tr_b16 a[222:223], v11 offset:22528
    s_waitcnt lgkmcnt(4)
    v_mfma_f32_16x16x32_bf16 v[52:55], v[128:131], a[116:119], v[52:55]
    s_waitcnt vmcnt(14) lgkmcnt(0)
    s_barrier
    v_mfma_f32_16x16x32_bf16 v[52:55], v[132:135], a[124:127], v[52:55]
    ds_read_b128 v[104:107], v14 offset:49152
    s_lshl_b32 s14, s101, 18
    ds_read_b64_tr_b16 a[224:225], v10 offset:49152
    s_add_u32 m0, s73, 81920
    v_mfma_f32_16x16x32_bf16 v[48:51], v[132:135], a[120:123], v[48:51]
    ds_read_b128 v[108:111], v14 offset:53248
    buffer_load_dwordx4 v4, s[52:55], s14 offen offset:0 lds
    v_mfma_f32_16x16x32_bf16 v[48:51], v[128:131], a[112:115], v[48:51]
    ds_read_b128 v[112:115], v14 offset:57344
    buffer_load_ushort v27, v31, s[60:63], 0 offen offset:0
    v_mfma_f32_16x16x32_bf16 v[48:51], v[124:127], a[104:107], v[48:51]
    ds_read_b128 v[116:119], v14 offset:61440
    v_mfma_f32_16x16x32_bf16 v[48:51], v[120:123], a[96:99], v[48:51]
    ds_read_b64_tr_b16 a[226:227], v10 offset:51200
    s_waitcnt lgkmcnt(3)
    v_mfma_f32_16x16x32_bf16 v[32:35], v[104:107], a[128:131], v[32:35]
    s_add_u32 m0, s73, 130304
    ds_read_b64_tr_b16 a[232:233], v10 offset:53248
    v_mfma_f32_16x16x32_bf16 v[32:35], v[108:111], a[136:139], v[32:35]
    buffer_load_dwordx4 v23, s[44:47], s26 offen offset:768 sc1 lds
    ds_read_b64_tr_b16 a[234:235], v10 offset:55296
    s_waitcnt lgkmcnt(3)
    v_mfma_f32_16x16x32_bf16 v[32:35], v[112:115], a[144:147], v[32:35]
    ds_read_b128 v[120:123], v14 offset:50176
    s_add_u32 m0, s73, 81920
    v_mfma_f32_16x16x32_bf16 v[32:35], v[116:119], a[152:155], v[32:35]
    ds_read_b128 v[124:127], v14 offset:54272
    buffer_load_dwordx4 v5, s[52:55], s14 offen offset:1024 lds
    v_mfma_f32_16x16x32_bf16 v[36:39], v[116:119], a[156:159], v[36:39]
    ds_read_b128 v[128:131], v14 offset:58368
    v_mfma_f32_16x16x32_bf16 v[36:39], v[112:115], a[148:151], v[36:39]
    ds_read_b128 v[132:135], v14 offset:62464
    v_mfma_f32_16x16x32_bf16 v[36:39], v[108:111], a[140:143], v[36:39]
    s_add_u32 m0, s73, 132096
    ds_read_b64_tr_b16 a[228:229], v11 offset:49152
    v_mfma_f32_16x16x32_bf16 v[36:39], v[104:107], a[132:135], v[36:39]
    buffer_load_dwordx4 v20, s[44:47], s26 offen offset:0 sc1 lds
    ds_read_b64_tr_b16 a[230:231], v11 offset:51200
    s_waitcnt lgkmcnt(4)
    v_mfma_f32_16x16x32_bf16 v[44:47], v[120:123], a[132:135], v[44:47]
    ds_read_b64_tr_b16 a[236:237], v11 offset:53248
    buffer_load_dwordx4 v[88:91], v252, s[56:59], 0 offen
    s_add_u32 m0, s73, 132608
    v_mfma_f32_16x16x32_bf16 v[44:47], v[124:127], a[140:143], v[44:47]
    buffer_load_dwordx4 v20, s[44:47], s26 offen offset:512 sc1 lds
    ds_read_b64_tr_b16 a[238:239], v11 offset:55296
    s_waitcnt lgkmcnt(4)
    v_mfma_f32_16x16x32_bf16 v[44:47], v[128:131], a[148:151], v[44:47]
    ds_read_b128 v[104:107], v14 offset:51200
    s_add_u32 m0, s73, 81920
    v_add_u32 v10, 65536, v10
    v_mfma_f32_16x16x32_bf16 v[44:47], v[132:135], a[156:159], v[44:47]
    ds_read_b128 v[108:111], v14 offset:55296
    buffer_load_dwordx4 v6, s[52:55], s14 offen offset:2048 lds
    v_mfma_f32_16x16x32_bf16 v[40:43], v[132:135], a[152:155], v[40:43]
    ds_read_b128 v[112:115], v14 offset:59392
    v_mfma_f32_16x16x32_bf16 v[40:43], v[128:131], a[144:147], v[40:43]
    ds_read_b128 v[116:119], v14 offset:63488
    v_mfma_f32_16x16x32_bf16 v[40:43], v[124:127], a[136:139], v[40:43]
    s_add_u32 m0, s73, 134144
    ds_read_b64_tr_b16 a[240:241], v10 offset:0
    v_mfma_f32_16x16x32_bf16 v[40:43], v[120:123], a[128:131], v[40:43]
    buffer_load_dwordx4 v21, s[44:47], s18 offen offset:0 sc1 lds
    ds_read_b64_tr_b16 a[242:243], v10 offset:2048
    s_waitcnt lgkmcnt(4)
    v_mfma_f32_16x16x32_bf16 v[48:51], v[104:107], a[128:131], v[48:51]
    ds_read_b64_tr_b16 a[248:249], v10 offset:4096
    s_add_u32 m0, s73, 81920
    v_mfma_f32_16x16x32_bf16 v[48:51], v[108:111], a[136:139], v[48:51]
    ds_read_b64_tr_b16 a[250:251], v10 offset:6144
    buffer_load_dwordx4 v7, s[52:55], s14 offen offset:3072 lds
    s_waitcnt lgkmcnt(4)
    v_mfma_f32_16x16x32_bf16 v[48:51], v[112:115], a[144:147], v[48:51]
    ds_read_b128 v[120:123], v14 offset:52224
    v_add_u32 v11, 65536, v11
    v_mfma_f32_16x16x32_bf16 v[48:51], v[116:119], a[152:155], v[48:51]
    ds_read_b128 v[124:127], v14 offset:56320
    v_mfma_f32_16x16x32_bf16 v[52:55], v[116:119], a[156:159], v[52:55]
    ds_read_b128 v[128:131], v14 offset:60416
    v_mfma_f32_16x16x32_bf16 v[52:55], v[112:115], a[148:151], v[52:55]
    ds_read_b128 v[132:135], v14 offset:64512
    v_mfma_f32_16x16x32_bf16 v[52:55], v[108:111], a[140:143], v[52:55]
    ds_read_b64_tr_b16 a[244:245], v11 offset:0
    v_mfma_f32_16x16x32_bf16 v[52:55], v[104:107], a[132:135], v[52:55]
    ds_read_b64_tr_b16 a[246:247], v11 offset:2048
    s_waitcnt lgkmcnt(4)
    v_mfma_f32_16x16x32_bf16 v[36:39], v[120:123], a[164:167], v[36:39]
    ds_read_b64_tr_b16 a[252:253], v11 offset:4096
    buffer_load_dwordx4 v[92:95], v252, s[56:59], s40 offen
    v_mfma_f32_16x16x32_bf16 v[36:39], v[124:127], a[172:175], v[36:39]
    ds_read_b64_tr_b16 a[254:255], v11 offset:6144
    s_waitcnt lgkmcnt(4)
    v_mfma_f32_16x16x32_bf16 v[36:39], v[128:131], a[180:183], v[36:39]
    s_waitcnt vmcnt(12) lgkmcnt(0)
    s_barrier
    v_mfma_f32_16x16x32_bf16 v[36:39], v[132:135], a[188:191], v[36:39]
    ds_read_b128 v[104:107], v14 offset:0
    v_mfma_f32_16x16x32_bf16 v[32:35], v[132:135], a[184:187], v[32:35]
    ds_read_b128 v[108:111], v14 offset:4096
    v_add_u32 v10, -65536, v10
    v_mfma_f32_16x16x32_bf16 v[32:35], v[128:131], a[176:179], v[32:35]
    ds_read_b128 v[112:115], v14 offset:8192
    v_mfma_f32_16x16x32_bf16 v[32:35], v[124:127], a[168:171], v[32:35]
    ds_read_b128 v[116:119], v14 offset:12288
    v_mfma_f32_16x16x32_bf16 v[32:35], v[120:123], a[160:163], v[32:35]
    ds_read_b64_tr_b16 v[220:221], v10 offset:32768
L_pl_G_6:
    s_cbranch_execz L_wret
    s_waitcnt lgkmcnt(3)
    v_mfma_f32_16x16x32_bf16 v[40:43], v[104:107], a[160:163], v[40:43]
    s_add_u32 m0, s73, 146944
    v_mfma_f32_16x16x32_bf16 v[40:43], v[108:111], a[168:171], v[40:43]
    buffer_load_dwordx4 v21, s[44:47], s18 offen offset:512 sc1 lds
    ds_read_b64_tr_b16 v[222:223], v10 offset:34816
    s_waitcnt lgkmcnt(2)
    v_mfma_f32_16x16x32_bf16 v[40:43], v[112:115], a[176:179], v[40:43]
    ds_read_b128 v[120:123], v14 offset:1024
    v_mfma_f32_16x16x32_bf16 v[40:43], v[116:119], a[184:187], v[40:43]
    ds_read_b128 v[124:127], v14 offset:5120
    v_mfma_f32_16x16x32_bf16 v[44:47], v[116:119], a[188:191], v[44:47]
    ds_read_b128 v[128:131], v14 offset:9216
    v_mfma_f32_16x16x32_bf16 v[44:47], v[112:115], a[180:183], v[44:47]
    ds_read_b128 v[132:135], v14 offset:13312
    v_mfma_f32_16x16x32_bf16 v[44:47], v[108:111], a[172:175], v[44:47]
    s_add_u32 m0, s73, 148480
    ds_read_b64_tr_b16 v[228:229], v10 offset:36864
    v_mfma_f32_16x16x32_bf16 v[44:47], v[104:107], a[164:167], v[44:47]
    buffer_load_dwordx4 v21, s[44:47], s19 offen offset:0 sc1 lds
    s_waitcnt lgkmcnt(3)
    v_mfma_f32_16x16x32_bf16 v[52:55], v[120:123], a[164:167], v[52:55]
    ds_read_b64_tr_b16 v[230:231], v10 offset:38912
    buffer_load_dwordx2 v[142:143], v253, s[56:59], 0 offen
    s_add_u32 m0, s73, 148992
    v_mfma_f32_16x16x32_bf16 v[52:55], v[124:127], a[172:175], v[52:55]
    buffer_load_dwordx4 v21, s[44:47], s19 offen offset:512 sc1 lds
    s_waitcnt lgkmcnt(2)
    v_mfma_f32_16x16x32_bf16 v[52:55], v[128:131], a[180:183], v[52:55]
    ds_read_b128 v[104:107], v14 offset:2048
    v_mfma_f32_16x16x32_bf16 v[52:55], v[132:135], a[188:191], v[52:55]
    ds_read_b128 v[108:111], v14 offset:6144
    v_mfma_f32_16x16x32_bf16 v[48:51], v[132:135], a[184:187], v[48:51]
    ds_read_b128 v[112:115], v14 offset:10240
    v_add_u32 v11, -65536, v11
    v_mfma_f32_16x16x32_bf16 v[48:51], v[128:131], a[176:179], v[48:51]
    ds_read_b128 v[116:119], v14 offset:14336
    v_mfma_f32_16x16x32_bf16 v[48:51], v[124:127], a[168:171], v[48:51]
    s_add_u32 m0, s73, 150528
    v_mfma_f32_16x16x32_bf16 v[48:51], v[120:123], a[160:163], v[48:51]
    buffer_load_dwordx4 v21, s[44:47], s20 offen offset:0 sc1 lds
    ds_read_b64_tr_b16 v[224:225], v11 offset:32768
    s_waitcnt lgkmcnt(3)
    v_mfma_f32_16x16x32_bf16 v[32:35], v[104:107], a[192:195], v[32:35]
    v_mfma_f32_16x16x32_bf16 v[32:35], v[108:111], a[200:203], v[32:35]
    ds_read_b64_tr_b16 v[226:227], v11 offset:34816
    s_waitcnt vmcnt(14)
    s_waitcnt lgkmcnt(2)
    v_mfma_f32_16x16x32_bf16 v[32:35], v[112:115], a[208:211], v[32:35]
    ds_read_b128 v[120:123], v14 offset:3072
    v_mfma_f32_16x16x32_bf16 v[32:35], v[116:119], a[216:219], v[32:35]
    ds_read_b128 v[124:127], v14 offset:7168
    v_mfma_f32_16x16x32_bf16 v[36:39], v[116:119], a[220:223], v[36:39]
    ds_read_b128 v[128:131], v14 offset:11264
    v_lshlrev_b32 v72, 16, v102
    v_mfma_f32_16x16x32_bf16 v[36:39], v[112:115], a[212:215], v[36:39]
    ds_read_b128 v[132:135], v14 offset:15360
    v_mfma_f32_16x16x32_bf16 v[36:39], v[108:111], a[204:207], v[36:39]
    ds_read_b64_tr_b16 v[232:233], v11 offset:36864
    v_lshlrev_b32 v73, 16, v102
    v_mfma_f32_16x16x32_bf16 v[36:39], v[104:107], a[196:199], v[36:39]
    s_waitcnt lgkmcnt(3)
    v_mfma_f32_16x16x32_bf16 v[44:47], v[120:123], a[196:199], v[44:47]
    ds_read_b64_tr_b16 v[234:235], v11 offset:38912
    buffer_load_dwordx2 v[96:97], v26, s[44:47], s42 offen offset:0 sc1
    v_mfma_f32_16x16x32_bf16 v[44:47], v[124:127], a[204:207], v[44:47]
    v_lshlrev_b32 v74, 16, v102
    s_waitcnt lgkmcnt(2)
    v_mfma_f32_16x16x32_bf16 v[44:47], v[128:131], a[212:215], v[44:47]
    s_waitcnt vmcnt(7) lgkmcnt(0)
    s_barrier
    v_mfma_f32_16x16x32_bf16 v[44:47], v[132:135], a[220:223], v[44:47]
    ds_read_b128 v[104:107], v14 offset:16384
    v_lshlrev_b32 v75, 16, v102
    v_mfma_f32_16x16x32_bf16 v[40:43], v[132:135], a[216:219], v[40:43]
    ds_read_b128 v[108:111], v14 offset:20480
    v_add_u32 v10, 65536, v10
    v_mfma_f32_16x16x32_bf16 v[40:43], v[128:131], a[208:211], v[40:43]
    ds_read_b128 v[112:115], v14 offset:24576
    v_mfma_f32_16x16x32_bf16 v[40:43], v[124:127], a[200:203], v[40:43]
    ds_read_b128 v[116:119], v14 offset:28672
    v_lshlrev_b32 v76, 16, v103
    v_mfma_f32_16x16x32_bf16 v[40:43], v[120:123], a[192:195], v[40:43]
    ds_read_b64_tr_b16 v[236:237], v10 offset:16384
    s_waitcnt lgkmcnt(3)
    v_mfma_f32_16x16x32_bf16 v[48:51], v[104:107], a[192:195], v[48:51]
    s_add_u32 m0, s73, 97792
    v_lshlrev_b32 v77, 16, v103
    v_mfma_f32_16x16x32_bf16 v[48:51], v[108:111], a[200:203], v[48:51]
    buffer_load_dwordx4 v21, s[44:47], s20 offen offset:512 sc1 lds
    ds_read_b64_tr_b16 v[238:239], v10 offset:18432
    s_waitcnt lgkmcnt(2)
    v_mfma_f32_16x16x32_bf16 v[48:51], v[112:115], a[208:211], v[48:51]
    ds_read_b128 v[120:123], v14 offset:17408
    v_mfma_f32_16x16x32_bf16 v[48:51], v[116:119], a[216:219], v[48:51]
    ds_read_b128 v[124:127], v14 offset:21504
    v_mfma_f32_16x16x32_bf16 v[52:55], v[116:119], a[220:223], v[52:55]
    ds_read_b128 v[128:131], v14 offset:25600
    v_lshlrev_b32 v78, 16, v103
    v_mfma_f32_16x16x32_bf16 v[52:55], v[112:115], a[212:215], v[52:55]
    ds_read_b128 v[132:135], v14 offset:29696
    v_mfma_f32_16x16x32_bf16 v[52:55], v[108:111], a[204:207], v[52:55]
    ds_read_b64_tr_b16 v[244:245], v10 offset:20480
    s_add_u32 m0, s73, 99328
    v_lshlrev_b32 v79, 16, v103
    v_mfma_f32_16x16x32_bf16 v[52:55], v[104:107], a[196:199], v[52:55]
    buffer_load_dwordx4 v21, s[44:47], s21 offen offset:0 sc1 lds
    s_waitcnt lgkmcnt(3)
    v_mfma_f32_16x16x32_bf16 v[36:39], v[120:123], a[228:231], v[36:39]
    ds_read_b64_tr_b16 v[246:247], v10 offset:22528
    buffer_load_dwordx2 v[98:99], v26, s[44:47], s42 offen offset:128 sc1
    s_add_u32 m0, s73, 99840
    v_mfma_f32_16x16x32_bf16 v[36:39], v[124:127], a[236:239], v[36:39]
    buffer_load_dwordx4 v21, s[44:47], s21 offen offset:512 sc1 lds
    s_waitcnt lgkmcnt(2)
    v_mfma_f32_16x16x32_bf16 v[36:39], v[128:131], a[244:247], v[36:39]
    ds_read_b128 v[104:107], v14 offset:18432
    v_lshlrev_b32 v80, 16, v102
    v_mfma_f32_16x16x32_bf16 v[36:39], v[132:135], a[252:255], v[36:39]
    ds_read_b128 v[108:111], v14 offset:22528
    v_lshlrev_b32 v81, 16, v102
    v_mfma_f32_16x16x32_bf16 v[32:35], v[132:135], a[248:251], v[32:35]
    ds_read_b128 v[112:115], v14 offset:26624
    v_add_u32 v11, 65536, v11
    v_mfma_f32_16x16x32_bf16 v[32:35], v[128:131], a[240:243], v[32:35]
    ds_read_b128 v[116:119], v14 offset:30720
    v_mfma_f32_16x16x32_bf16 v[32:35], v[124:127], a[232:235], v[32:35]
    s_add_u32 m0, s73, 101376
    v_lshlrev_b32 v82, 16, v102
    v_mfma_f32_16x16x32_bf16 v[32:35], v[120:123], a[224:227], v[32:35]
    buffer_load_dwordx4 v21, s[44:47], s22 offen offset:0 sc1 lds
    ds_read_b64_tr_b16 v[240:241], v11 offset:16384
    s_waitcnt lgkmcnt(3)
    v_mfma_f32_16x16x32_bf16 v[40:43], v[104:107], a[224:227], v[40:43]
    v_lshlrev_b32 v83, 16, v102
    v_mfma_f32_16x16x32_bf16 v[40:43], v[108:111], a[232:235], v[40:43]
    ds_read_b64_tr_b16 v[242:243], v11 offset:18432
    s_waitcnt lgkmcnt(2)
    v_mfma_f32_16x16x32_bf16 v[40:43], v[112:115], a[240:243], v[40:43]
    ds_read_b128 v[120:123], v14 offset:19456
    v_mfma_f32_16x16x32_bf16 v[40:43], v[116:119], a[248:251], v[40:43]
    ds_read_b128 v[124:127], v14 offset:23552
    v_mfma_f32_16x16x32_bf16 v[44:47], v[116:119], a[252:255], v[44:47]
    ds_read_b128 v[128:131], v14 offset:27648
    v_lshlrev_b32 v84, 16, v103
    v_mfma_f32_16x16x32_bf16 v[44:47], v[112:115], a[244:247], v[44:47]
    ds_read_b128 v[132:135], v14 offset:31744
    v_mfma_f32_16x16x32_bf16 v[44:47], v[108:111], a[236:239], v[44:47]
    ds_read_b64_tr_b16 v[248:249], v11 offset:20480
    v_lshlrev_b32 v85, 16, v103
    v_mfma_f32_16x16x32_bf16 v[44:47], v[104:107], a[228:231], v[44:47]
    s_waitcnt lgkmcnt(3)
    v_mfma_f32_16x16x32_bf16 v[52:55], v[120:123], a[228:231], v[52:55]
    ds_read_b64_tr_b16 v[250:251], v11 offset:22528
    buffer_load_dwordx2 v[100:101], v18, s[44:47], s42 offen offset:0 sc1
    v_mfma_f32_16x16x32_bf16 v[52:55], v[124:127], a[236:239], v[52:55]
    v_lshlrev_b32 v86, 16, v103
    s_waitcnt lgkmcnt(2)
    v_mfma_f32_16x16x32_bf16 v[52:55], v[128:131], a[244:247], v[52:55]
    s_waitcnt lgkmcnt(0)
    s_barrier
    v_mfma_f32_16x16x32_bf16 v[52:55], v[132:135], a[252:255], v[52:55]
    ds_read_b128 v[104:107], v14 offset:32768
    v_mfma_f32_16x16x32_bf16 v[48:51], v[132:135], a[248:251], v[48:51]
    ds_read_b128 v[108:111], v14 offset:36864
    v_lshlrev_b32 v87, 16, v103
    v_mfma_f32_16x16x32_bf16 v[48:51], v[128:131], a[240:243], v[48:51]
    ds_read_b128 v[112:115], v14 offset:40960
    v_mfma_f32_16x16x32_bf16 v[48:51], v[124:127], a[232:235], v[48:51]
    ds_read_b128 v[116:119], v14 offset:45056
    v_lshlrev_b32 v27, 16, v27
    v_mfma_f32_16x16x32_bf16 v[48:51], v[120:123], a[224:227], v[48:51]
L_Dc:
L_pl_D_0:
    s_cbranch_execz L_wret
    s_waitcnt lgkmcnt(2)
    v_mfma_f32_16x16x32_bf16 v[32:35], v[104:107], v[220:223], v[32:35]
    s_add_u32 m0, s73, 114176
    v_mfma_f32_16x16x32_bf16 v[32:35], v[108:111], v[228:231], v[32:35]
    buffer_load_dwordx4 v21, s[44:47], s22 offen offset:512 sc1 lds
    s_waitcnt lgkmcnt(0)
    v_mfma_f32_16x16x32_bf16 v[32:35], v[112:115], v[236:239], v[32:35]
    ds_read_b128 v[120:123], v14 offset:33792
    v_mfma_f32_16x16x32_bf16 v[32:35], v[116:119], v[244:247], v[32:35]
    ds_read_b128 v[124:127], v14 offset:37888
    v_mfma_f32_16x16x32_bf16 v[36:39], v[116:119], v[248:251], v[36:39]
    ds_read_b128 v[128:131], v14 offset:41984
    buffer_load_dword v189, v188, s[44:47], 0 offen sc1
    v_mfma_f32_16x16x32_bf16 v[36:39], v[112:115], v[240:243], v[36:39]
    ds_read_b128 v[132:135], v14 offset:46080
    v_mfma_f32_16x16x32_bf16 v[36:39], v[108:111], v[232:235], v[36:39]
    s_add_u32 m0, s73, 115712
    v_mfma_f32_16x16x32_bf16 v[36:39], v[104:107], v[224:227], v[36:39]
    buffer_load_dwordx4 v21, s[44:47], s23 offen offset:0 sc1 lds
    s_waitcnt lgkmcnt(2)
    v_mfma_f32_16x16x32_bf16 v[44:47], v[120:123], v[224:227], v[44:47]
    s_add_u32 m0, s73, 116224
    v_mfma_f32_16x16x32_bf16 v[44:47], v[124:127], v[232:235], v[44:47]
    buffer_load_dwordx4 v21, s[44:47], s23 offen offset:512 sc1 lds
    s_waitcnt lgkmcnt(0)
    v_mfma_f32_16x16x32_bf16 v[44:47], v[128:131], v[240:243], v[44:47]
    ds_read_b128 v[104:107], v14 offset:34816
    v_mfma_f32_16x16x32_bf16 v[44:47], v[132:135], v[248:251], v[44:47]
    ds_read_b128 v[108:111], v14 offset:38912
    v_mfma_f32_16x16x32_bf16 v[40:43], v[132:135], v[244:247], v[40:43]
    ds_read_b128 v[112:115], v14 offset:43008
    v_mfma_f32_16x16x32_bf16 v[40:43], v[128:131], v[236:239], v[40:43]
    ds_read_b128 v[116:119], v14 offset:47104
    v_mfma_f32_16x16x32_bf16 v[40:43], v[124:127], v[228:231], v[40:43]
    s_add_u32 m0, s73, 117760
    v_mfma_f32_16x16x32_bf16 v[40:43], v[120:123], v[220:223], v[40:43]
    buffer_load_dwordx4 v21, s[44:47], s24 offen offset:0 sc1 lds
    s_waitcnt lgkmcnt(2)
    v_mfma_f32_16x16x32_bf16 v[48:51], v[104:107], v[220:223], v[48:51]
    v_mfma_f32_16x16x32_bf16 v[48:51], v[108:111], v[228:231], v[48:51]
    s_waitcnt lgkmcnt(0)
    v_mfma_f32_16x16x32_bf16 v[48:51], v[112:115], v[236:239], v[48:51]
    ds_read_b128 v[120:123], v14 offset:35840
    v_mfma_f32_16x16x32_bf16 v[48:51], v[116:119], v[244:247], v[48:51]
    ds_read_b128 v[124:127], v14 offset:39936
    v_mfma_f32_16x16x32_bf16 v[52:55], v[116:119], v[248:251], v[52:55]
    ds_read_b128 v[128:131], v14 offset:44032
    v_mfma_f32_16x16x32_bf16 v[52:55], v[112:115], v[240:243], v[52:55]
    ds_read_b128 v[132:135], v14 offset:48128
    v_mfma_f32_16x16x32_bf16 v[52:55], v[108:111], v[232:235], v[52:55]
    v_mfma_f32_16x16x32_bf16 v[52:55], v[104:107], v[224:227], v[52:55]
    s_waitcnt lgkmcnt(2)
    v_mfma_f32_16x16x32_bf16 v[60:63], v[120:123], a[4:7], 0
    v_mfma_f32_16x16x32_bf16 v[60:63], v[124:127], a[12:15], v[60:63]
    s_waitcnt lgkmcnt(0)
    v_mfma_f32_16x16x32_bf16 v[60:63], v[128:131], a[20:23], v[60:63]
    s_waitcnt vmcnt(12)
    s_barrier
    v_mfma_f32_16x16x32_bf16 v[60:63], v[132:135], a[28:31], v[60:63]
    ds_read_b128 v[104:107], v14 offset:49152
    v_mfma_f32_16x16x32_bf16 v[56:59], v[132:135], a[24:27], 0
    ds_read_b128 v[108:111], v14 offset:53248
    v_mfma_f32_16x16x32_bf16 v[56:59], v[128:131], a[16:19], v[56:59]
    ds_read_b128 v[112:115], v14 offset:57344
    v_cvt_pk_bf16_f32 v192, v32, v33
    v_mfma_f32_16x16x32_bf16 v[56:59], v[124:127], a[8:11], v[56:59]
    ds_read_b128 v[116:119], v14 offset:61440
    v_mfma_f32_16x16x32_bf16 v[56:59], v[120:123], a[0:3], v[56:59]
    s_waitcnt lgkmcnt(2)
    v_mfma_f32_16x16x32_bf16 v[64:67], v[104:107], a[0:3], 0
    s_add_u32 m0, s73, 130560
    v_mfma_f32_16x16x32_bf16 v[64:67], v[108:111], a[8:11], v[64:67]
    buffer_load_dwordx4 v21, s[44:47], s24 offen offset:512 sc1 lds
    s_waitcnt lgkmcnt(0)
    v_mfma_f32_16x16x32_bf16 v[64:67], v[112:115], a[16:19], v[64:67]
    ds_read_b128 v[120:123], v14 offset:50176
    v_cvt_pk_bf16_f32 v193, v34, v35
    v_mfma_f32_16x16x32_bf16 v[64:67], v[116:119], a[24:27], v[64:67]
    ds_read_b128 v[124:127], v14 offset:54272
    v_mfma_f32_16x16x32_bf16 v[68:71], v[116:119], a[28:31], 0
    ds_read_b128 v[128:131], v14 offset:58368
    v_mfma_f32_16x16x32_bf16 v[68:71], v[112:115], a[20:23], v[68:71]
    buffer_store_dwordx4 v[192:195], v136, s[44:47], s32 offen sc1
    ds_read_b128 v[132:135], v14 offset:62464
    v_mfma_f32_16x16x32_bf16 v[68:71], v[108:111], a[12:15], v[68:71]
    s_add_u32 m0, s73, 132096
    v_mfma_f32_16x16x32_bf16 v[68:71], v[104:107], a[4:7], v[68:71]
    buffer_load_dwordx4 v21, s[44:47], s25 offen offset:0 sc1 lds
    s_waitcnt lgkmcnt(2)
    v_mfma_f32_16x16x32_bf16 v[60:63], v[120:123], a[36:39], v[60:63]
    s_add_u32 m0, s73, 132608
    v_mfma_f32_16x16x32_bf16 v[60:63], v[124:127], a[44:47], v[60:63]
    buffer_load_dwordx4 v21, s[44:47], s25 offen offset:512 sc1 lds
    s_waitcnt lgkmcnt(0)
    v_mfma_f32_16x16x32_bf16 v[60:63], v[128:131], a[52:55], v[60:63]
    ds_read_b128 v[104:107], v14 offset:51200
    v_mfma_f32_16x16x32_bf16 v[60:63], v[132:135], a[60:63], v[60:63]
    ds_read_b128 v[108:111], v14 offset:55296
    v_mfma_f32_16x16x32_bf16 v[56:59], v[132:135], a[56:59], v[56:59]
    ds_read_b128 v[112:115], v14 offset:59392
    v_mfma_f32_16x16x32_bf16 v[56:59], v[128:131], a[48:51], v[56:59]
    ds_read_b128 v[116:119], v14 offset:63488
    v_mfma_f32_16x16x32_bf16 v[56:59], v[124:127], a[40:43], v[56:59]
    s_add_u32 m0, s73, 134144
    v_cvt_pk_bf16_f32 v196, v36, v37
    v_mfma_f32_16x16x32_bf16 v[56:59], v[120:123], a[32:35], v[56:59]
    buffer_load_dwordx4 v21, s[44:47], s26 offen offset:0 sc1 lds
    s_waitcnt lgkmcnt(2)
    v_mfma_f32_16x16x32_bf16 v[64:67], v[104:107], a[32:35], v[64:67]
    v_mfma_f32_16x16x32_bf16 v[64:67], v[108:111], a[40:43], v[64:67]
    s_waitcnt lgkmcnt(0)
    v_mfma_f32_16x16x32_bf16 v[64:67], v[112:115], a[48:51], v[64:67]
    ds_read_b128 v[120:123], v14 offset:52224
    v_cvt_pk_bf16_f32 v197, v38, v39
    v_mfma_f32_16x16x32_bf16 v[64:67], v[116:119], a[56:59], v[64:67]
    ds_read_b128 v[124:127], v14 offset:56320
    v_mfma_f32_16x16x32_bf16 v[68:71], v[116:119], a[60:63], v[68:71]
    ds_read_b128 v[128:131], v14 offset:60416
    v_mfma_f32_16x16x32_bf16 v[68:71], v[112:115], a[52:55], v[68:71]
    ds_read_b128 v[132:135], v14 offset:64512
    v_mfma_f32_16x16x32_bf16 v[68:71], v[108:111], a[44:47], v[68:71]
    buffer_store_dwordx4 v[196:199], v136, s[44:47], s33 offen sc1
    v_mfma_f32_16x16x32_bf16 v[68:71], v[104:107], a[36:39], v[68:71]
    s_waitcnt lgkmcnt(2)
    v_mfma_f32_16x16x32_bf16 v[60:63], v[120:123], a[68:71], v[60:63]
    v_mfma_f32_16x16x32_bf16 v[60:63], v[124:127], a[76:79], v[60:63]
    s_waitcnt lgkmcnt(0)
    v_mfma_f32_16x16x32_bf16 v[60:63], v[128:131], a[84:87], v[60:63]
    s_waitcnt vmcnt(12)
    s_barrier
    v_mfma_f32_16x16x32_bf16 v[60:63], v[132:135], a[92:95], v[60:63]
    ds_read_b128 v[104:107], v14 offset:0
    v_mfma_f32_16x16x32_bf16 v[56:59], v[132:135], a[88:91], v[56:59]
    ds_read_b128 v[108:111], v14 offset:4096
    v_mfma_f32_16x16x32_bf16 v[56:59], v[128:131], a[80:83], v[56:59]
    ds_read_b128 v[112:115], v14 offset:8192
    v_cvt_pk_bf16_f32 v192, v40, v41
    v_mfma_f32_16x16x32_bf16 v[56:59], v[124:127], a[72:75], v[56:59]
    ds_read_b128 v[116:119], v14 offset:12288
    v_mfma_f32_16x16x32_bf16 v[56:59], v[120:123], a[64:67], v[56:59]
    s_waitcnt lgkmcnt(2)
    v_mfma_f32_16x16x32_bf16 v[64:67], v[104:107], a[64:67], v[64:67]
    s_add_u32 m0, s73, 146944
    v_cvt_pk_bf16_f32 v193, v42, v43
    s_waitcnt vmcnt(11)
    v_mfma_f32_16x16x32_bf16 v[64:67], v[108:111], a[72:75], v[64:67]
    buffer_load_dwordx4 v21, s[44:47], s26 offen offset:512 sc1 lds
    s_waitcnt lgkmcnt(0)
    v_mfma_f32_16x16x32_bf16 v[64:67], v[112:115], a[80:83], v[64:67]
    ds_read_b128 v[120:123], v14 offset:1024
    v_mul_f32 v96, v96, v97
    v_mfma_f32_16x16x32_bf16 v[64:67], v[116:119], a[88:91], v[64:67]
    ds_read_b128 v[124:127], v14 offset:5120
    v_cvt_pk_bf16_f32 v194, v44, v45
    v_mfma_f32_16x16x32_bf16 v[68:71], v[116:119], a[92:95], v[68:71]
    ds_read_b128 v[128:131], v14 offset:9216
    v_mul_f32 v98, v98, v99
    v_mfma_f32_16x16x32_bf16 v[68:71], v[112:115], a[84:87], v[68:71]
    ds_read_b128 v[132:135], v14 offset:13312
    v_mul_f32 v100, v100, v101
    v_mfma_f32_16x16x32_bf16 v[68:71], v[108:111], a[76:79], v[68:71]
    buffer_store_dwordx4 v[192:195], v136, s[44:47], s30 offen offset:0 sc1
    s_add_u32 m0, s73, 148480
    v_permlane16_swap_b32 v88, v90
    v_mfma_f32_16x16x32_bf16 v[68:71], v[104:107], a[68:71], v[68:71]
    buffer_load_dwordx4 v22, s[44:47], s18 offen offset:0 sc1 lds
    s_waitcnt lgkmcnt(2)
    v_mfma_f32_16x16x32_bf16 v[60:63], v[120:123], a[100:103], v[60:63]
    s_add_u32 m0, s73, 148992
    v_permlane16_swap_b32 v89, v91
    v_permlane16_swap_b32 v92, v94
    v_mfma_f32_16x16x32_bf16 v[60:63], v[124:127], a[108:111], v[60:63]
    buffer_load_dwordx4 v22, s[44:47], s18 offen offset:512 sc1 lds
    s_waitcnt vmcnt(13)
    s_waitcnt lgkmcnt(0)
    v_mfma_f32_16x16x32_bf16 v[60:63], v[128:131], a[116:119], v[60:63]
    ds_read_b128 v[104:107], v14 offset:2048
    v_permlane16_swap_b32 v93, v95
    v_mfma_f32_16x16x32_bf16 v[60:63], v[132:135], a[124:127], v[60:63]
    ds_read_b128 v[108:111], v14 offset:6144
    v_cmp_ne_u32 vcc, s68, v189
    v_mfma_f32_16x16x32_bf16 v[56:59], v[132:135], a[120:123], v[56:59]
    ds_read_b128 v[112:115], v14 offset:10240
    v_and_b32 v145, 0xffff0000, v88
    v_mfma_f32_16x16x32_bf16 v[56:59], v[128:131], a[112:115], v[56:59]
    ds_read_b128 v[116:119], v14 offset:14336
    v_cvt_pk_bf16_f32 v196, v46, v47
    v_mfma_f32_16x16x32_bf16 v[56:59], v[124:127], a[104:107], v[56:59]
    s_add_u32 m0, s73, 150528
    s_cbranch_vccnz L_rs_p3
L_ok_p3:
    v_lshlrev_b32 v144, 16, v88
    v_mfma_f32_16x16x32_bf16 v[56:59], v[120:123], a[96:99], v[56:59]
    buffer_load_dwordx4 v22, s[44:47], s19 offen offset:0 sc1 lds
    s_waitcnt lgkmcnt(2)
    v_mfma_f32_16x16x32_bf16 v[64:67], v[104:107], a[96:99], v[64:67]
    s_add_u32 m0, s73, 81920
    v_cvt_pk_bf16_f32 v197, v48, v49
    v_and_b32 v147, 0xffff0000, v89
    v_mfma_f32_16x16x32_bf16 v[64:67], v[108:111], a[104:107], v[64:67]
    buffer_load_dwordx4 v184, s[44:47], s37 offen offset:0 sc1 lds
    s_waitcnt lgkmcnt(0)
    v_mfma_f32_16x16x32_bf16 v[64:67], v[112:115], a[112:115], v[64:67]
    ds_read_b128 v[120:123], v14 offset:3072
    buffer_load_dwordx4 v185, s[44:47], s37 offen offset:1024 sc1 lds
    v_mfma_f32_16x16x32_bf16 v[64:67], v[116:119], a[120:123], v[64:67]
    ds_read_b128 v[124:127], v14 offset:7168
    s_add_u32 m0, s73, 83968
    v_cvt_pk_bf16_f32 v198, v50, v51
    v_mfma_f32_16x16x32_bf16 v[68:71], v[116:119], a[124:127], v[68:71]
    ds_read_b128 v[128:131], v14 offset:11264
    buffer_load_dwordx4 v184, s[44:47], s16 offen offset:0 sc1 lds
    v_mfma_f32_16x16x32_bf16 v[68:71], v[112:115], a[116:119], v[68:71]
    ds_read_b128 v[132:135], v14 offset:15360
    buffer_load_dwordx4 v185, s[44:47], s16 offen offset:1024 sc1 lds
    v_mfma_f32_16x16x32_bf16 v[68:71], v[108:111], a[108:111], v[68:71]
    buffer_store_dwordx4 v[196:199], v136, s[44:47], s30 offen offset:1024 sc1
    v_lshlrev_b32 v146, 16, v89
    v_and_b32 v149, 0xffff0000, v92
    v_lshlrev_b32 v148, 16, v92
    v_mfma_f32_16x16x32_bf16 v[68:71], v[104:107], a[100:103], v[68:71]
    s_waitcnt lgkmcnt(2)
    v_mfma_f32_16x16x32_bf16 v[60:63], v[120:123], a[132:135], v[60:63]
    v_and_b32 v151, 0xffff0000, v93
    v_mfma_f32_16x16x32_bf16 v[60:63], v[124:127], a[140:143], v[60:63]
    v_lshlrev_b32 v150, 16, v93
    s_waitcnt lgkmcnt(0)
    v_mfma_f32_16x16x32_bf16 v[60:63], v[128:131], a[148:151], v[60:63]
    s_waitcnt vmcnt(16)
    s_barrier
    v_mfma_f32_16x16x32_bf16 v[60:63], v[132:135], a[156:159], v[60:63]
    ds_read_b128 v[104:107], v14 offset:16384
    v_and_b32 v153, 0xffff0000, v90
    v_mfma_f32_16x16x32_bf16 v[56:59], v[132:135], a[152:155], v[56:59]
    ds_read_b128 v[108:111], v14 offset:20480
    v_lshlrev_b32 v152, 16, v90
    v_mfma_f32_16x16x32_bf16 v[56:59], v[128:131], a[144:147], v[56:59]
    ds_read_b128 v[112:115], v14 offset:24576
    v_cvt_pk_bf16_f32 v200, v52, v53
    v_mfma_f32_16x16x32_bf16 v[56:59], v[124:127], a[136:139], v[56:59]
    ds_read_b128 v[116:119], v14 offset:28672
    v_and_b32 v155, 0xffff0000, v91
    v_mfma_f32_16x16x32_bf16 v[56:59], v[120:123], a[128:131], v[56:59]
    s_waitcnt lgkmcnt(2)
    v_mfma_f32_16x16x32_bf16 v[64:67], v[104:107], a[128:131], v[64:67]
    s_add_u32 m0, s73, 97792
    v_lshlrev_b32 v154, 16, v91
    v_mfma_f32_16x16x32_bf16 v[64:67], v[108:111], a[136:139], v[64:67]
    buffer_load_dwordx4 v22, s[44:47], s19 offen offset:512 sc1 lds
    s_waitcnt lgkmcnt(0)
    v_mfma_f32_16x16x32_bf16 v[64:67], v[112:115], a[144:147], v[64:67]
    ds_read_b128 v[120:123], v14 offset:17408
    v_cvt_pk_bf16_f32 v201, v54, v55
    v_mfma_f32_16x16x32_bf16 v[64:67], v[116:119], a[152:155], v[64:67]
    ds_read_b128 v[124:127], v14 offset:21504
    v_and_b32 v157, 0xffff0000, v94
    v_mfma_f32_16x16x32_bf16 v[68:71], v[116:119], a[156:159], v[68:71]
    ds_read_b128 v[128:131], v14 offset:25600
    v_lshlrev_b32 v156, 16, v94
    v_mfma_f32_16x16x32_bf16 v[68:71], v[112:115], a[148:151], v[68:71]
    buffer_store_dwordx4 v[200:203], v136, s[44:47], s30 offen offset:2048 sc1
    ds_read_b128 v[132:135], v14 offset:29696
    v_and_b32 v159, 0xffff0000, v95
    v_mfma_f32_16x16x32_bf16 v[68:71], v[108:111], a[140:143], v[68:71]
    s_add_u32 m0, s73, 99328
    v_lshlrev_b32 v158, 16, v95
    v_mfma_f32_16x16x32_bf16 v[68:71], v[104:107], a[132:135], v[68:71]
    buffer_load_dwordx4 v22, s[44:47], s20 offen offset:0 sc1 lds
    s_waitcnt lgkmcnt(2)
    v_mfma_f32_16x16x32_bf16 v[60:63], v[120:123], a[164:167], v[60:63]
    s_add_u32 m0, s73, 99840
    v_and_b32 v161, 0xffff0000, v142
    v_mfma_f32_16x16x32_bf16 v[60:63], v[124:127], a[172:175], v[60:63]
    buffer_load_dwordx4 v22, s[44:47], s20 offen offset:512 sc1 lds
    s_waitcnt lgkmcnt(0)
    v_mfma_f32_16x16x32_bf16 v[60:63], v[128:131], a[180:183], v[60:63]
    ds_read_b128 v[104:107], v14 offset:18432
    v_lshlrev_b32 v160, 16, v142
    v_mfma_f32_16x16x32_bf16 v[60:63], v[132:135], a[188:191], v[60:63]
    ds_read_b128 v[108:111], v14 offset:22528
    v_mfma_f32_16x16x32_bf16 v[56:59], v[132:135], a[184:187], v[56:59]
    ds_read_b128 v[112:115], v14 offset:26624
    v_and_b32 v163, 0xffff0000, v143
    v_mfma_f32_16x16x32_bf16 v[56:59], v[128:131], a[176:179], v[56:59]
    ds_read_b128 v[116:119], v14 offset:30720
    v_lshlrev_b32 v162, 16, v143
    v_mfma_f32_16x16x32_bf16 v[56:59], v[124:127], a[168:171], v[56:59]
    s_add_u32 m0, s73, 101376
    v_mfma_f32_16x16x32_bf16 v[56:59], v[120:123], a[160:163], v[56:59]
    buffer_load_dwordx4 v22, s[44:47], s21 offen offset:0 sc1 lds
    s_waitcnt lgkmcnt(2)
    v_mfma_f32_16x16x32_bf16 v[64:67], v[104:107], a[160:163], v[64:67]
    v_fma_f32 v164, v144, v97, -v96
    v_mfma_f32_16x16x32_bf16 v[64:67], v[108:111], a[168:171], v[64:67]
    v_fma_f32 v165, v145, v97, -v96
    s_waitcnt lgkmcnt(0)
    v_mfma_f32_16x16x32_bf16 v[64:67], v[112:115], a[176:179], v[64:67]
    ds_read_b128 v[120:123], v14 offset:19456
    v_fma_f32 v166, v146, v97, -v96
    v_mfma_f32_16x16x32_bf16 v[64:67], v[116:119], a[184:187], v[64:67]
    ds_read_b128 v[124:127], v14 offset:23552
    v_mfma_f32_16x16x32_bf16 v[68:71], v[116:119], a[188:191], v[68:71]
    ds_read_b128 v[128:131], v14 offset:27648
    v_fma_f32 v167, v147, v97, -v96
    v_mfma_f32_16x16x32_bf16 v[68:71], v[112:115], a[180:183], v[68:71]
    ds_read_b128 v[132:135], v14 offset:31744
    v_mfma_f32_16x16x32_bf16 v[68:71], v[108:111], a[172:175], v[68:71]
    v_fma_f32 v168, v148, v99, -v98
    v_mfma_f32_16x16x32_bf16 v[68:71], v[104:107], a[164:167], v[68:71]
    v_fma_f32 v169, v149, v99, -v98
    s_waitcnt lgkmcnt(2)
    v_mfma_f32_16x16x32_bf16 v[60:63], v[120:123], a[196:199], v[60:63]
    v_mfma_f32_16x16x32_bf16 v[60:63], v[124:127], a[204:207], v[60:63]
    v_fma_f32 v170, v150, v99, -v98
    s_waitcnt lgkmcnt(0)
    v_mfma_f32_16x16x32_bf16 v[60:63], v[128:131], a[212:215], v[60:63]
    s_waitcnt vmcnt(16)
    s_barrier
    v_mfma_f32_16x16x32_bf16 v[60:63], v[132:135], a[220:223], v[60:63]
    ds_read_b128 v[104:107], v14 offset:32768
    v_fma_f32 v171, v151, v99, -v98
    v_mfma_f32_16x16x32_bf16 v[56:59], v[132:135], a[216:219], v[56:59]
    ds_read_b128 v[108:111], v14 offset:36864
    v_fma_f32 v172, v152, v97, -v96
    v_mfma_f32_16x16x32_bf16 v[56:59], v[128:131], a[208:211], v[56:59]
    ds_read_b128 v[112:115], v14 offset:40960
    v_mfma_f32_16x16x32_bf16 v[56:59], v[124:127], a[200:203], v[56:59]
    ds_read_b128 v[116:119], v14 offset:45056
    v_fma_f32 v173, v153, v97, -v96
    v_mfma_f32_16x16x32_bf16 v[56:59], v[120:123], a[192:195], v[56:59]
    s_waitcnt lgkmcnt(2)
    v_mfma_f32_16x16x32_bf16 v[64:67], v[104:107], a[192:195], v[64:67]
    s_add_u32 m0, s73, 114176
    v_fma_f32 v174, v154, v97, -v96
    v_mfma_f32_16x16x32_bf16 v[64:67], v[108:111], a[200:203], v[64:67]
    buffer_load_dwordx4 v22, s[44:47], s21 offen offset:512 sc1 lds
    s_waitcnt lgkmcnt(0)
    v_mfma_f32_16x16x32_bf16 v[64:67], v[112:115], a[208:211], v[64:67]
    ds_read_b128 v[120:123], v14 offset:33792
    v_fma_f32 v175, v155, v97, -v96
    v_mfma_f32_16x16x32_bf16 v[64:67], v[116:119], a[216:219], v[64:67]
    ds_read_b128 v[124:127], v14 offset:37888
    v_fma_f32 v176, v156, v99, -v98
    v_mfma_f32_16x16x32_bf16 v[68:71], v[116:119], a[220:223], v[68:71]
    ds_read_b128 v[128:131], v14 offset:41984
    v_mfma_f32_16x16x32_bf16 v[68:71], v[112:115], a[212:215], v[68:71]
    ds_read_b128 v[132:135], v14 offset:46080
    v_fma_f32 v177, v157, v99, -v98
    v_mfma_f32_16x16x32_bf16 v[68:71], v[108:111], a[204:207], v[68:71]
    s_add_u32 m0, s73, 115712
    v_fma_f32 v178, v158, v99, -v98
    v_mfma_f32_16x16x32_bf16 v[68:71], v[104:107], a[196:199], v[68:71]
    buffer_load_dwordx4 v22, s[44:47], s22 offen offset:0 sc1 lds
    s_waitcnt lgkmcnt(2)
    v_mfma_f32_16x16x32_bf16 v[60:63], v[120:123], a[228:231], v[60:63]
    s_add_u32 m0, s73, 116224
    v_fma_f32 v179, v159, v99, -v98
    v_mfma_f32_16x16x32_bf16 v[60:63], v[124:127], a[236:239], v[60:63]
    buffer_load_dwordx4 v22, s[44:47], s22 offen offset:512 sc1 lds
    s_waitcnt lgkmcnt(0)
    v_mfma_f32_16x16x32_bf16 v[60:63], v[128:131], a[244:247], v[60:63]
    ds_read_b128 v[104:107], v14 offset:34816
    v_fma_f32 v180, v160, v101, -v100
    v_mfma_f32_16x16x32_bf16 v[60:63], v[132:135], a[252:255], v[60:63]
    ds_read_b128 v[108:111], v14 offset:38912
    v_fma_f32 v181, v161, v101, -v100
    v_mfma_f32_16x16x32_bf16 v[56:59], v[132:135], a[248:251], v[56:59]
    ds_read_b128 v[112:115], v14 offset:43008
    v_mfma_f32_16x16x32_bf16 v[56:59], v[128:131], a[240:243], v[56:59]
    ds_read_b128 v[116:119], v14 offset:47104
    v_fma_f32 v182, v162, v101, -v100
    v_mfma_f32_16x16x32_bf16 v[56:59], v[124:127], a[232:235], v[56:59]
    s_add_u32 m0, s73, 117760
    v_fma_f32 v183, v163, v101, -v100
    v_mfma_f32_16x16x32_bf16 v[56:59], v[120:123], a[224:227], v[56:59]
    buffer_load_dwordx4 v22, s[44:47], s23 offen offset:0 sc1 lds
    s_waitcnt lgkmcnt(2)
    v_mfma_f32_16x16x32_bf16 v[64:67], v[104:107], a[224:227], v[64:67]
    v_mfma_f32_16x16x32_bf16 v[64:67], v[108:111], a[232:235], v[64:67]
    s_waitcnt lgkmcnt(0)
    v_mfma_f32_16x16x32_bf16 v[64:67], v[112:115], a[240:243], v[64:67]
    ds_read_b128 v[120:123], v14 offset:35840
    v_mfma_f32_16x16x32_bf16 v[64:67], v[116:119], a[248:251], v[64:67]
    ds_read_b128 v[124:127], v14 offset:39936
    v_mfma_f32_16x16x32_bf16 v[68:71], v[116:119], a[252:255], v[68:71]
    ds_read_b128 v[128:131], v14 offset:44032
    v_mfma_f32_16x16x32_bf16 v[68:71], v[112:115], a[244:247], v[68:71]
    ds_read_b128 v[132:135], v14 offset:48128
    v_mfma_f32_16x16x32_bf16 v[68:71], v[108:111], a[236:239], v[68:71]
    v_mfma_f32_16x16x32_bf16 v[68:71], v[104:107], a[228:231], v[68:71]
    s_waitcnt lgkmcnt(2)
    v_mfma_f32_16x16x32_bf16 v[60:63], v[120:123], v[224:227], v[60:63]
    v_mfma_f32_16x16x32_bf16 v[60:63], v[124:127], v[232:235], v[60:63]
L_pl_D_1:
    s_cbranch_execz L_wret
    s_waitcnt lgkmcnt(0)
    v_mfma_f32_16x16x32_bf16 v[60:63], v[128:131], v[240:243], v[60:63]
    s_waitcnt vmcnt(10)
    s_barrier
    v_mfma_f32_16x16x32_bf16 v[60:63], v[132:135], v[248:251], v[60:63]
    ds_read_b128 v[104:107], v14 offset:49152
    v_mfma_f32_16x16x32_bf16 v[56:59], v[132:135], v[244:247], v[56:59]
    ds_read_b128 v[108:111], v14 offset:53248
    v_mfma_f32_16x16x32_bf16 v[56:59], v[128:131], v[236:239], v[56:59]
    ds_read_b128 v[112:115], v14 offset:57344
    v_mfma_f32_16x16x32_bf16 v[56:59], v[124:127], v[228:231], v[56:59]
    ds_read_b128 v[116:119], v14 offset:61440
    v_mfma_f32_16x16x32_bf16 v[56:59], v[120:123], v[220:223], v[56:59]
    s_waitcnt lgkmcnt(2)
    v_mfma_f32_16x16x32_bf16 v[64:67], v[104:107], v[220:223], v[64:67]
    s_add_u32 m0, s73, 130560
    v_xor_b32 v186, s41, v10
    v_add_u32 v186, s43, v186
    v_mfma_f32_16x16x32_bf16 v[64:67], v[108:111], v[228:231], v[64:67]
    buffer_load_dwordx4 v22, s[44:47], s23 offen offset:512 sc1 lds
    ds_read_b64_tr_b16 v[12:13], v10 offset:16384
    s_waitcnt lgkmcnt(1)
    v_mfma_f32_16x16x32_bf16 v[64:67], v[112:115], v[236:239], v[64:67]
    ds_read_b128 v[120:123], v14 offset:50176
    v_mfma_f32_16x16x32_bf16 v[64:67], v[116:119], v[244:247], v[64:67]
    ds_read_b128 v[124:127], v14 offset:54272
    v_mfma_f32_16x16x32_bf16 v[68:71], v[116:119], v[248:251], v[68:71]
    ds_read_b128 v[128:131], v14 offset:58368
    ds_read_b64_tr_b16 v[24:25], v11 offset:16384
    v_mfma_f32_16x16x32_bf16 v[68:71], v[112:115], v[240:243], v[68:71]
    ds_read_b128 v[132:135], v14 offset:62464
    ds_read_b64_tr_b16 v[28:29], v10 offset:20480
    v_mfma_f32_16x16x32_bf16 v[68:71], v[108:111], v[232:235], v[68:71]
    s_add_u32 m0, s73, 132096
    ds_read_b64_tr_b16 v[190:191], v11 offset:20480
    v_mfma_f32_16x16x32_bf16 v[68:71], v[104:107], v[224:227], v[68:71]
    buffer_load_dwordx4 v22, s[44:47], s24 offen offset:0 sc1 lds
    ds_read_b64_tr_b16 v[142:143], v186 offset:18432
    s_waitcnt lgkmcnt(6)
    v_mfma_f32_16x16x32_bf16 v[76:79], v[120:123], a[4:7], v[76:79]
    s_add_u32 m0, s73, 132608
    s_waitcnt lgkmcnt(0)
    v_mfma_f32_16x16x32_bf16 v[76:79], v[124:127], a[12:15], v[76:79]
    buffer_load_dwordx4 v22, s[44:47], s24 offen offset:512 sc1 lds
    v_mfma_f32_16x16x32_bf16 v[76:79], v[128:131], a[20:23], v[76:79]
    ds_read_b128 v[104:107], v14 offset:51200
    v_and_b32 v9, 0xffff0000, v12
    v_mfma_f32_16x16x32_bf16 v[76:79], v[132:135], a[28:31], v[76:79]
    ds_read_b128 v[108:111], v14 offset:55296
    v_mfma_f32_16x16x32_bf16 v[72:75], v[132:135], a[24:27], v[72:75]
    ds_read_b128 v[112:115], v14 offset:59392
    v_lshlrev_b32 v8, 16, v12
    v_mfma_f32_16x16x32_bf16 v[72:75], v[128:131], a[16:19], v[72:75]
    ds_read_b128 v[116:119], v14 offset:63488
    v_cvt_pk_bf16_f32 v192, v56, v57
    v_mfma_f32_16x16x32_bf16 v[72:75], v[124:127], a[8:11], v[72:75]
    s_add_u32 m0, s73, 134144
    v_mul_f32 v165, v165, v9
    v_mfma_f32_16x16x32_bf16 v[72:75], v[120:123], a[0:3], v[72:75]
    buffer_load_dwordx4 v22, s[44:47], s25 offen offset:0 sc1 lds
    s_waitcnt lgkmcnt(2)
    v_mfma_f32_16x16x32_bf16 v[80:83], v[104:107], a[0:3], v[80:83]
    v_cvt_pk_bf16_f32 v193, v58, v59
    v_mul_f32 v164, v164, v8
    v_mfma_f32_16x16x32_bf16 v[80:83], v[108:111], a[8:11], v[80:83]
    v_and_b32 v31, 0xffff0000, v13
    s_waitcnt lgkmcnt(0)
    v_mfma_f32_16x16x32_bf16 v[80:83], v[112:115], a[16:19], v[80:83]
    ds_read_b128 v[120:123], v14 offset:52224
    v_lshlrev_b32 v30, 16, v13
    v_mfma_f32_16x16x32_bf16 v[80:83], v[116:119], a[24:27], v[80:83]
    ds_read_b128 v[124:127], v14 offset:56320
    v_cvt_pk_bf16_f32 v194, v60, v61
    v_mfma_f32_16x16x32_bf16 v[84:87], v[116:119], a[28:31], v[84:87]
    ds_read_b128 v[128:131], v14 offset:60416
    v_mfma_f32_16x16x32_bf16 v[84:87], v[112:115], a[20:23], v[84:87]
    ds_read_b128 v[132:135], v14 offset:64512
    v_mul_f32 v167, v167, v31
    v_mfma_f32_16x16x32_bf16 v[84:87], v[108:111], a[12:15], v[84:87]
    buffer_store_dwordx4 v[192:195], v136, s[44:47], s15 offen offset:0 sc1
    v_mul_f32 v166, v166, v30
    v_mfma_f32_16x16x32_bf16 v[84:87], v[104:107], a[4:7], v[84:87]
    s_waitcnt lgkmcnt(2)
    v_mfma_f32_16x16x32_bf16 v[76:79], v[120:123], a[36:39], v[76:79]
    v_and_b32 v9, 0xffff0000, v24
    v_mfma_f32_16x16x32_bf16 v[76:79], v[124:127], a[44:47], v[76:79]
    s_waitcnt lgkmcnt(0)
    v_mfma_f32_16x16x32_bf16 v[76:79], v[128:131], a[52:55], v[76:79]
    s_waitcnt vmcnt(9)
    s_barrier
    v_lshlrev_b32 v8, 16, v24
    v_mfma_f32_16x16x32_bf16 v[76:79], v[132:135], a[60:63], v[76:79]
    ds_read_b128 v[104:107], v14 offset:0
    v_mfma_f32_16x16x32_bf16 v[72:75], v[132:135], a[56:59], v[72:75]
    ds_read_b128 v[108:111], v14 offset:4096
    v_mul_f32 v169, v169, v9
    v_mfma_f32_16x16x32_bf16 v[72:75], v[128:131], a[48:51], v[72:75]
    ds_read_b128 v[112:115], v14 offset:8192
    v_cvt_pk_bf16_f32 v196, v62, v63
    v_mfma_f32_16x16x32_bf16 v[72:75], v[124:127], a[40:43], v[72:75]
    ds_read_b128 v[116:119], v14 offset:12288
    v_mul_f32 v168, v168, v8
    v_mfma_f32_16x16x32_bf16 v[72:75], v[120:123], a[32:35], v[72:75]
    v_and_b32 v31, 0xffff0000, v25
    s_waitcnt lgkmcnt(2)
    v_mfma_f32_16x16x32_bf16 v[80:83], v[104:107], a[32:35], v[80:83]
    s_add_u32 m0, s73, 146944
    v_cvt_pk_bf16_f32 v197, v64, v65
    v_lshlrev_b32 v30, 16, v25
    v_mfma_f32_16x16x32_bf16 v[80:83], v[108:111], a[40:43], v[80:83]
    buffer_load_dwordx4 v22, s[44:47], s25 offen offset:512 sc1 lds
    s_waitcnt lgkmcnt(0)
    v_mfma_f32_16x16x32_bf16 v[80:83], v[112:115], a[48:51], v[80:83]
    ds_read_b128 v[120:123], v14 offset:1024
    v_mul_f32 v171, v171, v31
    v_mfma_f32_16x16x32_bf16 v[80:83], v[116:119], a[56:59], v[80:83]
    ds_read_b128 v[124:127], v14 offset:5120
    v_cvt_pk_bf16_f32 v198, v66, v67
    v_mfma_f32_16x16x32_bf16 v[84:87], v[116:119], a[60:63], v[84:87]
    ds_read_b128 v[128:131], v14 offset:9216
    v_mul_f32 v170, v170, v30
    v_mfma_f32_16x16x32_bf16 v[84:87], v[112:115], a[52:55], v[84:87]
    ds_read_b128 v[132:135], v14 offset:13312
    v_mfma_f32_16x16x32_bf16 v[84:87], v[108:111], a[44:47], v[84:87]
    buffer_store_dwordx4 v[196:199], v136, s[44:47], s15 offen offset:1024 sc1
    s_add_u32 m0, s73, 148480
    v_and_b32 v9, 0xffff0000, v28
    v_mfma_f32_16x16x32_bf16 v[84:87], v[104:107], a[36:39], v[84:87]
    buffer_load_dwordx4 v22, s[44:47], s26 offen offset:0 sc1 lds
    s_waitcnt lgkmcnt(2)
    v_mfma_f32_16x16x32_bf16 v[76:79], v[120:123], a[68:71], v[76:79]
    s_add_u32 m0, s73, 148992
    v_lshlrev_b32 v8, 16, v28
    v_mfma_f32_16x16x32_bf16 v[76:79], v[124:127], a[76:79], v[76:79]
    buffer_load_dwordx4 v22, s[44:47], s26 offen offset:512 sc1 lds
    s_waitcnt lgkmcnt(0)
    v_mfma_f32_16x16x32_bf16 v[76:79], v[128:131], a[84:87], v[76:79]
    ds_read_b128 v[104:107], v14 offset:2048
    v_mul_f32 v173, v173, v9
    v_mfma_f32_16x16x32_bf16 v[76:79], v[132:135], a[92:95], v[76:79]
    ds_read_b128 v[108:111], v14 offset:6144
    v_mfma_f32_16x16x32_bf16 v[72:75], v[132:135], a[88:91], v[72:75]
    ds_read_b128 v[112:115], v14 offset:10240
    v_mul_f32 v172, v172, v8
    v_mfma_f32_16x16x32_bf16 v[72:75], v[128:131], a[80:83], v[72:75]
    ds_read_b128 v[116:119], v14 offset:14336
    v_and_b32 v31, 0xffff0000, v29
    v_mfma_f32_16x16x32_bf16 v[72:75], v[124:127], a[72:75], v[72:75]
    s_add_u32 m0, s73, 150528
    v_cvt_pk_bf16_f32 v200, v68, v69
    v_mfma_f32_16x16x32_bf16 v[72:75], v[120:123], a[64:67], v[72:75]
    buffer_load_dwordx4 v19, s[44:47], s18 offen offset:0 sc1 lds
    s_waitcnt lgkmcnt(2)
    v_mfma_f32_16x16x32_bf16 v[80:83], v[104:107], a[64:67], v[80:83]
    v_lshlrev_b32 v30, 16, v29
    v_mul_f32 v175, v175, v31
    v_mfma_f32_16x16x32_bf16 v[80:83], v[108:111], a[72:75], v[80:83]
    buffer_load_dwordx4 v[40:43], v136, s[44:47], s34 offen offset:0 sc1
    s_waitcnt lgkmcnt(0)
    v_mfma_f32_16x16x32_bf16 v[80:83], v[112:115], a[80:83], v[80:83]
    ds_read_b128 v[120:123], v14 offset:3072
    v_cvt_pk_bf16_f32 v201, v70, v71
    v_mfma_f32_16x16x32_bf16 v[80:83], v[116:119], a[88:91], v[80:83]
    ds_read_b128 v[124:127], v14 offset:7168
    v_mul_f32 v174, v174, v30
    v_mfma_f32_16x16x32_bf16 v[84:87], v[116:119], a[92:95], v[84:87]
    ds_read_b128 v[128:131], v14 offset:11264
    v_and_b32 v9, 0xffff0000, v190
    v_mfma_f32_16x16x32_bf16 v[84:87], v[112:115], a[84:87], v[84:87]
    ds_read_b128 v[132:135], v14 offset:15360
    buffer_load_dwordx4 v[44:47], v136, s[44:47], s34 offen offset:1024 sc1
    v_mfma_f32_16x16x32_bf16 v[84:87], v[108:111], a[76:79], v[84:87]
    buffer_store_dwordx4 v[200:203], v136, s[44:47], s15 offen offset:2048 sc1
    v_lshlrev_b32 v8, 16, v190
    v_mfma_f32_16x16x32_bf16 v[84:87], v[104:107], a[68:71], v[84:87]
    s_waitcnt lgkmcnt(2)
    v_mfma_f32_16x16x32_bf16 v[76:79], v[120:123], a[100:103], v[76:79]
    buffer_load_dwordx4 v[48:51], v136, s[44:47], s34 offen offset:2048 sc1
    v_mul_f32 v177, v177, v9
    v_mfma_f32_16x16x32_bf16 v[76:79], v[124:127], a[108:111], v[76:79]
    s_waitcnt lgkmcnt(0)
    v_mfma_f32_16x16x32_bf16 v[76:79], v[128:131], a[116:119], v[76:79]
    s_waitcnt vmcnt(14)
    s_barrier
    v_mul_f32 v176, v176, v8
    v_mfma_f32_16x16x32_bf16 v[76:79], v[132:135], a[124:127], v[76:79]
    ds_read_b128 v[104:107], v14 offset:16384
    v_and_b32 v31, 0xffff0000, v191
    v_mfma_f32_16x16x32_bf16 v[72:75], v[132:135], a[120:123], v[72:75]
    ds_read_b128 v[108:111], v14 offset:20480
    buffer_load_dwordx4 v[204:207], v136, s[44:47], s35 offen offset:0 sc1
    v_mfma_f32_16x16x32_bf16 v[72:75], v[128:131], a[112:115], v[72:75]
    ds_read_b128 v[112:115], v14 offset:24576
    v_lshlrev_b32 v30, 16, v191
    v_mfma_f32_16x16x32_bf16 v[72:75], v[124:127], a[104:107], v[72:75]
    ds_read_b128 v[116:119], v14 offset:28672
    v_mul_f32 v179, v179, v31
    v_mfma_f32_16x16x32_bf16 v[72:75], v[120:123], a[96:99], v[72:75]
    buffer_load_dwordx4 v[208:211], v136, s[44:47], s35 offen offset:1024 sc1
    s_waitcnt lgkmcnt(2)
    v_mfma_f32_16x16x32_bf16 v[80:83], v[104:107], a[96:99], v[80:83]
    v_mfma_f32_16x16x32_bf16 v[80:83], v[108:111], a[104:107], v[80:83]
    v_mul_f32 v178, v178, v30
    s_waitcnt lgkmcnt(0)
    v_mfma_f32_16x16x32_bf16 v[80:83], v[112:115], a[112:115], v[80:83]
    ds_read_b128 v[120:123], v14 offset:17408
    buffer_load_dwordx4 v[212:215], v136, s[44:47], s35 offen offset:2048 sc1
    v_mfma_f32_16x16x32_bf16 v[80:83], v[116:119], a[120:123], v[80:83]
    ds_read_b128 v[124:127], v14 offset:21504
    v_and_b32 v9, 0xffff0000, v142
    v_mfma_f32_16x16x32_bf16 v[84:87], v[116:119], a[124:127], v[84:87]
    ds_read_b128 v[128:131], v14 offset:25600
    v_lshlrev_b32 v8, 16, v142
    v_mfma_f32_16x16x32_bf16 v[84:87], v[112:115], a[116:119], v[84:87]
    ds_read_b128 v[132:135], v14 offset:29696
    v_mfma_f32_16x16x32_bf16 v[84:87], v[108:111], a[108:111], v[84:87]
    buffer_load_dwordx4 v[216:219], v136, s[44:47], s35 offen offset:3072 sc1
    v_mul_f32 v181, v181, v9
    v_mfma_f32_16x16x32_bf16 v[84:87], v[104:107], a[100:103], v[84:87]
    s_waitcnt lgkmcnt(2)
    v_mfma_f32_16x16x32_bf16 v[76:79], v[120:123], a[132:135], v[76:79]
    v_mul_f32 v180, v180, v8
    v_mfma_f32_16x16x32_bf16 v[76:79], v[124:127], a[140:143], v[76:79]
    v_and_b32 v31, 0xffff0000, v143
    s_waitcnt lgkmcnt(0)
    v_mfma_f32_16x16x32_bf16 v[76:79], v[128:131], a[148:151], v[76:79]
    ds_read_b128 v[104:107], v14 offset:18432
    v_mfma_f32_16x16x32_bf16 v[76:79], v[132:135], a[156:159], v[76:79]
    ds_read_b128 v[108:111], v14 offset:22528
    v_lshlrev_b32 v30, 16, v143
    v_mfma_f32_16x16x32_bf16 v[72:75], v[132:135], a[152:155], v[72:75]
    ds_read_b128 v[112:115], v14 offset:26624
    v_mfma_f32_16x16x32_bf16 v[72:75], v[128:131], a[144:147], v[72:75]
    ds_read_b128 v[116:119], v14 offset:30720
    v_mul_f32 v183, v183, v31
    v_mfma_f32_16x16x32_bf16 v[72:75], v[124:127], a[136:139], v[72:75]
    v_mfma_f32_16x16x32_bf16 v[72:75], v[120:123], a[128:131], v[72:75]
    v_mul_f32 v182, v182, v30
    s_waitcnt lgkmcnt(2)
    v_mfma_f32_16x16x32_bf16 v[80:83], v[104:107], a[128:131], v[80:83]
    v_mfma_f32_16x16x32_bf16 v[80:83], v[108:111], a[136:139], v[80:83]
    s_waitcnt lgkmcnt(0)
    v_mfma_f32_16x16x32_bf16 v[80:83], v[112:115], a[144:147], v[80:83]
    ds_read_b128 v[120:123], v14 offset:19456
    v_mfma_f32_16x16x32_bf16 v[80:83], v[116:119], a[152:155], v[80:83]
    ds_read_b128 v[124:127], v14 offset:23552
    v_mfma_f32_16x16x32_bf16 v[84:87], v[116:119], a[156:159], v[84:87]
    ds_read_b128 v[128:131], v14 offset:27648
    v_mfma_f32_16x16x32_bf16 v[84:87], v[112:115], a[148:151], v[84:87]
    ds_read_b128 v[132:135], v14 offset:31744
    v_mfma_f32_16x16x32_bf16 v[84:87], v[108:111], a[140:143], v[84:87]
    v_mfma_f32_16x16x32_bf16 v[84:87], v[104:107], a[132:135], v[84:87]
    s_waitcnt lgkmcnt(2)
    v_mfma_f32_16x16x32_bf16 v[76:79], v[120:123], a[164:167], v[76:79]
    s_add_u32 m0, s73, 97792
    v_mfma_f32_16x16x32_bf16 v[76:79], v[124:127], a[172:175], v[76:79]
    buffer_load_dwordx4 v19, s[44:47], s18 offen offset:512 sc1 lds
    s_waitcnt lgkmcnt(0)
    v_mfma_f32_16x16x32_bf16 v[76:79], v[128:131], a[180:183], v[76:79]
    s_waitcnt vmcnt(15)
    s_barrier
    v_mfma_f32_16x16x32_bf16 v[76:79], v[132:135], a[188:191], v[76:79]
    ds_read_b128 v[104:107], v14 offset:32768
    v_mfma_f32_16x16x32_bf16 v[72:75], v[132:135], a[184:187], v[72:75]
    ds_read_b128 v[108:111], v14 offset:36864
    v_mfma_f32_16x16x32_bf16 v[72:75], v[128:131], a[176:179], v[72:75]
    ds_read_b128 v[112:115], v14 offset:40960
    v_mfma_f32_16x16x32_bf16 v[72:75], v[124:127], a[168:171], v[72:75]
    ds_read_b128 v[116:119], v14 offset:45056
    s_add_u32 m0, s73, 99328
    v_mfma_f32_16x16x32_bf16 v[72:75], v[120:123], a[160:163], v[72:75]
    buffer_load_dwordx4 v19, s[44:47], s19 offen offset:0 sc1 lds
    s_waitcnt lgkmcnt(2)
    v_mfma_f32_16x16x32_bf16 v[80:83], v[104:107], a[160:163], v[80:83]
    s_add_u32 m0, s73, 99840
    v_mov_b32 v141, 0
    v_mfma_f32_16x16x32_bf16 v[80:83], v[108:111], a[168:171], v[80:83]
    buffer_load_dwordx4 v19, s[44:47], s19 offen offset:512 sc1 lds
    s_waitcnt lgkmcnt(0)
    v_mfma_f32_16x16x32_bf16 v[80:83], v[112:115], a[176:179], v[80:83]
    ds_read_b128 v[120:123], v14 offset:33792
    v_mfma_f32_16x16x32_bf16 v[80:83], v[116:119], a[184:187], v[80:83]
    ds_read_b128 v[124:127], v14 offset:37888
    buffer_atomic_add v141, v139, s[44:47], s11 offen offset:2060 sc0 sc1
    v_mfma_f32_16x16x32_bf16 v[84:87], v[116:119], a[188:191], v[84:87]
    ds_read_b128 v[128:131], v14 offset:41984
    v_mfma_f32_16x16x32_bf16 v[84:87], v[112:115], a[180:183], v[84:87]
    ds_read_b128 v[132:135], v14 offset:46080
    v_mfma_f32_16x16x32_bf16 v[84:87], v[108:111], a[172:175], v[84:87]
    s_add_u32 m0, s73, 101376
    v_mfma_f32_16x16x32_bf16 v[84:87], v[104:107], a[164:167], v[84:87]
    buffer_load_dwordx4 v19, s[44:47], s20 offen offset:0 sc1 lds
    s_waitcnt lgkmcnt(2)
    v_mfma_f32_16x16x32_bf16 v[76:79], v[120:123], a[196:199], v[76:79]
    s_add_u32 m0, s73, 114176
    v_mfma_f32_16x16x32_bf16 v[76:79], v[124:127], a[204:207], v[76:79]
    buffer_load_dwordx4 v19, s[44:47], s20 offen offset:512 sc1 lds
    s_waitcnt lgkmcnt(0)
    v_mfma_f32_16x16x32_bf16 v[76:79], v[128:131], a[212:215], v[76:79]
    ds_read_b128 v[104:107], v14 offset:34816
    v_mfma_f32_16x16x32_bf16 v[76:79], v[132:135], a[220:223], v[76:79]
    ds_read_b128 v[108:111], v14 offset:38912
    v_mfma_f32_16x16x32_bf16 v[72:75], v[132:135], a[216:219], v[72:75]
    ds_read_b128 v[112:115], v14 offset:43008
    v_mfma_f32_16x16x32_bf16 v[72:75], v[128:131], a[208:211], v[72:75]
    ds_read_b128 v[116:119], v14 offset:47104
    v_mfma_f32_16x16x32_bf16 v[72:75], v[124:127], a[200:203], v[72:75]
    s_add_u32 m0, s73, 115712
    v_mfma_f32_16x16x32_bf16 v[72:75], v[120:123], a[192:195], v[72:75]
    buffer_load_dwordx4 v19, s[44:47], s21 offen offset:0 sc1 lds
    s_waitcnt lgkmcnt(2)
    v_mfma_f32_16x16x32_bf16 v[80:83], v[104:107], a[192:195], v[80:83]
    s_add_u32 m0, s73, 116224
    v_mfma_f32_16x16x32_bf16 v[80:83], v[108:111], a[200:203], v[80:83]
    buffer_load_dwordx4 v19, s[44:47], s21 offen offset:512 sc1 lds
    s_waitcnt lgkmcnt(0)
    v_mfma_f32_16x16x32_bf16 v[80:83], v[112:115], a[208:211], v[80:83]
    ds_read_b128 v[120:123], v14 offset:35840
    v_mfma_f32_16x16x32_bf16 v[80:83], v[116:119], a[216:219], v[80:83]
    ds_read_b128 v[124:127], v14 offset:39936
    v_mfma_f32_16x16x32_bf16 v[84:87], v[116:119], a[220:223], v[84:87]
    ds_read_b128 v[128:131], v14 offset:44032
    v_mfma_f32_16x16x32_bf16 v[84:87], v[112:115], a[212:215], v[84:87]
    ds_read_b128 v[132:135], v14 offset:48128
    v_mfma_f32_16x16x32_bf16 v[84:87], v[108:111], a[204:207], v[84:87]
    s_add_u32 m0, s73, 117760
    v_mfma_f32_16x16x32_bf16 v[84:87], v[104:107], a[196:199], v[84:87]
    buffer_load_dwordx4 v19, s[44:47], s22 offen offset:0 sc1 lds
    s_waitcnt lgkmcnt(2)
    v_mfma_f32_16x16x32_bf16 v[76:79], v[120:123], a[228:231], v[76:79]
    v_mfma_f32_16x16x32_bf16 v[76:79], v[124:127], a[236:239], v[76:79]
    s_waitcnt lgkmcnt(0)
    v_mfma_f32_16x16x32_bf16 v[76:79], v[128:131], a[244:247], v[76:79]
    s_waitcnt vmcnt(17)
    s_barrier
    v_mfma_f32_16x16x32_bf16 v[76:79], v[132:135], a[252:255], v[76:79]
    ds_read_b128 v[104:107], v14 offset:49152
    v_mfma_f32_16x16x32_bf16 v[72:75], v[132:135], a[248:251], v[72:75]
    ds_read_b128 v[108:111], v14 offset:53248
    v_mfma_f32_16x16x32_bf16 v[72:75], v[128:131], a[240:243], v[72:75]
    ds_read_b128 v[112:115], v14 offset:57344
    v_mfma_f32_16x16x32_bf16 v[72:75], v[124:127], a[232:235], v[72:75]
    ds_read_b128 v[116:119], v14 offset:61440
    v_mfma_f32_16x16x32_bf16 v[72:75], v[120:123], a[224:227], v[72:75]
    s_waitcnt lgkmcnt(2)
    v_mfma_f32_16x16x32_bf16 v[80:83], v[104:107], a[224:227], v[80:83]
    s_add_u32 m0, s73, 130560
    v_mfma_f32_16x16x32_bf16 v[80:83], v[108:111], a[232:235], v[80:83]
    buffer_load_dwordx4 v19, s[44:47], s22 offen offset:512 sc1 lds
    s_waitcnt lgkmcnt(0)
    v_mfma_f32_16x16x32_bf16 v[80:83], v[112:115], a[240:243], v[80:83]
    ds_read_b128 v[120:123], v14 offset:50176
    v_mfma_f32_16x16x32_bf16 v[80:83], v[116:119], a[248:251], v[80:83]
    ds_read_b128 v[124:127], v14 offset:54272
    v_mfma_f32_16x16x32_bf16 v[84:87], v[116:119], a[252:255], v[84:87]
    ds_read_b128 v[128:131], v14 offset:58368
    v_mfma_f32_16x16x32_bf16 v[84:87], v[112:115], a[244:247], v[84:87]
    ds_read_b128 v[132:135], v14 offset:62464
    v_mfma_f32_16x16x32_bf16 v[84:87], v[108:111], a[236:239], v[84:87]
    s_add_u32 m0, s73, 132096
    v_mfma_f32_16x16x32_bf16 v[84:87], v[104:107], a[228:231], v[84:87]
    buffer_load_dwordx4 v19, s[44:47], s23 offen offset:0 sc1 lds
    s_waitcnt lgkmcnt(2)
    v_mfma_f32_16x16x32_bf16 v[76:79], v[120:123], v[224:227], v[76:79]
    s_add_u32 m0, s73, 132608
    s_waitcnt vmcnt(15)
    v_bitop3_b32 v43, v43, v47, s68 bitop3:0x7e
    v_bitop3_b32 v43, v43, v51, s68 bitop3:0xf6
    v_cmp_ne_u32 vcc, 0, v43
    v_mfma_f32_16x16x32_bf16 v[76:79], v[124:127], v[232:235], v[76:79]
    buffer_load_dwordx4 v19, s[44:47], s23 offen offset:512 sc1 lds
    s_waitcnt lgkmcnt(0)
    v_mfma_f32_16x16x32_bf16 v[76:79], v[128:131], v[240:243], v[76:79]
    ds_read_b128 v[104:107], v14 offset:51200
    s_cbranch_vccnz L_xs_a
L_xo_a:
    v_and_b32 v89, 0xffff0000, v40
    v_mfma_f32_16x16x32_bf16 v[76:79], v[132:135], v[248:251], v[76:79]
    ds_read_b128 v[108:111], v14 offset:55296
    v_lshlrev_b32 v88, 16, v40
    v_mfma_f32_16x16x32_bf16 v[72:75], v[132:135], v[244:247], v[72:75]
    ds_read_b128 v[112:115], v14 offset:59392
    v_and_b32 v91, 0xffff0000, v41
    v_mfma_f32_16x16x32_bf16 v[72:75], v[128:131], v[236:239], v[72:75]
    ds_read_b128 v[116:119], v14 offset:63488
    v_lshlrev_b32 v90, 16, v41
    v_mfma_f32_16x16x32_bf16 v[72:75], v[124:127], v[228:231], v[72:75]
    s_add_u32 m0, s73, 134144
    v_and_b32 v93, 0xffff0000, v42
    v_lshlrev_b32 v92, 16, v42
    v_mfma_f32_16x16x32_bf16 v[72:75], v[120:123], v[220:223], v[72:75]
    buffer_load_dwordx4 v19, s[44:47], s24 offen offset:0 sc1 lds
    s_waitcnt lgkmcnt(2)
    v_mfma_f32_16x16x32_bf16 v[80:83], v[104:107], v[220:223], v[80:83]
    s_waitcnt vmcnt(9)
    v_and_b32 v95, 0xffff0000, v44
    v_lshlrev_b32 v94, 16, v44
    v_mfma_f32_16x16x32_bf16 v[80:83], v[108:111], v[228:231], v[80:83]
    v_and_b32 v97, 0xffff0000, v45
    v_cmp_ne_u32 vcc, v140, v141
    s_waitcnt lgkmcnt(0)
    v_mfma_f32_16x16x32_bf16 v[80:83], v[112:115], v[236:239], v[80:83]
    ds_read_b128 v[120:123], v14 offset:52224
    v_lshlrev_b32 v96, 16, v45
    v_mfma_f32_16x16x32_bf16 v[80:83], v[116:119], v[244:247], v[80:83]
    ds_read_b128 v[124:127], v14 offset:56320
    s_cbranch_vccnz L_as_b
L_ao_b:
    v_and_b32 v99, 0xffff0000, v46
    v_lshlrev_b32 v98, 16, v46
    v_mfma_f32_16x16x32_bf16 v[84:87], v[116:119], v[248:251], v[84:87]
    ds_read_b128 v[128:131], v14 offset:60416
    buffer_load_dwordx4 v[56:59], v136, s[44:47], s11 offen offset:0 sc1
    v_and_b32 v101, 0xffff0000, v48
    v_mfma_f32_16x16x32_bf16 v[84:87], v[112:115], v[240:243], v[84:87]
    ds_read_b128 v[132:135], v14 offset:64512
    buffer_load_dwordx4 v[60:63], v136, s[44:47], s11 offen offset:1024 sc1
    v_lshlrev_b32 v100, 16, v48
    v_mfma_f32_16x16x32_bf16 v[84:87], v[108:111], v[232:235], v[84:87]
    v_and_b32 v103, 0xffff0000, v49
    v_lshlrev_b32 v102, 16, v49
    v_mfma_f32_16x16x32_bf16 v[84:87], v[104:107], v[224:227], v[84:87]
    buffer_load_dwordx4 v[64:67], v136, s[44:47], s11 offen offset:2048 sc1
    s_waitcnt lgkmcnt(2)
    v_mfma_f32_16x16x32_bf16 v[92:95], v[120:123], a[4:7], v[92:95]
    v_mfma_f32_16x16x32_bf16 v[92:95], v[124:127], a[12:15], v[92:95]
    s_waitcnt lgkmcnt(0)
    v_mfma_f32_16x16x32_bf16 v[92:95], v[128:131], a[20:23], v[92:95]
    s_waitcnt vmcnt(11)
    s_barrier
    v_mfma_f32_16x16x32_bf16 v[92:95], v[132:135], a[28:31], v[92:95]
    ds_read_b128 v[104:107], v14 offset:0
    v_mfma_f32_16x16x32_bf16 v[88:91], v[132:135], a[24:27], v[88:91]
    ds_read_b128 v[108:111], v14 offset:4096
    v_cvt_pk_bf16_f32 v192, v72, v73
    v_mfma_f32_16x16x32_bf16 v[88:91], v[128:131], a[16:19], v[88:91]
    ds_read_b128 v[112:115], v14 offset:8192
    v_cvt_pk_bf16_f32 v193, v74, v75
    v_mfma_f32_16x16x32_bf16 v[88:91], v[124:127], a[8:11], v[88:91]
    ds_read_b128 v[116:119], v14 offset:12288
    v_cvt_pk_bf16_f32 v194, v76, v77
    v_mfma_f32_16x16x32_bf16 v[88:91], v[120:123], a[0:3], v[88:91]
    buffer_store_dwordx4 v[192:195], v136, s[44:47], s31 offen offset:0 sc1
    s_waitcnt lgkmcnt(2)
    v_mfma_f32_16x16x32_bf16 v[96:99], v[104:107], a[0:3], v[96:99]
    s_add_u32 m0, s73, 146944
    v_cvt_pk_bf16_f32 v196, v78, v79
    v_cvt_pk_bf16_f32 v197, v80, v81
    v_mfma_f32_16x16x32_bf16 v[96:99], v[108:111], a[8:11], v[96:99]
    buffer_load_dwordx4 v19, s[44:47], s24 offen offset:512 sc1 lds
    s_waitcnt lgkmcnt(0)
    v_mfma_f32_16x16x32_bf16 v[96:99], v[112:115], a[16:19], v[96:99]
    ds_read_b128 v[120:123], v14 offset:1024
    v_cvt_pk_bf16_f32 v198, v82, v83
    v_mfma_f32_16x16x32_bf16 v[96:99], v[116:119], a[24:27], v[96:99]
    buffer_store_dwordx4 v[196:199], v136, s[44:47], s31 offen offset:1024 sc1
    ds_read_b128 v[124:127], v14 offset:5120
    v_bitop3_b32 v207, v207, v211, s36 bitop3:0x7e
    v_bitop3_b32 v207, v207, v215, s36 bitop3:0xf6
    v_mfma_f32_16x16x32_bf16 v[100:103], v[116:119], a[28:31], v[100:103]
    ds_read_b128 v[128:131], v14 offset:9216
    v_cvt_pk_bf16_f32 v200, v84, v85
    v_mfma_f32_16x16x32_bf16 v[100:103], v[112:115], a[20:23], v[100:103]
    ds_read_b128 v[132:135], v14 offset:13312
    v_cvt_pk_bf16_f32 v201, v86, v87
    v_mfma_f32_16x16x32_bf16 v[100:103], v[108:111], a[12:15], v[100:103]
    buffer_store_dwordx4 v[200:203], v136, s[44:47], s31 offen offset:2048 sc1
    s_add_u32 m0, s73, 148480
    v_bitop3_b32 v207, v207, v219, s36 bitop3:0xf6
    v_cmp_ne_u32 vcc, 0, v207
    v_mfma_f32_16x16x32_bf16 v[100:103], v[104:107], a[4:7], v[100:103]
    buffer_load_dwordx4 v19, s[44:47], s25 offen offset:0 sc1 lds
    s_waitcnt lgkmcnt(2)
    v_mfma_f32_16x16x32_bf16 v[92:95], v[120:123], a[36:39], v[92:95]
    s_add_u32 m0, s73, 148992
    s_cbranch_vccnz L_xs_8
L_xo_8:
    v_mfma_f32_16x16x32_bf16 v[92:95], v[124:127], a[44:47], v[92:95]
    buffer_load_dwordx4 v19, s[44:47], s25 offen offset:512 sc1 lds
    s_waitcnt lgkmcnt(0)
    v_mfma_f32_16x16x32_bf16 v[92:95], v[128:131], a[52:55], v[92:95]
    ds_read_b128 v[104:107], v14 offset:2048
    v_and_b32 v33, 0xffff0000, v204
    v_mfma_f32_16x16x32_bf16 v[92:95], v[132:135], a[60:63], v[92:95]
    ds_read_b128 v[108:111], v14 offset:6144
    v_lshlrev_b32 v32, 16, v204
    v_mfma_f32_16x16x32_bf16 v[88:91], v[132:135], a[56:59], v[88:91]
    ds_read_b128 v[112:115], v14 offset:10240
    v_and_b32 v35, 0xffff0000, v205
    v_mfma_f32_16x16x32_bf16 v[88:91], v[128:131], a[48:51], v[88:91]
    ds_read_b128 v[116:119], v14 offset:14336
    v_mfma_f32_16x16x32_bf16 v[88:91], v[124:127], a[40:43], v[88:91]
    s_add_u32 m0, s73, 150528
    v_lshlrev_b32 v34, 16, v205
    v_mfma_f32_16x16x32_bf16 v[88:91], v[120:123], a[32:35], v[88:91]
    buffer_load_dwordx4 v19, s[44:47], s26 offen offset:0 sc1 lds
    s_waitcnt lgkmcnt(2)
    v_mfma_f32_16x16x32_bf16 v[96:99], v[104:107], a[32:35], v[96:99]
    v_add_f32 v32, v32, v27
    v_mfma_f32_16x16x32_bf16 v[96:99], v[108:111], a[40:43], v[96:99]
    v_add_f32 v33, v33, v27
    s_waitcnt lgkmcnt(0)
    v_mfma_f32_16x16x32_bf16 v[96:99], v[112:115], a[48:51], v[96:99]
    ds_read_b128 v[120:123], v14 offset:3072
    v_add_f32 v34, v34, v27
    v_mfma_f32_16x16x32_bf16 v[96:99], v[116:119], a[56:59], v[96:99]
    ds_read_b128 v[124:127], v14 offset:7168
    v_mfma_f32_16x16x32_bf16 v[100:103], v[116:119], a[60:63], v[100:103]
    ds_read_b128 v[128:131], v14 offset:11264
    v_add_f32 v35, v35, v27
    v_mfma_f32_16x16x32_bf16 v[100:103], v[112:115], a[52:55], v[100:103]
    ds_read_b128 v[132:135], v14 offset:15360
    v_and_b32 v37, 0xffff0000, v208
    v_mfma_f32_16x16x32_bf16 v[100:103], v[108:111], a[44:47], v[100:103]
    v_mfma_f32_16x16x32_bf16 v[100:103], v[104:107], a[36:39], v[100:103]
    v_lshlrev_b32 v36, 16, v208
    s_waitcnt lgkmcnt(2)
    v_mfma_f32_16x16x32_bf16 v[92:95], v[120:123], a[68:71], v[92:95]
    v_and_b32 v39, 0xffff0000, v209
    v_mfma_f32_16x16x32_bf16 v[92:95], v[124:127], a[76:79], v[92:95]
    s_waitcnt lgkmcnt(0)
    v_mfma_f32_16x16x32_bf16 v[92:95], v[128:131], a[84:87], v[92:95]
    s_waitcnt vmcnt(14)
    s_barrier
    v_lshlrev_b32 v38, 16, v209
    v_mfma_f32_16x16x32_bf16 v[92:95], v[132:135], a[92:95], v[92:95]
    ds_read_b128 v[104:107], v14 offset:16384
    v_add_f32 v32, v32, v36
    v_mfma_f32_16x16x32_bf16 v[88:91], v[132:135], a[88:91], v[88:91]
    ds_read_b128 v[108:111], v14 offset:20480
    v_mfma_f32_16x16x32_bf16 v[88:91], v[128:131], a[80:83], v[88:91]
    ds_read_b128 v[112:115], v14 offset:24576
    v_add_f32 v33, v33, v37
    v_mfma_f32_16x16x32_bf16 v[88:91], v[124:127], a[72:75], v[88:91]
    ds_read_b128 v[116:119], v14 offset:28672
    v_add_f32 v34, v34, v38
    v_mfma_f32_16x16x32_bf16 v[88:91], v[120:123], a[64:67], v[88:91]
    s_waitcnt lgkmcnt(2)
    v_mfma_f32_16x16x32_bf16 v[96:99], v[104:107], a[64:67], v[96:99]
    s_add_u32 m0, s73, 97792
    v_add_f32 v35, v35, v39
    v_mfma_f32_16x16x32_bf16 v[96:99], v[108:111], a[72:75], v[96:99]
    buffer_load_dwordx4 v19, s[44:47], s26 offen offset:512 sc1 lds
    s_waitcnt lgkmcnt(0)
    v_mfma_f32_16x16x32_bf16 v[96:99], v[112:115], a[80:83], v[96:99]
    ds_read_b128 v[120:123], v14 offset:17408
    v_and_b32 v37, 0xffff0000, v212
    v_mfma_f32_16x16x32_bf16 v[96:99], v[116:119], a[88:91], v[96:99]
    ds_read_b128 v[124:127], v14 offset:21504
    v_lshlrev_b32 v36, 16, v212
    v_mfma_f32_16x16x32_bf16 v[100:103], v[116:119], a[92:95], v[100:103]
    ds_read_b128 v[128:131], v14 offset:25600
    v_and_b32 v39, 0xffff0000, v213
    v_mfma_f32_16x16x32_bf16 v[100:103], v[112:115], a[84:87], v[100:103]
    ds_read_b128 v[132:135], v14 offset:29696
    v_mfma_f32_16x16x32_bf16 v[100:103], v[108:111], a[76:79], v[100:103]
    v_lshlrev_b32 v38, 16, v213
    v_mfma_f32_16x16x32_bf16 v[100:103], v[104:107], a[68:71], v[100:103]
    v_add_f32 v32, v32, v36
    s_waitcnt lgkmcnt(2)
    v_mfma_f32_16x16x32_bf16 v[92:95], v[120:123], a[100:103], v[92:95]
    v_mfma_f32_16x16x32_bf16 v[92:95], v[124:127], a[108:111], v[92:95]
    v_add_f32 v33, v33, v37
    s_waitcnt lgkmcnt(0)
    v_mfma_f32_16x16x32_bf16 v[92:95], v[128:131], a[116:119], v[92:95]
    ds_read_b128 v[104:107], v14 offset:18432
    v_add_f32 v34, v34, v38
    v_mfma_f32_16x16x32_bf16 v[92:95], v[132:135], a[124:127], v[92:95]
    ds_read_b128 v[108:111], v14 offset:22528
    v_add_f32 v35, v35, v39
    v_mfma_f32_16x16x32_bf16 v[88:91], v[132:135], a[120:123], v[88:91]
    ds_read_b128 v[112:115], v14 offset:26624
    v_and_b32 v37, 0xffff0000, v216
    v_mfma_f32_16x16x32_bf16 v[88:91], v[128:131], a[112:115], v[88:91]
    ds_read_b128 v[116:119], v14 offset:30720
    v_lshlrev_b32 v36, 16, v216
    v_mfma_f32_16x16x32_bf16 v[88:91], v[124:127], a[104:107], v[88:91]
    v_and_b32 v39, 0xffff0000, v217
    v_lshlrev_b32 v38, 16, v217
    v_mfma_f32_16x16x32_bf16 v[88:91], v[120:123], a[96:99], v[88:91]
    v_add_f32 v32, v32, v36
    s_waitcnt lgkmcnt(2)
    v_mfma_f32_16x16x32_bf16 v[96:99], v[104:107], a[96:99], v[96:99]
L_pl_D_2:
    s_cbranch_execz L_wret
    v_add_f32 v33, v33, v37
    v_add_f32 v34, v34, v38
    v_mfma_f32_16x16x32_bf16 v[96:99], v[108:111], a[104:107], v[96:99]
    v_add_f32 v35, v35, v39
    s_waitcnt lgkmcnt(0)
    v_mfma_f32_16x16x32_bf16 v[96:99], v[112:115], a[112:115], v[96:99]
    ds_read_b128 v[120:123], v14 offset:19456
    v_mul_f32 v36, s38, v32
    v_mfma_f32_16x16x32_bf16 v[96:99], v[116:119], a[120:123], v[96:99]
    ds_read_b128 v[124:127], v14 offset:23552
    v_mul_f32 v37, s38, v33
    v_mfma_f32_16x16x32_bf16 v[100:103], v[116:119], a[124:127], v[100:103]
    ds_read_b128 v[128:131], v14 offset:27648
    v_mul_f32 v38, s38, v34
    v_mfma_f32_16x16x32_bf16 v[100:103], v[112:115], a[116:119], v[100:103]
    ds_read_b128 v[132:135], v14 offset:31744
    v_mul_f32 v39, s38, v35
    v_mfma_f32_16x16x32_bf16 v[100:103], v[108:111], a[108:111], v[100:103]
    v_exp_f32 v36, v36
    v_mfma_f32_16x16x32_bf16 v[100:103], v[104:107], a[100:103], v[100:103]
    s_waitcnt lgkmcnt(2)
    v_mfma_f32_16x16x32_bf16 v[92:95], v[120:123], a[132:135], v[92:95]
    v_exp_f32 v37, v37
    v_mfma_f32_16x16x32_bf16 v[92:95], v[124:127], a[140:143], v[92:95]
    s_waitcnt lgkmcnt(0)
    v_mfma_f32_16x16x32_bf16 v[92:95], v[128:131], a[148:151], v[92:95]
    s_waitcnt vmcnt(11)
    s_barrier
    v_mfma_f32_16x16x32_bf16 v[92:95], v[132:135], a[156:159], v[92:95]
    ds_read_b128 v[104:107], v14 offset:32768
    v_mfma_f32_16x16x32_bf16 v[88:91], v[132:135], a[152:155], v[88:91]
    ds_read_b128 v[108:111], v14 offset:36864
    v_exp_f32 v38, v38
    v_mfma_f32_16x16x32_bf16 v[88:91], v[128:131], a[144:147], v[88:91]
    ds_read_b128 v[112:115], v14 offset:40960
    v_exp_f32 v39, v39
    v_mfma_f32_16x16x32_bf16 v[88:91], v[124:127], a[136:139], v[88:91]
    ds_read_b128 v[116:119], v14 offset:45056
    v_mul_f32 v180, v180, v32
    v_mfma_f32_16x16x32_bf16 v[88:91], v[120:123], a[128:131], v[88:91]
    v_mul_f32 v181, v181, v33
    s_waitcnt lgkmcnt(2)
    v_mfma_f32_16x16x32_bf16 v[96:99], v[104:107], a[128:131], v[96:99]
    v_mul_f32 v182, v182, v34
    v_mul_f32 v183, v183, v35
    v_mfma_f32_16x16x32_bf16 v[96:99], v[108:111], a[136:139], v[96:99]
    v_add_f32 v36, 1.0, v36
    s_waitcnt lgkmcnt(0)
    v_mfma_f32_16x16x32_bf16 v[96:99], v[112:115], a[144:147], v[96:99]
    ds_read_b128 v[120:123], v14 offset:33792
    v_add_f32 v37, 1.0, v37
    v_mfma_f32_16x16x32_bf16 v[96:99], v[116:119], a[152:155], v[96:99]
    ds_read_b128 v[124:127], v14 offset:37888
    v_add_f32 v38, 1.0, v38
    v_mfma_f32_16x16x32_bf16 v[100:103], v[116:119], a[156:159], v[100:103]
    ds_read_b128 v[128:131], v14 offset:41984
    v_add_f32 v39, 1.0, v39
    v_mfma_f32_16x16x32_bf16 v[100:103], v[112:115], a[148:151], v[100:103]
    ds_read_b128 v[132:135], v14 offset:46080
    v_rcp_f32 v36, v36
    v_mfma_f32_16x16x32_bf16 v[100:103], v[108:111], a[140:143], v[100:103]
    v_rcp_f32 v37, v37
    v_mfma_f32_16x16x32_bf16 v[100:103], v[104:107], a[132:135], v[100:103]
    v_rcp_f32 v38, v38
    s_waitcnt lgkmcnt(2)
    v_mfma_f32_16x16x32_bf16 v[92:95], v[120:123], a[164:167], v[92:95]
    s_waitcnt vmcnt(8)
    v_rcp_f32 v39, v39
    v_mfma_f32_16x16x32_bf16 v[92:95], v[124:127], a[172:175], v[92:95]
    v_bitop3_b32 v59, v59, v63, s68 bitop3:0x7e
    s_waitcnt lgkmcnt(0)
    v_mfma_f32_16x16x32_bf16 v[92:95], v[128:131], a[180:183], v[92:95]
    ds_read_b128 v[104:107], v14 offset:34816
    v_bitop3_b32 v59, v59, v67, s68 bitop3:0xf6
    v_mfma_f32_16x16x32_bf16 v[92:95], v[132:135], a[188:191], v[92:95]
    ds_read_b128 v[108:111], v14 offset:38912
    v_cmp_ne_u32 vcc, 0, v59
    v_mfma_f32_16x16x32_bf16 v[88:91], v[132:135], a[184:187], v[88:91]
    ds_read_b128 v[112:115], v14 offset:43008
    v_fma_f32 v180, v180, v36, v160
    v_mfma_f32_16x16x32_bf16 v[88:91], v[128:131], a[176:179], v[88:91]
    ds_read_b128 v[116:119], v14 offset:47104
    buffer_load_dwordx4 v[72:75], v136, s[44:47], s12 offen offset:0 sc1
    s_cbranch_vccnz L_xs_b
L_xo_b:
    v_mfma_f32_16x16x32_bf16 v[88:91], v[124:127], a[168:171], v[88:91]
    v_and_b32 v41, 0xffff0000, v56
    v_lshlrev_b32 v40, 16, v56
    v_mfma_f32_16x16x32_bf16 v[88:91], v[120:123], a[160:163], v[88:91]
    buffer_load_dwordx4 v[76:79], v136, s[44:47], s12 offen offset:1024 sc1
    s_waitcnt lgkmcnt(2)
    v_mfma_f32_16x16x32_bf16 v[96:99], v[104:107], a[160:163], v[96:99]
    v_and_b32 v43, 0xffff0000, v57
    v_fma_f32 v181, v181, v37, v161
    v_mfma_f32_16x16x32_bf16 v[96:99], v[108:111], a[168:171], v[96:99]
    v_lshlrev_b32 v42, 16, v57
    s_waitcnt lgkmcnt(0)
    v_mfma_f32_16x16x32_bf16 v[96:99], v[112:115], a[176:179], v[96:99]
    ds_read_b128 v[120:123], v14 offset:35840
    buffer_load_dwordx4 v[80:83], v136, s[44:47], s12 offen offset:2048 sc1
    v_mfma_f32_16x16x32_bf16 v[96:99], v[116:119], a[184:187], v[96:99]
    ds_read_b128 v[124:127], v14 offset:39936
    v_and_b32 v45, 0xffff0000, v58
    v_mfma_f32_16x16x32_bf16 v[100:103], v[116:119], a[188:191], v[100:103]
    ds_read_b128 v[128:131], v14 offset:44032
    v_lshlrev_b32 v44, 16, v58
    v_mfma_f32_16x16x32_bf16 v[100:103], v[112:115], a[180:183], v[100:103]
    ds_read_b128 v[132:135], v14 offset:48128
    v_and_b32 v47, 0xffff0000, v60
    v_mfma_f32_16x16x32_bf16 v[100:103], v[108:111], a[172:175], v[100:103]
    v_lshlrev_b32 v46, 16, v60
    v_fma_f32 v182, v182, v38, v162
    v_mfma_f32_16x16x32_bf16 v[100:103], v[104:107], a[164:167], v[100:103]
    v_and_b32 v49, 0xffff0000, v61
    s_waitcnt lgkmcnt(2)
    v_mfma_f32_16x16x32_bf16 v[92:95], v[120:123], a[196:199], v[92:95]
    v_lshlrev_b32 v48, 16, v61
    v_fma_f32 v183, v183, v39, v163
    v_mfma_f32_16x16x32_bf16 v[92:95], v[124:127], a[204:207], v[92:95]
    v_and_b32 v51, 0xffff0000, v62
    s_waitcnt lgkmcnt(0)
    v_mfma_f32_16x16x32_bf16 v[92:95], v[128:131], a[212:215], v[92:95]
    s_waitcnt vmcnt(4)
    s_barrier
    v_lshlrev_b32 v50, 16, v62
    v_mfma_f32_16x16x32_bf16 v[92:95], v[132:135], a[220:223], v[92:95]
    ds_read_b128 v[104:107], v14 offset:49152
    v_cvt_pk_bf16_f32 v142, v180, v181
    v_mfma_f32_16x16x32_bf16 v[88:91], v[132:135], a[216:219], v[88:91]
    ds_read_b128 v[108:111], v14 offset:53248
    v_and_b32 v53, 0xffff0000, v64
    v_mfma_f32_16x16x32_bf16 v[88:91], v[128:131], a[208:211], v[88:91]
    ds_read_b128 v[112:115], v14 offset:57344
    v_lshlrev_b32 v52, 16, v64
    v_mfma_f32_16x16x32_bf16 v[88:91], v[124:127], a[200:203], v[88:91]
    ds_read_b128 v[116:119], v14 offset:61440
    v_and_b32 v55, 0xffff0000, v65
    v_mfma_f32_16x16x32_bf16 v[88:91], v[120:123], a[192:195], v[88:91]
    v_lshlrev_b32 v54, 16, v65
    v_cvt_pk_bf16_f32 v143, v182, v183
    s_waitcnt lgkmcnt(2)
    v_mfma_f32_16x16x32_bf16 v[96:99], v[104:107], a[192:195], v[96:99]
    v_mfma_f32_16x16x32_bf16 v[96:99], v[108:111], a[200:203], v[96:99]
    s_waitcnt lgkmcnt(0)
    v_mfma_f32_16x16x32_bf16 v[96:99], v[112:115], a[208:211], v[96:99]
    ds_read_b128 v[120:123], v14 offset:50176
    v_add_f32 v92, v92, v44
    v_add_f32 v93, v93, v45
    v_mfma_f32_16x16x32_bf16 v[96:99], v[116:119], a[216:219], v[96:99]
    ds_read_b128 v[124:127], v14 offset:54272
    v_add_f32 v94, v94, v46
    v_mfma_f32_16x16x32_bf16 v[100:103], v[116:119], a[220:223], v[100:103]
    ds_read_b128 v[128:131], v14 offset:58368
    v_add_f32 v95, v95, v47
    v_add_f32 v88, v88, v40
    v_mfma_f32_16x16x32_bf16 v[100:103], v[112:115], a[212:215], v[100:103]
    ds_read_b128 v[132:135], v14 offset:62464
    v_add_f32 v89, v89, v41
    v_mfma_f32_16x16x32_bf16 v[100:103], v[108:111], a[204:207], v[100:103]
    v_add_f32 v90, v90, v42
    v_add_f32 v91, v91, v43
    v_mfma_f32_16x16x32_bf16 v[100:103], v[104:107], a[196:199], v[100:103]
    s_waitcnt lgkmcnt(2)
    v_mfma_f32_16x16x32_bf16 v[92:95], v[120:123], a[228:231], v[92:95]
    v_mfma_f32_16x16x32_bf16 v[92:95], v[124:127], a[236:239], v[92:95]
    s_waitcnt lgkmcnt(0)
    v_mfma_f32_16x16x32_bf16 v[92:95], v[128:131], a[244:247], v[92:95]
    ds_read_b128 v[104:107], v14 offset:51200
    v_add_f32 v96, v96, v48
    v_add_f32 v97, v97, v49
    v_mfma_f32_16x16x32_bf16 v[92:95], v[132:135], a[252:255], v[92:95]
    ds_read_b128 v[108:111], v14 offset:55296
    v_add_f32 v98, v98, v50
    v_mfma_f32_16x16x32_bf16 v[88:91], v[132:135], a[248:251], v[88:91]
    ds_read_b128 v[112:115], v14 offset:59392
    v_add_f32 v99, v99, v51
    v_add_f32 v100, v100, v52
    v_mfma_f32_16x16x32_bf16 v[88:91], v[128:131], a[240:243], v[88:91]
    ds_read_b128 v[116:119], v14 offset:63488
    v_add_f32 v101, v101, v53
    v_mfma_f32_16x16x32_bf16 v[88:91], v[124:127], a[232:235], v[88:91]
    v_add_f32 v102, v102, v54
    v_add_f32 v103, v103, v55
    v_mfma_f32_16x16x32_bf16 v[88:91], v[120:123], a[224:227], v[88:91]
    s_waitcnt lgkmcnt(2)
    v_mfma_f32_16x16x32_bf16 v[96:99], v[104:107], a[224:227], v[96:99]
    v_mfma_f32_16x16x32_bf16 v[96:99], v[108:111], a[232:235], v[96:99]
    s_waitcnt lgkmcnt(0)
    v_mfma_f32_16x16x32_bf16 v[96:99], v[112:115], a[240:243], v[96:99]
    ds_read_b128 v[120:123], v14 offset:52224
    v_mfma_f32_16x16x32_bf16 v[96:99], v[116:119], a[248:251], v[96:99]
    ds_read_b128 v[124:127], v14 offset:56320
    v_mfma_f32_16x16x32_bf16 v[100:103], v[116:119], a[252:255], v[100:103]
    buffer_store_dwordx2 v[142:143], v253, s[64:67], 0 offen sc1
    ds_read_b128 v[128:131], v14 offset:60416
    v_mfma_f32_16x16x32_bf16 v[100:103], v[112:115], a[244:247], v[100:103]
    ds_read_b128 v[132:135], v14 offset:64512
    v_mfma_f32_16x16x32_bf16 v[100:103], v[108:111], a[236:239], v[100:103]
    v_mfma_f32_16x16x32_bf16 v[100:103], v[104:107], a[228:231], v[100:103]
    s_waitcnt lgkmcnt(2)
    v_mfma_f32_16x16x32_bf16 v[92:95], v[120:123], v[224:227], v[92:95]
    v_mfma_f32_16x16x32_bf16 v[92:95], v[124:127], v[232:235], v[92:95]
    s_waitcnt lgkmcnt(0)
    v_mfma_f32_16x16x32_bf16 v[92:95], v[128:131], v[240:243], v[92:95]
    s_waitcnt vmcnt(4)
    s_barrier
    v_mfma_f32_16x16x32_bf16 v[92:95], v[132:135], v[248:251], v[92:95]
    ds_read_b128 v[104:107], v14 offset:0
    v_mfma_f32_16x16x32_bf16 v[88:91], v[132:135], v[244:247], v[88:91]
    ds_read_b128 v[108:111], v14 offset:4096
    v_mfma_f32_16x16x32_bf16 v[88:91], v[128:131], v[236:239], v[88:91]
    ds_read_b128 v[112:115], v14 offset:8192
    v_mfma_f32_16x16x32_bf16 v[88:91], v[124:127], v[228:231], v[88:91]
    ds_read_b128 v[116:119], v14 offset:12288
    v_mfma_f32_16x16x32_bf16 v[88:91], v[120:123], v[220:223], v[88:91]
    s_waitcnt lgkmcnt(2)
    v_mfma_f32_16x16x32_bf16 v[96:99], v[104:107], v[220:223], v[96:99]
    v_mfma_f32_16x16x32_bf16 v[96:99], v[108:111], v[228:231], v[96:99]
    s_waitcnt lgkmcnt(0)
    v_mfma_f32_16x16x32_bf16 v[96:99], v[112:115], v[236:239], v[96:99]
    v_mfma_f32_16x16x32_bf16 v[96:99], v[116:119], v[244:247], v[96:99]
    v_mfma_f32_16x16x32_bf16 v[100:103], v[116:119], v[248:251], v[100:103]
    v_mfma_f32_16x16x32_bf16 v[100:103], v[112:115], v[240:243], v[100:103]
    v_mfma_f32_16x16x32_bf16 v[100:103], v[108:111], v[232:235], v[100:103]
    v_mfma_f32_16x16x32_bf16 v[100:103], v[104:107], v[224:227], v[100:103]
    s_waitcnt vmcnt(1)
    v_bitop3_b32 v75, v75, v79, s68 bitop3:0x7e
    v_bitop3_b32 v75, v75, v83, s68 bitop3:0xf6
    v_cmp_ne_u32 vcc, 0, v75
    s_cbranch_vccnz L_xs_z
L_xo_z:
    v_and_b32 v41, 0xffff0000, v72
    v_lshlrev_b32 v40, 16, v72
    v_and_b32 v43, 0xffff0000, v73
    v_lshlrev_b32 v42, 16, v73
    v_and_b32 v45, 0xffff0000, v74
    v_lshlrev_b32 v44, 16, v74
    v_and_b32 v47, 0xffff0000, v76
    v_lshlrev_b32 v46, 16, v76
    v_and_b32 v49, 0xffff0000, v77
    v_lshlrev_b32 v48, 16, v77
    v_and_b32 v51, 0xffff0000, v78
    v_lshlrev_b32 v50, 16, v78
    v_and_b32 v53, 0xffff0000, v80
    v_lshlrev_b32 v52, 16, v80
    v_and_b32 v55, 0xffff0000, v81
    v_lshlrev_b32 v54, 16, v81
    v_pk_add_f32 v[88:89], v[88:89], v[40:41]
    v_pk_add_f32 v[90:91], v[90:91], v[42:43]
    v_pk_add_f32 v[96:97], v[96:97], v[48:49]
    v_pk_add_f32 v[98:99], v[98:99], v[50:51]
    v_pk_mul_f32 v[56:57], v[88:89], s[38:39] op_sel_hi:[1,0]
    v_pk_mul_f32 v[58:59], v[90:91], s[38:39] op_sel_hi:[1,0]
    v_pk_mul_f32 v[64:65], v[96:97], s[38:39] op_sel_hi:[1,0]
    v_pk_mul_f32 v[66:67], v[98:99], s[38:39] op_sel_hi:[1,0]
    v_exp_f32 v56, v56
    v_exp_f32 v57, v57
    v_exp_f32 v58, v58
    v_exp_f32 v59, v59
    v_exp_f32 v64, v64
    v_exp_f32 v65, v65
    v_exp_f32 v66, v66
    v_exp_f32 v67, v67
    v_pk_mul_f32 v[164:165], v[164:165], v[88:89]
    v_pk_mul_f32 v[166:167], v[166:167], v[90:91]
    v_pk_mul_f32 v[172:173], v[172:173], v[96:97]
    v_pk_mul_f32 v[174:175], v[174:175], v[98:99]
    v_pk_add_f32 v[56:57], v[56:57], 1.0 op_sel_hi:[1,0]
    v_pk_add_f32 v[58:59], v[58:59], 1.0 op_sel_hi:[1,0]
    v_pk_add_f32 v[64:65], v[64:65], 1.0 op_sel_hi:[1,0]
    v_pk_add_f32 v[66:67], v[66:67], 1.0 op_sel_hi:[1,0]
    v_rcp_f32 v56, v56
    v_rcp_f32 v57, v57
    v_rcp_f32 v58, v58
    v_rcp_f32 v59, v59
    v_rcp_f32 v64, v64
    v_rcp_f32 v65, v65
    v_rcp_f32 v66, v66
    v_rcp_f32 v67, v67
    v_pk_fma_f32 v[164:165], v[164:165], v[56:57], v[144:145]
    v_pk_fma_f32 v[166:167], v[166:167], v[58:59], v[146:147]
    v_pk_fma_f32 v[172:173], v[172:173], v[64:65], v[152:153]
    v_pk_fma_f32 v[174:175], v[174:175], v[66:67], v[154:155]
    v_cvt_pk_bf16_f32 v88, v164, v165
    v_cvt_pk_bf16_f32 v90, v172, v173
    v_cvt_pk_bf16_f32 v89, v166, v167
    v_cvt_pk_bf16_f32 v91, v174, v175
    v_permlane16_swap_b32 v88, v90
    s_nop 0
    v_permlane16_swap_b32 v89, v91
    buffer_store_dwordx4 v[88:91], v252, s[64:67], 0 offen sc1
    v_pk_add_f32 v[92:93], v[92:93], v[44:45]
    v_pk_add_f32 v[94:95], v[94:95], v[46:47]
    v_pk_add_f32 v[100:101], v[100:101], v[52:53]
    v_pk_add_f32 v[102:103], v[102:103], v[54:55]
    v_pk_mul_f32 v[60:61], v[92:93], s[38:39] op_sel_hi:[1,0]
    v_pk_mul_f32 v[62:63], v[94:95], s[38:39] op_sel_hi:[1,0]
    v_pk_mul_f32 v[68:69], v[100:101], s[38:39] op_sel_hi:[1,0]
    v_pk_mul_f32 v[70:71], v[102:103], s[38:39] op_sel_hi:[1,0]
    v_exp_f32 v60, v60
    v_exp_f32 v61, v61
    v_exp_f32 v62, v62
    v_exp_f32 v63, v63
    v_exp_f32 v68, v68
    v_exp_f32 v69, v69
    v_exp_f32 v70, v70
    v_exp_f32 v71, v71
    v_pk_mul_f32 v[168:169], v[168:169], v[92:93]
    v_pk_mul_f32 v[170:171], v[170:171], v[94:95]
    v_pk_mul_f32 v[176:177], v[176:177], v[100:101]
    v_pk_mul_f32 v[178:179], v[178:179], v[102:103]
    v_pk_add_f32 v[60:61], v[60:61], 1.0 op_sel_hi:[1,0]
    v_pk_add_f32 v[62:63], v[62:63], 1.0 op_sel_hi:[1,0]
    v_pk_add_f32 v[68:69], v[68:69], 1.0 op_sel_hi:[1,0]
    v_pk_add_f32 v[70:71], v[70:71], 1.0 op_sel_hi:[1,0]
    v_rcp_f32 v60, v60
    v_rcp_f32 v61, v61
    v_rcp_f32 v62, v62
    v_rcp_f32 v63, v63
    v_rcp_f32 v68, v68
    v_rcp_f32 v69, v69
    v_rcp_f32 v70, v70
    v_rcp_f32 v71, v71
    v_pk_fma_f32 v[168:169], v[168:169], v[60:61], v[148:149]
    v_pk_fma_f32 v[170:171], v[170:171], v[62:63], v[150:151]
    v_pk_fma_f32 v[176:177], v[176:177], v[68:69], v[156:157]
    v_pk_fma_f32 v[178:179], v[178:179], v[70:71], v[158:159]
    v_cvt_pk_bf16_f32 v92, v168, v169
    v_cvt_pk_bf16_f32 v94, v176, v177
    v_cvt_pk_bf16_f32 v93, v170, v171
    v_cvt_pk_bf16_f32 v95, v178, v179
    v_permlane16_swap_b32 v92, v94
    s_nop 0
    v_permlane16_swap_b32 v93, v95
    buffer_store_dwordx4 v[92:95], v252, s[64:67], s40 offen sc1
    s_endpgm
L_segE:
.p2align 12
L_aux:
    s_mul_i32 s84, s101, 14
    s_lshr_b32 s84, s84, 2
    s_add_u32 s84, s84, 0
    s_add_u32 s85, s84, 1
    s_cmp_eq_u32 s85, 14
    s_cselect_b32 s85, 0, s85
    s_add_u32 s86, s85, 1
    s_cmp_eq_u32 s86, 14
    s_cselect_b32 s86, 0, s86
    s_add_u32 s87, s86, 1
    s_cmp_eq_u32 s87, 14
    s_cselect_b32 s87, 0, s87
    s_add_u32 s88, s87, 1
    s_cmp_eq_u32 s88, 14
    s_cselect_b32 s88, 0, s88
    s_add_u32 s89, s88, 1
    s_cmp_eq_u32 s89, 14
    s_cselect_b32 s89, 0, s89
    s_add_u32 s90, s89, 1
    s_cmp_eq_u32 s90, 14
    s_cselect_b32 s90, 0, s90
    s_add_u32 s91, s90, 1
    s_cmp_eq_u32 s91, 14
    s_cselect_b32 s91, 0, s91
    s_add_u32 s92, s91, 1
    s_cmp_eq_u32 s92, 14
    s_cselect_b32 s92, 0, s92
    s_add_u32 s93, s92, 1
    s_cmp_eq_u32 s93, 14
    s_cselect_b32 s93, 0, s93
    s_add_u32 s94, s93, 1
    s_cmp_eq_u32 s94, 14
    s_cselect_b32 s94, 0, s94
    s_add_u32 s95, s94, 1
    s_cmp_eq_u32 s95, 14
    s_cselect_b32 s95, 0, s95
    s_add_u32 s96, s95, 1
    s_cmp_eq_u32 s96, 14
    s_cselect_b32 s96, 0, s96
    s_add_u32 s97, s96, 1
    s_cmp_eq_u32 s97, 14
    s_cselect_b32 s97, 0, s97
    s_mul_i32 s98, s101, 4
    s_lshr_b32 s98, s98, 2
    s_add_u32 s98, s98, 14
    s_add_u32 s99, s98, 1
    s_cmp_eq_u32 s99, 18
    s_cselect_b32 s99, 14, s99
    s_add_u32 s100, s99, 1
    s_cmp_eq_u32 s100, 18
    s_cselect_b32 s100, 14, s100
    s_add_u32 s101, s100, 1
    s_cmp_eq_u32 s101, 18
    s_cselect_b32 s101, 14, s101
    s_lshl2_add_u32 s7, s5, s6
    s_add_u32 s7, s7, 188
    s_add_u32 s8, s5, 248
    s_cmp_eq_u32 s6, 27
    s_cselect_b32 s75, s8, s7
    s_mov_b32 s48, s24
    s_and_b32 s49, s25, 0xffff
    s_mov_b32 s50, 2359296
    s_mov_b32 s51, 0x20000
    v_lshlrev_b32 v240, 4, v2
    s_mul_i32 s74, s3, 16640
    s_add_u32 s74, s74, 73728
    s_sub_u32 s69, s75, 216
    s_lshl_b32 s70, s69, 4
    s_add_u32 s70, s70, s3
    s_lshl_b32 s12, s70, 12
    s_lshl_b32 s70, s70, 1
    v_lshrrev_b32 v242, 5, v2
    v_and_b32 v243, 31, v2
    v_lshlrev_b32 v242, 14, v242
    v_lshl_add_u32 v242, v243, 7, v242
    s_add_u32 s13, s12, 32768
    s_mov_b32 s9, 144896
    s_mov_b32 s11, 114688
    s_waitcnt vmcnt(9)
    v_and_b32 v21, 0xffff0000, v8
    v_lshlrev_b32 v20, 16, v8
    v_and_b32 v23, 0xffff0000, v9
    v_lshlrev_b32 v22, 16, v9
    v_and_b32 v25, 0xffff0000, v10
    v_lshlrev_b32 v24, 16, v10
    v_and_b32 v27, 0xffff0000, v12
    v_lshlrev_b32 v26, 16, v12
    v_and_b32 v29, 0xffff0000, v13
    v_lshlrev_b32 v28, 16, v13
    v_and_b32 v31, 0xffff0000, v14
    v_lshlrev_b32 v30, 16, v14
    v_and_b32 v33, 0xffff0000, v16
    v_lshlrev_b32 v32, 16, v16
    v_and_b32 v35, 0xffff0000, v17
    v_lshlrev_b32 v34, 16, v17
    v_and_b32 v37, 0xffff0000, v18
    v_lshlrev_b32 v36, 16, v18
    v_pk_add_f32 v[38:39], v[20:21], v[22:23]
    v_pk_add_f32 v[40:41], v[24:25], v[26:27]
    v_pk_add_f32 v[42:43], v[28:29], v[30:31]
    v_pk_add_f32 v[44:45], v[32:33], v[34:35]
    v_pk_add_f32 v[38:39], v[38:39], v[40:41]
    v_pk_add_f32 v[42:43], v[42:43], v[44:45]
    v_pk_add_f32 v[38:39], v[38:39], v[36:37]
    v_pk_add_f32 v[38:39], v[38:39], v[42:43]
    v_add_f32 v56, v38, v39
    s_nop 1
    v_add_f32_dpp v56, v56, v56 row_ror:8 row_mask:0xf bank_mask:0xf
    s_nop 1
    v_add_f32_dpp v56, v56, v56 row_ror:4 row_mask:0xf bank_mask:0xf
    s_nop 1
    v_add_f32_dpp v56, v56, v56 row_ror:2 row_mask:0xf bank_mask:0xf
    s_nop 1
    v_add_f32_dpp v56, v56, v56 row_ror:1 row_mask:0xf bank_mask:0xf
    v_mov_b32 v57, v56
    s_nop 1
    v_permlane16_swap_b32 v56, v57
    v_add_f32 v56, v56, v57
    v_mul_f32 v56, 0x3ae38e39, v56
    v_pk_add_f32 v[20:21], v[20:21], v[56:57] op_sel_hi:[1,0] neg_lo:[0,1] neg_hi:[0,1]
    v_pk_add_f32 v[22:23], v[22:23], v[56:57] op_sel_hi:[1,0] neg_lo:[0,1] neg_hi:[0,1]
    v_pk_add_f32 v[24:25], v[24:25], v[56:57] op_sel_hi:[1,0] neg_lo:[0,1] neg_hi:[0,1]
    v_pk_add_f32 v[26:27], v[26:27], v[56:57] op_sel_hi:[1,0] neg_lo:[0,1] neg_hi:[0,1]
    v_pk_add_f32 v[28:29], v[28:29], v[56:57] op_sel_hi:[1,0] neg_lo:[0,1] neg_hi:[0,1]
    v_pk_add_f32 v[30:31], v[30:31], v[56:57] op_sel_hi:[1,0] neg_lo:[0,1] neg_hi:[0,1]
    v_pk_add_f32 v[32:33], v[32:33], v[56:57] op_sel_hi:[1,0] neg_lo:[0,1] neg_hi:[0,1]
    v_pk_add_f32 v[34:35], v[34:35], v[56:57] op_sel_hi:[1,0] neg_lo:[0,1] neg_hi:[0,1]
    v_pk_add_f32 v[36:37], v[36:37], v[56:57] op_sel_hi:[1,0] neg_lo:[0,1] neg_hi:[0,1]
    v_pk_mul_f32 v[38:39], v[20:21], v[20:21]
    v_pk_mul_f32 v[40:41], v[22:23], v[22:23]
    v_pk_fma_f32 v[38:39], v[24:25], v[24:25], v[38:39]
    v_pk_fma_f32 v[40:41], v[26:27], v[26:27], v[40:41]
    v_pk_fma_f32 v[38:39], v[28:29], v[28:29], v[38:39]
    v_pk_fma_f32 v[40:41], v[30:31], v[30:31], v[40:41]
    v_pk_fma_f32 v[38:39], v[32:33], v[32:33], v[38:39]
    v_pk_fma_f32 v[40:41], v[34:35], v[34:35], v[40:41]
    v_pk_fma_f32 v[38:39], v[36:37], v[36:37], v[38:39]
    v_pk_add_f32 v[38:39], v[38:39], v[40:41]
    v_add_f32 v18, v38, v39
    s_nop 1
    v_add_f32_dpp v18, v18, v18 row_ror:8 row_mask:0xf bank_mask:0xf
    s_nop 1
    v_add_f32_dpp v18, v18, v18 row_ror:4 row_mask:0xf bank_mask:0xf
    s_nop 1
    v_add_f32_dpp v18, v18, v18 row_ror:2 row_mask:0xf bank_mask:0xf
    s_nop 1
    v_add_f32_dpp v18, v18, v18 row_ror:1 row_mask:0xf bank_mask:0xf
    v_mov_b32 v19, v18
    s_nop 1
    v_permlane16_swap_b32 v18, v19
    v_add_f32 v18, v18, v19
    v_mul_f32 v18, 0x3ae38e39, v18
    v_cvt_pk_bf16_f32 v38, v56, v18
    v_lshlrev_b32 v106, 16, v38
    v_and_b32 v38, 0xffff0000, v38
    v_add_f32 v38, 0x3727c5ac, v38
    v_sub_f32 v56, v56, v106
    v_cvt_pk_bf16_f32 v38, v38, v38
    v_lshlrev_b32 v38, 16, v38
    v_sqrt_f32 v38, v38
    s_nop 0
    v_cvt_pk_bf16_f32 v38, v38, v38
    v_lshlrev_b32 v38, 16, v38
    v_rcp_f32 v107, v38
    s_nop 0
    v_mul_f32 v56, v56, v107
    v_mul_f32 v18, v18, v107
    v_mul_f32 v18, v18, v107
    v_cvt_pk_bf16_f32 v38, v56, v18
    v_lshlrev_b32 v39, 16, v38
    v_and_b32 v38, 0xffff0000, v38
    v_add_f32 v38, 0x3727c5ac, v38
    v_sub_f32 v56, v56, v39
    v_cvt_pk_bf16_f32 v38, v38, v38
    v_lshlrev_b32 v38, 16, v38
    v_sqrt_f32 v38, v38
    s_nop 0
    v_cvt_pk_bf16_f32 v38, v38, v38
    v_lshlrev_b32 v38, 16, v38
    v_rcp_f32 v38, v38
    s_nop 0
    v_mul_f32 v18, v107, v38
    v_mul_f32 v56, v56, v38
    v_pk_fma_f32 v[20:21], v[20:21], v[18:19], v[56:57] op_sel_hi:[1,0,0]
    v_pk_fma_f32 v[22:23], v[22:23], v[18:19], v[56:57] op_sel_hi:[1,0,0]
    v_pk_fma_f32 v[24:25], v[24:25], v[18:19], v[56:57] op_sel_hi:[1,0,0]
    v_pk_fma_f32 v[26:27], v[26:27], v[18:19], v[56:57] op_sel_hi:[1,0,0]
    v_pk_fma_f32 v[28:29], v[28:29], v[18:19], v[56:57] op_sel_hi:[1,0,0]
    v_pk_fma_f32 v[30:31], v[30:31], v[18:19], v[56:57] op_sel_hi:[1,0,0]
    v_pk_fma_f32 v[32:33], v[32:33], v[18:19], v[56:57] op_sel_hi:[1,0,0]
    v_pk_fma_f32 v[34:35], v[34:35], v[18:19], v[56:57] op_sel_hi:[1,0,0]
    v_pk_fma_f32 v[36:37], v[36:37], v[18:19], v[56:57] op_sel_hi:[1,0,0]
    v_cvt_pk_bf16_f32 v8, v20, v21
    v_cvt_pk_bf16_f32 v9, v22, v23
    v_cvt_pk_bf16_f32 v10, v24, v25
    v_cvt_pk_bf16_f32 v11, v26, v27
    v_cvt_pk_bf16_f32 v12, v28, v29
    v_cvt_pk_bf16_f32 v13, v30, v31
    v_cvt_pk_bf16_f32 v14, v32, v33
    v_cvt_pk_bf16_f32 v15, v34, v35
    v_cvt_pk_bf16_f32 v16, v36, v37
    v_lshrrev_b32 v3, 5, v0
    v_and_b32 v1, 31, v0
    v_mul_u32_u24 v17, 1216, v3
    v_mad_u32_u24 v17, v1, 12, v17
    v_add_u32 v17, 144896, v17
    ds_write_b32 v17, v8 offset:0
    ds_write_b32 v17, v9 offset:4
    ds_write_b32 v17, v10 offset:8
    ds_write_b32 v17, v11 offset:384
    ds_write_b32 v17, v12 offset:388
    ds_write_b32 v17, v13 offset:392
    ds_write_b32 v17, v14 offset:768
    ds_write_b32 v17, v15 offset:772
    ds_write_b32 v17, v16 offset:776
    v_lshlrev_b32 v3, 3, v3
    s_lshl_b32 s5, s68, 6
    s_add_u32 s5, s5, 12386304
    v_cmp_eq_u32 vcc, 0, v1
    v_mov_b32 v18, 0x40000000
    s_nop 0
    v_cndmask_b32 v3, v18, v3, vcc
    buffer_store_dwordx2 v[106:107], v3, s[44:47], s5 offen sc1
    v_lshrrev_b32 v19, 4, v0
    v_and_b32 v17, 3, v2
    v_lshlrev_b32 v17, 3, v17
    v_lshl_add_u32 v19, v19, 5, v17
    v_bfe_u32 v6, v2, 2, 2
    v_mul_u32_u24 v17, 1216, v6
    v_mul_u32_u24 v6, 1152, v6
    v_add3_u32 v17, v17, v19, s9
    v_add3_u32 v6, v6, v19, s11
    v_lshlrev_b32 v19, 4, v0
    s_add_u32 s7, s15, 4096
    s_add_u32 s8, s15, 8192
    s_cmp_eq_u32 s3, 0
    s_cselect_b32 s8, s8, 0x40000000
    v_add_u32 v18, 2359296, v19
    v_mov_b32 v44, 0
    s_waitcnt lgkmcnt(0)
    s_barrier
    ds_read_b64_tr_b16 v[20:21], v17 offset:0
    ds_read_b64_tr_b16 v[22:23], v17 offset:4864
    ds_read_b64_tr_b16 v[24:25], v17 offset:512
    ds_read_b64_tr_b16 v[26:27], v17 offset:5376
    ds_read_b64_tr_b16 v[28:29], v17 offset:1024
    ds_read_b64_tr_b16 v[30:31], v17 offset:5888
    s_bfe_u32 s6, s68, 0x20001
    s_lshl_b32 s6, s6, 6
    s_lshr_b32 s9, s68, 3
    s_lshl_b32 s9, s9, 1
    s_add_u32 s6, s6, s9
    s_and_b32 s9, s68, 1
    s_add_u32 s6, s6, s9
    s_lshr_b32 s4, s6, 2
    s_lshl_b32 s4, s4, 7
    s_and_b32 s5, s6, 3
    s_lshl2_add_u32 s4, s5, s4
    s_add_u32 s4, s4, 12533760
    v_min_u32 v1, 1, v0
    v_lshlrev_b32 v1, 30, v1
    v_add_u32 v1, s4, v1
    s_waitcnt lgkmcnt(4)
    buffer_store_dwordx4 v[20:23], v19, s[44:47], s15 offen sc1
    s_waitcnt lgkmcnt(2)
    buffer_store_dwordx4 v[24:27], v19, s[44:47], s7 offen sc1
    s_waitcnt lgkmcnt(0)
    buffer_store_dwordx4 v[28:31], v19, s[44:47], s8 offen sc1
    buffer_load_dword v45, v44, s[64:67], 0 offen sc1
    s_waitcnt vmcnt(6)
    s_barrier
    ds_read_b64_tr_b16 v[60:61], v6 offset:0
    ds_read_b64_tr_b16 v[62:63], v6 offset:4608
    ds_read_b64_tr_b16 v[64:65], v6 offset:9216
    ds_read_b64_tr_b16 v[66:67], v6 offset:12672
    ds_read_b64_tr_b16 v[68:69], v6 offset:17280
    ds_read_b64_tr_b16 v[70:71], v6 offset:512
    ds_read_b64_tr_b16 v[72:73], v6 offset:5120
    ds_read_b64_tr_b16 v[74:75], v6 offset:9728
    ds_read_b64_tr_b16 v[76:77], v6 offset:13184
    ds_read_b64_tr_b16 v[78:79], v6 offset:17792
    v_alignbit_b32 v114, v99, v99, 16
    v_alignbit_b32 v115, v98, v98, 16
    s_waitcnt lgkmcnt(5)
    v_alignbit_b32 v108, v61, v60, 16
    v_alignbit_b32 v109, v62, v61, 16
    v_alignbit_b32 v110, v63, v62, 16
    v_alignbit_b32 v111, v64, v63, 16
    v_alignbit_b32 v112, v65, v64, 16
    v_dot2_f32_bf16 v116, v60, v114, 0
    ds_read_b64_tr_b16 v[80:81], v6 offset:1024
    v_dot2_f32_bf16 v117, v108, v114, 0
    v_dot2_f32_bf16 v118, v61, v114, 0
    v_dot2_f32_bf16 v119, v109, v114, 0
    v_dot2_f32_bf16 v120, v62, v114, 0
    ds_read_b64_tr_b16 v[82:83], v6 offset:5632
    v_dot2_f32_bf16 v121, v110, v114, 0
    v_dot2_f32_bf16 v122, v63, v114, 0
    v_dot2_f32_bf16 v123, v111, v114, 0
    v_dot2_f32_bf16 v116, v61, v115, v116
    v_dot2_f32_bf16 v117, v109, v115, v117
    ds_read_b64_tr_b16 v[84:85], v6 offset:10240
    v_dot2_f32_bf16 v118, v62, v115, v118
    v_dot2_f32_bf16 v119, v110, v115, v119
    v_dot2_f32_bf16 v120, v63, v115, v120
    v_dot2_f32_bf16 v121, v111, v115, v121
    v_dot2_f32_bf16 v122, v64, v115, v122
    ds_read_b64_tr_b16 v[86:87], v6 offset:13696
    v_dot2_f32_bf16 v123, v112, v115, v123
    v_and_b32 v133, 0xffff0000, v66
    v_lshlrev_b32 v132, 16, v66
    v_and_b32 v135, 0xffff0000, v67
    v_lshlrev_b32 v134, 16, v67
    ds_read_b64_tr_b16 v[88:89], v6 offset:18304
    v_and_b32 v137, 0xffff0000, v68
    v_lshlrev_b32 v136, 16, v68
    v_and_b32 v139, 0xffff0000, v69
    v_lshlrev_b32 v138, 16, v69
    v_pk_mul_f32 v[116:117], v[116:117], v[132:133]
    v_pk_mul_f32 v[118:119], v[118:119], v[134:135]
    v_pk_mul_f32 v[120:121], v[120:121], v[136:137]
    v_pk_mul_f32 v[122:123], v[122:123], v[138:139]
    v_cvt_pk_bf16_f32 v160, v123, v122
    v_cvt_pk_bf16_f32 v161, v121, v120
    v_cvt_pk_bf16_f32 v162, v119, v118
    v_cvt_pk_bf16_f32 v163, v117, v116
    buffer_store_dwordx4 v[160:163], v18, s[44:47], s15 offen sc1
    v_alignbit_b32 v114, v101, v101, 16
    v_alignbit_b32 v115, v100, v100, 16
    s_waitcnt lgkmcnt(5)
    v_alignbit_b32 v108, v71, v70, 16
    v_alignbit_b32 v109, v72, v71, 16
    v_alignbit_b32 v110, v73, v72, 16
    v_alignbit_b32 v111, v74, v73, 16
    v_alignbit_b32 v112, v75, v74, 16
    v_dot2_f32_bf16 v124, v70, v114, 0
    v_dot2_f32_bf16 v125, v108, v114, 0
    v_dot2_f32_bf16 v126, v71, v114, 0
    v_dot2_f32_bf16 v127, v109, v114, 0
    v_dot2_f32_bf16 v128, v72, v114, 0
    v_dot2_f32_bf16 v129, v110, v114, 0
    v_dot2_f32_bf16 v130, v73, v114, 0
    v_dot2_f32_bf16 v131, v111, v114, 0
    v_dot2_f32_bf16 v124, v71, v115, v124
    v_dot2_f32_bf16 v125, v109, v115, v125
    v_dot2_f32_bf16 v126, v72, v115, v126
    v_dot2_f32_bf16 v127, v110, v115, v127
    v_dot2_f32_bf16 v128, v73, v115, v128
    v_dot2_f32_bf16 v129, v111, v115, v129
    v_dot2_f32_bf16 v130, v74, v115, v130
    v_dot2_f32_bf16 v131, v112, v115, v131
    v_and_b32 v133, 0xffff0000, v76
    v_lshlrev_b32 v132, 16, v76
    v_and_b32 v135, 0xffff0000, v77
    v_lshlrev_b32 v134, 16, v77
    v_and_b32 v137, 0xffff0000, v78
    v_lshlrev_b32 v136, 16, v78
    v_and_b32 v139, 0xffff0000, v79
    v_lshlrev_b32 v138, 16, v79
    v_pk_mul_f32 v[124:125], v[124:125], v[132:133]
    v_pk_mul_f32 v[126:127], v[126:127], v[134:135]
    v_pk_mul_f32 v[128:129], v[128:129], v[136:137]
    v_pk_mul_f32 v[130:131], v[130:131], v[138:139]
    v_cvt_pk_bf16_f32 v164, v131, v130
    v_cvt_pk_bf16_f32 v165, v129, v128
    v_cvt_pk_bf16_f32 v166, v127, v126
    v_cvt_pk_bf16_f32 v167, v125, v124
    buffer_store_dwordx4 v[164:167], v18, s[44:47], s7 offen sc1
    v_alignbit_b32 v114, v103, v103, 16
    v_alignbit_b32 v115, v102, v102, 16
    s_waitcnt lgkmcnt(0)
    v_alignbit_b32 v108, v81, v80, 16
    v_alignbit_b32 v109, v82, v81, 16
    v_alignbit_b32 v110, v83, v82, 16
    v_alignbit_b32 v111, v84, v83, 16
    v_alignbit_b32 v112, v85, v84, 16
    v_dot2_f32_bf16 v116, v80, v114, 0
    v_dot2_f32_bf16 v117, v108, v114, 0
    v_dot2_f32_bf16 v118, v81, v114, 0
    v_dot2_f32_bf16 v119, v109, v114, 0
    v_dot2_f32_bf16 v120, v82, v114, 0
    v_dot2_f32_bf16 v121, v110, v114, 0
    v_dot2_f32_bf16 v122, v83, v114, 0
    v_dot2_f32_bf16 v123, v111, v114, 0
    v_dot2_f32_bf16 v116, v81, v115, v116
    v_dot2_f32_bf16 v117, v109, v115, v117
    v_dot2_f32_bf16 v118, v82, v115, v118
    v_dot2_f32_bf16 v119, v110, v115, v119
    v_dot2_f32_bf16 v120, v83, v115, v120
    v_dot2_f32_bf16 v121, v111, v115, v121
    v_dot2_f32_bf16 v122, v84, v115, v122
    v_dot2_f32_bf16 v123, v112, v115, v123
    v_and_b32 v133, 0xffff0000, v86
    v_lshlrev_b32 v132, 16, v86
    v_and_b32 v135, 0xffff0000, v87
    v_lshlrev_b32 v134, 16, v87
    v_and_b32 v137, 0xffff0000, v88
    v_lshlrev_b32 v136, 16, v88
    v_and_b32 v139, 0xffff0000, v89
    v_lshlrev_b32 v138, 16, v89
    v_pk_mul_f32 v[116:117], v[116:117], v[132:133]
    v_pk_mul_f32 v[118:119], v[118:119], v[134:135]
    v_pk_mul_f32 v[120:121], v[120:121], v[136:137]
    v_pk_mul_f32 v[122:123], v[122:123], v[138:139]
    v_cvt_pk_bf16_f32 v168, v123, v122
    v_cvt_pk_bf16_f32 v169, v121, v120
    v_cvt_pk_bf16_f32 v170, v119, v118
    v_cvt_pk_bf16_f32 v171, v117, v116
    buffer_store_dwordx4 v[168:171], v18, s[44:47], s8 offen sc1
    s_mov_b64 exec, 0
    s_call_b64 s[82:83], L_wc_X
    s_mov_b64 exec, -1
    s_waitcnt vmcnt(3)
    v_readfirstlane_b32 s68, v45
    s_nop 1
    s_cmp_eq_u32 s68, 0
    s_cbranch_scc1 L_nw_X
L_ng_X:
    s_barrier
    v_mov_b32 v3, s68
    buffer_store_dword v3, v1, s[44:47], 0 offen sc1
    v_add_u32 v1, 65536, v1
    s_waitcnt vmcnt(1)
    s_barrier
    buffer_store_dword v3, v1, s[44:47], 0 offen sc1
    s_mov_b64 exec, 0
    s_call_b64 s[82:83], L_wc_D
    s_mov_b64 exec, -1
L_segX:
L_pl_X_0:
    s_cbranch_execz L_pl_X_4
    s_add_u32 m0, s74, 32
    s_add_u32 s13, s12, 0
    buffer_load_dwordx4 v240, s[48:51], s13 offen offset:0 lds
    buffer_load_dwordx4 v240, s[48:51], s13 offen offset:1024 lds
    buffer_load_dwordx4 v240, s[48:51], s13 offen offset:2048 lds
    buffer_load_dwordx4 v240, s[48:51], s13 offen offset:3072 lds
    s_mov_b32 s60, s36
    s_and_b32 s61, s37, 0xffff
    s_mov_b32 s62, 4096
    s_mov_b32 s63, 0x20000
    v_and_b32 v24, 15, v2
    s_lshl_b32 s7, s71, 6
    v_add_u32 v24, s7, v24
    s_and_b32 s8, s3, 1
    s_lshl_b32 s4, s8, 5
    v_add_u32 v25, s4, v24
    v_lshlrev_b32 v26, 3, v25
    v_mul_u32_u24 v25, 1152, v25
    v_bfe_u32 v31, v2, 4, 1
    v_lshl_add_u32 v25, v31, 5, v25
    v_lshrrev_b32 v31, 5, v2
    v_lshl_add_u32 v25, v31, 4, v25
    s_bfe_u32 s7, s2, 0x20003
    s_mul_i32 s7, s7, 288
    s_lshl_b32 s4, s72, 6
    s_add_u32 s4, s4, s7
    v_add_u32 v252, s4, v25
    s_xor_b32 s8, s3, s72
    s_and_b32 s4, s72, 1
    s_lshl1_add_u32 s4, s4, s8
    v_lshl_add_u32 v24, s4, 4, v24
    s_add_u32 s7, s7, 256
    s_cmp_lt_u32 s8, 2
    s_cselect_b32 s7, s7, 0x40000000
    v_lshlrev_b32 v18, 3, v24
    v_mul_u32_u24 v24, 1152, v24
    v_lshrrev_b32 v31, 4, v2
    v_lshl_add_u32 v24, v31, 3, v24
    v_add_u32 v253, s7, v24
    v_lshrrev_b32 v24, 3, v2
    v_and_b32 v25, 7, v2
    v_bfe_u32 v31, v2, 4, 2
    v_lshlrev_b32 v31, 1, v31
    v_xor_b32 v25, v25, v31
    v_lshlrev_b32 v24, 12, v24
    v_lshl_add_u32 v24, v25, 4, v24
    s_mul_i32 s7, s72, 36
    s_bitcmp1_b32 s3, 0
    s_addc_u32 s7, s7, 0
    s_lshl_b32 s7, s7, 17
    s_lshl_b32 s8, s71, 7
    s_add_u32 s7, s7, s8
    v_add_u32 v4, s7, v24
    v_add_u32 v5, 31744, v4
    v_add_u32 v6, 31744, v5
    v_add_u32 v7, 31744, v6
    v_lshrrev_b32 v24, 2, v2
    v_lshlrev_b32 v24, 7, v24
    v_and_b32 v25, 3, v2
    v_lshl_add_u32 v24, v25, 3, v24
    s_and_b32 s7, s73, 8192
    v_add_u32 v24, s7, v24
    v_bfe_u32 v31, v2, 3, 2
    s_and_b32 s7, s3, 1
    s_lshl_b32 s7, s7, 1
    v_xor_b32 v31, s7, v31
    v_lshl_add_u32 v10, v31, 5, v24
    v_xor_b32 v11, 32, v10
    v_and_b32 v24, 15, v2
    v_lshrrev_b32 v25, 4, v2
    v_mul_u32_u24 v25, 17408, v25
    v_lshl_add_u32 v24, v24, 4, v25
    s_mul_i32 s7, s72, 36
    s_and_b32 s8, s3, 1
    s_add_u32 s7, s7, s8
    s_mul_i32 s7, s7, 69632
    s_bfe_u32 s8, s2, 0x20003
    s_lshl_b32 s8, s8, 12
    s_add_u32 s7, s7, s8
    s_add_u32 s7, s7, 12795904
    v_add_u32 v23, s7, v24
    s_xor_b32 s7, s72, 0
    v_lshl_add_u32 v19, s7, 10, v23
    s_xor_b32 s7, s72, 1
    v_lshl_add_u32 v20, s7, 10, v23
    s_xor_b32 s7, s72, 2
    v_lshl_add_u32 v21, s7, 10, v23
    s_xor_b32 s7, s72, 3
    v_lshl_add_u32 v22, s7, 10, v23
    v_lshlrev_b32 v14, 4, v2
    v_add_u32 v14, 98304, v14
    v_add_u32 v1, 0x10000, v14
    s_cmp_lt_u32 s75, 252
    s_cbranch_scc0 L_idle
    s_mov_b32 s56, s26
    s_and_b32 s57, s27, 0xffff
    s_mov_b32 s58, 1152
    s_mov_b32 s59, 0x20000
    s_bitcmp1_b32 s3, 1
    s_cselect_b32 s18, s85, s84
    s_mul_i32 s18, s18, 139264
    s_cselect_b32 s19, s87, s86
    s_mul_i32 s19, s19, 139264
    s_cselect_b32 s20, s89, s88
    s_mul_i32 s20, s20, 139264
    s_cselect_b32 s21, s91, s90
    s_mul_i32 s21, s21, 139264
    s_cselect_b32 s22, s93, s92
    s_mul_i32 s22, s22, 139264
    s_cselect_b32 s23, s95, s94
    s_mul_i32 s23, s23, 139264
    s_cselect_b32 s24, s97, s96
    s_mul_i32 s24, s24, 139264
    s_cselect_b32 s25, s99, s98
    s_mul_i32 s25, s25, 139264
    s_cselect_b32 s26, s101, s100
    s_mul_i32 s26, s26, 139264
    v_mov_b32 v9, 0
    buffer_load_ushort v9, v9, s[56:59], s70 offen
    s_lshl_b32 s4, s3, 6
    v_min_u32 v28, 63, v2
    v_add_u32 v28, s4, v28
    v_and_b32 v29, 3, v28
    v_lshrrev_b32 v28, 2, v28
    v_lshlrev_b32 v28, 7, v28
    v_lshl_add_u32 v28, v29, 2, v28
    v_add_u32 v28, 12599296, v28
    v_add_u32 v241, s74, v240
    v_cmp_eq_u32 vcc, 0, v2
    v_mov_b32 v196, 4136
    s_nop 0
    v_cndmask_b32 v196, v196, 30, vcc
    v_add_u32 v242, s74, v196
    v_bfe_u32 v196, v2, 3, 2
    v_mul_u32_u24 v196, 4160, v196
    v_and_b32 v197, 7, v2
    v_lshl_add_u32 v196, v197, 2, v196
    v_add_u32 v200, s74, v196
    v_mov_b32 v196, 0
    v_mov_b32 v197, 0
    v_mov_b32 v198, 0
    v_mov_b32 v199, 0
    ds_write_b32 v200, v196
    v_lshlrev_b32 v201, 4, v0
    ds_write_b128 v201, v[196:199]
    ds_write_b128 v201, v[196:199] offset:36864
    s_waitcnt vmcnt(1)
    ds_read_b128 v[212:215], v241 offset:32
    ds_read_b32 v216, v241 offset:48
    ds_read_b128 v[218:221], v241 offset:1056
    ds_read_b32 v222, v241 offset:1072
    ds_read_b128 v[224:227], v241 offset:2080
    ds_read_b32 v228, v241 offset:2096
    ds_read_b128 v[230:233], v241 offset:3104
    ds_read_b32 v234, v241 offset:3120
    v_lshrrev_b32 v202, 3, v2
    v_and_b32 v203, 7, v2
    v_lshrrev_b32 v204, 1, v202
    v_xor_b32 v203, v203, v204
    v_mul_u32_u24 v202, 9216, v202
    v_lshl_add_u32 v24, v203, 4, v202
    v_xor_b32 v25, 64, v24
    v_and_b32 v202, 15, v2
    v_add_u32 v202, 1, v202
    v_and_b32 v203, 1, v202
    v_mul_u32_u24 v203, 4160, v203
    v_lshrrev_b32 v202, 1, v202
    v_lshl_add_u32 v203, v202, 2, v203
    v_lshrrev_b32 v204, 4, v2
    v_lshl_add_u32 v203, v204, 4, v203
    v_add_u32 v236, s74, v203
    v_add_u32 v237, 1024, v236
    v_add_u32 v238, 1024, v237
    v_add_u32 v239, 1024, v238
    s_waitcnt lgkmcnt(0)
    s_waitcnt vmcnt(0)
    v_lshlrev_b32 v9, 16, v9
    v_lshlrev_b32 v208, 16, v212
    v_add_f32 v9, v9, v208
    v_cvt_pk_bf16_f32 v9, v9, v9
    ds_write_b16 v242, v9 offset:4160
    ds_write_b16 v242, v9 offset:2
    v_alignbit_b32 v212, v213, v212, 16
    v_alignbit_b32 v213, v214, v213, 16
    v_alignbit_b32 v214, v215, v214, 16
    v_alignbit_b32 v215, v216, v215, 16
    ds_write_b128 v241, v[212:215] offset:4192
    v_alignbit_b32 v218, v219, v218, 16
    v_alignbit_b32 v219, v220, v219, 16
    v_alignbit_b32 v220, v221, v220, 16
    v_alignbit_b32 v221, v222, v221, 16
    ds_write_b128 v241, v[218:221] offset:5216
    v_alignbit_b32 v224, v225, v224, 16
    v_alignbit_b32 v225, v226, v225, 16
    v_alignbit_b32 v226, v227, v226, 16
    v_alignbit_b32 v227, v228, v227, 16
    ds_write_b128 v241, v[224:227] offset:6240
    v_alignbit_b32 v230, v231, v230, 16
    v_alignbit_b32 v231, v232, v231, 16
    v_alignbit_b32 v232, v233, v232, 16
    v_alignbit_b32 v233, v234, v233, 16
    ds_write_b128 v241, v[230:233] offset:7264
    v_and_b32 v202, 15, v2
    v_lshlrev_b32 v202, 1, v202
    v_sub_u32 v202, v202, v204
    v_add_u32 v202, 17, v202
    v_bfe_u32 v203, v202, 1, 3
    v_xor_b32 v203, s3, v203
    v_lshlrev_b32 v203, 4, v203
    v_lshl_add_u32 v244, v202, 7, v203
    v_and_b32 v202, 15, v2
    v_lshlrev_b32 v202, 1, v202
    v_sub_u32 v202, v202, v204
    v_add_u32 v202, 13, v202
    v_bfe_u32 v203, v202, 1, 3
    v_xor_b32 v203, s3, v203
    v_lshlrev_b32 v203, 4, v203
    v_lshl_add_u32 v245, v202, 7, v203
    v_and_b32 v202, 15, v2
    v_lshlrev_b32 v202, 1, v202
    v_sub_u32 v202, v202, v204
    v_add_u32 v202, 9, v202
    v_bfe_u32 v203, v202, 1, 3
    v_xor_b32 v203, s3, v203
    v_lshlrev_b32 v203, 4, v203
    v_lshl_add_u32 v246, v202, 7, v203
    v_and_b32 v202, 15, v2
    v_lshlrev_b32 v202, 1, v202
    v_sub_u32 v202, v202, v204
    v_add_u32 v202, 5, v202
    v_bfe_u32 v203, v202, 1, 3
    v_xor_b32 v203, s3, v203
    v_lshlrev_b32 v203, 4, v203
    v_lshl_add_u32 v247, v202, 7, v203
    v_and_b32 v202, 15, v2
    v_lshlrev_b32 v202, 5, v202
    v_lshl_add_u32 v8, v204, 3, v202
    s_mul_i32 s7, s3, 589824
    s_lshl_b32 s8, s69, 8
L_pl_X_1:
    s_cbranch_execz L_pl_X_5
    s_add_u32 s7, s7, s8
    s_add_u32 s7, s7, 2359296
    s_lshl_b32 s9, s3, 13
    s_add_u32 s9, s9, 4096
    ds_read2_b32 v[64:65], v236 offset0:0 offset1:1
    ds_read2_b32 v[66:67], v236 offset0:2 offset1:3
    ds_read2_b32 v[68:69], v236 offset0:128 offset1:129
    ds_read2_b32 v[70:71], v236 offset0:130 offset1:131
    ds_read2_b32 v[72:73], v237 offset0:0 offset1:1
    ds_read2_b32 v[74:75], v237 offset0:2 offset1:3
    ds_read2_b32 v[76:77], v237 offset0:128 offset1:129
    ds_read2_b32 v[78:79], v237 offset0:130 offset1:131
    ds_read2_b32 v[80:81], v238 offset0:0 offset1:1
    ds_read2_b32 v[82:83], v238 offset0:2 offset1:3
    ds_read2_b32 v[84:85], v238 offset0:128 offset1:129
    ds_read2_b32 v[86:87], v238 offset0:130 offset1:131
    ds_read2_b32 v[88:89], v239 offset0:0 offset1:1
    ds_read2_b32 v[90:91], v239 offset0:2 offset1:3
    ds_read2_b32 v[92:93], v239 offset0:128 offset1:129
    ds_read2_b32 v[94:95], v239 offset0:130 offset1:131
    buffer_load_dword v29, v28, s[44:47], 0 offen sc1
    v_add_u32 v10, 131072, v10
    v_add_u32 v11, 131072, v11
    s_waitcnt vmcnt(0)
    v_cmp_ne_u32 vcc, s68, v29
    s_cbranch_vccnz L_rs_p1X
L_ok_p1X:
    s_barrier
    s_add_u32 m0, s9, 0
    s_add_u32 s13, s7, 0
    buffer_load_dwordx4 v24, s[44:47], s13 offen sc1 lds
    s_add_u32 m0, s9, 1024
    s_add_u32 s13, s7, 73728
    buffer_load_dwordx4 v25, s[44:47], s13 offen sc1 lds
    s_add_u32 m0, s9, 2048
    s_add_u32 s13, s7, 147456
    buffer_load_dwordx4 v24, s[44:47], s13 offen sc1 lds
    s_add_u32 m0, s9, 3072
    s_add_u32 s13, s7, 221184
    buffer_load_dwordx4 v25, s[44:47], s13 offen sc1 lds
    s_add_u32 m0, s9, 4096
    s_add_u32 s13, s7, 294912
    buffer_load_dwordx4 v24, s[44:47], s13 offen sc1 lds
    s_add_u32 m0, s9, 5120
    s_add_u32 s13, s7, 368640
    buffer_load_dwordx4 v25, s[44:47], s13 offen sc1 lds
    s_add_u32 m0, s9, 6144
    s_add_u32 s13, s7, 442368
    buffer_load_dwordx4 v24, s[44:47], s13 offen sc1 lds
    s_add_u32 m0, s9, 7168
    s_add_u32 s13, s7, 516096
    buffer_load_dwordx4 v25, s[44:47], s13 offen sc1 lds
    s_waitcnt vmcnt(0) lgkmcnt(0)
    s_barrier
    ds_read_b128 v[96:99], v244 offset:2048
    ds_read_b128 v[100:103], v244 offset:6144
    ds_read_b128 v[104:107], v244 offset:10240
    ds_read_b128 v[108:111], v244 offset:14336
    ds_read_b128 v[112:115], v244 offset:18432
    ds_read_b128 v[116:119], v244 offset:22528
    ds_read_b128 v[120:123], v244 offset:26624
    ds_read_b128 v[124:127], v244 offset:30720
    s_waitcnt lgkmcnt(0)
    v_mfma_f32_16x16x32_bf16 v[32:35], v[64:67], v[96:99], 0
    s_lshl_b32 s14, s84, 18
    ds_read_b128 v[160:163], v245 offset:2048
    v_mfma_f32_16x16x32_bf16 v[36:39], v[68:71], v[96:99], 0
    s_add_u32 m0, s73, 147456
    v_mfma_f32_16x16x32_bf16 v[36:39], v[64:67], v[100:103], v[36:39]
    buffer_load_dwordx4 v4, s[52:55], s14 offen offset:0 lds
    ds_read2_b32 v[128:129], v236 offset0:16 offset1:17
    v_mfma_f32_16x16x32_bf16 v[40:43], v[64:67], v[104:107], 0
    ds_read2_b32 v[130:131], v236 offset0:18 offset1:19
    v_mfma_f32_16x16x32_bf16 v[40:43], v[68:71], v[100:103], v[40:43]
    v_mfma_f32_16x16x32_bf16 v[40:43], v[72:75], v[96:99], v[40:43]
    ds_read_b128 v[164:167], v245 offset:6144
    v_mfma_f32_16x16x32_bf16 v[44:47], v[76:79], v[96:99], 0
    ds_read2_b32 v[132:133], v236 offset0:144 offset1:145
    v_mfma_f32_16x16x32_bf16 v[44:47], v[72:75], v[100:103], v[44:47]
    s_add_u32 s13, s12, 16384
    v_mfma_f32_16x16x32_bf16 v[44:47], v[68:71], v[104:107], v[44:47]
    ds_read2_b32 v[134:135], v236 offset0:146 offset1:147
    v_mfma_f32_16x16x32_bf16 v[44:47], v[64:67], v[108:111], v[44:47]
    s_add_u32 m0, s74, 8352
    ds_read_b128 v[168:171], v245 offset:10240
    v_mfma_f32_16x16x32_bf16 v[48:51], v[64:67], v[112:115], 0
    buffer_load_dwordx4 v240, s[48:51], s13 offen offset:0 lds
    ds_read2_b32 v[136:137], v237 offset0:16 offset1:17
    v_mfma_f32_16x16x32_bf16 v[48:51], v[68:71], v[108:111], v[48:51]
    v_mfma_f32_16x16x32_bf16 v[48:51], v[72:75], v[104:107], v[48:51]
    s_add_u32 m0, s73, 147456
    ds_read2_b32 v[138:139], v237 offset0:18 offset1:19
    v_mfma_f32_16x16x32_bf16 v[48:51], v[76:79], v[100:103], v[48:51]
    buffer_load_dwordx4 v5, s[52:55], s14 offen offset:1024 lds
    ds_read_b128 v[172:175], v245 offset:14336
    v_mfma_f32_16x16x32_bf16 v[48:51], v[80:83], v[96:99], v[48:51]
    v_mfma_f32_16x16x32_bf16 v[52:55], v[84:87], v[96:99], 0
    ds_read2_b32 v[140:141], v237 offset0:144 offset1:145
    v_mfma_f32_16x16x32_bf16 v[52:55], v[80:83], v[100:103], v[52:55]
    s_add_u32 m0, s74, 8352
    ds_read2_b32 v[142:143], v237 offset0:146 offset1:147
    v_mfma_f32_16x16x32_bf16 v[52:55], v[76:79], v[104:107], v[52:55]
    buffer_load_dwordx4 v240, s[48:51], s13 offen offset:1024 lds
    v_mfma_f32_16x16x32_bf16 v[52:55], v[72:75], v[108:111], v[52:55]
    ds_read_b128 v[176:179], v245 offset:18432
    v_mfma_f32_16x16x32_bf16 v[52:55], v[68:71], v[112:115], v[52:55]
    ds_read2_b32 v[144:145], v238 offset0:16 offset1:17
    v_mfma_f32_16x16x32_bf16 v[52:55], v[64:67], v[116:119], v[52:55]
    v_mfma_f32_16x16x32_bf16 v[56:59], v[64:67], v[120:123], 0
    ds_read2_b32 v[146:147], v238 offset0:18 offset1:19
    v_mfma_f32_16x16x32_bf16 v[56:59], v[68:71], v[116:119], v[56:59]
    ds_read_b128 v[180:183], v245 offset:22528
    v_mfma_f32_16x16x32_bf16 v[56:59], v[72:75], v[112:115], v[56:59]
    v_mfma_f32_16x16x32_bf16 v[56:59], v[76:79], v[108:111], v[56:59]
    s_add_u32 m0, s73, 147456
    ds_read2_b32 v[148:149], v238 offset0:144 offset1:145
    v_mfma_f32_16x16x32_bf16 v[56:59], v[80:83], v[104:107], v[56:59]
    buffer_load_dwordx4 v6, s[52:55], s14 offen offset:2048 lds
    ds_read2_b32 v[150:151], v238 offset0:146 offset1:147
    v_mfma_f32_16x16x32_bf16 v[56:59], v[84:87], v[100:103], v[56:59]
    s_add_u32 m0, s74, 8352
    ds_read_b128 v[184:187], v245 offset:26624
    v_mfma_f32_16x16x32_bf16 v[56:59], v[88:91], v[96:99], v[56:59]
    buffer_load_dwordx4 v240, s[48:51], s13 offen offset:2048 lds
    v_mfma_f32_16x16x32_bf16 v[60:63], v[92:95], v[96:99], 0
    ds_read2_b32 v[152:153], v239 offset0:16 offset1:17
    v_mfma_f32_16x16x32_bf16 v[60:63], v[88:91], v[100:103], v[60:63]
    ds_read2_b32 v[154:155], v239 offset0:18 offset1:19
    v_mfma_f32_16x16x32_bf16 v[60:63], v[84:87], v[104:107], v[60:63]
    v_mfma_f32_16x16x32_bf16 v[60:63], v[80:83], v[108:111], v[60:63]
    ds_read_b128 v[188:191], v245 offset:30720
    v_mfma_f32_16x16x32_bf16 v[60:63], v[76:79], v[112:115], v[60:63]
    s_add_u32 m0, s74, 8352
    ds_read2_b32 v[156:157], v239 offset0:144 offset1:145
    v_mfma_f32_16x16x32_bf16 v[60:63], v[72:75], v[116:119], v[60:63]
    buffer_load_dwordx4 v240, s[48:51], s13 offen offset:3072 lds
    v_mfma_f32_16x16x32_bf16 v[60:63], v[68:71], v[120:123], v[60:63]
    ds_read2_b32 v[158:159], v239 offset0:146 offset1:147
    v_mfma_f32_16x16x32_bf16 v[60:63], v[64:67], v[124:127], v[60:63]
    s_waitcnt lgkmcnt(12)
    v_mfma_f32_16x16x32_bf16 v[32:35], v[128:131], v[160:163], v[32:35]
    s_add_u32 m0, s73, 147456
    ds_read_b128 v[96:99], v246 offset:2048
    v_mfma_f32_16x16x32_bf16 v[36:39], v[132:135], v[160:163], v[36:39]
    buffer_load_dwordx4 v7, s[52:55], s14 offen offset:3072 lds
    v_mfma_f32_16x16x32_bf16 v[36:39], v[128:131], v[164:167], v[36:39]
    ds_read2_b32 v[64:65], v236 offset0:32 offset1:33
    v_mfma_f32_16x16x32_bf16 v[40:43], v[128:131], v[168:171], v[40:43]
    ds_read2_b32 v[66:67], v236 offset0:34 offset1:35
    v_mfma_f32_16x16x32_bf16 v[40:43], v[132:135], v[164:167], v[40:43]
    v_mfma_f32_16x16x32_bf16 v[40:43], v[136:139], v[160:163], v[40:43]
    ds_read_b128 v[100:103], v246 offset:6144
    v_mfma_f32_16x16x32_bf16 v[44:47], v[140:143], v[160:163], v[44:47]
    ds_read2_b32 v[68:69], v236 offset0:160 offset1:161
    v_mfma_f32_16x16x32_bf16 v[44:47], v[136:139], v[164:167], v[44:47]
    v_mfma_f32_16x16x32_bf16 v[44:47], v[132:135], v[168:171], v[44:47]
    ds_read2_b32 v[70:71], v236 offset0:162 offset1:163
    v_mfma_f32_16x16x32_bf16 v[44:47], v[128:131], v[172:175], v[44:47]
    ds_read_b128 v[104:107], v246 offset:10240
    s_waitcnt lgkmcnt(7)
    v_mfma_f32_16x16x32_bf16 v[48:51], v[128:131], v[176:179], v[48:51]
    ds_read2_b32 v[72:73], v237 offset0:32 offset1:33
    v_mfma_f32_16x16x32_bf16 v[48:51], v[132:135], v[172:175], v[48:51]
    ds_read2_b32 v[74:75], v237 offset0:34 offset1:35
    v_mfma_f32_16x16x32_bf16 v[48:51], v[136:139], v[168:171], v[48:51]
    v_mov_b32 v9, 8
    buffer_load_ushort v9, v9, s[56:59], s70 offen
    v_mfma_f32_16x16x32_bf16 v[48:51], v[140:143], v[164:167], v[48:51]
    ds_read_b128 v[108:111], v246 offset:14336
    v_mfma_f32_16x16x32_bf16 v[48:51], v[144:147], v[160:163], v[48:51]
    v_mfma_f32_16x16x32_bf16 v[52:55], v[148:151], v[160:163], v[52:55]
    ds_read2_b32 v[76:77], v237 offset0:160 offset1:161
    v_mfma_f32_16x16x32_bf16 v[52:55], v[144:147], v[164:167], v[52:55]
    ds_read2_b32 v[78:79], v237 offset0:162 offset1:163
    v_mfma_f32_16x16x32_bf16 v[52:55], v[140:143], v[168:171], v[52:55]
    v_mfma_f32_16x16x32_bf16 v[52:55], v[136:139], v[172:175], v[52:55]
    ds_read_b128 v[112:115], v246 offset:18432
    v_mfma_f32_16x16x32_bf16 v[52:55], v[132:135], v[176:179], v[52:55]
    ds_read2_b32 v[80:81], v238 offset0:32 offset1:33
    v_mfma_f32_16x16x32_bf16 v[52:55], v[128:131], v[180:183], v[52:55]
    v_mfma_f32_16x16x32_bf16 v[56:59], v[128:131], v[184:187], v[56:59]
    ds_read2_b32 v[82:83], v238 offset0:34 offset1:35
    v_mfma_f32_16x16x32_bf16 v[56:59], v[132:135], v[180:183], v[56:59]
    ds_read_b128 v[116:119], v246 offset:22528
    v_mfma_f32_16x16x32_bf16 v[56:59], v[136:139], v[176:179], v[56:59]
    v_mfma_f32_16x16x32_bf16 v[56:59], v[140:143], v[172:175], v[56:59]
    ds_read2_b32 v[84:85], v238 offset0:160 offset1:161
    v_mfma_f32_16x16x32_bf16 v[56:59], v[144:147], v[168:171], v[56:59]
    ds_read2_b32 v[86:87], v238 offset0:162 offset1:163
    v_mfma_f32_16x16x32_bf16 v[56:59], v[148:151], v[164:167], v[56:59]
    ds_read_b128 v[120:123], v246 offset:26624
    v_mfma_f32_16x16x32_bf16 v[56:59], v[152:155], v[160:163], v[56:59]
    v_mfma_f32_16x16x32_bf16 v[60:63], v[156:159], v[160:163], v[60:63]
    ds_read2_b32 v[88:89], v239 offset0:32 offset1:33
    v_mfma_f32_16x16x32_bf16 v[60:63], v[152:155], v[164:167], v[60:63]
    ds_read2_b32 v[90:91], v239 offset0:34 offset1:35
    v_mfma_f32_16x16x32_bf16 v[60:63], v[148:151], v[168:171], v[60:63]
    v_mfma_f32_16x16x32_bf16 v[60:63], v[144:147], v[172:175], v[60:63]
    ds_read_b128 v[124:127], v246 offset:30720
    v_mfma_f32_16x16x32_bf16 v[60:63], v[140:143], v[176:179], v[60:63]
    ds_read2_b32 v[92:93], v239 offset0:160 offset1:161
    v_mfma_f32_16x16x32_bf16 v[60:63], v[136:139], v[180:183], v[60:63]
    v_mfma_f32_16x16x32_bf16 v[60:63], v[132:135], v[184:187], v[60:63]
    ds_read2_b32 v[94:95], v239 offset0:162 offset1:163
    v_mfma_f32_16x16x32_bf16 v[60:63], v[128:131], v[188:191], v[60:63]
    s_waitcnt lgkmcnt(12)
    v_mfma_f32_16x16x32_bf16 v[32:35], v[64:67], v[96:99], v[32:35]
    s_lshl_b32 s14, s85, 18
    ds_read_b128 v[160:163], v247 offset:2048
    v_mfma_f32_16x16x32_bf16 v[36:39], v[68:71], v[96:99], v[36:39]
    s_add_u32 m0, s73, 49152
    v_mfma_f32_16x16x32_bf16 v[36:39], v[64:67], v[100:103], v[36:39]
    buffer_load_dwordx4 v4, s[52:55], s14 offen offset:0 lds
    ds_read2_b32 v[128:129], v236 offset0:48 offset1:49
    v_mfma_f32_16x16x32_bf16 v[40:43], v[64:67], v[104:107], v[40:43]
    ds_read2_b32 v[130:131], v236 offset0:50 offset1:51
    v_mfma_f32_16x16x32_bf16 v[40:43], v[68:71], v[100:103], v[40:43]
    v_mfma_f32_16x16x32_bf16 v[40:43], v[72:75], v[96:99], v[40:43]
    ds_read_b128 v[164:167], v247 offset:6144
    v_mfma_f32_16x16x32_bf16 v[44:47], v[76:79], v[96:99], v[44:47]
    ds_read2_b32 v[132:133], v236 offset0:176 offset1:177
    v_mfma_f32_16x16x32_bf16 v[44:47], v[72:75], v[100:103], v[44:47]
    v_mfma_f32_16x16x32_bf16 v[44:47], v[68:71], v[104:107], v[44:47]
    ds_read2_b32 v[134:135], v236 offset0:178 offset1:179
    v_mfma_f32_16x16x32_bf16 v[44:47], v[64:67], v[108:111], v[44:47]
    ds_read_b128 v[168:171], v247 offset:10240
    s_waitcnt lgkmcnt(7)
    v_mfma_f32_16x16x32_bf16 v[48:51], v[64:67], v[112:115], v[48:51]
    ds_read2_b32 v[136:137], v237 offset0:48 offset1:49
    v_mfma_f32_16x16x32_bf16 v[48:51], v[68:71], v[108:111], v[48:51]
    v_mfma_f32_16x16x32_bf16 v[48:51], v[72:75], v[104:107], v[48:51]
    s_add_u32 m0, s73, 49152
    ds_read2_b32 v[138:139], v237 offset0:50 offset1:51
    v_mfma_f32_16x16x32_bf16 v[48:51], v[76:79], v[100:103], v[48:51]
    buffer_load_dwordx4 v5, s[52:55], s14 offen offset:1024 lds
    ds_read_b128 v[172:175], v247 offset:14336
    v_mfma_f32_16x16x32_bf16 v[48:51], v[80:83], v[96:99], v[48:51]
    v_mfma_f32_16x16x32_bf16 v[52:55], v[84:87], v[96:99], v[52:55]
    ds_read2_b32 v[140:141], v237 offset0:176 offset1:177
    v_mfma_f32_16x16x32_bf16 v[52:55], v[80:83], v[100:103], v[52:55]
    ds_read2_b32 v[142:143], v237 offset0:178 offset1:179
    v_mfma_f32_16x16x32_bf16 v[52:55], v[76:79], v[104:107], v[52:55]
    v_mfma_f32_16x16x32_bf16 v[52:55], v[72:75], v[108:111], v[52:55]
    ds_read_b128 v[176:179], v247 offset:18432
    v_mfma_f32_16x16x32_bf16 v[52:55], v[68:71], v[112:115], v[52:55]
    ds_read2_b32 v[144:145], v238 offset0:48 offset1:49
    v_mfma_f32_16x16x32_bf16 v[52:55], v[64:67], v[116:119], v[52:55]
    v_mfma_f32_16x16x32_bf16 v[56:59], v[64:67], v[120:123], v[56:59]
    ds_read2_b32 v[146:147], v238 offset0:50 offset1:51
    v_mfma_f32_16x16x32_bf16 v[56:59], v[68:71], v[116:119], v[56:59]
    ds_read_b128 v[180:183], v247 offset:22528
    v_mfma_f32_16x16x32_bf16 v[56:59], v[72:75], v[112:115], v[56:59]
    v_mfma_f32_16x16x32_bf16 v[56:59], v[76:79], v[108:111], v[56:59]
    s_add_u32 m0, s73, 49152
    ds_read2_b32 v[148:149], v238 offset0:176 offset1:177
    v_mfma_f32_16x16x32_bf16 v[56:59], v[80:83], v[104:107], v[56:59]
    buffer_load_dwordx4 v6, s[52:55], s14 offen offset:2048 lds
    ds_read2_b32 v[150:151], v238 offset0:178 offset1:179
    v_mfma_f32_16x16x32_bf16 v[56:59], v[84:87], v[100:103], v[56:59]
    ds_read_b128 v[184:187], v247 offset:26624
    v_mfma_f32_16x16x32_bf16 v[56:59], v[88:91], v[96:99], v[56:59]
    v_mfma_f32_16x16x32_bf16 v[60:63], v[92:95], v[96:99], v[60:63]
    ds_read2_b32 v[152:153], v239 offset0:48 offset1:49
    v_mfma_f32_16x16x32_bf16 v[60:63], v[88:91], v[100:103], v[60:63]
    ds_read2_b32 v[154:155], v239 offset0:50 offset1:51
    v_mfma_f32_16x16x32_bf16 v[60:63], v[84:87], v[104:107], v[60:63]
    v_mfma_f32_16x16x32_bf16 v[60:63], v[80:83], v[108:111], v[60:63]
    ds_read_b128 v[188:191], v247 offset:30720
    v_mfma_f32_16x16x32_bf16 v[60:63], v[76:79], v[112:115], v[60:63]
    ds_read2_b32 v[156:157], v239 offset0:176 offset1:177
    v_mfma_f32_16x16x32_bf16 v[60:63], v[72:75], v[116:119], v[60:63]
    v_mfma_f32_16x16x32_bf16 v[60:63], v[68:71], v[120:123], v[60:63]
    ds_read2_b32 v[158:159], v239 offset0:178 offset1:179
    v_mfma_f32_16x16x32_bf16 v[60:63], v[64:67], v[124:127], v[60:63]
    s_waitcnt lgkmcnt(12)
    v_mfma_f32_16x16x32_bf16 v[32:35], v[128:131], v[160:163], v[32:35]
    s_add_u32 m0, s73, 49152
    ds_read_b128 v[96:99], v244 offset:0
    v_mfma_f32_16x16x32_bf16 v[36:39], v[132:135], v[160:163], v[36:39]
    buffer_load_dwordx4 v7, s[52:55], s14 offen offset:3072 lds
    v_mfma_f32_16x16x32_bf16 v[36:39], v[128:131], v[164:167], v[36:39]
    ds_read2_b32 v[64:65], v236 offset0:64 offset1:65
    v_mfma_f32_16x16x32_bf16 v[40:43], v[128:131], v[168:171], v[40:43]
    ds_read2_b32 v[66:67], v236 offset0:66 offset1:67
    v_mfma_f32_16x16x32_bf16 v[40:43], v[132:135], v[164:167], v[40:43]
    v_mfma_f32_16x16x32_bf16 v[40:43], v[136:139], v[160:163], v[40:43]
    ds_read_b128 v[100:103], v244 offset:4096
    v_mfma_f32_16x16x32_bf16 v[44:47], v[140:143], v[160:163], v[44:47]
    ds_read2_b32 v[68:69], v236 offset0:192 offset1:193
    v_mfma_f32_16x16x32_bf16 v[44:47], v[136:139], v[164:167], v[44:47]
    v_mfma_f32_16x16x32_bf16 v[44:47], v[132:135], v[168:171], v[44:47]
    ds_read2_b32 v[70:71], v236 offset0:194 offset1:195
    v_mfma_f32_16x16x32_bf16 v[44:47], v[128:131], v[172:175], v[44:47]
    ds_read_b128 v[104:107], v244 offset:8192
    s_waitcnt lgkmcnt(7)
    v_mfma_f32_16x16x32_bf16 v[48:51], v[128:131], v[176:179], v[48:51]
    ds_read2_b32 v[72:73], v237 offset0:64 offset1:65
    v_mfma_f32_16x16x32_bf16 v[48:51], v[132:135], v[172:175], v[48:51]
    ds_read2_b32 v[74:75], v237 offset0:66 offset1:67
    v_mfma_f32_16x16x32_bf16 v[48:51], v[136:139], v[168:171], v[48:51]
    ds_read_b128 v[108:111], v244 offset:12288
    v_mfma_f32_16x16x32_bf16 v[48:51], v[140:143], v[164:167], v[48:51]
    ds_read2_b32 v[76:77], v237 offset0:192 offset1:193
    v_mfma_f32_16x16x32_bf16 v[48:51], v[144:147], v[160:163], v[48:51]
    ds_read2_b32 v[78:79], v237 offset0:194 offset1:195
    v_mfma_f32_16x16x32_bf16 v[52:55], v[148:151], v[160:163], v[52:55]
    ds_read_b128 v[112:115], v244 offset:16384
    v_mfma_f32_16x16x32_bf16 v[52:55], v[144:147], v[164:167], v[52:55]
    ds_read2_b32 v[80:81], v238 offset0:64 offset1:65
    v_mfma_f32_16x16x32_bf16 v[52:55], v[140:143], v[168:171], v[52:55]
    ds_read2_b32 v[82:83], v238 offset0:66 offset1:67
    v_mfma_f32_16x16x32_bf16 v[52:55], v[136:139], v[172:175], v[52:55]
    ds_read_b128 v[116:119], v244 offset:20480
    v_mfma_f32_16x16x32_bf16 v[52:55], v[132:135], v[176:179], v[52:55]
    ds_read2_b32 v[84:85], v238 offset0:192 offset1:193
    v_mfma_f32_16x16x32_bf16 v[52:55], v[128:131], v[180:183], v[52:55]
    ds_read2_b32 v[86:87], v238 offset0:194 offset1:195
    v_mfma_f32_16x16x32_bf16 v[56:59], v[128:131], v[184:187], v[56:59]
    ds_read_b128 v[120:123], v244 offset:24576
    s_waitcnt vmcnt(5)
    s_barrier
    v_mfma_f32_16x16x32_bf16 v[56:59], v[132:135], v[180:183], v[56:59]
    ds_read2_b32 v[88:89], v239 offset0:64 offset1:65
    v_mfma_f32_16x16x32_bf16 v[56:59], v[136:139], v[176:179], v[56:59]
    ds_read_b64_tr_b16 a[0:1], v10 offset:16384
    v_mfma_f32_16x16x32_bf16 v[56:59], v[140:143], v[172:175], v[56:59]
    ds_read_b64_tr_b16 a[2:3], v10 offset:18432
    v_mfma_f32_16x16x32_bf16 v[56:59], v[144:147], v[168:171], v[56:59]
    ds_read_b64_tr_b16 a[8:9], v10 offset:20480
    v_mfma_f32_16x16x32_bf16 v[56:59], v[148:151], v[164:167], v[56:59]
    ds_read2_b32 v[90:91], v239 offset0:66 offset1:67
    v_mfma_f32_16x16x32_bf16 v[56:59], v[152:155], v[160:163], v[56:59]
    ds_read_b64_tr_b16 a[10:11], v10 offset:22528
    v_mfma_f32_16x16x32_bf16 v[60:63], v[156:159], v[160:163], v[60:63]
    ds_read_b64_tr_b16 a[4:5], v11 offset:16384
    v_mfma_f32_16x16x32_bf16 v[60:63], v[152:155], v[164:167], v[60:63]
    ds_read_b128 v[124:127], v244 offset:28672
    v_mfma_f32_16x16x32_bf16 v[60:63], v[148:151], v[168:171], v[60:63]
    ds_read_b64_tr_b16 a[6:7], v11 offset:18432
    v_mfma_f32_16x16x32_bf16 v[60:63], v[144:147], v[172:175], v[60:63]
    ds_read_b64_tr_b16 a[12:13], v11 offset:20480
    v_mfma_f32_16x16x32_bf16 v[60:63], v[140:143], v[176:179], v[60:63]
    ds_read2_b32 v[92:93], v239 offset0:192 offset1:193
    v_mfma_f32_16x16x32_bf16 v[60:63], v[136:139], v[180:183], v[60:63]
    ds_read_b64_tr_b16 a[14:15], v11 offset:22528
    v_mfma_f32_16x16x32_bf16 v[60:63], v[132:135], v[184:187], v[60:63]
    ds_read2_b32 v[94:95], v239 offset0:194 offset1:195
    v_mfma_f32_16x16x32_bf16 v[60:63], v[128:131], v[188:191], v[60:63]
    s_waitcnt lgkmcnt(15)
    v_mfma_f32_16x16x32_bf16 v[32:35], v[64:67], v[96:99], v[32:35]
    ds_read_b128 v[160:163], v245 offset:0
    s_waitcnt lgkmcnt(2)
    s_barrier
    v_mfma_f32_16x16x32_bf16 v[36:39], v[68:71], v[96:99], v[36:39]
    v_mfma_f32_16x16x32_bf16 v[36:39], v[64:67], v[100:103], v[36:39]
    ds_read2_b32 v[128:129], v236 offset0:80 offset1:81
    v_mfma_f32_16x16x32_bf16 v[40:43], v[64:67], v[104:107], v[40:43]
    s_lshl_b32 s14, s86, 18
    ds_read2_b32 v[130:131], v236 offset0:82 offset1:83
    v_mfma_f32_16x16x32_bf16 v[40:43], v[68:71], v[100:103], v[40:43]
    s_add_u32 m0, s73, 147456
    v_mfma_f32_16x16x32_bf16 v[40:43], v[72:75], v[96:99], v[40:43]
    buffer_load_dwordx4 v4, s[52:55], s14 offen offset:0 lds
    ds_read_b128 v[164:167], v245 offset:4096
    v_mfma_f32_16x16x32_bf16 v[44:47], v[76:79], v[96:99], v[44:47]
    ds_read2_b32 v[132:133], v236 offset0:208 offset1:209
    v_mfma_f32_16x16x32_bf16 v[44:47], v[72:75], v[100:103], v[44:47]
    v_mfma_f32_16x16x32_bf16 v[44:47], v[68:71], v[104:107], v[44:47]
    ds_read2_b32 v[134:135], v236 offset0:210 offset1:211
    v_mfma_f32_16x16x32_bf16 v[44:47], v[64:67], v[108:111], v[44:47]
    ds_read_b128 v[168:171], v245 offset:8192
    s_waitcnt lgkmcnt(7)
    v_mfma_f32_16x16x32_bf16 v[48:51], v[64:67], v[112:115], v[48:51]
    ds_read2_b32 v[136:137], v237 offset0:80 offset1:81
    v_mfma_f32_16x16x32_bf16 v[48:51], v[68:71], v[108:111], v[48:51]
    ds_read2_b32 v[138:139], v237 offset0:82 offset1:83
    v_mfma_f32_16x16x32_bf16 v[48:51], v[72:75], v[104:107], v[48:51]
    ds_read_b128 v[172:175], v245 offset:12288
    v_mfma_f32_16x16x32_bf16 v[48:51], v[76:79], v[100:103], v[48:51]
    ds_read2_b32 v[140:141], v237 offset0:208 offset1:209
    v_mfma_f32_16x16x32_bf16 v[48:51], v[80:83], v[96:99], v[48:51]
    ds_read2_b32 v[142:143], v237 offset0:210 offset1:211
    v_mfma_f32_16x16x32_bf16 v[52:55], v[84:87], v[96:99], v[52:55]
    ds_read_b128 v[176:179], v245 offset:16384
    v_mfma_f32_16x16x32_bf16 v[52:55], v[80:83], v[100:103], v[52:55]
    s_add_u32 m0, s73, 147456
    ds_read2_b32 v[144:145], v238 offset0:80 offset1:81
    v_mfma_f32_16x16x32_bf16 v[52:55], v[76:79], v[104:107], v[52:55]
    buffer_load_dwordx4 v5, s[52:55], s14 offen offset:1024 lds
    ds_read2_b32 v[146:147], v238 offset0:82 offset1:83
    v_mfma_f32_16x16x32_bf16 v[52:55], v[72:75], v[108:111], v[52:55]
    ds_read_b128 v[180:183], v245 offset:20480
    v_mfma_f32_16x16x32_bf16 v[52:55], v[68:71], v[112:115], v[52:55]
    ds_read_b128 v[212:215], v241 offset:8352
    v_mfma_f32_16x16x32_bf16 v[52:55], v[64:67], v[116:119], v[52:55]
    ds_read2_b32 v[148:149], v238 offset0:208 offset1:209
    v_mfma_f32_16x16x32_bf16 v[56:59], v[64:67], v[120:123], v[56:59]
    ds_read_b32 v216, v241 offset:8368
    v_mfma_f32_16x16x32_bf16 v[56:59], v[68:71], v[116:119], v[56:59]
    ds_read2_b32 v[150:151], v238 offset0:210 offset1:211
    v_mfma_f32_16x16x32_bf16 v[56:59], v[72:75], v[112:115], v[56:59]
    ds_read_b128 v[218:221], v241 offset:9376
    v_mfma_f32_16x16x32_bf16 v[56:59], v[76:79], v[108:111], v[56:59]
    ds_read_b128 v[184:187], v245 offset:24576
    v_mfma_f32_16x16x32_bf16 v[56:59], v[80:83], v[104:107], v[56:59]
    ds_read2_b32 v[152:153], v239 offset0:80 offset1:81
    v_mfma_f32_16x16x32_bf16 v[56:59], v[84:87], v[100:103], v[56:59]
    ds_read_b32 v222, v241 offset:9392
    v_mfma_f32_16x16x32_bf16 v[56:59], v[88:91], v[96:99], v[56:59]
    ds_read2_b32 v[154:155], v239 offset0:82 offset1:83
    v_mfma_f32_16x16x32_bf16 v[60:63], v[92:95], v[96:99], v[60:63]
    s_add_u32 m0, s73, 147456
    ds_read_b128 v[224:227], v241 offset:10400
    v_mfma_f32_16x16x32_bf16 v[60:63], v[88:91], v[100:103], v[60:63]
    buffer_load_dwordx4 v6, s[52:55], s14 offen offset:2048 lds
    ds_read_b128 v[188:191], v245 offset:28672
    v_mfma_f32_16x16x32_bf16 v[60:63], v[84:87], v[104:107], v[60:63]
    ds_read_b32 v228, v241 offset:10416
    v_mfma_f32_16x16x32_bf16 v[60:63], v[80:83], v[108:111], v[60:63]
    ds_read2_b32 v[156:157], v239 offset0:208 offset1:209
    v_mfma_f32_16x16x32_bf16 v[60:63], v[76:79], v[112:115], v[60:63]
    ds_read_b128 v[230:233], v241 offset:11424
    v_mfma_f32_16x16x32_bf16 v[60:63], v[72:75], v[116:119], v[60:63]
    ds_read2_b32 v[158:159], v239 offset0:210 offset1:211
    v_mfma_f32_16x16x32_bf16 v[60:63], v[68:71], v[120:123], v[60:63]
    ds_read_b32 v234, v241 offset:11440
    v_mfma_f32_16x16x32_bf16 v[60:63], v[64:67], v[124:127], v[60:63]
    s_waitcnt lgkmcnt(15)
    v_mfma_f32_16x16x32_bf16 v[32:35], v[128:131], v[160:163], v[32:35]
    ds_read_b128 v[96:99], v246 offset:0
    v_mfma_f32_16x16x32_bf16 v[36:39], v[132:135], v[160:163], v[36:39]
    ds_read2_b32 v[64:65], v236 offset0:96 offset1:97
    v_mfma_f32_16x16x32_bf16 v[36:39], v[128:131], v[164:167], v[36:39]
    ds_read2_b32 v[66:67], v236 offset0:98 offset1:99
    v_mfma_f32_16x16x32_bf16 v[40:43], v[128:131], v[168:171], v[40:43]
    s_add_u32 m0, s73, 147456
    ds_read_b128 v[100:103], v246 offset:4096
    v_mfma_f32_16x16x32_bf16 v[40:43], v[132:135], v[164:167], v[40:43]
    buffer_load_dwordx4 v7, s[52:55], s14 offen offset:3072 lds
    ds_read2_b32 v[68:69], v236 offset0:224 offset1:225
    s_waitcnt lgkmcnt(5)
    v_mfma_f32_16x16x32_bf16 v[40:43], v[136:139], v[160:163], v[40:43]
    ds_read2_b32 v[70:71], v236 offset0:226 offset1:227
    v_mfma_f32_16x16x32_bf16 v[44:47], v[140:143], v[160:163], v[44:47]
    s_waitcnt vmcnt(8)
    ds_read_b128 v[104:107], v246 offset:8192
    v_mfma_f32_16x16x32_bf16 v[44:47], v[136:139], v[164:167], v[44:47]
    ds_read2_b32 v[72:73], v237 offset0:96 offset1:97
    v_mfma_f32_16x16x32_bf16 v[44:47], v[132:135], v[168:171], v[44:47]
    ds_read2_b32 v[74:75], v237 offset0:98 offset1:99
    v_lshlrev_b32 v9, 16, v9
    v_mfma_f32_16x16x32_bf16 v[44:47], v[128:131], v[172:175], v[44:47]
    ds_read_b128 v[108:111], v246 offset:12288
    v_mfma_f32_16x16x32_bf16 v[48:51], v[128:131], v[176:179], v[48:51]
    ds_read2_b32 v[76:77], v237 offset0:224 offset1:225
    v_lshlrev_b32 v208, 16, v212
    v_mfma_f32_16x16x32_bf16 v[48:51], v[132:135], v[172:175], v[48:51]
    ds_read2_b32 v[78:79], v237 offset0:226 offset1:227
    v_mfma_f32_16x16x32_bf16 v[48:51], v[136:139], v[168:171], v[48:51]
    ds_read_b128 v[112:115], v246 offset:16384
    v_add_f32 v9, v9, v208
    v_mfma_f32_16x16x32_bf16 v[48:51], v[140:143], v[164:167], v[48:51]
    ds_read2_b32 v[80:81], v238 offset0:96 offset1:97
    v_cvt_pk_bf16_f32 v9, v9, v9
    v_mfma_f32_16x16x32_bf16 v[48:51], v[144:147], v[160:163], v[48:51]
    ds_read2_b32 v[82:83], v238 offset0:98 offset1:99
    v_mfma_f32_16x16x32_bf16 v[52:55], v[148:151], v[160:163], v[52:55]
    ds_write_b16 v242, v9 offset:12480
    v_mfma_f32_16x16x32_bf16 v[52:55], v[144:147], v[164:167], v[52:55]
    ds_read_b128 v[116:119], v246 offset:20480
    v_mfma_f32_16x16x32_bf16 v[52:55], v[140:143], v[168:171], v[52:55]
    ds_write_b16 v242, v9 offset:8322
    v_mfma_f32_16x16x32_bf16 v[52:55], v[136:139], v[172:175], v[52:55]
    ds_read2_b32 v[84:85], v238 offset0:224 offset1:225
    v_mfma_f32_16x16x32_bf16 v[52:55], v[132:135], v[176:179], v[52:55]
    ds_read2_b32 v[86:87], v238 offset0:226 offset1:227
    v_alignbit_b32 v212, v213, v212, 16
    v_mfma_f32_16x16x32_bf16 v[52:55], v[128:131], v[180:183], v[52:55]
    ds_read_b128 v[120:123], v246 offset:24576
    v_alignbit_b32 v213, v214, v213, 16
    v_mfma_f32_16x16x32_bf16 v[56:59], v[128:131], v[184:187], v[56:59]
    ds_read2_b32 v[88:89], v239 offset0:96 offset1:97
    s_waitcnt vmcnt(4)
    s_barrier
    v_mfma_f32_16x16x32_bf16 v[56:59], v[132:135], v[180:183], v[56:59]
    v_add_u32 v10, -131072, v10
    v_alignbit_b32 v214, v215, v214, 16
    v_mfma_f32_16x16x32_bf16 v[56:59], v[136:139], v[176:179], v[56:59]
    ds_read_b64_tr_b16 a[16:17], v10 offset:49152
    v_alignbit_b32 v215, v216, v215, 16
    v_mfma_f32_16x16x32_bf16 v[56:59], v[140:143], v[172:175], v[56:59]
    ds_write_b128 v241, v[212:215] offset:12512
    v_mfma_f32_16x16x32_bf16 v[56:59], v[144:147], v[168:171], v[56:59]
    ds_read_b64_tr_b16 a[18:19], v10 offset:51200
    v_mfma_f32_16x16x32_bf16 v[56:59], v[148:151], v[164:167], v[56:59]
    ds_read_b64_tr_b16 a[24:25], v10 offset:53248
    v_mfma_f32_16x16x32_bf16 v[56:59], v[152:155], v[160:163], v[56:59]
    ds_read_b64_tr_b16 a[26:27], v10 offset:55296
    v_mfma_f32_16x16x32_bf16 v[60:63], v[156:159], v[160:163], v[60:63]
    ds_read2_b32 v[90:91], v239 offset0:98 offset1:99
    v_add_u32 v11, -131072, v11
    v_alignbit_b32 v218, v219, v218, 16
    v_mfma_f32_16x16x32_bf16 v[60:63], v[152:155], v[164:167], v[60:63]
    ds_read_b64_tr_b16 a[20:21], v11 offset:49152
    v_alignbit_b32 v219, v220, v219, 16
    v_mfma_f32_16x16x32_bf16 v[60:63], v[148:151], v[168:171], v[60:63]
    ds_read_b128 v[124:127], v246 offset:28672
    ds_read2_b32 v[92:93], v239 offset0:224 offset1:225
    v_mfma_f32_16x16x32_bf16 v[60:63], v[144:147], v[172:175], v[60:63]
    ds_read_b64_tr_b16 a[22:23], v11 offset:51200
    v_alignbit_b32 v220, v221, v220, 16
    v_mfma_f32_16x16x32_bf16 v[60:63], v[140:143], v[176:179], v[60:63]
    ds_read_b64_tr_b16 a[28:29], v11 offset:53248
    ds_read2_b32 v[94:95], v239 offset0:226 offset1:227
    v_mfma_f32_16x16x32_bf16 v[60:63], v[136:139], v[180:183], v[60:63]
    ds_read_b64_tr_b16 a[30:31], v11 offset:55296
    v_alignbit_b32 v221, v222, v221, 16
    v_mfma_f32_16x16x32_bf16 v[60:63], v[132:135], v[184:187], v[60:63]
    ds_write_b128 v241, v[218:221] offset:13536
    v_mfma_f32_16x16x32_bf16 v[60:63], v[128:131], v[188:191], v[60:63]
    s_waitcnt lgkmcnt(15)
    v_mfma_f32_16x16x32_bf16 v[32:35], v[64:67], v[96:99], v[32:35]
    ds_read_b128 v[160:163], v247 offset:0
    s_waitcnt lgkmcnt(2)
    s_barrier
    v_mfma_f32_16x16x32_bf16 v[36:39], v[68:71], v[96:99], v[36:39]
    v_alignbit_b32 v224, v225, v224, 16
    v_mfma_f32_16x16x32_bf16 v[36:39], v[64:67], v[100:103], v[36:39]
    ds_read_b128 v[164:167], v247 offset:4096
    v_mfma_f32_16x16x32_bf16 v[40:43], v[64:67], v[104:107], v[40:43]
    s_lshl_b32 s14, s87, 18
    ds_read_b128 v[168:171], v247 offset:8192
L_pl_X_2:
    s_cbranch_execz L_pl_X_6
    v_mfma_f32_16x16x32_bf16 v[40:43], v[68:71], v[100:103], v[40:43]
    s_add_u32 m0, s73, 49152
    ds_read_b128 v[172:175], v247 offset:12288
    v_mfma_f32_16x16x32_bf16 v[40:43], v[72:75], v[96:99], v[40:43]
    buffer_load_dwordx4 v4, s[52:55], s14 offen offset:0 lds
    v_alignbit_b32 v225, v226, v225, 16
    v_mfma_f32_16x16x32_bf16 v[44:47], v[76:79], v[96:99], v[44:47]
    ds_read_b128 v[176:179], v247 offset:16384
    v_mfma_f32_16x16x32_bf16 v[44:47], v[72:75], v[100:103], v[44:47]
    ds_read_b128 v[180:183], v247 offset:20480
    v_mfma_f32_16x16x32_bf16 v[44:47], v[68:71], v[104:107], v[44:47]
    ds_read_b128 v[184:187], v247 offset:24576
    v_mfma_f32_16x16x32_bf16 v[44:47], v[64:67], v[108:111], v[44:47]
    v_alignbit_b32 v226, v227, v226, 16
    v_mfma_f32_16x16x32_bf16 v[48:51], v[64:67], v[112:115], v[48:51]
    ds_read_b128 v[188:191], v247 offset:28672
    v_mfma_f32_16x16x32_bf16 v[48:51], v[68:71], v[108:111], v[48:51]
    ds_read2_b32 v[128:129], v236 offset0:112 offset1:113
    v_mfma_f32_16x16x32_bf16 v[48:51], v[72:75], v[104:107], v[48:51]
    v_alignbit_b32 v227, v228, v227, 16
    v_mfma_f32_16x16x32_bf16 v[48:51], v[76:79], v[100:103], v[48:51]
    ds_read2_b32 v[130:131], v236 offset0:114 offset1:115
    v_mfma_f32_16x16x32_bf16 v[48:51], v[80:83], v[96:99], v[48:51]
    ds_read2_b32 v[132:133], v236 offset0:240 offset1:241
    v_mfma_f32_16x16x32_bf16 v[52:55], v[84:87], v[96:99], v[52:55]
    ds_write_b128 v241, v[224:227] offset:14560
    v_mfma_f32_16x16x32_bf16 v[52:55], v[80:83], v[100:103], v[52:55]
    s_add_u32 m0, s73, 49152
    ds_read2_b32 v[134:135], v236 offset0:242 offset1:243
    v_mfma_f32_16x16x32_bf16 v[52:55], v[76:79], v[104:107], v[52:55]
    buffer_load_dwordx4 v5, s[52:55], s14 offen offset:1024 lds
    ds_read2_b32 v[136:137], v237 offset0:112 offset1:113
    v_mfma_f32_16x16x32_bf16 v[52:55], v[72:75], v[108:111], v[52:55]
    s_add_u32 s6, s12, 4718592
    ds_read2_b32 v[138:139], v237 offset0:114 offset1:115
    v_mfma_f32_16x16x32_bf16 v[52:55], v[68:71], v[112:115], v[52:55]
    ds_read2_b32 v[140:141], v237 offset0:240 offset1:241
    v_alignbit_b32 v230, v231, v230, 16
    v_mfma_f32_16x16x32_bf16 v[52:55], v[64:67], v[116:119], v[52:55]
    ds_read2_b32 v[142:143], v237 offset0:242 offset1:243
    v_xor_b32 v244, 64, v244
    v_mfma_f32_16x16x32_bf16 v[56:59], v[64:67], v[120:123], v[56:59]
    ds_read2_b32 v[144:145], v238 offset0:112 offset1:113
    v_mfma_f32_16x16x32_bf16 v[56:59], v[68:71], v[116:119], v[56:59]
    ds_read2_b32 v[146:147], v238 offset0:114 offset1:115
    v_mfma_f32_16x16x32_bf16 v[56:59], v[72:75], v[112:115], v[56:59]
    ds_read2_b32 v[148:149], v238 offset0:240 offset1:241
    v_alignbit_b32 v231, v232, v231, 16
    v_mfma_f32_16x16x32_bf16 v[56:59], v[76:79], v[108:111], v[56:59]
    ds_read2_b32 v[150:151], v238 offset0:242 offset1:243
    v_xor_b32 v245, 64, v245
    v_mfma_f32_16x16x32_bf16 v[56:59], v[80:83], v[104:107], v[56:59]
    ds_read2_b32 v[152:153], v239 offset0:112 offset1:113
    v_mfma_f32_16x16x32_bf16 v[56:59], v[84:87], v[100:103], v[56:59]
    ds_read2_b32 v[154:155], v239 offset0:114 offset1:115
    v_mfma_f32_16x16x32_bf16 v[56:59], v[88:91], v[96:99], v[56:59]
    ds_read2_b32 v[156:157], v239 offset0:240 offset1:241
    v_alignbit_b32 v232, v233, v232, 16
    v_mfma_f32_16x16x32_bf16 v[60:63], v[92:95], v[96:99], v[60:63]
    s_add_u32 m0, s73, 49152
    ds_read2_b32 v[158:159], v239 offset0:242 offset1:243
    v_mfma_f32_16x16x32_bf16 v[60:63], v[88:91], v[100:103], v[60:63]
    buffer_load_dwordx4 v6, s[52:55], s14 offen offset:2048 lds
    v_xor_b32 v246, 64, v246
    v_mfma_f32_16x16x32_bf16 v[60:63], v[84:87], v[104:107], v[60:63]
    v_alignbit_b32 v233, v234, v233, 16
    v_add_u32 v236, 8320, v236
    v_mfma_f32_16x16x32_bf16 v[60:63], v[80:83], v[108:111], v[60:63]
    v_add_u32 v237, 8320, v237
    v_mfma_f32_16x16x32_bf16 v[60:63], v[76:79], v[112:115], v[60:63]
    v_mfma_f32_16x16x32_bf16 v[60:63], v[72:75], v[116:119], v[60:63]
    v_xor_b32 v247, 64, v247
    v_add_u32 v238, 8320, v238
    v_mfma_f32_16x16x32_bf16 v[60:63], v[68:71], v[120:123], v[60:63]
    ds_write_b128 v241, v[230:233] offset:15584
    v_mfma_f32_16x16x32_bf16 v[60:63], v[64:67], v[124:127], v[60:63]
    v_add_u32 v239, 8320, v239
    s_waitcnt lgkmcnt(1)
    v_mfma_f32_16x16x32_bf16 v[60:63], v[128:131], v[188:191], v[60:63]
    ds_read_b128 v[96:99], v244 offset:2048
    v_mfma_f32_16x16x32_bf16 v[60:63], v[132:135], v[184:187], v[60:63]
    ds_read2_b32 v[64:65], v236 offset0:0 offset1:1
    v_mfma_f32_16x16x32_bf16 v[60:63], v[136:139], v[180:183], v[60:63]
    ds_read2_b32 v[66:67], v236 offset0:2 offset1:3
    v_mfma_f32_16x16x32_bf16 v[60:63], v[140:143], v[176:179], v[60:63]
    s_add_u32 m0, s73, 49152
    ds_read_b128 v[100:103], v244 offset:6144
    v_mfma_f32_16x16x32_bf16 v[60:63], v[144:147], v[172:175], v[60:63]
    buffer_load_dwordx4 v7, s[52:55], s14 offen offset:3072 lds
    ds_read2_b32 v[68:69], v236 offset0:128 offset1:129
    v_mfma_f32_16x16x32_bf16 v[60:63], v[148:151], v[168:171], v[60:63]
    ds_read2_b32 v[70:71], v236 offset0:130 offset1:131
    v_mfma_f32_16x16x32_bf16 v[60:63], v[152:155], v[164:167], v[60:63]
    ds_read_b128 v[104:107], v244 offset:10240
    v_mfma_f32_16x16x32_bf16 v[60:63], v[156:159], v[160:163], v[60:63]
    ds_read2_b32 v[72:73], v237 offset0:0 offset1:1
    v_mfma_f32_16x16x32_bf16 v[56:59], v[128:131], v[184:187], v[56:59]
    ds_read2_b32 v[74:75], v237 offset0:2 offset1:3
    v_mfma_f32_16x16x32_bf16 v[56:59], v[132:135], v[180:183], v[56:59]
    ds_read_b128 v[108:111], v244 offset:14336
    v_mfma_f32_16x16x32_bf16 v[56:59], v[136:139], v[176:179], v[56:59]
    ds_read2_b32 v[76:77], v237 offset0:128 offset1:129
    v_mfma_f32_16x16x32_bf16 v[56:59], v[140:143], v[172:175], v[56:59]
    ds_read2_b32 v[78:79], v237 offset0:130 offset1:131
    v_mfma_f32_16x16x32_bf16 v[56:59], v[144:147], v[168:171], v[56:59]
    ds_read_b128 v[112:115], v244 offset:18432
    v_mfma_f32_16x16x32_bf16 v[56:59], v[148:151], v[164:167], v[56:59]
    ds_read2_b32 v[80:81], v238 offset0:0 offset1:1
    v_cvt_pk_bf16_f32 v206, v60, v61
    v_mfma_f32_16x16x32_bf16 v[56:59], v[152:155], v[160:163], v[56:59]
    ds_read2_b32 v[82:83], v238 offset0:2 offset1:3
    v_mfma_f32_16x16x32_bf16 v[52:55], v[128:131], v[180:183], v[52:55]
    ds_read_b128 v[116:119], v244 offset:22528
    v_mfma_f32_16x16x32_bf16 v[52:55], v[132:135], v[176:179], v[52:55]
    ds_read2_b32 v[84:85], v238 offset0:128 offset1:129
    v_cvt_pk_bf16_f32 v207, v62, v63
    v_mfma_f32_16x16x32_bf16 v[52:55], v[136:139], v[172:175], v[52:55]
    ds_read2_b32 v[86:87], v238 offset0:130 offset1:131
    v_mfma_f32_16x16x32_bf16 v[52:55], v[140:143], v[168:171], v[52:55]
    buffer_store_dwordx2 v[206:207], v8, s[44:47], s6 offen offset:3584 sc1
    ds_read_b128 v[120:123], v244 offset:26624
    v_mfma_f32_16x16x32_bf16 v[52:55], v[144:147], v[164:167], v[52:55]
    ds_read2_b32 v[88:89], v239 offset0:0 offset1:1
    v_mfma_f32_16x16x32_bf16 v[52:55], v[148:151], v[160:163], v[52:55]
    ds_read2_b32 v[90:91], v239 offset0:2 offset1:3
    v_mfma_f32_16x16x32_bf16 v[48:51], v[128:131], v[176:179], v[48:51]
    s_waitcnt vmcnt(5)
    s_barrier
    v_cvt_pk_bf16_f32 v204, v56, v57
    v_mfma_f32_16x16x32_bf16 v[48:51], v[132:135], v[172:175], v[48:51]
    ds_read_b128 v[124:127], v244 offset:30720
    v_add_u32 v10, 131072, v10
    v_mfma_f32_16x16x32_bf16 v[48:51], v[136:139], v[168:171], v[48:51]
    ds_read_b64_tr_b16 a[32:33], v10 offset:16384
    v_mfma_f32_16x16x32_bf16 v[48:51], v[140:143], v[164:167], v[48:51]
    ds_read2_b32 v[92:93], v239 offset0:128 offset1:129
    v_cvt_pk_bf16_f32 v205, v58, v59
    v_mfma_f32_16x16x32_bf16 v[48:51], v[144:147], v[160:163], v[48:51]
    ds_read_b64_tr_b16 a[34:35], v10 offset:18432
    v_mfma_f32_16x16x32_bf16 v[44:47], v[128:131], v[172:175], v[44:47]
    buffer_store_dwordx2 v[204:205], v8, s[44:47], s6 offen offset:3072 sc1
    ds_read_b64_tr_b16 a[40:41], v10 offset:20480
    v_mfma_f32_16x16x32_bf16 v[44:47], v[132:135], v[168:171], v[44:47]
    ds_read_b64_tr_b16 a[42:43], v10 offset:22528
    v_mfma_f32_16x16x32_bf16 v[44:47], v[136:139], v[164:167], v[44:47]
    ds_read2_b32 v[94:95], v239 offset0:130 offset1:131
    v_add_u32 v11, 131072, v11
    v_mfma_f32_16x16x32_bf16 v[44:47], v[140:143], v[160:163], v[44:47]
    ds_read_b64_tr_b16 a[36:37], v11 offset:16384
    v_cvt_pk_bf16_f32 v202, v52, v53
    v_mfma_f32_16x16x32_bf16 v[40:43], v[128:131], v[168:171], v[40:43]
    v_mfma_f32_16x16x32_bf16 v[40:43], v[132:135], v[164:167], v[40:43]
    ds_read_b64_tr_b16 a[38:39], v11 offset:18432
    v_mfma_f32_16x16x32_bf16 v[40:43], v[136:139], v[160:163], v[40:43]
    ds_read_b64_tr_b16 a[44:45], v11 offset:20480
    v_cvt_pk_bf16_f32 v203, v54, v55
    v_mfma_f32_16x16x32_bf16 v[36:39], v[128:131], v[164:167], v[36:39]
    ds_read_b64_tr_b16 a[46:47], v11 offset:22528
    v_mfma_f32_16x16x32_bf16 v[36:39], v[132:135], v[160:163], v[36:39]
    buffer_store_dwordx2 v[202:203], v8, s[44:47], s6 offen offset:2560 sc1
    v_mfma_f32_16x16x32_bf16 v[32:35], v[128:131], v[160:163], v[32:35]
    s_waitcnt lgkmcnt(4)
    v_mfma_f32_16x16x32_bf16 v[60:63], v[64:67], v[124:127], 0
    ds_read_b128 v[160:163], v245 offset:2048
    s_waitcnt lgkmcnt(1)
    s_barrier
    v_mfma_f32_16x16x32_bf16 v[60:63], v[68:71], v[120:123], v[60:63]
    v_cvt_pk_bf16_f32 v200, v48, v49
    v_mfma_f32_16x16x32_bf16 v[60:63], v[72:75], v[116:119], v[60:63]
    ds_read2_b32 v[128:129], v236 offset0:16 offset1:17
    v_mfma_f32_16x16x32_bf16 v[60:63], v[76:79], v[112:115], v[60:63]
    ds_read2_b32 v[130:131], v236 offset0:18 offset1:19
    s_lshl_b32 s14, s88, 18
    v_cvt_pk_bf16_f32 v201, v50, v51
    v_mfma_f32_16x16x32_bf16 v[60:63], v[80:83], v[108:111], v[60:63]
    s_add_u32 m0, s73, 147456
    v_mfma_f32_16x16x32_bf16 v[60:63], v[84:87], v[104:107], v[60:63]
    buffer_load_dwordx4 v4, s[52:55], s14 offen offset:0 lds
    ds_read_b128 v[164:167], v245 offset:6144
    v_mfma_f32_16x16x32_bf16 v[60:63], v[88:91], v[100:103], v[60:63]
    buffer_store_dwordx2 v[200:201], v8, s[44:47], s6 offen offset:2048 sc1
    ds_read2_b32 v[132:133], v236 offset0:144 offset1:145
    v_mfma_f32_16x16x32_bf16 v[60:63], v[92:95], v[96:99], v[60:63]
    s_add_u32 s13, s12, 32768
    v_cvt_pk_bf16_f32 v198, v44, v45
    v_mfma_f32_16x16x32_bf16 v[56:59], v[64:67], v[120:123], 0
    ds_read2_b32 v[134:135], v236 offset0:146 offset1:147
    v_mfma_f32_16x16x32_bf16 v[56:59], v[68:71], v[116:119], v[56:59]
    s_add_u32 m0, s74, 32
    ds_read_b128 v[168:171], v245 offset:10240
    v_mfma_f32_16x16x32_bf16 v[56:59], v[72:75], v[112:115], v[56:59]
    buffer_load_dwordx4 v240, s[48:51], s13 offen offset:0 lds
    v_cvt_pk_bf16_f32 v199, v46, v47
    v_mfma_f32_16x16x32_bf16 v[56:59], v[76:79], v[108:111], v[56:59]
    ds_read2_b32 v[136:137], v237 offset0:16 offset1:17
    v_mfma_f32_16x16x32_bf16 v[56:59], v[80:83], v[104:107], v[56:59]
    buffer_store_dwordx2 v[198:199], v8, s[44:47], s6 offen offset:1536 sc1
    ds_read2_b32 v[138:139], v237 offset0:18 offset1:19
    v_mfma_f32_16x16x32_bf16 v[56:59], v[84:87], v[100:103], v[56:59]
    ds_read_b128 v[172:175], v245 offset:14336
    v_mfma_f32_16x16x32_bf16 v[56:59], v[88:91], v[96:99], v[56:59]
    v_cvt_pk_bf16_f32 v196, v40, v41
    v_mfma_f32_16x16x32_bf16 v[52:55], v[64:67], v[116:119], 0
    ds_read2_b32 v[140:141], v237 offset0:144 offset1:145
    v_mfma_f32_16x16x32_bf16 v[52:55], v[68:71], v[112:115], v[52:55]
    ds_read2_b32 v[142:143], v237 offset0:146 offset1:147
    s_add_u32 m0, s73, 147456
    v_cvt_pk_bf16_f32 v197, v42, v43
    v_mfma_f32_16x16x32_bf16 v[52:55], v[72:75], v[108:111], v[52:55]
    buffer_load_dwordx4 v5, s[52:55], s14 offen offset:1024 lds
    v_mfma_f32_16x16x32_bf16 v[52:55], v[76:79], v[104:107], v[52:55]
    buffer_store_dwordx2 v[196:197], v8, s[44:47], s6 offen offset:1024 sc1
    ds_read_b128 v[176:179], v245 offset:18432
    s_add_u32 m0, s74, 32
    v_mfma_f32_16x16x32_bf16 v[52:55], v[80:83], v[100:103], v[52:55]
    buffer_load_dwordx4 v240, s[48:51], s13 offen offset:1024 lds
    ds_read2_b32 v[144:145], v238 offset0:16 offset1:17
    v_mfma_f32_16x16x32_bf16 v[52:55], v[84:87], v[96:99], v[52:55]
    v_mfma_f32_16x16x32_bf16 v[48:51], v[64:67], v[112:115], 0
    ds_read2_b32 v[146:147], v238 offset0:18 offset1:19
    v_cvt_pk_bf16_f32 v194, v36, v37
    v_mfma_f32_16x16x32_bf16 v[48:51], v[68:71], v[108:111], v[48:51]
    ds_read_b128 v[180:183], v245 offset:22528
    v_mfma_f32_16x16x32_bf16 v[48:51], v[72:75], v[104:107], v[48:51]
    v_cvt_pk_bf16_f32 v195, v38, v39
    v_mfma_f32_16x16x32_bf16 v[48:51], v[76:79], v[100:103], v[48:51]
    buffer_store_dwordx2 v[194:195], v8, s[44:47], s6 offen offset:512 sc1
    ds_read2_b32 v[148:149], v238 offset0:144 offset1:145
    s_add_u32 m0, s74, 32
    v_mfma_f32_16x16x32_bf16 v[48:51], v[80:83], v[96:99], v[48:51]
    buffer_load_dwordx4 v240, s[48:51], s13 offen offset:2048 lds
    ds_read2_b32 v[150:151], v238 offset0:146 offset1:147
    v_mfma_f32_16x16x32_bf16 v[44:47], v[64:67], v[108:111], 0
    ds_read_b128 v[184:187], v245 offset:26624
    v_mfma_f32_16x16x32_bf16 v[44:47], v[68:71], v[104:107], v[44:47]
    v_cvt_pk_bf16_f32 v192, v32, v33
    v_mfma_f32_16x16x32_bf16 v[44:47], v[72:75], v[100:103], v[44:47]
    s_add_u32 m0, s73, 147456
    ds_read2_b32 v[152:153], v239 offset0:16 offset1:17
    v_mfma_f32_16x16x32_bf16 v[44:47], v[76:79], v[96:99], v[44:47]
    buffer_load_dwordx4 v6, s[52:55], s14 offen offset:2048 lds
    v_cvt_pk_bf16_f32 v193, v34, v35
    v_mfma_f32_16x16x32_bf16 v[40:43], v[64:67], v[104:107], 0
    ds_read2_b32 v[154:155], v239 offset0:18 offset1:19
    v_mfma_f32_16x16x32_bf16 v[40:43], v[68:71], v[100:103], v[40:43]
    buffer_store_dwordx2 v[192:193], v8, s[44:47], s6 offen offset:0 sc1
    ds_read_b128 v[188:191], v245 offset:30720
    v_mfma_f32_16x16x32_bf16 v[40:43], v[72:75], v[96:99], v[40:43]
    s_add_u32 m0, s74, 32
    ds_read2_b32 v[156:157], v239 offset0:144 offset1:145
    v_mfma_f32_16x16x32_bf16 v[36:39], v[64:67], v[100:103], 0
    buffer_load_dwordx4 v240, s[48:51], s13 offen offset:3072 lds
    v_mfma_f32_16x16x32_bf16 v[36:39], v[68:71], v[96:99], v[36:39]
    ds_read2_b32 v[158:159], v239 offset0:146 offset1:147
    v_mfma_f32_16x16x32_bf16 v[32:35], v[64:67], v[96:99], 0
    s_waitcnt lgkmcnt(12)
    v_mfma_f32_16x16x32_bf16 v[32:35], v[128:131], v[160:163], v[32:35]
    ds_read_b128 v[96:99], v246 offset:2048
    v_mfma_f32_16x16x32_bf16 v[36:39], v[132:135], v[160:163], v[36:39]
    v_mfma_f32_16x16x32_bf16 v[36:39], v[128:131], v[164:167], v[36:39]
    ds_read2_b32 v[64:65], v236 offset0:32 offset1:33
    v_mfma_f32_16x16x32_bf16 v[40:43], v[128:131], v[168:171], v[40:43]
    s_add_u32 m0, s73, 147456
    ds_read2_b32 v[66:67], v236 offset0:34 offset1:35
    v_mfma_f32_16x16x32_bf16 v[40:43], v[132:135], v[164:167], v[40:43]
    buffer_load_dwordx4 v7, s[52:55], s14 offen offset:3072 lds
    v_mfma_f32_16x16x32_bf16 v[40:43], v[136:139], v[160:163], v[40:43]
    ds_read_b128 v[100:103], v246 offset:6144
    v_mfma_f32_16x16x32_bf16 v[44:47], v[140:143], v[160:163], v[44:47]
    ds_read2_b32 v[68:69], v236 offset0:160 offset1:161
    v_mfma_f32_16x16x32_bf16 v[44:47], v[136:139], v[164:167], v[44:47]
    ds_read2_b32 v[70:71], v236 offset0:162 offset1:163
    v_mfma_f32_16x16x32_bf16 v[44:47], v[132:135], v[168:171], v[44:47]
    ds_read_b128 v[104:107], v246 offset:10240
    v_mfma_f32_16x16x32_bf16 v[44:47], v[128:131], v[172:175], v[44:47]
    ds_read2_b32 v[72:73], v237 offset0:32 offset1:33
    s_waitcnt lgkmcnt(8)
    v_mfma_f32_16x16x32_bf16 v[48:51], v[128:131], v[176:179], v[48:51]
    ds_read2_b32 v[74:75], v237 offset0:34 offset1:35
    v_mfma_f32_16x16x32_bf16 v[48:51], v[132:135], v[172:175], v[48:51]
    ds_read_b128 v[108:111], v246 offset:14336
    v_mfma_f32_16x16x32_bf16 v[48:51], v[136:139], v[168:171], v[48:51]
    v_mov_b32 v9, 16
    buffer_load_ushort v9, v9, s[56:59], s70 offen
    v_mfma_f32_16x16x32_bf16 v[48:51], v[140:143], v[164:167], v[48:51]
    ds_read2_b32 v[76:77], v237 offset0:160 offset1:161
    v_mfma_f32_16x16x32_bf16 v[48:51], v[144:147], v[160:163], v[48:51]
    ds_read2_b32 v[78:79], v237 offset0:162 offset1:163
    s_waitcnt vmcnt(17)
    s_barrier
    v_mfma_f32_16x16x32_bf16 v[52:55], v[148:151], v[160:163], v[52:55]
    ds_read_b128 v[112:115], v246 offset:18432
    v_add_u32 v10, -131072, v10
    v_mfma_f32_16x16x32_bf16 v[52:55], v[144:147], v[164:167], v[52:55]
    ds_read_b64_tr_b16 a[48:49], v10 offset:49152
    v_mfma_f32_16x16x32_bf16 v[52:55], v[140:143], v[168:171], v[52:55]
    ds_read_b64_tr_b16 a[50:51], v10 offset:51200
    v_mfma_f32_16x16x32_bf16 v[52:55], v[136:139], v[172:175], v[52:55]
    ds_read2_b32 v[80:81], v238 offset0:32 offset1:33
    v_mfma_f32_16x16x32_bf16 v[52:55], v[132:135], v[176:179], v[52:55]
    ds_read_b64_tr_b16 a[56:57], v10 offset:53248
    v_mfma_f32_16x16x32_bf16 v[52:55], v[128:131], v[180:183], v[52:55]
    ds_read_b64_tr_b16 a[58:59], v10 offset:55296
    v_mfma_f32_16x16x32_bf16 v[56:59], v[128:131], v[184:187], v[56:59]
    ds_read2_b32 v[82:83], v238 offset0:34 offset1:35
    v_add_u32 v11, -131072, v11
    v_mfma_f32_16x16x32_bf16 v[56:59], v[132:135], v[180:183], v[56:59]
    ds_read_b64_tr_b16 a[52:53], v11 offset:49152
    v_mfma_f32_16x16x32_bf16 v[56:59], v[136:139], v[176:179], v[56:59]
    ds_read_b64_tr_b16 a[54:55], v11 offset:51200
    v_mfma_f32_16x16x32_bf16 v[56:59], v[140:143], v[172:175], v[56:59]
    ds_read_b128 v[116:119], v246 offset:22528
    v_mfma_f32_16x16x32_bf16 v[56:59], v[144:147], v[168:171], v[56:59]
    ds_read_b64_tr_b16 a[60:61], v11 offset:53248
    v_mfma_f32_16x16x32_bf16 v[56:59], v[148:151], v[164:167], v[56:59]
    ds_read_b64_tr_b16 a[62:63], v11 offset:55296
    v_mfma_f32_16x16x32_bf16 v[56:59], v[152:155], v[160:163], v[56:59]
    ds_read2_b32 v[84:85], v238 offset0:160 offset1:161
    v_mfma_f32_16x16x32_bf16 v[60:63], v[156:159], v[160:163], v[60:63]
    ds_read2_b32 v[86:87], v238 offset0:162 offset1:163
    v_mfma_f32_16x16x32_bf16 v[60:63], v[152:155], v[164:167], v[60:63]
    ds_read_b128 v[120:123], v246 offset:26624
    v_mfma_f32_16x16x32_bf16 v[60:63], v[148:151], v[168:171], v[60:63]
    ds_read2_b32 v[88:89], v239 offset0:32 offset1:33
    v_mfma_f32_16x16x32_bf16 v[60:63], v[144:147], v[172:175], v[60:63]
    ds_read2_b32 v[90:91], v239 offset0:34 offset1:35
    v_mfma_f32_16x16x32_bf16 v[60:63], v[140:143], v[176:179], v[60:63]
    ds_read_b128 v[124:127], v246 offset:30720
    v_mfma_f32_16x16x32_bf16 v[60:63], v[136:139], v[180:183], v[60:63]
    ds_read2_b32 v[92:93], v239 offset0:160 offset1:161
    v_mfma_f32_16x16x32_bf16 v[60:63], v[132:135], v[184:187], v[60:63]
    ds_read2_b32 v[94:95], v239 offset0:162 offset1:163
    v_mfma_f32_16x16x32_bf16 v[60:63], v[128:131], v[188:191], v[60:63]
    s_waitcnt lgkmcnt(15)
    v_mfma_f32_16x16x32_bf16 v[32:35], v[64:67], v[96:99], v[32:35]
    ds_read_b128 v[160:163], v247 offset:2048
    v_mfma_f32_16x16x32_bf16 v[36:39], v[68:71], v[96:99], v[36:39]
    v_mfma_f32_16x16x32_bf16 v[36:39], v[64:67], v[100:103], v[36:39]
    ds_read2_b32 v[128:129], v236 offset0:48 offset1:49
    v_mfma_f32_16x16x32_bf16 v[40:43], v[64:67], v[104:107], v[40:43]
    ds_read2_b32 v[130:131], v236 offset0:50 offset1:51
    v_mfma_f32_16x16x32_bf16 v[40:43], v[68:71], v[100:103], v[40:43]
    v_mfma_f32_16x16x32_bf16 v[40:43], v[72:75], v[96:99], v[40:43]
    ds_read_b128 v[164:167], v247 offset:6144
    v_mfma_f32_16x16x32_bf16 v[44:47], v[76:79], v[96:99], v[44:47]
    ds_read2_b32 v[132:133], v236 offset0:176 offset1:177
    v_mfma_f32_16x16x32_bf16 v[44:47], v[72:75], v[100:103], v[44:47]
    s_waitcnt lgkmcnt(13)
    s_barrier
    v_mfma_f32_16x16x32_bf16 v[44:47], v[68:71], v[104:107], v[44:47]
    ds_read2_b32 v[134:135], v236 offset0:178 offset1:179
    v_mfma_f32_16x16x32_bf16 v[44:47], v[64:67], v[108:111], v[44:47]
    ds_read_b128 v[168:171], v247 offset:10240
    s_waitcnt lgkmcnt(7)
    v_mfma_f32_16x16x32_bf16 v[48:51], v[64:67], v[112:115], v[48:51]
    ds_read2_b32 v[136:137], v237 offset0:48 offset1:49
    v_mfma_f32_16x16x32_bf16 v[48:51], v[68:71], v[108:111], v[48:51]
    v_mfma_f32_16x16x32_bf16 v[48:51], v[72:75], v[104:107], v[48:51]
    ds_read2_b32 v[138:139], v237 offset0:50 offset1:51
    v_mfma_f32_16x16x32_bf16 v[48:51], v[76:79], v[100:103], v[48:51]
    ds_read_b128 v[172:175], v247 offset:14336
    v_mfma_f32_16x16x32_bf16 v[48:51], v[80:83], v[96:99], v[48:51]
    v_mfma_f32_16x16x32_bf16 v[52:55], v[84:87], v[96:99], v[52:55]
    ds_read2_b32 v[140:141], v237 offset0:176 offset1:177
    v_mfma_f32_16x16x32_bf16 v[52:55], v[80:83], v[100:103], v[52:55]
    ds_read2_b32 v[142:143], v237 offset0:178 offset1:179
    v_mfma_f32_16x16x32_bf16 v[52:55], v[76:79], v[104:107], v[52:55]
    v_mfma_f32_16x16x32_bf16 v[52:55], v[72:75], v[108:111], v[52:55]
    ds_read_b128 v[176:179], v247 offset:18432
    v_mfma_f32_16x16x32_bf16 v[52:55], v[68:71], v[112:115], v[52:55]
    ds_read2_b32 v[144:145], v238 offset0:48 offset1:49
    v_mfma_f32_16x16x32_bf16 v[52:55], v[64:67], v[116:119], v[52:55]
    v_mfma_f32_16x16x32_bf16 v[56:59], v[64:67], v[120:123], v[56:59]
    ds_read2_b32 v[146:147], v238 offset0:50 offset1:51
    v_mfma_f32_16x16x32_bf16 v[56:59], v[68:71], v[116:119], v[56:59]
    ds_read_b128 v[180:183], v247 offset:22528
    v_mfma_f32_16x16x32_bf16 v[56:59], v[72:75], v[112:115], v[56:59]
    v_mfma_f32_16x16x32_bf16 v[56:59], v[76:79], v[108:111], v[56:59]
    ds_read2_b32 v[148:149], v238 offset0:176 offset1:177
    v_mfma_f32_16x16x32_bf16 v[56:59], v[80:83], v[104:107], v[56:59]
    ds_read2_b32 v[150:151], v238 offset0:178 offset1:179
    v_mfma_f32_16x16x32_bf16 v[56:59], v[84:87], v[100:103], v[56:59]
    ds_read_b128 v[184:187], v247 offset:26624
    v_mfma_f32_16x16x32_bf16 v[56:59], v[88:91], v[96:99], v[56:59]
    v_mfma_f32_16x16x32_bf16 v[60:63], v[92:95], v[96:99], v[60:63]
    ds_read2_b32 v[152:153], v239 offset0:48 offset1:49
    v_mfma_f32_16x16x32_bf16 v[60:63], v[88:91], v[100:103], v[60:63]
    ds_read2_b32 v[154:155], v239 offset0:50 offset1:51
    v_mfma_f32_16x16x32_bf16 v[60:63], v[84:87], v[104:107], v[60:63]
    v_mfma_f32_16x16x32_bf16 v[60:63], v[80:83], v[108:111], v[60:63]
    ds_read_b128 v[188:191], v247 offset:30720
    v_mfma_f32_16x16x32_bf16 v[60:63], v[76:79], v[112:115], v[60:63]
    ds_read2_b32 v[156:157], v239 offset0:176 offset1:177
    v_mfma_f32_16x16x32_bf16 v[60:63], v[72:75], v[116:119], v[60:63]
    v_mfma_f32_16x16x32_bf16 v[60:63], v[68:71], v[120:123], v[60:63]
    ds_read2_b32 v[158:159], v239 offset0:178 offset1:179
    v_mfma_f32_16x16x32_bf16 v[60:63], v[64:67], v[124:127], v[60:63]
    s_waitcnt lgkmcnt(12)
    v_mfma_f32_16x16x32_bf16 v[32:35], v[128:131], v[160:163], v[32:35]
    ds_read_b128 v[96:99], v244 offset:0
    v_mfma_f32_16x16x32_bf16 v[36:39], v[132:135], v[160:163], v[36:39]
    v_mfma_f32_16x16x32_bf16 v[36:39], v[128:131], v[164:167], v[36:39]
    ds_read2_b32 v[64:65], v236 offset0:64 offset1:65
    v_mfma_f32_16x16x32_bf16 v[40:43], v[128:131], v[168:171], v[40:43]
    ds_read2_b32 v[66:67], v236 offset0:66 offset1:67
    v_mfma_f32_16x16x32_bf16 v[40:43], v[132:135], v[164:167], v[40:43]
    v_mfma_f32_16x16x32_bf16 v[40:43], v[136:139], v[160:163], v[40:43]
    ds_read_b128 v[100:103], v244 offset:4096
    v_mfma_f32_16x16x32_bf16 v[44:47], v[140:143], v[160:163], v[44:47]
    ds_read2_b32 v[68:69], v236 offset0:192 offset1:193
    v_mfma_f32_16x16x32_bf16 v[44:47], v[136:139], v[164:167], v[44:47]
    s_add_u32 m0, s9, 36864
    s_add_u32 s13, s7, 128
    v_mfma_f32_16x16x32_bf16 v[44:47], v[132:135], v[168:171], v[44:47]
    buffer_load_dwordx4 v24, s[44:47], s13 offen sc1 lds
    ds_read2_b32 v[70:71], v236 offset0:194 offset1:195
    v_mfma_f32_16x16x32_bf16 v[44:47], v[128:131], v[172:175], v[44:47]
    ds_read_b128 v[104:107], v244 offset:8192
    s_waitcnt lgkmcnt(7)
    v_mfma_f32_16x16x32_bf16 v[48:51], v[128:131], v[176:179], v[48:51]
    ds_read2_b32 v[72:73], v237 offset0:64 offset1:65
    v_mfma_f32_16x16x32_bf16 v[48:51], v[132:135], v[172:175], v[48:51]
    ds_read2_b32 v[74:75], v237 offset0:66 offset1:67
    v_mfma_f32_16x16x32_bf16 v[48:51], v[136:139], v[168:171], v[48:51]
    ds_read_b128 v[108:111], v244 offset:12288
    v_mfma_f32_16x16x32_bf16 v[48:51], v[140:143], v[164:167], v[48:51]
    ds_read2_b32 v[76:77], v237 offset0:192 offset1:193
    v_mfma_f32_16x16x32_bf16 v[48:51], v[144:147], v[160:163], v[48:51]
    ds_read2_b32 v[78:79], v237 offset0:194 offset1:195
    v_mfma_f32_16x16x32_bf16 v[52:55], v[148:151], v[160:163], v[52:55]
    ds_read_b128 v[112:115], v244 offset:16384
    v_mfma_f32_16x16x32_bf16 v[52:55], v[144:147], v[164:167], v[52:55]
    ds_read2_b32 v[80:81], v238 offset0:64 offset1:65
    s_add_u32 m0, s9, 37888
    s_add_u32 s13, s7, 73856
    v_mfma_f32_16x16x32_bf16 v[52:55], v[140:143], v[168:171], v[52:55]
    buffer_load_dwordx4 v25, s[44:47], s13 offen sc1 lds
    ds_read2_b32 v[82:83], v238 offset0:66 offset1:67
    v_mfma_f32_16x16x32_bf16 v[52:55], v[136:139], v[172:175], v[52:55]
    ds_read_b128 v[116:119], v244 offset:20480
    v_mfma_f32_16x16x32_bf16 v[52:55], v[132:135], v[176:179], v[52:55]
    ds_read2_b32 v[84:85], v238 offset0:192 offset1:193
    v_mfma_f32_16x16x32_bf16 v[52:55], v[128:131], v[180:183], v[52:55]
    ds_read2_b32 v[86:87], v238 offset0:194 offset1:195
    v_mfma_f32_16x16x32_bf16 v[56:59], v[128:131], v[184:187], v[56:59]
    ds_read_b128 v[120:123], v244 offset:24576
    s_waitcnt vmcnt(3)
    s_barrier
    v_mfma_f32_16x16x32_bf16 v[56:59], v[132:135], v[180:183], v[56:59]
    ds_read2_b32 v[88:89], v239 offset0:64 offset1:65
    v_add_u32 v10, 131072, v10
    v_mfma_f32_16x16x32_bf16 v[56:59], v[136:139], v[176:179], v[56:59]
    ds_read_b64_tr_b16 a[64:65], v10 offset:16384
    v_mfma_f32_16x16x32_bf16 v[56:59], v[140:143], v[172:175], v[56:59]
    ds_read2_b32 v[90:91], v239 offset0:66 offset1:67
    v_mfma_f32_16x16x32_bf16 v[56:59], v[144:147], v[168:171], v[56:59]
    ds_read_b64_tr_b16 a[66:67], v10 offset:18432
    s_add_u32 m0, s9, 38912
    s_add_u32 s13, s7, 147584
    v_mfma_f32_16x16x32_bf16 v[56:59], v[148:151], v[164:167], v[56:59]
    ds_read_b64_tr_b16 a[72:73], v10 offset:20480
    buffer_load_dwordx4 v24, s[44:47], s13 offen sc1 lds
    v_mfma_f32_16x16x32_bf16 v[56:59], v[152:155], v[160:163], v[56:59]
    ds_read_b64_tr_b16 a[74:75], v10 offset:22528
    v_mfma_f32_16x16x32_bf16 v[60:63], v[156:159], v[160:163], v[60:63]
    ds_read_b128 v[124:127], v244 offset:28672
    v_add_u32 v11, 131072, v11
    v_mfma_f32_16x16x32_bf16 v[60:63], v[152:155], v[164:167], v[60:63]
    ds_read_b64_tr_b16 a[68:69], v11 offset:16384
    v_mfma_f32_16x16x32_bf16 v[60:63], v[148:151], v[168:171], v[60:63]
    ds_read2_b32 v[92:93], v239 offset0:192 offset1:193
    v_mfma_f32_16x16x32_bf16 v[60:63], v[144:147], v[172:175], v[60:63]
    ds_read_b64_tr_b16 a[70:71], v11 offset:18432
    v_mfma_f32_16x16x32_bf16 v[60:63], v[140:143], v[176:179], v[60:63]
    ds_read_b64_tr_b16 a[76:77], v11 offset:20480
    v_mfma_f32_16x16x32_bf16 v[60:63], v[136:139], v[180:183], v[60:63]
    ds_read_b64_tr_b16 a[78:79], v11 offset:22528
    v_mfma_f32_16x16x32_bf16 v[60:63], v[132:135], v[184:187], v[60:63]
    ds_read2_b32 v[94:95], v239 offset0:194 offset1:195
    s_add_u32 m0, s9, 39936
    s_add_u32 s13, s7, 221312
    v_mfma_f32_16x16x32_bf16 v[60:63], v[128:131], v[188:191], v[60:63]
    buffer_load_dwordx4 v25, s[44:47], s13 offen sc1 lds
    s_waitcnt lgkmcnt(15)
    v_mfma_f32_16x16x32_bf16 v[32:35], v[64:67], v[96:99], v[32:35]
    ds_read_b128 v[160:163], v245 offset:0
    s_waitcnt lgkmcnt(2)
    s_barrier
    v_mfma_f32_16x16x32_bf16 v[36:39], v[68:71], v[96:99], v[36:39]
    v_mfma_f32_16x16x32_bf16 v[36:39], v[64:67], v[100:103], v[36:39]
    ds_read2_b32 v[128:129], v236 offset0:80 offset1:81
    v_mfma_f32_16x16x32_bf16 v[40:43], v[64:67], v[104:107], v[40:43]
    s_lshl_b32 s14, s89, 18
    ds_read2_b32 v[130:131], v236 offset0:82 offset1:83
    v_mfma_f32_16x16x32_bf16 v[40:43], v[68:71], v[100:103], v[40:43]
    s_add_u32 m0, s73, 147456
    v_mfma_f32_16x16x32_bf16 v[40:43], v[72:75], v[96:99], v[40:43]
    buffer_load_dwordx4 v4, s[52:55], s14 offen offset:0 lds
    ds_read_b128 v[164:167], v245 offset:4096
    v_mfma_f32_16x16x32_bf16 v[44:47], v[76:79], v[96:99], v[44:47]
    ds_read2_b32 v[132:133], v236 offset0:208 offset1:209
    v_mfma_f32_16x16x32_bf16 v[44:47], v[72:75], v[100:103], v[44:47]
    s_add_u32 m0, s9, 40960
    s_add_u32 s13, s7, 295040
    v_mfma_f32_16x16x32_bf16 v[44:47], v[68:71], v[104:107], v[44:47]
    buffer_load_dwordx4 v24, s[44:47], s13 offen sc1 lds
    ds_read2_b32 v[134:135], v236 offset0:210 offset1:211
    v_mfma_f32_16x16x32_bf16 v[44:47], v[64:67], v[108:111], v[44:47]
    ds_read_b128 v[168:171], v245 offset:8192
    s_waitcnt lgkmcnt(7)
    v_mfma_f32_16x16x32_bf16 v[48:51], v[64:67], v[112:115], v[48:51]
    ds_read2_b32 v[136:137], v237 offset0:80 offset1:81
    v_mfma_f32_16x16x32_bf16 v[48:51], v[68:71], v[108:111], v[48:51]
    ds_read2_b32 v[138:139], v237 offset0:82 offset1:83
    v_mfma_f32_16x16x32_bf16 v[48:51], v[72:75], v[104:107], v[48:51]
    ds_read_b128 v[172:175], v245 offset:12288
    v_mfma_f32_16x16x32_bf16 v[48:51], v[76:79], v[100:103], v[48:51]
    ds_read2_b32 v[140:141], v237 offset0:208 offset1:209
    v_mfma_f32_16x16x32_bf16 v[48:51], v[80:83], v[96:99], v[48:51]
    ds_read2_b32 v[142:143], v237 offset0:210 offset1:211
    v_mfma_f32_16x16x32_bf16 v[52:55], v[84:87], v[96:99], v[52:55]
    ds_read_b128 v[176:179], v245 offset:16384
    v_mfma_f32_16x16x32_bf16 v[52:55], v[80:83], v[100:103], v[52:55]
    s_add_u32 m0, s73, 147456
    ds_read2_b32 v[144:145], v238 offset0:80 offset1:81
    v_mfma_f32_16x16x32_bf16 v[52:55], v[76:79], v[104:107], v[52:55]
    buffer_load_dwordx4 v5, s[52:55], s14 offen offset:1024 lds
    ds_read2_b32 v[146:147], v238 offset0:82 offset1:83
L_pl_X_3:
    s_cbranch_execz L_pl_X_7
    v_mfma_f32_16x16x32_bf16 v[52:55], v[72:75], v[108:111], v[52:55]
    ds_read_b128 v[180:183], v245 offset:20480
    s_add_u32 m0, s9, 41984
    s_add_u32 s13, s7, 368768
    v_mfma_f32_16x16x32_bf16 v[52:55], v[68:71], v[112:115], v[52:55]
    buffer_load_dwordx4 v25, s[44:47], s13 offen sc1 lds
    ds_read_b128 v[212:215], v241 offset:32
    v_mfma_f32_16x16x32_bf16 v[52:55], v[64:67], v[116:119], v[52:55]
    ds_read2_b32 v[148:149], v238 offset0:208 offset1:209
    v_mfma_f32_16x16x32_bf16 v[56:59], v[64:67], v[120:123], v[56:59]
    ds_read_b32 v216, v241 offset:48
    v_mfma_f32_16x16x32_bf16 v[56:59], v[68:71], v[116:119], v[56:59]
    ds_read2_b32 v[150:151], v238 offset0:210 offset1:211
    v_mfma_f32_16x16x32_bf16 v[56:59], v[72:75], v[112:115], v[56:59]
    ds_read_b128 v[218:221], v241 offset:1056
    v_mfma_f32_16x16x32_bf16 v[56:59], v[76:79], v[108:111], v[56:59]
    ds_read_b128 v[184:187], v245 offset:24576
    v_mfma_f32_16x16x32_bf16 v[56:59], v[80:83], v[104:107], v[56:59]
    ds_read2_b32 v[152:153], v239 offset0:80 offset1:81
    s_add_u32 m0, s9, 43008
    s_add_u32 s13, s7, 442496
    v_mfma_f32_16x16x32_bf16 v[56:59], v[84:87], v[100:103], v[56:59]
    buffer_load_dwordx4 v24, s[44:47], s13 offen sc1 lds
    ds_read_b32 v222, v241 offset:1072
    v_mfma_f32_16x16x32_bf16 v[56:59], v[88:91], v[96:99], v[56:59]
    ds_read2_b32 v[154:155], v239 offset0:82 offset1:83
    v_mfma_f32_16x16x32_bf16 v[60:63], v[92:95], v[96:99], v[60:63]
    s_add_u32 m0, s73, 147456
    ds_read_b128 v[224:227], v241 offset:2080
    v_mfma_f32_16x16x32_bf16 v[60:63], v[88:91], v[100:103], v[60:63]
    buffer_load_dwordx4 v6, s[52:55], s14 offen offset:2048 lds
    ds_read_b128 v[188:191], v245 offset:28672
    v_mfma_f32_16x16x32_bf16 v[60:63], v[84:87], v[104:107], v[60:63]
    ds_read_b32 v228, v241 offset:2096
    v_mfma_f32_16x16x32_bf16 v[60:63], v[80:83], v[108:111], v[60:63]
    ds_read2_b32 v[156:157], v239 offset0:208 offset1:209
    v_mfma_f32_16x16x32_bf16 v[60:63], v[76:79], v[112:115], v[60:63]
    ds_read_b128 v[230:233], v241 offset:3104
    v_mfma_f32_16x16x32_bf16 v[60:63], v[72:75], v[116:119], v[60:63]
    ds_read2_b32 v[158:159], v239 offset0:210 offset1:211
    v_mfma_f32_16x16x32_bf16 v[60:63], v[68:71], v[120:123], v[60:63]
    ds_read_b32 v234, v241 offset:3120
    s_add_u32 m0, s9, 44032
    s_add_u32 s13, s7, 516224
    v_mfma_f32_16x16x32_bf16 v[60:63], v[64:67], v[124:127], v[60:63]
    buffer_load_dwordx4 v25, s[44:47], s13 offen sc1 lds
    s_waitcnt lgkmcnt(15)
    v_mfma_f32_16x16x32_bf16 v[32:35], v[128:131], v[160:163], v[32:35]
    ds_read_b128 v[96:99], v246 offset:0
    v_mfma_f32_16x16x32_bf16 v[36:39], v[132:135], v[160:163], v[36:39]
    v_mfma_f32_16x16x32_bf16 v[36:39], v[128:131], v[164:167], v[36:39]
    ds_read2_b32 v[64:65], v236 offset0:96 offset1:97
    v_mfma_f32_16x16x32_bf16 v[40:43], v[128:131], v[168:171], v[40:43]
    s_add_u32 m0, s73, 147456
    ds_read2_b32 v[66:67], v236 offset0:98 offset1:99
    v_mfma_f32_16x16x32_bf16 v[40:43], v[132:135], v[164:167], v[40:43]
    buffer_load_dwordx4 v7, s[52:55], s14 offen offset:3072 lds
    s_waitcnt lgkmcnt(3)
    v_mfma_f32_16x16x32_bf16 v[40:43], v[136:139], v[160:163], v[40:43]
    ds_read_b128 v[100:103], v246 offset:4096
    v_mfma_f32_16x16x32_bf16 v[44:47], v[140:143], v[160:163], v[44:47]
    s_waitcnt vmcnt(12)
    ds_read2_b32 v[68:69], v236 offset0:224 offset1:225
    v_mfma_f32_16x16x32_bf16 v[44:47], v[136:139], v[164:167], v[44:47]
    v_mfma_f32_16x16x32_bf16 v[44:47], v[132:135], v[168:171], v[44:47]
    ds_read2_b32 v[70:71], v236 offset0:226 offset1:227
    v_lshlrev_b32 v9, 16, v9
    v_mfma_f32_16x16x32_bf16 v[44:47], v[128:131], v[172:175], v[44:47]
    ds_read_b128 v[104:107], v246 offset:8192
    v_mfma_f32_16x16x32_bf16 v[48:51], v[128:131], v[176:179], v[48:51]
    ds_read2_b32 v[72:73], v237 offset0:96 offset1:97
    v_lshlrev_b32 v208, 16, v212
    v_mfma_f32_16x16x32_bf16 v[48:51], v[132:135], v[172:175], v[48:51]
    v_mfma_f32_16x16x32_bf16 v[48:51], v[136:139], v[168:171], v[48:51]
    ds_read2_b32 v[74:75], v237 offset0:98 offset1:99
    v_add_f32 v9, v9, v208
    v_mfma_f32_16x16x32_bf16 v[48:51], v[140:143], v[164:167], v[48:51]
    ds_read_b128 v[108:111], v246 offset:12288
    v_cvt_pk_bf16_f32 v9, v9, v9
    v_mfma_f32_16x16x32_bf16 v[48:51], v[144:147], v[160:163], v[48:51]
    ds_read2_b32 v[76:77], v237 offset0:224 offset1:225
    v_mfma_f32_16x16x32_bf16 v[52:55], v[148:151], v[160:163], v[52:55]
    ds_write_b16 v242, v9 offset:4160
    v_mfma_f32_16x16x32_bf16 v[52:55], v[144:147], v[164:167], v[52:55]
    ds_read2_b32 v[78:79], v237 offset0:226 offset1:227
    v_mfma_f32_16x16x32_bf16 v[52:55], v[140:143], v[168:171], v[52:55]
    ds_write_b16 v242, v9 offset:2
    v_mfma_f32_16x16x32_bf16 v[52:55], v[136:139], v[172:175], v[52:55]
    ds_read_b128 v[112:115], v246 offset:16384
    v_mfma_f32_16x16x32_bf16 v[52:55], v[132:135], v[176:179], v[52:55]
    ds_read2_b32 v[80:81], v238 offset0:96 offset1:97
    v_alignbit_b32 v212, v213, v212, 16
    v_mfma_f32_16x16x32_bf16 v[52:55], v[128:131], v[180:183], v[52:55]
    v_alignbit_b32 v213, v214, v213, 16
    v_mfma_f32_16x16x32_bf16 v[56:59], v[128:131], v[184:187], v[56:59]
    ds_read2_b32 v[82:83], v238 offset0:98 offset1:99
    v_mfma_f32_16x16x32_bf16 v[56:59], v[132:135], v[180:183], v[56:59]
    ds_read_b128 v[116:119], v246 offset:20480
    v_alignbit_b32 v214, v215, v214, 16
    v_mfma_f32_16x16x32_bf16 v[56:59], v[136:139], v[176:179], v[56:59]
    v_mfma_f32_16x16x32_bf16 v[56:59], v[140:143], v[172:175], v[56:59]
    ds_read2_b32 v[84:85], v238 offset0:224 offset1:225
    v_alignbit_b32 v215, v216, v215, 16
    v_mfma_f32_16x16x32_bf16 v[56:59], v[144:147], v[168:171], v[56:59]
    ds_read2_b32 v[86:87], v238 offset0:226 offset1:227
    v_mfma_f32_16x16x32_bf16 v[56:59], v[148:151], v[164:167], v[56:59]
    ds_write_b128 v241, v[212:215] offset:4192
    v_mfma_f32_16x16x32_bf16 v[56:59], v[152:155], v[160:163], v[56:59]
    ds_read_b128 v[120:123], v246 offset:24576
    v_mfma_f32_16x16x32_bf16 v[60:63], v[156:159], v[160:163], v[60:63]
    ds_read2_b32 v[88:89], v239 offset0:96 offset1:97
    v_alignbit_b32 v218, v219, v218, 16
    v_mfma_f32_16x16x32_bf16 v[60:63], v[152:155], v[164:167], v[60:63]
    ds_read2_b32 v[90:91], v239 offset0:98 offset1:99
    v_alignbit_b32 v219, v220, v219, 16
    v_mfma_f32_16x16x32_bf16 v[60:63], v[148:151], v[168:171], v[60:63]
    v_mfma_f32_16x16x32_bf16 v[60:63], v[144:147], v[172:175], v[60:63]
    ds_read_b128 v[124:127], v246 offset:28672
    v_alignbit_b32 v220, v221, v220, 16
    v_mfma_f32_16x16x32_bf16 v[60:63], v[140:143], v[176:179], v[60:63]
    ds_read2_b32 v[92:93], v239 offset0:224 offset1:225
    v_mfma_f32_16x16x32_bf16 v[60:63], v[136:139], v[180:183], v[60:63]
    ds_read2_b32 v[94:95], v239 offset0:226 offset1:227
    v_alignbit_b32 v221, v222, v221, 16
    v_mfma_f32_16x16x32_bf16 v[60:63], v[132:135], v[184:187], v[60:63]
    ds_write_b128 v241, v[218:221] offset:5216
    v_mfma_f32_16x16x32_bf16 v[60:63], v[128:131], v[188:191], v[60:63]
    s_waitcnt lgkmcnt(15)
    v_mfma_f32_16x16x32_bf16 v[32:35], v[64:67], v[96:99], v[32:35]
    ds_read_b128 v[160:163], v247 offset:0
    v_mfma_f32_16x16x32_bf16 v[36:39], v[68:71], v[96:99], v[36:39]
    v_alignbit_b32 v224, v225, v224, 16
    v_mfma_f32_16x16x32_bf16 v[36:39], v[64:67], v[100:103], v[36:39]
    ds_read_b128 v[164:167], v247 offset:4096
    v_mfma_f32_16x16x32_bf16 v[40:43], v[64:67], v[104:107], v[40:43]
    ds_read_b128 v[168:171], v247 offset:8192
    v_mfma_f32_16x16x32_bf16 v[40:43], v[68:71], v[100:103], v[40:43]
    ds_read_b128 v[172:175], v247 offset:12288
    v_mfma_f32_16x16x32_bf16 v[40:43], v[72:75], v[96:99], v[40:43]
    v_alignbit_b32 v225, v226, v225, 16
    v_mfma_f32_16x16x32_bf16 v[44:47], v[76:79], v[96:99], v[44:47]
    ds_read_b128 v[176:179], v247 offset:16384
    v_mfma_f32_16x16x32_bf16 v[44:47], v[72:75], v[100:103], v[44:47]
    ds_read_b128 v[180:183], v247 offset:20480
    v_mfma_f32_16x16x32_bf16 v[44:47], v[68:71], v[104:107], v[44:47]
    ds_read_b128 v[184:187], v247 offset:24576
    v_mfma_f32_16x16x32_bf16 v[44:47], v[64:67], v[108:111], v[44:47]
    v_alignbit_b32 v226, v227, v226, 16
    s_waitcnt lgkmcnt(8)
    v_mfma_f32_16x16x32_bf16 v[48:51], v[64:67], v[112:115], v[48:51]
    ds_read_b128 v[188:191], v247 offset:28672
    v_mfma_f32_16x16x32_bf16 v[48:51], v[68:71], v[108:111], v[48:51]
    ds_read2_b32 v[128:129], v236 offset0:112 offset1:113
    v_mfma_f32_16x16x32_bf16 v[48:51], v[72:75], v[104:107], v[48:51]
    v_alignbit_b32 v227, v228, v227, 16
    v_mfma_f32_16x16x32_bf16 v[48:51], v[76:79], v[100:103], v[48:51]
    ds_read2_b32 v[130:131], v236 offset0:114 offset1:115
    v_mfma_f32_16x16x32_bf16 v[48:51], v[80:83], v[96:99], v[48:51]
    ds_read2_b32 v[132:133], v236 offset0:240 offset1:241
    v_mfma_f32_16x16x32_bf16 v[52:55], v[84:87], v[96:99], v[52:55]
    ds_read2_b32 v[134:135], v236 offset0:242 offset1:243
    v_mfma_f32_16x16x32_bf16 v[52:55], v[80:83], v[100:103], v[52:55]
    ds_write_b128 v241, v[224:227] offset:6240
    v_mfma_f32_16x16x32_bf16 v[52:55], v[76:79], v[104:107], v[52:55]
    ds_read2_b32 v[136:137], v237 offset0:112 offset1:113
    ds_read2_b32 v[138:139], v237 offset0:114 offset1:115
    v_mfma_f32_16x16x32_bf16 v[52:55], v[72:75], v[108:111], v[52:55]
    s_add_u32 s6, s12, 4734976
    ds_read2_b32 v[140:141], v237 offset0:240 offset1:241
    v_mfma_f32_16x16x32_bf16 v[52:55], v[68:71], v[112:115], v[52:55]
    ds_read2_b32 v[142:143], v237 offset0:242 offset1:243
    v_alignbit_b32 v230, v231, v230, 16
    v_xor_b32 v244, 64, v244
    v_mfma_f32_16x16x32_bf16 v[52:55], v[64:67], v[116:119], v[52:55]
    ds_read2_b32 v[144:145], v238 offset0:112 offset1:113
    v_mfma_f32_16x16x32_bf16 v[56:59], v[64:67], v[120:123], v[56:59]
    ds_read2_b32 v[146:147], v238 offset0:114 offset1:115
    v_xor_b32 v245, 64, v245
    v_mfma_f32_16x16x32_bf16 v[56:59], v[68:71], v[116:119], v[56:59]
    ds_read2_b32 v[148:149], v238 offset0:240 offset1:241
    v_mfma_f32_16x16x32_bf16 v[56:59], v[72:75], v[112:115], v[56:59]
    v_alignbit_b32 v231, v232, v231, 16
    v_xor_b32 v246, 64, v246
    v_mfma_f32_16x16x32_bf16 v[56:59], v[76:79], v[108:111], v[56:59]
    ds_read2_b32 v[150:151], v238 offset0:242 offset1:243
    v_mfma_f32_16x16x32_bf16 v[56:59], v[80:83], v[104:107], v[56:59]
    ds_read2_b32 v[152:153], v239 offset0:112 offset1:113
    v_xor_b32 v247, 64, v247
    v_mfma_f32_16x16x32_bf16 v[56:59], v[84:87], v[100:103], v[56:59]
    ds_read2_b32 v[154:155], v239 offset0:114 offset1:115
    v_mfma_f32_16x16x32_bf16 v[56:59], v[88:91], v[96:99], v[56:59]
    ds_read2_b32 v[156:157], v239 offset0:240 offset1:241
    v_alignbit_b32 v232, v233, v232, 16
    v_mfma_f32_16x16x32_bf16 v[60:63], v[92:95], v[96:99], v[60:63]
    ds_read2_b32 v[158:159], v239 offset0:242 offset1:243
    v_add_u32 v244, 36864, v244
    v_mfma_f32_16x16x32_bf16 v[60:63], v[88:91], v[100:103], v[60:63]
    v_add_u32 v236, -8320, v236
    v_mfma_f32_16x16x32_bf16 v[60:63], v[84:87], v[104:107], v[60:63]
    v_alignbit_b32 v233, v234, v233, 16
    v_add_u32 v245, 36864, v245
    v_mfma_f32_16x16x32_bf16 v[60:63], v[80:83], v[108:111], v[60:63]
    v_add_u32 v237, -8320, v237
    v_mfma_f32_16x16x32_bf16 v[60:63], v[76:79], v[112:115], v[60:63]
    s_waitcnt vmcnt(1)
    s_barrier
    v_add_u32 v246, 36864, v246
    v_mfma_f32_16x16x32_bf16 v[60:63], v[72:75], v[116:119], v[60:63]
    v_add_u32 v238, -8320, v238
    v_add_u32 v239, -8320, v239
    v_mfma_f32_16x16x32_bf16 v[60:63], v[68:71], v[120:123], v[60:63]
    ds_write_b128 v241, v[230:233] offset:7264
    v_mfma_f32_16x16x32_bf16 v[60:63], v[64:67], v[124:127], v[60:63]
    v_add_u32 v247, 36864, v247
    s_waitcnt lgkmcnt(1)
    v_mfma_f32_16x16x32_bf16 v[60:63], v[128:131], v[188:191], v[60:63]
    ds_read_b128 v[96:99], v244 offset:2048
    v_mfma_f32_16x16x32_bf16 v[60:63], v[132:135], v[184:187], v[60:63]
    ds_read2_b32 v[64:65], v236 offset0:0 offset1:1
    v_mfma_f32_16x16x32_bf16 v[60:63], v[136:139], v[180:183], v[60:63]
    ds_read2_b32 v[66:67], v236 offset0:2 offset1:3
    v_mfma_f32_16x16x32_bf16 v[60:63], v[140:143], v[176:179], v[60:63]
    ds_read_b128 v[100:103], v244 offset:6144
    v_mfma_f32_16x16x32_bf16 v[60:63], v[144:147], v[172:175], v[60:63]
    ds_read2_b32 v[68:69], v236 offset0:128 offset1:129
    v_mfma_f32_16x16x32_bf16 v[60:63], v[148:151], v[168:171], v[60:63]
    ds_read2_b32 v[70:71], v236 offset0:130 offset1:131
    v_mfma_f32_16x16x32_bf16 v[60:63], v[152:155], v[164:167], v[60:63]
    ds_read_b128 v[104:107], v244 offset:10240
    v_mfma_f32_16x16x32_bf16 v[60:63], v[156:159], v[160:163], v[60:63]
    ds_read2_b32 v[72:73], v237 offset0:0 offset1:1
    v_mfma_f32_16x16x32_bf16 v[56:59], v[128:131], v[184:187], v[56:59]
    ds_read2_b32 v[74:75], v237 offset0:2 offset1:3
    v_mfma_f32_16x16x32_bf16 v[56:59], v[132:135], v[180:183], v[56:59]
    ds_read_b128 v[108:111], v244 offset:14336
    v_mfma_f32_16x16x32_bf16 v[56:59], v[136:139], v[176:179], v[56:59]
    ds_read2_b32 v[76:77], v237 offset0:128 offset1:129
    v_mfma_f32_16x16x32_bf16 v[56:59], v[140:143], v[172:175], v[56:59]
    ds_read2_b32 v[78:79], v237 offset0:130 offset1:131
    v_mfma_f32_16x16x32_bf16 v[56:59], v[144:147], v[168:171], v[56:59]
    ds_read_b128 v[112:115], v244 offset:18432
    v_mfma_f32_16x16x32_bf16 v[56:59], v[148:151], v[164:167], v[56:59]
    ds_read2_b32 v[80:81], v238 offset0:0 offset1:1
    v_cvt_pk_bf16_f32 v206, v60, v61
    v_mfma_f32_16x16x32_bf16 v[56:59], v[152:155], v[160:163], v[56:59]
    ds_read2_b32 v[82:83], v238 offset0:2 offset1:3
    v_mfma_f32_16x16x32_bf16 v[52:55], v[128:131], v[180:183], v[52:55]
    ds_read_b128 v[116:119], v244 offset:22528
    v_mfma_f32_16x16x32_bf16 v[52:55], v[132:135], v[176:179], v[52:55]
    ds_read2_b32 v[84:85], v238 offset0:128 offset1:129
    v_cvt_pk_bf16_f32 v207, v62, v63
    v_mfma_f32_16x16x32_bf16 v[52:55], v[136:139], v[172:175], v[52:55]
    ds_read2_b32 v[86:87], v238 offset0:130 offset1:131
    v_mfma_f32_16x16x32_bf16 v[52:55], v[140:143], v[168:171], v[52:55]
    buffer_store_dwordx2 v[206:207], v8, s[44:47], s6 offen offset:3584 sc1
    ds_read_b128 v[120:123], v244 offset:26624
    v_mfma_f32_16x16x32_bf16 v[52:55], v[144:147], v[164:167], v[52:55]
    ds_read2_b32 v[88:89], v239 offset0:0 offset1:1
    v_mfma_f32_16x16x32_bf16 v[52:55], v[148:151], v[160:163], v[52:55]
    ds_read2_b32 v[90:91], v239 offset0:2 offset1:3
    v_mfma_f32_16x16x32_bf16 v[48:51], v[128:131], v[176:179], v[48:51]
    s_waitcnt vmcnt(1)
    s_barrier
    v_cvt_pk_bf16_f32 v204, v56, v57
    v_mfma_f32_16x16x32_bf16 v[48:51], v[132:135], v[172:175], v[48:51]
    ds_read_b128 v[124:127], v244 offset:30720
    v_mfma_f32_16x16x32_bf16 v[48:51], v[136:139], v[168:171], v[48:51]
    ds_read_b64_tr_b16 a[80:81], v10 offset:16384
    v_mfma_f32_16x16x32_bf16 v[48:51], v[140:143], v[164:167], v[48:51]
    ds_read_b64_tr_b16 a[82:83], v10 offset:18432
    v_cvt_pk_bf16_f32 v205, v58, v59
    v_mfma_f32_16x16x32_bf16 v[48:51], v[144:147], v[160:163], v[48:51]
    ds_read_b64_tr_b16 a[88:89], v10 offset:20480
    v_mfma_f32_16x16x32_bf16 v[44:47], v[128:131], v[172:175], v[44:47]
    buffer_store_dwordx2 v[204:205], v8, s[44:47], s6 offen offset:3072 sc1
    ds_read2_b32 v[92:93], v239 offset0:128 offset1:129
    v_mfma_f32_16x16x32_bf16 v[44:47], v[132:135], v[168:171], v[44:47]
    ds_read_b64_tr_b16 a[90:91], v10 offset:22528
    v_mfma_f32_16x16x32_bf16 v[44:47], v[136:139], v[164:167], v[44:47]
    ds_read_b64_tr_b16 a[84:85], v11 offset:16384
    ds_read2_b32 v[94:95], v239 offset0:130 offset1:131
    v_mfma_f32_16x16x32_bf16 v[44:47], v[140:143], v[160:163], v[44:47]
    v_cvt_pk_bf16_f32 v202, v52, v53
    v_mfma_f32_16x16x32_bf16 v[40:43], v[128:131], v[168:171], v[40:43]
    ds_read_b64_tr_b16 a[86:87], v11 offset:18432
    v_mfma_f32_16x16x32_bf16 v[40:43], v[132:135], v[164:167], v[40:43]
    ds_read_b64_tr_b16 a[92:93], v11 offset:20480
    v_mfma_f32_16x16x32_bf16 v[40:43], v[136:139], v[160:163], v[40:43]
    v_cvt_pk_bf16_f32 v203, v54, v55
    v_mfma_f32_16x16x32_bf16 v[36:39], v[128:131], v[164:167], v[36:39]
    ds_read_b64_tr_b16 a[94:95], v11 offset:22528
    v_mfma_f32_16x16x32_bf16 v[36:39], v[132:135], v[160:163], v[36:39]
    buffer_store_dwordx2 v[202:203], v8, s[44:47], s6 offen offset:2560 sc1
    v_mfma_f32_16x16x32_bf16 v[32:35], v[128:131], v[160:163], v[32:35]
    s_waitcnt lgkmcnt(3)
    v_mfma_f32_16x16x32_bf16 v[60:63], v[64:67], v[124:127], 0
    ds_read_b128 v[160:163], v245 offset:2048
    s_waitcnt lgkmcnt(1)
    s_barrier
    v_mfma_f32_16x16x32_bf16 v[60:63], v[68:71], v[120:123], v[60:63]
    v_cvt_pk_bf16_f32 v200, v48, v49
    v_mfma_f32_16x16x32_bf16 v[60:63], v[72:75], v[116:119], v[60:63]
    ds_read2_b32 v[128:129], v236 offset0:16 offset1:17
    v_mfma_f32_16x16x32_bf16 v[60:63], v[76:79], v[112:115], v[60:63]
    ds_read2_b32 v[130:131], v236 offset0:18 offset1:19
    s_lshl_b32 s14, s90, 18
    v_cvt_pk_bf16_f32 v201, v50, v51
    v_mfma_f32_16x16x32_bf16 v[60:63], v[80:83], v[108:111], v[60:63]
    s_add_u32 m0, s73, 147456
    v_mfma_f32_16x16x32_bf16 v[60:63], v[84:87], v[104:107], v[60:63]
    buffer_load_dwordx4 v4, s[52:55], s14 offen offset:0 lds
    ds_read_b128 v[164:167], v245 offset:6144
    v_mfma_f32_16x16x32_bf16 v[60:63], v[88:91], v[100:103], v[60:63]
    buffer_store_dwordx2 v[200:201], v8, s[44:47], s6 offen offset:2048 sc1
    ds_read2_b32 v[132:133], v236 offset0:144 offset1:145
    v_mfma_f32_16x16x32_bf16 v[60:63], v[92:95], v[96:99], v[60:63]
    s_add_u32 s13, s12, 49152
    v_cvt_pk_bf16_f32 v198, v44, v45
    v_mfma_f32_16x16x32_bf16 v[56:59], v[64:67], v[120:123], 0
    ds_read2_b32 v[134:135], v236 offset0:146 offset1:147
    v_mfma_f32_16x16x32_bf16 v[56:59], v[68:71], v[116:119], v[56:59]
    s_add_u32 m0, s74, 8352
    ds_read_b128 v[168:171], v245 offset:10240
    v_mfma_f32_16x16x32_bf16 v[56:59], v[72:75], v[112:115], v[56:59]
    buffer_load_dwordx4 v240, s[48:51], s13 offen offset:0 lds
    v_cvt_pk_bf16_f32 v199, v46, v47
    v_mfma_f32_16x16x32_bf16 v[56:59], v[76:79], v[108:111], v[56:59]
    ds_read2_b32 v[136:137], v237 offset0:16 offset1:17
    v_mfma_f32_16x16x32_bf16 v[56:59], v[80:83], v[104:107], v[56:59]
    buffer_store_dwordx2 v[198:199], v8, s[44:47], s6 offen offset:1536 sc1
    ds_read2_b32 v[138:139], v237 offset0:18 offset1:19
    v_mfma_f32_16x16x32_bf16 v[56:59], v[84:87], v[100:103], v[56:59]
    ds_read_b128 v[172:175], v245 offset:14336
    v_mfma_f32_16x16x32_bf16 v[56:59], v[88:91], v[96:99], v[56:59]
    v_cvt_pk_bf16_f32 v196, v40, v41
    v_mfma_f32_16x16x32_bf16 v[52:55], v[64:67], v[116:119], 0
    ds_read2_b32 v[140:141], v237 offset0:144 offset1:145
    v_mfma_f32_16x16x32_bf16 v[52:55], v[68:71], v[112:115], v[52:55]
    ds_read2_b32 v[142:143], v237 offset0:146 offset1:147
    s_add_u32 m0, s73, 147456
    v_cvt_pk_bf16_f32 v197, v42, v43
    v_mfma_f32_16x16x32_bf16 v[52:55], v[72:75], v[108:111], v[52:55]
    buffer_load_dwordx4 v5, s[52:55], s14 offen offset:1024 lds
    v_mfma_f32_16x16x32_bf16 v[52:55], v[76:79], v[104:107], v[52:55]
    buffer_store_dwordx2 v[196:197], v8, s[44:47], s6 offen offset:1024 sc1
    ds_read_b128 v[176:179], v245 offset:18432
    s_add_u32 m0, s74, 8352
    v_mfma_f32_16x16x32_bf16 v[52:55], v[80:83], v[100:103], v[52:55]
    buffer_load_dwordx4 v240, s[48:51], s13 offen offset:1024 lds
    ds_read2_b32 v[144:145], v238 offset0:16 offset1:17
    v_mfma_f32_16x16x32_bf16 v[52:55], v[84:87], v[96:99], v[52:55]
    v_mfma_f32_16x16x32_bf16 v[48:51], v[64:67], v[112:115], 0
    ds_read2_b32 v[146:147], v238 offset0:18 offset1:19
    v_cvt_pk_bf16_f32 v194, v36, v37
    v_mfma_f32_16x16x32_bf16 v[48:51], v[68:71], v[108:111], v[48:51]
    ds_read_b128 v[180:183], v245 offset:22528
    v_mfma_f32_16x16x32_bf16 v[48:51], v[72:75], v[104:107], v[48:51]
    v_cvt_pk_bf16_f32 v195, v38, v39
    v_mfma_f32_16x16x32_bf16 v[48:51], v[76:79], v[100:103], v[48:51]
    buffer_store_dwordx2 v[194:195], v8, s[44:47], s6 offen offset:512 sc1
    ds_read2_b32 v[148:149], v238 offset0:144 offset1:145
    s_add_u32 m0, s74, 8352
    v_mfma_f32_16x16x32_bf16 v[48:51], v[80:83], v[96:99], v[48:51]
    buffer_load_dwordx4 v240, s[48:51], s13 offen offset:2048 lds
    ds_read2_b32 v[150:151], v238 offset0:146 offset1:147
    v_mfma_f32_16x16x32_bf16 v[44:47], v[64:67], v[108:111], 0
    ds_read_b128 v[184:187], v245 offset:26624
    v_mfma_f32_16x16x32_bf16 v[44:47], v[68:71], v[104:107], v[44:47]
    v_cvt_pk_bf16_f32 v192, v32, v33
    v_mfma_f32_16x16x32_bf16 v[44:47], v[72:75], v[100:103], v[44:47]
    s_add_u32 m0, s73, 147456
    ds_read2_b32 v[152:153], v239 offset0:16 offset1:17
    v_mfma_f32_16x16x32_bf16 v[44:47], v[76:79], v[96:99], v[44:47]
    buffer_load_dwordx4 v6, s[52:55], s14 offen offset:2048 lds
    v_cvt_pk_bf16_f32 v193, v34, v35
    v_mfma_f32_16x16x32_bf16 v[40:43], v[64:67], v[104:107], 0
    ds_read2_b32 v[154:155], v239 offset0:18 offset1:19
    v_mfma_f32_16x16x32_bf16 v[40:43], v[68:71], v[100:103], v[40:43]
    buffer_store_dwordx2 v[192:193], v8, s[44:47], s6 offen offset:0 sc1
    ds_read_b128 v[188:191], v245 offset:30720
    v_mfma_f32_16x16x32_bf16 v[40:43], v[72:75], v[96:99], v[40:43]
    s_add_u32 m0, s74, 8352
    ds_read2_b32 v[156:157], v239 offset0:144 offset1:145
    v_mfma_f32_16x16x32_bf16 v[36:39], v[64:67], v[100:103], 0
    buffer_load_dwordx4 v240, s[48:51], s13 offen offset:3072 lds
    v_mfma_f32_16x16x32_bf16 v[36:39], v[68:71], v[96:99], v[36:39]
    ds_read2_b32 v[158:159], v239 offset0:146 offset1:147
    v_mfma_f32_16x16x32_bf16 v[32:35], v[64:67], v[96:99], 0
    s_waitcnt lgkmcnt(12)
    v_mfma_f32_16x16x32_bf16 v[32:35], v[128:131], v[160:163], v[32:35]
    ds_read_b128 v[96:99], v246 offset:2048
    v_mfma_f32_16x16x32_bf16 v[36:39], v[132:135], v[160:163], v[36:39]
    v_mfma_f32_16x16x32_bf16 v[36:39], v[128:131], v[164:167], v[36:39]
    ds_read2_b32 v[64:65], v236 offset0:32 offset1:33
    v_mfma_f32_16x16x32_bf16 v[40:43], v[128:131], v[168:171], v[40:43]
    s_barrier
    ds_read2_b32 v[66:67], v236 offset0:34 offset1:35
    s_add_u32 m0, s73, 147456
    v_mfma_f32_16x16x32_bf16 v[40:43], v[132:135], v[164:167], v[40:43]
    buffer_load_dwordx4 v7, s[52:55], s14 offen offset:3072 lds
    v_mfma_f32_16x16x32_bf16 v[40:43], v[136:139], v[160:163], v[40:43]
    ds_read_b128 v[100:103], v246 offset:6144
    v_mfma_f32_16x16x32_bf16 v[44:47], v[140:143], v[160:163], v[44:47]
    ds_read2_b32 v[68:69], v236 offset0:160 offset1:161
    v_mfma_f32_16x16x32_bf16 v[44:47], v[136:139], v[164:167], v[44:47]
    v_mfma_f32_16x16x32_bf16 v[44:47], v[132:135], v[168:171], v[44:47]
    ds_read2_b32 v[70:71], v236 offset0:162 offset1:163
    v_mfma_f32_16x16x32_bf16 v[44:47], v[128:131], v[172:175], v[44:47]
    ds_read_b128 v[104:107], v246 offset:10240
    s_waitcnt lgkmcnt(7)
    v_mfma_f32_16x16x32_bf16 v[48:51], v[128:131], v[176:179], v[48:51]
    ds_read2_b32 v[72:73], v237 offset0:32 offset1:33
    v_mfma_f32_16x16x32_bf16 v[48:51], v[132:135], v[172:175], v[48:51]
    ds_read2_b32 v[74:75], v237 offset0:34 offset1:35
    v_mfma_f32_16x16x32_bf16 v[48:51], v[136:139], v[168:171], v[48:51]
    v_mov_b32 v9, 24
    buffer_load_ushort v9, v9, s[56:59], s70 offen
    v_mfma_f32_16x16x32_bf16 v[48:51], v[140:143], v[164:167], v[48:51]
    ds_read_b128 v[108:111], v246 offset:14336
    v_mfma_f32_16x16x32_bf16 v[48:51], v[144:147], v[160:163], v[48:51]
    v_mfma_f32_16x16x32_bf16 v[52:55], v[148:151], v[160:163], v[52:55]
    ds_read2_b32 v[76:77], v237 offset0:160 offset1:161
    v_mfma_f32_16x16x32_bf16 v[52:55], v[144:147], v[164:167], v[52:55]
    ds_read2_b32 v[78:79], v237 offset0:162 offset1:163
    v_mfma_f32_16x16x32_bf16 v[52:55], v[140:143], v[168:171], v[52:55]
    v_mfma_f32_16x16x32_bf16 v[52:55], v[136:139], v[172:175], v[52:55]
    s_lshl_b32 s14, s91, 18
    ds_read_b128 v[112:115], v246 offset:18432
    v_mfma_f32_16x16x32_bf16 v[52:55], v[132:135], v[176:179], v[52:55]
    s_add_u32 m0, s73, 0
    ds_read2_b32 v[80:81], v238 offset0:32 offset1:33
    v_mfma_f32_16x16x32_bf16 v[52:55], v[128:131], v[180:183], v[52:55]
    buffer_load_dwordx4 v4, s[52:55], s14 offen offset:0 lds
    v_mfma_f32_16x16x32_bf16 v[56:59], v[128:131], v[184:187], v[56:59]
    ds_read2_b32 v[82:83], v238 offset0:34 offset1:35
    v_mfma_f32_16x16x32_bf16 v[56:59], v[132:135], v[180:183], v[56:59]
    ds_read_b128 v[116:119], v246 offset:22528
    v_mfma_f32_16x16x32_bf16 v[56:59], v[136:139], v[176:179], v[56:59]
    v_mfma_f32_16x16x32_bf16 v[56:59], v[140:143], v[172:175], v[56:59]
    ds_read2_b32 v[84:85], v238 offset0:160 offset1:161
    v_mfma_f32_16x16x32_bf16 v[56:59], v[144:147], v[168:171], v[56:59]
    ds_read2_b32 v[86:87], v238 offset0:162 offset1:163
    v_mfma_f32_16x16x32_bf16 v[56:59], v[148:151], v[164:167], v[56:59]
    ds_read_b128 v[120:123], v246 offset:26624
    v_mfma_f32_16x16x32_bf16 v[56:59], v[152:155], v[160:163], v[56:59]
    v_mfma_f32_16x16x32_bf16 v[60:63], v[156:159], v[160:163], v[60:63]
    ds_read2_b32 v[88:89], v239 offset0:32 offset1:33
    v_mfma_f32_16x16x32_bf16 v[60:63], v[152:155], v[164:167], v[60:63]
    ds_read2_b32 v[90:91], v239 offset0:34 offset1:35
    v_mfma_f32_16x16x32_bf16 v[60:63], v[148:151], v[168:171], v[60:63]
    s_add_u32 m0, s73, 0
    v_mfma_f32_16x16x32_bf16 v[60:63], v[144:147], v[172:175], v[60:63]
    buffer_load_dwordx4 v5, s[52:55], s14 offen offset:1024 lds
    ds_read_b128 v[124:127], v246 offset:30720
    v_mfma_f32_16x16x32_bf16 v[60:63], v[140:143], v[176:179], v[60:63]
    ds_read2_b32 v[92:93], v239 offset0:160 offset1:161
    v_mfma_f32_16x16x32_bf16 v[60:63], v[136:139], v[180:183], v[60:63]
    v_mfma_f32_16x16x32_bf16 v[60:63], v[132:135], v[184:187], v[60:63]
    ds_read2_b32 v[94:95], v239 offset0:162 offset1:163
    v_mfma_f32_16x16x32_bf16 v[60:63], v[128:131], v[188:191], v[60:63]
    s_waitcnt lgkmcnt(12)
    v_mfma_f32_16x16x32_bf16 v[32:35], v[64:67], v[96:99], v[32:35]
    ds_read_b128 v[160:163], v247 offset:2048
    v_mfma_f32_16x16x32_bf16 v[36:39], v[68:71], v[96:99], v[36:39]
    v_mfma_f32_16x16x32_bf16 v[36:39], v[64:67], v[100:103], v[36:39]
    ds_read2_b32 v[128:129], v236 offset0:48 offset1:49
    v_mfma_f32_16x16x32_bf16 v[40:43], v[64:67], v[104:107], v[40:43]
    ds_read2_b32 v[130:131], v236 offset0:50 offset1:51
    v_mfma_f32_16x16x32_bf16 v[40:43], v[68:71], v[100:103], v[40:43]
    v_mfma_f32_16x16x32_bf16 v[40:43], v[72:75], v[96:99], v[40:43]
    ds_read_b128 v[164:167], v247 offset:6144
    v_mfma_f32_16x16x32_bf16 v[44:47], v[76:79], v[96:99], v[44:47]
    s_add_u32 m0, s73, 0
    ds_read2_b32 v[132:133], v236 offset0:176 offset1:177
    v_mfma_f32_16x16x32_bf16 v[44:47], v[72:75], v[100:103], v[44:47]
    buffer_load_dwordx4 v6, s[52:55], s14 offen offset:2048 lds
    v_mfma_f32_16x16x32_bf16 v[44:47], v[68:71], v[104:107], v[44:47]
    ds_read2_b32 v[134:135], v236 offset0:178 offset1:179
    v_mfma_f32_16x16x32_bf16 v[44:47], v[64:67], v[108:111], v[44:47]
    ds_read_b128 v[168:171], v247 offset:10240
    s_waitcnt lgkmcnt(7)
    v_mfma_f32_16x16x32_bf16 v[48:51], v[64:67], v[112:115], v[48:51]
    ds_read2_b32 v[136:137], v237 offset0:48 offset1:49
    v_mfma_f32_16x16x32_bf16 v[48:51], v[68:71], v[108:111], v[48:51]
    v_mfma_f32_16x16x32_bf16 v[48:51], v[72:75], v[104:107], v[48:51]
    ds_read2_b32 v[138:139], v237 offset0:50 offset1:51
    v_mfma_f32_16x16x32_bf16 v[48:51], v[76:79], v[100:103], v[48:51]
    ds_read_b128 v[172:175], v247 offset:14336
    v_mfma_f32_16x16x32_bf16 v[48:51], v[80:83], v[96:99], v[48:51]
    v_mfma_f32_16x16x32_bf16 v[52:55], v[84:87], v[96:99], v[52:55]
    ds_read2_b32 v[140:141], v237 offset0:176 offset1:177
    v_mfma_f32_16x16x32_bf16 v[52:55], v[80:83], v[100:103], v[52:55]
    ds_read2_b32 v[142:143], v237 offset0:178 offset1:179
    v_mfma_f32_16x16x32_bf16 v[52:55], v[76:79], v[104:107], v[52:55]
    v_mfma_f32_16x16x32_bf16 v[52:55], v[72:75], v[108:111], v[52:55]
    s_add_u32 m0, s73, 0
    ds_read_b128 v[176:179], v247 offset:18432
    v_mfma_f32_16x16x32_bf16 v[52:55], v[68:71], v[112:115], v[52:55]
    buffer_load_dwordx4 v7, s[52:55], s14 offen offset:3072 lds
    ds_read2_b32 v[144:145], v238 offset0:48 offset1:49
    v_mfma_f32_16x16x32_bf16 v[52:55], v[64:67], v[116:119], v[52:55]
    v_mfma_f32_16x16x32_bf16 v[56:59], v[64:67], v[120:123], v[56:59]
    ds_read2_b32 v[146:147], v238 offset0:50 offset1:51
    v_mfma_f32_16x16x32_bf16 v[56:59], v[68:71], v[116:119], v[56:59]
    ds_read_b128 v[180:183], v247 offset:22528
    v_mfma_f32_16x16x32_bf16 v[56:59], v[72:75], v[112:115], v[56:59]
    v_mfma_f32_16x16x32_bf16 v[56:59], v[76:79], v[108:111], v[56:59]
    ds_read2_b32 v[148:149], v238 offset0:176 offset1:177
    v_mfma_f32_16x16x32_bf16 v[56:59], v[80:83], v[104:107], v[56:59]
    ds_read2_b32 v[150:151], v238 offset0:178 offset1:179
    v_mfma_f32_16x16x32_bf16 v[56:59], v[84:87], v[100:103], v[56:59]
    ds_read_b128 v[184:187], v247 offset:26624
    v_mfma_f32_16x16x32_bf16 v[56:59], v[88:91], v[96:99], v[56:59]
    v_mfma_f32_16x16x32_bf16 v[60:63], v[92:95], v[96:99], v[60:63]
    s_lshl_b32 s14, s92, 18
    ds_read2_b32 v[152:153], v239 offset0:48 offset1:49
    v_mfma_f32_16x16x32_bf16 v[60:63], v[88:91], v[100:103], v[60:63]
    s_add_u32 m0, s73, 16384
    ds_read2_b32 v[154:155], v239 offset0:50 offset1:51
    v_mfma_f32_16x16x32_bf16 v[60:63], v[84:87], v[104:107], v[60:63]
    buffer_load_dwordx4 v4, s[52:55], s14 offen offset:0 lds
    v_mfma_f32_16x16x32_bf16 v[60:63], v[80:83], v[108:111], v[60:63]
    ds_read_b128 v[188:191], v247 offset:30720
    v_mfma_f32_16x16x32_bf16 v[60:63], v[76:79], v[112:115], v[60:63]
    ds_read2_b32 v[156:157], v239 offset0:176 offset1:177
    v_mfma_f32_16x16x32_bf16 v[60:63], v[72:75], v[116:119], v[60:63]
    v_mfma_f32_16x16x32_bf16 v[60:63], v[68:71], v[120:123], v[60:63]
    ds_read2_b32 v[158:159], v239 offset0:178 offset1:179
L_pl_X_4:
    s_cbranch_execz L_wret
    v_mfma_f32_16x16x32_bf16 v[60:63], v[64:67], v[124:127], v[60:63]
    s_waitcnt lgkmcnt(12)
    v_mfma_f32_16x16x32_bf16 v[32:35], v[128:131], v[160:163], v[32:35]
    ds_read_b128 v[96:99], v244 offset:0
    v_mfma_f32_16x16x32_bf16 v[36:39], v[132:135], v[160:163], v[36:39]
    ds_read2_b32 v[64:65], v236 offset0:64 offset1:65
    v_mfma_f32_16x16x32_bf16 v[36:39], v[128:131], v[164:167], v[36:39]
    ds_read2_b32 v[66:67], v236 offset0:66 offset1:67
    v_mfma_f32_16x16x32_bf16 v[40:43], v[128:131], v[168:171], v[40:43]
    ds_read_b128 v[100:103], v244 offset:4096
    v_mfma_f32_16x16x32_bf16 v[40:43], v[132:135], v[164:167], v[40:43]
    ds_read2_b32 v[68:69], v236 offset0:192 offset1:193
    v_mfma_f32_16x16x32_bf16 v[40:43], v[136:139], v[160:163], v[40:43]
    s_add_u32 m0, s73, 16384
    ds_read2_b32 v[70:71], v236 offset0:194 offset1:195
    v_mfma_f32_16x16x32_bf16 v[44:47], v[140:143], v[160:163], v[44:47]
    buffer_load_dwordx4 v5, s[52:55], s14 offen offset:1024 lds
    ds_read_b128 v[104:107], v244 offset:8192
    v_mfma_f32_16x16x32_bf16 v[44:47], v[136:139], v[164:167], v[44:47]
    ds_read2_b32 v[72:73], v237 offset0:64 offset1:65
    s_waitcnt vmcnt(7)
    s_barrier
    v_mfma_f32_16x16x32_bf16 v[44:47], v[132:135], v[168:171], v[44:47]
    ds_read_b64_tr_b16 a[96:97], v10 offset:16384
    v_mfma_f32_16x16x32_bf16 v[44:47], v[128:131], v[172:175], v[44:47]
    ds_read2_b32 v[74:75], v237 offset0:66 offset1:67
    s_waitcnt lgkmcnt(10)
    v_mfma_f32_16x16x32_bf16 v[48:51], v[128:131], v[176:179], v[48:51]
    ds_read_b64_tr_b16 a[98:99], v10 offset:18432
    v_mfma_f32_16x16x32_bf16 v[48:51], v[132:135], v[172:175], v[48:51]
    ds_read_b64_tr_b16 a[104:105], v10 offset:20480
    v_mfma_f32_16x16x32_bf16 v[48:51], v[136:139], v[168:171], v[48:51]
    ds_read_b64_tr_b16 a[106:107], v10 offset:22528
    v_mfma_f32_16x16x32_bf16 v[48:51], v[140:143], v[164:167], v[48:51]
    ds_read_b128 v[108:111], v244 offset:12288
    v_mfma_f32_16x16x32_bf16 v[48:51], v[144:147], v[160:163], v[48:51]
    ds_read_b64_tr_b16 a[100:101], v11 offset:16384
    v_mfma_f32_16x16x32_bf16 v[52:55], v[148:151], v[160:163], v[52:55]
    ds_read_b64_tr_b16 a[102:103], v11 offset:18432
    v_mfma_f32_16x16x32_bf16 v[52:55], v[144:147], v[164:167], v[52:55]
    ds_read2_b32 v[76:77], v237 offset0:192 offset1:193
    v_mfma_f32_16x16x32_bf16 v[52:55], v[140:143], v[168:171], v[52:55]
    ds_read_b64_tr_b16 a[108:109], v11 offset:20480
    s_add_u32 m0, s73, 16384
    v_mfma_f32_16x16x32_bf16 v[52:55], v[136:139], v[172:175], v[52:55]
    ds_read_b64_tr_b16 a[110:111], v11 offset:22528
    buffer_load_dwordx4 v6, s[52:55], s14 offen offset:2048 lds
    v_mfma_f32_16x16x32_bf16 v[52:55], v[132:135], v[176:179], v[52:55]
    ds_read2_b32 v[78:79], v237 offset0:194 offset1:195
    v_mfma_f32_16x16x32_bf16 v[52:55], v[128:131], v[180:183], v[52:55]
    ds_read_b128 v[112:115], v244 offset:16384
    v_mfma_f32_16x16x32_bf16 v[56:59], v[128:131], v[184:187], v[56:59]
    ds_read2_b32 v[80:81], v238 offset0:64 offset1:65
    v_mfma_f32_16x16x32_bf16 v[56:59], v[132:135], v[180:183], v[56:59]
    ds_read2_b32 v[82:83], v238 offset0:66 offset1:67
    v_mfma_f32_16x16x32_bf16 v[56:59], v[136:139], v[176:179], v[56:59]
    ds_read_b128 v[116:119], v244 offset:20480
    v_mfma_f32_16x16x32_bf16 v[56:59], v[140:143], v[172:175], v[56:59]
    ds_read2_b32 v[84:85], v238 offset0:192 offset1:193
    v_mfma_f32_16x16x32_bf16 v[56:59], v[144:147], v[168:171], v[56:59]
    ds_read2_b32 v[86:87], v238 offset0:194 offset1:195
    v_mfma_f32_16x16x32_bf16 v[56:59], v[148:151], v[164:167], v[56:59]
    ds_read_b128 v[120:123], v244 offset:24576
    v_mfma_f32_16x16x32_bf16 v[56:59], v[152:155], v[160:163], v[56:59]
    v_mfma_f32_16x16x32_bf16 v[60:63], v[156:159], v[160:163], v[60:63]
    s_add_u32 m0, s73, 16384
    ds_read2_b32 v[88:89], v239 offset0:64 offset1:65
    v_mfma_f32_16x16x32_bf16 v[60:63], v[152:155], v[164:167], v[60:63]
    buffer_load_dwordx4 v7, s[52:55], s14 offen offset:3072 lds
    ds_read2_b32 v[90:91], v239 offset0:66 offset1:67
    v_mfma_f32_16x16x32_bf16 v[60:63], v[148:151], v[168:171], v[60:63]
    v_mfma_f32_16x16x32_bf16 v[60:63], v[144:147], v[172:175], v[60:63]
    ds_read_b128 v[124:127], v244 offset:28672
    v_mfma_f32_16x16x32_bf16 v[60:63], v[140:143], v[176:179], v[60:63]
    ds_read2_b32 v[92:93], v239 offset0:192 offset1:193
    v_mfma_f32_16x16x32_bf16 v[60:63], v[136:139], v[180:183], v[60:63]
    v_mfma_f32_16x16x32_bf16 v[60:63], v[132:135], v[184:187], v[60:63]
    ds_read2_b32 v[94:95], v239 offset0:194 offset1:195
    v_mfma_f32_16x16x32_bf16 v[60:63], v[128:131], v[188:191], v[60:63]
    s_waitcnt lgkmcnt(12)
    v_mfma_f32_16x16x32_bf16 v[32:35], v[64:67], v[96:99], v[32:35]
    ds_read_b128 v[160:163], v245 offset:0
    v_mfma_f32_16x16x32_bf16 v[36:39], v[68:71], v[96:99], v[36:39]
    ds_read2_b32 v[128:129], v236 offset0:80 offset1:81
    v_mfma_f32_16x16x32_bf16 v[36:39], v[64:67], v[100:103], v[36:39]
    ds_read2_b32 v[130:131], v236 offset0:82 offset1:83
    v_mfma_f32_16x16x32_bf16 v[40:43], v[64:67], v[104:107], v[40:43]
    ds_read_b128 v[164:167], v245 offset:4096
    s_barrier
    v_mfma_f32_16x16x32_bf16 v[40:43], v[68:71], v[100:103], v[40:43]
    ds_read2_b32 v[132:133], v236 offset0:208 offset1:209
    v_mfma_f32_16x16x32_bf16 v[40:43], v[72:75], v[96:99], v[40:43]
    ds_read2_b32 v[134:135], v236 offset0:210 offset1:211
    v_mfma_f32_16x16x32_bf16 v[44:47], v[76:79], v[96:99], v[44:47]
    ds_read_b128 v[168:171], v245 offset:8192
    v_mfma_f32_16x16x32_bf16 v[44:47], v[72:75], v[100:103], v[44:47]
    s_lshl_b32 s14, s93, 18
    ds_read2_b32 v[136:137], v237 offset0:80 offset1:81
    v_mfma_f32_16x16x32_bf16 v[44:47], v[68:71], v[104:107], v[44:47]
    s_add_u32 m0, s73, 147456
    ds_read2_b32 v[138:139], v237 offset0:82 offset1:83
    v_mfma_f32_16x16x32_bf16 v[44:47], v[64:67], v[108:111], v[44:47]
    buffer_load_dwordx4 v4, s[52:55], s14 offen offset:0 lds
    ds_read_b128 v[172:175], v245 offset:12288
    s_waitcnt lgkmcnt(10)
    v_mfma_f32_16x16x32_bf16 v[48:51], v[64:67], v[112:115], v[48:51]
    ds_read2_b32 v[140:141], v237 offset0:208 offset1:209
    v_mfma_f32_16x16x32_bf16 v[48:51], v[68:71], v[108:111], v[48:51]
    ds_read2_b32 v[142:143], v237 offset0:210 offset1:211
    v_mfma_f32_16x16x32_bf16 v[48:51], v[72:75], v[104:107], v[48:51]
    ds_read_b128 v[176:179], v245 offset:16384
    v_mfma_f32_16x16x32_bf16 v[48:51], v[76:79], v[100:103], v[48:51]
    ds_read2_b32 v[144:145], v238 offset0:80 offset1:81
    v_mfma_f32_16x16x32_bf16 v[48:51], v[80:83], v[96:99], v[48:51]
    ds_read2_b32 v[146:147], v238 offset0:82 offset1:83
    v_mfma_f32_16x16x32_bf16 v[52:55], v[84:87], v[96:99], v[52:55]
    ds_read_b128 v[180:183], v245 offset:20480
    v_mfma_f32_16x16x32_bf16 v[52:55], v[80:83], v[100:103], v[52:55]
    ds_read2_b32 v[148:149], v238 offset0:208 offset1:209
    v_mfma_f32_16x16x32_bf16 v[52:55], v[76:79], v[104:107], v[52:55]
    ds_read2_b32 v[150:151], v238 offset0:210 offset1:211
    v_mfma_f32_16x16x32_bf16 v[52:55], v[72:75], v[108:111], v[52:55]
    ds_read_b128 v[184:187], v245 offset:24576
    v_mfma_f32_16x16x32_bf16 v[52:55], v[68:71], v[112:115], v[52:55]
    s_add_u32 m0, s73, 147456
    ds_read_b128 v[212:215], v241 offset:8352
    v_mfma_f32_16x16x32_bf16 v[52:55], v[64:67], v[116:119], v[52:55]
    buffer_load_dwordx4 v5, s[52:55], s14 offen offset:1024 lds
    ds_read2_b32 v[152:153], v239 offset0:80 offset1:81
    v_mfma_f32_16x16x32_bf16 v[56:59], v[64:67], v[120:123], v[56:59]
    ds_read_b32 v216, v241 offset:8368
    v_mfma_f32_16x16x32_bf16 v[56:59], v[68:71], v[116:119], v[56:59]
    ds_read_b128 v[218:221], v241 offset:9376
    v_mfma_f32_16x16x32_bf16 v[56:59], v[72:75], v[112:115], v[56:59]
    ds_read_b32 v222, v241 offset:9392
    v_mfma_f32_16x16x32_bf16 v[56:59], v[76:79], v[108:111], v[56:59]
    ds_read_b128 v[224:227], v241 offset:10400
    v_mfma_f32_16x16x32_bf16 v[56:59], v[80:83], v[104:107], v[56:59]
    ds_read_b32 v228, v241 offset:10416
    s_waitcnt vmcnt(6)
    s_barrier
    v_mfma_f32_16x16x32_bf16 v[56:59], v[84:87], v[100:103], v[56:59]
    ds_read_b128 v[230:233], v241 offset:11424
    v_add_u32 v10, -131072, v10
    v_mfma_f32_16x16x32_bf16 v[56:59], v[88:91], v[96:99], v[56:59]
    ds_read_b64_tr_b16 a[112:113], v10 offset:0
    v_mfma_f32_16x16x32_bf16 v[60:63], v[92:95], v[96:99], v[60:63]
    ds_read_b64_tr_b16 a[114:115], v10 offset:2048
    v_mfma_f32_16x16x32_bf16 v[60:63], v[88:91], v[100:103], v[60:63]
    ds_read_b64_tr_b16 a[120:121], v10 offset:4096
    ds_read2_b32 v[154:155], v239 offset0:82 offset1:83
    v_mfma_f32_16x16x32_bf16 v[60:63], v[84:87], v[104:107], v[60:63]
    ds_read_b32 v234, v241 offset:11440
    v_mfma_f32_16x16x32_bf16 v[60:63], v[80:83], v[108:111], v[60:63]
    ds_read_b64_tr_b16 a[122:123], v10 offset:6144
    s_add_u32 m0, s73, 147456
    ds_read_b128 v[188:191], v245 offset:28672
    v_mfma_f32_16x16x32_bf16 v[60:63], v[76:79], v[112:115], v[60:63]
    v_add_u32 v11, -131072, v11
    buffer_load_dwordx4 v6, s[52:55], s14 offen offset:2048 lds
    ds_read2_b32 v[156:157], v239 offset0:208 offset1:209
    v_mfma_f32_16x16x32_bf16 v[60:63], v[72:75], v[116:119], v[60:63]
    ds_read_b64_tr_b16 a[116:117], v11 offset:0
    v_mfma_f32_16x16x32_bf16 v[60:63], v[68:71], v[120:123], v[60:63]
    ds_read_b64_tr_b16 a[118:119], v11 offset:2048
    ds_read2_b32 v[158:159], v239 offset0:210 offset1:211
    v_mfma_f32_16x16x32_bf16 v[60:63], v[64:67], v[124:127], v[60:63]
    ds_read_b64_tr_b16 a[124:125], v11 offset:4096
    s_waitcnt lgkmcnt(15)
    v_mfma_f32_16x16x32_bf16 v[32:35], v[128:131], v[160:163], v[32:35]
    ds_read_b64_tr_b16 a[126:127], v11 offset:6144
    v_mfma_f32_16x16x32_bf16 v[36:39], v[132:135], v[160:163], v[36:39]
    ds_read_b128 v[96:99], v246 offset:0
    v_mfma_f32_16x16x32_bf16 v[36:39], v[128:131], v[164:167], v[36:39]
    ds_read2_b32 v[64:65], v236 offset0:96 offset1:97
    v_mfma_f32_16x16x32_bf16 v[40:43], v[128:131], v[168:171], v[40:43]
    ds_read2_b32 v[66:67], v236 offset0:98 offset1:99
    v_mfma_f32_16x16x32_bf16 v[40:43], v[132:135], v[164:167], v[40:43]
    s_waitcnt lgkmcnt(11)
    v_mfma_f32_16x16x32_bf16 v[40:43], v[136:139], v[160:163], v[40:43]
    ds_read_b128 v[100:103], v246 offset:4096
    v_mfma_f32_16x16x32_bf16 v[44:47], v[140:143], v[160:163], v[44:47]
    ds_read2_b32 v[68:69], v236 offset0:224 offset1:225
    v_mfma_f32_16x16x32_bf16 v[44:47], v[136:139], v[164:167], v[44:47]
    s_add_u32 m0, s73, 147456
    ds_read2_b32 v[70:71], v236 offset0:226 offset1:227
    v_mfma_f32_16x16x32_bf16 v[44:47], v[132:135], v[168:171], v[44:47]
    buffer_load_dwordx4 v7, s[52:55], s14 offen offset:3072 lds
    v_lshlrev_b32 v9, 16, v9
    v_mfma_f32_16x16x32_bf16 v[44:47], v[128:131], v[172:175], v[44:47]
    ds_read_b128 v[104:107], v246 offset:8192
    s_waitcnt lgkmcnt(9)
    v_mfma_f32_16x16x32_bf16 v[48:51], v[128:131], v[176:179], v[48:51]
    ds_read2_b32 v[72:73], v237 offset0:96 offset1:97
    v_lshlrev_b32 v208, 16, v212
    v_mfma_f32_16x16x32_bf16 v[48:51], v[132:135], v[172:175], v[48:51]
    v_mfma_f32_16x16x32_bf16 v[48:51], v[136:139], v[168:171], v[48:51]
    ds_read2_b32 v[74:75], v237 offset0:98 offset1:99
    v_add_f32 v9, v9, v208
    v_mfma_f32_16x16x32_bf16 v[48:51], v[140:143], v[164:167], v[48:51]
    ds_read_b128 v[108:111], v246 offset:12288
    v_cvt_pk_bf16_f32 v9, v9, v9
    v_mfma_f32_16x16x32_bf16 v[48:51], v[144:147], v[160:163], v[48:51]
    ds_read2_b32 v[76:77], v237 offset0:224 offset1:225
    s_waitcnt lgkmcnt(11)
    s_barrier
    v_mfma_f32_16x16x32_bf16 v[52:55], v[148:151], v[160:163], v[52:55]
    ds_write_b16 v242, v9 offset:12480
    v_mfma_f32_16x16x32_bf16 v[52:55], v[144:147], v[164:167], v[52:55]
    ds_read2_b32 v[78:79], v237 offset0:226 offset1:227
    v_mfma_f32_16x16x32_bf16 v[52:55], v[140:143], v[168:171], v[52:55]
    ds_write_b16 v242, v9 offset:8322
    v_mfma_f32_16x16x32_bf16 v[52:55], v[136:139], v[172:175], v[52:55]
    s_lshl_b32 s14, s94, 18
    ds_read_b128 v[112:115], v246 offset:16384
    v_mfma_f32_16x16x32_bf16 v[52:55], v[132:135], v[176:179], v[52:55]
    ds_read2_b32 v[80:81], v238 offset0:96 offset1:97
    s_add_u32 m0, s73, 0
    v_alignbit_b32 v212, v213, v212, 16
    v_mfma_f32_16x16x32_bf16 v[52:55], v[128:131], v[180:183], v[52:55]
    buffer_load_dwordx4 v4, s[52:55], s14 offen offset:0 lds
    v_alignbit_b32 v213, v214, v213, 16
    v_mfma_f32_16x16x32_bf16 v[56:59], v[128:131], v[184:187], v[56:59]
    ds_read2_b32 v[82:83], v238 offset0:98 offset1:99
    v_mfma_f32_16x16x32_bf16 v[56:59], v[132:135], v[180:183], v[56:59]
    ds_read_b128 v[116:119], v246 offset:20480
    v_alignbit_b32 v214, v215, v214, 16
    v_mfma_f32_16x16x32_bf16 v[56:59], v[136:139], v[176:179], v[56:59]
    v_mfma_f32_16x16x32_bf16 v[56:59], v[140:143], v[172:175], v[56:59]
    ds_read2_b32 v[84:85], v238 offset0:224 offset1:225
    v_alignbit_b32 v215, v216, v215, 16
    v_mfma_f32_16x16x32_bf16 v[56:59], v[144:147], v[168:171], v[56:59]
    ds_read2_b32 v[86:87], v238 offset0:226 offset1:227
    v_mfma_f32_16x16x32_bf16 v[56:59], v[148:151], v[164:167], v[56:59]
    ds_write_b128 v241, v[212:215] offset:12512
    v_mfma_f32_16x16x32_bf16 v[56:59], v[152:155], v[160:163], v[56:59]
    ds_read_b128 v[120:123], v246 offset:24576
    v_mfma_f32_16x16x32_bf16 v[60:63], v[156:159], v[160:163], v[60:63]
    ds_read2_b32 v[88:89], v239 offset0:96 offset1:97
    v_alignbit_b32 v218, v219, v218, 16
    v_mfma_f32_16x16x32_bf16 v[60:63], v[152:155], v[164:167], v[60:63]
    ds_read2_b32 v[90:91], v239 offset0:98 offset1:99
    v_alignbit_b32 v219, v220, v219, 16
    v_mfma_f32_16x16x32_bf16 v[60:63], v[148:151], v[168:171], v[60:63]
    s_add_u32 m0, s73, 0
    ds_read_b128 v[124:127], v246 offset:28672
    v_mfma_f32_16x16x32_bf16 v[60:63], v[144:147], v[172:175], v[60:63]
    buffer_load_dwordx4 v5, s[52:55], s14 offen offset:1024 lds
    v_alignbit_b32 v220, v221, v220, 16
    v_mfma_f32_16x16x32_bf16 v[60:63], v[140:143], v[176:179], v[60:63]
    ds_read2_b32 v[92:93], v239 offset0:224 offset1:225
    v_mfma_f32_16x16x32_bf16 v[60:63], v[136:139], v[180:183], v[60:63]
    ds_read2_b32 v[94:95], v239 offset0:226 offset1:227
    v_alignbit_b32 v221, v222, v221, 16
    v_mfma_f32_16x16x32_bf16 v[60:63], v[132:135], v[184:187], v[60:63]
    ds_write_b128 v241, v[218:221] offset:13536
    v_mfma_f32_16x16x32_bf16 v[60:63], v[128:131], v[188:191], v[60:63]
    s_waitcnt lgkmcnt(15)
    v_mfma_f32_16x16x32_bf16 v[32:35], v[64:67], v[96:99], v[32:35]
    ds_read_b128 v[160:163], v247 offset:0
    s_waitcnt vmcnt(6)
    s_barrier
    v_mfma_f32_16x16x32_bf16 v[36:39], v[68:71], v[96:99], v[36:39]
    ds_read_b64_tr_b16 a[128:129], v10 offset:16384
    v_alignbit_b32 v224, v225, v224, 16
    v_mfma_f32_16x16x32_bf16 v[36:39], v[64:67], v[100:103], v[36:39]
    ds_read_b64_tr_b16 a[130:131], v10 offset:18432
    ds_read_b128 v[164:167], v247 offset:4096
    v_mfma_f32_16x16x32_bf16 v[40:43], v[64:67], v[104:107], v[40:43]
    ds_read_b128 v[168:171], v247 offset:8192
    v_mfma_f32_16x16x32_bf16 v[40:43], v[68:71], v[100:103], v[40:43]
    ds_read_b64_tr_b16 a[136:137], v10 offset:20480
    ds_read_b128 v[172:175], v247 offset:12288
    v_mfma_f32_16x16x32_bf16 v[40:43], v[72:75], v[96:99], v[40:43]
    ds_read_b64_tr_b16 a[138:139], v10 offset:22528
    v_alignbit_b32 v225, v226, v225, 16
    v_mfma_f32_16x16x32_bf16 v[44:47], v[76:79], v[96:99], v[44:47]
    s_add_u32 m0, s73, 0
    ds_read_b128 v[176:179], v247 offset:16384
    v_mfma_f32_16x16x32_bf16 v[44:47], v[72:75], v[100:103], v[44:47]
    ds_read_b64_tr_b16 a[132:133], v11 offset:16384
    buffer_load_dwordx4 v6, s[52:55], s14 offen offset:2048 lds
    ds_read_b128 v[180:183], v247 offset:20480
    v_mfma_f32_16x16x32_bf16 v[44:47], v[68:71], v[104:107], v[44:47]
    ds_read_b64_tr_b16 a[134:135], v11 offset:18432
    v_mfma_f32_16x16x32_bf16 v[44:47], v[64:67], v[108:111], v[44:47]
    ds_read_b128 v[184:187], v247 offset:24576
    v_alignbit_b32 v226, v227, v226, 16
    s_waitcnt lgkmcnt(14)
    v_mfma_f32_16x16x32_bf16 v[48:51], v[64:67], v[112:115], v[48:51]
    ds_read_b64_tr_b16 a[140:141], v11 offset:20480
    ds_read_b128 v[188:191], v247 offset:28672
    v_mfma_f32_16x16x32_bf16 v[48:51], v[68:71], v[108:111], v[48:51]
    ds_read_b64_tr_b16 a[142:143], v11 offset:22528
    v_mfma_f32_16x16x32_bf16 v[48:51], v[72:75], v[104:107], v[48:51]
    ds_read2_b32 v[128:129], v236 offset0:112 offset1:113
    v_alignbit_b32 v227, v228, v227, 16
    v_mfma_f32_16x16x32_bf16 v[48:51], v[76:79], v[100:103], v[48:51]
    ds_read2_b32 v[130:131], v236 offset0:114 offset1:115
    v_mfma_f32_16x16x32_bf16 v[48:51], v[80:83], v[96:99], v[48:51]
    ds_read2_b32 v[132:133], v236 offset0:240 offset1:241
    v_mfma_f32_16x16x32_bf16 v[52:55], v[84:87], v[96:99], v[52:55]
    ds_read2_b32 v[134:135], v236 offset0:242 offset1:243
    v_mfma_f32_16x16x32_bf16 v[52:55], v[80:83], v[100:103], v[52:55]
    ds_write_b128 v241, v[224:227] offset:14560
    v_mfma_f32_16x16x32_bf16 v[52:55], v[76:79], v[104:107], v[52:55]
    ds_read2_b32 v[136:137], v237 offset0:112 offset1:113
    ds_read2_b32 v[138:139], v237 offset0:114 offset1:115
    v_mfma_f32_16x16x32_bf16 v[52:55], v[72:75], v[108:111], v[52:55]
    s_add_u32 m0, s73, 0
    ds_read2_b32 v[140:141], v237 offset0:240 offset1:241
    s_add_u32 s6, s12, 4751360
    v_mfma_f32_16x16x32_bf16 v[52:55], v[68:71], v[112:115], v[52:55]
    buffer_load_dwordx4 v7, s[52:55], s14 offen offset:3072 lds
    v_alignbit_b32 v230, v231, v230, 16
    v_mfma_f32_16x16x32_bf16 v[52:55], v[64:67], v[116:119], v[52:55]
    ds_read2_b32 v[142:143], v237 offset0:242 offset1:243
    v_xor_b32 v244, 64, v244
    v_mfma_f32_16x16x32_bf16 v[56:59], v[64:67], v[120:123], v[56:59]
    ds_read2_b32 v[144:145], v238 offset0:112 offset1:113
    v_mfma_f32_16x16x32_bf16 v[56:59], v[68:71], v[116:119], v[56:59]
    ds_read2_b32 v[146:147], v238 offset0:114 offset1:115
    v_mfma_f32_16x16x32_bf16 v[56:59], v[72:75], v[112:115], v[56:59]
    ds_read2_b32 v[148:149], v238 offset0:240 offset1:241
    v_alignbit_b32 v231, v232, v231, 16
    v_mfma_f32_16x16x32_bf16 v[56:59], v[76:79], v[108:111], v[56:59]
    ds_read2_b32 v[150:151], v238 offset0:242 offset1:243
    v_xor_b32 v245, 64, v245
    v_mfma_f32_16x16x32_bf16 v[56:59], v[80:83], v[104:107], v[56:59]
    ds_read2_b32 v[152:153], v239 offset0:112 offset1:113
    s_waitcnt lgkmcnt(14)
    s_barrier
    v_mfma_f32_16x16x32_bf16 v[56:59], v[84:87], v[100:103], v[56:59]
    ds_read2_b32 v[154:155], v239 offset0:114 offset1:115
    v_mfma_f32_16x16x32_bf16 v[56:59], v[88:91], v[96:99], v[56:59]
    ds_read2_b32 v[156:157], v239 offset0:240 offset1:241
    v_alignbit_b32 v232, v233, v232, 16
    v_mfma_f32_16x16x32_bf16 v[60:63], v[92:95], v[96:99], v[60:63]
    s_lshl_b32 s14, s95, 18
    ds_read2_b32 v[158:159], v239 offset0:242 offset1:243
    v_mfma_f32_16x16x32_bf16 v[60:63], v[88:91], v[100:103], v[60:63]
    s_add_u32 m0, s73, 16384
    v_xor_b32 v246, 64, v246
    v_add_u32 v236, 8320, v236
    v_mfma_f32_16x16x32_bf16 v[60:63], v[84:87], v[104:107], v[60:63]
    buffer_load_dwordx4 v4, s[52:55], s14 offen offset:0 lds
    v_alignbit_b32 v233, v234, v233, 16
    v_mfma_f32_16x16x32_bf16 v[60:63], v[80:83], v[108:111], v[60:63]
    v_add_u32 v237, 8320, v237
    v_mfma_f32_16x16x32_bf16 v[60:63], v[76:79], v[112:115], v[60:63]
    v_mfma_f32_16x16x32_bf16 v[60:63], v[72:75], v[116:119], v[60:63]
    v_xor_b32 v247, 64, v247
    v_add_u32 v238, 8320, v238
    v_mfma_f32_16x16x32_bf16 v[60:63], v[68:71], v[120:123], v[60:63]
    ds_write_b128 v241, v[230:233] offset:15584
    v_mfma_f32_16x16x32_bf16 v[60:63], v[64:67], v[124:127], v[60:63]
    v_add_u32 v239, 8320, v239
    s_waitcnt lgkmcnt(1)
    v_mfma_f32_16x16x32_bf16 v[60:63], v[128:131], v[188:191], v[60:63]
    ds_read_b128 v[96:99], v244 offset:2048
    v_mfma_f32_16x16x32_bf16 v[60:63], v[132:135], v[184:187], v[60:63]
    ds_read2_b32 v[64:65], v236 offset0:0 offset1:1
    v_mfma_f32_16x16x32_bf16 v[60:63], v[136:139], v[180:183], v[60:63]
    ds_read2_b32 v[66:67], v236 offset0:2 offset1:3
    v_mfma_f32_16x16x32_bf16 v[60:63], v[140:143], v[176:179], v[60:63]
    ds_read_b128 v[100:103], v244 offset:6144
    v_mfma_f32_16x16x32_bf16 v[60:63], v[144:147], v[172:175], v[60:63]
    ds_read2_b32 v[68:69], v236 offset0:128 offset1:129
    v_mfma_f32_16x16x32_bf16 v[60:63], v[148:151], v[168:171], v[60:63]
    s_add_u32 m0, s73, 16384
    ds_read2_b32 v[70:71], v236 offset0:130 offset1:131
    v_mfma_f32_16x16x32_bf16 v[60:63], v[152:155], v[164:167], v[60:63]
    buffer_load_dwordx4 v5, s[52:55], s14 offen offset:1024 lds
    ds_read_b128 v[104:107], v244 offset:10240
    v_mfma_f32_16x16x32_bf16 v[60:63], v[156:159], v[160:163], v[60:63]
    ds_read2_b32 v[72:73], v237 offset0:0 offset1:1
    v_mfma_f32_16x16x32_bf16 v[56:59], v[128:131], v[184:187], v[56:59]
    ds_read2_b32 v[74:75], v237 offset0:2 offset1:3
    v_mfma_f32_16x16x32_bf16 v[56:59], v[132:135], v[180:183], v[56:59]
    ds_read_b128 v[108:111], v244 offset:14336
    v_mfma_f32_16x16x32_bf16 v[56:59], v[136:139], v[176:179], v[56:59]
    ds_read2_b32 v[76:77], v237 offset0:128 offset1:129
    v_mfma_f32_16x16x32_bf16 v[56:59], v[140:143], v[172:175], v[56:59]
    ds_read2_b32 v[78:79], v237 offset0:130 offset1:131
    v_mfma_f32_16x16x32_bf16 v[56:59], v[144:147], v[168:171], v[56:59]
    ds_read_b128 v[112:115], v244 offset:18432
    v_mfma_f32_16x16x32_bf16 v[56:59], v[148:151], v[164:167], v[56:59]
    ds_read2_b32 v[80:81], v238 offset0:0 offset1:1
    v_cvt_pk_bf16_f32 v206, v60, v61
    v_mfma_f32_16x16x32_bf16 v[56:59], v[152:155], v[160:163], v[56:59]
    ds_read2_b32 v[82:83], v238 offset0:2 offset1:3
    s_waitcnt vmcnt(6)
    s_barrier
    v_mfma_f32_16x16x32_bf16 v[52:55], v[128:131], v[180:183], v[52:55]
    ds_read_b128 v[116:119], v244 offset:22528
    v_add_u32 v10, 131072, v10
    v_mfma_f32_16x16x32_bf16 v[52:55], v[132:135], v[176:179], v[52:55]
    ds_read_b64_tr_b16 a[144:145], v10 offset:16384
    v_cvt_pk_bf16_f32 v207, v62, v63
    v_mfma_f32_16x16x32_bf16 v[52:55], v[136:139], v[172:175], v[52:55]
    ds_read_b64_tr_b16 a[146:147], v10 offset:18432
    s_add_u32 m0, s73, 16384
    v_mfma_f32_16x16x32_bf16 v[52:55], v[140:143], v[168:171], v[52:55]
    buffer_load_dwordx4 v6, s[52:55], s14 offen offset:2048 lds
    ds_read2_b32 v[84:85], v238 offset0:128 offset1:129
    v_mfma_f32_16x16x32_bf16 v[52:55], v[144:147], v[164:167], v[52:55]
    buffer_store_dwordx2 v[206:207], v8, s[44:47], s6 offen offset:3584 sc1
    ds_read_b64_tr_b16 a[152:153], v10 offset:20480
    v_mfma_f32_16x16x32_bf16 v[52:55], v[148:151], v[160:163], v[52:55]
    ds_read_b64_tr_b16 a[154:155], v10 offset:22528
    v_mfma_f32_16x16x32_bf16 v[48:51], v[128:131], v[176:179], v[48:51]
    ds_read2_b32 v[86:87], v238 offset0:130 offset1:131
    v_add_u32 v11, 131072, v11
    v_cvt_pk_bf16_f32 v204, v56, v57
    v_mfma_f32_16x16x32_bf16 v[48:51], v[132:135], v[172:175], v[48:51]
    ds_read_b64_tr_b16 a[148:149], v11 offset:16384
    ds_read_b128 v[120:123], v244 offset:26624
    v_mfma_f32_16x16x32_bf16 v[48:51], v[136:139], v[168:171], v[48:51]
    ds_read_b64_tr_b16 a[150:151], v11 offset:18432
    ds_read2_b32 v[88:89], v239 offset0:0 offset1:1
    v_mfma_f32_16x16x32_bf16 v[48:51], v[140:143], v[164:167], v[48:51]
    ds_read2_b32 v[90:91], v239 offset0:2 offset1:3
    v_cvt_pk_bf16_f32 v205, v58, v59
    v_mfma_f32_16x16x32_bf16 v[48:51], v[144:147], v[160:163], v[48:51]
    ds_read_b64_tr_b16 a[156:157], v11 offset:20480
    ds_read_b128 v[124:127], v244 offset:30720
    v_mfma_f32_16x16x32_bf16 v[44:47], v[128:131], v[172:175], v[44:47]
    buffer_store_dwordx2 v[204:205], v8, s[44:47], s6 offen offset:3072 sc1
    ds_read_b64_tr_b16 a[158:159], v11 offset:22528
    v_mfma_f32_16x16x32_bf16 v[44:47], v[132:135], v[168:171], v[44:47]
    ds_read2_b32 v[92:93], v239 offset0:128 offset1:129
    v_mfma_f32_16x16x32_bf16 v[44:47], v[136:139], v[164:167], v[44:47]
    s_add_u32 m0, s73, 16384
    ds_read2_b32 v[94:95], v239 offset0:130 offset1:131
    v_mfma_f32_16x16x32_bf16 v[44:47], v[140:143], v[160:163], v[44:47]
    buffer_load_dwordx4 v7, s[52:55], s14 offen offset:3072 lds
    v_cvt_pk_bf16_f32 v202, v52, v53
    v_mfma_f32_16x16x32_bf16 v[40:43], v[128:131], v[168:171], v[40:43]
    v_mfma_f32_16x16x32_bf16 v[40:43], v[132:135], v[164:167], v[40:43]
    v_mfma_f32_16x16x32_bf16 v[40:43], v[136:139], v[160:163], v[40:43]
    v_cvt_pk_bf16_f32 v203, v54, v55
    v_mfma_f32_16x16x32_bf16 v[36:39], v[128:131], v[164:167], v[36:39]
    v_mfma_f32_16x16x32_bf16 v[36:39], v[132:135], v[160:163], v[36:39]
    buffer_store_dwordx2 v[202:203], v8, s[44:47], s6 offen offset:2560 sc1
    v_mfma_f32_16x16x32_bf16 v[32:35], v[128:131], v[160:163], v[32:35]
    s_waitcnt lgkmcnt(0)
    v_mfma_f32_16x16x32_bf16 v[60:63], v[64:67], v[124:127], 0
    ds_read_b128 v[160:163], v245 offset:2048
    v_mfma_f32_16x16x32_bf16 v[60:63], v[68:71], v[120:123], v[60:63]
    v_cvt_pk_bf16_f32 v200, v48, v49
    v_mfma_f32_16x16x32_bf16 v[60:63], v[72:75], v[116:119], v[60:63]
    ds_read2_b32 v[128:129], v236 offset0:16 offset1:17
    v_mfma_f32_16x16x32_bf16 v[60:63], v[76:79], v[112:115], v[60:63]
    s_barrier
    v_cvt_pk_bf16_f32 v201, v50, v51
    v_mfma_f32_16x16x32_bf16 v[60:63], v[80:83], v[108:111], v[60:63]
    ds_read2_b32 v[130:131], v236 offset0:18 offset1:19
    v_mfma_f32_16x16x32_bf16 v[60:63], v[84:87], v[104:107], v[60:63]
    buffer_store_dwordx2 v[200:201], v8, s[44:47], s6 offen offset:2048 sc1
    ds_read_b128 v[164:167], v245 offset:6144
    v_mfma_f32_16x16x32_bf16 v[60:63], v[88:91], v[100:103], v[60:63]
    ds_read2_b32 v[132:133], v236 offset0:144 offset1:145
    v_mfma_f32_16x16x32_bf16 v[60:63], v[92:95], v[96:99], v[60:63]
    ds_read2_b32 v[134:135], v236 offset0:146 offset1:147
    s_lshl_b32 s14, s96, 18
    v_cvt_pk_bf16_f32 v198, v44, v45
    v_mfma_f32_16x16x32_bf16 v[56:59], v[64:67], v[120:123], 0
    s_add_u32 m0, s73, 147456
    ds_read_b128 v[168:171], v245 offset:10240
    v_mfma_f32_16x16x32_bf16 v[56:59], v[68:71], v[116:119], v[56:59]
    buffer_load_dwordx4 v4, s[52:55], s14 offen offset:0 lds
    ds_read2_b32 v[136:137], v237 offset0:16 offset1:17
    v_mfma_f32_16x16x32_bf16 v[56:59], v[72:75], v[112:115], v[56:59]
    ds_read2_b32 v[138:139], v237 offset0:18 offset1:19
    v_cvt_pk_bf16_f32 v199, v46, v47
    v_mfma_f32_16x16x32_bf16 v[56:59], v[76:79], v[108:111], v[56:59]
    ds_read_b128 v[172:175], v245 offset:14336
    v_mfma_f32_16x16x32_bf16 v[56:59], v[80:83], v[104:107], v[56:59]
    buffer_store_dwordx2 v[198:199], v8, s[44:47], s6 offen offset:1536 sc1
    ds_read2_b32 v[140:141], v237 offset0:144 offset1:145
    v_mfma_f32_16x16x32_bf16 v[56:59], v[84:87], v[100:103], v[56:59]
    ds_read2_b32 v[142:143], v237 offset0:146 offset1:147
    v_mfma_f32_16x16x32_bf16 v[56:59], v[88:91], v[96:99], v[56:59]
    ds_read_b128 v[176:179], v245 offset:18432
    v_cvt_pk_bf16_f32 v196, v40, v41
    v_mfma_f32_16x16x32_bf16 v[52:55], v[64:67], v[116:119], 0
    ds_read2_b32 v[144:145], v238 offset0:16 offset1:17
    v_mfma_f32_16x16x32_bf16 v[52:55], v[68:71], v[112:115], v[52:55]
    ds_read2_b32 v[146:147], v238 offset0:18 offset1:19
    v_cvt_pk_bf16_f32 v197, v42, v43
    v_mfma_f32_16x16x32_bf16 v[52:55], v[72:75], v[108:111], v[52:55]
    ds_read_b128 v[180:183], v245 offset:22528
    v_mfma_f32_16x16x32_bf16 v[52:55], v[76:79], v[104:107], v[52:55]
    buffer_store_dwordx2 v[196:197], v8, s[44:47], s6 offen offset:1024 sc1
    ds_read2_b32 v[148:149], v238 offset0:144 offset1:145
    v_mfma_f32_16x16x32_bf16 v[52:55], v[80:83], v[100:103], v[52:55]
    s_add_u32 m0, s73, 147456
    ds_read2_b32 v[150:151], v238 offset0:146 offset1:147
    v_mfma_f32_16x16x32_bf16 v[52:55], v[84:87], v[96:99], v[52:55]
    buffer_load_dwordx4 v5, s[52:55], s14 offen offset:1024 lds
    ds_read_b128 v[184:187], v245 offset:26624
    v_mfma_f32_16x16x32_bf16 v[48:51], v[64:67], v[112:115], 0
    ds_read2_b32 v[152:153], v239 offset0:16 offset1:17
    v_cvt_pk_bf16_f32 v194, v36, v37
    v_mfma_f32_16x16x32_bf16 v[48:51], v[68:71], v[108:111], v[48:51]
    ds_read2_b32 v[154:155], v239 offset0:18 offset1:19
    v_mfma_f32_16x16x32_bf16 v[48:51], v[72:75], v[104:107], v[48:51]
    ds_read_b128 v[188:191], v245 offset:30720
    v_cvt_pk_bf16_f32 v195, v38, v39
    v_mfma_f32_16x16x32_bf16 v[48:51], v[76:79], v[100:103], v[48:51]
    ds_read2_b32 v[156:157], v239 offset0:144 offset1:145
    v_mfma_f32_16x16x32_bf16 v[48:51], v[80:83], v[96:99], v[48:51]
    buffer_store_dwordx2 v[194:195], v8, s[44:47], s6 offen offset:512 sc1
    s_waitcnt vmcnt(13)
    s_barrier
    v_mfma_f32_16x16x32_bf16 v[44:47], v[64:67], v[108:111], 0
    v_add_u32 v10, -131072, v10
    v_cvt_pk_bf16_f32 v192, v32, v33
    v_mfma_f32_16x16x32_bf16 v[44:47], v[68:71], v[104:107], v[44:47]
    ds_read_b64_tr_b16 a[160:161], v10 offset:0
    v_mfma_f32_16x16x32_bf16 v[44:47], v[72:75], v[100:103], v[44:47]
    ds_read_b64_tr_b16 a[162:163], v10 offset:2048
    v_mfma_f32_16x16x32_bf16 v[44:47], v[76:79], v[96:99], v[44:47]
    ds_read_b64_tr_b16 a[168:169], v10 offset:4096
    v_cvt_pk_bf16_f32 v193, v34, v35
    v_mfma_f32_16x16x32_bf16 v[40:43], v[64:67], v[104:107], 0
    ds_read2_b32 v[158:159], v239 offset0:146 offset1:147
    v_mfma_f32_16x16x32_bf16 v[40:43], v[68:71], v[100:103], v[40:43]
    buffer_store_dwordx2 v[192:193], v8, s[44:47], s6 offen offset:0 sc1
    ds_read_b64_tr_b16 a[170:171], v10 offset:6144
    s_add_u32 m0, s73, 147456
    v_mfma_f32_16x16x32_bf16 v[40:43], v[72:75], v[96:99], v[40:43]
    v_add_u32 v11, -131072, v11
L_pl_X_5:
    s_cbranch_execz L_wret
    buffer_load_dwordx4 v6, s[52:55], s14 offen offset:2048 lds
    v_mfma_f32_16x16x32_bf16 v[36:39], v[64:67], v[100:103], 0
    ds_read_b64_tr_b16 a[164:165], v11 offset:0
    v_mfma_f32_16x16x32_bf16 v[36:39], v[68:71], v[96:99], v[36:39]
    ds_read_b64_tr_b16 a[166:167], v11 offset:2048
    v_mfma_f32_16x16x32_bf16 v[32:35], v[64:67], v[96:99], 0
    ds_read_b64_tr_b16 a[172:173], v11 offset:4096
    s_waitcnt lgkmcnt(15)
    v_mfma_f32_16x16x32_bf16 v[32:35], v[128:131], v[160:163], v[32:35]
    ds_read_b64_tr_b16 a[174:175], v11 offset:6144
    v_mfma_f32_16x16x32_bf16 v[36:39], v[132:135], v[160:163], v[36:39]
    ds_read_b128 v[96:99], v246 offset:2048
    v_mfma_f32_16x16x32_bf16 v[36:39], v[128:131], v[164:167], v[36:39]
    ds_read2_b32 v[64:65], v236 offset0:32 offset1:33
    v_mfma_f32_16x16x32_bf16 v[40:43], v[128:131], v[168:171], v[40:43]
    ds_read2_b32 v[66:67], v236 offset0:34 offset1:35
    v_mfma_f32_16x16x32_bf16 v[40:43], v[132:135], v[164:167], v[40:43]
    v_mfma_f32_16x16x32_bf16 v[40:43], v[136:139], v[160:163], v[40:43]
    ds_read_b128 v[100:103], v246 offset:6144
    v_mfma_f32_16x16x32_bf16 v[44:47], v[140:143], v[160:163], v[44:47]
    ds_read2_b32 v[68:69], v236 offset0:160 offset1:161
    v_mfma_f32_16x16x32_bf16 v[44:47], v[136:139], v[164:167], v[44:47]
    s_add_u32 m0, s73, 147456
    v_mfma_f32_16x16x32_bf16 v[44:47], v[132:135], v[168:171], v[44:47]
    buffer_load_dwordx4 v7, s[52:55], s14 offen offset:3072 lds
    ds_read2_b32 v[70:71], v236 offset0:162 offset1:163
    v_mfma_f32_16x16x32_bf16 v[44:47], v[128:131], v[172:175], v[44:47]
    ds_read_b128 v[104:107], v246 offset:10240
    s_waitcnt lgkmcnt(12)
    v_mfma_f32_16x16x32_bf16 v[48:51], v[128:131], v[176:179], v[48:51]
    ds_read2_b32 v[72:73], v237 offset0:32 offset1:33
    v_mfma_f32_16x16x32_bf16 v[48:51], v[132:135], v[172:175], v[48:51]
    v_mfma_f32_16x16x32_bf16 v[48:51], v[136:139], v[168:171], v[48:51]
    ds_read2_b32 v[74:75], v237 offset0:34 offset1:35
    v_mfma_f32_16x16x32_bf16 v[48:51], v[140:143], v[164:167], v[48:51]
    ds_read_b128 v[108:111], v246 offset:14336
    v_mfma_f32_16x16x32_bf16 v[48:51], v[144:147], v[160:163], v[48:51]
    s_waitcnt lgkmcnt(10)
    s_barrier
    v_mfma_f32_16x16x32_bf16 v[52:55], v[148:151], v[160:163], v[52:55]
    ds_read2_b32 v[76:77], v237 offset0:160 offset1:161
    v_mfma_f32_16x16x32_bf16 v[52:55], v[144:147], v[164:167], v[52:55]
    ds_read2_b32 v[78:79], v237 offset0:162 offset1:163
    v_mfma_f32_16x16x32_bf16 v[52:55], v[140:143], v[168:171], v[52:55]
    v_mfma_f32_16x16x32_bf16 v[52:55], v[136:139], v[172:175], v[52:55]
    s_lshl_b32 s14, s97, 18
    ds_read_b128 v[112:115], v246 offset:18432
    v_mfma_f32_16x16x32_bf16 v[52:55], v[132:135], v[176:179], v[52:55]
    s_add_u32 m0, s73, 0
    ds_read2_b32 v[80:81], v238 offset0:32 offset1:33
    v_mfma_f32_16x16x32_bf16 v[52:55], v[128:131], v[180:183], v[52:55]
    buffer_load_dwordx4 v4, s[52:55], s14 offen offset:0 lds
    v_mfma_f32_16x16x32_bf16 v[56:59], v[128:131], v[184:187], v[56:59]
    ds_read2_b32 v[82:83], v238 offset0:34 offset1:35
    v_mfma_f32_16x16x32_bf16 v[56:59], v[132:135], v[180:183], v[56:59]
    ds_read_b128 v[116:119], v246 offset:22528
    v_mfma_f32_16x16x32_bf16 v[56:59], v[136:139], v[176:179], v[56:59]
    v_mfma_f32_16x16x32_bf16 v[56:59], v[140:143], v[172:175], v[56:59]
    ds_read2_b32 v[84:85], v238 offset0:160 offset1:161
    v_mfma_f32_16x16x32_bf16 v[56:59], v[144:147], v[168:171], v[56:59]
    ds_read2_b32 v[86:87], v238 offset0:162 offset1:163
    v_mfma_f32_16x16x32_bf16 v[56:59], v[148:151], v[164:167], v[56:59]
    ds_read_b128 v[120:123], v246 offset:26624
    v_mfma_f32_16x16x32_bf16 v[56:59], v[152:155], v[160:163], v[56:59]
    v_mfma_f32_16x16x32_bf16 v[60:63], v[156:159], v[160:163], v[60:63]
    ds_read2_b32 v[88:89], v239 offset0:32 offset1:33
    v_mfma_f32_16x16x32_bf16 v[60:63], v[152:155], v[164:167], v[60:63]
    ds_read2_b32 v[90:91], v239 offset0:34 offset1:35
    v_mfma_f32_16x16x32_bf16 v[60:63], v[148:151], v[168:171], v[60:63]
    s_add_u32 m0, s73, 0
    v_mfma_f32_16x16x32_bf16 v[60:63], v[144:147], v[172:175], v[60:63]
    buffer_load_dwordx4 v5, s[52:55], s14 offen offset:1024 lds
    ds_read_b128 v[124:127], v246 offset:30720
    v_mfma_f32_16x16x32_bf16 v[60:63], v[140:143], v[176:179], v[60:63]
    ds_read2_b32 v[92:93], v239 offset0:160 offset1:161
    v_mfma_f32_16x16x32_bf16 v[60:63], v[136:139], v[180:183], v[60:63]
    v_mfma_f32_16x16x32_bf16 v[60:63], v[132:135], v[184:187], v[60:63]
    ds_read2_b32 v[94:95], v239 offset0:162 offset1:163
    v_mfma_f32_16x16x32_bf16 v[60:63], v[128:131], v[188:191], v[60:63]
    s_waitcnt lgkmcnt(12)
    v_mfma_f32_16x16x32_bf16 v[32:35], v[64:67], v[96:99], v[32:35]
    ds_read_b128 v[160:163], v247 offset:2048
    s_waitcnt vmcnt(12)
    s_barrier
    v_mfma_f32_16x16x32_bf16 v[36:39], v[68:71], v[96:99], v[36:39]
    ds_read_b64_tr_b16 a[176:177], v10 offset:16384
    v_mfma_f32_16x16x32_bf16 v[36:39], v[64:67], v[100:103], v[36:39]
    ds_read_b64_tr_b16 a[178:179], v10 offset:18432
    v_mfma_f32_16x16x32_bf16 v[40:43], v[64:67], v[104:107], v[40:43]
    ds_read2_b32 v[128:129], v236 offset0:48 offset1:49
    v_mfma_f32_16x16x32_bf16 v[40:43], v[68:71], v[100:103], v[40:43]
    ds_read_b64_tr_b16 a[184:185], v10 offset:20480
    v_mfma_f32_16x16x32_bf16 v[40:43], v[72:75], v[96:99], v[40:43]
    ds_read_b64_tr_b16 a[186:187], v10 offset:22528
    v_mfma_f32_16x16x32_bf16 v[44:47], v[76:79], v[96:99], v[44:47]
    s_add_u32 m0, s73, 0
    ds_read2_b32 v[130:131], v236 offset0:50 offset1:51
    v_mfma_f32_16x16x32_bf16 v[44:47], v[72:75], v[100:103], v[44:47]
    ds_read_b64_tr_b16 a[180:181], v11 offset:16384
    buffer_load_dwordx4 v6, s[52:55], s14 offen offset:2048 lds
    v_mfma_f32_16x16x32_bf16 v[44:47], v[68:71], v[104:107], v[44:47]
    ds_read_b64_tr_b16 a[182:183], v11 offset:18432
    v_mfma_f32_16x16x32_bf16 v[44:47], v[64:67], v[108:111], v[44:47]
    ds_read_b128 v[164:167], v247 offset:6144
    s_waitcnt lgkmcnt(10)
    v_mfma_f32_16x16x32_bf16 v[48:51], v[64:67], v[112:115], v[48:51]
    ds_read_b64_tr_b16 a[188:189], v11 offset:20480
    v_mfma_f32_16x16x32_bf16 v[48:51], v[68:71], v[108:111], v[48:51]
    ds_read_b64_tr_b16 a[190:191], v11 offset:22528
    v_mfma_f32_16x16x32_bf16 v[48:51], v[72:75], v[104:107], v[48:51]
    ds_read2_b32 v[132:133], v236 offset0:176 offset1:177
    v_mfma_f32_16x16x32_bf16 v[48:51], v[76:79], v[100:103], v[48:51]
    ds_read2_b32 v[134:135], v236 offset0:178 offset1:179
    v_mfma_f32_16x16x32_bf16 v[48:51], v[80:83], v[96:99], v[48:51]
    ds_read_b128 v[168:171], v247 offset:10240
    v_mfma_f32_16x16x32_bf16 v[52:55], v[84:87], v[96:99], v[52:55]
    ds_read2_b32 v[136:137], v237 offset0:48 offset1:49
    v_mfma_f32_16x16x32_bf16 v[52:55], v[80:83], v[100:103], v[52:55]
    ds_read2_b32 v[138:139], v237 offset0:50 offset1:51
    v_mfma_f32_16x16x32_bf16 v[52:55], v[76:79], v[104:107], v[52:55]
    ds_read_b128 v[172:175], v247 offset:14336
    v_mfma_f32_16x16x32_bf16 v[52:55], v[72:75], v[108:111], v[52:55]
    s_add_u32 m0, s73, 0
    ds_read2_b32 v[140:141], v237 offset0:176 offset1:177
    v_mfma_f32_16x16x32_bf16 v[52:55], v[68:71], v[112:115], v[52:55]
    buffer_load_dwordx4 v7, s[52:55], s14 offen offset:3072 lds
    ds_read2_b32 v[142:143], v237 offset0:178 offset1:179
    v_mfma_f32_16x16x32_bf16 v[52:55], v[64:67], v[116:119], v[52:55]
    ds_read_b128 v[176:179], v247 offset:18432
    v_mfma_f32_16x16x32_bf16 v[56:59], v[64:67], v[120:123], v[56:59]
    ds_read2_b32 v[144:145], v238 offset0:48 offset1:49
    v_mfma_f32_16x16x32_bf16 v[56:59], v[68:71], v[116:119], v[56:59]
    ds_read2_b32 v[146:147], v238 offset0:50 offset1:51
    v_mfma_f32_16x16x32_bf16 v[56:59], v[72:75], v[112:115], v[56:59]
    ds_read_b128 v[180:183], v247 offset:22528
    v_mfma_f32_16x16x32_bf16 v[56:59], v[76:79], v[108:111], v[56:59]
    ds_read2_b32 v[148:149], v238 offset0:176 offset1:177
    v_mfma_f32_16x16x32_bf16 v[56:59], v[80:83], v[104:107], v[56:59]
    ds_read2_b32 v[150:151], v238 offset0:178 offset1:179
    s_waitcnt lgkmcnt(14)
    s_barrier
    v_mfma_f32_16x16x32_bf16 v[56:59], v[84:87], v[100:103], v[56:59]
    ds_read_b128 v[184:187], v247 offset:26624
    v_mfma_f32_16x16x32_bf16 v[56:59], v[88:91], v[96:99], v[56:59]
    v_mfma_f32_16x16x32_bf16 v[60:63], v[92:95], v[96:99], v[60:63]
    s_lshl_b32 s14, s98, 18
    ds_read2_b32 v[152:153], v239 offset0:48 offset1:49
    v_mfma_f32_16x16x32_bf16 v[60:63], v[88:91], v[100:103], v[60:63]
    s_add_u32 m0, s73, 16384
    ds_read2_b32 v[154:155], v239 offset0:50 offset1:51
    v_mfma_f32_16x16x32_bf16 v[60:63], v[84:87], v[104:107], v[60:63]
    buffer_load_dwordx4 v4, s[52:55], s14 offen offset:0 lds
    v_mfma_f32_16x16x32_bf16 v[60:63], v[80:83], v[108:111], v[60:63]
    ds_read_b128 v[188:191], v247 offset:30720
    v_mfma_f32_16x16x32_bf16 v[60:63], v[76:79], v[112:115], v[60:63]
    ds_read2_b32 v[156:157], v239 offset0:176 offset1:177
    v_mfma_f32_16x16x32_bf16 v[60:63], v[72:75], v[116:119], v[60:63]
    v_mfma_f32_16x16x32_bf16 v[60:63], v[68:71], v[120:123], v[60:63]
    ds_read2_b32 v[158:159], v239 offset0:178 offset1:179
    v_mfma_f32_16x16x32_bf16 v[60:63], v[64:67], v[124:127], v[60:63]
    s_waitcnt lgkmcnt(12)
    v_mfma_f32_16x16x32_bf16 v[32:35], v[128:131], v[160:163], v[32:35]
    ds_read_b128 v[96:99], v244 offset:0
    v_mfma_f32_16x16x32_bf16 v[36:39], v[132:135], v[160:163], v[36:39]
    v_mfma_f32_16x16x32_bf16 v[36:39], v[128:131], v[164:167], v[36:39]
    ds_read2_b32 v[64:65], v236 offset0:64 offset1:65
    v_mfma_f32_16x16x32_bf16 v[40:43], v[128:131], v[168:171], v[40:43]
    ds_read2_b32 v[66:67], v236 offset0:66 offset1:67
    v_mfma_f32_16x16x32_bf16 v[40:43], v[132:135], v[164:167], v[40:43]
    v_mfma_f32_16x16x32_bf16 v[40:43], v[136:139], v[160:163], v[40:43]
    s_add_u32 m0, s73, 16384
    ds_read_b128 v[100:103], v244 offset:4096
    v_mfma_f32_16x16x32_bf16 v[44:47], v[140:143], v[160:163], v[44:47]
    buffer_load_dwordx4 v5, s[52:55], s14 offen offset:1024 lds
    ds_read2_b32 v[68:69], v236 offset0:192 offset1:193
    v_mfma_f32_16x16x32_bf16 v[44:47], v[136:139], v[164:167], v[44:47]
    v_mfma_f32_16x16x32_bf16 v[44:47], v[132:135], v[168:171], v[44:47]
    ds_read2_b32 v[70:71], v236 offset0:194 offset1:195
    v_mfma_f32_16x16x32_bf16 v[44:47], v[128:131], v[172:175], v[44:47]
    ds_read_b128 v[104:107], v244 offset:8192
    s_waitcnt lgkmcnt(7)
    v_mfma_f32_16x16x32_bf16 v[48:51], v[128:131], v[176:179], v[48:51]
    ds_read2_b32 v[72:73], v237 offset0:64 offset1:65
    v_mfma_f32_16x16x32_bf16 v[48:51], v[132:135], v[172:175], v[48:51]
    ds_read2_b32 v[74:75], v237 offset0:66 offset1:67
    v_mfma_f32_16x16x32_bf16 v[48:51], v[136:139], v[168:171], v[48:51]
    ds_read_b128 v[108:111], v244 offset:12288
    v_mfma_f32_16x16x32_bf16 v[48:51], v[140:143], v[164:167], v[48:51]
    ds_read2_b32 v[76:77], v237 offset0:192 offset1:193
    v_mfma_f32_16x16x32_bf16 v[48:51], v[144:147], v[160:163], v[48:51]
    ds_read2_b32 v[78:79], v237 offset0:194 offset1:195
    s_waitcnt vmcnt(6)
    s_barrier
    v_mfma_f32_16x16x32_bf16 v[52:55], v[148:151], v[160:163], v[52:55]
    ds_read_b128 v[112:115], v244 offset:16384
    v_add_u32 v10, 131072, v10
    v_mfma_f32_16x16x32_bf16 v[52:55], v[144:147], v[164:167], v[52:55]
    ds_read_b64_tr_b16 a[192:193], v10 offset:16384
    v_mfma_f32_16x16x32_bf16 v[52:55], v[140:143], v[168:171], v[52:55]
    ds_read_b64_tr_b16 a[194:195], v10 offset:18432
    s_add_u32 m0, s73, 16384
    v_mfma_f32_16x16x32_bf16 v[52:55], v[136:139], v[172:175], v[52:55]
    buffer_load_dwordx4 v6, s[52:55], s14 offen offset:2048 lds
    ds_read2_b32 v[80:81], v238 offset0:64 offset1:65
    v_mfma_f32_16x16x32_bf16 v[52:55], v[132:135], v[176:179], v[52:55]
    ds_read_b64_tr_b16 a[200:201], v10 offset:20480
    v_mfma_f32_16x16x32_bf16 v[52:55], v[128:131], v[180:183], v[52:55]
    ds_read_b64_tr_b16 a[202:203], v10 offset:22528
    v_mfma_f32_16x16x32_bf16 v[56:59], v[128:131], v[184:187], v[56:59]
    ds_read2_b32 v[82:83], v238 offset0:66 offset1:67
    v_add_u32 v11, 131072, v11
    v_mfma_f32_16x16x32_bf16 v[56:59], v[132:135], v[180:183], v[56:59]
    ds_read_b64_tr_b16 a[196:197], v11 offset:16384
    v_mfma_f32_16x16x32_bf16 v[56:59], v[136:139], v[176:179], v[56:59]
    ds_read_b64_tr_b16 a[198:199], v11 offset:18432
    v_mfma_f32_16x16x32_bf16 v[56:59], v[140:143], v[172:175], v[56:59]
    ds_read_b128 v[116:119], v244 offset:20480
    v_mfma_f32_16x16x32_bf16 v[56:59], v[144:147], v[168:171], v[56:59]
    ds_read_b64_tr_b16 a[204:205], v11 offset:20480
    v_mfma_f32_16x16x32_bf16 v[56:59], v[148:151], v[164:167], v[56:59]
    ds_read_b64_tr_b16 a[206:207], v11 offset:22528
    v_mfma_f32_16x16x32_bf16 v[56:59], v[152:155], v[160:163], v[56:59]
    ds_read2_b32 v[84:85], v238 offset0:192 offset1:193
    v_mfma_f32_16x16x32_bf16 v[60:63], v[156:159], v[160:163], v[60:63]
    s_add_u32 m0, s73, 16384
    ds_read2_b32 v[86:87], v238 offset0:194 offset1:195
    v_mfma_f32_16x16x32_bf16 v[60:63], v[152:155], v[164:167], v[60:63]
    buffer_load_dwordx4 v7, s[52:55], s14 offen offset:3072 lds
    ds_read_b128 v[120:123], v244 offset:24576
    v_mfma_f32_16x16x32_bf16 v[60:63], v[148:151], v[168:171], v[60:63]
    ds_read2_b32 v[88:89], v239 offset0:64 offset1:65
    v_mfma_f32_16x16x32_bf16 v[60:63], v[144:147], v[172:175], v[60:63]
    ds_read2_b32 v[90:91], v239 offset0:66 offset1:67
    v_mfma_f32_16x16x32_bf16 v[60:63], v[140:143], v[176:179], v[60:63]
    ds_read_b128 v[124:127], v244 offset:28672
    v_mfma_f32_16x16x32_bf16 v[60:63], v[136:139], v[180:183], v[60:63]
    ds_read2_b32 v[92:93], v239 offset0:192 offset1:193
    v_mfma_f32_16x16x32_bf16 v[60:63], v[132:135], v[184:187], v[60:63]
    ds_read2_b32 v[94:95], v239 offset0:194 offset1:195
    v_mfma_f32_16x16x32_bf16 v[60:63], v[128:131], v[188:191], v[60:63]
    s_waitcnt lgkmcnt(15)
    v_mfma_f32_16x16x32_bf16 v[32:35], v[64:67], v[96:99], v[32:35]
    ds_read_b128 v[160:163], v245 offset:0
    v_mfma_f32_16x16x32_bf16 v[36:39], v[68:71], v[96:99], v[36:39]
    v_mfma_f32_16x16x32_bf16 v[36:39], v[64:67], v[100:103], v[36:39]
    ds_read2_b32 v[128:129], v236 offset0:80 offset1:81
    v_mfma_f32_16x16x32_bf16 v[40:43], v[64:67], v[104:107], v[40:43]
    ds_read2_b32 v[130:131], v236 offset0:82 offset1:83
    s_waitcnt lgkmcnt(11)
    s_barrier
    v_mfma_f32_16x16x32_bf16 v[40:43], v[68:71], v[100:103], v[40:43]
    v_mfma_f32_16x16x32_bf16 v[40:43], v[72:75], v[96:99], v[40:43]
    ds_read_b128 v[164:167], v245 offset:4096
    v_mfma_f32_16x16x32_bf16 v[44:47], v[76:79], v[96:99], v[44:47]
    ds_read2_b32 v[132:133], v236 offset0:208 offset1:209
    v_mfma_f32_16x16x32_bf16 v[44:47], v[72:75], v[100:103], v[44:47]
    s_lshl_b32 s14, s99, 18
    v_mfma_f32_16x16x32_bf16 v[44:47], v[68:71], v[104:107], v[44:47]
    s_add_u32 m0, s73, 147456
    ds_read2_b32 v[134:135], v236 offset0:210 offset1:211
    v_mfma_f32_16x16x32_bf16 v[44:47], v[64:67], v[108:111], v[44:47]
    buffer_load_dwordx4 v4, s[52:55], s14 offen offset:0 lds
    ds_read_b128 v[168:171], v245 offset:8192
    s_waitcnt lgkmcnt(7)
    v_mfma_f32_16x16x32_bf16 v[48:51], v[64:67], v[112:115], v[48:51]
    ds_read2_b32 v[136:137], v237 offset0:80 offset1:81
    v_mfma_f32_16x16x32_bf16 v[48:51], v[68:71], v[108:111], v[48:51]
    v_mfma_f32_16x16x32_bf16 v[48:51], v[72:75], v[104:107], v[48:51]
    ds_read2_b32 v[138:139], v237 offset0:82 offset1:83
    v_mfma_f32_16x16x32_bf16 v[48:51], v[76:79], v[100:103], v[48:51]
    ds_read_b128 v[172:175], v245 offset:12288
    v_mfma_f32_16x16x32_bf16 v[48:51], v[80:83], v[96:99], v[48:51]
    ds_read2_b32 v[140:141], v237 offset0:208 offset1:209
    v_mfma_f32_16x16x32_bf16 v[52:55], v[84:87], v[96:99], v[52:55]
    ds_read2_b32 v[142:143], v237 offset0:210 offset1:211
    v_mfma_f32_16x16x32_bf16 v[52:55], v[80:83], v[100:103], v[52:55]
    ds_read_b128 v[176:179], v245 offset:16384
    v_mfma_f32_16x16x32_bf16 v[52:55], v[76:79], v[104:107], v[52:55]
    ds_read2_b32 v[144:145], v238 offset0:80 offset1:81
    v_mfma_f32_16x16x32_bf16 v[52:55], v[72:75], v[108:111], v[52:55]
    ds_read2_b32 v[146:147], v238 offset0:82 offset1:83
    v_mfma_f32_16x16x32_bf16 v[52:55], v[68:71], v[112:115], v[52:55]
    s_add_u32 m0, s73, 147456
    ds_read_b128 v[180:183], v245 offset:20480
    v_mfma_f32_16x16x32_bf16 v[52:55], v[64:67], v[116:119], v[52:55]
    buffer_load_dwordx4 v5, s[52:55], s14 offen offset:1024 lds
    ds_read2_b32 v[148:149], v238 offset0:208 offset1:209
    v_mfma_f32_16x16x32_bf16 v[56:59], v[64:67], v[120:123], v[56:59]
    ds_read2_b32 v[150:151], v238 offset0:210 offset1:211
    v_mfma_f32_16x16x32_bf16 v[56:59], v[68:71], v[116:119], v[56:59]
    ds_read_b128 v[184:187], v245 offset:24576
    v_mfma_f32_16x16x32_bf16 v[56:59], v[72:75], v[112:115], v[56:59]
    ds_read2_b32 v[152:153], v239 offset0:80 offset1:81
    v_mfma_f32_16x16x32_bf16 v[56:59], v[76:79], v[108:111], v[56:59]
    ds_read2_b32 v[154:155], v239 offset0:82 offset1:83
    v_mfma_f32_16x16x32_bf16 v[56:59], v[80:83], v[104:107], v[56:59]
    ds_read_b128 v[188:191], v245 offset:28672
    s_waitcnt vmcnt(6)
    s_barrier
    v_mfma_f32_16x16x32_bf16 v[56:59], v[84:87], v[100:103], v[56:59]
    ds_read2_b32 v[156:157], v239 offset0:208 offset1:209
    v_add_u32 v10, -131072, v10
    v_mfma_f32_16x16x32_bf16 v[56:59], v[88:91], v[96:99], v[56:59]
    ds_read_b64_tr_b16 a[208:209], v10 offset:0
    v_mfma_f32_16x16x32_bf16 v[60:63], v[92:95], v[96:99], v[60:63]
    ds_read_b64_tr_b16 a[210:211], v10 offset:2048
    v_mfma_f32_16x16x32_bf16 v[60:63], v[88:91], v[100:103], v[60:63]
    ds_read_b64_tr_b16 a[216:217], v10 offset:4096
    v_mfma_f32_16x16x32_bf16 v[60:63], v[84:87], v[104:107], v[60:63]
    ds_read2_b32 v[158:159], v239 offset0:210 offset1:211
    v_mfma_f32_16x16x32_bf16 v[60:63], v[80:83], v[108:111], v[60:63]
    ds_read_b64_tr_b16 a[218:219], v10 offset:6144
    s_add_u32 m0, s73, 147456
    v_mfma_f32_16x16x32_bf16 v[60:63], v[76:79], v[112:115], v[60:63]
    v_add_u32 v11, -131072, v11
    buffer_load_dwordx4 v6, s[52:55], s14 offen offset:2048 lds
    v_mfma_f32_16x16x32_bf16 v[60:63], v[72:75], v[116:119], v[60:63]
    ds_read_b64_tr_b16 a[212:213], v11 offset:0
    v_mfma_f32_16x16x32_bf16 v[60:63], v[68:71], v[120:123], v[60:63]
    ds_read_b64_tr_b16 a[214:215], v11 offset:2048
    v_mfma_f32_16x16x32_bf16 v[60:63], v[64:67], v[124:127], v[60:63]
    ds_read_b64_tr_b16 a[220:221], v11 offset:4096
    s_waitcnt lgkmcnt(15)
    v_mfma_f32_16x16x32_bf16 v[32:35], v[128:131], v[160:163], v[32:35]
    ds_read_b64_tr_b16 a[222:223], v11 offset:6144
    v_mfma_f32_16x16x32_bf16 v[36:39], v[132:135], v[160:163], v[36:39]
    ds_read_b128 v[96:99], v246 offset:0
    v_mfma_f32_16x16x32_bf16 v[36:39], v[128:131], v[164:167], v[36:39]
    ds_read2_b32 v[64:65], v236 offset0:96 offset1:97
    v_mfma_f32_16x16x32_bf16 v[40:43], v[128:131], v[168:171], v[40:43]
    ds_read2_b32 v[66:67], v236 offset0:98 offset1:99
    v_mfma_f32_16x16x32_bf16 v[40:43], v[132:135], v[164:167], v[40:43]
    v_mfma_f32_16x16x32_bf16 v[40:43], v[136:139], v[160:163], v[40:43]
    ds_read_b128 v[100:103], v246 offset:4096
    v_mfma_f32_16x16x32_bf16 v[44:47], v[140:143], v[160:163], v[44:47]
    ds_read2_b32 v[68:69], v236 offset0:224 offset1:225
    v_mfma_f32_16x16x32_bf16 v[44:47], v[136:139], v[164:167], v[44:47]
    s_add_u32 m0, s73, 147456
    v_mfma_f32_16x16x32_bf16 v[44:47], v[132:135], v[168:171], v[44:47]
    buffer_load_dwordx4 v7, s[52:55], s14 offen offset:3072 lds
    ds_read2_b32 v[70:71], v236 offset0:226 offset1:227
    v_mfma_f32_16x16x32_bf16 v[44:47], v[128:131], v[172:175], v[44:47]
    ds_read_b128 v[104:107], v246 offset:8192
    s_waitcnt lgkmcnt(12)
    v_mfma_f32_16x16x32_bf16 v[48:51], v[128:131], v[176:179], v[48:51]
    ds_read2_b32 v[72:73], v237 offset0:96 offset1:97
    v_mfma_f32_16x16x32_bf16 v[48:51], v[132:135], v[172:175], v[48:51]
    v_mfma_f32_16x16x32_bf16 v[48:51], v[136:139], v[168:171], v[48:51]
    ds_read2_b32 v[74:75], v237 offset0:98 offset1:99
    v_mfma_f32_16x16x32_bf16 v[48:51], v[140:143], v[164:167], v[48:51]
    ds_read_b128 v[108:111], v246 offset:12288
    v_mfma_f32_16x16x32_bf16 v[48:51], v[144:147], v[160:163], v[48:51]
    s_waitcnt lgkmcnt(10)
    s_barrier
    v_mfma_f32_16x16x32_bf16 v[52:55], v[148:151], v[160:163], v[52:55]
    ds_read2_b32 v[76:77], v237 offset0:224 offset1:225
    v_mfma_f32_16x16x32_bf16 v[52:55], v[144:147], v[164:167], v[52:55]
    ds_read2_b32 v[78:79], v237 offset0:226 offset1:227
    v_mfma_f32_16x16x32_bf16 v[52:55], v[140:143], v[168:171], v[52:55]
    v_mfma_f32_16x16x32_bf16 v[52:55], v[136:139], v[172:175], v[52:55]
    s_lshl_b32 s14, s100, 18
    ds_read_b128 v[112:115], v246 offset:16384
    v_mfma_f32_16x16x32_bf16 v[52:55], v[132:135], v[176:179], v[52:55]
    s_add_u32 m0, s73, 0
    ds_read2_b32 v[80:81], v238 offset0:96 offset1:97
    v_mfma_f32_16x16x32_bf16 v[52:55], v[128:131], v[180:183], v[52:55]
    buffer_load_dwordx4 v4, s[52:55], s14 offen offset:0 lds
    v_mfma_f32_16x16x32_bf16 v[56:59], v[128:131], v[184:187], v[56:59]
    ds_read2_b32 v[82:83], v238 offset0:98 offset1:99
    v_mfma_f32_16x16x32_bf16 v[56:59], v[132:135], v[180:183], v[56:59]
    ds_read_b128 v[116:119], v246 offset:20480
    v_mfma_f32_16x16x32_bf16 v[56:59], v[136:139], v[176:179], v[56:59]
    v_mfma_f32_16x16x32_bf16 v[56:59], v[140:143], v[172:175], v[56:59]
    ds_read2_b32 v[84:85], v238 offset0:224 offset1:225
    v_mfma_f32_16x16x32_bf16 v[56:59], v[144:147], v[168:171], v[56:59]
    ds_read2_b32 v[86:87], v238 offset0:226 offset1:227
    v_mfma_f32_16x16x32_bf16 v[56:59], v[148:151], v[164:167], v[56:59]
    ds_read_b128 v[120:123], v246 offset:24576
    v_mfma_f32_16x16x32_bf16 v[56:59], v[152:155], v[160:163], v[56:59]
    v_mfma_f32_16x16x32_bf16 v[60:63], v[156:159], v[160:163], v[60:63]
    ds_read2_b32 v[88:89], v239 offset0:96 offset1:97
    v_mfma_f32_16x16x32_bf16 v[60:63], v[152:155], v[164:167], v[60:63]
    s_add_u32 m0, s73, 0
    ds_read2_b32 v[90:91], v239 offset0:98 offset1:99
    v_mfma_f32_16x16x32_bf16 v[60:63], v[148:151], v[168:171], v[60:63]
    buffer_load_dwordx4 v5, s[52:55], s14 offen offset:1024 lds
    v_mfma_f32_16x16x32_bf16 v[60:63], v[144:147], v[172:175], v[60:63]
    ds_read_b128 v[124:127], v246 offset:28672
    v_mfma_f32_16x16x32_bf16 v[60:63], v[140:143], v[176:179], v[60:63]
    ds_read2_b32 v[92:93], v239 offset0:224 offset1:225
    v_mfma_f32_16x16x32_bf16 v[60:63], v[136:139], v[180:183], v[60:63]
    v_mfma_f32_16x16x32_bf16 v[60:63], v[132:135], v[184:187], v[60:63]
    ds_read2_b32 v[94:95], v239 offset0:226 offset1:227
    v_mfma_f32_16x16x32_bf16 v[60:63], v[128:131], v[188:191], v[60:63]
    s_waitcnt lgkmcnt(12)
    v_mfma_f32_16x16x32_bf16 v[32:35], v[64:67], v[96:99], v[32:35]
    ds_read_b128 v[160:163], v247 offset:0
    s_waitcnt vmcnt(6)
    s_barrier
    v_mfma_f32_16x16x32_bf16 v[36:39], v[68:71], v[96:99], v[36:39]
    ds_read_b64_tr_b16 a[224:225], v10 offset:16384
    s_bfe_u32 s4, s2, 0x20003
    v_mfma_f32_16x16x32_bf16 v[36:39], v[64:67], v[100:103], v[36:39]
    ds_read_b64_tr_b16 a[226:227], v10 offset:18432
    ds_read_b128 v[164:167], v247 offset:4096
    v_mfma_f32_16x16x32_bf16 v[40:43], v[64:67], v[104:107], v[40:43]
    s_lshl2_add_u32 s4, s72, s4
    ds_read_b128 v[168:171], v247 offset:8192
    v_mfma_f32_16x16x32_bf16 v[40:43], v[68:71], v[100:103], v[40:43]
    ds_read_b64_tr_b16 a[232:233], v10 offset:20480
    s_add_u32 m0, s73, 0
    ds_read_b128 v[172:175], v247 offset:12288
    v_mfma_f32_16x16x32_bf16 v[40:43], v[72:75], v[96:99], v[40:43]
    ds_read_b64_tr_b16 a[234:235], v10 offset:22528
    buffer_load_dwordx4 v6, s[52:55], s14 offen offset:2048 lds
    s_lshl_b32 s4, s4, 2
    v_mfma_f32_16x16x32_bf16 v[44:47], v[76:79], v[96:99], v[44:47]
    ds_read_b128 v[176:179], v247 offset:16384
    v_mfma_f32_16x16x32_bf16 v[44:47], v[72:75], v[100:103], v[44:47]
    ds_read_b64_tr_b16 a[228:229], v11 offset:16384
    s_lshr_b32 s5, s2, 4
    ds_read_b128 v[180:183], v247 offset:20480
    v_mfma_f32_16x16x32_bf16 v[44:47], v[68:71], v[104:107], v[44:47]
    ds_read_b64_tr_b16 a[230:231], v11 offset:18432
    v_mfma_f32_16x16x32_bf16 v[44:47], v[64:67], v[108:111], v[44:47]
    s_and_b32 s5, s5, 2
    ds_read_b128 v[184:187], v247 offset:24576
    s_waitcnt lgkmcnt(13)
    v_mfma_f32_16x16x32_bf16 v[48:51], v[64:67], v[112:115], v[48:51]
    ds_read_b64_tr_b16 a[236:237], v11 offset:20480
    ds_read_b128 v[188:191], v247 offset:28672
    v_mfma_f32_16x16x32_bf16 v[48:51], v[68:71], v[108:111], v[48:51]
    ds_read_b64_tr_b16 a[238:239], v11 offset:22528
    s_add_u32 s4, s4, s5
    v_mfma_f32_16x16x32_bf16 v[48:51], v[72:75], v[104:107], v[48:51]
    ds_read2_b32 v[128:129], v236 offset0:112 offset1:113
    v_mfma_f32_16x16x32_bf16 v[48:51], v[76:79], v[100:103], v[48:51]
    s_and_b32 s5, s2, 1
    ds_read2_b32 v[130:131], v236 offset0:114 offset1:115
    v_mfma_f32_16x16x32_bf16 v[48:51], v[80:83], v[96:99], v[48:51]
    ds_read2_b32 v[132:133], v236 offset0:240 offset1:241
    v_mfma_f32_16x16x32_bf16 v[52:55], v[84:87], v[96:99], v[52:55]
    s_add_u32 m0, s73, 0
    ds_read2_b32 v[134:135], v236 offset0:242 offset1:243
    s_add_u32 s4, s4, s5
    v_mfma_f32_16x16x32_bf16 v[52:55], v[80:83], v[100:103], v[52:55]
    buffer_load_dwordx4 v7, s[52:55], s14 offen offset:3072 lds
    ds_read2_b32 v[136:137], v237 offset0:112 offset1:113
    v_mfma_f32_16x16x32_bf16 v[52:55], v[76:79], v[104:107], v[52:55]
    s_lshl_b32 s4, s4, 7
    ds_read2_b32 v[138:139], v237 offset0:114 offset1:115
    v_mfma_f32_16x16x32_bf16 v[52:55], v[72:75], v[108:111], v[52:55]
    s_add_u32 s4, s4, 12566528
    ds_read2_b32 v[140:141], v237 offset0:240 offset1:241
    s_add_u32 s6, s12, 4767744
    v_mfma_f32_16x16x32_bf16 v[52:55], v[68:71], v[112:115], v[52:55]
    ds_read2_b32 v[142:143], v237 offset0:242 offset1:243
    v_mfma_f32_16x16x32_bf16 v[52:55], v[64:67], v[116:119], v[52:55]
    ds_read2_b32 v[144:145], v238 offset0:112 offset1:113
    v_lshl_add_u32 v28, v2, 2, s4
    v_mfma_f32_16x16x32_bf16 v[56:59], v[64:67], v[120:123], v[56:59]
    s_waitcnt lgkmcnt(9)
    s_barrier
    v_mfma_f32_16x16x32_bf16 v[56:59], v[68:71], v[116:119], v[56:59]
    ds_read2_b32 v[146:147], v238 offset0:114 offset1:115
    s_cmp_eq_u32 s3, 0
    s_cselect_b32 s4, 18, 0
    v_mfma_f32_16x16x32_bf16 v[56:59], v[72:75], v[112:115], v[56:59]
    ds_read2_b32 v[148:149], v238 offset0:240 offset1:241
    v_mfma_f32_16x16x32_bf16 v[56:59], v[76:79], v[108:111], v[56:59]
    ds_read2_b32 v[150:151], v238 offset0:242 offset1:243
    v_cmp_gt_u32 vcc, s4, v2
    v_mfma_f32_16x16x32_bf16 v[56:59], v[80:83], v[104:107], v[56:59]
    s_lshl_b32 s14, s101, 18
    ds_read2_b32 v[152:153], v239 offset0:112 offset1:113
    v_mfma_f32_16x16x32_bf16 v[56:59], v[84:87], v[100:103], v[56:59]
    ds_read2_b32 v[154:155], v239 offset0:114 offset1:115
    s_add_u32 m0, s73, 16384
    v_mov_b32 v13, 0x40000000
    v_mfma_f32_16x16x32_bf16 v[56:59], v[88:91], v[96:99], v[56:59]
    buffer_load_dwordx4 v4, s[52:55], s14 offen offset:0 lds
    ds_read2_b32 v[156:157], v239 offset0:240 offset1:241
    v_mfma_f32_16x16x32_bf16 v[60:63], v[92:95], v[96:99], v[60:63]
    ds_read2_b32 v[158:159], v239 offset0:242 offset1:243
    v_cndmask_b32 v28, v13, v28, vcc
    v_mfma_f32_16x16x32_bf16 v[60:63], v[88:91], v[100:103], v[60:63]
    v_mfma_f32_16x16x32_bf16 v[60:63], v[84:87], v[104:107], v[60:63]
    v_mov_b32 v13, s68
    v_mfma_f32_16x16x32_bf16 v[60:63], v[80:83], v[108:111], v[60:63]
    v_mfma_f32_16x16x32_bf16 v[60:63], v[76:79], v[112:115], v[60:63]
    v_cndmask_b32 v13, 0, v13, vcc
    v_mfma_f32_16x16x32_bf16 v[60:63], v[72:75], v[116:119], v[60:63]
    v_mfma_f32_16x16x32_bf16 v[60:63], v[68:71], v[120:123], v[60:63]
    v_mfma_f32_16x16x32_bf16 v[60:63], v[64:67], v[124:127], v[60:63]
    s_waitcnt lgkmcnt(0)
    v_mfma_f32_16x16x32_bf16 v[60:63], v[128:131], v[188:191], v[60:63]
    v_mfma_f32_16x16x32_bf16 v[60:63], v[132:135], v[184:187], v[60:63]
    s_add_u32 m0, s73, 16384
    v_mfma_f32_16x16x32_bf16 v[60:63], v[136:139], v[180:183], v[60:63]
    buffer_load_dwordx4 v5, s[52:55], s14 offen offset:1024 lds
    v_mfma_f32_16x16x32_bf16 v[60:63], v[140:143], v[176:179], v[60:63]
    v_mfma_f32_16x16x32_bf16 v[60:63], v[144:147], v[172:175], v[60:63]
    v_mfma_f32_16x16x32_bf16 v[60:63], v[148:151], v[168:171], v[60:63]
    v_mfma_f32_16x16x32_bf16 v[60:63], v[152:155], v[164:167], v[60:63]
    v_mfma_f32_16x16x32_bf16 v[60:63], v[156:159], v[160:163], v[60:63]
    v_mfma_f32_16x16x32_bf16 v[56:59], v[128:131], v[184:187], v[56:59]
    v_mfma_f32_16x16x32_bf16 v[56:59], v[132:135], v[180:183], v[56:59]
    v_mfma_f32_16x16x32_bf16 v[56:59], v[136:139], v[176:179], v[56:59]
    v_mfma_f32_16x16x32_bf16 v[56:59], v[140:143], v[172:175], v[56:59]
    s_add_u32 m0, s73, 16384
    v_mfma_f32_16x16x32_bf16 v[56:59], v[144:147], v[168:171], v[56:59]
    buffer_load_dwordx4 v6, s[52:55], s14 offen offset:2048 lds
    v_mfma_f32_16x16x32_bf16 v[56:59], v[148:151], v[164:167], v[56:59]
    v_cvt_pk_bf16_f32 v206, v60, v61
    v_mfma_f32_16x16x32_bf16 v[56:59], v[152:155], v[160:163], v[56:59]
    s_waitcnt vmcnt(7)
    s_barrier
    v_mfma_f32_16x16x32_bf16 v[52:55], v[128:131], v[180:183], v[52:55]
    v_add_u32 v10, 131072, v10
    v_mfma_f32_16x16x32_bf16 v[52:55], v[132:135], v[176:179], v[52:55]
    ds_read_b64_tr_b16 a[240:241], v10 offset:16384
    v_cvt_pk_bf16_f32 v207, v62, v63
    v_mfma_f32_16x16x32_bf16 v[52:55], v[136:139], v[172:175], v[52:55]
    ds_read_b64_tr_b16 a[242:243], v10 offset:18432
    v_mfma_f32_16x16x32_bf16 v[52:55], v[140:143], v[168:171], v[52:55]
    buffer_store_dwordx2 v[206:207], v8, s[44:47], s6 offen offset:3584 sc1
    v_mfma_f32_16x16x32_bf16 v[52:55], v[144:147], v[164:167], v[52:55]
    ds_read_b64_tr_b16 a[248:249], v10 offset:20480
    v_mfma_f32_16x16x32_bf16 v[52:55], v[148:151], v[160:163], v[52:55]
    ds_read_b64_tr_b16 a[250:251], v10 offset:22528
    v_mfma_f32_16x16x32_bf16 v[48:51], v[128:131], v[176:179], v[48:51]
    v_add_u32 v11, 131072, v11
    v_cvt_pk_bf16_f32 v204, v56, v57
    v_mfma_f32_16x16x32_bf16 v[48:51], v[132:135], v[172:175], v[48:51]
    ds_read_b64_tr_b16 a[244:245], v11 offset:16384
    s_add_u32 m0, s73, 16384
    v_mfma_f32_16x16x32_bf16 v[48:51], v[136:139], v[168:171], v[48:51]
    ds_read_b64_tr_b16 a[246:247], v11 offset:18432
    buffer_load_dwordx4 v7, s[52:55], s14 offen offset:3072 lds
    v_mfma_f32_16x16x32_bf16 v[48:51], v[140:143], v[164:167], v[48:51]
    v_cvt_pk_bf16_f32 v205, v58, v59
    v_mfma_f32_16x16x32_bf16 v[48:51], v[144:147], v[160:163], v[48:51]
L_pl_X_6:
    s_cbranch_execz L_wret
    ds_read_b64_tr_b16 a[252:253], v11 offset:20480
    v_mfma_f32_16x16x32_bf16 v[44:47], v[128:131], v[172:175], v[44:47]
    buffer_store_dwordx2 v[204:205], v8, s[44:47], s6 offen offset:3072 sc1
    ds_read_b64_tr_b16 a[254:255], v11 offset:22528
    v_mfma_f32_16x16x32_bf16 v[44:47], v[132:135], v[168:171], v[44:47]
    v_mfma_f32_16x16x32_bf16 v[44:47], v[136:139], v[164:167], v[44:47]
    v_mfma_f32_16x16x32_bf16 v[44:47], v[140:143], v[160:163], v[44:47]
    v_cvt_pk_bf16_f32 v202, v52, v53
    v_mfma_f32_16x16x32_bf16 v[40:43], v[128:131], v[168:171], v[40:43]
    v_mfma_f32_16x16x32_bf16 v[40:43], v[132:135], v[164:167], v[40:43]
    v_mfma_f32_16x16x32_bf16 v[40:43], v[136:139], v[160:163], v[40:43]
    v_cvt_pk_bf16_f32 v203, v54, v55
    v_mfma_f32_16x16x32_bf16 v[36:39], v[128:131], v[164:167], v[36:39]
    v_mfma_f32_16x16x32_bf16 v[36:39], v[132:135], v[160:163], v[36:39]
    buffer_store_dwordx2 v[202:203], v8, s[44:47], s6 offen offset:2560 sc1
    v_mfma_f32_16x16x32_bf16 v[32:35], v[128:131], v[160:163], v[32:35]
    v_mov_b32 v29, 0
    buffer_atomic_add v29, v28, s[44:47], 0 offen sc0 sc1
    v_cvt_pk_bf16_f32 v200, v48, v49
    v_cvt_pk_bf16_f32 v201, v50, v51
    buffer_store_dwordx2 v[200:201], v8, s[44:47], s6 offen offset:2048 sc1
    v_cvt_pk_bf16_f32 v198, v44, v45
    v_cvt_pk_bf16_f32 v199, v46, v47
    buffer_store_dwordx2 v[198:199], v8, s[44:47], s6 offen offset:1536 sc1
    v_cvt_pk_bf16_f32 v196, v40, v41
    v_cvt_pk_bf16_f32 v197, v42, v43
    buffer_store_dwordx2 v[196:197], v8, s[44:47], s6 offen offset:1024 sc1
    v_cvt_pk_bf16_f32 v194, v36, v37
    v_cvt_pk_bf16_f32 v195, v38, v39
    buffer_store_dwordx2 v[194:195], v8, s[44:47], s6 offen offset:512 sc1
    v_cvt_pk_bf16_f32 v192, v32, v33
    v_cvt_pk_bf16_f32 v193, v34, v35
    buffer_store_dwordx2 v[192:193], v8, s[44:47], s6 offen offset:0 sc1
    v_add_u32 v10, -131072, v10
    v_add_u32 v11, -131072, v11
    s_waitcnt lgkmcnt(0)
    s_barrier
L_DX:
    s_waitcnt vmcnt(0)
    v_cmp_ne_u32 vcc, v13, v29
    s_cbranch_vccnz L_rs_p2X
L_ok_p2X:
    s_barrier
    s_add_u32 m0, s73, 97536
    s_nop 0
    buffer_load_dwordx4 v23, s[44:47], s18 offen offset:768 sc1 lds
    s_add_u32 m0, s73, 99328
    s_nop 0
    buffer_load_dwordx4 v20, s[44:47], s18 offen offset:0 sc1 lds
    s_add_u32 m0, s73, 99840
    s_nop 0
    buffer_load_dwordx4 v20, s[44:47], s18 offen offset:512 sc1 lds
    s_add_u32 m0, s73, 100608
    s_nop 0
    buffer_load_dwordx4 v23, s[44:47], s19 offen offset:768 sc1 lds
    s_add_u32 m0, s73, 114688
    s_nop 0
    buffer_load_dwordx4 v20, s[44:47], s19 offen offset:0 sc1 lds
    s_add_u32 m0, s73, 115200
    s_nop 0
    buffer_load_dwordx4 v20, s[44:47], s19 offen offset:512 sc1 lds
    s_add_u32 m0, s73, 115968
    s_nop 0
    buffer_load_dwordx4 v23, s[44:47], s20 offen offset:768 sc1 lds
    s_add_u32 m0, s73, 117760
    s_nop 0
    buffer_load_dwordx4 v20, s[44:47], s20 offen offset:0 sc1 lds
    s_mov_b32 s56, s16
    s_and_b32 s57, s17, 0xffff
    s_mov_b32 s58, 2359296
    s_mov_b32 s59, 0x20000
    s_mov_b32 s40, 18432
    s_mov_b32 s42, 12386304
    s_mov_b32 s64, s38
    s_and_b32 s65, s39, 0xffff
    s_mov_b32 s66, 2359296
    s_mov_b32 s67, 0x20000
    v_lshlrev_b32 v136, 4, v2
    s_mul_i32 s7, s72, 36
    s_bitcmp1_b32 s3, 0
    s_addc_u32 s7, s7, 0
    s_lshl_b32 s7, s7, 17
    v_subrev_u32 v184, s7, v4
    v_subrev_u32 v185, s7, v5
    s_bfe_u32 s4, s2, 0x20003
    s_mul_i32 s4, s4, 9
    s_lshl1_add_u32 s7, s72, s4
    s_and_b32 s8, s3, 1
    s_add_u32 s7, s7, s8
    s_lshl_b32 s37, s7, 16
    s_add_u32 s37, s37, 4718592
    s_add_u32 s4, s4, 8
    s_lshl_b32 s16, s4, 16
    s_add_u32 s16, s16, 4718592
    s_sub_u32 s4, s4, s7
    s_lshl_b32 s4, s4, 7
    s_lshl_b32 s7, s7, 7
    s_add_u32 s7, s7, 12582912
    v_bfe_u32 v24, v2, 2, 1
    v_mul_u32_u24 v24, s4, v24
    v_and_b32 v25, 3, v2
    v_lshl_add_u32 v24, v25, 2, v24
    v_add_u32 v188, s7, v24
    s_lshl2_add_u32 s7, s2, s3
    s_mul_i32 s8, s7, 3072
    s_add_u32 s34, s8, 40828928
    s_add_u32 s11, s8, 43974656
    s_add_u32 s12, s8, 47120384
    s_lshl_b32 s35, s7, 12
    s_add_u32 s35, s35, 50266112
    s_xor_b32 s8, s7, 8
    s_mul_i32 s8, s8, 3072
    s_add_u32 s30, s8, 40828928
    s_xor_b32 s8, s7, 16
    s_mul_i32 s8, s8, 3072
    s_add_u32 s15, s8, 43974656
    s_xor_b32 s8, s7, 24
    s_mul_i32 s8, s8, 3072
    s_add_u32 s31, s8, 47120384
    s_andn2_b32 s7, s7, 24
    s_lshl3_add_u32 s7, s3, s7
    s_lshl2_add_u32 s8, s7, s72
    s_lshl_b32 s8, s8, 10
    s_add_u32 s32, s8, 50266112
    s_xor_b32 s8, s8, 4096
    s_add_u32 s33, s8, 50266112
    s_xor_b32 s8, s3, s72
    s_cmp_lt_u32 s8, 2
    s_cselect_b32 s35, s35, 0x40000000
    s_cselect_b32 s16, s16, 0x40000000
    s_cselect_b32 s36, s68, 0
    s_mov_b32 s38, 0xbfb8aa3b
    s_and_b32 s8, s8, 1
    s_mul_i32 s41, s8, 96
    s_and_b32 s43, s73, 4096
    v_lshlrev_b32 v24, 10, v2
    v_add_u32 v24, s35, v24
    s_add_u32 s7, s34, 2048
    v_mov_b32 v25, s36
    v_cmp_gt_u32 vcc, 4, v2
    s_nop 1
    v_cndmask_b32 v138, 0, v25, vcc
    v_mov_b32 v25, 0x40000000
    v_cndmask_b32 v137, v25, v24, vcc
    v_writelane_b32 v137, s7, 4
    v_writelane_b32 v138, s68, 4
    v_min_u32 v139, 1, v2
    v_lshlrev_b32 v139, 30, v139
    v_mov_b32 v140, 0
    v_writelane_b32 v140, s68, 0
    v_mov_b32 v195, s68
    v_mov_b32 v199, s68
    v_mov_b32 v202, s68
    v_mov_b32 v203, s68
    s_waitcnt vmcnt(4)
    s_barrier
    ds_read_b128 v[104:107], v14 offset:0
    ds_read_b128 v[108:111], v14 offset:4096
    ds_read_b128 v[112:115], v14 offset:8192
    ds_read_b128 v[116:119], v14 offset:12288
    s_waitcnt lgkmcnt(2)
    v_mfma_f32_16x16x32_bf16 v[32:35], v[104:107], a[0:3], 0
    s_add_u32 m0, s73, 130560
    s_sub_u32 s4, s75, 216
    s_lshl_b32 s7, s4, 7
    v_mfma_f32_16x16x32_bf16 v[32:35], v[108:111], a[8:11], v[32:35]
    buffer_load_dwordx4 v20, s[44:47], s20 offen offset:512 sc1 lds
    s_waitcnt lgkmcnt(0)
    v_mfma_f32_16x16x32_bf16 v[32:35], v[112:115], a[16:19], v[32:35]
    ds_read_b128 v[120:123], v14 offset:1024
    s_lshl2_add_u32 s7, s3, s7
    s_add_u32 s7, s7, 12582912
    v_mfma_f32_16x16x32_bf16 v[32:35], v[116:119], a[24:27], v[32:35]
    ds_read_b128 v[124:127], v14 offset:5120
    v_mfma_f32_16x16x32_bf16 v[36:39], v[116:119], a[28:31], 0
    ds_read_b128 v[128:131], v14 offset:9216
    s_cmp_lt_u32 s4, 36
    s_cselect_b32 s7, s7, 0x40000000
    v_mfma_f32_16x16x32_bf16 v[36:39], v[112:115], a[20:23], v[36:39]
    ds_read_b128 v[132:135], v14 offset:13312
    v_min_u32 v28, 1, v2
    v_mfma_f32_16x16x32_bf16 v[36:39], v[108:111], a[12:15], v[36:39]
    s_add_u32 m0, s73, 131328
    v_lshlrev_b32 v28, 30, v28
    v_mov_b32 v29, s68
    v_mfma_f32_16x16x32_bf16 v[36:39], v[104:107], a[4:7], v[36:39]
    buffer_load_dwordx4 v23, s[44:47], s21 offen offset:768 sc1 lds
    s_waitcnt lgkmcnt(2)
    v_mfma_f32_16x16x32_bf16 v[44:47], v[120:123], a[4:7], 0
    buffer_store_dword v29, v28, s[44:47], s7 offen sc1
    s_add_u32 m0, s73, 133120
    v_mfma_f32_16x16x32_bf16 v[44:47], v[124:127], a[12:15], v[44:47]
    buffer_load_dwordx4 v20, s[44:47], s21 offen offset:0 sc1 lds
    s_waitcnt lgkmcnt(0)
    v_mfma_f32_16x16x32_bf16 v[44:47], v[128:131], a[20:23], v[44:47]
    ds_read_b128 v[104:107], v14 offset:2048
    v_mfma_f32_16x16x32_bf16 v[44:47], v[132:135], a[28:31], v[44:47]
    ds_read_b128 v[108:111], v14 offset:6144
    v_mfma_f32_16x16x32_bf16 v[40:43], v[132:135], a[24:27], 0
    ds_read_b128 v[112:115], v14 offset:10240
    v_mfma_f32_16x16x32_bf16 v[40:43], v[128:131], a[16:19], v[40:43]
    ds_read_b128 v[116:119], v14 offset:14336
    v_mfma_f32_16x16x32_bf16 v[40:43], v[124:127], a[8:11], v[40:43]
    s_add_u32 m0, s73, 133632
    v_mfma_f32_16x16x32_bf16 v[40:43], v[120:123], a[0:3], v[40:43]
    buffer_load_dwordx4 v20, s[44:47], s21 offen offset:512 sc1 lds
    s_waitcnt lgkmcnt(2)
    v_mfma_f32_16x16x32_bf16 v[48:51], v[104:107], a[0:3], 0
    s_add_u32 m0, s73, 146688
    v_mfma_f32_16x16x32_bf16 v[48:51], v[108:111], a[8:11], v[48:51]
    buffer_load_dwordx4 v23, s[44:47], s22 offen offset:768 sc1 lds
    s_waitcnt lgkmcnt(0)
    v_mfma_f32_16x16x32_bf16 v[48:51], v[112:115], a[16:19], v[48:51]
    ds_read_b128 v[120:123], v14 offset:3072
    v_mfma_f32_16x16x32_bf16 v[48:51], v[116:119], a[24:27], v[48:51]
    ds_read_b128 v[124:127], v14 offset:7168
    v_mfma_f32_16x16x32_bf16 v[52:55], v[116:119], a[28:31], 0
    ds_read_b128 v[128:131], v14 offset:11264
    v_mfma_f32_16x16x32_bf16 v[52:55], v[112:115], a[20:23], v[52:55]
    ds_read_b128 v[132:135], v14 offset:15360
    v_mfma_f32_16x16x32_bf16 v[52:55], v[108:111], a[12:15], v[52:55]
    s_add_u32 m0, s73, 148480
    v_mfma_f32_16x16x32_bf16 v[52:55], v[104:107], a[4:7], v[52:55]
    buffer_load_dwordx4 v20, s[44:47], s22 offen offset:0 sc1 lds
    s_waitcnt lgkmcnt(2)
    v_mfma_f32_16x16x32_bf16 v[36:39], v[120:123], a[36:39], v[36:39]
    s_add_u32 m0, s73, 148992
    v_mfma_f32_16x16x32_bf16 v[36:39], v[124:127], a[44:47], v[36:39]
    buffer_load_dwordx4 v20, s[44:47], s22 offen offset:512 sc1 lds
    s_waitcnt lgkmcnt(0)
    v_mfma_f32_16x16x32_bf16 v[36:39], v[128:131], a[52:55], v[36:39]
    s_waitcnt vmcnt(8)
    s_barrier
    v_mfma_f32_16x16x32_bf16 v[36:39], v[132:135], a[60:63], v[36:39]
    ds_read_b128 v[104:107], v14 offset:16384
    v_mfma_f32_16x16x32_bf16 v[32:35], v[132:135], a[56:59], v[32:35]
    ds_read_b128 v[108:111], v14 offset:20480
    v_mfma_f32_16x16x32_bf16 v[32:35], v[128:131], a[48:51], v[32:35]
    ds_read_b128 v[112:115], v14 offset:24576
    v_mfma_f32_16x16x32_bf16 v[32:35], v[124:127], a[40:43], v[32:35]
    ds_read_b128 v[116:119], v14 offset:28672
    s_add_u32 m0, s73, 149760
    v_mfma_f32_16x16x32_bf16 v[32:35], v[120:123], a[32:35], v[32:35]
    buffer_load_dwordx4 v23, s[44:47], s23 offen offset:768 sc1 lds
    ds_read_b64_tr_b16 v[220:221], v10 offset:0
    s_waitcnt lgkmcnt(3)
    v_mfma_f32_16x16x32_bf16 v[40:43], v[104:107], a[32:35], v[40:43]
    s_add_u32 m0, s73, 98304
    ds_read_b64_tr_b16 v[222:223], v10 offset:2048
    v_mfma_f32_16x16x32_bf16 v[40:43], v[108:111], a[40:43], v[40:43]
    buffer_load_dwordx4 v20, s[44:47], s23 offen offset:0 sc1 lds
    s_waitcnt lgkmcnt(2)
    v_mfma_f32_16x16x32_bf16 v[40:43], v[112:115], a[48:51], v[40:43]
    ds_read_b128 v[120:123], v14 offset:17408
    v_mfma_f32_16x16x32_bf16 v[40:43], v[116:119], a[56:59], v[40:43]
    ds_read_b128 v[124:127], v14 offset:21504
    v_mfma_f32_16x16x32_bf16 v[44:47], v[116:119], a[60:63], v[44:47]
    ds_read_b128 v[128:131], v14 offset:25600
    v_mfma_f32_16x16x32_bf16 v[44:47], v[112:115], a[52:55], v[44:47]
    ds_read_b128 v[132:135], v14 offset:29696
    v_mfma_f32_16x16x32_bf16 v[44:47], v[108:111], a[44:47], v[44:47]
    s_add_u32 m0, s73, 98816
    ds_read_b64_tr_b16 v[228:229], v10 offset:4096
    v_mfma_f32_16x16x32_bf16 v[44:47], v[104:107], a[36:39], v[44:47]
    buffer_load_dwordx4 v20, s[44:47], s23 offen offset:512 sc1 lds
    s_waitcnt lgkmcnt(3)
    v_mfma_f32_16x16x32_bf16 v[52:55], v[120:123], a[36:39], v[52:55]
    s_add_u32 m0, s73, 99584
    ds_read_b64_tr_b16 v[230:231], v10 offset:6144
    v_mfma_f32_16x16x32_bf16 v[52:55], v[124:127], a[44:47], v[52:55]
    buffer_load_dwordx4 v23, s[44:47], s24 offen offset:768 sc1 lds
    s_waitcnt lgkmcnt(2)
    v_mfma_f32_16x16x32_bf16 v[52:55], v[128:131], a[52:55], v[52:55]
    ds_read_b128 v[104:107], v14 offset:18432
    v_mfma_f32_16x16x32_bf16 v[52:55], v[132:135], a[60:63], v[52:55]
    ds_read_b128 v[108:111], v14 offset:22528
    v_mfma_f32_16x16x32_bf16 v[48:51], v[132:135], a[56:59], v[48:51]
    ds_read_b128 v[112:115], v14 offset:26624
    v_mfma_f32_16x16x32_bf16 v[48:51], v[128:131], a[48:51], v[48:51]
    ds_read_b128 v[116:119], v14 offset:30720
    v_mfma_f32_16x16x32_bf16 v[48:51], v[124:127], a[40:43], v[48:51]
    s_add_u32 m0, s73, 101376
    ds_read_b64_tr_b16 v[224:225], v11 offset:0
    v_mfma_f32_16x16x32_bf16 v[48:51], v[120:123], a[32:35], v[48:51]
    buffer_load_dwordx4 v20, s[44:47], s24 offen offset:0 sc1 lds
    s_waitcnt lgkmcnt(3)
    v_mfma_f32_16x16x32_bf16 v[32:35], v[104:107], a[64:67], v[32:35]
    ds_read_b64_tr_b16 v[226:227], v11 offset:2048
    v_mfma_f32_16x16x32_bf16 v[32:35], v[108:111], a[72:75], v[32:35]
    s_waitcnt lgkmcnt(2)
    v_mfma_f32_16x16x32_bf16 v[32:35], v[112:115], a[80:83], v[32:35]
    ds_read_b128 v[120:123], v14 offset:19456
    v_mfma_f32_16x16x32_bf16 v[32:35], v[116:119], a[88:91], v[32:35]
    ds_read_b128 v[124:127], v14 offset:23552
    v_mfma_f32_16x16x32_bf16 v[36:39], v[116:119], a[92:95], v[36:39]
    ds_read_b128 v[128:131], v14 offset:27648
    v_mfma_f32_16x16x32_bf16 v[36:39], v[112:115], a[84:87], v[36:39]
    ds_read_b128 v[132:135], v14 offset:31744
    v_mfma_f32_16x16x32_bf16 v[36:39], v[108:111], a[76:79], v[36:39]
    ds_read_b64_tr_b16 v[232:233], v11 offset:4096
    v_mfma_f32_16x16x32_bf16 v[36:39], v[104:107], a[68:71], v[36:39]
    s_waitcnt lgkmcnt(3)
    v_mfma_f32_16x16x32_bf16 v[44:47], v[120:123], a[68:71], v[44:47]
    ds_read_b64_tr_b16 v[234:235], v11 offset:6144
    v_mfma_f32_16x16x32_bf16 v[44:47], v[124:127], a[76:79], v[44:47]
    s_waitcnt lgkmcnt(2)
    v_mfma_f32_16x16x32_bf16 v[44:47], v[128:131], a[84:87], v[44:47]
    s_waitcnt vmcnt(8) lgkmcnt(0)
    s_barrier
    v_mfma_f32_16x16x32_bf16 v[44:47], v[132:135], a[92:95], v[44:47]
    ds_read_b128 v[104:107], v14 offset:32768
    v_mfma_f32_16x16x32_bf16 v[40:43], v[132:135], a[88:91], v[40:43]
    ds_read_b128 v[108:111], v14 offset:36864
    v_mfma_f32_16x16x32_bf16 v[40:43], v[128:131], a[80:83], v[40:43]
    ds_read_b128 v[112:115], v14 offset:40960
    v_mfma_f32_16x16x32_bf16 v[40:43], v[124:127], a[72:75], v[40:43]
    ds_read_b128 v[116:119], v14 offset:45056
    v_mfma_f32_16x16x32_bf16 v[40:43], v[120:123], a[64:67], v[40:43]
    ds_read_b64_tr_b16 v[236:237], v10 offset:16384
    s_waitcnt lgkmcnt(3)
    v_mfma_f32_16x16x32_bf16 v[48:51], v[104:107], a[64:67], v[48:51]
    s_add_u32 m0, s73, 114176
    ds_read_b64_tr_b16 v[238:239], v10 offset:18432
    v_mfma_f32_16x16x32_bf16 v[48:51], v[108:111], a[72:75], v[48:51]
    buffer_load_dwordx4 v20, s[44:47], s24 offen offset:512 sc1 lds
    s_waitcnt lgkmcnt(2)
    v_mfma_f32_16x16x32_bf16 v[48:51], v[112:115], a[80:83], v[48:51]
    ds_read_b128 v[120:123], v14 offset:33792
    v_mfma_f32_16x16x32_bf16 v[48:51], v[116:119], a[88:91], v[48:51]
    ds_read_b128 v[124:127], v14 offset:37888
    v_lshrrev_b32 v30, 2, v26
    v_mfma_f32_16x16x32_bf16 v[52:55], v[116:119], a[92:95], v[52:55]
    ds_read_b128 v[128:131], v14 offset:41984
    v_mfma_f32_16x16x32_bf16 v[52:55], v[112:115], a[84:87], v[52:55]
    ds_read_b128 v[132:135], v14 offset:46080
    v_mfma_f32_16x16x32_bf16 v[52:55], v[108:111], a[76:79], v[52:55]
    s_add_u32 m0, s73, 114944
    ds_read_b64_tr_b16 v[244:245], v10 offset:20480
    v_mfma_f32_16x16x32_bf16 v[52:55], v[104:107], a[68:71], v[52:55]
    buffer_load_dwordx4 v23, s[44:47], s25 offen offset:768 sc1 lds
    s_waitcnt lgkmcnt(3)
    v_mfma_f32_16x16x32_bf16 v[36:39], v[120:123], a[100:103], v[36:39]
    s_add_u32 m0, s73, 116736
    ds_read_b64_tr_b16 v[246:247], v10 offset:22528
    v_mfma_f32_16x16x32_bf16 v[36:39], v[124:127], a[108:111], v[36:39]
    buffer_load_dwordx4 v20, s[44:47], s25 offen offset:0 sc1 lds
    s_waitcnt lgkmcnt(2)
    v_mfma_f32_16x16x32_bf16 v[36:39], v[128:131], a[116:119], v[36:39]
    ds_read_b128 v[104:107], v14 offset:34816
    v_lshrrev_b32 v31, 2, v18
    v_mfma_f32_16x16x32_bf16 v[36:39], v[132:135], a[124:127], v[36:39]
    ds_read_b128 v[108:111], v14 offset:38912
    v_mfma_f32_16x16x32_bf16 v[32:35], v[132:135], a[120:123], v[32:35]
    ds_read_b128 v[112:115], v14 offset:43008
    v_mfma_f32_16x16x32_bf16 v[32:35], v[128:131], a[112:115], v[32:35]
    ds_read_b128 v[116:119], v14 offset:47104
    v_mfma_f32_16x16x32_bf16 v[32:35], v[124:127], a[104:107], v[32:35]
    s_add_u32 m0, s73, 117248
    ds_read_b64_tr_b16 v[240:241], v11 offset:16384
    v_mfma_f32_16x16x32_bf16 v[32:35], v[120:123], a[96:99], v[32:35]
    buffer_load_dwordx4 v20, s[44:47], s25 offen offset:512 sc1 lds
    s_waitcnt lgkmcnt(3)
    v_mfma_f32_16x16x32_bf16 v[40:43], v[104:107], a[96:99], v[40:43]
    ds_read_b64_tr_b16 v[242:243], v11 offset:18432
    buffer_load_ushort v102, v30, s[60:63], 0 offen offset:0
    v_mfma_f32_16x16x32_bf16 v[40:43], v[108:111], a[104:107], v[40:43]
    s_waitcnt lgkmcnt(2)
    v_mfma_f32_16x16x32_bf16 v[40:43], v[112:115], a[112:115], v[40:43]
    ds_read_b128 v[120:123], v14 offset:35840
    v_mfma_f32_16x16x32_bf16 v[40:43], v[116:119], a[120:123], v[40:43]
    ds_read_b128 v[124:127], v14 offset:39936
    v_mfma_f32_16x16x32_bf16 v[44:47], v[116:119], a[124:127], v[44:47]
    ds_read_b128 v[128:131], v14 offset:44032
    v_mfma_f32_16x16x32_bf16 v[44:47], v[112:115], a[116:119], v[44:47]
    ds_read_b128 v[132:135], v14 offset:48128
    v_mfma_f32_16x16x32_bf16 v[44:47], v[108:111], a[108:111], v[44:47]
    ds_read_b64_tr_b16 v[248:249], v11 offset:20480
    buffer_load_ushort v103, v30, s[60:63], 0 offen offset:32
    v_mfma_f32_16x16x32_bf16 v[44:47], v[104:107], a[100:103], v[44:47]
    s_waitcnt lgkmcnt(3)
    v_mfma_f32_16x16x32_bf16 v[52:55], v[120:123], a[100:103], v[52:55]
    ds_read_b64_tr_b16 v[250:251], v11 offset:22528
    v_mfma_f32_16x16x32_bf16 v[52:55], v[124:127], a[108:111], v[52:55]
    s_waitcnt lgkmcnt(2)
    v_mfma_f32_16x16x32_bf16 v[52:55], v[128:131], a[116:119], v[52:55]
    s_waitcnt vmcnt(10) lgkmcnt(0)
    s_barrier
    v_mfma_f32_16x16x32_bf16 v[52:55], v[132:135], a[124:127], v[52:55]
    ds_read_b128 v[104:107], v14 offset:49152
    v_mfma_f32_16x16x32_bf16 v[48:51], v[132:135], a[120:123], v[48:51]
    ds_read_b128 v[108:111], v14 offset:53248
    buffer_load_ushort v27, v31, s[60:63], 0 offen offset:0
    v_mfma_f32_16x16x32_bf16 v[48:51], v[128:131], a[112:115], v[48:51]
    ds_read_b128 v[112:115], v14 offset:57344
    v_mfma_f32_16x16x32_bf16 v[48:51], v[124:127], a[104:107], v[48:51]
    ds_read_b128 v[116:119], v14 offset:61440
    v_mfma_f32_16x16x32_bf16 v[48:51], v[120:123], a[96:99], v[48:51]
    s_waitcnt lgkmcnt(2)
    v_mfma_f32_16x16x32_bf16 v[32:35], v[104:107], a[128:131], v[32:35]
    s_add_u32 m0, s73, 130304
    v_mfma_f32_16x16x32_bf16 v[32:35], v[108:111], a[136:139], v[32:35]
    buffer_load_dwordx4 v23, s[44:47], s26 offen offset:768 sc1 lds
    s_waitcnt lgkmcnt(0)
    v_mfma_f32_16x16x32_bf16 v[32:35], v[112:115], a[144:147], v[32:35]
    ds_read_b128 v[120:123], v14 offset:50176
    v_mfma_f32_16x16x32_bf16 v[32:35], v[116:119], a[152:155], v[32:35]
    ds_read_b128 v[124:127], v14 offset:54272
    v_mfma_f32_16x16x32_bf16 v[36:39], v[116:119], a[156:159], v[36:39]
    ds_read_b128 v[128:131], v14 offset:58368
    v_mfma_f32_16x16x32_bf16 v[36:39], v[112:115], a[148:151], v[36:39]
    ds_read_b128 v[132:135], v14 offset:62464
    v_mfma_f32_16x16x32_bf16 v[36:39], v[108:111], a[140:143], v[36:39]
    s_add_u32 m0, s73, 132096
    v_mfma_f32_16x16x32_bf16 v[36:39], v[104:107], a[132:135], v[36:39]
    buffer_load_dwordx4 v20, s[44:47], s26 offen offset:0 sc1 lds
    s_waitcnt lgkmcnt(2)
    v_mfma_f32_16x16x32_bf16 v[44:47], v[120:123], a[132:135], v[44:47]
    s_add_u32 m0, s73, 132608
    buffer_load_dwordx4 v[88:91], v252, s[56:59], 0 offen
    v_mfma_f32_16x16x32_bf16 v[44:47], v[124:127], a[140:143], v[44:47]
    buffer_load_dwordx4 v20, s[44:47], s26 offen offset:512 sc1 lds
    s_waitcnt lgkmcnt(0)
    v_mfma_f32_16x16x32_bf16 v[44:47], v[128:131], a[148:151], v[44:47]
    ds_read_b128 v[104:107], v14 offset:51200
    v_mfma_f32_16x16x32_bf16 v[44:47], v[132:135], a[156:159], v[44:47]
    ds_read_b128 v[108:111], v14 offset:55296
    v_mfma_f32_16x16x32_bf16 v[40:43], v[132:135], a[152:155], v[40:43]
    ds_read_b128 v[112:115], v14 offset:59392
    v_mfma_f32_16x16x32_bf16 v[40:43], v[128:131], a[144:147], v[40:43]
    ds_read_b128 v[116:119], v14 offset:63488
    v_mfma_f32_16x16x32_bf16 v[40:43], v[124:127], a[136:139], v[40:43]
    s_add_u32 m0, s73, 134144
    v_mfma_f32_16x16x32_bf16 v[40:43], v[120:123], a[128:131], v[40:43]
    buffer_load_dwordx4 v21, s[44:47], s18 offen offset:0 sc1 lds
    s_waitcnt lgkmcnt(2)
    v_mfma_f32_16x16x32_bf16 v[48:51], v[104:107], a[128:131], v[48:51]
    v_mfma_f32_16x16x32_bf16 v[48:51], v[108:111], a[136:139], v[48:51]
    s_waitcnt lgkmcnt(0)
    v_mfma_f32_16x16x32_bf16 v[48:51], v[112:115], a[144:147], v[48:51]
    ds_read_b128 v[120:123], v14 offset:52224
    v_mfma_f32_16x16x32_bf16 v[48:51], v[116:119], a[152:155], v[48:51]
    ds_read_b128 v[124:127], v14 offset:56320
    v_mfma_f32_16x16x32_bf16 v[52:55], v[116:119], a[156:159], v[52:55]
    ds_read_b128 v[128:131], v14 offset:60416
    v_mfma_f32_16x16x32_bf16 v[52:55], v[112:115], a[148:151], v[52:55]
    ds_read_b128 v[132:135], v14 offset:64512
    v_mfma_f32_16x16x32_bf16 v[52:55], v[108:111], a[140:143], v[52:55]
    v_mfma_f32_16x16x32_bf16 v[52:55], v[104:107], a[132:135], v[52:55]
    s_waitcnt lgkmcnt(2)
    v_mfma_f32_16x16x32_bf16 v[36:39], v[120:123], a[164:167], v[36:39]
    buffer_load_dwordx4 v[92:95], v252, s[56:59], s40 offen
    v_mfma_f32_16x16x32_bf16 v[36:39], v[124:127], a[172:175], v[36:39]
    s_waitcnt lgkmcnt(0)
    v_mfma_f32_16x16x32_bf16 v[36:39], v[128:131], a[180:183], v[36:39]
    s_waitcnt vmcnt(13)
    s_barrier
    v_mfma_f32_16x16x32_bf16 v[36:39], v[132:135], a[188:191], v[36:39]
    ds_read_b128 v[104:107], v14 offset:0
    v_mfma_f32_16x16x32_bf16 v[32:35], v[132:135], a[184:187], v[32:35]
    ds_read_b128 v[108:111], v14 offset:4096
    v_mfma_f32_16x16x32_bf16 v[32:35], v[128:131], a[176:179], v[32:35]
    ds_read_b128 v[112:115], v14 offset:8192
    v_mfma_f32_16x16x32_bf16 v[32:35], v[124:127], a[168:171], v[32:35]
    ds_read_b128 v[116:119], v14 offset:12288
    v_mfma_f32_16x16x32_bf16 v[32:35], v[120:123], a[160:163], v[32:35]
    s_waitcnt lgkmcnt(2)
    v_mfma_f32_16x16x32_bf16 v[40:43], v[104:107], a[160:163], v[40:43]
    s_add_u32 m0, s73, 146944
    v_mfma_f32_16x16x32_bf16 v[40:43], v[108:111], a[168:171], v[40:43]
    buffer_load_dwordx4 v21, s[44:47], s18 offen offset:512 sc1 lds
    s_waitcnt lgkmcnt(0)
    v_mfma_f32_16x16x32_bf16 v[40:43], v[112:115], a[176:179], v[40:43]
    ds_read_b128 v[120:123], v14 offset:1024
    v_mfma_f32_16x16x32_bf16 v[40:43], v[116:119], a[184:187], v[40:43]
    ds_read_b128 v[124:127], v14 offset:5120
    v_mfma_f32_16x16x32_bf16 v[44:47], v[116:119], a[188:191], v[44:47]
    ds_read_b128 v[128:131], v14 offset:9216
    v_mfma_f32_16x16x32_bf16 v[44:47], v[112:115], a[180:183], v[44:47]
    ds_read_b128 v[132:135], v14 offset:13312
    v_mfma_f32_16x16x32_bf16 v[44:47], v[108:111], a[172:175], v[44:47]
    s_add_u32 m0, s73, 148480
    v_mfma_f32_16x16x32_bf16 v[44:47], v[104:107], a[164:167], v[44:47]
    buffer_load_dwordx4 v21, s[44:47], s19 offen offset:0 sc1 lds
    s_waitcnt lgkmcnt(2)
    v_mfma_f32_16x16x32_bf16 v[52:55], v[120:123], a[164:167], v[52:55]
    s_add_u32 m0, s73, 148992
    buffer_load_dwordx2 v[142:143], v253, s[56:59], 0 offen
    v_mfma_f32_16x16x32_bf16 v[52:55], v[124:127], a[172:175], v[52:55]
    buffer_load_dwordx4 v21, s[44:47], s19 offen offset:512 sc1 lds
    s_waitcnt lgkmcnt(0)
    v_mfma_f32_16x16x32_bf16 v[52:55], v[128:131], a[180:183], v[52:55]
    ds_read_b128 v[104:107], v14 offset:2048
    v_mfma_f32_16x16x32_bf16 v[52:55], v[132:135], a[188:191], v[52:55]
    ds_read_b128 v[108:111], v14 offset:6144
    v_mfma_f32_16x16x32_bf16 v[48:51], v[132:135], a[184:187], v[48:51]
    ds_read_b128 v[112:115], v14 offset:10240
    v_mfma_f32_16x16x32_bf16 v[48:51], v[128:131], a[176:179], v[48:51]
    ds_read_b128 v[116:119], v14 offset:14336
    v_mfma_f32_16x16x32_bf16 v[48:51], v[124:127], a[168:171], v[48:51]
    s_add_u32 m0, s73, 150528
    v_mfma_f32_16x16x32_bf16 v[48:51], v[120:123], a[160:163], v[48:51]
    buffer_load_dwordx4 v21, s[44:47], s20 offen offset:0 sc1 lds
    s_waitcnt lgkmcnt(2)
    v_mfma_f32_16x16x32_bf16 v[32:35], v[104:107], a[192:195], v[32:35]
    v_mfma_f32_16x16x32_bf16 v[32:35], v[108:111], a[200:203], v[32:35]
    s_waitcnt vmcnt(11)
    s_waitcnt lgkmcnt(0)
    v_mfma_f32_16x16x32_bf16 v[32:35], v[112:115], a[208:211], v[32:35]
    ds_read_b128 v[120:123], v14 offset:3072
    v_mfma_f32_16x16x32_bf16 v[32:35], v[116:119], a[216:219], v[32:35]
    ds_read_b128 v[124:127], v14 offset:7168
    v_mfma_f32_16x16x32_bf16 v[36:39], v[116:119], a[220:223], v[36:39]
    ds_read_b128 v[128:131], v14 offset:11264
    v_lshlrev_b32 v72, 16, v102
    v_mfma_f32_16x16x32_bf16 v[36:39], v[112:115], a[212:215], v[36:39]
    ds_read_b128 v[132:135], v14 offset:15360
    v_mfma_f32_16x16x32_bf16 v[36:39], v[108:111], a[204:207], v[36:39]
    v_lshlrev_b32 v73, 16, v102
    v_mfma_f32_16x16x32_bf16 v[36:39], v[104:107], a[196:199], v[36:39]
    buffer_load_dwordx2 v[96:97], v26, s[44:47], s42 offen offset:0 sc1
    s_waitcnt lgkmcnt(2)
    v_mfma_f32_16x16x32_bf16 v[44:47], v[120:123], a[196:199], v[44:47]
    v_mfma_f32_16x16x32_bf16 v[44:47], v[124:127], a[204:207], v[44:47]
    v_lshlrev_b32 v74, 16, v102
    s_waitcnt lgkmcnt(0)
    v_mfma_f32_16x16x32_bf16 v[44:47], v[128:131], a[212:215], v[44:47]
    s_barrier
    v_mfma_f32_16x16x32_bf16 v[44:47], v[132:135], a[220:223], v[44:47]
    ds_read_b128 v[104:107], v14 offset:16384
    v_mfma_f32_16x16x32_bf16 v[40:43], v[132:135], a[216:219], v[40:43]
    ds_read_b128 v[108:111], v14 offset:20480
    v_lshlrev_b32 v75, 16, v102
    v_mfma_f32_16x16x32_bf16 v[40:43], v[128:131], a[208:211], v[40:43]
    ds_read_b128 v[112:115], v14 offset:24576
    v_mfma_f32_16x16x32_bf16 v[40:43], v[124:127], a[200:203], v[40:43]
    ds_read_b128 v[116:119], v14 offset:28672
    v_lshlrev_b32 v76, 16, v103
    v_mfma_f32_16x16x32_bf16 v[40:43], v[120:123], a[192:195], v[40:43]
    s_waitcnt lgkmcnt(2)
    v_mfma_f32_16x16x32_bf16 v[48:51], v[104:107], a[192:195], v[48:51]
    s_add_u32 m0, s73, 97792
    v_lshlrev_b32 v77, 16, v103
    v_mfma_f32_16x16x32_bf16 v[48:51], v[108:111], a[200:203], v[48:51]
    buffer_load_dwordx4 v21, s[44:47], s20 offen offset:512 sc1 lds
    s_waitcnt lgkmcnt(0)
    v_mfma_f32_16x16x32_bf16 v[48:51], v[112:115], a[208:211], v[48:51]
    ds_read_b128 v[120:123], v14 offset:17408
    v_mfma_f32_16x16x32_bf16 v[48:51], v[116:119], a[216:219], v[48:51]
    ds_read_b128 v[124:127], v14 offset:21504
    v_mfma_f32_16x16x32_bf16 v[52:55], v[116:119], a[220:223], v[52:55]
    ds_read_b128 v[128:131], v14 offset:25600
    v_lshlrev_b32 v78, 16, v103
    v_mfma_f32_16x16x32_bf16 v[52:55], v[112:115], a[212:215], v[52:55]
    ds_read_b128 v[132:135], v14 offset:29696
    v_mfma_f32_16x16x32_bf16 v[52:55], v[108:111], a[204:207], v[52:55]
    s_add_u32 m0, s73, 99328
    v_lshlrev_b32 v79, 16, v103
    v_mfma_f32_16x16x32_bf16 v[52:55], v[104:107], a[196:199], v[52:55]
    buffer_load_dwordx4 v21, s[44:47], s21 offen offset:0 sc1 lds
    s_waitcnt lgkmcnt(2)
    v_mfma_f32_16x16x32_bf16 v[36:39], v[120:123], a[228:231], v[36:39]
    buffer_load_dwordx2 v[98:99], v26, s[44:47], s42 offen offset:128 sc1
    s_add_u32 m0, s73, 99840
    v_lshlrev_b32 v80, 16, v102
    v_mfma_f32_16x16x32_bf16 v[36:39], v[124:127], a[236:239], v[36:39]
    buffer_load_dwordx4 v21, s[44:47], s21 offen offset:512 sc1 lds
    s_waitcnt lgkmcnt(0)
    v_mfma_f32_16x16x32_bf16 v[36:39], v[128:131], a[244:247], v[36:39]
    ds_read_b128 v[104:107], v14 offset:18432
    v_mfma_f32_16x16x32_bf16 v[36:39], v[132:135], a[252:255], v[36:39]
    ds_read_b128 v[108:111], v14 offset:22528
    v_mfma_f32_16x16x32_bf16 v[32:35], v[132:135], a[248:251], v[32:35]
    ds_read_b128 v[112:115], v14 offset:26624
    v_lshlrev_b32 v81, 16, v102
    v_mfma_f32_16x16x32_bf16 v[32:35], v[128:131], a[240:243], v[32:35]
    ds_read_b128 v[116:119], v14 offset:30720
    v_mfma_f32_16x16x32_bf16 v[32:35], v[124:127], a[232:235], v[32:35]
    s_add_u32 m0, s73, 101376
    v_lshlrev_b32 v82, 16, v102
    v_mfma_f32_16x16x32_bf16 v[32:35], v[120:123], a[224:227], v[32:35]
    buffer_load_dwordx4 v21, s[44:47], s22 offen offset:0 sc1 lds
    s_waitcnt lgkmcnt(2)
    v_mfma_f32_16x16x32_bf16 v[40:43], v[104:107], a[224:227], v[40:43]
    v_mfma_f32_16x16x32_bf16 v[40:43], v[108:111], a[232:235], v[40:43]
    v_lshlrev_b32 v83, 16, v102
    s_waitcnt lgkmcnt(0)
L_pl_X_7:
    s_cbranch_execz L_wret
    v_mfma_f32_16x16x32_bf16 v[40:43], v[112:115], a[240:243], v[40:43]
    ds_read_b128 v[120:123], v14 offset:19456
    v_mfma_f32_16x16x32_bf16 v[40:43], v[116:119], a[248:251], v[40:43]
    ds_read_b128 v[124:127], v14 offset:23552
    v_mfma_f32_16x16x32_bf16 v[44:47], v[116:119], a[252:255], v[44:47]
    ds_read_b128 v[128:131], v14 offset:27648
    v_lshlrev_b32 v84, 16, v103
    v_mfma_f32_16x16x32_bf16 v[44:47], v[112:115], a[244:247], v[44:47]
    ds_read_b128 v[132:135], v14 offset:31744
    v_mfma_f32_16x16x32_bf16 v[44:47], v[108:111], a[236:239], v[44:47]
    v_lshlrev_b32 v85, 16, v103
    v_mfma_f32_16x16x32_bf16 v[44:47], v[104:107], a[228:231], v[44:47]
    buffer_load_dwordx2 v[100:101], v18, s[44:47], s42 offen offset:0 sc1
    s_waitcnt lgkmcnt(2)
    v_mfma_f32_16x16x32_bf16 v[52:55], v[120:123], a[228:231], v[52:55]
    v_mfma_f32_16x16x32_bf16 v[52:55], v[124:127], a[236:239], v[52:55]
    v_lshlrev_b32 v86, 16, v103
    s_waitcnt lgkmcnt(0)
    v_mfma_f32_16x16x32_bf16 v[52:55], v[128:131], a[244:247], v[52:55]
    s_waitcnt vmcnt(13)
    s_barrier
    v_mfma_f32_16x16x32_bf16 v[52:55], v[132:135], a[252:255], v[52:55]
    ds_read_b128 v[104:107], v14 offset:32768
    v_lshlrev_b32 v87, 16, v103
    v_mfma_f32_16x16x32_bf16 v[48:51], v[132:135], a[248:251], v[48:51]
    ds_read_b128 v[108:111], v14 offset:36864
    v_add_u32 v10, 65536, v10
    v_mfma_f32_16x16x32_bf16 v[48:51], v[128:131], a[240:243], v[48:51]
    ds_read_b128 v[112:115], v14 offset:40960
    v_mfma_f32_16x16x32_bf16 v[48:51], v[124:127], a[232:235], v[48:51]
    ds_read_b128 v[116:119], v14 offset:45056
    v_add_u32 v11, 65536, v11
    v_mfma_f32_16x16x32_bf16 v[48:51], v[120:123], a[224:227], v[48:51]
    v_lshlrev_b32 v27, 16, v27
    s_branch L_Dc
L_idle:
    s_waitcnt vmcnt(0)
    s_barrier
    s_sub_u32 s4, s75, 252
    s_mul_i32 s4, s4, 1152
    s_mul_i32 s5, s3, 64
    s_add_u32 s4, s4, s5
    s_add_u32 s4, s4, 896
    s_lshl_b32 s4, s4, 12
    s_add_u32 s4, s4, 384
    v_lshlrev_b32 v24, 10, v2
    buffer_load_dword v255, v24, s[52:55], s4 offen
    s_add_u32 s4, s4, 65536
    buffer_load_dword v255, v24, s[52:55], s4 offen
    s_add_u32 s4, s4, 65536
    buffer_load_dword v255, v24, s[52:55], s4 offen
    s_add_u32 s4, s4, 65536
    buffer_load_dword v255, v24, s[52:55], s4 offen
    s_add_u32 s4, s4, 65536
    s_bitcmp1_b32 s3, 1
    s_cselect_b32 s18, s85, s84
    s_mul_i32 s18, s18, 139264
    s_cselect_b32 s19, s87, s86
    s_mul_i32 s19, s19, 139264
    s_cselect_b32 s20, s89, s88
    s_mul_i32 s20, s20, 139264
    s_cselect_b32 s21, s91, s90
    s_mul_i32 s21, s21, 139264
    s_cselect_b32 s22, s93, s92
    s_mul_i32 s22, s22, 139264
    s_cselect_b32 s23, s95, s94
    s_mul_i32 s23, s23, 139264
    s_cselect_b32 s24, s97, s96
    s_mul_i32 s24, s24, 139264
    s_cselect_b32 s25, s99, s98
    s_mul_i32 s25, s25, 139264
    s_cselect_b32 s26, s101, s100
    s_mul_i32 s26, s26, 139264
    s_add_u32 m0, s73, 32768
    s_lshl_b32 s14, s84, 18
    buffer_load_dwordx4 v4, s[52:55], s14 offen offset:0 lds
    buffer_load_dwordx4 v5, s[52:55], s14 offen offset:1024 lds
    buffer_load_dwordx4 v6, s[52:55], s14 offen offset:2048 lds
    buffer_load_dwordx4 v7, s[52:55], s14 offen offset:3072 lds
    s_add_u32 m0, s73, 49152
    s_lshl_b32 s14, s85, 18
    buffer_load_dwordx4 v4, s[52:55], s14 offen offset:0 lds
    buffer_load_dwordx4 v5, s[52:55], s14 offen offset:1024 lds
    buffer_load_dwordx4 v6, s[52:55], s14 offen offset:2048 lds
    buffer_load_dwordx4 v7, s[52:55], s14 offen offset:3072 lds
    s_add_u32 m0, s73, 65536
    s_lshl_b32 s14, s86, 18
    buffer_load_dwordx4 v4, s[52:55], s14 offen offset:0 lds
    buffer_load_dwordx4 v5, s[52:55], s14 offen offset:1024 lds
    buffer_load_dwordx4 v6, s[52:55], s14 offen offset:2048 lds
    buffer_load_dwordx4 v7, s[52:55], s14 offen offset:3072 lds
    s_add_u32 m0, s73, 81920
    s_lshl_b32 s14, s87, 18
    buffer_load_dwordx4 v4, s[52:55], s14 offen offset:0 lds
    buffer_load_dwordx4 v5, s[52:55], s14 offen offset:1024 lds
    buffer_load_dwordx4 v6, s[52:55], s14 offen offset:2048 lds
    buffer_load_dwordx4 v7, s[52:55], s14 offen offset:3072 lds
    s_add_u32 m0, s73, 98304
    s_lshl_b32 s14, s88, 18
    buffer_load_dwordx4 v4, s[52:55], s14 offen offset:0 lds
    buffer_load_dwordx4 v5, s[52:55], s14 offen offset:1024 lds
    buffer_load_dwordx4 v6, s[52:55], s14 offen offset:2048 lds
    buffer_load_dwordx4 v7, s[52:55], s14 offen offset:3072 lds
    s_add_u32 m0, s73, 114688
    s_lshl_b32 s14, s89, 18
    buffer_load_dwordx4 v4, s[52:55], s14 offen offset:0 lds
    buffer_load_dwordx4 v5, s[52:55], s14 offen offset:1024 lds
    buffer_load_dwordx4 v6, s[52:55], s14 offen offset:2048 lds
    buffer_load_dwordx4 v7, s[52:55], s14 offen offset:3072 lds
    s_add_u32 m0, s73, 131072
    s_lshl_b32 s14, s90, 18
    buffer_load_dwordx4 v4, s[52:55], s14 offen offset:0 lds
    buffer_load_dwordx4 v5, s[52:55], s14 offen offset:1024 lds
    buffer_load_dwordx4 v6, s[52:55], s14 offen offset:2048 lds
    buffer_load_dwordx4 v7, s[52:55], s14 offen offset:3072 lds
    s_add_u32 m0, s73, 147456
    s_lshl_b32 s14, s91, 18
    buffer_load_dwordx4 v4, s[52:55], s14 offen offset:0 lds
    buffer_load_dwordx4 v5, s[52:55], s14 offen offset:1024 lds
    buffer_load_dwordx4 v6, s[52:55], s14 offen offset:2048 lds
    buffer_load_dwordx4 v7, s[52:55], s14 offen offset:3072 lds
    s_waitcnt vmcnt(28)
    s_barrier
    ds_read_b64_tr_b16 a[0:1], v10 offset:32768
    ds_read_b64_tr_b16 a[2:3], v10 offset:34816
    ds_read_b64_tr_b16 a[8:9], v10 offset:36864
    ds_read_b64_tr_b16 a[10:11], v10 offset:38912
    ds_read_b64_tr_b16 a[4:5], v11 offset:32768
    ds_read_b64_tr_b16 a[6:7], v11 offset:34816
    ds_read_b64_tr_b16 a[12:13], v11 offset:36864
    ds_read_b64_tr_b16 a[14:15], v11 offset:38912
    s_waitcnt vmcnt(24) lgkmcnt(0)
    s_barrier
    ds_read_b64_tr_b16 a[16:17], v10 offset:49152
    s_add_u32 m0, s73, 32768
    s_lshl_b32 s14, s92, 18
    ds_read_b64_tr_b16 a[18:19], v10 offset:51200
    buffer_load_dwordx4 v4, s[52:55], s14 offen offset:0 lds
    ds_read_b64_tr_b16 a[24:25], v10 offset:53248
    ds_read_b64_tr_b16 a[26:27], v10 offset:55296
    buffer_load_dwordx4 v5, s[52:55], s14 offen offset:1024 lds
    ds_read_b64_tr_b16 a[20:21], v11 offset:49152
    buffer_load_dwordx4 v6, s[52:55], s14 offen offset:2048 lds
    ds_read_b64_tr_b16 a[22:23], v11 offset:51200
    ds_read_b64_tr_b16 a[28:29], v11 offset:53248
    buffer_load_dwordx4 v7, s[52:55], s14 offen offset:3072 lds
    ds_read_b64_tr_b16 a[30:31], v11 offset:55296
    s_waitcnt vmcnt(24) lgkmcnt(0)
    s_barrier
    v_add_u32 v10, 65536, v10
    ds_read_b64_tr_b16 a[32:33], v10 offset:0
    s_add_u32 m0, s73, 49152
    s_lshl_b32 s14, s93, 18
    ds_read_b64_tr_b16 a[34:35], v10 offset:2048
    buffer_load_dwordx4 v4, s[52:55], s14 offen offset:0 lds
    ds_read_b64_tr_b16 a[40:41], v10 offset:4096
    ds_read_b64_tr_b16 a[42:43], v10 offset:6144
    buffer_load_dwordx4 v5, s[52:55], s14 offen offset:1024 lds
    v_add_u32 v11, 65536, v11
    ds_read_b64_tr_b16 a[36:37], v11 offset:0
    buffer_load_dwordx4 v6, s[52:55], s14 offen offset:2048 lds
    ds_read_b64_tr_b16 a[38:39], v11 offset:2048
    ds_read_b64_tr_b16 a[44:45], v11 offset:4096
    buffer_load_dwordx4 v7, s[52:55], s14 offen offset:3072 lds
    ds_read_b64_tr_b16 a[46:47], v11 offset:6144
    s_waitcnt vmcnt(24) lgkmcnt(0)
    s_barrier
    ds_read_b64_tr_b16 a[48:49], v10 offset:16384
    s_add_u32 m0, s73, 65536
    s_lshl_b32 s14, s94, 18
    ds_read_b64_tr_b16 a[50:51], v10 offset:18432
    buffer_load_dwordx4 v4, s[52:55], s14 offen offset:0 lds
    ds_read_b64_tr_b16 a[56:57], v10 offset:20480
    ds_read_b64_tr_b16 a[58:59], v10 offset:22528
    buffer_load_dwordx4 v5, s[52:55], s14 offen offset:1024 lds
    ds_read_b64_tr_b16 a[52:53], v11 offset:16384
    buffer_load_dwordx4 v6, s[52:55], s14 offen offset:2048 lds
    ds_read_b64_tr_b16 a[54:55], v11 offset:18432
    ds_read_b64_tr_b16 a[60:61], v11 offset:20480
    buffer_load_dwordx4 v7, s[52:55], s14 offen offset:3072 lds
    ds_read_b64_tr_b16 a[62:63], v11 offset:22528
    s_waitcnt vmcnt(24) lgkmcnt(0)
    s_barrier
    ds_read_b64_tr_b16 a[64:65], v10 offset:32768
    s_add_u32 m0, s73, 81920
    s_lshl_b32 s14, s95, 18
    ds_read_b64_tr_b16 a[66:67], v10 offset:34816
    buffer_load_dwordx4 v4, s[52:55], s14 offen offset:0 lds
    ds_read_b64_tr_b16 a[72:73], v10 offset:36864
    ds_read_b64_tr_b16 a[74:75], v10 offset:38912
    buffer_load_dwordx4 v5, s[52:55], s14 offen offset:1024 lds
    ds_read_b64_tr_b16 a[68:69], v11 offset:32768
    buffer_load_dwordx4 v6, s[52:55], s14 offen offset:2048 lds
    ds_read_b64_tr_b16 a[70:71], v11 offset:34816
    ds_read_b64_tr_b16 a[76:77], v11 offset:36864
    buffer_load_dwordx4 v7, s[52:55], s14 offen offset:3072 lds
    ds_read_b64_tr_b16 a[78:79], v11 offset:38912
    s_waitcnt vmcnt(24) lgkmcnt(0)
    s_barrier
    ds_read_b64_tr_b16 a[80:81], v10 offset:49152
    s_add_u32 m0, s73, 98304
    s_lshl_b32 s14, s96, 18
    ds_read_b64_tr_b16 a[82:83], v10 offset:51200
    buffer_load_dwordx4 v4, s[52:55], s14 offen offset:0 lds
    ds_read_b64_tr_b16 a[88:89], v10 offset:53248
    ds_read_b64_tr_b16 a[90:91], v10 offset:55296
    buffer_load_dwordx4 v5, s[52:55], s14 offen offset:1024 lds
    ds_read_b64_tr_b16 a[84:85], v11 offset:49152
    buffer_load_dwordx4 v6, s[52:55], s14 offen offset:2048 lds
    ds_read_b64_tr_b16 a[86:87], v11 offset:51200
    ds_read_b64_tr_b16 a[92:93], v11 offset:53248
    buffer_load_dwordx4 v7, s[52:55], s14 offen offset:3072 lds
    ds_read_b64_tr_b16 a[94:95], v11 offset:55296
    s_waitcnt vmcnt(24) lgkmcnt(0)
    s_barrier
    v_add_u32 v10, 65536, v10
    ds_read_b64_tr_b16 a[96:97], v10 offset:0
    s_add_u32 m0, s73, 114688
    s_lshl_b32 s14, s97, 18
    ds_read_b64_tr_b16 a[98:99], v10 offset:2048
    buffer_load_dwordx4 v4, s[52:55], s14 offen offset:0 lds
    ds_read_b64_tr_b16 a[104:105], v10 offset:4096
    ds_read_b64_tr_b16 a[106:107], v10 offset:6144
    buffer_load_dwordx4 v5, s[52:55], s14 offen offset:1024 lds
    v_add_u32 v11, 65536, v11
    ds_read_b64_tr_b16 a[100:101], v11 offset:0
    buffer_load_dwordx4 v6, s[52:55], s14 offen offset:2048 lds
    ds_read_b64_tr_b16 a[102:103], v11 offset:2048
    ds_read_b64_tr_b16 a[108:109], v11 offset:4096
    buffer_load_dwordx4 v7, s[52:55], s14 offen offset:3072 lds
    ds_read_b64_tr_b16 a[110:111], v11 offset:6144
    s_waitcnt vmcnt(24) lgkmcnt(0)
    s_barrier
    ds_read_b64_tr_b16 a[112:113], v10 offset:16384
    s_add_u32 m0, s73, 131072
    s_lshl_b32 s14, s98, 18
    ds_read_b64_tr_b16 a[114:115], v10 offset:18432
    buffer_load_dwordx4 v4, s[52:55], s14 offen offset:0 lds
    ds_read_b64_tr_b16 a[120:121], v10 offset:20480
    ds_read_b64_tr_b16 a[122:123], v10 offset:22528
    buffer_load_dwordx4 v5, s[52:55], s14 offen offset:1024 lds
    ds_read_b64_tr_b16 a[116:117], v11 offset:16384
    buffer_load_dwordx4 v6, s[52:55], s14 offen offset:2048 lds
    ds_read_b64_tr_b16 a[118:119], v11 offset:18432
    ds_read_b64_tr_b16 a[124:125], v11 offset:20480
    buffer_load_dwordx4 v7, s[52:55], s14 offen offset:3072 lds
    ds_read_b64_tr_b16 a[126:127], v11 offset:22528
    s_waitcnt vmcnt(24) lgkmcnt(0)
    s_barrier
    v_add_u32 v10, -131072, v10
    ds_read_b64_tr_b16 a[128:129], v10 offset:32768
    s_add_u32 m0, s73, 147456
    s_lshl_b32 s14, s99, 18
    ds_read_b64_tr_b16 a[130:131], v10 offset:34816
    buffer_load_dwordx4 v4, s[52:55], s14 offen offset:0 lds
    ds_read_b64_tr_b16 a[136:137], v10 offset:36864
    ds_read_b64_tr_b16 a[138:139], v10 offset:38912
    buffer_load_dwordx4 v5, s[52:55], s14 offen offset:1024 lds
    v_add_u32 v11, -131072, v11
    ds_read_b64_tr_b16 a[132:133], v11 offset:32768
    buffer_load_dwordx4 v6, s[52:55], s14 offen offset:2048 lds
    ds_read_b64_tr_b16 a[134:135], v11 offset:34816
    ds_read_b64_tr_b16 a[140:141], v11 offset:36864
    buffer_load_dwordx4 v7, s[52:55], s14 offen offset:3072 lds
    ds_read_b64_tr_b16 a[142:143], v11 offset:38912
    s_waitcnt vmcnt(24) lgkmcnt(0)
    s_barrier
    ds_read_b64_tr_b16 a[144:145], v10 offset:49152
    s_add_u32 m0, s73, 0
    s_lshl_b32 s14, s100, 18
    ds_read_b64_tr_b16 a[146:147], v10 offset:51200
    buffer_load_dwordx4 v4, s[52:55], s14 offen offset:0 lds
    ds_read_b64_tr_b16 a[152:153], v10 offset:53248
    ds_read_b64_tr_b16 a[154:155], v10 offset:55296
    buffer_load_dwordx4 v5, s[52:55], s14 offen offset:1024 lds
    ds_read_b64_tr_b16 a[148:149], v11 offset:49152
    buffer_load_dwordx4 v6, s[52:55], s14 offen offset:2048 lds
    ds_read_b64_tr_b16 a[150:151], v11 offset:51200
    ds_read_b64_tr_b16 a[156:157], v11 offset:53248
    buffer_load_dwordx4 v7, s[52:55], s14 offen offset:3072 lds
    ds_read_b64_tr_b16 a[158:159], v11 offset:55296
    s_waitcnt vmcnt(24) lgkmcnt(0)
    s_barrier
    v_add_u32 v10, 65536, v10
    ds_read_b64_tr_b16 a[160:161], v10 offset:0
    s_add_u32 m0, s73, 16384
    s_lshl_b32 s14, s101, 18
    ds_read_b64_tr_b16 a[162:163], v10 offset:2048
    buffer_load_dwordx4 v4, s[52:55], s14 offen offset:0 lds
    ds_read_b64_tr_b16 a[168:169], v10 offset:4096
    ds_read_b64_tr_b16 a[170:171], v10 offset:6144
    buffer_load_dwordx4 v5, s[52:55], s14 offen offset:1024 lds
    v_add_u32 v11, 65536, v11
    ds_read_b64_tr_b16 a[164:165], v11 offset:0
    buffer_load_dwordx4 v6, s[52:55], s14 offen offset:2048 lds
    ds_read_b64_tr_b16 a[166:167], v11 offset:2048
    ds_read_b64_tr_b16 a[172:173], v11 offset:4096
    buffer_load_dwordx4 v7, s[52:55], s14 offen offset:3072 lds
    ds_read_b64_tr_b16 a[174:175], v11 offset:6144
    s_waitcnt vmcnt(24) lgkmcnt(0)
    s_barrier
    ds_read_b64_tr_b16 a[176:177], v10 offset:16384
    ds_read_b64_tr_b16 a[178:179], v10 offset:18432
    ds_read_b64_tr_b16 a[184:185], v10 offset:20480
    ds_read_b64_tr_b16 a[186:187], v10 offset:22528
    ds_read_b64_tr_b16 a[180:181], v11 offset:16384
    ds_read_b64_tr_b16 a[182:183], v11 offset:18432
    ds_read_b64_tr_b16 a[188:189], v11 offset:20480
    ds_read_b64_tr_b16 a[190:191], v11 offset:22528
    s_waitcnt vmcnt(20) lgkmcnt(0)
    s_barrier
    ds_read_b64_tr_b16 a[192:193], v10 offset:32768
    ds_read_b64_tr_b16 a[194:195], v10 offset:34816
    ds_read_b64_tr_b16 a[200:201], v10 offset:36864
    ds_read_b64_tr_b16 a[202:203], v10 offset:38912
    ds_read_b64_tr_b16 a[196:197], v11 offset:32768
    ds_read_b64_tr_b16 a[198:199], v11 offset:34816
    ds_read_b64_tr_b16 a[204:205], v11 offset:36864
    ds_read_b64_tr_b16 a[206:207], v11 offset:38912
    s_waitcnt vmcnt(16) lgkmcnt(0)
    s_barrier
    ds_read_b64_tr_b16 a[208:209], v10 offset:49152
    ds_read_b64_tr_b16 a[210:211], v10 offset:51200
    ds_read_b64_tr_b16 a[216:217], v10 offset:53248
    ds_read_b64_tr_b16 a[218:219], v10 offset:55296
    ds_read_b64_tr_b16 a[212:213], v11 offset:49152
    ds_read_b64_tr_b16 a[214:215], v11 offset:51200
    ds_read_b64_tr_b16 a[220:221], v11 offset:53248
    ds_read_b64_tr_b16 a[222:223], v11 offset:55296
    s_waitcnt vmcnt(12) lgkmcnt(0)
    s_barrier
    v_add_u32 v10, 65536, v10
    ds_read_b64_tr_b16 a[224:225], v10 offset:0
    ds_read_b64_tr_b16 a[226:227], v10 offset:2048
    ds_read_b64_tr_b16 a[232:233], v10 offset:4096
    ds_read_b64_tr_b16 a[234:235], v10 offset:6144
    v_add_u32 v11, 65536, v11
    ds_read_b64_tr_b16 a[228:229], v11 offset:0
    ds_read_b64_tr_b16 a[230:231], v11 offset:2048
    ds_read_b64_tr_b16 a[236:237], v11 offset:4096
    ds_read_b64_tr_b16 a[238:239], v11 offset:6144
    s_waitcnt vmcnt(8) lgkmcnt(0)
    s_barrier
    ds_read_b64_tr_b16 a[240:241], v10 offset:16384
    ds_read_b64_tr_b16 a[242:243], v10 offset:18432
    ds_read_b64_tr_b16 a[248:249], v10 offset:20480
    ds_read_b64_tr_b16 a[250:251], v10 offset:22528
    ds_read_b64_tr_b16 a[244:245], v11 offset:16384
    ds_read_b64_tr_b16 a[246:247], v11 offset:18432
    ds_read_b64_tr_b16 a[252:253], v11 offset:20480
    ds_read_b64_tr_b16 a[254:255], v11 offset:22528
    s_waitcnt lgkmcnt(0)
    s_barrier
    v_add_u32 v10, -131072, v10
    v_add_u32 v11, -131072, v11
    s_mov_b64 exec, 0
    s_call_b64 s[82:83], L_wc_D
    s_mov_b64 exec, -1
    s_bfe_u32 s4, s2, 0x20003
    s_lshl2_add_u32 s4, s72, s4
    s_lshl_b32 s4, s4, 2
    s_lshr_b32 s5, s2, 4
    s_and_b32 s5, s5, 2
    s_add_u32 s4, s4, s5
    s_and_b32 s5, s2, 1
    s_add_u32 s4, s4, s5
    s_lshl_b32 s4, s4, 7
    s_add_u32 s4, s4, 12566528
    v_lshl_add_u32 v28, v2, 2, s4
    s_cmp_eq_u32 s3, 0
    s_cselect_b32 s4, 18, 0
    v_cmp_gt_u32 vcc, s4, v2
    v_mov_b32 v13, 0x40000000
    s_nop 0
    v_cndmask_b32 v28, v13, v28, vcc
    v_mov_b32 v13, s68
    v_cndmask_b32 v13, 0, v13, vcc
    s_mov_b32 s5, 0
L_iw:
    s_sleep 16
    v_mov_b32 v29, 0
    buffer_atomic_add v29, v28, s[44:47], 0 offen sc0 sc1
    s_waitcnt vmcnt(0)
    v_cmp_eq_u32 vcc, 0, v13
    s_nop 1
    s_mov_b64 s[6:7], vcc
    v_cmp_ne_u32 vcc, v13, v29
    s_nop 1
    s_andn2_b64 s[8:9], exec, vcc
    s_andn2_b64 s[8:9], s[8:9], s[6:7]
    s_cbranch_scc1 L_ix
    s_cmp_eq_u64 s[6:7], exec
    s_cbranch_scc1 L_ix
    s_add_u32 s5, s5, 1
    s_cmp_lt_u32 s5, 100000
    s_cbranch_scc1 L_iw
L_ix:
    v_mov_b32 v29, 0
    buffer_atomic_add v29, v28, s[44:47], 0 offen sc0 sc1
    s_branch L_DX
L_end:
.section .rodata,"a"
.p2align 6
.amdhsa_kernel recurrent_scan__ssm_conv_h3__mixer_token_mlp__prompt_kernel
  .amdhsa_next_free_vgpr 512
  .amdhsa_next_free_sgpr 102
  .amdhsa_accum_offset 256
  .amdhsa_group_segment_fixed_size 0
  .amdhsa_kernarg_size 112
  .amdhsa_user_sgpr_count 2
  .amdhsa_user_sgpr_kernarg_segment_ptr 1
  .amdhsa_system_sgpr_workgroup_id_x 1
  .amdhsa_float_denorm_mode_32 3
.end_amdhsa_kernel
```

```asm
; @launch grid=(256,1,1) block=(256,1,1) lds=163840
.amdgcn_target "amdgcn-amd-amdhsa--gfx950"
.text
.globl recurrent_scan__ssm_conv_h3__mixer_token_mlp__prompt_kernel
.p2align 8
.type recurrent_scan__ssm_conv_h3__mixer_token_mlp__prompt_kernel,@function
recurrent_scan__ssm_conv_h3__mixer_token_mlp__prompt_kernel:
    s_cmp_lt_u32 s2, 256
    s_cbranch_scc0 L_exit
    s_load_dwordx2 s[56:57], s[0:1], 0
    s_load_dwordx2 s[48:49], s[0:1], 8
    s_load_dwordx2 s[52:53], s[0:1], 16
    s_load_dwordx2 s[60:61], s[0:1], 24
    s_load_dwordx16 s[16:31], s[0:1], 0
    s_load_dwordx8 s[32:39], s[0:1], 64
    s_load_dwordx4 s[40:43], s[0:1], 96
    s_memrealtime s[12:13]
    v_lshrrev_b32 v1, 6, v0
    v_and_b32 v2, 63, v0
    s_getpc_b64 s[6:7]
L_pc:
    s_lshr_b32 s4, s2, 1
    s_and_b32 s4, s4, 124
    v_add_u32 v22, s4, v1
    v_lshl_add_u32 v22, v2, 7, v22
    v_lshlrev_b32 v22, 7, v22
    v_min_u32 v22, L_end-L_pc-4, v22
    s_mov_b64 exec, 31
    global_load_dword v255, v22, s[6:7]
    s_mov_b64 exec, -1
    v_readfirstlane_b32 s3, v1
    s_and_b32 s4, s2, 7
    s_lshr_b32 s5, s2, 3
    s_lshl_b32 s4, s4, 5
    s_add_u32 s68, s4, s5
    v_lshrrev_b32 v3, 5, v0
    v_and_b32 v4, 31, v0
    v_mul_u32_u24 v5, 1152, v3
    v_mad_u32_u24 v5, v4, 12, v5
    s_mul_i32 s15, s68, 9216
    s_mul_i32 s4, s3, 3072
    s_add_u32 s5, s4, s15
    s_sub_u32 s5, s5, 3456
    v_lshlrev_b32 v6, 4, v2
    v_add_u32 v7, s5, v6
    v_add_u32 v58, 1024, v7
    s_add_u32 s4, s4, 114688
    s_lshl_b32 s5, s3, 11
    s_add_u32 s11, s5, s15
    s_add_u32 s5, s5, 127360
    s_mov_b32 m0, s4
    s_mov_b32 s58, 2359296
    s_mov_b32 s59, 0x20000
    s_mov_b32 s50, 2359296
    s_mov_b32 s51, 0x20000
    s_mov_b32 s54, 2359296
    s_mov_b32 s55, 0x20000
    s_mov_b32 s62, 4608
    s_mov_b32 s63, 0x20000
    v_lshlrev_b32 v59, 3, v0
    s_movk_i32 s10, 4096
    s_waitcnt lgkmcnt(0)
    buffer_load_dwordx3 v[8:10], v5, s[56:59], s15 offen offset:0
    buffer_load_dwordx3 v[12:14], v5, s[56:59], s15 offen offset:384
    buffer_load_dwordx3 v[16:18], v5, s[56:59], s15 offen offset:768
    buffer_load_dwordx4 v7, s[48:51], 0 offen lds
    s_add_u32 m0, s4, 1024
    s_cmp_eq_u32 s3, 3
    buffer_load_dwordx4 v58, s[48:51], 0 offen lds
    buffer_load_dwordx4 v58, s[48:51], 0 offen offset:1024 lds
    s_cbranch_scc1 L_xld
L_nox:
    s_mov_b32 m0, s5
    buffer_load_dwordx2 v[98:99], v59, s[60:63], 0 offen
    buffer_load_dwordx4 v6, s[52:55], s11 offen lds
    buffer_load_dwordx4 v6, s[52:55], s11 offen offset:1024 lds
    buffer_load_dwordx2 v[100:101], v59, s[60:63], 0 offen offset:2048
    buffer_load_dwordx2 v[102:103], v59, s[60:63], s10 offen
    s_mov_b32 s64, s40
    s_and_b32 s65, s41, 0xffff
    s_mov_b32 s66, 256
    s_mov_b32 s67, 0x20000
    s_or_b32 s12, s12, 1
    v_or_b32 v22, s2, v0
    v_lshlrev_b32 v22, 8, v22
    v_mov_b32 v23, s12
    buffer_store_dword v23, v22, s[64:67], 0 offen sc1
    s_mov_b32 s44, s42
    s_and_b32 s45, s43, 0xffff
    s_mov_b32 s46, 57606144
    s_mov_b32 s47, 0x20000
    s_and_b32 s5, s2, 7
    s_lshr_b32 s6, s2, 3
    s_lshr_b32 s7, s6, 2
    s_lshr_b32 s8, s3, 1
    s_lshl1_add_u32 s9, s7, s8
    s_cmp_ge_u32 s9, 10
    s_addc_u32 s14, s9, 0
    s_cmp_ge_u32 s9, 3
    s_addc_u32 s14, s14, 0
    s_lshl3_add_u32 s8, s8, 3
    s_cmp_eq_u32 s7, 7
    s_cselect_b32 s14, s8, s14
    s_and_b32 s4, s5, 1
    s_lshl4_add_u32 s71, s4, s14
    s_lshr_b32 s13, s5, 1
    s_mov_b32 s72, s13
    s_and_b32 s101, s6, 3
    s_lshl_b32 s73, s3, 12
    s_mov_b32 s52, s34
    s_and_b32 s53, s35, 0xffff
    s_mov_b32 s54, 18874368
    s_mov_b32 s55, 0x20000
    s_cmp_lt_u32 s6, 27
    s_cbranch_scc0 L_aux
    s_branch L_org
L_exit:
    s_endpgm
L_xld:
    s_mov_b64 exec, 0xffffff
    buffer_load_dwordx4 v58, s[48:51], 0 offen offset:2048 lds
    s_mov_b64 exec, -1
    s_mov_b32 m0, s5
    s_nop 0
    buffer_load_dwordx4 v6, s[52:55], s11 offen offset:2048 lds
    s_branch L_nox
L_nw_G:
    s_mov_b32 s5, 0
L_nl_G:
    buffer_load_dword v45, v44, s[64:67], 0 offen sc1
    s_waitcnt vmcnt(0)
    v_readfirstlane_b32 s68, v45
    s_nop 1
    s_cmp_lg_u32 s68, 0
    s_cbranch_scc1 L_ng_G
    s_add_u32 s5, s5, 1
    s_cmp_lt_u32 s5, 100000
    s_cbranch_scc1 L_nl_G
    s_branch L_ng_G
L_rs_p1G:
    s_mov_b32 s5, 0
L_rt_p1G:
    s_mov_b64 exec, vcc
    v_mov_b32 v29, 0
    buffer_atomic_add v29, v28, s[44:47], 0 offen sc0 sc1
    s_waitcnt vmcnt(0)
    v_cmp_ne_u32 vcc, v12, v29
    s_cbranch_vccz L_rx_p1G
    s_add_u32 s5, s5, 1
    s_cmp_lt_u32 s5, 100000
    s_cbranch_scc1 L_rt_p1G
L_rx_p1G:
    s_mov_b64 exec, -1
    s_branch L_ok_p1G
L_rs_p5:
    s_mov_b32 s5, 0
L_rt_p5:
    s_mov_b64 exec, vcc
    buffer_load_dword v29, v28, s[44:47], 0 offen sc1
    s_waitcnt vmcnt(0)
    v_cmp_ne_u32 vcc, s68, v29
    s_cbranch_vccz L_rx_p5
    s_add_u32 s5, s5, 1
    s_cmp_lt_u32 s5, 100000
    s_cbranch_scc1 L_rt_p5
L_rx_p5:
    s_mov_b64 exec, -1
    s_branch L_ok_p5
L_nw_X:
    s_mov_b32 s5, 0
L_nl_X:
    buffer_load_dword v45, v44, s[64:67], 0 offen sc1
    s_waitcnt vmcnt(0)
    v_readfirstlane_b32 s68, v45
    s_nop 1
    s_cmp_lg_u32 s68, 0
    s_cbranch_scc1 L_ng_X
    s_add_u32 s5, s5, 1
    s_cmp_lt_u32 s5, 100000
    s_cbranch_scc1 L_nl_X
    s_branch L_ng_X
L_rs_p1X:
    s_mov_b32 s5, 0
L_rt_p1X:
    s_mov_b64 exec, vcc
    v_mov_b32 v29, 0
    buffer_atomic_add v29, v28, s[44:47], 0 offen sc0 sc1
    s_waitcnt vmcnt(0)
    v_cmp_ne_u32 vcc, s68, v29
    s_cbranch_vccz L_rx_p1X
    s_add_u32 s5, s5, 1
    s_cmp_lt_u32 s5, 100000
    s_cbranch_scc1 L_rt_p1X
L_rx_p1X:
    s_mov_b64 exec, -1
    s_branch L_ok_p1X
L_rs_p2G:
    s_mov_b32 s5, 0
L_rt_p2G:
    s_mov_b64 exec, vcc
    v_mov_b32 v16, 0
    buffer_atomic_add v16, v15, s[44:47], 0 offen sc0 sc1
    s_waitcnt vmcnt(0)
    v_cmp_ne_u32 vcc, v13, v16
    s_cbranch_vccz L_rx_p2G
    s_add_u32 s5, s5, 1
    s_cmp_lt_u32 s5, 100000
    s_cbranch_scc1 L_rt_p2G
L_rx_p2G:
    s_mov_b64 exec, -1
    s_branch L_ok_p2G
L_xs_a:
    s_mov_b32 s5, 0
L_xt_a:
    buffer_load_dwordx4 v[40:43], v136, s[44:47], s34 offen offset:0 sc1
    buffer_load_dwordx4 v[44:47], v136, s[44:47], s34 offen offset:1024 sc1
    buffer_load_dwordx4 v[48:51], v136, s[44:47], s34 offen offset:2048 sc1
    s_waitcnt vmcnt(0)
    v_bitop3_b32 v43, v43, v47, s68 bitop3:0x7e
    v_bitop3_b32 v43, v43, v51, s68 bitop3:0xf6
    v_cmp_ne_u32 vcc, 0, v43
    s_cbranch_vccz L_xo_a
    s_add_u32 s5, s5, 1
    s_cmp_lt_u32 s5, 100000
    s_cbranch_scc1 L_xt_a
    s_branch L_xo_a
L_as_b:
    s_mov_b32 s5, 0
L_at_b:
    v_mov_b32 v141, 0
    buffer_atomic_add v141, v139, s[44:47], s11 offen offset:2060 sc0 sc1
    s_waitcnt vmcnt(0)
    v_cmp_ne_u32 vcc, v140, v141
    s_cbranch_vccz L_ao_b
    s_add_u32 s5, s5, 1
    s_cmp_lt_u32 s5, 100000
    s_cbranch_scc1 L_at_b
    s_branch L_ao_b
L_xs_b:
    s_mov_b32 s5, 0
L_xt_b:
    buffer_load_dwordx4 v[56:59], v136, s[44:47], s11 offen offset:0 sc1
    buffer_load_dwordx4 v[60:63], v136, s[44:47], s11 offen offset:1024 sc1
    buffer_load_dwordx4 v[64:67], v136, s[44:47], s11 offen offset:2048 sc1
    s_waitcnt vmcnt(0)
    v_bitop3_b32 v59, v59, v63, s68 bitop3:0x7e
    v_bitop3_b32 v59, v59, v67, s68 bitop3:0xf6
    v_cmp_ne_u32 vcc, 0, v59
    s_cbranch_vccz L_xo_b
    s_add_u32 s5, s5, 1
    s_cmp_lt_u32 s5, 100000
    s_cbranch_scc1 L_xt_b
    s_branch L_xo_b
L_xs_z:
    s_mov_b32 s5, 0
L_xt_z:
    buffer_load_dwordx4 v[72:75], v136, s[44:47], s12 offen offset:0 sc1
    buffer_load_dwordx4 v[76:79], v136, s[44:47], s12 offen offset:1024 sc1
    buffer_load_dwordx4 v[80:83], v136, s[44:47], s12 offen offset:2048 sc1
    s_waitcnt vmcnt(0)
    v_bitop3_b32 v75, v75, v79, s68 bitop3:0x7e
    v_bitop3_b32 v75, v75, v83, s68 bitop3:0xf6
    v_cmp_ne_u32 vcc, 0, v75
    s_cbranch_vccz L_xo_z
    s_add_u32 s5, s5, 1
    s_cmp_lt_u32 s5, 100000
    s_cbranch_scc1 L_xt_z
    s_branch L_xo_z
L_rs_p3:
    s_mov_b32 s5, 0
L_rt_p3:
    s_mov_b64 exec, vcc
    buffer_load_dword v189, v188, s[44:47], 0 offen sc1
    s_waitcnt vmcnt(0)
    v_cmp_ne_u32 vcc, s68, v189
    s_cbranch_vccz L_rx_p3
    s_add_u32 s5, s5, 1
    s_cmp_lt_u32 s5, 100000
    s_cbranch_scc1 L_rt_p3
L_rx_p3:
    s_mov_b64 exec, -1
    s_branch L_ok_p3
L_xs_8:
    s_mov_b32 s5, 0
L_xt_8:
    buffer_load_dwordx4 v[204:207], v136, s[44:47], s35 offen offset:0 sc1
    buffer_load_dwordx4 v[208:211], v136, s[44:47], s35 offen offset:1024 sc1
    buffer_load_dwordx4 v[212:215], v136, s[44:47], s35 offen offset:2048 sc1
    buffer_load_dwordx4 v[216:219], v136, s[44:47], s35 offen offset:3072 sc1
    s_waitcnt vmcnt(0)
    v_bitop3_b32 v207, v207, v211, s36 bitop3:0x7e
    v_bitop3_b32 v207, v207, v215, s36 bitop3:0xf6
    v_bitop3_b32 v207, v207, v219, s36 bitop3:0xf6
    v_cmp_ne_u32 vcc, 0, v207
    s_cbranch_vccz L_xo_8
    s_add_u32 s5, s5, 1
    s_cmp_lt_u32 s5, 100000
    s_cbranch_scc1 L_xt_8
    s_branch L_xo_8
L_rs_p2X:
    s_mov_b32 s5, 0
L_rt_p2X:
    s_mov_b64 exec, vcc
    v_mov_b32 v29, 0
    buffer_atomic_add v29, v28, s[44:47], 0 offen sc0 sc1
    s_waitcnt vmcnt(0)
    v_cmp_ne_u32 vcc, v13, v29
    s_cbranch_vccz L_rx_p2X
    s_add_u32 s5, s5, 1
    s_cmp_lt_u32 s5, 100000
    s_cbranch_scc1 L_rt_p2X
L_rx_p2X:
    s_mov_b64 exec, -1
    s_branch L_ok_p2X
L_wc_G:
    s_cmp_eq_u32 s3, 0
    s_cbranch_scc1 L_pl_G_0
    s_cmp_eq_u32 s3, 1
    s_cbranch_scc1 L_pl_G_1
    s_cmp_eq_u32 s3, 2
    s_cbranch_scc1 L_pl_G_2
    s_branch L_pl_G_3
L_wc_X:
    s_cmp_eq_u32 s3, 0
    s_cbranch_scc1 L_pl_X_0
    s_cmp_eq_u32 s3, 1
    s_cbranch_scc1 L_pl_X_1
    s_cmp_eq_u32 s3, 2
    s_cbranch_scc1 L_pl_X_2
    s_branch L_pl_X_3
L_wc_D:
    s_cmp_eq_u32 s3, 0
    s_cbranch_scc1 L_pl_D_0
    s_cmp_eq_u32 s3, 1
    s_cbranch_scc1 L_pl_D_1
    s_cmp_eq_u32 s3, 2
    s_cbranch_scc1 L_pl_D_2
    s_branch L_wret
L_wret:
    s_setpc_b64 s[82:83]
.p2align 12
L_org:
    s_mul_i32 s7, s6, 21846
    s_lshr_b32 s7, s7, 16
    s_mul_i32 s8, s7, 3
    s_sub_u32 s12, s6, s8
    s_mul_i32 s8, s13, 9
    s_add_u32 s69, s8, s7
    s_lshl1_add_u32 s70, s12, s4
    s_mul_i32 s8, s69, 6
    s_add_u32 s75, s8, s70
    s_mov_b32 s48, s30
    s_and_b32 s49, s31, 0xffff
    s_mov_b32 s50, 18874368
    s_mov_b32 s51, 0x20000
    s_add_u32 s12, s12, s7
    s_mul_i32 s8, s12, 21846
    s_lshr_b32 s8, s8, 16
    s_mul_i32 s8, s8, 3
    s_sub_u32 s12, s12, s8
    s_mul_i32 s4, s4, 1179648
    s_mul_i32 s7, s12, 65538
    s_lshr_b32 s7, s7, 16
    s_mul_i32 s7, s7, 73728
    s_add_u32 s5, s4, 0
    s_add_u32 s18, s7, s5
    s_add_u32 s8, s5, 221184
    s_add_u32 s19, s18, 73728
    s_cmp_eq_u32 s19, s8
    s_cselect_b32 s19, s5, s19
    s_add_u32 s20, s19, 73728
    s_cmp_eq_u32 s20, s8
    s_cselect_b32 s20, s5, s20
    s_mul_i32 s7, s12, 65538
    s_lshr_b32 s7, s7, 16
    s_mul_i32 s7, s7, 73728
    s_add_u32 s5, s4, 221184
    s_add_u32 s21, s7, s5
    s_add_u32 s8, s5, 221184
    s_add_u32 s22, s21, 73728
    s_cmp_eq_u32 s22, s8
    s_cselect_b32 s22, s5, s22
    s_add_u32 s23, s22, 73728
    s_cmp_eq_u32 s23, s8
    s_cselect_b32 s23, s5, s23
    s_mul_i32 s7, s12, 87384
    s_lshr_b32 s7, s7, 16
    s_mul_i32 s7, s7, 73728
    s_add_u32 s5, s4, 442368
    s_add_u32 s24, s7, s5
    s_add_u32 s8, s5, 294912
    s_add_u32 s25, s24, 73728
    s_cmp_eq_u32 s25, s8
    s_cselect_b32 s25, s5, s25
    s_add_u32 s26, s25, 73728
    s_cmp_eq_u32 s26, s8
    s_cselect_b32 s26, s5, s26
    s_add_u32 s27, s26, 73728
    s_cmp_eq_u32 s27, s8
    s_cselect_b32 s27, s5, s27
    s_mul_i32 s7, s12, 131076
    s_lshr_b32 s7, s7, 16
    s_mul_i32 s7, s7, 73728
    s_add_u32 s5, s4, 737280
    s_add_u32 s76, s7, s5
    s_add_u32 s8, s5, 442368
    s_add_u32 s77, s76, 73728
    s_cmp_eq_u32 s77, s8
    s_cselect_b32 s77, s5, s77
    s_add_u32 s78, s77, 73728
    s_cmp_eq_u32 s78, s8
    s_cselect_b32 s78, s5, s78
    s_add_u32 s79, s78, 73728
    s_cmp_eq_u32 s79, s8
    s_cselect_b32 s79, s5, s79
    s_add_u32 s80, s79, 73728
    s_cmp_eq_u32 s80, s8
    s_cselect_b32 s80, s5, s80
    s_add_u32 s81, s80, 73728
    s_cmp_eq_u32 s81, s8
    s_cselect_b32 s81, s5, s81
    v_lshrrev_b32 v24, 4, v2
    v_and_b32 v25, 15, v2
    v_lshlrev_b32 v26, 1, v24
    v_xor_b32 v25, v25, v26
    v_mul_u32_u24 v24, 9216, v24
    v_lshl_add_u32 v24, v25, 4, v24
    s_mul_i32 s7, s3, 147456
    s_lshl_b32 s8, s69, 8
    s_add_u32 s7, s7, s8
    v_add_u32 v148, s7, v24
    v_add_u32 v149, 35840, v148
    v_xor_b32 v24, 128, v148
    v_add_u32 v150, 71680, v24
    v_add_u32 v151, 35840, v150
    v_bfe_u32 v140, v2, 2, 2
    v_lshrrev_b32 v141, 4, v2
    v_lshl_add_u32 v142, v141, 3, v140
    v_lshlrev_b32 v142, 8, v142
    v_and_b32 v143, 3, v2
    v_lshl_add_u32 v142, v143, 3, v142
    v_and_b32 v141, 1, v141
    v_lshl_add_u32 v140, v141, 2, v140
    s_lshl_b32 s7, s3, 1
    v_xor_b32 v140, s7, v140
    v_lshl_add_u32 v152, v140, 5, v142
    v_xor_b32 v153, 32, v152
    v_add_u32 v154, 0x10000, v152
    v_add_u32 v155, 0x10000, v153
    v_and_b32 v24, 15, v2
    v_lshrrev_b32 v25, 4, v2
    v_mul_u32_u24 v26, 17408, v25
    v_lshl_add_u32 v26, v24, 4, v26
    v_mul_u32_u24 v25, 1536, v25
    v_lshl_add_u32 v25, v24, 4, v25
    v_add_u32 v159, 81920, v25
    v_add_u32 v250, 36864, v159
    s_mul_i32 s7, s3, 18432
    s_xor_b32 s8, s70, 1
    s_mul_i32 s8, s8, 1536
    s_add_u32 s7, s7, s8
    v_lshlrev_b32 v246, 4, v2
    v_add_u32 v156, s7, v246
    v_lshrrev_b32 v25, 5, v2
    v_mul_u32_u24 v25, 7680, v25
    v_add_u32 v157, v156, v25
    v_add_u32 v158, 7680, v156
    s_mul_i32 s74, s3, 3072
    s_add_u32 s74, s74, 81920
    v_mov_b32 v245, v26
    s_mov_b32 s9, 144896
    s_mov_b32 s11, 114688
    s_waitcnt vmcnt(9)
    v_and_b32 v21, 0xffff0000, v8
    s_add_u32 m0, s73, 81920
    s_lshl_b32 s14, s18, 3
    buffer_load_dwordx4 v148, s[48:51], s14 offen offset:0 lds
    v_lshlrev_b32 v20, 16, v8
    v_and_b32 v23, 0xffff0000, v9
    v_lshlrev_b32 v22, 16, v9
    v_and_b32 v25, 0xffff0000, v10
    v_lshlrev_b32 v24, 16, v10
    v_and_b32 v27, 0xffff0000, v12
    v_lshlrev_b32 v26, 16, v12
    v_and_b32 v29, 0xffff0000, v13
    v_lshlrev_b32 v28, 16, v13
    v_and_b32 v31, 0xffff0000, v14
    v_lshlrev_b32 v30, 16, v14
    v_and_b32 v33, 0xffff0000, v16
    v_lshlrev_b32 v32, 16, v16
    v_and_b32 v35, 0xffff0000, v17
    v_lshlrev_b32 v34, 16, v17
    v_and_b32 v37, 0xffff0000, v18
    v_lshlrev_b32 v36, 16, v18
    v_pk_add_f32 v[38:39], v[20:21], v[22:23]
    v_pk_add_f32 v[40:41], v[24:25], v[26:27]
    v_pk_add_f32 v[42:43], v[28:29], v[30:31]
    v_pk_add_f32 v[44:45], v[32:33], v[34:35]
    v_pk_add_f32 v[38:39], v[38:39], v[40:41]
    v_pk_add_f32 v[42:43], v[42:43], v[44:45]
    v_pk_add_f32 v[38:39], v[38:39], v[36:37]
    v_pk_add_f32 v[38:39], v[38:39], v[42:43]
    v_add_f32 v56, v38, v39
    buffer_load_dwordx4 v149, s[48:51], s14 offen offset:1024 lds
    s_nop 0
    v_add_f32_dpp v56, v56, v56 row_ror:8 row_mask:0xf bank_mask:0xf
    s_nop 1
    v_add_f32_dpp v56, v56, v56 row_ror:4 row_mask:0xf bank_mask:0xf
    s_nop 1
    v_add_f32_dpp v56, v56, v56 row_ror:2 row_mask:0xf bank_mask:0xf
    s_nop 1
    v_add_f32_dpp v56, v56, v56 row_ror:1 row_mask:0xf bank_mask:0xf
    v_mov_b32 v57, v56
    s_nop 1
    v_permlane16_swap_b32 v56, v57
    v_add_f32 v56, v56, v57
    v_mul_f32 v56, 0x3ae38e39, v56
    v_pk_add_f32 v[20:21], v[20:21], v[56:57] op_sel_hi:[1,0] neg_lo:[0,1] neg_hi:[0,1]
    v_pk_add_f32 v[22:23], v[22:23], v[56:57] op_sel_hi:[1,0] neg_lo:[0,1] neg_hi:[0,1]
    v_pk_add_f32 v[24:25], v[24:25], v[56:57] op_sel_hi:[1,0] neg_lo:[0,1] neg_hi:[0,1]
    v_pk_add_f32 v[26:27], v[26:27], v[56:57] op_sel_hi:[1,0] neg_lo:[0,1] neg_hi:[0,1]
    v_pk_add_f32 v[28:29], v[28:29], v[56:57] op_sel_hi:[1,0] neg_lo:[0,1] neg_hi:[0,1]
    v_pk_add_f32 v[30:31], v[30:31], v[56:57] op_sel_hi:[1,0] neg_lo:[0,1] neg_hi:[0,1]
    v_pk_add_f32 v[32:33], v[32:33], v[56:57] op_sel_hi:[1,0] neg_lo:[0,1] neg_hi:[0,1]
    v_pk_add_f32 v[34:35], v[34:35], v[56:57] op_sel_hi:[1,0] neg_lo:[0,1] neg_hi:[0,1]
    v_pk_add_f32 v[36:37], v[36:37], v[56:57] op_sel_hi:[1,0] neg_lo:[0,1] neg_hi:[0,1]
    v_pk_mul_f32 v[38:39], v[20:21], v[20:21]
    v_pk_mul_f32 v[40:41], v[22:23], v[22:23]
    v_pk_fma_f32 v[38:39], v[24:25], v[24:25], v[38:39]
    v_pk_fma_f32 v[40:41], v[26:27], v[26:27], v[40:41]
    v_pk_fma_f32 v[38:39], v[28:29], v[28:29], v[38:39]
    v_pk_fma_f32 v[40:41], v[30:31], v[30:31], v[40:41]
    v_pk_fma_f32 v[38:39], v[32:33], v[32:33], v[38:39]
    v_pk_fma_f32 v[40:41], v[34:35], v[34:35], v[40:41]
    v_pk_fma_f32 v[38:39], v[36:37], v[36:37], v[38:39]
    buffer_load_dwordx4 v150, s[48:51], s14 offen offset:2048 lds
    v_pk_add_f32 v[38:39], v[38:39], v[40:41]
    v_add_f32 v18, v38, v39
    s_nop 1
    v_add_f32_dpp v18, v18, v18 row_ror:8 row_mask:0xf bank_mask:0xf
    s_nop 1
    v_add_f32_dpp v18, v18, v18 row_ror:4 row_mask:0xf bank_mask:0xf
    s_nop 1
    v_add_f32_dpp v18, v18, v18 row_ror:2 row_mask:0xf bank_mask:0xf
    s_nop 1
    v_add_f32_dpp v18, v18, v18 row_ror:1 row_mask:0xf bank_mask:0xf
    v_mov_b32 v19, v18
    s_nop 1
    v_permlane16_swap_b32 v18, v19
    v_add_f32 v18, v18, v19
    v_mul_f32 v18, 0x3ae38e39, v18
    v_cvt_pk_bf16_f32 v38, v56, v18
    v_lshlrev_b32 v106, 16, v38
    v_and_b32 v38, 0xffff0000, v38
    v_add_f32 v38, 0x3727c5ac, v38
    v_sub_f32 v56, v56, v106
    v_cvt_pk_bf16_f32 v38, v38, v38
    v_lshlrev_b32 v38, 16, v38
    v_sqrt_f32 v38, v38
    s_nop 0
    v_cvt_pk_bf16_f32 v38, v38, v38
    v_lshlrev_b32 v38, 16, v38
    v_rcp_f32 v107, v38
    s_nop 0
    v_mul_f32 v56, v56, v107
    v_mul_f32 v18, v18, v107
    v_mul_f32 v18, v18, v107
    v_cvt_pk_bf16_f32 v38, v56, v18
    v_lshlrev_b32 v39, 16, v38
    buffer_load_dwordx4 v151, s[48:51], s14 offen offset:3072 lds
    v_and_b32 v38, 0xffff0000, v38
    v_add_f32 v38, 0x3727c5ac, v38
    v_sub_f32 v56, v56, v39
    v_cvt_pk_bf16_f32 v38, v38, v38
    v_lshlrev_b32 v38, 16, v38
    v_sqrt_f32 v38, v38
    s_nop 0
    v_cvt_pk_bf16_f32 v38, v38, v38
    v_lshlrev_b32 v38, 16, v38
    v_rcp_f32 v38, v38
    s_nop 0
    v_mul_f32 v18, v107, v38
    v_mul_f32 v56, v56, v38
    v_pk_fma_f32 v[20:21], v[20:21], v[18:19], v[56:57] op_sel_hi:[1,0,0]
    v_pk_fma_f32 v[22:23], v[22:23], v[18:19], v[56:57] op_sel_hi:[1,0,0]
    v_pk_fma_f32 v[24:25], v[24:25], v[18:19], v[56:57] op_sel_hi:[1,0,0]
    v_pk_fma_f32 v[26:27], v[26:27], v[18:19], v[56:57] op_sel_hi:[1,0,0]
    v_pk_fma_f32 v[28:29], v[28:29], v[18:19], v[56:57] op_sel_hi:[1,0,0]
    v_pk_fma_f32 v[30:31], v[30:31], v[18:19], v[56:57] op_sel_hi:[1,0,0]
    v_pk_fma_f32 v[32:33], v[32:33], v[18:19], v[56:57] op_sel_hi:[1,0,0]
    v_pk_fma_f32 v[34:35], v[34:35], v[18:19], v[56:57] op_sel_hi:[1,0,0]
    v_pk_fma_f32 v[36:37], v[36:37], v[18:19], v[56:57] op_sel_hi:[1,0,0]
    v_cvt_pk_bf16_f32 v8, v20, v21
    v_cvt_pk_bf16_f32 v9, v22, v23
    v_cvt_pk_bf16_f32 v10, v24, v25
    v_cvt_pk_bf16_f32 v11, v26, v27
    v_cvt_pk_bf16_f32 v12, v28, v29
    v_cvt_pk_bf16_f32 v13, v30, v31
    v_cvt_pk_bf16_f32 v14, v32, v33
    v_cvt_pk_bf16_f32 v15, v34, v35
    v_cvt_pk_bf16_f32 v16, v36, v37
    v_lshrrev_b32 v3, 5, v0
    v_and_b32 v1, 31, v0
    v_mul_u32_u24 v17, 1216, v3
    v_mad_u32_u24 v17, v1, 12, v17
    v_add_u32 v17, 144896, v17
    ds_write_b32 v17, v8 offset:0
    ds_write_b32 v17, v9 offset:4
    ds_write_b32 v17, v10 offset:8
    ds_write_b32 v17, v11 offset:384
    ds_write_b32 v17, v12 offset:388
    ds_write_b32 v17, v13 offset:392
    ds_write_b32 v17, v14 offset:768
    ds_write_b32 v17, v15 offset:772
    ds_write_b32 v17, v16 offset:776
    v_lshlrev_b32 v3, 3, v3
    s_lshl_b32 s5, s68, 6
    s_add_u32 s5, s5, 12386304
    v_cmp_eq_u32 vcc, 0, v1
    v_mov_b32 v18, 0x40000000
    s_nop 0
    v_cndmask_b32 v3, v18, v3, vcc
    buffer_store_dwordx2 v[106:107], v3, s[44:47], s5 offen sc1
    v_lshrrev_b32 v19, 4, v0
    v_and_b32 v17, 3, v2
    v_lshlrev_b32 v17, 3, v17
    v_lshl_add_u32 v19, v19, 5, v17
    v_bfe_u32 v6, v2, 2, 2
    v_mul_u32_u24 v17, 1216, v6
    v_mul_u32_u24 v6, 1152, v6
    v_add3_u32 v17, v17, v19, s9
    v_add3_u32 v6, v6, v19, s11
    v_lshlrev_b32 v19, 4, v0
    s_add_u32 s7, s15, 4096
    s_add_u32 s8, s15, 8192
    s_cmp_eq_u32 s3, 0
    s_cselect_b32 s8, s8, 0x40000000
    v_add_u32 v18, 2359296, v19
    v_mov_b32 v44, 0
    s_waitcnt lgkmcnt(0)
    s_barrier
    ds_read_b64_tr_b16 v[20:21], v17 offset:0
    ds_read_b64_tr_b16 v[22:23], v17 offset:4864
    ds_read_b64_tr_b16 v[24:25], v17 offset:512
    ds_read_b64_tr_b16 v[26:27], v17 offset:5376
    ds_read_b64_tr_b16 v[28:29], v17 offset:1024
    ds_read_b64_tr_b16 v[30:31], v17 offset:5888
    s_bfe_u32 s6, s68, 0x20001
    s_lshl_b32 s6, s6, 6
    s_lshr_b32 s9, s68, 3
    s_lshl_b32 s9, s9, 1
    s_add_u32 s6, s6, s9
    s_and_b32 s9, s68, 1
    s_add_u32 s6, s6, s9
    s_lshl_b32 s4, s6, 2
    s_add_u32 s4, s4, 12533760
    v_lshl_add_u32 v1, v0, 10, s4
    v_add_u32 v46, 65536, v1
    v_mov_b32 v47, 0x40000000
    v_cmp_gt_u32 vcc, 8, v0
    s_nop 1
    v_cndmask_b32 v1, v47, v1, vcc
    v_cmp_gt_u32 vcc, 4, v0
    s_nop 1
    v_cndmask_b32 v46, v47, v46, vcc
    s_waitcnt lgkmcnt(4)
    buffer_store_dwordx4 v[20:23], v19, s[44:47], s15 offen sc1
    s_waitcnt lgkmcnt(2)
    buffer_store_dwordx4 v[24:27], v19, s[44:47], s7 offen sc1
    s_waitcnt lgkmcnt(0)
    buffer_store_dwordx4 v[28:31], v19, s[44:47], s8 offen sc1
    buffer_load_dword v45, v44, s[64:67], 0 offen sc1
    s_waitcnt vmcnt(10)
    s_barrier
    ds_read_b64_tr_b16 v[60:61], v6 offset:0
    ds_read_b64_tr_b16 v[62:63], v6 offset:4608
    ds_read_b64_tr_b16 v[64:65], v6 offset:9216
    ds_read_b64_tr_b16 v[66:67], v6 offset:12672
    ds_read_b64_tr_b16 v[68:69], v6 offset:17280
    ds_read_b64_tr_b16 v[70:71], v6 offset:512
    ds_read_b64_tr_b16 v[72:73], v6 offset:5120
    ds_read_b64_tr_b16 v[74:75], v6 offset:9728
    ds_read_b64_tr_b16 v[76:77], v6 offset:13184
    ds_read_b64_tr_b16 v[78:79], v6 offset:17792
    v_alignbit_b32 v114, v99, v99, 16
    v_alignbit_b32 v115, v98, v98, 16
    s_waitcnt lgkmcnt(5)
    v_alignbit_b32 v108, v61, v60, 16
    v_alignbit_b32 v109, v62, v61, 16
    v_alignbit_b32 v110, v63, v62, 16
    v_alignbit_b32 v111, v64, v63, 16
    v_alignbit_b32 v112, v65, v64, 16
    v_dot2_f32_bf16 v116, v60, v114, 0
    ds_read_b64_tr_b16 v[80:81], v6 offset:1024
    v_dot2_f32_bf16 v117, v108, v114, 0
    v_dot2_f32_bf16 v118, v61, v114, 0
    v_dot2_f32_bf16 v119, v109, v114, 0
    v_dot2_f32_bf16 v120, v62, v114, 0
    ds_read_b64_tr_b16 v[82:83], v6 offset:5632
    v_dot2_f32_bf16 v121, v110, v114, 0
    v_dot2_f32_bf16 v122, v63, v114, 0
    v_dot2_f32_bf16 v123, v111, v114, 0
    v_dot2_f32_bf16 v116, v61, v115, v116
    v_dot2_f32_bf16 v117, v109, v115, v117
    ds_read_b64_tr_b16 v[84:85], v6 offset:10240
    v_dot2_f32_bf16 v118, v62, v115, v118
    v_dot2_f32_bf16 v119, v110, v115, v119
    v_dot2_f32_bf16 v120, v63, v115, v120
    v_dot2_f32_bf16 v121, v111, v115, v121
    v_dot2_f32_bf16 v122, v64, v115, v122
    ds_read_b64_tr_b16 v[86:87], v6 offset:13696
    v_dot2_f32_bf16 v123, v112, v115, v123
    v_and_b32 v133, 0xffff0000, v66
    v_lshlrev_b32 v132, 16, v66
    v_and_b32 v135, 0xffff0000, v67
    v_lshlrev_b32 v134, 16, v67
    ds_read_b64_tr_b16 v[88:89], v6 offset:18304
    v_and_b32 v137, 0xffff0000, v68
    v_lshlrev_b32 v136, 16, v68
    v_and_b32 v139, 0xffff0000, v69
    v_lshlrev_b32 v138, 16, v69
    v_pk_mul_f32 v[116:117], v[116:117], v[132:133]
    v_pk_mul_f32 v[118:119], v[118:119], v[134:135]
    v_pk_mul_f32 v[120:121], v[120:121], v[136:137]
    v_pk_mul_f32 v[122:123], v[122:123], v[138:139]
    v_cvt_pk_bf16_f32 v160, v123, v122
    v_cvt_pk_bf16_f32 v161, v121, v120
    v_cvt_pk_bf16_f32 v162, v119, v118
    v_cvt_pk_bf16_f32 v163, v117, v116
    buffer_store_dwordx4 v[160:163], v18, s[44:47], s15 offen sc1
    v_alignbit_b32 v114, v101, v101, 16
    v_alignbit_b32 v115, v100, v100, 16
    s_waitcnt lgkmcnt(5)
    v_alignbit_b32 v108, v71, v70, 16
    v_alignbit_b32 v109, v72, v71, 16
    v_alignbit_b32 v110, v73, v72, 16
    v_alignbit_b32 v111, v74, v73, 16
    v_alignbit_b32 v112, v75, v74, 16
    v_dot2_f32_bf16 v124, v70, v114, 0
    v_dot2_f32_bf16 v125, v108, v114, 0
    v_dot2_f32_bf16 v126, v71, v114, 0
    v_dot2_f32_bf16 v127, v109, v114, 0
    v_dot2_f32_bf16 v128, v72, v114, 0
    v_dot2_f32_bf16 v129, v110, v114, 0
    v_dot2_f32_bf16 v130, v73, v114, 0
    v_dot2_f32_bf16 v131, v111, v114, 0
    v_dot2_f32_bf16 v124, v71, v115, v124
    v_dot2_f32_bf16 v125, v109, v115, v125
    v_dot2_f32_bf16 v126, v72, v115, v126
    v_dot2_f32_bf16 v127, v110, v115, v127
    v_dot2_f32_bf16 v128, v73, v115, v128
    v_dot2_f32_bf16 v129, v111, v115, v129
    v_dot2_f32_bf16 v130, v74, v115, v130
    v_dot2_f32_bf16 v131, v112, v115, v131
    v_and_b32 v133, 0xffff0000, v76
    v_lshlrev_b32 v132, 16, v76
    v_and_b32 v135, 0xffff0000, v77
    v_lshlrev_b32 v134, 16, v77
    v_and_b32 v137, 0xffff0000, v78
    v_lshlrev_b32 v136, 16, v78
    v_and_b32 v139, 0xffff0000, v79
    v_lshlrev_b32 v138, 16, v79
    v_pk_mul_f32 v[124:125], v[124:125], v[132:133]
    v_pk_mul_f32 v[126:127], v[126:127], v[134:135]
    v_pk_mul_f32 v[128:129], v[128:129], v[136:137]
    v_pk_mul_f32 v[130:131], v[130:131], v[138:139]
    v_cvt_pk_bf16_f32 v164, v131, v130
    v_cvt_pk_bf16_f32 v165, v129, v128
    v_cvt_pk_bf16_f32 v166, v127, v126
    v_cvt_pk_bf16_f32 v167, v125, v124
    buffer_store_dwordx4 v[164:167], v18, s[44:47], s7 offen sc1
    v_alignbit_b32 v114, v103, v103, 16
    v_alignbit_b32 v115, v102, v102, 16
    s_waitcnt lgkmcnt(0)
    v_alignbit_b32 v108, v81, v80, 16
    v_alignbit_b32 v109, v82, v81, 16
    v_alignbit_b32 v110, v83, v82, 16
    v_alignbit_b32 v111, v84, v83, 16
    v_alignbit_b32 v112, v85, v84, 16
    v_dot2_f32_bf16 v116, v80, v114, 0
    v_dot2_f32_bf16 v117, v108, v114, 0
    v_dot2_f32_bf16 v118, v81, v114, 0
    v_dot2_f32_bf16 v119, v109, v114, 0
    v_dot2_f32_bf16 v120, v82, v114, 0
    v_dot2_f32_bf16 v121, v110, v114, 0
    v_dot2_f32_bf16 v122, v83, v114, 0
    v_dot2_f32_bf16 v123, v111, v114, 0
    v_dot2_f32_bf16 v116, v81, v115, v116
    v_dot2_f32_bf16 v117, v109, v115, v117
    v_dot2_f32_bf16 v118, v82, v115, v118
    v_dot2_f32_bf16 v119, v110, v115, v119
    v_dot2_f32_bf16 v120, v83, v115, v120
    v_dot2_f32_bf16 v121, v111, v115, v121
    v_dot2_f32_bf16 v122, v84, v115, v122
    v_dot2_f32_bf16 v123, v112, v115, v123
    v_and_b32 v133, 0xffff0000, v86
    v_lshlrev_b32 v132, 16, v86
    v_and_b32 v135, 0xffff0000, v87
    v_lshlrev_b32 v134, 16, v87
    v_and_b32 v137, 0xffff0000, v88
    v_lshlrev_b32 v136, 16, v88
    v_and_b32 v139, 0xffff0000, v89
    v_lshlrev_b32 v138, 16, v89
    v_pk_mul_f32 v[116:117], v[116:117], v[132:133]
    v_pk_mul_f32 v[118:119], v[118:119], v[134:135]
    v_pk_mul_f32 v[120:121], v[120:121], v[136:137]
    v_pk_mul_f32 v[122:123], v[122:123], v[138:139]
    v_cvt_pk_bf16_f32 v168, v123, v122
    v_cvt_pk_bf16_f32 v169, v121, v120
    v_cvt_pk_bf16_f32 v170, v119, v118
    v_cvt_pk_bf16_f32 v171, v117, v116
    buffer_store_dwordx4 v[168:171], v18, s[44:47], s8 offen sc1
    s_add_u32 m0, s73, 98304
    s_lshl_b32 s14, s19, 3
    buffer_load_dwordx4 v148, s[48:51], s14 offen offset:0 lds
    buffer_load_dwordx4 v149, s[48:51], s14 offen offset:1024 lds
    buffer_load_dwordx4 v150, s[48:51], s14 offen offset:2048 lds
    buffer_load_dwordx4 v151, s[48:51], s14 offen offset:3072 lds
    s_add_u32 m0, s73, 0
    s_lshl_b32 s14, s20, 3
    buffer_load_dwordx4 v148, s[48:51], s14 offen offset:0 lds
    buffer_load_dwordx4 v149, s[48:51], s14 offen offset:1024 lds
    buffer_load_dwordx4 v150, s[48:51], s14 offen offset:2048 lds
    buffer_load_dwordx4 v151, s[48:51], s14 offen offset:3072 lds
    s_add_u32 m0, s73, 16384
    s_lshl_b32 s14, s21, 3
    buffer_load_dwordx4 v148, s[48:51], s14 offen offset:0 lds
    buffer_load_dwordx4 v149, s[48:51], s14 offen offset:1024 lds
    s_waitcnt vmcnt(13)
    v_readfirstlane_b32 s68, v45
    s_nop 1
    s_cmp_eq_u32 s68, 0
    s_cbranch_scc1 L_nw_G
L_ng_G:
    s_barrier
    v_mov_b32 v3, s68
    buffer_store_dword v3, v1, s[44:47], 0 offen sc1
    s_mov_b64 exec, 0
    s_call_b64 s[82:83], L_wc_G
    s_mov_b64 exec, -1
    v_mov_b32 v1, v46
    s_waitcnt vmcnt(11)
    s_barrier
    buffer_store_dword v3, v1, s[44:47], 0 offen sc1
L_segG:
L_pl_G_0:
    s_cbranch_execz L_pl_G_4
    buffer_load_dwordx4 v150, s[48:51], s14 offen offset:2048 lds
    buffer_load_dwordx4 v151, s[48:51], s14 offen offset:3072 lds
    s_add_u32 m0, s73, 32768
    s_lshl_b32 s14, s22, 3
    buffer_load_dwordx4 v148, s[48:51], s14 offen offset:0 lds
    buffer_load_dwordx4 v149, s[48:51], s14 offen offset:1024 lds
    buffer_load_dwordx4 v150, s[48:51], s14 offen offset:2048 lds
    buffer_load_dwordx4 v151, s[48:51], s14 offen offset:3072 lds
    s_add_u32 m0, s73, 49152
    s_lshl_b32 s14, s23, 3
    buffer_load_dwordx4 v148, s[48:51], s14 offen offset:0 lds
    buffer_load_dwordx4 v149, s[48:51], s14 offen offset:1024 lds
    buffer_load_dwordx4 v150, s[48:51], s14 offen offset:2048 lds
    buffer_load_dwordx4 v151, s[48:51], s14 offen offset:3072 lds
    s_add_u32 m0, s73, 65536
    s_lshl_b32 s14, s24, 3
    buffer_load_dwordx4 v148, s[48:51], s14 offen offset:0 lds
    buffer_load_dwordx4 v149, s[48:51], s14 offen offset:1024 lds
    buffer_load_dwordx4 v150, s[48:51], s14 offen offset:2048 lds
    buffer_load_dwordx4 v151, s[48:51], s14 offen offset:3072 lds
    s_mov_b64 exec, 0
    s_call_b64 s[82:83], L_wc_D
    s_mov_b64 exec, -1
    s_mov_b32 s56, s32
    s_and_b32 s57, s33, 0xffff
    s_mov_b32 s58, 9216
    s_mov_b32 s59, 0x20000
    s_mov_b32 s60, s36
    s_and_b32 s61, s37, 0xffff
    s_mov_b32 s62, 4096
    s_mov_b32 s63, 0x20000
    s_and_b32 s4, s70, 1
    s_lshl1_add_u32 s4, s3, s4
    s_lshl_b32 s4, s4, 7
    s_bfe_u32 s5, s2, 0x10003
    s_lshl1_add_u32 s5, s72, s5
    s_lshr_b32 s5, s5, 0
    s_lshl_b32 s5, s5, 10
    s_add_u32 s4, s4, s5
    s_add_u32 s4, s4, 12533760
    v_lshl_add_u32 v28, v2, 2, s4
    v_cmp_gt_u32 vcc, 32, v2
    v_mov_b32 v12, 0x40000000
    s_nop 0
    v_cndmask_b32 v28, v12, v28, vcc
    v_mov_b32 v12, s68
    v_cndmask_b32 v12, 0, v12, vcc
    v_lshrrev_b32 v24, 4, v2
    v_lshlrev_b32 v25, 3, v24
    s_lshl_b32 s7, s69, 8
    s_lshl_b32 s8, s3, 6
    s_add_u32 s7, s7, s8
    buffer_load_dwordx2 v[144:145], v25, s[56:59], s7 offen
    buffer_load_dwordx2 v[146:147], v25, s[56:59], s7 offen offset:32
    s_waitcnt vmcnt(24)
    s_barrier
    ds_read_b64_tr_b16 a[0:1], v154 offset:16384
    ds_read_b64_tr_b16 a[2:3], v154 offset:17408
    ds_read_b64_tr_b16 a[4:5], v155 offset:16384
    ds_read_b64_tr_b16 a[6:7], v155 offset:17408
    ds_read_b64_tr_b16 a[8:9], v154 offset:24576
    ds_read_b64_tr_b16 a[10:11], v154 offset:25600
    ds_read_b64_tr_b16 a[12:13], v155 offset:24576
    ds_read_b64_tr_b16 a[14:15], v155 offset:25600
    ds_read_b64_tr_b16 a[16:17], v154 offset:32768
    ds_read_b64_tr_b16 a[18:19], v154 offset:33792
    ds_read_b64_tr_b16 a[20:21], v155 offset:32768
    ds_read_b64_tr_b16 a[22:23], v155 offset:33792
    ds_read_b64_tr_b16 a[24:25], v154 offset:40960
    ds_read_b64_tr_b16 a[26:27], v154 offset:41984
    ds_read_b64_tr_b16 a[28:29], v155 offset:40960
    ds_read_b64_tr_b16 a[30:31], v155 offset:41984
    s_waitcnt vmcnt(20)
    s_barrier
    ds_read_b64_tr_b16 a[32:33], v152 offset:0
    ds_read_b64_tr_b16 a[34:35], v152 offset:1024
    ds_read_b64_tr_b16 a[36:37], v153 offset:0
    ds_read_b64_tr_b16 a[38:39], v153 offset:1024
    ds_read_b64_tr_b16 a[40:41], v152 offset:8192
    ds_read_b64_tr_b16 a[42:43], v152 offset:9216
    ds_read_b64_tr_b16 a[44:45], v153 offset:8192
    ds_read_b64_tr_b16 a[46:47], v153 offset:9216
    s_waitcnt vmcnt(14)
    s_barrier
    ds_read_b64_tr_b16 a[48:49], v152 offset:16384
    ds_read_b64_tr_b16 a[50:51], v152 offset:17408
    ds_read_b64_tr_b16 a[52:53], v153 offset:16384
    ds_read_b64_tr_b16 a[54:55], v153 offset:17408
    ds_read_b64_tr_b16 a[56:57], v152 offset:24576
    ds_read_b64_tr_b16 a[58:59], v152 offset:25600
    ds_read_b64_tr_b16 a[60:61], v153 offset:24576
    ds_read_b64_tr_b16 a[62:63], v153 offset:25600
    v_mov_b32 v29, 0
    buffer_atomic_add v29, v28, s[44:47], 0 offen sc0 sc1
    s_waitcnt vmcnt(11)
    s_barrier
    ds_read_b64_tr_b16 a[64:65], v152 offset:32768
    ds_read_b64_tr_b16 a[66:67], v152 offset:33792
    ds_read_b64_tr_b16 a[68:69], v153 offset:32768
    ds_read_b64_tr_b16 a[70:71], v153 offset:33792
    ds_read_b64_tr_b16 a[72:73], v152 offset:40960
    ds_read_b64_tr_b16 a[74:75], v152 offset:41984
    ds_read_b64_tr_b16 a[76:77], v153 offset:40960
    ds_read_b64_tr_b16 a[78:79], v153 offset:41984
    s_waitcnt lgkmcnt(0)
    s_barrier
    s_waitcnt vmcnt(0)
    v_cmp_ne_u32 vcc, v12, v29
    s_cbranch_vccnz L_rs_p1G
L_ok_p1G:
    s_add_u32 m0, s74, 0
    s_nop 0
    buffer_load_dwordx4 v156, s[44:47], s18 offen offset:0 sc1 lds
    buffer_load_dwordx4 v157, s[44:47], s18 offen offset:1024 sc1 lds
    buffer_load_dwordx4 v158, s[44:47], s18 offen offset:2048 sc1 lds
    s_add_u32 m0, s74, 12288
    s_nop 0
    buffer_load_dwordx4 v156, s[44:47], s19 offen offset:0 sc1 lds
    buffer_load_dwordx4 v157, s[44:47], s19 offen offset:1024 sc1 lds
    buffer_load_dwordx4 v158, s[44:47], s19 offen offset:2048 sc1 lds
    s_add_u32 m0, s74, 24576
    s_nop 0
    buffer_load_dwordx4 v156, s[44:47], s20 offen offset:0 sc1 lds
    buffer_load_dwordx4 v157, s[44:47], s20 offen offset:1024 sc1 lds
    buffer_load_dwordx4 v158, s[44:47], s20 offen offset:2048 sc1 lds
    s_add_u32 m0, s74, 36864
    s_nop 0
    buffer_load_dwordx4 v156, s[44:47], s21 offen offset:0 sc1 lds
L_pl_G_1:
    s_cbranch_execz L_pl_G_5
    buffer_load_dwordx4 v157, s[44:47], s21 offen offset:1024 sc1 lds
    buffer_load_dwordx4 v158, s[44:47], s21 offen offset:2048 sc1 lds
    s_add_u32 m0, s73, 0
    s_lshl_b32 s14, s25, 3
    buffer_load_dwordx4 v148, s[48:51], s14 offen offset:0 lds
    buffer_load_dwordx4 v149, s[48:51], s14 offen offset:1024 lds
    buffer_load_dwordx4 v150, s[48:51], s14 offen offset:2048 lds
    buffer_load_dwordx4 v151, s[48:51], s14 offen offset:3072 lds
    s_waitcnt vmcnt(13) lgkmcnt(0)
    s_barrier
    ds_read_b128 v[80:83], v159 offset:0
    ds_read_b128 v[84:87], v159 offset:6144
    ds_read_b128 v[88:91], v159 offset:256
    ds_read_b128 v[92:95], v159 offset:6400
    ds_read_b128 v[96:99], v159 offset:512
    ds_read_b128 v[100:103], v159 offset:6656
    s_waitcnt lgkmcnt(0)
    v_mfma_f32_16x16x32_bf16 v[192:195], a[0:3], v[80:83], 0
    v_mfma_f32_16x16x32_bf16 v[192:195], a[8:11], v[84:87], v[192:195]
    ds_read_b128 v[104:107], v159 offset:768
    v_mfma_f32_16x16x32_bf16 v[196:199], a[12:15], v[84:87], 0
    ds_read_b128 v[108:111], v159 offset:6912
    v_mfma_f32_16x16x32_bf16 v[196:199], a[4:7], v[80:83], v[196:199]
    ds_read_b128 v[112:115], v159 offset:1024
    v_mfma_f32_16x16x32_bf16 v[204:207], a[4:7], v[88:91], 0
    ds_read_b128 v[116:119], v159 offset:7168
    v_mfma_f32_16x16x32_bf16 v[204:207], a[12:15], v[92:95], v[204:207]
    ds_read_b128 v[120:123], v159 offset:1280
    v_mfma_f32_16x16x32_bf16 v[200:203], a[8:11], v[92:95], 0
    ds_read_b128 v[124:127], v159 offset:7424
    v_and_b32 v24, 15, v2
    s_lshl_b32 s7, s71, 6
    v_add_u32 v24, s7, v24
    s_and_b32 s8, s3, 1
    s_lshl_b32 s4, s8, 5
    v_add_u32 v25, s4, v24
    v_lshlrev_b32 v26, 3, v25
    v_mul_u32_u24 v25, 1152, v25
    v_bfe_u32 v31, v2, 4, 1
    v_lshl_add_u32 v25, v31, 5, v25
    v_lshrrev_b32 v31, 5, v2
    v_lshl_add_u32 v25, v31, 4, v25
    s_bfe_u32 s7, s2, 0x20003
    s_mul_i32 s7, s7, 288
    s_lshl_b32 s4, s72, 6
    s_add_u32 s4, s4, s7
    v_add_u32 v252, s4, v25
    s_xor_b32 s8, s3, s72
    s_and_b32 s4, s72, 1
    s_lshl1_add_u32 s4, s4, s8
    v_lshl_add_u32 v24, s4, 4, v24
    s_add_u32 s7, s7, 256
    s_cmp_lt_u32 s8, 2
    s_cselect_b32 s7, s7, 0x40000000
    v_lshlrev_b32 v18, 3, v24
    v_mul_u32_u24 v24, 1152, v24
    v_lshrrev_b32 v31, 4, v2
    v_mfma_f32_16x16x32_bf16 v[200:203], a[0:3], v[88:91], v[200:203]
    v_mfma_f32_16x16x32_bf16 v[208:211], a[0:3], v[96:99], 0
    v_mfma_f32_16x16x32_bf16 v[208:211], a[8:11], v[100:103], v[208:211]
    v_mfma_f32_16x16x32_bf16 v[212:215], a[12:15], v[100:103], 0
    v_mfma_f32_16x16x32_bf16 v[212:215], a[4:7], v[96:99], v[212:215]
    s_waitcnt lgkmcnt(0)
    v_mfma_f32_16x16x32_bf16 v[220:223], a[4:7], v[104:107], 0
    s_waitcnt vmcnt(10)
    s_barrier
    v_mfma_f32_16x16x32_bf16 v[220:223], a[12:15], v[108:111], v[220:223]
    ds_read_b128 v[80:83], v159 offset:12288
    s_add_u32 m0, s74, 49152
    v_mfma_f32_16x16x32_bf16 v[216:219], a[8:11], v[108:111], 0
    ds_read_b128 v[84:87], v159 offset:18432
    buffer_load_dwordx4 v156, s[44:47], s22 offen offset:0 sc1 lds
    v_mfma_f32_16x16x32_bf16 v[216:219], a[0:3], v[104:107], v[216:219]
    ds_read_b128 v[88:91], v159 offset:12544
    v_mfma_f32_16x16x32_bf16 v[224:227], a[0:3], v[112:115], 0
    ds_read_b128 v[92:95], v159 offset:18688
    buffer_load_dwordx4 v157, s[44:47], s22 offen offset:1024 sc1 lds
    v_mfma_f32_16x16x32_bf16 v[224:227], a[8:11], v[116:119], v[224:227]
    ds_read_b128 v[96:99], v159 offset:12800
    v_mfma_f32_16x16x32_bf16 v[228:231], a[12:15], v[116:119], 0
    ds_read_b128 v[100:103], v159 offset:18944
    buffer_load_dwordx4 v158, s[44:47], s22 offen offset:2048 sc1 lds
    v_lshl_add_u32 v24, v31, 3, v24
    v_add_u32 v253, s7, v24
    v_lshrrev_b32 v24, 3, v2
    v_and_b32 v25, 7, v2
    v_bfe_u32 v31, v2, 4, 2
    v_lshlrev_b32 v31, 1, v31
    v_xor_b32 v25, v25, v31
    v_lshlrev_b32 v24, 12, v24
    v_lshl_add_u32 v24, v25, 4, v24
    s_mul_i32 s7, s72, 36
    s_bitcmp1_b32 s3, 0
    s_addc_u32 s7, s7, 0
    s_lshl_b32 s7, s7, 17
    s_lshl_b32 s8, s71, 7
    s_add_u32 s7, s7, s8
    v_add_u32 v4, s7, v24
    v_add_u32 v5, 31744, v4
    v_add_u32 v6, 31744, v5
    v_add_u32 v7, 31744, v6
    v_lshrrev_b32 v24, 2, v2
    v_lshlrev_b32 v24, 7, v24
    v_and_b32 v25, 3, v2
    v_lshl_add_u32 v24, v25, 3, v24
    s_and_b32 s7, s73, 8192
    v_add_u32 v24, s7, v24
    v_bfe_u32 v31, v2, 3, 2
    s_and_b32 s7, s3, 1
    v_mfma_f32_16x16x32_bf16 v[228:231], a[4:7], v[112:115], v[228:231]
    ds_read_b64_tr_b16 a[80:81], v152 offset:49152
    v_mfma_f32_16x16x32_bf16 v[236:239], a[4:7], v[120:123], 0
    ds_read_b64_tr_b16 a[82:83], v152 offset:50176
    s_add_u32 m0, s74, 61440
    v_mfma_f32_16x16x32_bf16 v[236:239], a[12:15], v[124:127], v[236:239]
    v_mfma_f32_16x16x32_bf16 v[232:235], a[8:11], v[124:127], 0
    ds_read_b64_tr_b16 a[84:85], v153 offset:49152
    buffer_load_dwordx4 v156, s[44:47], s23 offen offset:0 sc1 lds
    v_mfma_f32_16x16x32_bf16 v[232:235], a[0:3], v[120:123], v[232:235]
    ds_read_b64_tr_b16 a[86:87], v153 offset:50176
    s_waitcnt lgkmcnt(4)
    v_mfma_f32_16x16x32_bf16 v[192:195], a[16:19], v[80:83], v[192:195]
    buffer_load_dwordx4 v157, s[44:47], s23 offen offset:1024 sc1 lds
    v_mfma_f32_16x16x32_bf16 v[192:195], a[24:27], v[84:87], v[192:195]
    ds_read_b128 v[104:107], v159 offset:13056
    buffer_load_dwordx4 v158, s[44:47], s23 offen offset:2048 sc1 lds
    v_mfma_f32_16x16x32_bf16 v[196:199], a[28:31], v[84:87], v[196:199]
    ds_read_b128 v[108:111], v159 offset:19200
    v_mfma_f32_16x16x32_bf16 v[196:199], a[20:23], v[80:83], v[196:199]
    ds_read_b128 v[112:115], v159 offset:13312
    s_add_u32 m0, s73, 16384
    s_lshl_b32 s14, s26, 3
    v_mfma_f32_16x16x32_bf16 v[204:207], a[20:23], v[88:91], v[204:207]
    ds_read_b128 v[116:119], v159 offset:19456
    v_mfma_f32_16x16x32_bf16 v[204:207], a[28:31], v[92:95], v[204:207]
    ds_read_b128 v[120:123], v159 offset:13568
    buffer_load_dwordx4 v148, s[48:51], s14 offen offset:0 lds
    v_mfma_f32_16x16x32_bf16 v[200:203], a[24:27], v[92:95], v[200:203]
    ds_read_b128 v[124:127], v159 offset:19712
    buffer_load_dwordx4 v149, s[48:51], s14 offen offset:1024 lds
    s_lshl_b32 s7, s7, 1
    v_xor_b32 v31, s7, v31
    v_lshl_add_u32 v10, v31, 5, v24
    v_xor_b32 v11, 32, v10
    s_mul_i32 s84, s101, 14
    s_lshr_b32 s84, s84, 2
    s_add_u32 s84, s84, 0
    s_add_u32 s85, s84, 1
    s_cmp_eq_u32 s85, 14
    s_cselect_b32 s85, 0, s85
    s_add_u32 s86, s85, 1
    s_cmp_eq_u32 s86, 14
    s_cselect_b32 s86, 0, s86
    s_add_u32 s87, s86, 1
    s_cmp_eq_u32 s87, 14
    s_cselect_b32 s87, 0, s87
    s_add_u32 s88, s87, 1
    s_cmp_eq_u32 s88, 14
    s_cselect_b32 s88, 0, s88
    s_add_u32 s89, s88, 1
    s_cmp_eq_u32 s89, 14
    s_cselect_b32 s89, 0, s89
    s_add_u32 s90, s89, 1
    s_cmp_eq_u32 s90, 14
    s_cselect_b32 s90, 0, s90
    s_add_u32 s91, s90, 1
    s_cmp_eq_u32 s91, 14
    s_cselect_b32 s91, 0, s91
    s_add_u32 s92, s91, 1
    s_cmp_eq_u32 s92, 14
    s_cselect_b32 s92, 0, s92
    s_add_u32 s93, s92, 1
    s_cmp_eq_u32 s93, 14
    s_cselect_b32 s93, 0, s93
    s_add_u32 s94, s93, 1
    s_cmp_eq_u32 s94, 14
    s_cselect_b32 s94, 0, s94
    s_add_u32 s95, s94, 1
    s_cmp_eq_u32 s95, 14
    s_cselect_b32 s95, 0, s95
    s_add_u32 s96, s95, 1
    s_cmp_eq_u32 s96, 14
    s_cselect_b32 s96, 0, s96
    s_add_u32 s97, s96, 1
    s_cmp_eq_u32 s97, 14
    s_cselect_b32 s97, 0, s97
    s_mul_i32 s98, s101, 4
    s_lshr_b32 s98, s98, 2
    s_add_u32 s98, s98, 14
    s_add_u32 s99, s98, 1
    s_cmp_eq_u32 s99, 18
    s_cselect_b32 s99, 14, s99
    s_add_u32 s100, s99, 1
    s_cmp_eq_u32 s100, 18
    s_cselect_b32 s100, 14, s100
    s_add_u32 s101, s100, 1
    s_cmp_eq_u32 s101, 18
    s_cselect_b32 s101, 14, s101
    s_mul_i32 s7, s70, 6
    s_add_u32 s7, s7, 0
    s_mul_i32 s8, s7, 7282
    s_lshr_b32 s8, s8, 16
    v_mfma_f32_16x16x32_bf16 v[200:203], a[16:19], v[88:91], v[200:203]
    ds_read_b64_tr_b16 a[88:89], v152 offset:57344
    v_mfma_f32_16x16x32_bf16 v[208:211], a[16:19], v[96:99], v[208:211]
    ds_read_b64_tr_b16 a[90:91], v152 offset:58368
    buffer_load_dwordx4 v150, s[48:51], s14 offen offset:2048 lds
    v_mfma_f32_16x16x32_bf16 v[208:211], a[24:27], v[100:103], v[208:211]
    v_mfma_f32_16x16x32_bf16 v[212:215], a[28:31], v[100:103], v[212:215]
    ds_read_b64_tr_b16 a[92:93], v153 offset:57344
    buffer_load_dwordx4 v151, s[48:51], s14 offen offset:3072 lds
    v_mfma_f32_16x16x32_bf16 v[212:215], a[20:23], v[96:99], v[212:215]
    ds_read_b64_tr_b16 a[94:95], v153 offset:58368
    s_waitcnt lgkmcnt(4)
    v_mfma_f32_16x16x32_bf16 v[220:223], a[20:23], v[104:107], v[220:223]
    s_waitcnt vmcnt(17)
    s_barrier
    v_mfma_f32_16x16x32_bf16 v[220:223], a[28:31], v[108:111], v[220:223]
    ds_read_b128 v[80:83], v159 offset:24576
    s_add_u32 m0, s74, 0
    v_mfma_f32_16x16x32_bf16 v[216:219], a[24:27], v[108:111], v[216:219]
    ds_read_b128 v[84:87], v159 offset:30720
    buffer_load_dwordx4 v156, s[44:47], s24 offen offset:0 sc1 lds
    v_mfma_f32_16x16x32_bf16 v[216:219], a[16:19], v[104:107], v[216:219]
    ds_read_b128 v[88:91], v159 offset:24832
    v_mfma_f32_16x16x32_bf16 v[224:227], a[16:19], v[112:115], v[224:227]
    ds_read_b128 v[92:95], v159 offset:30976
    buffer_load_dwordx4 v157, s[44:47], s24 offen offset:1024 sc1 lds
    v_mfma_f32_16x16x32_bf16 v[224:227], a[24:27], v[116:119], v[224:227]
    ds_read_b128 v[96:99], v159 offset:25088
    v_mfma_f32_16x16x32_bf16 v[228:231], a[28:31], v[116:119], v[228:231]
    ds_read_b128 v[100:103], v159 offset:31232
    buffer_load_dwordx4 v158, s[44:47], s24 offen offset:2048 sc1 lds
    s_mul_i32 s5, s8, 9
    s_sub_u32 s7, s7, s5
    s_lshl_b32 s7, s7, 2
    s_mov_b32 s4, 0xeca86420
    s_mov_b32 s5, 3
    s_lshr_b64 s[4:5], s[4:5], s7
    s_and_b32 s4, s4, 15
    s_lshl4_add_u32 s4, s8, s4
    v_lshl_add_u32 v240, s4, 8, v245
    s_mul_i32 s7, s70, 6
    s_add_u32 s7, s7, 1
    s_mul_i32 s8, s7, 7282
    s_lshr_b32 s8, s8, 16
    s_mul_i32 s5, s8, 9
    s_sub_u32 s7, s7, s5
    s_lshl_b32 s7, s7, 2
    s_mov_b32 s4, 0xeca86420
    s_mov_b32 s5, 3
    s_lshr_b64 s[4:5], s[4:5], s7
    s_and_b32 s4, s4, 15
    s_lshl4_add_u32 s4, s8, s4
    v_lshl_add_u32 v241, s4, 8, v245
    s_mul_i32 s7, s70, 6
    s_add_u32 s7, s7, 2
    s_mul_i32 s8, s7, 7282
    s_lshr_b32 s8, s8, 16
    s_mul_i32 s5, s8, 9
    v_mfma_f32_16x16x32_bf16 v[228:231], a[20:23], v[112:115], v[228:231]
    ds_read_b64_tr_b16 a[96:97], v154 offset:0
    v_mfma_f32_16x16x32_bf16 v[236:239], a[20:23], v[120:123], v[236:239]
    ds_read_b64_tr_b16 a[98:99], v154 offset:1024
    s_add_u32 m0, s74, 12288
    v_mfma_f32_16x16x32_bf16 v[236:239], a[28:31], v[124:127], v[236:239]
    v_mfma_f32_16x16x32_bf16 v[232:235], a[24:27], v[124:127], v[232:235]
    ds_read_b64_tr_b16 a[100:101], v155 offset:0
    buffer_load_dwordx4 v156, s[44:47], s25 offen offset:0 sc1 lds
    v_mfma_f32_16x16x32_bf16 v[232:235], a[16:19], v[120:123], v[232:235]
    ds_read_b64_tr_b16 a[102:103], v155 offset:1024
    s_waitcnt lgkmcnt(4)
    v_mfma_f32_16x16x32_bf16 v[192:195], a[32:35], v[80:83], v[192:195]
    buffer_load_dwordx4 v157, s[44:47], s25 offen offset:1024 sc1 lds
    v_mfma_f32_16x16x32_bf16 v[192:195], a[40:43], v[84:87], v[192:195]
    ds_read_b128 v[104:107], v159 offset:25344
    buffer_load_dwordx4 v158, s[44:47], s25 offen offset:2048 sc1 lds
    v_mfma_f32_16x16x32_bf16 v[196:199], a[44:47], v[84:87], v[196:199]
    ds_read_b128 v[108:111], v159 offset:31488
    v_mfma_f32_16x16x32_bf16 v[196:199], a[36:39], v[80:83], v[196:199]
    ds_read_b128 v[112:115], v159 offset:25600
    s_add_u32 m0, s73, 32768
    s_lshl_b32 s14, s27, 3
    v_mfma_f32_16x16x32_bf16 v[204:207], a[36:39], v[88:91], v[204:207]
    ds_read_b128 v[116:119], v159 offset:31744
    v_mfma_f32_16x16x32_bf16 v[204:207], a[44:47], v[92:95], v[204:207]
    ds_read_b128 v[120:123], v159 offset:25856
    buffer_load_dwordx4 v148, s[48:51], s14 offen offset:0 lds
    v_mfma_f32_16x16x32_bf16 v[200:203], a[40:43], v[92:95], v[200:203]
    ds_read_b128 v[124:127], v159 offset:32000
    buffer_load_dwordx4 v149, s[48:51], s14 offen offset:1024 lds
    s_sub_u32 s7, s7, s5
    s_lshl_b32 s7, s7, 2
    s_mov_b32 s4, 0xeca86420
    s_mov_b32 s5, 3
    s_lshr_b64 s[4:5], s[4:5], s7
    s_and_b32 s4, s4, 15
    s_lshl4_add_u32 s4, s8, s4
    v_lshl_add_u32 v242, s4, 8, v245
    s_mul_i32 s7, s70, 6
    s_add_u32 s7, s7, 3
    s_mul_i32 s8, s7, 7282
    s_lshr_b32 s8, s8, 16
    s_mul_i32 s5, s8, 9
    s_sub_u32 s7, s7, s5
    s_lshl_b32 s7, s7, 2
    s_mov_b32 s4, 0xeca86420
    s_mov_b32 s5, 3
    s_lshr_b64 s[4:5], s[4:5], s7
    s_and_b32 s4, s4, 15
    s_lshl4_add_u32 s4, s8, s4
    v_lshl_add_u32 v243, s4, 8, v245
    s_mul_i32 s7, s70, 6
    s_add_u32 s7, s7, 4
    s_mul_i32 s8, s7, 7282
    s_lshr_b32 s8, s8, 16
    s_mul_i32 s5, s8, 9
    v_mfma_f32_16x16x32_bf16 v[200:203], a[32:35], v[88:91], v[200:203]
    ds_read_b64_tr_b16 a[104:105], v154 offset:8192
    v_mfma_f32_16x16x32_bf16 v[208:211], a[32:35], v[96:99], v[208:211]
    ds_read_b64_tr_b16 a[106:107], v154 offset:9216
    buffer_load_dwordx4 v150, s[48:51], s14 offen offset:2048 lds
    v_mfma_f32_16x16x32_bf16 v[208:211], a[40:43], v[100:103], v[208:211]
    v_mfma_f32_16x16x32_bf16 v[212:215], a[44:47], v[100:103], v[212:215]
    ds_read_b64_tr_b16 a[108:109], v155 offset:8192
    buffer_load_dwordx4 v151, s[48:51], s14 offen offset:3072 lds
    v_mfma_f32_16x16x32_bf16 v[212:215], a[36:39], v[96:99], v[212:215]
    ds_read_b64_tr_b16 a[110:111], v155 offset:9216
    s_waitcnt lgkmcnt(4)
    v_mfma_f32_16x16x32_bf16 v[220:223], a[36:39], v[104:107], v[220:223]
    s_waitcnt vmcnt(20)
    s_barrier
    v_mfma_f32_16x16x32_bf16 v[220:223], a[44:47], v[108:111], v[220:223]
    ds_read_b128 v[80:83], v250 offset:0
    s_add_u32 m0, s74, 24576
    v_mfma_f32_16x16x32_bf16 v[216:219], a[40:43], v[108:111], v[216:219]
    ds_read_b128 v[84:87], v250 offset:6144
    v_mfma_f32_16x16x32_bf16 v[216:219], a[32:35], v[104:107], v[216:219]
    ds_read_b128 v[88:91], v250 offset:256
    buffer_load_dwordx4 v156, s[44:47], s26 offen offset:0 sc1 lds
    v_mfma_f32_16x16x32_bf16 v[224:227], a[32:35], v[112:115], v[224:227]
    ds_read_b128 v[92:95], v250 offset:6400
    v_mfma_f32_16x16x32_bf16 v[224:227], a[40:43], v[116:119], v[224:227]
    ds_read_b128 v[96:99], v250 offset:512
    v_mfma_f32_16x16x32_bf16 v[228:231], a[44:47], v[116:119], v[228:231]
    ds_read_b128 v[100:103], v250 offset:6656
    buffer_load_dwordx4 v157, s[44:47], s26 offen offset:1024 sc1 lds
    s_sub_u32 s7, s7, s5
    s_lshl_b32 s7, s7, 2
    s_mov_b32 s4, 0xeca86420
    s_mov_b32 s5, 3
    s_lshr_b64 s[4:5], s[4:5], s7
    s_and_b32 s4, s4, 15
    s_lshl4_add_u32 s4, s8, s4
    v_lshl_add_u32 v244, s4, 8, v245
    s_mul_i32 s7, s70, 6
    s_add_u32 s7, s7, 5
    s_mul_i32 s8, s7, 7282
    s_lshr_b32 s8, s8, 16
    s_mul_i32 s5, s8, 9
    s_sub_u32 s7, s7, s5
    s_lshl_b32 s7, s7, 2
    s_mov_b32 s4, 0xeca86420
    s_mov_b32 s5, 3
    s_lshr_b64 s[4:5], s[4:5], s7
    s_and_b32 s4, s4, 15
    s_lshl4_add_u32 s4, s8, s4
    v_lshl_add_u32 v245, s4, 8, v245
    s_xor_b32 s7, s75, 1
    s_lshl2_add_u32 s7, s7, s3
    s_mul_i32 s9, s7, 6144
    s_add_u32 s9, s9, 28065792
    s_lshl_b32 s7, s7, 7
    s_add_u32 s6, s7, 33374208
    s_lshl2_add_u32 s7, s75, s3
    s_mul_i32 s10, s7, 6144
    s_add_u32 s10, s10, 28065792
    s_lshl_b32 s7, s7, 7
    v_mfma_f32_16x16x32_bf16 v[228:231], a[36:39], v[112:115], v[228:231]
    ds_read_b64_tr_b16 a[112:113], v152 offset:0
    v_mfma_f32_16x16x32_bf16 v[236:239], a[36:39], v[120:123], v[236:239]
    ds_read_b64_tr_b16 a[114:115], v152 offset:1024
    v_mfma_f32_16x16x32_bf16 v[236:239], a[44:47], v[124:127], v[236:239]
    buffer_load_dwordx4 v158, s[44:47], s26 offen offset:2048 sc1 lds
    v_mfma_f32_16x16x32_bf16 v[232:235], a[40:43], v[124:127], v[232:235]
    ds_read_b64_tr_b16 a[116:117], v153 offset:0
    v_mfma_f32_16x16x32_bf16 v[232:235], a[32:35], v[120:123], v[232:235]
    ds_read_b64_tr_b16 a[118:119], v153 offset:1024
    s_waitcnt lgkmcnt(4)
    v_mfma_f32_16x16x32_bf16 v[192:195], a[48:51], v[80:83], v[192:195]
    s_add_u32 m0, s73, 49152
    s_lshl_b32 s14, s76, 3
    v_mfma_f32_16x16x32_bf16 v[192:195], a[56:59], v[84:87], v[192:195]
    ds_read_b128 v[104:107], v250 offset:768
    v_mfma_f32_16x16x32_bf16 v[196:199], a[60:63], v[84:87], v[196:199]
    ds_read_b128 v[108:111], v250 offset:6912
    buffer_load_dwordx4 v148, s[48:51], s14 offen offset:0 lds
    v_mfma_f32_16x16x32_bf16 v[196:199], a[52:55], v[80:83], v[196:199]
    ds_read_b128 v[112:115], v250 offset:1024
    v_mfma_f32_16x16x32_bf16 v[204:207], a[52:55], v[88:91], v[204:207]
    ds_read_b128 v[116:119], v250 offset:7168
    buffer_load_dwordx4 v149, s[48:51], s14 offen offset:1024 lds
    v_mfma_f32_16x16x32_bf16 v[204:207], a[60:63], v[92:95], v[204:207]
    ds_read_b128 v[120:123], v250 offset:1280
    v_mfma_f32_16x16x32_bf16 v[200:203], a[56:59], v[92:95], v[200:203]
    ds_read_b128 v[124:127], v250 offset:7424
    s_add_u32 s7, s7, 33374208
    v_mov_b32 v28, s7
    v_add_u32 v247, 3072, v246
    v_cmp_eq_u32 vcc, 0, v2
    v_mov_b32 v248, 0x40000000
    s_nop 0
    v_cndmask_b32 v248, v248, 0, vcc
    v_mov_b32 v249, s68
    v_and_b32 v129, 0xffff0000, v144
    v_lshlrev_b32 v128, 16, v144
    v_and_b32 v131, 0xffff0000, v145
    v_lshlrev_b32 v130, 16, v145
    v_and_b32 v133, 0xffff0000, v146
    v_lshlrev_b32 v132, 16, v146
    v_and_b32 v135, 0xffff0000, v147
    v_lshlrev_b32 v134, 16, v147
    s_mul_i32 s4, s70, 43691
    s_lshr_b32 s4, s4, 16
    s_mul_i32 s5, s70, 21846
    s_lshr_b32 s5, s5, 16
    s_mul_i32 s5, s5, 3
    s_sub_u32 s5, s70, s5
    s_lshl2_add_u32 s4, s72, s4
    s_lshl_b32 s4, s4, 10
    s_mul_i32 s7, s72, 9
    s_sub_u32 s7, s69, s7
    s_lshl3_add_u32 s4, s7, s4
    v_mfma_f32_16x16x32_bf16 v[200:203], a[48:51], v[88:91], v[200:203]
    ds_read_b64_tr_b16 a[120:121], v152 offset:8192
    buffer_load_dwordx4 v150, s[48:51], s14 offen offset:2048 lds
    v_mfma_f32_16x16x32_bf16 v[208:211], a[48:51], v[96:99], v[208:211]
    ds_read_b64_tr_b16 a[122:123], v152 offset:9216
    v_mfma_f32_16x16x32_bf16 v[208:211], a[56:59], v[100:103], v[208:211]
    buffer_load_dwordx4 v151, s[48:51], s14 offen offset:3072 lds
    v_mfma_f32_16x16x32_bf16 v[212:215], a[60:63], v[100:103], v[212:215]
    ds_read_b64_tr_b16 a[124:125], v153 offset:8192
    v_mfma_f32_16x16x32_bf16 v[212:215], a[52:55], v[96:99], v[212:215]
    ds_read_b64_tr_b16 a[126:127], v153 offset:9216
    s_waitcnt lgkmcnt(4)
    v_mfma_f32_16x16x32_bf16 v[220:223], a[52:55], v[104:107], v[220:223]
    s_waitcnt vmcnt(17)
    s_barrier
    v_mfma_f32_16x16x32_bf16 v[220:223], a[60:63], v[108:111], v[220:223]
    ds_read_b128 v[80:83], v250 offset:12288
    s_add_u32 m0, s74, 36864
    v_mfma_f32_16x16x32_bf16 v[216:219], a[56:59], v[108:111], v[216:219]
    ds_read_b128 v[84:87], v250 offset:18432
    v_mfma_f32_16x16x32_bf16 v[216:219], a[48:51], v[104:107], v[216:219]
    ds_read_b128 v[88:91], v250 offset:12544
    buffer_load_dwordx4 v156, s[44:47], s27 offen offset:0 sc1 lds
    v_mfma_f32_16x16x32_bf16 v[224:227], a[48:51], v[112:115], v[224:227]
    ds_read_b128 v[92:95], v250 offset:18688
    v_mfma_f32_16x16x32_bf16 v[224:227], a[56:59], v[116:119], v[224:227]
    ds_read_b128 v[96:99], v250 offset:12800
    v_mfma_f32_16x16x32_bf16 v[228:231], a[60:63], v[116:119], v[228:231]
    ds_read_b128 v[100:103], v250 offset:18944
    buffer_load_dwordx4 v157, s[44:47], s27 offen offset:1024 sc1 lds
    s_add_u32 s4, s4, 12566528
    s_cmp_eq_u32 s5, 1
    s_cselect_b32 s7, 16, 8
    s_cmp_lg_u32 s5, 0
    s_cselect_b32 s5, 4, 0
    v_lshlrev_b32 v17, 7, v0
    v_add_u32 v17, s4, v17
    v_cmp_gt_u32 vcc, 8, v0
    v_mov_b32 v24, s5
    s_nop 0
    v_cndmask_b32 v24, 0, v24, vcc
    v_add_u32 v17, v17, v24
    v_cmp_gt_u32 vcc, s7, v0
    v_mov_b32 v24, 0x40000000
    s_nop 0
    v_cndmask_b32 v17, v24, v17, vcc
    s_bfe_u32 s4, s2, 0x20003
    s_lshl2_add_u32 s4, s72, s4
    s_lshl_b32 s4, s4, 3
    s_lshr_b32 s5, s2, 4
    s_and_b32 s5, s5, 6
    s_add_u32 s4, s4, s5
    s_and_b32 s5, s2, 1
    s_add_u32 s4, s4, s5
    s_lshl_b32 s4, s4, 7
    s_add_u32 s4, s4, 12566528
    v_lshl_add_u32 v15, v2, 2, s4
    s_cmp_eq_u32 s3, 0
    s_cselect_b32 s4, 18, 0
    v_cmp_gt_u32 vcc, s4, v2
    v_mov_b32 v13, 0x40000000
    v_mfma_f32_16x16x32_bf16 v[228:231], a[52:55], v[112:115], v[228:231]
    ds_read_b64_tr_b16 a[128:129], v152 offset:16384
    v_mfma_f32_16x16x32_bf16 v[236:239], a[52:55], v[120:123], v[236:239]
    ds_read_b64_tr_b16 a[130:131], v152 offset:17408
    v_mfma_f32_16x16x32_bf16 v[236:239], a[60:63], v[124:127], v[236:239]
    buffer_load_dwordx4 v158, s[44:47], s27 offen offset:2048 sc1 lds
    v_mfma_f32_16x16x32_bf16 v[232:235], a[56:59], v[124:127], v[232:235]
    ds_read_b64_tr_b16 a[132:133], v153 offset:16384
    v_mfma_f32_16x16x32_bf16 v[232:235], a[48:51], v[120:123], v[232:235]
    ds_read_b64_tr_b16 a[134:135], v153 offset:17408
    s_waitcnt lgkmcnt(4)
    v_mfma_f32_16x16x32_bf16 v[192:195], a[64:67], v[80:83], v[192:195]
    s_add_u32 m0, s73, 65536
    s_lshl_b32 s14, s77, 3
    v_mfma_f32_16x16x32_bf16 v[192:195], a[72:75], v[84:87], v[192:195]
    ds_read_b128 v[104:107], v250 offset:13056
    v_mfma_f32_16x16x32_bf16 v[196:199], a[76:79], v[84:87], v[196:199]
    ds_read_b128 v[108:111], v250 offset:19200
    buffer_load_dwordx4 v148, s[48:51], s14 offen offset:0 lds
    v_mfma_f32_16x16x32_bf16 v[196:199], a[68:71], v[80:83], v[196:199]
    ds_read_b128 v[112:115], v250 offset:13312
    v_mfma_f32_16x16x32_bf16 v[204:207], a[68:71], v[88:91], v[204:207]
    ds_read_b128 v[116:119], v250 offset:19456
    buffer_load_dwordx4 v149, s[48:51], s14 offen offset:1024 lds
    v_mfma_f32_16x16x32_bf16 v[204:207], a[76:79], v[92:95], v[204:207]
    ds_read_b128 v[120:123], v250 offset:13568
    v_mfma_f32_16x16x32_bf16 v[200:203], a[72:75], v[92:95], v[200:203]
    ds_read_b128 v[124:127], v250 offset:19712
    v_cndmask_b32 v15, v13, v15, vcc
    v_mov_b32 v13, s68
    v_cndmask_b32 v13, 0, v13, vcc
    v_and_b32 v24, 15, v2
    v_lshrrev_b32 v25, 4, v2
    v_mul_u32_u24 v25, 17408, v25
    v_lshl_add_u32 v24, v24, 4, v25
    s_mul_i32 s7, s72, 36
    s_and_b32 s8, s3, 1
    s_add_u32 s7, s7, s8
    s_mul_i32 s7, s7, 69632
    s_bfe_u32 s8, s2, 0x20003
    s_lshl_b32 s8, s8, 12
    s_add_u32 s7, s7, s8
    s_add_u32 s7, s7, 12795904
    v_add_u32 v23, s7, v24
    s_xor_b32 s7, s72, 0
    v_lshl_add_u32 v19, s7, 10, v23
    s_xor_b32 s7, s72, 1
    v_lshl_add_u32 v20, s7, 10, v23
    s_xor_b32 s7, s72, 2
    v_lshl_add_u32 v21, s7, 10, v23
    s_xor_b32 s7, s72, 3
    v_lshl_add_u32 v22, s7, 10, v23
    v_lshlrev_b32 v14, 4, v2
    v_add_u32 v14, 98304, v14
    v_add_u32 v1, 0x10000, v14
    v_mfma_f32_16x16x32_bf16 v[200:203], a[64:67], v[88:91], v[200:203]
    ds_read_b64_tr_b16 a[136:137], v152 offset:24576
    buffer_load_dwordx4 v150, s[48:51], s14 offen offset:2048 lds
    v_mfma_f32_16x16x32_bf16 v[208:211], a[64:67], v[96:99], v[208:211]
    ds_read_b64_tr_b16 a[138:139], v152 offset:25600
    v_mfma_f32_16x16x32_bf16 v[208:211], a[72:75], v[100:103], v[208:211]
    buffer_load_dwordx4 v151, s[48:51], s14 offen offset:3072 lds
    v_mfma_f32_16x16x32_bf16 v[212:215], a[76:79], v[100:103], v[212:215]
    ds_read_b64_tr_b16 a[140:141], v153 offset:24576
    v_mfma_f32_16x16x32_bf16 v[212:215], a[68:71], v[96:99], v[212:215]
    ds_read_b64_tr_b16 a[142:143], v153 offset:25600
    s_waitcnt lgkmcnt(4)
    v_mfma_f32_16x16x32_bf16 v[220:223], a[68:71], v[104:107], v[220:223]
    s_waitcnt vmcnt(14)
    s_barrier
    v_mfma_f32_16x16x32_bf16 v[220:223], a[76:79], v[108:111], v[220:223]
    ds_read_b128 v[80:83], v250 offset:24576
    s_add_u32 m0, s74, 49152
    v_mfma_f32_16x16x32_bf16 v[216:219], a[72:75], v[108:111], v[216:219]
    ds_read_b128 v[84:87], v250 offset:30720
    v_mfma_f32_16x16x32_bf16 v[216:219], a[64:67], v[104:107], v[216:219]
    ds_read_b128 v[88:91], v250 offset:24832
    buffer_load_dwordx4 v156, s[44:47], s76 offen offset:0 sc1 lds
    v_mfma_f32_16x16x32_bf16 v[224:227], a[64:67], v[112:115], v[224:227]
    ds_read_b128 v[92:95], v250 offset:30976
    v_mfma_f32_16x16x32_bf16 v[224:227], a[72:75], v[116:119], v[224:227]
    ds_read_b128 v[96:99], v250 offset:25088
    v_mfma_f32_16x16x32_bf16 v[228:231], a[76:79], v[116:119], v[228:231]
    ds_read_b128 v[100:103], v250 offset:31232
    buffer_load_dwordx4 v157, s[44:47], s76 offen offset:1024 sc1 lds
    s_mov_b32 s56, s16
    s_and_b32 s57, s17, 0xffff
    s_mov_b32 s58, 2359296
    s_mov_b32 s59, 0x20000
    s_mov_b32 s40, 18432
    s_mov_b32 s42, 12386304
    s_mov_b32 s64, s38
    s_and_b32 s65, s39, 0xffff
    s_mov_b32 s66, 2359296
    s_mov_b32 s67, 0x20000
    v_lshlrev_b32 v136, 4, v2
    s_mul_i32 s7, s72, 36
    s_bitcmp1_b32 s3, 0
    s_addc_u32 s7, s7, 0
    s_lshl_b32 s7, s7, 17
    v_subrev_u32 v184, s7, v4
    v_subrev_u32 v185, s7, v5
    s_bfe_u32 s4, s2, 0x20003
    s_mul_i32 s4, s4, 9
    s_lshl1_add_u32 s7, s72, s4
    s_and_b32 s8, s3, 1
    s_add_u32 s7, s7, s8
    s_lshl_b32 s37, s7, 16
    s_add_u32 s37, s37, 4718592
    s_add_u32 s4, s4, 8
    s_lshl_b32 s16, s4, 16
    s_add_u32 s16, s16, 4718592
    v_mfma_f32_16x16x32_bf16 v[228:231], a[68:71], v[112:115], v[228:231]
    ds_read_b64_tr_b16 a[144:145], v152 offset:32768
    v_mfma_f32_16x16x32_bf16 v[236:239], a[68:71], v[120:123], v[236:239]
    ds_read_b64_tr_b16 a[146:147], v152 offset:33792
    v_mfma_f32_16x16x32_bf16 v[236:239], a[76:79], v[124:127], v[236:239]
    buffer_load_dwordx4 v158, s[44:47], s76 offen offset:2048 sc1 lds
    v_mfma_f32_16x16x32_bf16 v[232:235], a[72:75], v[124:127], v[232:235]
    ds_read_b64_tr_b16 a[148:149], v153 offset:32768
    v_mfma_f32_16x16x32_bf16 v[232:235], a[64:67], v[120:123], v[232:235]
    ds_read_b64_tr_b16 a[150:151], v153 offset:33792
    s_waitcnt lgkmcnt(4)
    v_mfma_f32_16x16x32_bf16 v[192:195], a[80:83], v[80:83], v[192:195]
    s_add_u32 m0, s73, 0
    s_lshl_b32 s14, s78, 3
    v_mfma_f32_16x16x32_bf16 v[192:195], a[88:91], v[84:87], v[192:195]
    ds_read_b128 v[104:107], v250 offset:25344
    v_mfma_f32_16x16x32_bf16 v[196:199], a[92:95], v[84:87], v[196:199]
    ds_read_b128 v[108:111], v250 offset:31488
    buffer_load_dwordx4 v148, s[48:51], s14 offen offset:0 lds
    v_mfma_f32_16x16x32_bf16 v[196:199], a[84:87], v[80:83], v[196:199]
    ds_read_b128 v[112:115], v250 offset:25600
    v_mfma_f32_16x16x32_bf16 v[204:207], a[84:87], v[88:91], v[204:207]
    ds_read_b128 v[116:119], v250 offset:31744
    buffer_load_dwordx4 v149, s[48:51], s14 offen offset:1024 lds
    v_mfma_f32_16x16x32_bf16 v[204:207], a[92:95], v[92:95], v[204:207]
    ds_read_b128 v[120:123], v250 offset:25856
    v_mfma_f32_16x16x32_bf16 v[200:203], a[88:91], v[92:95], v[200:203]
    ds_read_b128 v[124:127], v250 offset:32000
    s_sub_u32 s4, s4, s7
    s_lshl_b32 s4, s4, 7
    s_lshl_b32 s7, s7, 7
    s_add_u32 s7, s7, 12582912
    v_bfe_u32 v24, v2, 2, 1
    v_mul_u32_u24 v24, s4, v24
    v_and_b32 v25, 3, v2
    v_lshl_add_u32 v24, v25, 2, v24
    v_add_u32 v188, s7, v24
    s_lshl2_add_u32 s7, s2, s3
    s_mul_i32 s8, s7, 3072
    s_add_u32 s34, s8, 40828928
    s_add_u32 s11, s8, 43974656
    s_add_u32 s12, s8, 47120384
L_pl_G_2:
    s_cbranch_execz L_pl_G_6
    s_lshl_b32 s35, s7, 12
    s_add_u32 s35, s35, 50266112
    s_xor_b32 s8, s7, 8
    s_mul_i32 s8, s8, 3072
    s_add_u32 s30, s8, 40828928
    s_xor_b32 s8, s7, 16
    s_mul_i32 s8, s8, 3072
    s_add_u32 s15, s8, 43974656
    s_xor_b32 s8, s7, 24
    s_mul_i32 s8, s8, 3072
    s_add_u32 s31, s8, 47120384
    s_andn2_b32 s7, s7, 24
    v_mfma_f32_16x16x32_bf16 v[200:203], a[80:83], v[88:91], v[200:203]
    ds_read_b64_tr_b16 a[152:153], v152 offset:40960
    buffer_load_dwordx4 v150, s[48:51], s14 offen offset:2048 lds
    v_mfma_f32_16x16x32_bf16 v[208:211], a[80:83], v[96:99], v[208:211]
    ds_read_b64_tr_b16 a[154:155], v152 offset:41984
    v_mfma_f32_16x16x32_bf16 v[208:211], a[88:91], v[100:103], v[208:211]
    buffer_load_dwordx4 v151, s[48:51], s14 offen offset:3072 lds
    v_mfma_f32_16x16x32_bf16 v[212:215], a[92:95], v[100:103], v[212:215]
    ds_read_b64_tr_b16 a[156:157], v153 offset:40960
    v_mfma_f32_16x16x32_bf16 v[212:215], a[84:87], v[96:99], v[212:215]
    ds_read_b64_tr_b16 a[158:159], v153 offset:41984
    s_waitcnt lgkmcnt(4)
    v_mfma_f32_16x16x32_bf16 v[220:223], a[84:87], v[104:107], v[220:223]
    s_waitcnt vmcnt(14)
    s_barrier
    v_mfma_f32_16x16x32_bf16 v[220:223], a[92:95], v[108:111], v[220:223]
    ds_read_b128 v[80:83], v159 offset:0
    s_add_u32 m0, s74, 61440
    v_mfma_f32_16x16x32_bf16 v[216:219], a[88:91], v[108:111], v[216:219]
    ds_read_b128 v[84:87], v159 offset:6144
    v_mfma_f32_16x16x32_bf16 v[216:219], a[80:83], v[104:107], v[216:219]
    ds_read_b128 v[88:91], v159 offset:256
    buffer_load_dwordx4 v156, s[44:47], s77 offen offset:0 sc1 lds
    v_mfma_f32_16x16x32_bf16 v[224:227], a[80:83], v[112:115], v[224:227]
    ds_read_b128 v[92:95], v159 offset:6400
    v_mfma_f32_16x16x32_bf16 v[224:227], a[88:91], v[116:119], v[224:227]
    ds_read_b128 v[96:99], v159 offset:512
    v_mfma_f32_16x16x32_bf16 v[228:231], a[92:95], v[116:119], v[228:231]
    ds_read_b128 v[100:103], v159 offset:6656
    buffer_load_dwordx4 v157, s[44:47], s77 offen offset:1024 sc1 lds
    s_lshl3_add_u32 s7, s3, s7
    s_lshl2_add_u32 s8, s7, s72
    s_lshl_b32 s8, s8, 10
    s_add_u32 s32, s8, 50266112
    s_xor_b32 s8, s8, 4096
    s_add_u32 s33, s8, 50266112
    s_xor_b32 s8, s3, s72
    s_cmp_lt_u32 s8, 2
    s_cselect_b32 s35, s35, 0x40000000
    s_cselect_b32 s16, s16, 0x40000000
    s_cselect_b32 s36, s68, 0
    s_mov_b32 s38, 0xbfb8aa3b
    s_and_b32 s8, s8, 1
    s_mul_i32 s41, s8, 96
    s_and_b32 s43, s73, 4096
    v_lshlrev_b32 v24, 10, v2
    v_add_u32 v24, s35, v24
    s_add_u32 s7, s34, 2048
    v_mov_b32 v25, s36
    v_cmp_gt_u32 vcc, 4, v2
    s_nop 1
    v_cndmask_b32 v138, 0, v25, vcc
    v_mov_b32 v25, 0x40000000
    v_cndmask_b32 v137, v25, v24, vcc
    v_writelane_b32 v137, s7, 4
    v_writelane_b32 v138, s68, 4
    v_min_u32 v139, 1, v2
    v_lshlrev_b32 v139, 30, v139
    v_mov_b32 v140, 0
    v_writelane_b32 v140, s68, 0
    v_mfma_f32_16x16x32_bf16 v[228:231], a[84:87], v[112:115], v[228:231]
    ds_read_b64_tr_b16 a[160:161], v152 offset:49152
    v_mfma_f32_16x16x32_bf16 v[236:239], a[84:87], v[120:123], v[236:239]
    ds_read_b64_tr_b16 a[162:163], v152 offset:50176
    v_mfma_f32_16x16x32_bf16 v[236:239], a[92:95], v[124:127], v[236:239]
    buffer_load_dwordx4 v158, s[44:47], s77 offen offset:2048 sc1 lds
    v_mfma_f32_16x16x32_bf16 v[232:235], a[88:91], v[124:127], v[232:235]
    ds_read_b64_tr_b16 a[164:165], v153 offset:49152
    v_mfma_f32_16x16x32_bf16 v[232:235], a[80:83], v[120:123], v[232:235]
    ds_read_b64_tr_b16 a[166:167], v153 offset:50176
    s_waitcnt lgkmcnt(4)
    v_mfma_f32_16x16x32_bf16 v[192:195], a[96:99], v[80:83], v[192:195]
    s_add_u32 m0, s73, 16384
    s_lshl_b32 s14, s79, 3
    v_mfma_f32_16x16x32_bf16 v[192:195], a[104:107], v[84:87], v[192:195]
    ds_read_b128 v[104:107], v159 offset:768
    v_mfma_f32_16x16x32_bf16 v[196:199], a[108:111], v[84:87], v[196:199]
    ds_read_b128 v[108:111], v159 offset:6912
    buffer_load_dwordx4 v148, s[48:51], s14 offen offset:0 lds
    v_mfma_f32_16x16x32_bf16 v[196:199], a[100:103], v[80:83], v[196:199]
    ds_read_b128 v[112:115], v159 offset:1024
    v_mfma_f32_16x16x32_bf16 v[204:207], a[100:103], v[88:91], v[204:207]
    ds_read_b128 v[116:119], v159 offset:7168
    buffer_load_dwordx4 v149, s[48:51], s14 offen offset:1024 lds
    v_mfma_f32_16x16x32_bf16 v[204:207], a[108:111], v[92:95], v[204:207]
    ds_read_b128 v[120:123], v159 offset:1280
    v_mfma_f32_16x16x32_bf16 v[200:203], a[104:107], v[92:95], v[200:203]
    ds_read_b128 v[124:127], v159 offset:7424
    v_mfma_f32_16x16x32_bf16 v[200:203], a[96:99], v[88:91], v[200:203]
    ds_read_b64_tr_b16 a[168:169], v152 offset:57344
    buffer_load_dwordx4 v150, s[48:51], s14 offen offset:2048 lds
    v_mfma_f32_16x16x32_bf16 v[208:211], a[96:99], v[96:99], v[208:211]
    ds_read_b64_tr_b16 a[170:171], v152 offset:58368
    v_mfma_f32_16x16x32_bf16 v[208:211], a[104:107], v[100:103], v[208:211]
    buffer_load_dwordx4 v151, s[48:51], s14 offen offset:3072 lds
    v_mfma_f32_16x16x32_bf16 v[212:215], a[108:111], v[100:103], v[212:215]
    ds_read_b64_tr_b16 a[172:173], v153 offset:57344
    v_mfma_f32_16x16x32_bf16 v[212:215], a[100:103], v[96:99], v[212:215]
    ds_read_b64_tr_b16 a[174:175], v153 offset:58368
    s_waitcnt lgkmcnt(4)
    v_mfma_f32_16x16x32_bf16 v[220:223], a[100:103], v[104:107], v[220:223]
    s_waitcnt vmcnt(14)
    s_barrier
    v_mfma_f32_16x16x32_bf16 v[220:223], a[108:111], v[108:111], v[220:223]
    ds_read_b128 v[80:83], v159 offset:12288
    s_add_u32 m0, s74, 0
    v_mfma_f32_16x16x32_bf16 v[216:219], a[104:107], v[108:111], v[216:219]
    ds_read_b128 v[84:87], v159 offset:18432
    v_mfma_f32_16x16x32_bf16 v[216:219], a[96:99], v[104:107], v[216:219]
    ds_read_b128 v[88:91], v159 offset:12544
    buffer_load_dwordx4 v156, s[44:47], s78 offen offset:0 sc1 lds
    v_mfma_f32_16x16x32_bf16 v[224:227], a[96:99], v[112:115], v[224:227]
    ds_read_b128 v[92:95], v159 offset:18688
    v_mfma_f32_16x16x32_bf16 v[224:227], a[104:107], v[116:119], v[224:227]
    ds_read_b128 v[96:99], v159 offset:12800
    v_mfma_f32_16x16x32_bf16 v[228:231], a[108:111], v[116:119], v[228:231]
    ds_read_b128 v[100:103], v159 offset:18944
    buffer_load_dwordx4 v157, s[44:47], s78 offen offset:1024 sc1 lds
    v_mfma_f32_16x16x32_bf16 v[228:231], a[100:103], v[112:115], v[228:231]
    ds_read_b64_tr_b16 a[176:177], v154 offset:0
    v_mfma_f32_16x16x32_bf16 v[236:239], a[100:103], v[120:123], v[236:239]
    ds_read_b64_tr_b16 a[178:179], v154 offset:1024
    v_mfma_f32_16x16x32_bf16 v[236:239], a[108:111], v[124:127], v[236:239]
    buffer_load_dwordx4 v158, s[44:47], s78 offen offset:2048 sc1 lds
    v_mfma_f32_16x16x32_bf16 v[232:235], a[104:107], v[124:127], v[232:235]
    ds_read_b64_tr_b16 a[180:181], v155 offset:0
    v_mfma_f32_16x16x32_bf16 v[232:235], a[96:99], v[120:123], v[232:235]
    ds_read_b64_tr_b16 a[182:183], v155 offset:1024
    s_waitcnt lgkmcnt(4)
    v_mfma_f32_16x16x32_bf16 v[192:195], a[112:115], v[80:83], v[192:195]
    s_add_u32 m0, s73, 32768
    s_lshl_b32 s14, s80, 3
    v_mfma_f32_16x16x32_bf16 v[192:195], a[120:123], v[84:87], v[192:195]
    ds_read_b128 v[104:107], v159 offset:13056
    v_mfma_f32_16x16x32_bf16 v[196:199], a[124:127], v[84:87], v[196:199]
    ds_read_b128 v[108:111], v159 offset:19200
    buffer_load_dwordx4 v148, s[48:51], s14 offen offset:0 lds
    v_mfma_f32_16x16x32_bf16 v[196:199], a[116:119], v[80:83], v[196:199]
    ds_read_b128 v[112:115], v159 offset:13312
    v_mfma_f32_16x16x32_bf16 v[204:207], a[116:119], v[88:91], v[204:207]
    ds_read_b128 v[116:119], v159 offset:19456
    buffer_load_dwordx4 v149, s[48:51], s14 offen offset:1024 lds
    v_mfma_f32_16x16x32_bf16 v[204:207], a[124:127], v[92:95], v[204:207]
    ds_read_b128 v[120:123], v159 offset:13568
    v_mfma_f32_16x16x32_bf16 v[200:203], a[120:123], v[92:95], v[200:203]
    ds_read_b128 v[124:127], v159 offset:19712
    v_mfma_f32_16x16x32_bf16 v[200:203], a[112:115], v[88:91], v[200:203]
    ds_read_b64_tr_b16 a[184:185], v154 offset:8192
    buffer_load_dwordx4 v150, s[48:51], s14 offen offset:2048 lds
    v_mfma_f32_16x16x32_bf16 v[208:211], a[112:115], v[96:99], v[208:211]
    ds_read_b64_tr_b16 a[186:187], v154 offset:9216
    v_mfma_f32_16x16x32_bf16 v[208:211], a[120:123], v[100:103], v[208:211]
    buffer_load_dwordx4 v151, s[48:51], s14 offen offset:3072 lds
    v_mfma_f32_16x16x32_bf16 v[212:215], a[124:127], v[100:103], v[212:215]
    ds_read_b64_tr_b16 a[188:189], v155 offset:8192
    v_mfma_f32_16x16x32_bf16 v[212:215], a[116:119], v[96:99], v[212:215]
    ds_read_b64_tr_b16 a[190:191], v155 offset:9216
    s_waitcnt lgkmcnt(4)
    v_mfma_f32_16x16x32_bf16 v[220:223], a[116:119], v[104:107], v[220:223]
    s_waitcnt vmcnt(14)
    s_barrier
    v_mfma_f32_16x16x32_bf16 v[220:223], a[124:127], v[108:111], v[220:223]
    ds_read_b128 v[80:83], v159 offset:24576
    s_add_u32 m0, s74, 12288
    v_mfma_f32_16x16x32_bf16 v[216:219], a[120:123], v[108:111], v[216:219]
    ds_read_b128 v[84:87], v159 offset:30720
    v_mfma_f32_16x16x32_bf16 v[216:219], a[112:115], v[104:107], v[216:219]
    ds_read_b128 v[88:91], v159 offset:24832
    buffer_load_dwordx4 v156, s[44:47], s79 offen offset:0 sc1 lds
    v_mfma_f32_16x16x32_bf16 v[224:227], a[112:115], v[112:115], v[224:227]
    ds_read_b128 v[92:95], v159 offset:30976
    v_mfma_f32_16x16x32_bf16 v[224:227], a[120:123], v[116:119], v[224:227]
    ds_read_b128 v[96:99], v159 offset:25088
    v_mfma_f32_16x16x32_bf16 v[228:231], a[124:127], v[116:119], v[228:231]
    ds_read_b128 v[100:103], v159 offset:31232
    buffer_load_dwordx4 v157, s[44:47], s79 offen offset:1024 sc1 lds
    v_mfma_f32_16x16x32_bf16 v[228:231], a[116:119], v[112:115], v[228:231]
    ds_read_b64_tr_b16 a[192:193], v152 offset:0
    v_mfma_f32_16x16x32_bf16 v[236:239], a[116:119], v[120:123], v[236:239]
    ds_read_b64_tr_b16 a[194:195], v152 offset:1024
    v_mfma_f32_16x16x32_bf16 v[236:239], a[124:127], v[124:127], v[236:239]
    buffer_load_dwordx4 v158, s[44:47], s79 offen offset:2048 sc1 lds
    v_mfma_f32_16x16x32_bf16 v[232:235], a[120:123], v[124:127], v[232:235]
    ds_read_b64_tr_b16 a[196:197], v153 offset:0
    v_mfma_f32_16x16x32_bf16 v[232:235], a[112:115], v[120:123], v[232:235]
    ds_read_b64_tr_b16 a[198:199], v153 offset:1024
    s_waitcnt lgkmcnt(4)
    v_mfma_f32_16x16x32_bf16 v[192:195], a[128:131], v[80:83], v[192:195]
    s_add_u32 m0, s73, 49152
    s_lshl_b32 s14, s81, 3
    v_mfma_f32_16x16x32_bf16 v[192:195], a[136:139], v[84:87], v[192:195]
    ds_read_b128 v[104:107], v159 offset:25344
    v_mfma_f32_16x16x32_bf16 v[196:199], a[140:143], v[84:87], v[196:199]
    ds_read_b128 v[108:111], v159 offset:31488
    buffer_load_dwordx4 v148, s[48:51], s14 offen offset:0 lds
    v_mfma_f32_16x16x32_bf16 v[196:199], a[132:135], v[80:83], v[196:199]
    ds_read_b128 v[112:115], v159 offset:25600
    v_mfma_f32_16x16x32_bf16 v[204:207], a[132:135], v[88:91], v[204:207]
    ds_read_b128 v[116:119], v159 offset:31744
    buffer_load_dwordx4 v149, s[48:51], s14 offen offset:1024 lds
    v_mfma_f32_16x16x32_bf16 v[204:207], a[140:143], v[92:95], v[204:207]
    ds_read_b128 v[120:123], v159 offset:25856
    v_mfma_f32_16x16x32_bf16 v[200:203], a[136:139], v[92:95], v[200:203]
    ds_read_b128 v[124:127], v159 offset:32000
    v_mfma_f32_16x16x32_bf16 v[200:203], a[128:131], v[88:91], v[200:203]
    ds_read_b64_tr_b16 a[200:201], v152 offset:8192
    buffer_load_dwordx4 v150, s[48:51], s14 offen offset:2048 lds
    v_mfma_f32_16x16x32_bf16 v[208:211], a[128:131], v[96:99], v[208:211]
    ds_read_b64_tr_b16 a[202:203], v152 offset:9216
    v_mfma_f32_16x16x32_bf16 v[208:211], a[136:139], v[100:103], v[208:211]
    buffer_load_dwordx4 v151, s[48:51], s14 offen offset:3072 lds
    v_mfma_f32_16x16x32_bf16 v[212:215], a[140:143], v[100:103], v[212:215]
    ds_read_b64_tr_b16 a[204:205], v153 offset:8192
    v_mfma_f32_16x16x32_bf16 v[212:215], a[132:135], v[96:99], v[212:215]
    ds_read_b64_tr_b16 a[206:207], v153 offset:9216
    s_waitcnt lgkmcnt(4)
    v_mfma_f32_16x16x32_bf16 v[220:223], a[132:135], v[104:107], v[220:223]
    s_waitcnt vmcnt(14)
    s_barrier
    v_mfma_f32_16x16x32_bf16 v[220:223], a[140:143], v[108:111], v[220:223]
    ds_read_b128 v[80:83], v250 offset:0
    s_add_u32 m0, s74, 24576
    v_mfma_f32_16x16x32_bf16 v[216:219], a[136:139], v[108:111], v[216:219]
    ds_read_b128 v[84:87], v250 offset:6144
    v_mfma_f32_16x16x32_bf16 v[216:219], a[128:131], v[104:107], v[216:219]
    ds_read_b128 v[88:91], v250 offset:256
    buffer_load_dwordx4 v156, s[44:47], s80 offen offset:0 sc1 lds
    v_mfma_f32_16x16x32_bf16 v[224:227], a[128:131], v[112:115], v[224:227]
    ds_read_b128 v[92:95], v250 offset:6400
    v_mfma_f32_16x16x32_bf16 v[224:227], a[136:139], v[116:119], v[224:227]
    ds_read_b128 v[96:99], v250 offset:512
    v_mfma_f32_16x16x32_bf16 v[228:231], a[140:143], v[116:119], v[228:231]
    ds_read_b128 v[100:103], v250 offset:6656
    buffer_load_dwordx4 v157, s[44:47], s80 offen offset:1024 sc1 lds
    v_mfma_f32_16x16x32_bf16 v[228:231], a[132:135], v[112:115], v[228:231]
    ds_read_b64_tr_b16 a[208:209], v152 offset:16384
    v_mfma_f32_16x16x32_bf16 v[236:239], a[132:135], v[120:123], v[236:239]
    ds_read_b64_tr_b16 a[210:211], v152 offset:17408
    v_mfma_f32_16x16x32_bf16 v[236:239], a[140:143], v[124:127], v[236:239]
    buffer_load_dwordx4 v158, s[44:47], s80 offen offset:2048 sc1 lds
    v_mfma_f32_16x16x32_bf16 v[232:235], a[136:139], v[124:127], v[232:235]
    ds_read_b64_tr_b16 a[212:213], v153 offset:16384
    v_mfma_f32_16x16x32_bf16 v[232:235], a[128:131], v[120:123], v[232:235]
    ds_read_b64_tr_b16 a[214:215], v153 offset:17408
    s_waitcnt lgkmcnt(4)
    v_mfma_f32_16x16x32_bf16 v[192:195], a[144:147], v[80:83], v[192:195]
    s_add_u32 m0, s73, 65536
    s_lshl_b32 s14, s84, 18
    v_mfma_f32_16x16x32_bf16 v[192:195], a[152:155], v[84:87], v[192:195]
    ds_read_b128 v[104:107], v250 offset:768
    v_mfma_f32_16x16x32_bf16 v[196:199], a[156:159], v[84:87], v[196:199]
    ds_read_b128 v[108:111], v250 offset:6912
    buffer_load_dwordx4 v4, s[52:55], s14 offen offset:0 lds
    v_mfma_f32_16x16x32_bf16 v[196:199], a[148:151], v[80:83], v[196:199]
    ds_read_b128 v[112:115], v250 offset:1024
    v_mfma_f32_16x16x32_bf16 v[204:207], a[148:151], v[88:91], v[204:207]
    ds_read_b128 v[116:119], v250 offset:7168
    buffer_load_dwordx4 v5, s[52:55], s14 offen offset:1024 lds
    v_mfma_f32_16x16x32_bf16 v[204:207], a[156:159], v[92:95], v[204:207]
    ds_read_b128 v[120:123], v250 offset:1280
    v_mfma_f32_16x16x32_bf16 v[200:203], a[152:155], v[92:95], v[200:203]
    ds_read_b128 v[124:127], v250 offset:7424
    v_mfma_f32_16x16x32_bf16 v[200:203], a[144:147], v[88:91], v[200:203]
    ds_read_b64_tr_b16 a[216:217], v152 offset:24576
    buffer_load_dwordx4 v6, s[52:55], s14 offen offset:2048 lds
    v_mfma_f32_16x16x32_bf16 v[208:211], a[144:147], v[96:99], v[208:211]
    ds_read_b64_tr_b16 a[218:219], v152 offset:25600
    v_mfma_f32_16x16x32_bf16 v[208:211], a[152:155], v[100:103], v[208:211]
    buffer_load_dwordx4 v7, s[52:55], s14 offen offset:3072 lds
    v_mfma_f32_16x16x32_bf16 v[212:215], a[156:159], v[100:103], v[212:215]
    ds_read_b64_tr_b16 a[220:221], v153 offset:24576
    v_mfma_f32_16x16x32_bf16 v[212:215], a[148:151], v[96:99], v[212:215]
    ds_read_b64_tr_b16 a[222:223], v153 offset:25600
    s_waitcnt lgkmcnt(4)
    v_mfma_f32_16x16x32_bf16 v[220:223], a[148:151], v[104:107], v[220:223]
    s_waitcnt vmcnt(14)
    s_barrier
    v_mfma_f32_16x16x32_bf16 v[220:223], a[156:159], v[108:111], v[220:223]
    ds_read_b128 v[80:83], v250 offset:12288
    v_mfma_f32_16x16x32_bf16 v[216:219], a[152:155], v[108:111], v[216:219]
    ds_read_b128 v[84:87], v250 offset:18432
    v_mfma_f32_16x16x32_bf16 v[216:219], a[144:147], v[104:107], v[216:219]
    ds_read_b128 v[88:91], v250 offset:12544
    v_mfma_f32_16x16x32_bf16 v[224:227], a[144:147], v[112:115], v[224:227]
    ds_read_b128 v[92:95], v250 offset:18688
    v_mfma_f32_16x16x32_bf16 v[224:227], a[152:155], v[116:119], v[224:227]
    ds_read_b128 v[96:99], v250 offset:12800
    v_mfma_f32_16x16x32_bf16 v[228:231], a[156:159], v[116:119], v[228:231]
    ds_read_b128 v[100:103], v250 offset:18944
    v_mfma_f32_16x16x32_bf16 v[228:231], a[148:151], v[112:115], v[228:231]
    ds_read_b64_tr_b16 a[224:225], v152 offset:32768
    v_mfma_f32_16x16x32_bf16 v[236:239], a[148:151], v[120:123], v[236:239]
    ds_read_b64_tr_b16 a[226:227], v152 offset:33792
    v_mfma_f32_16x16x32_bf16 v[236:239], a[156:159], v[124:127], v[236:239]
    v_mfma_f32_16x16x32_bf16 v[232:235], a[152:155], v[124:127], v[232:235]
    ds_read_b64_tr_b16 a[228:229], v153 offset:32768
    v_mfma_f32_16x16x32_bf16 v[232:235], a[144:147], v[120:123], v[232:235]
    ds_read_b64_tr_b16 a[230:231], v153 offset:33792
    s_waitcnt lgkmcnt(4)
    v_mfma_f32_16x16x32_bf16 v[192:195], a[160:163], v[80:83], v[192:195]
    v_mfma_f32_16x16x32_bf16 v[192:195], a[168:171], v[84:87], v[192:195]
    ds_read_b128 v[104:107], v250 offset:13056
    v_mfma_f32_16x16x32_bf16 v[196:199], a[172:175], v[84:87], v[196:199]
    ds_read_b128 v[108:111], v250 offset:19200
    v_mfma_f32_16x16x32_bf16 v[196:199], a[164:167], v[80:83], v[196:199]
    ds_read_b128 v[112:115], v250 offset:13312
    v_mfma_f32_16x16x32_bf16 v[204:207], a[164:167], v[88:91], v[204:207]
    ds_read_b128 v[116:119], v250 offset:19456
    v_mfma_f32_16x16x32_bf16 v[204:207], a[172:175], v[92:95], v[204:207]
    ds_read_b128 v[120:123], v250 offset:13568
    v_mfma_f32_16x16x32_bf16 v[200:203], a[168:171], v[92:95], v[200:203]
    ds_read_b128 v[124:127], v250 offset:19712
    v_mfma_f32_16x16x32_bf16 v[200:203], a[160:163], v[88:91], v[200:203]
    ds_read_b64_tr_b16 a[232:233], v152 offset:40960
    v_mfma_f32_16x16x32_bf16 v[208:211], a[160:163], v[96:99], v[208:211]
    ds_read_b64_tr_b16 a[234:235], v152 offset:41984
    v_mfma_f32_16x16x32_bf16 v[208:211], a[168:171], v[100:103], v[208:211]
    v_mfma_f32_16x16x32_bf16 v[212:215], a[172:175], v[100:103], v[212:215]
    ds_read_b64_tr_b16 a[236:237], v153 offset:40960
    v_mfma_f32_16x16x32_bf16 v[212:215], a[164:167], v[96:99], v[212:215]
    ds_read_b64_tr_b16 a[238:239], v153 offset:41984
    s_waitcnt lgkmcnt(4)
    v_mfma_f32_16x16x32_bf16 v[220:223], a[164:167], v[104:107], v[220:223]
    s_waitcnt vmcnt(7)
    s_barrier
    v_mfma_f32_16x16x32_bf16 v[220:223], a[172:175], v[108:111], v[220:223]
    ds_read_b128 v[80:83], v250 offset:24576
    v_mfma_f32_16x16x32_bf16 v[216:219], a[168:171], v[108:111], v[216:219]
    ds_read_b128 v[84:87], v250 offset:30720
    v_mfma_f32_16x16x32_bf16 v[216:219], a[160:163], v[104:107], v[216:219]
    ds_read_b128 v[88:91], v250 offset:24832
    v_mfma_f32_16x16x32_bf16 v[224:227], a[160:163], v[112:115], v[224:227]
    ds_read_b128 v[92:95], v250 offset:30976
    v_mfma_f32_16x16x32_bf16 v[224:227], a[168:171], v[116:119], v[224:227]
    ds_read_b128 v[96:99], v250 offset:25088
    v_mfma_f32_16x16x32_bf16 v[228:231], a[172:175], v[116:119], v[228:231]
    ds_read_b128 v[100:103], v250 offset:31232
    v_mfma_f32_16x16x32_bf16 v[228:231], a[164:167], v[112:115], v[228:231]
    ds_read_b64_tr_b16 a[240:241], v152 offset:49152
    v_mfma_f32_16x16x32_bf16 v[236:239], a[164:167], v[120:123], v[236:239]
    ds_read_b64_tr_b16 a[242:243], v152 offset:50176
    v_mfma_f32_16x16x32_bf16 v[236:239], a[172:175], v[124:127], v[236:239]
    v_mfma_f32_16x16x32_bf16 v[232:235], a[168:171], v[124:127], v[232:235]
    ds_read_b64_tr_b16 a[244:245], v153 offset:49152
    v_mfma_f32_16x16x32_bf16 v[232:235], a[160:163], v[120:123], v[232:235]
    ds_read_b64_tr_b16 a[246:247], v153 offset:50176
    s_waitcnt lgkmcnt(4)
    v_mfma_f32_16x16x32_bf16 v[192:195], a[176:179], v[80:83], v[192:195]
    v_mfma_f32_16x16x32_bf16 v[192:195], a[184:187], v[84:87], v[192:195]
    ds_read_b128 v[104:107], v250 offset:25344
    v_mfma_f32_16x16x32_bf16 v[196:199], a[188:191], v[84:87], v[196:199]
    ds_read_b128 v[108:111], v250 offset:31488
    v_mfma_f32_16x16x32_bf16 v[196:199], a[180:183], v[80:83], v[196:199]
    ds_read_b128 v[112:115], v250 offset:25600
    v_mfma_f32_16x16x32_bf16 v[204:207], a[180:183], v[88:91], v[204:207]
    ds_read_b128 v[116:119], v250 offset:31744
    v_mfma_f32_16x16x32_bf16 v[204:207], a[188:191], v[92:95], v[204:207]
    ds_read_b128 v[120:123], v250 offset:25856
    v_mfma_f32_16x16x32_bf16 v[200:203], a[184:187], v[92:95], v[200:203]
    ds_read_b128 v[124:127], v250 offset:32000
    v_mfma_f32_16x16x32_bf16 v[200:203], a[176:179], v[88:91], v[200:203]
    ds_read_b64_tr_b16 a[248:249], v152 offset:57344
    v_mfma_f32_16x16x32_bf16 v[208:211], a[176:179], v[96:99], v[208:211]
    ds_read_b64_tr_b16 a[250:251], v152 offset:58368
    v_mfma_f32_16x16x32_bf16 v[208:211], a[184:187], v[100:103], v[208:211]
    v_mfma_f32_16x16x32_bf16 v[212:215], a[188:191], v[100:103], v[212:215]
    ds_read_b64_tr_b16 a[252:253], v153 offset:57344
    v_mfma_f32_16x16x32_bf16 v[212:215], a[180:183], v[96:99], v[212:215]
    ds_read_b64_tr_b16 a[254:255], v153 offset:58368
    s_waitcnt lgkmcnt(4)
    v_mfma_f32_16x16x32_bf16 v[220:223], a[180:183], v[104:107], v[220:223]
    s_barrier
    v_mfma_f32_16x16x32_bf16 v[220:223], a[188:191], v[108:111], v[220:223]
    ds_read_b128 v[80:83], v159 offset:0
    s_add_u32 m0, s74, 36864
    v_mfma_f32_16x16x32_bf16 v[216:219], a[184:187], v[108:111], v[216:219]
    ds_read_b128 v[84:87], v159 offset:6144
    v_mfma_f32_16x16x32_bf16 v[216:219], a[176:179], v[104:107], v[216:219]
    ds_read_b128 v[88:91], v159 offset:256
    buffer_load_dwordx4 v156, s[44:47], s81 offen offset:0 sc1 lds
    v_mfma_f32_16x16x32_bf16 v[224:227], a[176:179], v[112:115], v[224:227]
    ds_read_b128 v[92:95], v159 offset:6400
    v_mfma_f32_16x16x32_bf16 v[224:227], a[184:187], v[116:119], v[224:227]
    ds_read_b128 v[96:99], v159 offset:512
    v_mfma_f32_16x16x32_bf16 v[228:231], a[188:191], v[116:119], v[228:231]
    ds_read_b128 v[100:103], v159 offset:6656
    buffer_load_dwordx4 v157, s[44:47], s81 offen offset:1024 sc1 lds
    v_mfma_f32_16x16x32_bf16 v[228:231], a[180:183], v[112:115], v[228:231]
    v_mfma_f32_16x16x32_bf16 v[236:239], a[180:183], v[120:123], v[236:239]
    v_mfma_f32_16x16x32_bf16 v[236:239], a[188:191], v[124:127], v[236:239]
    buffer_load_dwordx4 v158, s[44:47], s81 offen offset:2048 sc1 lds
    v_mfma_f32_16x16x32_bf16 v[232:235], a[184:187], v[124:127], v[232:235]
    v_mfma_f32_16x16x32_bf16 v[232:235], a[176:179], v[120:123], v[232:235]
    s_waitcnt lgkmcnt(0)
    v_mfma_f32_16x16x32_bf16 v[192:195], a[192:195], v[80:83], v[192:195]
    s_and_b32 s13, s70, 1
    s_mul_i32 s13, s13, 3072
    v_mfma_f32_16x16x32_bf16 v[192:195], a[200:203], v[84:87], v[192:195]
    ds_read_b128 v[104:107], v159 offset:768
    s_sub_u32 s13, s13, 1536
    v_mfma_f32_16x16x32_bf16 v[196:199], a[204:207], v[84:87], v[196:199]
    ds_read_b128 v[108:111], v159 offset:6912
    v_add_u32 v156, s13, v156
    v_mfma_f32_16x16x32_bf16 v[196:199], a[196:199], v[80:83], v[196:199]
    ds_read_b128 v[112:115], v159 offset:1024
    v_mfma_f32_16x16x32_bf16 v[204:207], a[196:199], v[88:91], v[204:207]
    ds_read_b128 v[116:119], v159 offset:7168
    v_add_u32 v157, s13, v157
    v_mfma_f32_16x16x32_bf16 v[204:207], a[204:207], v[92:95], v[204:207]
    ds_read_b128 v[120:123], v159 offset:1280
    v_add_u32 v158, s13, v158
    v_mfma_f32_16x16x32_bf16 v[200:203], a[200:203], v[92:95], v[200:203]
    ds_read_b128 v[124:127], v159 offset:7424
    s_add_u32 m0, s74, 49152
    v_mfma_f32_16x16x32_bf16 v[200:203], a[192:195], v[88:91], v[200:203]
    v_mfma_f32_16x16x32_bf16 v[208:211], a[192:195], v[96:99], v[208:211]
    buffer_load_dwordx4 v156, s[44:47], s18 offen offset:0 sc1 lds
    v_mfma_f32_16x16x32_bf16 v[208:211], a[200:203], v[100:103], v[208:211]
    buffer_load_dwordx4 v157, s[44:47], s18 offen offset:1024 sc1 lds
    v_mfma_f32_16x16x32_bf16 v[212:215], a[204:207], v[100:103], v[212:215]
    buffer_load_dwordx4 v158, s[44:47], s18 offen offset:2048 sc1 lds
    v_mfma_f32_16x16x32_bf16 v[212:215], a[196:199], v[96:99], v[212:215]
    s_waitcnt lgkmcnt(0)
    v_mfma_f32_16x16x32_bf16 v[220:223], a[196:199], v[104:107], v[220:223]
    s_barrier
    v_mfma_f32_16x16x32_bf16 v[220:223], a[204:207], v[108:111], v[220:223]
    ds_read_b128 v[80:83], v159 offset:12288
    s_add_u32 m0, s74, 61440
    v_mfma_f32_16x16x32_bf16 v[216:219], a[200:203], v[108:111], v[216:219]
    ds_read_b128 v[84:87], v159 offset:18432
    v_mfma_f32_16x16x32_bf16 v[216:219], a[192:195], v[104:107], v[216:219]
    ds_read_b128 v[88:91], v159 offset:12544
    buffer_load_dwordx4 v156, s[44:47], s19 offen offset:0 sc1 lds
    v_mfma_f32_16x16x32_bf16 v[224:227], a[192:195], v[112:115], v[224:227]
    ds_read_b128 v[92:95], v159 offset:18688
    v_mfma_f32_16x16x32_bf16 v[224:227], a[200:203], v[116:119], v[224:227]
    ds_read_b128 v[96:99], v159 offset:12800
    v_mfma_f32_16x16x32_bf16 v[228:231], a[204:207], v[116:119], v[228:231]
    ds_read_b128 v[100:103], v159 offset:18944
    buffer_load_dwordx4 v157, s[44:47], s19 offen offset:1024 sc1 lds
    v_mfma_f32_16x16x32_bf16 v[228:231], a[196:199], v[112:115], v[228:231]
    v_mfma_f32_16x16x32_bf16 v[236:239], a[196:199], v[120:123], v[236:239]
    v_mfma_f32_16x16x32_bf16 v[236:239], a[204:207], v[124:127], v[236:239]
    buffer_load_dwordx4 v158, s[44:47], s19 offen offset:2048 sc1 lds
    v_mfma_f32_16x16x32_bf16 v[232:235], a[200:203], v[124:127], v[232:235]
    v_mfma_f32_16x16x32_bf16 v[232:235], a[192:195], v[120:123], v[232:235]
    s_waitcnt lgkmcnt(0)
    v_mfma_f32_16x16x32_bf16 v[192:195], a[208:211], v[80:83], v[192:195]
    s_add_u32 m0, s74, 0
    v_mfma_f32_16x16x32_bf16 v[192:195], a[216:219], v[84:87], v[192:195]
    ds_read_b128 v[104:107], v159 offset:13056
    v_mfma_f32_16x16x32_bf16 v[196:199], a[220:223], v[84:87], v[196:199]
    ds_read_b128 v[108:111], v159 offset:19200
    v_mfma_f32_16x16x32_bf16 v[196:199], a[212:215], v[80:83], v[196:199]
    ds_read_b128 v[112:115], v159 offset:13312
    buffer_load_dwordx4 v156, s[44:47], s20 offen offset:0 sc1 lds
    v_mfma_f32_16x16x32_bf16 v[204:207], a[212:215], v[88:91], v[204:207]
    ds_read_b128 v[116:119], v159 offset:19456
    v_mfma_f32_16x16x32_bf16 v[204:207], a[220:223], v[92:95], v[204:207]
    ds_read_b128 v[120:123], v159 offset:13568
    v_mfma_f32_16x16x32_bf16 v[200:203], a[216:219], v[92:95], v[200:203]
    ds_read_b128 v[124:127], v159 offset:19712
    buffer_load_dwordx4 v157, s[44:47], s20 offen offset:1024 sc1 lds
    v_mfma_f32_16x16x32_bf16 v[200:203], a[208:211], v[88:91], v[200:203]
    v_mfma_f32_16x16x32_bf16 v[208:211], a[208:211], v[96:99], v[208:211]
    v_mfma_f32_16x16x32_bf16 v[208:211], a[216:219], v[100:103], v[208:211]
    buffer_load_dwordx4 v158, s[44:47], s20 offen offset:2048 sc1 lds
    v_mfma_f32_16x16x32_bf16 v[212:215], a[220:223], v[100:103], v[212:215]
    v_mfma_f32_16x16x32_bf16 v[212:215], a[212:215], v[96:99], v[212:215]
    s_waitcnt lgkmcnt(0)
    v_mfma_f32_16x16x32_bf16 v[220:223], a[212:215], v[104:107], v[220:223]
    s_waitcnt vmcnt(16)
    s_barrier
    v_mfma_f32_16x16x32_bf16 v[220:223], a[220:223], v[108:111], v[220:223]
    ds_read_b128 v[80:83], v159 offset:24576
    s_add_u32 m0, s74, 12288
    v_mfma_f32_16x16x32_bf16 v[216:219], a[216:219], v[108:111], v[216:219]
    ds_read_b128 v[84:87], v159 offset:30720
    v_mfma_f32_16x16x32_bf16 v[216:219], a[208:211], v[104:107], v[216:219]
    ds_read_b128 v[88:91], v159 offset:24832
    buffer_load_dwordx4 v156, s[44:47], s21 offen offset:0 sc1 lds
    v_mfma_f32_16x16x32_bf16 v[224:227], a[208:211], v[112:115], v[224:227]
    ds_read_b128 v[92:95], v159 offset:30976
    v_mfma_f32_16x16x32_bf16 v[224:227], a[216:219], v[116:119], v[224:227]
    ds_read_b128 v[96:99], v159 offset:25088
    v_mfma_f32_16x16x32_bf16 v[228:231], a[220:223], v[116:119], v[228:231]
    ds_read_b128 v[100:103], v159 offset:31232
    buffer_load_dwordx4 v157, s[44:47], s21 offen offset:1024 sc1 lds
    v_mfma_f32_16x16x32_bf16 v[228:231], a[212:215], v[112:115], v[228:231]
    v_mfma_f32_16x16x32_bf16 v[236:239], a[212:215], v[120:123], v[236:239]
    v_mfma_f32_16x16x32_bf16 v[236:239], a[220:223], v[124:127], v[236:239]
    buffer_load_dwordx4 v158, s[44:47], s21 offen offset:2048 sc1 lds
    v_mfma_f32_16x16x32_bf16 v[232:235], a[216:219], v[124:127], v[232:235]
    v_mfma_f32_16x16x32_bf16 v[232:235], a[208:211], v[120:123], v[232:235]
    s_waitcnt lgkmcnt(0)
    v_mfma_f32_16x16x32_bf16 v[192:195], a[224:227], v[80:83], v[192:195]
    s_add_u32 m0, s73, 0
    s_lshl_b32 s14, s85, 18
    v_mfma_f32_16x16x32_bf16 v[192:195], a[232:235], v[84:87], v[192:195]
    ds_read_b128 v[104:107], v159 offset:25344
    v_mfma_f32_16x16x32_bf16 v[196:199], a[236:239], v[84:87], v[196:199]
    ds_read_b128 v[108:111], v159 offset:31488
    buffer_load_dwordx4 v4, s[52:55], s14 offen offset:0 lds
    v_mfma_f32_16x16x32_bf16 v[196:199], a[228:231], v[80:83], v[196:199]
    ds_read_b128 v[112:115], v159 offset:25600
    v_mfma_f32_16x16x32_bf16 v[204:207], a[228:231], v[88:91], v[204:207]
    ds_read_b128 v[116:119], v159 offset:31744
    buffer_load_dwordx4 v5, s[52:55], s14 offen offset:1024 lds
    v_mfma_f32_16x16x32_bf16 v[204:207], a[236:239], v[92:95], v[204:207]
    ds_read_b128 v[120:123], v159 offset:25856
    v_mfma_f32_16x16x32_bf16 v[200:203], a[232:235], v[92:95], v[200:203]
    ds_read_b128 v[124:127], v159 offset:32000
    v_mfma_f32_16x16x32_bf16 v[200:203], a[224:227], v[88:91], v[200:203]
    buffer_load_dwordx4 v6, s[52:55], s14 offen offset:2048 lds
    v_mfma_f32_16x16x32_bf16 v[208:211], a[224:227], v[96:99], v[208:211]
    v_mfma_f32_16x16x32_bf16 v[208:211], a[232:235], v[100:103], v[208:211]
    buffer_load_dwordx4 v7, s[52:55], s14 offen offset:3072 lds
    v_mfma_f32_16x16x32_bf16 v[212:215], a[236:239], v[100:103], v[212:215]
    v_mfma_f32_16x16x32_bf16 v[212:215], a[228:231], v[96:99], v[212:215]
    s_waitcnt lgkmcnt(0)
    v_mfma_f32_16x16x32_bf16 v[220:223], a[228:231], v[104:107], v[220:223]
    s_waitcnt vmcnt(16)
    s_barrier
    v_mfma_f32_16x16x32_bf16 v[220:223], a[236:239], v[108:111], v[220:223]
    ds_read_b128 v[80:83], v250 offset:0
    v_mfma_f32_16x16x32_bf16 v[216:219], a[232:235], v[108:111], v[216:219]
    ds_read_b128 v[84:87], v250 offset:6144
    v_mfma_f32_16x16x32_bf16 v[216:219], a[224:227], v[104:107], v[216:219]
    ds_read_b128 v[88:91], v250 offset:256
    v_mfma_f32_16x16x32_bf16 v[224:227], a[224:227], v[112:115], v[224:227]
    ds_read_b128 v[92:95], v250 offset:6400
    v_mfma_f32_16x16x32_bf16 v[224:227], a[232:235], v[116:119], v[224:227]
    ds_read_b128 v[96:99], v250 offset:512
    v_mfma_f32_16x16x32_bf16 v[228:231], a[236:239], v[116:119], v[228:231]
    ds_read_b128 v[100:103], v250 offset:6656
    v_mfma_f32_16x16x32_bf16 v[228:231], a[228:231], v[112:115], v[228:231]
    v_mfma_f32_16x16x32_bf16 v[236:239], a[228:231], v[120:123], v[236:239]
L_pl_G_3:
    s_cbranch_execz L_wret
    v_mfma_f32_16x16x32_bf16 v[236:239], a[236:239], v[124:127], v[236:239]
    v_mfma_f32_16x16x32_bf16 v[232:235], a[232:235], v[124:127], v[232:235]
    v_mfma_f32_16x16x32_bf16 v[232:235], a[224:227], v[120:123], v[232:235]
    s_waitcnt lgkmcnt(0)
    v_mfma_f32_16x16x32_bf16 v[192:195], a[240:243], v[80:83], v[192:195]
    v_mfma_f32_16x16x32_bf16 v[192:195], a[248:251], v[84:87], v[192:195]
    ds_read_b128 v[104:107], v250 offset:768
    v_mfma_f32_16x16x32_bf16 v[196:199], a[252:255], v[84:87], v[196:199]
    ds_read_b128 v[108:111], v250 offset:6912
    v_mfma_f32_16x16x32_bf16 v[196:199], a[244:247], v[80:83], v[196:199]
    ds_read_b128 v[112:115], v250 offset:1024
    v_mfma_f32_16x16x32_bf16 v[204:207], a[244:247], v[88:91], v[204:207]
    ds_read_b128 v[116:119], v250 offset:7168
    v_mfma_f32_16x16x32_bf16 v[204:207], a[252:255], v[92:95], v[204:207]
    ds_read_b128 v[120:123], v250 offset:1280
    v_mfma_f32_16x16x32_bf16 v[200:203], a[248:251], v[92:95], v[200:203]
    ds_read_b128 v[124:127], v250 offset:7424
    v_mfma_f32_16x16x32_bf16 v[200:203], a[240:243], v[88:91], v[200:203]
    v_mfma_f32_16x16x32_bf16 v[208:211], a[240:243], v[96:99], v[208:211]
    v_mfma_f32_16x16x32_bf16 v[208:211], a[248:251], v[100:103], v[208:211]
    v_mfma_f32_16x16x32_bf16 v[212:215], a[252:255], v[100:103], v[212:215]
    v_mfma_f32_16x16x32_bf16 v[212:215], a[244:247], v[96:99], v[212:215]
    s_waitcnt lgkmcnt(0)
    v_mfma_f32_16x16x32_bf16 v[220:223], a[244:247], v[104:107], v[220:223]
    s_waitcnt vmcnt(13)
    s_barrier
    v_mfma_f32_16x16x32_bf16 v[220:223], a[252:255], v[108:111], v[220:223]
    ds_read_b128 v[80:83], v250 offset:12288
    v_mfma_f32_16x16x32_bf16 v[216:219], a[248:251], v[108:111], v[216:219]
    ds_read_b128 v[84:87], v250 offset:18432
    v_mfma_f32_16x16x32_bf16 v[216:219], a[240:243], v[104:107], v[216:219]
    ds_read_b128 v[88:91], v250 offset:12544
    v_mfma_f32_16x16x32_bf16 v[224:227], a[240:243], v[112:115], v[224:227]
    ds_read_b128 v[92:95], v250 offset:18688
    v_cvt_pk_bf16_f32 v192, v192, v193
    v_mfma_f32_16x16x32_bf16 v[224:227], a[248:251], v[116:119], v[224:227]
    ds_read_b128 v[96:99], v250 offset:12800
    v_mfma_f32_16x16x32_bf16 v[228:231], a[252:255], v[116:119], v[228:231]
    ds_read_b128 v[100:103], v250 offset:18944
    v_cvt_pk_bf16_f32 v193, v194, v195
    v_mfma_f32_16x16x32_bf16 v[228:231], a[244:247], v[112:115], v[228:231]
    v_mfma_f32_16x16x32_bf16 v[236:239], a[244:247], v[120:123], v[236:239]
    v_cvt_pk_bf16_f32 v194, v196, v197
    v_mfma_f32_16x16x32_bf16 v[236:239], a[252:255], v[124:127], v[236:239]
    v_cvt_pk_bf16_f32 v195, v198, v199
    v_mfma_f32_16x16x32_bf16 v[232:235], a[248:251], v[124:127], v[232:235]
    v_mfma_f32_16x16x32_bf16 v[232:235], a[240:243], v[120:123], v[232:235]
    buffer_store_dwordx4 v[192:195], v246, s[44:47], s9 offen offset:0 sc1
    s_waitcnt lgkmcnt(0)
    v_mfma_f32_16x16x32_bf16 v[32:35], a[0:3], v[80:83], v[128:131]
    v_mfma_f32_16x16x32_bf16 v[32:35], a[8:11], v[84:87], v[32:35]
    ds_read_b128 v[104:107], v250 offset:13056
    v_mfma_f32_16x16x32_bf16 v[36:39], a[12:15], v[84:87], v[132:135]
    ds_read_b128 v[108:111], v250 offset:19200
    v_mfma_f32_16x16x32_bf16 v[36:39], a[4:7], v[80:83], v[36:39]
    ds_read_b128 v[112:115], v250 offset:13312
    v_mfma_f32_16x16x32_bf16 v[44:47], a[4:7], v[88:91], v[132:135]
    ds_read_b128 v[116:119], v250 offset:19456
    v_cvt_pk_bf16_f32 v200, v200, v201
    v_mfma_f32_16x16x32_bf16 v[44:47], a[12:15], v[92:95], v[44:47]
    ds_read_b128 v[120:123], v250 offset:13568
    v_mfma_f32_16x16x32_bf16 v[40:43], a[8:11], v[92:95], v[128:131]
    ds_read_b128 v[124:127], v250 offset:19712
    v_cvt_pk_bf16_f32 v201, v202, v203
    v_mfma_f32_16x16x32_bf16 v[40:43], a[0:3], v[88:91], v[40:43]
    v_mfma_f32_16x16x32_bf16 v[48:51], a[0:3], v[96:99], v[128:131]
    v_cvt_pk_bf16_f32 v202, v204, v205
    v_mfma_f32_16x16x32_bf16 v[48:51], a[8:11], v[100:103], v[48:51]
    v_cvt_pk_bf16_f32 v203, v206, v207
    v_mfma_f32_16x16x32_bf16 v[52:55], a[12:15], v[100:103], v[132:135]
    v_mfma_f32_16x16x32_bf16 v[52:55], a[4:7], v[96:99], v[52:55]
    buffer_store_dwordx4 v[200:203], v246, s[44:47], s9 offen offset:1024 sc1
    s_waitcnt lgkmcnt(0)
    v_mfma_f32_16x16x32_bf16 v[60:63], a[4:7], v[104:107], v[132:135]
    s_waitcnt vmcnt(12)
    s_barrier
    v_mfma_f32_16x16x32_bf16 v[60:63], a[12:15], v[108:111], v[60:63]
    ds_read_b128 v[80:83], v250 offset:24576
    s_add_u32 m0, s74, 24576
    v_cvt_pk_bf16_f32 v208, v208, v209
    v_mfma_f32_16x16x32_bf16 v[56:59], a[8:11], v[108:111], v[128:131]
    ds_read_b128 v[84:87], v250 offset:30720
    v_mfma_f32_16x16x32_bf16 v[56:59], a[0:3], v[104:107], v[56:59]
    ds_read_b128 v[88:91], v250 offset:24832
    buffer_load_dwordx4 v156, s[44:47], s22 offen offset:0 sc1 lds
    v_mfma_f32_16x16x32_bf16 v[64:67], a[0:3], v[112:115], v[128:131]
    ds_read_b128 v[92:95], v250 offset:30976
    v_cvt_pk_bf16_f32 v209, v210, v211
    v_mfma_f32_16x16x32_bf16 v[64:67], a[8:11], v[116:119], v[64:67]
    ds_read_b128 v[96:99], v250 offset:25088
    v_cvt_pk_bf16_f32 v210, v212, v213
    v_mfma_f32_16x16x32_bf16 v[68:71], a[12:15], v[116:119], v[132:135]
    ds_read_b128 v[100:103], v250 offset:31232
    buffer_load_dwordx4 v157, s[44:47], s22 offen offset:1024 sc1 lds
    v_mfma_f32_16x16x32_bf16 v[68:71], a[4:7], v[112:115], v[68:71]
    v_mfma_f32_16x16x32_bf16 v[76:79], a[4:7], v[120:123], v[132:135]
    v_cvt_pk_bf16_f32 v211, v214, v215
    v_mfma_f32_16x16x32_bf16 v[76:79], a[12:15], v[124:127], v[76:79]
    buffer_load_dwordx4 v158, s[44:47], s22 offen offset:2048 sc1 lds
    v_mfma_f32_16x16x32_bf16 v[72:75], a[8:11], v[124:127], v[128:131]
    buffer_store_dwordx4 v[208:211], v246, s[44:47], s9 offen offset:2048 sc1
    v_mfma_f32_16x16x32_bf16 v[72:75], a[0:3], v[120:123], v[72:75]
    s_waitcnt lgkmcnt(0)
    v_mfma_f32_16x16x32_bf16 v[32:35], a[16:19], v[80:83], v[32:35]
    s_add_u32 m0, s74, 36864
    v_mfma_f32_16x16x32_bf16 v[32:35], a[24:27], v[84:87], v[32:35]
    ds_read_b128 v[104:107], v250 offset:25344
    v_cvt_pk_bf16_f32 v216, v216, v217
    v_mfma_f32_16x16x32_bf16 v[36:39], a[28:31], v[84:87], v[36:39]
    ds_read_b128 v[108:111], v250 offset:31488
    v_mfma_f32_16x16x32_bf16 v[36:39], a[20:23], v[80:83], v[36:39]
    ds_read_b128 v[112:115], v250 offset:25600
    buffer_load_dwordx4 v156, s[44:47], s23 offen offset:0 sc1 lds
    v_mfma_f32_16x16x32_bf16 v[44:47], a[20:23], v[88:91], v[44:47]
    ds_read_b128 v[116:119], v250 offset:31744
    v_cvt_pk_bf16_f32 v217, v218, v219
    v_mfma_f32_16x16x32_bf16 v[44:47], a[28:31], v[92:95], v[44:47]
    ds_read_b128 v[120:123], v250 offset:25856
    v_cvt_pk_bf16_f32 v218, v220, v221
    v_mfma_f32_16x16x32_bf16 v[40:43], a[24:27], v[92:95], v[40:43]
    ds_read_b128 v[124:127], v250 offset:32000
    buffer_load_dwordx4 v157, s[44:47], s23 offen offset:1024 sc1 lds
    v_mfma_f32_16x16x32_bf16 v[40:43], a[16:19], v[88:91], v[40:43]
    v_mfma_f32_16x16x32_bf16 v[48:51], a[16:19], v[96:99], v[48:51]
    v_cvt_pk_bf16_f32 v219, v222, v223
    v_mfma_f32_16x16x32_bf16 v[48:51], a[24:27], v[100:103], v[48:51]
    buffer_load_dwordx4 v158, s[44:47], s23 offen offset:2048 sc1 lds
    v_mfma_f32_16x16x32_bf16 v[52:55], a[28:31], v[100:103], v[52:55]
    buffer_store_dwordx4 v[216:219], v247, s[44:47], s9 offen offset:0 sc1
    v_mfma_f32_16x16x32_bf16 v[52:55], a[20:23], v[96:99], v[52:55]
    s_waitcnt lgkmcnt(0)
    v_mfma_f32_16x16x32_bf16 v[60:63], a[20:23], v[104:107], v[60:63]
    s_waitcnt vmcnt(17)
    s_barrier
    v_mfma_f32_16x16x32_bf16 v[60:63], a[28:31], v[108:111], v[60:63]
    ds_read_b128 v[80:83], v159 offset:0
    s_add_u32 m0, s74, 49152
    v_cvt_pk_bf16_f32 v224, v224, v225
    v_mfma_f32_16x16x32_bf16 v[56:59], a[24:27], v[108:111], v[56:59]
    ds_read_b128 v[84:87], v159 offset:6144
    v_mfma_f32_16x16x32_bf16 v[56:59], a[16:19], v[104:107], v[56:59]
    ds_read_b128 v[88:91], v159 offset:256
    buffer_load_dwordx4 v156, s[44:47], s24 offen offset:0 sc1 lds
    v_mfma_f32_16x16x32_bf16 v[64:67], a[16:19], v[112:115], v[64:67]
    ds_read_b128 v[92:95], v159 offset:6400
    v_cvt_pk_bf16_f32 v225, v226, v227
    v_mfma_f32_16x16x32_bf16 v[64:67], a[24:27], v[116:119], v[64:67]
    ds_read_b128 v[96:99], v159 offset:512
    v_cvt_pk_bf16_f32 v226, v228, v229
    v_mfma_f32_16x16x32_bf16 v[68:71], a[28:31], v[116:119], v[68:71]
    ds_read_b128 v[100:103], v159 offset:6656
    buffer_load_dwordx4 v157, s[44:47], s24 offen offset:1024 sc1 lds
    v_mfma_f32_16x16x32_bf16 v[68:71], a[20:23], v[112:115], v[68:71]
    v_add_u32 v10, 65536, v10
    v_mfma_f32_16x16x32_bf16 v[76:79], a[20:23], v[120:123], v[76:79]
    ds_read_b64_tr_b16 a[0:1], v10 offset:0
    v_cvt_pk_bf16_f32 v227, v230, v231
    v_mfma_f32_16x16x32_bf16 v[76:79], a[28:31], v[124:127], v[76:79]
    ds_read_b64_tr_b16 a[2:3], v10 offset:2048
    buffer_load_dwordx4 v158, s[44:47], s24 offen offset:2048 sc1 lds
    v_mfma_f32_16x16x32_bf16 v[72:75], a[24:27], v[124:127], v[72:75]
    buffer_store_dwordx4 v[224:227], v247, s[44:47], s9 offen offset:1024 sc1
    ds_read_b64_tr_b16 a[8:9], v10 offset:4096
    v_mfma_f32_16x16x32_bf16 v[72:75], a[16:19], v[120:123], v[72:75]
    ds_read_b64_tr_b16 a[10:11], v10 offset:6144
    s_waitcnt lgkmcnt(4)
    v_mfma_f32_16x16x32_bf16 v[32:35], a[32:35], v[80:83], v[32:35]
    s_add_u32 m0, s74, 61440
    v_mfma_f32_16x16x32_bf16 v[32:35], a[40:43], v[84:87], v[32:35]
    ds_read_b128 v[104:107], v159 offset:768
    v_cvt_pk_bf16_f32 v232, v232, v233
    v_mfma_f32_16x16x32_bf16 v[36:39], a[44:47], v[84:87], v[36:39]
    ds_read_b128 v[108:111], v159 offset:6912
    v_mfma_f32_16x16x32_bf16 v[36:39], a[36:39], v[80:83], v[36:39]
    ds_read_b128 v[112:115], v159 offset:1024
    buffer_load_dwordx4 v156, s[44:47], s25 offen offset:0 sc1 lds
    v_mfma_f32_16x16x32_bf16 v[44:47], a[36:39], v[88:91], v[44:47]
    ds_read_b128 v[116:119], v159 offset:7168
    v_cvt_pk_bf16_f32 v233, v234, v235
    v_mfma_f32_16x16x32_bf16 v[44:47], a[44:47], v[92:95], v[44:47]
    ds_read_b128 v[120:123], v159 offset:1280
    v_cvt_pk_bf16_f32 v234, v236, v237
    v_mfma_f32_16x16x32_bf16 v[40:43], a[40:43], v[92:95], v[40:43]
    ds_read_b128 v[124:127], v159 offset:7424
    buffer_load_dwordx4 v157, s[44:47], s25 offen offset:1024 sc1 lds
    v_mfma_f32_16x16x32_bf16 v[40:43], a[32:35], v[88:91], v[40:43]
    v_add_u32 v11, 65536, v11
    v_mfma_f32_16x16x32_bf16 v[48:51], a[32:35], v[96:99], v[48:51]
    ds_read_b64_tr_b16 a[4:5], v11 offset:0
    v_cvt_pk_bf16_f32 v235, v238, v239
    v_mfma_f32_16x16x32_bf16 v[48:51], a[40:43], v[100:103], v[48:51]
    ds_read_b64_tr_b16 a[6:7], v11 offset:2048
    buffer_load_dwordx4 v158, s[44:47], s25 offen offset:2048 sc1 lds
    v_mfma_f32_16x16x32_bf16 v[52:55], a[44:47], v[100:103], v[52:55]
    buffer_store_dwordx4 v[232:235], v247, s[44:47], s9 offen offset:2048 sc1
    ds_read_b64_tr_b16 a[12:13], v11 offset:4096
    v_mfma_f32_16x16x32_bf16 v[52:55], a[36:39], v[96:99], v[52:55]
    ds_read_b64_tr_b16 a[14:15], v11 offset:6144
    s_waitcnt lgkmcnt(4)
    v_mfma_f32_16x16x32_bf16 v[60:63], a[36:39], v[104:107], v[60:63]
    s_waitcnt vmcnt(18)
    s_barrier
    v_mfma_f32_16x16x32_bf16 v[60:63], a[44:47], v[108:111], v[60:63]
    ds_read_b128 v[80:83], v159 offset:12288
    s_add_u32 m0, s74, 0
    v_mfma_f32_16x16x32_bf16 v[56:59], a[40:43], v[108:111], v[56:59]
    ds_read_b128 v[84:87], v159 offset:18432
    v_mfma_f32_16x16x32_bf16 v[56:59], a[32:35], v[104:107], v[56:59]
    ds_read_b128 v[88:91], v159 offset:12544
    buffer_load_dwordx4 v156, s[44:47], s26 offen offset:0 sc1 lds
    v_mfma_f32_16x16x32_bf16 v[64:67], a[32:35], v[112:115], v[64:67]
    ds_read_b128 v[92:95], v159 offset:18688
    v_mfma_f32_16x16x32_bf16 v[64:67], a[40:43], v[116:119], v[64:67]
    ds_read_b128 v[96:99], v159 offset:12800
    v_mfma_f32_16x16x32_bf16 v[68:71], a[44:47], v[116:119], v[68:71]
    ds_read_b128 v[100:103], v159 offset:18944
    buffer_load_dwordx4 v157, s[44:47], s26 offen offset:1024 sc1 lds
    v_mfma_f32_16x16x32_bf16 v[68:71], a[36:39], v[112:115], v[68:71]
    v_add_u32 v10, -65536, v10
    v_mfma_f32_16x16x32_bf16 v[76:79], a[36:39], v[120:123], v[76:79]
    ds_read_b64_tr_b16 a[16:17], v10 offset:0
    v_mfma_f32_16x16x32_bf16 v[76:79], a[44:47], v[124:127], v[76:79]
    ds_read_b64_tr_b16 a[18:19], v10 offset:2048
    buffer_load_dwordx4 v158, s[44:47], s26 offen offset:2048 sc1 lds
    v_mfma_f32_16x16x32_bf16 v[72:75], a[40:43], v[124:127], v[72:75]
    ds_read_b64_tr_b16 a[24:25], v10 offset:4096
    v_mfma_f32_16x16x32_bf16 v[72:75], a[32:35], v[120:123], v[72:75]
    ds_read_b64_tr_b16 a[26:27], v10 offset:6144
    s_waitcnt lgkmcnt(4)
    v_mfma_f32_16x16x32_bf16 v[32:35], a[48:51], v[80:83], v[32:35]
    v_mfma_f32_16x16x32_bf16 v[32:35], a[56:59], v[84:87], v[32:35]
    ds_read_b128 v[104:107], v159 offset:13056
    v_mfma_f32_16x16x32_bf16 v[36:39], a[60:63], v[84:87], v[36:39]
    ds_read_b128 v[108:111], v159 offset:19200
    v_mfma_f32_16x16x32_bf16 v[36:39], a[52:55], v[80:83], v[36:39]
    ds_read_b128 v[112:115], v159 offset:13312
    v_mfma_f32_16x16x32_bf16 v[44:47], a[52:55], v[88:91], v[44:47]
    ds_read_b128 v[116:119], v159 offset:19456
    v_mfma_f32_16x16x32_bf16 v[44:47], a[60:63], v[92:95], v[44:47]
    ds_read_b128 v[120:123], v159 offset:13568
    v_mfma_f32_16x16x32_bf16 v[40:43], a[56:59], v[92:95], v[40:43]
    ds_read_b128 v[124:127], v159 offset:19712
    v_mfma_f32_16x16x32_bf16 v[40:43], a[48:51], v[88:91], v[40:43]
    v_add_u32 v11, -65536, v11
    v_mfma_f32_16x16x32_bf16 v[48:51], a[48:51], v[96:99], v[48:51]
    ds_read_b64_tr_b16 a[20:21], v11 offset:0
    v_mfma_f32_16x16x32_bf16 v[48:51], a[56:59], v[100:103], v[48:51]
    ds_read_b64_tr_b16 a[22:23], v11 offset:2048
    v_mfma_f32_16x16x32_bf16 v[52:55], a[60:63], v[100:103], v[52:55]
    ds_read_b64_tr_b16 a[28:29], v11 offset:4096
    v_mfma_f32_16x16x32_bf16 v[52:55], a[52:55], v[96:99], v[52:55]
    ds_read_b64_tr_b16 a[30:31], v11 offset:6144
    s_waitcnt lgkmcnt(4)
    v_mfma_f32_16x16x32_bf16 v[60:63], a[52:55], v[104:107], v[60:63]
    s_waitcnt vmcnt(16)
    s_barrier
    v_mfma_f32_16x16x32_bf16 v[60:63], a[60:63], v[108:111], v[60:63]
    ds_read_b128 v[80:83], v159 offset:24576
    s_add_u32 m0, s74, 12288
    v_mfma_f32_16x16x32_bf16 v[56:59], a[56:59], v[108:111], v[56:59]
    ds_read_b128 v[84:87], v159 offset:30720
    v_mfma_f32_16x16x32_bf16 v[56:59], a[48:51], v[104:107], v[56:59]
    ds_read_b128 v[88:91], v159 offset:24832
    buffer_load_dwordx4 v156, s[44:47], s27 offen offset:0 sc1 lds
    v_mfma_f32_16x16x32_bf16 v[64:67], a[48:51], v[112:115], v[64:67]
    ds_read_b128 v[92:95], v159 offset:30976
    v_mfma_f32_16x16x32_bf16 v[64:67], a[56:59], v[116:119], v[64:67]
    ds_read_b128 v[96:99], v159 offset:25088
    v_mfma_f32_16x16x32_bf16 v[68:71], a[60:63], v[116:119], v[68:71]
    ds_read_b128 v[100:103], v159 offset:31232
    buffer_load_dwordx4 v157, s[44:47], s27 offen offset:1024 sc1 lds
    v_mfma_f32_16x16x32_bf16 v[68:71], a[52:55], v[112:115], v[68:71]
    v_mfma_f32_16x16x32_bf16 v[76:79], a[52:55], v[120:123], v[76:79]
    v_mfma_f32_16x16x32_bf16 v[76:79], a[60:63], v[124:127], v[76:79]
    buffer_load_dwordx4 v158, s[44:47], s27 offen offset:2048 sc1 lds
    v_mfma_f32_16x16x32_bf16 v[72:75], a[56:59], v[124:127], v[72:75]
    v_mfma_f32_16x16x32_bf16 v[72:75], a[48:51], v[120:123], v[72:75]
    s_waitcnt lgkmcnt(0)
    v_mfma_f32_16x16x32_bf16 v[32:35], a[64:67], v[80:83], v[32:35]
    s_add_u32 m0, s73, 16384
    s_lshl_b32 s14, s86, 18
    v_mfma_f32_16x16x32_bf16 v[32:35], a[72:75], v[84:87], v[32:35]
    ds_read_b128 v[104:107], v159 offset:25344
    v_mfma_f32_16x16x32_bf16 v[36:39], a[76:79], v[84:87], v[36:39]
    ds_read_b128 v[108:111], v159 offset:31488
    buffer_load_dwordx4 v4, s[52:55], s14 offen offset:0 lds
    v_mfma_f32_16x16x32_bf16 v[36:39], a[68:71], v[80:83], v[36:39]
    ds_read_b128 v[112:115], v159 offset:25600
    v_mfma_f32_16x16x32_bf16 v[44:47], a[68:71], v[88:91], v[44:47]
    ds_read_b128 v[116:119], v159 offset:31744
    buffer_load_dwordx4 v5, s[52:55], s14 offen offset:1024 lds
    v_mfma_f32_16x16x32_bf16 v[44:47], a[76:79], v[92:95], v[44:47]
    ds_read_b128 v[120:123], v159 offset:25856
    v_mfma_f32_16x16x32_bf16 v[40:43], a[72:75], v[92:95], v[40:43]
    ds_read_b128 v[124:127], v159 offset:32000
    v_mfma_f32_16x16x32_bf16 v[40:43], a[64:67], v[88:91], v[40:43]
    buffer_load_dwordx4 v6, s[52:55], s14 offen offset:2048 lds
    v_mfma_f32_16x16x32_bf16 v[48:51], a[64:67], v[96:99], v[48:51]
    v_mfma_f32_16x16x32_bf16 v[48:51], a[72:75], v[100:103], v[48:51]
    buffer_load_dwordx4 v7, s[52:55], s14 offen offset:3072 lds
    v_mfma_f32_16x16x32_bf16 v[52:55], a[76:79], v[100:103], v[52:55]
    v_mfma_f32_16x16x32_bf16 v[52:55], a[68:71], v[96:99], v[52:55]
    s_waitcnt lgkmcnt(0)
    v_mfma_f32_16x16x32_bf16 v[60:63], a[68:71], v[104:107], v[60:63]
    s_waitcnt vmcnt(19)
    s_barrier
    v_mfma_f32_16x16x32_bf16 v[60:63], a[76:79], v[108:111], v[60:63]
    ds_read_b128 v[80:83], v250 offset:0
    v_mfma_f32_16x16x32_bf16 v[56:59], a[72:75], v[108:111], v[56:59]
    ds_read_b128 v[84:87], v250 offset:6144
    v_mfma_f32_16x16x32_bf16 v[56:59], a[64:67], v[104:107], v[56:59]
    ds_read_b128 v[88:91], v250 offset:256
    v_mfma_f32_16x16x32_bf16 v[64:67], a[64:67], v[112:115], v[64:67]
    ds_read_b128 v[92:95], v250 offset:6400
    v_mfma_f32_16x16x32_bf16 v[64:67], a[72:75], v[116:119], v[64:67]
    ds_read_b128 v[96:99], v250 offset:512
    v_mfma_f32_16x16x32_bf16 v[68:71], a[76:79], v[116:119], v[68:71]
    ds_read_b128 v[100:103], v250 offset:6656
    v_mfma_f32_16x16x32_bf16 v[68:71], a[68:71], v[112:115], v[68:71]
    v_mfma_f32_16x16x32_bf16 v[76:79], a[68:71], v[120:123], v[76:79]
    v_mfma_f32_16x16x32_bf16 v[76:79], a[76:79], v[124:127], v[76:79]
    v_mfma_f32_16x16x32_bf16 v[72:75], a[72:75], v[124:127], v[72:75]
    v_mfma_f32_16x16x32_bf16 v[72:75], a[64:67], v[120:123], v[72:75]
    s_waitcnt lgkmcnt(0)
    v_mfma_f32_16x16x32_bf16 v[32:35], a[80:83], v[80:83], v[32:35]
    v_mfma_f32_16x16x32_bf16 v[32:35], a[88:91], v[84:87], v[32:35]
    ds_read_b128 v[104:107], v250 offset:768
    v_mfma_f32_16x16x32_bf16 v[36:39], a[92:95], v[84:87], v[36:39]
    ds_read_b128 v[108:111], v250 offset:6912
    v_mfma_f32_16x16x32_bf16 v[36:39], a[84:87], v[80:83], v[36:39]
    ds_read_b128 v[112:115], v250 offset:1024
    v_mfma_f32_16x16x32_bf16 v[44:47], a[84:87], v[88:91], v[44:47]
    ds_read_b128 v[116:119], v250 offset:7168
    v_mfma_f32_16x16x32_bf16 v[44:47], a[92:95], v[92:95], v[44:47]
    ds_read_b128 v[120:123], v250 offset:1280
    v_mfma_f32_16x16x32_bf16 v[40:43], a[88:91], v[92:95], v[40:43]
    ds_read_b128 v[124:127], v250 offset:7424
    v_mfma_f32_16x16x32_bf16 v[40:43], a[80:83], v[88:91], v[40:43]
    s_waitcnt vmcnt(10)
    buffer_store_dword v249, v248, s[44:47], s6 offen sc1
    v_mfma_f32_16x16x32_bf16 v[48:51], a[80:83], v[96:99], v[48:51]
    v_mfma_f32_16x16x32_bf16 v[48:51], a[88:91], v[100:103], v[48:51]
    v_mfma_f32_16x16x32_bf16 v[52:55], a[92:95], v[100:103], v[52:55]
    v_mfma_f32_16x16x32_bf16 v[52:55], a[84:87], v[96:99], v[52:55]
    s_waitcnt lgkmcnt(0)
    v_mfma_f32_16x16x32_bf16 v[60:63], a[84:87], v[104:107], v[60:63]
    s_barrier
    v_mfma_f32_16x16x32_bf16 v[60:63], a[92:95], v[108:111], v[60:63]
    ds_read_b128 v[80:83], v250 offset:12288
    v_mfma_f32_16x16x32_bf16 v[56:59], a[88:91], v[108:111], v[56:59]
    ds_read_b128 v[84:87], v250 offset:18432
    v_mfma_f32_16x16x32_bf16 v[56:59], a[80:83], v[104:107], v[56:59]
    ds_read_b128 v[88:91], v250 offset:12544
    v_mfma_f32_16x16x32_bf16 v[64:67], a[80:83], v[112:115], v[64:67]
    ds_read_b128 v[92:95], v250 offset:18688
    v_mfma_f32_16x16x32_bf16 v[64:67], a[88:91], v[116:119], v[64:67]
    ds_read_b128 v[96:99], v250 offset:12800
    v_mfma_f32_16x16x32_bf16 v[68:71], a[92:95], v[116:119], v[68:71]
    ds_read_b128 v[100:103], v250 offset:18944
    v_mfma_f32_16x16x32_bf16 v[68:71], a[84:87], v[112:115], v[68:71]
    v_mfma_f32_16x16x32_bf16 v[76:79], a[84:87], v[120:123], v[76:79]
    v_mfma_f32_16x16x32_bf16 v[76:79], a[92:95], v[124:127], v[76:79]
    v_mfma_f32_16x16x32_bf16 v[72:75], a[88:91], v[124:127], v[72:75]
    v_mfma_f32_16x16x32_bf16 v[72:75], a[80:83], v[120:123], v[72:75]
    s_waitcnt lgkmcnt(0)
    v_mfma_f32_16x16x32_bf16 v[32:35], a[96:99], v[80:83], v[32:35]
    v_mfma_f32_16x16x32_bf16 v[32:35], a[104:107], v[84:87], v[32:35]
    ds_read_b128 v[104:107], v250 offset:13056
    v_mfma_f32_16x16x32_bf16 v[36:39], a[108:111], v[84:87], v[36:39]
    ds_read_b128 v[108:111], v250 offset:19200
    v_mfma_f32_16x16x32_bf16 v[36:39], a[100:103], v[80:83], v[36:39]
    ds_read_b128 v[112:115], v250 offset:13312
    v_mfma_f32_16x16x32_bf16 v[44:47], a[100:103], v[88:91], v[44:47]
    ds_read_b128 v[116:119], v250 offset:19456
    v_mfma_f32_16x16x32_bf16 v[44:47], a[108:111], v[92:95], v[44:47]
    ds_read_b128 v[120:123], v250 offset:13568
    v_mfma_f32_16x16x32_bf16 v[40:43], a[104:107], v[92:95], v[40:43]
    ds_read_b128 v[124:127], v250 offset:19712
    v_mfma_f32_16x16x32_bf16 v[40:43], a[96:99], v[88:91], v[40:43]
    v_mfma_f32_16x16x32_bf16 v[48:51], a[96:99], v[96:99], v[48:51]
    v_mfma_f32_16x16x32_bf16 v[48:51], a[104:107], v[100:103], v[48:51]
    v_mfma_f32_16x16x32_bf16 v[52:55], a[108:111], v[100:103], v[52:55]
    v_mfma_f32_16x16x32_bf16 v[52:55], a[100:103], v[96:99], v[52:55]
    s_waitcnt lgkmcnt(0)
    v_mfma_f32_16x16x32_bf16 v[60:63], a[100:103], v[104:107], v[60:63]
    s_barrier
    v_mfma_f32_16x16x32_bf16 v[60:63], a[108:111], v[108:111], v[60:63]
    ds_read_b128 v[80:83], v250 offset:24576
    s_add_u32 m0, s74, 24576
    v_mfma_f32_16x16x32_bf16 v[56:59], a[104:107], v[108:111], v[56:59]
    ds_read_b128 v[84:87], v250 offset:30720
    v_mfma_f32_16x16x32_bf16 v[56:59], a[96:99], v[104:107], v[56:59]
    ds_read_b128 v[88:91], v250 offset:24832
    buffer_load_dwordx4 v156, s[44:47], s76 offen offset:0 sc1 lds
    v_mfma_f32_16x16x32_bf16 v[64:67], a[96:99], v[112:115], v[64:67]
    ds_read_b128 v[92:95], v250 offset:30976
    v_mfma_f32_16x16x32_bf16 v[64:67], a[104:107], v[116:119], v[64:67]
    ds_read_b128 v[96:99], v250 offset:25088
    v_mfma_f32_16x16x32_bf16 v[68:71], a[108:111], v[116:119], v[68:71]
    ds_read_b128 v[100:103], v250 offset:31232
    buffer_load_dwordx4 v157, s[44:47], s76 offen offset:1024 sc1 lds
    v_mfma_f32_16x16x32_bf16 v[68:71], a[100:103], v[112:115], v[68:71]
    v_mfma_f32_16x16x32_bf16 v[76:79], a[100:103], v[120:123], v[76:79]
    v_mfma_f32_16x16x32_bf16 v[76:79], a[108:111], v[124:127], v[76:79]
    buffer_load_dwordx4 v158, s[44:47], s76 offen offset:2048 sc1 lds
    v_mfma_f32_16x16x32_bf16 v[72:75], a[104:107], v[124:127], v[72:75]
    v_mfma_f32_16x16x32_bf16 v[72:75], a[96:99], v[120:123], v[72:75]
    s_waitcnt lgkmcnt(0)
    v_mfma_f32_16x16x32_bf16 v[32:35], a[112:115], v[80:83], v[32:35]
    s_add_u32 m0, s74, 36864
    v_mfma_f32_16x16x32_bf16 v[32:35], a[120:123], v[84:87], v[32:35]
    ds_read_b128 v[104:107], v250 offset:25344
    v_mfma_f32_16x16x32_bf16 v[36:39], a[124:127], v[84:87], v[36:39]
    ds_read_b128 v[108:111], v250 offset:31488
    v_mfma_f32_16x16x32_bf16 v[36:39], a[116:119], v[80:83], v[36:39]
    ds_read_b128 v[112:115], v250 offset:25600
    buffer_load_dwordx4 v156, s[44:47], s77 offen offset:0 sc1 lds
    v_mfma_f32_16x16x32_bf16 v[44:47], a[116:119], v[88:91], v[44:47]
    ds_read_b128 v[116:119], v250 offset:31744
    v_mfma_f32_16x16x32_bf16 v[44:47], a[124:127], v[92:95], v[44:47]
    ds_read_b128 v[120:123], v250 offset:25856
    v_mfma_f32_16x16x32_bf16 v[40:43], a[120:123], v[92:95], v[40:43]
    ds_read_b128 v[124:127], v250 offset:32000
    buffer_load_dwordx4 v157, s[44:47], s77 offen offset:1024 sc1 lds
    v_mfma_f32_16x16x32_bf16 v[40:43], a[112:115], v[88:91], v[40:43]
    v_mfma_f32_16x16x32_bf16 v[48:51], a[112:115], v[96:99], v[48:51]
    v_mfma_f32_16x16x32_bf16 v[48:51], a[120:123], v[100:103], v[48:51]
    buffer_load_dwordx4 v158, s[44:47], s77 offen offset:2048 sc1 lds
    v_mfma_f32_16x16x32_bf16 v[52:55], a[124:127], v[100:103], v[52:55]
    v_mfma_f32_16x16x32_bf16 v[52:55], a[116:119], v[96:99], v[52:55]
    s_waitcnt lgkmcnt(0)
    v_mfma_f32_16x16x32_bf16 v[60:63], a[116:119], v[104:107], v[60:63]
    s_waitcnt vmcnt(14)
    s_barrier
    v_mfma_f32_16x16x32_bf16 v[60:63], a[124:127], v[108:111], v[60:63]
    ds_read_b128 v[80:83], v159 offset:0
    s_add_u32 m0, s74, 49152
    v_mfma_f32_16x16x32_bf16 v[56:59], a[120:123], v[108:111], v[56:59]
    ds_read_b128 v[84:87], v159 offset:6144
    v_mfma_f32_16x16x32_bf16 v[56:59], a[112:115], v[104:107], v[56:59]
    ds_read_b128 v[88:91], v159 offset:256
    buffer_load_dwordx4 v156, s[44:47], s78 offen offset:0 sc1 lds
    v_mfma_f32_16x16x32_bf16 v[64:67], a[112:115], v[112:115], v[64:67]
    ds_read_b128 v[92:95], v159 offset:6400
    v_mfma_f32_16x16x32_bf16 v[64:67], a[120:123], v[116:119], v[64:67]
    ds_read_b128 v[96:99], v159 offset:512
    v_mfma_f32_16x16x32_bf16 v[68:71], a[124:127], v[116:119], v[68:71]
    ds_read_b128 v[100:103], v159 offset:6656
    buffer_load_dwordx4 v157, s[44:47], s78 offen offset:1024 sc1 lds
    v_mfma_f32_16x16x32_bf16 v[68:71], a[116:119], v[112:115], v[68:71]
    v_mfma_f32_16x16x32_bf16 v[76:79], a[116:119], v[120:123], v[76:79]
    v_mfma_f32_16x16x32_bf16 v[76:79], a[124:127], v[124:127], v[76:79]
    buffer_load_dwordx4 v158, s[44:47], s78 offen offset:2048 sc1 lds
    v_mfma_f32_16x16x32_bf16 v[72:75], a[120:123], v[124:127], v[72:75]
    v_mfma_f32_16x16x32_bf16 v[72:75], a[112:115], v[120:123], v[72:75]
    s_waitcnt lgkmcnt(0)
    v_mfma_f32_16x16x32_bf16 v[32:35], a[128:131], v[80:83], v[32:35]
    s_add_u32 m0, s74, 61440
    v_mfma_f32_16x16x32_bf16 v[32:35], a[136:139], v[84:87], v[32:35]
    ds_read_b128 v[104:107], v159 offset:768
    v_mfma_f32_16x16x32_bf16 v[36:39], a[140:143], v[84:87], v[36:39]
    ds_read_b128 v[108:111], v159 offset:6912
    v_mfma_f32_16x16x32_bf16 v[36:39], a[132:135], v[80:83], v[36:39]
    ds_read_b128 v[112:115], v159 offset:1024
    buffer_load_dwordx4 v156, s[44:47], s79 offen offset:0 sc1 lds
    v_mfma_f32_16x16x32_bf16 v[44:47], a[132:135], v[88:91], v[44:47]
    ds_read_b128 v[116:119], v159 offset:7168
    v_mfma_f32_16x16x32_bf16 v[44:47], a[140:143], v[92:95], v[44:47]
    ds_read_b128 v[120:123], v159 offset:1280
    v_mfma_f32_16x16x32_bf16 v[40:43], a[136:139], v[92:95], v[40:43]
    ds_read_b128 v[124:127], v159 offset:7424
    buffer_load_dwordx4 v157, s[44:47], s79 offen offset:1024 sc1 lds
    v_mfma_f32_16x16x32_bf16 v[40:43], a[128:131], v[88:91], v[40:43]
    v_mfma_f32_16x16x32_bf16 v[48:51], a[128:131], v[96:99], v[48:51]
    v_mfma_f32_16x16x32_bf16 v[48:51], a[136:139], v[100:103], v[48:51]
    buffer_load_dwordx4 v158, s[44:47], s79 offen offset:2048 sc1 lds
    v_mfma_f32_16x16x32_bf16 v[52:55], a[140:143], v[100:103], v[52:55]
    v_mfma_f32_16x16x32_bf16 v[52:55], a[132:135], v[96:99], v[52:55]
    s_waitcnt lgkmcnt(0)
    v_mfma_f32_16x16x32_bf16 v[60:63], a[132:135], v[104:107], v[60:63]
    s_waitcnt vmcnt(13)
    s_barrier
    v_mfma_f32_16x16x32_bf16 v[60:63], a[140:143], v[108:111], v[60:63]
    ds_read_b128 v[80:83], v159 offset:12288
    s_add_u32 m0, s74, 0
    v_mfma_f32_16x16x32_bf16 v[56:59], a[136:139], v[108:111], v[56:59]
    ds_read_b128 v[84:87], v159 offset:18432
    v_mfma_f32_16x16x32_bf16 v[56:59], a[128:131], v[104:107], v[56:59]
    ds_read_b128 v[88:91], v159 offset:12544
    buffer_load_dwordx4 v156, s[44:47], s80 offen offset:0 sc1 lds
    v_mfma_f32_16x16x32_bf16 v[64:67], a[128:131], v[112:115], v[64:67]
    ds_read_b128 v[92:95], v159 offset:18688
    v_mfma_f32_16x16x32_bf16 v[64:67], a[136:139], v[116:119], v[64:67]
    ds_read_b128 v[96:99], v159 offset:12800
    buffer_load_dword v29, v28, s[44:47], 0 offen sc1
    v_mfma_f32_16x16x32_bf16 v[68:71], a[140:143], v[116:119], v[68:71]
    ds_read_b128 v[100:103], v159 offset:18944
    buffer_load_dwordx4 v157, s[44:47], s80 offen offset:1024 sc1 lds
    v_mfma_f32_16x16x32_bf16 v[68:71], a[132:135], v[112:115], v[68:71]
    ds_read_b64_tr_b16 a[32:33], v10 offset:16384
    v_mfma_f32_16x16x32_bf16 v[76:79], a[132:135], v[120:123], v[76:79]
    ds_read_b64_tr_b16 a[34:35], v10 offset:18432
    v_mfma_f32_16x16x32_bf16 v[76:79], a[140:143], v[124:127], v[76:79]
    buffer_load_dwordx4 v158, s[44:47], s80 offen offset:2048 sc1 lds
    v_mfma_f32_16x16x32_bf16 v[72:75], a[136:139], v[124:127], v[72:75]
    ds_read_b64_tr_b16 a[40:41], v10 offset:20480
    v_mfma_f32_16x16x32_bf16 v[72:75], a[128:131], v[120:123], v[72:75]
    ds_read_b64_tr_b16 a[42:43], v10 offset:22528
    s_waitcnt lgkmcnt(4)
    v_mfma_f32_16x16x32_bf16 v[32:35], a[144:147], v[80:83], v[32:35]
    s_add_u32 m0, s73, 32768
    s_lshl_b32 s14, s87, 18
    v_mfma_f32_16x16x32_bf16 v[32:35], a[152:155], v[84:87], v[32:35]
    ds_read_b128 v[104:107], v159 offset:13056
    v_mfma_f32_16x16x32_bf16 v[36:39], a[156:159], v[84:87], v[36:39]
    ds_read_b128 v[108:111], v159 offset:19200
    buffer_load_dwordx4 v4, s[52:55], s14 offen offset:0 lds
    v_mfma_f32_16x16x32_bf16 v[36:39], a[148:151], v[80:83], v[36:39]
    ds_read_b128 v[112:115], v159 offset:13312
    v_mfma_f32_16x16x32_bf16 v[44:47], a[148:151], v[88:91], v[44:47]
    ds_read_b128 v[116:119], v159 offset:19456
    buffer_load_dwordx4 v5, s[52:55], s14 offen offset:1024 lds
    v_mfma_f32_16x16x32_bf16 v[44:47], a[156:159], v[92:95], v[44:47]
    ds_read_b128 v[120:123], v159 offset:13568
    v_mfma_f32_16x16x32_bf16 v[40:43], a[152:155], v[92:95], v[40:43]
    ds_read_b128 v[124:127], v159 offset:19712
    v_mfma_f32_16x16x32_bf16 v[40:43], a[144:147], v[88:91], v[40:43]
    ds_read_b64_tr_b16 a[36:37], v11 offset:16384
    buffer_load_dwordx4 v6, s[52:55], s14 offen offset:2048 lds
    v_mfma_f32_16x16x32_bf16 v[48:51], a[144:147], v[96:99], v[48:51]
    ds_read_b64_tr_b16 a[38:39], v11 offset:18432
    v_mfma_f32_16x16x32_bf16 v[48:51], a[152:155], v[100:103], v[48:51]
    buffer_load_dwordx4 v7, s[52:55], s14 offen offset:3072 lds
L_pl_G_4:
    s_cbranch_execz L_wret
    v_mfma_f32_16x16x32_bf16 v[52:55], a[156:159], v[100:103], v[52:55]
    ds_read_b64_tr_b16 a[44:45], v11 offset:20480
    v_mfma_f32_16x16x32_bf16 v[52:55], a[148:151], v[96:99], v[52:55]
    ds_read_b64_tr_b16 a[46:47], v11 offset:22528
    s_waitcnt lgkmcnt(4)
    v_mfma_f32_16x16x32_bf16 v[60:63], a[148:151], v[104:107], v[60:63]
    s_waitcnt vmcnt(17)
    s_barrier
    v_mfma_f32_16x16x32_bf16 v[60:63], a[156:159], v[108:111], v[60:63]
    ds_read_b128 v[80:83], v159 offset:24576
    v_mfma_f32_16x16x32_bf16 v[56:59], a[152:155], v[108:111], v[56:59]
    ds_read_b128 v[84:87], v159 offset:30720
    v_mfma_f32_16x16x32_bf16 v[56:59], a[144:147], v[104:107], v[56:59]
    ds_read_b128 v[88:91], v159 offset:24832
    v_mfma_f32_16x16x32_bf16 v[64:67], a[144:147], v[112:115], v[64:67]
    ds_read_b128 v[92:95], v159 offset:30976
    v_mfma_f32_16x16x32_bf16 v[64:67], a[152:155], v[116:119], v[64:67]
    ds_read_b128 v[96:99], v159 offset:25088
    v_mfma_f32_16x16x32_bf16 v[68:71], a[156:159], v[116:119], v[68:71]
    ds_read_b128 v[100:103], v159 offset:31232
    v_mfma_f32_16x16x32_bf16 v[68:71], a[148:151], v[112:115], v[68:71]
    v_mfma_f32_16x16x32_bf16 v[76:79], a[148:151], v[120:123], v[76:79]
    v_mfma_f32_16x16x32_bf16 v[76:79], a[156:159], v[124:127], v[76:79]
    v_mfma_f32_16x16x32_bf16 v[72:75], a[152:155], v[124:127], v[72:75]
    v_mfma_f32_16x16x32_bf16 v[72:75], a[144:147], v[120:123], v[72:75]
    s_waitcnt lgkmcnt(0)
    v_mfma_f32_16x16x32_bf16 v[32:35], a[160:163], v[80:83], v[32:35]
    v_mfma_f32_16x16x32_bf16 v[32:35], a[168:171], v[84:87], v[32:35]
    ds_read_b128 v[104:107], v159 offset:25344
    v_mfma_f32_16x16x32_bf16 v[36:39], a[172:175], v[84:87], v[36:39]
    ds_read_b128 v[108:111], v159 offset:31488
    v_mfma_f32_16x16x32_bf16 v[36:39], a[164:167], v[80:83], v[36:39]
    ds_read_b128 v[112:115], v159 offset:25600
    v_mfma_f32_16x16x32_bf16 v[44:47], a[164:167], v[88:91], v[44:47]
    ds_read_b128 v[116:119], v159 offset:31744
    v_mfma_f32_16x16x32_bf16 v[44:47], a[172:175], v[92:95], v[44:47]
    ds_read_b128 v[120:123], v159 offset:25856
    v_mfma_f32_16x16x32_bf16 v[40:43], a[168:171], v[92:95], v[40:43]
    ds_read_b128 v[124:127], v159 offset:32000
    v_mfma_f32_16x16x32_bf16 v[40:43], a[160:163], v[88:91], v[40:43]
    v_mfma_f32_16x16x32_bf16 v[48:51], a[160:163], v[96:99], v[48:51]
    v_mfma_f32_16x16x32_bf16 v[48:51], a[168:171], v[100:103], v[48:51]
    v_mfma_f32_16x16x32_bf16 v[52:55], a[172:175], v[100:103], v[52:55]
    v_mfma_f32_16x16x32_bf16 v[52:55], a[164:167], v[96:99], v[52:55]
    s_waitcnt lgkmcnt(0)
    v_mfma_f32_16x16x32_bf16 v[60:63], a[164:167], v[104:107], v[60:63]
    s_waitcnt vmcnt(14)
    s_barrier
    v_mfma_f32_16x16x32_bf16 v[60:63], a[172:175], v[108:111], v[60:63]
    ds_read_b128 v[80:83], v250 offset:0
    s_waitcnt vmcnt(6)
    v_mfma_f32_16x16x32_bf16 v[56:59], a[168:171], v[108:111], v[56:59]
    ds_read_b128 v[84:87], v250 offset:6144
    v_cmp_ne_u32 vcc, s68, v29
    v_mfma_f32_16x16x32_bf16 v[56:59], a[160:163], v[104:107], v[56:59]
    ds_read_b128 v[88:91], v250 offset:256
    v_mfma_f32_16x16x32_bf16 v[64:67], a[160:163], v[112:115], v[64:67]
    ds_read_b128 v[92:95], v250 offset:6400
    v_mfma_f32_16x16x32_bf16 v[64:67], a[168:171], v[116:119], v[64:67]
    ds_read_b128 v[96:99], v250 offset:512
    s_cbranch_vccnz L_rs_p5
L_ok_p5:
    v_mfma_f32_16x16x32_bf16 v[68:71], a[172:175], v[116:119], v[68:71]
    ds_read_b128 v[100:103], v250 offset:6656
    buffer_load_dwordx4 v[160:163], v246, s[44:47], s10 offen offset:0 sc1
    v_mfma_f32_16x16x32_bf16 v[68:71], a[164:167], v[112:115], v[68:71]
    v_mfma_f32_16x16x32_bf16 v[76:79], a[164:167], v[120:123], v[76:79]
    v_mfma_f32_16x16x32_bf16 v[76:79], a[172:175], v[124:127], v[76:79]
    buffer_load_dwordx4 v[164:167], v246, s[44:47], s10 offen offset:1024 sc1
    v_mfma_f32_16x16x32_bf16 v[72:75], a[168:171], v[124:127], v[72:75]
    buffer_load_dwordx4 v[168:171], v246, s[44:47], s10 offen offset:2048 sc1
    v_mfma_f32_16x16x32_bf16 v[72:75], a[160:163], v[120:123], v[72:75]
    s_waitcnt lgkmcnt(0)
    v_mfma_f32_16x16x32_bf16 v[32:35], a[176:179], v[80:83], v[32:35]
    v_mfma_f32_16x16x32_bf16 v[32:35], a[184:187], v[84:87], v[32:35]
    ds_read_b128 v[104:107], v250 offset:768
    v_mfma_f32_16x16x32_bf16 v[36:39], a[188:191], v[84:87], v[36:39]
    ds_read_b128 v[108:111], v250 offset:6912
    buffer_load_dwordx4 v[172:175], v247, s[44:47], s10 offen offset:0 sc1
    v_mfma_f32_16x16x32_bf16 v[36:39], a[180:183], v[80:83], v[36:39]
    ds_read_b128 v[112:115], v250 offset:1024
    v_mfma_f32_16x16x32_bf16 v[44:47], a[180:183], v[88:91], v[44:47]
    ds_read_b128 v[116:119], v250 offset:7168
    v_mfma_f32_16x16x32_bf16 v[44:47], a[188:191], v[92:95], v[44:47]
    ds_read_b128 v[120:123], v250 offset:1280
    buffer_load_dwordx4 v[176:179], v247, s[44:47], s10 offen offset:1024 sc1
    v_mfma_f32_16x16x32_bf16 v[40:43], a[184:187], v[92:95], v[40:43]
    ds_read_b128 v[124:127], v250 offset:7424
    v_mfma_f32_16x16x32_bf16 v[40:43], a[176:179], v[88:91], v[40:43]
    v_mfma_f32_16x16x32_bf16 v[48:51], a[176:179], v[96:99], v[48:51]
    v_mfma_f32_16x16x32_bf16 v[48:51], a[184:187], v[100:103], v[48:51]
    v_mfma_f32_16x16x32_bf16 v[52:55], a[188:191], v[100:103], v[52:55]
    buffer_load_dwordx4 v[180:183], v247, s[44:47], s10 offen offset:2048 sc1
    v_mfma_f32_16x16x32_bf16 v[52:55], a[180:183], v[96:99], v[52:55]
    s_waitcnt lgkmcnt(0)
    v_mfma_f32_16x16x32_bf16 v[60:63], a[180:183], v[104:107], v[60:63]
    s_barrier
    v_mfma_f32_16x16x32_bf16 v[60:63], a[188:191], v[108:111], v[60:63]
    ds_read_b128 v[80:83], v250 offset:12288
    s_add_u32 m0, s74, 12288
    v_mfma_f32_16x16x32_bf16 v[56:59], a[184:187], v[108:111], v[56:59]
    ds_read_b128 v[84:87], v250 offset:18432
    v_mfma_f32_16x16x32_bf16 v[56:59], a[176:179], v[104:107], v[56:59]
    ds_read_b128 v[88:91], v250 offset:12544
    buffer_load_dwordx4 v156, s[44:47], s81 offen offset:0 sc1 lds
    v_mfma_f32_16x16x32_bf16 v[64:67], a[176:179], v[112:115], v[64:67]
    ds_read_b128 v[92:95], v250 offset:18688
    v_mfma_f32_16x16x32_bf16 v[64:67], a[184:187], v[116:119], v[64:67]
    ds_read_b128 v[96:99], v250 offset:12800
    v_mfma_f32_16x16x32_bf16 v[68:71], a[188:191], v[116:119], v[68:71]
    ds_read_b128 v[100:103], v250 offset:18944
    buffer_load_dwordx4 v157, s[44:47], s81 offen offset:1024 sc1 lds
    v_mfma_f32_16x16x32_bf16 v[68:71], a[180:183], v[112:115], v[68:71]
    v_mfma_f32_16x16x32_bf16 v[76:79], a[180:183], v[120:123], v[76:79]
    v_mfma_f32_16x16x32_bf16 v[76:79], a[188:191], v[124:127], v[76:79]
    buffer_load_dwordx4 v158, s[44:47], s81 offen offset:2048 sc1 lds
    v_mfma_f32_16x16x32_bf16 v[72:75], a[184:187], v[124:127], v[72:75]
    v_mfma_f32_16x16x32_bf16 v[72:75], a[176:179], v[120:123], v[72:75]
    s_waitcnt lgkmcnt(0)
    v_mfma_f32_16x16x32_bf16 v[32:35], a[192:195], v[80:83], v[32:35]
    s_add_u32 m0, s73, 49152
    s_lshl_b32 s14, s88, 18
    v_mfma_f32_16x16x32_bf16 v[32:35], a[200:203], v[84:87], v[32:35]
    ds_read_b128 v[104:107], v250 offset:13056
    v_mfma_f32_16x16x32_bf16 v[36:39], a[204:207], v[84:87], v[36:39]
    ds_read_b128 v[108:111], v250 offset:19200
    buffer_load_dwordx4 v4, s[52:55], s14 offen offset:0 lds
    v_mfma_f32_16x16x32_bf16 v[36:39], a[196:199], v[80:83], v[36:39]
    ds_read_b128 v[112:115], v250 offset:13312
    v_mfma_f32_16x16x32_bf16 v[44:47], a[196:199], v[88:91], v[44:47]
    ds_read_b128 v[116:119], v250 offset:19456
    buffer_load_dwordx4 v5, s[52:55], s14 offen offset:1024 lds
    v_mfma_f32_16x16x32_bf16 v[44:47], a[204:207], v[92:95], v[44:47]
    ds_read_b128 v[120:123], v250 offset:13568
    v_mfma_f32_16x16x32_bf16 v[40:43], a[200:203], v[92:95], v[40:43]
    ds_read_b128 v[124:127], v250 offset:19712
    v_mfma_f32_16x16x32_bf16 v[40:43], a[192:195], v[88:91], v[40:43]
    buffer_load_dwordx4 v6, s[52:55], s14 offen offset:2048 lds
    v_mfma_f32_16x16x32_bf16 v[48:51], a[192:195], v[96:99], v[48:51]
    v_mfma_f32_16x16x32_bf16 v[48:51], a[200:203], v[100:103], v[48:51]
    buffer_load_dwordx4 v7, s[52:55], s14 offen offset:3072 lds
    v_mfma_f32_16x16x32_bf16 v[52:55], a[204:207], v[100:103], v[52:55]
    v_mfma_f32_16x16x32_bf16 v[52:55], a[196:199], v[96:99], v[52:55]
    s_waitcnt lgkmcnt(0)
    v_mfma_f32_16x16x32_bf16 v[60:63], a[196:199], v[104:107], v[60:63]
    s_barrier
    v_mfma_f32_16x16x32_bf16 v[60:63], a[204:207], v[108:111], v[60:63]
    ds_read_b128 v[80:83], v250 offset:24576
    v_mfma_f32_16x16x32_bf16 v[56:59], a[200:203], v[108:111], v[56:59]
    ds_read_b128 v[84:87], v250 offset:30720
    v_mfma_f32_16x16x32_bf16 v[56:59], a[192:195], v[104:107], v[56:59]
    ds_read_b128 v[88:91], v250 offset:24832
    v_mfma_f32_16x16x32_bf16 v[64:67], a[192:195], v[112:115], v[64:67]
    ds_read_b128 v[92:95], v250 offset:30976
    v_mfma_f32_16x16x32_bf16 v[64:67], a[200:203], v[116:119], v[64:67]
    ds_read_b128 v[96:99], v250 offset:25088
    v_mfma_f32_16x16x32_bf16 v[68:71], a[204:207], v[116:119], v[68:71]
    ds_read_b128 v[100:103], v250 offset:31232
    s_waitcnt vmcnt(7)
    v_mfma_f32_16x16x32_bf16 v[68:71], a[196:199], v[112:115], v[68:71]
    v_mfma_f32_16x16x32_bf16 v[76:79], a[196:199], v[120:123], v[76:79]
    v_mfma_f32_16x16x32_bf16 v[76:79], a[204:207], v[124:127], v[76:79]
    v_mfma_f32_16x16x32_bf16 v[72:75], a[200:203], v[124:127], v[72:75]
    v_mfma_f32_16x16x32_bf16 v[72:75], a[192:195], v[120:123], v[72:75]
    s_waitcnt lgkmcnt(0)
    v_mfma_f32_16x16x32_bf16 v[32:35], a[208:211], v[80:83], v[32:35]
    s_add_u32 m0, s73, 65536
    s_lshl_b32 s14, s89, 18
    v_mfma_f32_16x16x32_bf16 v[32:35], a[216:219], v[84:87], v[32:35]
    ds_read_b128 v[104:107], v250 offset:25344
    v_mfma_f32_16x16x32_bf16 v[36:39], a[220:223], v[84:87], v[36:39]
    ds_read_b128 v[108:111], v250 offset:31488
    buffer_load_dwordx4 v4, s[52:55], s14 offen offset:0 lds
    v_and_b32 v193, 0xffff0000, v172
    v_lshlrev_b32 v192, 16, v172
    v_mfma_f32_16x16x32_bf16 v[36:39], a[212:215], v[80:83], v[36:39]
    ds_read_b128 v[112:115], v250 offset:25600
    v_and_b32 v195, 0xffff0000, v173
    v_lshlrev_b32 v194, 16, v173
    v_mfma_f32_16x16x32_bf16 v[44:47], a[212:215], v[88:91], v[44:47]
    ds_read_b128 v[116:119], v250 offset:31744
    buffer_load_dwordx4 v5, s[52:55], s14 offen offset:1024 lds
    v_add_f32 v56, v56, v192
    v_mfma_f32_16x16x32_bf16 v[44:47], a[220:223], v[92:95], v[44:47]
    ds_read_b128 v[120:123], v250 offset:25856
    v_add_f32 v57, v57, v193
    v_add_f32 v58, v58, v194
    v_mfma_f32_16x16x32_bf16 v[40:43], a[216:219], v[92:95], v[40:43]
    ds_read_b128 v[124:127], v250 offset:32000
    v_add_f32 v59, v59, v195
    v_and_b32 v197, 0xffff0000, v174
    v_mfma_f32_16x16x32_bf16 v[40:43], a[208:211], v[88:91], v[40:43]
    buffer_load_dwordx4 v6, s[52:55], s14 offen offset:2048 lds
    v_lshlrev_b32 v196, 16, v174
    v_and_b32 v199, 0xffff0000, v175
    v_mfma_f32_16x16x32_bf16 v[48:51], a[208:211], v[96:99], v[48:51]
    v_lshlrev_b32 v198, 16, v175
    v_add_f32 v60, v60, v196
    v_mfma_f32_16x16x32_bf16 v[48:51], a[216:219], v[100:103], v[48:51]
    buffer_load_dwordx4 v7, s[52:55], s14 offen offset:3072 lds
    v_add_f32 v61, v61, v197
    v_mfma_f32_16x16x32_bf16 v[52:55], a[220:223], v[100:103], v[52:55]
    v_add_f32 v62, v62, v198
    v_add_f32 v63, v63, v199
    v_mfma_f32_16x16x32_bf16 v[52:55], a[212:215], v[96:99], v[52:55]
    s_waitcnt lgkmcnt(0)
    v_mfma_f32_16x16x32_bf16 v[60:63], a[212:215], v[104:107], v[60:63]
    s_barrier
    v_mfma_f32_16x16x32_bf16 v[60:63], a[220:223], v[108:111], v[60:63]
    ds_read_b128 v[80:83], v159 offset:0
    v_mfma_f32_16x16x32_bf16 v[56:59], a[216:219], v[108:111], v[56:59]
    ds_read_b128 v[84:87], v159 offset:6144
    v_and_b32 v193, 0xffff0000, v160
    v_lshlrev_b32 v192, 16, v160
    v_mfma_f32_16x16x32_bf16 v[56:59], a[208:211], v[104:107], v[56:59]
    ds_read_b128 v[88:91], v159 offset:256
    v_and_b32 v195, 0xffff0000, v161
    v_lshlrev_b32 v194, 16, v161
    v_mfma_f32_16x16x32_bf16 v[64:67], a[208:211], v[112:115], v[64:67]
    ds_read_b128 v[92:95], v159 offset:6400
    v_add_f32 v32, v32, v192
    v_mfma_f32_16x16x32_bf16 v[64:67], a[216:219], v[116:119], v[64:67]
    ds_read_b128 v[96:99], v159 offset:512
    v_add_f32 v33, v33, v193
    v_add_f32 v34, v34, v194
    v_mfma_f32_16x16x32_bf16 v[68:71], a[220:223], v[116:119], v[68:71]
    ds_read_b128 v[100:103], v159 offset:6656
    v_add_f32 v35, v35, v195
    v_and_b32 v197, 0xffff0000, v162
    v_mfma_f32_16x16x32_bf16 v[68:71], a[212:215], v[112:115], v[68:71]
    ds_read_b64_tr_b16 a[48:49], v10 offset:32768
    v_lshlrev_b32 v196, 16, v162
    v_and_b32 v199, 0xffff0000, v163
    v_mfma_f32_16x16x32_bf16 v[76:79], a[212:215], v[120:123], v[76:79]
    ds_read_b64_tr_b16 a[50:51], v10 offset:34816
    v_lshlrev_b32 v198, 16, v163
    v_mfma_f32_16x16x32_bf16 v[76:79], a[220:223], v[124:127], v[76:79]
    v_add_f32 v36, v36, v196
    v_add_f32 v37, v37, v197
    v_mfma_f32_16x16x32_bf16 v[72:75], a[216:219], v[124:127], v[72:75]
    ds_read_b64_tr_b16 a[56:57], v10 offset:36864
    v_add_f32 v38, v38, v198
    v_add_f32 v39, v39, v199
    v_mfma_f32_16x16x32_bf16 v[72:75], a[208:211], v[120:123], v[72:75]
    ds_read_b64_tr_b16 a[58:59], v10 offset:38912
    s_waitcnt lgkmcnt(4)
    v_mfma_f32_16x16x32_bf16 v[32:35], a[224:227], v[80:83], v[32:35]
    s_add_u32 m0, s73, 0
    s_lshl_b32 s14, s90, 18
    v_mfma_f32_16x16x32_bf16 v[32:35], a[232:235], v[84:87], v[32:35]
    ds_read_b128 v[104:107], v159 offset:768
    v_mfma_f32_16x16x32_bf16 v[36:39], a[236:239], v[84:87], v[36:39]
    ds_read_b128 v[108:111], v159 offset:6912
    buffer_load_dwordx4 v4, s[52:55], s14 offen offset:0 lds
    v_and_b32 v193, 0xffff0000, v176
    v_lshlrev_b32 v192, 16, v176
    v_mfma_f32_16x16x32_bf16 v[36:39], a[228:231], v[80:83], v[36:39]
    ds_read_b128 v[112:115], v159 offset:1024
    v_and_b32 v195, 0xffff0000, v177
    v_lshlrev_b32 v194, 16, v177
    v_mfma_f32_16x16x32_bf16 v[44:47], a[228:231], v[88:91], v[44:47]
    ds_read_b128 v[116:119], v159 offset:7168
    buffer_load_dwordx4 v5, s[52:55], s14 offen offset:1024 lds
    v_add_f32 v64, v64, v192
    v_mfma_f32_16x16x32_bf16 v[44:47], a[236:239], v[92:95], v[44:47]
    ds_read_b128 v[120:123], v159 offset:1280
    v_add_f32 v65, v65, v193
    v_add_f32 v66, v66, v194
    v_mfma_f32_16x16x32_bf16 v[40:43], a[232:235], v[92:95], v[40:43]
    ds_read_b128 v[124:127], v159 offset:7424
    v_add_f32 v67, v67, v195
    v_and_b32 v197, 0xffff0000, v178
    v_mfma_f32_16x16x32_bf16 v[40:43], a[224:227], v[88:91], v[40:43]
    ds_read_b64_tr_b16 a[52:53], v11 offset:32768
    buffer_load_dwordx4 v6, s[52:55], s14 offen offset:2048 lds
    v_lshlrev_b32 v196, 16, v178
    v_and_b32 v199, 0xffff0000, v179
    v_mfma_f32_16x16x32_bf16 v[48:51], a[224:227], v[96:99], v[48:51]
    ds_read_b64_tr_b16 a[54:55], v11 offset:34816
    v_lshlrev_b32 v198, 16, v179
    v_mfma_f32_16x16x32_bf16 v[48:51], a[232:235], v[100:103], v[48:51]
    buffer_load_dwordx4 v7, s[52:55], s14 offen offset:3072 lds
    v_add_f32 v68, v68, v196
    v_add_f32 v69, v69, v197
    v_mfma_f32_16x16x32_bf16 v[52:55], a[236:239], v[100:103], v[52:55]
    ds_read_b64_tr_b16 a[60:61], v11 offset:36864
    v_add_f32 v70, v70, v198
    v_add_f32 v71, v71, v199
    v_mfma_f32_16x16x32_bf16 v[52:55], a[228:231], v[96:99], v[52:55]
    ds_read_b64_tr_b16 a[62:63], v11 offset:38912
    s_waitcnt lgkmcnt(4)
    v_mfma_f32_16x16x32_bf16 v[60:63], a[228:231], v[104:107], v[60:63]
    s_waitcnt vmcnt(12)
    s_barrier
    v_mfma_f32_16x16x32_bf16 v[60:63], a[236:239], v[108:111], v[60:63]
    ds_read_b128 v[80:83], v159 offset:12288
    v_mfma_f32_16x16x32_bf16 v[56:59], a[232:235], v[108:111], v[56:59]
    ds_read_b128 v[84:87], v159 offset:18432
    v_and_b32 v193, 0xffff0000, v164
    v_lshlrev_b32 v192, 16, v164
    v_mfma_f32_16x16x32_bf16 v[56:59], a[224:227], v[104:107], v[56:59]
    ds_read_b128 v[88:91], v159 offset:12544
    v_and_b32 v195, 0xffff0000, v165
    v_lshlrev_b32 v194, 16, v165
    v_mfma_f32_16x16x32_bf16 v[64:67], a[224:227], v[112:115], v[64:67]
    ds_read_b128 v[92:95], v159 offset:18688
    v_add_f32 v40, v40, v192
    v_mfma_f32_16x16x32_bf16 v[64:67], a[232:235], v[116:119], v[64:67]
    ds_read_b128 v[96:99], v159 offset:12800
    v_add_f32 v41, v41, v193
    v_add_f32 v42, v42, v194
    v_mfma_f32_16x16x32_bf16 v[68:71], a[236:239], v[116:119], v[68:71]
    ds_read_b128 v[100:103], v159 offset:18944
    v_add_f32 v43, v43, v195
    v_mfma_f32_16x16x32_bf16 v[68:71], a[228:231], v[112:115], v[68:71]
    v_and_b32 v197, 0xffff0000, v166
    v_lshlrev_b32 v196, 16, v166
    v_mfma_f32_16x16x32_bf16 v[76:79], a[228:231], v[120:123], v[76:79]
    v_and_b32 v199, 0xffff0000, v167
    v_lshlrev_b32 v198, 16, v167
    v_mfma_f32_16x16x32_bf16 v[76:79], a[236:239], v[124:127], v[76:79]
    v_add_f32 v44, v44, v196
    v_add_f32 v45, v45, v197
    v_mfma_f32_16x16x32_bf16 v[72:75], a[232:235], v[124:127], v[72:75]
    v_add_f32 v46, v46, v198
    v_add_f32 v47, v47, v199
    v_mfma_f32_16x16x32_bf16 v[72:75], a[224:227], v[120:123], v[72:75]
    s_waitcnt lgkmcnt(0)
    v_mfma_f32_16x16x32_bf16 v[32:35], a[240:243], v[80:83], v[32:35]
    s_add_u32 m0, s73, 16384
    s_lshl_b32 s14, s91, 18
    v_mfma_f32_16x16x32_bf16 v[32:35], a[248:251], v[84:87], v[32:35]
    ds_read_b128 v[104:107], v159 offset:13056
    v_mfma_f32_16x16x32_bf16 v[36:39], a[252:255], v[84:87], v[36:39]
    ds_read_b128 v[108:111], v159 offset:19200
    buffer_load_dwordx4 v4, s[52:55], s14 offen offset:0 lds
    v_and_b32 v193, 0xffff0000, v180
    v_lshlrev_b32 v192, 16, v180
    v_mfma_f32_16x16x32_bf16 v[36:39], a[244:247], v[80:83], v[36:39]
    ds_read_b128 v[112:115], v159 offset:13312
    v_and_b32 v195, 0xffff0000, v181
    v_lshlrev_b32 v194, 16, v181
    v_mfma_f32_16x16x32_bf16 v[44:47], a[244:247], v[88:91], v[44:47]
    ds_read_b128 v[116:119], v159 offset:19456
    buffer_load_dwordx4 v5, s[52:55], s14 offen offset:1024 lds
    v_add_f32 v72, v72, v192
    v_mfma_f32_16x16x32_bf16 v[44:47], a[252:255], v[92:95], v[44:47]
    ds_read_b128 v[120:123], v159 offset:13568
    v_add_f32 v73, v73, v193
    v_add_f32 v74, v74, v194
    v_mfma_f32_16x16x32_bf16 v[40:43], a[248:251], v[92:95], v[40:43]
    ds_read_b128 v[124:127], v159 offset:19712
    v_add_f32 v75, v75, v195
    v_and_b32 v197, 0xffff0000, v182
    v_mfma_f32_16x16x32_bf16 v[40:43], a[240:243], v[88:91], v[40:43]
    buffer_load_dwordx4 v6, s[52:55], s14 offen offset:2048 lds
    v_lshlrev_b32 v196, 16, v182
    v_and_b32 v199, 0xffff0000, v183
    v_mfma_f32_16x16x32_bf16 v[48:51], a[240:243], v[96:99], v[48:51]
    v_lshlrev_b32 v198, 16, v183
    v_add_f32 v76, v76, v196
    v_mfma_f32_16x16x32_bf16 v[48:51], a[248:251], v[100:103], v[48:51]
    buffer_load_dwordx4 v7, s[52:55], s14 offen offset:3072 lds
    v_add_f32 v77, v77, v197
    v_mfma_f32_16x16x32_bf16 v[52:55], a[252:255], v[100:103], v[52:55]
    v_add_f32 v78, v78, v198
    v_add_f32 v79, v79, v199
    v_mfma_f32_16x16x32_bf16 v[52:55], a[244:247], v[96:99], v[52:55]
    s_waitcnt lgkmcnt(0)
    v_mfma_f32_16x16x32_bf16 v[60:63], a[244:247], v[104:107], v[60:63]
    s_barrier
    v_mfma_f32_16x16x32_bf16 v[60:63], a[252:255], v[108:111], v[60:63]
    s_add_u32 m0, s73, 131072
    s_lshl_b32 s14, s92, 18
    v_mfma_f32_16x16x32_bf16 v[56:59], a[248:251], v[108:111], v[56:59]
    buffer_load_dwordx4 v4, s[52:55], s14 offen offset:0 lds
    v_and_b32 v193, 0xffff0000, v168
    v_lshlrev_b32 v192, 16, v168
    v_mfma_f32_16x16x32_bf16 v[56:59], a[240:243], v[104:107], v[56:59]
    buffer_load_dwordx4 v5, s[52:55], s14 offen offset:1024 lds
    v_and_b32 v195, 0xffff0000, v169
    v_lshlrev_b32 v194, 16, v169
    v_mfma_f32_16x16x32_bf16 v[64:67], a[240:243], v[112:115], v[64:67]
    buffer_load_dwordx4 v6, s[52:55], s14 offen offset:2048 lds
    v_add_f32 v48, v48, v192
    v_mfma_f32_16x16x32_bf16 v[64:67], a[248:251], v[116:119], v[64:67]
    buffer_load_dwordx4 v7, s[52:55], s14 offen offset:3072 lds
    v_add_f32 v49, v49, v193
    v_add_f32 v50, v50, v194
    v_mfma_f32_16x16x32_bf16 v[68:71], a[252:255], v[116:119], v[68:71]
    s_add_u32 m0, s73, 147456
    s_lshl_b32 s14, s93, 18
    v_add_f32 v51, v51, v195
    v_and_b32 v197, 0xffff0000, v170
    v_mfma_f32_16x16x32_bf16 v[68:71], a[244:247], v[112:115], v[68:71]
    buffer_load_dwordx4 v4, s[52:55], s14 offen offset:0 lds
    v_lshlrev_b32 v196, 16, v170
    v_and_b32 v199, 0xffff0000, v171
    v_mfma_f32_16x16x32_bf16 v[76:79], a[244:247], v[120:123], v[76:79]
    buffer_load_dwordx4 v5, s[52:55], s14 offen offset:1024 lds
    v_lshlrev_b32 v198, 16, v171
    v_mfma_f32_16x16x32_bf16 v[76:79], a[252:255], v[124:127], v[76:79]
    buffer_load_dwordx4 v6, s[52:55], s14 offen offset:2048 lds
    v_add_f32 v52, v52, v196
    v_add_f32 v53, v53, v197
    v_mfma_f32_16x16x32_bf16 v[72:75], a[248:251], v[124:127], v[72:75]
    buffer_load_dwordx4 v7, s[52:55], s14 offen offset:3072 lds
    v_add_f32 v54, v54, v198
    v_add_f32 v55, v55, v199
    v_mfma_f32_16x16x32_bf16 v[72:75], a[240:243], v[120:123], v[72:75]
    s_waitcnt lgkmcnt(0)
    v_mov_b32 v88, 0xc0135761
    s_mov_b32 s10, 0xbdd2d3e8
    s_lshl_b32 s9, s69, 2
    s_add_u32 s9, s9, s3
    s_mul_i32 s9, s9, 69632
    s_add_u32 s9, s9, 12795904
    v_pk_mul_f32 v[160:161], v[32:33], v[32:33]
    v_pk_mul_f32 v[162:163], v[34:35], v[34:35]
    v_pk_mul_f32 v[164:165], v[36:37], v[36:37]
    v_pk_mul_f32 v[166:167], v[38:39], v[38:39]
    v_pk_mul_f32 v[168:169], v[40:41], v[40:41]
    v_pk_mul_f32 v[170:171], v[42:43], v[42:43]
    v_pk_mul_f32 v[172:173], v[44:45], v[44:45]
    v_pk_mul_f32 v[174:175], v[46:47], v[46:47]
    v_pk_fma_f32 v[160:161], v[160:161], s[10:11], v[88:89] op_sel_hi:[1,0,0]
    v_pk_fma_f32 v[162:163], v[162:163], s[10:11], v[88:89] op_sel_hi:[1,0,0]
    v_pk_fma_f32 v[164:165], v[164:165], s[10:11], v[88:89] op_sel_hi:[1,0,0]
    v_pk_fma_f32 v[166:167], v[166:167], s[10:11], v[88:89] op_sel_hi:[1,0,0]
    v_pk_fma_f32 v[168:169], v[168:169], s[10:11], v[88:89] op_sel_hi:[1,0,0]
    v_pk_fma_f32 v[170:171], v[170:171], s[10:11], v[88:89] op_sel_hi:[1,0,0]
    v_pk_fma_f32 v[172:173], v[172:173], s[10:11], v[88:89] op_sel_hi:[1,0,0]
    v_pk_fma_f32 v[174:175], v[174:175], s[10:11], v[88:89] op_sel_hi:[1,0,0]
    v_pk_mul_f32 v[160:161], v[160:161], v[32:33]
    v_pk_mul_f32 v[162:163], v[162:163], v[34:35]
    v_pk_mul_f32 v[164:165], v[164:165], v[36:37]
    v_pk_mul_f32 v[166:167], v[166:167], v[38:39]
    v_pk_mul_f32 v[168:169], v[168:169], v[40:41]
    v_pk_mul_f32 v[170:171], v[170:171], v[42:43]
    v_pk_mul_f32 v[172:173], v[172:173], v[44:45]
    v_pk_mul_f32 v[174:175], v[174:175], v[46:47]
    v_exp_f32 v160, v160
    v_exp_f32 v161, v161
    v_exp_f32 v162, v162
    v_exp_f32 v163, v163
    v_exp_f32 v164, v164
    v_exp_f32 v165, v165
    v_exp_f32 v166, v166
    v_exp_f32 v167, v167
    v_exp_f32 v168, v168
    v_exp_f32 v169, v169
    v_exp_f32 v170, v170
    v_exp_f32 v171, v171
    v_exp_f32 v172, v172
    v_exp_f32 v173, v173
    v_exp_f32 v174, v174
    v_exp_f32 v175, v175
    v_pk_add_f32 v[160:161], v[160:161], 1.0 op_sel_hi:[1,0]
    v_pk_add_f32 v[162:163], v[162:163], 1.0 op_sel_hi:[1,0]
    v_pk_add_f32 v[164:165], v[164:165], 1.0 op_sel_hi:[1,0]
    v_pk_add_f32 v[166:167], v[166:167], 1.0 op_sel_hi:[1,0]
    v_pk_add_f32 v[168:169], v[168:169], 1.0 op_sel_hi:[1,0]
    v_pk_add_f32 v[170:171], v[170:171], 1.0 op_sel_hi:[1,0]
    v_pk_add_f32 v[172:173], v[172:173], 1.0 op_sel_hi:[1,0]
    v_pk_add_f32 v[174:175], v[174:175], 1.0 op_sel_hi:[1,0]
    v_rcp_f32 v160, v160
    v_rcp_f32 v161, v161
    v_rcp_f32 v162, v162
    v_rcp_f32 v163, v163
    v_rcp_f32 v164, v164
    v_rcp_f32 v165, v165
    v_rcp_f32 v166, v166
    v_rcp_f32 v167, v167
    v_rcp_f32 v168, v168
    v_rcp_f32 v169, v169
    v_rcp_f32 v170, v170
    v_rcp_f32 v171, v171
    v_rcp_f32 v172, v172
    v_rcp_f32 v173, v173
    v_rcp_f32 v174, v174
    v_rcp_f32 v175, v175
    v_pk_mul_f32 v[32:33], v[32:33], v[160:161]
    v_pk_mul_f32 v[34:35], v[34:35], v[162:163]
    v_pk_mul_f32 v[36:37], v[36:37], v[164:165]
    v_pk_mul_f32 v[38:39], v[38:39], v[166:167]
    v_pk_mul_f32 v[40:41], v[40:41], v[168:169]
    v_pk_mul_f32 v[42:43], v[42:43], v[170:171]
    v_pk_mul_f32 v[44:45], v[44:45], v[172:173]
    v_pk_mul_f32 v[46:47], v[46:47], v[174:175]
    v_cvt_pk_bf16_f32 v96, v32, v33
    v_cvt_pk_bf16_f32 v97, v34, v35
    v_cvt_pk_bf16_f32 v98, v36, v37
    v_cvt_pk_bf16_f32 v99, v38, v39
    v_cvt_pk_bf16_f32 v100, v40, v41
    v_cvt_pk_bf16_f32 v101, v42, v43
    v_cvt_pk_bf16_f32 v102, v44, v45
    v_cvt_pk_bf16_f32 v103, v46, v47
    buffer_store_dwordx4 v[96:99], v240, s[44:47], s9 offen sc1
    buffer_store_dwordx4 v[100:103], v241, s[44:47], s9 offen sc1
    v_pk_mul_f32 v[160:161], v[48:49], v[48:49]
    v_pk_mul_f32 v[162:163], v[50:51], v[50:51]
    v_pk_mul_f32 v[164:165], v[52:53], v[52:53]
    v_pk_mul_f32 v[166:167], v[54:55], v[54:55]
    v_pk_mul_f32 v[168:169], v[56:57], v[56:57]
    v_pk_mul_f32 v[170:171], v[58:59], v[58:59]
    v_pk_mul_f32 v[172:173], v[60:61], v[60:61]
    v_pk_mul_f32 v[174:175], v[62:63], v[62:63]
    v_pk_fma_f32 v[160:161], v[160:161], s[10:11], v[88:89] op_sel_hi:[1,0,0]
    v_pk_fma_f32 v[162:163], v[162:163], s[10:11], v[88:89] op_sel_hi:[1,0,0]
    v_pk_fma_f32 v[164:165], v[164:165], s[10:11], v[88:89] op_sel_hi:[1,0,0]
    v_pk_fma_f32 v[166:167], v[166:167], s[10:11], v[88:89] op_sel_hi:[1,0,0]
    v_pk_fma_f32 v[168:169], v[168:169], s[10:11], v[88:89] op_sel_hi:[1,0,0]
    v_pk_fma_f32 v[170:171], v[170:171], s[10:11], v[88:89] op_sel_hi:[1,0,0]
    v_pk_fma_f32 v[172:173], v[172:173], s[10:11], v[88:89] op_sel_hi:[1,0,0]
    v_pk_fma_f32 v[174:175], v[174:175], s[10:11], v[88:89] op_sel_hi:[1,0,0]
    v_pk_mul_f32 v[160:161], v[160:161], v[48:49]
    v_pk_mul_f32 v[162:163], v[162:163], v[50:51]
    v_pk_mul_f32 v[164:165], v[164:165], v[52:53]
    v_pk_mul_f32 v[166:167], v[166:167], v[54:55]
    v_pk_mul_f32 v[168:169], v[168:169], v[56:57]
    v_pk_mul_f32 v[170:171], v[170:171], v[58:59]
    v_pk_mul_f32 v[172:173], v[172:173], v[60:61]
    v_pk_mul_f32 v[174:175], v[174:175], v[62:63]
    v_exp_f32 v160, v160
    v_exp_f32 v161, v161
    v_exp_f32 v162, v162
    v_exp_f32 v163, v163
    v_exp_f32 v164, v164
    v_exp_f32 v165, v165
    v_exp_f32 v166, v166
    v_exp_f32 v167, v167
    v_exp_f32 v168, v168
    v_exp_f32 v169, v169
    v_exp_f32 v170, v170
    v_exp_f32 v171, v171
    v_exp_f32 v172, v172
    v_exp_f32 v173, v173
    v_exp_f32 v174, v174
    v_exp_f32 v175, v175
    v_pk_add_f32 v[160:161], v[160:161], 1.0 op_sel_hi:[1,0]
    v_pk_add_f32 v[162:163], v[162:163], 1.0 op_sel_hi:[1,0]
    v_pk_add_f32 v[164:165], v[164:165], 1.0 op_sel_hi:[1,0]
    v_pk_add_f32 v[166:167], v[166:167], 1.0 op_sel_hi:[1,0]
    v_pk_add_f32 v[168:169], v[168:169], 1.0 op_sel_hi:[1,0]
    v_pk_add_f32 v[170:171], v[170:171], 1.0 op_sel_hi:[1,0]
    v_pk_add_f32 v[172:173], v[172:173], 1.0 op_sel_hi:[1,0]
    v_pk_add_f32 v[174:175], v[174:175], 1.0 op_sel_hi:[1,0]
    v_rcp_f32 v160, v160
    v_rcp_f32 v161, v161
    v_rcp_f32 v162, v162
    v_rcp_f32 v163, v163
    v_rcp_f32 v164, v164
    v_rcp_f32 v165, v165
    v_rcp_f32 v166, v166
    v_rcp_f32 v167, v167
    v_rcp_f32 v168, v168
    v_rcp_f32 v169, v169
    v_rcp_f32 v170, v170
    v_rcp_f32 v171, v171
    v_rcp_f32 v172, v172
    v_rcp_f32 v173, v173
    v_rcp_f32 v174, v174
    v_rcp_f32 v175, v175
    v_pk_mul_f32 v[48:49], v[48:49], v[160:161]
    v_pk_mul_f32 v[50:51], v[50:51], v[162:163]
    v_pk_mul_f32 v[52:53], v[52:53], v[164:165]
    v_pk_mul_f32 v[54:55], v[54:55], v[166:167]
    v_pk_mul_f32 v[56:57], v[56:57], v[168:169]
    v_pk_mul_f32 v[58:59], v[58:59], v[170:171]
    v_pk_mul_f32 v[60:61], v[60:61], v[172:173]
    v_pk_mul_f32 v[62:63], v[62:63], v[174:175]
    v_cvt_pk_bf16_f32 v104, v48, v49
    v_cvt_pk_bf16_f32 v105, v50, v51
    v_cvt_pk_bf16_f32 v106, v52, v53
    v_cvt_pk_bf16_f32 v107, v54, v55
    v_cvt_pk_bf16_f32 v108, v56, v57
    v_cvt_pk_bf16_f32 v109, v58, v59
    v_cvt_pk_bf16_f32 v110, v60, v61
    v_cvt_pk_bf16_f32 v111, v62, v63
    buffer_store_dwordx4 v[104:107], v242, s[44:47], s9 offen sc1
    buffer_store_dwordx4 v[108:111], v243, s[44:47], s9 offen sc1
    v_pk_mul_f32 v[160:161], v[64:65], v[64:65]
    v_pk_mul_f32 v[162:163], v[66:67], v[66:67]
    v_pk_mul_f32 v[164:165], v[68:69], v[68:69]
    v_pk_mul_f32 v[166:167], v[70:71], v[70:71]
    v_pk_mul_f32 v[168:169], v[72:73], v[72:73]
    v_pk_mul_f32 v[170:171], v[74:75], v[74:75]
    v_pk_mul_f32 v[172:173], v[76:77], v[76:77]
    v_pk_mul_f32 v[174:175], v[78:79], v[78:79]
    v_pk_fma_f32 v[160:161], v[160:161], s[10:11], v[88:89] op_sel_hi:[1,0,0]
    v_pk_fma_f32 v[162:163], v[162:163], s[10:11], v[88:89] op_sel_hi:[1,0,0]
    v_pk_fma_f32 v[164:165], v[164:165], s[10:11], v[88:89] op_sel_hi:[1,0,0]
    v_pk_fma_f32 v[166:167], v[166:167], s[10:11], v[88:89] op_sel_hi:[1,0,0]
    v_pk_fma_f32 v[168:169], v[168:169], s[10:11], v[88:89] op_sel_hi:[1,0,0]
    v_pk_fma_f32 v[170:171], v[170:171], s[10:11], v[88:89] op_sel_hi:[1,0,0]
    v_pk_fma_f32 v[172:173], v[172:173], s[10:11], v[88:89] op_sel_hi:[1,0,0]
    v_pk_fma_f32 v[174:175], v[174:175], s[10:11], v[88:89] op_sel_hi:[1,0,0]
    v_pk_mul_f32 v[160:161], v[160:161], v[64:65]
    v_pk_mul_f32 v[162:163], v[162:163], v[66:67]
L_pl_G_5:
    s_cbranch_execz L_wret
    v_pk_mul_f32 v[164:165], v[164:165], v[68:69]
    v_pk_mul_f32 v[166:167], v[166:167], v[70:71]
    v_pk_mul_f32 v[168:169], v[168:169], v[72:73]
    v_pk_mul_f32 v[170:171], v[170:171], v[74:75]
    v_pk_mul_f32 v[172:173], v[172:173], v[76:77]
    v_pk_mul_f32 v[174:175], v[174:175], v[78:79]
    v_exp_f32 v160, v160
    v_exp_f32 v161, v161
    v_exp_f32 v162, v162
    v_exp_f32 v163, v163
    v_exp_f32 v164, v164
    v_exp_f32 v165, v165
    v_exp_f32 v166, v166
    v_exp_f32 v167, v167
    v_exp_f32 v168, v168
    v_exp_f32 v169, v169
    v_exp_f32 v170, v170
    v_exp_f32 v171, v171
    v_exp_f32 v172, v172
    v_exp_f32 v173, v173
    v_exp_f32 v174, v174
    v_exp_f32 v175, v175
    v_pk_add_f32 v[160:161], v[160:161], 1.0 op_sel_hi:[1,0]
    v_pk_add_f32 v[162:163], v[162:163], 1.0 op_sel_hi:[1,0]
    v_pk_add_f32 v[164:165], v[164:165], 1.0 op_sel_hi:[1,0]
    v_pk_add_f32 v[166:167], v[166:167], 1.0 op_sel_hi:[1,0]
    v_pk_add_f32 v[168:169], v[168:169], 1.0 op_sel_hi:[1,0]
    v_pk_add_f32 v[170:171], v[170:171], 1.0 op_sel_hi:[1,0]
    v_pk_add_f32 v[172:173], v[172:173], 1.0 op_sel_hi:[1,0]
    v_pk_add_f32 v[174:175], v[174:175], 1.0 op_sel_hi:[1,0]
    v_rcp_f32 v160, v160
    v_rcp_f32 v161, v161
    v_rcp_f32 v162, v162
    v_rcp_f32 v163, v163
    v_rcp_f32 v164, v164
    v_rcp_f32 v165, v165
    v_rcp_f32 v166, v166
    v_rcp_f32 v167, v167
    v_rcp_f32 v168, v168
    v_rcp_f32 v169, v169
    v_rcp_f32 v170, v170
    v_rcp_f32 v171, v171
    v_rcp_f32 v172, v172
    v_rcp_f32 v173, v173
    v_rcp_f32 v174, v174
    v_rcp_f32 v175, v175
    v_pk_mul_f32 v[64:65], v[64:65], v[160:161]
    v_pk_mul_f32 v[66:67], v[66:67], v[162:163]
    v_pk_mul_f32 v[68:69], v[68:69], v[164:165]
    v_pk_mul_f32 v[70:71], v[70:71], v[166:167]
    v_pk_mul_f32 v[72:73], v[72:73], v[168:169]
    v_pk_mul_f32 v[74:75], v[74:75], v[170:171]
    v_pk_mul_f32 v[76:77], v[76:77], v[172:173]
    v_pk_mul_f32 v[78:79], v[78:79], v[174:175]
    v_cvt_pk_bf16_f32 v112, v64, v65
    v_cvt_pk_bf16_f32 v113, v66, v67
    v_cvt_pk_bf16_f32 v114, v68, v69
    v_cvt_pk_bf16_f32 v115, v70, v71
    v_cvt_pk_bf16_f32 v116, v72, v73
    v_cvt_pk_bf16_f32 v117, v74, v75
    v_cvt_pk_bf16_f32 v118, v76, v77
    v_cvt_pk_bf16_f32 v119, v78, v79
    buffer_store_dwordx4 v[112:115], v244, s[44:47], s9 offen sc1
    buffer_store_dwordx4 v[116:119], v245, s[44:47], s9 offen sc1
    s_waitcnt vmcnt(0)
    s_barrier
    buffer_store_dword v249, v17, s[44:47], 0 offen sc1
    ds_read_b64_tr_b16 a[64:65], v10 offset:49152
    s_add_u32 m0, s73, 32768
    s_lshl_b32 s14, s94, 18
    ds_read_b64_tr_b16 a[66:67], v10 offset:51200
    ds_read_b64_tr_b16 a[72:73], v10 offset:53248
    ds_read_b64_tr_b16 a[74:75], v10 offset:55296
    ds_read_b64_tr_b16 a[68:69], v11 offset:49152
    buffer_load_dwordx4 v4, s[52:55], s14 offen offset:0 lds
    ds_read_b64_tr_b16 a[70:71], v11 offset:51200
    ds_read_b64_tr_b16 a[76:77], v11 offset:53248
    ds_read_b64_tr_b16 a[78:79], v11 offset:55296
    v_add_u32 v10, 65536, v10
    ds_read_b64_tr_b16 a[80:81], v10 offset:0
    ds_read_b64_tr_b16 a[82:83], v10 offset:2048
    buffer_load_dwordx4 v5, s[52:55], s14 offen offset:1024 lds
    ds_read_b64_tr_b16 a[88:89], v10 offset:4096
    ds_read_b64_tr_b16 a[90:91], v10 offset:6144
    v_add_u32 v11, 65536, v11
    ds_read_b64_tr_b16 a[84:85], v11 offset:0
    ds_read_b64_tr_b16 a[86:87], v11 offset:2048
    ds_read_b64_tr_b16 a[92:93], v11 offset:4096
    buffer_load_dwordx4 v6, s[52:55], s14 offen offset:2048 lds
    ds_read_b64_tr_b16 a[94:95], v11 offset:6144
    v_add_u32 v10, -65536, v10
    ds_read_b64_tr_b16 a[96:97], v10 offset:0
    ds_read_b64_tr_b16 a[98:99], v10 offset:2048
    ds_read_b64_tr_b16 a[104:105], v10 offset:4096
    ds_read_b64_tr_b16 a[106:107], v10 offset:6144
    buffer_load_dwordx4 v7, s[52:55], s14 offen offset:3072 lds
    v_add_u32 v11, -65536, v11
    ds_read_b64_tr_b16 a[100:101], v11 offset:0
    ds_read_b64_tr_b16 a[102:103], v11 offset:2048
    ds_read_b64_tr_b16 a[108:109], v11 offset:4096
    ds_read_b64_tr_b16 a[110:111], v11 offset:6144
    ds_read_b64_tr_b16 a[112:113], v10 offset:16384
    s_add_u32 m0, s73, 81920
    s_lshl_b32 s14, s95, 18
    ds_read_b64_tr_b16 a[114:115], v10 offset:18432
    ds_read_b64_tr_b16 a[120:121], v10 offset:20480
    ds_read_b64_tr_b16 a[122:123], v10 offset:22528
    ds_read_b64_tr_b16 a[116:117], v11 offset:16384
    buffer_load_dwordx4 v4, s[52:55], s14 offen offset:0 lds
    ds_read_b64_tr_b16 a[118:119], v11 offset:18432
    ds_read_b64_tr_b16 a[124:125], v11 offset:20480
    ds_read_b64_tr_b16 a[126:127], v11 offset:22528
    v_add_u32 v10, 131072, v10
    ds_read_b64_tr_b16 a[128:129], v10 offset:0
    ds_read_b64_tr_b16 a[130:131], v10 offset:2048
    buffer_load_dwordx4 v5, s[52:55], s14 offen offset:1024 lds
    ds_read_b64_tr_b16 a[136:137], v10 offset:4096
    ds_read_b64_tr_b16 a[138:139], v10 offset:6144
    v_add_u32 v11, 131072, v11
    ds_read_b64_tr_b16 a[132:133], v11 offset:0
    ds_read_b64_tr_b16 a[134:135], v11 offset:2048
    ds_read_b64_tr_b16 a[140:141], v11 offset:4096
    buffer_load_dwordx4 v6, s[52:55], s14 offen offset:2048 lds
    ds_read_b64_tr_b16 a[142:143], v11 offset:6144
    ds_read_b64_tr_b16 a[144:145], v10 offset:16384
    ds_read_b64_tr_b16 a[146:147], v10 offset:18432
    ds_read_b64_tr_b16 a[152:153], v10 offset:20480
    ds_read_b64_tr_b16 a[154:155], v10 offset:22528
    buffer_load_dwordx4 v7, s[52:55], s14 offen offset:3072 lds
    ds_read_b64_tr_b16 a[148:149], v11 offset:16384
    ds_read_b64_tr_b16 a[150:151], v11 offset:18432
    ds_read_b64_tr_b16 a[156:157], v11 offset:20480
    ds_read_b64_tr_b16 a[158:159], v11 offset:22528
    s_bitcmp1_b32 s3, 1
    s_cselect_b32 s18, s85, s84
    s_mul_i32 s18, s18, 139264
    s_cselect_b32 s19, s87, s86
    s_mul_i32 s19, s19, 139264
    s_cselect_b32 s20, s89, s88
    s_mul_i32 s20, s20, 139264
    s_cselect_b32 s21, s91, s90
    s_mul_i32 s21, s21, 139264
    s_cselect_b32 s22, s93, s92
    s_mul_i32 s22, s22, 139264
    s_cselect_b32 s23, s95, s94
    s_mul_i32 s23, s23, 139264
    s_cselect_b32 s24, s97, s96
    s_mul_i32 s24, s24, 139264
    s_cselect_b32 s25, s99, s98
    s_mul_i32 s25, s25, 139264
    s_cselect_b32 s26, s101, s100
    s_mul_i32 s26, s26, 139264
    s_waitcnt lgkmcnt(0)
    s_barrier
    s_add_u32 m0, s73, 0
    s_lshl_b32 s14, s96, 18
    buffer_load_dwordx4 v4, s[52:55], s14 offen offset:0 lds
    buffer_load_dwordx4 v5, s[52:55], s14 offen offset:1024 lds
    buffer_load_dwordx4 v6, s[52:55], s14 offen offset:2048 lds
    buffer_load_dwordx4 v7, s[52:55], s14 offen offset:3072 lds
    s_add_u32 m0, s73, 16384
    s_lshl_b32 s14, s97, 18
    buffer_load_dwordx4 v4, s[52:55], s14 offen offset:0 lds
    buffer_load_dwordx4 v5, s[52:55], s14 offen offset:1024 lds
    buffer_load_dwordx4 v6, s[52:55], s14 offen offset:2048 lds
    buffer_load_dwordx4 v7, s[52:55], s14 offen offset:3072 lds
    v_mov_b32 v16, 0
    buffer_atomic_add v16, v15, s[44:47], 0 offen sc0 sc1
    s_add_u32 m0, s73, 49152
    s_lshl_b32 s14, s98, 18
    buffer_load_dwordx4 v4, s[52:55], s14 offen offset:0 lds
    buffer_load_dwordx4 v5, s[52:55], s14 offen offset:1024 lds
    buffer_load_dwordx4 v6, s[52:55], s14 offen offset:2048 lds
    buffer_load_dwordx4 v7, s[52:55], s14 offen offset:3072 lds
    s_add_u32 m0, s73, 65536
    s_lshl_b32 s14, s99, 18
    buffer_load_dwordx4 v4, s[52:55], s14 offen offset:0 lds
    buffer_load_dwordx4 v5, s[52:55], s14 offen offset:1024 lds
    buffer_load_dwordx4 v6, s[52:55], s14 offen offset:2048 lds
    buffer_load_dwordx4 v7, s[52:55], s14 offen offset:3072 lds
L_DG:
    s_waitcnt vmcnt(8)
    v_cmp_ne_u32 vcc, v13, v16
    s_cbranch_vccnz L_rs_p2G
L_ok_p2G:
    s_barrier
    s_add_u32 m0, s73, 97536
    s_nop 0
    buffer_load_dwordx4 v23, s[44:47], s18 offen offset:768 sc1 lds
    s_add_u32 m0, s73, 99328
    s_nop 0
    buffer_load_dwordx4 v20, s[44:47], s18 offen offset:0 sc1 lds
    s_add_u32 m0, s73, 99840
    s_nop 0
    buffer_load_dwordx4 v20, s[44:47], s18 offen offset:512 sc1 lds
    s_add_u32 m0, s73, 100608
    s_nop 0
    buffer_load_dwordx4 v23, s[44:47], s19 offen offset:768 sc1 lds
    s_add_u32 m0, s73, 114688
    s_nop 0
    buffer_load_dwordx4 v20, s[44:47], s19 offen offset:0 sc1 lds
    s_add_u32 m0, s73, 115200
    s_nop 0
    buffer_load_dwordx4 v20, s[44:47], s19 offen offset:512 sc1 lds
    s_add_u32 m0, s73, 115968
    s_nop 0
    buffer_load_dwordx4 v23, s[44:47], s20 offen offset:768 sc1 lds
    s_add_u32 m0, s73, 117760
    s_nop 0
    buffer_load_dwordx4 v20, s[44:47], s20 offen offset:0 sc1 lds
    v_mov_b32 v195, s68
    v_mov_b32 v199, s68
    v_mov_b32 v202, s68
    v_mov_b32 v203, s68
    s_waitcnt vmcnt(4)
    s_barrier
    ds_read_b128 v[104:107], v14 offset:0
    ds_read_b128 v[108:111], v14 offset:4096
    ds_read_b128 v[112:115], v14 offset:8192
    ds_read_b128 v[116:119], v14 offset:12288
    s_waitcnt lgkmcnt(2)
    v_mfma_f32_16x16x32_bf16 v[32:35], v[104:107], a[0:3], 0
    s_add_u32 m0, s73, 130560
    v_mfma_f32_16x16x32_bf16 v[32:35], v[108:111], a[8:11], v[32:35]
    buffer_load_dwordx4 v20, s[44:47], s20 offen offset:512 sc1 lds
    s_waitcnt lgkmcnt(0)
    v_mfma_f32_16x16x32_bf16 v[32:35], v[112:115], a[16:19], v[32:35]
    ds_read_b128 v[120:123], v14 offset:1024
    v_mfma_f32_16x16x32_bf16 v[32:35], v[116:119], a[24:27], v[32:35]
    ds_read_b128 v[124:127], v14 offset:5120
    v_mfma_f32_16x16x32_bf16 v[36:39], v[116:119], a[28:31], 0
    ds_read_b128 v[128:131], v14 offset:9216
    v_mfma_f32_16x16x32_bf16 v[36:39], v[112:115], a[20:23], v[36:39]
    ds_read_b128 v[132:135], v14 offset:13312
    v_mfma_f32_16x16x32_bf16 v[36:39], v[108:111], a[12:15], v[36:39]
    s_add_u32 m0, s73, 131328
    v_mfma_f32_16x16x32_bf16 v[36:39], v[104:107], a[4:7], v[36:39]
    buffer_load_dwordx4 v23, s[44:47], s21 offen offset:768 sc1 lds
    s_waitcnt lgkmcnt(2)
    v_mfma_f32_16x16x32_bf16 v[44:47], v[120:123], a[4:7], 0
    s_add_u32 m0, s73, 133120
    v_mfma_f32_16x16x32_bf16 v[44:47], v[124:127], a[12:15], v[44:47]
    buffer_load_dwordx4 v20, s[44:47], s21 offen offset:0 sc1 lds
    s_waitcnt lgkmcnt(0)
    v_mfma_f32_16x16x32_bf16 v[44:47], v[128:131], a[20:23], v[44:47]
    ds_read_b128 v[104:107], v14 offset:2048
    v_mfma_f32_16x16x32_bf16 v[44:47], v[132:135], a[28:31], v[44:47]
    ds_read_b128 v[108:111], v14 offset:6144
    v_mfma_f32_16x16x32_bf16 v[40:43], v[132:135], a[24:27], 0
    ds_read_b128 v[112:115], v14 offset:10240
    v_mfma_f32_16x16x32_bf16 v[40:43], v[128:131], a[16:19], v[40:43]
    ds_read_b128 v[116:119], v14 offset:14336
    v_mfma_f32_16x16x32_bf16 v[40:43], v[124:127], a[8:11], v[40:43]
    s_add_u32 m0, s73, 133632
    v_mfma_f32_16x16x32_bf16 v[40:43], v[120:123], a[0:3], v[40:43]
    buffer_load_dwordx4 v20, s[44:47], s21 offen offset:512 sc1 lds
    s_waitcnt lgkmcnt(2)
    v_mfma_f32_16x16x32_bf16 v[48:51], v[104:107], a[0:3], 0
    s_add_u32 m0, s73, 146688
    v_mfma_f32_16x16x32_bf16 v[48:51], v[108:111], a[8:11], v[48:51]
    buffer_load_dwordx4 v23, s[44:47], s22 offen offset:768 sc1 lds
    s_waitcnt lgkmcnt(0)
    v_mfma_f32_16x16x32_bf16 v[48:51], v[112:115], a[16:19], v[48:51]
    ds_read_b128 v[120:123], v14 offset:3072
    v_mfma_f32_16x16x32_bf16 v[48:51], v[116:119], a[24:27], v[48:51]
    ds_read_b128 v[124:127], v14 offset:7168
    v_mfma_f32_16x16x32_bf16 v[52:55], v[116:119], a[28:31], 0
    ds_read_b128 v[128:131], v14 offset:11264
    v_mfma_f32_16x16x32_bf16 v[52:55], v[112:115], a[20:23], v[52:55]
    ds_read_b128 v[132:135], v14 offset:15360
    v_mfma_f32_16x16x32_bf16 v[52:55], v[108:111], a[12:15], v[52:55]
    s_add_u32 m0, s73, 148480
    v_mfma_f32_16x16x32_bf16 v[52:55], v[104:107], a[4:7], v[52:55]
    buffer_load_dwordx4 v20, s[44:47], s22 offen offset:0 sc1 lds
    s_waitcnt lgkmcnt(2)
    v_mfma_f32_16x16x32_bf16 v[36:39], v[120:123], a[36:39], v[36:39]
    s_add_u32 m0, s73, 148992
    v_mfma_f32_16x16x32_bf16 v[36:39], v[124:127], a[44:47], v[36:39]
    buffer_load_dwordx4 v20, s[44:47], s22 offen offset:512 sc1 lds
    s_waitcnt lgkmcnt(0)
    v_mfma_f32_16x16x32_bf16 v[36:39], v[128:131], a[52:55], v[36:39]
    s_waitcnt vmcnt(7)
    s_barrier
    v_mfma_f32_16x16x32_bf16 v[36:39], v[132:135], a[60:63], v[36:39]
    ds_read_b128 v[104:107], v14 offset:16384
    v_add_u32 v10, -131072, v10
    v_mfma_f32_16x16x32_bf16 v[32:35], v[132:135], a[56:59], v[32:35]
    ds_read_b128 v[108:111], v14 offset:20480
    v_mfma_f32_16x16x32_bf16 v[32:35], v[128:131], a[48:51], v[32:35]
    ds_read_b128 v[112:115], v14 offset:24576
    ds_read_b64_tr_b16 a[160:161], v10 offset:32768
    v_mfma_f32_16x16x32_bf16 v[32:35], v[124:127], a[40:43], v[32:35]
    ds_read_b128 v[116:119], v14 offset:28672
    s_add_u32 m0, s73, 149760
    v_mfma_f32_16x16x32_bf16 v[32:35], v[120:123], a[32:35], v[32:35]
    buffer_load_dwordx4 v23, s[44:47], s23 offen offset:768 sc1 lds
    ds_read_b64_tr_b16 a[162:163], v10 offset:34816
    s_waitcnt lgkmcnt(4)
    v_mfma_f32_16x16x32_bf16 v[40:43], v[104:107], a[32:35], v[40:43]
    s_add_u32 m0, s73, 98304
    ds_read_b64_tr_b16 a[168:169], v10 offset:36864
    v_mfma_f32_16x16x32_bf16 v[40:43], v[108:111], a[40:43], v[40:43]
    buffer_load_dwordx4 v20, s[44:47], s23 offen offset:0 sc1 lds
    ds_read_b64_tr_b16 a[170:171], v10 offset:38912
    s_waitcnt lgkmcnt(3)
    v_mfma_f32_16x16x32_bf16 v[40:43], v[112:115], a[48:51], v[40:43]
    ds_read_b128 v[120:123], v14 offset:17408
    v_mfma_f32_16x16x32_bf16 v[40:43], v[116:119], a[56:59], v[40:43]
    ds_read_b128 v[124:127], v14 offset:21504
    v_add_u32 v11, -131072, v11
    v_mfma_f32_16x16x32_bf16 v[44:47], v[116:119], a[60:63], v[44:47]
    ds_read_b128 v[128:131], v14 offset:25600
    v_mfma_f32_16x16x32_bf16 v[44:47], v[112:115], a[52:55], v[44:47]
    ds_read_b128 v[132:135], v14 offset:29696
    v_mfma_f32_16x16x32_bf16 v[44:47], v[108:111], a[44:47], v[44:47]
    s_add_u32 m0, s73, 98816
    ds_read_b64_tr_b16 a[164:165], v11 offset:32768
    v_mfma_f32_16x16x32_bf16 v[44:47], v[104:107], a[36:39], v[44:47]
    buffer_load_dwordx4 v20, s[44:47], s23 offen offset:512 sc1 lds
    ds_read_b64_tr_b16 a[166:167], v11 offset:34816
    s_waitcnt lgkmcnt(4)
    v_mfma_f32_16x16x32_bf16 v[52:55], v[120:123], a[36:39], v[52:55]
    s_add_u32 m0, s73, 99584
    ds_read_b64_tr_b16 a[172:173], v11 offset:36864
    v_mfma_f32_16x16x32_bf16 v[52:55], v[124:127], a[44:47], v[52:55]
    buffer_load_dwordx4 v23, s[44:47], s24 offen offset:768 sc1 lds
    ds_read_b64_tr_b16 a[174:175], v11 offset:38912
    s_waitcnt lgkmcnt(4)
    v_mfma_f32_16x16x32_bf16 v[52:55], v[128:131], a[52:55], v[52:55]
    ds_read_b128 v[104:107], v14 offset:18432
    v_mfma_f32_16x16x32_bf16 v[52:55], v[132:135], a[60:63], v[52:55]
    ds_read_b128 v[108:111], v14 offset:22528
    v_add_u32 v10, 65536, v10
    v_mfma_f32_16x16x32_bf16 v[48:51], v[132:135], a[56:59], v[48:51]
    ds_read_b128 v[112:115], v14 offset:26624
    v_mfma_f32_16x16x32_bf16 v[48:51], v[128:131], a[48:51], v[48:51]
    ds_read_b128 v[116:119], v14 offset:30720
    v_mfma_f32_16x16x32_bf16 v[48:51], v[124:127], a[40:43], v[48:51]
    s_add_u32 m0, s73, 101376
    ds_read_b64_tr_b16 a[176:177], v10 offset:16384
    v_mfma_f32_16x16x32_bf16 v[48:51], v[120:123], a[32:35], v[48:51]
    buffer_load_dwordx4 v20, s[44:47], s24 offen offset:0 sc1 lds
    ds_read_b64_tr_b16 a[178:179], v10 offset:18432
    s_waitcnt lgkmcnt(4)
    v_mfma_f32_16x16x32_bf16 v[32:35], v[104:107], a[64:67], v[32:35]
    ds_read_b64_tr_b16 a[184:185], v10 offset:20480
    v_mfma_f32_16x16x32_bf16 v[32:35], v[108:111], a[72:75], v[32:35]
    ds_read_b64_tr_b16 a[186:187], v10 offset:22528
    s_waitcnt lgkmcnt(4)
    v_mfma_f32_16x16x32_bf16 v[32:35], v[112:115], a[80:83], v[32:35]
    ds_read_b128 v[120:123], v14 offset:19456
    v_mfma_f32_16x16x32_bf16 v[32:35], v[116:119], a[88:91], v[32:35]
    ds_read_b128 v[124:127], v14 offset:23552
    v_add_u32 v11, 65536, v11
    v_mfma_f32_16x16x32_bf16 v[36:39], v[116:119], a[92:95], v[36:39]
    ds_read_b128 v[128:131], v14 offset:27648
    v_mfma_f32_16x16x32_bf16 v[36:39], v[112:115], a[84:87], v[36:39]
    ds_read_b128 v[132:135], v14 offset:31744
    v_mfma_f32_16x16x32_bf16 v[36:39], v[108:111], a[76:79], v[36:39]
    ds_read_b64_tr_b16 a[180:181], v11 offset:16384
    v_mfma_f32_16x16x32_bf16 v[36:39], v[104:107], a[68:71], v[36:39]
    ds_read_b64_tr_b16 a[182:183], v11 offset:18432
    s_waitcnt lgkmcnt(4)
    v_mfma_f32_16x16x32_bf16 v[44:47], v[120:123], a[68:71], v[44:47]
    ds_read_b64_tr_b16 a[188:189], v11 offset:20480
    v_mfma_f32_16x16x32_bf16 v[44:47], v[124:127], a[76:79], v[44:47]
    ds_read_b64_tr_b16 a[190:191], v11 offset:22528
    s_waitcnt lgkmcnt(4)
    v_mfma_f32_16x16x32_bf16 v[44:47], v[128:131], a[84:87], v[44:47]
    s_waitcnt vmcnt(8) lgkmcnt(0)
    s_barrier
    v_mfma_f32_16x16x32_bf16 v[44:47], v[132:135], a[92:95], v[44:47]
    ds_read_b128 v[104:107], v14 offset:32768
    s_lshl_b32 s14, s100, 18
    s_add_u32 m0, s73, 32768
    v_add_u32 v10, -65536, v10
    v_mfma_f32_16x16x32_bf16 v[40:43], v[132:135], a[88:91], v[40:43]
    ds_read_b128 v[108:111], v14 offset:36864
    buffer_load_dwordx4 v4, s[52:55], s14 offen offset:0 lds
    v_mfma_f32_16x16x32_bf16 v[40:43], v[128:131], a[80:83], v[40:43]
    ds_read_b128 v[112:115], v14 offset:40960
    ds_read_b64_tr_b16 a[192:193], v10 offset:0
    v_mfma_f32_16x16x32_bf16 v[40:43], v[124:127], a[72:75], v[40:43]
    ds_read_b128 v[116:119], v14 offset:45056
    v_mfma_f32_16x16x32_bf16 v[40:43], v[120:123], a[64:67], v[40:43]
    ds_read_b64_tr_b16 a[194:195], v10 offset:2048
    s_waitcnt lgkmcnt(4)
    v_mfma_f32_16x16x32_bf16 v[48:51], v[104:107], a[64:67], v[48:51]
    s_add_u32 m0, s73, 114176
    ds_read_b64_tr_b16 a[200:201], v10 offset:4096
    v_mfma_f32_16x16x32_bf16 v[48:51], v[108:111], a[72:75], v[48:51]
    buffer_load_dwordx4 v20, s[44:47], s24 offen offset:512 sc1 lds
    ds_read_b64_tr_b16 a[202:203], v10 offset:6144
    s_waitcnt lgkmcnt(3)
    v_mfma_f32_16x16x32_bf16 v[48:51], v[112:115], a[80:83], v[48:51]
    ds_read_b128 v[120:123], v14 offset:33792
    s_add_u32 m0, s73, 32768
    v_lshrrev_b32 v30, 2, v26
    v_mfma_f32_16x16x32_bf16 v[48:51], v[116:119], a[88:91], v[48:51]
    ds_read_b128 v[124:127], v14 offset:37888
    buffer_load_dwordx4 v5, s[52:55], s14 offen offset:1024 lds
    v_mfma_f32_16x16x32_bf16 v[52:55], v[116:119], a[92:95], v[52:55]
    ds_read_b128 v[128:131], v14 offset:41984
    v_add_u32 v11, -65536, v11
    v_mfma_f32_16x16x32_bf16 v[52:55], v[112:115], a[84:87], v[52:55]
    ds_read_b128 v[132:135], v14 offset:46080
    v_mfma_f32_16x16x32_bf16 v[52:55], v[108:111], a[76:79], v[52:55]
    s_add_u32 m0, s73, 114944
    ds_read_b64_tr_b16 a[196:197], v11 offset:0
    v_mfma_f32_16x16x32_bf16 v[52:55], v[104:107], a[68:71], v[52:55]
    buffer_load_dwordx4 v23, s[44:47], s25 offen offset:768 sc1 lds
    ds_read_b64_tr_b16 a[198:199], v11 offset:2048
    s_waitcnt lgkmcnt(4)
    v_mfma_f32_16x16x32_bf16 v[36:39], v[120:123], a[100:103], v[36:39]
    s_add_u32 m0, s73, 116736
    ds_read_b64_tr_b16 a[204:205], v11 offset:4096
    v_mfma_f32_16x16x32_bf16 v[36:39], v[124:127], a[108:111], v[36:39]
    buffer_load_dwordx4 v20, s[44:47], s25 offen offset:0 sc1 lds
    ds_read_b64_tr_b16 a[206:207], v11 offset:6144
    s_waitcnt lgkmcnt(4)
    v_mfma_f32_16x16x32_bf16 v[36:39], v[128:131], a[116:119], v[36:39]
    ds_read_b128 v[104:107], v14 offset:34816
    s_add_u32 m0, s73, 32768
    v_lshrrev_b32 v31, 2, v18
    v_mfma_f32_16x16x32_bf16 v[36:39], v[132:135], a[124:127], v[36:39]
    ds_read_b128 v[108:111], v14 offset:38912
    buffer_load_dwordx4 v6, s[52:55], s14 offen offset:2048 lds
    v_mfma_f32_16x16x32_bf16 v[32:35], v[132:135], a[120:123], v[32:35]
    ds_read_b128 v[112:115], v14 offset:43008
    v_mfma_f32_16x16x32_bf16 v[32:35], v[128:131], a[112:115], v[32:35]
    ds_read_b128 v[116:119], v14 offset:47104
    v_mfma_f32_16x16x32_bf16 v[32:35], v[124:127], a[104:107], v[32:35]
    s_add_u32 m0, s73, 117248
    ds_read_b64_tr_b16 a[208:209], v10 offset:16384
    v_mfma_f32_16x16x32_bf16 v[32:35], v[120:123], a[96:99], v[32:35]
    buffer_load_dwordx4 v20, s[44:47], s25 offen offset:512 sc1 lds
    ds_read_b64_tr_b16 a[210:211], v10 offset:18432
    s_waitcnt lgkmcnt(4)
    v_mfma_f32_16x16x32_bf16 v[40:43], v[104:107], a[96:99], v[40:43]
    ds_read_b64_tr_b16 a[216:217], v10 offset:20480
    buffer_load_ushort v102, v30, s[60:63], 0 offen offset:0
    s_add_u32 m0, s73, 32768
    v_mfma_f32_16x16x32_bf16 v[40:43], v[108:111], a[104:107], v[40:43]
    ds_read_b64_tr_b16 a[218:219], v10 offset:22528
    buffer_load_dwordx4 v7, s[52:55], s14 offen offset:3072 lds
    s_waitcnt lgkmcnt(4)
    v_mfma_f32_16x16x32_bf16 v[40:43], v[112:115], a[112:115], v[40:43]
    ds_read_b128 v[120:123], v14 offset:35840
    v_mfma_f32_16x16x32_bf16 v[40:43], v[116:119], a[120:123], v[40:43]
    ds_read_b128 v[124:127], v14 offset:39936
    v_mfma_f32_16x16x32_bf16 v[44:47], v[116:119], a[124:127], v[44:47]
    ds_read_b128 v[128:131], v14 offset:44032
    v_mfma_f32_16x16x32_bf16 v[44:47], v[112:115], a[116:119], v[44:47]
    ds_read_b128 v[132:135], v14 offset:48128
    v_mfma_f32_16x16x32_bf16 v[44:47], v[108:111], a[108:111], v[44:47]
    ds_read_b64_tr_b16 a[212:213], v11 offset:16384
    buffer_load_ushort v103, v30, s[60:63], 0 offen offset:32
    v_mfma_f32_16x16x32_bf16 v[44:47], v[104:107], a[100:103], v[44:47]
    ds_read_b64_tr_b16 a[214:215], v11 offset:18432
    s_waitcnt lgkmcnt(4)
    v_mfma_f32_16x16x32_bf16 v[52:55], v[120:123], a[100:103], v[52:55]
    ds_read_b64_tr_b16 a[220:221], v11 offset:20480
    v_mfma_f32_16x16x32_bf16 v[52:55], v[124:127], a[108:111], v[52:55]
    ds_read_b64_tr_b16 a[222:223], v11 offset:22528
    s_waitcnt lgkmcnt(4)
    v_mfma_f32_16x16x32_bf16 v[52:55], v[128:131], a[116:119], v[52:55]
    s_waitcnt vmcnt(14) lgkmcnt(0)
    s_barrier
    v_mfma_f32_16x16x32_bf16 v[52:55], v[132:135], a[124:127], v[52:55]
    ds_read_b128 v[104:107], v14 offset:49152
    s_lshl_b32 s14, s101, 18
    ds_read_b64_tr_b16 a[224:225], v10 offset:49152
    s_add_u32 m0, s73, 81920
    v_mfma_f32_16x16x32_bf16 v[48:51], v[132:135], a[120:123], v[48:51]
    ds_read_b128 v[108:111], v14 offset:53248
    buffer_load_dwordx4 v4, s[52:55], s14 offen offset:0 lds
    v_mfma_f32_16x16x32_bf16 v[48:51], v[128:131], a[112:115], v[48:51]
    ds_read_b128 v[112:115], v14 offset:57344
    buffer_load_ushort v27, v31, s[60:63], 0 offen offset:0
    v_mfma_f32_16x16x32_bf16 v[48:51], v[124:127], a[104:107], v[48:51]
    ds_read_b128 v[116:119], v14 offset:61440
    v_mfma_f32_16x16x32_bf16 v[48:51], v[120:123], a[96:99], v[48:51]
    ds_read_b64_tr_b16 a[226:227], v10 offset:51200
    s_waitcnt lgkmcnt(3)
    v_mfma_f32_16x16x32_bf16 v[32:35], v[104:107], a[128:131], v[32:35]
    s_add_u32 m0, s73, 130304
    ds_read_b64_tr_b16 a[232:233], v10 offset:53248
    v_mfma_f32_16x16x32_bf16 v[32:35], v[108:111], a[136:139], v[32:35]
    buffer_load_dwordx4 v23, s[44:47], s26 offen offset:768 sc1 lds
    ds_read_b64_tr_b16 a[234:235], v10 offset:55296
    s_waitcnt lgkmcnt(3)
    v_mfma_f32_16x16x32_bf16 v[32:35], v[112:115], a[144:147], v[32:35]
    ds_read_b128 v[120:123], v14 offset:50176
    s_add_u32 m0, s73, 81920
    v_mfma_f32_16x16x32_bf16 v[32:35], v[116:119], a[152:155], v[32:35]
    ds_read_b128 v[124:127], v14 offset:54272
    buffer_load_dwordx4 v5, s[52:55], s14 offen offset:1024 lds
    v_mfma_f32_16x16x32_bf16 v[36:39], v[116:119], a[156:159], v[36:39]
    ds_read_b128 v[128:131], v14 offset:58368
    v_mfma_f32_16x16x32_bf16 v[36:39], v[112:115], a[148:151], v[36:39]
    ds_read_b128 v[132:135], v14 offset:62464
    v_mfma_f32_16x16x32_bf16 v[36:39], v[108:111], a[140:143], v[36:39]
    s_add_u32 m0, s73, 132096
    ds_read_b64_tr_b16 a[228:229], v11 offset:49152
    v_mfma_f32_16x16x32_bf16 v[36:39], v[104:107], a[132:135], v[36:39]
    buffer_load_dwordx4 v20, s[44:47], s26 offen offset:0 sc1 lds
    ds_read_b64_tr_b16 a[230:231], v11 offset:51200
    s_waitcnt lgkmcnt(4)
    v_mfma_f32_16x16x32_bf16 v[44:47], v[120:123], a[132:135], v[44:47]
    ds_read_b64_tr_b16 a[236:237], v11 offset:53248
    buffer_load_dwordx4 v[88:91], v252, s[56:59], 0 offen
    s_add_u32 m0, s73, 132608
    v_mfma_f32_16x16x32_bf16 v[44:47], v[124:127], a[140:143], v[44:47]
    buffer_load_dwordx4 v20, s[44:47], s26 offen offset:512 sc1 lds
    ds_read_b64_tr_b16 a[238:239], v11 offset:55296
    s_waitcnt lgkmcnt(4)
    v_mfma_f32_16x16x32_bf16 v[44:47], v[128:131], a[148:151], v[44:47]
    ds_read_b128 v[104:107], v14 offset:51200
    s_add_u32 m0, s73, 81920
    v_add_u32 v10, 65536, v10
    v_mfma_f32_16x16x32_bf16 v[44:47], v[132:135], a[156:159], v[44:47]
    ds_read_b128 v[108:111], v14 offset:55296
    buffer_load_dwordx4 v6, s[52:55], s14 offen offset:2048 lds
    v_mfma_f32_16x16x32_bf16 v[40:43], v[132:135], a[152:155], v[40:43]
    ds_read_b128 v[112:115], v14 offset:59392
    v_mfma_f32_16x16x32_bf16 v[40:43], v[128:131], a[144:147], v[40:43]
    ds_read_b128 v[116:119], v14 offset:63488
    v_mfma_f32_16x16x32_bf16 v[40:43], v[124:127], a[136:139], v[40:43]
    s_add_u32 m0, s73, 134144
    ds_read_b64_tr_b16 a[240:241], v10 offset:0
    v_mfma_f32_16x16x32_bf16 v[40:43], v[120:123], a[128:131], v[40:43]
    buffer_load_dwordx4 v21, s[44:47], s18 offen offset:0 sc1 lds
    ds_read_b64_tr_b16 a[242:243], v10 offset:2048
    s_waitcnt lgkmcnt(4)
    v_mfma_f32_16x16x32_bf16 v[48:51], v[104:107], a[128:131], v[48:51]
    ds_read_b64_tr_b16 a[248:249], v10 offset:4096
    s_add_u32 m0, s73, 81920
    v_mfma_f32_16x16x32_bf16 v[48:51], v[108:111], a[136:139], v[48:51]
    ds_read_b64_tr_b16 a[250:251], v10 offset:6144
    buffer_load_dwordx4 v7, s[52:55], s14 offen offset:3072 lds
    s_waitcnt lgkmcnt(4)
    v_mfma_f32_16x16x32_bf16 v[48:51], v[112:115], a[144:147], v[48:51]
    ds_read_b128 v[120:123], v14 offset:52224
    v_add_u32 v11, 65536, v11
    v_mfma_f32_16x16x32_bf16 v[48:51], v[116:119], a[152:155], v[48:51]
    ds_read_b128 v[124:127], v14 offset:56320
    v_mfma_f32_16x16x32_bf16 v[52:55], v[116:119], a[156:159], v[52:55]
    ds_read_b128 v[128:131], v14 offset:60416
    v_mfma_f32_16x16x32_bf16 v[52:55], v[112:115], a[148:151], v[52:55]
    ds_read_b128 v[132:135], v14 offset:64512
    v_mfma_f32_16x16x32_bf16 v[52:55], v[108:111], a[140:143], v[52:55]
    ds_read_b64_tr_b16 a[244:245], v11 offset:0
    v_mfma_f32_16x16x32_bf16 v[52:55], v[104:107], a[132:135], v[52:55]
    ds_read_b64_tr_b16 a[246:247], v11 offset:2048
    s_waitcnt lgkmcnt(4)
    v_mfma_f32_16x16x32_bf16 v[36:39], v[120:123], a[164:167], v[36:39]
    ds_read_b64_tr_b16 a[252:253], v11 offset:4096
    buffer_load_dwordx4 v[92:95], v252, s[56:59], s40 offen
    v_mfma_f32_16x16x32_bf16 v[36:39], v[124:127], a[172:175], v[36:39]
    ds_read_b64_tr_b16 a[254:255], v11 offset:6144
    s_waitcnt lgkmcnt(4)
    v_mfma_f32_16x16x32_bf16 v[36:39], v[128:131], a[180:183], v[36:39]
    s_waitcnt vmcnt(12) lgkmcnt(0)
    s_barrier
    v_mfma_f32_16x16x32_bf16 v[36:39], v[132:135], a[188:191], v[36:39]
    ds_read_b128 v[104:107], v14 offset:0
    v_mfma_f32_16x16x32_bf16 v[32:35], v[132:135], a[184:187], v[32:35]
    ds_read_b128 v[108:111], v14 offset:4096
    v_add_u32 v10, -65536, v10
    v_mfma_f32_16x16x32_bf16 v[32:35], v[128:131], a[176:179], v[32:35]
    ds_read_b128 v[112:115], v14 offset:8192
    v_mfma_f32_16x16x32_bf16 v[32:35], v[124:127], a[168:171], v[32:35]
L_pl_G_6:
    s_cbranch_execz L_wret
    ds_read_b128 v[116:119], v14 offset:12288
    v_mfma_f32_16x16x32_bf16 v[32:35], v[120:123], a[160:163], v[32:35]
    ds_read_b64_tr_b16 v[220:221], v10 offset:32768
    s_waitcnt lgkmcnt(3)
    v_mfma_f32_16x16x32_bf16 v[40:43], v[104:107], a[160:163], v[40:43]
    s_add_u32 m0, s73, 146944
    v_mfma_f32_16x16x32_bf16 v[40:43], v[108:111], a[168:171], v[40:43]
    buffer_load_dwordx4 v21, s[44:47], s18 offen offset:512 sc1 lds
    ds_read_b64_tr_b16 v[222:223], v10 offset:34816
    s_waitcnt lgkmcnt(2)
    v_mfma_f32_16x16x32_bf16 v[40:43], v[112:115], a[176:179], v[40:43]
    ds_read_b128 v[120:123], v14 offset:1024
    v_mfma_f32_16x16x32_bf16 v[40:43], v[116:119], a[184:187], v[40:43]
    ds_read_b128 v[124:127], v14 offset:5120
    v_mfma_f32_16x16x32_bf16 v[44:47], v[116:119], a[188:191], v[44:47]
    ds_read_b128 v[128:131], v14 offset:9216
    v_mfma_f32_16x16x32_bf16 v[44:47], v[112:115], a[180:183], v[44:47]
    ds_read_b128 v[132:135], v14 offset:13312
    v_mfma_f32_16x16x32_bf16 v[44:47], v[108:111], a[172:175], v[44:47]
    s_add_u32 m0, s73, 148480
    ds_read_b64_tr_b16 v[228:229], v10 offset:36864
    v_mfma_f32_16x16x32_bf16 v[44:47], v[104:107], a[164:167], v[44:47]
    buffer_load_dwordx4 v21, s[44:47], s19 offen offset:0 sc1 lds
    s_waitcnt lgkmcnt(3)
    v_mfma_f32_16x16x32_bf16 v[52:55], v[120:123], a[164:167], v[52:55]
    ds_read_b64_tr_b16 v[230:231], v10 offset:38912
    buffer_load_dwordx2 v[142:143], v253, s[56:59], 0 offen
    s_add_u32 m0, s73, 148992
    v_mfma_f32_16x16x32_bf16 v[52:55], v[124:127], a[172:175], v[52:55]
    buffer_load_dwordx4 v21, s[44:47], s19 offen offset:512 sc1 lds
    s_waitcnt lgkmcnt(2)
    v_mfma_f32_16x16x32_bf16 v[52:55], v[128:131], a[180:183], v[52:55]
    ds_read_b128 v[104:107], v14 offset:2048
    v_mfma_f32_16x16x32_bf16 v[52:55], v[132:135], a[188:191], v[52:55]
    ds_read_b128 v[108:111], v14 offset:6144
    v_mfma_f32_16x16x32_bf16 v[48:51], v[132:135], a[184:187], v[48:51]
    ds_read_b128 v[112:115], v14 offset:10240
    v_add_u32 v11, -65536, v11
    v_mfma_f32_16x16x32_bf16 v[48:51], v[128:131], a[176:179], v[48:51]
    ds_read_b128 v[116:119], v14 offset:14336
    v_mfma_f32_16x16x32_bf16 v[48:51], v[124:127], a[168:171], v[48:51]
    s_add_u32 m0, s73, 150528
    v_mfma_f32_16x16x32_bf16 v[48:51], v[120:123], a[160:163], v[48:51]
    buffer_load_dwordx4 v21, s[44:47], s20 offen offset:0 sc1 lds
    ds_read_b64_tr_b16 v[224:225], v11 offset:32768
    s_waitcnt lgkmcnt(3)
    v_mfma_f32_16x16x32_bf16 v[32:35], v[104:107], a[192:195], v[32:35]
    v_mfma_f32_16x16x32_bf16 v[32:35], v[108:111], a[200:203], v[32:35]
    ds_read_b64_tr_b16 v[226:227], v11 offset:34816
    s_waitcnt vmcnt(14)
    s_waitcnt lgkmcnt(2)
    v_mfma_f32_16x16x32_bf16 v[32:35], v[112:115], a[208:211], v[32:35]
    ds_read_b128 v[120:123], v14 offset:3072
    v_mfma_f32_16x16x32_bf16 v[32:35], v[116:119], a[216:219], v[32:35]
    ds_read_b128 v[124:127], v14 offset:7168
    v_mfma_f32_16x16x32_bf16 v[36:39], v[116:119], a[220:223], v[36:39]
    ds_read_b128 v[128:131], v14 offset:11264
    v_lshlrev_b32 v72, 16, v102
    v_mfma_f32_16x16x32_bf16 v[36:39], v[112:115], a[212:215], v[36:39]
    ds_read_b128 v[132:135], v14 offset:15360
    v_mfma_f32_16x16x32_bf16 v[36:39], v[108:111], a[204:207], v[36:39]
    ds_read_b64_tr_b16 v[232:233], v11 offset:36864
    v_lshlrev_b32 v73, 16, v102
    v_mfma_f32_16x16x32_bf16 v[36:39], v[104:107], a[196:199], v[36:39]
    s_waitcnt lgkmcnt(3)
    v_mfma_f32_16x16x32_bf16 v[44:47], v[120:123], a[196:199], v[44:47]
    ds_read_b64_tr_b16 v[234:235], v11 offset:38912
    buffer_load_dwordx2 v[96:97], v26, s[44:47], s42 offen offset:0 sc1
    v_mfma_f32_16x16x32_bf16 v[44:47], v[124:127], a[204:207], v[44:47]
    v_lshlrev_b32 v74, 16, v102
    s_waitcnt lgkmcnt(2)
    v_mfma_f32_16x16x32_bf16 v[44:47], v[128:131], a[212:215], v[44:47]
    s_waitcnt vmcnt(7) lgkmcnt(0)
    s_barrier
    v_mfma_f32_16x16x32_bf16 v[44:47], v[132:135], a[220:223], v[44:47]
    ds_read_b128 v[104:107], v14 offset:16384
    v_lshlrev_b32 v75, 16, v102
    v_mfma_f32_16x16x32_bf16 v[40:43], v[132:135], a[216:219], v[40:43]
    ds_read_b128 v[108:111], v14 offset:20480
    v_add_u32 v10, 65536, v10
    v_mfma_f32_16x16x32_bf16 v[40:43], v[128:131], a[208:211], v[40:43]
    ds_read_b128 v[112:115], v14 offset:24576
    v_mfma_f32_16x16x32_bf16 v[40:43], v[124:127], a[200:203], v[40:43]
    ds_read_b128 v[116:119], v14 offset:28672
    v_lshlrev_b32 v76, 16, v103
    v_mfma_f32_16x16x32_bf16 v[40:43], v[120:123], a[192:195], v[40:43]
    ds_read_b64_tr_b16 v[236:237], v10 offset:16384
    s_waitcnt lgkmcnt(3)
    v_mfma_f32_16x16x32_bf16 v[48:51], v[104:107], a[192:195], v[48:51]
    s_add_u32 m0, s73, 97792
    v_lshlrev_b32 v77, 16, v103
    v_mfma_f32_16x16x32_bf16 v[48:51], v[108:111], a[200:203], v[48:51]
    buffer_load_dwordx4 v21, s[44:47], s20 offen offset:512 sc1 lds
    ds_read_b64_tr_b16 v[238:239], v10 offset:18432
    s_waitcnt lgkmcnt(2)
    v_mfma_f32_16x16x32_bf16 v[48:51], v[112:115], a[208:211], v[48:51]
    ds_read_b128 v[120:123], v14 offset:17408
    v_mfma_f32_16x16x32_bf16 v[48:51], v[116:119], a[216:219], v[48:51]
    ds_read_b128 v[124:127], v14 offset:21504
    v_mfma_f32_16x16x32_bf16 v[52:55], v[116:119], a[220:223], v[52:55]
    ds_read_b128 v[128:131], v14 offset:25600
    v_lshlrev_b32 v78, 16, v103
    v_mfma_f32_16x16x32_bf16 v[52:55], v[112:115], a[212:215], v[52:55]
    ds_read_b128 v[132:135], v14 offset:29696
    v_mfma_f32_16x16x32_bf16 v[52:55], v[108:111], a[204:207], v[52:55]
    ds_read_b64_tr_b16 v[244:245], v10 offset:20480
    s_add_u32 m0, s73, 99328
    v_lshlrev_b32 v79, 16, v103
    v_mfma_f32_16x16x32_bf16 v[52:55], v[104:107], a[196:199], v[52:55]
    buffer_load_dwordx4 v21, s[44:47], s21 offen offset:0 sc1 lds
    s_waitcnt lgkmcnt(3)
    v_mfma_f32_16x16x32_bf16 v[36:39], v[120:123], a[228:231], v[36:39]
    ds_read_b64_tr_b16 v[246:247], v10 offset:22528
    buffer_load_dwordx2 v[98:99], v26, s[44:47], s42 offen offset:128 sc1
    s_add_u32 m0, s73, 99840
    v_mfma_f32_16x16x32_bf16 v[36:39], v[124:127], a[236:239], v[36:39]
    buffer_load_dwordx4 v21, s[44:47], s21 offen offset:512 sc1 lds
    s_waitcnt lgkmcnt(2)
    v_mfma_f32_16x16x32_bf16 v[36:39], v[128:131], a[244:247], v[36:39]
    ds_read_b128 v[104:107], v14 offset:18432
    v_lshlrev_b32 v80, 16, v102
    v_mfma_f32_16x16x32_bf16 v[36:39], v[132:135], a[252:255], v[36:39]
    ds_read_b128 v[108:111], v14 offset:22528
    v_lshlrev_b32 v81, 16, v102
    v_mfma_f32_16x16x32_bf16 v[32:35], v[132:135], a[248:251], v[32:35]
    ds_read_b128 v[112:115], v14 offset:26624
    v_add_u32 v11, 65536, v11
    v_mfma_f32_16x16x32_bf16 v[32:35], v[128:131], a[240:243], v[32:35]
    ds_read_b128 v[116:119], v14 offset:30720
    v_mfma_f32_16x16x32_bf16 v[32:35], v[124:127], a[232:235], v[32:35]
    s_add_u32 m0, s73, 101376
    v_lshlrev_b32 v82, 16, v102
    v_mfma_f32_16x16x32_bf16 v[32:35], v[120:123], a[224:227], v[32:35]
    buffer_load_dwordx4 v21, s[44:47], s22 offen offset:0 sc1 lds
    ds_read_b64_tr_b16 v[240:241], v11 offset:16384
    s_waitcnt lgkmcnt(3)
    v_mfma_f32_16x16x32_bf16 v[40:43], v[104:107], a[224:227], v[40:43]
    v_lshlrev_b32 v83, 16, v102
    v_mfma_f32_16x16x32_bf16 v[40:43], v[108:111], a[232:235], v[40:43]
    ds_read_b64_tr_b16 v[242:243], v11 offset:18432
    s_waitcnt lgkmcnt(2)
    v_mfma_f32_16x16x32_bf16 v[40:43], v[112:115], a[240:243], v[40:43]
    ds_read_b128 v[120:123], v14 offset:19456
    v_mfma_f32_16x16x32_bf16 v[40:43], v[116:119], a[248:251], v[40:43]
    ds_read_b128 v[124:127], v14 offset:23552
    v_mfma_f32_16x16x32_bf16 v[44:47], v[116:119], a[252:255], v[44:47]
    ds_read_b128 v[128:131], v14 offset:27648
    v_lshlrev_b32 v84, 16, v103
    v_mfma_f32_16x16x32_bf16 v[44:47], v[112:115], a[244:247], v[44:47]
    ds_read_b128 v[132:135], v14 offset:31744
    v_mfma_f32_16x16x32_bf16 v[44:47], v[108:111], a[236:239], v[44:47]
    ds_read_b64_tr_b16 v[248:249], v11 offset:20480
    v_lshlrev_b32 v85, 16, v103
    v_mfma_f32_16x16x32_bf16 v[44:47], v[104:107], a[228:231], v[44:47]
    s_waitcnt lgkmcnt(3)
    v_mfma_f32_16x16x32_bf16 v[52:55], v[120:123], a[228:231], v[52:55]
    ds_read_b64_tr_b16 v[250:251], v11 offset:22528
    buffer_load_dwordx2 v[100:101], v18, s[44:47], s42 offen offset:0 sc1
    v_mfma_f32_16x16x32_bf16 v[52:55], v[124:127], a[236:239], v[52:55]
    v_lshlrev_b32 v86, 16, v103
    s_waitcnt lgkmcnt(2)
    v_mfma_f32_16x16x32_bf16 v[52:55], v[128:131], a[244:247], v[52:55]
    s_waitcnt lgkmcnt(0)
    s_barrier
    v_mfma_f32_16x16x32_bf16 v[52:55], v[132:135], a[252:255], v[52:55]
    ds_read_b128 v[104:107], v14 offset:32768
    v_mfma_f32_16x16x32_bf16 v[48:51], v[132:135], a[248:251], v[48:51]
    ds_read_b128 v[108:111], v14 offset:36864
    v_lshlrev_b32 v87, 16, v103
    v_mfma_f32_16x16x32_bf16 v[48:51], v[128:131], a[240:243], v[48:51]
    ds_read_b128 v[112:115], v14 offset:40960
    v_mfma_f32_16x16x32_bf16 v[48:51], v[124:127], a[232:235], v[48:51]
    ds_read_b128 v[116:119], v14 offset:45056
    v_lshlrev_b32 v27, 16, v27
    v_mfma_f32_16x16x32_bf16 v[48:51], v[120:123], a[224:227], v[48:51]
L_Dc:
L_pl_D_0:
    s_cbranch_execz L_wret
    s_waitcnt lgkmcnt(2)
    v_mfma_f32_16x16x32_bf16 v[32:35], v[104:107], v[220:223], v[32:35]
    s_add_u32 m0, s73, 114176
    v_mfma_f32_16x16x32_bf16 v[32:35], v[108:111], v[228:231], v[32:35]
    buffer_load_dwordx4 v21, s[44:47], s22 offen offset:512 sc1 lds
    s_waitcnt lgkmcnt(0)
    v_mfma_f32_16x16x32_bf16 v[32:35], v[112:115], v[236:239], v[32:35]
    ds_read_b128 v[120:123], v14 offset:33792
    v_mfma_f32_16x16x32_bf16 v[32:35], v[116:119], v[244:247], v[32:35]
    ds_read_b128 v[124:127], v14 offset:37888
    v_mfma_f32_16x16x32_bf16 v[36:39], v[116:119], v[248:251], v[36:39]
    ds_read_b128 v[128:131], v14 offset:41984
    buffer_load_dword v189, v188, s[44:47], 0 offen sc1
    v_mfma_f32_16x16x32_bf16 v[36:39], v[112:115], v[240:243], v[36:39]
    ds_read_b128 v[132:135], v14 offset:46080
    v_mfma_f32_16x16x32_bf16 v[36:39], v[108:111], v[232:235], v[36:39]
    s_add_u32 m0, s73, 115712
    v_mfma_f32_16x16x32_bf16 v[36:39], v[104:107], v[224:227], v[36:39]
    buffer_load_dwordx4 v21, s[44:47], s23 offen offset:0 sc1 lds
    s_waitcnt lgkmcnt(2)
    v_mfma_f32_16x16x32_bf16 v[44:47], v[120:123], v[224:227], v[44:47]
    s_add_u32 m0, s73, 116224
    v_mfma_f32_16x16x32_bf16 v[44:47], v[124:127], v[232:235], v[44:47]
    buffer_load_dwordx4 v21, s[44:47], s23 offen offset:512 sc1 lds
    s_waitcnt lgkmcnt(0)
    v_mfma_f32_16x16x32_bf16 v[44:47], v[128:131], v[240:243], v[44:47]
    ds_read_b128 v[104:107], v14 offset:34816
    v_mfma_f32_16x16x32_bf16 v[44:47], v[132:135], v[248:251], v[44:47]
    ds_read_b128 v[108:111], v14 offset:38912
    v_mfma_f32_16x16x32_bf16 v[40:43], v[132:135], v[244:247], v[40:43]
    ds_read_b128 v[112:115], v14 offset:43008
    v_mfma_f32_16x16x32_bf16 v[40:43], v[128:131], v[236:239], v[40:43]
    ds_read_b128 v[116:119], v14 offset:47104
    v_mfma_f32_16x16x32_bf16 v[40:43], v[124:127], v[228:231], v[40:43]
    s_add_u32 m0, s73, 117760
    v_mfma_f32_16x16x32_bf16 v[40:43], v[120:123], v[220:223], v[40:43]
    buffer_load_dwordx4 v21, s[44:47], s24 offen offset:0 sc1 lds
    s_waitcnt lgkmcnt(2)
    v_mfma_f32_16x16x32_bf16 v[48:51], v[104:107], v[220:223], v[48:51]
    v_mfma_f32_16x16x32_bf16 v[48:51], v[108:111], v[228:231], v[48:51]
    s_waitcnt lgkmcnt(0)
    v_mfma_f32_16x16x32_bf16 v[48:51], v[112:115], v[236:239], v[48:51]
    ds_read_b128 v[120:123], v14 offset:35840
    v_mfma_f32_16x16x32_bf16 v[48:51], v[116:119], v[244:247], v[48:51]
    ds_read_b128 v[124:127], v14 offset:39936
    v_mfma_f32_16x16x32_bf16 v[52:55], v[116:119], v[248:251], v[52:55]
    ds_read_b128 v[128:131], v14 offset:44032
    v_mfma_f32_16x16x32_bf16 v[52:55], v[112:115], v[240:243], v[52:55]
    ds_read_b128 v[132:135], v14 offset:48128
    v_mfma_f32_16x16x32_bf16 v[52:55], v[108:111], v[232:235], v[52:55]
    v_mfma_f32_16x16x32_bf16 v[52:55], v[104:107], v[224:227], v[52:55]
    s_waitcnt lgkmcnt(2)
    v_mfma_f32_16x16x32_bf16 v[60:63], v[120:123], a[4:7], 0
    v_mfma_f32_16x16x32_bf16 v[60:63], v[124:127], a[12:15], v[60:63]
    s_waitcnt lgkmcnt(0)
    v_mfma_f32_16x16x32_bf16 v[60:63], v[128:131], a[20:23], v[60:63]
    s_waitcnt vmcnt(12)
    s_barrier
    v_mfma_f32_16x16x32_bf16 v[60:63], v[132:135], a[28:31], v[60:63]
    ds_read_b128 v[104:107], v14 offset:49152
    v_mfma_f32_16x16x32_bf16 v[56:59], v[132:135], a[24:27], 0
    ds_read_b128 v[108:111], v14 offset:53248
    v_mfma_f32_16x16x32_bf16 v[56:59], v[128:131], a[16:19], v[56:59]
    ds_read_b128 v[112:115], v14 offset:57344
    v_cvt_pk_bf16_f32 v192, v32, v33
    v_mfma_f32_16x16x32_bf16 v[56:59], v[124:127], a[8:11], v[56:59]
    ds_read_b128 v[116:119], v14 offset:61440
    v_mfma_f32_16x16x32_bf16 v[56:59], v[120:123], a[0:3], v[56:59]
    s_waitcnt lgkmcnt(2)
    v_mfma_f32_16x16x32_bf16 v[64:67], v[104:107], a[0:3], 0
    s_add_u32 m0, s73, 130560
    v_mfma_f32_16x16x32_bf16 v[64:67], v[108:111], a[8:11], v[64:67]
    buffer_load_dwordx4 v21, s[44:47], s24 offen offset:512 sc1 lds
    s_waitcnt lgkmcnt(0)
    v_mfma_f32_16x16x32_bf16 v[64:67], v[112:115], a[16:19], v[64:67]
    ds_read_b128 v[120:123], v14 offset:50176
    v_cvt_pk_bf16_f32 v193, v34, v35
    v_mfma_f32_16x16x32_bf16 v[64:67], v[116:119], a[24:27], v[64:67]
    ds_read_b128 v[124:127], v14 offset:54272
    v_mfma_f32_16x16x32_bf16 v[68:71], v[116:119], a[28:31], 0
    ds_read_b128 v[128:131], v14 offset:58368
    v_mfma_f32_16x16x32_bf16 v[68:71], v[112:115], a[20:23], v[68:71]
    buffer_store_dwordx4 v[192:195], v136, s[44:47], s32 offen sc1
    ds_read_b128 v[132:135], v14 offset:62464
    v_mfma_f32_16x16x32_bf16 v[68:71], v[108:111], a[12:15], v[68:71]
    s_add_u32 m0, s73, 132096
    v_mfma_f32_16x16x32_bf16 v[68:71], v[104:107], a[4:7], v[68:71]
    buffer_load_dwordx4 v21, s[44:47], s25 offen offset:0 sc1 lds
    s_waitcnt lgkmcnt(2)
    v_mfma_f32_16x16x32_bf16 v[60:63], v[120:123], a[36:39], v[60:63]
    s_add_u32 m0, s73, 132608
    v_mfma_f32_16x16x32_bf16 v[60:63], v[124:127], a[44:47], v[60:63]
    buffer_load_dwordx4 v21, s[44:47], s25 offen offset:512 sc1 lds
    s_waitcnt lgkmcnt(0)
    v_mfma_f32_16x16x32_bf16 v[60:63], v[128:131], a[52:55], v[60:63]
    ds_read_b128 v[104:107], v14 offset:51200
    v_mfma_f32_16x16x32_bf16 v[60:63], v[132:135], a[60:63], v[60:63]
    ds_read_b128 v[108:111], v14 offset:55296
    v_mfma_f32_16x16x32_bf16 v[56:59], v[132:135], a[56:59], v[56:59]
    ds_read_b128 v[112:115], v14 offset:59392
    v_mfma_f32_16x16x32_bf16 v[56:59], v[128:131], a[48:51], v[56:59]
    ds_read_b128 v[116:119], v14 offset:63488
    v_mfma_f32_16x16x32_bf16 v[56:59], v[124:127], a[40:43], v[56:59]
    s_add_u32 m0, s73, 134144
    v_cvt_pk_bf16_f32 v196, v36, v37
    v_mfma_f32_16x16x32_bf16 v[56:59], v[120:123], a[32:35], v[56:59]
    buffer_load_dwordx4 v21, s[44:47], s26 offen offset:0 sc1 lds
    s_waitcnt lgkmcnt(2)
    v_mfma_f32_16x16x32_bf16 v[64:67], v[104:107], a[32:35], v[64:67]
    v_mfma_f32_16x16x32_bf16 v[64:67], v[108:111], a[40:43], v[64:67]
    s_waitcnt lgkmcnt(0)
    v_mfma_f32_16x16x32_bf16 v[64:67], v[112:115], a[48:51], v[64:67]
    ds_read_b128 v[120:123], v14 offset:52224
    v_cvt_pk_bf16_f32 v197, v38, v39
    v_mfma_f32_16x16x32_bf16 v[64:67], v[116:119], a[56:59], v[64:67]
    ds_read_b128 v[124:127], v14 offset:56320
    v_mfma_f32_16x16x32_bf16 v[68:71], v[116:119], a[60:63], v[68:71]
    ds_read_b128 v[128:131], v14 offset:60416
    v_mfma_f32_16x16x32_bf16 v[68:71], v[112:115], a[52:55], v[68:71]
    ds_read_b128 v[132:135], v14 offset:64512
    v_mfma_f32_16x16x32_bf16 v[68:71], v[108:111], a[44:47], v[68:71]
    buffer_store_dwordx4 v[196:199], v136, s[44:47], s33 offen sc1
    v_mfma_f32_16x16x32_bf16 v[68:71], v[104:107], a[36:39], v[68:71]
    s_waitcnt lgkmcnt(2)
    v_mfma_f32_16x16x32_bf16 v[60:63], v[120:123], a[68:71], v[60:63]
    v_mfma_f32_16x16x32_bf16 v[60:63], v[124:127], a[76:79], v[60:63]
    s_waitcnt lgkmcnt(0)
    v_mfma_f32_16x16x32_bf16 v[60:63], v[128:131], a[84:87], v[60:63]
    s_waitcnt vmcnt(12)
    s_barrier
    v_mfma_f32_16x16x32_bf16 v[60:63], v[132:135], a[92:95], v[60:63]
    ds_read_b128 v[104:107], v14 offset:0
    v_mfma_f32_16x16x32_bf16 v[56:59], v[132:135], a[88:91], v[56:59]
    ds_read_b128 v[108:111], v14 offset:4096
    v_mfma_f32_16x16x32_bf16 v[56:59], v[128:131], a[80:83], v[56:59]
    ds_read_b128 v[112:115], v14 offset:8192
    v_cvt_pk_bf16_f32 v192, v40, v41
    v_mfma_f32_16x16x32_bf16 v[56:59], v[124:127], a[72:75], v[56:59]
    ds_read_b128 v[116:119], v14 offset:12288
    v_mfma_f32_16x16x32_bf16 v[56:59], v[120:123], a[64:67], v[56:59]
    s_waitcnt lgkmcnt(2)
    v_mfma_f32_16x16x32_bf16 v[64:67], v[104:107], a[64:67], v[64:67]
    s_add_u32 m0, s73, 146944
    v_cvt_pk_bf16_f32 v193, v42, v43
    s_waitcnt vmcnt(11)
    v_mfma_f32_16x16x32_bf16 v[64:67], v[108:111], a[72:75], v[64:67]
    buffer_load_dwordx4 v21, s[44:47], s26 offen offset:512 sc1 lds
    s_waitcnt lgkmcnt(0)
    v_mfma_f32_16x16x32_bf16 v[64:67], v[112:115], a[80:83], v[64:67]
    ds_read_b128 v[120:123], v14 offset:1024
    v_mul_f32 v96, v96, v97
    v_mfma_f32_16x16x32_bf16 v[64:67], v[116:119], a[88:91], v[64:67]
    ds_read_b128 v[124:127], v14 offset:5120
    v_cvt_pk_bf16_f32 v194, v44, v45
    v_mfma_f32_16x16x32_bf16 v[68:71], v[116:119], a[92:95], v[68:71]
    ds_read_b128 v[128:131], v14 offset:9216
    v_mul_f32 v98, v98, v99
    v_mfma_f32_16x16x32_bf16 v[68:71], v[112:115], a[84:87], v[68:71]
    ds_read_b128 v[132:135], v14 offset:13312
    v_mul_f32 v100, v100, v101
    v_mfma_f32_16x16x32_bf16 v[68:71], v[108:111], a[76:79], v[68:71]
    buffer_store_dwordx4 v[192:195], v136, s[44:47], s30 offen offset:0 sc1
    s_add_u32 m0, s73, 148480
    v_permlane16_swap_b32 v88, v90
    v_mfma_f32_16x16x32_bf16 v[68:71], v[104:107], a[68:71], v[68:71]
    buffer_load_dwordx4 v22, s[44:47], s18 offen offset:0 sc1 lds
    s_waitcnt lgkmcnt(2)
    v_mfma_f32_16x16x32_bf16 v[60:63], v[120:123], a[100:103], v[60:63]
    s_add_u32 m0, s73, 148992
    v_permlane16_swap_b32 v89, v91
    v_permlane16_swap_b32 v92, v94
    v_mfma_f32_16x16x32_bf16 v[60:63], v[124:127], a[108:111], v[60:63]
    buffer_load_dwordx4 v22, s[44:47], s18 offen offset:512 sc1 lds
    s_waitcnt vmcnt(13)
    s_waitcnt lgkmcnt(0)
    v_mfma_f32_16x16x32_bf16 v[60:63], v[128:131], a[116:119], v[60:63]
    ds_read_b128 v[104:107], v14 offset:2048
    v_permlane16_swap_b32 v93, v95
    v_mfma_f32_16x16x32_bf16 v[60:63], v[132:135], a[124:127], v[60:63]
    ds_read_b128 v[108:111], v14 offset:6144
    v_cmp_ne_u32 vcc, s68, v189
    v_mfma_f32_16x16x32_bf16 v[56:59], v[132:135], a[120:123], v[56:59]
    ds_read_b128 v[112:115], v14 offset:10240
    v_and_b32 v145, 0xffff0000, v88
    v_mfma_f32_16x16x32_bf16 v[56:59], v[128:131], a[112:115], v[56:59]
    ds_read_b128 v[116:119], v14 offset:14336
    v_cvt_pk_bf16_f32 v196, v46, v47
    v_mfma_f32_16x16x32_bf16 v[56:59], v[124:127], a[104:107], v[56:59]
    s_add_u32 m0, s73, 150528
    s_cbranch_vccnz L_rs_p3
L_ok_p3:
    v_lshlrev_b32 v144, 16, v88
    v_mfma_f32_16x16x32_bf16 v[56:59], v[120:123], a[96:99], v[56:59]
    buffer_load_dwordx4 v22, s[44:47], s19 offen offset:0 sc1 lds
    s_waitcnt lgkmcnt(2)
    v_mfma_f32_16x16x32_bf16 v[64:67], v[104:107], a[96:99], v[64:67]
    s_add_u32 m0, s73, 81920
    v_cvt_pk_bf16_f32 v197, v48, v49
    v_and_b32 v147, 0xffff0000, v89
    v_mfma_f32_16x16x32_bf16 v[64:67], v[108:111], a[104:107], v[64:67]
    buffer_load_dwordx4 v184, s[44:47], s37 offen offset:0 sc1 lds
    s_waitcnt lgkmcnt(0)
    v_mfma_f32_16x16x32_bf16 v[64:67], v[112:115], a[112:115], v[64:67]
    ds_read_b128 v[120:123], v14 offset:3072
    buffer_load_dwordx4 v185, s[44:47], s37 offen offset:1024 sc1 lds
    v_mfma_f32_16x16x32_bf16 v[64:67], v[116:119], a[120:123], v[64:67]
    ds_read_b128 v[124:127], v14 offset:7168
    s_add_u32 m0, s73, 83968
    v_cvt_pk_bf16_f32 v198, v50, v51
    v_mfma_f32_16x16x32_bf16 v[68:71], v[116:119], a[124:127], v[68:71]
    ds_read_b128 v[128:131], v14 offset:11264
    buffer_load_dwordx4 v184, s[44:47], s16 offen offset:0 sc1 lds
    v_mfma_f32_16x16x32_bf16 v[68:71], v[112:115], a[116:119], v[68:71]
    ds_read_b128 v[132:135], v14 offset:15360
    buffer_load_dwordx4 v185, s[44:47], s16 offen offset:1024 sc1 lds
    v_mfma_f32_16x16x32_bf16 v[68:71], v[108:111], a[108:111], v[68:71]
    buffer_store_dwordx4 v[196:199], v136, s[44:47], s30 offen offset:1024 sc1
    v_lshlrev_b32 v146, 16, v89
    v_and_b32 v149, 0xffff0000, v92
    v_lshlrev_b32 v148, 16, v92
    v_mfma_f32_16x16x32_bf16 v[68:71], v[104:107], a[100:103], v[68:71]
    s_waitcnt lgkmcnt(2)
    v_mfma_f32_16x16x32_bf16 v[60:63], v[120:123], a[132:135], v[60:63]
    v_and_b32 v151, 0xffff0000, v93
    v_mfma_f32_16x16x32_bf16 v[60:63], v[124:127], a[140:143], v[60:63]
    v_lshlrev_b32 v150, 16, v93
    s_waitcnt lgkmcnt(0)
    v_mfma_f32_16x16x32_bf16 v[60:63], v[128:131], a[148:151], v[60:63]
    s_waitcnt vmcnt(16)
    s_barrier
    v_mfma_f32_16x16x32_bf16 v[60:63], v[132:135], a[156:159], v[60:63]
    ds_read_b128 v[104:107], v14 offset:16384
    v_and_b32 v153, 0xffff0000, v90
    v_mfma_f32_16x16x32_bf16 v[56:59], v[132:135], a[152:155], v[56:59]
    ds_read_b128 v[108:111], v14 offset:20480
    v_lshlrev_b32 v152, 16, v90
    v_mfma_f32_16x16x32_bf16 v[56:59], v[128:131], a[144:147], v[56:59]
    ds_read_b128 v[112:115], v14 offset:24576
    v_cvt_pk_bf16_f32 v200, v52, v53
    v_mfma_f32_16x16x32_bf16 v[56:59], v[124:127], a[136:139], v[56:59]
    ds_read_b128 v[116:119], v14 offset:28672
    v_and_b32 v155, 0xffff0000, v91
    v_mfma_f32_16x16x32_bf16 v[56:59], v[120:123], a[128:131], v[56:59]
    s_waitcnt lgkmcnt(2)
    v_mfma_f32_16x16x32_bf16 v[64:67], v[104:107], a[128:131], v[64:67]
    s_add_u32 m0, s73, 97792
    v_lshlrev_b32 v154, 16, v91
    v_mfma_f32_16x16x32_bf16 v[64:67], v[108:111], a[136:139], v[64:67]
    buffer_load_dwordx4 v22, s[44:47], s19 offen offset:512 sc1 lds
    s_waitcnt lgkmcnt(0)
    v_mfma_f32_16x16x32_bf16 v[64:67], v[112:115], a[144:147], v[64:67]
    ds_read_b128 v[120:123], v14 offset:17408
    v_cvt_pk_bf16_f32 v201, v54, v55
    v_mfma_f32_16x16x32_bf16 v[64:67], v[116:119], a[152:155], v[64:67]
    ds_read_b128 v[124:127], v14 offset:21504
    v_and_b32 v157, 0xffff0000, v94
    v_mfma_f32_16x16x32_bf16 v[68:71], v[116:119], a[156:159], v[68:71]
    ds_read_b128 v[128:131], v14 offset:25600
    v_lshlrev_b32 v156, 16, v94
    v_mfma_f32_16x16x32_bf16 v[68:71], v[112:115], a[148:151], v[68:71]
    buffer_store_dwordx4 v[200:203], v136, s[44:47], s30 offen offset:2048 sc1
    ds_read_b128 v[132:135], v14 offset:29696
    v_and_b32 v159, 0xffff0000, v95
    v_mfma_f32_16x16x32_bf16 v[68:71], v[108:111], a[140:143], v[68:71]
    s_add_u32 m0, s73, 99328
    v_lshlrev_b32 v158, 16, v95
    v_mfma_f32_16x16x32_bf16 v[68:71], v[104:107], a[132:135], v[68:71]
    buffer_load_dwordx4 v22, s[44:47], s20 offen offset:0 sc1 lds
    s_waitcnt lgkmcnt(2)
    v_mfma_f32_16x16x32_bf16 v[60:63], v[120:123], a[164:167], v[60:63]
    s_add_u32 m0, s73, 99840
    v_and_b32 v161, 0xffff0000, v142
    v_mfma_f32_16x16x32_bf16 v[60:63], v[124:127], a[172:175], v[60:63]
    buffer_load_dwordx4 v22, s[44:47], s20 offen offset:512 sc1 lds
    s_waitcnt lgkmcnt(0)
    v_mfma_f32_16x16x32_bf16 v[60:63], v[128:131], a[180:183], v[60:63]
    ds_read_b128 v[104:107], v14 offset:18432
    v_lshlrev_b32 v160, 16, v142
    v_mfma_f32_16x16x32_bf16 v[60:63], v[132:135], a[188:191], v[60:63]
    ds_read_b128 v[108:111], v14 offset:22528
    v_mfma_f32_16x16x32_bf16 v[56:59], v[132:135], a[184:187], v[56:59]
    ds_read_b128 v[112:115], v14 offset:26624
    v_and_b32 v163, 0xffff0000, v143
    v_mfma_f32_16x16x32_bf16 v[56:59], v[128:131], a[176:179], v[56:59]
    ds_read_b128 v[116:119], v14 offset:30720
    v_lshlrev_b32 v162, 16, v143
    v_mfma_f32_16x16x32_bf16 v[56:59], v[124:127], a[168:171], v[56:59]
    s_add_u32 m0, s73, 101376
    v_mfma_f32_16x16x32_bf16 v[56:59], v[120:123], a[160:163], v[56:59]
    buffer_load_dwordx4 v22, s[44:47], s21 offen offset:0 sc1 lds
    s_waitcnt lgkmcnt(2)
    v_mfma_f32_16x16x32_bf16 v[64:67], v[104:107], a[160:163], v[64:67]
    v_fma_f32 v164, v144, v97, -v96
    v_mfma_f32_16x16x32_bf16 v[64:67], v[108:111], a[168:171], v[64:67]
    v_fma_f32 v165, v145, v97, -v96
    s_waitcnt lgkmcnt(0)
    v_mfma_f32_16x16x32_bf16 v[64:67], v[112:115], a[176:179], v[64:67]
    ds_read_b128 v[120:123], v14 offset:19456
    v_fma_f32 v166, v146, v97, -v96
    v_mfma_f32_16x16x32_bf16 v[64:67], v[116:119], a[184:187], v[64:67]
    ds_read_b128 v[124:127], v14 offset:23552
    v_mfma_f32_16x16x32_bf16 v[68:71], v[116:119], a[188:191], v[68:71]
    ds_read_b128 v[128:131], v14 offset:27648
    v_fma_f32 v167, v147, v97, -v96
    v_mfma_f32_16x16x32_bf16 v[68:71], v[112:115], a[180:183], v[68:71]
    ds_read_b128 v[132:135], v14 offset:31744
    v_mfma_f32_16x16x32_bf16 v[68:71], v[108:111], a[172:175], v[68:71]
    v_fma_f32 v168, v148, v99, -v98
    v_mfma_f32_16x16x32_bf16 v[68:71], v[104:107], a[164:167], v[68:71]
    v_fma_f32 v169, v149, v99, -v98
    s_waitcnt lgkmcnt(2)
    v_mfma_f32_16x16x32_bf16 v[60:63], v[120:123], a[196:199], v[60:63]
    v_mfma_f32_16x16x32_bf16 v[60:63], v[124:127], a[204:207], v[60:63]
    v_fma_f32 v170, v150, v99, -v98
    s_waitcnt lgkmcnt(0)
    v_mfma_f32_16x16x32_bf16 v[60:63], v[128:131], a[212:215], v[60:63]
    s_waitcnt vmcnt(16)
    s_barrier
    v_mfma_f32_16x16x32_bf16 v[60:63], v[132:135], a[220:223], v[60:63]
    ds_read_b128 v[104:107], v14 offset:32768
    v_fma_f32 v171, v151, v99, -v98
    v_mfma_f32_16x16x32_bf16 v[56:59], v[132:135], a[216:219], v[56:59]
    ds_read_b128 v[108:111], v14 offset:36864
    v_fma_f32 v172, v152, v97, -v96
    v_mfma_f32_16x16x32_bf16 v[56:59], v[128:131], a[208:211], v[56:59]
    ds_read_b128 v[112:115], v14 offset:40960
    v_mfma_f32_16x16x32_bf16 v[56:59], v[124:127], a[200:203], v[56:59]
    ds_read_b128 v[116:119], v14 offset:45056
    v_fma_f32 v173, v153, v97, -v96
    v_mfma_f32_16x16x32_bf16 v[56:59], v[120:123], a[192:195], v[56:59]
    s_waitcnt lgkmcnt(2)
    v_mfma_f32_16x16x32_bf16 v[64:67], v[104:107], a[192:195], v[64:67]
    s_add_u32 m0, s73, 114176
    v_fma_f32 v174, v154, v97, -v96
    v_mfma_f32_16x16x32_bf16 v[64:67], v[108:111], a[200:203], v[64:67]
    buffer_load_dwordx4 v22, s[44:47], s21 offen offset:512 sc1 lds
    s_waitcnt lgkmcnt(0)
    v_mfma_f32_16x16x32_bf16 v[64:67], v[112:115], a[208:211], v[64:67]
    ds_read_b128 v[120:123], v14 offset:33792
    v_fma_f32 v175, v155, v97, -v96
    v_mfma_f32_16x16x32_bf16 v[64:67], v[116:119], a[216:219], v[64:67]
    ds_read_b128 v[124:127], v14 offset:37888
    v_fma_f32 v176, v156, v99, -v98
    v_mfma_f32_16x16x32_bf16 v[68:71], v[116:119], a[220:223], v[68:71]
    ds_read_b128 v[128:131], v14 offset:41984
    v_mfma_f32_16x16x32_bf16 v[68:71], v[112:115], a[212:215], v[68:71]
    ds_read_b128 v[132:135], v14 offset:46080
    v_fma_f32 v177, v157, v99, -v98
    v_mfma_f32_16x16x32_bf16 v[68:71], v[108:111], a[204:207], v[68:71]
    s_add_u32 m0, s73, 115712
    v_fma_f32 v178, v158, v99, -v98
    v_mfma_f32_16x16x32_bf16 v[68:71], v[104:107], a[196:199], v[68:71]
    buffer_load_dwordx4 v22, s[44:47], s22 offen offset:0 sc1 lds
    s_waitcnt lgkmcnt(2)
    v_mfma_f32_16x16x32_bf16 v[60:63], v[120:123], a[228:231], v[60:63]
    s_add_u32 m0, s73, 116224
    v_fma_f32 v179, v159, v99, -v98
    v_mfma_f32_16x16x32_bf16 v[60:63], v[124:127], a[236:239], v[60:63]
    buffer_load_dwordx4 v22, s[44:47], s22 offen offset:512 sc1 lds
    s_waitcnt lgkmcnt(0)
    v_mfma_f32_16x16x32_bf16 v[60:63], v[128:131], a[244:247], v[60:63]
    ds_read_b128 v[104:107], v14 offset:34816
    v_fma_f32 v180, v160, v101, -v100
    v_mfma_f32_16x16x32_bf16 v[60:63], v[132:135], a[252:255], v[60:63]
    ds_read_b128 v[108:111], v14 offset:38912
    v_fma_f32 v181, v161, v101, -v100
    v_mfma_f32_16x16x32_bf16 v[56:59], v[132:135], a[248:251], v[56:59]
    ds_read_b128 v[112:115], v14 offset:43008
    v_mfma_f32_16x16x32_bf16 v[56:59], v[128:131], a[240:243], v[56:59]
    ds_read_b128 v[116:119], v14 offset:47104
    v_fma_f32 v182, v162, v101, -v100
    v_mfma_f32_16x16x32_bf16 v[56:59], v[124:127], a[232:235], v[56:59]
    s_add_u32 m0, s73, 117760
    v_fma_f32 v183, v163, v101, -v100
    v_mfma_f32_16x16x32_bf16 v[56:59], v[120:123], a[224:227], v[56:59]
    buffer_load_dwordx4 v22, s[44:47], s23 offen offset:0 sc1 lds
    s_waitcnt lgkmcnt(2)
    v_mfma_f32_16x16x32_bf16 v[64:67], v[104:107], a[224:227], v[64:67]
    v_mfma_f32_16x16x32_bf16 v[64:67], v[108:111], a[232:235], v[64:67]
    s_waitcnt lgkmcnt(0)
    v_mfma_f32_16x16x32_bf16 v[64:67], v[112:115], a[240:243], v[64:67]
    ds_read_b128 v[120:123], v14 offset:35840
    v_mfma_f32_16x16x32_bf16 v[64:67], v[116:119], a[248:251], v[64:67]
    ds_read_b128 v[124:127], v14 offset:39936
    v_mfma_f32_16x16x32_bf16 v[68:71], v[116:119], a[252:255], v[68:71]
    ds_read_b128 v[128:131], v14 offset:44032
    v_mfma_f32_16x16x32_bf16 v[68:71], v[112:115], a[244:247], v[68:71]
    ds_read_b128 v[132:135], v14 offset:48128
    v_mfma_f32_16x16x32_bf16 v[68:71], v[108:111], a[236:239], v[68:71]
L_pl_D_1:
    s_cbranch_execz L_wret
    v_mfma_f32_16x16x32_bf16 v[68:71], v[104:107], a[228:231], v[68:71]
    s_waitcnt lgkmcnt(2)
    v_mfma_f32_16x16x32_bf16 v[60:63], v[120:123], v[224:227], v[60:63]
    v_mfma_f32_16x16x32_bf16 v[60:63], v[124:127], v[232:235], v[60:63]
    s_waitcnt lgkmcnt(0)
    v_mfma_f32_16x16x32_bf16 v[60:63], v[128:131], v[240:243], v[60:63]
    s_waitcnt vmcnt(10)
    s_barrier
    v_mfma_f32_16x16x32_bf16 v[60:63], v[132:135], v[248:251], v[60:63]
    ds_read_b128 v[104:107], v14 offset:49152
    v_mfma_f32_16x16x32_bf16 v[56:59], v[132:135], v[244:247], v[56:59]
    ds_read_b128 v[108:111], v14 offset:53248
    v_mfma_f32_16x16x32_bf16 v[56:59], v[128:131], v[236:239], v[56:59]
    ds_read_b128 v[112:115], v14 offset:57344
    v_mfma_f32_16x16x32_bf16 v[56:59], v[124:127], v[228:231], v[56:59]
    ds_read_b128 v[116:119], v14 offset:61440
    v_mfma_f32_16x16x32_bf16 v[56:59], v[120:123], v[220:223], v[56:59]
    s_waitcnt lgkmcnt(2)
    v_mfma_f32_16x16x32_bf16 v[64:67], v[104:107], v[220:223], v[64:67]
    s_add_u32 m0, s73, 130560
    v_xor_b32 v186, s41, v10
    v_add_u32 v186, s43, v186
    v_mfma_f32_16x16x32_bf16 v[64:67], v[108:111], v[228:231], v[64:67]
    buffer_load_dwordx4 v22, s[44:47], s23 offen offset:512 sc1 lds
    ds_read_b64_tr_b16 v[12:13], v10 offset:16384
    s_waitcnt lgkmcnt(1)
    v_mfma_f32_16x16x32_bf16 v[64:67], v[112:115], v[236:239], v[64:67]
    ds_read_b128 v[120:123], v14 offset:50176
    v_mfma_f32_16x16x32_bf16 v[64:67], v[116:119], v[244:247], v[64:67]
    ds_read_b128 v[124:127], v14 offset:54272
    v_mfma_f32_16x16x32_bf16 v[68:71], v[116:119], v[248:251], v[68:71]
    ds_read_b128 v[128:131], v14 offset:58368
    ds_read_b64_tr_b16 v[24:25], v11 offset:16384
    v_mfma_f32_16x16x32_bf16 v[68:71], v[112:115], v[240:243], v[68:71]
    ds_read_b128 v[132:135], v14 offset:62464
    ds_read_b64_tr_b16 v[28:29], v10 offset:20480
    v_mfma_f32_16x16x32_bf16 v[68:71], v[108:111], v[232:235], v[68:71]
    s_add_u32 m0, s73, 132096
    ds_read_b64_tr_b16 v[190:191], v11 offset:20480
    v_mfma_f32_16x16x32_bf16 v[68:71], v[104:107], v[224:227], v[68:71]
    buffer_load_dwordx4 v22, s[44:47], s24 offen offset:0 sc1 lds
    ds_read_b64_tr_b16 v[142:143], v186 offset:18432
    s_waitcnt lgkmcnt(6)
    v_mfma_f32_16x16x32_bf16 v[76:79], v[120:123], a[4:7], v[76:79]
    s_add_u32 m0, s73, 132608
    s_waitcnt lgkmcnt(0)
    v_mfma_f32_16x16x32_bf16 v[76:79], v[124:127], a[12:15], v[76:79]
    buffer_load_dwordx4 v22, s[44:47], s24 offen offset:512 sc1 lds
    v_mfma_f32_16x16x32_bf16 v[76:79], v[128:131], a[20:23], v[76:79]
    ds_read_b128 v[104:107], v14 offset:51200
    v_and_b32 v9, 0xffff0000, v12
    v_mfma_f32_16x16x32_bf16 v[76:79], v[132:135], a[28:31], v[76:79]
    ds_read_b128 v[108:111], v14 offset:55296
    v_mfma_f32_16x16x32_bf16 v[72:75], v[132:135], a[24:27], v[72:75]
    ds_read_b128 v[112:115], v14 offset:59392
    v_lshlrev_b32 v8, 16, v12
    v_mfma_f32_16x16x32_bf16 v[72:75], v[128:131], a[16:19], v[72:75]
    ds_read_b128 v[116:119], v14 offset:63488
    v_cvt_pk_bf16_f32 v192, v56, v57
    v_mfma_f32_16x16x32_bf16 v[72:75], v[124:127], a[8:11], v[72:75]
    s_add_u32 m0, s73, 134144
    v_mul_f32 v165, v165, v9
    v_mfma_f32_16x16x32_bf16 v[72:75], v[120:123], a[0:3], v[72:75]
    buffer_load_dwordx4 v22, s[44:47], s25 offen offset:0 sc1 lds
    s_waitcnt lgkmcnt(2)
    v_mfma_f32_16x16x32_bf16 v[80:83], v[104:107], a[0:3], v[80:83]
    v_cvt_pk_bf16_f32 v193, v58, v59
    v_mul_f32 v164, v164, v8
    v_mfma_f32_16x16x32_bf16 v[80:83], v[108:111], a[8:11], v[80:83]
    v_and_b32 v31, 0xffff0000, v13
    s_waitcnt lgkmcnt(0)
    v_mfma_f32_16x16x32_bf16 v[80:83], v[112:115], a[16:19], v[80:83]
    ds_read_b128 v[120:123], v14 offset:52224
    v_lshlrev_b32 v30, 16, v13
    v_mfma_f32_16x16x32_bf16 v[80:83], v[116:119], a[24:27], v[80:83]
    ds_read_b128 v[124:127], v14 offset:56320
    v_cvt_pk_bf16_f32 v194, v60, v61
    v_mfma_f32_16x16x32_bf16 v[84:87], v[116:119], a[28:31], v[84:87]
    ds_read_b128 v[128:131], v14 offset:60416
    v_mfma_f32_16x16x32_bf16 v[84:87], v[112:115], a[20:23], v[84:87]
    ds_read_b128 v[132:135], v14 offset:64512
    v_mul_f32 v167, v167, v31
    v_mfma_f32_16x16x32_bf16 v[84:87], v[108:111], a[12:15], v[84:87]
    buffer_store_dwordx4 v[192:195], v136, s[44:47], s15 offen offset:0 sc1
    v_mul_f32 v166, v166, v30
    v_mfma_f32_16x16x32_bf16 v[84:87], v[104:107], a[4:7], v[84:87]
    s_waitcnt lgkmcnt(2)
    v_mfma_f32_16x16x32_bf16 v[76:79], v[120:123], a[36:39], v[76:79]
    v_and_b32 v9, 0xffff0000, v24
    v_mfma_f32_16x16x32_bf16 v[76:79], v[124:127], a[44:47], v[76:79]
    s_waitcnt lgkmcnt(0)
    v_mfma_f32_16x16x32_bf16 v[76:79], v[128:131], a[52:55], v[76:79]
    s_waitcnt vmcnt(9)
    s_barrier
    v_lshlrev_b32 v8, 16, v24
    v_mfma_f32_16x16x32_bf16 v[76:79], v[132:135], a[60:63], v[76:79]
    ds_read_b128 v[104:107], v14 offset:0
    v_mfma_f32_16x16x32_bf16 v[72:75], v[132:135], a[56:59], v[72:75]
    ds_read_b128 v[108:111], v14 offset:4096
    v_mul_f32 v169, v169, v9
    v_mfma_f32_16x16x32_bf16 v[72:75], v[128:131], a[48:51], v[72:75]
    ds_read_b128 v[112:115], v14 offset:8192
    v_cvt_pk_bf16_f32 v196, v62, v63
    v_mfma_f32_16x16x32_bf16 v[72:75], v[124:127], a[40:43], v[72:75]
    ds_read_b128 v[116:119], v14 offset:12288
    v_mul_f32 v168, v168, v8
    v_mfma_f32_16x16x32_bf16 v[72:75], v[120:123], a[32:35], v[72:75]
    v_and_b32 v31, 0xffff0000, v25
    s_waitcnt lgkmcnt(2)
    v_mfma_f32_16x16x32_bf16 v[80:83], v[104:107], a[32:35], v[80:83]
    s_add_u32 m0, s73, 146944
    v_cvt_pk_bf16_f32 v197, v64, v65
    v_lshlrev_b32 v30, 16, v25
    v_mfma_f32_16x16x32_bf16 v[80:83], v[108:111], a[40:43], v[80:83]
    buffer_load_dwordx4 v22, s[44:47], s25 offen offset:512 sc1 lds
    s_waitcnt lgkmcnt(0)
    v_mfma_f32_16x16x32_bf16 v[80:83], v[112:115], a[48:51], v[80:83]
    ds_read_b128 v[120:123], v14 offset:1024
    v_mul_f32 v171, v171, v31
    v_mfma_f32_16x16x32_bf16 v[80:83], v[116:119], a[56:59], v[80:83]
    ds_read_b128 v[124:127], v14 offset:5120
    v_cvt_pk_bf16_f32 v198, v66, v67
    v_mfma_f32_16x16x32_bf16 v[84:87], v[116:119], a[60:63], v[84:87]
    ds_read_b128 v[128:131], v14 offset:9216
    v_mul_f32 v170, v170, v30
    v_mfma_f32_16x16x32_bf16 v[84:87], v[112:115], a[52:55], v[84:87]
    ds_read_b128 v[132:135], v14 offset:13312
    v_mfma_f32_16x16x32_bf16 v[84:87], v[108:111], a[44:47], v[84:87]
    buffer_store_dwordx4 v[196:199], v136, s[44:47], s15 offen offset:1024 sc1
    s_add_u32 m0, s73, 148480
    v_and_b32 v9, 0xffff0000, v28
    v_mfma_f32_16x16x32_bf16 v[84:87], v[104:107], a[36:39], v[84:87]
    buffer_load_dwordx4 v22, s[44:47], s26 offen offset:0 sc1 lds
    s_waitcnt lgkmcnt(2)
    v_mfma_f32_16x16x32_bf16 v[76:79], v[120:123], a[68:71], v[76:79]
    s_add_u32 m0, s73, 148992
    v_lshlrev_b32 v8, 16, v28
    v_mfma_f32_16x16x32_bf16 v[76:79], v[124:127], a[76:79], v[76:79]
    buffer_load_dwordx4 v22, s[44:47], s26 offen offset:512 sc1 lds
    s_waitcnt lgkmcnt(0)
    v_mfma_f32_16x16x32_bf16 v[76:79], v[128:131], a[84:87], v[76:79]
    ds_read_b128 v[104:107], v14 offset:2048
    v_mul_f32 v173, v173, v9
    v_mfma_f32_16x16x32_bf16 v[76:79], v[132:135], a[92:95], v[76:79]
    ds_read_b128 v[108:111], v14 offset:6144
    v_mfma_f32_16x16x32_bf16 v[72:75], v[132:135], a[88:91], v[72:75]
    ds_read_b128 v[112:115], v14 offset:10240
    v_mul_f32 v172, v172, v8
    v_mfma_f32_16x16x32_bf16 v[72:75], v[128:131], a[80:83], v[72:75]
    ds_read_b128 v[116:119], v14 offset:14336
    v_and_b32 v31, 0xffff0000, v29
    v_mfma_f32_16x16x32_bf16 v[72:75], v[124:127], a[72:75], v[72:75]
    s_add_u32 m0, s73, 150528
    v_cvt_pk_bf16_f32 v200, v68, v69
    v_mfma_f32_16x16x32_bf16 v[72:75], v[120:123], a[64:67], v[72:75]
    buffer_load_dwordx4 v19, s[44:47], s18 offen offset:0 sc1 lds
    s_waitcnt lgkmcnt(2)
    v_mfma_f32_16x16x32_bf16 v[80:83], v[104:107], a[64:67], v[80:83]
    v_lshlrev_b32 v30, 16, v29
    v_mul_f32 v175, v175, v31
    v_mfma_f32_16x16x32_bf16 v[80:83], v[108:111], a[72:75], v[80:83]
    buffer_load_dwordx4 v[40:43], v136, s[44:47], s34 offen offset:0 sc1
    s_waitcnt lgkmcnt(0)
    v_mfma_f32_16x16x32_bf16 v[80:83], v[112:115], a[80:83], v[80:83]
    ds_read_b128 v[120:123], v14 offset:3072
    v_cvt_pk_bf16_f32 v201, v70, v71
    v_mfma_f32_16x16x32_bf16 v[80:83], v[116:119], a[88:91], v[80:83]
    ds_read_b128 v[124:127], v14 offset:7168
    v_mul_f32 v174, v174, v30
    v_mfma_f32_16x16x32_bf16 v[84:87], v[116:119], a[92:95], v[84:87]
    ds_read_b128 v[128:131], v14 offset:11264
    v_and_b32 v9, 0xffff0000, v190
    v_mfma_f32_16x16x32_bf16 v[84:87], v[112:115], a[84:87], v[84:87]
    ds_read_b128 v[132:135], v14 offset:15360
    buffer_load_dwordx4 v[44:47], v136, s[44:47], s34 offen offset:1024 sc1
    v_mfma_f32_16x16x32_bf16 v[84:87], v[108:111], a[76:79], v[84:87]
    buffer_store_dwordx4 v[200:203], v136, s[44:47], s15 offen offset:2048 sc1
    v_lshlrev_b32 v8, 16, v190
    v_mfma_f32_16x16x32_bf16 v[84:87], v[104:107], a[68:71], v[84:87]
    s_waitcnt lgkmcnt(2)
    v_mfma_f32_16x16x32_bf16 v[76:79], v[120:123], a[100:103], v[76:79]
    buffer_load_dwordx4 v[48:51], v136, s[44:47], s34 offen offset:2048 sc1
    v_mul_f32 v177, v177, v9
    v_mfma_f32_16x16x32_bf16 v[76:79], v[124:127], a[108:111], v[76:79]
    s_waitcnt lgkmcnt(0)
    v_mfma_f32_16x16x32_bf16 v[76:79], v[128:131], a[116:119], v[76:79]
    s_waitcnt vmcnt(14)
    s_barrier
    v_mul_f32 v176, v176, v8
    v_mfma_f32_16x16x32_bf16 v[76:79], v[132:135], a[124:127], v[76:79]
    ds_read_b128 v[104:107], v14 offset:16384
    v_and_b32 v31, 0xffff0000, v191
    v_mfma_f32_16x16x32_bf16 v[72:75], v[132:135], a[120:123], v[72:75]
    ds_read_b128 v[108:111], v14 offset:20480
    buffer_load_dwordx4 v[204:207], v136, s[44:47], s35 offen offset:0 sc1
    v_mfma_f32_16x16x32_bf16 v[72:75], v[128:131], a[112:115], v[72:75]
    ds_read_b128 v[112:115], v14 offset:24576
    v_lshlrev_b32 v30, 16, v191
    v_mfma_f32_16x16x32_bf16 v[72:75], v[124:127], a[104:107], v[72:75]
    ds_read_b128 v[116:119], v14 offset:28672
    v_mul_f32 v179, v179, v31
    v_mfma_f32_16x16x32_bf16 v[72:75], v[120:123], a[96:99], v[72:75]
    buffer_load_dwordx4 v[208:211], v136, s[44:47], s35 offen offset:1024 sc1
    s_waitcnt lgkmcnt(2)
    v_mfma_f32_16x16x32_bf16 v[80:83], v[104:107], a[96:99], v[80:83]
    v_mfma_f32_16x16x32_bf16 v[80:83], v[108:111], a[104:107], v[80:83]
    v_mul_f32 v178, v178, v30
    s_waitcnt lgkmcnt(0)
    v_mfma_f32_16x16x32_bf16 v[80:83], v[112:115], a[112:115], v[80:83]
    ds_read_b128 v[120:123], v14 offset:17408
    buffer_load_dwordx4 v[212:215], v136, s[44:47], s35 offen offset:2048 sc1
    v_mfma_f32_16x16x32_bf16 v[80:83], v[116:119], a[120:123], v[80:83]
    ds_read_b128 v[124:127], v14 offset:21504
    v_and_b32 v9, 0xffff0000, v142
    v_mfma_f32_16x16x32_bf16 v[84:87], v[116:119], a[124:127], v[84:87]
    ds_read_b128 v[128:131], v14 offset:25600
    v_lshlrev_b32 v8, 16, v142
    v_mfma_f32_16x16x32_bf16 v[84:87], v[112:115], a[116:119], v[84:87]
    ds_read_b128 v[132:135], v14 offset:29696
    v_mfma_f32_16x16x32_bf16 v[84:87], v[108:111], a[108:111], v[84:87]
    buffer_load_dwordx4 v[216:219], v136, s[44:47], s35 offen offset:3072 sc1
    v_mul_f32 v181, v181, v9
    v_mfma_f32_16x16x32_bf16 v[84:87], v[104:107], a[100:103], v[84:87]
    s_waitcnt lgkmcnt(2)
    v_mfma_f32_16x16x32_bf16 v[76:79], v[120:123], a[132:135], v[76:79]
    v_mul_f32 v180, v180, v8
    v_mfma_f32_16x16x32_bf16 v[76:79], v[124:127], a[140:143], v[76:79]
    v_and_b32 v31, 0xffff0000, v143
    s_waitcnt lgkmcnt(0)
    v_mfma_f32_16x16x32_bf16 v[76:79], v[128:131], a[148:151], v[76:79]
    ds_read_b128 v[104:107], v14 offset:18432
    v_mfma_f32_16x16x32_bf16 v[76:79], v[132:135], a[156:159], v[76:79]
    ds_read_b128 v[108:111], v14 offset:22528
    v_lshlrev_b32 v30, 16, v143
    v_mfma_f32_16x16x32_bf16 v[72:75], v[132:135], a[152:155], v[72:75]
    ds_read_b128 v[112:115], v14 offset:26624
    v_mfma_f32_16x16x32_bf16 v[72:75], v[128:131], a[144:147], v[72:75]
    ds_read_b128 v[116:119], v14 offset:30720
    v_mul_f32 v183, v183, v31
    v_mfma_f32_16x16x32_bf16 v[72:75], v[124:127], a[136:139], v[72:75]
    v_mfma_f32_16x16x32_bf16 v[72:75], v[120:123], a[128:131], v[72:75]
    v_mul_f32 v182, v182, v30
    s_waitcnt lgkmcnt(2)
    v_mfma_f32_16x16x32_bf16 v[80:83], v[104:107], a[128:131], v[80:83]
    v_mfma_f32_16x16x32_bf16 v[80:83], v[108:111], a[136:139], v[80:83]
    s_waitcnt lgkmcnt(0)
    v_mfma_f32_16x16x32_bf16 v[80:83], v[112:115], a[144:147], v[80:83]
    ds_read_b128 v[120:123], v14 offset:19456
    v_mfma_f32_16x16x32_bf16 v[80:83], v[116:119], a[152:155], v[80:83]
    ds_read_b128 v[124:127], v14 offset:23552
    v_mfma_f32_16x16x32_bf16 v[84:87], v[116:119], a[156:159], v[84:87]
    ds_read_b128 v[128:131], v14 offset:27648
    v_mfma_f32_16x16x32_bf16 v[84:87], v[112:115], a[148:151], v[84:87]
    ds_read_b128 v[132:135], v14 offset:31744
    v_mfma_f32_16x16x32_bf16 v[84:87], v[108:111], a[140:143], v[84:87]
    v_mfma_f32_16x16x32_bf16 v[84:87], v[104:107], a[132:135], v[84:87]
    s_waitcnt lgkmcnt(2)
    v_mfma_f32_16x16x32_bf16 v[76:79], v[120:123], a[164:167], v[76:79]
    s_add_u32 m0, s73, 97792
    v_mfma_f32_16x16x32_bf16 v[76:79], v[124:127], a[172:175], v[76:79]
    buffer_load_dwordx4 v19, s[44:47], s18 offen offset:512 sc1 lds
    s_waitcnt lgkmcnt(0)
    v_mfma_f32_16x16x32_bf16 v[76:79], v[128:131], a[180:183], v[76:79]
    s_waitcnt vmcnt(15)
    s_barrier
    v_mfma_f32_16x16x32_bf16 v[76:79], v[132:135], a[188:191], v[76:79]
    ds_read_b128 v[104:107], v14 offset:32768
    v_mfma_f32_16x16x32_bf16 v[72:75], v[132:135], a[184:187], v[72:75]
    ds_read_b128 v[108:111], v14 offset:36864
    v_mfma_f32_16x16x32_bf16 v[72:75], v[128:131], a[176:179], v[72:75]
    ds_read_b128 v[112:115], v14 offset:40960
    v_mfma_f32_16x16x32_bf16 v[72:75], v[124:127], a[168:171], v[72:75]
    ds_read_b128 v[116:119], v14 offset:45056
    s_add_u32 m0, s73, 99328
    v_mfma_f32_16x16x32_bf16 v[72:75], v[120:123], a[160:163], v[72:75]
    buffer_load_dwordx4 v19, s[44:47], s19 offen offset:0 sc1 lds
    s_waitcnt lgkmcnt(2)
    v_mfma_f32_16x16x32_bf16 v[80:83], v[104:107], a[160:163], v[80:83]
    s_add_u32 m0, s73, 99840
    v_mov_b32 v141, 0
    v_mfma_f32_16x16x32_bf16 v[80:83], v[108:111], a[168:171], v[80:83]
    buffer_load_dwordx4 v19, s[44:47], s19 offen offset:512 sc1 lds
    s_waitcnt lgkmcnt(0)
    v_mfma_f32_16x16x32_bf16 v[80:83], v[112:115], a[176:179], v[80:83]
    ds_read_b128 v[120:123], v14 offset:33792
    v_mfma_f32_16x16x32_bf16 v[80:83], v[116:119], a[184:187], v[80:83]
    ds_read_b128 v[124:127], v14 offset:37888
    buffer_atomic_add v141, v139, s[44:47], s11 offen offset:2060 sc0 sc1
    v_mfma_f32_16x16x32_bf16 v[84:87], v[116:119], a[188:191], v[84:87]
    ds_read_b128 v[128:131], v14 offset:41984
    v_mfma_f32_16x16x32_bf16 v[84:87], v[112:115], a[180:183], v[84:87]
    ds_read_b128 v[132:135], v14 offset:46080
    v_mfma_f32_16x16x32_bf16 v[84:87], v[108:111], a[172:175], v[84:87]
    s_add_u32 m0, s73, 101376
    v_mfma_f32_16x16x32_bf16 v[84:87], v[104:107], a[164:167], v[84:87]
    buffer_load_dwordx4 v19, s[44:47], s20 offen offset:0 sc1 lds
    s_waitcnt lgkmcnt(2)
    v_mfma_f32_16x16x32_bf16 v[76:79], v[120:123], a[196:199], v[76:79]
    s_add_u32 m0, s73, 114176
    v_mfma_f32_16x16x32_bf16 v[76:79], v[124:127], a[204:207], v[76:79]
    buffer_load_dwordx4 v19, s[44:47], s20 offen offset:512 sc1 lds
    s_waitcnt lgkmcnt(0)
    v_mfma_f32_16x16x32_bf16 v[76:79], v[128:131], a[212:215], v[76:79]
    ds_read_b128 v[104:107], v14 offset:34816
    v_mfma_f32_16x16x32_bf16 v[76:79], v[132:135], a[220:223], v[76:79]
    ds_read_b128 v[108:111], v14 offset:38912
    v_mfma_f32_16x16x32_bf16 v[72:75], v[132:135], a[216:219], v[72:75]
    ds_read_b128 v[112:115], v14 offset:43008
    v_mfma_f32_16x16x32_bf16 v[72:75], v[128:131], a[208:211], v[72:75]
    ds_read_b128 v[116:119], v14 offset:47104
    v_mfma_f32_16x16x32_bf16 v[72:75], v[124:127], a[200:203], v[72:75]
    s_add_u32 m0, s73, 115712
    v_mfma_f32_16x16x32_bf16 v[72:75], v[120:123], a[192:195], v[72:75]
    buffer_load_dwordx4 v19, s[44:47], s21 offen offset:0 sc1 lds
    s_waitcnt lgkmcnt(2)
    v_mfma_f32_16x16x32_bf16 v[80:83], v[104:107], a[192:195], v[80:83]
    s_add_u32 m0, s73, 116224
    v_mfma_f32_16x16x32_bf16 v[80:83], v[108:111], a[200:203], v[80:83]
    buffer_load_dwordx4 v19, s[44:47], s21 offen offset:512 sc1 lds
    s_waitcnt lgkmcnt(0)
    v_mfma_f32_16x16x32_bf16 v[80:83], v[112:115], a[208:211], v[80:83]
    ds_read_b128 v[120:123], v14 offset:35840
    v_mfma_f32_16x16x32_bf16 v[80:83], v[116:119], a[216:219], v[80:83]
    ds_read_b128 v[124:127], v14 offset:39936
    v_mfma_f32_16x16x32_bf16 v[84:87], v[116:119], a[220:223], v[84:87]
    ds_read_b128 v[128:131], v14 offset:44032
    v_mfma_f32_16x16x32_bf16 v[84:87], v[112:115], a[212:215], v[84:87]
    ds_read_b128 v[132:135], v14 offset:48128
    v_mfma_f32_16x16x32_bf16 v[84:87], v[108:111], a[204:207], v[84:87]
    s_add_u32 m0, s73, 117760
    v_mfma_f32_16x16x32_bf16 v[84:87], v[104:107], a[196:199], v[84:87]
    buffer_load_dwordx4 v19, s[44:47], s22 offen offset:0 sc1 lds
    s_waitcnt lgkmcnt(2)
    v_mfma_f32_16x16x32_bf16 v[76:79], v[120:123], a[228:231], v[76:79]
    v_mfma_f32_16x16x32_bf16 v[76:79], v[124:127], a[236:239], v[76:79]
    s_waitcnt lgkmcnt(0)
    v_mfma_f32_16x16x32_bf16 v[76:79], v[128:131], a[244:247], v[76:79]
    s_waitcnt vmcnt(17)
    s_barrier
    v_mfma_f32_16x16x32_bf16 v[76:79], v[132:135], a[252:255], v[76:79]
    ds_read_b128 v[104:107], v14 offset:49152
    v_mfma_f32_16x16x32_bf16 v[72:75], v[132:135], a[248:251], v[72:75]
    ds_read_b128 v[108:111], v14 offset:53248
    v_mfma_f32_16x16x32_bf16 v[72:75], v[128:131], a[240:243], v[72:75]
    ds_read_b128 v[112:115], v14 offset:57344
    v_mfma_f32_16x16x32_bf16 v[72:75], v[124:127], a[232:235], v[72:75]
    ds_read_b128 v[116:119], v14 offset:61440
    v_mfma_f32_16x16x32_bf16 v[72:75], v[120:123], a[224:227], v[72:75]
    s_waitcnt lgkmcnt(2)
    v_mfma_f32_16x16x32_bf16 v[80:83], v[104:107], a[224:227], v[80:83]
    s_add_u32 m0, s73, 130560
    v_mfma_f32_16x16x32_bf16 v[80:83], v[108:111], a[232:235], v[80:83]
    buffer_load_dwordx4 v19, s[44:47], s22 offen offset:512 sc1 lds
    s_waitcnt lgkmcnt(0)
    v_mfma_f32_16x16x32_bf16 v[80:83], v[112:115], a[240:243], v[80:83]
    ds_read_b128 v[120:123], v14 offset:50176
    v_mfma_f32_16x16x32_bf16 v[80:83], v[116:119], a[248:251], v[80:83]
    ds_read_b128 v[124:127], v14 offset:54272
    v_mfma_f32_16x16x32_bf16 v[84:87], v[116:119], a[252:255], v[84:87]
    ds_read_b128 v[128:131], v14 offset:58368
    v_mfma_f32_16x16x32_bf16 v[84:87], v[112:115], a[244:247], v[84:87]
    ds_read_b128 v[132:135], v14 offset:62464
    v_mfma_f32_16x16x32_bf16 v[84:87], v[108:111], a[236:239], v[84:87]
    s_add_u32 m0, s73, 132096
    v_mfma_f32_16x16x32_bf16 v[84:87], v[104:107], a[228:231], v[84:87]
    buffer_load_dwordx4 v19, s[44:47], s23 offen offset:0 sc1 lds
    s_waitcnt lgkmcnt(2)
    v_mfma_f32_16x16x32_bf16 v[76:79], v[120:123], v[224:227], v[76:79]
    s_add_u32 m0, s73, 132608
    s_waitcnt vmcnt(15)
    v_bitop3_b32 v43, v43, v47, s68 bitop3:0x7e
    v_bitop3_b32 v43, v43, v51, s68 bitop3:0xf6
    v_cmp_ne_u32 vcc, 0, v43
    v_mfma_f32_16x16x32_bf16 v[76:79], v[124:127], v[232:235], v[76:79]
    buffer_load_dwordx4 v19, s[44:47], s23 offen offset:512 sc1 lds
    s_waitcnt lgkmcnt(0)
    v_mfma_f32_16x16x32_bf16 v[76:79], v[128:131], v[240:243], v[76:79]
    ds_read_b128 v[104:107], v14 offset:51200
    s_cbranch_vccnz L_xs_a
L_xo_a:
    v_and_b32 v89, 0xffff0000, v40
    v_mfma_f32_16x16x32_bf16 v[76:79], v[132:135], v[248:251], v[76:79]
    ds_read_b128 v[108:111], v14 offset:55296
    v_lshlrev_b32 v88, 16, v40
    v_mfma_f32_16x16x32_bf16 v[72:75], v[132:135], v[244:247], v[72:75]
    ds_read_b128 v[112:115], v14 offset:59392
    v_and_b32 v91, 0xffff0000, v41
    v_mfma_f32_16x16x32_bf16 v[72:75], v[128:131], v[236:239], v[72:75]
    ds_read_b128 v[116:119], v14 offset:63488
    v_lshlrev_b32 v90, 16, v41
    v_mfma_f32_16x16x32_bf16 v[72:75], v[124:127], v[228:231], v[72:75]
    s_add_u32 m0, s73, 134144
    v_and_b32 v93, 0xffff0000, v42
    v_lshlrev_b32 v92, 16, v42
    v_mfma_f32_16x16x32_bf16 v[72:75], v[120:123], v[220:223], v[72:75]
    buffer_load_dwordx4 v19, s[44:47], s24 offen offset:0 sc1 lds
    s_waitcnt lgkmcnt(2)
    v_mfma_f32_16x16x32_bf16 v[80:83], v[104:107], v[220:223], v[80:83]
    s_waitcnt vmcnt(9)
    v_and_b32 v95, 0xffff0000, v44
    v_lshlrev_b32 v94, 16, v44
    v_mfma_f32_16x16x32_bf16 v[80:83], v[108:111], v[228:231], v[80:83]
    v_and_b32 v97, 0xffff0000, v45
    v_cmp_ne_u32 vcc, v140, v141
    s_waitcnt lgkmcnt(0)
    v_mfma_f32_16x16x32_bf16 v[80:83], v[112:115], v[236:239], v[80:83]
    ds_read_b128 v[120:123], v14 offset:52224
    v_lshlrev_b32 v96, 16, v45
    v_mfma_f32_16x16x32_bf16 v[80:83], v[116:119], v[244:247], v[80:83]
    ds_read_b128 v[124:127], v14 offset:56320
    s_cbranch_vccnz L_as_b
L_ao_b:
    v_and_b32 v99, 0xffff0000, v46
    v_lshlrev_b32 v98, 16, v46
    v_mfma_f32_16x16x32_bf16 v[84:87], v[116:119], v[248:251], v[84:87]
    ds_read_b128 v[128:131], v14 offset:60416
    buffer_load_dwordx4 v[56:59], v136, s[44:47], s11 offen offset:0 sc1
    v_and_b32 v101, 0xffff0000, v48
    v_mfma_f32_16x16x32_bf16 v[84:87], v[112:115], v[240:243], v[84:87]
    ds_read_b128 v[132:135], v14 offset:64512
    buffer_load_dwordx4 v[60:63], v136, s[44:47], s11 offen offset:1024 sc1
    v_lshlrev_b32 v100, 16, v48
    v_mfma_f32_16x16x32_bf16 v[84:87], v[108:111], v[232:235], v[84:87]
    v_and_b32 v103, 0xffff0000, v49
    v_lshlrev_b32 v102, 16, v49
    v_mfma_f32_16x16x32_bf16 v[84:87], v[104:107], v[224:227], v[84:87]
    buffer_load_dwordx4 v[64:67], v136, s[44:47], s11 offen offset:2048 sc1
    s_waitcnt lgkmcnt(2)
    v_mfma_f32_16x16x32_bf16 v[92:95], v[120:123], a[4:7], v[92:95]
    v_mfma_f32_16x16x32_bf16 v[92:95], v[124:127], a[12:15], v[92:95]
    s_waitcnt lgkmcnt(0)
    v_mfma_f32_16x16x32_bf16 v[92:95], v[128:131], a[20:23], v[92:95]
    s_waitcnt vmcnt(11)
    s_barrier
    v_mfma_f32_16x16x32_bf16 v[92:95], v[132:135], a[28:31], v[92:95]
    ds_read_b128 v[104:107], v14 offset:0
    v_mfma_f32_16x16x32_bf16 v[88:91], v[132:135], a[24:27], v[88:91]
    ds_read_b128 v[108:111], v14 offset:4096
    v_cvt_pk_bf16_f32 v192, v72, v73
    v_mfma_f32_16x16x32_bf16 v[88:91], v[128:131], a[16:19], v[88:91]
    ds_read_b128 v[112:115], v14 offset:8192
    v_cvt_pk_bf16_f32 v193, v74, v75
    v_mfma_f32_16x16x32_bf16 v[88:91], v[124:127], a[8:11], v[88:91]
    ds_read_b128 v[116:119], v14 offset:12288
    v_cvt_pk_bf16_f32 v194, v76, v77
    v_mfma_f32_16x16x32_bf16 v[88:91], v[120:123], a[0:3], v[88:91]
    buffer_store_dwordx4 v[192:195], v136, s[44:47], s31 offen offset:0 sc1
    s_waitcnt lgkmcnt(2)
    v_mfma_f32_16x16x32_bf16 v[96:99], v[104:107], a[0:3], v[96:99]
    s_add_u32 m0, s73, 146944
    v_cvt_pk_bf16_f32 v196, v78, v79
    v_cvt_pk_bf16_f32 v197, v80, v81
    v_mfma_f32_16x16x32_bf16 v[96:99], v[108:111], a[8:11], v[96:99]
    buffer_load_dwordx4 v19, s[44:47], s24 offen offset:512 sc1 lds
    s_waitcnt lgkmcnt(0)
    v_mfma_f32_16x16x32_bf16 v[96:99], v[112:115], a[16:19], v[96:99]
    ds_read_b128 v[120:123], v14 offset:1024
    v_cvt_pk_bf16_f32 v198, v82, v83
    v_mfma_f32_16x16x32_bf16 v[96:99], v[116:119], a[24:27], v[96:99]
    buffer_store_dwordx4 v[196:199], v136, s[44:47], s31 offen offset:1024 sc1
    ds_read_b128 v[124:127], v14 offset:5120
    v_bitop3_b32 v207, v207, v211, s36 bitop3:0x7e
    v_bitop3_b32 v207, v207, v215, s36 bitop3:0xf6
    v_mfma_f32_16x16x32_bf16 v[100:103], v[116:119], a[28:31], v[100:103]
    ds_read_b128 v[128:131], v14 offset:9216
    v_cvt_pk_bf16_f32 v200, v84, v85
    v_mfma_f32_16x16x32_bf16 v[100:103], v[112:115], a[20:23], v[100:103]
    ds_read_b128 v[132:135], v14 offset:13312
    v_cvt_pk_bf16_f32 v201, v86, v87
    v_mfma_f32_16x16x32_bf16 v[100:103], v[108:111], a[12:15], v[100:103]
    buffer_store_dwordx4 v[200:203], v136, s[44:47], s31 offen offset:2048 sc1
    s_add_u32 m0, s73, 148480
    v_bitop3_b32 v207, v207, v219, s36 bitop3:0xf6
    v_cmp_ne_u32 vcc, 0, v207
    v_mfma_f32_16x16x32_bf16 v[100:103], v[104:107], a[4:7], v[100:103]
    buffer_load_dwordx4 v19, s[44:47], s25 offen offset:0 sc1 lds
    s_waitcnt lgkmcnt(2)
    v_mfma_f32_16x16x32_bf16 v[92:95], v[120:123], a[36:39], v[92:95]
    s_add_u32 m0, s73, 148992
    s_cbranch_vccnz L_xs_8
L_xo_8:
    v_mfma_f32_16x16x32_bf16 v[92:95], v[124:127], a[44:47], v[92:95]
    buffer_load_dwordx4 v19, s[44:47], s25 offen offset:512 sc1 lds
    s_waitcnt lgkmcnt(0)
    v_mfma_f32_16x16x32_bf16 v[92:95], v[128:131], a[52:55], v[92:95]
    ds_read_b128 v[104:107], v14 offset:2048
    v_and_b32 v33, 0xffff0000, v204
    v_mfma_f32_16x16x32_bf16 v[92:95], v[132:135], a[60:63], v[92:95]
    ds_read_b128 v[108:111], v14 offset:6144
    v_lshlrev_b32 v32, 16, v204
    v_mfma_f32_16x16x32_bf16 v[88:91], v[132:135], a[56:59], v[88:91]
    ds_read_b128 v[112:115], v14 offset:10240
    v_and_b32 v35, 0xffff0000, v205
    v_mfma_f32_16x16x32_bf16 v[88:91], v[128:131], a[48:51], v[88:91]
    ds_read_b128 v[116:119], v14 offset:14336
    v_mfma_f32_16x16x32_bf16 v[88:91], v[124:127], a[40:43], v[88:91]
    s_add_u32 m0, s73, 150528
    v_lshlrev_b32 v34, 16, v205
    v_mfma_f32_16x16x32_bf16 v[88:91], v[120:123], a[32:35], v[88:91]
    buffer_load_dwordx4 v19, s[44:47], s26 offen offset:0 sc1 lds
    s_waitcnt lgkmcnt(2)
    v_mfma_f32_16x16x32_bf16 v[96:99], v[104:107], a[32:35], v[96:99]
    v_add_f32 v32, v32, v27
    v_mfma_f32_16x16x32_bf16 v[96:99], v[108:111], a[40:43], v[96:99]
    v_add_f32 v33, v33, v27
    s_waitcnt lgkmcnt(0)
    v_mfma_f32_16x16x32_bf16 v[96:99], v[112:115], a[48:51], v[96:99]
    ds_read_b128 v[120:123], v14 offset:3072
    v_add_f32 v34, v34, v27
    v_mfma_f32_16x16x32_bf16 v[96:99], v[116:119], a[56:59], v[96:99]
    ds_read_b128 v[124:127], v14 offset:7168
    v_mfma_f32_16x16x32_bf16 v[100:103], v[116:119], a[60:63], v[100:103]
    ds_read_b128 v[128:131], v14 offset:11264
    v_add_f32 v35, v35, v27
    v_mfma_f32_16x16x32_bf16 v[100:103], v[112:115], a[52:55], v[100:103]
    ds_read_b128 v[132:135], v14 offset:15360
    v_and_b32 v37, 0xffff0000, v208
    v_mfma_f32_16x16x32_bf16 v[100:103], v[108:111], a[44:47], v[100:103]
    v_mfma_f32_16x16x32_bf16 v[100:103], v[104:107], a[36:39], v[100:103]
    v_lshlrev_b32 v36, 16, v208
    s_waitcnt lgkmcnt(2)
    v_mfma_f32_16x16x32_bf16 v[92:95], v[120:123], a[68:71], v[92:95]
    v_and_b32 v39, 0xffff0000, v209
    v_mfma_f32_16x16x32_bf16 v[92:95], v[124:127], a[76:79], v[92:95]
    s_waitcnt lgkmcnt(0)
    v_mfma_f32_16x16x32_bf16 v[92:95], v[128:131], a[84:87], v[92:95]
    s_waitcnt vmcnt(14)
    s_barrier
    v_lshlrev_b32 v38, 16, v209
    v_mfma_f32_16x16x32_bf16 v[92:95], v[132:135], a[92:95], v[92:95]
    ds_read_b128 v[104:107], v14 offset:16384
    v_add_f32 v32, v32, v36
    v_mfma_f32_16x16x32_bf16 v[88:91], v[132:135], a[88:91], v[88:91]
    ds_read_b128 v[108:111], v14 offset:20480
    v_mfma_f32_16x16x32_bf16 v[88:91], v[128:131], a[80:83], v[88:91]
    ds_read_b128 v[112:115], v14 offset:24576
    v_add_f32 v33, v33, v37
    v_mfma_f32_16x16x32_bf16 v[88:91], v[124:127], a[72:75], v[88:91]
    ds_read_b128 v[116:119], v14 offset:28672
    v_add_f32 v34, v34, v38
    v_mfma_f32_16x16x32_bf16 v[88:91], v[120:123], a[64:67], v[88:91]
    s_waitcnt lgkmcnt(2)
    v_mfma_f32_16x16x32_bf16 v[96:99], v[104:107], a[64:67], v[96:99]
    s_add_u32 m0, s73, 97792
    v_add_f32 v35, v35, v39
    v_mfma_f32_16x16x32_bf16 v[96:99], v[108:111], a[72:75], v[96:99]
    buffer_load_dwordx4 v19, s[44:47], s26 offen offset:512 sc1 lds
    s_waitcnt lgkmcnt(0)
    v_mfma_f32_16x16x32_bf16 v[96:99], v[112:115], a[80:83], v[96:99]
    ds_read_b128 v[120:123], v14 offset:17408
    v_and_b32 v37, 0xffff0000, v212
    v_mfma_f32_16x16x32_bf16 v[96:99], v[116:119], a[88:91], v[96:99]
    ds_read_b128 v[124:127], v14 offset:21504
    v_lshlrev_b32 v36, 16, v212
    v_mfma_f32_16x16x32_bf16 v[100:103], v[116:119], a[92:95], v[100:103]
    ds_read_b128 v[128:131], v14 offset:25600
    v_and_b32 v39, 0xffff0000, v213
    v_mfma_f32_16x16x32_bf16 v[100:103], v[112:115], a[84:87], v[100:103]
    ds_read_b128 v[132:135], v14 offset:29696
    v_mfma_f32_16x16x32_bf16 v[100:103], v[108:111], a[76:79], v[100:103]
    v_lshlrev_b32 v38, 16, v213
    v_mfma_f32_16x16x32_bf16 v[100:103], v[104:107], a[68:71], v[100:103]
    v_add_f32 v32, v32, v36
    s_waitcnt lgkmcnt(2)
    v_mfma_f32_16x16x32_bf16 v[92:95], v[120:123], a[100:103], v[92:95]
    v_mfma_f32_16x16x32_bf16 v[92:95], v[124:127], a[108:111], v[92:95]
    v_add_f32 v33, v33, v37
    s_waitcnt lgkmcnt(0)
    v_mfma_f32_16x16x32_bf16 v[92:95], v[128:131], a[116:119], v[92:95]
    ds_read_b128 v[104:107], v14 offset:18432
    v_add_f32 v34, v34, v38
    v_mfma_f32_16x16x32_bf16 v[92:95], v[132:135], a[124:127], v[92:95]
    ds_read_b128 v[108:111], v14 offset:22528
    v_add_f32 v35, v35, v39
    v_mfma_f32_16x16x32_bf16 v[88:91], v[132:135], a[120:123], v[88:91]
    ds_read_b128 v[112:115], v14 offset:26624
    v_and_b32 v37, 0xffff0000, v216
    v_mfma_f32_16x16x32_bf16 v[88:91], v[128:131], a[112:115], v[88:91]
    ds_read_b128 v[116:119], v14 offset:30720
    v_lshlrev_b32 v36, 16, v216
    v_mfma_f32_16x16x32_bf16 v[88:91], v[124:127], a[104:107], v[88:91]
    v_and_b32 v39, 0xffff0000, v217
    v_lshlrev_b32 v38, 16, v217
L_pl_D_2:
    s_cbranch_execz L_wret
    v_mfma_f32_16x16x32_bf16 v[88:91], v[120:123], a[96:99], v[88:91]
    v_add_f32 v32, v32, v36
    s_waitcnt lgkmcnt(2)
    v_mfma_f32_16x16x32_bf16 v[96:99], v[104:107], a[96:99], v[96:99]
    v_add_f32 v33, v33, v37
    v_add_f32 v34, v34, v38
    v_mfma_f32_16x16x32_bf16 v[96:99], v[108:111], a[104:107], v[96:99]
    v_add_f32 v35, v35, v39
    s_waitcnt lgkmcnt(0)
    v_mfma_f32_16x16x32_bf16 v[96:99], v[112:115], a[112:115], v[96:99]
    ds_read_b128 v[120:123], v14 offset:19456
    v_mul_f32 v36, s38, v32
    v_mfma_f32_16x16x32_bf16 v[96:99], v[116:119], a[120:123], v[96:99]
    ds_read_b128 v[124:127], v14 offset:23552
    v_mul_f32 v37, s38, v33
    v_mfma_f32_16x16x32_bf16 v[100:103], v[116:119], a[124:127], v[100:103]
    ds_read_b128 v[128:131], v14 offset:27648
    v_mul_f32 v38, s38, v34
    v_mfma_f32_16x16x32_bf16 v[100:103], v[112:115], a[116:119], v[100:103]
    ds_read_b128 v[132:135], v14 offset:31744
    v_mul_f32 v39, s38, v35
    v_mfma_f32_16x16x32_bf16 v[100:103], v[108:111], a[108:111], v[100:103]
    v_exp_f32 v36, v36
    v_mfma_f32_16x16x32_bf16 v[100:103], v[104:107], a[100:103], v[100:103]
    s_waitcnt lgkmcnt(2)
    v_mfma_f32_16x16x32_bf16 v[92:95], v[120:123], a[132:135], v[92:95]
    v_exp_f32 v37, v37
    v_mfma_f32_16x16x32_bf16 v[92:95], v[124:127], a[140:143], v[92:95]
    s_waitcnt lgkmcnt(0)
    v_mfma_f32_16x16x32_bf16 v[92:95], v[128:131], a[148:151], v[92:95]
    s_waitcnt vmcnt(11)
    s_barrier
    v_mfma_f32_16x16x32_bf16 v[92:95], v[132:135], a[156:159], v[92:95]
    ds_read_b128 v[104:107], v14 offset:32768
    v_mfma_f32_16x16x32_bf16 v[88:91], v[132:135], a[152:155], v[88:91]
    ds_read_b128 v[108:111], v14 offset:36864
    v_exp_f32 v38, v38
    v_mfma_f32_16x16x32_bf16 v[88:91], v[128:131], a[144:147], v[88:91]
    ds_read_b128 v[112:115], v14 offset:40960
    v_exp_f32 v39, v39
    v_mfma_f32_16x16x32_bf16 v[88:91], v[124:127], a[136:139], v[88:91]
    ds_read_b128 v[116:119], v14 offset:45056
    v_mul_f32 v180, v180, v32
    v_mfma_f32_16x16x32_bf16 v[88:91], v[120:123], a[128:131], v[88:91]
    v_mul_f32 v181, v181, v33
    s_waitcnt lgkmcnt(2)
    v_mfma_f32_16x16x32_bf16 v[96:99], v[104:107], a[128:131], v[96:99]
    v_mul_f32 v182, v182, v34
    v_mul_f32 v183, v183, v35
    v_mfma_f32_16x16x32_bf16 v[96:99], v[108:111], a[136:139], v[96:99]
    v_add_f32 v36, 1.0, v36
    s_waitcnt lgkmcnt(0)
    v_mfma_f32_16x16x32_bf16 v[96:99], v[112:115], a[144:147], v[96:99]
    ds_read_b128 v[120:123], v14 offset:33792
    v_add_f32 v37, 1.0, v37
    v_mfma_f32_16x16x32_bf16 v[96:99], v[116:119], a[152:155], v[96:99]
    ds_read_b128 v[124:127], v14 offset:37888
    v_add_f32 v38, 1.0, v38
    v_mfma_f32_16x16x32_bf16 v[100:103], v[116:119], a[156:159], v[100:103]
    ds_read_b128 v[128:131], v14 offset:41984
    v_add_f32 v39, 1.0, v39
    v_mfma_f32_16x16x32_bf16 v[100:103], v[112:115], a[148:151], v[100:103]
    ds_read_b128 v[132:135], v14 offset:46080
    v_rcp_f32 v36, v36
    v_mfma_f32_16x16x32_bf16 v[100:103], v[108:111], a[140:143], v[100:103]
    v_rcp_f32 v37, v37
    v_mfma_f32_16x16x32_bf16 v[100:103], v[104:107], a[132:135], v[100:103]
    v_rcp_f32 v38, v38
    s_waitcnt lgkmcnt(2)
    v_mfma_f32_16x16x32_bf16 v[92:95], v[120:123], a[164:167], v[92:95]
    s_waitcnt vmcnt(8)
    v_rcp_f32 v39, v39
    v_mfma_f32_16x16x32_bf16 v[92:95], v[124:127], a[172:175], v[92:95]
    v_bitop3_b32 v59, v59, v63, s68 bitop3:0x7e
    s_waitcnt lgkmcnt(0)
    v_mfma_f32_16x16x32_bf16 v[92:95], v[128:131], a[180:183], v[92:95]
    ds_read_b128 v[104:107], v14 offset:34816
    v_bitop3_b32 v59, v59, v67, s68 bitop3:0xf6
    v_mfma_f32_16x16x32_bf16 v[92:95], v[132:135], a[188:191], v[92:95]
    ds_read_b128 v[108:111], v14 offset:38912
    v_cmp_ne_u32 vcc, 0, v59
    v_mfma_f32_16x16x32_bf16 v[88:91], v[132:135], a[184:187], v[88:91]
    ds_read_b128 v[112:115], v14 offset:43008
    v_fma_f32 v180, v180, v36, v160
    v_mfma_f32_16x16x32_bf16 v[88:91], v[128:131], a[176:179], v[88:91]
    ds_read_b128 v[116:119], v14 offset:47104
    buffer_load_dwordx4 v[72:75], v136, s[44:47], s12 offen offset:0 sc1
    s_cbranch_vccnz L_xs_b
L_xo_b:
    v_mfma_f32_16x16x32_bf16 v[88:91], v[124:127], a[168:171], v[88:91]
    v_and_b32 v41, 0xffff0000, v56
    v_lshlrev_b32 v40, 16, v56
    v_mfma_f32_16x16x32_bf16 v[88:91], v[120:123], a[160:163], v[88:91]
    buffer_load_dwordx4 v[76:79], v136, s[44:47], s12 offen offset:1024 sc1
    s_waitcnt lgkmcnt(2)
    v_mfma_f32_16x16x32_bf16 v[96:99], v[104:107], a[160:163], v[96:99]
    v_and_b32 v43, 0xffff0000, v57
    v_fma_f32 v181, v181, v37, v161
    v_mfma_f32_16x16x32_bf16 v[96:99], v[108:111], a[168:171], v[96:99]
    v_lshlrev_b32 v42, 16, v57
    s_waitcnt lgkmcnt(0)
    v_mfma_f32_16x16x32_bf16 v[96:99], v[112:115], a[176:179], v[96:99]
    ds_read_b128 v[120:123], v14 offset:35840
    buffer_load_dwordx4 v[80:83], v136, s[44:47], s12 offen offset:2048 sc1
    v_mfma_f32_16x16x32_bf16 v[96:99], v[116:119], a[184:187], v[96:99]
    ds_read_b128 v[124:127], v14 offset:39936
    v_and_b32 v45, 0xffff0000, v58
    v_mfma_f32_16x16x32_bf16 v[100:103], v[116:119], a[188:191], v[100:103]
    ds_read_b128 v[128:131], v14 offset:44032
    v_lshlrev_b32 v44, 16, v58
    v_mfma_f32_16x16x32_bf16 v[100:103], v[112:115], a[180:183], v[100:103]
    ds_read_b128 v[132:135], v14 offset:48128
    v_and_b32 v47, 0xffff0000, v60
    v_mfma_f32_16x16x32_bf16 v[100:103], v[108:111], a[172:175], v[100:103]
    v_lshlrev_b32 v46, 16, v60
    v_fma_f32 v182, v182, v38, v162
    v_mfma_f32_16x16x32_bf16 v[100:103], v[104:107], a[164:167], v[100:103]
    v_and_b32 v49, 0xffff0000, v61
    s_waitcnt lgkmcnt(2)
    v_mfma_f32_16x16x32_bf16 v[92:95], v[120:123], a[196:199], v[92:95]
    v_lshlrev_b32 v48, 16, v61
    v_fma_f32 v183, v183, v39, v163
    v_mfma_f32_16x16x32_bf16 v[92:95], v[124:127], a[204:207], v[92:95]
    v_and_b32 v51, 0xffff0000, v62
    s_waitcnt lgkmcnt(0)
    v_mfma_f32_16x16x32_bf16 v[92:95], v[128:131], a[212:215], v[92:95]
    s_waitcnt vmcnt(4)
    s_barrier
    v_lshlrev_b32 v50, 16, v62
    v_mfma_f32_16x16x32_bf16 v[92:95], v[132:135], a[220:223], v[92:95]
    ds_read_b128 v[104:107], v14 offset:49152
    v_cvt_pk_bf16_f32 v142, v180, v181
    v_mfma_f32_16x16x32_bf16 v[88:91], v[132:135], a[216:219], v[88:91]
    ds_read_b128 v[108:111], v14 offset:53248
    v_and_b32 v53, 0xffff0000, v64
    v_mfma_f32_16x16x32_bf16 v[88:91], v[128:131], a[208:211], v[88:91]
    ds_read_b128 v[112:115], v14 offset:57344
    v_lshlrev_b32 v52, 16, v64
    v_mfma_f32_16x16x32_bf16 v[88:91], v[124:127], a[200:203], v[88:91]
    ds_read_b128 v[116:119], v14 offset:61440
    v_and_b32 v55, 0xffff0000, v65
    v_mfma_f32_16x16x32_bf16 v[88:91], v[120:123], a[192:195], v[88:91]
    v_lshlrev_b32 v54, 16, v65
    v_cvt_pk_bf16_f32 v143, v182, v183
    s_waitcnt lgkmcnt(2)
    v_mfma_f32_16x16x32_bf16 v[96:99], v[104:107], a[192:195], v[96:99]
    v_mfma_f32_16x16x32_bf16 v[96:99], v[108:111], a[200:203], v[96:99]
    s_waitcnt lgkmcnt(0)
    v_mfma_f32_16x16x32_bf16 v[96:99], v[112:115], a[208:211], v[96:99]
    ds_read_b128 v[120:123], v14 offset:50176
    v_add_f32 v92, v92, v44
    v_add_f32 v93, v93, v45
    v_mfma_f32_16x16x32_bf16 v[96:99], v[116:119], a[216:219], v[96:99]
    ds_read_b128 v[124:127], v14 offset:54272
    v_add_f32 v94, v94, v46
    v_mfma_f32_16x16x32_bf16 v[100:103], v[116:119], a[220:223], v[100:103]
    ds_read_b128 v[128:131], v14 offset:58368
    v_add_f32 v95, v95, v47
    v_add_f32 v88, v88, v40
    v_mfma_f32_16x16x32_bf16 v[100:103], v[112:115], a[212:215], v[100:103]
    ds_read_b128 v[132:135], v14 offset:62464
    v_add_f32 v89, v89, v41
    v_mfma_f32_16x16x32_bf16 v[100:103], v[108:111], a[204:207], v[100:103]
    v_add_f32 v90, v90, v42
    v_add_f32 v91, v91, v43
    v_mfma_f32_16x16x32_bf16 v[100:103], v[104:107], a[196:199], v[100:103]
    s_waitcnt lgkmcnt(2)
    v_mfma_f32_16x16x32_bf16 v[92:95], v[120:123], a[228:231], v[92:95]
    v_mfma_f32_16x16x32_bf16 v[92:95], v[124:127], a[236:239], v[92:95]
    s_waitcnt lgkmcnt(0)
    v_mfma_f32_16x16x32_bf16 v[92:95], v[128:131], a[244:247], v[92:95]
    ds_read_b128 v[104:107], v14 offset:51200
    v_add_f32 v96, v96, v48
    v_add_f32 v97, v97, v49
    v_mfma_f32_16x16x32_bf16 v[92:95], v[132:135], a[252:255], v[92:95]
    ds_read_b128 v[108:111], v14 offset:55296
    v_add_f32 v98, v98, v50
    v_mfma_f32_16x16x32_bf16 v[88:91], v[132:135], a[248:251], v[88:91]
    ds_read_b128 v[112:115], v14 offset:59392
    v_add_f32 v99, v99, v51
    v_add_f32 v100, v100, v52
    v_mfma_f32_16x16x32_bf16 v[88:91], v[128:131], a[240:243], v[88:91]
    ds_read_b128 v[116:119], v14 offset:63488
    v_add_f32 v101, v101, v53
    v_mfma_f32_16x16x32_bf16 v[88:91], v[124:127], a[232:235], v[88:91]
    v_add_f32 v102, v102, v54
    v_add_f32 v103, v103, v55
    v_mfma_f32_16x16x32_bf16 v[88:91], v[120:123], a[224:227], v[88:91]
    s_waitcnt lgkmcnt(2)
    v_mfma_f32_16x16x32_bf16 v[96:99], v[104:107], a[224:227], v[96:99]
    v_mfma_f32_16x16x32_bf16 v[96:99], v[108:111], a[232:235], v[96:99]
    s_waitcnt lgkmcnt(0)
    v_mfma_f32_16x16x32_bf16 v[96:99], v[112:115], a[240:243], v[96:99]
    ds_read_b128 v[120:123], v14 offset:52224
    v_mfma_f32_16x16x32_bf16 v[96:99], v[116:119], a[248:251], v[96:99]
    ds_read_b128 v[124:127], v14 offset:56320
    v_mfma_f32_16x16x32_bf16 v[100:103], v[116:119], a[252:255], v[100:103]
    buffer_store_dwordx2 v[142:143], v253, s[64:67], 0 offen sc1
    ds_read_b128 v[128:131], v14 offset:60416
    v_mfma_f32_16x16x32_bf16 v[100:103], v[112:115], a[244:247], v[100:103]
    ds_read_b128 v[132:135], v14 offset:64512
    v_mfma_f32_16x16x32_bf16 v[100:103], v[108:111], a[236:239], v[100:103]
    v_mfma_f32_16x16x32_bf16 v[100:103], v[104:107], a[228:231], v[100:103]
    s_waitcnt lgkmcnt(2)
    v_mfma_f32_16x16x32_bf16 v[92:95], v[120:123], v[224:227], v[92:95]
    v_mfma_f32_16x16x32_bf16 v[92:95], v[124:127], v[232:235], v[92:95]
    s_waitcnt lgkmcnt(0)
    v_mfma_f32_16x16x32_bf16 v[92:95], v[128:131], v[240:243], v[92:95]
    s_waitcnt vmcnt(4)
    s_barrier
    v_mfma_f32_16x16x32_bf16 v[92:95], v[132:135], v[248:251], v[92:95]
    ds_read_b128 v[104:107], v14 offset:0
    v_mfma_f32_16x16x32_bf16 v[88:91], v[132:135], v[244:247], v[88:91]
    ds_read_b128 v[108:111], v14 offset:4096
    v_mfma_f32_16x16x32_bf16 v[88:91], v[128:131], v[236:239], v[88:91]
    ds_read_b128 v[112:115], v14 offset:8192
    v_mfma_f32_16x16x32_bf16 v[88:91], v[124:127], v[228:231], v[88:91]
    ds_read_b128 v[116:119], v14 offset:12288
    v_mfma_f32_16x16x32_bf16 v[88:91], v[120:123], v[220:223], v[88:91]
    s_waitcnt lgkmcnt(2)
    v_mfma_f32_16x16x32_bf16 v[96:99], v[104:107], v[220:223], v[96:99]
    v_mfma_f32_16x16x32_bf16 v[96:99], v[108:111], v[228:231], v[96:99]
    s_waitcnt lgkmcnt(0)
    v_mfma_f32_16x16x32_bf16 v[96:99], v[112:115], v[236:239], v[96:99]
    v_mfma_f32_16x16x32_bf16 v[96:99], v[116:119], v[244:247], v[96:99]
    v_mfma_f32_16x16x32_bf16 v[100:103], v[116:119], v[248:251], v[100:103]
    v_mfma_f32_16x16x32_bf16 v[100:103], v[112:115], v[240:243], v[100:103]
    v_mfma_f32_16x16x32_bf16 v[100:103], v[108:111], v[232:235], v[100:103]
    v_mfma_f32_16x16x32_bf16 v[100:103], v[104:107], v[224:227], v[100:103]
    s_waitcnt vmcnt(1)
    v_bitop3_b32 v75, v75, v79, s68 bitop3:0x7e
    v_bitop3_b32 v75, v75, v83, s68 bitop3:0xf6
    v_cmp_ne_u32 vcc, 0, v75
    s_cbranch_vccnz L_xs_z
L_xo_z:
    v_and_b32 v41, 0xffff0000, v72
    v_lshlrev_b32 v40, 16, v72
    v_and_b32 v43, 0xffff0000, v73
    v_lshlrev_b32 v42, 16, v73
    v_and_b32 v45, 0xffff0000, v74
    v_lshlrev_b32 v44, 16, v74
    v_and_b32 v47, 0xffff0000, v76
    v_lshlrev_b32 v46, 16, v76
    v_and_b32 v49, 0xffff0000, v77
    v_lshlrev_b32 v48, 16, v77
    v_and_b32 v51, 0xffff0000, v78
    v_lshlrev_b32 v50, 16, v78
    v_and_b32 v53, 0xffff0000, v80
    v_lshlrev_b32 v52, 16, v80
    v_and_b32 v55, 0xffff0000, v81
    v_lshlrev_b32 v54, 16, v81
    v_pk_add_f32 v[88:89], v[88:89], v[40:41]
    v_pk_add_f32 v[90:91], v[90:91], v[42:43]
    v_pk_add_f32 v[96:97], v[96:97], v[48:49]
    v_pk_add_f32 v[98:99], v[98:99], v[50:51]
    v_pk_mul_f32 v[56:57], v[88:89], s[38:39] op_sel_hi:[1,0]
    v_pk_mul_f32 v[58:59], v[90:91], s[38:39] op_sel_hi:[1,0]
    v_pk_mul_f32 v[64:65], v[96:97], s[38:39] op_sel_hi:[1,0]
    v_pk_mul_f32 v[66:67], v[98:99], s[38:39] op_sel_hi:[1,0]
    v_exp_f32 v56, v56
    v_exp_f32 v57, v57
    v_exp_f32 v58, v58
    v_exp_f32 v59, v59
    v_exp_f32 v64, v64
    v_exp_f32 v65, v65
    v_exp_f32 v66, v66
    v_exp_f32 v67, v67
    v_pk_mul_f32 v[164:165], v[164:165], v[88:89]
    v_pk_mul_f32 v[166:167], v[166:167], v[90:91]
    v_pk_mul_f32 v[172:173], v[172:173], v[96:97]
    v_pk_mul_f32 v[174:175], v[174:175], v[98:99]
    v_pk_add_f32 v[56:57], v[56:57], 1.0 op_sel_hi:[1,0]
    v_pk_add_f32 v[58:59], v[58:59], 1.0 op_sel_hi:[1,0]
    v_pk_add_f32 v[64:65], v[64:65], 1.0 op_sel_hi:[1,0]
    v_pk_add_f32 v[66:67], v[66:67], 1.0 op_sel_hi:[1,0]
    v_rcp_f32 v56, v56
    v_rcp_f32 v57, v57
    v_rcp_f32 v58, v58
    v_rcp_f32 v59, v59
    v_rcp_f32 v64, v64
    v_rcp_f32 v65, v65
    v_rcp_f32 v66, v66
    v_rcp_f32 v67, v67
    v_pk_fma_f32 v[164:165], v[164:165], v[56:57], v[144:145]
    v_pk_fma_f32 v[166:167], v[166:167], v[58:59], v[146:147]
    v_pk_fma_f32 v[172:173], v[172:173], v[64:65], v[152:153]
    v_pk_fma_f32 v[174:175], v[174:175], v[66:67], v[154:155]
    v_cvt_pk_bf16_f32 v88, v164, v165
    v_cvt_pk_bf16_f32 v90, v172, v173
    v_cvt_pk_bf16_f32 v89, v166, v167
    v_cvt_pk_bf16_f32 v91, v174, v175
    v_permlane16_swap_b32 v88, v90
    s_nop 0
    v_permlane16_swap_b32 v89, v91
    buffer_store_dwordx4 v[88:91], v252, s[64:67], 0 offen sc1
    v_pk_add_f32 v[92:93], v[92:93], v[44:45]
    v_pk_add_f32 v[94:95], v[94:95], v[46:47]
    v_pk_add_f32 v[100:101], v[100:101], v[52:53]
    v_pk_add_f32 v[102:103], v[102:103], v[54:55]
    v_pk_mul_f32 v[60:61], v[92:93], s[38:39] op_sel_hi:[1,0]
    v_pk_mul_f32 v[62:63], v[94:95], s[38:39] op_sel_hi:[1,0]
    v_pk_mul_f32 v[68:69], v[100:101], s[38:39] op_sel_hi:[1,0]
    v_pk_mul_f32 v[70:71], v[102:103], s[38:39] op_sel_hi:[1,0]
    v_exp_f32 v60, v60
    v_exp_f32 v61, v61
    v_exp_f32 v62, v62
    v_exp_f32 v63, v63
    v_exp_f32 v68, v68
    v_exp_f32 v69, v69
    v_exp_f32 v70, v70
    v_exp_f32 v71, v71
    v_pk_mul_f32 v[168:169], v[168:169], v[92:93]
    v_pk_mul_f32 v[170:171], v[170:171], v[94:95]
    v_pk_mul_f32 v[176:177], v[176:177], v[100:101]
    v_pk_mul_f32 v[178:179], v[178:179], v[102:103]
    v_pk_add_f32 v[60:61], v[60:61], 1.0 op_sel_hi:[1,0]
    v_pk_add_f32 v[62:63], v[62:63], 1.0 op_sel_hi:[1,0]
    v_pk_add_f32 v[68:69], v[68:69], 1.0 op_sel_hi:[1,0]
    v_pk_add_f32 v[70:71], v[70:71], 1.0 op_sel_hi:[1,0]
    v_rcp_f32 v60, v60
    v_rcp_f32 v61, v61
    v_rcp_f32 v62, v62
    v_rcp_f32 v63, v63
    v_rcp_f32 v68, v68
    v_rcp_f32 v69, v69
    v_rcp_f32 v70, v70
    v_rcp_f32 v71, v71
    v_pk_fma_f32 v[168:169], v[168:169], v[60:61], v[148:149]
    v_pk_fma_f32 v[170:171], v[170:171], v[62:63], v[150:151]
    v_pk_fma_f32 v[176:177], v[176:177], v[68:69], v[156:157]
    v_pk_fma_f32 v[178:179], v[178:179], v[70:71], v[158:159]
    v_cvt_pk_bf16_f32 v92, v168, v169
    v_cvt_pk_bf16_f32 v94, v176, v177
    v_cvt_pk_bf16_f32 v93, v170, v171
    v_cvt_pk_bf16_f32 v95, v178, v179
    v_permlane16_swap_b32 v92, v94
    s_nop 0
    v_permlane16_swap_b32 v93, v95
    buffer_store_dwordx4 v[92:95], v252, s[64:67], s40 offen sc1
    s_endpgm
L_segE:
.p2align 12
L_aux:
    s_mul_i32 s84, s101, 14
    s_lshr_b32 s84, s84, 2
    s_add_u32 s84, s84, 0
    s_add_u32 s85, s84, 1
    s_cmp_eq_u32 s85, 14
    s_cselect_b32 s85, 0, s85
    s_add_u32 s86, s85, 1
    s_cmp_eq_u32 s86, 14
    s_cselect_b32 s86, 0, s86
    s_add_u32 s87, s86, 1
    s_cmp_eq_u32 s87, 14
    s_cselect_b32 s87, 0, s87
    s_add_u32 s88, s87, 1
    s_cmp_eq_u32 s88, 14
    s_cselect_b32 s88, 0, s88
    s_add_u32 s89, s88, 1
    s_cmp_eq_u32 s89, 14
    s_cselect_b32 s89, 0, s89
    s_add_u32 s90, s89, 1
    s_cmp_eq_u32 s90, 14
    s_cselect_b32 s90, 0, s90
    s_add_u32 s91, s90, 1
    s_cmp_eq_u32 s91, 14
    s_cselect_b32 s91, 0, s91
    s_add_u32 s92, s91, 1
    s_cmp_eq_u32 s92, 14
    s_cselect_b32 s92, 0, s92
    s_add_u32 s93, s92, 1
    s_cmp_eq_u32 s93, 14
    s_cselect_b32 s93, 0, s93
    s_add_u32 s94, s93, 1
    s_cmp_eq_u32 s94, 14
    s_cselect_b32 s94, 0, s94
    s_add_u32 s95, s94, 1
    s_cmp_eq_u32 s95, 14
    s_cselect_b32 s95, 0, s95
    s_add_u32 s96, s95, 1
    s_cmp_eq_u32 s96, 14
    s_cselect_b32 s96, 0, s96
    s_add_u32 s97, s96, 1
    s_cmp_eq_u32 s97, 14
    s_cselect_b32 s97, 0, s97
    s_mul_i32 s98, s101, 4
    s_lshr_b32 s98, s98, 2
    s_add_u32 s98, s98, 14
    s_add_u32 s99, s98, 1
    s_cmp_eq_u32 s99, 18
    s_cselect_b32 s99, 14, s99
    s_add_u32 s100, s99, 1
    s_cmp_eq_u32 s100, 18
    s_cselect_b32 s100, 14, s100
    s_add_u32 s101, s100, 1
    s_cmp_eq_u32 s101, 18
    s_cselect_b32 s101, 14, s101
    s_lshl2_add_u32 s7, s5, s6
    s_add_u32 s7, s7, 188
    s_add_u32 s8, s5, 248
    s_cmp_eq_u32 s6, 27
    s_cselect_b32 s75, s8, s7
    s_mov_b32 s48, s24
    s_and_b32 s49, s25, 0xffff
    s_mov_b32 s50, 2359296
    s_mov_b32 s51, 0x20000
    v_lshlrev_b32 v240, 4, v2
    s_mul_i32 s74, s3, 16640
    s_add_u32 s74, s74, 73728
    s_sub_u32 s69, s75, 216
    s_lshl_b32 s70, s69, 4
    s_add_u32 s70, s70, s3
    s_lshl_b32 s12, s70, 12
    s_lshl_b32 s70, s70, 1
    v_lshrrev_b32 v242, 5, v2
    v_and_b32 v243, 31, v2
    v_lshlrev_b32 v242, 14, v242
    v_lshl_add_u32 v242, v243, 7, v242
    s_add_u32 s13, s12, 32768
    s_mov_b32 s9, 144896
    s_mov_b32 s11, 114688
    s_waitcnt vmcnt(9)
    v_and_b32 v21, 0xffff0000, v8
    v_lshlrev_b32 v20, 16, v8
    v_and_b32 v23, 0xffff0000, v9
    v_lshlrev_b32 v22, 16, v9
    v_and_b32 v25, 0xffff0000, v10
    v_lshlrev_b32 v24, 16, v10
    v_and_b32 v27, 0xffff0000, v12
    v_lshlrev_b32 v26, 16, v12
    v_and_b32 v29, 0xffff0000, v13
    v_lshlrev_b32 v28, 16, v13
    v_and_b32 v31, 0xffff0000, v14
    v_lshlrev_b32 v30, 16, v14
    v_and_b32 v33, 0xffff0000, v16
    v_lshlrev_b32 v32, 16, v16
    v_and_b32 v35, 0xffff0000, v17
    v_lshlrev_b32 v34, 16, v17
    v_and_b32 v37, 0xffff0000, v18
    v_lshlrev_b32 v36, 16, v18
    v_pk_add_f32 v[38:39], v[20:21], v[22:23]
    v_pk_add_f32 v[40:41], v[24:25], v[26:27]
    v_pk_add_f32 v[42:43], v[28:29], v[30:31]
    v_pk_add_f32 v[44:45], v[32:33], v[34:35]
    v_pk_add_f32 v[38:39], v[38:39], v[40:41]
    v_pk_add_f32 v[42:43], v[42:43], v[44:45]
    v_pk_add_f32 v[38:39], v[38:39], v[36:37]
    v_pk_add_f32 v[38:39], v[38:39], v[42:43]
    v_add_f32 v56, v38, v39
    s_nop 1
    v_add_f32_dpp v56, v56, v56 row_ror:8 row_mask:0xf bank_mask:0xf
    s_nop 1
    v_add_f32_dpp v56, v56, v56 row_ror:4 row_mask:0xf bank_mask:0xf
    s_nop 1
    v_add_f32_dpp v56, v56, v56 row_ror:2 row_mask:0xf bank_mask:0xf
    s_nop 1
    v_add_f32_dpp v56, v56, v56 row_ror:1 row_mask:0xf bank_mask:0xf
    v_mov_b32 v57, v56
    s_nop 1
    v_permlane16_swap_b32 v56, v57
    v_add_f32 v56, v56, v57
    v_mul_f32 v56, 0x3ae38e39, v56
    v_pk_add_f32 v[20:21], v[20:21], v[56:57] op_sel_hi:[1,0] neg_lo:[0,1] neg_hi:[0,1]
    v_pk_add_f32 v[22:23], v[22:23], v[56:57] op_sel_hi:[1,0] neg_lo:[0,1] neg_hi:[0,1]
    v_pk_add_f32 v[24:25], v[24:25], v[56:57] op_sel_hi:[1,0] neg_lo:[0,1] neg_hi:[0,1]
    v_pk_add_f32 v[26:27], v[26:27], v[56:57] op_sel_hi:[1,0] neg_lo:[0,1] neg_hi:[0,1]
    v_pk_add_f32 v[28:29], v[28:29], v[56:57] op_sel_hi:[1,0] neg_lo:[0,1] neg_hi:[0,1]
    v_pk_add_f32 v[30:31], v[30:31], v[56:57] op_sel_hi:[1,0] neg_lo:[0,1] neg_hi:[0,1]
    v_pk_add_f32 v[32:33], v[32:33], v[56:57] op_sel_hi:[1,0] neg_lo:[0,1] neg_hi:[0,1]
    v_pk_add_f32 v[34:35], v[34:35], v[56:57] op_sel_hi:[1,0] neg_lo:[0,1] neg_hi:[0,1]
    v_pk_add_f32 v[36:37], v[36:37], v[56:57] op_sel_hi:[1,0] neg_lo:[0,1] neg_hi:[0,1]
    v_pk_mul_f32 v[38:39], v[20:21], v[20:21]
    v_pk_mul_f32 v[40:41], v[22:23], v[22:23]
    v_pk_fma_f32 v[38:39], v[24:25], v[24:25], v[38:39]
    v_pk_fma_f32 v[40:41], v[26:27], v[26:27], v[40:41]
    v_pk_fma_f32 v[38:39], v[28:29], v[28:29], v[38:39]
    v_pk_fma_f32 v[40:41], v[30:31], v[30:31], v[40:41]
    v_pk_fma_f32 v[38:39], v[32:33], v[32:33], v[38:39]
    v_pk_fma_f32 v[40:41], v[34:35], v[34:35], v[40:41]
    v_pk_fma_f32 v[38:39], v[36:37], v[36:37], v[38:39]
    v_pk_add_f32 v[38:39], v[38:39], v[40:41]
    v_add_f32 v18, v38, v39
    s_nop 1
    v_add_f32_dpp v18, v18, v18 row_ror:8 row_mask:0xf bank_mask:0xf
    s_nop 1
    v_add_f32_dpp v18, v18, v18 row_ror:4 row_mask:0xf bank_mask:0xf
    s_nop 1
    v_add_f32_dpp v18, v18, v18 row_ror:2 row_mask:0xf bank_mask:0xf
    s_nop 1
    v_add_f32_dpp v18, v18, v18 row_ror:1 row_mask:0xf bank_mask:0xf
    v_mov_b32 v19, v18
    s_nop 1
    v_permlane16_swap_b32 v18, v19
    v_add_f32 v18, v18, v19
    v_mul_f32 v18, 0x3ae38e39, v18
    v_cvt_pk_bf16_f32 v38, v56, v18
    v_lshlrev_b32 v106, 16, v38
    v_and_b32 v38, 0xffff0000, v38
    v_add_f32 v38, 0x3727c5ac, v38
    v_sub_f32 v56, v56, v106
    v_cvt_pk_bf16_f32 v38, v38, v38
    v_lshlrev_b32 v38, 16, v38
    v_sqrt_f32 v38, v38
    s_nop 0
    v_cvt_pk_bf16_f32 v38, v38, v38
    v_lshlrev_b32 v38, 16, v38
    v_rcp_f32 v107, v38
    s_nop 0
    v_mul_f32 v56, v56, v107
    v_mul_f32 v18, v18, v107
    v_mul_f32 v18, v18, v107
    v_cvt_pk_bf16_f32 v38, v56, v18
    v_lshlrev_b32 v39, 16, v38
    v_and_b32 v38, 0xffff0000, v38
    v_add_f32 v38, 0x3727c5ac, v38
    v_sub_f32 v56, v56, v39
    v_cvt_pk_bf16_f32 v38, v38, v38
    v_lshlrev_b32 v38, 16, v38
    v_sqrt_f32 v38, v38
    s_nop 0
    v_cvt_pk_bf16_f32 v38, v38, v38
    v_lshlrev_b32 v38, 16, v38
    v_rcp_f32 v38, v38
    s_nop 0
    v_mul_f32 v18, v107, v38
    v_mul_f32 v56, v56, v38
    v_pk_fma_f32 v[20:21], v[20:21], v[18:19], v[56:57] op_sel_hi:[1,0,0]
    v_pk_fma_f32 v[22:23], v[22:23], v[18:19], v[56:57] op_sel_hi:[1,0,0]
    v_pk_fma_f32 v[24:25], v[24:25], v[18:19], v[56:57] op_sel_hi:[1,0,0]
    v_pk_fma_f32 v[26:27], v[26:27], v[18:19], v[56:57] op_sel_hi:[1,0,0]
    v_pk_fma_f32 v[28:29], v[28:29], v[18:19], v[56:57] op_sel_hi:[1,0,0]
    v_pk_fma_f32 v[30:31], v[30:31], v[18:19], v[56:57] op_sel_hi:[1,0,0]
    v_pk_fma_f32 v[32:33], v[32:33], v[18:19], v[56:57] op_sel_hi:[1,0,0]
    v_pk_fma_f32 v[34:35], v[34:35], v[18:19], v[56:57] op_sel_hi:[1,0,0]
    v_pk_fma_f32 v[36:37], v[36:37], v[18:19], v[56:57] op_sel_hi:[1,0,0]
    v_cvt_pk_bf16_f32 v8, v20, v21
    v_cvt_pk_bf16_f32 v9, v22, v23
    v_cvt_pk_bf16_f32 v10, v24, v25
    v_cvt_pk_bf16_f32 v11, v26, v27
    v_cvt_pk_bf16_f32 v12, v28, v29
    v_cvt_pk_bf16_f32 v13, v30, v31
    v_cvt_pk_bf16_f32 v14, v32, v33
    v_cvt_pk_bf16_f32 v15, v34, v35
    v_cvt_pk_bf16_f32 v16, v36, v37
    v_lshrrev_b32 v3, 5, v0
    v_and_b32 v1, 31, v0
    v_mul_u32_u24 v17, 1216, v3
    v_mad_u32_u24 v17, v1, 12, v17
    v_add_u32 v17, 144896, v17
    ds_write_b32 v17, v8 offset:0
    ds_write_b32 v17, v9 offset:4
    ds_write_b32 v17, v10 offset:8
    ds_write_b32 v17, v11 offset:384
    ds_write_b32 v17, v12 offset:388
    ds_write_b32 v17, v13 offset:392
    ds_write_b32 v17, v14 offset:768
    ds_write_b32 v17, v15 offset:772
    ds_write_b32 v17, v16 offset:776
    v_lshlrev_b32 v3, 3, v3
    s_lshl_b32 s5, s68, 6
    s_add_u32 s5, s5, 12386304
    v_cmp_eq_u32 vcc, 0, v1
    v_mov_b32 v18, 0x40000000
    s_nop 0
    v_cndmask_b32 v3, v18, v3, vcc
    buffer_store_dwordx2 v[106:107], v3, s[44:47], s5 offen sc1
    v_lshrrev_b32 v19, 4, v0
    v_and_b32 v17, 3, v2
    v_lshlrev_b32 v17, 3, v17
    v_lshl_add_u32 v19, v19, 5, v17
    v_bfe_u32 v6, v2, 2, 2
    v_mul_u32_u24 v17, 1216, v6
    v_mul_u32_u24 v6, 1152, v6
    v_add3_u32 v17, v17, v19, s9
    v_add3_u32 v6, v6, v19, s11
    v_lshlrev_b32 v19, 4, v0
    s_add_u32 s7, s15, 4096
    s_add_u32 s8, s15, 8192
    s_cmp_eq_u32 s3, 0
    s_cselect_b32 s8, s8, 0x40000000
    v_add_u32 v18, 2359296, v19
    v_mov_b32 v44, 0
    s_waitcnt lgkmcnt(0)
    s_barrier
    ds_read_b64_tr_b16 v[20:21], v17 offset:0
    ds_read_b64_tr_b16 v[22:23], v17 offset:4864
    ds_read_b64_tr_b16 v[24:25], v17 offset:512
    ds_read_b64_tr_b16 v[26:27], v17 offset:5376
    ds_read_b64_tr_b16 v[28:29], v17 offset:1024
    ds_read_b64_tr_b16 v[30:31], v17 offset:5888
    s_bfe_u32 s6, s68, 0x20001
    s_lshl_b32 s6, s6, 6
    s_lshr_b32 s9, s68, 3
    s_lshl_b32 s9, s9, 1
    s_add_u32 s6, s6, s9
    s_and_b32 s9, s68, 1
    s_add_u32 s6, s6, s9
    s_lshl_b32 s4, s6, 2
    s_add_u32 s4, s4, 12533760
    v_lshl_add_u32 v1, v0, 10, s4
    v_add_u32 v46, 65536, v1
    v_mov_b32 v47, 0x40000000
    v_cmp_gt_u32 vcc, 8, v0
    s_nop 1
    v_cndmask_b32 v1, v47, v1, vcc
    v_cmp_gt_u32 vcc, 4, v0
    s_nop 1
    v_cndmask_b32 v46, v47, v46, vcc
    s_waitcnt lgkmcnt(4)
    buffer_store_dwordx4 v[20:23], v19, s[44:47], s15 offen sc1
    s_waitcnt lgkmcnt(2)
    buffer_store_dwordx4 v[24:27], v19, s[44:47], s7 offen sc1
    s_waitcnt lgkmcnt(0)
    buffer_store_dwordx4 v[28:31], v19, s[44:47], s8 offen sc1
    buffer_load_dword v45, v44, s[64:67], 0 offen sc1
    s_waitcnt vmcnt(6)
    s_barrier
    ds_read_b64_tr_b16 v[60:61], v6 offset:0
    ds_read_b64_tr_b16 v[62:63], v6 offset:4608
    ds_read_b64_tr_b16 v[64:65], v6 offset:9216
    ds_read_b64_tr_b16 v[66:67], v6 offset:12672
    ds_read_b64_tr_b16 v[68:69], v6 offset:17280
    ds_read_b64_tr_b16 v[70:71], v6 offset:512
    ds_read_b64_tr_b16 v[72:73], v6 offset:5120
    ds_read_b64_tr_b16 v[74:75], v6 offset:9728
    ds_read_b64_tr_b16 v[76:77], v6 offset:13184
    ds_read_b64_tr_b16 v[78:79], v6 offset:17792
    v_alignbit_b32 v114, v99, v99, 16
    v_alignbit_b32 v115, v98, v98, 16
    s_waitcnt lgkmcnt(5)
    v_alignbit_b32 v108, v61, v60, 16
    v_alignbit_b32 v109, v62, v61, 16
    v_alignbit_b32 v110, v63, v62, 16
    v_alignbit_b32 v111, v64, v63, 16
    v_alignbit_b32 v112, v65, v64, 16
    v_dot2_f32_bf16 v116, v60, v114, 0
    ds_read_b64_tr_b16 v[80:81], v6 offset:1024
    v_dot2_f32_bf16 v117, v108, v114, 0
    v_dot2_f32_bf16 v118, v61, v114, 0
    v_dot2_f32_bf16 v119, v109, v114, 0
    v_dot2_f32_bf16 v120, v62, v114, 0
    ds_read_b64_tr_b16 v[82:83], v6 offset:5632
    v_dot2_f32_bf16 v121, v110, v114, 0
    v_dot2_f32_bf16 v122, v63, v114, 0
    v_dot2_f32_bf16 v123, v111, v114, 0
    v_dot2_f32_bf16 v116, v61, v115, v116
    v_dot2_f32_bf16 v117, v109, v115, v117
    ds_read_b64_tr_b16 v[84:85], v6 offset:10240
    v_dot2_f32_bf16 v118, v62, v115, v118
    v_dot2_f32_bf16 v119, v110, v115, v119
    v_dot2_f32_bf16 v120, v63, v115, v120
    v_dot2_f32_bf16 v121, v111, v115, v121
    v_dot2_f32_bf16 v122, v64, v115, v122
    ds_read_b64_tr_b16 v[86:87], v6 offset:13696
    v_dot2_f32_bf16 v123, v112, v115, v123
    v_and_b32 v133, 0xffff0000, v66
    v_lshlrev_b32 v132, 16, v66
    v_and_b32 v135, 0xffff0000, v67
    v_lshlrev_b32 v134, 16, v67
    ds_read_b64_tr_b16 v[88:89], v6 offset:18304
    v_and_b32 v137, 0xffff0000, v68
    v_lshlrev_b32 v136, 16, v68
    v_and_b32 v139, 0xffff0000, v69
    v_lshlrev_b32 v138, 16, v69
    v_pk_mul_f32 v[116:117], v[116:117], v[132:133]
    v_pk_mul_f32 v[118:119], v[118:119], v[134:135]
    v_pk_mul_f32 v[120:121], v[120:121], v[136:137]
    v_pk_mul_f32 v[122:123], v[122:123], v[138:139]
    v_cvt_pk_bf16_f32 v160, v123, v122
    v_cvt_pk_bf16_f32 v161, v121, v120
    v_cvt_pk_bf16_f32 v162, v119, v118
    v_cvt_pk_bf16_f32 v163, v117, v116
    buffer_store_dwordx4 v[160:163], v18, s[44:47], s15 offen sc1
    v_alignbit_b32 v114, v101, v101, 16
    v_alignbit_b32 v115, v100, v100, 16
    s_waitcnt lgkmcnt(5)
    v_alignbit_b32 v108, v71, v70, 16
    v_alignbit_b32 v109, v72, v71, 16
    v_alignbit_b32 v110, v73, v72, 16
    v_alignbit_b32 v111, v74, v73, 16
    v_alignbit_b32 v112, v75, v74, 16
    v_dot2_f32_bf16 v124, v70, v114, 0
    v_dot2_f32_bf16 v125, v108, v114, 0
    v_dot2_f32_bf16 v126, v71, v114, 0
    v_dot2_f32_bf16 v127, v109, v114, 0
    v_dot2_f32_bf16 v128, v72, v114, 0
    v_dot2_f32_bf16 v129, v110, v114, 0
    v_dot2_f32_bf16 v130, v73, v114, 0
    v_dot2_f32_bf16 v131, v111, v114, 0
    v_dot2_f32_bf16 v124, v71, v115, v124
    v_dot2_f32_bf16 v125, v109, v115, v125
    v_dot2_f32_bf16 v126, v72, v115, v126
    v_dot2_f32_bf16 v127, v110, v115, v127
    v_dot2_f32_bf16 v128, v73, v115, v128
    v_dot2_f32_bf16 v129, v111, v115, v129
    v_dot2_f32_bf16 v130, v74, v115, v130
    v_dot2_f32_bf16 v131, v112, v115, v131
    v_and_b32 v133, 0xffff0000, v76
    v_lshlrev_b32 v132, 16, v76
    v_and_b32 v135, 0xffff0000, v77
    v_lshlrev_b32 v134, 16, v77
    v_and_b32 v137, 0xffff0000, v78
    v_lshlrev_b32 v136, 16, v78
    v_and_b32 v139, 0xffff0000, v79
    v_lshlrev_b32 v138, 16, v79
    v_pk_mul_f32 v[124:125], v[124:125], v[132:133]
    v_pk_mul_f32 v[126:127], v[126:127], v[134:135]
    v_pk_mul_f32 v[128:129], v[128:129], v[136:137]
    v_pk_mul_f32 v[130:131], v[130:131], v[138:139]
    v_cvt_pk_bf16_f32 v164, v131, v130
    v_cvt_pk_bf16_f32 v165, v129, v128
    v_cvt_pk_bf16_f32 v166, v127, v126
    v_cvt_pk_bf16_f32 v167, v125, v124
    buffer_store_dwordx4 v[164:167], v18, s[44:47], s7 offen sc1
    v_alignbit_b32 v114, v103, v103, 16
    v_alignbit_b32 v115, v102, v102, 16
    s_waitcnt lgkmcnt(0)
    v_alignbit_b32 v108, v81, v80, 16
    v_alignbit_b32 v109, v82, v81, 16
    v_alignbit_b32 v110, v83, v82, 16
    v_alignbit_b32 v111, v84, v83, 16
    v_alignbit_b32 v112, v85, v84, 16
    v_dot2_f32_bf16 v116, v80, v114, 0
    v_dot2_f32_bf16 v117, v108, v114, 0
    v_dot2_f32_bf16 v118, v81, v114, 0
    v_dot2_f32_bf16 v119, v109, v114, 0
    v_dot2_f32_bf16 v120, v82, v114, 0
    v_dot2_f32_bf16 v121, v110, v114, 0
    v_dot2_f32_bf16 v122, v83, v114, 0
    v_dot2_f32_bf16 v123, v111, v114, 0
    v_dot2_f32_bf16 v116, v81, v115, v116
    v_dot2_f32_bf16 v117, v109, v115, v117
    v_dot2_f32_bf16 v118, v82, v115, v118
    v_dot2_f32_bf16 v119, v110, v115, v119
    v_dot2_f32_bf16 v120, v83, v115, v120
    v_dot2_f32_bf16 v121, v111, v115, v121
    v_dot2_f32_bf16 v122, v84, v115, v122
    v_dot2_f32_bf16 v123, v112, v115, v123
    v_and_b32 v133, 0xffff0000, v86
    v_lshlrev_b32 v132, 16, v86
    v_and_b32 v135, 0xffff0000, v87
    v_lshlrev_b32 v134, 16, v87
    v_and_b32 v137, 0xffff0000, v88
    v_lshlrev_b32 v136, 16, v88
    v_and_b32 v139, 0xffff0000, v89
    v_lshlrev_b32 v138, 16, v89
    v_pk_mul_f32 v[116:117], v[116:117], v[132:133]
    v_pk_mul_f32 v[118:119], v[118:119], v[134:135]
    v_pk_mul_f32 v[120:121], v[120:121], v[136:137]
    v_pk_mul_f32 v[122:123], v[122:123], v[138:139]
    v_cvt_pk_bf16_f32 v168, v123, v122
    v_cvt_pk_bf16_f32 v169, v121, v120
    v_cvt_pk_bf16_f32 v170, v119, v118
    v_cvt_pk_bf16_f32 v171, v117, v116
    buffer_store_dwordx4 v[168:171], v18, s[44:47], s8 offen sc1
    s_mov_b64 exec, 0
    s_call_b64 s[82:83], L_wc_X
    s_mov_b64 exec, -1
    s_waitcnt vmcnt(3)
    v_readfirstlane_b32 s68, v45
    s_nop 1
    s_cmp_eq_u32 s68, 0
    s_cbranch_scc1 L_nw_X
L_ng_X:
    s_barrier
    v_mov_b32 v3, s68
    buffer_store_dword v3, v1, s[44:47], 0 offen sc1
    v_mov_b32 v1, v46
    s_waitcnt vmcnt(1)
    s_barrier
    buffer_store_dword v3, v1, s[44:47], 0 offen sc1
    s_mov_b64 exec, 0
    s_call_b64 s[82:83], L_wc_D
    s_mov_b64 exec, -1
L_segX:
L_pl_X_0:
    s_cbranch_execz L_pl_X_4
    s_add_u32 m0, s74, 32
    s_add_u32 s13, s12, 0
    buffer_load_dwordx4 v240, s[48:51], s13 offen offset:0 lds
    buffer_load_dwordx4 v240, s[48:51], s13 offen offset:1024 lds
    buffer_load_dwordx4 v240, s[48:51], s13 offen offset:2048 lds
    buffer_load_dwordx4 v240, s[48:51], s13 offen offset:3072 lds
    s_mov_b32 s60, s36
    s_and_b32 s61, s37, 0xffff
    s_mov_b32 s62, 4096
    s_mov_b32 s63, 0x20000
    v_and_b32 v24, 15, v2
    s_lshl_b32 s7, s71, 6
    v_add_u32 v24, s7, v24
    s_and_b32 s8, s3, 1
    s_lshl_b32 s4, s8, 5
    v_add_u32 v25, s4, v24
    v_lshlrev_b32 v26, 3, v25
    v_mul_u32_u24 v25, 1152, v25
    v_bfe_u32 v31, v2, 4, 1
    v_lshl_add_u32 v25, v31, 5, v25
    v_lshrrev_b32 v31, 5, v2
    v_lshl_add_u32 v25, v31, 4, v25
    s_bfe_u32 s7, s2, 0x20003
    s_mul_i32 s7, s7, 288
    s_lshl_b32 s4, s72, 6
    s_add_u32 s4, s4, s7
    v_add_u32 v252, s4, v25
    s_xor_b32 s8, s3, s72
    s_and_b32 s4, s72, 1
    s_lshl1_add_u32 s4, s4, s8
    v_lshl_add_u32 v24, s4, 4, v24
    s_add_u32 s7, s7, 256
    s_cmp_lt_u32 s8, 2
    s_cselect_b32 s7, s7, 0x40000000
    v_lshlrev_b32 v18, 3, v24
    v_mul_u32_u24 v24, 1152, v24
    v_lshrrev_b32 v31, 4, v2
    v_lshl_add_u32 v24, v31, 3, v24
    v_add_u32 v253, s7, v24
    v_lshrrev_b32 v24, 3, v2
    v_and_b32 v25, 7, v2
    v_bfe_u32 v31, v2, 4, 2
    v_lshlrev_b32 v31, 1, v31
    v_xor_b32 v25, v25, v31
    v_lshlrev_b32 v24, 12, v24
    v_lshl_add_u32 v24, v25, 4, v24
    s_mul_i32 s7, s72, 36
    s_bitcmp1_b32 s3, 0
    s_addc_u32 s7, s7, 0
    s_lshl_b32 s7, s7, 17
    s_lshl_b32 s8, s71, 7
    s_add_u32 s7, s7, s8
    v_add_u32 v4, s7, v24
    v_add_u32 v5, 31744, v4
    v_add_u32 v6, 31744, v5
    v_add_u32 v7, 31744, v6
    v_lshrrev_b32 v24, 2, v2
    v_lshlrev_b32 v24, 7, v24
    v_and_b32 v25, 3, v2
    v_lshl_add_u32 v24, v25, 3, v24
    s_and_b32 s7, s73, 8192
    v_add_u32 v24, s7, v24
    v_bfe_u32 v31, v2, 3, 2
    s_and_b32 s7, s3, 1
    s_lshl_b32 s7, s7, 1
    v_xor_b32 v31, s7, v31
    v_lshl_add_u32 v10, v31, 5, v24
    v_xor_b32 v11, 32, v10
    v_and_b32 v24, 15, v2
    v_lshrrev_b32 v25, 4, v2
    v_mul_u32_u24 v25, 17408, v25
    v_lshl_add_u32 v24, v24, 4, v25
    s_mul_i32 s7, s72, 36
    s_and_b32 s8, s3, 1
    s_add_u32 s7, s7, s8
    s_mul_i32 s7, s7, 69632
    s_bfe_u32 s8, s2, 0x20003
    s_lshl_b32 s8, s8, 12
    s_add_u32 s7, s7, s8
    s_add_u32 s7, s7, 12795904
    v_add_u32 v23, s7, v24
    s_xor_b32 s7, s72, 0
    v_lshl_add_u32 v19, s7, 10, v23
    s_xor_b32 s7, s72, 1
    v_lshl_add_u32 v20, s7, 10, v23
    s_xor_b32 s7, s72, 2
    v_lshl_add_u32 v21, s7, 10, v23
    s_xor_b32 s7, s72, 3
    v_lshl_add_u32 v22, s7, 10, v23
    v_lshlrev_b32 v14, 4, v2
    v_add_u32 v14, 98304, v14
    v_add_u32 v1, 0x10000, v14
    s_cmp_lt_u32 s75, 252
    s_cbranch_scc0 L_idle
    s_mov_b32 s56, s26
    s_and_b32 s57, s27, 0xffff
    s_mov_b32 s58, 1152
    s_mov_b32 s59, 0x20000
    s_bitcmp1_b32 s3, 1
    s_cselect_b32 s18, s85, s84
    s_mul_i32 s18, s18, 139264
    s_cselect_b32 s19, s87, s86
    s_mul_i32 s19, s19, 139264
    s_cselect_b32 s20, s89, s88
    s_mul_i32 s20, s20, 139264
    s_cselect_b32 s21, s91, s90
    s_mul_i32 s21, s21, 139264
    s_cselect_b32 s22, s93, s92
    s_mul_i32 s22, s22, 139264
    s_cselect_b32 s23, s95, s94
    s_mul_i32 s23, s23, 139264
    s_cselect_b32 s24, s97, s96
    s_mul_i32 s24, s24, 139264
    s_cselect_b32 s25, s99, s98
    s_mul_i32 s25, s25, 139264
    s_cselect_b32 s26, s101, s100
    s_mul_i32 s26, s26, 139264
    v_mov_b32 v9, 0
    buffer_load_ushort v9, v9, s[56:59], s70 offen
    s_lshr_b32 s4, s2, 1
    s_and_b32 s4, s4, 3
    s_lshl2_add_u32 s4, s4, s3
    s_lshl_b32 s4, s4, 8
    s_add_u32 s4, s4, 12599296
    v_lshl_add_u32 v28, v2, 2, s4
    v_add_u32 v241, s74, v240
    v_cmp_eq_u32 vcc, 0, v2
    v_mov_b32 v196, 4136
    s_nop 0
    v_cndmask_b32 v196, v196, 30, vcc
    v_add_u32 v242, s74, v196
    v_bfe_u32 v196, v2, 3, 2
    v_mul_u32_u24 v196, 4160, v196
    v_and_b32 v197, 7, v2
    v_lshl_add_u32 v196, v197, 2, v196
    v_add_u32 v200, s74, v196
    v_mov_b32 v196, 0
    v_mov_b32 v197, 0
    v_mov_b32 v198, 0
    v_mov_b32 v199, 0
    ds_write_b32 v200, v196
    v_lshlrev_b32 v201, 4, v0
    ds_write_b128 v201, v[196:199]
    ds_write_b128 v201, v[196:199] offset:36864
    s_waitcnt vmcnt(1)
    ds_read_b128 v[212:215], v241 offset:32
    ds_read_b32 v216, v241 offset:48
    ds_read_b128 v[218:221], v241 offset:1056
    ds_read_b32 v222, v241 offset:1072
    ds_read_b128 v[224:227], v241 offset:2080
    ds_read_b32 v228, v241 offset:2096
    ds_read_b128 v[230:233], v241 offset:3104
    ds_read_b32 v234, v241 offset:3120
    v_lshrrev_b32 v202, 3, v2
    v_and_b32 v203, 7, v2
    v_lshrrev_b32 v204, 1, v202
    v_xor_b32 v203, v203, v204
    v_mul_u32_u24 v202, 9216, v202
    v_lshl_add_u32 v24, v203, 4, v202
    v_xor_b32 v25, 64, v24
    v_and_b32 v202, 15, v2
    v_add_u32 v202, 1, v202
    v_and_b32 v203, 1, v202
    v_mul_u32_u24 v203, 4160, v203
    v_lshrrev_b32 v202, 1, v202
    v_lshl_add_u32 v203, v202, 2, v203
    v_lshrrev_b32 v204, 4, v2
    v_lshl_add_u32 v203, v204, 4, v203
    v_add_u32 v236, s74, v203
    v_add_u32 v237, 1024, v236
    v_add_u32 v238, 1024, v237
    v_add_u32 v239, 1024, v238
    s_waitcnt lgkmcnt(0)
    s_waitcnt vmcnt(0)
    v_lshlrev_b32 v9, 16, v9
    v_lshlrev_b32 v208, 16, v212
    v_add_f32 v9, v9, v208
    v_cvt_pk_bf16_f32 v9, v9, v9
    ds_write_b16 v242, v9 offset:4160
    ds_write_b16 v242, v9 offset:2
    v_alignbit_b32 v212, v213, v212, 16
    v_alignbit_b32 v213, v214, v213, 16
    v_alignbit_b32 v214, v215, v214, 16
    v_alignbit_b32 v215, v216, v215, 16
    ds_write_b128 v241, v[212:215] offset:4192
    v_alignbit_b32 v218, v219, v218, 16
    v_alignbit_b32 v219, v220, v219, 16
    v_alignbit_b32 v220, v221, v220, 16
    v_alignbit_b32 v221, v222, v221, 16
    ds_write_b128 v241, v[218:221] offset:5216
    v_alignbit_b32 v224, v225, v224, 16
    v_alignbit_b32 v225, v226, v225, 16
    v_alignbit_b32 v226, v227, v226, 16
    v_alignbit_b32 v227, v228, v227, 16
    ds_write_b128 v241, v[224:227] offset:6240
    v_alignbit_b32 v230, v231, v230, 16
    v_alignbit_b32 v231, v232, v231, 16
    v_alignbit_b32 v232, v233, v232, 16
    v_alignbit_b32 v233, v234, v233, 16
    ds_write_b128 v241, v[230:233] offset:7264
    v_and_b32 v202, 15, v2
    v_lshlrev_b32 v202, 1, v202
    v_sub_u32 v202, v202, v204
    v_add_u32 v202, 17, v202
    v_bfe_u32 v203, v202, 1, 3
    v_xor_b32 v203, s3, v203
    v_lshlrev_b32 v203, 4, v203
    v_lshl_add_u32 v244, v202, 7, v203
    v_and_b32 v202, 15, v2
    v_lshlrev_b32 v202, 1, v202
    v_sub_u32 v202, v202, v204
    v_add_u32 v202, 13, v202
    v_bfe_u32 v203, v202, 1, 3
    v_xor_b32 v203, s3, v203
    v_lshlrev_b32 v203, 4, v203
    v_lshl_add_u32 v245, v202, 7, v203
    v_and_b32 v202, 15, v2
    v_lshlrev_b32 v202, 1, v202
    v_sub_u32 v202, v202, v204
    v_add_u32 v202, 9, v202
    v_bfe_u32 v203, v202, 1, 3
    v_xor_b32 v203, s3, v203
    v_lshlrev_b32 v203, 4, v203
    v_lshl_add_u32 v246, v202, 7, v203
    v_and_b32 v202, 15, v2
    v_lshlrev_b32 v202, 1, v202
    v_sub_u32 v202, v202, v204
    v_add_u32 v202, 5, v202
    v_bfe_u32 v203, v202, 1, 3
    v_xor_b32 v203, s3, v203
    v_lshlrev_b32 v203, 4, v203
    v_lshl_add_u32 v247, v202, 7, v203
    v_and_b32 v202, 15, v2
    v_lshlrev_b32 v202, 5, v202
    v_lshl_add_u32 v8, v204, 3, v202
    s_mul_i32 s7, s3, 589824
L_pl_X_1:
    s_cbranch_execz L_pl_X_5
    s_lshl_b32 s8, s69, 8
    s_add_u32 s7, s7, s8
    s_add_u32 s7, s7, 2359296
    s_lshl_b32 s9, s3, 13
    s_add_u32 s9, s9, 4096
    ds_read2_b32 v[64:65], v236 offset0:0 offset1:1
    ds_read2_b32 v[66:67], v236 offset0:2 offset1:3
    ds_read2_b32 v[68:69], v236 offset0:128 offset1:129
    ds_read2_b32 v[70:71], v236 offset0:130 offset1:131
    ds_read2_b32 v[72:73], v237 offset0:0 offset1:1
    ds_read2_b32 v[74:75], v237 offset0:2 offset1:3
    ds_read2_b32 v[76:77], v237 offset0:128 offset1:129
    ds_read2_b32 v[78:79], v237 offset0:130 offset1:131
    ds_read2_b32 v[80:81], v238 offset0:0 offset1:1
    ds_read2_b32 v[82:83], v238 offset0:2 offset1:3
    ds_read2_b32 v[84:85], v238 offset0:128 offset1:129
    ds_read2_b32 v[86:87], v238 offset0:130 offset1:131
    ds_read2_b32 v[88:89], v239 offset0:0 offset1:1
    ds_read2_b32 v[90:91], v239 offset0:2 offset1:3
    ds_read2_b32 v[92:93], v239 offset0:128 offset1:129
    ds_read2_b32 v[94:95], v239 offset0:130 offset1:131
    v_mov_b32 v29, 0
    buffer_atomic_add v29, v28, s[44:47], 0 offen sc0 sc1
    v_add_u32 v10, 131072, v10
    v_add_u32 v11, 131072, v11
    s_waitcnt vmcnt(0)
    v_cmp_ne_u32 vcc, s68, v29
    s_cbranch_vccnz L_rs_p1X
L_ok_p1X:
    s_barrier
    s_add_u32 m0, s9, 0
    s_add_u32 s13, s7, 0
    buffer_load_dwordx4 v24, s[44:47], s13 offen sc1 lds
    s_add_u32 m0, s9, 1024
    s_add_u32 s13, s7, 73728
    buffer_load_dwordx4 v25, s[44:47], s13 offen sc1 lds
    s_add_u32 m0, s9, 2048
    s_add_u32 s13, s7, 147456
    buffer_load_dwordx4 v24, s[44:47], s13 offen sc1 lds
    s_add_u32 m0, s9, 3072
    s_add_u32 s13, s7, 221184
    buffer_load_dwordx4 v25, s[44:47], s13 offen sc1 lds
    s_add_u32 m0, s9, 4096
    s_add_u32 s13, s7, 294912
    buffer_load_dwordx4 v24, s[44:47], s13 offen sc1 lds
    s_add_u32 m0, s9, 5120
    s_add_u32 s13, s7, 368640
    buffer_load_dwordx4 v25, s[44:47], s13 offen sc1 lds
    s_add_u32 m0, s9, 6144
    s_add_u32 s13, s7, 442368
    buffer_load_dwordx4 v24, s[44:47], s13 offen sc1 lds
    s_add_u32 m0, s9, 7168
    s_add_u32 s13, s7, 516096
    buffer_load_dwordx4 v25, s[44:47], s13 offen sc1 lds
    s_waitcnt vmcnt(0) lgkmcnt(0)
    s_barrier
    ds_read_b128 v[96:99], v244 offset:2048
    ds_read_b128 v[100:103], v244 offset:6144
    ds_read_b128 v[104:107], v244 offset:10240
    ds_read_b128 v[108:111], v244 offset:14336
    ds_read_b128 v[112:115], v244 offset:18432
    ds_read_b128 v[116:119], v244 offset:22528
    ds_read_b128 v[120:123], v244 offset:26624
    ds_read_b128 v[124:127], v244 offset:30720
    s_waitcnt lgkmcnt(0)
    v_mfma_f32_16x16x32_bf16 v[32:35], v[64:67], v[96:99], 0
    s_lshl_b32 s14, s84, 18
    ds_read_b128 v[160:163], v245 offset:2048
    v_mfma_f32_16x16x32_bf16 v[36:39], v[68:71], v[96:99], 0
    s_add_u32 m0, s73, 147456
    v_mfma_f32_16x16x32_bf16 v[36:39], v[64:67], v[100:103], v[36:39]
    buffer_load_dwordx4 v4, s[52:55], s14 offen offset:0 lds
    ds_read2_b32 v[128:129], v236 offset0:16 offset1:17
    v_mfma_f32_16x16x32_bf16 v[40:43], v[64:67], v[104:107], 0
    ds_read2_b32 v[130:131], v236 offset0:18 offset1:19
    v_mfma_f32_16x16x32_bf16 v[40:43], v[68:71], v[100:103], v[40:43]
    v_mfma_f32_16x16x32_bf16 v[40:43], v[72:75], v[96:99], v[40:43]
    ds_read_b128 v[164:167], v245 offset:6144
    v_mfma_f32_16x16x32_bf16 v[44:47], v[76:79], v[96:99], 0
    ds_read2_b32 v[132:133], v236 offset0:144 offset1:145
    v_mfma_f32_16x16x32_bf16 v[44:47], v[72:75], v[100:103], v[44:47]
    s_add_u32 s13, s12, 16384
    v_mfma_f32_16x16x32_bf16 v[44:47], v[68:71], v[104:107], v[44:47]
    ds_read2_b32 v[134:135], v236 offset0:146 offset1:147
    v_mfma_f32_16x16x32_bf16 v[44:47], v[64:67], v[108:111], v[44:47]
    s_add_u32 m0, s74, 8352
    ds_read_b128 v[168:171], v245 offset:10240
    v_mfma_f32_16x16x32_bf16 v[48:51], v[64:67], v[112:115], 0
    buffer_load_dwordx4 v240, s[48:51], s13 offen offset:0 lds
    ds_read2_b32 v[136:137], v237 offset0:16 offset1:17
    v_mfma_f32_16x16x32_bf16 v[48:51], v[68:71], v[108:111], v[48:51]
    v_mfma_f32_16x16x32_bf16 v[48:51], v[72:75], v[104:107], v[48:51]
    s_add_u32 m0, s73, 147456
    ds_read2_b32 v[138:139], v237 offset0:18 offset1:19
    v_mfma_f32_16x16x32_bf16 v[48:51], v[76:79], v[100:103], v[48:51]
    buffer_load_dwordx4 v5, s[52:55], s14 offen offset:1024 lds
    ds_read_b128 v[172:175], v245 offset:14336
    v_mfma_f32_16x16x32_bf16 v[48:51], v[80:83], v[96:99], v[48:51]
    v_mfma_f32_16x16x32_bf16 v[52:55], v[84:87], v[96:99], 0
    ds_read2_b32 v[140:141], v237 offset0:144 offset1:145
    v_mfma_f32_16x16x32_bf16 v[52:55], v[80:83], v[100:103], v[52:55]
    s_add_u32 m0, s74, 8352
    ds_read2_b32 v[142:143], v237 offset0:146 offset1:147
    v_mfma_f32_16x16x32_bf16 v[52:55], v[76:79], v[104:107], v[52:55]
    buffer_load_dwordx4 v240, s[48:51], s13 offen offset:1024 lds
    v_mfma_f32_16x16x32_bf16 v[52:55], v[72:75], v[108:111], v[52:55]
    ds_read_b128 v[176:179], v245 offset:18432
    v_mfma_f32_16x16x32_bf16 v[52:55], v[68:71], v[112:115], v[52:55]
    ds_read2_b32 v[144:145], v238 offset0:16 offset1:17
    v_mfma_f32_16x16x32_bf16 v[52:55], v[64:67], v[116:119], v[52:55]
    v_mfma_f32_16x16x32_bf16 v[56:59], v[64:67], v[120:123], 0
    ds_read2_b32 v[146:147], v238 offset0:18 offset1:19
    v_mfma_f32_16x16x32_bf16 v[56:59], v[68:71], v[116:119], v[56:59]
    ds_read_b128 v[180:183], v245 offset:22528
    v_mfma_f32_16x16x32_bf16 v[56:59], v[72:75], v[112:115], v[56:59]
    v_mfma_f32_16x16x32_bf16 v[56:59], v[76:79], v[108:111], v[56:59]
    s_add_u32 m0, s73, 147456
    ds_read2_b32 v[148:149], v238 offset0:144 offset1:145
    v_mfma_f32_16x16x32_bf16 v[56:59], v[80:83], v[104:107], v[56:59]
    buffer_load_dwordx4 v6, s[52:55], s14 offen offset:2048 lds
    ds_read2_b32 v[150:151], v238 offset0:146 offset1:147
    v_mfma_f32_16x16x32_bf16 v[56:59], v[84:87], v[100:103], v[56:59]
    s_add_u32 m0, s74, 8352
    ds_read_b128 v[184:187], v245 offset:26624
    v_mfma_f32_16x16x32_bf16 v[56:59], v[88:91], v[96:99], v[56:59]
    buffer_load_dwordx4 v240, s[48:51], s13 offen offset:2048 lds
    v_mfma_f32_16x16x32_bf16 v[60:63], v[92:95], v[96:99], 0
    ds_read2_b32 v[152:153], v239 offset0:16 offset1:17
    v_mfma_f32_16x16x32_bf16 v[60:63], v[88:91], v[100:103], v[60:63]
    ds_read2_b32 v[154:155], v239 offset0:18 offset1:19
    v_mfma_f32_16x16x32_bf16 v[60:63], v[84:87], v[104:107], v[60:63]
    v_mfma_f32_16x16x32_bf16 v[60:63], v[80:83], v[108:111], v[60:63]
    ds_read_b128 v[188:191], v245 offset:30720
    v_mfma_f32_16x16x32_bf16 v[60:63], v[76:79], v[112:115], v[60:63]
    s_add_u32 m0, s74, 8352
    ds_read2_b32 v[156:157], v239 offset0:144 offset1:145
    v_mfma_f32_16x16x32_bf16 v[60:63], v[72:75], v[116:119], v[60:63]
    buffer_load_dwordx4 v240, s[48:51], s13 offen offset:3072 lds
    v_mfma_f32_16x16x32_bf16 v[60:63], v[68:71], v[120:123], v[60:63]
    ds_read2_b32 v[158:159], v239 offset0:146 offset1:147
    v_mfma_f32_16x16x32_bf16 v[60:63], v[64:67], v[124:127], v[60:63]
    s_waitcnt lgkmcnt(12)
    v_mfma_f32_16x16x32_bf16 v[32:35], v[128:131], v[160:163], v[32:35]
    s_add_u32 m0, s73, 147456
    ds_read_b128 v[96:99], v246 offset:2048
    v_mfma_f32_16x16x32_bf16 v[36:39], v[132:135], v[160:163], v[36:39]
    buffer_load_dwordx4 v7, s[52:55], s14 offen offset:3072 lds
    v_mfma_f32_16x16x32_bf16 v[36:39], v[128:131], v[164:167], v[36:39]
    ds_read2_b32 v[64:65], v236 offset0:32 offset1:33
    v_mfma_f32_16x16x32_bf16 v[40:43], v[128:131], v[168:171], v[40:43]
    ds_read2_b32 v[66:67], v236 offset0:34 offset1:35
    v_mfma_f32_16x16x32_bf16 v[40:43], v[132:135], v[164:167], v[40:43]
    v_mfma_f32_16x16x32_bf16 v[40:43], v[136:139], v[160:163], v[40:43]
    ds_read_b128 v[100:103], v246 offset:6144
    v_mfma_f32_16x16x32_bf16 v[44:47], v[140:143], v[160:163], v[44:47]
    ds_read2_b32 v[68:69], v236 offset0:160 offset1:161
    v_mfma_f32_16x16x32_bf16 v[44:47], v[136:139], v[164:167], v[44:47]
    v_mfma_f32_16x16x32_bf16 v[44:47], v[132:135], v[168:171], v[44:47]
    ds_read2_b32 v[70:71], v236 offset0:162 offset1:163
    v_mfma_f32_16x16x32_bf16 v[44:47], v[128:131], v[172:175], v[44:47]
    ds_read_b128 v[104:107], v246 offset:10240
    s_waitcnt lgkmcnt(7)
    v_mfma_f32_16x16x32_bf16 v[48:51], v[128:131], v[176:179], v[48:51]
    ds_read2_b32 v[72:73], v237 offset0:32 offset1:33
    v_mfma_f32_16x16x32_bf16 v[48:51], v[132:135], v[172:175], v[48:51]
    ds_read2_b32 v[74:75], v237 offset0:34 offset1:35
    v_mfma_f32_16x16x32_bf16 v[48:51], v[136:139], v[168:171], v[48:51]
    v_mov_b32 v9, 8
    buffer_load_ushort v9, v9, s[56:59], s70 offen
    v_mfma_f32_16x16x32_bf16 v[48:51], v[140:143], v[164:167], v[48:51]
    ds_read_b128 v[108:111], v246 offset:14336
    v_mfma_f32_16x16x32_bf16 v[48:51], v[144:147], v[160:163], v[48:51]
    v_mfma_f32_16x16x32_bf16 v[52:55], v[148:151], v[160:163], v[52:55]
    ds_read2_b32 v[76:77], v237 offset0:160 offset1:161
    v_mfma_f32_16x16x32_bf16 v[52:55], v[144:147], v[164:167], v[52:55]
    ds_read2_b32 v[78:79], v237 offset0:162 offset1:163
    v_mfma_f32_16x16x32_bf16 v[52:55], v[140:143], v[168:171], v[52:55]
    v_mfma_f32_16x16x32_bf16 v[52:55], v[136:139], v[172:175], v[52:55]
    ds_read_b128 v[112:115], v246 offset:18432
    v_mfma_f32_16x16x32_bf16 v[52:55], v[132:135], v[176:179], v[52:55]
    ds_read2_b32 v[80:81], v238 offset0:32 offset1:33
    v_mfma_f32_16x16x32_bf16 v[52:55], v[128:131], v[180:183], v[52:55]
    v_mfma_f32_16x16x32_bf16 v[56:59], v[128:131], v[184:187], v[56:59]
    ds_read2_b32 v[82:83], v238 offset0:34 offset1:35
    v_mfma_f32_16x16x32_bf16 v[56:59], v[132:135], v[180:183], v[56:59]
    ds_read_b128 v[116:119], v246 offset:22528
    v_mfma_f32_16x16x32_bf16 v[56:59], v[136:139], v[176:179], v[56:59]
    v_mfma_f32_16x16x32_bf16 v[56:59], v[140:143], v[172:175], v[56:59]
    ds_read2_b32 v[84:85], v238 offset0:160 offset1:161
    v_mfma_f32_16x16x32_bf16 v[56:59], v[144:147], v[168:171], v[56:59]
    ds_read2_b32 v[86:87], v238 offset0:162 offset1:163
    v_mfma_f32_16x16x32_bf16 v[56:59], v[148:151], v[164:167], v[56:59]
    ds_read_b128 v[120:123], v246 offset:26624
    v_mfma_f32_16x16x32_bf16 v[56:59], v[152:155], v[160:163], v[56:59]
    v_mfma_f32_16x16x32_bf16 v[60:63], v[156:159], v[160:163], v[60:63]
    ds_read2_b32 v[88:89], v239 offset0:32 offset1:33
    v_mfma_f32_16x16x32_bf16 v[60:63], v[152:155], v[164:167], v[60:63]
    ds_read2_b32 v[90:91], v239 offset0:34 offset1:35
    v_mfma_f32_16x16x32_bf16 v[60:63], v[148:151], v[168:171], v[60:63]
    v_mfma_f32_16x16x32_bf16 v[60:63], v[144:147], v[172:175], v[60:63]
    ds_read_b128 v[124:127], v246 offset:30720
    v_mfma_f32_16x16x32_bf16 v[60:63], v[140:143], v[176:179], v[60:63]
    ds_read2_b32 v[92:93], v239 offset0:160 offset1:161
    v_mfma_f32_16x16x32_bf16 v[60:63], v[136:139], v[180:183], v[60:63]
    v_mfma_f32_16x16x32_bf16 v[60:63], v[132:135], v[184:187], v[60:63]
    ds_read2_b32 v[94:95], v239 offset0:162 offset1:163
    v_mfma_f32_16x16x32_bf16 v[60:63], v[128:131], v[188:191], v[60:63]
    s_waitcnt lgkmcnt(12)
    v_mfma_f32_16x16x32_bf16 v[32:35], v[64:67], v[96:99], v[32:35]
    s_lshl_b32 s14, s85, 18
    ds_read_b128 v[160:163], v247 offset:2048
    v_mfma_f32_16x16x32_bf16 v[36:39], v[68:71], v[96:99], v[36:39]
    s_add_u32 m0, s73, 49152
    v_mfma_f32_16x16x32_bf16 v[36:39], v[64:67], v[100:103], v[36:39]
    buffer_load_dwordx4 v4, s[52:55], s14 offen offset:0 lds
    ds_read2_b32 v[128:129], v236 offset0:48 offset1:49
    v_mfma_f32_16x16x32_bf16 v[40:43], v[64:67], v[104:107], v[40:43]
    ds_read2_b32 v[130:131], v236 offset0:50 offset1:51
    v_mfma_f32_16x16x32_bf16 v[40:43], v[68:71], v[100:103], v[40:43]
    v_mfma_f32_16x16x32_bf16 v[40:43], v[72:75], v[96:99], v[40:43]
    ds_read_b128 v[164:167], v247 offset:6144
    v_mfma_f32_16x16x32_bf16 v[44:47], v[76:79], v[96:99], v[44:47]
    ds_read2_b32 v[132:133], v236 offset0:176 offset1:177
    v_mfma_f32_16x16x32_bf16 v[44:47], v[72:75], v[100:103], v[44:47]
    v_mfma_f32_16x16x32_bf16 v[44:47], v[68:71], v[104:107], v[44:47]
    ds_read2_b32 v[134:135], v236 offset0:178 offset1:179
    v_mfma_f32_16x16x32_bf16 v[44:47], v[64:67], v[108:111], v[44:47]
    ds_read_b128 v[168:171], v247 offset:10240
    s_waitcnt lgkmcnt(7)
    v_mfma_f32_16x16x32_bf16 v[48:51], v[64:67], v[112:115], v[48:51]
    ds_read2_b32 v[136:137], v237 offset0:48 offset1:49
    v_mfma_f32_16x16x32_bf16 v[48:51], v[68:71], v[108:111], v[48:51]
    v_mfma_f32_16x16x32_bf16 v[48:51], v[72:75], v[104:107], v[48:51]
    s_add_u32 m0, s73, 49152
    ds_read2_b32 v[138:139], v237 offset0:50 offset1:51
    v_mfma_f32_16x16x32_bf16 v[48:51], v[76:79], v[100:103], v[48:51]
    buffer_load_dwordx4 v5, s[52:55], s14 offen offset:1024 lds
    ds_read_b128 v[172:175], v247 offset:14336
    v_mfma_f32_16x16x32_bf16 v[48:51], v[80:83], v[96:99], v[48:51]
    v_mfma_f32_16x16x32_bf16 v[52:55], v[84:87], v[96:99], v[52:55]
    ds_read2_b32 v[140:141], v237 offset0:176 offset1:177
    v_mfma_f32_16x16x32_bf16 v[52:55], v[80:83], v[100:103], v[52:55]
    ds_read2_b32 v[142:143], v237 offset0:178 offset1:179
    v_mfma_f32_16x16x32_bf16 v[52:55], v[76:79], v[104:107], v[52:55]
    v_mfma_f32_16x16x32_bf16 v[52:55], v[72:75], v[108:111], v[52:55]
    ds_read_b128 v[176:179], v247 offset:18432
    v_mfma_f32_16x16x32_bf16 v[52:55], v[68:71], v[112:115], v[52:55]
    ds_read2_b32 v[144:145], v238 offset0:48 offset1:49
    v_mfma_f32_16x16x32_bf16 v[52:55], v[64:67], v[116:119], v[52:55]
    v_mfma_f32_16x16x32_bf16 v[56:59], v[64:67], v[120:123], v[56:59]
    ds_read2_b32 v[146:147], v238 offset0:50 offset1:51
    v_mfma_f32_16x16x32_bf16 v[56:59], v[68:71], v[116:119], v[56:59]
    ds_read_b128 v[180:183], v247 offset:22528
    v_mfma_f32_16x16x32_bf16 v[56:59], v[72:75], v[112:115], v[56:59]
    v_mfma_f32_16x16x32_bf16 v[56:59], v[76:79], v[108:111], v[56:59]
    s_add_u32 m0, s73, 49152
    ds_read2_b32 v[148:149], v238 offset0:176 offset1:177
    v_mfma_f32_16x16x32_bf16 v[56:59], v[80:83], v[104:107], v[56:59]
    buffer_load_dwordx4 v6, s[52:55], s14 offen offset:2048 lds
    ds_read2_b32 v[150:151], v238 offset0:178 offset1:179
    v_mfma_f32_16x16x32_bf16 v[56:59], v[84:87], v[100:103], v[56:59]
    ds_read_b128 v[184:187], v247 offset:26624
    v_mfma_f32_16x16x32_bf16 v[56:59], v[88:91], v[96:99], v[56:59]
    v_mfma_f32_16x16x32_bf16 v[60:63], v[92:95], v[96:99], v[60:63]
    ds_read2_b32 v[152:153], v239 offset0:48 offset1:49
    v_mfma_f32_16x16x32_bf16 v[60:63], v[88:91], v[100:103], v[60:63]
    ds_read2_b32 v[154:155], v239 offset0:50 offset1:51
    v_mfma_f32_16x16x32_bf16 v[60:63], v[84:87], v[104:107], v[60:63]
    v_mfma_f32_16x16x32_bf16 v[60:63], v[80:83], v[108:111], v[60:63]
    ds_read_b128 v[188:191], v247 offset:30720
    v_mfma_f32_16x16x32_bf16 v[60:63], v[76:79], v[112:115], v[60:63]
    ds_read2_b32 v[156:157], v239 offset0:176 offset1:177
    v_mfma_f32_16x16x32_bf16 v[60:63], v[72:75], v[116:119], v[60:63]
    v_mfma_f32_16x16x32_bf16 v[60:63], v[68:71], v[120:123], v[60:63]
    ds_read2_b32 v[158:159], v239 offset0:178 offset1:179
    v_mfma_f32_16x16x32_bf16 v[60:63], v[64:67], v[124:127], v[60:63]
    s_waitcnt lgkmcnt(12)
    v_mfma_f32_16x16x32_bf16 v[32:35], v[128:131], v[160:163], v[32:35]
    s_add_u32 m0, s73, 49152
    ds_read_b128 v[96:99], v244 offset:0
    v_mfma_f32_16x16x32_bf16 v[36:39], v[132:135], v[160:163], v[36:39]
    buffer_load_dwordx4 v7, s[52:55], s14 offen offset:3072 lds
    v_mfma_f32_16x16x32_bf16 v[36:39], v[128:131], v[164:167], v[36:39]
    ds_read2_b32 v[64:65], v236 offset0:64 offset1:65
    v_mfma_f32_16x16x32_bf16 v[40:43], v[128:131], v[168:171], v[40:43]
    ds_read2_b32 v[66:67], v236 offset0:66 offset1:67
    v_mfma_f32_16x16x32_bf16 v[40:43], v[132:135], v[164:167], v[40:43]
    v_mfma_f32_16x16x32_bf16 v[40:43], v[136:139], v[160:163], v[40:43]
    ds_read_b128 v[100:103], v244 offset:4096
    v_mfma_f32_16x16x32_bf16 v[44:47], v[140:143], v[160:163], v[44:47]
    ds_read2_b32 v[68:69], v236 offset0:192 offset1:193
    v_mfma_f32_16x16x32_bf16 v[44:47], v[136:139], v[164:167], v[44:47]
    v_mfma_f32_16x16x32_bf16 v[44:47], v[132:135], v[168:171], v[44:47]
    ds_read2_b32 v[70:71], v236 offset0:194 offset1:195
    v_mfma_f32_16x16x32_bf16 v[44:47], v[128:131], v[172:175], v[44:47]
    ds_read_b128 v[104:107], v244 offset:8192
    s_waitcnt lgkmcnt(7)
    v_mfma_f32_16x16x32_bf16 v[48:51], v[128:131], v[176:179], v[48:51]
    ds_read2_b32 v[72:73], v237 offset0:64 offset1:65
    v_mfma_f32_16x16x32_bf16 v[48:51], v[132:135], v[172:175], v[48:51]
    ds_read2_b32 v[74:75], v237 offset0:66 offset1:67
    v_mfma_f32_16x16x32_bf16 v[48:51], v[136:139], v[168:171], v[48:51]
    ds_read_b128 v[108:111], v244 offset:12288
    v_mfma_f32_16x16x32_bf16 v[48:51], v[140:143], v[164:167], v[48:51]
    ds_read2_b32 v[76:77], v237 offset0:192 offset1:193
    v_mfma_f32_16x16x32_bf16 v[48:51], v[144:147], v[160:163], v[48:51]
    ds_read2_b32 v[78:79], v237 offset0:194 offset1:195
    v_mfma_f32_16x16x32_bf16 v[52:55], v[148:151], v[160:163], v[52:55]
    ds_read_b128 v[112:115], v244 offset:16384
    v_mfma_f32_16x16x32_bf16 v[52:55], v[144:147], v[164:167], v[52:55]
    ds_read2_b32 v[80:81], v238 offset0:64 offset1:65
    v_mfma_f32_16x16x32_bf16 v[52:55], v[140:143], v[168:171], v[52:55]
    ds_read2_b32 v[82:83], v238 offset0:66 offset1:67
    v_mfma_f32_16x16x32_bf16 v[52:55], v[136:139], v[172:175], v[52:55]
    ds_read_b128 v[116:119], v244 offset:20480
    v_mfma_f32_16x16x32_bf16 v[52:55], v[132:135], v[176:179], v[52:55]
    ds_read2_b32 v[84:85], v238 offset0:192 offset1:193
    v_mfma_f32_16x16x32_bf16 v[52:55], v[128:131], v[180:183], v[52:55]
    ds_read2_b32 v[86:87], v238 offset0:194 offset1:195
    v_mfma_f32_16x16x32_bf16 v[56:59], v[128:131], v[184:187], v[56:59]
    ds_read_b128 v[120:123], v244 offset:24576
    s_waitcnt vmcnt(5)
    s_barrier
    v_mfma_f32_16x16x32_bf16 v[56:59], v[132:135], v[180:183], v[56:59]
    ds_read2_b32 v[88:89], v239 offset0:64 offset1:65
    v_mfma_f32_16x16x32_bf16 v[56:59], v[136:139], v[176:179], v[56:59]
    ds_read_b64_tr_b16 a[0:1], v10 offset:16384
    v_mfma_f32_16x16x32_bf16 v[56:59], v[140:143], v[172:175], v[56:59]
    ds_read_b64_tr_b16 a[2:3], v10 offset:18432
    v_mfma_f32_16x16x32_bf16 v[56:59], v[144:147], v[168:171], v[56:59]
    ds_read_b64_tr_b16 a[8:9], v10 offset:20480
    v_mfma_f32_16x16x32_bf16 v[56:59], v[148:151], v[164:167], v[56:59]
    ds_read2_b32 v[90:91], v239 offset0:66 offset1:67
    v_mfma_f32_16x16x32_bf16 v[56:59], v[152:155], v[160:163], v[56:59]
    ds_read_b64_tr_b16 a[10:11], v10 offset:22528
    v_mfma_f32_16x16x32_bf16 v[60:63], v[156:159], v[160:163], v[60:63]
    ds_read_b64_tr_b16 a[4:5], v11 offset:16384
    v_mfma_f32_16x16x32_bf16 v[60:63], v[152:155], v[164:167], v[60:63]
    ds_read_b128 v[124:127], v244 offset:28672
    v_mfma_f32_16x16x32_bf16 v[60:63], v[148:151], v[168:171], v[60:63]
    ds_read_b64_tr_b16 a[6:7], v11 offset:18432
    v_mfma_f32_16x16x32_bf16 v[60:63], v[144:147], v[172:175], v[60:63]
    ds_read_b64_tr_b16 a[12:13], v11 offset:20480
    v_mfma_f32_16x16x32_bf16 v[60:63], v[140:143], v[176:179], v[60:63]
    ds_read2_b32 v[92:93], v239 offset0:192 offset1:193
    v_mfma_f32_16x16x32_bf16 v[60:63], v[136:139], v[180:183], v[60:63]
    ds_read_b64_tr_b16 a[14:15], v11 offset:22528
    v_mfma_f32_16x16x32_bf16 v[60:63], v[132:135], v[184:187], v[60:63]
    ds_read2_b32 v[94:95], v239 offset0:194 offset1:195
    v_mfma_f32_16x16x32_bf16 v[60:63], v[128:131], v[188:191], v[60:63]
    s_waitcnt lgkmcnt(15)
    v_mfma_f32_16x16x32_bf16 v[32:35], v[64:67], v[96:99], v[32:35]
    ds_read_b128 v[160:163], v245 offset:0
    s_waitcnt lgkmcnt(2)
    s_barrier
    v_mfma_f32_16x16x32_bf16 v[36:39], v[68:71], v[96:99], v[36:39]
    v_mfma_f32_16x16x32_bf16 v[36:39], v[64:67], v[100:103], v[36:39]
    ds_read2_b32 v[128:129], v236 offset0:80 offset1:81
    v_mfma_f32_16x16x32_bf16 v[40:43], v[64:67], v[104:107], v[40:43]
    s_lshl_b32 s14, s86, 18
    ds_read2_b32 v[130:131], v236 offset0:82 offset1:83
    v_mfma_f32_16x16x32_bf16 v[40:43], v[68:71], v[100:103], v[40:43]
    s_add_u32 m0, s73, 147456
    v_mfma_f32_16x16x32_bf16 v[40:43], v[72:75], v[96:99], v[40:43]
    buffer_load_dwordx4 v4, s[52:55], s14 offen offset:0 lds
    ds_read_b128 v[164:167], v245 offset:4096
    v_mfma_f32_16x16x32_bf16 v[44:47], v[76:79], v[96:99], v[44:47]
    ds_read2_b32 v[132:133], v236 offset0:208 offset1:209
    v_mfma_f32_16x16x32_bf16 v[44:47], v[72:75], v[100:103], v[44:47]
    v_mfma_f32_16x16x32_bf16 v[44:47], v[68:71], v[104:107], v[44:47]
    ds_read2_b32 v[134:135], v236 offset0:210 offset1:211
    v_mfma_f32_16x16x32_bf16 v[44:47], v[64:67], v[108:111], v[44:47]
    ds_read_b128 v[168:171], v245 offset:8192
    s_waitcnt lgkmcnt(7)
    v_mfma_f32_16x16x32_bf16 v[48:51], v[64:67], v[112:115], v[48:51]
    ds_read2_b32 v[136:137], v237 offset0:80 offset1:81
    v_mfma_f32_16x16x32_bf16 v[48:51], v[68:71], v[108:111], v[48:51]
    ds_read2_b32 v[138:139], v237 offset0:82 offset1:83
    v_mfma_f32_16x16x32_bf16 v[48:51], v[72:75], v[104:107], v[48:51]
    ds_read_b128 v[172:175], v245 offset:12288
    v_mfma_f32_16x16x32_bf16 v[48:51], v[76:79], v[100:103], v[48:51]
    ds_read2_b32 v[140:141], v237 offset0:208 offset1:209
    v_mfma_f32_16x16x32_bf16 v[48:51], v[80:83], v[96:99], v[48:51]
    ds_read2_b32 v[142:143], v237 offset0:210 offset1:211
    v_mfma_f32_16x16x32_bf16 v[52:55], v[84:87], v[96:99], v[52:55]
    ds_read_b128 v[176:179], v245 offset:16384
    v_mfma_f32_16x16x32_bf16 v[52:55], v[80:83], v[100:103], v[52:55]
    s_add_u32 m0, s73, 147456
    ds_read2_b32 v[144:145], v238 offset0:80 offset1:81
    v_mfma_f32_16x16x32_bf16 v[52:55], v[76:79], v[104:107], v[52:55]
    buffer_load_dwordx4 v5, s[52:55], s14 offen offset:1024 lds
    ds_read2_b32 v[146:147], v238 offset0:82 offset1:83
    v_mfma_f32_16x16x32_bf16 v[52:55], v[72:75], v[108:111], v[52:55]
    ds_read_b128 v[180:183], v245 offset:20480
    v_mfma_f32_16x16x32_bf16 v[52:55], v[68:71], v[112:115], v[52:55]
    ds_read_b128 v[212:215], v241 offset:8352
    v_mfma_f32_16x16x32_bf16 v[52:55], v[64:67], v[116:119], v[52:55]
    ds_read2_b32 v[148:149], v238 offset0:208 offset1:209
    v_mfma_f32_16x16x32_bf16 v[56:59], v[64:67], v[120:123], v[56:59]
    ds_read_b32 v216, v241 offset:8368
    v_mfma_f32_16x16x32_bf16 v[56:59], v[68:71], v[116:119], v[56:59]
    ds_read2_b32 v[150:151], v238 offset0:210 offset1:211
    v_mfma_f32_16x16x32_bf16 v[56:59], v[72:75], v[112:115], v[56:59]
    ds_read_b128 v[218:221], v241 offset:9376
    v_mfma_f32_16x16x32_bf16 v[56:59], v[76:79], v[108:111], v[56:59]
    ds_read_b128 v[184:187], v245 offset:24576
    v_mfma_f32_16x16x32_bf16 v[56:59], v[80:83], v[104:107], v[56:59]
    ds_read2_b32 v[152:153], v239 offset0:80 offset1:81
    v_mfma_f32_16x16x32_bf16 v[56:59], v[84:87], v[100:103], v[56:59]
    ds_read_b32 v222, v241 offset:9392
    v_mfma_f32_16x16x32_bf16 v[56:59], v[88:91], v[96:99], v[56:59]
    ds_read2_b32 v[154:155], v239 offset0:82 offset1:83
    v_mfma_f32_16x16x32_bf16 v[60:63], v[92:95], v[96:99], v[60:63]
    s_add_u32 m0, s73, 147456
    ds_read_b128 v[224:227], v241 offset:10400
    v_mfma_f32_16x16x32_bf16 v[60:63], v[88:91], v[100:103], v[60:63]
    buffer_load_dwordx4 v6, s[52:55], s14 offen offset:2048 lds
    ds_read_b128 v[188:191], v245 offset:28672
    v_mfma_f32_16x16x32_bf16 v[60:63], v[84:87], v[104:107], v[60:63]
    ds_read_b32 v228, v241 offset:10416
    v_mfma_f32_16x16x32_bf16 v[60:63], v[80:83], v[108:111], v[60:63]
    ds_read2_b32 v[156:157], v239 offset0:208 offset1:209
    v_mfma_f32_16x16x32_bf16 v[60:63], v[76:79], v[112:115], v[60:63]
    ds_read_b128 v[230:233], v241 offset:11424
    v_mfma_f32_16x16x32_bf16 v[60:63], v[72:75], v[116:119], v[60:63]
    ds_read2_b32 v[158:159], v239 offset0:210 offset1:211
    v_mfma_f32_16x16x32_bf16 v[60:63], v[68:71], v[120:123], v[60:63]
    ds_read_b32 v234, v241 offset:11440
    v_mfma_f32_16x16x32_bf16 v[60:63], v[64:67], v[124:127], v[60:63]
    s_waitcnt lgkmcnt(15)
    v_mfma_f32_16x16x32_bf16 v[32:35], v[128:131], v[160:163], v[32:35]
    ds_read_b128 v[96:99], v246 offset:0
    v_mfma_f32_16x16x32_bf16 v[36:39], v[132:135], v[160:163], v[36:39]
    ds_read2_b32 v[64:65], v236 offset0:96 offset1:97
    v_mfma_f32_16x16x32_bf16 v[36:39], v[128:131], v[164:167], v[36:39]
    ds_read2_b32 v[66:67], v236 offset0:98 offset1:99
    v_mfma_f32_16x16x32_bf16 v[40:43], v[128:131], v[168:171], v[40:43]
    s_add_u32 m0, s73, 147456
    ds_read_b128 v[100:103], v246 offset:4096
    v_mfma_f32_16x16x32_bf16 v[40:43], v[132:135], v[164:167], v[40:43]
    buffer_load_dwordx4 v7, s[52:55], s14 offen offset:3072 lds
    ds_read2_b32 v[68:69], v236 offset0:224 offset1:225
    s_waitcnt lgkmcnt(5)
    v_mfma_f32_16x16x32_bf16 v[40:43], v[136:139], v[160:163], v[40:43]
    ds_read2_b32 v[70:71], v236 offset0:226 offset1:227
    v_mfma_f32_16x16x32_bf16 v[44:47], v[140:143], v[160:163], v[44:47]
    s_waitcnt vmcnt(8)
    ds_read_b128 v[104:107], v246 offset:8192
    v_mfma_f32_16x16x32_bf16 v[44:47], v[136:139], v[164:167], v[44:47]
    ds_read2_b32 v[72:73], v237 offset0:96 offset1:97
    v_mfma_f32_16x16x32_bf16 v[44:47], v[132:135], v[168:171], v[44:47]
    ds_read2_b32 v[74:75], v237 offset0:98 offset1:99
    v_lshlrev_b32 v9, 16, v9
    v_mfma_f32_16x16x32_bf16 v[44:47], v[128:131], v[172:175], v[44:47]
    ds_read_b128 v[108:111], v246 offset:12288
    v_mfma_f32_16x16x32_bf16 v[48:51], v[128:131], v[176:179], v[48:51]
    ds_read2_b32 v[76:77], v237 offset0:224 offset1:225
    v_lshlrev_b32 v208, 16, v212
    v_mfma_f32_16x16x32_bf16 v[48:51], v[132:135], v[172:175], v[48:51]
    ds_read2_b32 v[78:79], v237 offset0:226 offset1:227
    v_mfma_f32_16x16x32_bf16 v[48:51], v[136:139], v[168:171], v[48:51]
    ds_read_b128 v[112:115], v246 offset:16384
    v_add_f32 v9, v9, v208
    v_mfma_f32_16x16x32_bf16 v[48:51], v[140:143], v[164:167], v[48:51]
    ds_read2_b32 v[80:81], v238 offset0:96 offset1:97
    v_cvt_pk_bf16_f32 v9, v9, v9
    v_mfma_f32_16x16x32_bf16 v[48:51], v[144:147], v[160:163], v[48:51]
    ds_read2_b32 v[82:83], v238 offset0:98 offset1:99
    v_mfma_f32_16x16x32_bf16 v[52:55], v[148:151], v[160:163], v[52:55]
    ds_write_b16 v242, v9 offset:12480
    v_mfma_f32_16x16x32_bf16 v[52:55], v[144:147], v[164:167], v[52:55]
    ds_read_b128 v[116:119], v246 offset:20480
    v_mfma_f32_16x16x32_bf16 v[52:55], v[140:143], v[168:171], v[52:55]
    ds_write_b16 v242, v9 offset:8322
    v_mfma_f32_16x16x32_bf16 v[52:55], v[136:139], v[172:175], v[52:55]
    ds_read2_b32 v[84:85], v238 offset0:224 offset1:225
    v_mfma_f32_16x16x32_bf16 v[52:55], v[132:135], v[176:179], v[52:55]
    ds_read2_b32 v[86:87], v238 offset0:226 offset1:227
    v_alignbit_b32 v212, v213, v212, 16
    v_mfma_f32_16x16x32_bf16 v[52:55], v[128:131], v[180:183], v[52:55]
    ds_read_b128 v[120:123], v246 offset:24576
    v_alignbit_b32 v213, v214, v213, 16
    v_mfma_f32_16x16x32_bf16 v[56:59], v[128:131], v[184:187], v[56:59]
    ds_read2_b32 v[88:89], v239 offset0:96 offset1:97
    s_waitcnt vmcnt(4)
    s_barrier
    v_mfma_f32_16x16x32_bf16 v[56:59], v[132:135], v[180:183], v[56:59]
    v_add_u32 v10, -131072, v10
    v_alignbit_b32 v214, v215, v214, 16
    v_mfma_f32_16x16x32_bf16 v[56:59], v[136:139], v[176:179], v[56:59]
    ds_read_b64_tr_b16 a[16:17], v10 offset:49152
    v_alignbit_b32 v215, v216, v215, 16
    v_mfma_f32_16x16x32_bf16 v[56:59], v[140:143], v[172:175], v[56:59]
    ds_write_b128 v241, v[212:215] offset:12512
    v_mfma_f32_16x16x32_bf16 v[56:59], v[144:147], v[168:171], v[56:59]
    ds_read_b64_tr_b16 a[18:19], v10 offset:51200
    v_mfma_f32_16x16x32_bf16 v[56:59], v[148:151], v[164:167], v[56:59]
    ds_read_b64_tr_b16 a[24:25], v10 offset:53248
    v_mfma_f32_16x16x32_bf16 v[56:59], v[152:155], v[160:163], v[56:59]
    ds_read_b64_tr_b16 a[26:27], v10 offset:55296
    v_mfma_f32_16x16x32_bf16 v[60:63], v[156:159], v[160:163], v[60:63]
    ds_read2_b32 v[90:91], v239 offset0:98 offset1:99
    v_add_u32 v11, -131072, v11
    v_alignbit_b32 v218, v219, v218, 16
    v_mfma_f32_16x16x32_bf16 v[60:63], v[152:155], v[164:167], v[60:63]
    ds_read_b64_tr_b16 a[20:21], v11 offset:49152
    v_alignbit_b32 v219, v220, v219, 16
    v_mfma_f32_16x16x32_bf16 v[60:63], v[148:151], v[168:171], v[60:63]
    ds_read_b128 v[124:127], v246 offset:28672
    ds_read2_b32 v[92:93], v239 offset0:224 offset1:225
    v_mfma_f32_16x16x32_bf16 v[60:63], v[144:147], v[172:175], v[60:63]
    ds_read_b64_tr_b16 a[22:23], v11 offset:51200
    v_alignbit_b32 v220, v221, v220, 16
    v_mfma_f32_16x16x32_bf16 v[60:63], v[140:143], v[176:179], v[60:63]
    ds_read_b64_tr_b16 a[28:29], v11 offset:53248
    ds_read2_b32 v[94:95], v239 offset0:226 offset1:227
    v_mfma_f32_16x16x32_bf16 v[60:63], v[136:139], v[180:183], v[60:63]
    ds_read_b64_tr_b16 a[30:31], v11 offset:55296
    v_alignbit_b32 v221, v222, v221, 16
    v_mfma_f32_16x16x32_bf16 v[60:63], v[132:135], v[184:187], v[60:63]
    ds_write_b128 v241, v[218:221] offset:13536
    v_mfma_f32_16x16x32_bf16 v[60:63], v[128:131], v[188:191], v[60:63]
    s_waitcnt lgkmcnt(15)
    v_mfma_f32_16x16x32_bf16 v[32:35], v[64:67], v[96:99], v[32:35]
    ds_read_b128 v[160:163], v247 offset:0
    s_waitcnt lgkmcnt(2)
    s_barrier
    v_mfma_f32_16x16x32_bf16 v[36:39], v[68:71], v[96:99], v[36:39]
    v_alignbit_b32 v224, v225, v224, 16
    v_mfma_f32_16x16x32_bf16 v[36:39], v[64:67], v[100:103], v[36:39]
    ds_read_b128 v[164:167], v247 offset:4096
    v_mfma_f32_16x16x32_bf16 v[40:43], v[64:67], v[104:107], v[40:43]
L_pl_X_2:
    s_cbranch_execz L_pl_X_6
    s_lshl_b32 s14, s87, 18
    ds_read_b128 v[168:171], v247 offset:8192
    v_mfma_f32_16x16x32_bf16 v[40:43], v[68:71], v[100:103], v[40:43]
    s_add_u32 m0, s73, 49152
    ds_read_b128 v[172:175], v247 offset:12288
    v_mfma_f32_16x16x32_bf16 v[40:43], v[72:75], v[96:99], v[40:43]
    buffer_load_dwordx4 v4, s[52:55], s14 offen offset:0 lds
    v_alignbit_b32 v225, v226, v225, 16
    v_mfma_f32_16x16x32_bf16 v[44:47], v[76:79], v[96:99], v[44:47]
    ds_read_b128 v[176:179], v247 offset:16384
    v_mfma_f32_16x16x32_bf16 v[44:47], v[72:75], v[100:103], v[44:47]
    ds_read_b128 v[180:183], v247 offset:20480
    v_mfma_f32_16x16x32_bf16 v[44:47], v[68:71], v[104:107], v[44:47]
    ds_read_b128 v[184:187], v247 offset:24576
    v_mfma_f32_16x16x32_bf16 v[44:47], v[64:67], v[108:111], v[44:47]
    v_alignbit_b32 v226, v227, v226, 16
    v_mfma_f32_16x16x32_bf16 v[48:51], v[64:67], v[112:115], v[48:51]
    ds_read_b128 v[188:191], v247 offset:28672
    v_mfma_f32_16x16x32_bf16 v[48:51], v[68:71], v[108:111], v[48:51]
    ds_read2_b32 v[128:129], v236 offset0:112 offset1:113
    v_mfma_f32_16x16x32_bf16 v[48:51], v[72:75], v[104:107], v[48:51]
    v_alignbit_b32 v227, v228, v227, 16
    v_mfma_f32_16x16x32_bf16 v[48:51], v[76:79], v[100:103], v[48:51]
    ds_read2_b32 v[130:131], v236 offset0:114 offset1:115
    v_mfma_f32_16x16x32_bf16 v[48:51], v[80:83], v[96:99], v[48:51]
    ds_read2_b32 v[132:133], v236 offset0:240 offset1:241
    v_mfma_f32_16x16x32_bf16 v[52:55], v[84:87], v[96:99], v[52:55]
    ds_write_b128 v241, v[224:227] offset:14560
    v_mfma_f32_16x16x32_bf16 v[52:55], v[80:83], v[100:103], v[52:55]
    s_add_u32 m0, s73, 49152
    ds_read2_b32 v[134:135], v236 offset0:242 offset1:243
    v_mfma_f32_16x16x32_bf16 v[52:55], v[76:79], v[104:107], v[52:55]
    buffer_load_dwordx4 v5, s[52:55], s14 offen offset:1024 lds
    ds_read2_b32 v[136:137], v237 offset0:112 offset1:113
    v_mfma_f32_16x16x32_bf16 v[52:55], v[72:75], v[108:111], v[52:55]
    s_add_u32 s6, s12, 4718592
    ds_read2_b32 v[138:139], v237 offset0:114 offset1:115
    v_mfma_f32_16x16x32_bf16 v[52:55], v[68:71], v[112:115], v[52:55]
    ds_read2_b32 v[140:141], v237 offset0:240 offset1:241
    v_alignbit_b32 v230, v231, v230, 16
    v_mfma_f32_16x16x32_bf16 v[52:55], v[64:67], v[116:119], v[52:55]
    ds_read2_b32 v[142:143], v237 offset0:242 offset1:243
    v_xor_b32 v244, 64, v244
    v_mfma_f32_16x16x32_bf16 v[56:59], v[64:67], v[120:123], v[56:59]
    ds_read2_b32 v[144:145], v238 offset0:112 offset1:113
    v_mfma_f32_16x16x32_bf16 v[56:59], v[68:71], v[116:119], v[56:59]
    ds_read2_b32 v[146:147], v238 offset0:114 offset1:115
    v_mfma_f32_16x16x32_bf16 v[56:59], v[72:75], v[112:115], v[56:59]
    ds_read2_b32 v[148:149], v238 offset0:240 offset1:241
    v_alignbit_b32 v231, v232, v231, 16
    v_mfma_f32_16x16x32_bf16 v[56:59], v[76:79], v[108:111], v[56:59]
    ds_read2_b32 v[150:151], v238 offset0:242 offset1:243
    v_xor_b32 v245, 64, v245
    v_mfma_f32_16x16x32_bf16 v[56:59], v[80:83], v[104:107], v[56:59]
    ds_read2_b32 v[152:153], v239 offset0:112 offset1:113
    v_mfma_f32_16x16x32_bf16 v[56:59], v[84:87], v[100:103], v[56:59]
    ds_read2_b32 v[154:155], v239 offset0:114 offset1:115
    v_mfma_f32_16x16x32_bf16 v[56:59], v[88:91], v[96:99], v[56:59]
    ds_read2_b32 v[156:157], v239 offset0:240 offset1:241
    v_alignbit_b32 v232, v233, v232, 16
    v_mfma_f32_16x16x32_bf16 v[60:63], v[92:95], v[96:99], v[60:63]
    s_add_u32 m0, s73, 49152
    ds_read2_b32 v[158:159], v239 offset0:242 offset1:243
    v_mfma_f32_16x16x32_bf16 v[60:63], v[88:91], v[100:103], v[60:63]
    buffer_load_dwordx4 v6, s[52:55], s14 offen offset:2048 lds
    v_xor_b32 v246, 64, v246
    v_mfma_f32_16x16x32_bf16 v[60:63], v[84:87], v[104:107], v[60:63]
    v_alignbit_b32 v233, v234, v233, 16
    v_add_u32 v236, 8320, v236
    v_mfma_f32_16x16x32_bf16 v[60:63], v[80:83], v[108:111], v[60:63]
    v_add_u32 v237, 8320, v237
    v_mfma_f32_16x16x32_bf16 v[60:63], v[76:79], v[112:115], v[60:63]
    v_mfma_f32_16x16x32_bf16 v[60:63], v[72:75], v[116:119], v[60:63]
    v_xor_b32 v247, 64, v247
    v_add_u32 v238, 8320, v238
    v_mfma_f32_16x16x32_bf16 v[60:63], v[68:71], v[120:123], v[60:63]
    ds_write_b128 v241, v[230:233] offset:15584
    v_mfma_f32_16x16x32_bf16 v[60:63], v[64:67], v[124:127], v[60:63]
    v_add_u32 v239, 8320, v239
    s_waitcnt lgkmcnt(1)
    v_mfma_f32_16x16x32_bf16 v[60:63], v[128:131], v[188:191], v[60:63]
    ds_read_b128 v[96:99], v244 offset:2048
    v_mfma_f32_16x16x32_bf16 v[60:63], v[132:135], v[184:187], v[60:63]
    ds_read2_b32 v[64:65], v236 offset0:0 offset1:1
    v_mfma_f32_16x16x32_bf16 v[60:63], v[136:139], v[180:183], v[60:63]
    ds_read2_b32 v[66:67], v236 offset0:2 offset1:3
    v_mfma_f32_16x16x32_bf16 v[60:63], v[140:143], v[176:179], v[60:63]
    s_add_u32 m0, s73, 49152
    ds_read_b128 v[100:103], v244 offset:6144
    v_mfma_f32_16x16x32_bf16 v[60:63], v[144:147], v[172:175], v[60:63]
    buffer_load_dwordx4 v7, s[52:55], s14 offen offset:3072 lds
    ds_read2_b32 v[68:69], v236 offset0:128 offset1:129
    v_mfma_f32_16x16x32_bf16 v[60:63], v[148:151], v[168:171], v[60:63]
    ds_read2_b32 v[70:71], v236 offset0:130 offset1:131
    v_mfma_f32_16x16x32_bf16 v[60:63], v[152:155], v[164:167], v[60:63]
    ds_read_b128 v[104:107], v244 offset:10240
    v_mfma_f32_16x16x32_bf16 v[60:63], v[156:159], v[160:163], v[60:63]
    ds_read2_b32 v[72:73], v237 offset0:0 offset1:1
    v_mfma_f32_16x16x32_bf16 v[56:59], v[128:131], v[184:187], v[56:59]
    ds_read2_b32 v[74:75], v237 offset0:2 offset1:3
    v_mfma_f32_16x16x32_bf16 v[56:59], v[132:135], v[180:183], v[56:59]
    ds_read_b128 v[108:111], v244 offset:14336
    v_mfma_f32_16x16x32_bf16 v[56:59], v[136:139], v[176:179], v[56:59]
    ds_read2_b32 v[76:77], v237 offset0:128 offset1:129
    v_mfma_f32_16x16x32_bf16 v[56:59], v[140:143], v[172:175], v[56:59]
    ds_read2_b32 v[78:79], v237 offset0:130 offset1:131
    v_mfma_f32_16x16x32_bf16 v[56:59], v[144:147], v[168:171], v[56:59]
    ds_read_b128 v[112:115], v244 offset:18432
    v_mfma_f32_16x16x32_bf16 v[56:59], v[148:151], v[164:167], v[56:59]
    ds_read2_b32 v[80:81], v238 offset0:0 offset1:1
    v_cvt_pk_bf16_f32 v206, v60, v61
    v_mfma_f32_16x16x32_bf16 v[56:59], v[152:155], v[160:163], v[56:59]
    ds_read2_b32 v[82:83], v238 offset0:2 offset1:3
    v_mfma_f32_16x16x32_bf16 v[52:55], v[128:131], v[180:183], v[52:55]
    ds_read_b128 v[116:119], v244 offset:22528
    v_mfma_f32_16x16x32_bf16 v[52:55], v[132:135], v[176:179], v[52:55]
    ds_read2_b32 v[84:85], v238 offset0:128 offset1:129
    v_cvt_pk_bf16_f32 v207, v62, v63
    v_mfma_f32_16x16x32_bf16 v[52:55], v[136:139], v[172:175], v[52:55]
    ds_read2_b32 v[86:87], v238 offset0:130 offset1:131
    v_mfma_f32_16x16x32_bf16 v[52:55], v[140:143], v[168:171], v[52:55]
    buffer_store_dwordx2 v[206:207], v8, s[44:47], s6 offen offset:3584 sc1
    ds_read_b128 v[120:123], v244 offset:26624
    v_mfma_f32_16x16x32_bf16 v[52:55], v[144:147], v[164:167], v[52:55]
    ds_read2_b32 v[88:89], v239 offset0:0 offset1:1
    v_mfma_f32_16x16x32_bf16 v[52:55], v[148:151], v[160:163], v[52:55]
    ds_read2_b32 v[90:91], v239 offset0:2 offset1:3
    v_mfma_f32_16x16x32_bf16 v[48:51], v[128:131], v[176:179], v[48:51]
    s_waitcnt vmcnt(5)
    s_barrier
    v_cvt_pk_bf16_f32 v204, v56, v57
    v_mfma_f32_16x16x32_bf16 v[48:51], v[132:135], v[172:175], v[48:51]
    ds_read_b128 v[124:127], v244 offset:30720
    v_add_u32 v10, 131072, v10
    v_mfma_f32_16x16x32_bf16 v[48:51], v[136:139], v[168:171], v[48:51]
    ds_read_b64_tr_b16 a[32:33], v10 offset:16384
    v_mfma_f32_16x16x32_bf16 v[48:51], v[140:143], v[164:167], v[48:51]
    ds_read2_b32 v[92:93], v239 offset0:128 offset1:129
    v_cvt_pk_bf16_f32 v205, v58, v59
    v_mfma_f32_16x16x32_bf16 v[48:51], v[144:147], v[160:163], v[48:51]
    ds_read_b64_tr_b16 a[34:35], v10 offset:18432
    v_mfma_f32_16x16x32_bf16 v[44:47], v[128:131], v[172:175], v[44:47]
    buffer_store_dwordx2 v[204:205], v8, s[44:47], s6 offen offset:3072 sc1
    ds_read_b64_tr_b16 a[40:41], v10 offset:20480
    v_mfma_f32_16x16x32_bf16 v[44:47], v[132:135], v[168:171], v[44:47]
    ds_read_b64_tr_b16 a[42:43], v10 offset:22528
    v_mfma_f32_16x16x32_bf16 v[44:47], v[136:139], v[164:167], v[44:47]
    ds_read2_b32 v[94:95], v239 offset0:130 offset1:131
    v_add_u32 v11, 131072, v11
    v_mfma_f32_16x16x32_bf16 v[44:47], v[140:143], v[160:163], v[44:47]
    ds_read_b64_tr_b16 a[36:37], v11 offset:16384
    v_cvt_pk_bf16_f32 v202, v52, v53
    v_mfma_f32_16x16x32_bf16 v[40:43], v[128:131], v[168:171], v[40:43]
    v_mfma_f32_16x16x32_bf16 v[40:43], v[132:135], v[164:167], v[40:43]
    ds_read_b64_tr_b16 a[38:39], v11 offset:18432
    v_mfma_f32_16x16x32_bf16 v[40:43], v[136:139], v[160:163], v[40:43]
    ds_read_b64_tr_b16 a[44:45], v11 offset:20480
    v_cvt_pk_bf16_f32 v203, v54, v55
    v_mfma_f32_16x16x32_bf16 v[36:39], v[128:131], v[164:167], v[36:39]
    ds_read_b64_tr_b16 a[46:47], v11 offset:22528
    v_mfma_f32_16x16x32_bf16 v[36:39], v[132:135], v[160:163], v[36:39]
    buffer_store_dwordx2 v[202:203], v8, s[44:47], s6 offen offset:2560 sc1
    v_mfma_f32_16x16x32_bf16 v[32:35], v[128:131], v[160:163], v[32:35]
    s_waitcnt lgkmcnt(4)
    v_mfma_f32_16x16x32_bf16 v[60:63], v[64:67], v[124:127], 0
    ds_read_b128 v[160:163], v245 offset:2048
    s_waitcnt lgkmcnt(1)
    s_barrier
    v_mfma_f32_16x16x32_bf16 v[60:63], v[68:71], v[120:123], v[60:63]
    v_cvt_pk_bf16_f32 v200, v48, v49
    v_mfma_f32_16x16x32_bf16 v[60:63], v[72:75], v[116:119], v[60:63]
    ds_read2_b32 v[128:129], v236 offset0:16 offset1:17
    v_mfma_f32_16x16x32_bf16 v[60:63], v[76:79], v[112:115], v[60:63]
    ds_read2_b32 v[130:131], v236 offset0:18 offset1:19
    s_lshl_b32 s14, s88, 18
    v_cvt_pk_bf16_f32 v201, v50, v51
    v_mfma_f32_16x16x32_bf16 v[60:63], v[80:83], v[108:111], v[60:63]
    s_add_u32 m0, s73, 147456
    v_mfma_f32_16x16x32_bf16 v[60:63], v[84:87], v[104:107], v[60:63]
    buffer_load_dwordx4 v4, s[52:55], s14 offen offset:0 lds
    ds_read_b128 v[164:167], v245 offset:6144
    v_mfma_f32_16x16x32_bf16 v[60:63], v[88:91], v[100:103], v[60:63]
    buffer_store_dwordx2 v[200:201], v8, s[44:47], s6 offen offset:2048 sc1
    ds_read2_b32 v[132:133], v236 offset0:144 offset1:145
    v_mfma_f32_16x16x32_bf16 v[60:63], v[92:95], v[96:99], v[60:63]
    s_add_u32 s13, s12, 32768
    v_cvt_pk_bf16_f32 v198, v44, v45
    v_mfma_f32_16x16x32_bf16 v[56:59], v[64:67], v[120:123], 0
    ds_read2_b32 v[134:135], v236 offset0:146 offset1:147
    v_mfma_f32_16x16x32_bf16 v[56:59], v[68:71], v[116:119], v[56:59]
    s_add_u32 m0, s74, 32
    ds_read_b128 v[168:171], v245 offset:10240
    v_mfma_f32_16x16x32_bf16 v[56:59], v[72:75], v[112:115], v[56:59]
    buffer_load_dwordx4 v240, s[48:51], s13 offen offset:0 lds
    v_cvt_pk_bf16_f32 v199, v46, v47
    v_mfma_f32_16x16x32_bf16 v[56:59], v[76:79], v[108:111], v[56:59]
    ds_read2_b32 v[136:137], v237 offset0:16 offset1:17
    v_mfma_f32_16x16x32_bf16 v[56:59], v[80:83], v[104:107], v[56:59]
    buffer_store_dwordx2 v[198:199], v8, s[44:47], s6 offen offset:1536 sc1
    ds_read2_b32 v[138:139], v237 offset0:18 offset1:19
    v_mfma_f32_16x16x32_bf16 v[56:59], v[84:87], v[100:103], v[56:59]
    ds_read_b128 v[172:175], v245 offset:14336
    v_mfma_f32_16x16x32_bf16 v[56:59], v[88:91], v[96:99], v[56:59]
    v_cvt_pk_bf16_f32 v196, v40, v41
    v_mfma_f32_16x16x32_bf16 v[52:55], v[64:67], v[116:119], 0
    ds_read2_b32 v[140:141], v237 offset0:144 offset1:145
    v_mfma_f32_16x16x32_bf16 v[52:55], v[68:71], v[112:115], v[52:55]
    ds_read2_b32 v[142:143], v237 offset0:146 offset1:147
    s_add_u32 m0, s73, 147456
    v_cvt_pk_bf16_f32 v197, v42, v43
    v_mfma_f32_16x16x32_bf16 v[52:55], v[72:75], v[108:111], v[52:55]
    buffer_load_dwordx4 v5, s[52:55], s14 offen offset:1024 lds
    v_mfma_f32_16x16x32_bf16 v[52:55], v[76:79], v[104:107], v[52:55]
    buffer_store_dwordx2 v[196:197], v8, s[44:47], s6 offen offset:1024 sc1
    ds_read_b128 v[176:179], v245 offset:18432
    s_add_u32 m0, s74, 32
    v_mfma_f32_16x16x32_bf16 v[52:55], v[80:83], v[100:103], v[52:55]
    buffer_load_dwordx4 v240, s[48:51], s13 offen offset:1024 lds
    ds_read2_b32 v[144:145], v238 offset0:16 offset1:17
    v_mfma_f32_16x16x32_bf16 v[52:55], v[84:87], v[96:99], v[52:55]
    v_mfma_f32_16x16x32_bf16 v[48:51], v[64:67], v[112:115], 0
    ds_read2_b32 v[146:147], v238 offset0:18 offset1:19
    v_cvt_pk_bf16_f32 v194, v36, v37
    v_mfma_f32_16x16x32_bf16 v[48:51], v[68:71], v[108:111], v[48:51]
    ds_read_b128 v[180:183], v245 offset:22528
    v_mfma_f32_16x16x32_bf16 v[48:51], v[72:75], v[104:107], v[48:51]
    v_cvt_pk_bf16_f32 v195, v38, v39
    v_mfma_f32_16x16x32_bf16 v[48:51], v[76:79], v[100:103], v[48:51]
    buffer_store_dwordx2 v[194:195], v8, s[44:47], s6 offen offset:512 sc1
    ds_read2_b32 v[148:149], v238 offset0:144 offset1:145
    s_add_u32 m0, s74, 32
    v_mfma_f32_16x16x32_bf16 v[48:51], v[80:83], v[96:99], v[48:51]
    buffer_load_dwordx4 v240, s[48:51], s13 offen offset:2048 lds
    ds_read2_b32 v[150:151], v238 offset0:146 offset1:147
    v_mfma_f32_16x16x32_bf16 v[44:47], v[64:67], v[108:111], 0
    ds_read_b128 v[184:187], v245 offset:26624
    v_mfma_f32_16x16x32_bf16 v[44:47], v[68:71], v[104:107], v[44:47]
    v_cvt_pk_bf16_f32 v192, v32, v33
    v_mfma_f32_16x16x32_bf16 v[44:47], v[72:75], v[100:103], v[44:47]
    s_add_u32 m0, s73, 147456
    ds_read2_b32 v[152:153], v239 offset0:16 offset1:17
    v_mfma_f32_16x16x32_bf16 v[44:47], v[76:79], v[96:99], v[44:47]
    buffer_load_dwordx4 v6, s[52:55], s14 offen offset:2048 lds
    v_cvt_pk_bf16_f32 v193, v34, v35
    v_mfma_f32_16x16x32_bf16 v[40:43], v[64:67], v[104:107], 0
    ds_read2_b32 v[154:155], v239 offset0:18 offset1:19
    v_mfma_f32_16x16x32_bf16 v[40:43], v[68:71], v[100:103], v[40:43]
    buffer_store_dwordx2 v[192:193], v8, s[44:47], s6 offen offset:0 sc1
    ds_read_b128 v[188:191], v245 offset:30720
    v_mfma_f32_16x16x32_bf16 v[40:43], v[72:75], v[96:99], v[40:43]
    s_add_u32 m0, s74, 32
    ds_read2_b32 v[156:157], v239 offset0:144 offset1:145
    v_mfma_f32_16x16x32_bf16 v[36:39], v[64:67], v[100:103], 0
    buffer_load_dwordx4 v240, s[48:51], s13 offen offset:3072 lds
    v_mfma_f32_16x16x32_bf16 v[36:39], v[68:71], v[96:99], v[36:39]
    ds_read2_b32 v[158:159], v239 offset0:146 offset1:147
    v_mfma_f32_16x16x32_bf16 v[32:35], v[64:67], v[96:99], 0
    s_waitcnt lgkmcnt(12)
    v_mfma_f32_16x16x32_bf16 v[32:35], v[128:131], v[160:163], v[32:35]
    ds_read_b128 v[96:99], v246 offset:2048
    v_mfma_f32_16x16x32_bf16 v[36:39], v[132:135], v[160:163], v[36:39]
    v_mfma_f32_16x16x32_bf16 v[36:39], v[128:131], v[164:167], v[36:39]
    ds_read2_b32 v[64:65], v236 offset0:32 offset1:33
    v_mfma_f32_16x16x32_bf16 v[40:43], v[128:131], v[168:171], v[40:43]
    s_add_u32 m0, s73, 147456
    ds_read2_b32 v[66:67], v236 offset0:34 offset1:35
    v_mfma_f32_16x16x32_bf16 v[40:43], v[132:135], v[164:167], v[40:43]
    buffer_load_dwordx4 v7, s[52:55], s14 offen offset:3072 lds
    v_mfma_f32_16x16x32_bf16 v[40:43], v[136:139], v[160:163], v[40:43]
    ds_read_b128 v[100:103], v246 offset:6144
    v_mfma_f32_16x16x32_bf16 v[44:47], v[140:143], v[160:163], v[44:47]
    ds_read2_b32 v[68:69], v236 offset0:160 offset1:161
    v_mfma_f32_16x16x32_bf16 v[44:47], v[136:139], v[164:167], v[44:47]
    ds_read2_b32 v[70:71], v236 offset0:162 offset1:163
    v_mfma_f32_16x16x32_bf16 v[44:47], v[132:135], v[168:171], v[44:47]
    ds_read_b128 v[104:107], v246 offset:10240
    v_mfma_f32_16x16x32_bf16 v[44:47], v[128:131], v[172:175], v[44:47]
    ds_read2_b32 v[72:73], v237 offset0:32 offset1:33
    s_waitcnt lgkmcnt(8)
    v_mfma_f32_16x16x32_bf16 v[48:51], v[128:131], v[176:179], v[48:51]
    ds_read2_b32 v[74:75], v237 offset0:34 offset1:35
    v_mfma_f32_16x16x32_bf16 v[48:51], v[132:135], v[172:175], v[48:51]
    ds_read_b128 v[108:111], v246 offset:14336
    v_mfma_f32_16x16x32_bf16 v[48:51], v[136:139], v[168:171], v[48:51]
    v_mov_b32 v9, 16
    buffer_load_ushort v9, v9, s[56:59], s70 offen
    v_mfma_f32_16x16x32_bf16 v[48:51], v[140:143], v[164:167], v[48:51]
    ds_read2_b32 v[76:77], v237 offset0:160 offset1:161
    v_mfma_f32_16x16x32_bf16 v[48:51], v[144:147], v[160:163], v[48:51]
    ds_read2_b32 v[78:79], v237 offset0:162 offset1:163
    s_waitcnt vmcnt(17)
    s_barrier
    v_mfma_f32_16x16x32_bf16 v[52:55], v[148:151], v[160:163], v[52:55]
    ds_read_b128 v[112:115], v246 offset:18432
    v_add_u32 v10, -131072, v10
    v_mfma_f32_16x16x32_bf16 v[52:55], v[144:147], v[164:167], v[52:55]
    ds_read_b64_tr_b16 a[48:49], v10 offset:49152
    v_mfma_f32_16x16x32_bf16 v[52:55], v[140:143], v[168:171], v[52:55]
    ds_read_b64_tr_b16 a[50:51], v10 offset:51200
    v_mfma_f32_16x16x32_bf16 v[52:55], v[136:139], v[172:175], v[52:55]
    ds_read2_b32 v[80:81], v238 offset0:32 offset1:33
    v_mfma_f32_16x16x32_bf16 v[52:55], v[132:135], v[176:179], v[52:55]
    ds_read_b64_tr_b16 a[56:57], v10 offset:53248
    v_mfma_f32_16x16x32_bf16 v[52:55], v[128:131], v[180:183], v[52:55]
    ds_read_b64_tr_b16 a[58:59], v10 offset:55296
    v_mfma_f32_16x16x32_bf16 v[56:59], v[128:131], v[184:187], v[56:59]
    ds_read2_b32 v[82:83], v238 offset0:34 offset1:35
    v_add_u32 v11, -131072, v11
    v_mfma_f32_16x16x32_bf16 v[56:59], v[132:135], v[180:183], v[56:59]
    ds_read_b64_tr_b16 a[52:53], v11 offset:49152
    v_mfma_f32_16x16x32_bf16 v[56:59], v[136:139], v[176:179], v[56:59]
    ds_read_b64_tr_b16 a[54:55], v11 offset:51200
    v_mfma_f32_16x16x32_bf16 v[56:59], v[140:143], v[172:175], v[56:59]
    ds_read_b128 v[116:119], v246 offset:22528
    v_mfma_f32_16x16x32_bf16 v[56:59], v[144:147], v[168:171], v[56:59]
    ds_read_b64_tr_b16 a[60:61], v11 offset:53248
    v_mfma_f32_16x16x32_bf16 v[56:59], v[148:151], v[164:167], v[56:59]
    ds_read_b64_tr_b16 a[62:63], v11 offset:55296
    v_mfma_f32_16x16x32_bf16 v[56:59], v[152:155], v[160:163], v[56:59]
    ds_read2_b32 v[84:85], v238 offset0:160 offset1:161
    v_mfma_f32_16x16x32_bf16 v[60:63], v[156:159], v[160:163], v[60:63]
    ds_read2_b32 v[86:87], v238 offset0:162 offset1:163
    v_mfma_f32_16x16x32_bf16 v[60:63], v[152:155], v[164:167], v[60:63]
    ds_read_b128 v[120:123], v246 offset:26624
    v_mfma_f32_16x16x32_bf16 v[60:63], v[148:151], v[168:171], v[60:63]
    ds_read2_b32 v[88:89], v239 offset0:32 offset1:33
    v_mfma_f32_16x16x32_bf16 v[60:63], v[144:147], v[172:175], v[60:63]
    ds_read2_b32 v[90:91], v239 offset0:34 offset1:35
    v_mfma_f32_16x16x32_bf16 v[60:63], v[140:143], v[176:179], v[60:63]
    ds_read_b128 v[124:127], v246 offset:30720
    v_mfma_f32_16x16x32_bf16 v[60:63], v[136:139], v[180:183], v[60:63]
    ds_read2_b32 v[92:93], v239 offset0:160 offset1:161
    v_mfma_f32_16x16x32_bf16 v[60:63], v[132:135], v[184:187], v[60:63]
    ds_read2_b32 v[94:95], v239 offset0:162 offset1:163
    v_mfma_f32_16x16x32_bf16 v[60:63], v[128:131], v[188:191], v[60:63]
    s_waitcnt lgkmcnt(15)
    v_mfma_f32_16x16x32_bf16 v[32:35], v[64:67], v[96:99], v[32:35]
    ds_read_b128 v[160:163], v247 offset:2048
    v_mfma_f32_16x16x32_bf16 v[36:39], v[68:71], v[96:99], v[36:39]
    v_mfma_f32_16x16x32_bf16 v[36:39], v[64:67], v[100:103], v[36:39]
    ds_read2_b32 v[128:129], v236 offset0:48 offset1:49
    v_mfma_f32_16x16x32_bf16 v[40:43], v[64:67], v[104:107], v[40:43]
    ds_read2_b32 v[130:131], v236 offset0:50 offset1:51
    v_mfma_f32_16x16x32_bf16 v[40:43], v[68:71], v[100:103], v[40:43]
    v_mfma_f32_16x16x32_bf16 v[40:43], v[72:75], v[96:99], v[40:43]
    ds_read_b128 v[164:167], v247 offset:6144
    v_mfma_f32_16x16x32_bf16 v[44:47], v[76:79], v[96:99], v[44:47]
    ds_read2_b32 v[132:133], v236 offset0:176 offset1:177
    v_mfma_f32_16x16x32_bf16 v[44:47], v[72:75], v[100:103], v[44:47]
    s_waitcnt lgkmcnt(13)
    s_barrier
    v_mfma_f32_16x16x32_bf16 v[44:47], v[68:71], v[104:107], v[44:47]
    ds_read2_b32 v[134:135], v236 offset0:178 offset1:179
    v_mfma_f32_16x16x32_bf16 v[44:47], v[64:67], v[108:111], v[44:47]
    ds_read_b128 v[168:171], v247 offset:10240
    s_waitcnt lgkmcnt(7)
    v_mfma_f32_16x16x32_bf16 v[48:51], v[64:67], v[112:115], v[48:51]
    ds_read2_b32 v[136:137], v237 offset0:48 offset1:49
    v_mfma_f32_16x16x32_bf16 v[48:51], v[68:71], v[108:111], v[48:51]
    v_mfma_f32_16x16x32_bf16 v[48:51], v[72:75], v[104:107], v[48:51]
    ds_read2_b32 v[138:139], v237 offset0:50 offset1:51
    v_mfma_f32_16x16x32_bf16 v[48:51], v[76:79], v[100:103], v[48:51]
    ds_read_b128 v[172:175], v247 offset:14336
    v_mfma_f32_16x16x32_bf16 v[48:51], v[80:83], v[96:99], v[48:51]
    v_mfma_f32_16x16x32_bf16 v[52:55], v[84:87], v[96:99], v[52:55]
    ds_read2_b32 v[140:141], v237 offset0:176 offset1:177
    v_mfma_f32_16x16x32_bf16 v[52:55], v[80:83], v[100:103], v[52:55]
    ds_read2_b32 v[142:143], v237 offset0:178 offset1:179
    v_mfma_f32_16x16x32_bf16 v[52:55], v[76:79], v[104:107], v[52:55]
    v_mfma_f32_16x16x32_bf16 v[52:55], v[72:75], v[108:111], v[52:55]
    ds_read_b128 v[176:179], v247 offset:18432
    v_mfma_f32_16x16x32_bf16 v[52:55], v[68:71], v[112:115], v[52:55]
    ds_read2_b32 v[144:145], v238 offset0:48 offset1:49
    v_mfma_f32_16x16x32_bf16 v[52:55], v[64:67], v[116:119], v[52:55]
    v_mfma_f32_16x16x32_bf16 v[56:59], v[64:67], v[120:123], v[56:59]
    ds_read2_b32 v[146:147], v238 offset0:50 offset1:51
    v_mfma_f32_16x16x32_bf16 v[56:59], v[68:71], v[116:119], v[56:59]
    ds_read_b128 v[180:183], v247 offset:22528
    v_mfma_f32_16x16x32_bf16 v[56:59], v[72:75], v[112:115], v[56:59]
    v_mfma_f32_16x16x32_bf16 v[56:59], v[76:79], v[108:111], v[56:59]
    ds_read2_b32 v[148:149], v238 offset0:176 offset1:177
    v_mfma_f32_16x16x32_bf16 v[56:59], v[80:83], v[104:107], v[56:59]
    ds_read2_b32 v[150:151], v238 offset0:178 offset1:179
    v_mfma_f32_16x16x32_bf16 v[56:59], v[84:87], v[100:103], v[56:59]
    ds_read_b128 v[184:187], v247 offset:26624
    v_mfma_f32_16x16x32_bf16 v[56:59], v[88:91], v[96:99], v[56:59]
    v_mfma_f32_16x16x32_bf16 v[60:63], v[92:95], v[96:99], v[60:63]
    ds_read2_b32 v[152:153], v239 offset0:48 offset1:49
    v_mfma_f32_16x16x32_bf16 v[60:63], v[88:91], v[100:103], v[60:63]
    ds_read2_b32 v[154:155], v239 offset0:50 offset1:51
    v_mfma_f32_16x16x32_bf16 v[60:63], v[84:87], v[104:107], v[60:63]
    v_mfma_f32_16x16x32_bf16 v[60:63], v[80:83], v[108:111], v[60:63]
    ds_read_b128 v[188:191], v247 offset:30720
    v_mfma_f32_16x16x32_bf16 v[60:63], v[76:79], v[112:115], v[60:63]
    ds_read2_b32 v[156:157], v239 offset0:176 offset1:177
    v_mfma_f32_16x16x32_bf16 v[60:63], v[72:75], v[116:119], v[60:63]
    v_mfma_f32_16x16x32_bf16 v[60:63], v[68:71], v[120:123], v[60:63]
    ds_read2_b32 v[158:159], v239 offset0:178 offset1:179
    v_mfma_f32_16x16x32_bf16 v[60:63], v[64:67], v[124:127], v[60:63]
    s_waitcnt lgkmcnt(12)
    v_mfma_f32_16x16x32_bf16 v[32:35], v[128:131], v[160:163], v[32:35]
    ds_read_b128 v[96:99], v244 offset:0
    v_mfma_f32_16x16x32_bf16 v[36:39], v[132:135], v[160:163], v[36:39]
    v_mfma_f32_16x16x32_bf16 v[36:39], v[128:131], v[164:167], v[36:39]
    ds_read2_b32 v[64:65], v236 offset0:64 offset1:65
    v_mfma_f32_16x16x32_bf16 v[40:43], v[128:131], v[168:171], v[40:43]
    ds_read2_b32 v[66:67], v236 offset0:66 offset1:67
    v_mfma_f32_16x16x32_bf16 v[40:43], v[132:135], v[164:167], v[40:43]
    v_mfma_f32_16x16x32_bf16 v[40:43], v[136:139], v[160:163], v[40:43]
    ds_read_b128 v[100:103], v244 offset:4096
    v_mfma_f32_16x16x32_bf16 v[44:47], v[140:143], v[160:163], v[44:47]
    ds_read2_b32 v[68:69], v236 offset0:192 offset1:193
    v_mfma_f32_16x16x32_bf16 v[44:47], v[136:139], v[164:167], v[44:47]
    s_add_u32 m0, s9, 36864
    s_add_u32 s13, s7, 128
    v_mfma_f32_16x16x32_bf16 v[44:47], v[132:135], v[168:171], v[44:47]
    buffer_load_dwordx4 v24, s[44:47], s13 offen sc1 lds
    ds_read2_b32 v[70:71], v236 offset0:194 offset1:195
    v_mfma_f32_16x16x32_bf16 v[44:47], v[128:131], v[172:175], v[44:47]
    ds_read_b128 v[104:107], v244 offset:8192
    s_waitcnt lgkmcnt(7)
    v_mfma_f32_16x16x32_bf16 v[48:51], v[128:131], v[176:179], v[48:51]
    ds_read2_b32 v[72:73], v237 offset0:64 offset1:65
    v_mfma_f32_16x16x32_bf16 v[48:51], v[132:135], v[172:175], v[48:51]
    ds_read2_b32 v[74:75], v237 offset0:66 offset1:67
    v_mfma_f32_16x16x32_bf16 v[48:51], v[136:139], v[168:171], v[48:51]
    ds_read_b128 v[108:111], v244 offset:12288
    v_mfma_f32_16x16x32_bf16 v[48:51], v[140:143], v[164:167], v[48:51]
    ds_read2_b32 v[76:77], v237 offset0:192 offset1:193
    v_mfma_f32_16x16x32_bf16 v[48:51], v[144:147], v[160:163], v[48:51]
    ds_read2_b32 v[78:79], v237 offset0:194 offset1:195
    v_mfma_f32_16x16x32_bf16 v[52:55], v[148:151], v[160:163], v[52:55]
    ds_read_b128 v[112:115], v244 offset:16384
    v_mfma_f32_16x16x32_bf16 v[52:55], v[144:147], v[164:167], v[52:55]
    ds_read2_b32 v[80:81], v238 offset0:64 offset1:65
    s_add_u32 m0, s9, 37888
    s_add_u32 s13, s7, 73856
    v_mfma_f32_16x16x32_bf16 v[52:55], v[140:143], v[168:171], v[52:55]
    buffer_load_dwordx4 v25, s[44:47], s13 offen sc1 lds
    ds_read2_b32 v[82:83], v238 offset0:66 offset1:67
    v_mfma_f32_16x16x32_bf16 v[52:55], v[136:139], v[172:175], v[52:55]
    ds_read_b128 v[116:119], v244 offset:20480
    v_mfma_f32_16x16x32_bf16 v[52:55], v[132:135], v[176:179], v[52:55]
    ds_read2_b32 v[84:85], v238 offset0:192 offset1:193
    v_mfma_f32_16x16x32_bf16 v[52:55], v[128:131], v[180:183], v[52:55]
    ds_read2_b32 v[86:87], v238 offset0:194 offset1:195
    v_mfma_f32_16x16x32_bf16 v[56:59], v[128:131], v[184:187], v[56:59]
    ds_read_b128 v[120:123], v244 offset:24576
    s_waitcnt vmcnt(3)
    s_barrier
    v_mfma_f32_16x16x32_bf16 v[56:59], v[132:135], v[180:183], v[56:59]
    ds_read2_b32 v[88:89], v239 offset0:64 offset1:65
    v_add_u32 v10, 131072, v10
    v_mfma_f32_16x16x32_bf16 v[56:59], v[136:139], v[176:179], v[56:59]
    ds_read_b64_tr_b16 a[64:65], v10 offset:16384
    v_mfma_f32_16x16x32_bf16 v[56:59], v[140:143], v[172:175], v[56:59]
    ds_read2_b32 v[90:91], v239 offset0:66 offset1:67
    v_mfma_f32_16x16x32_bf16 v[56:59], v[144:147], v[168:171], v[56:59]
    ds_read_b64_tr_b16 a[66:67], v10 offset:18432
    s_add_u32 m0, s9, 38912
    s_add_u32 s13, s7, 147584
    v_mfma_f32_16x16x32_bf16 v[56:59], v[148:151], v[164:167], v[56:59]
    ds_read_b64_tr_b16 a[72:73], v10 offset:20480
    buffer_load_dwordx4 v24, s[44:47], s13 offen sc1 lds
    v_mfma_f32_16x16x32_bf16 v[56:59], v[152:155], v[160:163], v[56:59]
    ds_read_b64_tr_b16 a[74:75], v10 offset:22528
    v_mfma_f32_16x16x32_bf16 v[60:63], v[156:159], v[160:163], v[60:63]
    ds_read_b128 v[124:127], v244 offset:28672
    v_add_u32 v11, 131072, v11
    v_mfma_f32_16x16x32_bf16 v[60:63], v[152:155], v[164:167], v[60:63]
    ds_read_b64_tr_b16 a[68:69], v11 offset:16384
    v_mfma_f32_16x16x32_bf16 v[60:63], v[148:151], v[168:171], v[60:63]
    ds_read2_b32 v[92:93], v239 offset0:192 offset1:193
    v_mfma_f32_16x16x32_bf16 v[60:63], v[144:147], v[172:175], v[60:63]
    ds_read_b64_tr_b16 a[70:71], v11 offset:18432
    v_mfma_f32_16x16x32_bf16 v[60:63], v[140:143], v[176:179], v[60:63]
    ds_read_b64_tr_b16 a[76:77], v11 offset:20480
    v_mfma_f32_16x16x32_bf16 v[60:63], v[136:139], v[180:183], v[60:63]
    ds_read_b64_tr_b16 a[78:79], v11 offset:22528
    v_mfma_f32_16x16x32_bf16 v[60:63], v[132:135], v[184:187], v[60:63]
    ds_read2_b32 v[94:95], v239 offset0:194 offset1:195
    s_add_u32 m0, s9, 39936
    s_add_u32 s13, s7, 221312
    v_mfma_f32_16x16x32_bf16 v[60:63], v[128:131], v[188:191], v[60:63]
    buffer_load_dwordx4 v25, s[44:47], s13 offen sc1 lds
    s_waitcnt lgkmcnt(15)
    v_mfma_f32_16x16x32_bf16 v[32:35], v[64:67], v[96:99], v[32:35]
    ds_read_b128 v[160:163], v245 offset:0
    s_waitcnt lgkmcnt(2)
    s_barrier
    v_mfma_f32_16x16x32_bf16 v[36:39], v[68:71], v[96:99], v[36:39]
    v_mfma_f32_16x16x32_bf16 v[36:39], v[64:67], v[100:103], v[36:39]
    ds_read2_b32 v[128:129], v236 offset0:80 offset1:81
    v_mfma_f32_16x16x32_bf16 v[40:43], v[64:67], v[104:107], v[40:43]
    s_lshl_b32 s14, s89, 18
    ds_read2_b32 v[130:131], v236 offset0:82 offset1:83
    v_mfma_f32_16x16x32_bf16 v[40:43], v[68:71], v[100:103], v[40:43]
    s_add_u32 m0, s73, 147456
    v_mfma_f32_16x16x32_bf16 v[40:43], v[72:75], v[96:99], v[40:43]
    buffer_load_dwordx4 v4, s[52:55], s14 offen offset:0 lds
    ds_read_b128 v[164:167], v245 offset:4096
    v_mfma_f32_16x16x32_bf16 v[44:47], v[76:79], v[96:99], v[44:47]
    ds_read2_b32 v[132:133], v236 offset0:208 offset1:209
    v_mfma_f32_16x16x32_bf16 v[44:47], v[72:75], v[100:103], v[44:47]
    s_add_u32 m0, s9, 40960
    s_add_u32 s13, s7, 295040
    v_mfma_f32_16x16x32_bf16 v[44:47], v[68:71], v[104:107], v[44:47]
    buffer_load_dwordx4 v24, s[44:47], s13 offen sc1 lds
    ds_read2_b32 v[134:135], v236 offset0:210 offset1:211
    v_mfma_f32_16x16x32_bf16 v[44:47], v[64:67], v[108:111], v[44:47]
    ds_read_b128 v[168:171], v245 offset:8192
    s_waitcnt lgkmcnt(7)
    v_mfma_f32_16x16x32_bf16 v[48:51], v[64:67], v[112:115], v[48:51]
    ds_read2_b32 v[136:137], v237 offset0:80 offset1:81
    v_mfma_f32_16x16x32_bf16 v[48:51], v[68:71], v[108:111], v[48:51]
    ds_read2_b32 v[138:139], v237 offset0:82 offset1:83
    v_mfma_f32_16x16x32_bf16 v[48:51], v[72:75], v[104:107], v[48:51]
    ds_read_b128 v[172:175], v245 offset:12288
    v_mfma_f32_16x16x32_bf16 v[48:51], v[76:79], v[100:103], v[48:51]
    ds_read2_b32 v[140:141], v237 offset0:208 offset1:209
    v_mfma_f32_16x16x32_bf16 v[48:51], v[80:83], v[96:99], v[48:51]
    ds_read2_b32 v[142:143], v237 offset0:210 offset1:211
    v_mfma_f32_16x16x32_bf16 v[52:55], v[84:87], v[96:99], v[52:55]
    ds_read_b128 v[176:179], v245 offset:16384
    v_mfma_f32_16x16x32_bf16 v[52:55], v[80:83], v[100:103], v[52:55]
    s_add_u32 m0, s73, 147456
    ds_read2_b32 v[144:145], v238 offset0:80 offset1:81
    v_mfma_f32_16x16x32_bf16 v[52:55], v[76:79], v[104:107], v[52:55]
    buffer_load_dwordx4 v5, s[52:55], s14 offen offset:1024 lds
L_pl_X_3:
    s_cbranch_execz L_pl_X_7
    ds_read2_b32 v[146:147], v238 offset0:82 offset1:83
    v_mfma_f32_16x16x32_bf16 v[52:55], v[72:75], v[108:111], v[52:55]
    ds_read_b128 v[180:183], v245 offset:20480
    s_add_u32 m0, s9, 41984
    s_add_u32 s13, s7, 368768
    v_mfma_f32_16x16x32_bf16 v[52:55], v[68:71], v[112:115], v[52:55]
    buffer_load_dwordx4 v25, s[44:47], s13 offen sc1 lds
    ds_read_b128 v[212:215], v241 offset:32
    v_mfma_f32_16x16x32_bf16 v[52:55], v[64:67], v[116:119], v[52:55]
    ds_read2_b32 v[148:149], v238 offset0:208 offset1:209
    v_mfma_f32_16x16x32_bf16 v[56:59], v[64:67], v[120:123], v[56:59]
    ds_read_b32 v216, v241 offset:48
    v_mfma_f32_16x16x32_bf16 v[56:59], v[68:71], v[116:119], v[56:59]
    ds_read2_b32 v[150:151], v238 offset0:210 offset1:211
    v_mfma_f32_16x16x32_bf16 v[56:59], v[72:75], v[112:115], v[56:59]
    ds_read_b128 v[218:221], v241 offset:1056
    v_mfma_f32_16x16x32_bf16 v[56:59], v[76:79], v[108:111], v[56:59]
    ds_read_b128 v[184:187], v245 offset:24576
    v_mfma_f32_16x16x32_bf16 v[56:59], v[80:83], v[104:107], v[56:59]
    ds_read2_b32 v[152:153], v239 offset0:80 offset1:81
    s_add_u32 m0, s9, 43008
    s_add_u32 s13, s7, 442496
    v_mfma_f32_16x16x32_bf16 v[56:59], v[84:87], v[100:103], v[56:59]
    buffer_load_dwordx4 v24, s[44:47], s13 offen sc1 lds
    ds_read_b32 v222, v241 offset:1072
    v_mfma_f32_16x16x32_bf16 v[56:59], v[88:91], v[96:99], v[56:59]
    ds_read2_b32 v[154:155], v239 offset0:82 offset1:83
    v_mfma_f32_16x16x32_bf16 v[60:63], v[92:95], v[96:99], v[60:63]
    s_add_u32 m0, s73, 147456
    ds_read_b128 v[224:227], v241 offset:2080
    v_mfma_f32_16x16x32_bf16 v[60:63], v[88:91], v[100:103], v[60:63]
    buffer_load_dwordx4 v6, s[52:55], s14 offen offset:2048 lds
    ds_read_b128 v[188:191], v245 offset:28672
    v_mfma_f32_16x16x32_bf16 v[60:63], v[84:87], v[104:107], v[60:63]
    ds_read_b32 v228, v241 offset:2096
    v_mfma_f32_16x16x32_bf16 v[60:63], v[80:83], v[108:111], v[60:63]
    ds_read2_b32 v[156:157], v239 offset0:208 offset1:209
    v_mfma_f32_16x16x32_bf16 v[60:63], v[76:79], v[112:115], v[60:63]
    ds_read_b128 v[230:233], v241 offset:3104
    v_mfma_f32_16x16x32_bf16 v[60:63], v[72:75], v[116:119], v[60:63]
    ds_read2_b32 v[158:159], v239 offset0:210 offset1:211
    v_mfma_f32_16x16x32_bf16 v[60:63], v[68:71], v[120:123], v[60:63]
    ds_read_b32 v234, v241 offset:3120
    s_add_u32 m0, s9, 44032
    s_add_u32 s13, s7, 516224
    v_mfma_f32_16x16x32_bf16 v[60:63], v[64:67], v[124:127], v[60:63]
    buffer_load_dwordx4 v25, s[44:47], s13 offen sc1 lds
    s_waitcnt lgkmcnt(15)
    v_mfma_f32_16x16x32_bf16 v[32:35], v[128:131], v[160:163], v[32:35]
    ds_read_b128 v[96:99], v246 offset:0
    v_mfma_f32_16x16x32_bf16 v[36:39], v[132:135], v[160:163], v[36:39]
    v_mfma_f32_16x16x32_bf16 v[36:39], v[128:131], v[164:167], v[36:39]
    ds_read2_b32 v[64:65], v236 offset0:96 offset1:97
    v_mfma_f32_16x16x32_bf16 v[40:43], v[128:131], v[168:171], v[40:43]
    s_add_u32 m0, s73, 147456
    ds_read2_b32 v[66:67], v236 offset0:98 offset1:99
    v_mfma_f32_16x16x32_bf16 v[40:43], v[132:135], v[164:167], v[40:43]
    buffer_load_dwordx4 v7, s[52:55], s14 offen offset:3072 lds
    s_waitcnt lgkmcnt(3)
    v_mfma_f32_16x16x32_bf16 v[40:43], v[136:139], v[160:163], v[40:43]
    ds_read_b128 v[100:103], v246 offset:4096
    v_mfma_f32_16x16x32_bf16 v[44:47], v[140:143], v[160:163], v[44:47]
    s_waitcnt vmcnt(12)
    ds_read2_b32 v[68:69], v236 offset0:224 offset1:225
    v_mfma_f32_16x16x32_bf16 v[44:47], v[136:139], v[164:167], v[44:47]
    v_mfma_f32_16x16x32_bf16 v[44:47], v[132:135], v[168:171], v[44:47]
    ds_read2_b32 v[70:71], v236 offset0:226 offset1:227
    v_lshlrev_b32 v9, 16, v9
    v_mfma_f32_16x16x32_bf16 v[44:47], v[128:131], v[172:175], v[44:47]
    ds_read_b128 v[104:107], v246 offset:8192
    v_mfma_f32_16x16x32_bf16 v[48:51], v[128:131], v[176:179], v[48:51]
    ds_read2_b32 v[72:73], v237 offset0:96 offset1:97
    v_lshlrev_b32 v208, 16, v212
    v_mfma_f32_16x16x32_bf16 v[48:51], v[132:135], v[172:175], v[48:51]
    v_mfma_f32_16x16x32_bf16 v[48:51], v[136:139], v[168:171], v[48:51]
    ds_read2_b32 v[74:75], v237 offset0:98 offset1:99
    v_add_f32 v9, v9, v208
    v_mfma_f32_16x16x32_bf16 v[48:51], v[140:143], v[164:167], v[48:51]
    ds_read_b128 v[108:111], v246 offset:12288
    v_cvt_pk_bf16_f32 v9, v9, v9
    v_mfma_f32_16x16x32_bf16 v[48:51], v[144:147], v[160:163], v[48:51]
    ds_read2_b32 v[76:77], v237 offset0:224 offset1:225
    v_mfma_f32_16x16x32_bf16 v[52:55], v[148:151], v[160:163], v[52:55]
    ds_write_b16 v242, v9 offset:4160
    v_mfma_f32_16x16x32_bf16 v[52:55], v[144:147], v[164:167], v[52:55]
    ds_read2_b32 v[78:79], v237 offset0:226 offset1:227
    v_mfma_f32_16x16x32_bf16 v[52:55], v[140:143], v[168:171], v[52:55]
    ds_write_b16 v242, v9 offset:2
    v_mfma_f32_16x16x32_bf16 v[52:55], v[136:139], v[172:175], v[52:55]
    ds_read_b128 v[112:115], v246 offset:16384
    v_mfma_f32_16x16x32_bf16 v[52:55], v[132:135], v[176:179], v[52:55]
    ds_read2_b32 v[80:81], v238 offset0:96 offset1:97
    v_alignbit_b32 v212, v213, v212, 16
    v_mfma_f32_16x16x32_bf16 v[52:55], v[128:131], v[180:183], v[52:55]
    v_alignbit_b32 v213, v214, v213, 16
    v_mfma_f32_16x16x32_bf16 v[56:59], v[128:131], v[184:187], v[56:59]
    ds_read2_b32 v[82:83], v238 offset0:98 offset1:99
    v_mfma_f32_16x16x32_bf16 v[56:59], v[132:135], v[180:183], v[56:59]
    ds_read_b128 v[116:119], v246 offset:20480
    v_alignbit_b32 v214, v215, v214, 16
    v_mfma_f32_16x16x32_bf16 v[56:59], v[136:139], v[176:179], v[56:59]
    v_mfma_f32_16x16x32_bf16 v[56:59], v[140:143], v[172:175], v[56:59]
    ds_read2_b32 v[84:85], v238 offset0:224 offset1:225
    v_alignbit_b32 v215, v216, v215, 16
    v_mfma_f32_16x16x32_bf16 v[56:59], v[144:147], v[168:171], v[56:59]
    ds_read2_b32 v[86:87], v238 offset0:226 offset1:227
    v_mfma_f32_16x16x32_bf16 v[56:59], v[148:151], v[164:167], v[56:59]
    ds_write_b128 v241, v[212:215] offset:4192
    v_mfma_f32_16x16x32_bf16 v[56:59], v[152:155], v[160:163], v[56:59]
    ds_read_b128 v[120:123], v246 offset:24576
    v_mfma_f32_16x16x32_bf16 v[60:63], v[156:159], v[160:163], v[60:63]
    ds_read2_b32 v[88:89], v239 offset0:96 offset1:97
    v_alignbit_b32 v218, v219, v218, 16
    v_mfma_f32_16x16x32_bf16 v[60:63], v[152:155], v[164:167], v[60:63]
    ds_read2_b32 v[90:91], v239 offset0:98 offset1:99
    v_alignbit_b32 v219, v220, v219, 16
    v_mfma_f32_16x16x32_bf16 v[60:63], v[148:151], v[168:171], v[60:63]
    v_mfma_f32_16x16x32_bf16 v[60:63], v[144:147], v[172:175], v[60:63]
    ds_read_b128 v[124:127], v246 offset:28672
    v_alignbit_b32 v220, v221, v220, 16
    v_mfma_f32_16x16x32_bf16 v[60:63], v[140:143], v[176:179], v[60:63]
    ds_read2_b32 v[92:93], v239 offset0:224 offset1:225
    v_mfma_f32_16x16x32_bf16 v[60:63], v[136:139], v[180:183], v[60:63]
    ds_read2_b32 v[94:95], v239 offset0:226 offset1:227
    v_alignbit_b32 v221, v222, v221, 16
    v_mfma_f32_16x16x32_bf16 v[60:63], v[132:135], v[184:187], v[60:63]
    ds_write_b128 v241, v[218:221] offset:5216
    v_mfma_f32_16x16x32_bf16 v[60:63], v[128:131], v[188:191], v[60:63]
    s_waitcnt lgkmcnt(15)
    v_mfma_f32_16x16x32_bf16 v[32:35], v[64:67], v[96:99], v[32:35]
    ds_read_b128 v[160:163], v247 offset:0
    v_mfma_f32_16x16x32_bf16 v[36:39], v[68:71], v[96:99], v[36:39]
    v_alignbit_b32 v224, v225, v224, 16
    v_mfma_f32_16x16x32_bf16 v[36:39], v[64:67], v[100:103], v[36:39]
    ds_read_b128 v[164:167], v247 offset:4096
    v_mfma_f32_16x16x32_bf16 v[40:43], v[64:67], v[104:107], v[40:43]
    ds_read_b128 v[168:171], v247 offset:8192
    v_mfma_f32_16x16x32_bf16 v[40:43], v[68:71], v[100:103], v[40:43]
    ds_read_b128 v[172:175], v247 offset:12288
    v_mfma_f32_16x16x32_bf16 v[40:43], v[72:75], v[96:99], v[40:43]
    v_alignbit_b32 v225, v226, v225, 16
    v_mfma_f32_16x16x32_bf16 v[44:47], v[76:79], v[96:99], v[44:47]
    ds_read_b128 v[176:179], v247 offset:16384
    v_mfma_f32_16x16x32_bf16 v[44:47], v[72:75], v[100:103], v[44:47]
    ds_read_b128 v[180:183], v247 offset:20480
    v_mfma_f32_16x16x32_bf16 v[44:47], v[68:71], v[104:107], v[44:47]
    ds_read_b128 v[184:187], v247 offset:24576
    v_mfma_f32_16x16x32_bf16 v[44:47], v[64:67], v[108:111], v[44:47]
    v_alignbit_b32 v226, v227, v226, 16
    s_waitcnt lgkmcnt(8)
    v_mfma_f32_16x16x32_bf16 v[48:51], v[64:67], v[112:115], v[48:51]
    ds_read_b128 v[188:191], v247 offset:28672
    v_mfma_f32_16x16x32_bf16 v[48:51], v[68:71], v[108:111], v[48:51]
    ds_read2_b32 v[128:129], v236 offset0:112 offset1:113
    v_mfma_f32_16x16x32_bf16 v[48:51], v[72:75], v[104:107], v[48:51]
    v_alignbit_b32 v227, v228, v227, 16
    v_mfma_f32_16x16x32_bf16 v[48:51], v[76:79], v[100:103], v[48:51]
    ds_read2_b32 v[130:131], v236 offset0:114 offset1:115
    v_mfma_f32_16x16x32_bf16 v[48:51], v[80:83], v[96:99], v[48:51]
    ds_read2_b32 v[132:133], v236 offset0:240 offset1:241
    v_mfma_f32_16x16x32_bf16 v[52:55], v[84:87], v[96:99], v[52:55]
    ds_read2_b32 v[134:135], v236 offset0:242 offset1:243
    v_mfma_f32_16x16x32_bf16 v[52:55], v[80:83], v[100:103], v[52:55]
    ds_write_b128 v241, v[224:227] offset:6240
    v_mfma_f32_16x16x32_bf16 v[52:55], v[76:79], v[104:107], v[52:55]
    ds_read2_b32 v[136:137], v237 offset0:112 offset1:113
    ds_read2_b32 v[138:139], v237 offset0:114 offset1:115
    v_mfma_f32_16x16x32_bf16 v[52:55], v[72:75], v[108:111], v[52:55]
    s_add_u32 s6, s12, 4734976
    ds_read2_b32 v[140:141], v237 offset0:240 offset1:241
    v_mfma_f32_16x16x32_bf16 v[52:55], v[68:71], v[112:115], v[52:55]
    ds_read2_b32 v[142:143], v237 offset0:242 offset1:243
    v_alignbit_b32 v230, v231, v230, 16
    v_xor_b32 v244, 64, v244
    v_mfma_f32_16x16x32_bf16 v[52:55], v[64:67], v[116:119], v[52:55]
    ds_read2_b32 v[144:145], v238 offset0:112 offset1:113
    v_mfma_f32_16x16x32_bf16 v[56:59], v[64:67], v[120:123], v[56:59]
    ds_read2_b32 v[146:147], v238 offset0:114 offset1:115
    v_xor_b32 v245, 64, v245
    v_mfma_f32_16x16x32_bf16 v[56:59], v[68:71], v[116:119], v[56:59]
    ds_read2_b32 v[148:149], v238 offset0:240 offset1:241
    v_mfma_f32_16x16x32_bf16 v[56:59], v[72:75], v[112:115], v[56:59]
    v_alignbit_b32 v231, v232, v231, 16
    v_xor_b32 v246, 64, v246
    v_mfma_f32_16x16x32_bf16 v[56:59], v[76:79], v[108:111], v[56:59]
    ds_read2_b32 v[150:151], v238 offset0:242 offset1:243
    v_mfma_f32_16x16x32_bf16 v[56:59], v[80:83], v[104:107], v[56:59]
    ds_read2_b32 v[152:153], v239 offset0:112 offset1:113
    v_xor_b32 v247, 64, v247
    v_mfma_f32_16x16x32_bf16 v[56:59], v[84:87], v[100:103], v[56:59]
    ds_read2_b32 v[154:155], v239 offset0:114 offset1:115
    v_mfma_f32_16x16x32_bf16 v[56:59], v[88:91], v[96:99], v[56:59]
    ds_read2_b32 v[156:157], v239 offset0:240 offset1:241
    v_alignbit_b32 v232, v233, v232, 16
    v_mfma_f32_16x16x32_bf16 v[60:63], v[92:95], v[96:99], v[60:63]
    ds_read2_b32 v[158:159], v239 offset0:242 offset1:243
    v_add_u32 v244, 36864, v244
    v_mfma_f32_16x16x32_bf16 v[60:63], v[88:91], v[100:103], v[60:63]
    v_add_u32 v236, -8320, v236
    v_mfma_f32_16x16x32_bf16 v[60:63], v[84:87], v[104:107], v[60:63]
    v_alignbit_b32 v233, v234, v233, 16
    v_add_u32 v245, 36864, v245
    v_mfma_f32_16x16x32_bf16 v[60:63], v[80:83], v[108:111], v[60:63]
    v_add_u32 v237, -8320, v237
    v_mfma_f32_16x16x32_bf16 v[60:63], v[76:79], v[112:115], v[60:63]
    s_waitcnt vmcnt(1)
    s_barrier
    v_add_u32 v246, 36864, v246
    v_mfma_f32_16x16x32_bf16 v[60:63], v[72:75], v[116:119], v[60:63]
    v_add_u32 v238, -8320, v238
    v_add_u32 v239, -8320, v239
    v_mfma_f32_16x16x32_bf16 v[60:63], v[68:71], v[120:123], v[60:63]
    ds_write_b128 v241, v[230:233] offset:7264
    v_mfma_f32_16x16x32_bf16 v[60:63], v[64:67], v[124:127], v[60:63]
    v_add_u32 v247, 36864, v247
    s_waitcnt lgkmcnt(1)
    v_mfma_f32_16x16x32_bf16 v[60:63], v[128:131], v[188:191], v[60:63]
    ds_read_b128 v[96:99], v244 offset:2048
    v_mfma_f32_16x16x32_bf16 v[60:63], v[132:135], v[184:187], v[60:63]
    ds_read2_b32 v[64:65], v236 offset0:0 offset1:1
    v_mfma_f32_16x16x32_bf16 v[60:63], v[136:139], v[180:183], v[60:63]
    ds_read2_b32 v[66:67], v236 offset0:2 offset1:3
    v_mfma_f32_16x16x32_bf16 v[60:63], v[140:143], v[176:179], v[60:63]
    ds_read_b128 v[100:103], v244 offset:6144
    v_mfma_f32_16x16x32_bf16 v[60:63], v[144:147], v[172:175], v[60:63]
    ds_read2_b32 v[68:69], v236 offset0:128 offset1:129
    v_mfma_f32_16x16x32_bf16 v[60:63], v[148:151], v[168:171], v[60:63]
    ds_read2_b32 v[70:71], v236 offset0:130 offset1:131
    v_mfma_f32_16x16x32_bf16 v[60:63], v[152:155], v[164:167], v[60:63]
    ds_read_b128 v[104:107], v244 offset:10240
    v_mfma_f32_16x16x32_bf16 v[60:63], v[156:159], v[160:163], v[60:63]
    ds_read2_b32 v[72:73], v237 offset0:0 offset1:1
    v_mfma_f32_16x16x32_bf16 v[56:59], v[128:131], v[184:187], v[56:59]
    ds_read2_b32 v[74:75], v237 offset0:2 offset1:3
    v_mfma_f32_16x16x32_bf16 v[56:59], v[132:135], v[180:183], v[56:59]
    ds_read_b128 v[108:111], v244 offset:14336
    v_mfma_f32_16x16x32_bf16 v[56:59], v[136:139], v[176:179], v[56:59]
    ds_read2_b32 v[76:77], v237 offset0:128 offset1:129
    v_mfma_f32_16x16x32_bf16 v[56:59], v[140:143], v[172:175], v[56:59]
    ds_read2_b32 v[78:79], v237 offset0:130 offset1:131
    v_mfma_f32_16x16x32_bf16 v[56:59], v[144:147], v[168:171], v[56:59]
    ds_read_b128 v[112:115], v244 offset:18432
    v_mfma_f32_16x16x32_bf16 v[56:59], v[148:151], v[164:167], v[56:59]
    ds_read2_b32 v[80:81], v238 offset0:0 offset1:1
    v_cvt_pk_bf16_f32 v206, v60, v61
    v_mfma_f32_16x16x32_bf16 v[56:59], v[152:155], v[160:163], v[56:59]
    ds_read2_b32 v[82:83], v238 offset0:2 offset1:3
    v_mfma_f32_16x16x32_bf16 v[52:55], v[128:131], v[180:183], v[52:55]
    ds_read_b128 v[116:119], v244 offset:22528
    v_mfma_f32_16x16x32_bf16 v[52:55], v[132:135], v[176:179], v[52:55]
    ds_read2_b32 v[84:85], v238 offset0:128 offset1:129
    v_cvt_pk_bf16_f32 v207, v62, v63
    v_mfma_f32_16x16x32_bf16 v[52:55], v[136:139], v[172:175], v[52:55]
    ds_read2_b32 v[86:87], v238 offset0:130 offset1:131
    v_mfma_f32_16x16x32_bf16 v[52:55], v[140:143], v[168:171], v[52:55]
    buffer_store_dwordx2 v[206:207], v8, s[44:47], s6 offen offset:3584 sc1
    ds_read_b128 v[120:123], v244 offset:26624
    v_mfma_f32_16x16x32_bf16 v[52:55], v[144:147], v[164:167], v[52:55]
    ds_read2_b32 v[88:89], v239 offset0:0 offset1:1
    v_mfma_f32_16x16x32_bf16 v[52:55], v[148:151], v[160:163], v[52:55]
    ds_read2_b32 v[90:91], v239 offset0:2 offset1:3
    v_mfma_f32_16x16x32_bf16 v[48:51], v[128:131], v[176:179], v[48:51]
    s_waitcnt vmcnt(1)
    s_barrier
    v_cvt_pk_bf16_f32 v204, v56, v57
    v_mfma_f32_16x16x32_bf16 v[48:51], v[132:135], v[172:175], v[48:51]
    ds_read_b128 v[124:127], v244 offset:30720
    v_mfma_f32_16x16x32_bf16 v[48:51], v[136:139], v[168:171], v[48:51]
    ds_read_b64_tr_b16 a[80:81], v10 offset:16384
    v_mfma_f32_16x16x32_bf16 v[48:51], v[140:143], v[164:167], v[48:51]
    ds_read_b64_tr_b16 a[82:83], v10 offset:18432
    v_cvt_pk_bf16_f32 v205, v58, v59
    v_mfma_f32_16x16x32_bf16 v[48:51], v[144:147], v[160:163], v[48:51]
    ds_read_b64_tr_b16 a[88:89], v10 offset:20480
    v_mfma_f32_16x16x32_bf16 v[44:47], v[128:131], v[172:175], v[44:47]
    buffer_store_dwordx2 v[204:205], v8, s[44:47], s6 offen offset:3072 sc1
    ds_read2_b32 v[92:93], v239 offset0:128 offset1:129
    v_mfma_f32_16x16x32_bf16 v[44:47], v[132:135], v[168:171], v[44:47]
    ds_read_b64_tr_b16 a[90:91], v10 offset:22528
    v_mfma_f32_16x16x32_bf16 v[44:47], v[136:139], v[164:167], v[44:47]
    ds_read_b64_tr_b16 a[84:85], v11 offset:16384
    ds_read2_b32 v[94:95], v239 offset0:130 offset1:131
    v_mfma_f32_16x16x32_bf16 v[44:47], v[140:143], v[160:163], v[44:47]
    v_cvt_pk_bf16_f32 v202, v52, v53
    v_mfma_f32_16x16x32_bf16 v[40:43], v[128:131], v[168:171], v[40:43]
    ds_read_b64_tr_b16 a[86:87], v11 offset:18432
    v_mfma_f32_16x16x32_bf16 v[40:43], v[132:135], v[164:167], v[40:43]
    ds_read_b64_tr_b16 a[92:93], v11 offset:20480
    v_mfma_f32_16x16x32_bf16 v[40:43], v[136:139], v[160:163], v[40:43]
    v_cvt_pk_bf16_f32 v203, v54, v55
    v_mfma_f32_16x16x32_bf16 v[36:39], v[128:131], v[164:167], v[36:39]
    ds_read_b64_tr_b16 a[94:95], v11 offset:22528
    v_mfma_f32_16x16x32_bf16 v[36:39], v[132:135], v[160:163], v[36:39]
    buffer_store_dwordx2 v[202:203], v8, s[44:47], s6 offen offset:2560 sc1
    v_mfma_f32_16x16x32_bf16 v[32:35], v[128:131], v[160:163], v[32:35]
    s_waitcnt lgkmcnt(3)
    v_mfma_f32_16x16x32_bf16 v[60:63], v[64:67], v[124:127], 0
    ds_read_b128 v[160:163], v245 offset:2048
    s_waitcnt lgkmcnt(1)
    s_barrier
    v_mfma_f32_16x16x32_bf16 v[60:63], v[68:71], v[120:123], v[60:63]
    v_cvt_pk_bf16_f32 v200, v48, v49
    v_mfma_f32_16x16x32_bf16 v[60:63], v[72:75], v[116:119], v[60:63]
    ds_read2_b32 v[128:129], v236 offset0:16 offset1:17
    v_mfma_f32_16x16x32_bf16 v[60:63], v[76:79], v[112:115], v[60:63]
    ds_read2_b32 v[130:131], v236 offset0:18 offset1:19
    s_lshl_b32 s14, s90, 18
    v_cvt_pk_bf16_f32 v201, v50, v51
    v_mfma_f32_16x16x32_bf16 v[60:63], v[80:83], v[108:111], v[60:63]
    s_add_u32 m0, s73, 147456
    v_mfma_f32_16x16x32_bf16 v[60:63], v[84:87], v[104:107], v[60:63]
    buffer_load_dwordx4 v4, s[52:55], s14 offen offset:0 lds
    ds_read_b128 v[164:167], v245 offset:6144
    v_mfma_f32_16x16x32_bf16 v[60:63], v[88:91], v[100:103], v[60:63]
    buffer_store_dwordx2 v[200:201], v8, s[44:47], s6 offen offset:2048 sc1
    ds_read2_b32 v[132:133], v236 offset0:144 offset1:145
    v_mfma_f32_16x16x32_bf16 v[60:63], v[92:95], v[96:99], v[60:63]
    s_add_u32 s13, s12, 49152
    v_cvt_pk_bf16_f32 v198, v44, v45
    v_mfma_f32_16x16x32_bf16 v[56:59], v[64:67], v[120:123], 0
    ds_read2_b32 v[134:135], v236 offset0:146 offset1:147
    v_mfma_f32_16x16x32_bf16 v[56:59], v[68:71], v[116:119], v[56:59]
    s_add_u32 m0, s74, 8352
    ds_read_b128 v[168:171], v245 offset:10240
    v_mfma_f32_16x16x32_bf16 v[56:59], v[72:75], v[112:115], v[56:59]
    buffer_load_dwordx4 v240, s[48:51], s13 offen offset:0 lds
    v_cvt_pk_bf16_f32 v199, v46, v47
    v_mfma_f32_16x16x32_bf16 v[56:59], v[76:79], v[108:111], v[56:59]
    ds_read2_b32 v[136:137], v237 offset0:16 offset1:17
    v_mfma_f32_16x16x32_bf16 v[56:59], v[80:83], v[104:107], v[56:59]
    buffer_store_dwordx2 v[198:199], v8, s[44:47], s6 offen offset:1536 sc1
    ds_read2_b32 v[138:139], v237 offset0:18 offset1:19
    v_mfma_f32_16x16x32_bf16 v[56:59], v[84:87], v[100:103], v[56:59]
    ds_read_b128 v[172:175], v245 offset:14336
    v_mfma_f32_16x16x32_bf16 v[56:59], v[88:91], v[96:99], v[56:59]
    v_cvt_pk_bf16_f32 v196, v40, v41
    v_mfma_f32_16x16x32_bf16 v[52:55], v[64:67], v[116:119], 0
    ds_read2_b32 v[140:141], v237 offset0:144 offset1:145
    v_mfma_f32_16x16x32_bf16 v[52:55], v[68:71], v[112:115], v[52:55]
    ds_read2_b32 v[142:143], v237 offset0:146 offset1:147
    s_add_u32 m0, s73, 147456
    v_cvt_pk_bf16_f32 v197, v42, v43
    v_mfma_f32_16x16x32_bf16 v[52:55], v[72:75], v[108:111], v[52:55]
    buffer_load_dwordx4 v5, s[52:55], s14 offen offset:1024 lds
    v_mfma_f32_16x16x32_bf16 v[52:55], v[76:79], v[104:107], v[52:55]
    buffer_store_dwordx2 v[196:197], v8, s[44:47], s6 offen offset:1024 sc1
    ds_read_b128 v[176:179], v245 offset:18432
    s_add_u32 m0, s74, 8352
    v_mfma_f32_16x16x32_bf16 v[52:55], v[80:83], v[100:103], v[52:55]
    buffer_load_dwordx4 v240, s[48:51], s13 offen offset:1024 lds
    ds_read2_b32 v[144:145], v238 offset0:16 offset1:17
    v_mfma_f32_16x16x32_bf16 v[52:55], v[84:87], v[96:99], v[52:55]
    v_mfma_f32_16x16x32_bf16 v[48:51], v[64:67], v[112:115], 0
    ds_read2_b32 v[146:147], v238 offset0:18 offset1:19
    v_cvt_pk_bf16_f32 v194, v36, v37
    v_mfma_f32_16x16x32_bf16 v[48:51], v[68:71], v[108:111], v[48:51]
    ds_read_b128 v[180:183], v245 offset:22528
    v_mfma_f32_16x16x32_bf16 v[48:51], v[72:75], v[104:107], v[48:51]
    v_cvt_pk_bf16_f32 v195, v38, v39
    v_mfma_f32_16x16x32_bf16 v[48:51], v[76:79], v[100:103], v[48:51]
    buffer_store_dwordx2 v[194:195], v8, s[44:47], s6 offen offset:512 sc1
    ds_read2_b32 v[148:149], v238 offset0:144 offset1:145
    s_add_u32 m0, s74, 8352
    v_mfma_f32_16x16x32_bf16 v[48:51], v[80:83], v[96:99], v[48:51]
    buffer_load_dwordx4 v240, s[48:51], s13 offen offset:2048 lds
    ds_read2_b32 v[150:151], v238 offset0:146 offset1:147
    v_mfma_f32_16x16x32_bf16 v[44:47], v[64:67], v[108:111], 0
    ds_read_b128 v[184:187], v245 offset:26624
    v_mfma_f32_16x16x32_bf16 v[44:47], v[68:71], v[104:107], v[44:47]
    v_cvt_pk_bf16_f32 v192, v32, v33
    v_mfma_f32_16x16x32_bf16 v[44:47], v[72:75], v[100:103], v[44:47]
    s_add_u32 m0, s73, 147456
    ds_read2_b32 v[152:153], v239 offset0:16 offset1:17
    v_mfma_f32_16x16x32_bf16 v[44:47], v[76:79], v[96:99], v[44:47]
    buffer_load_dwordx4 v6, s[52:55], s14 offen offset:2048 lds
    v_cvt_pk_bf16_f32 v193, v34, v35
    v_mfma_f32_16x16x32_bf16 v[40:43], v[64:67], v[104:107], 0
    ds_read2_b32 v[154:155], v239 offset0:18 offset1:19
    v_mfma_f32_16x16x32_bf16 v[40:43], v[68:71], v[100:103], v[40:43]
    buffer_store_dwordx2 v[192:193], v8, s[44:47], s6 offen offset:0 sc1
    ds_read_b128 v[188:191], v245 offset:30720
    v_mfma_f32_16x16x32_bf16 v[40:43], v[72:75], v[96:99], v[40:43]
    s_add_u32 m0, s74, 8352
    ds_read2_b32 v[156:157], v239 offset0:144 offset1:145
    v_mfma_f32_16x16x32_bf16 v[36:39], v[64:67], v[100:103], 0
    buffer_load_dwordx4 v240, s[48:51], s13 offen offset:3072 lds
    v_mfma_f32_16x16x32_bf16 v[36:39], v[68:71], v[96:99], v[36:39]
    ds_read2_b32 v[158:159], v239 offset0:146 offset1:147
    v_mfma_f32_16x16x32_bf16 v[32:35], v[64:67], v[96:99], 0
    s_waitcnt lgkmcnt(12)
    v_mfma_f32_16x16x32_bf16 v[32:35], v[128:131], v[160:163], v[32:35]
    ds_read_b128 v[96:99], v246 offset:2048
    v_mfma_f32_16x16x32_bf16 v[36:39], v[132:135], v[160:163], v[36:39]
    v_mfma_f32_16x16x32_bf16 v[36:39], v[128:131], v[164:167], v[36:39]
    ds_read2_b32 v[64:65], v236 offset0:32 offset1:33
    v_mfma_f32_16x16x32_bf16 v[40:43], v[128:131], v[168:171], v[40:43]
    s_barrier
    ds_read2_b32 v[66:67], v236 offset0:34 offset1:35
    s_add_u32 m0, s73, 147456
    v_mfma_f32_16x16x32_bf16 v[40:43], v[132:135], v[164:167], v[40:43]
    buffer_load_dwordx4 v7, s[52:55], s14 offen offset:3072 lds
    v_mfma_f32_16x16x32_bf16 v[40:43], v[136:139], v[160:163], v[40:43]
    ds_read_b128 v[100:103], v246 offset:6144
    v_mfma_f32_16x16x32_bf16 v[44:47], v[140:143], v[160:163], v[44:47]
    ds_read2_b32 v[68:69], v236 offset0:160 offset1:161
    v_mfma_f32_16x16x32_bf16 v[44:47], v[136:139], v[164:167], v[44:47]
    v_mfma_f32_16x16x32_bf16 v[44:47], v[132:135], v[168:171], v[44:47]
    ds_read2_b32 v[70:71], v236 offset0:162 offset1:163
    v_mfma_f32_16x16x32_bf16 v[44:47], v[128:131], v[172:175], v[44:47]
    ds_read_b128 v[104:107], v246 offset:10240
    s_waitcnt lgkmcnt(7)
    v_mfma_f32_16x16x32_bf16 v[48:51], v[128:131], v[176:179], v[48:51]
    ds_read2_b32 v[72:73], v237 offset0:32 offset1:33
    v_mfma_f32_16x16x32_bf16 v[48:51], v[132:135], v[172:175], v[48:51]
    ds_read2_b32 v[74:75], v237 offset0:34 offset1:35
    v_mfma_f32_16x16x32_bf16 v[48:51], v[136:139], v[168:171], v[48:51]
    v_mov_b32 v9, 24
    buffer_load_ushort v9, v9, s[56:59], s70 offen
    v_mfma_f32_16x16x32_bf16 v[48:51], v[140:143], v[164:167], v[48:51]
    ds_read_b128 v[108:111], v246 offset:14336
    v_mfma_f32_16x16x32_bf16 v[48:51], v[144:147], v[160:163], v[48:51]
    v_mfma_f32_16x16x32_bf16 v[52:55], v[148:151], v[160:163], v[52:55]
    ds_read2_b32 v[76:77], v237 offset0:160 offset1:161
    v_mfma_f32_16x16x32_bf16 v[52:55], v[144:147], v[164:167], v[52:55]
    ds_read2_b32 v[78:79], v237 offset0:162 offset1:163
    v_mfma_f32_16x16x32_bf16 v[52:55], v[140:143], v[168:171], v[52:55]
    v_mfma_f32_16x16x32_bf16 v[52:55], v[136:139], v[172:175], v[52:55]
    s_lshl_b32 s14, s91, 18
    ds_read_b128 v[112:115], v246 offset:18432
    v_mfma_f32_16x16x32_bf16 v[52:55], v[132:135], v[176:179], v[52:55]
    s_add_u32 m0, s73, 0
    ds_read2_b32 v[80:81], v238 offset0:32 offset1:33
    v_mfma_f32_16x16x32_bf16 v[52:55], v[128:131], v[180:183], v[52:55]
    buffer_load_dwordx4 v4, s[52:55], s14 offen offset:0 lds
    v_mfma_f32_16x16x32_bf16 v[56:59], v[128:131], v[184:187], v[56:59]
    ds_read2_b32 v[82:83], v238 offset0:34 offset1:35
    v_mfma_f32_16x16x32_bf16 v[56:59], v[132:135], v[180:183], v[56:59]
    ds_read_b128 v[116:119], v246 offset:22528
    v_mfma_f32_16x16x32_bf16 v[56:59], v[136:139], v[176:179], v[56:59]
    v_mfma_f32_16x16x32_bf16 v[56:59], v[140:143], v[172:175], v[56:59]
    ds_read2_b32 v[84:85], v238 offset0:160 offset1:161
    v_mfma_f32_16x16x32_bf16 v[56:59], v[144:147], v[168:171], v[56:59]
    ds_read2_b32 v[86:87], v238 offset0:162 offset1:163
    v_mfma_f32_16x16x32_bf16 v[56:59], v[148:151], v[164:167], v[56:59]
    ds_read_b128 v[120:123], v246 offset:26624
    v_mfma_f32_16x16x32_bf16 v[56:59], v[152:155], v[160:163], v[56:59]
    v_mfma_f32_16x16x32_bf16 v[60:63], v[156:159], v[160:163], v[60:63]
    ds_read2_b32 v[88:89], v239 offset0:32 offset1:33
    v_mfma_f32_16x16x32_bf16 v[60:63], v[152:155], v[164:167], v[60:63]
    ds_read2_b32 v[90:91], v239 offset0:34 offset1:35
    v_mfma_f32_16x16x32_bf16 v[60:63], v[148:151], v[168:171], v[60:63]
    s_add_u32 m0, s73, 0
    v_mfma_f32_16x16x32_bf16 v[60:63], v[144:147], v[172:175], v[60:63]
    buffer_load_dwordx4 v5, s[52:55], s14 offen offset:1024 lds
    ds_read_b128 v[124:127], v246 offset:30720
    v_mfma_f32_16x16x32_bf16 v[60:63], v[140:143], v[176:179], v[60:63]
    ds_read2_b32 v[92:93], v239 offset0:160 offset1:161
    v_mfma_f32_16x16x32_bf16 v[60:63], v[136:139], v[180:183], v[60:63]
    v_mfma_f32_16x16x32_bf16 v[60:63], v[132:135], v[184:187], v[60:63]
    ds_read2_b32 v[94:95], v239 offset0:162 offset1:163
    v_mfma_f32_16x16x32_bf16 v[60:63], v[128:131], v[188:191], v[60:63]
    s_waitcnt lgkmcnt(12)
    v_mfma_f32_16x16x32_bf16 v[32:35], v[64:67], v[96:99], v[32:35]
    ds_read_b128 v[160:163], v247 offset:2048
    v_mfma_f32_16x16x32_bf16 v[36:39], v[68:71], v[96:99], v[36:39]
    v_mfma_f32_16x16x32_bf16 v[36:39], v[64:67], v[100:103], v[36:39]
    ds_read2_b32 v[128:129], v236 offset0:48 offset1:49
    v_mfma_f32_16x16x32_bf16 v[40:43], v[64:67], v[104:107], v[40:43]
    ds_read2_b32 v[130:131], v236 offset0:50 offset1:51
    v_mfma_f32_16x16x32_bf16 v[40:43], v[68:71], v[100:103], v[40:43]
    v_mfma_f32_16x16x32_bf16 v[40:43], v[72:75], v[96:99], v[40:43]
    ds_read_b128 v[164:167], v247 offset:6144
    v_mfma_f32_16x16x32_bf16 v[44:47], v[76:79], v[96:99], v[44:47]
    s_add_u32 m0, s73, 0
    ds_read2_b32 v[132:133], v236 offset0:176 offset1:177
    v_mfma_f32_16x16x32_bf16 v[44:47], v[72:75], v[100:103], v[44:47]
    buffer_load_dwordx4 v6, s[52:55], s14 offen offset:2048 lds
    v_mfma_f32_16x16x32_bf16 v[44:47], v[68:71], v[104:107], v[44:47]
    ds_read2_b32 v[134:135], v236 offset0:178 offset1:179
    v_mfma_f32_16x16x32_bf16 v[44:47], v[64:67], v[108:111], v[44:47]
    ds_read_b128 v[168:171], v247 offset:10240
    s_waitcnt lgkmcnt(7)
    v_mfma_f32_16x16x32_bf16 v[48:51], v[64:67], v[112:115], v[48:51]
    ds_read2_b32 v[136:137], v237 offset0:48 offset1:49
    v_mfma_f32_16x16x32_bf16 v[48:51], v[68:71], v[108:111], v[48:51]
    v_mfma_f32_16x16x32_bf16 v[48:51], v[72:75], v[104:107], v[48:51]
    ds_read2_b32 v[138:139], v237 offset0:50 offset1:51
    v_mfma_f32_16x16x32_bf16 v[48:51], v[76:79], v[100:103], v[48:51]
    ds_read_b128 v[172:175], v247 offset:14336
    v_mfma_f32_16x16x32_bf16 v[48:51], v[80:83], v[96:99], v[48:51]
    v_mfma_f32_16x16x32_bf16 v[52:55], v[84:87], v[96:99], v[52:55]
    ds_read2_b32 v[140:141], v237 offset0:176 offset1:177
    v_mfma_f32_16x16x32_bf16 v[52:55], v[80:83], v[100:103], v[52:55]
    ds_read2_b32 v[142:143], v237 offset0:178 offset1:179
    v_mfma_f32_16x16x32_bf16 v[52:55], v[76:79], v[104:107], v[52:55]
    v_mfma_f32_16x16x32_bf16 v[52:55], v[72:75], v[108:111], v[52:55]
    s_add_u32 m0, s73, 0
    ds_read_b128 v[176:179], v247 offset:18432
    v_mfma_f32_16x16x32_bf16 v[52:55], v[68:71], v[112:115], v[52:55]
    buffer_load_dwordx4 v7, s[52:55], s14 offen offset:3072 lds
    ds_read2_b32 v[144:145], v238 offset0:48 offset1:49
    v_mfma_f32_16x16x32_bf16 v[52:55], v[64:67], v[116:119], v[52:55]
    v_mfma_f32_16x16x32_bf16 v[56:59], v[64:67], v[120:123], v[56:59]
    ds_read2_b32 v[146:147], v238 offset0:50 offset1:51
    v_mfma_f32_16x16x32_bf16 v[56:59], v[68:71], v[116:119], v[56:59]
    ds_read_b128 v[180:183], v247 offset:22528
    v_mfma_f32_16x16x32_bf16 v[56:59], v[72:75], v[112:115], v[56:59]
    v_mfma_f32_16x16x32_bf16 v[56:59], v[76:79], v[108:111], v[56:59]
    ds_read2_b32 v[148:149], v238 offset0:176 offset1:177
    v_mfma_f32_16x16x32_bf16 v[56:59], v[80:83], v[104:107], v[56:59]
    ds_read2_b32 v[150:151], v238 offset0:178 offset1:179
    v_mfma_f32_16x16x32_bf16 v[56:59], v[84:87], v[100:103], v[56:59]
    ds_read_b128 v[184:187], v247 offset:26624
    v_mfma_f32_16x16x32_bf16 v[56:59], v[88:91], v[96:99], v[56:59]
    v_mfma_f32_16x16x32_bf16 v[60:63], v[92:95], v[96:99], v[60:63]
    s_lshl_b32 s14, s92, 18
    ds_read2_b32 v[152:153], v239 offset0:48 offset1:49
    v_mfma_f32_16x16x32_bf16 v[60:63], v[88:91], v[100:103], v[60:63]
    s_add_u32 m0, s73, 16384
    ds_read2_b32 v[154:155], v239 offset0:50 offset1:51
    v_mfma_f32_16x16x32_bf16 v[60:63], v[84:87], v[104:107], v[60:63]
    buffer_load_dwordx4 v4, s[52:55], s14 offen offset:0 lds
    v_mfma_f32_16x16x32_bf16 v[60:63], v[80:83], v[108:111], v[60:63]
    ds_read_b128 v[188:191], v247 offset:30720
    v_mfma_f32_16x16x32_bf16 v[60:63], v[76:79], v[112:115], v[60:63]
    ds_read2_b32 v[156:157], v239 offset0:176 offset1:177
    v_mfma_f32_16x16x32_bf16 v[60:63], v[72:75], v[116:119], v[60:63]
    v_mfma_f32_16x16x32_bf16 v[60:63], v[68:71], v[120:123], v[60:63]
L_pl_X_4:
    s_cbranch_execz L_wret
    ds_read2_b32 v[158:159], v239 offset0:178 offset1:179
    v_mfma_f32_16x16x32_bf16 v[60:63], v[64:67], v[124:127], v[60:63]
    s_waitcnt lgkmcnt(12)
    v_mfma_f32_16x16x32_bf16 v[32:35], v[128:131], v[160:163], v[32:35]
    ds_read_b128 v[96:99], v244 offset:0
    v_mfma_f32_16x16x32_bf16 v[36:39], v[132:135], v[160:163], v[36:39]
    ds_read2_b32 v[64:65], v236 offset0:64 offset1:65
    v_mfma_f32_16x16x32_bf16 v[36:39], v[128:131], v[164:167], v[36:39]
    ds_read2_b32 v[66:67], v236 offset0:66 offset1:67
    v_mfma_f32_16x16x32_bf16 v[40:43], v[128:131], v[168:171], v[40:43]
    ds_read_b128 v[100:103], v244 offset:4096
    v_mfma_f32_16x16x32_bf16 v[40:43], v[132:135], v[164:167], v[40:43]
    ds_read2_b32 v[68:69], v236 offset0:192 offset1:193
    v_mfma_f32_16x16x32_bf16 v[40:43], v[136:139], v[160:163], v[40:43]
    s_add_u32 m0, s73, 16384
    ds_read2_b32 v[70:71], v236 offset0:194 offset1:195
    v_mfma_f32_16x16x32_bf16 v[44:47], v[140:143], v[160:163], v[44:47]
    buffer_load_dwordx4 v5, s[52:55], s14 offen offset:1024 lds
    ds_read_b128 v[104:107], v244 offset:8192
    v_mfma_f32_16x16x32_bf16 v[44:47], v[136:139], v[164:167], v[44:47]
    ds_read2_b32 v[72:73], v237 offset0:64 offset1:65
    s_waitcnt vmcnt(7)
    s_barrier
    v_mfma_f32_16x16x32_bf16 v[44:47], v[132:135], v[168:171], v[44:47]
    ds_read_b64_tr_b16 a[96:97], v10 offset:16384
    v_mfma_f32_16x16x32_bf16 v[44:47], v[128:131], v[172:175], v[44:47]
    ds_read2_b32 v[74:75], v237 offset0:66 offset1:67
    s_waitcnt lgkmcnt(10)
    v_mfma_f32_16x16x32_bf16 v[48:51], v[128:131], v[176:179], v[48:51]
    ds_read_b64_tr_b16 a[98:99], v10 offset:18432
    v_mfma_f32_16x16x32_bf16 v[48:51], v[132:135], v[172:175], v[48:51]
    ds_read_b64_tr_b16 a[104:105], v10 offset:20480
    v_mfma_f32_16x16x32_bf16 v[48:51], v[136:139], v[168:171], v[48:51]
    ds_read_b64_tr_b16 a[106:107], v10 offset:22528
    v_mfma_f32_16x16x32_bf16 v[48:51], v[140:143], v[164:167], v[48:51]
    ds_read_b128 v[108:111], v244 offset:12288
    v_mfma_f32_16x16x32_bf16 v[48:51], v[144:147], v[160:163], v[48:51]
    ds_read_b64_tr_b16 a[100:101], v11 offset:16384
    v_mfma_f32_16x16x32_bf16 v[52:55], v[148:151], v[160:163], v[52:55]
    ds_read_b64_tr_b16 a[102:103], v11 offset:18432
    v_mfma_f32_16x16x32_bf16 v[52:55], v[144:147], v[164:167], v[52:55]
    ds_read2_b32 v[76:77], v237 offset0:192 offset1:193
    v_mfma_f32_16x16x32_bf16 v[52:55], v[140:143], v[168:171], v[52:55]
    ds_read_b64_tr_b16 a[108:109], v11 offset:20480
    s_add_u32 m0, s73, 16384
    v_mfma_f32_16x16x32_bf16 v[52:55], v[136:139], v[172:175], v[52:55]
    ds_read_b64_tr_b16 a[110:111], v11 offset:22528
    buffer_load_dwordx4 v6, s[52:55], s14 offen offset:2048 lds
    v_mfma_f32_16x16x32_bf16 v[52:55], v[132:135], v[176:179], v[52:55]
    ds_read2_b32 v[78:79], v237 offset0:194 offset1:195
    v_mfma_f32_16x16x32_bf16 v[52:55], v[128:131], v[180:183], v[52:55]
    ds_read_b128 v[112:115], v244 offset:16384
    v_mfma_f32_16x16x32_bf16 v[56:59], v[128:131], v[184:187], v[56:59]
    ds_read2_b32 v[80:81], v238 offset0:64 offset1:65
    v_mfma_f32_16x16x32_bf16 v[56:59], v[132:135], v[180:183], v[56:59]
    ds_read2_b32 v[82:83], v238 offset0:66 offset1:67
    v_mfma_f32_16x16x32_bf16 v[56:59], v[136:139], v[176:179], v[56:59]
    ds_read_b128 v[116:119], v244 offset:20480
    v_mfma_f32_16x16x32_bf16 v[56:59], v[140:143], v[172:175], v[56:59]
    ds_read2_b32 v[84:85], v238 offset0:192 offset1:193
    v_mfma_f32_16x16x32_bf16 v[56:59], v[144:147], v[168:171], v[56:59]
    ds_read2_b32 v[86:87], v238 offset0:194 offset1:195
    v_mfma_f32_16x16x32_bf16 v[56:59], v[148:151], v[164:167], v[56:59]
    ds_read_b128 v[120:123], v244 offset:24576
    v_mfma_f32_16x16x32_bf16 v[56:59], v[152:155], v[160:163], v[56:59]
    v_mfma_f32_16x16x32_bf16 v[60:63], v[156:159], v[160:163], v[60:63]
    s_add_u32 m0, s73, 16384
    ds_read2_b32 v[88:89], v239 offset0:64 offset1:65
    v_mfma_f32_16x16x32_bf16 v[60:63], v[152:155], v[164:167], v[60:63]
    buffer_load_dwordx4 v7, s[52:55], s14 offen offset:3072 lds
    ds_read2_b32 v[90:91], v239 offset0:66 offset1:67
    v_mfma_f32_16x16x32_bf16 v[60:63], v[148:151], v[168:171], v[60:63]
    v_mfma_f32_16x16x32_bf16 v[60:63], v[144:147], v[172:175], v[60:63]
    ds_read_b128 v[124:127], v244 offset:28672
    v_mfma_f32_16x16x32_bf16 v[60:63], v[140:143], v[176:179], v[60:63]
    ds_read2_b32 v[92:93], v239 offset0:192 offset1:193
    v_mfma_f32_16x16x32_bf16 v[60:63], v[136:139], v[180:183], v[60:63]
    v_mfma_f32_16x16x32_bf16 v[60:63], v[132:135], v[184:187], v[60:63]
    ds_read2_b32 v[94:95], v239 offset0:194 offset1:195
    v_mfma_f32_16x16x32_bf16 v[60:63], v[128:131], v[188:191], v[60:63]
    s_waitcnt lgkmcnt(12)
    v_mfma_f32_16x16x32_bf16 v[32:35], v[64:67], v[96:99], v[32:35]
    ds_read_b128 v[160:163], v245 offset:0
    v_mfma_f32_16x16x32_bf16 v[36:39], v[68:71], v[96:99], v[36:39]
    ds_read2_b32 v[128:129], v236 offset0:80 offset1:81
    v_mfma_f32_16x16x32_bf16 v[36:39], v[64:67], v[100:103], v[36:39]
    ds_read2_b32 v[130:131], v236 offset0:82 offset1:83
    v_mfma_f32_16x16x32_bf16 v[40:43], v[64:67], v[104:107], v[40:43]
    ds_read_b128 v[164:167], v245 offset:4096
    s_barrier
    v_mfma_f32_16x16x32_bf16 v[40:43], v[68:71], v[100:103], v[40:43]
    ds_read2_b32 v[132:133], v236 offset0:208 offset1:209
    v_mfma_f32_16x16x32_bf16 v[40:43], v[72:75], v[96:99], v[40:43]
    ds_read2_b32 v[134:135], v236 offset0:210 offset1:211
    v_mfma_f32_16x16x32_bf16 v[44:47], v[76:79], v[96:99], v[44:47]
    ds_read_b128 v[168:171], v245 offset:8192
    v_mfma_f32_16x16x32_bf16 v[44:47], v[72:75], v[100:103], v[44:47]
    s_lshl_b32 s14, s93, 18
    ds_read2_b32 v[136:137], v237 offset0:80 offset1:81
    v_mfma_f32_16x16x32_bf16 v[44:47], v[68:71], v[104:107], v[44:47]
    s_add_u32 m0, s73, 147456
    ds_read2_b32 v[138:139], v237 offset0:82 offset1:83
    v_mfma_f32_16x16x32_bf16 v[44:47], v[64:67], v[108:111], v[44:47]
    buffer_load_dwordx4 v4, s[52:55], s14 offen offset:0 lds
    ds_read_b128 v[172:175], v245 offset:12288
    s_waitcnt lgkmcnt(10)
    v_mfma_f32_16x16x32_bf16 v[48:51], v[64:67], v[112:115], v[48:51]
    ds_read2_b32 v[140:141], v237 offset0:208 offset1:209
    v_mfma_f32_16x16x32_bf16 v[48:51], v[68:71], v[108:111], v[48:51]
    ds_read2_b32 v[142:143], v237 offset0:210 offset1:211
    v_mfma_f32_16x16x32_bf16 v[48:51], v[72:75], v[104:107], v[48:51]
    ds_read_b128 v[176:179], v245 offset:16384
    v_mfma_f32_16x16x32_bf16 v[48:51], v[76:79], v[100:103], v[48:51]
    ds_read2_b32 v[144:145], v238 offset0:80 offset1:81
    v_mfma_f32_16x16x32_bf16 v[48:51], v[80:83], v[96:99], v[48:51]
    ds_read2_b32 v[146:147], v238 offset0:82 offset1:83
    v_mfma_f32_16x16x32_bf16 v[52:55], v[84:87], v[96:99], v[52:55]
    ds_read_b128 v[180:183], v245 offset:20480
    v_mfma_f32_16x16x32_bf16 v[52:55], v[80:83], v[100:103], v[52:55]
    ds_read2_b32 v[148:149], v238 offset0:208 offset1:209
    v_mfma_f32_16x16x32_bf16 v[52:55], v[76:79], v[104:107], v[52:55]
    ds_read2_b32 v[150:151], v238 offset0:210 offset1:211
    v_mfma_f32_16x16x32_bf16 v[52:55], v[72:75], v[108:111], v[52:55]
    ds_read_b128 v[184:187], v245 offset:24576
    v_mfma_f32_16x16x32_bf16 v[52:55], v[68:71], v[112:115], v[52:55]
    s_add_u32 m0, s73, 147456
    ds_read_b128 v[212:215], v241 offset:8352
    v_mfma_f32_16x16x32_bf16 v[52:55], v[64:67], v[116:119], v[52:55]
    buffer_load_dwordx4 v5, s[52:55], s14 offen offset:1024 lds
    ds_read2_b32 v[152:153], v239 offset0:80 offset1:81
    v_mfma_f32_16x16x32_bf16 v[56:59], v[64:67], v[120:123], v[56:59]
    ds_read_b32 v216, v241 offset:8368
    v_mfma_f32_16x16x32_bf16 v[56:59], v[68:71], v[116:119], v[56:59]
    ds_read_b128 v[218:221], v241 offset:9376
    v_mfma_f32_16x16x32_bf16 v[56:59], v[72:75], v[112:115], v[56:59]
    ds_read_b32 v222, v241 offset:9392
    v_mfma_f32_16x16x32_bf16 v[56:59], v[76:79], v[108:111], v[56:59]
    ds_read_b128 v[224:227], v241 offset:10400
    v_mfma_f32_16x16x32_bf16 v[56:59], v[80:83], v[104:107], v[56:59]
    ds_read_b32 v228, v241 offset:10416
    s_waitcnt vmcnt(6)
    s_barrier
    v_mfma_f32_16x16x32_bf16 v[56:59], v[84:87], v[100:103], v[56:59]
    ds_read_b128 v[230:233], v241 offset:11424
    v_add_u32 v10, -131072, v10
    v_mfma_f32_16x16x32_bf16 v[56:59], v[88:91], v[96:99], v[56:59]
    ds_read_b64_tr_b16 a[112:113], v10 offset:0
    v_mfma_f32_16x16x32_bf16 v[60:63], v[92:95], v[96:99], v[60:63]
    ds_read_b64_tr_b16 a[114:115], v10 offset:2048
    v_mfma_f32_16x16x32_bf16 v[60:63], v[88:91], v[100:103], v[60:63]
    ds_read_b64_tr_b16 a[120:121], v10 offset:4096
    ds_read2_b32 v[154:155], v239 offset0:82 offset1:83
    v_mfma_f32_16x16x32_bf16 v[60:63], v[84:87], v[104:107], v[60:63]
    ds_read_b32 v234, v241 offset:11440
    v_mfma_f32_16x16x32_bf16 v[60:63], v[80:83], v[108:111], v[60:63]
    ds_read_b64_tr_b16 a[122:123], v10 offset:6144
    s_add_u32 m0, s73, 147456
    ds_read_b128 v[188:191], v245 offset:28672
    v_mfma_f32_16x16x32_bf16 v[60:63], v[76:79], v[112:115], v[60:63]
    v_add_u32 v11, -131072, v11
    buffer_load_dwordx4 v6, s[52:55], s14 offen offset:2048 lds
    ds_read2_b32 v[156:157], v239 offset0:208 offset1:209
    v_mfma_f32_16x16x32_bf16 v[60:63], v[72:75], v[116:119], v[60:63]
    ds_read_b64_tr_b16 a[116:117], v11 offset:0
    v_mfma_f32_16x16x32_bf16 v[60:63], v[68:71], v[120:123], v[60:63]
    ds_read_b64_tr_b16 a[118:119], v11 offset:2048
    ds_read2_b32 v[158:159], v239 offset0:210 offset1:211
    v_mfma_f32_16x16x32_bf16 v[60:63], v[64:67], v[124:127], v[60:63]
    ds_read_b64_tr_b16 a[124:125], v11 offset:4096
    s_waitcnt lgkmcnt(15)
    v_mfma_f32_16x16x32_bf16 v[32:35], v[128:131], v[160:163], v[32:35]
    ds_read_b64_tr_b16 a[126:127], v11 offset:6144
    v_mfma_f32_16x16x32_bf16 v[36:39], v[132:135], v[160:163], v[36:39]
    ds_read_b128 v[96:99], v246 offset:0
    v_mfma_f32_16x16x32_bf16 v[36:39], v[128:131], v[164:167], v[36:39]
    ds_read2_b32 v[64:65], v236 offset0:96 offset1:97
    v_mfma_f32_16x16x32_bf16 v[40:43], v[128:131], v[168:171], v[40:43]
    ds_read2_b32 v[66:67], v236 offset0:98 offset1:99
    v_mfma_f32_16x16x32_bf16 v[40:43], v[132:135], v[164:167], v[40:43]
    s_waitcnt lgkmcnt(11)
    v_mfma_f32_16x16x32_bf16 v[40:43], v[136:139], v[160:163], v[40:43]
    ds_read_b128 v[100:103], v246 offset:4096
    v_mfma_f32_16x16x32_bf16 v[44:47], v[140:143], v[160:163], v[44:47]
    ds_read2_b32 v[68:69], v236 offset0:224 offset1:225
    v_mfma_f32_16x16x32_bf16 v[44:47], v[136:139], v[164:167], v[44:47]
    s_add_u32 m0, s73, 147456
    ds_read2_b32 v[70:71], v236 offset0:226 offset1:227
    v_mfma_f32_16x16x32_bf16 v[44:47], v[132:135], v[168:171], v[44:47]
    buffer_load_dwordx4 v7, s[52:55], s14 offen offset:3072 lds
    v_lshlrev_b32 v9, 16, v9
    v_mfma_f32_16x16x32_bf16 v[44:47], v[128:131], v[172:175], v[44:47]
    ds_read_b128 v[104:107], v246 offset:8192
    s_waitcnt lgkmcnt(9)
    v_mfma_f32_16x16x32_bf16 v[48:51], v[128:131], v[176:179], v[48:51]
    ds_read2_b32 v[72:73], v237 offset0:96 offset1:97
    v_lshlrev_b32 v208, 16, v212
    v_mfma_f32_16x16x32_bf16 v[48:51], v[132:135], v[172:175], v[48:51]
    v_mfma_f32_16x16x32_bf16 v[48:51], v[136:139], v[168:171], v[48:51]
    ds_read2_b32 v[74:75], v237 offset0:98 offset1:99
    v_add_f32 v9, v9, v208
    v_mfma_f32_16x16x32_bf16 v[48:51], v[140:143], v[164:167], v[48:51]
    ds_read_b128 v[108:111], v246 offset:12288
    v_cvt_pk_bf16_f32 v9, v9, v9
    v_mfma_f32_16x16x32_bf16 v[48:51], v[144:147], v[160:163], v[48:51]
    ds_read2_b32 v[76:77], v237 offset0:224 offset1:225
    s_waitcnt lgkmcnt(11)
    s_barrier
    v_mfma_f32_16x16x32_bf16 v[52:55], v[148:151], v[160:163], v[52:55]
    ds_write_b16 v242, v9 offset:12480
    v_mfma_f32_16x16x32_bf16 v[52:55], v[144:147], v[164:167], v[52:55]
    ds_read2_b32 v[78:79], v237 offset0:226 offset1:227
    v_mfma_f32_16x16x32_bf16 v[52:55], v[140:143], v[168:171], v[52:55]
    ds_write_b16 v242, v9 offset:8322
    v_mfma_f32_16x16x32_bf16 v[52:55], v[136:139], v[172:175], v[52:55]
    s_lshl_b32 s14, s94, 18
    ds_read_b128 v[112:115], v246 offset:16384
    v_mfma_f32_16x16x32_bf16 v[52:55], v[132:135], v[176:179], v[52:55]
    ds_read2_b32 v[80:81], v238 offset0:96 offset1:97
    s_add_u32 m0, s73, 0
    v_alignbit_b32 v212, v213, v212, 16
    v_mfma_f32_16x16x32_bf16 v[52:55], v[128:131], v[180:183], v[52:55]
    buffer_load_dwordx4 v4, s[52:55], s14 offen offset:0 lds
    v_alignbit_b32 v213, v214, v213, 16
    v_mfma_f32_16x16x32_bf16 v[56:59], v[128:131], v[184:187], v[56:59]
    ds_read2_b32 v[82:83], v238 offset0:98 offset1:99
    v_mfma_f32_16x16x32_bf16 v[56:59], v[132:135], v[180:183], v[56:59]
    ds_read_b128 v[116:119], v246 offset:20480
    v_alignbit_b32 v214, v215, v214, 16
    v_mfma_f32_16x16x32_bf16 v[56:59], v[136:139], v[176:179], v[56:59]
    v_mfma_f32_16x16x32_bf16 v[56:59], v[140:143], v[172:175], v[56:59]
    ds_read2_b32 v[84:85], v238 offset0:224 offset1:225
    v_alignbit_b32 v215, v216, v215, 16
    v_mfma_f32_16x16x32_bf16 v[56:59], v[144:147], v[168:171], v[56:59]
    ds_read2_b32 v[86:87], v238 offset0:226 offset1:227
    v_mfma_f32_16x16x32_bf16 v[56:59], v[148:151], v[164:167], v[56:59]
    ds_write_b128 v241, v[212:215] offset:12512
    v_mfma_f32_16x16x32_bf16 v[56:59], v[152:155], v[160:163], v[56:59]
    ds_read_b128 v[120:123], v246 offset:24576
    v_mfma_f32_16x16x32_bf16 v[60:63], v[156:159], v[160:163], v[60:63]
    ds_read2_b32 v[88:89], v239 offset0:96 offset1:97
    v_alignbit_b32 v218, v219, v218, 16
    v_mfma_f32_16x16x32_bf16 v[60:63], v[152:155], v[164:167], v[60:63]
    ds_read2_b32 v[90:91], v239 offset0:98 offset1:99
    v_alignbit_b32 v219, v220, v219, 16
    v_mfma_f32_16x16x32_bf16 v[60:63], v[148:151], v[168:171], v[60:63]
    s_add_u32 m0, s73, 0
    ds_read_b128 v[124:127], v246 offset:28672
    v_mfma_f32_16x16x32_bf16 v[60:63], v[144:147], v[172:175], v[60:63]
    buffer_load_dwordx4 v5, s[52:55], s14 offen offset:1024 lds
    v_alignbit_b32 v220, v221, v220, 16
    v_mfma_f32_16x16x32_bf16 v[60:63], v[140:143], v[176:179], v[60:63]
    ds_read2_b32 v[92:93], v239 offset0:224 offset1:225
    v_mfma_f32_16x16x32_bf16 v[60:63], v[136:139], v[180:183], v[60:63]
    ds_read2_b32 v[94:95], v239 offset0:226 offset1:227
    v_alignbit_b32 v221, v222, v221, 16
    v_mfma_f32_16x16x32_bf16 v[60:63], v[132:135], v[184:187], v[60:63]
    ds_write_b128 v241, v[218:221] offset:13536
    v_mfma_f32_16x16x32_bf16 v[60:63], v[128:131], v[188:191], v[60:63]
    s_waitcnt lgkmcnt(15)
    v_mfma_f32_16x16x32_bf16 v[32:35], v[64:67], v[96:99], v[32:35]
    ds_read_b128 v[160:163], v247 offset:0
    s_waitcnt vmcnt(6)
    s_barrier
    v_mfma_f32_16x16x32_bf16 v[36:39], v[68:71], v[96:99], v[36:39]
    ds_read_b64_tr_b16 a[128:129], v10 offset:16384
    v_alignbit_b32 v224, v225, v224, 16
    v_mfma_f32_16x16x32_bf16 v[36:39], v[64:67], v[100:103], v[36:39]
    ds_read_b64_tr_b16 a[130:131], v10 offset:18432
    ds_read_b128 v[164:167], v247 offset:4096
    v_mfma_f32_16x16x32_bf16 v[40:43], v[64:67], v[104:107], v[40:43]
    ds_read_b128 v[168:171], v247 offset:8192
    v_mfma_f32_16x16x32_bf16 v[40:43], v[68:71], v[100:103], v[40:43]
    ds_read_b64_tr_b16 a[136:137], v10 offset:20480
    ds_read_b128 v[172:175], v247 offset:12288
    v_mfma_f32_16x16x32_bf16 v[40:43], v[72:75], v[96:99], v[40:43]
    ds_read_b64_tr_b16 a[138:139], v10 offset:22528
    v_alignbit_b32 v225, v226, v225, 16
    v_mfma_f32_16x16x32_bf16 v[44:47], v[76:79], v[96:99], v[44:47]
    s_add_u32 m0, s73, 0
    ds_read_b128 v[176:179], v247 offset:16384
    v_mfma_f32_16x16x32_bf16 v[44:47], v[72:75], v[100:103], v[44:47]
    ds_read_b64_tr_b16 a[132:133], v11 offset:16384
    buffer_load_dwordx4 v6, s[52:55], s14 offen offset:2048 lds
    ds_read_b128 v[180:183], v247 offset:20480
    v_mfma_f32_16x16x32_bf16 v[44:47], v[68:71], v[104:107], v[44:47]
    ds_read_b64_tr_b16 a[134:135], v11 offset:18432
    v_mfma_f32_16x16x32_bf16 v[44:47], v[64:67], v[108:111], v[44:47]
    ds_read_b128 v[184:187], v247 offset:24576
    v_alignbit_b32 v226, v227, v226, 16
    s_waitcnt lgkmcnt(14)
    v_mfma_f32_16x16x32_bf16 v[48:51], v[64:67], v[112:115], v[48:51]
    ds_read_b64_tr_b16 a[140:141], v11 offset:20480
    ds_read_b128 v[188:191], v247 offset:28672
    v_mfma_f32_16x16x32_bf16 v[48:51], v[68:71], v[108:111], v[48:51]
    ds_read_b64_tr_b16 a[142:143], v11 offset:22528
    v_mfma_f32_16x16x32_bf16 v[48:51], v[72:75], v[104:107], v[48:51]
    ds_read2_b32 v[128:129], v236 offset0:112 offset1:113
    v_alignbit_b32 v227, v228, v227, 16
    v_mfma_f32_16x16x32_bf16 v[48:51], v[76:79], v[100:103], v[48:51]
    ds_read2_b32 v[130:131], v236 offset0:114 offset1:115
    v_mfma_f32_16x16x32_bf16 v[48:51], v[80:83], v[96:99], v[48:51]
    ds_read2_b32 v[132:133], v236 offset0:240 offset1:241
    v_mfma_f32_16x16x32_bf16 v[52:55], v[84:87], v[96:99], v[52:55]
    ds_read2_b32 v[134:135], v236 offset0:242 offset1:243
    v_mfma_f32_16x16x32_bf16 v[52:55], v[80:83], v[100:103], v[52:55]
    ds_write_b128 v241, v[224:227] offset:14560
    v_mfma_f32_16x16x32_bf16 v[52:55], v[76:79], v[104:107], v[52:55]
    ds_read2_b32 v[136:137], v237 offset0:112 offset1:113
    ds_read2_b32 v[138:139], v237 offset0:114 offset1:115
    v_mfma_f32_16x16x32_bf16 v[52:55], v[72:75], v[108:111], v[52:55]
    s_add_u32 m0, s73, 0
    ds_read2_b32 v[140:141], v237 offset0:240 offset1:241
    s_add_u32 s6, s12, 4751360
    v_mfma_f32_16x16x32_bf16 v[52:55], v[68:71], v[112:115], v[52:55]
    buffer_load_dwordx4 v7, s[52:55], s14 offen offset:3072 lds
    v_alignbit_b32 v230, v231, v230, 16
    v_mfma_f32_16x16x32_bf16 v[52:55], v[64:67], v[116:119], v[52:55]
    ds_read2_b32 v[142:143], v237 offset0:242 offset1:243
    v_xor_b32 v244, 64, v244
    v_mfma_f32_16x16x32_bf16 v[56:59], v[64:67], v[120:123], v[56:59]
    ds_read2_b32 v[144:145], v238 offset0:112 offset1:113
    v_mfma_f32_16x16x32_bf16 v[56:59], v[68:71], v[116:119], v[56:59]
    ds_read2_b32 v[146:147], v238 offset0:114 offset1:115
    v_mfma_f32_16x16x32_bf16 v[56:59], v[72:75], v[112:115], v[56:59]
    ds_read2_b32 v[148:149], v238 offset0:240 offset1:241
    v_alignbit_b32 v231, v232, v231, 16
    v_mfma_f32_16x16x32_bf16 v[56:59], v[76:79], v[108:111], v[56:59]
    ds_read2_b32 v[150:151], v238 offset0:242 offset1:243
    v_xor_b32 v245, 64, v245
    v_mfma_f32_16x16x32_bf16 v[56:59], v[80:83], v[104:107], v[56:59]
    ds_read2_b32 v[152:153], v239 offset0:112 offset1:113
    s_waitcnt lgkmcnt(14)
    s_barrier
    v_mfma_f32_16x16x32_bf16 v[56:59], v[84:87], v[100:103], v[56:59]
    ds_read2_b32 v[154:155], v239 offset0:114 offset1:115
    v_mfma_f32_16x16x32_bf16 v[56:59], v[88:91], v[96:99], v[56:59]
    ds_read2_b32 v[156:157], v239 offset0:240 offset1:241
    v_alignbit_b32 v232, v233, v232, 16
    v_mfma_f32_16x16x32_bf16 v[60:63], v[92:95], v[96:99], v[60:63]
    s_lshl_b32 s14, s95, 18
    ds_read2_b32 v[158:159], v239 offset0:242 offset1:243
    v_mfma_f32_16x16x32_bf16 v[60:63], v[88:91], v[100:103], v[60:63]
    s_add_u32 m0, s73, 16384
    v_xor_b32 v246, 64, v246
    v_add_u32 v236, 8320, v236
    v_mfma_f32_16x16x32_bf16 v[60:63], v[84:87], v[104:107], v[60:63]
    buffer_load_dwordx4 v4, s[52:55], s14 offen offset:0 lds
    v_alignbit_b32 v233, v234, v233, 16
    v_mfma_f32_16x16x32_bf16 v[60:63], v[80:83], v[108:111], v[60:63]
    v_add_u32 v237, 8320, v237
    v_mfma_f32_16x16x32_bf16 v[60:63], v[76:79], v[112:115], v[60:63]
    v_mfma_f32_16x16x32_bf16 v[60:63], v[72:75], v[116:119], v[60:63]
    v_xor_b32 v247, 64, v247
    v_add_u32 v238, 8320, v238
    v_mfma_f32_16x16x32_bf16 v[60:63], v[68:71], v[120:123], v[60:63]
    ds_write_b128 v241, v[230:233] offset:15584
    v_mfma_f32_16x16x32_bf16 v[60:63], v[64:67], v[124:127], v[60:63]
    v_add_u32 v239, 8320, v239
    s_waitcnt lgkmcnt(1)
    v_mfma_f32_16x16x32_bf16 v[60:63], v[128:131], v[188:191], v[60:63]
    ds_read_b128 v[96:99], v244 offset:2048
    v_mfma_f32_16x16x32_bf16 v[60:63], v[132:135], v[184:187], v[60:63]
    ds_read2_b32 v[64:65], v236 offset0:0 offset1:1
    v_mfma_f32_16x16x32_bf16 v[60:63], v[136:139], v[180:183], v[60:63]
    ds_read2_b32 v[66:67], v236 offset0:2 offset1:3
    v_mfma_f32_16x16x32_bf16 v[60:63], v[140:143], v[176:179], v[60:63]
    ds_read_b128 v[100:103], v244 offset:6144
    v_mfma_f32_16x16x32_bf16 v[60:63], v[144:147], v[172:175], v[60:63]
    ds_read2_b32 v[68:69], v236 offset0:128 offset1:129
    v_mfma_f32_16x16x32_bf16 v[60:63], v[148:151], v[168:171], v[60:63]
    s_add_u32 m0, s73, 16384
    ds_read2_b32 v[70:71], v236 offset0:130 offset1:131
    v_mfma_f32_16x16x32_bf16 v[60:63], v[152:155], v[164:167], v[60:63]
    buffer_load_dwordx4 v5, s[52:55], s14 offen offset:1024 lds
    ds_read_b128 v[104:107], v244 offset:10240
    v_mfma_f32_16x16x32_bf16 v[60:63], v[156:159], v[160:163], v[60:63]
    ds_read2_b32 v[72:73], v237 offset0:0 offset1:1
    v_mfma_f32_16x16x32_bf16 v[56:59], v[128:131], v[184:187], v[56:59]
    ds_read2_b32 v[74:75], v237 offset0:2 offset1:3
    v_mfma_f32_16x16x32_bf16 v[56:59], v[132:135], v[180:183], v[56:59]
    ds_read_b128 v[108:111], v244 offset:14336
    v_mfma_f32_16x16x32_bf16 v[56:59], v[136:139], v[176:179], v[56:59]
    ds_read2_b32 v[76:77], v237 offset0:128 offset1:129
    v_mfma_f32_16x16x32_bf16 v[56:59], v[140:143], v[172:175], v[56:59]
    ds_read2_b32 v[78:79], v237 offset0:130 offset1:131
    v_mfma_f32_16x16x32_bf16 v[56:59], v[144:147], v[168:171], v[56:59]
    ds_read_b128 v[112:115], v244 offset:18432
    v_mfma_f32_16x16x32_bf16 v[56:59], v[148:151], v[164:167], v[56:59]
    ds_read2_b32 v[80:81], v238 offset0:0 offset1:1
    v_cvt_pk_bf16_f32 v206, v60, v61
    v_mfma_f32_16x16x32_bf16 v[56:59], v[152:155], v[160:163], v[56:59]
    ds_read2_b32 v[82:83], v238 offset0:2 offset1:3
    s_waitcnt vmcnt(6)
    s_barrier
    v_mfma_f32_16x16x32_bf16 v[52:55], v[128:131], v[180:183], v[52:55]
    ds_read_b128 v[116:119], v244 offset:22528
    v_add_u32 v10, 131072, v10
    v_mfma_f32_16x16x32_bf16 v[52:55], v[132:135], v[176:179], v[52:55]
    ds_read_b64_tr_b16 a[144:145], v10 offset:16384
    v_cvt_pk_bf16_f32 v207, v62, v63
    v_mfma_f32_16x16x32_bf16 v[52:55], v[136:139], v[172:175], v[52:55]
    ds_read_b64_tr_b16 a[146:147], v10 offset:18432
    s_add_u32 m0, s73, 16384
    v_mfma_f32_16x16x32_bf16 v[52:55], v[140:143], v[168:171], v[52:55]
    buffer_load_dwordx4 v6, s[52:55], s14 offen offset:2048 lds
    ds_read2_b32 v[84:85], v238 offset0:128 offset1:129
    v_mfma_f32_16x16x32_bf16 v[52:55], v[144:147], v[164:167], v[52:55]
    buffer_store_dwordx2 v[206:207], v8, s[44:47], s6 offen offset:3584 sc1
    ds_read_b64_tr_b16 a[152:153], v10 offset:20480
    v_mfma_f32_16x16x32_bf16 v[52:55], v[148:151], v[160:163], v[52:55]
    ds_read_b64_tr_b16 a[154:155], v10 offset:22528
    v_mfma_f32_16x16x32_bf16 v[48:51], v[128:131], v[176:179], v[48:51]
    ds_read2_b32 v[86:87], v238 offset0:130 offset1:131
    v_add_u32 v11, 131072, v11
    v_cvt_pk_bf16_f32 v204, v56, v57
    v_mfma_f32_16x16x32_bf16 v[48:51], v[132:135], v[172:175], v[48:51]
    ds_read_b64_tr_b16 a[148:149], v11 offset:16384
    ds_read_b128 v[120:123], v244 offset:26624
    v_mfma_f32_16x16x32_bf16 v[48:51], v[136:139], v[168:171], v[48:51]
    ds_read_b64_tr_b16 a[150:151], v11 offset:18432
    ds_read2_b32 v[88:89], v239 offset0:0 offset1:1
    v_mfma_f32_16x16x32_bf16 v[48:51], v[140:143], v[164:167], v[48:51]
    ds_read2_b32 v[90:91], v239 offset0:2 offset1:3
    v_cvt_pk_bf16_f32 v205, v58, v59
    v_mfma_f32_16x16x32_bf16 v[48:51], v[144:147], v[160:163], v[48:51]
    ds_read_b64_tr_b16 a[156:157], v11 offset:20480
    ds_read_b128 v[124:127], v244 offset:30720
    v_mfma_f32_16x16x32_bf16 v[44:47], v[128:131], v[172:175], v[44:47]
    buffer_store_dwordx2 v[204:205], v8, s[44:47], s6 offen offset:3072 sc1
    ds_read_b64_tr_b16 a[158:159], v11 offset:22528
    v_mfma_f32_16x16x32_bf16 v[44:47], v[132:135], v[168:171], v[44:47]
    ds_read2_b32 v[92:93], v239 offset0:128 offset1:129
    v_mfma_f32_16x16x32_bf16 v[44:47], v[136:139], v[164:167], v[44:47]
    s_add_u32 m0, s73, 16384
    ds_read2_b32 v[94:95], v239 offset0:130 offset1:131
    v_mfma_f32_16x16x32_bf16 v[44:47], v[140:143], v[160:163], v[44:47]
    buffer_load_dwordx4 v7, s[52:55], s14 offen offset:3072 lds
    v_cvt_pk_bf16_f32 v202, v52, v53
    v_mfma_f32_16x16x32_bf16 v[40:43], v[128:131], v[168:171], v[40:43]
    v_mfma_f32_16x16x32_bf16 v[40:43], v[132:135], v[164:167], v[40:43]
    v_mfma_f32_16x16x32_bf16 v[40:43], v[136:139], v[160:163], v[40:43]
    v_cvt_pk_bf16_f32 v203, v54, v55
    v_mfma_f32_16x16x32_bf16 v[36:39], v[128:131], v[164:167], v[36:39]
    v_mfma_f32_16x16x32_bf16 v[36:39], v[132:135], v[160:163], v[36:39]
    buffer_store_dwordx2 v[202:203], v8, s[44:47], s6 offen offset:2560 sc1
    v_mfma_f32_16x16x32_bf16 v[32:35], v[128:131], v[160:163], v[32:35]
    s_waitcnt lgkmcnt(0)
    v_mfma_f32_16x16x32_bf16 v[60:63], v[64:67], v[124:127], 0
    ds_read_b128 v[160:163], v245 offset:2048
    v_mfma_f32_16x16x32_bf16 v[60:63], v[68:71], v[120:123], v[60:63]
    v_cvt_pk_bf16_f32 v200, v48, v49
    v_mfma_f32_16x16x32_bf16 v[60:63], v[72:75], v[116:119], v[60:63]
    ds_read2_b32 v[128:129], v236 offset0:16 offset1:17
    v_mfma_f32_16x16x32_bf16 v[60:63], v[76:79], v[112:115], v[60:63]
    s_barrier
    v_cvt_pk_bf16_f32 v201, v50, v51
    v_mfma_f32_16x16x32_bf16 v[60:63], v[80:83], v[108:111], v[60:63]
    ds_read2_b32 v[130:131], v236 offset0:18 offset1:19
    v_mfma_f32_16x16x32_bf16 v[60:63], v[84:87], v[104:107], v[60:63]
    buffer_store_dwordx2 v[200:201], v8, s[44:47], s6 offen offset:2048 sc1
    ds_read_b128 v[164:167], v245 offset:6144
    v_mfma_f32_16x16x32_bf16 v[60:63], v[88:91], v[100:103], v[60:63]
    ds_read2_b32 v[132:133], v236 offset0:144 offset1:145
    v_mfma_f32_16x16x32_bf16 v[60:63], v[92:95], v[96:99], v[60:63]
    ds_read2_b32 v[134:135], v236 offset0:146 offset1:147
    s_lshl_b32 s14, s96, 18
    v_cvt_pk_bf16_f32 v198, v44, v45
    v_mfma_f32_16x16x32_bf16 v[56:59], v[64:67], v[120:123], 0
    s_add_u32 m0, s73, 147456
    ds_read_b128 v[168:171], v245 offset:10240
    v_mfma_f32_16x16x32_bf16 v[56:59], v[68:71], v[116:119], v[56:59]
    buffer_load_dwordx4 v4, s[52:55], s14 offen offset:0 lds
    ds_read2_b32 v[136:137], v237 offset0:16 offset1:17
    v_mfma_f32_16x16x32_bf16 v[56:59], v[72:75], v[112:115], v[56:59]
    ds_read2_b32 v[138:139], v237 offset0:18 offset1:19
    v_cvt_pk_bf16_f32 v199, v46, v47
    v_mfma_f32_16x16x32_bf16 v[56:59], v[76:79], v[108:111], v[56:59]
    ds_read_b128 v[172:175], v245 offset:14336
    v_mfma_f32_16x16x32_bf16 v[56:59], v[80:83], v[104:107], v[56:59]
    buffer_store_dwordx2 v[198:199], v8, s[44:47], s6 offen offset:1536 sc1
    ds_read2_b32 v[140:141], v237 offset0:144 offset1:145
    v_mfma_f32_16x16x32_bf16 v[56:59], v[84:87], v[100:103], v[56:59]
    ds_read2_b32 v[142:143], v237 offset0:146 offset1:147
    v_mfma_f32_16x16x32_bf16 v[56:59], v[88:91], v[96:99], v[56:59]
    ds_read_b128 v[176:179], v245 offset:18432
    v_cvt_pk_bf16_f32 v196, v40, v41
    v_mfma_f32_16x16x32_bf16 v[52:55], v[64:67], v[116:119], 0
    ds_read2_b32 v[144:145], v238 offset0:16 offset1:17
    v_mfma_f32_16x16x32_bf16 v[52:55], v[68:71], v[112:115], v[52:55]
    ds_read2_b32 v[146:147], v238 offset0:18 offset1:19
    v_cvt_pk_bf16_f32 v197, v42, v43
    v_mfma_f32_16x16x32_bf16 v[52:55], v[72:75], v[108:111], v[52:55]
    ds_read_b128 v[180:183], v245 offset:22528
    v_mfma_f32_16x16x32_bf16 v[52:55], v[76:79], v[104:107], v[52:55]
    buffer_store_dwordx2 v[196:197], v8, s[44:47], s6 offen offset:1024 sc1
    ds_read2_b32 v[148:149], v238 offset0:144 offset1:145
    v_mfma_f32_16x16x32_bf16 v[52:55], v[80:83], v[100:103], v[52:55]
    s_add_u32 m0, s73, 147456
    ds_read2_b32 v[150:151], v238 offset0:146 offset1:147
    v_mfma_f32_16x16x32_bf16 v[52:55], v[84:87], v[96:99], v[52:55]
    buffer_load_dwordx4 v5, s[52:55], s14 offen offset:1024 lds
    ds_read_b128 v[184:187], v245 offset:26624
    v_mfma_f32_16x16x32_bf16 v[48:51], v[64:67], v[112:115], 0
    ds_read2_b32 v[152:153], v239 offset0:16 offset1:17
    v_cvt_pk_bf16_f32 v194, v36, v37
    v_mfma_f32_16x16x32_bf16 v[48:51], v[68:71], v[108:111], v[48:51]
    ds_read2_b32 v[154:155], v239 offset0:18 offset1:19
    v_mfma_f32_16x16x32_bf16 v[48:51], v[72:75], v[104:107], v[48:51]
    ds_read_b128 v[188:191], v245 offset:30720
    v_cvt_pk_bf16_f32 v195, v38, v39
    v_mfma_f32_16x16x32_bf16 v[48:51], v[76:79], v[100:103], v[48:51]
    ds_read2_b32 v[156:157], v239 offset0:144 offset1:145
    v_mfma_f32_16x16x32_bf16 v[48:51], v[80:83], v[96:99], v[48:51]
    buffer_store_dwordx2 v[194:195], v8, s[44:47], s6 offen offset:512 sc1
    s_waitcnt vmcnt(13)
    s_barrier
    v_mfma_f32_16x16x32_bf16 v[44:47], v[64:67], v[108:111], 0
    v_add_u32 v10, -131072, v10
    v_cvt_pk_bf16_f32 v192, v32, v33
    v_mfma_f32_16x16x32_bf16 v[44:47], v[68:71], v[104:107], v[44:47]
    ds_read_b64_tr_b16 a[160:161], v10 offset:0
    v_mfma_f32_16x16x32_bf16 v[44:47], v[72:75], v[100:103], v[44:47]
    ds_read_b64_tr_b16 a[162:163], v10 offset:2048
    v_mfma_f32_16x16x32_bf16 v[44:47], v[76:79], v[96:99], v[44:47]
    ds_read_b64_tr_b16 a[168:169], v10 offset:4096
    v_cvt_pk_bf16_f32 v193, v34, v35
    v_mfma_f32_16x16x32_bf16 v[40:43], v[64:67], v[104:107], 0
    ds_read2_b32 v[158:159], v239 offset0:146 offset1:147
    v_mfma_f32_16x16x32_bf16 v[40:43], v[68:71], v[100:103], v[40:43]
    buffer_store_dwordx2 v[192:193], v8, s[44:47], s6 offen offset:0 sc1
    ds_read_b64_tr_b16 a[170:171], v10 offset:6144
    s_add_u32 m0, s73, 147456
L_pl_X_5:
    s_cbranch_execz L_wret
    v_mfma_f32_16x16x32_bf16 v[40:43], v[72:75], v[96:99], v[40:43]
    v_add_u32 v11, -131072, v11
    buffer_load_dwordx4 v6, s[52:55], s14 offen offset:2048 lds
    v_mfma_f32_16x16x32_bf16 v[36:39], v[64:67], v[100:103], 0
    ds_read_b64_tr_b16 a[164:165], v11 offset:0
    v_mfma_f32_16x16x32_bf16 v[36:39], v[68:71], v[96:99], v[36:39]
    ds_read_b64_tr_b16 a[166:167], v11 offset:2048
    v_mfma_f32_16x16x32_bf16 v[32:35], v[64:67], v[96:99], 0
    ds_read_b64_tr_b16 a[172:173], v11 offset:4096
    s_waitcnt lgkmcnt(15)
    v_mfma_f32_16x16x32_bf16 v[32:35], v[128:131], v[160:163], v[32:35]
    ds_read_b64_tr_b16 a[174:175], v11 offset:6144
    v_mfma_f32_16x16x32_bf16 v[36:39], v[132:135], v[160:163], v[36:39]
    ds_read_b128 v[96:99], v246 offset:2048
    v_mfma_f32_16x16x32_bf16 v[36:39], v[128:131], v[164:167], v[36:39]
    ds_read2_b32 v[64:65], v236 offset0:32 offset1:33
    v_mfma_f32_16x16x32_bf16 v[40:43], v[128:131], v[168:171], v[40:43]
    ds_read2_b32 v[66:67], v236 offset0:34 offset1:35
    v_mfma_f32_16x16x32_bf16 v[40:43], v[132:135], v[164:167], v[40:43]
    v_mfma_f32_16x16x32_bf16 v[40:43], v[136:139], v[160:163], v[40:43]
    ds_read_b128 v[100:103], v246 offset:6144
    v_mfma_f32_16x16x32_bf16 v[44:47], v[140:143], v[160:163], v[44:47]
    ds_read2_b32 v[68:69], v236 offset0:160 offset1:161
    v_mfma_f32_16x16x32_bf16 v[44:47], v[136:139], v[164:167], v[44:47]
    s_add_u32 m0, s73, 147456
    v_mfma_f32_16x16x32_bf16 v[44:47], v[132:135], v[168:171], v[44:47]
    buffer_load_dwordx4 v7, s[52:55], s14 offen offset:3072 lds
    ds_read2_b32 v[70:71], v236 offset0:162 offset1:163
    v_mfma_f32_16x16x32_bf16 v[44:47], v[128:131], v[172:175], v[44:47]
    ds_read_b128 v[104:107], v246 offset:10240
    s_waitcnt lgkmcnt(12)
    v_mfma_f32_16x16x32_bf16 v[48:51], v[128:131], v[176:179], v[48:51]
    ds_read2_b32 v[72:73], v237 offset0:32 offset1:33
    v_mfma_f32_16x16x32_bf16 v[48:51], v[132:135], v[172:175], v[48:51]
    v_mfma_f32_16x16x32_bf16 v[48:51], v[136:139], v[168:171], v[48:51]
    ds_read2_b32 v[74:75], v237 offset0:34 offset1:35
    v_mfma_f32_16x16x32_bf16 v[48:51], v[140:143], v[164:167], v[48:51]
    ds_read_b128 v[108:111], v246 offset:14336
    v_mfma_f32_16x16x32_bf16 v[48:51], v[144:147], v[160:163], v[48:51]
    s_waitcnt lgkmcnt(10)
    s_barrier
    v_mfma_f32_16x16x32_bf16 v[52:55], v[148:151], v[160:163], v[52:55]
    ds_read2_b32 v[76:77], v237 offset0:160 offset1:161
    v_mfma_f32_16x16x32_bf16 v[52:55], v[144:147], v[164:167], v[52:55]
    ds_read2_b32 v[78:79], v237 offset0:162 offset1:163
    v_mfma_f32_16x16x32_bf16 v[52:55], v[140:143], v[168:171], v[52:55]
    v_mfma_f32_16x16x32_bf16 v[52:55], v[136:139], v[172:175], v[52:55]
    s_lshl_b32 s14, s97, 18
    ds_read_b128 v[112:115], v246 offset:18432
    v_mfma_f32_16x16x32_bf16 v[52:55], v[132:135], v[176:179], v[52:55]
    s_add_u32 m0, s73, 0
    ds_read2_b32 v[80:81], v238 offset0:32 offset1:33
    v_mfma_f32_16x16x32_bf16 v[52:55], v[128:131], v[180:183], v[52:55]
    buffer_load_dwordx4 v4, s[52:55], s14 offen offset:0 lds
    v_mfma_f32_16x16x32_bf16 v[56:59], v[128:131], v[184:187], v[56:59]
    ds_read2_b32 v[82:83], v238 offset0:34 offset1:35
    v_mfma_f32_16x16x32_bf16 v[56:59], v[132:135], v[180:183], v[56:59]
    ds_read_b128 v[116:119], v246 offset:22528
    v_mfma_f32_16x16x32_bf16 v[56:59], v[136:139], v[176:179], v[56:59]
    v_mfma_f32_16x16x32_bf16 v[56:59], v[140:143], v[172:175], v[56:59]
    ds_read2_b32 v[84:85], v238 offset0:160 offset1:161
    v_mfma_f32_16x16x32_bf16 v[56:59], v[144:147], v[168:171], v[56:59]
    ds_read2_b32 v[86:87], v238 offset0:162 offset1:163
    v_mfma_f32_16x16x32_bf16 v[56:59], v[148:151], v[164:167], v[56:59]
    ds_read_b128 v[120:123], v246 offset:26624
    v_mfma_f32_16x16x32_bf16 v[56:59], v[152:155], v[160:163], v[56:59]
    v_mfma_f32_16x16x32_bf16 v[60:63], v[156:159], v[160:163], v[60:63]
    ds_read2_b32 v[88:89], v239 offset0:32 offset1:33
    v_mfma_f32_16x16x32_bf16 v[60:63], v[152:155], v[164:167], v[60:63]
    ds_read2_b32 v[90:91], v239 offset0:34 offset1:35
    v_mfma_f32_16x16x32_bf16 v[60:63], v[148:151], v[168:171], v[60:63]
    s_add_u32 m0, s73, 0
    v_mfma_f32_16x16x32_bf16 v[60:63], v[144:147], v[172:175], v[60:63]
    buffer_load_dwordx4 v5, s[52:55], s14 offen offset:1024 lds
    ds_read_b128 v[124:127], v246 offset:30720
    v_mfma_f32_16x16x32_bf16 v[60:63], v[140:143], v[176:179], v[60:63]
    ds_read2_b32 v[92:93], v239 offset0:160 offset1:161
    v_mfma_f32_16x16x32_bf16 v[60:63], v[136:139], v[180:183], v[60:63]
    v_mfma_f32_16x16x32_bf16 v[60:63], v[132:135], v[184:187], v[60:63]
    ds_read2_b32 v[94:95], v239 offset0:162 offset1:163
    v_mfma_f32_16x16x32_bf16 v[60:63], v[128:131], v[188:191], v[60:63]
    s_waitcnt lgkmcnt(12)
    v_mfma_f32_16x16x32_bf16 v[32:35], v[64:67], v[96:99], v[32:35]
    ds_read_b128 v[160:163], v247 offset:2048
    s_waitcnt vmcnt(12)
    s_barrier
    v_mfma_f32_16x16x32_bf16 v[36:39], v[68:71], v[96:99], v[36:39]
    ds_read_b64_tr_b16 a[176:177], v10 offset:16384
    v_mfma_f32_16x16x32_bf16 v[36:39], v[64:67], v[100:103], v[36:39]
    ds_read_b64_tr_b16 a[178:179], v10 offset:18432
    v_mfma_f32_16x16x32_bf16 v[40:43], v[64:67], v[104:107], v[40:43]
    ds_read2_b32 v[128:129], v236 offset0:48 offset1:49
    v_mfma_f32_16x16x32_bf16 v[40:43], v[68:71], v[100:103], v[40:43]
    ds_read_b64_tr_b16 a[184:185], v10 offset:20480
    v_mfma_f32_16x16x32_bf16 v[40:43], v[72:75], v[96:99], v[40:43]
    ds_read_b64_tr_b16 a[186:187], v10 offset:22528
    v_mfma_f32_16x16x32_bf16 v[44:47], v[76:79], v[96:99], v[44:47]
    s_add_u32 m0, s73, 0
    ds_read2_b32 v[130:131], v236 offset0:50 offset1:51
    v_mfma_f32_16x16x32_bf16 v[44:47], v[72:75], v[100:103], v[44:47]
    ds_read_b64_tr_b16 a[180:181], v11 offset:16384
    buffer_load_dwordx4 v6, s[52:55], s14 offen offset:2048 lds
    v_mfma_f32_16x16x32_bf16 v[44:47], v[68:71], v[104:107], v[44:47]
    ds_read_b64_tr_b16 a[182:183], v11 offset:18432
    v_mfma_f32_16x16x32_bf16 v[44:47], v[64:67], v[108:111], v[44:47]
    ds_read_b128 v[164:167], v247 offset:6144
    s_waitcnt lgkmcnt(10)
    v_mfma_f32_16x16x32_bf16 v[48:51], v[64:67], v[112:115], v[48:51]
    ds_read_b64_tr_b16 a[188:189], v11 offset:20480
    v_mfma_f32_16x16x32_bf16 v[48:51], v[68:71], v[108:111], v[48:51]
    ds_read_b64_tr_b16 a[190:191], v11 offset:22528
    v_mfma_f32_16x16x32_bf16 v[48:51], v[72:75], v[104:107], v[48:51]
    ds_read2_b32 v[132:133], v236 offset0:176 offset1:177
    v_mfma_f32_16x16x32_bf16 v[48:51], v[76:79], v[100:103], v[48:51]
    ds_read2_b32 v[134:135], v236 offset0:178 offset1:179
    v_mfma_f32_16x16x32_bf16 v[48:51], v[80:83], v[96:99], v[48:51]
    ds_read_b128 v[168:171], v247 offset:10240
    v_mfma_f32_16x16x32_bf16 v[52:55], v[84:87], v[96:99], v[52:55]
    ds_read2_b32 v[136:137], v237 offset0:48 offset1:49
    v_mfma_f32_16x16x32_bf16 v[52:55], v[80:83], v[100:103], v[52:55]
    ds_read2_b32 v[138:139], v237 offset0:50 offset1:51
    v_mfma_f32_16x16x32_bf16 v[52:55], v[76:79], v[104:107], v[52:55]
    ds_read_b128 v[172:175], v247 offset:14336
    v_mfma_f32_16x16x32_bf16 v[52:55], v[72:75], v[108:111], v[52:55]
    s_add_u32 m0, s73, 0
    ds_read2_b32 v[140:141], v237 offset0:176 offset1:177
    v_mfma_f32_16x16x32_bf16 v[52:55], v[68:71], v[112:115], v[52:55]
    buffer_load_dwordx4 v7, s[52:55], s14 offen offset:3072 lds
    ds_read2_b32 v[142:143], v237 offset0:178 offset1:179
    v_mfma_f32_16x16x32_bf16 v[52:55], v[64:67], v[116:119], v[52:55]
    ds_read_b128 v[176:179], v247 offset:18432
    v_mfma_f32_16x16x32_bf16 v[56:59], v[64:67], v[120:123], v[56:59]
    ds_read2_b32 v[144:145], v238 offset0:48 offset1:49
    v_mfma_f32_16x16x32_bf16 v[56:59], v[68:71], v[116:119], v[56:59]
    ds_read2_b32 v[146:147], v238 offset0:50 offset1:51
    v_mfma_f32_16x16x32_bf16 v[56:59], v[72:75], v[112:115], v[56:59]
    ds_read_b128 v[180:183], v247 offset:22528
    v_mfma_f32_16x16x32_bf16 v[56:59], v[76:79], v[108:111], v[56:59]
    ds_read2_b32 v[148:149], v238 offset0:176 offset1:177
    v_mfma_f32_16x16x32_bf16 v[56:59], v[80:83], v[104:107], v[56:59]
    ds_read2_b32 v[150:151], v238 offset0:178 offset1:179
    s_waitcnt lgkmcnt(14)
    s_barrier
    v_mfma_f32_16x16x32_bf16 v[56:59], v[84:87], v[100:103], v[56:59]
    ds_read_b128 v[184:187], v247 offset:26624
    v_mfma_f32_16x16x32_bf16 v[56:59], v[88:91], v[96:99], v[56:59]
    v_mfma_f32_16x16x32_bf16 v[60:63], v[92:95], v[96:99], v[60:63]
    s_lshl_b32 s14, s98, 18
    ds_read2_b32 v[152:153], v239 offset0:48 offset1:49
    v_mfma_f32_16x16x32_bf16 v[60:63], v[88:91], v[100:103], v[60:63]
    s_add_u32 m0, s73, 16384
    ds_read2_b32 v[154:155], v239 offset0:50 offset1:51
    v_mfma_f32_16x16x32_bf16 v[60:63], v[84:87], v[104:107], v[60:63]
    buffer_load_dwordx4 v4, s[52:55], s14 offen offset:0 lds
    v_mfma_f32_16x16x32_bf16 v[60:63], v[80:83], v[108:111], v[60:63]
    ds_read_b128 v[188:191], v247 offset:30720
    v_mfma_f32_16x16x32_bf16 v[60:63], v[76:79], v[112:115], v[60:63]
    ds_read2_b32 v[156:157], v239 offset0:176 offset1:177
    v_mfma_f32_16x16x32_bf16 v[60:63], v[72:75], v[116:119], v[60:63]
    v_mfma_f32_16x16x32_bf16 v[60:63], v[68:71], v[120:123], v[60:63]
    ds_read2_b32 v[158:159], v239 offset0:178 offset1:179
    v_mfma_f32_16x16x32_bf16 v[60:63], v[64:67], v[124:127], v[60:63]
    s_waitcnt lgkmcnt(12)
    v_mfma_f32_16x16x32_bf16 v[32:35], v[128:131], v[160:163], v[32:35]
    ds_read_b128 v[96:99], v244 offset:0
    v_mfma_f32_16x16x32_bf16 v[36:39], v[132:135], v[160:163], v[36:39]
    v_mfma_f32_16x16x32_bf16 v[36:39], v[128:131], v[164:167], v[36:39]
    ds_read2_b32 v[64:65], v236 offset0:64 offset1:65
    v_mfma_f32_16x16x32_bf16 v[40:43], v[128:131], v[168:171], v[40:43]
    ds_read2_b32 v[66:67], v236 offset0:66 offset1:67
    v_mfma_f32_16x16x32_bf16 v[40:43], v[132:135], v[164:167], v[40:43]
    v_mfma_f32_16x16x32_bf16 v[40:43], v[136:139], v[160:163], v[40:43]
    s_add_u32 m0, s73, 16384
    ds_read_b128 v[100:103], v244 offset:4096
    v_mfma_f32_16x16x32_bf16 v[44:47], v[140:143], v[160:163], v[44:47]
    buffer_load_dwordx4 v5, s[52:55], s14 offen offset:1024 lds
    ds_read2_b32 v[68:69], v236 offset0:192 offset1:193
    v_mfma_f32_16x16x32_bf16 v[44:47], v[136:139], v[164:167], v[44:47]
    v_mfma_f32_16x16x32_bf16 v[44:47], v[132:135], v[168:171], v[44:47]
    ds_read2_b32 v[70:71], v236 offset0:194 offset1:195
    v_mfma_f32_16x16x32_bf16 v[44:47], v[128:131], v[172:175], v[44:47]
    ds_read_b128 v[104:107], v244 offset:8192
    s_waitcnt lgkmcnt(7)
    v_mfma_f32_16x16x32_bf16 v[48:51], v[128:131], v[176:179], v[48:51]
    ds_read2_b32 v[72:73], v237 offset0:64 offset1:65
    v_mfma_f32_16x16x32_bf16 v[48:51], v[132:135], v[172:175], v[48:51]
    ds_read2_b32 v[74:75], v237 offset0:66 offset1:67
    v_mfma_f32_16x16x32_bf16 v[48:51], v[136:139], v[168:171], v[48:51]
    ds_read_b128 v[108:111], v244 offset:12288
    v_mfma_f32_16x16x32_bf16 v[48:51], v[140:143], v[164:167], v[48:51]
    ds_read2_b32 v[76:77], v237 offset0:192 offset1:193
    v_mfma_f32_16x16x32_bf16 v[48:51], v[144:147], v[160:163], v[48:51]
    ds_read2_b32 v[78:79], v237 offset0:194 offset1:195
    s_waitcnt vmcnt(6)
    s_barrier
    v_mfma_f32_16x16x32_bf16 v[52:55], v[148:151], v[160:163], v[52:55]
    ds_read_b128 v[112:115], v244 offset:16384
    v_add_u32 v10, 131072, v10
    v_mfma_f32_16x16x32_bf16 v[52:55], v[144:147], v[164:167], v[52:55]
    ds_read_b64_tr_b16 a[192:193], v10 offset:16384
    v_mfma_f32_16x16x32_bf16 v[52:55], v[140:143], v[168:171], v[52:55]
    ds_read_b64_tr_b16 a[194:195], v10 offset:18432
    s_add_u32 m0, s73, 16384
    v_mfma_f32_16x16x32_bf16 v[52:55], v[136:139], v[172:175], v[52:55]
    buffer_load_dwordx4 v6, s[52:55], s14 offen offset:2048 lds
    ds_read2_b32 v[80:81], v238 offset0:64 offset1:65
    v_mfma_f32_16x16x32_bf16 v[52:55], v[132:135], v[176:179], v[52:55]
    ds_read_b64_tr_b16 a[200:201], v10 offset:20480
    v_mfma_f32_16x16x32_bf16 v[52:55], v[128:131], v[180:183], v[52:55]
    ds_read_b64_tr_b16 a[202:203], v10 offset:22528
    v_mfma_f32_16x16x32_bf16 v[56:59], v[128:131], v[184:187], v[56:59]
    ds_read2_b32 v[82:83], v238 offset0:66 offset1:67
    v_add_u32 v11, 131072, v11
    v_mfma_f32_16x16x32_bf16 v[56:59], v[132:135], v[180:183], v[56:59]
    ds_read_b64_tr_b16 a[196:197], v11 offset:16384
    v_mfma_f32_16x16x32_bf16 v[56:59], v[136:139], v[176:179], v[56:59]
    ds_read_b64_tr_b16 a[198:199], v11 offset:18432
    v_mfma_f32_16x16x32_bf16 v[56:59], v[140:143], v[172:175], v[56:59]
    ds_read_b128 v[116:119], v244 offset:20480
    v_mfma_f32_16x16x32_bf16 v[56:59], v[144:147], v[168:171], v[56:59]
    ds_read_b64_tr_b16 a[204:205], v11 offset:20480
    v_mfma_f32_16x16x32_bf16 v[56:59], v[148:151], v[164:167], v[56:59]
    ds_read_b64_tr_b16 a[206:207], v11 offset:22528
    v_mfma_f32_16x16x32_bf16 v[56:59], v[152:155], v[160:163], v[56:59]
    ds_read2_b32 v[84:85], v238 offset0:192 offset1:193
    v_mfma_f32_16x16x32_bf16 v[60:63], v[156:159], v[160:163], v[60:63]
    s_add_u32 m0, s73, 16384
    ds_read2_b32 v[86:87], v238 offset0:194 offset1:195
    v_mfma_f32_16x16x32_bf16 v[60:63], v[152:155], v[164:167], v[60:63]
    buffer_load_dwordx4 v7, s[52:55], s14 offen offset:3072 lds
    ds_read_b128 v[120:123], v244 offset:24576
    v_mfma_f32_16x16x32_bf16 v[60:63], v[148:151], v[168:171], v[60:63]
    ds_read2_b32 v[88:89], v239 offset0:64 offset1:65
    v_mfma_f32_16x16x32_bf16 v[60:63], v[144:147], v[172:175], v[60:63]
    ds_read2_b32 v[90:91], v239 offset0:66 offset1:67
    v_mfma_f32_16x16x32_bf16 v[60:63], v[140:143], v[176:179], v[60:63]
    ds_read_b128 v[124:127], v244 offset:28672
    v_mfma_f32_16x16x32_bf16 v[60:63], v[136:139], v[180:183], v[60:63]
    ds_read2_b32 v[92:93], v239 offset0:192 offset1:193
    v_mfma_f32_16x16x32_bf16 v[60:63], v[132:135], v[184:187], v[60:63]
    ds_read2_b32 v[94:95], v239 offset0:194 offset1:195
    v_mfma_f32_16x16x32_bf16 v[60:63], v[128:131], v[188:191], v[60:63]
    s_waitcnt lgkmcnt(15)
    v_mfma_f32_16x16x32_bf16 v[32:35], v[64:67], v[96:99], v[32:35]
    ds_read_b128 v[160:163], v245 offset:0
    v_mfma_f32_16x16x32_bf16 v[36:39], v[68:71], v[96:99], v[36:39]
    v_mfma_f32_16x16x32_bf16 v[36:39], v[64:67], v[100:103], v[36:39]
    ds_read2_b32 v[128:129], v236 offset0:80 offset1:81
    v_mfma_f32_16x16x32_bf16 v[40:43], v[64:67], v[104:107], v[40:43]
    ds_read2_b32 v[130:131], v236 offset0:82 offset1:83
    s_waitcnt lgkmcnt(11)
    s_barrier
    v_mfma_f32_16x16x32_bf16 v[40:43], v[68:71], v[100:103], v[40:43]
    v_mfma_f32_16x16x32_bf16 v[40:43], v[72:75], v[96:99], v[40:43]
    ds_read_b128 v[164:167], v245 offset:4096
    v_mfma_f32_16x16x32_bf16 v[44:47], v[76:79], v[96:99], v[44:47]
    ds_read2_b32 v[132:133], v236 offset0:208 offset1:209
    v_mfma_f32_16x16x32_bf16 v[44:47], v[72:75], v[100:103], v[44:47]
    s_lshl_b32 s14, s99, 18
    v_mfma_f32_16x16x32_bf16 v[44:47], v[68:71], v[104:107], v[44:47]
    s_add_u32 m0, s73, 147456
    ds_read2_b32 v[134:135], v236 offset0:210 offset1:211
    v_mfma_f32_16x16x32_bf16 v[44:47], v[64:67], v[108:111], v[44:47]
    buffer_load_dwordx4 v4, s[52:55], s14 offen offset:0 lds
    ds_read_b128 v[168:171], v245 offset:8192
    s_waitcnt lgkmcnt(7)
    v_mfma_f32_16x16x32_bf16 v[48:51], v[64:67], v[112:115], v[48:51]
    ds_read2_b32 v[136:137], v237 offset0:80 offset1:81
    v_mfma_f32_16x16x32_bf16 v[48:51], v[68:71], v[108:111], v[48:51]
    v_mfma_f32_16x16x32_bf16 v[48:51], v[72:75], v[104:107], v[48:51]
    ds_read2_b32 v[138:139], v237 offset0:82 offset1:83
    v_mfma_f32_16x16x32_bf16 v[48:51], v[76:79], v[100:103], v[48:51]
    ds_read_b128 v[172:175], v245 offset:12288
    v_mfma_f32_16x16x32_bf16 v[48:51], v[80:83], v[96:99], v[48:51]
    ds_read2_b32 v[140:141], v237 offset0:208 offset1:209
    v_mfma_f32_16x16x32_bf16 v[52:55], v[84:87], v[96:99], v[52:55]
    ds_read2_b32 v[142:143], v237 offset0:210 offset1:211
    v_mfma_f32_16x16x32_bf16 v[52:55], v[80:83], v[100:103], v[52:55]
    ds_read_b128 v[176:179], v245 offset:16384
    v_mfma_f32_16x16x32_bf16 v[52:55], v[76:79], v[104:107], v[52:55]
    ds_read2_b32 v[144:145], v238 offset0:80 offset1:81
    v_mfma_f32_16x16x32_bf16 v[52:55], v[72:75], v[108:111], v[52:55]
    ds_read2_b32 v[146:147], v238 offset0:82 offset1:83
    v_mfma_f32_16x16x32_bf16 v[52:55], v[68:71], v[112:115], v[52:55]
    s_add_u32 m0, s73, 147456
    ds_read_b128 v[180:183], v245 offset:20480
    v_mfma_f32_16x16x32_bf16 v[52:55], v[64:67], v[116:119], v[52:55]
    buffer_load_dwordx4 v5, s[52:55], s14 offen offset:1024 lds
    ds_read2_b32 v[148:149], v238 offset0:208 offset1:209
    v_mfma_f32_16x16x32_bf16 v[56:59], v[64:67], v[120:123], v[56:59]
    ds_read2_b32 v[150:151], v238 offset0:210 offset1:211
    v_mfma_f32_16x16x32_bf16 v[56:59], v[68:71], v[116:119], v[56:59]
    ds_read_b128 v[184:187], v245 offset:24576
    v_mfma_f32_16x16x32_bf16 v[56:59], v[72:75], v[112:115], v[56:59]
    ds_read2_b32 v[152:153], v239 offset0:80 offset1:81
    v_mfma_f32_16x16x32_bf16 v[56:59], v[76:79], v[108:111], v[56:59]
    ds_read2_b32 v[154:155], v239 offset0:82 offset1:83
    v_mfma_f32_16x16x32_bf16 v[56:59], v[80:83], v[104:107], v[56:59]
    ds_read_b128 v[188:191], v245 offset:28672
    s_waitcnt vmcnt(6)
    s_barrier
    v_mfma_f32_16x16x32_bf16 v[56:59], v[84:87], v[100:103], v[56:59]
    ds_read2_b32 v[156:157], v239 offset0:208 offset1:209
    v_add_u32 v10, -131072, v10
    v_mfma_f32_16x16x32_bf16 v[56:59], v[88:91], v[96:99], v[56:59]
    ds_read_b64_tr_b16 a[208:209], v10 offset:0
    v_mfma_f32_16x16x32_bf16 v[60:63], v[92:95], v[96:99], v[60:63]
    ds_read_b64_tr_b16 a[210:211], v10 offset:2048
    v_mfma_f32_16x16x32_bf16 v[60:63], v[88:91], v[100:103], v[60:63]
    ds_read_b64_tr_b16 a[216:217], v10 offset:4096
    v_mfma_f32_16x16x32_bf16 v[60:63], v[84:87], v[104:107], v[60:63]
    ds_read2_b32 v[158:159], v239 offset0:210 offset1:211
    v_mfma_f32_16x16x32_bf16 v[60:63], v[80:83], v[108:111], v[60:63]
    ds_read_b64_tr_b16 a[218:219], v10 offset:6144
    s_add_u32 m0, s73, 147456
    v_mfma_f32_16x16x32_bf16 v[60:63], v[76:79], v[112:115], v[60:63]
    v_add_u32 v11, -131072, v11
    buffer_load_dwordx4 v6, s[52:55], s14 offen offset:2048 lds
    v_mfma_f32_16x16x32_bf16 v[60:63], v[72:75], v[116:119], v[60:63]
    ds_read_b64_tr_b16 a[212:213], v11 offset:0
    v_mfma_f32_16x16x32_bf16 v[60:63], v[68:71], v[120:123], v[60:63]
    ds_read_b64_tr_b16 a[214:215], v11 offset:2048
    v_mfma_f32_16x16x32_bf16 v[60:63], v[64:67], v[124:127], v[60:63]
    ds_read_b64_tr_b16 a[220:221], v11 offset:4096
    s_waitcnt lgkmcnt(15)
    v_mfma_f32_16x16x32_bf16 v[32:35], v[128:131], v[160:163], v[32:35]
    ds_read_b64_tr_b16 a[222:223], v11 offset:6144
    v_mfma_f32_16x16x32_bf16 v[36:39], v[132:135], v[160:163], v[36:39]
    ds_read_b128 v[96:99], v246 offset:0
    v_mfma_f32_16x16x32_bf16 v[36:39], v[128:131], v[164:167], v[36:39]
    ds_read2_b32 v[64:65], v236 offset0:96 offset1:97
    v_mfma_f32_16x16x32_bf16 v[40:43], v[128:131], v[168:171], v[40:43]
    ds_read2_b32 v[66:67], v236 offset0:98 offset1:99
    v_mfma_f32_16x16x32_bf16 v[40:43], v[132:135], v[164:167], v[40:43]
    v_mfma_f32_16x16x32_bf16 v[40:43], v[136:139], v[160:163], v[40:43]
    ds_read_b128 v[100:103], v246 offset:4096
    v_mfma_f32_16x16x32_bf16 v[44:47], v[140:143], v[160:163], v[44:47]
    ds_read2_b32 v[68:69], v236 offset0:224 offset1:225
    v_mfma_f32_16x16x32_bf16 v[44:47], v[136:139], v[164:167], v[44:47]
    s_add_u32 m0, s73, 147456
    v_mfma_f32_16x16x32_bf16 v[44:47], v[132:135], v[168:171], v[44:47]
    buffer_load_dwordx4 v7, s[52:55], s14 offen offset:3072 lds
    ds_read2_b32 v[70:71], v236 offset0:226 offset1:227
    v_mfma_f32_16x16x32_bf16 v[44:47], v[128:131], v[172:175], v[44:47]
    ds_read_b128 v[104:107], v246 offset:8192
    s_waitcnt lgkmcnt(12)
    v_mfma_f32_16x16x32_bf16 v[48:51], v[128:131], v[176:179], v[48:51]
    ds_read2_b32 v[72:73], v237 offset0:96 offset1:97
    v_mfma_f32_16x16x32_bf16 v[48:51], v[132:135], v[172:175], v[48:51]
    v_mfma_f32_16x16x32_bf16 v[48:51], v[136:139], v[168:171], v[48:51]
    ds_read2_b32 v[74:75], v237 offset0:98 offset1:99
    v_mfma_f32_16x16x32_bf16 v[48:51], v[140:143], v[164:167], v[48:51]
    ds_read_b128 v[108:111], v246 offset:12288
    v_mfma_f32_16x16x32_bf16 v[48:51], v[144:147], v[160:163], v[48:51]
    s_waitcnt lgkmcnt(10)
    s_barrier
    v_mfma_f32_16x16x32_bf16 v[52:55], v[148:151], v[160:163], v[52:55]
    ds_read2_b32 v[76:77], v237 offset0:224 offset1:225
    v_mfma_f32_16x16x32_bf16 v[52:55], v[144:147], v[164:167], v[52:55]
    ds_read2_b32 v[78:79], v237 offset0:226 offset1:227
    v_mfma_f32_16x16x32_bf16 v[52:55], v[140:143], v[168:171], v[52:55]
    v_mfma_f32_16x16x32_bf16 v[52:55], v[136:139], v[172:175], v[52:55]
    s_lshl_b32 s14, s100, 18
    ds_read_b128 v[112:115], v246 offset:16384
    v_mfma_f32_16x16x32_bf16 v[52:55], v[132:135], v[176:179], v[52:55]
    s_add_u32 m0, s73, 0
    ds_read2_b32 v[80:81], v238 offset0:96 offset1:97
    v_mfma_f32_16x16x32_bf16 v[52:55], v[128:131], v[180:183], v[52:55]
    buffer_load_dwordx4 v4, s[52:55], s14 offen offset:0 lds
    v_mfma_f32_16x16x32_bf16 v[56:59], v[128:131], v[184:187], v[56:59]
    ds_read2_b32 v[82:83], v238 offset0:98 offset1:99
    v_mfma_f32_16x16x32_bf16 v[56:59], v[132:135], v[180:183], v[56:59]
    ds_read_b128 v[116:119], v246 offset:20480
    v_mfma_f32_16x16x32_bf16 v[56:59], v[136:139], v[176:179], v[56:59]
    v_mfma_f32_16x16x32_bf16 v[56:59], v[140:143], v[172:175], v[56:59]
    ds_read2_b32 v[84:85], v238 offset0:224 offset1:225
    v_mfma_f32_16x16x32_bf16 v[56:59], v[144:147], v[168:171], v[56:59]
    ds_read2_b32 v[86:87], v238 offset0:226 offset1:227
    v_mfma_f32_16x16x32_bf16 v[56:59], v[148:151], v[164:167], v[56:59]
    ds_read_b128 v[120:123], v246 offset:24576
    v_mfma_f32_16x16x32_bf16 v[56:59], v[152:155], v[160:163], v[56:59]
    v_mfma_f32_16x16x32_bf16 v[60:63], v[156:159], v[160:163], v[60:63]
    ds_read2_b32 v[88:89], v239 offset0:96 offset1:97
    v_mfma_f32_16x16x32_bf16 v[60:63], v[152:155], v[164:167], v[60:63]
    s_add_u32 m0, s73, 0
    ds_read2_b32 v[90:91], v239 offset0:98 offset1:99
    v_mfma_f32_16x16x32_bf16 v[60:63], v[148:151], v[168:171], v[60:63]
    buffer_load_dwordx4 v5, s[52:55], s14 offen offset:1024 lds
    v_mfma_f32_16x16x32_bf16 v[60:63], v[144:147], v[172:175], v[60:63]
    ds_read_b128 v[124:127], v246 offset:28672
    v_mfma_f32_16x16x32_bf16 v[60:63], v[140:143], v[176:179], v[60:63]
    ds_read2_b32 v[92:93], v239 offset0:224 offset1:225
    v_mfma_f32_16x16x32_bf16 v[60:63], v[136:139], v[180:183], v[60:63]
    v_mfma_f32_16x16x32_bf16 v[60:63], v[132:135], v[184:187], v[60:63]
    ds_read2_b32 v[94:95], v239 offset0:226 offset1:227
    v_mfma_f32_16x16x32_bf16 v[60:63], v[128:131], v[188:191], v[60:63]
    s_waitcnt lgkmcnt(12)
    v_mfma_f32_16x16x32_bf16 v[32:35], v[64:67], v[96:99], v[32:35]
    ds_read_b128 v[160:163], v247 offset:0
    s_waitcnt vmcnt(6)
    s_barrier
    v_mfma_f32_16x16x32_bf16 v[36:39], v[68:71], v[96:99], v[36:39]
    ds_read_b64_tr_b16 a[224:225], v10 offset:16384
    s_bfe_u32 s4, s2, 0x20003
    v_mfma_f32_16x16x32_bf16 v[36:39], v[64:67], v[100:103], v[36:39]
    ds_read_b64_tr_b16 a[226:227], v10 offset:18432
    ds_read_b128 v[164:167], v247 offset:4096
    v_mfma_f32_16x16x32_bf16 v[40:43], v[64:67], v[104:107], v[40:43]
    s_lshl2_add_u32 s4, s72, s4
    ds_read_b128 v[168:171], v247 offset:8192
    v_mfma_f32_16x16x32_bf16 v[40:43], v[68:71], v[100:103], v[40:43]
    ds_read_b64_tr_b16 a[232:233], v10 offset:20480
    s_add_u32 m0, s73, 0
    ds_read_b128 v[172:175], v247 offset:12288
    v_mfma_f32_16x16x32_bf16 v[40:43], v[72:75], v[96:99], v[40:43]
    ds_read_b64_tr_b16 a[234:235], v10 offset:22528
    buffer_load_dwordx4 v6, s[52:55], s14 offen offset:2048 lds
    s_lshl_b32 s4, s4, 3
    v_mfma_f32_16x16x32_bf16 v[44:47], v[76:79], v[96:99], v[44:47]
    ds_read_b128 v[176:179], v247 offset:16384
    v_mfma_f32_16x16x32_bf16 v[44:47], v[72:75], v[100:103], v[44:47]
    ds_read_b64_tr_b16 a[228:229], v11 offset:16384
    s_lshr_b32 s5, s2, 4
    ds_read_b128 v[180:183], v247 offset:20480
    v_mfma_f32_16x16x32_bf16 v[44:47], v[68:71], v[104:107], v[44:47]
    ds_read_b64_tr_b16 a[230:231], v11 offset:18432
    v_mfma_f32_16x16x32_bf16 v[44:47], v[64:67], v[108:111], v[44:47]
    s_and_b32 s5, s5, 6
    ds_read_b128 v[184:187], v247 offset:24576
    s_waitcnt lgkmcnt(13)
    v_mfma_f32_16x16x32_bf16 v[48:51], v[64:67], v[112:115], v[48:51]
    ds_read_b64_tr_b16 a[236:237], v11 offset:20480
    ds_read_b128 v[188:191], v247 offset:28672
    v_mfma_f32_16x16x32_bf16 v[48:51], v[68:71], v[108:111], v[48:51]
    ds_read_b64_tr_b16 a[238:239], v11 offset:22528
    s_add_u32 s4, s4, s5
    v_mfma_f32_16x16x32_bf16 v[48:51], v[72:75], v[104:107], v[48:51]
    ds_read2_b32 v[128:129], v236 offset0:112 offset1:113
    v_mfma_f32_16x16x32_bf16 v[48:51], v[76:79], v[100:103], v[48:51]
    s_and_b32 s5, s2, 1
    ds_read2_b32 v[130:131], v236 offset0:114 offset1:115
    v_mfma_f32_16x16x32_bf16 v[48:51], v[80:83], v[96:99], v[48:51]
    ds_read2_b32 v[132:133], v236 offset0:240 offset1:241
    v_mfma_f32_16x16x32_bf16 v[52:55], v[84:87], v[96:99], v[52:55]
    s_add_u32 m0, s73, 0
    ds_read2_b32 v[134:135], v236 offset0:242 offset1:243
    s_add_u32 s4, s4, s5
    v_mfma_f32_16x16x32_bf16 v[52:55], v[80:83], v[100:103], v[52:55]
    buffer_load_dwordx4 v7, s[52:55], s14 offen offset:3072 lds
    ds_read2_b32 v[136:137], v237 offset0:112 offset1:113
    v_mfma_f32_16x16x32_bf16 v[52:55], v[76:79], v[104:107], v[52:55]
    s_lshl_b32 s4, s4, 7
    ds_read2_b32 v[138:139], v237 offset0:114 offset1:115
    v_mfma_f32_16x16x32_bf16 v[52:55], v[72:75], v[108:111], v[52:55]
    s_add_u32 s4, s4, 12566528
    ds_read2_b32 v[140:141], v237 offset0:240 offset1:241
    s_add_u32 s6, s12, 4767744
    v_mfma_f32_16x16x32_bf16 v[52:55], v[68:71], v[112:115], v[52:55]
    ds_read2_b32 v[142:143], v237 offset0:242 offset1:243
    v_mfma_f32_16x16x32_bf16 v[52:55], v[64:67], v[116:119], v[52:55]
    ds_read2_b32 v[144:145], v238 offset0:112 offset1:113
    v_lshl_add_u32 v28, v2, 2, s4
    v_mfma_f32_16x16x32_bf16 v[56:59], v[64:67], v[120:123], v[56:59]
    s_waitcnt lgkmcnt(9)
    s_barrier
    v_mfma_f32_16x16x32_bf16 v[56:59], v[68:71], v[116:119], v[56:59]
    ds_read2_b32 v[146:147], v238 offset0:114 offset1:115
    s_cmp_eq_u32 s3, 0
    s_cselect_b32 s4, 18, 0
    v_mfma_f32_16x16x32_bf16 v[56:59], v[72:75], v[112:115], v[56:59]
    ds_read2_b32 v[148:149], v238 offset0:240 offset1:241
    v_mfma_f32_16x16x32_bf16 v[56:59], v[76:79], v[108:111], v[56:59]
    ds_read2_b32 v[150:151], v238 offset0:242 offset1:243
    v_cmp_gt_u32 vcc, s4, v2
    v_mfma_f32_16x16x32_bf16 v[56:59], v[80:83], v[104:107], v[56:59]
    s_lshl_b32 s14, s101, 18
    ds_read2_b32 v[152:153], v239 offset0:112 offset1:113
    v_mfma_f32_16x16x32_bf16 v[56:59], v[84:87], v[100:103], v[56:59]
    ds_read2_b32 v[154:155], v239 offset0:114 offset1:115
    s_add_u32 m0, s73, 16384
    v_mov_b32 v13, 0x40000000
    v_mfma_f32_16x16x32_bf16 v[56:59], v[88:91], v[96:99], v[56:59]
    buffer_load_dwordx4 v4, s[52:55], s14 offen offset:0 lds
    ds_read2_b32 v[156:157], v239 offset0:240 offset1:241
    v_mfma_f32_16x16x32_bf16 v[60:63], v[92:95], v[96:99], v[60:63]
    ds_read2_b32 v[158:159], v239 offset0:242 offset1:243
    v_cndmask_b32 v28, v13, v28, vcc
    v_mfma_f32_16x16x32_bf16 v[60:63], v[88:91], v[100:103], v[60:63]
    v_mfma_f32_16x16x32_bf16 v[60:63], v[84:87], v[104:107], v[60:63]
    v_mov_b32 v13, s68
    v_mfma_f32_16x16x32_bf16 v[60:63], v[80:83], v[108:111], v[60:63]
    v_mfma_f32_16x16x32_bf16 v[60:63], v[76:79], v[112:115], v[60:63]
    v_cndmask_b32 v13, 0, v13, vcc
    v_mfma_f32_16x16x32_bf16 v[60:63], v[72:75], v[116:119], v[60:63]
    v_mfma_f32_16x16x32_bf16 v[60:63], v[68:71], v[120:123], v[60:63]
    v_mfma_f32_16x16x32_bf16 v[60:63], v[64:67], v[124:127], v[60:63]
    s_waitcnt lgkmcnt(0)
    v_mfma_f32_16x16x32_bf16 v[60:63], v[128:131], v[188:191], v[60:63]
    v_mfma_f32_16x16x32_bf16 v[60:63], v[132:135], v[184:187], v[60:63]
    s_add_u32 m0, s73, 16384
    v_mfma_f32_16x16x32_bf16 v[60:63], v[136:139], v[180:183], v[60:63]
    buffer_load_dwordx4 v5, s[52:55], s14 offen offset:1024 lds
    v_mfma_f32_16x16x32_bf16 v[60:63], v[140:143], v[176:179], v[60:63]
    v_mfma_f32_16x16x32_bf16 v[60:63], v[144:147], v[172:175], v[60:63]
    v_mfma_f32_16x16x32_bf16 v[60:63], v[148:151], v[168:171], v[60:63]
    v_mfma_f32_16x16x32_bf16 v[60:63], v[152:155], v[164:167], v[60:63]
    v_mfma_f32_16x16x32_bf16 v[60:63], v[156:159], v[160:163], v[60:63]
    v_mfma_f32_16x16x32_bf16 v[56:59], v[128:131], v[184:187], v[56:59]
    v_mfma_f32_16x16x32_bf16 v[56:59], v[132:135], v[180:183], v[56:59]
    v_mfma_f32_16x16x32_bf16 v[56:59], v[136:139], v[176:179], v[56:59]
    v_mfma_f32_16x16x32_bf16 v[56:59], v[140:143], v[172:175], v[56:59]
    s_add_u32 m0, s73, 16384
    v_mfma_f32_16x16x32_bf16 v[56:59], v[144:147], v[168:171], v[56:59]
    buffer_load_dwordx4 v6, s[52:55], s14 offen offset:2048 lds
    v_mfma_f32_16x16x32_bf16 v[56:59], v[148:151], v[164:167], v[56:59]
    v_cvt_pk_bf16_f32 v206, v60, v61
    v_mfma_f32_16x16x32_bf16 v[56:59], v[152:155], v[160:163], v[56:59]
    s_waitcnt vmcnt(7)
    s_barrier
    v_mfma_f32_16x16x32_bf16 v[52:55], v[128:131], v[180:183], v[52:55]
    v_add_u32 v10, 131072, v10
    v_mfma_f32_16x16x32_bf16 v[52:55], v[132:135], v[176:179], v[52:55]
    ds_read_b64_tr_b16 a[240:241], v10 offset:16384
    v_cvt_pk_bf16_f32 v207, v62, v63
    v_mfma_f32_16x16x32_bf16 v[52:55], v[136:139], v[172:175], v[52:55]
    ds_read_b64_tr_b16 a[242:243], v10 offset:18432
    v_mfma_f32_16x16x32_bf16 v[52:55], v[140:143], v[168:171], v[52:55]
    buffer_store_dwordx2 v[206:207], v8, s[44:47], s6 offen offset:3584 sc1
    v_mfma_f32_16x16x32_bf16 v[52:55], v[144:147], v[164:167], v[52:55]
    ds_read_b64_tr_b16 a[248:249], v10 offset:20480
    v_mfma_f32_16x16x32_bf16 v[52:55], v[148:151], v[160:163], v[52:55]
    ds_read_b64_tr_b16 a[250:251], v10 offset:22528
    v_mfma_f32_16x16x32_bf16 v[48:51], v[128:131], v[176:179], v[48:51]
    v_add_u32 v11, 131072, v11
    v_cvt_pk_bf16_f32 v204, v56, v57
    v_mfma_f32_16x16x32_bf16 v[48:51], v[132:135], v[172:175], v[48:51]
    ds_read_b64_tr_b16 a[244:245], v11 offset:16384
    s_add_u32 m0, s73, 16384
    v_mfma_f32_16x16x32_bf16 v[48:51], v[136:139], v[168:171], v[48:51]
    ds_read_b64_tr_b16 a[246:247], v11 offset:18432
    buffer_load_dwordx4 v7, s[52:55], s14 offen offset:3072 lds
    v_mfma_f32_16x16x32_bf16 v[48:51], v[140:143], v[164:167], v[48:51]
L_pl_X_6:
    s_cbranch_execz L_wret
    v_cvt_pk_bf16_f32 v205, v58, v59
    v_mfma_f32_16x16x32_bf16 v[48:51], v[144:147], v[160:163], v[48:51]
    ds_read_b64_tr_b16 a[252:253], v11 offset:20480
    v_mfma_f32_16x16x32_bf16 v[44:47], v[128:131], v[172:175], v[44:47]
    buffer_store_dwordx2 v[204:205], v8, s[44:47], s6 offen offset:3072 sc1
    ds_read_b64_tr_b16 a[254:255], v11 offset:22528
    v_mfma_f32_16x16x32_bf16 v[44:47], v[132:135], v[168:171], v[44:47]
    v_mfma_f32_16x16x32_bf16 v[44:47], v[136:139], v[164:167], v[44:47]
    v_mfma_f32_16x16x32_bf16 v[44:47], v[140:143], v[160:163], v[44:47]
    v_cvt_pk_bf16_f32 v202, v52, v53
    v_mfma_f32_16x16x32_bf16 v[40:43], v[128:131], v[168:171], v[40:43]
    v_mfma_f32_16x16x32_bf16 v[40:43], v[132:135], v[164:167], v[40:43]
    v_mfma_f32_16x16x32_bf16 v[40:43], v[136:139], v[160:163], v[40:43]
    v_cvt_pk_bf16_f32 v203, v54, v55
    v_mfma_f32_16x16x32_bf16 v[36:39], v[128:131], v[164:167], v[36:39]
    v_mfma_f32_16x16x32_bf16 v[36:39], v[132:135], v[160:163], v[36:39]
    buffer_store_dwordx2 v[202:203], v8, s[44:47], s6 offen offset:2560 sc1
    v_mfma_f32_16x16x32_bf16 v[32:35], v[128:131], v[160:163], v[32:35]
    v_mov_b32 v29, 0
    buffer_atomic_add v29, v28, s[44:47], 0 offen sc0 sc1
    v_cvt_pk_bf16_f32 v200, v48, v49
    v_cvt_pk_bf16_f32 v201, v50, v51
    buffer_store_dwordx2 v[200:201], v8, s[44:47], s6 offen offset:2048 sc1
    v_cvt_pk_bf16_f32 v198, v44, v45
    v_cvt_pk_bf16_f32 v199, v46, v47
    buffer_store_dwordx2 v[198:199], v8, s[44:47], s6 offen offset:1536 sc1
    v_cvt_pk_bf16_f32 v196, v40, v41
    v_cvt_pk_bf16_f32 v197, v42, v43
    buffer_store_dwordx2 v[196:197], v8, s[44:47], s6 offen offset:1024 sc1
    v_cvt_pk_bf16_f32 v194, v36, v37
    v_cvt_pk_bf16_f32 v195, v38, v39
    buffer_store_dwordx2 v[194:195], v8, s[44:47], s6 offen offset:512 sc1
    v_cvt_pk_bf16_f32 v192, v32, v33
    v_cvt_pk_bf16_f32 v193, v34, v35
    buffer_store_dwordx2 v[192:193], v8, s[44:47], s6 offen offset:0 sc1
    v_add_u32 v10, -131072, v10
    v_add_u32 v11, -131072, v11
    s_waitcnt lgkmcnt(0)
    s_barrier
L_DX:
    s_waitcnt vmcnt(0)
    v_cmp_ne_u32 vcc, v13, v29
    s_cbranch_vccnz L_rs_p2X
L_ok_p2X:
    s_barrier
    s_add_u32 m0, s73, 97536
    s_nop 0
    buffer_load_dwordx4 v23, s[44:47], s18 offen offset:768 sc1 lds
    s_add_u32 m0, s73, 99328
    s_nop 0
    buffer_load_dwordx4 v20, s[44:47], s18 offen offset:0 sc1 lds
    s_add_u32 m0, s73, 99840
    s_nop 0
    buffer_load_dwordx4 v20, s[44:47], s18 offen offset:512 sc1 lds
    s_add_u32 m0, s73, 100608
    s_nop 0
    buffer_load_dwordx4 v23, s[44:47], s19 offen offset:768 sc1 lds
    s_add_u32 m0, s73, 114688
    s_nop 0
    buffer_load_dwordx4 v20, s[44:47], s19 offen offset:0 sc1 lds
    s_add_u32 m0, s73, 115200
    s_nop 0
    buffer_load_dwordx4 v20, s[44:47], s19 offen offset:512 sc1 lds
    s_add_u32 m0, s73, 115968
    s_nop 0
    buffer_load_dwordx4 v23, s[44:47], s20 offen offset:768 sc1 lds
    s_add_u32 m0, s73, 117760
    s_nop 0
    buffer_load_dwordx4 v20, s[44:47], s20 offen offset:0 sc1 lds
    s_mov_b32 s56, s16
    s_and_b32 s57, s17, 0xffff
    s_mov_b32 s58, 2359296
    s_mov_b32 s59, 0x20000
    s_mov_b32 s40, 18432
    s_mov_b32 s42, 12386304
    s_mov_b32 s64, s38
    s_and_b32 s65, s39, 0xffff
    s_mov_b32 s66, 2359296
    s_mov_b32 s67, 0x20000
    v_lshlrev_b32 v136, 4, v2
    s_mul_i32 s7, s72, 36
    s_bitcmp1_b32 s3, 0
    s_addc_u32 s7, s7, 0
    s_lshl_b32 s7, s7, 17
    v_subrev_u32 v184, s7, v4
    v_subrev_u32 v185, s7, v5
    s_bfe_u32 s4, s2, 0x20003
    s_mul_i32 s4, s4, 9
    s_lshl1_add_u32 s7, s72, s4
    s_and_b32 s8, s3, 1
    s_add_u32 s7, s7, s8
    s_lshl_b32 s37, s7, 16
    s_add_u32 s37, s37, 4718592
    s_add_u32 s4, s4, 8
    s_lshl_b32 s16, s4, 16
    s_add_u32 s16, s16, 4718592
    s_sub_u32 s4, s4, s7
    s_lshl_b32 s4, s4, 7
    s_lshl_b32 s7, s7, 7
    s_add_u32 s7, s7, 12582912
    v_bfe_u32 v24, v2, 2, 1
    v_mul_u32_u24 v24, s4, v24
    v_and_b32 v25, 3, v2
    v_lshl_add_u32 v24, v25, 2, v24
    v_add_u32 v188, s7, v24
    s_lshl2_add_u32 s7, s2, s3
    s_mul_i32 s8, s7, 3072
    s_add_u32 s34, s8, 40828928
    s_add_u32 s11, s8, 43974656
    s_add_u32 s12, s8, 47120384
    s_lshl_b32 s35, s7, 12
    s_add_u32 s35, s35, 50266112
    s_xor_b32 s8, s7, 8
    s_mul_i32 s8, s8, 3072
    s_add_u32 s30, s8, 40828928
    s_xor_b32 s8, s7, 16
    s_mul_i32 s8, s8, 3072
    s_add_u32 s15, s8, 43974656
    s_xor_b32 s8, s7, 24
    s_mul_i32 s8, s8, 3072
    s_add_u32 s31, s8, 47120384
    s_andn2_b32 s7, s7, 24
    s_lshl3_add_u32 s7, s3, s7
    s_lshl2_add_u32 s8, s7, s72
    s_lshl_b32 s8, s8, 10
    s_add_u32 s32, s8, 50266112
    s_xor_b32 s8, s8, 4096
    s_add_u32 s33, s8, 50266112
    s_xor_b32 s8, s3, s72
    s_cmp_lt_u32 s8, 2
    s_cselect_b32 s35, s35, 0x40000000
    s_cselect_b32 s16, s16, 0x40000000
    s_cselect_b32 s36, s68, 0
    s_mov_b32 s38, 0xbfb8aa3b
    s_and_b32 s8, s8, 1
    s_mul_i32 s41, s8, 96
    s_and_b32 s43, s73, 4096
    v_lshlrev_b32 v24, 10, v2
    v_add_u32 v24, s35, v24
    s_add_u32 s7, s34, 2048
    v_mov_b32 v25, s36
    v_cmp_gt_u32 vcc, 4, v2
    s_nop 1
    v_cndmask_b32 v138, 0, v25, vcc
    v_mov_b32 v25, 0x40000000
    v_cndmask_b32 v137, v25, v24, vcc
    v_writelane_b32 v137, s7, 4
    v_writelane_b32 v138, s68, 4
    v_min_u32 v139, 1, v2
    v_lshlrev_b32 v139, 30, v139
    v_mov_b32 v140, 0
    v_writelane_b32 v140, s68, 0
    v_mov_b32 v195, s68
    v_mov_b32 v199, s68
    v_mov_b32 v202, s68
    v_mov_b32 v203, s68
    s_waitcnt vmcnt(4)
    s_barrier
    ds_read_b128 v[104:107], v14 offset:0
    ds_read_b128 v[108:111], v14 offset:4096
    ds_read_b128 v[112:115], v14 offset:8192
    ds_read_b128 v[116:119], v14 offset:12288
    s_waitcnt lgkmcnt(2)
    v_mfma_f32_16x16x32_bf16 v[32:35], v[104:107], a[0:3], 0
    s_add_u32 m0, s73, 130560
    s_sub_u32 s4, s75, 216
    s_lshl_b32 s7, s4, 7
    v_mfma_f32_16x16x32_bf16 v[32:35], v[108:111], a[8:11], v[32:35]
    buffer_load_dwordx4 v20, s[44:47], s20 offen offset:512 sc1 lds
    s_waitcnt lgkmcnt(0)
    v_mfma_f32_16x16x32_bf16 v[32:35], v[112:115], a[16:19], v[32:35]
    ds_read_b128 v[120:123], v14 offset:1024
    s_lshl2_add_u32 s7, s3, s7
    s_add_u32 s7, s7, 12582912
    v_mfma_f32_16x16x32_bf16 v[32:35], v[116:119], a[24:27], v[32:35]
    ds_read_b128 v[124:127], v14 offset:5120
    v_mfma_f32_16x16x32_bf16 v[36:39], v[116:119], a[28:31], 0
    ds_read_b128 v[128:131], v14 offset:9216
    s_cmp_lt_u32 s4, 36
    s_cselect_b32 s7, s7, 0x40000000
    v_mfma_f32_16x16x32_bf16 v[36:39], v[112:115], a[20:23], v[36:39]
    ds_read_b128 v[132:135], v14 offset:13312
    v_min_u32 v28, 1, v2
    v_mfma_f32_16x16x32_bf16 v[36:39], v[108:111], a[12:15], v[36:39]
    s_add_u32 m0, s73, 131328
    v_lshlrev_b32 v28, 30, v28
    v_mov_b32 v29, s68
    v_mfma_f32_16x16x32_bf16 v[36:39], v[104:107], a[4:7], v[36:39]
    buffer_load_dwordx4 v23, s[44:47], s21 offen offset:768 sc1 lds
    s_waitcnt lgkmcnt(2)
    v_mfma_f32_16x16x32_bf16 v[44:47], v[120:123], a[4:7], 0
    buffer_store_dword v29, v28, s[44:47], s7 offen sc1
    s_add_u32 m0, s73, 133120
    v_mfma_f32_16x16x32_bf16 v[44:47], v[124:127], a[12:15], v[44:47]
    buffer_load_dwordx4 v20, s[44:47], s21 offen offset:0 sc1 lds
    s_waitcnt lgkmcnt(0)
    v_mfma_f32_16x16x32_bf16 v[44:47], v[128:131], a[20:23], v[44:47]
    ds_read_b128 v[104:107], v14 offset:2048
    v_mfma_f32_16x16x32_bf16 v[44:47], v[132:135], a[28:31], v[44:47]
    ds_read_b128 v[108:111], v14 offset:6144
    v_mfma_f32_16x16x32_bf16 v[40:43], v[132:135], a[24:27], 0
    ds_read_b128 v[112:115], v14 offset:10240
    v_mfma_f32_16x16x32_bf16 v[40:43], v[128:131], a[16:19], v[40:43]
    ds_read_b128 v[116:119], v14 offset:14336
    v_mfma_f32_16x16x32_bf16 v[40:43], v[124:127], a[8:11], v[40:43]
    s_add_u32 m0, s73, 133632
    v_mfma_f32_16x16x32_bf16 v[40:43], v[120:123], a[0:3], v[40:43]
    buffer_load_dwordx4 v20, s[44:47], s21 offen offset:512 sc1 lds
    s_waitcnt lgkmcnt(2)
    v_mfma_f32_16x16x32_bf16 v[48:51], v[104:107], a[0:3], 0
    s_add_u32 m0, s73, 146688
    v_mfma_f32_16x16x32_bf16 v[48:51], v[108:111], a[8:11], v[48:51]
    buffer_load_dwordx4 v23, s[44:47], s22 offen offset:768 sc1 lds
    s_waitcnt lgkmcnt(0)
    v_mfma_f32_16x16x32_bf16 v[48:51], v[112:115], a[16:19], v[48:51]
    ds_read_b128 v[120:123], v14 offset:3072
    v_mfma_f32_16x16x32_bf16 v[48:51], v[116:119], a[24:27], v[48:51]
    ds_read_b128 v[124:127], v14 offset:7168
    v_mfma_f32_16x16x32_bf16 v[52:55], v[116:119], a[28:31], 0
    ds_read_b128 v[128:131], v14 offset:11264
    v_mfma_f32_16x16x32_bf16 v[52:55], v[112:115], a[20:23], v[52:55]
    ds_read_b128 v[132:135], v14 offset:15360
    v_mfma_f32_16x16x32_bf16 v[52:55], v[108:111], a[12:15], v[52:55]
    s_add_u32 m0, s73, 148480
    v_mfma_f32_16x16x32_bf16 v[52:55], v[104:107], a[4:7], v[52:55]
    buffer_load_dwordx4 v20, s[44:47], s22 offen offset:0 sc1 lds
    s_waitcnt lgkmcnt(2)
    v_mfma_f32_16x16x32_bf16 v[36:39], v[120:123], a[36:39], v[36:39]
    s_add_u32 m0, s73, 148992
    v_mfma_f32_16x16x32_bf16 v[36:39], v[124:127], a[44:47], v[36:39]
    buffer_load_dwordx4 v20, s[44:47], s22 offen offset:512 sc1 lds
    s_waitcnt lgkmcnt(0)
    v_mfma_f32_16x16x32_bf16 v[36:39], v[128:131], a[52:55], v[36:39]
    s_waitcnt vmcnt(8)
    s_barrier
    v_mfma_f32_16x16x32_bf16 v[36:39], v[132:135], a[60:63], v[36:39]
    ds_read_b128 v[104:107], v14 offset:16384
    v_mfma_f32_16x16x32_bf16 v[32:35], v[132:135], a[56:59], v[32:35]
    ds_read_b128 v[108:111], v14 offset:20480
    v_mfma_f32_16x16x32_bf16 v[32:35], v[128:131], a[48:51], v[32:35]
    ds_read_b128 v[112:115], v14 offset:24576
    v_mfma_f32_16x16x32_bf16 v[32:35], v[124:127], a[40:43], v[32:35]
    ds_read_b128 v[116:119], v14 offset:28672
    s_add_u32 m0, s73, 149760
    v_mfma_f32_16x16x32_bf16 v[32:35], v[120:123], a[32:35], v[32:35]
    buffer_load_dwordx4 v23, s[44:47], s23 offen offset:768 sc1 lds
    ds_read_b64_tr_b16 v[220:221], v10 offset:0
    s_waitcnt lgkmcnt(3)
    v_mfma_f32_16x16x32_bf16 v[40:43], v[104:107], a[32:35], v[40:43]
    s_add_u32 m0, s73, 98304
    ds_read_b64_tr_b16 v[222:223], v10 offset:2048
    v_mfma_f32_16x16x32_bf16 v[40:43], v[108:111], a[40:43], v[40:43]
    buffer_load_dwordx4 v20, s[44:47], s23 offen offset:0 sc1 lds
    s_waitcnt lgkmcnt(2)
    v_mfma_f32_16x16x32_bf16 v[40:43], v[112:115], a[48:51], v[40:43]
    ds_read_b128 v[120:123], v14 offset:17408
    v_mfma_f32_16x16x32_bf16 v[40:43], v[116:119], a[56:59], v[40:43]
    ds_read_b128 v[124:127], v14 offset:21504
    v_mfma_f32_16x16x32_bf16 v[44:47], v[116:119], a[60:63], v[44:47]
    ds_read_b128 v[128:131], v14 offset:25600
    v_mfma_f32_16x16x32_bf16 v[44:47], v[112:115], a[52:55], v[44:47]
    ds_read_b128 v[132:135], v14 offset:29696
    v_mfma_f32_16x16x32_bf16 v[44:47], v[108:111], a[44:47], v[44:47]
    s_add_u32 m0, s73, 98816
    ds_read_b64_tr_b16 v[228:229], v10 offset:4096
    v_mfma_f32_16x16x32_bf16 v[44:47], v[104:107], a[36:39], v[44:47]
    buffer_load_dwordx4 v20, s[44:47], s23 offen offset:512 sc1 lds
    s_waitcnt lgkmcnt(3)
    v_mfma_f32_16x16x32_bf16 v[52:55], v[120:123], a[36:39], v[52:55]
    s_add_u32 m0, s73, 99584
    ds_read_b64_tr_b16 v[230:231], v10 offset:6144
    v_mfma_f32_16x16x32_bf16 v[52:55], v[124:127], a[44:47], v[52:55]
    buffer_load_dwordx4 v23, s[44:47], s24 offen offset:768 sc1 lds
    s_waitcnt lgkmcnt(2)
    v_mfma_f32_16x16x32_bf16 v[52:55], v[128:131], a[52:55], v[52:55]
    ds_read_b128 v[104:107], v14 offset:18432
    v_mfma_f32_16x16x32_bf16 v[52:55], v[132:135], a[60:63], v[52:55]
    ds_read_b128 v[108:111], v14 offset:22528
    v_mfma_f32_16x16x32_bf16 v[48:51], v[132:135], a[56:59], v[48:51]
    ds_read_b128 v[112:115], v14 offset:26624
    v_mfma_f32_16x16x32_bf16 v[48:51], v[128:131], a[48:51], v[48:51]
    ds_read_b128 v[116:119], v14 offset:30720
    v_mfma_f32_16x16x32_bf16 v[48:51], v[124:127], a[40:43], v[48:51]
    s_add_u32 m0, s73, 101376
    ds_read_b64_tr_b16 v[224:225], v11 offset:0
    v_mfma_f32_16x16x32_bf16 v[48:51], v[120:123], a[32:35], v[48:51]
    buffer_load_dwordx4 v20, s[44:47], s24 offen offset:0 sc1 lds
    s_waitcnt lgkmcnt(3)
    v_mfma_f32_16x16x32_bf16 v[32:35], v[104:107], a[64:67], v[32:35]
    ds_read_b64_tr_b16 v[226:227], v11 offset:2048
    v_mfma_f32_16x16x32_bf16 v[32:35], v[108:111], a[72:75], v[32:35]
    s_waitcnt lgkmcnt(2)
    v_mfma_f32_16x16x32_bf16 v[32:35], v[112:115], a[80:83], v[32:35]
    ds_read_b128 v[120:123], v14 offset:19456
    v_mfma_f32_16x16x32_bf16 v[32:35], v[116:119], a[88:91], v[32:35]
    ds_read_b128 v[124:127], v14 offset:23552
    v_mfma_f32_16x16x32_bf16 v[36:39], v[116:119], a[92:95], v[36:39]
    ds_read_b128 v[128:131], v14 offset:27648
    v_mfma_f32_16x16x32_bf16 v[36:39], v[112:115], a[84:87], v[36:39]
    ds_read_b128 v[132:135], v14 offset:31744
    v_mfma_f32_16x16x32_bf16 v[36:39], v[108:111], a[76:79], v[36:39]
    ds_read_b64_tr_b16 v[232:233], v11 offset:4096
    v_mfma_f32_16x16x32_bf16 v[36:39], v[104:107], a[68:71], v[36:39]
    s_waitcnt lgkmcnt(3)
    v_mfma_f32_16x16x32_bf16 v[44:47], v[120:123], a[68:71], v[44:47]
    ds_read_b64_tr_b16 v[234:235], v11 offset:6144
    v_mfma_f32_16x16x32_bf16 v[44:47], v[124:127], a[76:79], v[44:47]
    s_waitcnt lgkmcnt(2)
    v_mfma_f32_16x16x32_bf16 v[44:47], v[128:131], a[84:87], v[44:47]
    s_waitcnt vmcnt(8) lgkmcnt(0)
    s_barrier
    v_mfma_f32_16x16x32_bf16 v[44:47], v[132:135], a[92:95], v[44:47]
    ds_read_b128 v[104:107], v14 offset:32768
    v_mfma_f32_16x16x32_bf16 v[40:43], v[132:135], a[88:91], v[40:43]
    ds_read_b128 v[108:111], v14 offset:36864
    v_mfma_f32_16x16x32_bf16 v[40:43], v[128:131], a[80:83], v[40:43]
    ds_read_b128 v[112:115], v14 offset:40960
    v_mfma_f32_16x16x32_bf16 v[40:43], v[124:127], a[72:75], v[40:43]
    ds_read_b128 v[116:119], v14 offset:45056
    v_mfma_f32_16x16x32_bf16 v[40:43], v[120:123], a[64:67], v[40:43]
    ds_read_b64_tr_b16 v[236:237], v10 offset:16384
    s_waitcnt lgkmcnt(3)
    v_mfma_f32_16x16x32_bf16 v[48:51], v[104:107], a[64:67], v[48:51]
    s_add_u32 m0, s73, 114176
    ds_read_b64_tr_b16 v[238:239], v10 offset:18432
    v_mfma_f32_16x16x32_bf16 v[48:51], v[108:111], a[72:75], v[48:51]
    buffer_load_dwordx4 v20, s[44:47], s24 offen offset:512 sc1 lds
    s_waitcnt lgkmcnt(2)
    v_mfma_f32_16x16x32_bf16 v[48:51], v[112:115], a[80:83], v[48:51]
    ds_read_b128 v[120:123], v14 offset:33792
    v_mfma_f32_16x16x32_bf16 v[48:51], v[116:119], a[88:91], v[48:51]
    ds_read_b128 v[124:127], v14 offset:37888
    v_lshrrev_b32 v30, 2, v26
    v_mfma_f32_16x16x32_bf16 v[52:55], v[116:119], a[92:95], v[52:55]
    ds_read_b128 v[128:131], v14 offset:41984
    v_mfma_f32_16x16x32_bf16 v[52:55], v[112:115], a[84:87], v[52:55]
    ds_read_b128 v[132:135], v14 offset:46080
    v_mfma_f32_16x16x32_bf16 v[52:55], v[108:111], a[76:79], v[52:55]
    s_add_u32 m0, s73, 114944
    ds_read_b64_tr_b16 v[244:245], v10 offset:20480
    v_mfma_f32_16x16x32_bf16 v[52:55], v[104:107], a[68:71], v[52:55]
    buffer_load_dwordx4 v23, s[44:47], s25 offen offset:768 sc1 lds
    s_waitcnt lgkmcnt(3)
    v_mfma_f32_16x16x32_bf16 v[36:39], v[120:123], a[100:103], v[36:39]
    s_add_u32 m0, s73, 116736
    ds_read_b64_tr_b16 v[246:247], v10 offset:22528
    v_mfma_f32_16x16x32_bf16 v[36:39], v[124:127], a[108:111], v[36:39]
    buffer_load_dwordx4 v20, s[44:47], s25 offen offset:0 sc1 lds
    s_waitcnt lgkmcnt(2)
    v_mfma_f32_16x16x32_bf16 v[36:39], v[128:131], a[116:119], v[36:39]
    ds_read_b128 v[104:107], v14 offset:34816
    v_lshrrev_b32 v31, 2, v18
    v_mfma_f32_16x16x32_bf16 v[36:39], v[132:135], a[124:127], v[36:39]
    ds_read_b128 v[108:111], v14 offset:38912
    v_mfma_f32_16x16x32_bf16 v[32:35], v[132:135], a[120:123], v[32:35]
    ds_read_b128 v[112:115], v14 offset:43008
    v_mfma_f32_16x16x32_bf16 v[32:35], v[128:131], a[112:115], v[32:35]
    ds_read_b128 v[116:119], v14 offset:47104
    v_mfma_f32_16x16x32_bf16 v[32:35], v[124:127], a[104:107], v[32:35]
    s_add_u32 m0, s73, 117248
    ds_read_b64_tr_b16 v[240:241], v11 offset:16384
    v_mfma_f32_16x16x32_bf16 v[32:35], v[120:123], a[96:99], v[32:35]
    buffer_load_dwordx4 v20, s[44:47], s25 offen offset:512 sc1 lds
    s_waitcnt lgkmcnt(3)
    v_mfma_f32_16x16x32_bf16 v[40:43], v[104:107], a[96:99], v[40:43]
    ds_read_b64_tr_b16 v[242:243], v11 offset:18432
    buffer_load_ushort v102, v30, s[60:63], 0 offen offset:0
    v_mfma_f32_16x16x32_bf16 v[40:43], v[108:111], a[104:107], v[40:43]
    s_waitcnt lgkmcnt(2)
    v_mfma_f32_16x16x32_bf16 v[40:43], v[112:115], a[112:115], v[40:43]
    ds_read_b128 v[120:123], v14 offset:35840
    v_mfma_f32_16x16x32_bf16 v[40:43], v[116:119], a[120:123], v[40:43]
    ds_read_b128 v[124:127], v14 offset:39936
    v_mfma_f32_16x16x32_bf16 v[44:47], v[116:119], a[124:127], v[44:47]
    ds_read_b128 v[128:131], v14 offset:44032
    v_mfma_f32_16x16x32_bf16 v[44:47], v[112:115], a[116:119], v[44:47]
    ds_read_b128 v[132:135], v14 offset:48128
    v_mfma_f32_16x16x32_bf16 v[44:47], v[108:111], a[108:111], v[44:47]
    ds_read_b64_tr_b16 v[248:249], v11 offset:20480
    buffer_load_ushort v103, v30, s[60:63], 0 offen offset:32
    v_mfma_f32_16x16x32_bf16 v[44:47], v[104:107], a[100:103], v[44:47]
    s_waitcnt lgkmcnt(3)
    v_mfma_f32_16x16x32_bf16 v[52:55], v[120:123], a[100:103], v[52:55]
    ds_read_b64_tr_b16 v[250:251], v11 offset:22528
    v_mfma_f32_16x16x32_bf16 v[52:55], v[124:127], a[108:111], v[52:55]
    s_waitcnt lgkmcnt(2)
    v_mfma_f32_16x16x32_bf16 v[52:55], v[128:131], a[116:119], v[52:55]
    s_waitcnt vmcnt(10) lgkmcnt(0)
    s_barrier
    v_mfma_f32_16x16x32_bf16 v[52:55], v[132:135], a[124:127], v[52:55]
    ds_read_b128 v[104:107], v14 offset:49152
    v_mfma_f32_16x16x32_bf16 v[48:51], v[132:135], a[120:123], v[48:51]
    ds_read_b128 v[108:111], v14 offset:53248
    buffer_load_ushort v27, v31, s[60:63], 0 offen offset:0
    v_mfma_f32_16x16x32_bf16 v[48:51], v[128:131], a[112:115], v[48:51]
    ds_read_b128 v[112:115], v14 offset:57344
    v_mfma_f32_16x16x32_bf16 v[48:51], v[124:127], a[104:107], v[48:51]
    ds_read_b128 v[116:119], v14 offset:61440
    v_mfma_f32_16x16x32_bf16 v[48:51], v[120:123], a[96:99], v[48:51]
    s_waitcnt lgkmcnt(2)
    v_mfma_f32_16x16x32_bf16 v[32:35], v[104:107], a[128:131], v[32:35]
    s_add_u32 m0, s73, 130304
    v_mfma_f32_16x16x32_bf16 v[32:35], v[108:111], a[136:139], v[32:35]
    buffer_load_dwordx4 v23, s[44:47], s26 offen offset:768 sc1 lds
    s_waitcnt lgkmcnt(0)
    v_mfma_f32_16x16x32_bf16 v[32:35], v[112:115], a[144:147], v[32:35]
    ds_read_b128 v[120:123], v14 offset:50176
    v_mfma_f32_16x16x32_bf16 v[32:35], v[116:119], a[152:155], v[32:35]
    ds_read_b128 v[124:127], v14 offset:54272
    v_mfma_f32_16x16x32_bf16 v[36:39], v[116:119], a[156:159], v[36:39]
    ds_read_b128 v[128:131], v14 offset:58368
    v_mfma_f32_16x16x32_bf16 v[36:39], v[112:115], a[148:151], v[36:39]
    ds_read_b128 v[132:135], v14 offset:62464
    v_mfma_f32_16x16x32_bf16 v[36:39], v[108:111], a[140:143], v[36:39]
    s_add_u32 m0, s73, 132096
    v_mfma_f32_16x16x32_bf16 v[36:39], v[104:107], a[132:135], v[36:39]
    buffer_load_dwordx4 v20, s[44:47], s26 offen offset:0 sc1 lds
    s_waitcnt lgkmcnt(2)
    v_mfma_f32_16x16x32_bf16 v[44:47], v[120:123], a[132:135], v[44:47]
    s_add_u32 m0, s73, 132608
    buffer_load_dwordx4 v[88:91], v252, s[56:59], 0 offen
    v_mfma_f32_16x16x32_bf16 v[44:47], v[124:127], a[140:143], v[44:47]
    buffer_load_dwordx4 v20, s[44:47], s26 offen offset:512 sc1 lds
    s_waitcnt lgkmcnt(0)
    v_mfma_f32_16x16x32_bf16 v[44:47], v[128:131], a[148:151], v[44:47]
    ds_read_b128 v[104:107], v14 offset:51200
    v_mfma_f32_16x16x32_bf16 v[44:47], v[132:135], a[156:159], v[44:47]
    ds_read_b128 v[108:111], v14 offset:55296
    v_mfma_f32_16x16x32_bf16 v[40:43], v[132:135], a[152:155], v[40:43]
    ds_read_b128 v[112:115], v14 offset:59392
    v_mfma_f32_16x16x32_bf16 v[40:43], v[128:131], a[144:147], v[40:43]
    ds_read_b128 v[116:119], v14 offset:63488
    v_mfma_f32_16x16x32_bf16 v[40:43], v[124:127], a[136:139], v[40:43]
    s_add_u32 m0, s73, 134144
    v_mfma_f32_16x16x32_bf16 v[40:43], v[120:123], a[128:131], v[40:43]
    buffer_load_dwordx4 v21, s[44:47], s18 offen offset:0 sc1 lds
    s_waitcnt lgkmcnt(2)
    v_mfma_f32_16x16x32_bf16 v[48:51], v[104:107], a[128:131], v[48:51]
    v_mfma_f32_16x16x32_bf16 v[48:51], v[108:111], a[136:139], v[48:51]
    s_waitcnt lgkmcnt(0)
    v_mfma_f32_16x16x32_bf16 v[48:51], v[112:115], a[144:147], v[48:51]
    ds_read_b128 v[120:123], v14 offset:52224
    v_mfma_f32_16x16x32_bf16 v[48:51], v[116:119], a[152:155], v[48:51]
    ds_read_b128 v[124:127], v14 offset:56320
    v_mfma_f32_16x16x32_bf16 v[52:55], v[116:119], a[156:159], v[52:55]
    ds_read_b128 v[128:131], v14 offset:60416
    v_mfma_f32_16x16x32_bf16 v[52:55], v[112:115], a[148:151], v[52:55]
    ds_read_b128 v[132:135], v14 offset:64512
    v_mfma_f32_16x16x32_bf16 v[52:55], v[108:111], a[140:143], v[52:55]
    v_mfma_f32_16x16x32_bf16 v[52:55], v[104:107], a[132:135], v[52:55]
    s_waitcnt lgkmcnt(2)
    v_mfma_f32_16x16x32_bf16 v[36:39], v[120:123], a[164:167], v[36:39]
    buffer_load_dwordx4 v[92:95], v252, s[56:59], s40 offen
    v_mfma_f32_16x16x32_bf16 v[36:39], v[124:127], a[172:175], v[36:39]
    s_waitcnt lgkmcnt(0)
    v_mfma_f32_16x16x32_bf16 v[36:39], v[128:131], a[180:183], v[36:39]
    s_waitcnt vmcnt(13)
    s_barrier
    v_mfma_f32_16x16x32_bf16 v[36:39], v[132:135], a[188:191], v[36:39]
    ds_read_b128 v[104:107], v14 offset:0
    v_mfma_f32_16x16x32_bf16 v[32:35], v[132:135], a[184:187], v[32:35]
    ds_read_b128 v[108:111], v14 offset:4096
    v_mfma_f32_16x16x32_bf16 v[32:35], v[128:131], a[176:179], v[32:35]
    ds_read_b128 v[112:115], v14 offset:8192
    v_mfma_f32_16x16x32_bf16 v[32:35], v[124:127], a[168:171], v[32:35]
    ds_read_b128 v[116:119], v14 offset:12288
    v_mfma_f32_16x16x32_bf16 v[32:35], v[120:123], a[160:163], v[32:35]
    s_waitcnt lgkmcnt(2)
    v_mfma_f32_16x16x32_bf16 v[40:43], v[104:107], a[160:163], v[40:43]
    s_add_u32 m0, s73, 146944
    v_mfma_f32_16x16x32_bf16 v[40:43], v[108:111], a[168:171], v[40:43]
    buffer_load_dwordx4 v21, s[44:47], s18 offen offset:512 sc1 lds
    s_waitcnt lgkmcnt(0)
    v_mfma_f32_16x16x32_bf16 v[40:43], v[112:115], a[176:179], v[40:43]
    ds_read_b128 v[120:123], v14 offset:1024
    v_mfma_f32_16x16x32_bf16 v[40:43], v[116:119], a[184:187], v[40:43]
    ds_read_b128 v[124:127], v14 offset:5120
    v_mfma_f32_16x16x32_bf16 v[44:47], v[116:119], a[188:191], v[44:47]
    ds_read_b128 v[128:131], v14 offset:9216
    v_mfma_f32_16x16x32_bf16 v[44:47], v[112:115], a[180:183], v[44:47]
    ds_read_b128 v[132:135], v14 offset:13312
    v_mfma_f32_16x16x32_bf16 v[44:47], v[108:111], a[172:175], v[44:47]
    s_add_u32 m0, s73, 148480
    v_mfma_f32_16x16x32_bf16 v[44:47], v[104:107], a[164:167], v[44:47]
    buffer_load_dwordx4 v21, s[44:47], s19 offen offset:0 sc1 lds
    s_waitcnt lgkmcnt(2)
    v_mfma_f32_16x16x32_bf16 v[52:55], v[120:123], a[164:167], v[52:55]
    s_add_u32 m0, s73, 148992
    buffer_load_dwordx2 v[142:143], v253, s[56:59], 0 offen
    v_mfma_f32_16x16x32_bf16 v[52:55], v[124:127], a[172:175], v[52:55]
    buffer_load_dwordx4 v21, s[44:47], s19 offen offset:512 sc1 lds
    s_waitcnt lgkmcnt(0)
    v_mfma_f32_16x16x32_bf16 v[52:55], v[128:131], a[180:183], v[52:55]
    ds_read_b128 v[104:107], v14 offset:2048
    v_mfma_f32_16x16x32_bf16 v[52:55], v[132:135], a[188:191], v[52:55]
    ds_read_b128 v[108:111], v14 offset:6144
    v_mfma_f32_16x16x32_bf16 v[48:51], v[132:135], a[184:187], v[48:51]
    ds_read_b128 v[112:115], v14 offset:10240
    v_mfma_f32_16x16x32_bf16 v[48:51], v[128:131], a[176:179], v[48:51]
    ds_read_b128 v[116:119], v14 offset:14336
    v_mfma_f32_16x16x32_bf16 v[48:51], v[124:127], a[168:171], v[48:51]
    s_add_u32 m0, s73, 150528
    v_mfma_f32_16x16x32_bf16 v[48:51], v[120:123], a[160:163], v[48:51]
    buffer_load_dwordx4 v21, s[44:47], s20 offen offset:0 sc1 lds
    s_waitcnt lgkmcnt(2)
    v_mfma_f32_16x16x32_bf16 v[32:35], v[104:107], a[192:195], v[32:35]
    v_mfma_f32_16x16x32_bf16 v[32:35], v[108:111], a[200:203], v[32:35]
    s_waitcnt vmcnt(11)
    s_waitcnt lgkmcnt(0)
    v_mfma_f32_16x16x32_bf16 v[32:35], v[112:115], a[208:211], v[32:35]
    ds_read_b128 v[120:123], v14 offset:3072
    v_mfma_f32_16x16x32_bf16 v[32:35], v[116:119], a[216:219], v[32:35]
    ds_read_b128 v[124:127], v14 offset:7168
    v_mfma_f32_16x16x32_bf16 v[36:39], v[116:119], a[220:223], v[36:39]
    ds_read_b128 v[128:131], v14 offset:11264
    v_lshlrev_b32 v72, 16, v102
    v_mfma_f32_16x16x32_bf16 v[36:39], v[112:115], a[212:215], v[36:39]
    ds_read_b128 v[132:135], v14 offset:15360
    v_mfma_f32_16x16x32_bf16 v[36:39], v[108:111], a[204:207], v[36:39]
    v_lshlrev_b32 v73, 16, v102
    v_mfma_f32_16x16x32_bf16 v[36:39], v[104:107], a[196:199], v[36:39]
    buffer_load_dwordx2 v[96:97], v26, s[44:47], s42 offen offset:0 sc1
    s_waitcnt lgkmcnt(2)
    v_mfma_f32_16x16x32_bf16 v[44:47], v[120:123], a[196:199], v[44:47]
    v_mfma_f32_16x16x32_bf16 v[44:47], v[124:127], a[204:207], v[44:47]
    v_lshlrev_b32 v74, 16, v102
    s_waitcnt lgkmcnt(0)
    v_mfma_f32_16x16x32_bf16 v[44:47], v[128:131], a[212:215], v[44:47]
    s_barrier
    v_mfma_f32_16x16x32_bf16 v[44:47], v[132:135], a[220:223], v[44:47]
    ds_read_b128 v[104:107], v14 offset:16384
    v_mfma_f32_16x16x32_bf16 v[40:43], v[132:135], a[216:219], v[40:43]
    ds_read_b128 v[108:111], v14 offset:20480
    v_lshlrev_b32 v75, 16, v102
    v_mfma_f32_16x16x32_bf16 v[40:43], v[128:131], a[208:211], v[40:43]
    ds_read_b128 v[112:115], v14 offset:24576
    v_mfma_f32_16x16x32_bf16 v[40:43], v[124:127], a[200:203], v[40:43]
    ds_read_b128 v[116:119], v14 offset:28672
    v_lshlrev_b32 v76, 16, v103
    v_mfma_f32_16x16x32_bf16 v[40:43], v[120:123], a[192:195], v[40:43]
    s_waitcnt lgkmcnt(2)
    v_mfma_f32_16x16x32_bf16 v[48:51], v[104:107], a[192:195], v[48:51]
    s_add_u32 m0, s73, 97792
    v_lshlrev_b32 v77, 16, v103
    v_mfma_f32_16x16x32_bf16 v[48:51], v[108:111], a[200:203], v[48:51]
    buffer_load_dwordx4 v21, s[44:47], s20 offen offset:512 sc1 lds
    s_waitcnt lgkmcnt(0)
    v_mfma_f32_16x16x32_bf16 v[48:51], v[112:115], a[208:211], v[48:51]
    ds_read_b128 v[120:123], v14 offset:17408
    v_mfma_f32_16x16x32_bf16 v[48:51], v[116:119], a[216:219], v[48:51]
    ds_read_b128 v[124:127], v14 offset:21504
    v_mfma_f32_16x16x32_bf16 v[52:55], v[116:119], a[220:223], v[52:55]
    ds_read_b128 v[128:131], v14 offset:25600
    v_lshlrev_b32 v78, 16, v103
    v_mfma_f32_16x16x32_bf16 v[52:55], v[112:115], a[212:215], v[52:55]
    ds_read_b128 v[132:135], v14 offset:29696
    v_mfma_f32_16x16x32_bf16 v[52:55], v[108:111], a[204:207], v[52:55]
    s_add_u32 m0, s73, 99328
    v_lshlrev_b32 v79, 16, v103
    v_mfma_f32_16x16x32_bf16 v[52:55], v[104:107], a[196:199], v[52:55]
    buffer_load_dwordx4 v21, s[44:47], s21 offen offset:0 sc1 lds
    s_waitcnt lgkmcnt(2)
    v_mfma_f32_16x16x32_bf16 v[36:39], v[120:123], a[228:231], v[36:39]
    buffer_load_dwordx2 v[98:99], v26, s[44:47], s42 offen offset:128 sc1
    s_add_u32 m0, s73, 99840
    v_lshlrev_b32 v80, 16, v102
    v_mfma_f32_16x16x32_bf16 v[36:39], v[124:127], a[236:239], v[36:39]
    buffer_load_dwordx4 v21, s[44:47], s21 offen offset:512 sc1 lds
    s_waitcnt lgkmcnt(0)
    v_mfma_f32_16x16x32_bf16 v[36:39], v[128:131], a[244:247], v[36:39]
    ds_read_b128 v[104:107], v14 offset:18432
    v_mfma_f32_16x16x32_bf16 v[36:39], v[132:135], a[252:255], v[36:39]
    ds_read_b128 v[108:111], v14 offset:22528
    v_mfma_f32_16x16x32_bf16 v[32:35], v[132:135], a[248:251], v[32:35]
    ds_read_b128 v[112:115], v14 offset:26624
    v_lshlrev_b32 v81, 16, v102
    v_mfma_f32_16x16x32_bf16 v[32:35], v[128:131], a[240:243], v[32:35]
    ds_read_b128 v[116:119], v14 offset:30720
    v_mfma_f32_16x16x32_bf16 v[32:35], v[124:127], a[232:235], v[32:35]
    s_add_u32 m0, s73, 101376
    v_lshlrev_b32 v82, 16, v102
    v_mfma_f32_16x16x32_bf16 v[32:35], v[120:123], a[224:227], v[32:35]
    buffer_load_dwordx4 v21, s[44:47], s22 offen offset:0 sc1 lds
    s_waitcnt lgkmcnt(2)
    v_mfma_f32_16x16x32_bf16 v[40:43], v[104:107], a[224:227], v[40:43]
    v_mfma_f32_16x16x32_bf16 v[40:43], v[108:111], a[232:235], v[40:43]
L_pl_X_7:
    s_cbranch_execz L_wret
    v_lshlrev_b32 v83, 16, v102
    s_waitcnt lgkmcnt(0)
    v_mfma_f32_16x16x32_bf16 v[40:43], v[112:115], a[240:243], v[40:43]
    ds_read_b128 v[120:123], v14 offset:19456
    v_mfma_f32_16x16x32_bf16 v[40:43], v[116:119], a[248:251], v[40:43]
    ds_read_b128 v[124:127], v14 offset:23552
    v_mfma_f32_16x16x32_bf16 v[44:47], v[116:119], a[252:255], v[44:47]
    ds_read_b128 v[128:131], v14 offset:27648
    v_lshlrev_b32 v84, 16, v103
    v_mfma_f32_16x16x32_bf16 v[44:47], v[112:115], a[244:247], v[44:47]
    ds_read_b128 v[132:135], v14 offset:31744
    v_mfma_f32_16x16x32_bf16 v[44:47], v[108:111], a[236:239], v[44:47]
    v_lshlrev_b32 v85, 16, v103
    v_mfma_f32_16x16x32_bf16 v[44:47], v[104:107], a[228:231], v[44:47]
    buffer_load_dwordx2 v[100:101], v18, s[44:47], s42 offen offset:0 sc1
    s_waitcnt lgkmcnt(2)
    v_mfma_f32_16x16x32_bf16 v[52:55], v[120:123], a[228:231], v[52:55]
    v_mfma_f32_16x16x32_bf16 v[52:55], v[124:127], a[236:239], v[52:55]
    v_lshlrev_b32 v86, 16, v103
    s_waitcnt lgkmcnt(0)
    v_mfma_f32_16x16x32_bf16 v[52:55], v[128:131], a[244:247], v[52:55]
    s_waitcnt vmcnt(13)
    s_barrier
    v_mfma_f32_16x16x32_bf16 v[52:55], v[132:135], a[252:255], v[52:55]
    ds_read_b128 v[104:107], v14 offset:32768
    v_lshlrev_b32 v87, 16, v103
    v_mfma_f32_16x16x32_bf16 v[48:51], v[132:135], a[248:251], v[48:51]
    ds_read_b128 v[108:111], v14 offset:36864
    v_add_u32 v10, 65536, v10
    v_mfma_f32_16x16x32_bf16 v[48:51], v[128:131], a[240:243], v[48:51]
    ds_read_b128 v[112:115], v14 offset:40960
    v_mfma_f32_16x16x32_bf16 v[48:51], v[124:127], a[232:235], v[48:51]
    ds_read_b128 v[116:119], v14 offset:45056
    v_add_u32 v11, 65536, v11
    v_mfma_f32_16x16x32_bf16 v[48:51], v[120:123], a[224:227], v[48:51]
    v_lshlrev_b32 v27, 16, v27
    s_branch L_Dc
L_idle:
    s_waitcnt vmcnt(0)
    s_barrier
    s_sub_u32 s4, s75, 252
    s_mul_i32 s4, s4, 1152
    s_mul_i32 s5, s3, 64
    s_add_u32 s4, s4, s5
    s_add_u32 s4, s4, 896
    s_lshl_b32 s4, s4, 12
    s_add_u32 s4, s4, 384
    v_lshlrev_b32 v24, 10, v2
    buffer_load_dword v255, v24, s[52:55], s4 offen
    s_add_u32 s4, s4, 65536
    buffer_load_dword v255, v24, s[52:55], s4 offen
    s_add_u32 s4, s4, 65536
    buffer_load_dword v255, v24, s[52:55], s4 offen
    s_add_u32 s4, s4, 65536
    buffer_load_dword v255, v24, s[52:55], s4 offen
    s_add_u32 s4, s4, 65536
    s_bitcmp1_b32 s3, 1
    s_cselect_b32 s18, s85, s84
    s_mul_i32 s18, s18, 139264
    s_cselect_b32 s19, s87, s86
    s_mul_i32 s19, s19, 139264
    s_cselect_b32 s20, s89, s88
    s_mul_i32 s20, s20, 139264
    s_cselect_b32 s21, s91, s90
    s_mul_i32 s21, s21, 139264
    s_cselect_b32 s22, s93, s92
    s_mul_i32 s22, s22, 139264
    s_cselect_b32 s23, s95, s94
    s_mul_i32 s23, s23, 139264
    s_cselect_b32 s24, s97, s96
    s_mul_i32 s24, s24, 139264
    s_cselect_b32 s25, s99, s98
    s_mul_i32 s25, s25, 139264
    s_cselect_b32 s26, s101, s100
    s_mul_i32 s26, s26, 139264
    s_add_u32 m0, s73, 32768
    s_lshl_b32 s14, s84, 18
    buffer_load_dwordx4 v4, s[52:55], s14 offen offset:0 lds
    buffer_load_dwordx4 v5, s[52:55], s14 offen offset:1024 lds
    buffer_load_dwordx4 v6, s[52:55], s14 offen offset:2048 lds
    buffer_load_dwordx4 v7, s[52:55], s14 offen offset:3072 lds
    s_add_u32 m0, s73, 49152
    s_lshl_b32 s14, s85, 18
    buffer_load_dwordx4 v4, s[52:55], s14 offen offset:0 lds
    buffer_load_dwordx4 v5, s[52:55], s14 offen offset:1024 lds
    buffer_load_dwordx4 v6, s[52:55], s14 offen offset:2048 lds
    buffer_load_dwordx4 v7, s[52:55], s14 offen offset:3072 lds
    s_add_u32 m0, s73, 65536
    s_lshl_b32 s14, s86, 18
    buffer_load_dwordx4 v4, s[52:55], s14 offen offset:0 lds
    buffer_load_dwordx4 v5, s[52:55], s14 offen offset:1024 lds
    buffer_load_dwordx4 v6, s[52:55], s14 offen offset:2048 lds
    buffer_load_dwordx4 v7, s[52:55], s14 offen offset:3072 lds
    s_add_u32 m0, s73, 81920
    s_lshl_b32 s14, s87, 18
    buffer_load_dwordx4 v4, s[52:55], s14 offen offset:0 lds
    buffer_load_dwordx4 v5, s[52:55], s14 offen offset:1024 lds
    buffer_load_dwordx4 v6, s[52:55], s14 offen offset:2048 lds
    buffer_load_dwordx4 v7, s[52:55], s14 offen offset:3072 lds
    s_add_u32 m0, s73, 98304
    s_lshl_b32 s14, s88, 18
    buffer_load_dwordx4 v4, s[52:55], s14 offen offset:0 lds
    buffer_load_dwordx4 v5, s[52:55], s14 offen offset:1024 lds
    buffer_load_dwordx4 v6, s[52:55], s14 offen offset:2048 lds
    buffer_load_dwordx4 v7, s[52:55], s14 offen offset:3072 lds
    s_add_u32 m0, s73, 114688
    s_lshl_b32 s14, s89, 18
    buffer_load_dwordx4 v4, s[52:55], s14 offen offset:0 lds
    buffer_load_dwordx4 v5, s[52:55], s14 offen offset:1024 lds
    buffer_load_dwordx4 v6, s[52:55], s14 offen offset:2048 lds
    buffer_load_dwordx4 v7, s[52:55], s14 offen offset:3072 lds
    s_add_u32 m0, s73, 131072
    s_lshl_b32 s14, s90, 18
    buffer_load_dwordx4 v4, s[52:55], s14 offen offset:0 lds
    buffer_load_dwordx4 v5, s[52:55], s14 offen offset:1024 lds
    buffer_load_dwordx4 v6, s[52:55], s14 offen offset:2048 lds
    buffer_load_dwordx4 v7, s[52:55], s14 offen offset:3072 lds
    s_add_u32 m0, s73, 147456
    s_lshl_b32 s14, s91, 18
    buffer_load_dwordx4 v4, s[52:55], s14 offen offset:0 lds
    buffer_load_dwordx4 v5, s[52:55], s14 offen offset:1024 lds
    buffer_load_dwordx4 v6, s[52:55], s14 offen offset:2048 lds
    buffer_load_dwordx4 v7, s[52:55], s14 offen offset:3072 lds
    s_waitcnt vmcnt(28)
    s_barrier
    ds_read_b64_tr_b16 a[0:1], v10 offset:32768
    ds_read_b64_tr_b16 a[2:3], v10 offset:34816
    ds_read_b64_tr_b16 a[8:9], v10 offset:36864
    ds_read_b64_tr_b16 a[10:11], v10 offset:38912
    ds_read_b64_tr_b16 a[4:5], v11 offset:32768
    ds_read_b64_tr_b16 a[6:7], v11 offset:34816
    ds_read_b64_tr_b16 a[12:13], v11 offset:36864
    ds_read_b64_tr_b16 a[14:15], v11 offset:38912
    s_waitcnt vmcnt(24) lgkmcnt(0)
    s_barrier
    ds_read_b64_tr_b16 a[16:17], v10 offset:49152
    s_add_u32 m0, s73, 32768
    s_lshl_b32 s14, s92, 18
    ds_read_b64_tr_b16 a[18:19], v10 offset:51200
    buffer_load_dwordx4 v4, s[52:55], s14 offen offset:0 lds
    ds_read_b64_tr_b16 a[24:25], v10 offset:53248
    ds_read_b64_tr_b16 a[26:27], v10 offset:55296
    buffer_load_dwordx4 v5, s[52:55], s14 offen offset:1024 lds
    ds_read_b64_tr_b16 a[20:21], v11 offset:49152
    buffer_load_dwordx4 v6, s[52:55], s14 offen offset:2048 lds
    ds_read_b64_tr_b16 a[22:23], v11 offset:51200
    ds_read_b64_tr_b16 a[28:29], v11 offset:53248
    buffer_load_dwordx4 v7, s[52:55], s14 offen offset:3072 lds
    ds_read_b64_tr_b16 a[30:31], v11 offset:55296
    s_waitcnt vmcnt(24) lgkmcnt(0)
    s_barrier
    v_add_u32 v10, 65536, v10
    ds_read_b64_tr_b16 a[32:33], v10 offset:0
    s_add_u32 m0, s73, 49152
    s_lshl_b32 s14, s93, 18
    ds_read_b64_tr_b16 a[34:35], v10 offset:2048
    buffer_load_dwordx4 v4, s[52:55], s14 offen offset:0 lds
    ds_read_b64_tr_b16 a[40:41], v10 offset:4096
    ds_read_b64_tr_b16 a[42:43], v10 offset:6144
    buffer_load_dwordx4 v5, s[52:55], s14 offen offset:1024 lds
    v_add_u32 v11, 65536, v11
    ds_read_b64_tr_b16 a[36:37], v11 offset:0
    buffer_load_dwordx4 v6, s[52:55], s14 offen offset:2048 lds
    ds_read_b64_tr_b16 a[38:39], v11 offset:2048
    ds_read_b64_tr_b16 a[44:45], v11 offset:4096
    buffer_load_dwordx4 v7, s[52:55], s14 offen offset:3072 lds
    ds_read_b64_tr_b16 a[46:47], v11 offset:6144
    s_waitcnt vmcnt(24) lgkmcnt(0)
    s_barrier
    ds_read_b64_tr_b16 a[48:49], v10 offset:16384
    s_add_u32 m0, s73, 65536
    s_lshl_b32 s14, s94, 18
    ds_read_b64_tr_b16 a[50:51], v10 offset:18432
    buffer_load_dwordx4 v4, s[52:55], s14 offen offset:0 lds
    ds_read_b64_tr_b16 a[56:57], v10 offset:20480
    ds_read_b64_tr_b16 a[58:59], v10 offset:22528
    buffer_load_dwordx4 v5, s[52:55], s14 offen offset:1024 lds
    ds_read_b64_tr_b16 a[52:53], v11 offset:16384
    buffer_load_dwordx4 v6, s[52:55], s14 offen offset:2048 lds
    ds_read_b64_tr_b16 a[54:55], v11 offset:18432
    ds_read_b64_tr_b16 a[60:61], v11 offset:20480
    buffer_load_dwordx4 v7, s[52:55], s14 offen offset:3072 lds
    ds_read_b64_tr_b16 a[62:63], v11 offset:22528
    s_waitcnt vmcnt(24) lgkmcnt(0)
    s_barrier
    ds_read_b64_tr_b16 a[64:65], v10 offset:32768
    s_add_u32 m0, s73, 81920
    s_lshl_b32 s14, s95, 18
    ds_read_b64_tr_b16 a[66:67], v10 offset:34816
    buffer_load_dwordx4 v4, s[52:55], s14 offen offset:0 lds
    ds_read_b64_tr_b16 a[72:73], v10 offset:36864
    ds_read_b64_tr_b16 a[74:75], v10 offset:38912
    buffer_load_dwordx4 v5, s[52:55], s14 offen offset:1024 lds
    ds_read_b64_tr_b16 a[68:69], v11 offset:32768
    buffer_load_dwordx4 v6, s[52:55], s14 offen offset:2048 lds
    ds_read_b64_tr_b16 a[70:71], v11 offset:34816
    ds_read_b64_tr_b16 a[76:77], v11 offset:36864
    buffer_load_dwordx4 v7, s[52:55], s14 offen offset:3072 lds
    ds_read_b64_tr_b16 a[78:79], v11 offset:38912
    s_waitcnt vmcnt(24) lgkmcnt(0)
    s_barrier
    ds_read_b64_tr_b16 a[80:81], v10 offset:49152
    s_add_u32 m0, s73, 98304
    s_lshl_b32 s14, s96, 18
    ds_read_b64_tr_b16 a[82:83], v10 offset:51200
    buffer_load_dwordx4 v4, s[52:55], s14 offen offset:0 lds
    ds_read_b64_tr_b16 a[88:89], v10 offset:53248
    ds_read_b64_tr_b16 a[90:91], v10 offset:55296
    buffer_load_dwordx4 v5, s[52:55], s14 offen offset:1024 lds
    ds_read_b64_tr_b16 a[84:85], v11 offset:49152
    buffer_load_dwordx4 v6, s[52:55], s14 offen offset:2048 lds
    ds_read_b64_tr_b16 a[86:87], v11 offset:51200
    ds_read_b64_tr_b16 a[92:93], v11 offset:53248
    buffer_load_dwordx4 v7, s[52:55], s14 offen offset:3072 lds
    ds_read_b64_tr_b16 a[94:95], v11 offset:55296
    s_waitcnt vmcnt(24) lgkmcnt(0)
    s_barrier
    v_add_u32 v10, 65536, v10
    ds_read_b64_tr_b16 a[96:97], v10 offset:0
    s_add_u32 m0, s73, 114688
    s_lshl_b32 s14, s97, 18
    ds_read_b64_tr_b16 a[98:99], v10 offset:2048
    buffer_load_dwordx4 v4, s[52:55], s14 offen offset:0 lds
    ds_read_b64_tr_b16 a[104:105], v10 offset:4096
    ds_read_b64_tr_b16 a[106:107], v10 offset:6144
    buffer_load_dwordx4 v5, s[52:55], s14 offen offset:1024 lds
    v_add_u32 v11, 65536, v11
    ds_read_b64_tr_b16 a[100:101], v11 offset:0
    buffer_load_dwordx4 v6, s[52:55], s14 offen offset:2048 lds
    ds_read_b64_tr_b16 a[102:103], v11 offset:2048
    ds_read_b64_tr_b16 a[108:109], v11 offset:4096
    buffer_load_dwordx4 v7, s[52:55], s14 offen offset:3072 lds
    ds_read_b64_tr_b16 a[110:111], v11 offset:6144
    s_waitcnt vmcnt(24) lgkmcnt(0)
    s_barrier
    ds_read_b64_tr_b16 a[112:113], v10 offset:16384
    s_add_u32 m0, s73, 131072
    s_lshl_b32 s14, s98, 18
    ds_read_b64_tr_b16 a[114:115], v10 offset:18432
    buffer_load_dwordx4 v4, s[52:55], s14 offen offset:0 lds
    ds_read_b64_tr_b16 a[120:121], v10 offset:20480
    ds_read_b64_tr_b16 a[122:123], v10 offset:22528
    buffer_load_dwordx4 v5, s[52:55], s14 offen offset:1024 lds
    ds_read_b64_tr_b16 a[116:117], v11 offset:16384
    buffer_load_dwordx4 v6, s[52:55], s14 offen offset:2048 lds
    ds_read_b64_tr_b16 a[118:119], v11 offset:18432
    ds_read_b64_tr_b16 a[124:125], v11 offset:20480
    buffer_load_dwordx4 v7, s[52:55], s14 offen offset:3072 lds
    ds_read_b64_tr_b16 a[126:127], v11 offset:22528
    s_waitcnt vmcnt(24) lgkmcnt(0)
    s_barrier
    v_add_u32 v10, -131072, v10
    ds_read_b64_tr_b16 a[128:129], v10 offset:32768
    s_add_u32 m0, s73, 147456
    s_lshl_b32 s14, s99, 18
    ds_read_b64_tr_b16 a[130:131], v10 offset:34816
    buffer_load_dwordx4 v4, s[52:55], s14 offen offset:0 lds
    ds_read_b64_tr_b16 a[136:137], v10 offset:36864
    ds_read_b64_tr_b16 a[138:139], v10 offset:38912
    buffer_load_dwordx4 v5, s[52:55], s14 offen offset:1024 lds
    v_add_u32 v11, -131072, v11
    ds_read_b64_tr_b16 a[132:133], v11 offset:32768
    buffer_load_dwordx4 v6, s[52:55], s14 offen offset:2048 lds
    ds_read_b64_tr_b16 a[134:135], v11 offset:34816
    ds_read_b64_tr_b16 a[140:141], v11 offset:36864
    buffer_load_dwordx4 v7, s[52:55], s14 offen offset:3072 lds
    ds_read_b64_tr_b16 a[142:143], v11 offset:38912
    s_waitcnt vmcnt(24) lgkmcnt(0)
    s_barrier
    ds_read_b64_tr_b16 a[144:145], v10 offset:49152
    s_add_u32 m0, s73, 0
    s_lshl_b32 s14, s100, 18
    ds_read_b64_tr_b16 a[146:147], v10 offset:51200
    buffer_load_dwordx4 v4, s[52:55], s14 offen offset:0 lds
    ds_read_b64_tr_b16 a[152:153], v10 offset:53248
    ds_read_b64_tr_b16 a[154:155], v10 offset:55296
    buffer_load_dwordx4 v5, s[52:55], s14 offen offset:1024 lds
    ds_read_b64_tr_b16 a[148:149], v11 offset:49152
    buffer_load_dwordx4 v6, s[52:55], s14 offen offset:2048 lds
    ds_read_b64_tr_b16 a[150:151], v11 offset:51200
    ds_read_b64_tr_b16 a[156:157], v11 offset:53248
    buffer_load_dwordx4 v7, s[52:55], s14 offen offset:3072 lds
    ds_read_b64_tr_b16 a[158:159], v11 offset:55296
    s_waitcnt vmcnt(24) lgkmcnt(0)
    s_barrier
    v_add_u32 v10, 65536, v10
    ds_read_b64_tr_b16 a[160:161], v10 offset:0
    s_add_u32 m0, s73, 16384
    s_lshl_b32 s14, s101, 18
    ds_read_b64_tr_b16 a[162:163], v10 offset:2048
    buffer_load_dwordx4 v4, s[52:55], s14 offen offset:0 lds
    ds_read_b64_tr_b16 a[168:169], v10 offset:4096
    ds_read_b64_tr_b16 a[170:171], v10 offset:6144
    buffer_load_dwordx4 v5, s[52:55], s14 offen offset:1024 lds
    v_add_u32 v11, 65536, v11
    ds_read_b64_tr_b16 a[164:165], v11 offset:0
    buffer_load_dwordx4 v6, s[52:55], s14 offen offset:2048 lds
    ds_read_b64_tr_b16 a[166:167], v11 offset:2048
    ds_read_b64_tr_b16 a[172:173], v11 offset:4096
    buffer_load_dwordx4 v7, s[52:55], s14 offen offset:3072 lds
    ds_read_b64_tr_b16 a[174:175], v11 offset:6144
    s_waitcnt vmcnt(24) lgkmcnt(0)
    s_barrier
    ds_read_b64_tr_b16 a[176:177], v10 offset:16384
    ds_read_b64_tr_b16 a[178:179], v10 offset:18432
    ds_read_b64_tr_b16 a[184:185], v10 offset:20480
    ds_read_b64_tr_b16 a[186:187], v10 offset:22528
    ds_read_b64_tr_b16 a[180:181], v11 offset:16384
    ds_read_b64_tr_b16 a[182:183], v11 offset:18432
    ds_read_b64_tr_b16 a[188:189], v11 offset:20480
    ds_read_b64_tr_b16 a[190:191], v11 offset:22528
    s_waitcnt vmcnt(20) lgkmcnt(0)
    s_barrier
    ds_read_b64_tr_b16 a[192:193], v10 offset:32768
    ds_read_b64_tr_b16 a[194:195], v10 offset:34816
    ds_read_b64_tr_b16 a[200:201], v10 offset:36864
    ds_read_b64_tr_b16 a[202:203], v10 offset:38912
    ds_read_b64_tr_b16 a[196:197], v11 offset:32768
    ds_read_b64_tr_b16 a[198:199], v11 offset:34816
    ds_read_b64_tr_b16 a[204:205], v11 offset:36864
    ds_read_b64_tr_b16 a[206:207], v11 offset:38912
    s_waitcnt vmcnt(16) lgkmcnt(0)
    s_barrier
    ds_read_b64_tr_b16 a[208:209], v10 offset:49152
    ds_read_b64_tr_b16 a[210:211], v10 offset:51200
    ds_read_b64_tr_b16 a[216:217], v10 offset:53248
    ds_read_b64_tr_b16 a[218:219], v10 offset:55296
    ds_read_b64_tr_b16 a[212:213], v11 offset:49152
    ds_read_b64_tr_b16 a[214:215], v11 offset:51200
    ds_read_b64_tr_b16 a[220:221], v11 offset:53248
    ds_read_b64_tr_b16 a[222:223], v11 offset:55296
    s_waitcnt vmcnt(12) lgkmcnt(0)
    s_barrier
    v_add_u32 v10, 65536, v10
    ds_read_b64_tr_b16 a[224:225], v10 offset:0
    ds_read_b64_tr_b16 a[226:227], v10 offset:2048
    ds_read_b64_tr_b16 a[232:233], v10 offset:4096
    ds_read_b64_tr_b16 a[234:235], v10 offset:6144
    v_add_u32 v11, 65536, v11
    ds_read_b64_tr_b16 a[228:229], v11 offset:0
    ds_read_b64_tr_b16 a[230:231], v11 offset:2048
    ds_read_b64_tr_b16 a[236:237], v11 offset:4096
    ds_read_b64_tr_b16 a[238:239], v11 offset:6144
    s_waitcnt vmcnt(8) lgkmcnt(0)
    s_barrier
    ds_read_b64_tr_b16 a[240:241], v10 offset:16384
    ds_read_b64_tr_b16 a[242:243], v10 offset:18432
    ds_read_b64_tr_b16 a[248:249], v10 offset:20480
    ds_read_b64_tr_b16 a[250:251], v10 offset:22528
    ds_read_b64_tr_b16 a[244:245], v11 offset:16384
    ds_read_b64_tr_b16 a[246:247], v11 offset:18432
    ds_read_b64_tr_b16 a[252:253], v11 offset:20480
    ds_read_b64_tr_b16 a[254:255], v11 offset:22528
    s_waitcnt lgkmcnt(0)
    s_barrier
    v_add_u32 v10, -131072, v10
    v_add_u32 v11, -131072, v11
    s_mov_b64 exec, 0
    s_call_b64 s[82:83], L_wc_D
    s_mov_b64 exec, -1
    s_bfe_u32 s4, s2, 0x20003
    s_lshl2_add_u32 s4, s72, s4
    s_lshl_b32 s4, s4, 3
    s_lshr_b32 s5, s2, 4
    s_and_b32 s5, s5, 6
    s_add_u32 s4, s4, s5
    s_and_b32 s5, s2, 1
    s_add_u32 s4, s4, s5
    s_lshl_b32 s4, s4, 7
    s_add_u32 s4, s4, 12566528
    v_lshl_add_u32 v28, v2, 2, s4
    s_cmp_eq_u32 s3, 0
    s_cselect_b32 s4, 18, 0
    v_cmp_gt_u32 vcc, s4, v2
    v_mov_b32 v13, 0x40000000
    s_nop 0
    v_cndmask_b32 v28, v13, v28, vcc
    v_mov_b32 v13, s68
    v_cndmask_b32 v13, 0, v13, vcc
    s_mov_b32 s5, 0
L_iw:
    s_sleep 16
    v_mov_b32 v29, 0
    buffer_atomic_add v29, v28, s[44:47], 0 offen sc0 sc1
    s_waitcnt vmcnt(0)
    v_cmp_eq_u32 vcc, 0, v13
    s_nop 1
    s_mov_b64 s[6:7], vcc
    v_cmp_ne_u32 vcc, v13, v29
    s_nop 1
    s_andn2_b64 s[8:9], exec, vcc
    s_andn2_b64 s[8:9], s[8:9], s[6:7]
    s_cbranch_scc1 L_ix
    s_cmp_eq_u64 s[6:7], exec
    s_cbranch_scc1 L_ix
    s_add_u32 s5, s5, 1
    s_cmp_lt_u32 s5, 100000
    s_cbranch_scc1 L_iw
L_ix:
    v_mov_b32 v29, 0
    buffer_atomic_add v29, v28, s[44:47], 0 offen sc0 sc1
    s_branch L_DX
L_end:
.section .rodata,"a"
.p2align 6
.amdhsa_kernel recurrent_scan__ssm_conv_h3__mixer_token_mlp__prompt_kernel
  .amdhsa_next_free_vgpr 512
  .amdhsa_next_free_sgpr 102
  .amdhsa_accum_offset 256
  .amdhsa_group_segment_fixed_size 0
  .amdhsa_kernarg_size 112
  .amdhsa_user_sgpr_count 2
  .amdhsa_user_sgpr_kernarg_segment_ptr 1
  .amdhsa_system_sgpr_workgroup_id_x 1
  .amdhsa_float_denorm_mode_32 3
.end_amdhsa_kernel
```

```asm
; @launch grid=(256,1,1) block=(256,1,1) lds=163840
.amdgcn_target "amdgcn-amd-amdhsa--gfx950"
.text
.globl recurrent_scan__ssm_conv_h3__mixer_token_mlp__prompt_kernel
.p2align 8
.type recurrent_scan__ssm_conv_h3__mixer_token_mlp__prompt_kernel,@function
recurrent_scan__ssm_conv_h3__mixer_token_mlp__prompt_kernel:
    s_cmp_lt_u32 s2, 256
    s_cbranch_scc0 L_exit
    s_load_dwordx2 s[56:57], s[0:1], 0
    s_load_dwordx2 s[48:49], s[0:1], 8
    s_load_dwordx2 s[52:53], s[0:1], 16
    s_load_dwordx2 s[60:61], s[0:1], 24
    s_load_dwordx16 s[16:31], s[0:1], 0
    s_load_dwordx8 s[32:39], s[0:1], 64
    s_load_dwordx4 s[40:43], s[0:1], 96
    s_memrealtime s[12:13]
    v_lshrrev_b32 v1, 6, v0
    v_and_b32 v2, 63, v0
    s_getpc_b64 s[6:7]
L_pc:
    s_lshr_b32 s4, s2, 1
    s_and_b32 s4, s4, 124
    v_add_u32 v22, s4, v1
    v_lshl_add_u32 v22, v2, 7, v22
    v_lshlrev_b32 v22, 7, v22
    v_min_u32 v22, L_end-L_pc-4, v22
    s_mov_b64 exec, 31
    global_load_dword v255, v22, s[6:7]
    s_mov_b64 exec, -1
    v_readfirstlane_b32 s3, v1
    s_and_b32 s4, s2, 7
    s_lshr_b32 s5, s2, 3
    s_lshl_b32 s4, s4, 5
    s_add_u32 s68, s4, s5
    v_lshrrev_b32 v3, 5, v0
    v_and_b32 v4, 31, v0
    v_mul_u32_u24 v5, 1152, v3
    v_mad_u32_u24 v5, v4, 12, v5
    s_mul_i32 s15, s68, 9216
    s_mul_i32 s4, s3, 3072
    s_add_u32 s5, s4, s15
    s_sub_u32 s5, s5, 3456
    v_lshlrev_b32 v6, 4, v2
    v_add_u32 v7, s5, v6
    v_add_u32 v58, 1024, v7
    s_add_u32 s4, s4, 114688
    s_lshl_b32 s5, s3, 11
    s_add_u32 s11, s5, s15
    s_add_u32 s5, s5, 127360
    s_cmp_lt_u32 s2, 216
    s_cselect_b32 s9, 0, 106496
    s_sub_u32 s4, s4, s9
    s_sub_u32 s5, s5, s9
    s_mov_b32 m0, s4
    s_mov_b32 s58, 2359296
    s_mov_b32 s59, 0x20000
    s_mov_b32 s50, 2359296
    s_mov_b32 s51, 0x20000
    s_mov_b32 s54, 2359296
    s_mov_b32 s55, 0x20000
    s_mov_b32 s62, 4608
    s_mov_b32 s63, 0x20000
    v_lshlrev_b32 v59, 3, v0
    s_movk_i32 s10, 4096
    v_lshlrev_b32 v91, 3, v2
    v_or_b32 v22, s2, v0
    v_lshlrev_b32 v22, 8, v22
    s_mov_b32 s66, 256
    s_mov_b32 s67, 0x20000
    s_waitcnt lgkmcnt(0)
    buffer_load_dwordx3 v[8:10], v5, s[56:59], s15 offen offset:0
    buffer_load_dwordx3 v[12:14], v5, s[56:59], s15 offen offset:384
    buffer_load_dwordx3 v[16:18], v5, s[56:59], s15 offen offset:768
    s_mov_b32 s64, s40
    s_and_b32 s65, s41, 0xffff
    s_or_b32 s12, s12, 1
    v_mov_b32 v23, s12
    buffer_store_dword v23, v22, s[64:67], 0 offen sc1
    buffer_load_dwordx4 v7, s[48:51], 0 offen lds
    s_add_u32 m0, s4, 1024
    s_cmp_eq_u32 s3, 3
    buffer_load_dwordx4 v58, s[48:51], 0 offen lds
    buffer_load_dwordx4 v58, s[48:51], 0 offen offset:1024 lds
    s_cbranch_scc1 L_xld
L_nox:
    s_mov_b32 m0, s5
    buffer_load_dwordx2 v[98:99], v59, s[60:63], 0 offen
    buffer_load_dwordx4 v6, s[52:55], s11 offen lds
    buffer_load_dwordx4 v6, s[52:55], s11 offen offset:1024 lds
    buffer_load_dwordx2 v[100:101], v59, s[60:63], 0 offen offset:2048
    buffer_load_dwordx2 v[102:103], v59, s[60:63], s10 offen
    s_mov_b32 s44, s42
    s_and_b32 s45, s43, 0xffff
    s_mov_b32 s46, 57606144
    s_mov_b32 s47, 0x20000
    s_and_b32 s5, s2, 7
    s_lshr_b32 s6, s2, 3
    s_lshr_b32 s7, s6, 2
    s_lshr_b32 s8, s3, 1
    s_lshl1_add_u32 s9, s7, s8
    s_cmp_ge_u32 s9, 10
    s_addc_u32 s14, s9, 0
    s_cmp_ge_u32 s9, 3
    s_addc_u32 s14, s14, 0
    s_lshl3_add_u32 s8, s8, 3
    s_cmp_eq_u32 s7, 7
    s_cselect_b32 s14, s8, s14
    s_and_b32 s4, s5, 1
    s_lshl4_add_u32 s71, s4, s14
    s_lshr_b32 s13, s5, 1
    s_mov_b32 s72, s13
    s_and_b32 s101, s6, 3
    s_lshl_b32 s73, s3, 12
    s_mov_b32 s52, s34
    s_and_b32 s53, s35, 0xffff
    s_mov_b32 s54, 18874368
    s_mov_b32 s55, 0x20000
    s_cmp_lt_u32 s6, 27
    s_cbranch_scc0 L_aux
    s_branch L_org
L_exit:
    s_endpgm
L_xld:
    s_mov_b64 exec, 0xffffff
    buffer_load_dwordx4 v58, s[48:51], 0 offen offset:2048 lds
    s_mov_b64 exec, -1
    s_mov_b32 m0, s5
    s_nop 0
    buffer_load_dwordx4 v6, s[52:55], s11 offen offset:2048 lds
    s_branch L_nox
L_nw_G:
    s_mov_b32 s5, 0
L_nl_G:
    buffer_load_dword v45, v54, s[64:67], 0 offen sc1
    s_waitcnt vmcnt(0)
    v_readfirstlane_b32 s68, v45
    s_nop 1
    s_cmp_lg_u32 s68, 0
    s_cbranch_scc1 L_ng_G
    s_add_u32 s5, s5, 1
    s_cmp_lt_u32 s5, 100000
    s_cbranch_scc1 L_nl_G
    s_branch L_ng_G
L_rs_p1G:
    s_mov_b32 s5, 0
L_rt_p1G:
    s_mov_b64 exec, vcc
    v_mov_b32 v29, 0
    buffer_atomic_add v29, v28, s[44:47], 0 offen sc0 sc1
    s_waitcnt vmcnt(0)
    v_cmp_ne_u32 vcc, v12, v29
    s_cbranch_vccz L_rx_p1G
    s_add_u32 s5, s5, 1
    s_cmp_lt_u32 s5, 100000
    s_cbranch_scc1 L_rt_p1G
L_rx_p1G:
    s_mov_b64 exec, -1
    s_branch L_ok_p1G
L_rs_p5:
    s_mov_b32 s5, 0
L_rt_p5:
    s_mov_b64 exec, vcc
    buffer_load_dword v29, v28, s[44:47], 0 offen sc1
    s_waitcnt vmcnt(0)
    v_cmp_ne_u32 vcc, s68, v29
    s_cbranch_vccz L_rx_p5
    s_add_u32 s5, s5, 1
    s_cmp_lt_u32 s5, 100000
    s_cbranch_scc1 L_rt_p5
L_rx_p5:
    s_mov_b64 exec, -1
    s_branch L_ok_p5
L_nw_X:
    s_mov_b32 s5, 0
L_nl_X:
    buffer_load_dword v45, v54, s[64:67], 0 offen sc1
    s_waitcnt vmcnt(0)
    v_readfirstlane_b32 s68, v45
    s_nop 1
    s_cmp_lg_u32 s68, 0
    s_cbranch_scc1 L_ng_X
    s_add_u32 s5, s5, 1
    s_cmp_lt_u32 s5, 100000
    s_cbranch_scc1 L_nl_X
    s_branch L_ng_X
L_rs_p1X:
    s_mov_b32 s5, 0
L_rt_p1X:
    s_mov_b64 exec, vcc
    v_mov_b32 v29, 0
    buffer_atomic_add v29, v28, s[44:47], 0 offen sc0 sc1
    s_waitcnt vmcnt(0)
    v_cmp_ne_u32 vcc, s68, v29
    s_cbranch_vccz L_rx_p1X
    s_add_u32 s5, s5, 1
    s_cmp_lt_u32 s5, 100000
    s_cbranch_scc1 L_rt_p1X
L_rx_p1X:
    s_mov_b64 exec, -1
    s_branch L_ok_p1X
L_rs_p2G:
    s_mov_b32 s5, 0
L_rt_p2G:
    s_mov_b64 exec, vcc
    v_mov_b32 v16, 0
    buffer_atomic_add v16, v15, s[44:47], 0 offen sc0 sc1
    s_waitcnt vmcnt(0)
    v_cmp_ne_u32 vcc, v13, v16
    s_cbranch_vccz L_rx_p2G
    s_add_u32 s5, s5, 1
    s_cmp_lt_u32 s5, 100000
    s_cbranch_scc1 L_rt_p2G
L_rx_p2G:
    s_mov_b64 exec, -1
    s_branch L_ok_p2G
L_as_a:
    s_mov_b32 s5, 0
L_at_a:
    v_mov_b32 v141, 0
    buffer_atomic_add v141, v137, s[44:47], 0 offen offset:12 sc0 sc1
    s_waitcnt vmcnt(0)
    v_cmp_ne_u32 vcc, v138, v141
    s_cbranch_vccz L_ao_a
    s_add_u32 s5, s5, 1
    s_cmp_lt_u32 s5, 100000
    s_cbranch_scc1 L_at_a
    s_branch L_ao_a
L_xs_a:
    s_mov_b32 s5, 0
L_xt_a:
    buffer_load_dwordx4 v[40:43], v136, s[44:47], s34 offen offset:0 sc1
    buffer_load_dwordx4 v[44:47], v136, s[44:47], s34 offen offset:1024 sc1
    buffer_load_dwordx4 v[48:51], v136, s[44:47], s34 offen offset:2048 sc1
    s_waitcnt vmcnt(0)
    v_bitop3_b32 v43, v43, v47, s68 bitop3:0x7e
    v_bitop3_b32 v43, v43, v51, s68 bitop3:0xf6
    v_cmp_ne_u32 vcc, 0, v43
    s_cbranch_vccz L_xo_a
    s_add_u32 s5, s5, 1
    s_cmp_lt_u32 s5, 100000
    s_cbranch_scc1 L_xt_a
    s_branch L_xo_a
L_as_b:
    s_mov_b32 s5, 0
L_at_b:
    v_mov_b32 v141, 0
    buffer_atomic_add v141, v139, s[44:47], s11 offen offset:2060 sc0 sc1
    s_waitcnt vmcnt(0)
    v_cmp_ne_u32 vcc, v140, v141
    s_cbranch_vccz L_ao_b
    s_add_u32 s5, s5, 1
    s_cmp_lt_u32 s5, 100000
    s_cbranch_scc1 L_at_b
    s_branch L_ao_b
L_xs_b:
    s_mov_b32 s5, 0
L_xt_b:
    buffer_load_dwordx4 v[56:59], v136, s[44:47], s11 offen offset:0 sc1
    buffer_load_dwordx4 v[60:63], v136, s[44:47], s11 offen offset:1024 sc1
    buffer_load_dwordx4 v[64:67], v136, s[44:47], s11 offen offset:2048 sc1
    s_waitcnt vmcnt(0)
    v_bitop3_b32 v59, v59, v63, s68 bitop3:0x7e
    v_bitop3_b32 v59, v59, v67, s68 bitop3:0xf6
    v_cmp_ne_u32 vcc, 0, v59
    s_cbranch_vccz L_xo_b
    s_add_u32 s5, s5, 1
    s_cmp_lt_u32 s5, 100000
    s_cbranch_scc1 L_xt_b
    s_branch L_xo_b
L_xs_z:
    s_mov_b32 s5, 0
L_xt_z:
    buffer_load_dwordx4 v[72:75], v136, s[44:47], s12 offen offset:0 sc1
    buffer_load_dwordx4 v[76:79], v136, s[44:47], s12 offen offset:1024 sc1
    buffer_load_dwordx4 v[80:83], v136, s[44:47], s12 offen offset:2048 sc1
    s_waitcnt vmcnt(0)
    v_bitop3_b32 v75, v75, v79, s68 bitop3:0x7e
    v_bitop3_b32 v75, v75, v83, s68 bitop3:0xf6
    v_cmp_ne_u32 vcc, 0, v75
    s_cbranch_vccz L_xo_z
    s_add_u32 s5, s5, 1
    s_cmp_lt_u32 s5, 100000
    s_cbranch_scc1 L_xt_z
    s_branch L_xo_z
L_rs_p3:
    s_mov_b32 s5, 0
L_rt_p3:
    s_mov_b64 exec, vcc
    buffer_load_dword v189, v188, s[44:47], 0 offen sc1
    s_waitcnt vmcnt(0)
    v_cmp_ne_u32 vcc, s68, v189
    s_cbranch_vccz L_rx_p3
    s_add_u32 s5, s5, 1
    s_cmp_lt_u32 s5, 100000
    s_cbranch_scc1 L_rt_p3
L_rx_p3:
    s_mov_b64 exec, -1
    s_branch L_ok_p3
L_xs_8:
    s_mov_b32 s5, 0
L_xt_8:
    buffer_load_dwordx4 v[204:207], v136, s[44:47], s35 offen offset:0 sc1
    buffer_load_dwordx4 v[208:211], v136, s[44:47], s35 offen offset:1024 sc1
    buffer_load_dwordx4 v[212:215], v136, s[44:47], s35 offen offset:2048 sc1
    buffer_load_dwordx4 v[216:219], v136, s[44:47], s35 offen offset:3072 sc1
    s_waitcnt vmcnt(0)
    v_bitop3_b32 v207, v207, v211, s36 bitop3:0x7e
    v_bitop3_b32 v207, v207, v215, s36 bitop3:0xf6
    v_bitop3_b32 v207, v207, v219, s36 bitop3:0xf6
    v_cmp_ne_u32 vcc, 0, v207
    s_cbranch_vccz L_xo_8
    s_add_u32 s5, s5, 1
    s_cmp_lt_u32 s5, 100000
    s_cbranch_scc1 L_xt_8
    s_branch L_xo_8
L_rs_p2X:
    s_mov_b32 s5, 0
L_rt_p2X:
    s_mov_b64 exec, vcc
    v_mov_b32 v29, 0
    buffer_atomic_add v29, v28, s[44:47], 0 offen sc0 sc1
    s_waitcnt vmcnt(0)
    v_cmp_ne_u32 vcc, v13, v29
    s_cbranch_vccz L_rx_p2X
    s_add_u32 s5, s5, 1
    s_cmp_lt_u32 s5, 100000
    s_cbranch_scc1 L_rt_p2X
L_rx_p2X:
    s_mov_b64 exec, -1
    s_branch L_ok_p2X
L_wc_G:
    s_cmp_eq_u32 s3, 0
    s_cbranch_scc1 L_pl_G_0
    s_cmp_eq_u32 s3, 1
    s_cbranch_scc1 L_pl_G_1
    s_cmp_eq_u32 s3, 2
    s_cbranch_scc1 L_pl_G_2
    s_branch L_pl_G_3
L_wc_X:
    s_cmp_eq_u32 s3, 0
    s_cbranch_scc1 L_pl_X_0
    s_cmp_eq_u32 s3, 1
    s_cbranch_scc1 L_pl_X_1
    s_cmp_eq_u32 s3, 2
    s_cbranch_scc1 L_pl_X_2
    s_branch L_pl_X_3
L_wc_D:
    s_cmp_eq_u32 s3, 0
    s_cbranch_scc1 L_pl_D_0
    s_cmp_eq_u32 s3, 1
    s_cbranch_scc1 L_pl_D_1
    s_cmp_eq_u32 s3, 2
    s_cbranch_scc1 L_pl_D_2
    s_branch L_wret
L_wret:
    s_setpc_b64 s[82:83]
.p2align 12
L_org:
    s_mul_i32 s7, s6, 21846
    s_lshr_b32 s7, s7, 16
    s_mul_i32 s8, s7, 3
    s_sub_u32 s12, s6, s8
    s_mul_i32 s8, s13, 9
    s_add_u32 s69, s8, s7
    s_lshl1_add_u32 s70, s12, s4
    s_mul_i32 s8, s69, 6
    s_add_u32 s75, s8, s70
    s_mov_b32 s48, s30
    s_and_b32 s49, s31, 0xffff
    s_mov_b32 s50, 18874368
    s_mov_b32 s51, 0x20000
    s_add_u32 s12, s12, s7
    s_mul_i32 s8, s12, 21846
    s_lshr_b32 s8, s8, 16
    s_mul_i32 s8, s8, 3
    s_sub_u32 s12, s12, s8
    s_mul_i32 s4, s4, 1179648
    s_mul_i32 s7, s12, 65538
    s_lshr_b32 s7, s7, 16
    s_mul_i32 s7, s7, 73728
    s_add_u32 s5, s4, 0
    s_add_u32 s18, s7, s5
    s_add_u32 s8, s5, 221184
    s_add_u32 s19, s18, 73728
    s_cmp_eq_u32 s19, s8
    s_cselect_b32 s19, s5, s19
    s_add_u32 s20, s19, 73728
    s_cmp_eq_u32 s20, s8
    s_cselect_b32 s20, s5, s20
    s_mul_i32 s7, s12, 65538
    s_lshr_b32 s7, s7, 16
    s_mul_i32 s7, s7, 73728
    s_add_u32 s5, s4, 221184
    s_add_u32 s21, s7, s5
    s_add_u32 s8, s5, 221184
    s_add_u32 s22, s21, 73728
    s_cmp_eq_u32 s22, s8
    s_cselect_b32 s22, s5, s22
    s_add_u32 s23, s22, 73728
    s_cmp_eq_u32 s23, s8
    s_cselect_b32 s23, s5, s23
    s_mul_i32 s7, s12, 87384
    s_lshr_b32 s7, s7, 16
    s_mul_i32 s7, s7, 73728
    s_add_u32 s5, s4, 442368
    s_add_u32 s24, s7, s5
    s_add_u32 s8, s5, 294912
    s_add_u32 s25, s24, 73728
    s_cmp_eq_u32 s25, s8
    s_cselect_b32 s25, s5, s25
    s_add_u32 s26, s25, 73728
    s_cmp_eq_u32 s26, s8
    s_cselect_b32 s26, s5, s26
    s_add_u32 s27, s26, 73728
    s_cmp_eq_u32 s27, s8
    s_cselect_b32 s27, s5, s27
    s_mul_i32 s7, s12, 131076
    s_lshr_b32 s7, s7, 16
    s_mul_i32 s7, s7, 73728
    s_add_u32 s5, s4, 737280
    s_add_u32 s76, s7, s5
    s_add_u32 s8, s5, 442368
    s_add_u32 s77, s76, 73728
    s_cmp_eq_u32 s77, s8
    s_cselect_b32 s77, s5, s77
    s_add_u32 s78, s77, 73728
    s_cmp_eq_u32 s78, s8
    s_cselect_b32 s78, s5, s78
    s_add_u32 s79, s78, 73728
    s_cmp_eq_u32 s79, s8
    s_cselect_b32 s79, s5, s79
    s_add_u32 s80, s79, 73728
    s_cmp_eq_u32 s80, s8
    s_cselect_b32 s80, s5, s80
    s_add_u32 s81, s80, 73728
    s_cmp_eq_u32 s81, s8
    s_cselect_b32 s81, s5, s81
    v_lshrrev_b32 v24, 4, v2
    v_and_b32 v25, 15, v2
    v_lshlrev_b32 v26, 1, v24
    v_xor_b32 v25, v25, v26
    v_mul_u32_u24 v24, 9216, v24
    v_lshl_add_u32 v24, v25, 4, v24
    s_mul_i32 s7, s3, 147456
    s_lshl_b32 s8, s69, 8
    s_add_u32 s7, s7, s8
    v_add_u32 v148, s7, v24
    v_add_u32 v149, 35840, v148
    v_xor_b32 v24, 128, v148
    v_add_u32 v150, 71680, v24
    v_add_u32 v151, 35840, v150
    s_mov_b32 s9, 144896
    s_mov_b32 s11, 114688
    v_mul_u32_u24 v48, 1216, v3
    v_mad_u32_u24 v48, v4, 12, v48
    v_add_u32 v48, s9, v48
    v_mov_b32 v47, 0x40000000
    v_lshlrev_b32 v3, 3, v3
    s_lshl_b32 s5, s68, 6
    s_add_u32 s5, s5, 12386304
    v_cmp_eq_u32 vcc, 0, v4
    s_nop 1
    v_cndmask_b32 v49, v47, v3, vcc
    v_lshrrev_b32 v5, 4, v0
    v_and_b32 v4, 3, v2
    v_lshlrev_b32 v4, 3, v4
    v_lshl_add_u32 v5, v5, 5, v4
    v_bfe_u32 v6, v2, 2, 2
    v_mul_u32_u24 v4, 1216, v6
    v_mul_u32_u24 v6, 1152, v6
    v_add3_u32 v50, v4, v5, s9
    v_add3_u32 v51, v6, v5, s11
    s_mul_i32 s4, s3, 2176
    v_add_u32 v55, s4, v51
    v_lshlrev_b32 v52, 4, v0
    s_add_u32 s7, s15, 4096
    s_add_u32 s8, s15, 8192
    s_cmp_eq_u32 s3, 0
    s_cselect_b32 s8, s8, 0x40000000
    v_add_u32 v53, 2359296, v52
    v_mov_b32 v54, 0
    s_mul_i32 s4, s3, 1028
    s_sub_u32 s4, 8204, s4
    v_add_u32 v90, s4, v53
    s_bfe_u32 s6, s68, 0x20001
    s_lshl_b32 s6, s6, 6
    s_lshr_b32 s9, s68, 3
    s_lshl1_add_u32 s6, s9, s6
    s_and_b32 s9, s68, 1
    s_add_u32 s6, s6, s9
    s_lshl_b32 s4, s6, 2
    s_add_u32 s4, s4, 12533760
    v_lshl_add_u32 v1, v0, 10, s4
    s_lshl_b32 s4, s68, 2
    s_add_u32 s4, s4, 12599296
    v_lshl_add_u32 v46, v0, 10, s4
    v_cmp_gt_u32 vcc, 8, v0
    s_nop 1
    v_cndmask_b32 v1, v47, v1, vcc
    v_cmp_gt_u32 vcc, 4, v0
    s_nop 1
    v_cndmask_b32 v46, v47, v46, vcc
    s_waitcnt vmcnt(9)
    v_and_b32 v21, 0xffff0000, v8
    s_add_u32 m0, s73, 81920
    s_lshl_b32 s14, s18, 3
    buffer_load_dwordx4 v148, s[48:51], s14 offen offset:0 lds
    v_lshlrev_b32 v20, 16, v8
    v_and_b32 v23, 0xffff0000, v9
    v_lshlrev_b32 v22, 16, v9
    v_and_b32 v25, 0xffff0000, v10
    v_lshlrev_b32 v24, 16, v10
    v_and_b32 v27, 0xffff0000, v12
    v_lshlrev_b32 v26, 16, v12
    v_and_b32 v29, 0xffff0000, v13
    v_lshlrev_b32 v28, 16, v13
    v_and_b32 v31, 0xffff0000, v14
    v_lshlrev_b32 v30, 16, v14
    v_and_b32 v33, 0xffff0000, v16
    v_lshlrev_b32 v32, 16, v16
    v_and_b32 v35, 0xffff0000, v17
    v_lshlrev_b32 v34, 16, v17
    v_and_b32 v37, 0xffff0000, v18
    v_lshlrev_b32 v36, 16, v18
    v_pk_add_f32 v[38:39], v[20:21], v[22:23]
    v_pk_add_f32 v[40:41], v[24:25], v[26:27]
    v_pk_add_f32 v[42:43], v[28:29], v[30:31]
    v_pk_add_f32 v[44:45], v[32:33], v[34:35]
    v_pk_add_f32 v[38:39], v[38:39], v[40:41]
    v_pk_add_f32 v[42:43], v[42:43], v[44:45]
    v_pk_add_f32 v[38:39], v[38:39], v[36:37]
    v_pk_add_f32 v[38:39], v[38:39], v[42:43]
    v_add_f32 v56, v38, v39
    buffer_load_dwordx4 v149, s[48:51], s14 offen offset:1024 lds
    s_nop 0
    v_add_f32_dpp v56, v56, v56 row_ror:8 row_mask:0xf bank_mask:0xf
    s_nop 1
    v_add_f32_dpp v56, v56, v56 row_ror:4 row_mask:0xf bank_mask:0xf
    s_nop 1
    v_add_f32_dpp v56, v56, v56 row_ror:2 row_mask:0xf bank_mask:0xf
    s_nop 1
    v_add_f32_dpp v56, v56, v56 row_ror:1 row_mask:0xf bank_mask:0xf
    v_mov_b32 v57, v56
    s_nop 1
    v_permlane16_swap_b32 v56, v57
    v_add_f32 v56, v56, v57
    v_mul_f32 v56, 0x3ae38e39, v56
    v_pk_add_f32 v[20:21], v[20:21], v[56:57] op_sel_hi:[1,0] neg_lo:[0,1] neg_hi:[0,1]
    v_pk_add_f32 v[22:23], v[22:23], v[56:57] op_sel_hi:[1,0] neg_lo:[0,1] neg_hi:[0,1]
    v_pk_add_f32 v[24:25], v[24:25], v[56:57] op_sel_hi:[1,0] neg_lo:[0,1] neg_hi:[0,1]
    v_pk_add_f32 v[26:27], v[26:27], v[56:57] op_sel_hi:[1,0] neg_lo:[0,1] neg_hi:[0,1]
    v_pk_add_f32 v[28:29], v[28:29], v[56:57] op_sel_hi:[1,0] neg_lo:[0,1] neg_hi:[0,1]
    v_pk_add_f32 v[30:31], v[30:31], v[56:57] op_sel_hi:[1,0] neg_lo:[0,1] neg_hi:[0,1]
    v_pk_add_f32 v[32:33], v[32:33], v[56:57] op_sel_hi:[1,0] neg_lo:[0,1] neg_hi:[0,1]
    v_pk_add_f32 v[34:35], v[34:35], v[56:57] op_sel_hi:[1,0] neg_lo:[0,1] neg_hi:[0,1]
    v_pk_add_f32 v[36:37], v[36:37], v[56:57] op_sel_hi:[1,0] neg_lo:[0,1] neg_hi:[0,1]
    v_pk_mul_f32 v[38:39], v[20:21], v[20:21]
    v_pk_mul_f32 v[40:41], v[22:23], v[22:23]
    v_pk_fma_f32 v[38:39], v[24:25], v[24:25], v[38:39]
    v_pk_fma_f32 v[40:41], v[26:27], v[26:27], v[40:41]
    v_pk_fma_f32 v[38:39], v[28:29], v[28:29], v[38:39]
    v_pk_fma_f32 v[40:41], v[30:31], v[30:31], v[40:41]
    v_pk_fma_f32 v[38:39], v[32:33], v[32:33], v[38:39]
    v_pk_fma_f32 v[40:41], v[34:35], v[34:35], v[40:41]
    v_pk_fma_f32 v[38:39], v[36:37], v[36:37], v[38:39]
    buffer_load_dwordx4 v150, s[48:51], s14 offen offset:2048 lds
    v_pk_add_f32 v[38:39], v[38:39], v[40:41]
    v_add_f32 v18, v38, v39
    s_nop 1
    v_add_f32_dpp v18, v18, v18 row_ror:8 row_mask:0xf bank_mask:0xf
    s_nop 1
    v_add_f32_dpp v18, v18, v18 row_ror:4 row_mask:0xf bank_mask:0xf
    s_nop 1
    v_add_f32_dpp v18, v18, v18 row_ror:2 row_mask:0xf bank_mask:0xf
    s_nop 1
    v_add_f32_dpp v18, v18, v18 row_ror:1 row_mask:0xf bank_mask:0xf
    v_mov_b32 v19, v18
    s_nop 1
    v_permlane16_swap_b32 v18, v19
    v_add_f32 v18, v18, v19
    v_mul_f32 v18, 0x3ae38e39, v18
    v_cvt_pk_bf16_f32 v38, v56, v18
    v_lshlrev_b32 v106, 16, v38
    v_and_b32 v38, 0xffff0000, v38
    v_add_f32 v38, 0x3727c5ac, v38
    v_sub_f32 v56, v56, v106
    v_cvt_pk_bf16_f32 v38, v38, v38
    v_lshlrev_b32 v38, 16, v38
    v_sqrt_f32 v38, v38
    s_nop 0
    v_cvt_pk_bf16_f32 v38, v38, v38
    v_lshlrev_b32 v38, 16, v38
    v_rcp_f32 v107, v38
    s_nop 0
    v_mul_f32 v56, v56, v107
    v_mul_f32 v18, v18, v107
    v_mul_f32 v18, v18, v107
    v_cvt_pk_bf16_f32 v38, v56, v18
    v_lshlrev_b32 v39, 16, v38
    buffer_load_dwordx4 v151, s[48:51], s14 offen offset:3072 lds
    v_and_b32 v38, 0xffff0000, v38
    v_add_f32 v38, 0x3727c5ac, v38
    v_sub_f32 v56, v56, v39
    v_cvt_pk_bf16_f32 v38, v38, v38
    v_lshlrev_b32 v38, 16, v38
    v_sqrt_f32 v38, v38
    s_nop 0
    v_cvt_pk_bf16_f32 v38, v38, v38
    v_lshlrev_b32 v38, 16, v38
    v_rcp_f32 v38, v38
    s_nop 0
    v_mul_f32 v18, v107, v38
    v_mul_f32 v56, v56, v38
    v_pk_fma_f32 v[20:21], v[20:21], v[18:19], v[56:57] op_sel_hi:[1,0,0]
    v_pk_fma_f32 v[22:23], v[22:23], v[18:19], v[56:57] op_sel_hi:[1,0,0]
    v_pk_fma_f32 v[24:25], v[24:25], v[18:19], v[56:57] op_sel_hi:[1,0,0]
    v_pk_fma_f32 v[26:27], v[26:27], v[18:19], v[56:57] op_sel_hi:[1,0,0]
    v_pk_fma_f32 v[28:29], v[28:29], v[18:19], v[56:57] op_sel_hi:[1,0,0]
    v_pk_fma_f32 v[30:31], v[30:31], v[18:19], v[56:57] op_sel_hi:[1,0,0]
    v_pk_fma_f32 v[32:33], v[32:33], v[18:19], v[56:57] op_sel_hi:[1,0,0]
    v_pk_fma_f32 v[34:35], v[34:35], v[18:19], v[56:57] op_sel_hi:[1,0,0]
    v_pk_fma_f32 v[36:37], v[36:37], v[18:19], v[56:57] op_sel_hi:[1,0,0]
    v_cvt_pk_bf16_f32 v8, v20, v21
    v_cvt_pk_bf16_f32 v9, v22, v23
    v_cvt_pk_bf16_f32 v10, v24, v25
    v_cvt_pk_bf16_f32 v11, v26, v27
    v_cvt_pk_bf16_f32 v12, v28, v29
    v_cvt_pk_bf16_f32 v13, v30, v31
    v_cvt_pk_bf16_f32 v14, v32, v33
    v_cvt_pk_bf16_f32 v15, v34, v35
    v_cvt_pk_bf16_f32 v16, v36, v37
    ds_write_b32 v48, v8 offset:0
    ds_write_b32 v48, v9 offset:4
    ds_write_b32 v48, v10 offset:8
    ds_write_b32 v48, v11 offset:384
    ds_write_b32 v48, v12 offset:388
    ds_write_b32 v48, v13 offset:392
    ds_write_b32 v48, v14 offset:768
    ds_write_b32 v48, v15 offset:772
    ds_write_b32 v48, v16 offset:776
    buffer_store_dwordx2 v[106:107], v49, s[44:47], s5 offen sc1
    s_waitcnt lgkmcnt(0)
    s_barrier
    ds_read_b64_tr_b16 v[20:21], v50 offset:0
    ds_read_b64_tr_b16 v[22:23], v50 offset:4864
    ds_read_b64_tr_b16 v[24:25], v50 offset:512
    ds_read_b64_tr_b16 v[26:27], v50 offset:5376
    ds_read_b64_tr_b16 v[28:29], v50 offset:1024
    ds_read_b64_tr_b16 v[30:31], v50 offset:5888
    s_waitcnt lgkmcnt(4)
    buffer_store_dwordx4 v[20:23], v52, s[44:47], s15 offen sc1
    s_waitcnt lgkmcnt(2)
    buffer_store_dwordx4 v[24:27], v52, s[44:47], s7 offen sc1
    s_waitcnt lgkmcnt(0)
    buffer_store_dwordx4 v[28:31], v52, s[44:47], s8 offen sc1
    buffer_load_dword v45, v54, s[64:67], 0 offen sc1
    s_waitcnt vmcnt(9)
    s_barrier
    ds_read_b64_tr_b16 v[60:61], v51 offset:0
    ds_read_b64_tr_b16 v[62:63], v51 offset:4608
    ds_read_b64_tr_b16 v[64:65], v51 offset:9216
    ds_read_b64_tr_b16 v[66:67], v51 offset:12672
    ds_read_b64_tr_b16 v[68:69], v51 offset:17280
    ds_read_b64_tr_b16 v[70:71], v51 offset:512
    ds_read_b64_tr_b16 v[72:73], v51 offset:5120
    ds_read_b64_tr_b16 v[74:75], v51 offset:9728
    ds_read_b64_tr_b16 v[76:77], v51 offset:13184
    ds_read_b64_tr_b16 v[78:79], v51 offset:17792
    v_alignbit_b32 v114, v99, v99, 16
    v_alignbit_b32 v115, v98, v98, 16
    s_waitcnt lgkmcnt(5)
    v_alignbit_b32 v108, v61, v60, 16
    v_alignbit_b32 v109, v62, v61, 16
    v_alignbit_b32 v110, v63, v62, 16
    v_alignbit_b32 v111, v64, v63, 16
    v_alignbit_b32 v112, v65, v64, 16
    v_dot2_f32_bf16 v116, v60, v114, 0
    ds_read_b64_tr_b16 v[80:81], v51 offset:1024
    v_dot2_f32_bf16 v117, v108, v114, 0
    v_dot2_f32_bf16 v118, v61, v114, 0
    v_dot2_f32_bf16 v119, v109, v114, 0
    v_dot2_f32_bf16 v120, v62, v114, 0
    ds_read_b64_tr_b16 v[82:83], v51 offset:5632
    v_dot2_f32_bf16 v121, v110, v114, 0
    v_dot2_f32_bf16 v122, v63, v114, 0
    v_dot2_f32_bf16 v123, v111, v114, 0
    v_dot2_f32_bf16 v116, v61, v115, v116
    v_dot2_f32_bf16 v117, v109, v115, v117
    ds_read_b64_tr_b16 v[84:85], v51 offset:10240
    v_dot2_f32_bf16 v118, v62, v115, v118
    v_dot2_f32_bf16 v119, v110, v115, v119
    v_dot2_f32_bf16 v120, v63, v115, v120
    v_dot2_f32_bf16 v121, v111, v115, v121
    v_dot2_f32_bf16 v122, v64, v115, v122
    ds_read_b64_tr_b16 v[86:87], v51 offset:13696
    v_dot2_f32_bf16 v123, v112, v115, v123
    v_and_b32 v133, 0xffff0000, v66
    v_lshlrev_b32 v132, 16, v66
    v_and_b32 v135, 0xffff0000, v67
    v_lshlrev_b32 v134, 16, v67
    ds_read_b64_tr_b16 v[88:89], v51 offset:18304
    v_and_b32 v137, 0xffff0000, v68
    v_lshlrev_b32 v136, 16, v68
    v_and_b32 v139, 0xffff0000, v69
    v_lshlrev_b32 v138, 16, v69
    v_pk_mul_f32 v[116:117], v[116:117], v[132:133]
    v_pk_mul_f32 v[118:119], v[118:119], v[134:135]
    v_pk_mul_f32 v[120:121], v[120:121], v[136:137]
    v_pk_mul_f32 v[122:123], v[122:123], v[138:139]
    v_cvt_pk_bf16_f32 v160, v123, v122
    v_cvt_pk_bf16_f32 v161, v121, v120
    v_cvt_pk_bf16_f32 v162, v119, v118
    v_cvt_pk_bf16_f32 v163, v117, v116
    buffer_store_dwordx4 v[160:163], v53, s[44:47], s15 offen sc1
    v_alignbit_b32 v114, v101, v101, 16
    v_alignbit_b32 v115, v100, v100, 16
    s_waitcnt lgkmcnt(5)
    v_alignbit_b32 v108, v71, v70, 16
    v_alignbit_b32 v109, v72, v71, 16
    v_alignbit_b32 v110, v73, v72, 16
    v_alignbit_b32 v111, v74, v73, 16
    v_alignbit_b32 v112, v75, v74, 16
    v_dot2_f32_bf16 v124, v70, v114, 0
    v_dot2_f32_bf16 v125, v108, v114, 0
    v_dot2_f32_bf16 v126, v71, v114, 0
    v_dot2_f32_bf16 v127, v109, v114, 0
    v_dot2_f32_bf16 v128, v72, v114, 0
    v_dot2_f32_bf16 v129, v110, v114, 0
    v_dot2_f32_bf16 v130, v73, v114, 0
    v_dot2_f32_bf16 v131, v111, v114, 0
    v_dot2_f32_bf16 v124, v71, v115, v124
    v_dot2_f32_bf16 v125, v109, v115, v125
    v_dot2_f32_bf16 v126, v72, v115, v126
    v_dot2_f32_bf16 v127, v110, v115, v127
    v_dot2_f32_bf16 v128, v73, v115, v128
    v_dot2_f32_bf16 v129, v111, v115, v129
    v_dot2_f32_bf16 v130, v74, v115, v130
    v_dot2_f32_bf16 v131, v112, v115, v131
    v_and_b32 v133, 0xffff0000, v76
    v_lshlrev_b32 v132, 16, v76
    v_and_b32 v135, 0xffff0000, v77
    v_lshlrev_b32 v134, 16, v77
    v_and_b32 v137, 0xffff0000, v78
    v_lshlrev_b32 v136, 16, v78
    v_and_b32 v139, 0xffff0000, v79
    v_lshlrev_b32 v138, 16, v79
    v_pk_mul_f32 v[124:125], v[124:125], v[132:133]
    v_pk_mul_f32 v[126:127], v[126:127], v[134:135]
    v_pk_mul_f32 v[128:129], v[128:129], v[136:137]
    v_pk_mul_f32 v[130:131], v[130:131], v[138:139]
    v_cvt_pk_bf16_f32 v164, v131, v130
    v_cvt_pk_bf16_f32 v165, v129, v128
    v_cvt_pk_bf16_f32 v166, v127, v126
    v_cvt_pk_bf16_f32 v167, v125, v124
    buffer_store_dwordx4 v[164:167], v53, s[44:47], s7 offen sc1
    v_alignbit_b32 v114, v103, v103, 16
    v_alignbit_b32 v115, v102, v102, 16
    s_waitcnt lgkmcnt(0)
    v_alignbit_b32 v108, v81, v80, 16
    v_alignbit_b32 v109, v82, v81, 16
    v_alignbit_b32 v110, v83, v82, 16
    v_alignbit_b32 v111, v84, v83, 16
    v_alignbit_b32 v112, v85, v84, 16
    v_dot2_f32_bf16 v116, v80, v114, 0
    v_dot2_f32_bf16 v117, v108, v114, 0
    v_dot2_f32_bf16 v118, v81, v114, 0
    v_dot2_f32_bf16 v119, v109, v114, 0
    v_dot2_f32_bf16 v120, v82, v114, 0
    v_dot2_f32_bf16 v121, v110, v114, 0
    v_dot2_f32_bf16 v122, v83, v114, 0
    v_dot2_f32_bf16 v123, v111, v114, 0
    v_dot2_f32_bf16 v116, v81, v115, v116
    v_dot2_f32_bf16 v117, v109, v115, v117
    v_dot2_f32_bf16 v118, v82, v115, v118
    v_dot2_f32_bf16 v119, v110, v115, v119
    v_dot2_f32_bf16 v120, v83, v115, v120
    v_dot2_f32_bf16 v121, v111, v115, v121
    v_dot2_f32_bf16 v122, v84, v115, v122
    v_dot2_f32_bf16 v123, v112, v115, v123
    v_and_b32 v133, 0xffff0000, v86
    v_lshlrev_b32 v132, 16, v86
    v_and_b32 v135, 0xffff0000, v87
    v_lshlrev_b32 v134, 16, v87
    v_and_b32 v137, 0xffff0000, v88
    v_lshlrev_b32 v136, 16, v88
    v_and_b32 v139, 0xffff0000, v89
    v_lshlrev_b32 v138, 16, v89
    v_pk_mul_f32 v[116:117], v[116:117], v[132:133]
    v_pk_mul_f32 v[118:119], v[118:119], v[134:135]
    v_pk_mul_f32 v[120:121], v[120:121], v[136:137]
    v_pk_mul_f32 v[122:123], v[122:123], v[138:139]
    v_cvt_pk_bf16_f32 v168, v123, v122
    v_cvt_pk_bf16_f32 v169, v121, v120
    v_cvt_pk_bf16_f32 v170, v119, v118
    v_cvt_pk_bf16_f32 v171, v117, v116
    buffer_store_dwordx4 v[168:171], v53, s[44:47], s8 offen sc1
    s_add_u32 m0, s73, 98304
    s_lshl_b32 s14, s19, 3
    buffer_load_dwordx4 v148, s[48:51], s14 offen offset:0 lds
    buffer_load_dwordx4 v149, s[48:51], s14 offen offset:1024 lds
    buffer_load_dwordx4 v150, s[48:51], s14 offen offset:2048 lds
    buffer_load_dwordx4 v151, s[48:51], s14 offen offset:3072 lds
    s_add_u32 m0, s73, 0
    s_lshl_b32 s14, s20, 3
    buffer_load_dwordx4 v148, s[48:51], s14 offen offset:0 lds
    buffer_load_dwordx4 v149, s[48:51], s14 offen offset:1024 lds
    buffer_load_dwordx4 v150, s[48:51], s14 offen offset:2048 lds
    buffer_load_dwordx4 v151, s[48:51], s14 offen offset:3072 lds
    s_add_u32 m0, s73, 16384
    s_lshl_b32 s14, s21, 3
    buffer_load_dwordx4 v148, s[48:51], s14 offen offset:0 lds
    buffer_load_dwordx4 v149, s[48:51], s14 offen offset:1024 lds
    s_waitcnt vmcnt(13)
    v_readfirstlane_b32 s68, v45
    s_nop 1
    s_cmp_eq_u32 s68, 0
    s_cbranch_scc1 L_nw_G
L_ng_G:
    s_barrier
    v_mov_b32 v3, s68
    buffer_store_dword v3, v1, s[44:47], 0 offen sc1
    s_mov_b64 exec, 0
    s_call_b64 s[82:83], L_wc_G
    s_mov_b64 exec, -1
    s_waitcnt vmcnt(11)
    s_barrier
    buffer_store_dword v3, v46, s[44:47], 0 offen sc1
L_segG:
L_pl_G_0:
    s_cbranch_execz L_pl_G_4
    buffer_load_dwordx4 v150, s[48:51], s14 offen offset:2048 lds
    buffer_load_dwordx4 v151, s[48:51], s14 offen offset:3072 lds
    s_add_u32 m0, s73, 32768
    s_lshl_b32 s14, s22, 3
    buffer_load_dwordx4 v148, s[48:51], s14 offen offset:0 lds
    buffer_load_dwordx4 v149, s[48:51], s14 offen offset:1024 lds
    buffer_load_dwordx4 v150, s[48:51], s14 offen offset:2048 lds
    buffer_load_dwordx4 v151, s[48:51], s14 offen offset:3072 lds
    s_add_u32 m0, s73, 49152
    s_lshl_b32 s14, s23, 3
    buffer_load_dwordx4 v148, s[48:51], s14 offen offset:0 lds
    buffer_load_dwordx4 v149, s[48:51], s14 offen offset:1024 lds
    buffer_load_dwordx4 v150, s[48:51], s14 offen offset:2048 lds
    buffer_load_dwordx4 v151, s[48:51], s14 offen offset:3072 lds
    s_add_u32 m0, s73, 65536
    s_lshl_b32 s14, s24, 3
    buffer_load_dwordx4 v148, s[48:51], s14 offen offset:0 lds
    buffer_load_dwordx4 v149, s[48:51], s14 offen offset:1024 lds
    buffer_load_dwordx4 v150, s[48:51], s14 offen offset:2048 lds
    buffer_load_dwordx4 v151, s[48:51], s14 offen offset:3072 lds
    v_bfe_u32 v140, v2, 2, 2
    v_lshrrev_b32 v141, 4, v2
    v_lshl_add_u32 v142, v141, 3, v140
    v_lshlrev_b32 v142, 8, v142
    v_and_b32 v143, 3, v2
    v_lshl_add_u32 v142, v143, 3, v142
    v_and_b32 v141, 1, v141
    v_lshl_add_u32 v140, v141, 2, v140
    s_lshl_b32 s7, s3, 1
    v_xor_b32 v140, s7, v140
    v_lshl_add_u32 v152, v140, 5, v142
    v_xor_b32 v153, 32, v152
    v_add_u32 v154, 0x10000, v152
    v_add_u32 v155, 0x10000, v153
    v_and_b32 v24, 15, v2
    v_lshrrev_b32 v25, 4, v2
    v_mul_u32_u24 v26, 17408, v25
    v_lshl_add_u32 v26, v24, 4, v26
    v_mul_u32_u24 v25, 1536, v25
    v_lshl_add_u32 v25, v24, 4, v25
    v_add_u32 v159, 81920, v25
    v_add_u32 v250, 36864, v159
    s_mul_i32 s7, s3, 18432
    s_xor_b32 s8, s70, 1
    s_mul_i32 s8, s8, 1536
    s_add_u32 s7, s7, s8
    v_lshlrev_b32 v246, 4, v2
    v_add_u32 v156, s7, v246
    v_lshrrev_b32 v25, 5, v2
    v_mul_u32_u24 v25, 7680, v25
    v_add_u32 v157, v156, v25
    v_add_u32 v158, 7680, v156
    s_mul_i32 s74, s3, 3072
    s_add_u32 s74, s74, 81920
    v_mov_b32 v245, v26
    s_mov_b64 exec, 0
    s_call_b64 s[82:83], L_wc_D
    s_mov_b64 exec, -1
    s_mov_b32 s56, s32
    s_and_b32 s57, s33, 0xffff
    s_mov_b32 s58, 9216
    s_mov_b32 s59, 0x20000
    s_mov_b32 s60, s36
    s_and_b32 s61, s37, 0xffff
    s_mov_b32 s62, 4096
    s_mov_b32 s63, 0x20000
    s_and_b32 s4, s70, 1
    s_lshl1_add_u32 s4, s3, s4
    s_lshl_b32 s4, s4, 7
    s_bfe_u32 s5, s2, 0x10003
    s_lshl1_add_u32 s5, s72, s5
    s_lshr_b32 s5, s5, 0
    s_lshl_b32 s5, s5, 10
    s_add_u32 s4, s4, s5
    s_add_u32 s4, s4, 12533760
    v_lshl_add_u32 v28, v2, 2, s4
    v_cmp_gt_u32 vcc, 32, v2
    v_mov_b32 v12, 0x40000000
    s_nop 0
    v_cndmask_b32 v28, v12, v28, vcc
    v_mov_b32 v12, s68
    v_cndmask_b32 v12, 0, v12, vcc
    v_lshrrev_b32 v24, 4, v2
    v_lshlrev_b32 v25, 3, v24
    s_lshl_b32 s7, s69, 8
    s_lshl_b32 s8, s3, 6
    s_add_u32 s7, s7, s8
    buffer_load_dwordx2 v[144:145], v25, s[56:59], s7 offen
    buffer_load_dwordx2 v[146:147], v25, s[56:59], s7 offen offset:32
    s_waitcnt vmcnt(24)
    s_barrier
    ds_read_b64_tr_b16 a[0:1], v154 offset:16384
    ds_read_b64_tr_b16 a[2:3], v154 offset:17408
    ds_read_b64_tr_b16 a[4:5], v155 offset:16384
    ds_read_b64_tr_b16 a[6:7], v155 offset:17408
    ds_read_b64_tr_b16 a[8:9], v154 offset:24576
    ds_read_b64_tr_b16 a[10:11], v154 offset:25600
    ds_read_b64_tr_b16 a[12:13], v155 offset:24576
    ds_read_b64_tr_b16 a[14:15], v155 offset:25600
    ds_read_b64_tr_b16 a[16:17], v154 offset:32768
    ds_read_b64_tr_b16 a[18:19], v154 offset:33792
    ds_read_b64_tr_b16 a[20:21], v155 offset:32768
    ds_read_b64_tr_b16 a[22:23], v155 offset:33792
    ds_read_b64_tr_b16 a[24:25], v154 offset:40960
    ds_read_b64_tr_b16 a[26:27], v154 offset:41984
    ds_read_b64_tr_b16 a[28:29], v155 offset:40960
    ds_read_b64_tr_b16 a[30:31], v155 offset:41984
    s_waitcnt vmcnt(20)
    s_barrier
    ds_read_b64_tr_b16 a[32:33], v152 offset:0
    ds_read_b64_tr_b16 a[34:35], v152 offset:1024
    ds_read_b64_tr_b16 a[36:37], v153 offset:0
    ds_read_b64_tr_b16 a[38:39], v153 offset:1024
    ds_read_b64_tr_b16 a[40:41], v152 offset:8192
    ds_read_b64_tr_b16 a[42:43], v152 offset:9216
    ds_read_b64_tr_b16 a[44:45], v153 offset:8192
    ds_read_b64_tr_b16 a[46:47], v153 offset:9216
    s_waitcnt vmcnt(14)
    s_barrier
    ds_read_b64_tr_b16 a[48:49], v152 offset:16384
    ds_read_b64_tr_b16 a[50:51], v152 offset:17408
    ds_read_b64_tr_b16 a[52:53], v153 offset:16384
    ds_read_b64_tr_b16 a[54:55], v153 offset:17408
    ds_read_b64_tr_b16 a[56:57], v152 offset:24576
    ds_read_b64_tr_b16 a[58:59], v152 offset:25600
    ds_read_b64_tr_b16 a[60:61], v153 offset:24576
    ds_read_b64_tr_b16 a[62:63], v153 offset:25600
    v_mov_b32 v29, 0
    buffer_atomic_add v29, v28, s[44:47], 0 offen sc0 sc1
    s_waitcnt vmcnt(11)
    s_barrier
    ds_read_b64_tr_b16 a[64:65], v152 offset:32768
    ds_read_b64_tr_b16 a[66:67], v152 offset:33792
    ds_read_b64_tr_b16 a[68:69], v153 offset:32768
    ds_read_b64_tr_b16 a[70:71], v153 offset:33792
    ds_read_b64_tr_b16 a[72:73], v152 offset:40960
    ds_read_b64_tr_b16 a[74:75], v152 offset:41984
    ds_read_b64_tr_b16 a[76:77], v153 offset:40960
    ds_read_b64_tr_b16 a[78:79], v153 offset:41984
    s_waitcnt lgkmcnt(0)
    s_barrier
    s_waitcnt vmcnt(0)
    v_cmp_ne_u32 vcc, v12, v29
    s_cbranch_vccnz L_rs_p1G
L_ok_p1G:
    s_add_u32 m0, s74, 0
    s_nop 0
    buffer_load_dwordx4 v156, s[44:47], s18 offen offset:0 sc1 lds
    buffer_load_dwordx4 v157, s[44:47], s18 offen offset:1024 sc1 lds
    buffer_load_dwordx4 v158, s[44:47], s18 offen offset:2048 sc1 lds
    s_add_u32 m0, s74, 12288
    s_nop 0
    buffer_load_dwordx4 v156, s[44:47], s19 offen offset:0 sc1 lds
    buffer_load_dwordx4 v157, s[44:47], s19 offen offset:1024 sc1 lds
    buffer_load_dwordx4 v158, s[44:47], s19 offen offset:2048 sc1 lds
    s_add_u32 m0, s74, 24576
    s_nop 0
    buffer_load_dwordx4 v156, s[44:47], s20 offen offset:0 sc1 lds
    buffer_load_dwordx4 v157, s[44:47], s20 offen offset:1024 sc1 lds
    buffer_load_dwordx4 v158, s[44:47], s20 offen offset:2048 sc1 lds
L_pl_G_1:
    s_cbranch_execz L_pl_G_5
    s_add_u32 m0, s74, 36864
    s_nop 0
    buffer_load_dwordx4 v156, s[44:47], s21 offen offset:0 sc1 lds
    buffer_load_dwordx4 v157, s[44:47], s21 offen offset:1024 sc1 lds
    buffer_load_dwordx4 v158, s[44:47], s21 offen offset:2048 sc1 lds
    s_add_u32 m0, s73, 0
    s_lshl_b32 s14, s25, 3
    buffer_load_dwordx4 v148, s[48:51], s14 offen offset:0 lds
    buffer_load_dwordx4 v149, s[48:51], s14 offen offset:1024 lds
    buffer_load_dwordx4 v150, s[48:51], s14 offen offset:2048 lds
    buffer_load_dwordx4 v151, s[48:51], s14 offen offset:3072 lds
    s_waitcnt vmcnt(13) lgkmcnt(0)
    s_barrier
    ds_read_b128 v[80:83], v159 offset:0
    ds_read_b128 v[84:87], v159 offset:6144
    ds_read_b128 v[88:91], v159 offset:256
    ds_read_b128 v[92:95], v159 offset:6400
    ds_read_b128 v[96:99], v159 offset:512
    ds_read_b128 v[100:103], v159 offset:6656
    s_waitcnt lgkmcnt(0)
    v_mfma_f32_16x16x32_bf16 v[192:195], a[0:3], v[80:83], 0
    v_mfma_f32_16x16x32_bf16 v[192:195], a[8:11], v[84:87], v[192:195]
    ds_read_b128 v[104:107], v159 offset:768
    v_mfma_f32_16x16x32_bf16 v[196:199], a[12:15], v[84:87], 0
    ds_read_b128 v[108:111], v159 offset:6912
    v_mfma_f32_16x16x32_bf16 v[196:199], a[4:7], v[80:83], v[196:199]
    ds_read_b128 v[112:115], v159 offset:1024
    v_mfma_f32_16x16x32_bf16 v[204:207], a[4:7], v[88:91], 0
    ds_read_b128 v[116:119], v159 offset:7168
    v_mfma_f32_16x16x32_bf16 v[204:207], a[12:15], v[92:95], v[204:207]
    ds_read_b128 v[120:123], v159 offset:1280
    v_mfma_f32_16x16x32_bf16 v[200:203], a[8:11], v[92:95], 0
    ds_read_b128 v[124:127], v159 offset:7424
    v_and_b32 v24, 15, v2
    s_lshl_b32 s7, s71, 6
    v_add_u32 v24, s7, v24
    s_and_b32 s8, s3, 1
    s_lshl_b32 s4, s8, 5
    v_add_u32 v25, s4, v24
    v_lshlrev_b32 v26, 3, v25
    v_mul_u32_u24 v25, 1152, v25
    v_bfe_u32 v31, v2, 4, 1
    v_lshl_add_u32 v25, v31, 5, v25
    v_lshrrev_b32 v31, 5, v2
    v_lshl_add_u32 v25, v31, 4, v25
    s_bfe_u32 s7, s2, 0x20003
    s_mul_i32 s7, s7, 288
    s_lshl_b32 s4, s72, 6
    s_add_u32 s4, s4, s7
    v_add_u32 v252, s4, v25
    s_xor_b32 s8, s3, s72
    s_and_b32 s4, s72, 1
    s_lshl1_add_u32 s4, s4, s8
    v_lshl_add_u32 v24, s4, 4, v24
    s_add_u32 s7, s7, 256
    s_cmp_lt_u32 s8, 2
    s_cselect_b32 s7, s7, 0x40000000
    v_lshlrev_b32 v18, 3, v24
    v_mul_u32_u24 v24, 1152, v24
    v_lshrrev_b32 v31, 4, v2
    v_mfma_f32_16x16x32_bf16 v[200:203], a[0:3], v[88:91], v[200:203]
    v_mfma_f32_16x16x32_bf16 v[208:211], a[0:3], v[96:99], 0
    v_mfma_f32_16x16x32_bf16 v[208:211], a[8:11], v[100:103], v[208:211]
    v_mfma_f32_16x16x32_bf16 v[212:215], a[12:15], v[100:103], 0
    v_mfma_f32_16x16x32_bf16 v[212:215], a[4:7], v[96:99], v[212:215]
    s_waitcnt lgkmcnt(0)
    v_mfma_f32_16x16x32_bf16 v[220:223], a[4:7], v[104:107], 0
    s_waitcnt vmcnt(10)
    s_barrier
    v_mfma_f32_16x16x32_bf16 v[220:223], a[12:15], v[108:111], v[220:223]
    ds_read_b128 v[80:83], v159 offset:12288
    s_add_u32 m0, s74, 49152
    v_mfma_f32_16x16x32_bf16 v[216:219], a[8:11], v[108:111], 0
    ds_read_b128 v[84:87], v159 offset:18432
    buffer_load_dwordx4 v156, s[44:47], s22 offen offset:0 sc1 lds
    v_mfma_f32_16x16x32_bf16 v[216:219], a[0:3], v[104:107], v[216:219]
    ds_read_b128 v[88:91], v159 offset:12544
    v_mfma_f32_16x16x32_bf16 v[224:227], a[0:3], v[112:115], 0
    ds_read_b128 v[92:95], v159 offset:18688
    buffer_load_dwordx4 v157, s[44:47], s22 offen offset:1024 sc1 lds
    v_mfma_f32_16x16x32_bf16 v[224:227], a[8:11], v[116:119], v[224:227]
    ds_read_b128 v[96:99], v159 offset:12800
    v_mfma_f32_16x16x32_bf16 v[228:231], a[12:15], v[116:119], 0
    ds_read_b128 v[100:103], v159 offset:18944
    buffer_load_dwordx4 v158, s[44:47], s22 offen offset:2048 sc1 lds
    v_lshl_add_u32 v24, v31, 3, v24
    v_add_u32 v253, s7, v24
    v_lshrrev_b32 v24, 3, v2
    v_and_b32 v25, 7, v2
    v_bfe_u32 v31, v2, 4, 2
    v_lshlrev_b32 v31, 1, v31
    v_xor_b32 v25, v25, v31
    v_lshlrev_b32 v24, 12, v24
    v_lshl_add_u32 v24, v25, 4, v24
    s_mul_i32 s7, s72, 36
    s_bitcmp1_b32 s3, 0
    s_addc_u32 s7, s7, 0
    s_lshl_b32 s7, s7, 17
    s_lshl_b32 s8, s71, 7
    s_add_u32 s7, s7, s8
    v_add_u32 v4, s7, v24
    v_add_u32 v5, 31744, v4
    v_add_u32 v6, 31744, v5
    v_add_u32 v7, 31744, v6
    v_lshrrev_b32 v24, 2, v2
    v_lshlrev_b32 v24, 7, v24
    v_and_b32 v25, 3, v2
    v_lshl_add_u32 v24, v25, 3, v24
    s_and_b32 s7, s73, 8192
    v_add_u32 v24, s7, v24
    v_bfe_u32 v31, v2, 3, 2
    s_and_b32 s7, s3, 1
    v_mfma_f32_16x16x32_bf16 v[228:231], a[4:7], v[112:115], v[228:231]
    ds_read_b64_tr_b16 a[80:81], v152 offset:49152
    v_mfma_f32_16x16x32_bf16 v[236:239], a[4:7], v[120:123], 0
    ds_read_b64_tr_b16 a[82:83], v152 offset:50176
    s_add_u32 m0, s74, 61440
    v_mfma_f32_16x16x32_bf16 v[236:239], a[12:15], v[124:127], v[236:239]
    v_mfma_f32_16x16x32_bf16 v[232:235], a[8:11], v[124:127], 0
    ds_read_b64_tr_b16 a[84:85], v153 offset:49152
    buffer_load_dwordx4 v156, s[44:47], s23 offen offset:0 sc1 lds
    v_mfma_f32_16x16x32_bf16 v[232:235], a[0:3], v[120:123], v[232:235]
    ds_read_b64_tr_b16 a[86:87], v153 offset:50176
    s_waitcnt lgkmcnt(4)
    v_mfma_f32_16x16x32_bf16 v[192:195], a[16:19], v[80:83], v[192:195]
    buffer_load_dwordx4 v157, s[44:47], s23 offen offset:1024 sc1 lds
    v_mfma_f32_16x16x32_bf16 v[192:195], a[24:27], v[84:87], v[192:195]
    ds_read_b128 v[104:107], v159 offset:13056
    buffer_load_dwordx4 v158, s[44:47], s23 offen offset:2048 sc1 lds
    v_mfma_f32_16x16x32_bf16 v[196:199], a[28:31], v[84:87], v[196:199]
    ds_read_b128 v[108:111], v159 offset:19200
    v_mfma_f32_16x16x32_bf16 v[196:199], a[20:23], v[80:83], v[196:199]
    ds_read_b128 v[112:115], v159 offset:13312
    s_add_u32 m0, s73, 16384
    s_lshl_b32 s14, s26, 3
    v_mfma_f32_16x16x32_bf16 v[204:207], a[20:23], v[88:91], v[204:207]
    ds_read_b128 v[116:119], v159 offset:19456
    v_mfma_f32_16x16x32_bf16 v[204:207], a[28:31], v[92:95], v[204:207]
    ds_read_b128 v[120:123], v159 offset:13568
    buffer_load_dwordx4 v148, s[48:51], s14 offen offset:0 lds
    v_mfma_f32_16x16x32_bf16 v[200:203], a[24:27], v[92:95], v[200:203]
    ds_read_b128 v[124:127], v159 offset:19712
    buffer_load_dwordx4 v149, s[48:51], s14 offen offset:1024 lds
    s_lshl_b32 s7, s7, 1
    v_xor_b32 v31, s7, v31
    v_lshl_add_u32 v10, v31, 5, v24
    v_xor_b32 v11, 32, v10
    s_mul_i32 s84, s101, 14
    s_lshr_b32 s84, s84, 2
    s_add_u32 s84, s84, 0
    s_add_u32 s85, s84, 1
    s_cmp_eq_u32 s85, 14
    s_cselect_b32 s85, 0, s85
    s_add_u32 s86, s85, 1
    s_cmp_eq_u32 s86, 14
    s_cselect_b32 s86, 0, s86
    s_add_u32 s87, s86, 1
    s_cmp_eq_u32 s87, 14
    s_cselect_b32 s87, 0, s87
    s_add_u32 s88, s87, 1
    s_cmp_eq_u32 s88, 14
    s_cselect_b32 s88, 0, s88
    s_add_u32 s89, s88, 1
    s_cmp_eq_u32 s89, 14
    s_cselect_b32 s89, 0, s89
    s_add_u32 s90, s89, 1
    s_cmp_eq_u32 s90, 14
    s_cselect_b32 s90, 0, s90
    s_add_u32 s91, s90, 1
    s_cmp_eq_u32 s91, 14
    s_cselect_b32 s91, 0, s91
    s_add_u32 s92, s91, 1
    s_cmp_eq_u32 s92, 14
    s_cselect_b32 s92, 0, s92
    s_add_u32 s93, s92, 1
    s_cmp_eq_u32 s93, 14
    s_cselect_b32 s93, 0, s93
    s_add_u32 s94, s93, 1
    s_cmp_eq_u32 s94, 14
    s_cselect_b32 s94, 0, s94
    s_add_u32 s95, s94, 1
    s_cmp_eq_u32 s95, 14
    s_cselect_b32 s95, 0, s95
    s_add_u32 s96, s95, 1
    s_cmp_eq_u32 s96, 14
    s_cselect_b32 s96, 0, s96
    s_add_u32 s97, s96, 1
    s_cmp_eq_u32 s97, 14
    s_cselect_b32 s97, 0, s97
    s_mul_i32 s98, s101, 4
    s_lshr_b32 s98, s98, 2
    s_add_u32 s98, s98, 14
    s_add_u32 s99, s98, 1
    s_cmp_eq_u32 s99, 18
    s_cselect_b32 s99, 14, s99
    s_add_u32 s100, s99, 1
    s_cmp_eq_u32 s100, 18
    s_cselect_b32 s100, 14, s100
    s_add_u32 s101, s100, 1
    s_cmp_eq_u32 s101, 18
    s_cselect_b32 s101, 14, s101
    s_mul_i32 s7, s70, 6
    s_add_u32 s7, s7, 0
    s_mul_i32 s8, s7, 7282
    s_lshr_b32 s8, s8, 16
    v_mfma_f32_16x16x32_bf16 v[200:203], a[16:19], v[88:91], v[200:203]
    ds_read_b64_tr_b16 a[88:89], v152 offset:57344
    v_mfma_f32_16x16x32_bf16 v[208:211], a[16:19], v[96:99], v[208:211]
    ds_read_b64_tr_b16 a[90:91], v152 offset:58368
    buffer_load_dwordx4 v150, s[48:51], s14 offen offset:2048 lds
    v_mfma_f32_16x16x32_bf16 v[208:211], a[24:27], v[100:103], v[208:211]
    v_mfma_f32_16x16x32_bf16 v[212:215], a[28:31], v[100:103], v[212:215]
    ds_read_b64_tr_b16 a[92:93], v153 offset:57344
    buffer_load_dwordx4 v151, s[48:51], s14 offen offset:3072 lds
    v_mfma_f32_16x16x32_bf16 v[212:215], a[20:23], v[96:99], v[212:215]
    ds_read_b64_tr_b16 a[94:95], v153 offset:58368
    s_waitcnt lgkmcnt(4)
    v_mfma_f32_16x16x32_bf16 v[220:223], a[20:23], v[104:107], v[220:223]
    s_waitcnt vmcnt(17)
    s_barrier
    v_mfma_f32_16x16x32_bf16 v[220:223], a[28:31], v[108:111], v[220:223]
    ds_read_b128 v[80:83], v159 offset:24576
    s_add_u32 m0, s74, 0
    v_mfma_f32_16x16x32_bf16 v[216:219], a[24:27], v[108:111], v[216:219]
    ds_read_b128 v[84:87], v159 offset:30720
    buffer_load_dwordx4 v156, s[44:47], s24 offen offset:0 sc1 lds
    v_mfma_f32_16x16x32_bf16 v[216:219], a[16:19], v[104:107], v[216:219]
    ds_read_b128 v[88:91], v159 offset:24832
    v_mfma_f32_16x16x32_bf16 v[224:227], a[16:19], v[112:115], v[224:227]
    ds_read_b128 v[92:95], v159 offset:30976
    buffer_load_dwordx4 v157, s[44:47], s24 offen offset:1024 sc1 lds
    v_mfma_f32_16x16x32_bf16 v[224:227], a[24:27], v[116:119], v[224:227]
    ds_read_b128 v[96:99], v159 offset:25088
    v_mfma_f32_16x16x32_bf16 v[228:231], a[28:31], v[116:119], v[228:231]
    ds_read_b128 v[100:103], v159 offset:31232
    buffer_load_dwordx4 v158, s[44:47], s24 offen offset:2048 sc1 lds
    s_mul_i32 s5, s8, 9
    s_sub_u32 s7, s7, s5
    s_lshl_b32 s7, s7, 2
    s_mov_b32 s4, 0xeca86420
    s_mov_b32 s5, 3
    s_lshr_b64 s[4:5], s[4:5], s7
    s_and_b32 s4, s4, 15
    s_lshl4_add_u32 s4, s8, s4
    v_lshl_add_u32 v240, s4, 8, v245
    s_mul_i32 s7, s70, 6
    s_add_u32 s7, s7, 1
    s_mul_i32 s8, s7, 7282
    s_lshr_b32 s8, s8, 16
    s_mul_i32 s5, s8, 9
    s_sub_u32 s7, s7, s5
    s_lshl_b32 s7, s7, 2
    s_mov_b32 s4, 0xeca86420
    s_mov_b32 s5, 3
    s_lshr_b64 s[4:5], s[4:5], s7
    s_and_b32 s4, s4, 15
    s_lshl4_add_u32 s4, s8, s4
    v_lshl_add_u32 v241, s4, 8, v245
    s_mul_i32 s7, s70, 6
    s_add_u32 s7, s7, 2
    s_mul_i32 s8, s7, 7282
    s_lshr_b32 s8, s8, 16
    s_mul_i32 s5, s8, 9
    v_mfma_f32_16x16x32_bf16 v[228:231], a[20:23], v[112:115], v[228:231]
    ds_read_b64_tr_b16 a[96:97], v154 offset:0
    v_mfma_f32_16x16x32_bf16 v[236:239], a[20:23], v[120:123], v[236:239]
    ds_read_b64_tr_b16 a[98:99], v154 offset:1024
    s_add_u32 m0, s74, 12288
    v_mfma_f32_16x16x32_bf16 v[236:239], a[28:31], v[124:127], v[236:239]
    v_mfma_f32_16x16x32_bf16 v[232:235], a[24:27], v[124:127], v[232:235]
    ds_read_b64_tr_b16 a[100:101], v155 offset:0
    buffer_load_dwordx4 v156, s[44:47], s25 offen offset:0 sc1 lds
    v_mfma_f32_16x16x32_bf16 v[232:235], a[16:19], v[120:123], v[232:235]
    ds_read_b64_tr_b16 a[102:103], v155 offset:1024
    s_waitcnt lgkmcnt(4)
    v_mfma_f32_16x16x32_bf16 v[192:195], a[32:35], v[80:83], v[192:195]
    buffer_load_dwordx4 v157, s[44:47], s25 offen offset:1024 sc1 lds
    v_mfma_f32_16x16x32_bf16 v[192:195], a[40:43], v[84:87], v[192:195]
    ds_read_b128 v[104:107], v159 offset:25344
    buffer_load_dwordx4 v158, s[44:47], s25 offen offset:2048 sc1 lds
    v_mfma_f32_16x16x32_bf16 v[196:199], a[44:47], v[84:87], v[196:199]
    ds_read_b128 v[108:111], v159 offset:31488
    v_mfma_f32_16x16x32_bf16 v[196:199], a[36:39], v[80:83], v[196:199]
    ds_read_b128 v[112:115], v159 offset:25600
    s_add_u32 m0, s73, 32768
    s_lshl_b32 s14, s27, 3
    v_mfma_f32_16x16x32_bf16 v[204:207], a[36:39], v[88:91], v[204:207]
    ds_read_b128 v[116:119], v159 offset:31744
    v_mfma_f32_16x16x32_bf16 v[204:207], a[44:47], v[92:95], v[204:207]
    ds_read_b128 v[120:123], v159 offset:25856
    buffer_load_dwordx4 v148, s[48:51], s14 offen offset:0 lds
    v_mfma_f32_16x16x32_bf16 v[200:203], a[40:43], v[92:95], v[200:203]
    ds_read_b128 v[124:127], v159 offset:32000
    buffer_load_dwordx4 v149, s[48:51], s14 offen offset:1024 lds
    s_sub_u32 s7, s7, s5
    s_lshl_b32 s7, s7, 2
    s_mov_b32 s4, 0xeca86420
    s_mov_b32 s5, 3
    s_lshr_b64 s[4:5], s[4:5], s7
    s_and_b32 s4, s4, 15
    s_lshl4_add_u32 s4, s8, s4
    v_lshl_add_u32 v242, s4, 8, v245
    s_mul_i32 s7, s70, 6
    s_add_u32 s7, s7, 3
    s_mul_i32 s8, s7, 7282
    s_lshr_b32 s8, s8, 16
    s_mul_i32 s5, s8, 9
    s_sub_u32 s7, s7, s5
    s_lshl_b32 s7, s7, 2
    s_mov_b32 s4, 0xeca86420
    s_mov_b32 s5, 3
    s_lshr_b64 s[4:5], s[4:5], s7
    s_and_b32 s4, s4, 15
    s_lshl4_add_u32 s4, s8, s4
    v_lshl_add_u32 v243, s4, 8, v245
    s_mul_i32 s7, s70, 6
    s_add_u32 s7, s7, 4
    s_mul_i32 s8, s7, 7282
    s_lshr_b32 s8, s8, 16
    s_mul_i32 s5, s8, 9
    v_mfma_f32_16x16x32_bf16 v[200:203], a[32:35], v[88:91], v[200:203]
    ds_read_b64_tr_b16 a[104:105], v154 offset:8192
    v_mfma_f32_16x16x32_bf16 v[208:211], a[32:35], v[96:99], v[208:211]
    ds_read_b64_tr_b16 a[106:107], v154 offset:9216
    buffer_load_dwordx4 v150, s[48:51], s14 offen offset:2048 lds
    v_mfma_f32_16x16x32_bf16 v[208:211], a[40:43], v[100:103], v[208:211]
    v_mfma_f32_16x16x32_bf16 v[212:215], a[44:47], v[100:103], v[212:215]
    ds_read_b64_tr_b16 a[108:109], v155 offset:8192
    buffer_load_dwordx4 v151, s[48:51], s14 offen offset:3072 lds
    v_mfma_f32_16x16x32_bf16 v[212:215], a[36:39], v[96:99], v[212:215]
    ds_read_b64_tr_b16 a[110:111], v155 offset:9216
    s_waitcnt lgkmcnt(4)
    v_mfma_f32_16x16x32_bf16 v[220:223], a[36:39], v[104:107], v[220:223]
    s_waitcnt vmcnt(20)
    s_barrier
    v_mfma_f32_16x16x32_bf16 v[220:223], a[44:47], v[108:111], v[220:223]
    ds_read_b128 v[80:83], v250 offset:0
    s_add_u32 m0, s74, 24576
    v_mfma_f32_16x16x32_bf16 v[216:219], a[40:43], v[108:111], v[216:219]
    ds_read_b128 v[84:87], v250 offset:6144
    v_mfma_f32_16x16x32_bf16 v[216:219], a[32:35], v[104:107], v[216:219]
    ds_read_b128 v[88:91], v250 offset:256
    buffer_load_dwordx4 v156, s[44:47], s26 offen offset:0 sc1 lds
    v_mfma_f32_16x16x32_bf16 v[224:227], a[32:35], v[112:115], v[224:227]
    ds_read_b128 v[92:95], v250 offset:6400
    v_mfma_f32_16x16x32_bf16 v[224:227], a[40:43], v[116:119], v[224:227]
    ds_read_b128 v[96:99], v250 offset:512
    v_mfma_f32_16x16x32_bf16 v[228:231], a[44:47], v[116:119], v[228:231]
    ds_read_b128 v[100:103], v250 offset:6656
    buffer_load_dwordx4 v157, s[44:47], s26 offen offset:1024 sc1 lds
    s_sub_u32 s7, s7, s5
    s_lshl_b32 s7, s7, 2
    s_mov_b32 s4, 0xeca86420
    s_mov_b32 s5, 3
    s_lshr_b64 s[4:5], s[4:5], s7
    s_and_b32 s4, s4, 15
    s_lshl4_add_u32 s4, s8, s4
    v_lshl_add_u32 v244, s4, 8, v245
    s_mul_i32 s7, s70, 6
    s_add_u32 s7, s7, 5
    s_mul_i32 s8, s7, 7282
    s_lshr_b32 s8, s8, 16
    s_mul_i32 s5, s8, 9
    s_sub_u32 s7, s7, s5
    s_lshl_b32 s7, s7, 2
    s_mov_b32 s4, 0xeca86420
    s_mov_b32 s5, 3
    s_lshr_b64 s[4:5], s[4:5], s7
    s_and_b32 s4, s4, 15
    s_lshl4_add_u32 s4, s8, s4
    v_lshl_add_u32 v245, s4, 8, v245
    s_xor_b32 s7, s75, 1
    s_lshl2_add_u32 s7, s7, s3
    s_mul_i32 s9, s7, 6144
    s_add_u32 s9, s9, 28065792
    s_lshl_b32 s7, s7, 7
    s_add_u32 s6, s7, 33374208
    s_lshl2_add_u32 s7, s75, s3
    s_mul_i32 s10, s7, 6144
    s_add_u32 s10, s10, 28065792
    s_lshl_b32 s7, s7, 7
    v_mfma_f32_16x16x32_bf16 v[228:231], a[36:39], v[112:115], v[228:231]
    ds_read_b64_tr_b16 a[112:113], v152 offset:0
    v_mfma_f32_16x16x32_bf16 v[236:239], a[36:39], v[120:123], v[236:239]
    ds_read_b64_tr_b16 a[114:115], v152 offset:1024
    v_mfma_f32_16x16x32_bf16 v[236:239], a[44:47], v[124:127], v[236:239]
    buffer_load_dwordx4 v158, s[44:47], s26 offen offset:2048 sc1 lds
    v_mfma_f32_16x16x32_bf16 v[232:235], a[40:43], v[124:127], v[232:235]
    ds_read_b64_tr_b16 a[116:117], v153 offset:0
    v_mfma_f32_16x16x32_bf16 v[232:235], a[32:35], v[120:123], v[232:235]
    ds_read_b64_tr_b16 a[118:119], v153 offset:1024
    s_waitcnt lgkmcnt(4)
    v_mfma_f32_16x16x32_bf16 v[192:195], a[48:51], v[80:83], v[192:195]
    s_add_u32 m0, s73, 49152
    s_lshl_b32 s14, s76, 3
    v_mfma_f32_16x16x32_bf16 v[192:195], a[56:59], v[84:87], v[192:195]
    ds_read_b128 v[104:107], v250 offset:768
    v_mfma_f32_16x16x32_bf16 v[196:199], a[60:63], v[84:87], v[196:199]
    ds_read_b128 v[108:111], v250 offset:6912
    buffer_load_dwordx4 v148, s[48:51], s14 offen offset:0 lds
    v_mfma_f32_16x16x32_bf16 v[196:199], a[52:55], v[80:83], v[196:199]
    ds_read_b128 v[112:115], v250 offset:1024
    v_mfma_f32_16x16x32_bf16 v[204:207], a[52:55], v[88:91], v[204:207]
    ds_read_b128 v[116:119], v250 offset:7168
    buffer_load_dwordx4 v149, s[48:51], s14 offen offset:1024 lds
    v_mfma_f32_16x16x32_bf16 v[204:207], a[60:63], v[92:95], v[204:207]
    ds_read_b128 v[120:123], v250 offset:1280
    v_mfma_f32_16x16x32_bf16 v[200:203], a[56:59], v[92:95], v[200:203]
    ds_read_b128 v[124:127], v250 offset:7424
    s_add_u32 s7, s7, 33374208
    v_mov_b32 v28, s7
    v_add_u32 v247, 3072, v246
    v_cmp_eq_u32 vcc, 0, v2
    v_mov_b32 v248, 0x40000000
    s_nop 0
    v_cndmask_b32 v248, v248, 0, vcc
    v_mov_b32 v249, s68
    v_and_b32 v129, 0xffff0000, v144
    v_lshlrev_b32 v128, 16, v144
    v_and_b32 v131, 0xffff0000, v145
    v_lshlrev_b32 v130, 16, v145
    v_and_b32 v133, 0xffff0000, v146
    v_lshlrev_b32 v132, 16, v146
    v_and_b32 v135, 0xffff0000, v147
    v_lshlrev_b32 v134, 16, v147
    s_mul_i32 s4, s70, 43691
    s_lshr_b32 s4, s4, 16
    s_mul_i32 s5, s70, 21846
    s_lshr_b32 s5, s5, 16
    s_mul_i32 s5, s5, 3
    s_sub_u32 s5, s70, s5
    s_lshl2_add_u32 s4, s72, s4
    s_lshl_b32 s4, s4, 10
    s_mul_i32 s7, s72, 9
    s_sub_u32 s7, s69, s7
    s_lshl3_add_u32 s4, s7, s4
    v_mfma_f32_16x16x32_bf16 v[200:203], a[48:51], v[88:91], v[200:203]
    ds_read_b64_tr_b16 a[120:121], v152 offset:8192
    buffer_load_dwordx4 v150, s[48:51], s14 offen offset:2048 lds
    v_mfma_f32_16x16x32_bf16 v[208:211], a[48:51], v[96:99], v[208:211]
    ds_read_b64_tr_b16 a[122:123], v152 offset:9216
    v_mfma_f32_16x16x32_bf16 v[208:211], a[56:59], v[100:103], v[208:211]
    buffer_load_dwordx4 v151, s[48:51], s14 offen offset:3072 lds
    v_mfma_f32_16x16x32_bf16 v[212:215], a[60:63], v[100:103], v[212:215]
    ds_read_b64_tr_b16 a[124:125], v153 offset:8192
    v_mfma_f32_16x16x32_bf16 v[212:215], a[52:55], v[96:99], v[212:215]
    ds_read_b64_tr_b16 a[126:127], v153 offset:9216
    s_waitcnt lgkmcnt(4)
    v_mfma_f32_16x16x32_bf16 v[220:223], a[52:55], v[104:107], v[220:223]
    s_waitcnt vmcnt(17)
    s_barrier
    v_mfma_f32_16x16x32_bf16 v[220:223], a[60:63], v[108:111], v[220:223]
    ds_read_b128 v[80:83], v250 offset:12288
    s_add_u32 m0, s74, 36864
    v_mfma_f32_16x16x32_bf16 v[216:219], a[56:59], v[108:111], v[216:219]
    ds_read_b128 v[84:87], v250 offset:18432
    v_mfma_f32_16x16x32_bf16 v[216:219], a[48:51], v[104:107], v[216:219]
    ds_read_b128 v[88:91], v250 offset:12544
    buffer_load_dwordx4 v156, s[44:47], s27 offen offset:0 sc1 lds
    v_mfma_f32_16x16x32_bf16 v[224:227], a[48:51], v[112:115], v[224:227]
    ds_read_b128 v[92:95], v250 offset:18688
    v_mfma_f32_16x16x32_bf16 v[224:227], a[56:59], v[116:119], v[224:227]
    ds_read_b128 v[96:99], v250 offset:12800
    v_mfma_f32_16x16x32_bf16 v[228:231], a[60:63], v[116:119], v[228:231]
    ds_read_b128 v[100:103], v250 offset:18944
    buffer_load_dwordx4 v157, s[44:47], s27 offen offset:1024 sc1 lds
    s_add_u32 s4, s4, 12566528
    s_cmp_eq_u32 s5, 1
    s_cselect_b32 s7, 16, 8
    s_cmp_lg_u32 s5, 0
    s_cselect_b32 s5, 4, 0
    v_lshlrev_b32 v17, 7, v0
    v_add_u32 v17, s4, v17
    v_cmp_gt_u32 vcc, 8, v0
    v_mov_b32 v24, s5
    s_nop 0
    v_cndmask_b32 v24, 0, v24, vcc
    v_add_u32 v17, v17, v24
    v_cmp_gt_u32 vcc, s7, v0
    v_mov_b32 v24, 0x40000000
    s_nop 0
    v_cndmask_b32 v17, v24, v17, vcc
    s_bfe_u32 s4, s2, 0x20003
    s_lshl2_add_u32 s4, s72, s4
    s_lshl_b32 s4, s4, 3
    s_lshr_b32 s5, s2, 4
    s_and_b32 s5, s5, 6
    s_add_u32 s4, s4, s5
    s_and_b32 s5, s2, 1
    s_add_u32 s4, s4, s5
    s_lshl_b32 s4, s4, 7
    s_add_u32 s4, s4, 12566528
    v_lshl_add_u32 v15, v2, 2, s4
    s_cmp_eq_u32 s3, 0
    s_cselect_b32 s4, 18, 0
    v_cmp_gt_u32 vcc, s4, v2
    v_mov_b32 v13, 0x40000000
    v_mfma_f32_16x16x32_bf16 v[228:231], a[52:55], v[112:115], v[228:231]
    ds_read_b64_tr_b16 a[128:129], v152 offset:16384
    v_mfma_f32_16x16x32_bf16 v[236:239], a[52:55], v[120:123], v[236:239]
    ds_read_b64_tr_b16 a[130:131], v152 offset:17408
    v_mfma_f32_16x16x32_bf16 v[236:239], a[60:63], v[124:127], v[236:239]
    buffer_load_dwordx4 v158, s[44:47], s27 offen offset:2048 sc1 lds
    v_mfma_f32_16x16x32_bf16 v[232:235], a[56:59], v[124:127], v[232:235]
    ds_read_b64_tr_b16 a[132:133], v153 offset:16384
    v_mfma_f32_16x16x32_bf16 v[232:235], a[48:51], v[120:123], v[232:235]
    ds_read_b64_tr_b16 a[134:135], v153 offset:17408
    s_waitcnt lgkmcnt(4)
    v_mfma_f32_16x16x32_bf16 v[192:195], a[64:67], v[80:83], v[192:195]
    s_add_u32 m0, s73, 65536
    s_lshl_b32 s14, s77, 3
    v_mfma_f32_16x16x32_bf16 v[192:195], a[72:75], v[84:87], v[192:195]
    ds_read_b128 v[104:107], v250 offset:13056
    v_mfma_f32_16x16x32_bf16 v[196:199], a[76:79], v[84:87], v[196:199]
    ds_read_b128 v[108:111], v250 offset:19200
    buffer_load_dwordx4 v148, s[48:51], s14 offen offset:0 lds
    v_mfma_f32_16x16x32_bf16 v[196:199], a[68:71], v[80:83], v[196:199]
    ds_read_b128 v[112:115], v250 offset:13312
    v_mfma_f32_16x16x32_bf16 v[204:207], a[68:71], v[88:91], v[204:207]
    ds_read_b128 v[116:119], v250 offset:19456
    buffer_load_dwordx4 v149, s[48:51], s14 offen offset:1024 lds
    v_mfma_f32_16x16x32_bf16 v[204:207], a[76:79], v[92:95], v[204:207]
    ds_read_b128 v[120:123], v250 offset:13568
    v_mfma_f32_16x16x32_bf16 v[200:203], a[72:75], v[92:95], v[200:203]
    ds_read_b128 v[124:127], v250 offset:19712
    v_cndmask_b32 v15, v13, v15, vcc
    v_mov_b32 v13, s68
    v_cndmask_b32 v13, 0, v13, vcc
    v_and_b32 v24, 15, v2
    v_lshrrev_b32 v25, 4, v2
    v_mul_u32_u24 v25, 17408, v25
    v_lshl_add_u32 v24, v24, 4, v25
    s_mul_i32 s7, s72, 36
    s_and_b32 s8, s3, 1
    s_add_u32 s7, s7, s8
    s_mul_i32 s7, s7, 69632
    s_bfe_u32 s8, s2, 0x20003
    s_lshl_b32 s8, s8, 12
    s_add_u32 s7, s7, s8
    s_add_u32 s7, s7, 12795904
    v_add_u32 v23, s7, v24
    s_xor_b32 s7, s72, 0
    v_lshl_add_u32 v19, s7, 10, v23
    s_xor_b32 s7, s72, 1
    v_lshl_add_u32 v20, s7, 10, v23
    s_xor_b32 s7, s72, 2
    v_lshl_add_u32 v21, s7, 10, v23
    s_xor_b32 s7, s72, 3
    v_lshl_add_u32 v22, s7, 10, v23
    v_lshlrev_b32 v14, 4, v2
    v_add_u32 v14, 98304, v14
    v_add_u32 v1, 0x10000, v14
    v_mfma_f32_16x16x32_bf16 v[200:203], a[64:67], v[88:91], v[200:203]
    ds_read_b64_tr_b16 a[136:137], v152 offset:24576
    buffer_load_dwordx4 v150, s[48:51], s14 offen offset:2048 lds
    v_mfma_f32_16x16x32_bf16 v[208:211], a[64:67], v[96:99], v[208:211]
    ds_read_b64_tr_b16 a[138:139], v152 offset:25600
    v_mfma_f32_16x16x32_bf16 v[208:211], a[72:75], v[100:103], v[208:211]
    buffer_load_dwordx4 v151, s[48:51], s14 offen offset:3072 lds
    v_mfma_f32_16x16x32_bf16 v[212:215], a[76:79], v[100:103], v[212:215]
    ds_read_b64_tr_b16 a[140:141], v153 offset:24576
    v_mfma_f32_16x16x32_bf16 v[212:215], a[68:71], v[96:99], v[212:215]
    ds_read_b64_tr_b16 a[142:143], v153 offset:25600
    s_waitcnt lgkmcnt(4)
    v_mfma_f32_16x16x32_bf16 v[220:223], a[68:71], v[104:107], v[220:223]
    s_waitcnt vmcnt(14)
    s_barrier
    v_mfma_f32_16x16x32_bf16 v[220:223], a[76:79], v[108:111], v[220:223]
    ds_read_b128 v[80:83], v250 offset:24576
    s_add_u32 m0, s74, 49152
    v_mfma_f32_16x16x32_bf16 v[216:219], a[72:75], v[108:111], v[216:219]
    ds_read_b128 v[84:87], v250 offset:30720
    v_mfma_f32_16x16x32_bf16 v[216:219], a[64:67], v[104:107], v[216:219]
    ds_read_b128 v[88:91], v250 offset:24832
    buffer_load_dwordx4 v156, s[44:47], s76 offen offset:0 sc1 lds
    v_mfma_f32_16x16x32_bf16 v[224:227], a[64:67], v[112:115], v[224:227]
    ds_read_b128 v[92:95], v250 offset:30976
    v_mfma_f32_16x16x32_bf16 v[224:227], a[72:75], v[116:119], v[224:227]
    ds_read_b128 v[96:99], v250 offset:25088
    v_mfma_f32_16x16x32_bf16 v[228:231], a[76:79], v[116:119], v[228:231]
    ds_read_b128 v[100:103], v250 offset:31232
    buffer_load_dwordx4 v157, s[44:47], s76 offen offset:1024 sc1 lds
    s_mov_b32 s56, s16
    s_and_b32 s57, s17, 0xffff
    s_mov_b32 s58, 2359296
    s_mov_b32 s59, 0x20000
    s_mov_b32 s40, 18432
    s_mov_b32 s42, 12386304
    s_mov_b32 s64, s38
    s_and_b32 s65, s39, 0xffff
    s_mov_b32 s66, 2359296
    s_mov_b32 s67, 0x20000
    v_lshlrev_b32 v136, 4, v2
    s_mul_i32 s7, s72, 36
    s_bitcmp1_b32 s3, 0
    s_addc_u32 s7, s7, 0
    s_lshl_b32 s7, s7, 17
    v_subrev_u32 v184, s7, v4
    v_subrev_u32 v185, s7, v5
    s_bfe_u32 s4, s2, 0x20003
    s_mul_i32 s4, s4, 9
    s_lshl1_add_u32 s7, s72, s4
    s_and_b32 s8, s3, 1
    s_add_u32 s7, s7, s8
    s_lshl_b32 s37, s7, 16
    s_add_u32 s37, s37, 4718592
    s_add_u32 s4, s4, 8
    s_lshl_b32 s16, s4, 16
    s_add_u32 s16, s16, 4718592
    v_mfma_f32_16x16x32_bf16 v[228:231], a[68:71], v[112:115], v[228:231]
    ds_read_b64_tr_b16 a[144:145], v152 offset:32768
    v_mfma_f32_16x16x32_bf16 v[236:239], a[68:71], v[120:123], v[236:239]
    ds_read_b64_tr_b16 a[146:147], v152 offset:33792
    v_mfma_f32_16x16x32_bf16 v[236:239], a[76:79], v[124:127], v[236:239]
    buffer_load_dwordx4 v158, s[44:47], s76 offen offset:2048 sc1 lds
    v_mfma_f32_16x16x32_bf16 v[232:235], a[72:75], v[124:127], v[232:235]
    ds_read_b64_tr_b16 a[148:149], v153 offset:32768
    v_mfma_f32_16x16x32_bf16 v[232:235], a[64:67], v[120:123], v[232:235]
    ds_read_b64_tr_b16 a[150:151], v153 offset:33792
    s_waitcnt lgkmcnt(4)
    v_mfma_f32_16x16x32_bf16 v[192:195], a[80:83], v[80:83], v[192:195]
    s_add_u32 m0, s73, 0
    s_lshl_b32 s14, s78, 3
    v_mfma_f32_16x16x32_bf16 v[192:195], a[88:91], v[84:87], v[192:195]
    ds_read_b128 v[104:107], v250 offset:25344
    v_mfma_f32_16x16x32_bf16 v[196:199], a[92:95], v[84:87], v[196:199]
    ds_read_b128 v[108:111], v250 offset:31488
    buffer_load_dwordx4 v148, s[48:51], s14 offen offset:0 lds
    v_mfma_f32_16x16x32_bf16 v[196:199], a[84:87], v[80:83], v[196:199]
    ds_read_b128 v[112:115], v250 offset:25600
    v_mfma_f32_16x16x32_bf16 v[204:207], a[84:87], v[88:91], v[204:207]
    ds_read_b128 v[116:119], v250 offset:31744
    buffer_load_dwordx4 v149, s[48:51], s14 offen offset:1024 lds
    v_mfma_f32_16x16x32_bf16 v[204:207], a[92:95], v[92:95], v[204:207]
    ds_read_b128 v[120:123], v250 offset:25856
    v_mfma_f32_16x16x32_bf16 v[200:203], a[88:91], v[92:95], v[200:203]
    ds_read_b128 v[124:127], v250 offset:32000
    s_sub_u32 s4, s4, s7
    s_lshl_b32 s4, s4, 7
    s_lshl_b32 s7, s7, 7
    s_add_u32 s7, s7, 12582912
    v_bfe_u32 v24, v2, 2, 1
    v_mul_u32_u24 v24, s4, v24
    v_and_b32 v25, 3, v2
    v_lshl_add_u32 v24, v25, 2, v24
    v_add_u32 v188, s7, v24
    s_lshl2_add_u32 s7, s2, s3
    s_mul_i32 s8, s7, 3072
    s_add_u32 s34, s8, 40828928
L_pl_G_2:
    s_cbranch_execz L_pl_G_6
    s_add_u32 s11, s8, 43974656
    s_add_u32 s12, s8, 47120384
    s_lshl_b32 s35, s7, 12
    s_add_u32 s35, s35, 50266112
    s_xor_b32 s8, s7, 8
    s_mul_i32 s8, s8, 3072
    s_add_u32 s30, s8, 40828928
    s_xor_b32 s8, s7, 16
    s_mul_i32 s8, s8, 3072
    s_add_u32 s15, s8, 43974656
    s_xor_b32 s8, s7, 24
    s_mul_i32 s8, s8, 3072
    s_add_u32 s31, s8, 47120384
    s_andn2_b32 s7, s7, 24
    v_mfma_f32_16x16x32_bf16 v[200:203], a[80:83], v[88:91], v[200:203]
    ds_read_b64_tr_b16 a[152:153], v152 offset:40960
    buffer_load_dwordx4 v150, s[48:51], s14 offen offset:2048 lds
    v_mfma_f32_16x16x32_bf16 v[208:211], a[80:83], v[96:99], v[208:211]
    ds_read_b64_tr_b16 a[154:155], v152 offset:41984
    v_mfma_f32_16x16x32_bf16 v[208:211], a[88:91], v[100:103], v[208:211]
    buffer_load_dwordx4 v151, s[48:51], s14 offen offset:3072 lds
    v_mfma_f32_16x16x32_bf16 v[212:215], a[92:95], v[100:103], v[212:215]
    ds_read_b64_tr_b16 a[156:157], v153 offset:40960
    v_mfma_f32_16x16x32_bf16 v[212:215], a[84:87], v[96:99], v[212:215]
    ds_read_b64_tr_b16 a[158:159], v153 offset:41984
    s_waitcnt lgkmcnt(4)
    v_mfma_f32_16x16x32_bf16 v[220:223], a[84:87], v[104:107], v[220:223]
    s_waitcnt vmcnt(14)
    s_barrier
    v_mfma_f32_16x16x32_bf16 v[220:223], a[92:95], v[108:111], v[220:223]
    ds_read_b128 v[80:83], v159 offset:0
    s_add_u32 m0, s74, 61440
    v_mfma_f32_16x16x32_bf16 v[216:219], a[88:91], v[108:111], v[216:219]
    ds_read_b128 v[84:87], v159 offset:6144
    v_mfma_f32_16x16x32_bf16 v[216:219], a[80:83], v[104:107], v[216:219]
    ds_read_b128 v[88:91], v159 offset:256
    buffer_load_dwordx4 v156, s[44:47], s77 offen offset:0 sc1 lds
    v_mfma_f32_16x16x32_bf16 v[224:227], a[80:83], v[112:115], v[224:227]
    ds_read_b128 v[92:95], v159 offset:6400
    v_mfma_f32_16x16x32_bf16 v[224:227], a[88:91], v[116:119], v[224:227]
    ds_read_b128 v[96:99], v159 offset:512
    v_mfma_f32_16x16x32_bf16 v[228:231], a[92:95], v[116:119], v[228:231]
    ds_read_b128 v[100:103], v159 offset:6656
    buffer_load_dwordx4 v157, s[44:47], s77 offen offset:1024 sc1 lds
    s_lshl3_add_u32 s7, s3, s7
    s_lshl2_add_u32 s8, s7, s72
    s_lshl_b32 s8, s8, 10
    s_add_u32 s32, s8, 50266112
    s_xor_b32 s8, s8, 4096
    s_add_u32 s33, s8, 50266112
    s_xor_b32 s8, s3, s72
    s_cmp_lt_u32 s8, 2
    s_cselect_b32 s35, s35, 0x40000000
    s_cselect_b32 s16, s16, 0x40000000
    s_cselect_b32 s36, s68, 0
    s_mov_b32 s38, 0xbfb8aa3b
    s_and_b32 s8, s8, 1
    s_mul_i32 s41, s8, 96
    s_and_b32 s43, s73, 4096
    v_lshlrev_b32 v24, 10, v2
    v_add_u32 v24, s35, v24
    s_add_u32 s7, s34, 2048
    v_mov_b32 v25, s36
    v_cmp_gt_u32 vcc, 4, v2
    s_nop 1
    v_cndmask_b32 v138, 0, v25, vcc
    v_mov_b32 v25, 0x40000000
    v_cndmask_b32 v137, v25, v24, vcc
    v_writelane_b32 v137, s7, 4
    v_writelane_b32 v138, s68, 4
    v_min_u32 v139, 1, v2
    v_lshlrev_b32 v139, 30, v139
    v_mov_b32 v140, 0
    v_writelane_b32 v140, s68, 0
    v_mfma_f32_16x16x32_bf16 v[228:231], a[84:87], v[112:115], v[228:231]
    ds_read_b64_tr_b16 a[160:161], v152 offset:49152
    v_mfma_f32_16x16x32_bf16 v[236:239], a[84:87], v[120:123], v[236:239]
    ds_read_b64_tr_b16 a[162:163], v152 offset:50176
    v_mfma_f32_16x16x32_bf16 v[236:239], a[92:95], v[124:127], v[236:239]
    buffer_load_dwordx4 v158, s[44:47], s77 offen offset:2048 sc1 lds
    v_mfma_f32_16x16x32_bf16 v[232:235], a[88:91], v[124:127], v[232:235]
    ds_read_b64_tr_b16 a[164:165], v153 offset:49152
    v_mfma_f32_16x16x32_bf16 v[232:235], a[80:83], v[120:123], v[232:235]
    ds_read_b64_tr_b16 a[166:167], v153 offset:50176
    s_waitcnt lgkmcnt(4)
    v_mfma_f32_16x16x32_bf16 v[192:195], a[96:99], v[80:83], v[192:195]
    s_add_u32 m0, s73, 16384
    s_lshl_b32 s14, s79, 3
    v_mfma_f32_16x16x32_bf16 v[192:195], a[104:107], v[84:87], v[192:195]
    ds_read_b128 v[104:107], v159 offset:768
    v_mfma_f32_16x16x32_bf16 v[196:199], a[108:111], v[84:87], v[196:199]
    ds_read_b128 v[108:111], v159 offset:6912
    buffer_load_dwordx4 v148, s[48:51], s14 offen offset:0 lds
    v_mfma_f32_16x16x32_bf16 v[196:199], a[100:103], v[80:83], v[196:199]
    ds_read_b128 v[112:115], v159 offset:1024
    v_mfma_f32_16x16x32_bf16 v[204:207], a[100:103], v[88:91], v[204:207]
    ds_read_b128 v[116:119], v159 offset:7168
    buffer_load_dwordx4 v149, s[48:51], s14 offen offset:1024 lds
    v_mfma_f32_16x16x32_bf16 v[204:207], a[108:111], v[92:95], v[204:207]
    ds_read_b128 v[120:123], v159 offset:1280
    v_mfma_f32_16x16x32_bf16 v[200:203], a[104:107], v[92:95], v[200:203]
    ds_read_b128 v[124:127], v159 offset:7424
    v_mfma_f32_16x16x32_bf16 v[200:203], a[96:99], v[88:91], v[200:203]
    ds_read_b64_tr_b16 a[168:169], v152 offset:57344
    buffer_load_dwordx4 v150, s[48:51], s14 offen offset:2048 lds
    v_mfma_f32_16x16x32_bf16 v[208:211], a[96:99], v[96:99], v[208:211]
    ds_read_b64_tr_b16 a[170:171], v152 offset:58368
    v_mfma_f32_16x16x32_bf16 v[208:211], a[104:107], v[100:103], v[208:211]
    buffer_load_dwordx4 v151, s[48:51], s14 offen offset:3072 lds
    v_mfma_f32_16x16x32_bf16 v[212:215], a[108:111], v[100:103], v[212:215]
    ds_read_b64_tr_b16 a[172:173], v153 offset:57344
    v_mfma_f32_16x16x32_bf16 v[212:215], a[100:103], v[96:99], v[212:215]
    ds_read_b64_tr_b16 a[174:175], v153 offset:58368
    s_waitcnt lgkmcnt(4)
    v_mfma_f32_16x16x32_bf16 v[220:223], a[100:103], v[104:107], v[220:223]
    s_waitcnt vmcnt(14)
    s_barrier
    v_mfma_f32_16x16x32_bf16 v[220:223], a[108:111], v[108:111], v[220:223]
    ds_read_b128 v[80:83], v159 offset:12288
    s_add_u32 m0, s74, 0
    v_mfma_f32_16x16x32_bf16 v[216:219], a[104:107], v[108:111], v[216:219]
    ds_read_b128 v[84:87], v159 offset:18432
    v_mfma_f32_16x16x32_bf16 v[216:219], a[96:99], v[104:107], v[216:219]
    ds_read_b128 v[88:91], v159 offset:12544
    buffer_load_dwordx4 v156, s[44:47], s78 offen offset:0 sc1 lds
    v_mfma_f32_16x16x32_bf16 v[224:227], a[96:99], v[112:115], v[224:227]
    ds_read_b128 v[92:95], v159 offset:18688
    v_mfma_f32_16x16x32_bf16 v[224:227], a[104:107], v[116:119], v[224:227]
    ds_read_b128 v[96:99], v159 offset:12800
    v_mfma_f32_16x16x32_bf16 v[228:231], a[108:111], v[116:119], v[228:231]
    ds_read_b128 v[100:103], v159 offset:18944
    buffer_load_dwordx4 v157, s[44:47], s78 offen offset:1024 sc1 lds
    v_mfma_f32_16x16x32_bf16 v[228:231], a[100:103], v[112:115], v[228:231]
    ds_read_b64_tr_b16 a[176:177], v154 offset:0
    v_mfma_f32_16x16x32_bf16 v[236:239], a[100:103], v[120:123], v[236:239]
    ds_read_b64_tr_b16 a[178:179], v154 offset:1024
    v_mfma_f32_16x16x32_bf16 v[236:239], a[108:111], v[124:127], v[236:239]
    buffer_load_dwordx4 v158, s[44:47], s78 offen offset:2048 sc1 lds
    v_mfma_f32_16x16x32_bf16 v[232:235], a[104:107], v[124:127], v[232:235]
    ds_read_b64_tr_b16 a[180:181], v155 offset:0
    v_mfma_f32_16x16x32_bf16 v[232:235], a[96:99], v[120:123], v[232:235]
    ds_read_b64_tr_b16 a[182:183], v155 offset:1024
    s_waitcnt lgkmcnt(4)
    v_mfma_f32_16x16x32_bf16 v[192:195], a[112:115], v[80:83], v[192:195]
    s_add_u32 m0, s73, 32768
    s_lshl_b32 s14, s80, 3
    v_mfma_f32_16x16x32_bf16 v[192:195], a[120:123], v[84:87], v[192:195]
    ds_read_b128 v[104:107], v159 offset:13056
    v_mfma_f32_16x16x32_bf16 v[196:199], a[124:127], v[84:87], v[196:199]
    ds_read_b128 v[108:111], v159 offset:19200
    buffer_load_dwordx4 v148, s[48:51], s14 offen offset:0 lds
    v_mfma_f32_16x16x32_bf16 v[196:199], a[116:119], v[80:83], v[196:199]
    ds_read_b128 v[112:115], v159 offset:13312
    v_mfma_f32_16x16x32_bf16 v[204:207], a[116:119], v[88:91], v[204:207]
    ds_read_b128 v[116:119], v159 offset:19456
    buffer_load_dwordx4 v149, s[48:51], s14 offen offset:1024 lds
    v_mfma_f32_16x16x32_bf16 v[204:207], a[124:127], v[92:95], v[204:207]
    ds_read_b128 v[120:123], v159 offset:13568
    v_mfma_f32_16x16x32_bf16 v[200:203], a[120:123], v[92:95], v[200:203]
    ds_read_b128 v[124:127], v159 offset:19712
    v_mfma_f32_16x16x32_bf16 v[200:203], a[112:115], v[88:91], v[200:203]
    ds_read_b64_tr_b16 a[184:185], v154 offset:8192
    buffer_load_dwordx4 v150, s[48:51], s14 offen offset:2048 lds
    v_mfma_f32_16x16x32_bf16 v[208:211], a[112:115], v[96:99], v[208:211]
    ds_read_b64_tr_b16 a[186:187], v154 offset:9216
    v_mfma_f32_16x16x32_bf16 v[208:211], a[120:123], v[100:103], v[208:211]
    buffer_load_dwordx4 v151, s[48:51], s14 offen offset:3072 lds
    v_mfma_f32_16x16x32_bf16 v[212:215], a[124:127], v[100:103], v[212:215]
    ds_read_b64_tr_b16 a[188:189], v155 offset:8192
    v_mfma_f32_16x16x32_bf16 v[212:215], a[116:119], v[96:99], v[212:215]
    ds_read_b64_tr_b16 a[190:191], v155 offset:9216
    s_waitcnt lgkmcnt(4)
    v_mfma_f32_16x16x32_bf16 v[220:223], a[116:119], v[104:107], v[220:223]
    s_waitcnt vmcnt(14)
    s_barrier
    v_mfma_f32_16x16x32_bf16 v[220:223], a[124:127], v[108:111], v[220:223]
    ds_read_b128 v[80:83], v159 offset:24576
    s_add_u32 m0, s74, 12288
    v_mfma_f32_16x16x32_bf16 v[216:219], a[120:123], v[108:111], v[216:219]
    ds_read_b128 v[84:87], v159 offset:30720
    v_mfma_f32_16x16x32_bf16 v[216:219], a[112:115], v[104:107], v[216:219]
    ds_read_b128 v[88:91], v159 offset:24832
    buffer_load_dwordx4 v156, s[44:47], s79 offen offset:0 sc1 lds
    v_mfma_f32_16x16x32_bf16 v[224:227], a[112:115], v[112:115], v[224:227]
    ds_read_b128 v[92:95], v159 offset:30976
    v_mfma_f32_16x16x32_bf16 v[224:227], a[120:123], v[116:119], v[224:227]
    ds_read_b128 v[96:99], v159 offset:25088
    v_mfma_f32_16x16x32_bf16 v[228:231], a[124:127], v[116:119], v[228:231]
    ds_read_b128 v[100:103], v159 offset:31232
    buffer_load_dwordx4 v157, s[44:47], s79 offen offset:1024 sc1 lds
    v_mfma_f32_16x16x32_bf16 v[228:231], a[116:119], v[112:115], v[228:231]
    ds_read_b64_tr_b16 a[192:193], v152 offset:0
    v_mfma_f32_16x16x32_bf16 v[236:239], a[116:119], v[120:123], v[236:239]
    ds_read_b64_tr_b16 a[194:195], v152 offset:1024
    v_mfma_f32_16x16x32_bf16 v[236:239], a[124:127], v[124:127], v[236:239]
    buffer_load_dwordx4 v158, s[44:47], s79 offen offset:2048 sc1 lds
    v_mfma_f32_16x16x32_bf16 v[232:235], a[120:123], v[124:127], v[232:235]
    ds_read_b64_tr_b16 a[196:197], v153 offset:0
    v_mfma_f32_16x16x32_bf16 v[232:235], a[112:115], v[120:123], v[232:235]
    ds_read_b64_tr_b16 a[198:199], v153 offset:1024
    s_waitcnt lgkmcnt(4)
    v_mfma_f32_16x16x32_bf16 v[192:195], a[128:131], v[80:83], v[192:195]
    s_add_u32 m0, s73, 49152
    s_lshl_b32 s14, s81, 3
    v_mfma_f32_16x16x32_bf16 v[192:195], a[136:139], v[84:87], v[192:195]
    ds_read_b128 v[104:107], v159 offset:25344
    v_mfma_f32_16x16x32_bf16 v[196:199], a[140:143], v[84:87], v[196:199]
    ds_read_b128 v[108:111], v159 offset:31488
    buffer_load_dwordx4 v148, s[48:51], s14 offen offset:0 lds
    v_mfma_f32_16x16x32_bf16 v[196:199], a[132:135], v[80:83], v[196:199]
    ds_read_b128 v[112:115], v159 offset:25600
    v_mfma_f32_16x16x32_bf16 v[204:207], a[132:135], v[88:91], v[204:207]
    ds_read_b128 v[116:119], v159 offset:31744
    buffer_load_dwordx4 v149, s[48:51], s14 offen offset:1024 lds
    v_mfma_f32_16x16x32_bf16 v[204:207], a[140:143], v[92:95], v[204:207]
    ds_read_b128 v[120:123], v159 offset:25856
    v_mfma_f32_16x16x32_bf16 v[200:203], a[136:139], v[92:95], v[200:203]
    ds_read_b128 v[124:127], v159 offset:32000
    v_mfma_f32_16x16x32_bf16 v[200:203], a[128:131], v[88:91], v[200:203]
    ds_read_b64_tr_b16 a[200:201], v152 offset:8192
    buffer_load_dwordx4 v150, s[48:51], s14 offen offset:2048 lds
    v_mfma_f32_16x16x32_bf16 v[208:211], a[128:131], v[96:99], v[208:211]
    ds_read_b64_tr_b16 a[202:203], v152 offset:9216
    v_mfma_f32_16x16x32_bf16 v[208:211], a[136:139], v[100:103], v[208:211]
    buffer_load_dwordx4 v151, s[48:51], s14 offen offset:3072 lds
    v_mfma_f32_16x16x32_bf16 v[212:215], a[140:143], v[100:103], v[212:215]
    ds_read_b64_tr_b16 a[204:205], v153 offset:8192
    v_mfma_f32_16x16x32_bf16 v[212:215], a[132:135], v[96:99], v[212:215]
    ds_read_b64_tr_b16 a[206:207], v153 offset:9216
    s_waitcnt lgkmcnt(4)
    v_mfma_f32_16x16x32_bf16 v[220:223], a[132:135], v[104:107], v[220:223]
    s_waitcnt vmcnt(14)
    s_barrier
    v_mfma_f32_16x16x32_bf16 v[220:223], a[140:143], v[108:111], v[220:223]
    ds_read_b128 v[80:83], v250 offset:0
    s_add_u32 m0, s74, 24576
    v_mfma_f32_16x16x32_bf16 v[216:219], a[136:139], v[108:111], v[216:219]
    ds_read_b128 v[84:87], v250 offset:6144
    v_mfma_f32_16x16x32_bf16 v[216:219], a[128:131], v[104:107], v[216:219]
    ds_read_b128 v[88:91], v250 offset:256
    buffer_load_dwordx4 v156, s[44:47], s80 offen offset:0 sc1 lds
    v_mfma_f32_16x16x32_bf16 v[224:227], a[128:131], v[112:115], v[224:227]
    ds_read_b128 v[92:95], v250 offset:6400
    v_mfma_f32_16x16x32_bf16 v[224:227], a[136:139], v[116:119], v[224:227]
    ds_read_b128 v[96:99], v250 offset:512
    v_mfma_f32_16x16x32_bf16 v[228:231], a[140:143], v[116:119], v[228:231]
    ds_read_b128 v[100:103], v250 offset:6656
    buffer_load_dwordx4 v157, s[44:47], s80 offen offset:1024 sc1 lds
    v_mfma_f32_16x16x32_bf16 v[228:231], a[132:135], v[112:115], v[228:231]
    ds_read_b64_tr_b16 a[208:209], v152 offset:16384
    v_mfma_f32_16x16x32_bf16 v[236:239], a[132:135], v[120:123], v[236:239]
    ds_read_b64_tr_b16 a[210:211], v152 offset:17408
    v_mfma_f32_16x16x32_bf16 v[236:239], a[140:143], v[124:127], v[236:239]
    buffer_load_dwordx4 v158, s[44:47], s80 offen offset:2048 sc1 lds
    v_mfma_f32_16x16x32_bf16 v[232:235], a[136:139], v[124:127], v[232:235]
    ds_read_b64_tr_b16 a[212:213], v153 offset:16384
    v_mfma_f32_16x16x32_bf16 v[232:235], a[128:131], v[120:123], v[232:235]
    ds_read_b64_tr_b16 a[214:215], v153 offset:17408
    s_waitcnt lgkmcnt(4)
    v_mfma_f32_16x16x32_bf16 v[192:195], a[144:147], v[80:83], v[192:195]
    s_add_u32 m0, s73, 65536
    s_lshl_b32 s14, s84, 18
    v_mfma_f32_16x16x32_bf16 v[192:195], a[152:155], v[84:87], v[192:195]
    ds_read_b128 v[104:107], v250 offset:768
    v_mfma_f32_16x16x32_bf16 v[196:199], a[156:159], v[84:87], v[196:199]
    ds_read_b128 v[108:111], v250 offset:6912
    buffer_load_dwordx4 v4, s[52:55], s14 offen offset:0 lds
    v_mfma_f32_16x16x32_bf16 v[196:199], a[148:151], v[80:83], v[196:199]
    ds_read_b128 v[112:115], v250 offset:1024
    v_mfma_f32_16x16x32_bf16 v[204:207], a[148:151], v[88:91], v[204:207]
    ds_read_b128 v[116:119], v250 offset:7168
    buffer_load_dwordx4 v5, s[52:55], s14 offen offset:1024 lds
    v_mfma_f32_16x16x32_bf16 v[204:207], a[156:159], v[92:95], v[204:207]
    ds_read_b128 v[120:123], v250 offset:1280
    v_mfma_f32_16x16x32_bf16 v[200:203], a[152:155], v[92:95], v[200:203]
    ds_read_b128 v[124:127], v250 offset:7424
    v_mfma_f32_16x16x32_bf16 v[200:203], a[144:147], v[88:91], v[200:203]
    ds_read_b64_tr_b16 a[216:217], v152 offset:24576
    buffer_load_dwordx4 v6, s[52:55], s14 offen offset:2048 lds
    v_mfma_f32_16x16x32_bf16 v[208:211], a[144:147], v[96:99], v[208:211]
    ds_read_b64_tr_b16 a[218:219], v152 offset:25600
    v_mfma_f32_16x16x32_bf16 v[208:211], a[152:155], v[100:103], v[208:211]
    buffer_load_dwordx4 v7, s[52:55], s14 offen offset:3072 lds
    v_mfma_f32_16x16x32_bf16 v[212:215], a[156:159], v[100:103], v[212:215]
    ds_read_b64_tr_b16 a[220:221], v153 offset:24576
    v_mfma_f32_16x16x32_bf16 v[212:215], a[148:151], v[96:99], v[212:215]
    ds_read_b64_tr_b16 a[222:223], v153 offset:25600
    s_waitcnt lgkmcnt(4)
    v_mfma_f32_16x16x32_bf16 v[220:223], a[148:151], v[104:107], v[220:223]
    s_waitcnt vmcnt(14)
    s_barrier
    v_mfma_f32_16x16x32_bf16 v[220:223], a[156:159], v[108:111], v[220:223]
    ds_read_b128 v[80:83], v250 offset:12288
    v_mfma_f32_16x16x32_bf16 v[216:219], a[152:155], v[108:111], v[216:219]
    ds_read_b128 v[84:87], v250 offset:18432
    v_mfma_f32_16x16x32_bf16 v[216:219], a[144:147], v[104:107], v[216:219]
    ds_read_b128 v[88:91], v250 offset:12544
    v_mfma_f32_16x16x32_bf16 v[224:227], a[144:147], v[112:115], v[224:227]
    ds_read_b128 v[92:95], v250 offset:18688
    v_mfma_f32_16x16x32_bf16 v[224:227], a[152:155], v[116:119], v[224:227]
    ds_read_b128 v[96:99], v250 offset:12800
    v_mfma_f32_16x16x32_bf16 v[228:231], a[156:159], v[116:119], v[228:231]
    ds_read_b128 v[100:103], v250 offset:18944
    v_mfma_f32_16x16x32_bf16 v[228:231], a[148:151], v[112:115], v[228:231]
    ds_read_b64_tr_b16 a[224:225], v152 offset:32768
    v_mfma_f32_16x16x32_bf16 v[236:239], a[148:151], v[120:123], v[236:239]
    ds_read_b64_tr_b16 a[226:227], v152 offset:33792
    v_mfma_f32_16x16x32_bf16 v[236:239], a[156:159], v[124:127], v[236:239]
    v_mfma_f32_16x16x32_bf16 v[232:235], a[152:155], v[124:127], v[232:235]
    ds_read_b64_tr_b16 a[228:229], v153 offset:32768
    v_mfma_f32_16x16x32_bf16 v[232:235], a[144:147], v[120:123], v[232:235]
    ds_read_b64_tr_b16 a[230:231], v153 offset:33792
    s_waitcnt lgkmcnt(4)
    v_mfma_f32_16x16x32_bf16 v[192:195], a[160:163], v[80:83], v[192:195]
    v_mfma_f32_16x16x32_bf16 v[192:195], a[168:171], v[84:87], v[192:195]
    ds_read_b128 v[104:107], v250 offset:13056
    v_mfma_f32_16x16x32_bf16 v[196:199], a[172:175], v[84:87], v[196:199]
    ds_read_b128 v[108:111], v250 offset:19200
    v_mfma_f32_16x16x32_bf16 v[196:199], a[164:167], v[80:83], v[196:199]
    ds_read_b128 v[112:115], v250 offset:13312
    v_mfma_f32_16x16x32_bf16 v[204:207], a[164:167], v[88:91], v[204:207]
    ds_read_b128 v[116:119], v250 offset:19456
    v_mfma_f32_16x16x32_bf16 v[204:207], a[172:175], v[92:95], v[204:207]
    ds_read_b128 v[120:123], v250 offset:13568
    v_mfma_f32_16x16x32_bf16 v[200:203], a[168:171], v[92:95], v[200:203]
    ds_read_b128 v[124:127], v250 offset:19712
    v_mfma_f32_16x16x32_bf16 v[200:203], a[160:163], v[88:91], v[200:203]
    ds_read_b64_tr_b16 a[232:233], v152 offset:40960
    v_mfma_f32_16x16x32_bf16 v[208:211], a[160:163], v[96:99], v[208:211]
    ds_read_b64_tr_b16 a[234:235], v152 offset:41984
    v_mfma_f32_16x16x32_bf16 v[208:211], a[168:171], v[100:103], v[208:211]
    v_mfma_f32_16x16x32_bf16 v[212:215], a[172:175], v[100:103], v[212:215]
    ds_read_b64_tr_b16 a[236:237], v153 offset:40960
    v_mfma_f32_16x16x32_bf16 v[212:215], a[164:167], v[96:99], v[212:215]
    ds_read_b64_tr_b16 a[238:239], v153 offset:41984
    s_waitcnt lgkmcnt(4)
    v_mfma_f32_16x16x32_bf16 v[220:223], a[164:167], v[104:107], v[220:223]
    s_waitcnt vmcnt(7)
    s_barrier
    v_mfma_f32_16x16x32_bf16 v[220:223], a[172:175], v[108:111], v[220:223]
    ds_read_b128 v[80:83], v250 offset:24576
    v_mfma_f32_16x16x32_bf16 v[216:219], a[168:171], v[108:111], v[216:219]
    ds_read_b128 v[84:87], v250 offset:30720
    v_mfma_f32_16x16x32_bf16 v[216:219], a[160:163], v[104:107], v[216:219]
    ds_read_b128 v[88:91], v250 offset:24832
    v_mfma_f32_16x16x32_bf16 v[224:227], a[160:163], v[112:115], v[224:227]
    ds_read_b128 v[92:95], v250 offset:30976
    v_mfma_f32_16x16x32_bf16 v[224:227], a[168:171], v[116:119], v[224:227]
    ds_read_b128 v[96:99], v250 offset:25088
    v_mfma_f32_16x16x32_bf16 v[228:231], a[172:175], v[116:119], v[228:231]
    ds_read_b128 v[100:103], v250 offset:31232
    v_mfma_f32_16x16x32_bf16 v[228:231], a[164:167], v[112:115], v[228:231]
    ds_read_b64_tr_b16 a[240:241], v152 offset:49152
    v_mfma_f32_16x16x32_bf16 v[236:239], a[164:167], v[120:123], v[236:239]
    ds_read_b64_tr_b16 a[242:243], v152 offset:50176
    v_mfma_f32_16x16x32_bf16 v[236:239], a[172:175], v[124:127], v[236:239]
    v_mfma_f32_16x16x32_bf16 v[232:235], a[168:171], v[124:127], v[232:235]
    ds_read_b64_tr_b16 a[244:245], v153 offset:49152
    v_mfma_f32_16x16x32_bf16 v[232:235], a[160:163], v[120:123], v[232:235]
    ds_read_b64_tr_b16 a[246:247], v153 offset:50176
    s_waitcnt lgkmcnt(4)
    v_mfma_f32_16x16x32_bf16 v[192:195], a[176:179], v[80:83], v[192:195]
    v_mfma_f32_16x16x32_bf16 v[192:195], a[184:187], v[84:87], v[192:195]
    ds_read_b128 v[104:107], v250 offset:25344
    v_mfma_f32_16x16x32_bf16 v[196:199], a[188:191], v[84:87], v[196:199]
    ds_read_b128 v[108:111], v250 offset:31488
    v_mfma_f32_16x16x32_bf16 v[196:199], a[180:183], v[80:83], v[196:199]
    ds_read_b128 v[112:115], v250 offset:25600
    v_mfma_f32_16x16x32_bf16 v[204:207], a[180:183], v[88:91], v[204:207]
    ds_read_b128 v[116:119], v250 offset:31744
    v_mfma_f32_16x16x32_bf16 v[204:207], a[188:191], v[92:95], v[204:207]
    ds_read_b128 v[120:123], v250 offset:25856
    v_mfma_f32_16x16x32_bf16 v[200:203], a[184:187], v[92:95], v[200:203]
    ds_read_b128 v[124:127], v250 offset:32000
    v_mfma_f32_16x16x32_bf16 v[200:203], a[176:179], v[88:91], v[200:203]
    ds_read_b64_tr_b16 a[248:249], v152 offset:57344
    v_mfma_f32_16x16x32_bf16 v[208:211], a[176:179], v[96:99], v[208:211]
    ds_read_b64_tr_b16 a[250:251], v152 offset:58368
    v_mfma_f32_16x16x32_bf16 v[208:211], a[184:187], v[100:103], v[208:211]
    v_mfma_f32_16x16x32_bf16 v[212:215], a[188:191], v[100:103], v[212:215]
    ds_read_b64_tr_b16 a[252:253], v153 offset:57344
    v_mfma_f32_16x16x32_bf16 v[212:215], a[180:183], v[96:99], v[212:215]
    ds_read_b64_tr_b16 a[254:255], v153 offset:58368
    s_waitcnt lgkmcnt(4)
    v_mfma_f32_16x16x32_bf16 v[220:223], a[180:183], v[104:107], v[220:223]
    s_barrier
    v_mfma_f32_16x16x32_bf16 v[220:223], a[188:191], v[108:111], v[220:223]
    ds_read_b128 v[80:83], v159 offset:0
    s_add_u32 m0, s74, 36864
    v_mfma_f32_16x16x32_bf16 v[216:219], a[184:187], v[108:111], v[216:219]
    ds_read_b128 v[84:87], v159 offset:6144
    v_mfma_f32_16x16x32_bf16 v[216:219], a[176:179], v[104:107], v[216:219]
    ds_read_b128 v[88:91], v159 offset:256
    buffer_load_dwordx4 v156, s[44:47], s81 offen offset:0 sc1 lds
    v_mfma_f32_16x16x32_bf16 v[224:227], a[176:179], v[112:115], v[224:227]
    ds_read_b128 v[92:95], v159 offset:6400
    v_mfma_f32_16x16x32_bf16 v[224:227], a[184:187], v[116:119], v[224:227]
    ds_read_b128 v[96:99], v159 offset:512
    v_mfma_f32_16x16x32_bf16 v[228:231], a[188:191], v[116:119], v[228:231]
    ds_read_b128 v[100:103], v159 offset:6656
    buffer_load_dwordx4 v157, s[44:47], s81 offen offset:1024 sc1 lds
    v_mfma_f32_16x16x32_bf16 v[228:231], a[180:183], v[112:115], v[228:231]
    v_mfma_f32_16x16x32_bf16 v[236:239], a[180:183], v[120:123], v[236:239]
    v_mfma_f32_16x16x32_bf16 v[236:239], a[188:191], v[124:127], v[236:239]
    buffer_load_dwordx4 v158, s[44:47], s81 offen offset:2048 sc1 lds
    v_mfma_f32_16x16x32_bf16 v[232:235], a[184:187], v[124:127], v[232:235]
    v_mfma_f32_16x16x32_bf16 v[232:235], a[176:179], v[120:123], v[232:235]
    s_waitcnt lgkmcnt(0)
    v_mfma_f32_16x16x32_bf16 v[192:195], a[192:195], v[80:83], v[192:195]
    s_and_b32 s13, s70, 1
    s_mul_i32 s13, s13, 3072
    v_mfma_f32_16x16x32_bf16 v[192:195], a[200:203], v[84:87], v[192:195]
    ds_read_b128 v[104:107], v159 offset:768
    s_sub_u32 s13, s13, 1536
    v_mfma_f32_16x16x32_bf16 v[196:199], a[204:207], v[84:87], v[196:199]
    ds_read_b128 v[108:111], v159 offset:6912
    v_add_u32 v156, s13, v156
    v_mfma_f32_16x16x32_bf16 v[196:199], a[196:199], v[80:83], v[196:199]
    ds_read_b128 v[112:115], v159 offset:1024
    v_mfma_f32_16x16x32_bf16 v[204:207], a[196:199], v[88:91], v[204:207]
    ds_read_b128 v[116:119], v159 offset:7168
    v_add_u32 v157, s13, v157
    v_mfma_f32_16x16x32_bf16 v[204:207], a[204:207], v[92:95], v[204:207]
    ds_read_b128 v[120:123], v159 offset:1280
    v_add_u32 v158, s13, v158
    v_mfma_f32_16x16x32_bf16 v[200:203], a[200:203], v[92:95], v[200:203]
    ds_read_b128 v[124:127], v159 offset:7424
    s_add_u32 m0, s74, 49152
    v_mfma_f32_16x16x32_bf16 v[200:203], a[192:195], v[88:91], v[200:203]
    v_mfma_f32_16x16x32_bf16 v[208:211], a[192:195], v[96:99], v[208:211]
    buffer_load_dwordx4 v156, s[44:47], s18 offen offset:0 sc1 lds
    v_mfma_f32_16x16x32_bf16 v[208:211], a[200:203], v[100:103], v[208:211]
    buffer_load_dwordx4 v157, s[44:47], s18 offen offset:1024 sc1 lds
    v_mfma_f32_16x16x32_bf16 v[212:215], a[204:207], v[100:103], v[212:215]
    buffer_load_dwordx4 v158, s[44:47], s18 offen offset:2048 sc1 lds
    v_mfma_f32_16x16x32_bf16 v[212:215], a[196:199], v[96:99], v[212:215]
    s_waitcnt lgkmcnt(0)
    v_mfma_f32_16x16x32_bf16 v[220:223], a[196:199], v[104:107], v[220:223]
    s_barrier
    v_mfma_f32_16x16x32_bf16 v[220:223], a[204:207], v[108:111], v[220:223]
    ds_read_b128 v[80:83], v159 offset:12288
    s_add_u32 m0, s74, 61440
    v_mfma_f32_16x16x32_bf16 v[216:219], a[200:203], v[108:111], v[216:219]
    ds_read_b128 v[84:87], v159 offset:18432
    v_mfma_f32_16x16x32_bf16 v[216:219], a[192:195], v[104:107], v[216:219]
    ds_read_b128 v[88:91], v159 offset:12544
    buffer_load_dwordx4 v156, s[44:47], s19 offen offset:0 sc1 lds
    v_mfma_f32_16x16x32_bf16 v[224:227], a[192:195], v[112:115], v[224:227]
    ds_read_b128 v[92:95], v159 offset:18688
    v_mfma_f32_16x16x32_bf16 v[224:227], a[200:203], v[116:119], v[224:227]
    ds_read_b128 v[96:99], v159 offset:12800
    v_mfma_f32_16x16x32_bf16 v[228:231], a[204:207], v[116:119], v[228:231]
    ds_read_b128 v[100:103], v159 offset:18944
    buffer_load_dwordx4 v157, s[44:47], s19 offen offset:1024 sc1 lds
    v_mfma_f32_16x16x32_bf16 v[228:231], a[196:199], v[112:115], v[228:231]
    v_mfma_f32_16x16x32_bf16 v[236:239], a[196:199], v[120:123], v[236:239]
    v_mfma_f32_16x16x32_bf16 v[236:239], a[204:207], v[124:127], v[236:239]
    buffer_load_dwordx4 v158, s[44:47], s19 offen offset:2048 sc1 lds
    v_mfma_f32_16x16x32_bf16 v[232:235], a[200:203], v[124:127], v[232:235]
    v_mfma_f32_16x16x32_bf16 v[232:235], a[192:195], v[120:123], v[232:235]
    s_waitcnt lgkmcnt(0)
    v_mfma_f32_16x16x32_bf16 v[192:195], a[208:211], v[80:83], v[192:195]
    s_add_u32 m0, s74, 0
    v_mfma_f32_16x16x32_bf16 v[192:195], a[216:219], v[84:87], v[192:195]
    ds_read_b128 v[104:107], v159 offset:13056
    v_mfma_f32_16x16x32_bf16 v[196:199], a[220:223], v[84:87], v[196:199]
    ds_read_b128 v[108:111], v159 offset:19200
    v_mfma_f32_16x16x32_bf16 v[196:199], a[212:215], v[80:83], v[196:199]
    ds_read_b128 v[112:115], v159 offset:13312
    buffer_load_dwordx4 v156, s[44:47], s20 offen offset:0 sc1 lds
    v_mfma_f32_16x16x32_bf16 v[204:207], a[212:215], v[88:91], v[204:207]
    ds_read_b128 v[116:119], v159 offset:19456
    v_mfma_f32_16x16x32_bf16 v[204:207], a[220:223], v[92:95], v[204:207]
    ds_read_b128 v[120:123], v159 offset:13568
    v_mfma_f32_16x16x32_bf16 v[200:203], a[216:219], v[92:95], v[200:203]
    ds_read_b128 v[124:127], v159 offset:19712
    buffer_load_dwordx4 v157, s[44:47], s20 offen offset:1024 sc1 lds
    v_mfma_f32_16x16x32_bf16 v[200:203], a[208:211], v[88:91], v[200:203]
    v_mfma_f32_16x16x32_bf16 v[208:211], a[208:211], v[96:99], v[208:211]
    v_mfma_f32_16x16x32_bf16 v[208:211], a[216:219], v[100:103], v[208:211]
    buffer_load_dwordx4 v158, s[44:47], s20 offen offset:2048 sc1 lds
    v_mfma_f32_16x16x32_bf16 v[212:215], a[220:223], v[100:103], v[212:215]
    v_mfma_f32_16x16x32_bf16 v[212:215], a[212:215], v[96:99], v[212:215]
    s_waitcnt lgkmcnt(0)
    v_mfma_f32_16x16x32_bf16 v[220:223], a[212:215], v[104:107], v[220:223]
    s_waitcnt vmcnt(16)
    s_barrier
    v_mfma_f32_16x16x32_bf16 v[220:223], a[220:223], v[108:111], v[220:223]
    ds_read_b128 v[80:83], v159 offset:24576
    s_add_u32 m0, s74, 12288
    v_mfma_f32_16x16x32_bf16 v[216:219], a[216:219], v[108:111], v[216:219]
    ds_read_b128 v[84:87], v159 offset:30720
    v_mfma_f32_16x16x32_bf16 v[216:219], a[208:211], v[104:107], v[216:219]
    ds_read_b128 v[88:91], v159 offset:24832
    buffer_load_dwordx4 v156, s[44:47], s21 offen offset:0 sc1 lds
    v_mfma_f32_16x16x32_bf16 v[224:227], a[208:211], v[112:115], v[224:227]
    ds_read_b128 v[92:95], v159 offset:30976
    v_mfma_f32_16x16x32_bf16 v[224:227], a[216:219], v[116:119], v[224:227]
    ds_read_b128 v[96:99], v159 offset:25088
    v_mfma_f32_16x16x32_bf16 v[228:231], a[220:223], v[116:119], v[228:231]
    ds_read_b128 v[100:103], v159 offset:31232
    buffer_load_dwordx4 v157, s[44:47], s21 offen offset:1024 sc1 lds
    v_mfma_f32_16x16x32_bf16 v[228:231], a[212:215], v[112:115], v[228:231]
    v_mfma_f32_16x16x32_bf16 v[236:239], a[212:215], v[120:123], v[236:239]
    v_mfma_f32_16x16x32_bf16 v[236:239], a[220:223], v[124:127], v[236:239]
    buffer_load_dwordx4 v158, s[44:47], s21 offen offset:2048 sc1 lds
    v_mfma_f32_16x16x32_bf16 v[232:235], a[216:219], v[124:127], v[232:235]
    v_mfma_f32_16x16x32_bf16 v[232:235], a[208:211], v[120:123], v[232:235]
    s_waitcnt lgkmcnt(0)
    v_mfma_f32_16x16x32_bf16 v[192:195], a[224:227], v[80:83], v[192:195]
    s_add_u32 m0, s73, 0
    s_lshl_b32 s14, s85, 18
    v_mfma_f32_16x16x32_bf16 v[192:195], a[232:235], v[84:87], v[192:195]
    ds_read_b128 v[104:107], v159 offset:25344
    v_mfma_f32_16x16x32_bf16 v[196:199], a[236:239], v[84:87], v[196:199]
    ds_read_b128 v[108:111], v159 offset:31488
    buffer_load_dwordx4 v4, s[52:55], s14 offen offset:0 lds
    v_mfma_f32_16x16x32_bf16 v[196:199], a[228:231], v[80:83], v[196:199]
    ds_read_b128 v[112:115], v159 offset:25600
    v_mfma_f32_16x16x32_bf16 v[204:207], a[228:231], v[88:91], v[204:207]
    ds_read_b128 v[116:119], v159 offset:31744
    buffer_load_dwordx4 v5, s[52:55], s14 offen offset:1024 lds
    v_mfma_f32_16x16x32_bf16 v[204:207], a[236:239], v[92:95], v[204:207]
    ds_read_b128 v[120:123], v159 offset:25856
    v_mfma_f32_16x16x32_bf16 v[200:203], a[232:235], v[92:95], v[200:203]
    ds_read_b128 v[124:127], v159 offset:32000
    v_mfma_f32_16x16x32_bf16 v[200:203], a[224:227], v[88:91], v[200:203]
    buffer_load_dwordx4 v6, s[52:55], s14 offen offset:2048 lds
    v_mfma_f32_16x16x32_bf16 v[208:211], a[224:227], v[96:99], v[208:211]
    v_mfma_f32_16x16x32_bf16 v[208:211], a[232:235], v[100:103], v[208:211]
    buffer_load_dwordx4 v7, s[52:55], s14 offen offset:3072 lds
    v_mfma_f32_16x16x32_bf16 v[212:215], a[236:239], v[100:103], v[212:215]
    v_mfma_f32_16x16x32_bf16 v[212:215], a[228:231], v[96:99], v[212:215]
    s_waitcnt lgkmcnt(0)
    v_mfma_f32_16x16x32_bf16 v[220:223], a[228:231], v[104:107], v[220:223]
    s_waitcnt vmcnt(16)
    s_barrier
    v_mfma_f32_16x16x32_bf16 v[220:223], a[236:239], v[108:111], v[220:223]
    ds_read_b128 v[80:83], v250 offset:0
    v_mfma_f32_16x16x32_bf16 v[216:219], a[232:235], v[108:111], v[216:219]
    ds_read_b128 v[84:87], v250 offset:6144
    v_mfma_f32_16x16x32_bf16 v[216:219], a[224:227], v[104:107], v[216:219]
    ds_read_b128 v[88:91], v250 offset:256
    v_mfma_f32_16x16x32_bf16 v[224:227], a[224:227], v[112:115], v[224:227]
    ds_read_b128 v[92:95], v250 offset:6400
    v_mfma_f32_16x16x32_bf16 v[224:227], a[232:235], v[116:119], v[224:227]
    ds_read_b128 v[96:99], v250 offset:512
    v_mfma_f32_16x16x32_bf16 v[228:231], a[236:239], v[116:119], v[228:231]
L_pl_G_3:
    s_cbranch_execz L_wret
    ds_read_b128 v[100:103], v250 offset:6656
    v_mfma_f32_16x16x32_bf16 v[228:231], a[228:231], v[112:115], v[228:231]
    v_mfma_f32_16x16x32_bf16 v[236:239], a[228:231], v[120:123], v[236:239]
    v_mfma_f32_16x16x32_bf16 v[236:239], a[236:239], v[124:127], v[236:239]
    v_mfma_f32_16x16x32_bf16 v[232:235], a[232:235], v[124:127], v[232:235]
    v_mfma_f32_16x16x32_bf16 v[232:235], a[224:227], v[120:123], v[232:235]
    s_waitcnt lgkmcnt(0)
    v_mfma_f32_16x16x32_bf16 v[192:195], a[240:243], v[80:83], v[192:195]
    v_mfma_f32_16x16x32_bf16 v[192:195], a[248:251], v[84:87], v[192:195]
    ds_read_b128 v[104:107], v250 offset:768
    v_mfma_f32_16x16x32_bf16 v[196:199], a[252:255], v[84:87], v[196:199]
    ds_read_b128 v[108:111], v250 offset:6912
    v_mfma_f32_16x16x32_bf16 v[196:199], a[244:247], v[80:83], v[196:199]
    ds_read_b128 v[112:115], v250 offset:1024
    v_mfma_f32_16x16x32_bf16 v[204:207], a[244:247], v[88:91], v[204:207]
    ds_read_b128 v[116:119], v250 offset:7168
    v_mfma_f32_16x16x32_bf16 v[204:207], a[252:255], v[92:95], v[204:207]
    ds_read_b128 v[120:123], v250 offset:1280
    v_mfma_f32_16x16x32_bf16 v[200:203], a[248:251], v[92:95], v[200:203]
    ds_read_b128 v[124:127], v250 offset:7424
    v_mfma_f32_16x16x32_bf16 v[200:203], a[240:243], v[88:91], v[200:203]
    v_mfma_f32_16x16x32_bf16 v[208:211], a[240:243], v[96:99], v[208:211]
    v_mfma_f32_16x16x32_bf16 v[208:211], a[248:251], v[100:103], v[208:211]
    v_mfma_f32_16x16x32_bf16 v[212:215], a[252:255], v[100:103], v[212:215]
    v_mfma_f32_16x16x32_bf16 v[212:215], a[244:247], v[96:99], v[212:215]
    s_waitcnt lgkmcnt(0)
    v_mfma_f32_16x16x32_bf16 v[220:223], a[244:247], v[104:107], v[220:223]
    s_waitcnt vmcnt(13)
    s_barrier
    v_mfma_f32_16x16x32_bf16 v[220:223], a[252:255], v[108:111], v[220:223]
    ds_read_b128 v[80:83], v250 offset:12288
    v_mfma_f32_16x16x32_bf16 v[216:219], a[248:251], v[108:111], v[216:219]
    ds_read_b128 v[84:87], v250 offset:18432
    v_mfma_f32_16x16x32_bf16 v[216:219], a[240:243], v[104:107], v[216:219]
    ds_read_b128 v[88:91], v250 offset:12544
    v_mfma_f32_16x16x32_bf16 v[224:227], a[240:243], v[112:115], v[224:227]
    ds_read_b128 v[92:95], v250 offset:18688
    v_cvt_pk_bf16_f32 v192, v192, v193
    v_mfma_f32_16x16x32_bf16 v[224:227], a[248:251], v[116:119], v[224:227]
    ds_read_b128 v[96:99], v250 offset:12800
    v_mfma_f32_16x16x32_bf16 v[228:231], a[252:255], v[116:119], v[228:231]
    ds_read_b128 v[100:103], v250 offset:18944
    v_cvt_pk_bf16_f32 v193, v194, v195
    v_mfma_f32_16x16x32_bf16 v[228:231], a[244:247], v[112:115], v[228:231]
    v_mfma_f32_16x16x32_bf16 v[236:239], a[244:247], v[120:123], v[236:239]
    v_cvt_pk_bf16_f32 v194, v196, v197
    v_mfma_f32_16x16x32_bf16 v[236:239], a[252:255], v[124:127], v[236:239]
    v_cvt_pk_bf16_f32 v195, v198, v199
    v_mfma_f32_16x16x32_bf16 v[232:235], a[248:251], v[124:127], v[232:235]
    v_mfma_f32_16x16x32_bf16 v[232:235], a[240:243], v[120:123], v[232:235]
    buffer_store_dwordx4 v[192:195], v246, s[44:47], s9 offen offset:0 sc1
    s_waitcnt lgkmcnt(0)
    v_mfma_f32_16x16x32_bf16 v[32:35], a[0:3], v[80:83], v[128:131]
    v_mfma_f32_16x16x32_bf16 v[32:35], a[8:11], v[84:87], v[32:35]
    ds_read_b128 v[104:107], v250 offset:13056
    v_mfma_f32_16x16x32_bf16 v[36:39], a[12:15], v[84:87], v[132:135]
    ds_read_b128 v[108:111], v250 offset:19200
    v_mfma_f32_16x16x32_bf16 v[36:39], a[4:7], v[80:83], v[36:39]
    ds_read_b128 v[112:115], v250 offset:13312
    v_mfma_f32_16x16x32_bf16 v[44:47], a[4:7], v[88:91], v[132:135]
    ds_read_b128 v[116:119], v250 offset:19456
    v_cvt_pk_bf16_f32 v200, v200, v201
    v_mfma_f32_16x16x32_bf16 v[44:47], a[12:15], v[92:95], v[44:47]
    ds_read_b128 v[120:123], v250 offset:13568
    v_mfma_f32_16x16x32_bf16 v[40:43], a[8:11], v[92:95], v[128:131]
    ds_read_b128 v[124:127], v250 offset:19712
    v_cvt_pk_bf16_f32 v201, v202, v203
    v_mfma_f32_16x16x32_bf16 v[40:43], a[0:3], v[88:91], v[40:43]
    v_mfma_f32_16x16x32_bf16 v[48:51], a[0:3], v[96:99], v[128:131]
    v_cvt_pk_bf16_f32 v202, v204, v205
    v_mfma_f32_16x16x32_bf16 v[48:51], a[8:11], v[100:103], v[48:51]
    v_cvt_pk_bf16_f32 v203, v206, v207
    v_mfma_f32_16x16x32_bf16 v[52:55], a[12:15], v[100:103], v[132:135]
    v_mfma_f32_16x16x32_bf16 v[52:55], a[4:7], v[96:99], v[52:55]
    buffer_store_dwordx4 v[200:203], v246, s[44:47], s9 offen offset:1024 sc1
    s_waitcnt lgkmcnt(0)
    v_mfma_f32_16x16x32_bf16 v[60:63], a[4:7], v[104:107], v[132:135]
    s_waitcnt vmcnt(12)
    s_barrier
    v_mfma_f32_16x16x32_bf16 v[60:63], a[12:15], v[108:111], v[60:63]
    ds_read_b128 v[80:83], v250 offset:24576
    s_add_u32 m0, s74, 24576
    v_cvt_pk_bf16_f32 v208, v208, v209
    v_mfma_f32_16x16x32_bf16 v[56:59], a[8:11], v[108:111], v[128:131]
    ds_read_b128 v[84:87], v250 offset:30720
    v_mfma_f32_16x16x32_bf16 v[56:59], a[0:3], v[104:107], v[56:59]
    ds_read_b128 v[88:91], v250 offset:24832
    buffer_load_dwordx4 v156, s[44:47], s22 offen offset:0 sc1 lds
    v_mfma_f32_16x16x32_bf16 v[64:67], a[0:3], v[112:115], v[128:131]
    ds_read_b128 v[92:95], v250 offset:30976
    v_cvt_pk_bf16_f32 v209, v210, v211
    v_mfma_f32_16x16x32_bf16 v[64:67], a[8:11], v[116:119], v[64:67]
    ds_read_b128 v[96:99], v250 offset:25088
    v_cvt_pk_bf16_f32 v210, v212, v213
    v_mfma_f32_16x16x32_bf16 v[68:71], a[12:15], v[116:119], v[132:135]
    ds_read_b128 v[100:103], v250 offset:31232
    buffer_load_dwordx4 v157, s[44:47], s22 offen offset:1024 sc1 lds
    v_mfma_f32_16x16x32_bf16 v[68:71], a[4:7], v[112:115], v[68:71]
    v_mfma_f32_16x16x32_bf16 v[76:79], a[4:7], v[120:123], v[132:135]
    v_cvt_pk_bf16_f32 v211, v214, v215
    v_mfma_f32_16x16x32_bf16 v[76:79], a[12:15], v[124:127], v[76:79]
    buffer_load_dwordx4 v158, s[44:47], s22 offen offset:2048 sc1 lds
    v_mfma_f32_16x16x32_bf16 v[72:75], a[8:11], v[124:127], v[128:131]
    buffer_store_dwordx4 v[208:211], v246, s[44:47], s9 offen offset:2048 sc1
    v_mfma_f32_16x16x32_bf16 v[72:75], a[0:3], v[120:123], v[72:75]
    s_waitcnt lgkmcnt(0)
    v_mfma_f32_16x16x32_bf16 v[32:35], a[16:19], v[80:83], v[32:35]
    s_add_u32 m0, s74, 36864
    v_mfma_f32_16x16x32_bf16 v[32:35], a[24:27], v[84:87], v[32:35]
    ds_read_b128 v[104:107], v250 offset:25344
    v_cvt_pk_bf16_f32 v216, v216, v217
    v_mfma_f32_16x16x32_bf16 v[36:39], a[28:31], v[84:87], v[36:39]
    ds_read_b128 v[108:111], v250 offset:31488
    v_mfma_f32_16x16x32_bf16 v[36:39], a[20:23], v[80:83], v[36:39]
    ds_read_b128 v[112:115], v250 offset:25600
    buffer_load_dwordx4 v156, s[44:47], s23 offen offset:0 sc1 lds
    v_mfma_f32_16x16x32_bf16 v[44:47], a[20:23], v[88:91], v[44:47]
    ds_read_b128 v[116:119], v250 offset:31744
    v_cvt_pk_bf16_f32 v217, v218, v219
    v_mfma_f32_16x16x32_bf16 v[44:47], a[28:31], v[92:95], v[44:47]
    ds_read_b128 v[120:123], v250 offset:25856
    v_cvt_pk_bf16_f32 v218, v220, v221
    v_mfma_f32_16x16x32_bf16 v[40:43], a[24:27], v[92:95], v[40:43]
    ds_read_b128 v[124:127], v250 offset:32000
    buffer_load_dwordx4 v157, s[44:47], s23 offen offset:1024 sc1 lds
    v_mfma_f32_16x16x32_bf16 v[40:43], a[16:19], v[88:91], v[40:43]
    v_mfma_f32_16x16x32_bf16 v[48:51], a[16:19], v[96:99], v[48:51]
    v_cvt_pk_bf16_f32 v219, v222, v223
    v_mfma_f32_16x16x32_bf16 v[48:51], a[24:27], v[100:103], v[48:51]
    buffer_load_dwordx4 v158, s[44:47], s23 offen offset:2048 sc1 lds
    v_mfma_f32_16x16x32_bf16 v[52:55], a[28:31], v[100:103], v[52:55]
    buffer_store_dwordx4 v[216:219], v247, s[44:47], s9 offen offset:0 sc1
    v_mfma_f32_16x16x32_bf16 v[52:55], a[20:23], v[96:99], v[52:55]
    s_waitcnt lgkmcnt(0)
    v_mfma_f32_16x16x32_bf16 v[60:63], a[20:23], v[104:107], v[60:63]
    s_waitcnt vmcnt(17)
    s_barrier
    v_mfma_f32_16x16x32_bf16 v[60:63], a[28:31], v[108:111], v[60:63]
    ds_read_b128 v[80:83], v159 offset:0
    s_add_u32 m0, s74, 49152
    v_cvt_pk_bf16_f32 v224, v224, v225
    v_mfma_f32_16x16x32_bf16 v[56:59], a[24:27], v[108:111], v[56:59]
    ds_read_b128 v[84:87], v159 offset:6144
    v_mfma_f32_16x16x32_bf16 v[56:59], a[16:19], v[104:107], v[56:59]
    ds_read_b128 v[88:91], v159 offset:256
    buffer_load_dwordx4 v156, s[44:47], s24 offen offset:0 sc1 lds
    v_mfma_f32_16x16x32_bf16 v[64:67], a[16:19], v[112:115], v[64:67]
    ds_read_b128 v[92:95], v159 offset:6400
    v_cvt_pk_bf16_f32 v225, v226, v227
    v_mfma_f32_16x16x32_bf16 v[64:67], a[24:27], v[116:119], v[64:67]
    ds_read_b128 v[96:99], v159 offset:512
    v_cvt_pk_bf16_f32 v226, v228, v229
    v_mfma_f32_16x16x32_bf16 v[68:71], a[28:31], v[116:119], v[68:71]
    ds_read_b128 v[100:103], v159 offset:6656
    buffer_load_dwordx4 v157, s[44:47], s24 offen offset:1024 sc1 lds
    v_mfma_f32_16x16x32_bf16 v[68:71], a[20:23], v[112:115], v[68:71]
    v_add_u32 v10, 65536, v10
    v_mfma_f32_16x16x32_bf16 v[76:79], a[20:23], v[120:123], v[76:79]
    ds_read_b64_tr_b16 a[0:1], v10 offset:0
    v_cvt_pk_bf16_f32 v227, v230, v231
    v_mfma_f32_16x16x32_bf16 v[76:79], a[28:31], v[124:127], v[76:79]
    ds_read_b64_tr_b16 a[2:3], v10 offset:2048
    buffer_load_dwordx4 v158, s[44:47], s24 offen offset:2048 sc1 lds
    v_mfma_f32_16x16x32_bf16 v[72:75], a[24:27], v[124:127], v[72:75]
    buffer_store_dwordx4 v[224:227], v247, s[44:47], s9 offen offset:1024 sc1
    ds_read_b64_tr_b16 a[8:9], v10 offset:4096
    v_mfma_f32_16x16x32_bf16 v[72:75], a[16:19], v[120:123], v[72:75]
    ds_read_b64_tr_b16 a[10:11], v10 offset:6144
    s_waitcnt lgkmcnt(4)
    v_mfma_f32_16x16x32_bf16 v[32:35], a[32:35], v[80:83], v[32:35]
    s_add_u32 m0, s74, 61440
    v_mfma_f32_16x16x32_bf16 v[32:35], a[40:43], v[84:87], v[32:35]
    ds_read_b128 v[104:107], v159 offset:768
    v_cvt_pk_bf16_f32 v232, v232, v233
    v_mfma_f32_16x16x32_bf16 v[36:39], a[44:47], v[84:87], v[36:39]
    ds_read_b128 v[108:111], v159 offset:6912
    v_mfma_f32_16x16x32_bf16 v[36:39], a[36:39], v[80:83], v[36:39]
    ds_read_b128 v[112:115], v159 offset:1024
    buffer_load_dwordx4 v156, s[44:47], s25 offen offset:0 sc1 lds
    v_mfma_f32_16x16x32_bf16 v[44:47], a[36:39], v[88:91], v[44:47]
    ds_read_b128 v[116:119], v159 offset:7168
    v_cvt_pk_bf16_f32 v233, v234, v235
    v_mfma_f32_16x16x32_bf16 v[44:47], a[44:47], v[92:95], v[44:47]
    ds_read_b128 v[120:123], v159 offset:1280
    v_cvt_pk_bf16_f32 v234, v236, v237
    v_mfma_f32_16x16x32_bf16 v[40:43], a[40:43], v[92:95], v[40:43]
    ds_read_b128 v[124:127], v159 offset:7424
    buffer_load_dwordx4 v157, s[44:47], s25 offen offset:1024 sc1 lds
    v_mfma_f32_16x16x32_bf16 v[40:43], a[32:35], v[88:91], v[40:43]
    v_add_u32 v11, 65536, v11
    v_mfma_f32_16x16x32_bf16 v[48:51], a[32:35], v[96:99], v[48:51]
    ds_read_b64_tr_b16 a[4:5], v11 offset:0
    v_cvt_pk_bf16_f32 v235, v238, v239
    v_mfma_f32_16x16x32_bf16 v[48:51], a[40:43], v[100:103], v[48:51]
    ds_read_b64_tr_b16 a[6:7], v11 offset:2048
    buffer_load_dwordx4 v158, s[44:47], s25 offen offset:2048 sc1 lds
    v_mfma_f32_16x16x32_bf16 v[52:55], a[44:47], v[100:103], v[52:55]
    buffer_store_dwordx4 v[232:235], v247, s[44:47], s9 offen offset:2048 sc1
    ds_read_b64_tr_b16 a[12:13], v11 offset:4096
    v_mfma_f32_16x16x32_bf16 v[52:55], a[36:39], v[96:99], v[52:55]
    ds_read_b64_tr_b16 a[14:15], v11 offset:6144
    s_waitcnt lgkmcnt(4)
    v_mfma_f32_16x16x32_bf16 v[60:63], a[36:39], v[104:107], v[60:63]
    s_waitcnt vmcnt(18)
    s_barrier
    v_mfma_f32_16x16x32_bf16 v[60:63], a[44:47], v[108:111], v[60:63]
    ds_read_b128 v[80:83], v159 offset:12288
    s_add_u32 m0, s74, 0
    v_mfma_f32_16x16x32_bf16 v[56:59], a[40:43], v[108:111], v[56:59]
    ds_read_b128 v[84:87], v159 offset:18432
    v_mfma_f32_16x16x32_bf16 v[56:59], a[32:35], v[104:107], v[56:59]
    ds_read_b128 v[88:91], v159 offset:12544
    buffer_load_dwordx4 v156, s[44:47], s26 offen offset:0 sc1 lds
    v_mfma_f32_16x16x32_bf16 v[64:67], a[32:35], v[112:115], v[64:67]
    ds_read_b128 v[92:95], v159 offset:18688
    v_mfma_f32_16x16x32_bf16 v[64:67], a[40:43], v[116:119], v[64:67]
    ds_read_b128 v[96:99], v159 offset:12800
    v_mfma_f32_16x16x32_bf16 v[68:71], a[44:47], v[116:119], v[68:71]
    ds_read_b128 v[100:103], v159 offset:18944
    buffer_load_dwordx4 v157, s[44:47], s26 offen offset:1024 sc1 lds
    v_mfma_f32_16x16x32_bf16 v[68:71], a[36:39], v[112:115], v[68:71]
    v_add_u32 v10, -65536, v10
    v_mfma_f32_16x16x32_bf16 v[76:79], a[36:39], v[120:123], v[76:79]
    ds_read_b64_tr_b16 a[16:17], v10 offset:0
    v_mfma_f32_16x16x32_bf16 v[76:79], a[44:47], v[124:127], v[76:79]
    ds_read_b64_tr_b16 a[18:19], v10 offset:2048
    buffer_load_dwordx4 v158, s[44:47], s26 offen offset:2048 sc1 lds
    v_mfma_f32_16x16x32_bf16 v[72:75], a[40:43], v[124:127], v[72:75]
    ds_read_b64_tr_b16 a[24:25], v10 offset:4096
    v_mfma_f32_16x16x32_bf16 v[72:75], a[32:35], v[120:123], v[72:75]
    ds_read_b64_tr_b16 a[26:27], v10 offset:6144
    s_waitcnt lgkmcnt(4)
    v_mfma_f32_16x16x32_bf16 v[32:35], a[48:51], v[80:83], v[32:35]
    v_mfma_f32_16x16x32_bf16 v[32:35], a[56:59], v[84:87], v[32:35]
    ds_read_b128 v[104:107], v159 offset:13056
    v_mfma_f32_16x16x32_bf16 v[36:39], a[60:63], v[84:87], v[36:39]
    ds_read_b128 v[108:111], v159 offset:19200
    v_mfma_f32_16x16x32_bf16 v[36:39], a[52:55], v[80:83], v[36:39]
    ds_read_b128 v[112:115], v159 offset:13312
    v_mfma_f32_16x16x32_bf16 v[44:47], a[52:55], v[88:91], v[44:47]
    ds_read_b128 v[116:119], v159 offset:19456
    v_mfma_f32_16x16x32_bf16 v[44:47], a[60:63], v[92:95], v[44:47]
    ds_read_b128 v[120:123], v159 offset:13568
    v_mfma_f32_16x16x32_bf16 v[40:43], a[56:59], v[92:95], v[40:43]
    ds_read_b128 v[124:127], v159 offset:19712
    v_mfma_f32_16x16x32_bf16 v[40:43], a[48:51], v[88:91], v[40:43]
    v_add_u32 v11, -65536, v11
    v_mfma_f32_16x16x32_bf16 v[48:51], a[48:51], v[96:99], v[48:51]
    ds_read_b64_tr_b16 a[20:21], v11 offset:0
    v_mfma_f32_16x16x32_bf16 v[48:51], a[56:59], v[100:103], v[48:51]
    ds_read_b64_tr_b16 a[22:23], v11 offset:2048
    v_mfma_f32_16x16x32_bf16 v[52:55], a[60:63], v[100:103], v[52:55]
    ds_read_b64_tr_b16 a[28:29], v11 offset:4096
    v_mfma_f32_16x16x32_bf16 v[52:55], a[52:55], v[96:99], v[52:55]
    ds_read_b64_tr_b16 a[30:31], v11 offset:6144
    s_waitcnt lgkmcnt(4)
    v_mfma_f32_16x16x32_bf16 v[60:63], a[52:55], v[104:107], v[60:63]
    s_waitcnt vmcnt(16)
    s_barrier
    v_mfma_f32_16x16x32_bf16 v[60:63], a[60:63], v[108:111], v[60:63]
    ds_read_b128 v[80:83], v159 offset:24576
    s_add_u32 m0, s74, 12288
    v_mfma_f32_16x16x32_bf16 v[56:59], a[56:59], v[108:111], v[56:59]
    ds_read_b128 v[84:87], v159 offset:30720
    v_mfma_f32_16x16x32_bf16 v[56:59], a[48:51], v[104:107], v[56:59]
    ds_read_b128 v[88:91], v159 offset:24832
    buffer_load_dwordx4 v156, s[44:47], s27 offen offset:0 sc1 lds
    v_mfma_f32_16x16x32_bf16 v[64:67], a[48:51], v[112:115], v[64:67]
    ds_read_b128 v[92:95], v159 offset:30976
    v_mfma_f32_16x16x32_bf16 v[64:67], a[56:59], v[116:119], v[64:67]
    ds_read_b128 v[96:99], v159 offset:25088
    v_mfma_f32_16x16x32_bf16 v[68:71], a[60:63], v[116:119], v[68:71]
    ds_read_b128 v[100:103], v159 offset:31232
    buffer_load_dwordx4 v157, s[44:47], s27 offen offset:1024 sc1 lds
    v_mfma_f32_16x16x32_bf16 v[68:71], a[52:55], v[112:115], v[68:71]
    v_mfma_f32_16x16x32_bf16 v[76:79], a[52:55], v[120:123], v[76:79]
    v_mfma_f32_16x16x32_bf16 v[76:79], a[60:63], v[124:127], v[76:79]
    buffer_load_dwordx4 v158, s[44:47], s27 offen offset:2048 sc1 lds
    v_mfma_f32_16x16x32_bf16 v[72:75], a[56:59], v[124:127], v[72:75]
    v_mfma_f32_16x16x32_bf16 v[72:75], a[48:51], v[120:123], v[72:75]
    s_waitcnt lgkmcnt(0)
    v_mfma_f32_16x16x32_bf16 v[32:35], a[64:67], v[80:83], v[32:35]
    s_add_u32 m0, s73, 16384
    s_lshl_b32 s14, s86, 18
    v_mfma_f32_16x16x32_bf16 v[32:35], a[72:75], v[84:87], v[32:35]
    ds_read_b128 v[104:107], v159 offset:25344
    v_mfma_f32_16x16x32_bf16 v[36:39], a[76:79], v[84:87], v[36:39]
    ds_read_b128 v[108:111], v159 offset:31488
    buffer_load_dwordx4 v4, s[52:55], s14 offen offset:0 lds
    v_mfma_f32_16x16x32_bf16 v[36:39], a[68:71], v[80:83], v[36:39]
    ds_read_b128 v[112:115], v159 offset:25600
    v_mfma_f32_16x16x32_bf16 v[44:47], a[68:71], v[88:91], v[44:47]
    ds_read_b128 v[116:119], v159 offset:31744
    buffer_load_dwordx4 v5, s[52:55], s14 offen offset:1024 lds
    v_mfma_f32_16x16x32_bf16 v[44:47], a[76:79], v[92:95], v[44:47]
    ds_read_b128 v[120:123], v159 offset:25856
    v_mfma_f32_16x16x32_bf16 v[40:43], a[72:75], v[92:95], v[40:43]
    ds_read_b128 v[124:127], v159 offset:32000
    v_mfma_f32_16x16x32_bf16 v[40:43], a[64:67], v[88:91], v[40:43]
    buffer_load_dwordx4 v6, s[52:55], s14 offen offset:2048 lds
    v_mfma_f32_16x16x32_bf16 v[48:51], a[64:67], v[96:99], v[48:51]
    v_mfma_f32_16x16x32_bf16 v[48:51], a[72:75], v[100:103], v[48:51]
    buffer_load_dwordx4 v7, s[52:55], s14 offen offset:3072 lds
    v_mfma_f32_16x16x32_bf16 v[52:55], a[76:79], v[100:103], v[52:55]
    v_mfma_f32_16x16x32_bf16 v[52:55], a[68:71], v[96:99], v[52:55]
    s_waitcnt lgkmcnt(0)
    v_mfma_f32_16x16x32_bf16 v[60:63], a[68:71], v[104:107], v[60:63]
    s_waitcnt vmcnt(19)
    s_barrier
    v_mfma_f32_16x16x32_bf16 v[60:63], a[76:79], v[108:111], v[60:63]
    ds_read_b128 v[80:83], v250 offset:0
    v_mfma_f32_16x16x32_bf16 v[56:59], a[72:75], v[108:111], v[56:59]
    ds_read_b128 v[84:87], v250 offset:6144
    v_mfma_f32_16x16x32_bf16 v[56:59], a[64:67], v[104:107], v[56:59]
    ds_read_b128 v[88:91], v250 offset:256
    v_mfma_f32_16x16x32_bf16 v[64:67], a[64:67], v[112:115], v[64:67]
    ds_read_b128 v[92:95], v250 offset:6400
    v_mfma_f32_16x16x32_bf16 v[64:67], a[72:75], v[116:119], v[64:67]
    ds_read_b128 v[96:99], v250 offset:512
    v_mfma_f32_16x16x32_bf16 v[68:71], a[76:79], v[116:119], v[68:71]
    ds_read_b128 v[100:103], v250 offset:6656
    v_mfma_f32_16x16x32_bf16 v[68:71], a[68:71], v[112:115], v[68:71]
    v_mfma_f32_16x16x32_bf16 v[76:79], a[68:71], v[120:123], v[76:79]
    v_mfma_f32_16x16x32_bf16 v[76:79], a[76:79], v[124:127], v[76:79]
    v_mfma_f32_16x16x32_bf16 v[72:75], a[72:75], v[124:127], v[72:75]
    v_mfma_f32_16x16x32_bf16 v[72:75], a[64:67], v[120:123], v[72:75]
    s_waitcnt lgkmcnt(0)
    v_mfma_f32_16x16x32_bf16 v[32:35], a[80:83], v[80:83], v[32:35]
    v_mfma_f32_16x16x32_bf16 v[32:35], a[88:91], v[84:87], v[32:35]
    ds_read_b128 v[104:107], v250 offset:768
    v_mfma_f32_16x16x32_bf16 v[36:39], a[92:95], v[84:87], v[36:39]
    ds_read_b128 v[108:111], v250 offset:6912
    v_mfma_f32_16x16x32_bf16 v[36:39], a[84:87], v[80:83], v[36:39]
    ds_read_b128 v[112:115], v250 offset:1024
    v_mfma_f32_16x16x32_bf16 v[44:47], a[84:87], v[88:91], v[44:47]
    ds_read_b128 v[116:119], v250 offset:7168
    v_mfma_f32_16x16x32_bf16 v[44:47], a[92:95], v[92:95], v[44:47]
    ds_read_b128 v[120:123], v250 offset:1280
    v_mfma_f32_16x16x32_bf16 v[40:43], a[88:91], v[92:95], v[40:43]
    ds_read_b128 v[124:127], v250 offset:7424
    v_mfma_f32_16x16x32_bf16 v[40:43], a[80:83], v[88:91], v[40:43]
    s_waitcnt vmcnt(10)
    buffer_store_dword v249, v248, s[44:47], s6 offen sc1
    v_mfma_f32_16x16x32_bf16 v[48:51], a[80:83], v[96:99], v[48:51]
    v_mfma_f32_16x16x32_bf16 v[48:51], a[88:91], v[100:103], v[48:51]
    v_mfma_f32_16x16x32_bf16 v[52:55], a[92:95], v[100:103], v[52:55]
    v_mfma_f32_16x16x32_bf16 v[52:55], a[84:87], v[96:99], v[52:55]
    s_waitcnt lgkmcnt(0)
    v_mfma_f32_16x16x32_bf16 v[60:63], a[84:87], v[104:107], v[60:63]
    s_barrier
    v_mfma_f32_16x16x32_bf16 v[60:63], a[92:95], v[108:111], v[60:63]
    ds_read_b128 v[80:83], v250 offset:12288
    v_mfma_f32_16x16x32_bf16 v[56:59], a[88:91], v[108:111], v[56:59]
    ds_read_b128 v[84:87], v250 offset:18432
    v_mfma_f32_16x16x32_bf16 v[56:59], a[80:83], v[104:107], v[56:59]
    ds_read_b128 v[88:91], v250 offset:12544
    v_mfma_f32_16x16x32_bf16 v[64:67], a[80:83], v[112:115], v[64:67]
    ds_read_b128 v[92:95], v250 offset:18688
    v_mfma_f32_16x16x32_bf16 v[64:67], a[88:91], v[116:119], v[64:67]
    ds_read_b128 v[96:99], v250 offset:12800
    v_mfma_f32_16x16x32_bf16 v[68:71], a[92:95], v[116:119], v[68:71]
    ds_read_b128 v[100:103], v250 offset:18944
    v_mfma_f32_16x16x32_bf16 v[68:71], a[84:87], v[112:115], v[68:71]
    v_mfma_f32_16x16x32_bf16 v[76:79], a[84:87], v[120:123], v[76:79]
    v_mfma_f32_16x16x32_bf16 v[76:79], a[92:95], v[124:127], v[76:79]
    v_mfma_f32_16x16x32_bf16 v[72:75], a[88:91], v[124:127], v[72:75]
    v_mfma_f32_16x16x32_bf16 v[72:75], a[80:83], v[120:123], v[72:75]
    s_waitcnt lgkmcnt(0)
    v_mfma_f32_16x16x32_bf16 v[32:35], a[96:99], v[80:83], v[32:35]
    v_mfma_f32_16x16x32_bf16 v[32:35], a[104:107], v[84:87], v[32:35]
    ds_read_b128 v[104:107], v250 offset:13056
    v_mfma_f32_16x16x32_bf16 v[36:39], a[108:111], v[84:87], v[36:39]
    ds_read_b128 v[108:111], v250 offset:19200
    v_mfma_f32_16x16x32_bf16 v[36:39], a[100:103], v[80:83], v[36:39]
    ds_read_b128 v[112:115], v250 offset:13312
    v_mfma_f32_16x16x32_bf16 v[44:47], a[100:103], v[88:91], v[44:47]
    ds_read_b128 v[116:119], v250 offset:19456
    v_mfma_f32_16x16x32_bf16 v[44:47], a[108:111], v[92:95], v[44:47]
    ds_read_b128 v[120:123], v250 offset:13568
    v_mfma_f32_16x16x32_bf16 v[40:43], a[104:107], v[92:95], v[40:43]
    ds_read_b128 v[124:127], v250 offset:19712
    v_mfma_f32_16x16x32_bf16 v[40:43], a[96:99], v[88:91], v[40:43]
    v_mfma_f32_16x16x32_bf16 v[48:51], a[96:99], v[96:99], v[48:51]
    v_mfma_f32_16x16x32_bf16 v[48:51], a[104:107], v[100:103], v[48:51]
    v_mfma_f32_16x16x32_bf16 v[52:55], a[108:111], v[100:103], v[52:55]
    v_mfma_f32_16x16x32_bf16 v[52:55], a[100:103], v[96:99], v[52:55]
    s_waitcnt lgkmcnt(0)
    v_mfma_f32_16x16x32_bf16 v[60:63], a[100:103], v[104:107], v[60:63]
    s_barrier
    v_mfma_f32_16x16x32_bf16 v[60:63], a[108:111], v[108:111], v[60:63]
    ds_read_b128 v[80:83], v250 offset:24576
    s_add_u32 m0, s74, 24576
    v_mfma_f32_16x16x32_bf16 v[56:59], a[104:107], v[108:111], v[56:59]
    ds_read_b128 v[84:87], v250 offset:30720
    v_mfma_f32_16x16x32_bf16 v[56:59], a[96:99], v[104:107], v[56:59]
    ds_read_b128 v[88:91], v250 offset:24832
    buffer_load_dwordx4 v156, s[44:47], s76 offen offset:0 sc1 lds
    v_mfma_f32_16x16x32_bf16 v[64:67], a[96:99], v[112:115], v[64:67]
    ds_read_b128 v[92:95], v250 offset:30976
    v_mfma_f32_16x16x32_bf16 v[64:67], a[104:107], v[116:119], v[64:67]
    ds_read_b128 v[96:99], v250 offset:25088
    v_mfma_f32_16x16x32_bf16 v[68:71], a[108:111], v[116:119], v[68:71]
    ds_read_b128 v[100:103], v250 offset:31232
    buffer_load_dwordx4 v157, s[44:47], s76 offen offset:1024 sc1 lds
    v_mfma_f32_16x16x32_bf16 v[68:71], a[100:103], v[112:115], v[68:71]
    v_mfma_f32_16x16x32_bf16 v[76:79], a[100:103], v[120:123], v[76:79]
    v_mfma_f32_16x16x32_bf16 v[76:79], a[108:111], v[124:127], v[76:79]
    buffer_load_dwordx4 v158, s[44:47], s76 offen offset:2048 sc1 lds
    v_mfma_f32_16x16x32_bf16 v[72:75], a[104:107], v[124:127], v[72:75]
    v_mfma_f32_16x16x32_bf16 v[72:75], a[96:99], v[120:123], v[72:75]
    s_waitcnt lgkmcnt(0)
    v_mfma_f32_16x16x32_bf16 v[32:35], a[112:115], v[80:83], v[32:35]
    s_add_u32 m0, s74, 36864
    v_mfma_f32_16x16x32_bf16 v[32:35], a[120:123], v[84:87], v[32:35]
    ds_read_b128 v[104:107], v250 offset:25344
    v_mfma_f32_16x16x32_bf16 v[36:39], a[124:127], v[84:87], v[36:39]
    ds_read_b128 v[108:111], v250 offset:31488
    v_mfma_f32_16x16x32_bf16 v[36:39], a[116:119], v[80:83], v[36:39]
    ds_read_b128 v[112:115], v250 offset:25600
    buffer_load_dwordx4 v156, s[44:47], s77 offen offset:0 sc1 lds
    v_mfma_f32_16x16x32_bf16 v[44:47], a[116:119], v[88:91], v[44:47]
    ds_read_b128 v[116:119], v250 offset:31744
    v_mfma_f32_16x16x32_bf16 v[44:47], a[124:127], v[92:95], v[44:47]
    ds_read_b128 v[120:123], v250 offset:25856
    v_mfma_f32_16x16x32_bf16 v[40:43], a[120:123], v[92:95], v[40:43]
    ds_read_b128 v[124:127], v250 offset:32000
    buffer_load_dwordx4 v157, s[44:47], s77 offen offset:1024 sc1 lds
    v_mfma_f32_16x16x32_bf16 v[40:43], a[112:115], v[88:91], v[40:43]
    v_mfma_f32_16x16x32_bf16 v[48:51], a[112:115], v[96:99], v[48:51]
    v_mfma_f32_16x16x32_bf16 v[48:51], a[120:123], v[100:103], v[48:51]
    buffer_load_dwordx4 v158, s[44:47], s77 offen offset:2048 sc1 lds
    v_mfma_f32_16x16x32_bf16 v[52:55], a[124:127], v[100:103], v[52:55]
    v_mfma_f32_16x16x32_bf16 v[52:55], a[116:119], v[96:99], v[52:55]
    s_waitcnt lgkmcnt(0)
    v_mfma_f32_16x16x32_bf16 v[60:63], a[116:119], v[104:107], v[60:63]
    s_waitcnt vmcnt(14)
    s_barrier
    v_mfma_f32_16x16x32_bf16 v[60:63], a[124:127], v[108:111], v[60:63]
    ds_read_b128 v[80:83], v159 offset:0
    s_add_u32 m0, s74, 49152
    v_mfma_f32_16x16x32_bf16 v[56:59], a[120:123], v[108:111], v[56:59]
    ds_read_b128 v[84:87], v159 offset:6144
    v_mfma_f32_16x16x32_bf16 v[56:59], a[112:115], v[104:107], v[56:59]
    ds_read_b128 v[88:91], v159 offset:256
    buffer_load_dwordx4 v156, s[44:47], s78 offen offset:0 sc1 lds
    v_mfma_f32_16x16x32_bf16 v[64:67], a[112:115], v[112:115], v[64:67]
    ds_read_b128 v[92:95], v159 offset:6400
    v_mfma_f32_16x16x32_bf16 v[64:67], a[120:123], v[116:119], v[64:67]
    ds_read_b128 v[96:99], v159 offset:512
    v_mfma_f32_16x16x32_bf16 v[68:71], a[124:127], v[116:119], v[68:71]
    ds_read_b128 v[100:103], v159 offset:6656
    buffer_load_dwordx4 v157, s[44:47], s78 offen offset:1024 sc1 lds
    v_mfma_f32_16x16x32_bf16 v[68:71], a[116:119], v[112:115], v[68:71]
    v_mfma_f32_16x16x32_bf16 v[76:79], a[116:119], v[120:123], v[76:79]
    v_mfma_f32_16x16x32_bf16 v[76:79], a[124:127], v[124:127], v[76:79]
    buffer_load_dwordx4 v158, s[44:47], s78 offen offset:2048 sc1 lds
    v_mfma_f32_16x16x32_bf16 v[72:75], a[120:123], v[124:127], v[72:75]
    v_mfma_f32_16x16x32_bf16 v[72:75], a[112:115], v[120:123], v[72:75]
    s_waitcnt lgkmcnt(0)
    v_mfma_f32_16x16x32_bf16 v[32:35], a[128:131], v[80:83], v[32:35]
    s_add_u32 m0, s74, 61440
    v_mfma_f32_16x16x32_bf16 v[32:35], a[136:139], v[84:87], v[32:35]
    ds_read_b128 v[104:107], v159 offset:768
    v_mfma_f32_16x16x32_bf16 v[36:39], a[140:143], v[84:87], v[36:39]
    ds_read_b128 v[108:111], v159 offset:6912
    v_mfma_f32_16x16x32_bf16 v[36:39], a[132:135], v[80:83], v[36:39]
    ds_read_b128 v[112:115], v159 offset:1024
    buffer_load_dwordx4 v156, s[44:47], s79 offen offset:0 sc1 lds
    v_mfma_f32_16x16x32_bf16 v[44:47], a[132:135], v[88:91], v[44:47]
    ds_read_b128 v[116:119], v159 offset:7168
    v_mfma_f32_16x16x32_bf16 v[44:47], a[140:143], v[92:95], v[44:47]
    ds_read_b128 v[120:123], v159 offset:1280
    v_mfma_f32_16x16x32_bf16 v[40:43], a[136:139], v[92:95], v[40:43]
    ds_read_b128 v[124:127], v159 offset:7424
    buffer_load_dwordx4 v157, s[44:47], s79 offen offset:1024 sc1 lds
    v_mfma_f32_16x16x32_bf16 v[40:43], a[128:131], v[88:91], v[40:43]
    v_mfma_f32_16x16x32_bf16 v[48:51], a[128:131], v[96:99], v[48:51]
    v_mfma_f32_16x16x32_bf16 v[48:51], a[136:139], v[100:103], v[48:51]
    buffer_load_dwordx4 v158, s[44:47], s79 offen offset:2048 sc1 lds
    v_mfma_f32_16x16x32_bf16 v[52:55], a[140:143], v[100:103], v[52:55]
    v_mfma_f32_16x16x32_bf16 v[52:55], a[132:135], v[96:99], v[52:55]
    s_waitcnt lgkmcnt(0)
    v_mfma_f32_16x16x32_bf16 v[60:63], a[132:135], v[104:107], v[60:63]
    s_waitcnt vmcnt(13)
    s_barrier
    v_mfma_f32_16x16x32_bf16 v[60:63], a[140:143], v[108:111], v[60:63]
    ds_read_b128 v[80:83], v159 offset:12288
    s_add_u32 m0, s74, 0
    v_mfma_f32_16x16x32_bf16 v[56:59], a[136:139], v[108:111], v[56:59]
    ds_read_b128 v[84:87], v159 offset:18432
    v_mfma_f32_16x16x32_bf16 v[56:59], a[128:131], v[104:107], v[56:59]
    ds_read_b128 v[88:91], v159 offset:12544
    buffer_load_dwordx4 v156, s[44:47], s80 offen offset:0 sc1 lds
    v_mfma_f32_16x16x32_bf16 v[64:67], a[128:131], v[112:115], v[64:67]
    ds_read_b128 v[92:95], v159 offset:18688
    v_mfma_f32_16x16x32_bf16 v[64:67], a[136:139], v[116:119], v[64:67]
    ds_read_b128 v[96:99], v159 offset:12800
    buffer_load_dword v29, v28, s[44:47], 0 offen sc1
    v_mfma_f32_16x16x32_bf16 v[68:71], a[140:143], v[116:119], v[68:71]
    ds_read_b128 v[100:103], v159 offset:18944
    buffer_load_dwordx4 v157, s[44:47], s80 offen offset:1024 sc1 lds
    v_mfma_f32_16x16x32_bf16 v[68:71], a[132:135], v[112:115], v[68:71]
    ds_read_b64_tr_b16 a[32:33], v10 offset:16384
    v_mfma_f32_16x16x32_bf16 v[76:79], a[132:135], v[120:123], v[76:79]
    ds_read_b64_tr_b16 a[34:35], v10 offset:18432
    v_mfma_f32_16x16x32_bf16 v[76:79], a[140:143], v[124:127], v[76:79]
    buffer_load_dwordx4 v158, s[44:47], s80 offen offset:2048 sc1 lds
    v_mfma_f32_16x16x32_bf16 v[72:75], a[136:139], v[124:127], v[72:75]
    ds_read_b64_tr_b16 a[40:41], v10 offset:20480
    v_mfma_f32_16x16x32_bf16 v[72:75], a[128:131], v[120:123], v[72:75]
    ds_read_b64_tr_b16 a[42:43], v10 offset:22528
    s_waitcnt lgkmcnt(4)
    v_mfma_f32_16x16x32_bf16 v[32:35], a[144:147], v[80:83], v[32:35]
    s_add_u32 m0, s73, 32768
    s_lshl_b32 s14, s87, 18
    v_mfma_f32_16x16x32_bf16 v[32:35], a[152:155], v[84:87], v[32:35]
    ds_read_b128 v[104:107], v159 offset:13056
    v_mfma_f32_16x16x32_bf16 v[36:39], a[156:159], v[84:87], v[36:39]
    ds_read_b128 v[108:111], v159 offset:19200
    buffer_load_dwordx4 v4, s[52:55], s14 offen offset:0 lds
    v_mfma_f32_16x16x32_bf16 v[36:39], a[148:151], v[80:83], v[36:39]
    ds_read_b128 v[112:115], v159 offset:13312
    v_mfma_f32_16x16x32_bf16 v[44:47], a[148:151], v[88:91], v[44:47]
    ds_read_b128 v[116:119], v159 offset:19456
    buffer_load_dwordx4 v5, s[52:55], s14 offen offset:1024 lds
    v_mfma_f32_16x16x32_bf16 v[44:47], a[156:159], v[92:95], v[44:47]
    ds_read_b128 v[120:123], v159 offset:13568
    v_mfma_f32_16x16x32_bf16 v[40:43], a[152:155], v[92:95], v[40:43]
    ds_read_b128 v[124:127], v159 offset:19712
    v_mfma_f32_16x16x32_bf16 v[40:43], a[144:147], v[88:91], v[40:43]
    ds_read_b64_tr_b16 a[36:37], v11 offset:16384
    buffer_load_dwordx4 v6, s[52:55], s14 offen offset:2048 lds
    v_mfma_f32_16x16x32_bf16 v[48:51], a[144:147], v[96:99], v[48:51]
    ds_read_b64_tr_b16 a[38:39], v11 offset:18432
L_pl_G_4:
    s_cbranch_execz L_wret
    v_mfma_f32_16x16x32_bf16 v[48:51], a[152:155], v[100:103], v[48:51]
    buffer_load_dwordx4 v7, s[52:55], s14 offen offset:3072 lds
    v_mfma_f32_16x16x32_bf16 v[52:55], a[156:159], v[100:103], v[52:55]
    ds_read_b64_tr_b16 a[44:45], v11 offset:20480
    v_mfma_f32_16x16x32_bf16 v[52:55], a[148:151], v[96:99], v[52:55]
    ds_read_b64_tr_b16 a[46:47], v11 offset:22528
    s_waitcnt lgkmcnt(4)
    v_mfma_f32_16x16x32_bf16 v[60:63], a[148:151], v[104:107], v[60:63]
    s_waitcnt vmcnt(17)
    s_barrier
    v_mfma_f32_16x16x32_bf16 v[60:63], a[156:159], v[108:111], v[60:63]
    ds_read_b128 v[80:83], v159 offset:24576
    v_mfma_f32_16x16x32_bf16 v[56:59], a[152:155], v[108:111], v[56:59]
    ds_read_b128 v[84:87], v159 offset:30720
    v_mfma_f32_16x16x32_bf16 v[56:59], a[144:147], v[104:107], v[56:59]
    ds_read_b128 v[88:91], v159 offset:24832
    v_mfma_f32_16x16x32_bf16 v[64:67], a[144:147], v[112:115], v[64:67]
    ds_read_b128 v[92:95], v159 offset:30976
    v_mfma_f32_16x16x32_bf16 v[64:67], a[152:155], v[116:119], v[64:67]
    ds_read_b128 v[96:99], v159 offset:25088
    v_mfma_f32_16x16x32_bf16 v[68:71], a[156:159], v[116:119], v[68:71]
    ds_read_b128 v[100:103], v159 offset:31232
    v_mfma_f32_16x16x32_bf16 v[68:71], a[148:151], v[112:115], v[68:71]
    v_mfma_f32_16x16x32_bf16 v[76:79], a[148:151], v[120:123], v[76:79]
    v_mfma_f32_16x16x32_bf16 v[76:79], a[156:159], v[124:127], v[76:79]
    v_mfma_f32_16x16x32_bf16 v[72:75], a[152:155], v[124:127], v[72:75]
    v_mfma_f32_16x16x32_bf16 v[72:75], a[144:147], v[120:123], v[72:75]
    s_waitcnt lgkmcnt(0)
    v_mfma_f32_16x16x32_bf16 v[32:35], a[160:163], v[80:83], v[32:35]
    v_mfma_f32_16x16x32_bf16 v[32:35], a[168:171], v[84:87], v[32:35]
    ds_read_b128 v[104:107], v159 offset:25344
    v_mfma_f32_16x16x32_bf16 v[36:39], a[172:175], v[84:87], v[36:39]
    ds_read_b128 v[108:111], v159 offset:31488
    v_mfma_f32_16x16x32_bf16 v[36:39], a[164:167], v[80:83], v[36:39]
    ds_read_b128 v[112:115], v159 offset:25600
    v_mfma_f32_16x16x32_bf16 v[44:47], a[164:167], v[88:91], v[44:47]
    ds_read_b128 v[116:119], v159 offset:31744
    v_mfma_f32_16x16x32_bf16 v[44:47], a[172:175], v[92:95], v[44:47]
    ds_read_b128 v[120:123], v159 offset:25856
    v_mfma_f32_16x16x32_bf16 v[40:43], a[168:171], v[92:95], v[40:43]
    ds_read_b128 v[124:127], v159 offset:32000
    v_mfma_f32_16x16x32_bf16 v[40:43], a[160:163], v[88:91], v[40:43]
    v_mfma_f32_16x16x32_bf16 v[48:51], a[160:163], v[96:99], v[48:51]
    v_mfma_f32_16x16x32_bf16 v[48:51], a[168:171], v[100:103], v[48:51]
    v_mfma_f32_16x16x32_bf16 v[52:55], a[172:175], v[100:103], v[52:55]
    v_mfma_f32_16x16x32_bf16 v[52:55], a[164:167], v[96:99], v[52:55]
    s_waitcnt lgkmcnt(0)
    v_mfma_f32_16x16x32_bf16 v[60:63], a[164:167], v[104:107], v[60:63]
    s_waitcnt vmcnt(14)
    s_barrier
    v_mfma_f32_16x16x32_bf16 v[60:63], a[172:175], v[108:111], v[60:63]
    ds_read_b128 v[80:83], v250 offset:0
    s_waitcnt vmcnt(6)
    v_mfma_f32_16x16x32_bf16 v[56:59], a[168:171], v[108:111], v[56:59]
    ds_read_b128 v[84:87], v250 offset:6144
    v_cmp_ne_u32 vcc, s68, v29
    v_mfma_f32_16x16x32_bf16 v[56:59], a[160:163], v[104:107], v[56:59]
    ds_read_b128 v[88:91], v250 offset:256
    v_mfma_f32_16x16x32_bf16 v[64:67], a[160:163], v[112:115], v[64:67]
    ds_read_b128 v[92:95], v250 offset:6400
    v_mfma_f32_16x16x32_bf16 v[64:67], a[168:171], v[116:119], v[64:67]
    ds_read_b128 v[96:99], v250 offset:512
    s_cbranch_vccnz L_rs_p5
L_ok_p5:
    v_mfma_f32_16x16x32_bf16 v[68:71], a[172:175], v[116:119], v[68:71]
    ds_read_b128 v[100:103], v250 offset:6656
    buffer_load_dwordx4 v[160:163], v246, s[44:47], s10 offen offset:0 sc1
    v_mfma_f32_16x16x32_bf16 v[68:71], a[164:167], v[112:115], v[68:71]
    v_mfma_f32_16x16x32_bf16 v[76:79], a[164:167], v[120:123], v[76:79]
    v_mfma_f32_16x16x32_bf16 v[76:79], a[172:175], v[124:127], v[76:79]
    buffer_load_dwordx4 v[164:167], v246, s[44:47], s10 offen offset:1024 sc1
    v_mfma_f32_16x16x32_bf16 v[72:75], a[168:171], v[124:127], v[72:75]
    buffer_load_dwordx4 v[168:171], v246, s[44:47], s10 offen offset:2048 sc1
    v_mfma_f32_16x16x32_bf16 v[72:75], a[160:163], v[120:123], v[72:75]
    s_waitcnt lgkmcnt(0)
    v_mfma_f32_16x16x32_bf16 v[32:35], a[176:179], v[80:83], v[32:35]
    v_mfma_f32_16x16x32_bf16 v[32:35], a[184:187], v[84:87], v[32:35]
    ds_read_b128 v[104:107], v250 offset:768
    v_mfma_f32_16x16x32_bf16 v[36:39], a[188:191], v[84:87], v[36:39]
    ds_read_b128 v[108:111], v250 offset:6912
    buffer_load_dwordx4 v[172:175], v247, s[44:47], s10 offen offset:0 sc1
    v_mfma_f32_16x16x32_bf16 v[36:39], a[180:183], v[80:83], v[36:39]
    ds_read_b128 v[112:115], v250 offset:1024
    v_mfma_f32_16x16x32_bf16 v[44:47], a[180:183], v[88:91], v[44:47]
    ds_read_b128 v[116:119], v250 offset:7168
    v_mfma_f32_16x16x32_bf16 v[44:47], a[188:191], v[92:95], v[44:47]
    ds_read_b128 v[120:123], v250 offset:1280
    buffer_load_dwordx4 v[176:179], v247, s[44:47], s10 offen offset:1024 sc1
    v_mfma_f32_16x16x32_bf16 v[40:43], a[184:187], v[92:95], v[40:43]
    ds_read_b128 v[124:127], v250 offset:7424
    v_mfma_f32_16x16x32_bf16 v[40:43], a[176:179], v[88:91], v[40:43]
    v_mfma_f32_16x16x32_bf16 v[48:51], a[176:179], v[96:99], v[48:51]
    v_mfma_f32_16x16x32_bf16 v[48:51], a[184:187], v[100:103], v[48:51]
    v_mfma_f32_16x16x32_bf16 v[52:55], a[188:191], v[100:103], v[52:55]
    buffer_load_dwordx4 v[180:183], v247, s[44:47], s10 offen offset:2048 sc1
    v_mfma_f32_16x16x32_bf16 v[52:55], a[180:183], v[96:99], v[52:55]
    s_waitcnt lgkmcnt(0)
    v_mfma_f32_16x16x32_bf16 v[60:63], a[180:183], v[104:107], v[60:63]
    s_barrier
    v_mfma_f32_16x16x32_bf16 v[60:63], a[188:191], v[108:111], v[60:63]
    ds_read_b128 v[80:83], v250 offset:12288
    s_add_u32 m0, s74, 12288
    v_mfma_f32_16x16x32_bf16 v[56:59], a[184:187], v[108:111], v[56:59]
    ds_read_b128 v[84:87], v250 offset:18432
    v_mfma_f32_16x16x32_bf16 v[56:59], a[176:179], v[104:107], v[56:59]
    ds_read_b128 v[88:91], v250 offset:12544
    buffer_load_dwordx4 v156, s[44:47], s81 offen offset:0 sc1 lds
    v_mfma_f32_16x16x32_bf16 v[64:67], a[176:179], v[112:115], v[64:67]
    ds_read_b128 v[92:95], v250 offset:18688
    v_mfma_f32_16x16x32_bf16 v[64:67], a[184:187], v[116:119], v[64:67]
    ds_read_b128 v[96:99], v250 offset:12800
    v_mfma_f32_16x16x32_bf16 v[68:71], a[188:191], v[116:119], v[68:71]
    ds_read_b128 v[100:103], v250 offset:18944
    buffer_load_dwordx4 v157, s[44:47], s81 offen offset:1024 sc1 lds
    v_mfma_f32_16x16x32_bf16 v[68:71], a[180:183], v[112:115], v[68:71]
    v_mfma_f32_16x16x32_bf16 v[76:79], a[180:183], v[120:123], v[76:79]
    v_mfma_f32_16x16x32_bf16 v[76:79], a[188:191], v[124:127], v[76:79]
    buffer_load_dwordx4 v158, s[44:47], s81 offen offset:2048 sc1 lds
    v_mfma_f32_16x16x32_bf16 v[72:75], a[184:187], v[124:127], v[72:75]
    v_mfma_f32_16x16x32_bf16 v[72:75], a[176:179], v[120:123], v[72:75]
    s_waitcnt lgkmcnt(0)
    v_mfma_f32_16x16x32_bf16 v[32:35], a[192:195], v[80:83], v[32:35]
    s_add_u32 m0, s73, 49152
    s_lshl_b32 s14, s88, 18
    v_mfma_f32_16x16x32_bf16 v[32:35], a[200:203], v[84:87], v[32:35]
    ds_read_b128 v[104:107], v250 offset:13056
    v_mfma_f32_16x16x32_bf16 v[36:39], a[204:207], v[84:87], v[36:39]
    ds_read_b128 v[108:111], v250 offset:19200
    buffer_load_dwordx4 v4, s[52:55], s14 offen offset:0 lds
    v_mfma_f32_16x16x32_bf16 v[36:39], a[196:199], v[80:83], v[36:39]
    ds_read_b128 v[112:115], v250 offset:13312
    v_mfma_f32_16x16x32_bf16 v[44:47], a[196:199], v[88:91], v[44:47]
    ds_read_b128 v[116:119], v250 offset:19456
    buffer_load_dwordx4 v5, s[52:55], s14 offen offset:1024 lds
    v_mfma_f32_16x16x32_bf16 v[44:47], a[204:207], v[92:95], v[44:47]
    ds_read_b128 v[120:123], v250 offset:13568
    v_mfma_f32_16x16x32_bf16 v[40:43], a[200:203], v[92:95], v[40:43]
    ds_read_b128 v[124:127], v250 offset:19712
    v_mfma_f32_16x16x32_bf16 v[40:43], a[192:195], v[88:91], v[40:43]
    buffer_load_dwordx4 v6, s[52:55], s14 offen offset:2048 lds
    v_mfma_f32_16x16x32_bf16 v[48:51], a[192:195], v[96:99], v[48:51]
    v_mfma_f32_16x16x32_bf16 v[48:51], a[200:203], v[100:103], v[48:51]
    buffer_load_dwordx4 v7, s[52:55], s14 offen offset:3072 lds
    v_mfma_f32_16x16x32_bf16 v[52:55], a[204:207], v[100:103], v[52:55]
    v_mfma_f32_16x16x32_bf16 v[52:55], a[196:199], v[96:99], v[52:55]
    s_waitcnt lgkmcnt(0)
    v_mfma_f32_16x16x32_bf16 v[60:63], a[196:199], v[104:107], v[60:63]
    s_barrier
    v_mfma_f32_16x16x32_bf16 v[60:63], a[204:207], v[108:111], v[60:63]
    ds_read_b128 v[80:83], v250 offset:24576
    v_mfma_f32_16x16x32_bf16 v[56:59], a[200:203], v[108:111], v[56:59]
    ds_read_b128 v[84:87], v250 offset:30720
    v_mfma_f32_16x16x32_bf16 v[56:59], a[192:195], v[104:107], v[56:59]
    ds_read_b128 v[88:91], v250 offset:24832
    v_mfma_f32_16x16x32_bf16 v[64:67], a[192:195], v[112:115], v[64:67]
    ds_read_b128 v[92:95], v250 offset:30976
    v_mfma_f32_16x16x32_bf16 v[64:67], a[200:203], v[116:119], v[64:67]
    ds_read_b128 v[96:99], v250 offset:25088
    v_mfma_f32_16x16x32_bf16 v[68:71], a[204:207], v[116:119], v[68:71]
    ds_read_b128 v[100:103], v250 offset:31232
    s_waitcnt vmcnt(7)
    v_mfma_f32_16x16x32_bf16 v[68:71], a[196:199], v[112:115], v[68:71]
    v_mfma_f32_16x16x32_bf16 v[76:79], a[196:199], v[120:123], v[76:79]
    v_mfma_f32_16x16x32_bf16 v[76:79], a[204:207], v[124:127], v[76:79]
    v_mfma_f32_16x16x32_bf16 v[72:75], a[200:203], v[124:127], v[72:75]
    v_mfma_f32_16x16x32_bf16 v[72:75], a[192:195], v[120:123], v[72:75]
    s_waitcnt lgkmcnt(0)
    v_mfma_f32_16x16x32_bf16 v[32:35], a[208:211], v[80:83], v[32:35]
    s_add_u32 m0, s73, 65536
    s_lshl_b32 s14, s89, 18
    v_mfma_f32_16x16x32_bf16 v[32:35], a[216:219], v[84:87], v[32:35]
    ds_read_b128 v[104:107], v250 offset:25344
    v_mfma_f32_16x16x32_bf16 v[36:39], a[220:223], v[84:87], v[36:39]
    ds_read_b128 v[108:111], v250 offset:31488
    buffer_load_dwordx4 v4, s[52:55], s14 offen offset:0 lds
    v_and_b32 v193, 0xffff0000, v172
    v_lshlrev_b32 v192, 16, v172
    v_mfma_f32_16x16x32_bf16 v[36:39], a[212:215], v[80:83], v[36:39]
    ds_read_b128 v[112:115], v250 offset:25600
    v_and_b32 v195, 0xffff0000, v173
    v_lshlrev_b32 v194, 16, v173
    v_mfma_f32_16x16x32_bf16 v[44:47], a[212:215], v[88:91], v[44:47]
    ds_read_b128 v[116:119], v250 offset:31744
    buffer_load_dwordx4 v5, s[52:55], s14 offen offset:1024 lds
    v_add_f32 v56, v56, v192
    v_mfma_f32_16x16x32_bf16 v[44:47], a[220:223], v[92:95], v[44:47]
    ds_read_b128 v[120:123], v250 offset:25856
    v_add_f32 v57, v57, v193
    v_add_f32 v58, v58, v194
    v_mfma_f32_16x16x32_bf16 v[40:43], a[216:219], v[92:95], v[40:43]
    ds_read_b128 v[124:127], v250 offset:32000
    v_add_f32 v59, v59, v195
    v_and_b32 v197, 0xffff0000, v174
    v_mfma_f32_16x16x32_bf16 v[40:43], a[208:211], v[88:91], v[40:43]
    buffer_load_dwordx4 v6, s[52:55], s14 offen offset:2048 lds
    v_lshlrev_b32 v196, 16, v174
    v_and_b32 v199, 0xffff0000, v175
    v_mfma_f32_16x16x32_bf16 v[48:51], a[208:211], v[96:99], v[48:51]
    v_lshlrev_b32 v198, 16, v175
    v_add_f32 v60, v60, v196
    v_mfma_f32_16x16x32_bf16 v[48:51], a[216:219], v[100:103], v[48:51]
    buffer_load_dwordx4 v7, s[52:55], s14 offen offset:3072 lds
    v_add_f32 v61, v61, v197
    v_mfma_f32_16x16x32_bf16 v[52:55], a[220:223], v[100:103], v[52:55]
    v_add_f32 v62, v62, v198
    v_add_f32 v63, v63, v199
    v_mfma_f32_16x16x32_bf16 v[52:55], a[212:215], v[96:99], v[52:55]
    s_waitcnt lgkmcnt(0)
    v_mfma_f32_16x16x32_bf16 v[60:63], a[212:215], v[104:107], v[60:63]
    s_barrier
    v_mfma_f32_16x16x32_bf16 v[60:63], a[220:223], v[108:111], v[60:63]
    ds_read_b128 v[80:83], v159 offset:0
    v_mfma_f32_16x16x32_bf16 v[56:59], a[216:219], v[108:111], v[56:59]
    ds_read_b128 v[84:87], v159 offset:6144
    v_and_b32 v193, 0xffff0000, v160
    v_lshlrev_b32 v192, 16, v160
    v_mfma_f32_16x16x32_bf16 v[56:59], a[208:211], v[104:107], v[56:59]
    ds_read_b128 v[88:91], v159 offset:256
    v_and_b32 v195, 0xffff0000, v161
    v_lshlrev_b32 v194, 16, v161
    v_mfma_f32_16x16x32_bf16 v[64:67], a[208:211], v[112:115], v[64:67]
    ds_read_b128 v[92:95], v159 offset:6400
    v_add_f32 v32, v32, v192
    v_mfma_f32_16x16x32_bf16 v[64:67], a[216:219], v[116:119], v[64:67]
    ds_read_b128 v[96:99], v159 offset:512
    v_add_f32 v33, v33, v193
    v_add_f32 v34, v34, v194
    v_mfma_f32_16x16x32_bf16 v[68:71], a[220:223], v[116:119], v[68:71]
    ds_read_b128 v[100:103], v159 offset:6656
    v_add_f32 v35, v35, v195
    v_and_b32 v197, 0xffff0000, v162
    v_mfma_f32_16x16x32_bf16 v[68:71], a[212:215], v[112:115], v[68:71]
    ds_read_b64_tr_b16 a[48:49], v10 offset:32768
    v_lshlrev_b32 v196, 16, v162
    v_and_b32 v199, 0xffff0000, v163
    v_mfma_f32_16x16x32_bf16 v[76:79], a[212:215], v[120:123], v[76:79]
    ds_read_b64_tr_b16 a[50:51], v10 offset:34816
    v_lshlrev_b32 v198, 16, v163
    v_mfma_f32_16x16x32_bf16 v[76:79], a[220:223], v[124:127], v[76:79]
    v_add_f32 v36, v36, v196
    v_add_f32 v37, v37, v197
    v_mfma_f32_16x16x32_bf16 v[72:75], a[216:219], v[124:127], v[72:75]
    ds_read_b64_tr_b16 a[56:57], v10 offset:36864
    v_add_f32 v38, v38, v198
    v_add_f32 v39, v39, v199
    v_mfma_f32_16x16x32_bf16 v[72:75], a[208:211], v[120:123], v[72:75]
    ds_read_b64_tr_b16 a[58:59], v10 offset:38912
    s_waitcnt lgkmcnt(4)
    v_mfma_f32_16x16x32_bf16 v[32:35], a[224:227], v[80:83], v[32:35]
    s_add_u32 m0, s73, 0
    s_lshl_b32 s14, s90, 18
    v_mfma_f32_16x16x32_bf16 v[32:35], a[232:235], v[84:87], v[32:35]
    ds_read_b128 v[104:107], v159 offset:768
    v_mfma_f32_16x16x32_bf16 v[36:39], a[236:239], v[84:87], v[36:39]
    ds_read_b128 v[108:111], v159 offset:6912
    buffer_load_dwordx4 v4, s[52:55], s14 offen offset:0 lds
    v_and_b32 v193, 0xffff0000, v176
    v_lshlrev_b32 v192, 16, v176
    v_mfma_f32_16x16x32_bf16 v[36:39], a[228:231], v[80:83], v[36:39]
    ds_read_b128 v[112:115], v159 offset:1024
    v_and_b32 v195, 0xffff0000, v177
    v_lshlrev_b32 v194, 16, v177
    v_mfma_f32_16x16x32_bf16 v[44:47], a[228:231], v[88:91], v[44:47]
    ds_read_b128 v[116:119], v159 offset:7168
    buffer_load_dwordx4 v5, s[52:55], s14 offen offset:1024 lds
    v_add_f32 v64, v64, v192
    v_mfma_f32_16x16x32_bf16 v[44:47], a[236:239], v[92:95], v[44:47]
    ds_read_b128 v[120:123], v159 offset:1280
    v_add_f32 v65, v65, v193
    v_add_f32 v66, v66, v194
    v_mfma_f32_16x16x32_bf16 v[40:43], a[232:235], v[92:95], v[40:43]
    ds_read_b128 v[124:127], v159 offset:7424
    v_add_f32 v67, v67, v195
    v_and_b32 v197, 0xffff0000, v178
    v_mfma_f32_16x16x32_bf16 v[40:43], a[224:227], v[88:91], v[40:43]
    ds_read_b64_tr_b16 a[52:53], v11 offset:32768
    buffer_load_dwordx4 v6, s[52:55], s14 offen offset:2048 lds
    v_lshlrev_b32 v196, 16, v178
    v_and_b32 v199, 0xffff0000, v179
    v_mfma_f32_16x16x32_bf16 v[48:51], a[224:227], v[96:99], v[48:51]
    ds_read_b64_tr_b16 a[54:55], v11 offset:34816
    v_lshlrev_b32 v198, 16, v179
    v_mfma_f32_16x16x32_bf16 v[48:51], a[232:235], v[100:103], v[48:51]
    buffer_load_dwordx4 v7, s[52:55], s14 offen offset:3072 lds
    v_add_f32 v68, v68, v196
    v_add_f32 v69, v69, v197
    v_mfma_f32_16x16x32_bf16 v[52:55], a[236:239], v[100:103], v[52:55]
    ds_read_b64_tr_b16 a[60:61], v11 offset:36864
    v_add_f32 v70, v70, v198
    v_add_f32 v71, v71, v199
    v_mfma_f32_16x16x32_bf16 v[52:55], a[228:231], v[96:99], v[52:55]
    ds_read_b64_tr_b16 a[62:63], v11 offset:38912
    s_waitcnt lgkmcnt(4)
    v_mfma_f32_16x16x32_bf16 v[60:63], a[228:231], v[104:107], v[60:63]
    s_waitcnt vmcnt(12)
    s_barrier
    v_mfma_f32_16x16x32_bf16 v[60:63], a[236:239], v[108:111], v[60:63]
    ds_read_b128 v[80:83], v159 offset:12288
    v_mfma_f32_16x16x32_bf16 v[56:59], a[232:235], v[108:111], v[56:59]
    ds_read_b128 v[84:87], v159 offset:18432
    v_and_b32 v193, 0xffff0000, v164
    v_lshlrev_b32 v192, 16, v164
    v_mfma_f32_16x16x32_bf16 v[56:59], a[224:227], v[104:107], v[56:59]
    ds_read_b128 v[88:91], v159 offset:12544
    v_and_b32 v195, 0xffff0000, v165
    v_lshlrev_b32 v194, 16, v165
    v_mfma_f32_16x16x32_bf16 v[64:67], a[224:227], v[112:115], v[64:67]
    ds_read_b128 v[92:95], v159 offset:18688
    v_add_f32 v40, v40, v192
    v_mfma_f32_16x16x32_bf16 v[64:67], a[232:235], v[116:119], v[64:67]
    ds_read_b128 v[96:99], v159 offset:12800
    v_add_f32 v41, v41, v193
    v_add_f32 v42, v42, v194
    v_mfma_f32_16x16x32_bf16 v[68:71], a[236:239], v[116:119], v[68:71]
    ds_read_b128 v[100:103], v159 offset:18944
    v_add_f32 v43, v43, v195
    v_mfma_f32_16x16x32_bf16 v[68:71], a[228:231], v[112:115], v[68:71]
    v_and_b32 v197, 0xffff0000, v166
    v_lshlrev_b32 v196, 16, v166
    v_mfma_f32_16x16x32_bf16 v[76:79], a[228:231], v[120:123], v[76:79]
    v_and_b32 v199, 0xffff0000, v167
    v_lshlrev_b32 v198, 16, v167
    v_mfma_f32_16x16x32_bf16 v[76:79], a[236:239], v[124:127], v[76:79]
    v_add_f32 v44, v44, v196
    v_add_f32 v45, v45, v197
    v_mfma_f32_16x16x32_bf16 v[72:75], a[232:235], v[124:127], v[72:75]
    v_add_f32 v46, v46, v198
    v_add_f32 v47, v47, v199
    v_mfma_f32_16x16x32_bf16 v[72:75], a[224:227], v[120:123], v[72:75]
    s_waitcnt lgkmcnt(0)
    v_mfma_f32_16x16x32_bf16 v[32:35], a[240:243], v[80:83], v[32:35]
    s_add_u32 m0, s73, 16384
    s_lshl_b32 s14, s91, 18
    v_mfma_f32_16x16x32_bf16 v[32:35], a[248:251], v[84:87], v[32:35]
    ds_read_b128 v[104:107], v159 offset:13056
    v_mfma_f32_16x16x32_bf16 v[36:39], a[252:255], v[84:87], v[36:39]
    ds_read_b128 v[108:111], v159 offset:19200
    buffer_load_dwordx4 v4, s[52:55], s14 offen offset:0 lds
    v_and_b32 v193, 0xffff0000, v180
    v_lshlrev_b32 v192, 16, v180
    v_mfma_f32_16x16x32_bf16 v[36:39], a[244:247], v[80:83], v[36:39]
    ds_read_b128 v[112:115], v159 offset:13312
    v_and_b32 v195, 0xffff0000, v181
    v_lshlrev_b32 v194, 16, v181
    v_mfma_f32_16x16x32_bf16 v[44:47], a[244:247], v[88:91], v[44:47]
    ds_read_b128 v[116:119], v159 offset:19456
    buffer_load_dwordx4 v5, s[52:55], s14 offen offset:1024 lds
    v_add_f32 v72, v72, v192
    v_mfma_f32_16x16x32_bf16 v[44:47], a[252:255], v[92:95], v[44:47]
    ds_read_b128 v[120:123], v159 offset:13568
    v_add_f32 v73, v73, v193
    v_add_f32 v74, v74, v194
    v_mfma_f32_16x16x32_bf16 v[40:43], a[248:251], v[92:95], v[40:43]
    ds_read_b128 v[124:127], v159 offset:19712
    v_add_f32 v75, v75, v195
    v_and_b32 v197, 0xffff0000, v182
    v_mfma_f32_16x16x32_bf16 v[40:43], a[240:243], v[88:91], v[40:43]
    buffer_load_dwordx4 v6, s[52:55], s14 offen offset:2048 lds
    v_lshlrev_b32 v196, 16, v182
    v_and_b32 v199, 0xffff0000, v183
    v_mfma_f32_16x16x32_bf16 v[48:51], a[240:243], v[96:99], v[48:51]
    v_lshlrev_b32 v198, 16, v183
    v_add_f32 v76, v76, v196
    v_mfma_f32_16x16x32_bf16 v[48:51], a[248:251], v[100:103], v[48:51]
    buffer_load_dwordx4 v7, s[52:55], s14 offen offset:3072 lds
    v_add_f32 v77, v77, v197
    v_mfma_f32_16x16x32_bf16 v[52:55], a[252:255], v[100:103], v[52:55]
    v_add_f32 v78, v78, v198
    v_add_f32 v79, v79, v199
    v_mfma_f32_16x16x32_bf16 v[52:55], a[244:247], v[96:99], v[52:55]
    s_waitcnt lgkmcnt(0)
    v_mfma_f32_16x16x32_bf16 v[60:63], a[244:247], v[104:107], v[60:63]
    s_barrier
    v_mfma_f32_16x16x32_bf16 v[60:63], a[252:255], v[108:111], v[60:63]
    s_add_u32 m0, s73, 131072
    s_lshl_b32 s14, s92, 18
    v_mfma_f32_16x16x32_bf16 v[56:59], a[248:251], v[108:111], v[56:59]
    buffer_load_dwordx4 v4, s[52:55], s14 offen offset:0 lds
    v_and_b32 v193, 0xffff0000, v168
    v_lshlrev_b32 v192, 16, v168
    v_mfma_f32_16x16x32_bf16 v[56:59], a[240:243], v[104:107], v[56:59]
    buffer_load_dwordx4 v5, s[52:55], s14 offen offset:1024 lds
    v_and_b32 v195, 0xffff0000, v169
    v_lshlrev_b32 v194, 16, v169
    v_mfma_f32_16x16x32_bf16 v[64:67], a[240:243], v[112:115], v[64:67]
    buffer_load_dwordx4 v6, s[52:55], s14 offen offset:2048 lds
    v_add_f32 v48, v48, v192
    v_mfma_f32_16x16x32_bf16 v[64:67], a[248:251], v[116:119], v[64:67]
    buffer_load_dwordx4 v7, s[52:55], s14 offen offset:3072 lds
    v_add_f32 v49, v49, v193
    v_add_f32 v50, v50, v194
    v_mfma_f32_16x16x32_bf16 v[68:71], a[252:255], v[116:119], v[68:71]
    s_add_u32 m0, s73, 147456
    s_lshl_b32 s14, s93, 18
    v_add_f32 v51, v51, v195
    v_and_b32 v197, 0xffff0000, v170
    v_mfma_f32_16x16x32_bf16 v[68:71], a[244:247], v[112:115], v[68:71]
    buffer_load_dwordx4 v4, s[52:55], s14 offen offset:0 lds
    v_lshlrev_b32 v196, 16, v170
    v_and_b32 v199, 0xffff0000, v171
    v_mfma_f32_16x16x32_bf16 v[76:79], a[244:247], v[120:123], v[76:79]
    buffer_load_dwordx4 v5, s[52:55], s14 offen offset:1024 lds
    v_lshlrev_b32 v198, 16, v171
    v_mfma_f32_16x16x32_bf16 v[76:79], a[252:255], v[124:127], v[76:79]
    buffer_load_dwordx4 v6, s[52:55], s14 offen offset:2048 lds
    v_add_f32 v52, v52, v196
    v_add_f32 v53, v53, v197
    v_mfma_f32_16x16x32_bf16 v[72:75], a[248:251], v[124:127], v[72:75]
    buffer_load_dwordx4 v7, s[52:55], s14 offen offset:3072 lds
    v_add_f32 v54, v54, v198
    v_add_f32 v55, v55, v199
    v_mfma_f32_16x16x32_bf16 v[72:75], a[240:243], v[120:123], v[72:75]
    s_waitcnt lgkmcnt(0)
    v_mov_b32 v88, 0xc0135761
    s_mov_b32 s10, 0xbdd2d3e8
    s_lshl_b32 s9, s69, 2
    s_add_u32 s9, s9, s3
    s_mul_i32 s9, s9, 69632
    s_add_u32 s9, s9, 12795904
    v_pk_mul_f32 v[160:161], v[32:33], v[32:33]
    v_pk_mul_f32 v[162:163], v[34:35], v[34:35]
    v_pk_mul_f32 v[164:165], v[36:37], v[36:37]
    v_pk_mul_f32 v[166:167], v[38:39], v[38:39]
    v_pk_mul_f32 v[168:169], v[40:41], v[40:41]
    v_pk_mul_f32 v[170:171], v[42:43], v[42:43]
    v_pk_mul_f32 v[172:173], v[44:45], v[44:45]
    v_pk_mul_f32 v[174:175], v[46:47], v[46:47]
    v_pk_fma_f32 v[160:161], v[160:161], s[10:11], v[88:89] op_sel_hi:[1,0,0]
    v_pk_fma_f32 v[162:163], v[162:163], s[10:11], v[88:89] op_sel_hi:[1,0,0]
    v_pk_fma_f32 v[164:165], v[164:165], s[10:11], v[88:89] op_sel_hi:[1,0,0]
    v_pk_fma_f32 v[166:167], v[166:167], s[10:11], v[88:89] op_sel_hi:[1,0,0]
    v_pk_fma_f32 v[168:169], v[168:169], s[10:11], v[88:89] op_sel_hi:[1,0,0]
    v_pk_fma_f32 v[170:171], v[170:171], s[10:11], v[88:89] op_sel_hi:[1,0,0]
    v_pk_fma_f32 v[172:173], v[172:173], s[10:11], v[88:89] op_sel_hi:[1,0,0]
    v_pk_fma_f32 v[174:175], v[174:175], s[10:11], v[88:89] op_sel_hi:[1,0,0]
    v_pk_mul_f32 v[160:161], v[160:161], v[32:33]
    v_pk_mul_f32 v[162:163], v[162:163], v[34:35]
    v_pk_mul_f32 v[164:165], v[164:165], v[36:37]
    v_pk_mul_f32 v[166:167], v[166:167], v[38:39]
    v_pk_mul_f32 v[168:169], v[168:169], v[40:41]
    v_pk_mul_f32 v[170:171], v[170:171], v[42:43]
    v_pk_mul_f32 v[172:173], v[172:173], v[44:45]
    v_pk_mul_f32 v[174:175], v[174:175], v[46:47]
    v_exp_f32 v160, v160
    v_exp_f32 v161, v161
    v_exp_f32 v162, v162
    v_exp_f32 v163, v163
    v_exp_f32 v164, v164
    v_exp_f32 v165, v165
    v_exp_f32 v166, v166
    v_exp_f32 v167, v167
    v_exp_f32 v168, v168
    v_exp_f32 v169, v169
    v_exp_f32 v170, v170
    v_exp_f32 v171, v171
    v_exp_f32 v172, v172
    v_exp_f32 v173, v173
    v_exp_f32 v174, v174
    v_exp_f32 v175, v175
    v_pk_add_f32 v[160:161], v[160:161], 1.0 op_sel_hi:[1,0]
    v_pk_add_f32 v[162:163], v[162:163], 1.0 op_sel_hi:[1,0]
    v_pk_add_f32 v[164:165], v[164:165], 1.0 op_sel_hi:[1,0]
    v_pk_add_f32 v[166:167], v[166:167], 1.0 op_sel_hi:[1,0]
    v_pk_add_f32 v[168:169], v[168:169], 1.0 op_sel_hi:[1,0]
    v_pk_add_f32 v[170:171], v[170:171], 1.0 op_sel_hi:[1,0]
    v_pk_add_f32 v[172:173], v[172:173], 1.0 op_sel_hi:[1,0]
    v_pk_add_f32 v[174:175], v[174:175], 1.0 op_sel_hi:[1,0]
    v_rcp_f32 v160, v160
    v_rcp_f32 v161, v161
    v_rcp_f32 v162, v162
    v_rcp_f32 v163, v163
    v_rcp_f32 v164, v164
    v_rcp_f32 v165, v165
    v_rcp_f32 v166, v166
    v_rcp_f32 v167, v167
    v_rcp_f32 v168, v168
    v_rcp_f32 v169, v169
    v_rcp_f32 v170, v170
    v_rcp_f32 v171, v171
    v_rcp_f32 v172, v172
    v_rcp_f32 v173, v173
    v_rcp_f32 v174, v174
    v_rcp_f32 v175, v175
    v_pk_mul_f32 v[32:33], v[32:33], v[160:161]
    v_pk_mul_f32 v[34:35], v[34:35], v[162:163]
    v_pk_mul_f32 v[36:37], v[36:37], v[164:165]
    v_pk_mul_f32 v[38:39], v[38:39], v[166:167]
    v_pk_mul_f32 v[40:41], v[40:41], v[168:169]
    v_pk_mul_f32 v[42:43], v[42:43], v[170:171]
    v_pk_mul_f32 v[44:45], v[44:45], v[172:173]
    v_pk_mul_f32 v[46:47], v[46:47], v[174:175]
    v_cvt_pk_bf16_f32 v96, v32, v33
    v_cvt_pk_bf16_f32 v97, v34, v35
    v_cvt_pk_bf16_f32 v98, v36, v37
    v_cvt_pk_bf16_f32 v99, v38, v39
    v_cvt_pk_bf16_f32 v100, v40, v41
    v_cvt_pk_bf16_f32 v101, v42, v43
    v_cvt_pk_bf16_f32 v102, v44, v45
    v_cvt_pk_bf16_f32 v103, v46, v47
    buffer_store_dwordx4 v[96:99], v240, s[44:47], s9 offen sc1
    buffer_store_dwordx4 v[100:103], v241, s[44:47], s9 offen sc1
    v_pk_mul_f32 v[160:161], v[48:49], v[48:49]
    v_pk_mul_f32 v[162:163], v[50:51], v[50:51]
    v_pk_mul_f32 v[164:165], v[52:53], v[52:53]
    v_pk_mul_f32 v[166:167], v[54:55], v[54:55]
    v_pk_mul_f32 v[168:169], v[56:57], v[56:57]
    v_pk_mul_f32 v[170:171], v[58:59], v[58:59]
    v_pk_mul_f32 v[172:173], v[60:61], v[60:61]
    v_pk_mul_f32 v[174:175], v[62:63], v[62:63]
    v_pk_fma_f32 v[160:161], v[160:161], s[10:11], v[88:89] op_sel_hi:[1,0,0]
    v_pk_fma_f32 v[162:163], v[162:163], s[10:11], v[88:89] op_sel_hi:[1,0,0]
    v_pk_fma_f32 v[164:165], v[164:165], s[10:11], v[88:89] op_sel_hi:[1,0,0]
    v_pk_fma_f32 v[166:167], v[166:167], s[10:11], v[88:89] op_sel_hi:[1,0,0]
    v_pk_fma_f32 v[168:169], v[168:169], s[10:11], v[88:89] op_sel_hi:[1,0,0]
    v_pk_fma_f32 v[170:171], v[170:171], s[10:11], v[88:89] op_sel_hi:[1,0,0]
    v_pk_fma_f32 v[172:173], v[172:173], s[10:11], v[88:89] op_sel_hi:[1,0,0]
    v_pk_fma_f32 v[174:175], v[174:175], s[10:11], v[88:89] op_sel_hi:[1,0,0]
    v_pk_mul_f32 v[160:161], v[160:161], v[48:49]
    v_pk_mul_f32 v[162:163], v[162:163], v[50:51]
    v_pk_mul_f32 v[164:165], v[164:165], v[52:53]
    v_pk_mul_f32 v[166:167], v[166:167], v[54:55]
    v_pk_mul_f32 v[168:169], v[168:169], v[56:57]
    v_pk_mul_f32 v[170:171], v[170:171], v[58:59]
    v_pk_mul_f32 v[172:173], v[172:173], v[60:61]
    v_pk_mul_f32 v[174:175], v[174:175], v[62:63]
    v_exp_f32 v160, v160
    v_exp_f32 v161, v161
    v_exp_f32 v162, v162
    v_exp_f32 v163, v163
    v_exp_f32 v164, v164
    v_exp_f32 v165, v165
    v_exp_f32 v166, v166
    v_exp_f32 v167, v167
    v_exp_f32 v168, v168
    v_exp_f32 v169, v169
    v_exp_f32 v170, v170
    v_exp_f32 v171, v171
    v_exp_f32 v172, v172
    v_exp_f32 v173, v173
    v_exp_f32 v174, v174
    v_exp_f32 v175, v175
    v_pk_add_f32 v[160:161], v[160:161], 1.0 op_sel_hi:[1,0]
    v_pk_add_f32 v[162:163], v[162:163], 1.0 op_sel_hi:[1,0]
    v_pk_add_f32 v[164:165], v[164:165], 1.0 op_sel_hi:[1,0]
    v_pk_add_f32 v[166:167], v[166:167], 1.0 op_sel_hi:[1,0]
    v_pk_add_f32 v[168:169], v[168:169], 1.0 op_sel_hi:[1,0]
    v_pk_add_f32 v[170:171], v[170:171], 1.0 op_sel_hi:[1,0]
    v_pk_add_f32 v[172:173], v[172:173], 1.0 op_sel_hi:[1,0]
    v_pk_add_f32 v[174:175], v[174:175], 1.0 op_sel_hi:[1,0]
    v_rcp_f32 v160, v160
    v_rcp_f32 v161, v161
    v_rcp_f32 v162, v162
    v_rcp_f32 v163, v163
    v_rcp_f32 v164, v164
    v_rcp_f32 v165, v165
    v_rcp_f32 v166, v166
    v_rcp_f32 v167, v167
    v_rcp_f32 v168, v168
    v_rcp_f32 v169, v169
    v_rcp_f32 v170, v170
    v_rcp_f32 v171, v171
    v_rcp_f32 v172, v172
    v_rcp_f32 v173, v173
    v_rcp_f32 v174, v174
    v_rcp_f32 v175, v175
    v_pk_mul_f32 v[48:49], v[48:49], v[160:161]
    v_pk_mul_f32 v[50:51], v[50:51], v[162:163]
    v_pk_mul_f32 v[52:53], v[52:53], v[164:165]
    v_pk_mul_f32 v[54:55], v[54:55], v[166:167]
    v_pk_mul_f32 v[56:57], v[56:57], v[168:169]
    v_pk_mul_f32 v[58:59], v[58:59], v[170:171]
    v_pk_mul_f32 v[60:61], v[60:61], v[172:173]
    v_pk_mul_f32 v[62:63], v[62:63], v[174:175]
    v_cvt_pk_bf16_f32 v104, v48, v49
    v_cvt_pk_bf16_f32 v105, v50, v51
    v_cvt_pk_bf16_f32 v106, v52, v53
    v_cvt_pk_bf16_f32 v107, v54, v55
    v_cvt_pk_bf16_f32 v108, v56, v57
    v_cvt_pk_bf16_f32 v109, v58, v59
    v_cvt_pk_bf16_f32 v110, v60, v61
    v_cvt_pk_bf16_f32 v111, v62, v63
    buffer_store_dwordx4 v[104:107], v242, s[44:47], s9 offen sc1
    buffer_store_dwordx4 v[108:111], v243, s[44:47], s9 offen sc1
    v_pk_mul_f32 v[160:161], v[64:65], v[64:65]
    v_pk_mul_f32 v[162:163], v[66:67], v[66:67]
    v_pk_mul_f32 v[164:165], v[68:69], v[68:69]
    v_pk_mul_f32 v[166:167], v[70:71], v[70:71]
    v_pk_mul_f32 v[168:169], v[72:73], v[72:73]
    v_pk_mul_f32 v[170:171], v[74:75], v[74:75]
    v_pk_mul_f32 v[172:173], v[76:77], v[76:77]
    v_pk_mul_f32 v[174:175], v[78:79], v[78:79]
    v_pk_fma_f32 v[160:161], v[160:161], s[10:11], v[88:89] op_sel_hi:[1,0,0]
    v_pk_fma_f32 v[162:163], v[162:163], s[10:11], v[88:89] op_sel_hi:[1,0,0]
    v_pk_fma_f32 v[164:165], v[164:165], s[10:11], v[88:89] op_sel_hi:[1,0,0]
    v_pk_fma_f32 v[166:167], v[166:167], s[10:11], v[88:89] op_sel_hi:[1,0,0]
    v_pk_fma_f32 v[168:169], v[168:169], s[10:11], v[88:89] op_sel_hi:[1,0,0]
    v_pk_fma_f32 v[170:171], v[170:171], s[10:11], v[88:89] op_sel_hi:[1,0,0]
    v_pk_fma_f32 v[172:173], v[172:173], s[10:11], v[88:89] op_sel_hi:[1,0,0]
    v_pk_fma_f32 v[174:175], v[174:175], s[10:11], v[88:89] op_sel_hi:[1,0,0]
L_pl_G_5:
    s_cbranch_execz L_wret
    v_pk_mul_f32 v[160:161], v[160:161], v[64:65]
    v_pk_mul_f32 v[162:163], v[162:163], v[66:67]
    v_pk_mul_f32 v[164:165], v[164:165], v[68:69]
    v_pk_mul_f32 v[166:167], v[166:167], v[70:71]
    v_pk_mul_f32 v[168:169], v[168:169], v[72:73]
    v_pk_mul_f32 v[170:171], v[170:171], v[74:75]
    v_pk_mul_f32 v[172:173], v[172:173], v[76:77]
    v_pk_mul_f32 v[174:175], v[174:175], v[78:79]
    v_exp_f32 v160, v160
    v_exp_f32 v161, v161
    v_exp_f32 v162, v162
    v_exp_f32 v163, v163
    v_exp_f32 v164, v164
    v_exp_f32 v165, v165
    v_exp_f32 v166, v166
    v_exp_f32 v167, v167
    v_exp_f32 v168, v168
    v_exp_f32 v169, v169
    v_exp_f32 v170, v170
    v_exp_f32 v171, v171
    v_exp_f32 v172, v172
    v_exp_f32 v173, v173
    v_exp_f32 v174, v174
    v_exp_f32 v175, v175
    v_pk_add_f32 v[160:161], v[160:161], 1.0 op_sel_hi:[1,0]
    v_pk_add_f32 v[162:163], v[162:163], 1.0 op_sel_hi:[1,0]
    v_pk_add_f32 v[164:165], v[164:165], 1.0 op_sel_hi:[1,0]
    v_pk_add_f32 v[166:167], v[166:167], 1.0 op_sel_hi:[1,0]
    v_pk_add_f32 v[168:169], v[168:169], 1.0 op_sel_hi:[1,0]
    v_pk_add_f32 v[170:171], v[170:171], 1.0 op_sel_hi:[1,0]
    v_pk_add_f32 v[172:173], v[172:173], 1.0 op_sel_hi:[1,0]
    v_pk_add_f32 v[174:175], v[174:175], 1.0 op_sel_hi:[1,0]
    v_rcp_f32 v160, v160
    v_rcp_f32 v161, v161
    v_rcp_f32 v162, v162
    v_rcp_f32 v163, v163
    v_rcp_f32 v164, v164
    v_rcp_f32 v165, v165
    v_rcp_f32 v166, v166
    v_rcp_f32 v167, v167
    v_rcp_f32 v168, v168
    v_rcp_f32 v169, v169
    v_rcp_f32 v170, v170
    v_rcp_f32 v171, v171
    v_rcp_f32 v172, v172
    v_rcp_f32 v173, v173
    v_rcp_f32 v174, v174
    v_rcp_f32 v175, v175
    v_pk_mul_f32 v[64:65], v[64:65], v[160:161]
    v_pk_mul_f32 v[66:67], v[66:67], v[162:163]
    v_pk_mul_f32 v[68:69], v[68:69], v[164:165]
    v_pk_mul_f32 v[70:71], v[70:71], v[166:167]
    v_pk_mul_f32 v[72:73], v[72:73], v[168:169]
    v_pk_mul_f32 v[74:75], v[74:75], v[170:171]
    v_pk_mul_f32 v[76:77], v[76:77], v[172:173]
    v_pk_mul_f32 v[78:79], v[78:79], v[174:175]
    v_cvt_pk_bf16_f32 v112, v64, v65
    v_cvt_pk_bf16_f32 v113, v66, v67
    v_cvt_pk_bf16_f32 v114, v68, v69
    v_cvt_pk_bf16_f32 v115, v70, v71
    v_cvt_pk_bf16_f32 v116, v72, v73
    v_cvt_pk_bf16_f32 v117, v74, v75
    v_cvt_pk_bf16_f32 v118, v76, v77
    v_cvt_pk_bf16_f32 v119, v78, v79
    buffer_store_dwordx4 v[112:115], v244, s[44:47], s9 offen sc1
    buffer_store_dwordx4 v[116:119], v245, s[44:47], s9 offen sc1
    s_waitcnt vmcnt(6)
    s_barrier
    ds_read_b64_tr_b16 a[64:65], v10 offset:49152
    s_add_u32 m0, s73, 32768
    s_lshl_b32 s14, s94, 18
    ds_read_b64_tr_b16 a[66:67], v10 offset:51200
    ds_read_b64_tr_b16 a[72:73], v10 offset:53248
    ds_read_b64_tr_b16 a[74:75], v10 offset:55296
    ds_read_b64_tr_b16 a[68:69], v11 offset:49152
    buffer_load_dwordx4 v4, s[52:55], s14 offen offset:0 lds
    ds_read_b64_tr_b16 a[70:71], v11 offset:51200
    ds_read_b64_tr_b16 a[76:77], v11 offset:53248
    ds_read_b64_tr_b16 a[78:79], v11 offset:55296
    v_add_u32 v10, 65536, v10
    ds_read_b64_tr_b16 a[80:81], v10 offset:0
    ds_read_b64_tr_b16 a[82:83], v10 offset:2048
    buffer_load_dwordx4 v5, s[52:55], s14 offen offset:1024 lds
    ds_read_b64_tr_b16 a[88:89], v10 offset:4096
    ds_read_b64_tr_b16 a[90:91], v10 offset:6144
    v_add_u32 v11, 65536, v11
    ds_read_b64_tr_b16 a[84:85], v11 offset:0
    ds_read_b64_tr_b16 a[86:87], v11 offset:2048
    ds_read_b64_tr_b16 a[92:93], v11 offset:4096
    buffer_load_dwordx4 v6, s[52:55], s14 offen offset:2048 lds
    ds_read_b64_tr_b16 a[94:95], v11 offset:6144
    v_add_u32 v10, -65536, v10
    ds_read_b64_tr_b16 a[96:97], v10 offset:0
    ds_read_b64_tr_b16 a[98:99], v10 offset:2048
    ds_read_b64_tr_b16 a[104:105], v10 offset:4096
    ds_read_b64_tr_b16 a[106:107], v10 offset:6144
    buffer_load_dwordx4 v7, s[52:55], s14 offen offset:3072 lds
    v_add_u32 v11, -65536, v11
    ds_read_b64_tr_b16 a[100:101], v11 offset:0
    ds_read_b64_tr_b16 a[102:103], v11 offset:2048
    ds_read_b64_tr_b16 a[108:109], v11 offset:4096
    ds_read_b64_tr_b16 a[110:111], v11 offset:6144
    ds_read_b64_tr_b16 a[112:113], v10 offset:16384
    s_add_u32 m0, s73, 81920
    s_lshl_b32 s14, s95, 18
    ds_read_b64_tr_b16 a[114:115], v10 offset:18432
    ds_read_b64_tr_b16 a[120:121], v10 offset:20480
    ds_read_b64_tr_b16 a[122:123], v10 offset:22528
    ds_read_b64_tr_b16 a[116:117], v11 offset:16384
    buffer_load_dwordx4 v4, s[52:55], s14 offen offset:0 lds
    ds_read_b64_tr_b16 a[118:119], v11 offset:18432
    ds_read_b64_tr_b16 a[124:125], v11 offset:20480
    ds_read_b64_tr_b16 a[126:127], v11 offset:22528
    v_add_u32 v10, 131072, v10
    ds_read_b64_tr_b16 a[128:129], v10 offset:0
    ds_read_b64_tr_b16 a[130:131], v10 offset:2048
    buffer_load_dwordx4 v5, s[52:55], s14 offen offset:1024 lds
    ds_read_b64_tr_b16 a[136:137], v10 offset:4096
    ds_read_b64_tr_b16 a[138:139], v10 offset:6144
    v_add_u32 v11, 131072, v11
    ds_read_b64_tr_b16 a[132:133], v11 offset:0
    ds_read_b64_tr_b16 a[134:135], v11 offset:2048
    ds_read_b64_tr_b16 a[140:141], v11 offset:4096
    buffer_load_dwordx4 v6, s[52:55], s14 offen offset:2048 lds
    ds_read_b64_tr_b16 a[142:143], v11 offset:6144
    ds_read_b64_tr_b16 a[144:145], v10 offset:16384
    ds_read_b64_tr_b16 a[146:147], v10 offset:18432
    ds_read_b64_tr_b16 a[152:153], v10 offset:20480
    ds_read_b64_tr_b16 a[154:155], v10 offset:22528
    buffer_load_dwordx4 v7, s[52:55], s14 offen offset:3072 lds
    ds_read_b64_tr_b16 a[148:149], v11 offset:16384
    ds_read_b64_tr_b16 a[150:151], v11 offset:18432
    ds_read_b64_tr_b16 a[156:157], v11 offset:20480
    ds_read_b64_tr_b16 a[158:159], v11 offset:22528
    s_bitcmp1_b32 s3, 1
    s_cselect_b32 s18, s85, s84
    s_mul_i32 s18, s18, 139264
    s_cselect_b32 s19, s87, s86
    s_mul_i32 s19, s19, 139264
    s_cselect_b32 s20, s89, s88
    s_mul_i32 s20, s20, 139264
    s_cselect_b32 s21, s91, s90
    s_mul_i32 s21, s21, 139264
    s_cselect_b32 s22, s93, s92
    s_mul_i32 s22, s22, 139264
    s_cselect_b32 s23, s95, s94
    s_mul_i32 s23, s23, 139264
    s_cselect_b32 s24, s97, s96
    s_mul_i32 s24, s24, 139264
    s_cselect_b32 s25, s99, s98
    s_mul_i32 s25, s25, 139264
    s_cselect_b32 s26, s101, s100
    s_mul_i32 s26, s26, 139264
    s_waitcnt vmcnt(8) lgkmcnt(0)
    s_barrier
    buffer_store_dword v249, v17, s[44:47], 0 offen sc1
    s_add_u32 m0, s73, 0
    s_lshl_b32 s14, s96, 18
    buffer_load_dwordx4 v4, s[52:55], s14 offen offset:0 lds
    buffer_load_dwordx4 v5, s[52:55], s14 offen offset:1024 lds
    buffer_load_dwordx4 v6, s[52:55], s14 offen offset:2048 lds
    buffer_load_dwordx4 v7, s[52:55], s14 offen offset:3072 lds
    s_add_u32 m0, s73, 16384
    s_lshl_b32 s14, s97, 18
    buffer_load_dwordx4 v4, s[52:55], s14 offen offset:0 lds
    buffer_load_dwordx4 v5, s[52:55], s14 offen offset:1024 lds
    buffer_load_dwordx4 v6, s[52:55], s14 offen offset:2048 lds
    buffer_load_dwordx4 v7, s[52:55], s14 offen offset:3072 lds
    v_mov_b32 v16, 0
    buffer_atomic_add v16, v15, s[44:47], 0 offen sc0 sc1
    s_add_u32 m0, s73, 49152
    s_lshl_b32 s14, s98, 18
    buffer_load_dwordx4 v4, s[52:55], s14 offen offset:0 lds
    buffer_load_dwordx4 v5, s[52:55], s14 offen offset:1024 lds
    buffer_load_dwordx4 v6, s[52:55], s14 offen offset:2048 lds
    buffer_load_dwordx4 v7, s[52:55], s14 offen offset:3072 lds
    s_add_u32 m0, s73, 65536
    s_lshl_b32 s14, s99, 18
    buffer_load_dwordx4 v4, s[52:55], s14 offen offset:0 lds
    buffer_load_dwordx4 v5, s[52:55], s14 offen offset:1024 lds
    buffer_load_dwordx4 v6, s[52:55], s14 offen offset:2048 lds
    buffer_load_dwordx4 v7, s[52:55], s14 offen offset:3072 lds
L_DG:
    s_waitcnt vmcnt(8)
    v_cmp_ne_u32 vcc, v13, v16
    s_cbranch_vccnz L_rs_p2G
L_ok_p2G:
    s_barrier
    s_add_u32 m0, s73, 97536
    s_nop 0
    buffer_load_dwordx4 v23, s[44:47], s18 offen offset:768 sc1 lds
    s_add_u32 m0, s73, 99328
    s_nop 0
    buffer_load_dwordx4 v20, s[44:47], s18 offen offset:0 sc1 lds
    s_add_u32 m0, s73, 99840
    s_nop 0
    buffer_load_dwordx4 v20, s[44:47], s18 offen offset:512 sc1 lds
    s_add_u32 m0, s73, 100608
    s_nop 0
    buffer_load_dwordx4 v23, s[44:47], s19 offen offset:768 sc1 lds
    s_add_u32 m0, s73, 114688
    s_nop 0
    buffer_load_dwordx4 v20, s[44:47], s19 offen offset:0 sc1 lds
    s_add_u32 m0, s73, 115200
    s_nop 0
    buffer_load_dwordx4 v20, s[44:47], s19 offen offset:512 sc1 lds
    s_add_u32 m0, s73, 115968
    s_nop 0
    buffer_load_dwordx4 v23, s[44:47], s20 offen offset:768 sc1 lds
    s_add_u32 m0, s73, 117760
    s_nop 0
    buffer_load_dwordx4 v20, s[44:47], s20 offen offset:0 sc1 lds
    v_mov_b32 v195, s68
    v_mov_b32 v199, s68
    v_mov_b32 v202, s68
    v_mov_b32 v203, s68
    s_waitcnt vmcnt(4)
    s_barrier
    ds_read_b128 v[104:107], v14 offset:0
    ds_read_b128 v[108:111], v14 offset:4096
    ds_read_b128 v[112:115], v14 offset:8192
    ds_read_b128 v[116:119], v14 offset:12288
    s_waitcnt lgkmcnt(2)
    v_mfma_f32_16x16x32_bf16 v[32:35], v[104:107], a[0:3], 0
    s_add_u32 m0, s73, 130560
    v_mfma_f32_16x16x32_bf16 v[32:35], v[108:111], a[8:11], v[32:35]
    buffer_load_dwordx4 v20, s[44:47], s20 offen offset:512 sc1 lds
    s_waitcnt lgkmcnt(0)
    v_mfma_f32_16x16x32_bf16 v[32:35], v[112:115], a[16:19], v[32:35]
    ds_read_b128 v[120:123], v14 offset:1024
    v_mfma_f32_16x16x32_bf16 v[32:35], v[116:119], a[24:27], v[32:35]
    ds_read_b128 v[124:127], v14 offset:5120
    v_mfma_f32_16x16x32_bf16 v[36:39], v[116:119], a[28:31], 0
    ds_read_b128 v[128:131], v14 offset:9216
    v_mfma_f32_16x16x32_bf16 v[36:39], v[112:115], a[20:23], v[36:39]
    ds_read_b128 v[132:135], v14 offset:13312
    v_mfma_f32_16x16x32_bf16 v[36:39], v[108:111], a[12:15], v[36:39]
    s_add_u32 m0, s73, 131328
    v_mfma_f32_16x16x32_bf16 v[36:39], v[104:107], a[4:7], v[36:39]
    buffer_load_dwordx4 v23, s[44:47], s21 offen offset:768 sc1 lds
    s_waitcnt lgkmcnt(2)
    v_mfma_f32_16x16x32_bf16 v[44:47], v[120:123], a[4:7], 0
    s_add_u32 m0, s73, 133120
    v_mfma_f32_16x16x32_bf16 v[44:47], v[124:127], a[12:15], v[44:47]
    buffer_load_dwordx4 v20, s[44:47], s21 offen offset:0 sc1 lds
    s_waitcnt lgkmcnt(0)
    v_mfma_f32_16x16x32_bf16 v[44:47], v[128:131], a[20:23], v[44:47]
    ds_read_b128 v[104:107], v14 offset:2048
    v_mfma_f32_16x16x32_bf16 v[44:47], v[132:135], a[28:31], v[44:47]
    ds_read_b128 v[108:111], v14 offset:6144
    v_mfma_f32_16x16x32_bf16 v[40:43], v[132:135], a[24:27], 0
    ds_read_b128 v[112:115], v14 offset:10240
    v_mfma_f32_16x16x32_bf16 v[40:43], v[128:131], a[16:19], v[40:43]
    ds_read_b128 v[116:119], v14 offset:14336
    v_mfma_f32_16x16x32_bf16 v[40:43], v[124:127], a[8:11], v[40:43]
    s_add_u32 m0, s73, 133632
    v_mfma_f32_16x16x32_bf16 v[40:43], v[120:123], a[0:3], v[40:43]
    buffer_load_dwordx4 v20, s[44:47], s21 offen offset:512 sc1 lds
    s_waitcnt lgkmcnt(2)
    v_mfma_f32_16x16x32_bf16 v[48:51], v[104:107], a[0:3], 0
    s_add_u32 m0, s73, 146688
    v_mfma_f32_16x16x32_bf16 v[48:51], v[108:111], a[8:11], v[48:51]
    buffer_load_dwordx4 v23, s[44:47], s22 offen offset:768 sc1 lds
    s_waitcnt lgkmcnt(0)
    v_mfma_f32_16x16x32_bf16 v[48:51], v[112:115], a[16:19], v[48:51]
    ds_read_b128 v[120:123], v14 offset:3072
    v_mfma_f32_16x16x32_bf16 v[48:51], v[116:119], a[24:27], v[48:51]
    ds_read_b128 v[124:127], v14 offset:7168
    v_mfma_f32_16x16x32_bf16 v[52:55], v[116:119], a[28:31], 0
    ds_read_b128 v[128:131], v14 offset:11264
    v_mfma_f32_16x16x32_bf16 v[52:55], v[112:115], a[20:23], v[52:55]
    ds_read_b128 v[132:135], v14 offset:15360
    v_mfma_f32_16x16x32_bf16 v[52:55], v[108:111], a[12:15], v[52:55]
    s_add_u32 m0, s73, 148480
    v_mfma_f32_16x16x32_bf16 v[52:55], v[104:107], a[4:7], v[52:55]
    buffer_load_dwordx4 v20, s[44:47], s22 offen offset:0 sc1 lds
    s_waitcnt lgkmcnt(2)
    v_mfma_f32_16x16x32_bf16 v[36:39], v[120:123], a[36:39], v[36:39]
    s_add_u32 m0, s73, 148992
    v_mfma_f32_16x16x32_bf16 v[36:39], v[124:127], a[44:47], v[36:39]
    buffer_load_dwordx4 v20, s[44:47], s22 offen offset:512 sc1 lds
    s_waitcnt lgkmcnt(0)
    v_mfma_f32_16x16x32_bf16 v[36:39], v[128:131], a[52:55], v[36:39]
    s_waitcnt vmcnt(7)
    s_barrier
    v_mfma_f32_16x16x32_bf16 v[36:39], v[132:135], a[60:63], v[36:39]
    ds_read_b128 v[104:107], v14 offset:16384
    v_add_u32 v10, -131072, v10
    v_mfma_f32_16x16x32_bf16 v[32:35], v[132:135], a[56:59], v[32:35]
    ds_read_b128 v[108:111], v14 offset:20480
    v_mfma_f32_16x16x32_bf16 v[32:35], v[128:131], a[48:51], v[32:35]
    ds_read_b128 v[112:115], v14 offset:24576
    ds_read_b64_tr_b16 a[160:161], v10 offset:32768
    v_mfma_f32_16x16x32_bf16 v[32:35], v[124:127], a[40:43], v[32:35]
    ds_read_b128 v[116:119], v14 offset:28672
    s_add_u32 m0, s73, 149760
    v_mfma_f32_16x16x32_bf16 v[32:35], v[120:123], a[32:35], v[32:35]
    buffer_load_dwordx4 v23, s[44:47], s23 offen offset:768 sc1 lds
    ds_read_b64_tr_b16 a[162:163], v10 offset:34816
    s_waitcnt lgkmcnt(4)
    v_mfma_f32_16x16x32_bf16 v[40:43], v[104:107], a[32:35], v[40:43]
    s_add_u32 m0, s73, 98304
    ds_read_b64_tr_b16 a[168:169], v10 offset:36864
    v_mfma_f32_16x16x32_bf16 v[40:43], v[108:111], a[40:43], v[40:43]
    buffer_load_dwordx4 v20, s[44:47], s23 offen offset:0 sc1 lds
    ds_read_b64_tr_b16 a[170:171], v10 offset:38912
    s_waitcnt lgkmcnt(3)
    v_mfma_f32_16x16x32_bf16 v[40:43], v[112:115], a[48:51], v[40:43]
    ds_read_b128 v[120:123], v14 offset:17408
    v_mfma_f32_16x16x32_bf16 v[40:43], v[116:119], a[56:59], v[40:43]
    ds_read_b128 v[124:127], v14 offset:21504
    v_add_u32 v11, -131072, v11
    v_mfma_f32_16x16x32_bf16 v[44:47], v[116:119], a[60:63], v[44:47]
    ds_read_b128 v[128:131], v14 offset:25600
    v_mfma_f32_16x16x32_bf16 v[44:47], v[112:115], a[52:55], v[44:47]
    ds_read_b128 v[132:135], v14 offset:29696
    v_mfma_f32_16x16x32_bf16 v[44:47], v[108:111], a[44:47], v[44:47]
    s_add_u32 m0, s73, 98816
    ds_read_b64_tr_b16 a[164:165], v11 offset:32768
    v_mfma_f32_16x16x32_bf16 v[44:47], v[104:107], a[36:39], v[44:47]
    buffer_load_dwordx4 v20, s[44:47], s23 offen offset:512 sc1 lds
    ds_read_b64_tr_b16 a[166:167], v11 offset:34816
    s_waitcnt lgkmcnt(4)
    v_mfma_f32_16x16x32_bf16 v[52:55], v[120:123], a[36:39], v[52:55]
    s_add_u32 m0, s73, 99584
    ds_read_b64_tr_b16 a[172:173], v11 offset:36864
    v_mfma_f32_16x16x32_bf16 v[52:55], v[124:127], a[44:47], v[52:55]
    buffer_load_dwordx4 v23, s[44:47], s24 offen offset:768 sc1 lds
    ds_read_b64_tr_b16 a[174:175], v11 offset:38912
    s_waitcnt lgkmcnt(4)
    v_mfma_f32_16x16x32_bf16 v[52:55], v[128:131], a[52:55], v[52:55]
    ds_read_b128 v[104:107], v14 offset:18432
    v_mfma_f32_16x16x32_bf16 v[52:55], v[132:135], a[60:63], v[52:55]
    ds_read_b128 v[108:111], v14 offset:22528
    v_add_u32 v10, 65536, v10
    v_mfma_f32_16x16x32_bf16 v[48:51], v[132:135], a[56:59], v[48:51]
    ds_read_b128 v[112:115], v14 offset:26624
    v_mfma_f32_16x16x32_bf16 v[48:51], v[128:131], a[48:51], v[48:51]
    ds_read_b128 v[116:119], v14 offset:30720
    v_mfma_f32_16x16x32_bf16 v[48:51], v[124:127], a[40:43], v[48:51]
    s_add_u32 m0, s73, 101376
    ds_read_b64_tr_b16 a[176:177], v10 offset:16384
    v_mfma_f32_16x16x32_bf16 v[48:51], v[120:123], a[32:35], v[48:51]
    buffer_load_dwordx4 v20, s[44:47], s24 offen offset:0 sc1 lds
    ds_read_b64_tr_b16 a[178:179], v10 offset:18432
    s_waitcnt lgkmcnt(4)
    v_mfma_f32_16x16x32_bf16 v[32:35], v[104:107], a[64:67], v[32:35]
    ds_read_b64_tr_b16 a[184:185], v10 offset:20480
    v_mfma_f32_16x16x32_bf16 v[32:35], v[108:111], a[72:75], v[32:35]
    ds_read_b64_tr_b16 a[186:187], v10 offset:22528
    s_waitcnt lgkmcnt(4)
    v_mfma_f32_16x16x32_bf16 v[32:35], v[112:115], a[80:83], v[32:35]
    ds_read_b128 v[120:123], v14 offset:19456
    v_mfma_f32_16x16x32_bf16 v[32:35], v[116:119], a[88:91], v[32:35]
    ds_read_b128 v[124:127], v14 offset:23552
    v_add_u32 v11, 65536, v11
    v_mfma_f32_16x16x32_bf16 v[36:39], v[116:119], a[92:95], v[36:39]
    ds_read_b128 v[128:131], v14 offset:27648
    v_mfma_f32_16x16x32_bf16 v[36:39], v[112:115], a[84:87], v[36:39]
    ds_read_b128 v[132:135], v14 offset:31744
    v_mfma_f32_16x16x32_bf16 v[36:39], v[108:111], a[76:79], v[36:39]
    ds_read_b64_tr_b16 a[180:181], v11 offset:16384
    v_mfma_f32_16x16x32_bf16 v[36:39], v[104:107], a[68:71], v[36:39]
    ds_read_b64_tr_b16 a[182:183], v11 offset:18432
    s_waitcnt lgkmcnt(4)
    v_mfma_f32_16x16x32_bf16 v[44:47], v[120:123], a[68:71], v[44:47]
    ds_read_b64_tr_b16 a[188:189], v11 offset:20480
    v_mfma_f32_16x16x32_bf16 v[44:47], v[124:127], a[76:79], v[44:47]
    ds_read_b64_tr_b16 a[190:191], v11 offset:22528
    s_waitcnt lgkmcnt(4)
    v_mfma_f32_16x16x32_bf16 v[44:47], v[128:131], a[84:87], v[44:47]
    s_waitcnt vmcnt(8) lgkmcnt(0)
    s_barrier
    v_mfma_f32_16x16x32_bf16 v[44:47], v[132:135], a[92:95], v[44:47]
    ds_read_b128 v[104:107], v14 offset:32768
    s_lshl_b32 s14, s100, 18
    s_add_u32 m0, s73, 32768
    v_add_u32 v10, -65536, v10
    v_mfma_f32_16x16x32_bf16 v[40:43], v[132:135], a[88:91], v[40:43]
    ds_read_b128 v[108:111], v14 offset:36864
    buffer_load_dwordx4 v4, s[52:55], s14 offen offset:0 lds
    v_mfma_f32_16x16x32_bf16 v[40:43], v[128:131], a[80:83], v[40:43]
    ds_read_b128 v[112:115], v14 offset:40960
    ds_read_b64_tr_b16 a[192:193], v10 offset:0
    v_mfma_f32_16x16x32_bf16 v[40:43], v[124:127], a[72:75], v[40:43]
    ds_read_b128 v[116:119], v14 offset:45056
    v_mfma_f32_16x16x32_bf16 v[40:43], v[120:123], a[64:67], v[40:43]
    ds_read_b64_tr_b16 a[194:195], v10 offset:2048
    s_waitcnt lgkmcnt(4)
    v_mfma_f32_16x16x32_bf16 v[48:51], v[104:107], a[64:67], v[48:51]
    s_add_u32 m0, s73, 114176
    ds_read_b64_tr_b16 a[200:201], v10 offset:4096
    v_mfma_f32_16x16x32_bf16 v[48:51], v[108:111], a[72:75], v[48:51]
    buffer_load_dwordx4 v20, s[44:47], s24 offen offset:512 sc1 lds
    ds_read_b64_tr_b16 a[202:203], v10 offset:6144
    s_waitcnt lgkmcnt(3)
    v_mfma_f32_16x16x32_bf16 v[48:51], v[112:115], a[80:83], v[48:51]
    ds_read_b128 v[120:123], v14 offset:33792
    s_add_u32 m0, s73, 32768
    v_lshrrev_b32 v30, 2, v26
    v_mfma_f32_16x16x32_bf16 v[48:51], v[116:119], a[88:91], v[48:51]
    ds_read_b128 v[124:127], v14 offset:37888
    buffer_load_dwordx4 v5, s[52:55], s14 offen offset:1024 lds
    v_mfma_f32_16x16x32_bf16 v[52:55], v[116:119], a[92:95], v[52:55]
    ds_read_b128 v[128:131], v14 offset:41984
    v_add_u32 v11, -65536, v11
    v_mfma_f32_16x16x32_bf16 v[52:55], v[112:115], a[84:87], v[52:55]
    ds_read_b128 v[132:135], v14 offset:46080
    v_mfma_f32_16x16x32_bf16 v[52:55], v[108:111], a[76:79], v[52:55]
    s_add_u32 m0, s73, 114944
    ds_read_b64_tr_b16 a[196:197], v11 offset:0
    v_mfma_f32_16x16x32_bf16 v[52:55], v[104:107], a[68:71], v[52:55]
    buffer_load_dwordx4 v23, s[44:47], s25 offen offset:768 sc1 lds
    ds_read_b64_tr_b16 a[198:199], v11 offset:2048
    s_waitcnt lgkmcnt(4)
    v_mfma_f32_16x16x32_bf16 v[36:39], v[120:123], a[100:103], v[36:39]
    s_add_u32 m0, s73, 116736
    ds_read_b64_tr_b16 a[204:205], v11 offset:4096
    v_mfma_f32_16x16x32_bf16 v[36:39], v[124:127], a[108:111], v[36:39]
    buffer_load_dwordx4 v20, s[44:47], s25 offen offset:0 sc1 lds
    ds_read_b64_tr_b16 a[206:207], v11 offset:6144
    s_waitcnt lgkmcnt(4)
    v_mfma_f32_16x16x32_bf16 v[36:39], v[128:131], a[116:119], v[36:39]
    ds_read_b128 v[104:107], v14 offset:34816
    s_add_u32 m0, s73, 32768
    v_lshrrev_b32 v31, 2, v18
    v_mfma_f32_16x16x32_bf16 v[36:39], v[132:135], a[124:127], v[36:39]
    ds_read_b128 v[108:111], v14 offset:38912
    buffer_load_dwordx4 v6, s[52:55], s14 offen offset:2048 lds
    v_mfma_f32_16x16x32_bf16 v[32:35], v[132:135], a[120:123], v[32:35]
    ds_read_b128 v[112:115], v14 offset:43008
    v_mfma_f32_16x16x32_bf16 v[32:35], v[128:131], a[112:115], v[32:35]
    ds_read_b128 v[116:119], v14 offset:47104
    v_mfma_f32_16x16x32_bf16 v[32:35], v[124:127], a[104:107], v[32:35]
    s_add_u32 m0, s73, 117248
    ds_read_b64_tr_b16 a[208:209], v10 offset:16384
    v_mfma_f32_16x16x32_bf16 v[32:35], v[120:123], a[96:99], v[32:35]
    buffer_load_dwordx4 v20, s[44:47], s25 offen offset:512 sc1 lds
    ds_read_b64_tr_b16 a[210:211], v10 offset:18432
    s_waitcnt lgkmcnt(4)
    v_mfma_f32_16x16x32_bf16 v[40:43], v[104:107], a[96:99], v[40:43]
    ds_read_b64_tr_b16 a[216:217], v10 offset:20480
    buffer_load_ushort v102, v30, s[60:63], 0 offen offset:0
    s_add_u32 m0, s73, 32768
    v_mfma_f32_16x16x32_bf16 v[40:43], v[108:111], a[104:107], v[40:43]
    ds_read_b64_tr_b16 a[218:219], v10 offset:22528
    buffer_load_dwordx4 v7, s[52:55], s14 offen offset:3072 lds
    s_waitcnt lgkmcnt(4)
    v_mfma_f32_16x16x32_bf16 v[40:43], v[112:115], a[112:115], v[40:43]
    ds_read_b128 v[120:123], v14 offset:35840
    v_mfma_f32_16x16x32_bf16 v[40:43], v[116:119], a[120:123], v[40:43]
    ds_read_b128 v[124:127], v14 offset:39936
    v_mfma_f32_16x16x32_bf16 v[44:47], v[116:119], a[124:127], v[44:47]
    ds_read_b128 v[128:131], v14 offset:44032
    v_mfma_f32_16x16x32_bf16 v[44:47], v[112:115], a[116:119], v[44:47]
    ds_read_b128 v[132:135], v14 offset:48128
    v_mfma_f32_16x16x32_bf16 v[44:47], v[108:111], a[108:111], v[44:47]
    ds_read_b64_tr_b16 a[212:213], v11 offset:16384
    buffer_load_ushort v103, v30, s[60:63], 0 offen offset:32
    v_mfma_f32_16x16x32_bf16 v[44:47], v[104:107], a[100:103], v[44:47]
    ds_read_b64_tr_b16 a[214:215], v11 offset:18432
    s_waitcnt lgkmcnt(4)
    v_mfma_f32_16x16x32_bf16 v[52:55], v[120:123], a[100:103], v[52:55]
    ds_read_b64_tr_b16 a[220:221], v11 offset:20480
    v_mfma_f32_16x16x32_bf16 v[52:55], v[124:127], a[108:111], v[52:55]
    ds_read_b64_tr_b16 a[222:223], v11 offset:22528
    s_waitcnt lgkmcnt(4)
    v_mfma_f32_16x16x32_bf16 v[52:55], v[128:131], a[116:119], v[52:55]
    s_waitcnt vmcnt(14) lgkmcnt(0)
    s_barrier
    v_mfma_f32_16x16x32_bf16 v[52:55], v[132:135], a[124:127], v[52:55]
    ds_read_b128 v[104:107], v14 offset:49152
    s_lshl_b32 s14, s101, 18
    ds_read_b64_tr_b16 a[224:225], v10 offset:49152
    s_add_u32 m0, s73, 81920
    v_mfma_f32_16x16x32_bf16 v[48:51], v[132:135], a[120:123], v[48:51]
    ds_read_b128 v[108:111], v14 offset:53248
    buffer_load_dwordx4 v4, s[52:55], s14 offen offset:0 lds
    v_mfma_f32_16x16x32_bf16 v[48:51], v[128:131], a[112:115], v[48:51]
    ds_read_b128 v[112:115], v14 offset:57344
    buffer_load_ushort v27, v31, s[60:63], 0 offen offset:0
    v_mfma_f32_16x16x32_bf16 v[48:51], v[124:127], a[104:107], v[48:51]
    ds_read_b128 v[116:119], v14 offset:61440
    v_mfma_f32_16x16x32_bf16 v[48:51], v[120:123], a[96:99], v[48:51]
    ds_read_b64_tr_b16 a[226:227], v10 offset:51200
    s_waitcnt lgkmcnt(3)
    v_mfma_f32_16x16x32_bf16 v[32:35], v[104:107], a[128:131], v[32:35]
    s_add_u32 m0, s73, 130304
    ds_read_b64_tr_b16 a[232:233], v10 offset:53248
    v_mfma_f32_16x16x32_bf16 v[32:35], v[108:111], a[136:139], v[32:35]
    buffer_load_dwordx4 v23, s[44:47], s26 offen offset:768 sc1 lds
    ds_read_b64_tr_b16 a[234:235], v10 offset:55296
    s_waitcnt lgkmcnt(3)
    v_mfma_f32_16x16x32_bf16 v[32:35], v[112:115], a[144:147], v[32:35]
    ds_read_b128 v[120:123], v14 offset:50176
    s_add_u32 m0, s73, 81920
    v_mfma_f32_16x16x32_bf16 v[32:35], v[116:119], a[152:155], v[32:35]
    ds_read_b128 v[124:127], v14 offset:54272
    buffer_load_dwordx4 v5, s[52:55], s14 offen offset:1024 lds
    v_mfma_f32_16x16x32_bf16 v[36:39], v[116:119], a[156:159], v[36:39]
    ds_read_b128 v[128:131], v14 offset:58368
    v_mfma_f32_16x16x32_bf16 v[36:39], v[112:115], a[148:151], v[36:39]
    ds_read_b128 v[132:135], v14 offset:62464
    v_mfma_f32_16x16x32_bf16 v[36:39], v[108:111], a[140:143], v[36:39]
    s_add_u32 m0, s73, 132096
    ds_read_b64_tr_b16 a[228:229], v11 offset:49152
    v_mfma_f32_16x16x32_bf16 v[36:39], v[104:107], a[132:135], v[36:39]
    buffer_load_dwordx4 v20, s[44:47], s26 offen offset:0 sc1 lds
    ds_read_b64_tr_b16 a[230:231], v11 offset:51200
    s_waitcnt lgkmcnt(4)
    v_mfma_f32_16x16x32_bf16 v[44:47], v[120:123], a[132:135], v[44:47]
    ds_read_b64_tr_b16 a[236:237], v11 offset:53248
    buffer_load_dwordx4 v[88:91], v252, s[56:59], 0 offen
    s_add_u32 m0, s73, 132608
    v_mfma_f32_16x16x32_bf16 v[44:47], v[124:127], a[140:143], v[44:47]
    buffer_load_dwordx4 v20, s[44:47], s26 offen offset:512 sc1 lds
    ds_read_b64_tr_b16 a[238:239], v11 offset:55296
    s_waitcnt lgkmcnt(4)
    v_mfma_f32_16x16x32_bf16 v[44:47], v[128:131], a[148:151], v[44:47]
    ds_read_b128 v[104:107], v14 offset:51200
    s_add_u32 m0, s73, 81920
    v_add_u32 v10, 65536, v10
    v_mfma_f32_16x16x32_bf16 v[44:47], v[132:135], a[156:159], v[44:47]
    ds_read_b128 v[108:111], v14 offset:55296
    buffer_load_dwordx4 v6, s[52:55], s14 offen offset:2048 lds
    v_mfma_f32_16x16x32_bf16 v[40:43], v[132:135], a[152:155], v[40:43]
    ds_read_b128 v[112:115], v14 offset:59392
    v_mfma_f32_16x16x32_bf16 v[40:43], v[128:131], a[144:147], v[40:43]
    ds_read_b128 v[116:119], v14 offset:63488
    v_mfma_f32_16x16x32_bf16 v[40:43], v[124:127], a[136:139], v[40:43]
    s_add_u32 m0, s73, 134144
    ds_read_b64_tr_b16 a[240:241], v10 offset:0
    v_mfma_f32_16x16x32_bf16 v[40:43], v[120:123], a[128:131], v[40:43]
    buffer_load_dwordx4 v21, s[44:47], s18 offen offset:0 sc1 lds
    ds_read_b64_tr_b16 a[242:243], v10 offset:2048
    s_waitcnt lgkmcnt(4)
    v_mfma_f32_16x16x32_bf16 v[48:51], v[104:107], a[128:131], v[48:51]
    ds_read_b64_tr_b16 a[248:249], v10 offset:4096
    s_add_u32 m0, s73, 81920
    v_mfma_f32_16x16x32_bf16 v[48:51], v[108:111], a[136:139], v[48:51]
    ds_read_b64_tr_b16 a[250:251], v10 offset:6144
    buffer_load_dwordx4 v7, s[52:55], s14 offen offset:3072 lds
    s_waitcnt lgkmcnt(4)
    v_mfma_f32_16x16x32_bf16 v[48:51], v[112:115], a[144:147], v[48:51]
    ds_read_b128 v[120:123], v14 offset:52224
    v_add_u32 v11, 65536, v11
    v_mfma_f32_16x16x32_bf16 v[48:51], v[116:119], a[152:155], v[48:51]
    ds_read_b128 v[124:127], v14 offset:56320
    v_mfma_f32_16x16x32_bf16 v[52:55], v[116:119], a[156:159], v[52:55]
    ds_read_b128 v[128:131], v14 offset:60416
    v_mfma_f32_16x16x32_bf16 v[52:55], v[112:115], a[148:151], v[52:55]
    ds_read_b128 v[132:135], v14 offset:64512
    v_mfma_f32_16x16x32_bf16 v[52:55], v[108:111], a[140:143], v[52:55]
    ds_read_b64_tr_b16 a[244:245], v11 offset:0
    v_mfma_f32_16x16x32_bf16 v[52:55], v[104:107], a[132:135], v[52:55]
    ds_read_b64_tr_b16 a[246:247], v11 offset:2048
    s_waitcnt lgkmcnt(4)
    v_mfma_f32_16x16x32_bf16 v[36:39], v[120:123], a[164:167], v[36:39]
    ds_read_b64_tr_b16 a[252:253], v11 offset:4096
    buffer_load_dwordx4 v[92:95], v252, s[56:59], s40 offen
    v_mfma_f32_16x16x32_bf16 v[36:39], v[124:127], a[172:175], v[36:39]
    ds_read_b64_tr_b16 a[254:255], v11 offset:6144
    s_waitcnt lgkmcnt(4)
    v_mfma_f32_16x16x32_bf16 v[36:39], v[128:131], a[180:183], v[36:39]
    s_waitcnt vmcnt(12) lgkmcnt(0)
    s_barrier
    v_mfma_f32_16x16x32_bf16 v[36:39], v[132:135], a[188:191], v[36:39]
    ds_read_b128 v[104:107], v14 offset:0
    v_mfma_f32_16x16x32_bf16 v[32:35], v[132:135], a[184:187], v[32:35]
    ds_read_b128 v[108:111], v14 offset:4096
    v_add_u32 v10, -65536, v10
L_pl_G_6:
    s_cbranch_execz L_wret
    v_mfma_f32_16x16x32_bf16 v[32:35], v[128:131], a[176:179], v[32:35]
    ds_read_b128 v[112:115], v14 offset:8192
    v_mfma_f32_16x16x32_bf16 v[32:35], v[124:127], a[168:171], v[32:35]
    ds_read_b128 v[116:119], v14 offset:12288
    v_mfma_f32_16x16x32_bf16 v[32:35], v[120:123], a[160:163], v[32:35]
    ds_read_b64_tr_b16 v[220:221], v10 offset:32768
    s_waitcnt lgkmcnt(3)
    v_mfma_f32_16x16x32_bf16 v[40:43], v[104:107], a[160:163], v[40:43]
    s_add_u32 m0, s73, 146944
    v_mfma_f32_16x16x32_bf16 v[40:43], v[108:111], a[168:171], v[40:43]
    buffer_load_dwordx4 v21, s[44:47], s18 offen offset:512 sc1 lds
    ds_read_b64_tr_b16 v[222:223], v10 offset:34816
    s_waitcnt lgkmcnt(2)
    v_mfma_f32_16x16x32_bf16 v[40:43], v[112:115], a[176:179], v[40:43]
    ds_read_b128 v[120:123], v14 offset:1024
    v_mfma_f32_16x16x32_bf16 v[40:43], v[116:119], a[184:187], v[40:43]
    ds_read_b128 v[124:127], v14 offset:5120
    v_mfma_f32_16x16x32_bf16 v[44:47], v[116:119], a[188:191], v[44:47]
    ds_read_b128 v[128:131], v14 offset:9216
    v_mfma_f32_16x16x32_bf16 v[44:47], v[112:115], a[180:183], v[44:47]
    ds_read_b128 v[132:135], v14 offset:13312
    v_mfma_f32_16x16x32_bf16 v[44:47], v[108:111], a[172:175], v[44:47]
    s_add_u32 m0, s73, 148480
    ds_read_b64_tr_b16 v[228:229], v10 offset:36864
    v_mfma_f32_16x16x32_bf16 v[44:47], v[104:107], a[164:167], v[44:47]
    buffer_load_dwordx4 v21, s[44:47], s19 offen offset:0 sc1 lds
    s_waitcnt lgkmcnt(3)
    v_mfma_f32_16x16x32_bf16 v[52:55], v[120:123], a[164:167], v[52:55]
    ds_read_b64_tr_b16 v[230:231], v10 offset:38912
    buffer_load_dwordx2 v[142:143], v253, s[56:59], 0 offen
    s_add_u32 m0, s73, 148992
    v_mfma_f32_16x16x32_bf16 v[52:55], v[124:127], a[172:175], v[52:55]
    buffer_load_dwordx4 v21, s[44:47], s19 offen offset:512 sc1 lds
    s_waitcnt lgkmcnt(2)
    v_mfma_f32_16x16x32_bf16 v[52:55], v[128:131], a[180:183], v[52:55]
    ds_read_b128 v[104:107], v14 offset:2048
    v_mfma_f32_16x16x32_bf16 v[52:55], v[132:135], a[188:191], v[52:55]
    ds_read_b128 v[108:111], v14 offset:6144
    v_mfma_f32_16x16x32_bf16 v[48:51], v[132:135], a[184:187], v[48:51]
    ds_read_b128 v[112:115], v14 offset:10240
    v_add_u32 v11, -65536, v11
    v_mfma_f32_16x16x32_bf16 v[48:51], v[128:131], a[176:179], v[48:51]
    ds_read_b128 v[116:119], v14 offset:14336
    v_mfma_f32_16x16x32_bf16 v[48:51], v[124:127], a[168:171], v[48:51]
    s_add_u32 m0, s73, 150528
    v_mfma_f32_16x16x32_bf16 v[48:51], v[120:123], a[160:163], v[48:51]
    buffer_load_dwordx4 v21, s[44:47], s20 offen offset:0 sc1 lds
    ds_read_b64_tr_b16 v[224:225], v11 offset:32768
    s_waitcnt lgkmcnt(3)
    v_mfma_f32_16x16x32_bf16 v[32:35], v[104:107], a[192:195], v[32:35]
    v_mfma_f32_16x16x32_bf16 v[32:35], v[108:111], a[200:203], v[32:35]
    ds_read_b64_tr_b16 v[226:227], v11 offset:34816
    s_waitcnt vmcnt(14)
    s_waitcnt lgkmcnt(2)
    v_mfma_f32_16x16x32_bf16 v[32:35], v[112:115], a[208:211], v[32:35]
    ds_read_b128 v[120:123], v14 offset:3072
    v_mfma_f32_16x16x32_bf16 v[32:35], v[116:119], a[216:219], v[32:35]
    ds_read_b128 v[124:127], v14 offset:7168
    v_mfma_f32_16x16x32_bf16 v[36:39], v[116:119], a[220:223], v[36:39]
    ds_read_b128 v[128:131], v14 offset:11264
    v_lshlrev_b32 v72, 16, v102
    v_mfma_f32_16x16x32_bf16 v[36:39], v[112:115], a[212:215], v[36:39]
    ds_read_b128 v[132:135], v14 offset:15360
    v_mfma_f32_16x16x32_bf16 v[36:39], v[108:111], a[204:207], v[36:39]
    ds_read_b64_tr_b16 v[232:233], v11 offset:36864
    v_lshlrev_b32 v73, 16, v102
    v_mfma_f32_16x16x32_bf16 v[36:39], v[104:107], a[196:199], v[36:39]
    s_waitcnt lgkmcnt(3)
    v_mfma_f32_16x16x32_bf16 v[44:47], v[120:123], a[196:199], v[44:47]
    ds_read_b64_tr_b16 v[234:235], v11 offset:38912
    buffer_load_dwordx2 v[96:97], v26, s[44:47], s42 offen offset:0 sc1
    v_mfma_f32_16x16x32_bf16 v[44:47], v[124:127], a[204:207], v[44:47]
    v_lshlrev_b32 v74, 16, v102
    s_waitcnt lgkmcnt(2)
    v_mfma_f32_16x16x32_bf16 v[44:47], v[128:131], a[212:215], v[44:47]
    s_waitcnt vmcnt(7) lgkmcnt(0)
    s_barrier
    v_mfma_f32_16x16x32_bf16 v[44:47], v[132:135], a[220:223], v[44:47]
    ds_read_b128 v[104:107], v14 offset:16384
    v_lshlrev_b32 v75, 16, v102
    v_mfma_f32_16x16x32_bf16 v[40:43], v[132:135], a[216:219], v[40:43]
    ds_read_b128 v[108:111], v14 offset:20480
    v_add_u32 v10, 65536, v10
    v_mfma_f32_16x16x32_bf16 v[40:43], v[128:131], a[208:211], v[40:43]
    ds_read_b128 v[112:115], v14 offset:24576
    v_mfma_f32_16x16x32_bf16 v[40:43], v[124:127], a[200:203], v[40:43]
    ds_read_b128 v[116:119], v14 offset:28672
    v_lshlrev_b32 v76, 16, v103
    v_mfma_f32_16x16x32_bf16 v[40:43], v[120:123], a[192:195], v[40:43]
    ds_read_b64_tr_b16 v[236:237], v10 offset:16384
    s_waitcnt lgkmcnt(3)
    v_mfma_f32_16x16x32_bf16 v[48:51], v[104:107], a[192:195], v[48:51]
    s_add_u32 m0, s73, 97792
    v_lshlrev_b32 v77, 16, v103
    v_mfma_f32_16x16x32_bf16 v[48:51], v[108:111], a[200:203], v[48:51]
    buffer_load_dwordx4 v21, s[44:47], s20 offen offset:512 sc1 lds
    ds_read_b64_tr_b16 v[238:239], v10 offset:18432
    s_waitcnt lgkmcnt(2)
    v_mfma_f32_16x16x32_bf16 v[48:51], v[112:115], a[208:211], v[48:51]
    ds_read_b128 v[120:123], v14 offset:17408
    v_mfma_f32_16x16x32_bf16 v[48:51], v[116:119], a[216:219], v[48:51]
    ds_read_b128 v[124:127], v14 offset:21504
    v_mfma_f32_16x16x32_bf16 v[52:55], v[116:119], a[220:223], v[52:55]
    ds_read_b128 v[128:131], v14 offset:25600
    v_lshlrev_b32 v78, 16, v103
    v_mfma_f32_16x16x32_bf16 v[52:55], v[112:115], a[212:215], v[52:55]
    ds_read_b128 v[132:135], v14 offset:29696
    v_mfma_f32_16x16x32_bf16 v[52:55], v[108:111], a[204:207], v[52:55]
    ds_read_b64_tr_b16 v[244:245], v10 offset:20480
    s_add_u32 m0, s73, 99328
    v_lshlrev_b32 v79, 16, v103
    v_mfma_f32_16x16x32_bf16 v[52:55], v[104:107], a[196:199], v[52:55]
    buffer_load_dwordx4 v21, s[44:47], s21 offen offset:0 sc1 lds
    s_waitcnt lgkmcnt(3)
    v_mfma_f32_16x16x32_bf16 v[36:39], v[120:123], a[228:231], v[36:39]
    ds_read_b64_tr_b16 v[246:247], v10 offset:22528
    buffer_load_dwordx2 v[98:99], v26, s[44:47], s42 offen offset:128 sc1
    s_add_u32 m0, s73, 99840
    v_mfma_f32_16x16x32_bf16 v[36:39], v[124:127], a[236:239], v[36:39]
    buffer_load_dwordx4 v21, s[44:47], s21 offen offset:512 sc1 lds
    s_waitcnt lgkmcnt(2)
    v_mfma_f32_16x16x32_bf16 v[36:39], v[128:131], a[244:247], v[36:39]
    ds_read_b128 v[104:107], v14 offset:18432
    v_lshlrev_b32 v80, 16, v102
    v_mfma_f32_16x16x32_bf16 v[36:39], v[132:135], a[252:255], v[36:39]
    ds_read_b128 v[108:111], v14 offset:22528
    v_lshlrev_b32 v81, 16, v102
    v_mfma_f32_16x16x32_bf16 v[32:35], v[132:135], a[248:251], v[32:35]
    ds_read_b128 v[112:115], v14 offset:26624
    v_add_u32 v11, 65536, v11
    v_mfma_f32_16x16x32_bf16 v[32:35], v[128:131], a[240:243], v[32:35]
    ds_read_b128 v[116:119], v14 offset:30720
    v_mfma_f32_16x16x32_bf16 v[32:35], v[124:127], a[232:235], v[32:35]
    s_add_u32 m0, s73, 101376
    v_lshlrev_b32 v82, 16, v102
    v_mfma_f32_16x16x32_bf16 v[32:35], v[120:123], a[224:227], v[32:35]
    buffer_load_dwordx4 v21, s[44:47], s22 offen offset:0 sc1 lds
    ds_read_b64_tr_b16 v[240:241], v11 offset:16384
    s_waitcnt lgkmcnt(3)
    v_mfma_f32_16x16x32_bf16 v[40:43], v[104:107], a[224:227], v[40:43]
    v_lshlrev_b32 v83, 16, v102
    v_mfma_f32_16x16x32_bf16 v[40:43], v[108:111], a[232:235], v[40:43]
    ds_read_b64_tr_b16 v[242:243], v11 offset:18432
    s_waitcnt lgkmcnt(2)
    v_mfma_f32_16x16x32_bf16 v[40:43], v[112:115], a[240:243], v[40:43]
    ds_read_b128 v[120:123], v14 offset:19456
    v_mfma_f32_16x16x32_bf16 v[40:43], v[116:119], a[248:251], v[40:43]
    ds_read_b128 v[124:127], v14 offset:23552
    v_mfma_f32_16x16x32_bf16 v[44:47], v[116:119], a[252:255], v[44:47]
    ds_read_b128 v[128:131], v14 offset:27648
    v_lshlrev_b32 v84, 16, v103
    v_mfma_f32_16x16x32_bf16 v[44:47], v[112:115], a[244:247], v[44:47]
    ds_read_b128 v[132:135], v14 offset:31744
    v_mfma_f32_16x16x32_bf16 v[44:47], v[108:111], a[236:239], v[44:47]
    ds_read_b64_tr_b16 v[248:249], v11 offset:20480
    v_lshlrev_b32 v85, 16, v103
    v_mfma_f32_16x16x32_bf16 v[44:47], v[104:107], a[228:231], v[44:47]
    s_waitcnt lgkmcnt(3)
    v_mfma_f32_16x16x32_bf16 v[52:55], v[120:123], a[228:231], v[52:55]
    ds_read_b64_tr_b16 v[250:251], v11 offset:22528
    buffer_load_dwordx2 v[100:101], v18, s[44:47], s42 offen offset:0 sc1
    v_mfma_f32_16x16x32_bf16 v[52:55], v[124:127], a[236:239], v[52:55]
    v_lshlrev_b32 v86, 16, v103
    s_waitcnt lgkmcnt(2)
    v_mfma_f32_16x16x32_bf16 v[52:55], v[128:131], a[244:247], v[52:55]
    s_waitcnt lgkmcnt(0)
    s_barrier
    v_mfma_f32_16x16x32_bf16 v[52:55], v[132:135], a[252:255], v[52:55]
    ds_read_b128 v[104:107], v14 offset:32768
    v_mfma_f32_16x16x32_bf16 v[48:51], v[132:135], a[248:251], v[48:51]
    ds_read_b128 v[108:111], v14 offset:36864
    v_lshlrev_b32 v87, 16, v103
    v_mfma_f32_16x16x32_bf16 v[48:51], v[128:131], a[240:243], v[48:51]
    ds_read_b128 v[112:115], v14 offset:40960
    v_mfma_f32_16x16x32_bf16 v[48:51], v[124:127], a[232:235], v[48:51]
    ds_read_b128 v[116:119], v14 offset:45056
    v_lshlrev_b32 v27, 16, v27
    v_mfma_f32_16x16x32_bf16 v[48:51], v[120:123], a[224:227], v[48:51]
L_Dc:
L_pl_D_0:
    s_cbranch_execz L_wret
    s_waitcnt lgkmcnt(2)
    v_mfma_f32_16x16x32_bf16 v[32:35], v[104:107], v[220:223], v[32:35]
    s_add_u32 m0, s73, 114176
    v_mfma_f32_16x16x32_bf16 v[32:35], v[108:111], v[228:231], v[32:35]
    buffer_load_dwordx4 v21, s[44:47], s22 offen offset:512 sc1 lds
    s_waitcnt lgkmcnt(0)
    v_mfma_f32_16x16x32_bf16 v[32:35], v[112:115], v[236:239], v[32:35]
    ds_read_b128 v[120:123], v14 offset:33792
    v_mfma_f32_16x16x32_bf16 v[32:35], v[116:119], v[244:247], v[32:35]
    ds_read_b128 v[124:127], v14 offset:37888
    v_mfma_f32_16x16x32_bf16 v[36:39], v[116:119], v[248:251], v[36:39]
    ds_read_b128 v[128:131], v14 offset:41984
    buffer_load_dword v189, v188, s[44:47], 0 offen sc1
    v_mfma_f32_16x16x32_bf16 v[36:39], v[112:115], v[240:243], v[36:39]
    ds_read_b128 v[132:135], v14 offset:46080
    v_mfma_f32_16x16x32_bf16 v[36:39], v[108:111], v[232:235], v[36:39]
    s_add_u32 m0, s73, 115712
    v_mfma_f32_16x16x32_bf16 v[36:39], v[104:107], v[224:227], v[36:39]
    buffer_load_dwordx4 v21, s[44:47], s23 offen offset:0 sc1 lds
    s_waitcnt lgkmcnt(2)
    v_mfma_f32_16x16x32_bf16 v[44:47], v[120:123], v[224:227], v[44:47]
    s_add_u32 m0, s73, 116224
    v_mfma_f32_16x16x32_bf16 v[44:47], v[124:127], v[232:235], v[44:47]
    buffer_load_dwordx4 v21, s[44:47], s23 offen offset:512 sc1 lds
    s_waitcnt lgkmcnt(0)
    v_mfma_f32_16x16x32_bf16 v[44:47], v[128:131], v[240:243], v[44:47]
    ds_read_b128 v[104:107], v14 offset:34816
    v_mfma_f32_16x16x32_bf16 v[44:47], v[132:135], v[248:251], v[44:47]
    ds_read_b128 v[108:111], v14 offset:38912
    v_mfma_f32_16x16x32_bf16 v[40:43], v[132:135], v[244:247], v[40:43]
    ds_read_b128 v[112:115], v14 offset:43008
    v_mfma_f32_16x16x32_bf16 v[40:43], v[128:131], v[236:239], v[40:43]
    ds_read_b128 v[116:119], v14 offset:47104
    v_mfma_f32_16x16x32_bf16 v[40:43], v[124:127], v[228:231], v[40:43]
    s_add_u32 m0, s73, 117760
    v_mfma_f32_16x16x32_bf16 v[40:43], v[120:123], v[220:223], v[40:43]
    buffer_load_dwordx4 v21, s[44:47], s24 offen offset:0 sc1 lds
    s_waitcnt lgkmcnt(2)
    v_mfma_f32_16x16x32_bf16 v[48:51], v[104:107], v[220:223], v[48:51]
    v_mfma_f32_16x16x32_bf16 v[48:51], v[108:111], v[228:231], v[48:51]
    s_waitcnt lgkmcnt(0)
    v_mfma_f32_16x16x32_bf16 v[48:51], v[112:115], v[236:239], v[48:51]
    ds_read_b128 v[120:123], v14 offset:35840
    v_mfma_f32_16x16x32_bf16 v[48:51], v[116:119], v[244:247], v[48:51]
    ds_read_b128 v[124:127], v14 offset:39936
    v_mfma_f32_16x16x32_bf16 v[52:55], v[116:119], v[248:251], v[52:55]
    ds_read_b128 v[128:131], v14 offset:44032
    v_mfma_f32_16x16x32_bf16 v[52:55], v[112:115], v[240:243], v[52:55]
    ds_read_b128 v[132:135], v14 offset:48128
    v_mfma_f32_16x16x32_bf16 v[52:55], v[108:111], v[232:235], v[52:55]
    v_mfma_f32_16x16x32_bf16 v[52:55], v[104:107], v[224:227], v[52:55]
    s_waitcnt lgkmcnt(2)
    v_mfma_f32_16x16x32_bf16 v[60:63], v[120:123], a[4:7], 0
    v_mfma_f32_16x16x32_bf16 v[60:63], v[124:127], a[12:15], v[60:63]
    s_waitcnt lgkmcnt(0)
    v_mfma_f32_16x16x32_bf16 v[60:63], v[128:131], a[20:23], v[60:63]
    s_waitcnt vmcnt(12)
    s_barrier
    v_mfma_f32_16x16x32_bf16 v[60:63], v[132:135], a[28:31], v[60:63]
    ds_read_b128 v[104:107], v14 offset:49152
    v_mfma_f32_16x16x32_bf16 v[56:59], v[132:135], a[24:27], 0
    ds_read_b128 v[108:111], v14 offset:53248
    v_mfma_f32_16x16x32_bf16 v[56:59], v[128:131], a[16:19], v[56:59]
    ds_read_b128 v[112:115], v14 offset:57344
    v_cvt_pk_bf16_f32 v192, v32, v33
    v_mfma_f32_16x16x32_bf16 v[56:59], v[124:127], a[8:11], v[56:59]
    ds_read_b128 v[116:119], v14 offset:61440
    v_mfma_f32_16x16x32_bf16 v[56:59], v[120:123], a[0:3], v[56:59]
    s_waitcnt lgkmcnt(2)
    v_mfma_f32_16x16x32_bf16 v[64:67], v[104:107], a[0:3], 0
    s_add_u32 m0, s73, 130560
    v_mfma_f32_16x16x32_bf16 v[64:67], v[108:111], a[8:11], v[64:67]
    buffer_load_dwordx4 v21, s[44:47], s24 offen offset:512 sc1 lds
    s_waitcnt lgkmcnt(0)
    v_mfma_f32_16x16x32_bf16 v[64:67], v[112:115], a[16:19], v[64:67]
    ds_read_b128 v[120:123], v14 offset:50176
    v_cvt_pk_bf16_f32 v193, v34, v35
    v_mfma_f32_16x16x32_bf16 v[64:67], v[116:119], a[24:27], v[64:67]
    ds_read_b128 v[124:127], v14 offset:54272
    v_mfma_f32_16x16x32_bf16 v[68:71], v[116:119], a[28:31], 0
    ds_read_b128 v[128:131], v14 offset:58368
    v_mfma_f32_16x16x32_bf16 v[68:71], v[112:115], a[20:23], v[68:71]
    buffer_store_dwordx4 v[192:195], v136, s[44:47], s32 offen sc1
    ds_read_b128 v[132:135], v14 offset:62464
    v_mfma_f32_16x16x32_bf16 v[68:71], v[108:111], a[12:15], v[68:71]
    s_add_u32 m0, s73, 132096
    v_mfma_f32_16x16x32_bf16 v[68:71], v[104:107], a[4:7], v[68:71]
    buffer_load_dwordx4 v21, s[44:47], s25 offen offset:0 sc1 lds
    s_waitcnt lgkmcnt(2)
    v_mfma_f32_16x16x32_bf16 v[60:63], v[120:123], a[36:39], v[60:63]
    s_add_u32 m0, s73, 132608
    v_mfma_f32_16x16x32_bf16 v[60:63], v[124:127], a[44:47], v[60:63]
    buffer_load_dwordx4 v21, s[44:47], s25 offen offset:512 sc1 lds
    s_waitcnt lgkmcnt(0)
    v_mfma_f32_16x16x32_bf16 v[60:63], v[128:131], a[52:55], v[60:63]
    ds_read_b128 v[104:107], v14 offset:51200
    v_mfma_f32_16x16x32_bf16 v[60:63], v[132:135], a[60:63], v[60:63]
    ds_read_b128 v[108:111], v14 offset:55296
    v_mfma_f32_16x16x32_bf16 v[56:59], v[132:135], a[56:59], v[56:59]
    ds_read_b128 v[112:115], v14 offset:59392
    v_mfma_f32_16x16x32_bf16 v[56:59], v[128:131], a[48:51], v[56:59]
    ds_read_b128 v[116:119], v14 offset:63488
    v_mfma_f32_16x16x32_bf16 v[56:59], v[124:127], a[40:43], v[56:59]
    s_add_u32 m0, s73, 134144
    v_cvt_pk_bf16_f32 v196, v36, v37
    v_mfma_f32_16x16x32_bf16 v[56:59], v[120:123], a[32:35], v[56:59]
    buffer_load_dwordx4 v21, s[44:47], s26 offen offset:0 sc1 lds
    s_waitcnt lgkmcnt(2)
    v_mfma_f32_16x16x32_bf16 v[64:67], v[104:107], a[32:35], v[64:67]
    v_mfma_f32_16x16x32_bf16 v[64:67], v[108:111], a[40:43], v[64:67]
    s_waitcnt lgkmcnt(0)
    v_mfma_f32_16x16x32_bf16 v[64:67], v[112:115], a[48:51], v[64:67]
    ds_read_b128 v[120:123], v14 offset:52224
    v_cvt_pk_bf16_f32 v197, v38, v39
    v_mfma_f32_16x16x32_bf16 v[64:67], v[116:119], a[56:59], v[64:67]
    ds_read_b128 v[124:127], v14 offset:56320
    v_mfma_f32_16x16x32_bf16 v[68:71], v[116:119], a[60:63], v[68:71]
    ds_read_b128 v[128:131], v14 offset:60416
    v_mfma_f32_16x16x32_bf16 v[68:71], v[112:115], a[52:55], v[68:71]
    ds_read_b128 v[132:135], v14 offset:64512
    v_mfma_f32_16x16x32_bf16 v[68:71], v[108:111], a[44:47], v[68:71]
    buffer_store_dwordx4 v[196:199], v136, s[44:47], s33 offen sc1
    v_mfma_f32_16x16x32_bf16 v[68:71], v[104:107], a[36:39], v[68:71]
    s_waitcnt lgkmcnt(2)
    v_mfma_f32_16x16x32_bf16 v[60:63], v[120:123], a[68:71], v[60:63]
    v_mfma_f32_16x16x32_bf16 v[60:63], v[124:127], a[76:79], v[60:63]
    s_waitcnt lgkmcnt(0)
    v_mfma_f32_16x16x32_bf16 v[60:63], v[128:131], a[84:87], v[60:63]
    s_waitcnt vmcnt(12)
    s_barrier
    v_mfma_f32_16x16x32_bf16 v[60:63], v[132:135], a[92:95], v[60:63]
    ds_read_b128 v[104:107], v14 offset:0
    v_mfma_f32_16x16x32_bf16 v[56:59], v[132:135], a[88:91], v[56:59]
    ds_read_b128 v[108:111], v14 offset:4096
    v_mfma_f32_16x16x32_bf16 v[56:59], v[128:131], a[80:83], v[56:59]
    ds_read_b128 v[112:115], v14 offset:8192
    v_cvt_pk_bf16_f32 v192, v40, v41
    v_mfma_f32_16x16x32_bf16 v[56:59], v[124:127], a[72:75], v[56:59]
    ds_read_b128 v[116:119], v14 offset:12288
    v_mfma_f32_16x16x32_bf16 v[56:59], v[120:123], a[64:67], v[56:59]
    s_waitcnt lgkmcnt(2)
    v_mfma_f32_16x16x32_bf16 v[64:67], v[104:107], a[64:67], v[64:67]
    s_add_u32 m0, s73, 146944
    v_cvt_pk_bf16_f32 v193, v42, v43
    s_waitcnt vmcnt(11)
    v_mfma_f32_16x16x32_bf16 v[64:67], v[108:111], a[72:75], v[64:67]
    buffer_load_dwordx4 v21, s[44:47], s26 offen offset:512 sc1 lds
    s_waitcnt lgkmcnt(0)
    v_mfma_f32_16x16x32_bf16 v[64:67], v[112:115], a[80:83], v[64:67]
    ds_read_b128 v[120:123], v14 offset:1024
    v_mul_f32 v96, v96, v97
    v_mfma_f32_16x16x32_bf16 v[64:67], v[116:119], a[88:91], v[64:67]
    ds_read_b128 v[124:127], v14 offset:5120
    v_cvt_pk_bf16_f32 v194, v44, v45
    v_mfma_f32_16x16x32_bf16 v[68:71], v[116:119], a[92:95], v[68:71]
    ds_read_b128 v[128:131], v14 offset:9216
    v_mul_f32 v98, v98, v99
    v_mfma_f32_16x16x32_bf16 v[68:71], v[112:115], a[84:87], v[68:71]
    ds_read_b128 v[132:135], v14 offset:13312
    v_mul_f32 v100, v100, v101
    v_mfma_f32_16x16x32_bf16 v[68:71], v[108:111], a[76:79], v[68:71]
    buffer_store_dwordx4 v[192:195], v136, s[44:47], s30 offen offset:0 sc1
    s_add_u32 m0, s73, 148480
    v_permlane16_swap_b32 v88, v90
    v_mfma_f32_16x16x32_bf16 v[68:71], v[104:107], a[68:71], v[68:71]
    buffer_load_dwordx4 v22, s[44:47], s18 offen offset:0 sc1 lds
    s_waitcnt lgkmcnt(2)
    v_mfma_f32_16x16x32_bf16 v[60:63], v[120:123], a[100:103], v[60:63]
    s_add_u32 m0, s73, 148992
    v_permlane16_swap_b32 v89, v91
    v_permlane16_swap_b32 v92, v94
    v_mfma_f32_16x16x32_bf16 v[60:63], v[124:127], a[108:111], v[60:63]
    buffer_load_dwordx4 v22, s[44:47], s18 offen offset:512 sc1 lds
    s_waitcnt vmcnt(13)
    s_waitcnt lgkmcnt(0)
    v_mfma_f32_16x16x32_bf16 v[60:63], v[128:131], a[116:119], v[60:63]
    ds_read_b128 v[104:107], v14 offset:2048
    v_permlane16_swap_b32 v93, v95
    v_mfma_f32_16x16x32_bf16 v[60:63], v[132:135], a[124:127], v[60:63]
    ds_read_b128 v[108:111], v14 offset:6144
    v_cmp_ne_u32 vcc, s68, v189
    v_mfma_f32_16x16x32_bf16 v[56:59], v[132:135], a[120:123], v[56:59]
    ds_read_b128 v[112:115], v14 offset:10240
    v_and_b32 v145, 0xffff0000, v88
    v_mfma_f32_16x16x32_bf16 v[56:59], v[128:131], a[112:115], v[56:59]
    ds_read_b128 v[116:119], v14 offset:14336
    v_cvt_pk_bf16_f32 v196, v46, v47
    v_mfma_f32_16x16x32_bf16 v[56:59], v[124:127], a[104:107], v[56:59]
    s_add_u32 m0, s73, 150528
    s_cbranch_vccnz L_rs_p3
L_ok_p3:
    v_lshlrev_b32 v144, 16, v88
    v_mfma_f32_16x16x32_bf16 v[56:59], v[120:123], a[96:99], v[56:59]
    buffer_load_dwordx4 v22, s[44:47], s19 offen offset:0 sc1 lds
    s_waitcnt lgkmcnt(2)
    v_mfma_f32_16x16x32_bf16 v[64:67], v[104:107], a[96:99], v[64:67]
    s_add_u32 m0, s73, 81920
    v_cvt_pk_bf16_f32 v197, v48, v49
    v_and_b32 v147, 0xffff0000, v89
    v_mfma_f32_16x16x32_bf16 v[64:67], v[108:111], a[104:107], v[64:67]
    buffer_load_dwordx4 v184, s[44:47], s37 offen offset:0 sc1 lds
    s_waitcnt lgkmcnt(0)
    v_mfma_f32_16x16x32_bf16 v[64:67], v[112:115], a[112:115], v[64:67]
    ds_read_b128 v[120:123], v14 offset:3072
    buffer_load_dwordx4 v185, s[44:47], s37 offen offset:1024 sc1 lds
    v_mfma_f32_16x16x32_bf16 v[64:67], v[116:119], a[120:123], v[64:67]
    ds_read_b128 v[124:127], v14 offset:7168
    s_add_u32 m0, s73, 83968
    v_cvt_pk_bf16_f32 v198, v50, v51
    v_mfma_f32_16x16x32_bf16 v[68:71], v[116:119], a[124:127], v[68:71]
    ds_read_b128 v[128:131], v14 offset:11264
    buffer_load_dwordx4 v184, s[44:47], s16 offen offset:0 sc1 lds
    v_mfma_f32_16x16x32_bf16 v[68:71], v[112:115], a[116:119], v[68:71]
    ds_read_b128 v[132:135], v14 offset:15360
    buffer_load_dwordx4 v185, s[44:47], s16 offen offset:1024 sc1 lds
    v_mfma_f32_16x16x32_bf16 v[68:71], v[108:111], a[108:111], v[68:71]
    buffer_store_dwordx4 v[196:199], v136, s[44:47], s30 offen offset:1024 sc1
    v_lshlrev_b32 v146, 16, v89
    v_and_b32 v149, 0xffff0000, v92
    v_lshlrev_b32 v148, 16, v92
    v_mfma_f32_16x16x32_bf16 v[68:71], v[104:107], a[100:103], v[68:71]
    s_waitcnt lgkmcnt(2)
    v_mfma_f32_16x16x32_bf16 v[60:63], v[120:123], a[132:135], v[60:63]
    v_and_b32 v151, 0xffff0000, v93
    v_mfma_f32_16x16x32_bf16 v[60:63], v[124:127], a[140:143], v[60:63]
    v_lshlrev_b32 v150, 16, v93
    s_waitcnt lgkmcnt(0)
    v_mfma_f32_16x16x32_bf16 v[60:63], v[128:131], a[148:151], v[60:63]
    s_waitcnt vmcnt(16)
    s_barrier
    v_mfma_f32_16x16x32_bf16 v[60:63], v[132:135], a[156:159], v[60:63]
    ds_read_b128 v[104:107], v14 offset:16384
    v_and_b32 v153, 0xffff0000, v90
    v_mfma_f32_16x16x32_bf16 v[56:59], v[132:135], a[152:155], v[56:59]
    ds_read_b128 v[108:111], v14 offset:20480
    v_lshlrev_b32 v152, 16, v90
    v_mfma_f32_16x16x32_bf16 v[56:59], v[128:131], a[144:147], v[56:59]
    ds_read_b128 v[112:115], v14 offset:24576
    v_cvt_pk_bf16_f32 v200, v52, v53
    v_mfma_f32_16x16x32_bf16 v[56:59], v[124:127], a[136:139], v[56:59]
    ds_read_b128 v[116:119], v14 offset:28672
    v_and_b32 v155, 0xffff0000, v91
    v_mfma_f32_16x16x32_bf16 v[56:59], v[120:123], a[128:131], v[56:59]
    s_waitcnt lgkmcnt(2)
    v_mfma_f32_16x16x32_bf16 v[64:67], v[104:107], a[128:131], v[64:67]
    s_add_u32 m0, s73, 97792
    v_lshlrev_b32 v154, 16, v91
    v_mfma_f32_16x16x32_bf16 v[64:67], v[108:111], a[136:139], v[64:67]
    buffer_load_dwordx4 v22, s[44:47], s19 offen offset:512 sc1 lds
    s_waitcnt lgkmcnt(0)
    v_mfma_f32_16x16x32_bf16 v[64:67], v[112:115], a[144:147], v[64:67]
    ds_read_b128 v[120:123], v14 offset:17408
    v_cvt_pk_bf16_f32 v201, v54, v55
    v_mfma_f32_16x16x32_bf16 v[64:67], v[116:119], a[152:155], v[64:67]
    ds_read_b128 v[124:127], v14 offset:21504
    v_and_b32 v157, 0xffff0000, v94
    v_mfma_f32_16x16x32_bf16 v[68:71], v[116:119], a[156:159], v[68:71]
    ds_read_b128 v[128:131], v14 offset:25600
    v_lshlrev_b32 v156, 16, v94
    v_mfma_f32_16x16x32_bf16 v[68:71], v[112:115], a[148:151], v[68:71]
    buffer_store_dwordx4 v[200:203], v136, s[44:47], s30 offen offset:2048 sc1
    ds_read_b128 v[132:135], v14 offset:29696
    v_and_b32 v159, 0xffff0000, v95
    v_mfma_f32_16x16x32_bf16 v[68:71], v[108:111], a[140:143], v[68:71]
    s_add_u32 m0, s73, 99328
    v_lshlrev_b32 v158, 16, v95
    v_mfma_f32_16x16x32_bf16 v[68:71], v[104:107], a[132:135], v[68:71]
    buffer_load_dwordx4 v22, s[44:47], s20 offen offset:0 sc1 lds
    s_waitcnt lgkmcnt(2)
    v_mfma_f32_16x16x32_bf16 v[60:63], v[120:123], a[164:167], v[60:63]
    s_add_u32 m0, s73, 99840
    v_and_b32 v161, 0xffff0000, v142
    v_mfma_f32_16x16x32_bf16 v[60:63], v[124:127], a[172:175], v[60:63]
    buffer_load_dwordx4 v22, s[44:47], s20 offen offset:512 sc1 lds
    s_waitcnt lgkmcnt(0)
    v_mfma_f32_16x16x32_bf16 v[60:63], v[128:131], a[180:183], v[60:63]
    ds_read_b128 v[104:107], v14 offset:18432
    v_lshlrev_b32 v160, 16, v142
    v_mfma_f32_16x16x32_bf16 v[60:63], v[132:135], a[188:191], v[60:63]
    ds_read_b128 v[108:111], v14 offset:22528
    v_mfma_f32_16x16x32_bf16 v[56:59], v[132:135], a[184:187], v[56:59]
    ds_read_b128 v[112:115], v14 offset:26624
    v_and_b32 v163, 0xffff0000, v143
    v_mfma_f32_16x16x32_bf16 v[56:59], v[128:131], a[176:179], v[56:59]
    ds_read_b128 v[116:119], v14 offset:30720
    v_lshlrev_b32 v162, 16, v143
    v_mfma_f32_16x16x32_bf16 v[56:59], v[124:127], a[168:171], v[56:59]
    s_add_u32 m0, s73, 101376
    v_mfma_f32_16x16x32_bf16 v[56:59], v[120:123], a[160:163], v[56:59]
    buffer_load_dwordx4 v22, s[44:47], s21 offen offset:0 sc1 lds
    s_waitcnt lgkmcnt(2)
    v_mfma_f32_16x16x32_bf16 v[64:67], v[104:107], a[160:163], v[64:67]
    v_fma_f32 v164, v144, v97, -v96
    v_mfma_f32_16x16x32_bf16 v[64:67], v[108:111], a[168:171], v[64:67]
    v_fma_f32 v165, v145, v97, -v96
    s_waitcnt lgkmcnt(0)
    v_mfma_f32_16x16x32_bf16 v[64:67], v[112:115], a[176:179], v[64:67]
    ds_read_b128 v[120:123], v14 offset:19456
    v_fma_f32 v166, v146, v97, -v96
    v_mfma_f32_16x16x32_bf16 v[64:67], v[116:119], a[184:187], v[64:67]
    ds_read_b128 v[124:127], v14 offset:23552
    v_mfma_f32_16x16x32_bf16 v[68:71], v[116:119], a[188:191], v[68:71]
    ds_read_b128 v[128:131], v14 offset:27648
    v_fma_f32 v167, v147, v97, -v96
    v_mfma_f32_16x16x32_bf16 v[68:71], v[112:115], a[180:183], v[68:71]
    ds_read_b128 v[132:135], v14 offset:31744
    v_mfma_f32_16x16x32_bf16 v[68:71], v[108:111], a[172:175], v[68:71]
    v_fma_f32 v168, v148, v99, -v98
    v_mfma_f32_16x16x32_bf16 v[68:71], v[104:107], a[164:167], v[68:71]
    v_fma_f32 v169, v149, v99, -v98
    s_waitcnt lgkmcnt(2)
    v_mfma_f32_16x16x32_bf16 v[60:63], v[120:123], a[196:199], v[60:63]
    v_mfma_f32_16x16x32_bf16 v[60:63], v[124:127], a[204:207], v[60:63]
    v_fma_f32 v170, v150, v99, -v98
    s_waitcnt lgkmcnt(0)
    v_mfma_f32_16x16x32_bf16 v[60:63], v[128:131], a[212:215], v[60:63]
    s_waitcnt vmcnt(16)
    s_barrier
    v_mfma_f32_16x16x32_bf16 v[60:63], v[132:135], a[220:223], v[60:63]
    ds_read_b128 v[104:107], v14 offset:32768
    v_fma_f32 v171, v151, v99, -v98
    v_mfma_f32_16x16x32_bf16 v[56:59], v[132:135], a[216:219], v[56:59]
    ds_read_b128 v[108:111], v14 offset:36864
    v_fma_f32 v172, v152, v97, -v96
    v_mfma_f32_16x16x32_bf16 v[56:59], v[128:131], a[208:211], v[56:59]
    ds_read_b128 v[112:115], v14 offset:40960
    v_mfma_f32_16x16x32_bf16 v[56:59], v[124:127], a[200:203], v[56:59]
    ds_read_b128 v[116:119], v14 offset:45056
    v_fma_f32 v173, v153, v97, -v96
    v_mfma_f32_16x16x32_bf16 v[56:59], v[120:123], a[192:195], v[56:59]
    s_waitcnt lgkmcnt(2)
    v_mfma_f32_16x16x32_bf16 v[64:67], v[104:107], a[192:195], v[64:67]
    s_add_u32 m0, s73, 114176
    v_fma_f32 v174, v154, v97, -v96
    v_mfma_f32_16x16x32_bf16 v[64:67], v[108:111], a[200:203], v[64:67]
    buffer_load_dwordx4 v22, s[44:47], s21 offen offset:512 sc1 lds
    s_waitcnt lgkmcnt(0)
    v_mfma_f32_16x16x32_bf16 v[64:67], v[112:115], a[208:211], v[64:67]
    ds_read_b128 v[120:123], v14 offset:33792
    v_fma_f32 v175, v155, v97, -v96
    v_mfma_f32_16x16x32_bf16 v[64:67], v[116:119], a[216:219], v[64:67]
    ds_read_b128 v[124:127], v14 offset:37888
    v_fma_f32 v176, v156, v99, -v98
    v_mfma_f32_16x16x32_bf16 v[68:71], v[116:119], a[220:223], v[68:71]
    ds_read_b128 v[128:131], v14 offset:41984
    v_mfma_f32_16x16x32_bf16 v[68:71], v[112:115], a[212:215], v[68:71]
    ds_read_b128 v[132:135], v14 offset:46080
    v_fma_f32 v177, v157, v99, -v98
    v_mfma_f32_16x16x32_bf16 v[68:71], v[108:111], a[204:207], v[68:71]
    s_add_u32 m0, s73, 115712
    v_fma_f32 v178, v158, v99, -v98
    v_mfma_f32_16x16x32_bf16 v[68:71], v[104:107], a[196:199], v[68:71]
    buffer_load_dwordx4 v22, s[44:47], s22 offen offset:0 sc1 lds
    s_waitcnt lgkmcnt(2)
    v_mfma_f32_16x16x32_bf16 v[60:63], v[120:123], a[228:231], v[60:63]
    s_add_u32 m0, s73, 116224
    v_fma_f32 v179, v159, v99, -v98
    v_mfma_f32_16x16x32_bf16 v[60:63], v[124:127], a[236:239], v[60:63]
    buffer_load_dwordx4 v22, s[44:47], s22 offen offset:512 sc1 lds
    s_waitcnt lgkmcnt(0)
    v_mfma_f32_16x16x32_bf16 v[60:63], v[128:131], a[244:247], v[60:63]
    ds_read_b128 v[104:107], v14 offset:34816
    v_fma_f32 v180, v160, v101, -v100
    v_mfma_f32_16x16x32_bf16 v[60:63], v[132:135], a[252:255], v[60:63]
    ds_read_b128 v[108:111], v14 offset:38912
    v_fma_f32 v181, v161, v101, -v100
    v_mfma_f32_16x16x32_bf16 v[56:59], v[132:135], a[248:251], v[56:59]
    ds_read_b128 v[112:115], v14 offset:43008
    v_mfma_f32_16x16x32_bf16 v[56:59], v[128:131], a[240:243], v[56:59]
    ds_read_b128 v[116:119], v14 offset:47104
    v_fma_f32 v182, v162, v101, -v100
    v_mfma_f32_16x16x32_bf16 v[56:59], v[124:127], a[232:235], v[56:59]
    s_add_u32 m0, s73, 117760
    v_fma_f32 v183, v163, v101, -v100
    v_mfma_f32_16x16x32_bf16 v[56:59], v[120:123], a[224:227], v[56:59]
    buffer_load_dwordx4 v22, s[44:47], s23 offen offset:0 sc1 lds
    s_waitcnt lgkmcnt(2)
    v_mfma_f32_16x16x32_bf16 v[64:67], v[104:107], a[224:227], v[64:67]
    v_mfma_f32_16x16x32_bf16 v[64:67], v[108:111], a[232:235], v[64:67]
    s_waitcnt lgkmcnt(0)
    v_mfma_f32_16x16x32_bf16 v[64:67], v[112:115], a[240:243], v[64:67]
    ds_read_b128 v[120:123], v14 offset:35840
    v_mfma_f32_16x16x32_bf16 v[64:67], v[116:119], a[248:251], v[64:67]
    ds_read_b128 v[124:127], v14 offset:39936
    v_mfma_f32_16x16x32_bf16 v[68:71], v[116:119], a[252:255], v[68:71]
    ds_read_b128 v[128:131], v14 offset:44032
    v_mfma_f32_16x16x32_bf16 v[68:71], v[112:115], a[244:247], v[68:71]
L_pl_D_1:
    s_cbranch_execz L_wret
    ds_read_b128 v[132:135], v14 offset:48128
    v_mfma_f32_16x16x32_bf16 v[68:71], v[108:111], a[236:239], v[68:71]
    v_mfma_f32_16x16x32_bf16 v[68:71], v[104:107], a[228:231], v[68:71]
    s_waitcnt lgkmcnt(2)
    v_mfma_f32_16x16x32_bf16 v[60:63], v[120:123], v[224:227], v[60:63]
    v_mfma_f32_16x16x32_bf16 v[60:63], v[124:127], v[232:235], v[60:63]
    s_waitcnt lgkmcnt(0)
    v_mfma_f32_16x16x32_bf16 v[60:63], v[128:131], v[240:243], v[60:63]
    s_waitcnt vmcnt(10)
    s_barrier
    v_mfma_f32_16x16x32_bf16 v[60:63], v[132:135], v[248:251], v[60:63]
    ds_read_b128 v[104:107], v14 offset:49152
    v_mfma_f32_16x16x32_bf16 v[56:59], v[132:135], v[244:247], v[56:59]
    ds_read_b128 v[108:111], v14 offset:53248
    v_mfma_f32_16x16x32_bf16 v[56:59], v[128:131], v[236:239], v[56:59]
    ds_read_b128 v[112:115], v14 offset:57344
    v_mfma_f32_16x16x32_bf16 v[56:59], v[124:127], v[228:231], v[56:59]
    ds_read_b128 v[116:119], v14 offset:61440
    v_mfma_f32_16x16x32_bf16 v[56:59], v[120:123], v[220:223], v[56:59]
    s_waitcnt lgkmcnt(2)
    v_mfma_f32_16x16x32_bf16 v[64:67], v[104:107], v[220:223], v[64:67]
    s_add_u32 m0, s73, 130560
    v_xor_b32 v186, s41, v10
    v_add_u32 v186, s43, v186
    v_mfma_f32_16x16x32_bf16 v[64:67], v[108:111], v[228:231], v[64:67]
    buffer_load_dwordx4 v22, s[44:47], s23 offen offset:512 sc1 lds
    ds_read_b64_tr_b16 v[12:13], v10 offset:16384
    s_waitcnt lgkmcnt(1)
    v_mfma_f32_16x16x32_bf16 v[64:67], v[112:115], v[236:239], v[64:67]
    ds_read_b128 v[120:123], v14 offset:50176
    v_mfma_f32_16x16x32_bf16 v[64:67], v[116:119], v[244:247], v[64:67]
    ds_read_b128 v[124:127], v14 offset:54272
    v_mfma_f32_16x16x32_bf16 v[68:71], v[116:119], v[248:251], v[68:71]
    ds_read_b128 v[128:131], v14 offset:58368
    ds_read_b64_tr_b16 v[24:25], v11 offset:16384
    v_mfma_f32_16x16x32_bf16 v[68:71], v[112:115], v[240:243], v[68:71]
    ds_read_b128 v[132:135], v14 offset:62464
    ds_read_b64_tr_b16 v[28:29], v10 offset:20480
    v_mfma_f32_16x16x32_bf16 v[68:71], v[108:111], v[232:235], v[68:71]
    s_add_u32 m0, s73, 132096
    ds_read_b64_tr_b16 v[190:191], v11 offset:20480
    v_mfma_f32_16x16x32_bf16 v[68:71], v[104:107], v[224:227], v[68:71]
    buffer_load_dwordx4 v22, s[44:47], s24 offen offset:0 sc1 lds
    ds_read_b64_tr_b16 v[142:143], v186 offset:18432
    s_waitcnt lgkmcnt(6)
    v_mfma_f32_16x16x32_bf16 v[76:79], v[120:123], a[4:7], v[76:79]
    s_add_u32 m0, s73, 132608
    s_waitcnt lgkmcnt(0)
    v_mfma_f32_16x16x32_bf16 v[76:79], v[124:127], a[12:15], v[76:79]
    buffer_load_dwordx4 v22, s[44:47], s24 offen offset:512 sc1 lds
    v_mfma_f32_16x16x32_bf16 v[76:79], v[128:131], a[20:23], v[76:79]
    ds_read_b128 v[104:107], v14 offset:51200
    v_and_b32 v9, 0xffff0000, v12
    v_mfma_f32_16x16x32_bf16 v[76:79], v[132:135], a[28:31], v[76:79]
    ds_read_b128 v[108:111], v14 offset:55296
    v_mfma_f32_16x16x32_bf16 v[72:75], v[132:135], a[24:27], v[72:75]
    ds_read_b128 v[112:115], v14 offset:59392
    v_lshlrev_b32 v8, 16, v12
    v_mfma_f32_16x16x32_bf16 v[72:75], v[128:131], a[16:19], v[72:75]
    ds_read_b128 v[116:119], v14 offset:63488
    v_mfma_f32_16x16x32_bf16 v[72:75], v[124:127], a[8:11], v[72:75]
    s_add_u32 m0, s73, 134144
    v_mul_f32 v165, v165, v9
    v_mfma_f32_16x16x32_bf16 v[72:75], v[120:123], a[0:3], v[72:75]
    buffer_load_dwordx4 v22, s[44:47], s25 offen offset:0 sc1 lds
    s_waitcnt lgkmcnt(2)
    v_mfma_f32_16x16x32_bf16 v[80:83], v[104:107], a[0:3], v[80:83]
    v_mul_f32 v164, v164, v8
    v_mfma_f32_16x16x32_bf16 v[80:83], v[108:111], a[8:11], v[80:83]
    v_and_b32 v31, 0xffff0000, v13
    s_waitcnt lgkmcnt(0)
    v_mfma_f32_16x16x32_bf16 v[80:83], v[112:115], a[16:19], v[80:83]
    ds_read_b128 v[120:123], v14 offset:52224
    v_mfma_f32_16x16x32_bf16 v[80:83], v[116:119], a[24:27], v[80:83]
    ds_read_b128 v[124:127], v14 offset:56320
    v_lshlrev_b32 v30, 16, v13
    v_mfma_f32_16x16x32_bf16 v[84:87], v[116:119], a[28:31], v[84:87]
    ds_read_b128 v[128:131], v14 offset:60416
    v_mfma_f32_16x16x32_bf16 v[84:87], v[112:115], a[20:23], v[84:87]
    ds_read_b128 v[132:135], v14 offset:64512
    v_mul_f32 v167, v167, v31
    v_mfma_f32_16x16x32_bf16 v[84:87], v[108:111], a[12:15], v[84:87]
    v_mul_f32 v166, v166, v30
    v_mfma_f32_16x16x32_bf16 v[84:87], v[104:107], a[4:7], v[84:87]
    s_waitcnt lgkmcnt(2)
    v_mfma_f32_16x16x32_bf16 v[76:79], v[120:123], a[36:39], v[76:79]
    v_and_b32 v9, 0xffff0000, v24
    v_mfma_f32_16x16x32_bf16 v[76:79], v[124:127], a[44:47], v[76:79]
    v_mov_b32 v141, 0
    s_waitcnt lgkmcnt(0)
    v_mfma_f32_16x16x32_bf16 v[76:79], v[128:131], a[52:55], v[76:79]
    buffer_atomic_add v141, v137, s[44:47], 0 offen offset:12 sc0 sc1
    s_waitcnt vmcnt(9)
    s_barrier
    v_mfma_f32_16x16x32_bf16 v[76:79], v[132:135], a[60:63], v[76:79]
    ds_read_b128 v[104:107], v14 offset:0
    v_lshlrev_b32 v8, 16, v24
    v_mfma_f32_16x16x32_bf16 v[72:75], v[132:135], a[56:59], v[72:75]
    ds_read_b128 v[108:111], v14 offset:4096
    v_mul_f32 v169, v169, v9
    v_mfma_f32_16x16x32_bf16 v[72:75], v[128:131], a[48:51], v[72:75]
    ds_read_b128 v[112:115], v14 offset:8192
    v_cvt_pk_bf16_f32 v192, v56, v57
    v_mfma_f32_16x16x32_bf16 v[72:75], v[124:127], a[40:43], v[72:75]
    ds_read_b128 v[116:119], v14 offset:12288
    v_mul_f32 v168, v168, v8
    v_mfma_f32_16x16x32_bf16 v[72:75], v[120:123], a[32:35], v[72:75]
    v_and_b32 v31, 0xffff0000, v25
    s_waitcnt lgkmcnt(2)
    v_mfma_f32_16x16x32_bf16 v[80:83], v[104:107], a[32:35], v[80:83]
    s_add_u32 m0, s73, 146944
    v_cvt_pk_bf16_f32 v193, v58, v59
    v_lshlrev_b32 v30, 16, v25
    v_mfma_f32_16x16x32_bf16 v[80:83], v[108:111], a[40:43], v[80:83]
    buffer_load_dwordx4 v22, s[44:47], s25 offen offset:512 sc1 lds
    s_waitcnt lgkmcnt(0)
    v_mfma_f32_16x16x32_bf16 v[80:83], v[112:115], a[48:51], v[80:83]
    ds_read_b128 v[120:123], v14 offset:1024
    v_mul_f32 v171, v171, v31
    v_mfma_f32_16x16x32_bf16 v[80:83], v[116:119], a[56:59], v[80:83]
    ds_read_b128 v[124:127], v14 offset:5120
    v_cvt_pk_bf16_f32 v194, v60, v61
    v_mfma_f32_16x16x32_bf16 v[84:87], v[116:119], a[60:63], v[84:87]
    ds_read_b128 v[128:131], v14 offset:9216
    v_mul_f32 v170, v170, v30
    v_mfma_f32_16x16x32_bf16 v[84:87], v[112:115], a[52:55], v[84:87]
    ds_read_b128 v[132:135], v14 offset:13312
    v_mfma_f32_16x16x32_bf16 v[84:87], v[108:111], a[44:47], v[84:87]
    buffer_store_dwordx4 v[192:195], v136, s[44:47], s15 offen offset:0 sc1
    s_add_u32 m0, s73, 148480
    v_and_b32 v9, 0xffff0000, v28
    v_mfma_f32_16x16x32_bf16 v[84:87], v[104:107], a[36:39], v[84:87]
    buffer_load_dwordx4 v22, s[44:47], s26 offen offset:0 sc1 lds
    s_waitcnt lgkmcnt(2)
    v_mfma_f32_16x16x32_bf16 v[76:79], v[120:123], a[68:71], v[76:79]
    s_add_u32 m0, s73, 148992
    v_cvt_pk_bf16_f32 v196, v62, v63
    v_lshlrev_b32 v8, 16, v28
    v_mfma_f32_16x16x32_bf16 v[76:79], v[124:127], a[76:79], v[76:79]
    buffer_load_dwordx4 v22, s[44:47], s26 offen offset:512 sc1 lds
    s_waitcnt lgkmcnt(0)
    v_mfma_f32_16x16x32_bf16 v[76:79], v[128:131], a[84:87], v[76:79]
    ds_read_b128 v[104:107], v14 offset:2048
    v_mul_f32 v173, v173, v9
    v_mfma_f32_16x16x32_bf16 v[76:79], v[132:135], a[92:95], v[76:79]
    ds_read_b128 v[108:111], v14 offset:6144
    v_mul_f32 v172, v172, v8
    v_mfma_f32_16x16x32_bf16 v[72:75], v[132:135], a[88:91], v[72:75]
    ds_read_b128 v[112:115], v14 offset:10240
    v_cvt_pk_bf16_f32 v197, v64, v65
    v_mfma_f32_16x16x32_bf16 v[72:75], v[128:131], a[80:83], v[72:75]
    ds_read_b128 v[116:119], v14 offset:14336
    v_and_b32 v31, 0xffff0000, v29
    v_mfma_f32_16x16x32_bf16 v[72:75], v[124:127], a[72:75], v[72:75]
    s_add_u32 m0, s73, 150528
    v_mfma_f32_16x16x32_bf16 v[72:75], v[120:123], a[64:67], v[72:75]
    buffer_load_dwordx4 v19, s[44:47], s18 offen offset:0 sc1 lds
    s_waitcnt lgkmcnt(2)
    v_mfma_f32_16x16x32_bf16 v[80:83], v[104:107], a[64:67], v[80:83]
    v_cvt_pk_bf16_f32 v198, v66, v67
    v_lshlrev_b32 v30, 16, v29
    v_mfma_f32_16x16x32_bf16 v[80:83], v[108:111], a[72:75], v[80:83]
    v_mul_f32 v175, v175, v31
    s_waitcnt lgkmcnt(0)
    v_mfma_f32_16x16x32_bf16 v[80:83], v[112:115], a[80:83], v[80:83]
    buffer_store_dwordx4 v[196:199], v136, s[44:47], s15 offen offset:1024 sc1
    ds_read_b128 v[120:123], v14 offset:3072
    v_mfma_f32_16x16x32_bf16 v[80:83], v[116:119], a[88:91], v[80:83]
    ds_read_b128 v[124:127], v14 offset:7168
    v_mul_f32 v174, v174, v30
    v_mfma_f32_16x16x32_bf16 v[84:87], v[116:119], a[92:95], v[84:87]
    ds_read_b128 v[128:131], v14 offset:11264
    v_and_b32 v9, 0xffff0000, v190
    v_mfma_f32_16x16x32_bf16 v[84:87], v[112:115], a[84:87], v[84:87]
    ds_read_b128 v[132:135], v14 offset:15360
    v_mfma_f32_16x16x32_bf16 v[84:87], v[108:111], a[76:79], v[84:87]
    v_cvt_pk_bf16_f32 v200, v68, v69
    v_lshlrev_b32 v8, 16, v190
    v_mfma_f32_16x16x32_bf16 v[84:87], v[104:107], a[68:71], v[84:87]
    s_waitcnt lgkmcnt(2)
    v_mfma_f32_16x16x32_bf16 v[76:79], v[120:123], a[100:103], v[76:79]
    v_mul_f32 v177, v177, v9
    v_mfma_f32_16x16x32_bf16 v[76:79], v[124:127], a[108:111], v[76:79]
    v_mul_f32 v176, v176, v8
    s_waitcnt lgkmcnt(0)
    v_mfma_f32_16x16x32_bf16 v[76:79], v[128:131], a[116:119], v[76:79]
    s_waitcnt vmcnt(11)
    s_barrier
    v_cvt_pk_bf16_f32 v201, v70, v71
    v_mfma_f32_16x16x32_bf16 v[76:79], v[132:135], a[124:127], v[76:79]
    ds_read_b128 v[104:107], v14 offset:16384
    v_and_b32 v31, 0xffff0000, v191
    v_mfma_f32_16x16x32_bf16 v[72:75], v[132:135], a[120:123], v[72:75]
    ds_read_b128 v[108:111], v14 offset:20480
    v_mfma_f32_16x16x32_bf16 v[72:75], v[128:131], a[112:115], v[72:75]
    ds_read_b128 v[112:115], v14 offset:24576
    v_lshlrev_b32 v30, 16, v191
    v_mfma_f32_16x16x32_bf16 v[72:75], v[124:127], a[104:107], v[72:75]
    buffer_store_dwordx4 v[200:203], v136, s[44:47], s15 offen offset:2048 sc1
    ds_read_b128 v[116:119], v14 offset:28672
    v_mfma_f32_16x16x32_bf16 v[72:75], v[120:123], a[96:99], v[72:75]
    v_mul_f32 v179, v179, v31
    s_waitcnt lgkmcnt(2)
    v_mfma_f32_16x16x32_bf16 v[80:83], v[104:107], a[96:99], v[80:83]
    s_add_u32 m0, s73, 97792
    v_mul_f32 v178, v178, v30
    v_mfma_f32_16x16x32_bf16 v[80:83], v[108:111], a[104:107], v[80:83]
    buffer_load_dwordx4 v19, s[44:47], s18 offen offset:512 sc1 lds
    s_waitcnt lgkmcnt(0)
    v_mfma_f32_16x16x32_bf16 v[80:83], v[112:115], a[112:115], v[80:83]
    ds_read_b128 v[120:123], v14 offset:17408
    v_and_b32 v9, 0xffff0000, v142
    v_mfma_f32_16x16x32_bf16 v[80:83], v[116:119], a[120:123], v[80:83]
    ds_read_b128 v[124:127], v14 offset:21504
    v_mfma_f32_16x16x32_bf16 v[84:87], v[116:119], a[124:127], v[84:87]
    ds_read_b128 v[128:131], v14 offset:25600
    v_lshlrev_b32 v8, 16, v142
    v_mfma_f32_16x16x32_bf16 v[84:87], v[112:115], a[116:119], v[84:87]
    ds_read_b128 v[132:135], v14 offset:29696
    v_mfma_f32_16x16x32_bf16 v[84:87], v[108:111], a[108:111], v[84:87]
    s_add_u32 m0, s73, 99328
    v_mul_f32 v181, v181, v9
    v_mfma_f32_16x16x32_bf16 v[84:87], v[104:107], a[100:103], v[84:87]
    buffer_load_dwordx4 v19, s[44:47], s19 offen offset:0 sc1 lds
    s_waitcnt lgkmcnt(2)
    v_mfma_f32_16x16x32_bf16 v[76:79], v[120:123], a[132:135], v[76:79]
    v_mul_f32 v180, v180, v8
    v_mfma_f32_16x16x32_bf16 v[76:79], v[124:127], a[140:143], v[76:79]
    s_waitcnt vmcnt(9)
    v_and_b32 v31, 0xffff0000, v143
    s_waitcnt lgkmcnt(0)
    v_mfma_f32_16x16x32_bf16 v[76:79], v[128:131], a[148:151], v[76:79]
    ds_read_b128 v[104:107], v14 offset:18432
    v_mfma_f32_16x16x32_bf16 v[76:79], v[132:135], a[156:159], v[76:79]
    ds_read_b128 v[108:111], v14 offset:22528
    v_cmp_ne_u32 vcc, v138, v141
    v_mfma_f32_16x16x32_bf16 v[72:75], v[132:135], a[152:155], v[72:75]
    ds_read_b128 v[112:115], v14 offset:26624
    v_lshlrev_b32 v30, 16, v143
    v_mfma_f32_16x16x32_bf16 v[72:75], v[128:131], a[144:147], v[72:75]
    ds_read_b128 v[116:119], v14 offset:30720
    v_mul_f32 v183, v183, v31
    v_mfma_f32_16x16x32_bf16 v[72:75], v[124:127], a[136:139], v[72:75]
    s_cbranch_vccnz L_as_a
L_ao_a:
    v_mfma_f32_16x16x32_bf16 v[72:75], v[120:123], a[128:131], v[72:75]
    v_mul_f32 v182, v182, v30
    s_waitcnt lgkmcnt(2)
    v_mfma_f32_16x16x32_bf16 v[80:83], v[104:107], a[128:131], v[80:83]
    buffer_load_dwordx4 v[40:43], v136, s[44:47], s34 offen offset:0 sc1
    v_mfma_f32_16x16x32_bf16 v[80:83], v[108:111], a[136:139], v[80:83]
    s_waitcnt lgkmcnt(0)
    v_mfma_f32_16x16x32_bf16 v[80:83], v[112:115], a[144:147], v[80:83]
    ds_read_b128 v[120:123], v14 offset:19456
    buffer_load_dwordx4 v[44:47], v136, s[44:47], s34 offen offset:1024 sc1
    v_mfma_f32_16x16x32_bf16 v[80:83], v[116:119], a[152:155], v[80:83]
    ds_read_b128 v[124:127], v14 offset:23552
    v_mfma_f32_16x16x32_bf16 v[84:87], v[116:119], a[156:159], v[84:87]
    ds_read_b128 v[128:131], v14 offset:27648
    v_mfma_f32_16x16x32_bf16 v[84:87], v[112:115], a[148:151], v[84:87]
    ds_read_b128 v[132:135], v14 offset:31744
    buffer_load_dwordx4 v[48:51], v136, s[44:47], s34 offen offset:2048 sc1
    v_mfma_f32_16x16x32_bf16 v[84:87], v[108:111], a[140:143], v[84:87]
    v_mfma_f32_16x16x32_bf16 v[84:87], v[104:107], a[132:135], v[84:87]
    buffer_load_dwordx4 v[204:207], v136, s[44:47], s35 offen offset:0 sc1
    s_waitcnt lgkmcnt(2)
    v_mfma_f32_16x16x32_bf16 v[76:79], v[120:123], a[164:167], v[76:79]
    v_mfma_f32_16x16x32_bf16 v[76:79], v[124:127], a[172:175], v[76:79]
    buffer_load_dwordx4 v[208:211], v136, s[44:47], s35 offen offset:1024 sc1
    s_waitcnt lgkmcnt(0)
    v_mfma_f32_16x16x32_bf16 v[76:79], v[128:131], a[180:183], v[76:79]
    s_barrier
    v_mfma_f32_16x16x32_bf16 v[76:79], v[132:135], a[188:191], v[76:79]
    ds_read_b128 v[104:107], v14 offset:32768
    v_mfma_f32_16x16x32_bf16 v[72:75], v[132:135], a[184:187], v[72:75]
    ds_read_b128 v[108:111], v14 offset:36864
    buffer_load_dwordx4 v[212:215], v136, s[44:47], s35 offen offset:2048 sc1
    v_mfma_f32_16x16x32_bf16 v[72:75], v[128:131], a[176:179], v[72:75]
    ds_read_b128 v[112:115], v14 offset:40960
    v_mfma_f32_16x16x32_bf16 v[72:75], v[124:127], a[168:171], v[72:75]
    ds_read_b128 v[116:119], v14 offset:45056
    buffer_load_dwordx4 v[216:219], v136, s[44:47], s35 offen offset:3072 sc1
    v_mfma_f32_16x16x32_bf16 v[72:75], v[120:123], a[160:163], v[72:75]
    s_waitcnt lgkmcnt(2)
    v_mfma_f32_16x16x32_bf16 v[80:83], v[104:107], a[160:163], v[80:83]
    v_mfma_f32_16x16x32_bf16 v[80:83], v[108:111], a[168:171], v[80:83]
    s_waitcnt lgkmcnt(0)
    v_mfma_f32_16x16x32_bf16 v[80:83], v[112:115], a[176:179], v[80:83]
    ds_read_b128 v[120:123], v14 offset:33792
    v_mfma_f32_16x16x32_bf16 v[80:83], v[116:119], a[184:187], v[80:83]
    ds_read_b128 v[124:127], v14 offset:37888
    v_mfma_f32_16x16x32_bf16 v[84:87], v[116:119], a[188:191], v[84:87]
    ds_read_b128 v[128:131], v14 offset:41984
    v_mfma_f32_16x16x32_bf16 v[84:87], v[112:115], a[180:183], v[84:87]
    ds_read_b128 v[132:135], v14 offset:46080
    v_mfma_f32_16x16x32_bf16 v[84:87], v[108:111], a[172:175], v[84:87]
    v_mfma_f32_16x16x32_bf16 v[84:87], v[104:107], a[164:167], v[84:87]
    s_waitcnt lgkmcnt(2)
    v_mfma_f32_16x16x32_bf16 v[76:79], v[120:123], a[196:199], v[76:79]
    v_mov_b32 v141, 0
    v_mfma_f32_16x16x32_bf16 v[76:79], v[124:127], a[204:207], v[76:79]
    s_waitcnt lgkmcnt(0)
    v_mfma_f32_16x16x32_bf16 v[76:79], v[128:131], a[212:215], v[76:79]
    ds_read_b128 v[104:107], v14 offset:34816
    v_mfma_f32_16x16x32_bf16 v[76:79], v[132:135], a[220:223], v[76:79]
    ds_read_b128 v[108:111], v14 offset:38912
    buffer_atomic_add v141, v139, s[44:47], s11 offen offset:2060 sc0 sc1
    v_mfma_f32_16x16x32_bf16 v[72:75], v[132:135], a[216:219], v[72:75]
    ds_read_b128 v[112:115], v14 offset:43008
    v_mfma_f32_16x16x32_bf16 v[72:75], v[128:131], a[208:211], v[72:75]
    ds_read_b128 v[116:119], v14 offset:47104
    v_mfma_f32_16x16x32_bf16 v[72:75], v[124:127], a[200:203], v[72:75]
    v_mfma_f32_16x16x32_bf16 v[72:75], v[120:123], a[192:195], v[72:75]
    s_waitcnt lgkmcnt(2)
    v_mfma_f32_16x16x32_bf16 v[80:83], v[104:107], a[192:195], v[80:83]
    s_add_u32 m0, s73, 99840
    v_mfma_f32_16x16x32_bf16 v[80:83], v[108:111], a[200:203], v[80:83]
    buffer_load_dwordx4 v19, s[44:47], s19 offen offset:512 sc1 lds
    s_waitcnt lgkmcnt(0)
    v_mfma_f32_16x16x32_bf16 v[80:83], v[112:115], a[208:211], v[80:83]
    ds_read_b128 v[120:123], v14 offset:35840
    v_mfma_f32_16x16x32_bf16 v[80:83], v[116:119], a[216:219], v[80:83]
    ds_read_b128 v[124:127], v14 offset:39936
    v_mfma_f32_16x16x32_bf16 v[84:87], v[116:119], a[220:223], v[84:87]
    ds_read_b128 v[128:131], v14 offset:44032
    v_mfma_f32_16x16x32_bf16 v[84:87], v[112:115], a[212:215], v[84:87]
    ds_read_b128 v[132:135], v14 offset:48128
    v_mfma_f32_16x16x32_bf16 v[84:87], v[108:111], a[204:207], v[84:87]
    s_add_u32 m0, s73, 101376
    v_mfma_f32_16x16x32_bf16 v[84:87], v[104:107], a[196:199], v[84:87]
    buffer_load_dwordx4 v19, s[44:47], s20 offen offset:0 sc1 lds
    s_waitcnt lgkmcnt(2)
    v_mfma_f32_16x16x32_bf16 v[76:79], v[120:123], a[228:231], v[76:79]
    s_add_u32 m0, s73, 114176
    v_mfma_f32_16x16x32_bf16 v[76:79], v[124:127], a[236:239], v[76:79]
    buffer_load_dwordx4 v19, s[44:47], s20 offen offset:512 sc1 lds
    s_waitcnt lgkmcnt(0)
    v_mfma_f32_16x16x32_bf16 v[76:79], v[128:131], a[244:247], v[76:79]
    s_waitcnt vmcnt(15)
    s_barrier
    v_mfma_f32_16x16x32_bf16 v[76:79], v[132:135], a[252:255], v[76:79]
    ds_read_b128 v[104:107], v14 offset:49152
    v_mfma_f32_16x16x32_bf16 v[72:75], v[132:135], a[248:251], v[72:75]
    ds_read_b128 v[108:111], v14 offset:53248
    v_mfma_f32_16x16x32_bf16 v[72:75], v[128:131], a[240:243], v[72:75]
    ds_read_b128 v[112:115], v14 offset:57344
    v_mfma_f32_16x16x32_bf16 v[72:75], v[124:127], a[232:235], v[72:75]
    ds_read_b128 v[116:119], v14 offset:61440
    s_add_u32 m0, s73, 115712
    v_mfma_f32_16x16x32_bf16 v[72:75], v[120:123], a[224:227], v[72:75]
    buffer_load_dwordx4 v19, s[44:47], s21 offen offset:0 sc1 lds
    s_waitcnt lgkmcnt(2)
    v_mfma_f32_16x16x32_bf16 v[80:83], v[104:107], a[224:227], v[80:83]
    s_add_u32 m0, s73, 116224
    v_mfma_f32_16x16x32_bf16 v[80:83], v[108:111], a[232:235], v[80:83]
    buffer_load_dwordx4 v19, s[44:47], s21 offen offset:512 sc1 lds
    s_waitcnt lgkmcnt(0)
    v_mfma_f32_16x16x32_bf16 v[80:83], v[112:115], a[240:243], v[80:83]
    ds_read_b128 v[120:123], v14 offset:50176
    v_mfma_f32_16x16x32_bf16 v[80:83], v[116:119], a[248:251], v[80:83]
    ds_read_b128 v[124:127], v14 offset:54272
    v_mfma_f32_16x16x32_bf16 v[84:87], v[116:119], a[252:255], v[84:87]
    ds_read_b128 v[128:131], v14 offset:58368
    v_mfma_f32_16x16x32_bf16 v[84:87], v[112:115], a[244:247], v[84:87]
    ds_read_b128 v[132:135], v14 offset:62464
    v_mfma_f32_16x16x32_bf16 v[84:87], v[108:111], a[236:239], v[84:87]
    s_add_u32 m0, s73, 117760
    v_mfma_f32_16x16x32_bf16 v[84:87], v[104:107], a[228:231], v[84:87]
    buffer_load_dwordx4 v19, s[44:47], s22 offen offset:0 sc1 lds
    s_waitcnt lgkmcnt(2)
    v_mfma_f32_16x16x32_bf16 v[76:79], v[120:123], v[224:227], v[76:79]
    s_add_u32 m0, s73, 130560
    s_waitcnt vmcnt(11)
    v_bitop3_b32 v43, v43, v47, s68 bitop3:0x7e
    v_bitop3_b32 v43, v43, v51, s68 bitop3:0xf6
    v_cmp_ne_u32 vcc, 0, v43
    v_mfma_f32_16x16x32_bf16 v[76:79], v[124:127], v[232:235], v[76:79]
    buffer_load_dwordx4 v19, s[44:47], s22 offen offset:512 sc1 lds
    s_waitcnt lgkmcnt(0)
    v_mfma_f32_16x16x32_bf16 v[76:79], v[128:131], v[240:243], v[76:79]
    ds_read_b128 v[104:107], v14 offset:51200
    s_cbranch_vccnz L_xs_a
L_xo_a:
    v_and_b32 v89, 0xffff0000, v40
    v_mfma_f32_16x16x32_bf16 v[76:79], v[132:135], v[248:251], v[76:79]
    ds_read_b128 v[108:111], v14 offset:55296
    v_lshlrev_b32 v88, 16, v40
    v_mfma_f32_16x16x32_bf16 v[72:75], v[132:135], v[244:247], v[72:75]
    ds_read_b128 v[112:115], v14 offset:59392
    v_and_b32 v91, 0xffff0000, v41
    v_mfma_f32_16x16x32_bf16 v[72:75], v[128:131], v[236:239], v[72:75]
    ds_read_b128 v[116:119], v14 offset:63488
    v_lshlrev_b32 v90, 16, v41
    v_mfma_f32_16x16x32_bf16 v[72:75], v[124:127], v[228:231], v[72:75]
    s_add_u32 m0, s73, 132096
    v_and_b32 v93, 0xffff0000, v42
    v_lshlrev_b32 v92, 16, v42
    v_mfma_f32_16x16x32_bf16 v[72:75], v[120:123], v[220:223], v[72:75]
    buffer_load_dwordx4 v19, s[44:47], s23 offen offset:0 sc1 lds
    s_waitcnt lgkmcnt(2)
    v_mfma_f32_16x16x32_bf16 v[80:83], v[104:107], v[220:223], v[80:83]
    s_add_u32 m0, s73, 132608
    v_and_b32 v95, 0xffff0000, v44
    v_lshlrev_b32 v94, 16, v44
    v_mfma_f32_16x16x32_bf16 v[80:83], v[108:111], v[228:231], v[80:83]
    buffer_load_dwordx4 v19, s[44:47], s23 offen offset:512 sc1 lds
    v_and_b32 v97, 0xffff0000, v45
    s_waitcnt lgkmcnt(0)
    v_mfma_f32_16x16x32_bf16 v[80:83], v[112:115], v[236:239], v[80:83]
    ds_read_b128 v[120:123], v14 offset:52224
    v_lshlrev_b32 v96, 16, v45
    v_mfma_f32_16x16x32_bf16 v[80:83], v[116:119], v[244:247], v[80:83]
    ds_read_b128 v[124:127], v14 offset:56320
    v_and_b32 v99, 0xffff0000, v46
    v_lshlrev_b32 v98, 16, v46
    v_mfma_f32_16x16x32_bf16 v[84:87], v[116:119], v[248:251], v[84:87]
    ds_read_b128 v[128:131], v14 offset:60416
    s_waitcnt vmcnt(9)
    v_and_b32 v101, 0xffff0000, v48
    v_mfma_f32_16x16x32_bf16 v[84:87], v[112:115], v[240:243], v[84:87]
    ds_read_b128 v[132:135], v14 offset:64512
    v_lshlrev_b32 v100, 16, v48
    v_cmp_ne_u32 vcc, v140, v141
    v_mfma_f32_16x16x32_bf16 v[84:87], v[108:111], v[232:235], v[84:87]
    s_add_u32 m0, s73, 134144
    v_and_b32 v103, 0xffff0000, v49
    v_lshlrev_b32 v102, 16, v49
    v_mfma_f32_16x16x32_bf16 v[84:87], v[104:107], v[224:227], v[84:87]
    buffer_load_dwordx4 v19, s[44:47], s24 offen offset:0 sc1 lds
    s_cbranch_vccnz L_as_b
L_ao_b:
    s_waitcnt lgkmcnt(2)
    v_mfma_f32_16x16x32_bf16 v[92:95], v[120:123], a[4:7], v[92:95]
    buffer_load_dwordx4 v[56:59], v136, s[44:47], s11 offen offset:0 sc1
    v_mfma_f32_16x16x32_bf16 v[92:95], v[124:127], a[12:15], v[92:95]
    s_waitcnt lgkmcnt(0)
    v_mfma_f32_16x16x32_bf16 v[92:95], v[128:131], a[20:23], v[92:95]
    buffer_load_dwordx4 v[60:63], v136, s[44:47], s11 offen offset:1024 sc1
    s_waitcnt vmcnt(10)
    s_barrier
    v_mfma_f32_16x16x32_bf16 v[92:95], v[132:135], a[28:31], v[92:95]
    ds_read_b128 v[104:107], v14 offset:0
    buffer_load_dwordx4 v[64:67], v136, s[44:47], s11 offen offset:2048 sc1
    v_mfma_f32_16x16x32_bf16 v[88:91], v[132:135], a[24:27], v[88:91]
    ds_read_b128 v[108:111], v14 offset:4096
    v_cvt_pk_bf16_f32 v192, v72, v73
    v_mfma_f32_16x16x32_bf16 v[88:91], v[128:131], a[16:19], v[88:91]
    ds_read_b128 v[112:115], v14 offset:8192
    v_cvt_pk_bf16_f32 v193, v74, v75
    v_mfma_f32_16x16x32_bf16 v[88:91], v[124:127], a[8:11], v[88:91]
    ds_read_b128 v[116:119], v14 offset:12288
    v_cvt_pk_bf16_f32 v194, v76, v77
    v_mfma_f32_16x16x32_bf16 v[88:91], v[120:123], a[0:3], v[88:91]
    buffer_store_dwordx4 v[192:195], v136, s[44:47], s31 offen offset:0 sc1
    s_waitcnt lgkmcnt(2)
    v_mfma_f32_16x16x32_bf16 v[96:99], v[104:107], a[0:3], v[96:99]
    s_add_u32 m0, s73, 146944
    v_cvt_pk_bf16_f32 v196, v78, v79
    v_cvt_pk_bf16_f32 v197, v80, v81
    v_mfma_f32_16x16x32_bf16 v[96:99], v[108:111], a[8:11], v[96:99]
    buffer_load_dwordx4 v19, s[44:47], s24 offen offset:512 sc1 lds
    s_waitcnt lgkmcnt(0)
    v_mfma_f32_16x16x32_bf16 v[96:99], v[112:115], a[16:19], v[96:99]
    ds_read_b128 v[120:123], v14 offset:1024
    v_cvt_pk_bf16_f32 v198, v82, v83
    v_mfma_f32_16x16x32_bf16 v[96:99], v[116:119], a[24:27], v[96:99]
    buffer_store_dwordx4 v[196:199], v136, s[44:47], s31 offen offset:1024 sc1
    ds_read_b128 v[124:127], v14 offset:5120
    v_bitop3_b32 v207, v207, v211, s36 bitop3:0x7e
    v_bitop3_b32 v207, v207, v215, s36 bitop3:0xf6
    v_mfma_f32_16x16x32_bf16 v[100:103], v[116:119], a[28:31], v[100:103]
    ds_read_b128 v[128:131], v14 offset:9216
    v_cvt_pk_bf16_f32 v200, v84, v85
    v_mfma_f32_16x16x32_bf16 v[100:103], v[112:115], a[20:23], v[100:103]
    ds_read_b128 v[132:135], v14 offset:13312
    v_cvt_pk_bf16_f32 v201, v86, v87
    v_mfma_f32_16x16x32_bf16 v[100:103], v[108:111], a[12:15], v[100:103]
    buffer_store_dwordx4 v[200:203], v136, s[44:47], s31 offen offset:2048 sc1
    s_add_u32 m0, s73, 148480
    v_bitop3_b32 v207, v207, v219, s36 bitop3:0xf6
    v_cmp_ne_u32 vcc, 0, v207
    v_mfma_f32_16x16x32_bf16 v[100:103], v[104:107], a[4:7], v[100:103]
    buffer_load_dwordx4 v19, s[44:47], s25 offen offset:0 sc1 lds
    s_waitcnt lgkmcnt(2)
    v_mfma_f32_16x16x32_bf16 v[92:95], v[120:123], a[36:39], v[92:95]
    s_add_u32 m0, s73, 148992
    s_cbranch_vccnz L_xs_8
L_xo_8:
    v_mfma_f32_16x16x32_bf16 v[92:95], v[124:127], a[44:47], v[92:95]
    buffer_load_dwordx4 v19, s[44:47], s25 offen offset:512 sc1 lds
    s_waitcnt lgkmcnt(0)
    v_mfma_f32_16x16x32_bf16 v[92:95], v[128:131], a[52:55], v[92:95]
    ds_read_b128 v[104:107], v14 offset:2048
    v_and_b32 v33, 0xffff0000, v204
    v_mfma_f32_16x16x32_bf16 v[92:95], v[132:135], a[60:63], v[92:95]
    ds_read_b128 v[108:111], v14 offset:6144
    v_lshlrev_b32 v32, 16, v204
    v_mfma_f32_16x16x32_bf16 v[88:91], v[132:135], a[56:59], v[88:91]
    ds_read_b128 v[112:115], v14 offset:10240
    v_and_b32 v35, 0xffff0000, v205
    v_mfma_f32_16x16x32_bf16 v[88:91], v[128:131], a[48:51], v[88:91]
    ds_read_b128 v[116:119], v14 offset:14336
    v_mfma_f32_16x16x32_bf16 v[88:91], v[124:127], a[40:43], v[88:91]
    s_add_u32 m0, s73, 150528
    v_lshlrev_b32 v34, 16, v205
    v_mfma_f32_16x16x32_bf16 v[88:91], v[120:123], a[32:35], v[88:91]
    buffer_load_dwordx4 v19, s[44:47], s26 offen offset:0 sc1 lds
    s_waitcnt lgkmcnt(2)
    v_mfma_f32_16x16x32_bf16 v[96:99], v[104:107], a[32:35], v[96:99]
    v_add_f32 v32, v32, v27
    v_mfma_f32_16x16x32_bf16 v[96:99], v[108:111], a[40:43], v[96:99]
    v_add_f32 v33, v33, v27
    s_waitcnt lgkmcnt(0)
    v_mfma_f32_16x16x32_bf16 v[96:99], v[112:115], a[48:51], v[96:99]
    ds_read_b128 v[120:123], v14 offset:3072
    v_add_f32 v34, v34, v27
    v_mfma_f32_16x16x32_bf16 v[96:99], v[116:119], a[56:59], v[96:99]
    ds_read_b128 v[124:127], v14 offset:7168
    v_mfma_f32_16x16x32_bf16 v[100:103], v[116:119], a[60:63], v[100:103]
    ds_read_b128 v[128:131], v14 offset:11264
    v_add_f32 v35, v35, v27
    v_mfma_f32_16x16x32_bf16 v[100:103], v[112:115], a[52:55], v[100:103]
    ds_read_b128 v[132:135], v14 offset:15360
    v_and_b32 v37, 0xffff0000, v208
    v_mfma_f32_16x16x32_bf16 v[100:103], v[108:111], a[44:47], v[100:103]
    v_mfma_f32_16x16x32_bf16 v[100:103], v[104:107], a[36:39], v[100:103]
    v_lshlrev_b32 v36, 16, v208
    s_waitcnt lgkmcnt(2)
    v_mfma_f32_16x16x32_bf16 v[92:95], v[120:123], a[68:71], v[92:95]
    v_and_b32 v39, 0xffff0000, v209
    v_mfma_f32_16x16x32_bf16 v[92:95], v[124:127], a[76:79], v[92:95]
    s_waitcnt lgkmcnt(0)
    v_mfma_f32_16x16x32_bf16 v[92:95], v[128:131], a[84:87], v[92:95]
    s_waitcnt vmcnt(14)
    s_barrier
    v_lshlrev_b32 v38, 16, v209
    v_mfma_f32_16x16x32_bf16 v[92:95], v[132:135], a[92:95], v[92:95]
    ds_read_b128 v[104:107], v14 offset:16384
    v_add_f32 v32, v32, v36
    v_mfma_f32_16x16x32_bf16 v[88:91], v[132:135], a[88:91], v[88:91]
    ds_read_b128 v[108:111], v14 offset:20480
    v_mfma_f32_16x16x32_bf16 v[88:91], v[128:131], a[80:83], v[88:91]
    ds_read_b128 v[112:115], v14 offset:24576
    v_add_f32 v33, v33, v37
    v_mfma_f32_16x16x32_bf16 v[88:91], v[124:127], a[72:75], v[88:91]
    ds_read_b128 v[116:119], v14 offset:28672
    v_add_f32 v34, v34, v38
    v_mfma_f32_16x16x32_bf16 v[88:91], v[120:123], a[64:67], v[88:91]
    s_waitcnt lgkmcnt(2)
    v_mfma_f32_16x16x32_bf16 v[96:99], v[104:107], a[64:67], v[96:99]
    s_add_u32 m0, s73, 97792
    v_add_f32 v35, v35, v39
    v_mfma_f32_16x16x32_bf16 v[96:99], v[108:111], a[72:75], v[96:99]
    buffer_load_dwordx4 v19, s[44:47], s26 offen offset:512 sc1 lds
    s_waitcnt lgkmcnt(0)
    v_mfma_f32_16x16x32_bf16 v[96:99], v[112:115], a[80:83], v[96:99]
    ds_read_b128 v[120:123], v14 offset:17408
    v_and_b32 v37, 0xffff0000, v212
    v_mfma_f32_16x16x32_bf16 v[96:99], v[116:119], a[88:91], v[96:99]
    ds_read_b128 v[124:127], v14 offset:21504
    v_lshlrev_b32 v36, 16, v212
    v_mfma_f32_16x16x32_bf16 v[100:103], v[116:119], a[92:95], v[100:103]
    ds_read_b128 v[128:131], v14 offset:25600
    v_and_b32 v39, 0xffff0000, v213
    v_mfma_f32_16x16x32_bf16 v[100:103], v[112:115], a[84:87], v[100:103]
    ds_read_b128 v[132:135], v14 offset:29696
    v_mfma_f32_16x16x32_bf16 v[100:103], v[108:111], a[76:79], v[100:103]
    v_lshlrev_b32 v38, 16, v213
    v_mfma_f32_16x16x32_bf16 v[100:103], v[104:107], a[68:71], v[100:103]
    v_add_f32 v32, v32, v36
    s_waitcnt lgkmcnt(2)
    v_mfma_f32_16x16x32_bf16 v[92:95], v[120:123], a[100:103], v[92:95]
    v_mfma_f32_16x16x32_bf16 v[92:95], v[124:127], a[108:111], v[92:95]
    v_add_f32 v33, v33, v37
    s_waitcnt lgkmcnt(0)
    v_mfma_f32_16x16x32_bf16 v[92:95], v[128:131], a[116:119], v[92:95]
    ds_read_b128 v[104:107], v14 offset:18432
    v_add_f32 v34, v34, v38
    v_mfma_f32_16x16x32_bf16 v[92:95], v[132:135], a[124:127], v[92:95]
    ds_read_b128 v[108:111], v14 offset:22528
    v_add_f32 v35, v35, v39
    v_mfma_f32_16x16x32_bf16 v[88:91], v[132:135], a[120:123], v[88:91]
    ds_read_b128 v[112:115], v14 offset:26624
    v_and_b32 v37, 0xffff0000, v216
L_pl_D_2:
    s_cbranch_execz L_wret
    v_mfma_f32_16x16x32_bf16 v[88:91], v[128:131], a[112:115], v[88:91]
    ds_read_b128 v[116:119], v14 offset:30720
    v_lshlrev_b32 v36, 16, v216
    v_mfma_f32_16x16x32_bf16 v[88:91], v[124:127], a[104:107], v[88:91]
    v_and_b32 v39, 0xffff0000, v217
    v_lshlrev_b32 v38, 16, v217
    v_mfma_f32_16x16x32_bf16 v[88:91], v[120:123], a[96:99], v[88:91]
    v_add_f32 v32, v32, v36
    s_waitcnt lgkmcnt(2)
    v_mfma_f32_16x16x32_bf16 v[96:99], v[104:107], a[96:99], v[96:99]
    v_add_f32 v33, v33, v37
    v_add_f32 v34, v34, v38
    v_mfma_f32_16x16x32_bf16 v[96:99], v[108:111], a[104:107], v[96:99]
    v_add_f32 v35, v35, v39
    s_waitcnt lgkmcnt(0)
    v_mfma_f32_16x16x32_bf16 v[96:99], v[112:115], a[112:115], v[96:99]
    ds_read_b128 v[120:123], v14 offset:19456
    v_mul_f32 v36, s38, v32
    v_mfma_f32_16x16x32_bf16 v[96:99], v[116:119], a[120:123], v[96:99]
    ds_read_b128 v[124:127], v14 offset:23552
    v_mul_f32 v37, s38, v33
    v_mfma_f32_16x16x32_bf16 v[100:103], v[116:119], a[124:127], v[100:103]
    ds_read_b128 v[128:131], v14 offset:27648
    v_mul_f32 v38, s38, v34
    v_mfma_f32_16x16x32_bf16 v[100:103], v[112:115], a[116:119], v[100:103]
    ds_read_b128 v[132:135], v14 offset:31744
    v_mul_f32 v39, s38, v35
    v_mfma_f32_16x16x32_bf16 v[100:103], v[108:111], a[108:111], v[100:103]
    v_exp_f32 v36, v36
    v_mfma_f32_16x16x32_bf16 v[100:103], v[104:107], a[100:103], v[100:103]
    s_waitcnt lgkmcnt(2)
    v_mfma_f32_16x16x32_bf16 v[92:95], v[120:123], a[132:135], v[92:95]
    v_exp_f32 v37, v37
    v_mfma_f32_16x16x32_bf16 v[92:95], v[124:127], a[140:143], v[92:95]
    s_waitcnt lgkmcnt(0)
    v_mfma_f32_16x16x32_bf16 v[92:95], v[128:131], a[148:151], v[92:95]
    s_waitcnt vmcnt(11)
    s_barrier
    v_mfma_f32_16x16x32_bf16 v[92:95], v[132:135], a[156:159], v[92:95]
    ds_read_b128 v[104:107], v14 offset:32768
    v_mfma_f32_16x16x32_bf16 v[88:91], v[132:135], a[152:155], v[88:91]
    ds_read_b128 v[108:111], v14 offset:36864
    v_exp_f32 v38, v38
    v_mfma_f32_16x16x32_bf16 v[88:91], v[128:131], a[144:147], v[88:91]
    ds_read_b128 v[112:115], v14 offset:40960
    v_exp_f32 v39, v39
    v_mfma_f32_16x16x32_bf16 v[88:91], v[124:127], a[136:139], v[88:91]
    ds_read_b128 v[116:119], v14 offset:45056
    v_mul_f32 v180, v180, v32
    v_mfma_f32_16x16x32_bf16 v[88:91], v[120:123], a[128:131], v[88:91]
    v_mul_f32 v181, v181, v33
    s_waitcnt lgkmcnt(2)
    v_mfma_f32_16x16x32_bf16 v[96:99], v[104:107], a[128:131], v[96:99]
    v_mul_f32 v182, v182, v34
    v_mul_f32 v183, v183, v35
    v_mfma_f32_16x16x32_bf16 v[96:99], v[108:111], a[136:139], v[96:99]
    v_add_f32 v36, 1.0, v36
    s_waitcnt lgkmcnt(0)
    v_mfma_f32_16x16x32_bf16 v[96:99], v[112:115], a[144:147], v[96:99]
    ds_read_b128 v[120:123], v14 offset:33792
    v_add_f32 v37, 1.0, v37
    v_mfma_f32_16x16x32_bf16 v[96:99], v[116:119], a[152:155], v[96:99]
    ds_read_b128 v[124:127], v14 offset:37888
    v_add_f32 v38, 1.0, v38
    v_mfma_f32_16x16x32_bf16 v[100:103], v[116:119], a[156:159], v[100:103]
    ds_read_b128 v[128:131], v14 offset:41984
    v_add_f32 v39, 1.0, v39
    v_mfma_f32_16x16x32_bf16 v[100:103], v[112:115], a[148:151], v[100:103]
    ds_read_b128 v[132:135], v14 offset:46080
    v_rcp_f32 v36, v36
    v_mfma_f32_16x16x32_bf16 v[100:103], v[108:111], a[140:143], v[100:103]
    v_rcp_f32 v37, v37
    v_mfma_f32_16x16x32_bf16 v[100:103], v[104:107], a[132:135], v[100:103]
    v_rcp_f32 v38, v38
    s_waitcnt lgkmcnt(2)
    v_mfma_f32_16x16x32_bf16 v[92:95], v[120:123], a[164:167], v[92:95]
    s_waitcnt vmcnt(8)
    v_bitop3_b32 v59, v59, v63, s68 bitop3:0x7e
    v_rcp_f32 v39, v39
    v_mfma_f32_16x16x32_bf16 v[92:95], v[124:127], a[172:175], v[92:95]
    buffer_load_dwordx4 v[72:75], v136, s[44:47], s12 offen offset:0 sc1
    s_waitcnt lgkmcnt(0)
    v_mfma_f32_16x16x32_bf16 v[92:95], v[128:131], a[180:183], v[92:95]
    ds_read_b128 v[104:107], v14 offset:34816
    v_bitop3_b32 v59, v59, v67, s68 bitop3:0xf6
    v_mfma_f32_16x16x32_bf16 v[92:95], v[132:135], a[188:191], v[92:95]
    ds_read_b128 v[108:111], v14 offset:38912
    v_cmp_ne_u32 vcc, 0, v59
    v_mfma_f32_16x16x32_bf16 v[88:91], v[132:135], a[184:187], v[88:91]
    ds_read_b128 v[112:115], v14 offset:43008
    buffer_load_dwordx4 v[76:79], v136, s[44:47], s12 offen offset:1024 sc1
    v_mfma_f32_16x16x32_bf16 v[88:91], v[128:131], a[176:179], v[88:91]
    ds_read_b128 v[116:119], v14 offset:47104
    s_cbranch_vccnz L_xs_b
L_xo_b:
    v_fma_f32 v180, v180, v36, v160
    v_mfma_f32_16x16x32_bf16 v[88:91], v[124:127], a[168:171], v[88:91]
    buffer_load_dwordx4 v[80:83], v136, s[44:47], s12 offen offset:2048 sc1
    v_and_b32 v41, 0xffff0000, v56
    v_mfma_f32_16x16x32_bf16 v[88:91], v[120:123], a[160:163], v[88:91]
    v_lshlrev_b32 v40, 16, v56
    s_waitcnt lgkmcnt(2)
    v_mfma_f32_16x16x32_bf16 v[96:99], v[104:107], a[160:163], v[96:99]
    v_and_b32 v43, 0xffff0000, v57
    v_fma_f32 v181, v181, v37, v161
    v_mfma_f32_16x16x32_bf16 v[96:99], v[108:111], a[168:171], v[96:99]
    v_lshlrev_b32 v42, 16, v57
    s_waitcnt lgkmcnt(0)
    v_mfma_f32_16x16x32_bf16 v[96:99], v[112:115], a[176:179], v[96:99]
    ds_read_b128 v[120:123], v14 offset:35840
    v_and_b32 v45, 0xffff0000, v58
    v_mfma_f32_16x16x32_bf16 v[96:99], v[116:119], a[184:187], v[96:99]
    ds_read_b128 v[124:127], v14 offset:39936
    v_fma_f32 v182, v182, v38, v162
    v_mfma_f32_16x16x32_bf16 v[100:103], v[116:119], a[188:191], v[100:103]
    ds_read_b128 v[128:131], v14 offset:44032
    v_lshlrev_b32 v44, 16, v58
    v_mfma_f32_16x16x32_bf16 v[100:103], v[112:115], a[180:183], v[100:103]
    ds_read_b128 v[132:135], v14 offset:48128
    v_and_b32 v47, 0xffff0000, v60
    v_mfma_f32_16x16x32_bf16 v[100:103], v[108:111], a[172:175], v[100:103]
    v_lshlrev_b32 v46, 16, v60
    v_fma_f32 v183, v183, v39, v163
    v_mfma_f32_16x16x32_bf16 v[100:103], v[104:107], a[164:167], v[100:103]
    v_and_b32 v49, 0xffff0000, v61
    s_waitcnt lgkmcnt(2)
    v_mfma_f32_16x16x32_bf16 v[92:95], v[120:123], a[196:199], v[92:95]
    v_lshlrev_b32 v48, 16, v61
    v_cvt_pk_bf16_f32 v142, v180, v181
    v_mfma_f32_16x16x32_bf16 v[92:95], v[124:127], a[204:207], v[92:95]
    v_and_b32 v51, 0xffff0000, v62
    s_waitcnt lgkmcnt(0)
    v_mfma_f32_16x16x32_bf16 v[92:95], v[128:131], a[212:215], v[92:95]
    s_waitcnt vmcnt(4)
    s_barrier
    v_lshlrev_b32 v50, 16, v62
    v_mfma_f32_16x16x32_bf16 v[92:95], v[132:135], a[220:223], v[92:95]
    ds_read_b128 v[104:107], v14 offset:49152
    v_cvt_pk_bf16_f32 v143, v182, v183
    v_mfma_f32_16x16x32_bf16 v[88:91], v[132:135], a[216:219], v[88:91]
    ds_read_b128 v[108:111], v14 offset:53248
    v_and_b32 v53, 0xffff0000, v64
    v_mfma_f32_16x16x32_bf16 v[88:91], v[128:131], a[208:211], v[88:91]
    ds_read_b128 v[112:115], v14 offset:57344
    v_lshlrev_b32 v52, 16, v64
    v_mfma_f32_16x16x32_bf16 v[88:91], v[124:127], a[200:203], v[88:91]
    ds_read_b128 v[116:119], v14 offset:61440
    v_and_b32 v55, 0xffff0000, v65
    v_mfma_f32_16x16x32_bf16 v[88:91], v[120:123], a[192:195], v[88:91]
    v_lshlrev_b32 v54, 16, v65
    s_waitcnt lgkmcnt(2)
    v_mfma_f32_16x16x32_bf16 v[96:99], v[104:107], a[192:195], v[96:99]
    v_mfma_f32_16x16x32_bf16 v[96:99], v[108:111], a[200:203], v[96:99]
    s_waitcnt lgkmcnt(0)
    v_mfma_f32_16x16x32_bf16 v[96:99], v[112:115], a[208:211], v[96:99]
    ds_read_b128 v[120:123], v14 offset:50176
    v_add_f32 v92, v92, v44
    v_add_f32 v93, v93, v45
    v_mfma_f32_16x16x32_bf16 v[96:99], v[116:119], a[216:219], v[96:99]
    ds_read_b128 v[124:127], v14 offset:54272
    v_add_f32 v94, v94, v46
    v_mfma_f32_16x16x32_bf16 v[100:103], v[116:119], a[220:223], v[100:103]
    ds_read_b128 v[128:131], v14 offset:58368
    v_add_f32 v95, v95, v47
    v_add_f32 v88, v88, v40
    v_mfma_f32_16x16x32_bf16 v[100:103], v[112:115], a[212:215], v[100:103]
    ds_read_b128 v[132:135], v14 offset:62464
    v_add_f32 v89, v89, v41
    v_mfma_f32_16x16x32_bf16 v[100:103], v[108:111], a[204:207], v[100:103]
    v_add_f32 v90, v90, v42
    v_add_f32 v91, v91, v43
    v_mfma_f32_16x16x32_bf16 v[100:103], v[104:107], a[196:199], v[100:103]
    s_waitcnt lgkmcnt(2)
    v_mfma_f32_16x16x32_bf16 v[92:95], v[120:123], a[228:231], v[92:95]
    v_mfma_f32_16x16x32_bf16 v[92:95], v[124:127], a[236:239], v[92:95]
    s_waitcnt lgkmcnt(0)
    v_mfma_f32_16x16x32_bf16 v[92:95], v[128:131], a[244:247], v[92:95]
    ds_read_b128 v[104:107], v14 offset:51200
    v_add_f32 v96, v96, v48
    v_add_f32 v97, v97, v49
    v_mfma_f32_16x16x32_bf16 v[92:95], v[132:135], a[252:255], v[92:95]
    ds_read_b128 v[108:111], v14 offset:55296
    v_add_f32 v98, v98, v50
    v_mfma_f32_16x16x32_bf16 v[88:91], v[132:135], a[248:251], v[88:91]
    ds_read_b128 v[112:115], v14 offset:59392
    v_add_f32 v99, v99, v51
    v_add_f32 v100, v100, v52
    v_mfma_f32_16x16x32_bf16 v[88:91], v[128:131], a[240:243], v[88:91]
    ds_read_b128 v[116:119], v14 offset:63488
    v_add_f32 v101, v101, v53
    v_mfma_f32_16x16x32_bf16 v[88:91], v[124:127], a[232:235], v[88:91]
    v_add_f32 v102, v102, v54
    v_add_f32 v103, v103, v55
    v_mfma_f32_16x16x32_bf16 v[88:91], v[120:123], a[224:227], v[88:91]
    s_waitcnt lgkmcnt(2)
    v_mfma_f32_16x16x32_bf16 v[96:99], v[104:107], a[224:227], v[96:99]
    v_mfma_f32_16x16x32_bf16 v[96:99], v[108:111], a[232:235], v[96:99]
    s_waitcnt lgkmcnt(0)
    v_mfma_f32_16x16x32_bf16 v[96:99], v[112:115], a[240:243], v[96:99]
    ds_read_b128 v[120:123], v14 offset:52224
    v_mfma_f32_16x16x32_bf16 v[96:99], v[116:119], a[248:251], v[96:99]
    ds_read_b128 v[124:127], v14 offset:56320
    v_mfma_f32_16x16x32_bf16 v[100:103], v[116:119], a[252:255], v[100:103]
    buffer_store_dwordx2 v[142:143], v253, s[64:67], 0 offen sc1
    ds_read_b128 v[128:131], v14 offset:60416
    v_mfma_f32_16x16x32_bf16 v[100:103], v[112:115], a[244:247], v[100:103]
    ds_read_b128 v[132:135], v14 offset:64512
    v_mfma_f32_16x16x32_bf16 v[100:103], v[108:111], a[236:239], v[100:103]
    v_mfma_f32_16x16x32_bf16 v[100:103], v[104:107], a[228:231], v[100:103]
    s_waitcnt lgkmcnt(2)
    v_mfma_f32_16x16x32_bf16 v[92:95], v[120:123], v[224:227], v[92:95]
    v_mfma_f32_16x16x32_bf16 v[92:95], v[124:127], v[232:235], v[92:95]
    s_waitcnt lgkmcnt(0)
    v_mfma_f32_16x16x32_bf16 v[92:95], v[128:131], v[240:243], v[92:95]
    s_waitcnt vmcnt(4)
    s_barrier
    v_mfma_f32_16x16x32_bf16 v[92:95], v[132:135], v[248:251], v[92:95]
    ds_read_b128 v[104:107], v14 offset:0
    v_mfma_f32_16x16x32_bf16 v[88:91], v[132:135], v[244:247], v[88:91]
    ds_read_b128 v[108:111], v14 offset:4096
    v_mfma_f32_16x16x32_bf16 v[88:91], v[128:131], v[236:239], v[88:91]
    ds_read_b128 v[112:115], v14 offset:8192
    v_mfma_f32_16x16x32_bf16 v[88:91], v[124:127], v[228:231], v[88:91]
    ds_read_b128 v[116:119], v14 offset:12288
    v_mfma_f32_16x16x32_bf16 v[88:91], v[120:123], v[220:223], v[88:91]
    s_waitcnt lgkmcnt(2)
    v_mfma_f32_16x16x32_bf16 v[96:99], v[104:107], v[220:223], v[96:99]
    v_mfma_f32_16x16x32_bf16 v[96:99], v[108:111], v[228:231], v[96:99]
    s_waitcnt lgkmcnt(0)
    v_mfma_f32_16x16x32_bf16 v[96:99], v[112:115], v[236:239], v[96:99]
    v_mfma_f32_16x16x32_bf16 v[96:99], v[116:119], v[244:247], v[96:99]
    v_mfma_f32_16x16x32_bf16 v[100:103], v[116:119], v[248:251], v[100:103]
    v_mfma_f32_16x16x32_bf16 v[100:103], v[112:115], v[240:243], v[100:103]
    v_mfma_f32_16x16x32_bf16 v[100:103], v[108:111], v[232:235], v[100:103]
    v_mfma_f32_16x16x32_bf16 v[100:103], v[104:107], v[224:227], v[100:103]
    s_waitcnt vmcnt(1)
    v_bitop3_b32 v75, v75, v79, s68 bitop3:0x7e
    v_bitop3_b32 v75, v75, v83, s68 bitop3:0xf6
    v_cmp_ne_u32 vcc, 0, v75
    s_cbranch_vccnz L_xs_z
L_xo_z:
    v_and_b32 v41, 0xffff0000, v72
    v_lshlrev_b32 v40, 16, v72
    v_and_b32 v43, 0xffff0000, v73
    v_lshlrev_b32 v42, 16, v73
    v_and_b32 v45, 0xffff0000, v74
    v_lshlrev_b32 v44, 16, v74
    v_and_b32 v47, 0xffff0000, v76
    v_lshlrev_b32 v46, 16, v76
    v_and_b32 v49, 0xffff0000, v77
    v_lshlrev_b32 v48, 16, v77
    v_and_b32 v51, 0xffff0000, v78
    v_lshlrev_b32 v50, 16, v78
    v_and_b32 v53, 0xffff0000, v80
    v_lshlrev_b32 v52, 16, v80
    v_and_b32 v55, 0xffff0000, v81
    v_lshlrev_b32 v54, 16, v81
    v_pk_add_f32 v[88:89], v[88:89], v[40:41]
    v_pk_add_f32 v[90:91], v[90:91], v[42:43]
    v_pk_add_f32 v[96:97], v[96:97], v[48:49]
    v_pk_add_f32 v[98:99], v[98:99], v[50:51]
    v_pk_mul_f32 v[56:57], v[88:89], s[38:39] op_sel_hi:[1,0]
    v_pk_mul_f32 v[58:59], v[90:91], s[38:39] op_sel_hi:[1,0]
    v_pk_mul_f32 v[64:65], v[96:97], s[38:39] op_sel_hi:[1,0]
    v_pk_mul_f32 v[66:67], v[98:99], s[38:39] op_sel_hi:[1,0]
    v_exp_f32 v56, v56
    v_exp_f32 v57, v57
    v_exp_f32 v58, v58
    v_exp_f32 v59, v59
    v_exp_f32 v64, v64
    v_exp_f32 v65, v65
    v_exp_f32 v66, v66
    v_exp_f32 v67, v67
    v_pk_mul_f32 v[164:165], v[164:165], v[88:89]
    v_pk_mul_f32 v[166:167], v[166:167], v[90:91]
    v_pk_mul_f32 v[172:173], v[172:173], v[96:97]
    v_pk_mul_f32 v[174:175], v[174:175], v[98:99]
    v_pk_add_f32 v[56:57], v[56:57], 1.0 op_sel_hi:[1,0]
    v_pk_add_f32 v[58:59], v[58:59], 1.0 op_sel_hi:[1,0]
    v_pk_add_f32 v[64:65], v[64:65], 1.0 op_sel_hi:[1,0]
    v_pk_add_f32 v[66:67], v[66:67], 1.0 op_sel_hi:[1,0]
    v_rcp_f32 v56, v56
    v_rcp_f32 v57, v57
    v_rcp_f32 v58, v58
    v_rcp_f32 v59, v59
    v_rcp_f32 v64, v64
    v_rcp_f32 v65, v65
    v_rcp_f32 v66, v66
    v_rcp_f32 v67, v67
    v_pk_fma_f32 v[164:165], v[164:165], v[56:57], v[144:145]
    v_pk_fma_f32 v[166:167], v[166:167], v[58:59], v[146:147]
    v_pk_fma_f32 v[172:173], v[172:173], v[64:65], v[152:153]
    v_pk_fma_f32 v[174:175], v[174:175], v[66:67], v[154:155]
    v_cvt_pk_bf16_f32 v88, v164, v165
    v_cvt_pk_bf16_f32 v90, v172, v173
    v_cvt_pk_bf16_f32 v89, v166, v167
    v_cvt_pk_bf16_f32 v91, v174, v175
    v_permlane16_swap_b32 v88, v90
    s_nop 0
    v_permlane16_swap_b32 v89, v91
    buffer_store_dwordx4 v[88:91], v252, s[64:67], 0 offen sc1
    v_pk_add_f32 v[92:93], v[92:93], v[44:45]
    v_pk_add_f32 v[94:95], v[94:95], v[46:47]
    v_pk_add_f32 v[100:101], v[100:101], v[52:53]
    v_pk_add_f32 v[102:103], v[102:103], v[54:55]
    v_pk_mul_f32 v[60:61], v[92:93], s[38:39] op_sel_hi:[1,0]
    v_pk_mul_f32 v[62:63], v[94:95], s[38:39] op_sel_hi:[1,0]
    v_pk_mul_f32 v[68:69], v[100:101], s[38:39] op_sel_hi:[1,0]
    v_pk_mul_f32 v[70:71], v[102:103], s[38:39] op_sel_hi:[1,0]
    v_exp_f32 v60, v60
    v_exp_f32 v61, v61
    v_exp_f32 v62, v62
    v_exp_f32 v63, v63
    v_exp_f32 v68, v68
    v_exp_f32 v69, v69
    v_exp_f32 v70, v70
    v_exp_f32 v71, v71
    v_pk_mul_f32 v[168:169], v[168:169], v[92:93]
    v_pk_mul_f32 v[170:171], v[170:171], v[94:95]
    v_pk_mul_f32 v[176:177], v[176:177], v[100:101]
    v_pk_mul_f32 v[178:179], v[178:179], v[102:103]
    v_pk_add_f32 v[60:61], v[60:61], 1.0 op_sel_hi:[1,0]
    v_pk_add_f32 v[62:63], v[62:63], 1.0 op_sel_hi:[1,0]
    v_pk_add_f32 v[68:69], v[68:69], 1.0 op_sel_hi:[1,0]
    v_pk_add_f32 v[70:71], v[70:71], 1.0 op_sel_hi:[1,0]
    v_rcp_f32 v60, v60
    v_rcp_f32 v61, v61
    v_rcp_f32 v62, v62
    v_rcp_f32 v63, v63
    v_rcp_f32 v68, v68
    v_rcp_f32 v69, v69
    v_rcp_f32 v70, v70
    v_rcp_f32 v71, v71
    v_pk_fma_f32 v[168:169], v[168:169], v[60:61], v[148:149]
    v_pk_fma_f32 v[170:171], v[170:171], v[62:63], v[150:151]
    v_pk_fma_f32 v[176:177], v[176:177], v[68:69], v[156:157]
    v_pk_fma_f32 v[178:179], v[178:179], v[70:71], v[158:159]
    v_cvt_pk_bf16_f32 v92, v168, v169
    v_cvt_pk_bf16_f32 v94, v176, v177
    v_cvt_pk_bf16_f32 v93, v170, v171
    v_cvt_pk_bf16_f32 v95, v178, v179
    v_permlane16_swap_b32 v92, v94
    s_nop 0
    v_permlane16_swap_b32 v93, v95
    buffer_store_dwordx4 v[92:95], v252, s[64:67], s40 offen sc1
    s_endpgm
L_segE:
.p2align 12
L_aux:
    s_mul_i32 s84, s101, 14
    s_lshr_b32 s84, s84, 2
    s_add_u32 s84, s84, 0
    s_add_u32 s85, s84, 1
    s_cmp_eq_u32 s85, 14
    s_cselect_b32 s85, 0, s85
    s_add_u32 s86, s85, 1
    s_cmp_eq_u32 s86, 14
    s_cselect_b32 s86, 0, s86
    s_add_u32 s87, s86, 1
    s_cmp_eq_u32 s87, 14
    s_cselect_b32 s87, 0, s87
    s_add_u32 s88, s87, 1
    s_cmp_eq_u32 s88, 14
    s_cselect_b32 s88, 0, s88
    s_add_u32 s89, s88, 1
    s_cmp_eq_u32 s89, 14
    s_cselect_b32 s89, 0, s89
    s_add_u32 s90, s89, 1
    s_cmp_eq_u32 s90, 14
    s_cselect_b32 s90, 0, s90
    s_add_u32 s91, s90, 1
    s_cmp_eq_u32 s91, 14
    s_cselect_b32 s91, 0, s91
    s_add_u32 s92, s91, 1
    s_cmp_eq_u32 s92, 14
    s_cselect_b32 s92, 0, s92
    s_add_u32 s93, s92, 1
    s_cmp_eq_u32 s93, 14
    s_cselect_b32 s93, 0, s93
    s_add_u32 s94, s93, 1
    s_cmp_eq_u32 s94, 14
    s_cselect_b32 s94, 0, s94
    s_add_u32 s95, s94, 1
    s_cmp_eq_u32 s95, 14
    s_cselect_b32 s95, 0, s95
    s_add_u32 s96, s95, 1
    s_cmp_eq_u32 s96, 14
    s_cselect_b32 s96, 0, s96
    s_add_u32 s97, s96, 1
    s_cmp_eq_u32 s97, 14
    s_cselect_b32 s97, 0, s97
    s_mul_i32 s98, s101, 4
    s_lshr_b32 s98, s98, 2
    s_add_u32 s98, s98, 14
    s_add_u32 s99, s98, 1
    s_cmp_eq_u32 s99, 18
    s_cselect_b32 s99, 14, s99
    s_add_u32 s100, s99, 1
    s_cmp_eq_u32 s100, 18
    s_cselect_b32 s100, 14, s100
    s_add_u32 s101, s100, 1
    s_cmp_eq_u32 s101, 18
    s_cselect_b32 s101, 14, s101
    s_lshl2_add_u32 s7, s5, s6
    s_add_u32 s7, s7, 188
    s_add_u32 s8, s5, 248
    s_cmp_eq_u32 s6, 27
    s_cselect_b32 s75, s8, s7
    s_mov_b32 s48, s24
    s_and_b32 s49, s25, 0xffff
    s_mov_b32 s50, 2359296
    s_mov_b32 s51, 0x20000
    v_lshlrev_b32 v240, 4, v2
    s_mul_i32 s74, s3, 16640
    s_add_u32 s74, s74, 73728
    s_sub_u32 s69, s75, 216
    s_lshl_b32 s70, s69, 4
    s_add_u32 s70, s70, s3
    s_lshl_b32 s12, s70, 12
    s_lshl_b32 s70, s70, 1
    s_mov_b32 s9, 144896
    s_mov_b32 s11, 8192
    v_mul_u32_u24 v48, 1216, v3
    v_mad_u32_u24 v48, v4, 12, v48
    v_add_u32 v48, s9, v48
    v_mov_b32 v47, 0x40000000
    v_lshlrev_b32 v3, 3, v3
    s_lshl_b32 s5, s68, 6
    s_add_u32 s5, s5, 12386304
    v_cmp_eq_u32 vcc, 0, v4
    s_nop 1
    v_cndmask_b32 v49, v47, v3, vcc
    v_lshrrev_b32 v5, 4, v0
    v_and_b32 v4, 3, v2
    v_lshlrev_b32 v4, 3, v4
    v_lshl_add_u32 v5, v5, 5, v4
    v_bfe_u32 v6, v2, 2, 2
    v_mul_u32_u24 v4, 1216, v6
    v_mul_u32_u24 v6, 1152, v6
    v_add3_u32 v50, v4, v5, s9
    v_add3_u32 v51, v6, v5, s11
    s_mul_i32 s4, s3, 2176
    v_add_u32 v55, s4, v51
    v_lshlrev_b32 v52, 4, v0
    s_add_u32 s7, s15, 4096
    s_add_u32 s8, s15, 8192
    s_cmp_eq_u32 s3, 0
    s_cselect_b32 s8, s8, 0x40000000
    v_add_u32 v53, 2359296, v52
    v_mov_b32 v54, 0
    s_mul_i32 s4, s3, 1028
    s_sub_u32 s4, 8204, s4
    v_add_u32 v90, s4, v53
    s_bfe_u32 s6, s68, 0x20001
    s_lshl_b32 s6, s6, 6
    s_lshr_b32 s9, s68, 3
    s_lshl1_add_u32 s6, s9, s6
    s_and_b32 s9, s68, 1
    s_add_u32 s6, s6, s9
    s_lshl_b32 s4, s6, 2
    s_add_u32 s4, s4, 12533760
    v_lshl_add_u32 v1, v0, 10, s4
    s_lshl_b32 s4, s68, 2
    s_add_u32 s4, s4, 12599296
    v_lshl_add_u32 v46, v0, 10, s4
    v_cmp_gt_u32 vcc, 8, v0
    s_nop 1
    v_cndmask_b32 v1, v47, v1, vcc
    v_cmp_gt_u32 vcc, 4, v0
    s_nop 1
    v_cndmask_b32 v46, v47, v46, vcc
    s_waitcnt vmcnt(9)
    v_and_b32 v21, 0xffff0000, v8
    v_lshlrev_b32 v20, 16, v8
    v_and_b32 v23, 0xffff0000, v9
    v_lshlrev_b32 v22, 16, v9
    v_and_b32 v25, 0xffff0000, v10
    v_lshlrev_b32 v24, 16, v10
    v_and_b32 v27, 0xffff0000, v12
    v_lshlrev_b32 v26, 16, v12
    v_and_b32 v29, 0xffff0000, v13
    v_lshlrev_b32 v28, 16, v13
    v_and_b32 v31, 0xffff0000, v14
    v_lshlrev_b32 v30, 16, v14
    v_and_b32 v33, 0xffff0000, v16
    v_lshlrev_b32 v32, 16, v16
    v_and_b32 v35, 0xffff0000, v17
    v_lshlrev_b32 v34, 16, v17
    v_and_b32 v37, 0xffff0000, v18
    v_lshlrev_b32 v36, 16, v18
    v_pk_add_f32 v[38:39], v[20:21], v[22:23]
    v_pk_add_f32 v[40:41], v[24:25], v[26:27]
    v_pk_add_f32 v[42:43], v[28:29], v[30:31]
    v_pk_add_f32 v[44:45], v[32:33], v[34:35]
    v_pk_add_f32 v[38:39], v[38:39], v[40:41]
    v_pk_add_f32 v[42:43], v[42:43], v[44:45]
    v_pk_add_f32 v[38:39], v[38:39], v[36:37]
    v_pk_add_f32 v[38:39], v[38:39], v[42:43]
    v_add_f32 v56, v38, v39
    s_nop 1
    v_add_f32_dpp v56, v56, v56 row_ror:8 row_mask:0xf bank_mask:0xf
    s_nop 1
    v_add_f32_dpp v56, v56, v56 row_ror:4 row_mask:0xf bank_mask:0xf
    s_nop 1
    v_add_f32_dpp v56, v56, v56 row_ror:2 row_mask:0xf bank_mask:0xf
    s_nop 1
    v_add_f32_dpp v56, v56, v56 row_ror:1 row_mask:0xf bank_mask:0xf
    v_mov_b32 v57, v56
    s_nop 1
    v_permlane16_swap_b32 v56, v57
    v_add_f32 v56, v56, v57
    v_mul_f32 v56, 0x3ae38e39, v56
    v_pk_add_f32 v[20:21], v[20:21], v[56:57] op_sel_hi:[1,0] neg_lo:[0,1] neg_hi:[0,1]
    v_pk_add_f32 v[22:23], v[22:23], v[56:57] op_sel_hi:[1,0] neg_lo:[0,1] neg_hi:[0,1]
    v_pk_add_f32 v[24:25], v[24:25], v[56:57] op_sel_hi:[1,0] neg_lo:[0,1] neg_hi:[0,1]
    v_pk_add_f32 v[26:27], v[26:27], v[56:57] op_sel_hi:[1,0] neg_lo:[0,1] neg_hi:[0,1]
    v_pk_add_f32 v[28:29], v[28:29], v[56:57] op_sel_hi:[1,0] neg_lo:[0,1] neg_hi:[0,1]
    v_pk_add_f32 v[30:31], v[30:31], v[56:57] op_sel_hi:[1,0] neg_lo:[0,1] neg_hi:[0,1]
    v_pk_add_f32 v[32:33], v[32:33], v[56:57] op_sel_hi:[1,0] neg_lo:[0,1] neg_hi:[0,1]
    v_pk_add_f32 v[34:35], v[34:35], v[56:57] op_sel_hi:[1,0] neg_lo:[0,1] neg_hi:[0,1]
    v_pk_add_f32 v[36:37], v[36:37], v[56:57] op_sel_hi:[1,0] neg_lo:[0,1] neg_hi:[0,1]
    v_pk_mul_f32 v[38:39], v[20:21], v[20:21]
    v_pk_mul_f32 v[40:41], v[22:23], v[22:23]
    v_pk_fma_f32 v[38:39], v[24:25], v[24:25], v[38:39]
    v_pk_fma_f32 v[40:41], v[26:27], v[26:27], v[40:41]
    v_pk_fma_f32 v[38:39], v[28:29], v[28:29], v[38:39]
    v_pk_fma_f32 v[40:41], v[30:31], v[30:31], v[40:41]
    v_pk_fma_f32 v[38:39], v[32:33], v[32:33], v[38:39]
    v_pk_fma_f32 v[40:41], v[34:35], v[34:35], v[40:41]
    v_pk_fma_f32 v[38:39], v[36:37], v[36:37], v[38:39]
    v_pk_add_f32 v[38:39], v[38:39], v[40:41]
    v_add_f32 v18, v38, v39
    s_nop 1
    v_add_f32_dpp v18, v18, v18 row_ror:8 row_mask:0xf bank_mask:0xf
    s_nop 1
    v_add_f32_dpp v18, v18, v18 row_ror:4 row_mask:0xf bank_mask:0xf
    s_nop 1
    v_add_f32_dpp v18, v18, v18 row_ror:2 row_mask:0xf bank_mask:0xf
    s_nop 1
    v_add_f32_dpp v18, v18, v18 row_ror:1 row_mask:0xf bank_mask:0xf
    v_mov_b32 v19, v18
    s_nop 1
    v_permlane16_swap_b32 v18, v19
    v_add_f32 v18, v18, v19
    v_mul_f32 v18, 0x3ae38e39, v18
    v_cvt_pk_bf16_f32 v38, v56, v18
    v_lshlrev_b32 v106, 16, v38
    v_and_b32 v38, 0xffff0000, v38
    v_add_f32 v38, 0x3727c5ac, v38
    v_sub_f32 v56, v56, v106
    v_cvt_pk_bf16_f32 v38, v38, v38
    v_lshlrev_b32 v38, 16, v38
    v_sqrt_f32 v38, v38
    s_nop 0
    v_cvt_pk_bf16_f32 v38, v38, v38
    v_lshlrev_b32 v38, 16, v38
    v_rcp_f32 v107, v38
    s_nop 0
    v_mul_f32 v56, v56, v107
    v_mul_f32 v18, v18, v107
    v_mul_f32 v18, v18, v107
    v_cvt_pk_bf16_f32 v38, v56, v18
    v_lshlrev_b32 v39, 16, v38
    v_and_b32 v38, 0xffff0000, v38
    v_add_f32 v38, 0x3727c5ac, v38
    v_sub_f32 v56, v56, v39
    v_cvt_pk_bf16_f32 v38, v38, v38
    v_lshlrev_b32 v38, 16, v38
    v_sqrt_f32 v38, v38
    s_nop 0
    v_cvt_pk_bf16_f32 v38, v38, v38
    v_lshlrev_b32 v38, 16, v38
    v_rcp_f32 v38, v38
    s_nop 0
    v_mul_f32 v18, v107, v38
    v_mul_f32 v56, v56, v38
    v_pk_fma_f32 v[20:21], v[20:21], v[18:19], v[56:57] op_sel_hi:[1,0,0]
    v_pk_fma_f32 v[22:23], v[22:23], v[18:19], v[56:57] op_sel_hi:[1,0,0]
    v_pk_fma_f32 v[24:25], v[24:25], v[18:19], v[56:57] op_sel_hi:[1,0,0]
    v_pk_fma_f32 v[26:27], v[26:27], v[18:19], v[56:57] op_sel_hi:[1,0,0]
    v_pk_fma_f32 v[28:29], v[28:29], v[18:19], v[56:57] op_sel_hi:[1,0,0]
    v_pk_fma_f32 v[30:31], v[30:31], v[18:19], v[56:57] op_sel_hi:[1,0,0]
    v_pk_fma_f32 v[32:33], v[32:33], v[18:19], v[56:57] op_sel_hi:[1,0,0]
    v_pk_fma_f32 v[34:35], v[34:35], v[18:19], v[56:57] op_sel_hi:[1,0,0]
    v_pk_fma_f32 v[36:37], v[36:37], v[18:19], v[56:57] op_sel_hi:[1,0,0]
    v_cvt_pk_bf16_f32 v8, v20, v21
    v_cvt_pk_bf16_f32 v9, v22, v23
    v_cvt_pk_bf16_f32 v10, v24, v25
    v_cvt_pk_bf16_f32 v11, v26, v27
    v_cvt_pk_bf16_f32 v12, v28, v29
    v_cvt_pk_bf16_f32 v13, v30, v31
    v_cvt_pk_bf16_f32 v14, v32, v33
    v_cvt_pk_bf16_f32 v15, v34, v35
    v_cvt_pk_bf16_f32 v16, v36, v37
    ds_write_b32 v48, v8 offset:0
    ds_write_b32 v48, v9 offset:4
    ds_write_b32 v48, v10 offset:8
    ds_write_b32 v48, v11 offset:384
    ds_write_b32 v48, v12 offset:388
    ds_write_b32 v48, v13 offset:392
    ds_write_b32 v48, v14 offset:768
    ds_write_b32 v48, v15 offset:772
    ds_write_b32 v48, v16 offset:776
    buffer_store_dwordx2 v[106:107], v49, s[44:47], s5 offen sc1
    s_waitcnt lgkmcnt(0)
    s_barrier
    ds_read_b64_tr_b16 v[20:21], v50 offset:0
    ds_read_b64_tr_b16 v[22:23], v50 offset:4864
    ds_read_b64_tr_b16 v[24:25], v50 offset:512
    ds_read_b64_tr_b16 v[26:27], v50 offset:5376
    ds_read_b64_tr_b16 v[28:29], v50 offset:1024
    ds_read_b64_tr_b16 v[30:31], v50 offset:5888
    s_waitcnt lgkmcnt(4)
    buffer_store_dwordx4 v[20:23], v52, s[44:47], s15 offen sc1
    s_waitcnt lgkmcnt(2)
    buffer_store_dwordx4 v[24:27], v52, s[44:47], s7 offen sc1
    s_waitcnt lgkmcnt(0)
    buffer_store_dwordx4 v[28:31], v52, s[44:47], s8 offen sc1
    buffer_load_dword v45, v54, s[64:67], 0 offen sc1
    s_waitcnt vmcnt(5)
    s_barrier
    ds_read_b64_tr_b16 v[60:61], v51 offset:0
    ds_read_b64_tr_b16 v[62:63], v51 offset:4608
    ds_read_b64_tr_b16 v[64:65], v51 offset:9216
    ds_read_b64_tr_b16 v[66:67], v51 offset:12672
    ds_read_b64_tr_b16 v[68:69], v51 offset:17280
    ds_read_b64_tr_b16 v[70:71], v51 offset:512
    ds_read_b64_tr_b16 v[72:73], v51 offset:5120
    ds_read_b64_tr_b16 v[74:75], v51 offset:9728
    ds_read_b64_tr_b16 v[76:77], v51 offset:13184
    ds_read_b64_tr_b16 v[78:79], v51 offset:17792
    v_alignbit_b32 v114, v99, v99, 16
    v_alignbit_b32 v115, v98, v98, 16
    s_waitcnt lgkmcnt(5)
    v_alignbit_b32 v108, v61, v60, 16
    v_alignbit_b32 v109, v62, v61, 16
    v_alignbit_b32 v110, v63, v62, 16
    v_alignbit_b32 v111, v64, v63, 16
    v_alignbit_b32 v112, v65, v64, 16
    v_dot2_f32_bf16 v116, v60, v114, 0
    ds_read_b64_tr_b16 v[80:81], v51 offset:1024
    v_dot2_f32_bf16 v117, v108, v114, 0
    v_dot2_f32_bf16 v118, v61, v114, 0
    v_dot2_f32_bf16 v119, v109, v114, 0
    v_dot2_f32_bf16 v120, v62, v114, 0
    ds_read_b64_tr_b16 v[82:83], v51 offset:5632
    v_dot2_f32_bf16 v121, v110, v114, 0
    v_dot2_f32_bf16 v122, v63, v114, 0
    v_dot2_f32_bf16 v123, v111, v114, 0
    v_dot2_f32_bf16 v116, v61, v115, v116
    v_dot2_f32_bf16 v117, v109, v115, v117
    ds_read_b64_tr_b16 v[84:85], v51 offset:10240
    v_dot2_f32_bf16 v118, v62, v115, v118
    v_dot2_f32_bf16 v119, v110, v115, v119
    v_dot2_f32_bf16 v120, v63, v115, v120
    v_dot2_f32_bf16 v121, v111, v115, v121
    v_dot2_f32_bf16 v122, v64, v115, v122
    ds_read_b64_tr_b16 v[86:87], v51 offset:13696
    v_dot2_f32_bf16 v123, v112, v115, v123
    v_and_b32 v133, 0xffff0000, v66
    v_lshlrev_b32 v132, 16, v66
    v_and_b32 v135, 0xffff0000, v67
    v_lshlrev_b32 v134, 16, v67
    ds_read_b64_tr_b16 v[88:89], v51 offset:18304
    v_and_b32 v137, 0xffff0000, v68
    v_lshlrev_b32 v136, 16, v68
    v_and_b32 v139, 0xffff0000, v69
    v_lshlrev_b32 v138, 16, v69
    v_pk_mul_f32 v[116:117], v[116:117], v[132:133]
    v_pk_mul_f32 v[118:119], v[118:119], v[134:135]
    v_pk_mul_f32 v[120:121], v[120:121], v[136:137]
    v_pk_mul_f32 v[122:123], v[122:123], v[138:139]
    v_cvt_pk_bf16_f32 v160, v123, v122
    v_cvt_pk_bf16_f32 v161, v121, v120
    v_cvt_pk_bf16_f32 v162, v119, v118
    v_cvt_pk_bf16_f32 v163, v117, v116
    buffer_store_dwordx4 v[160:163], v53, s[44:47], s15 offen sc1
    v_alignbit_b32 v114, v101, v101, 16
    v_alignbit_b32 v115, v100, v100, 16
    s_waitcnt lgkmcnt(5)
    v_alignbit_b32 v108, v71, v70, 16
    v_alignbit_b32 v109, v72, v71, 16
    v_alignbit_b32 v110, v73, v72, 16
    v_alignbit_b32 v111, v74, v73, 16
    v_alignbit_b32 v112, v75, v74, 16
    v_dot2_f32_bf16 v124, v70, v114, 0
    v_dot2_f32_bf16 v125, v108, v114, 0
    v_dot2_f32_bf16 v126, v71, v114, 0
    v_dot2_f32_bf16 v127, v109, v114, 0
    v_dot2_f32_bf16 v128, v72, v114, 0
    v_dot2_f32_bf16 v129, v110, v114, 0
    v_dot2_f32_bf16 v130, v73, v114, 0
    v_dot2_f32_bf16 v131, v111, v114, 0
    v_dot2_f32_bf16 v124, v71, v115, v124
    v_dot2_f32_bf16 v125, v109, v115, v125
    v_dot2_f32_bf16 v126, v72, v115, v126
    v_dot2_f32_bf16 v127, v110, v115, v127
    v_dot2_f32_bf16 v128, v73, v115, v128
    v_dot2_f32_bf16 v129, v111, v115, v129
    v_dot2_f32_bf16 v130, v74, v115, v130
    v_dot2_f32_bf16 v131, v112, v115, v131
    v_and_b32 v133, 0xffff0000, v76
    v_lshlrev_b32 v132, 16, v76
    v_and_b32 v135, 0xffff0000, v77
    v_lshlrev_b32 v134, 16, v77
    v_and_b32 v137, 0xffff0000, v78
    v_lshlrev_b32 v136, 16, v78
    v_and_b32 v139, 0xffff0000, v79
    v_lshlrev_b32 v138, 16, v79
    v_pk_mul_f32 v[124:125], v[124:125], v[132:133]
    v_pk_mul_f32 v[126:127], v[126:127], v[134:135]
    v_pk_mul_f32 v[128:129], v[128:129], v[136:137]
    v_pk_mul_f32 v[130:131], v[130:131], v[138:139]
    v_cvt_pk_bf16_f32 v164, v131, v130
    v_cvt_pk_bf16_f32 v165, v129, v128
    v_cvt_pk_bf16_f32 v166, v127, v126
    v_cvt_pk_bf16_f32 v167, v125, v124
    buffer_store_dwordx4 v[164:167], v53, s[44:47], s7 offen sc1
    v_alignbit_b32 v114, v103, v103, 16
    v_alignbit_b32 v115, v102, v102, 16
    s_waitcnt lgkmcnt(0)
    v_alignbit_b32 v108, v81, v80, 16
    v_alignbit_b32 v109, v82, v81, 16
    v_alignbit_b32 v110, v83, v82, 16
    v_alignbit_b32 v111, v84, v83, 16
    v_alignbit_b32 v112, v85, v84, 16
    v_dot2_f32_bf16 v116, v80, v114, 0
    v_dot2_f32_bf16 v117, v108, v114, 0
    v_dot2_f32_bf16 v118, v81, v114, 0
    v_dot2_f32_bf16 v119, v109, v114, 0
    v_dot2_f32_bf16 v120, v82, v114, 0
    v_dot2_f32_bf16 v121, v110, v114, 0
    v_dot2_f32_bf16 v122, v83, v114, 0
    v_dot2_f32_bf16 v123, v111, v114, 0
    v_dot2_f32_bf16 v116, v81, v115, v116
    v_dot2_f32_bf16 v117, v109, v115, v117
    v_dot2_f32_bf16 v118, v82, v115, v118
    v_dot2_f32_bf16 v119, v110, v115, v119
    v_dot2_f32_bf16 v120, v83, v115, v120
    v_dot2_f32_bf16 v121, v111, v115, v121
    v_dot2_f32_bf16 v122, v84, v115, v122
    v_dot2_f32_bf16 v123, v112, v115, v123
    v_and_b32 v133, 0xffff0000, v86
    v_lshlrev_b32 v132, 16, v86
    v_and_b32 v135, 0xffff0000, v87
    v_lshlrev_b32 v134, 16, v87
    v_and_b32 v137, 0xffff0000, v88
    v_lshlrev_b32 v136, 16, v88
    v_and_b32 v139, 0xffff0000, v89
    v_lshlrev_b32 v138, 16, v89
    v_pk_mul_f32 v[116:117], v[116:117], v[132:133]
    v_pk_mul_f32 v[118:119], v[118:119], v[134:135]
    v_pk_mul_f32 v[120:121], v[120:121], v[136:137]
    v_pk_mul_f32 v[122:123], v[122:123], v[138:139]
    v_cvt_pk_bf16_f32 v168, v123, v122
    v_cvt_pk_bf16_f32 v169, v121, v120
    v_cvt_pk_bf16_f32 v170, v119, v118
    v_cvt_pk_bf16_f32 v171, v117, v116
    buffer_store_dwordx4 v[168:171], v53, s[44:47], s8 offen sc1
    s_add_u32 m0, s74, 32
    s_add_u32 s13, s12, 0
    buffer_load_dwordx4 v240, s[48:51], s13 offen offset:0 lds
    buffer_load_dwordx4 v240, s[48:51], s13 offen offset:1024 lds
    buffer_load_dwordx4 v240, s[48:51], s13 offen offset:2048 lds
    buffer_load_dwordx4 v240, s[48:51], s13 offen offset:3072 lds
    s_mov_b64 exec, 0
    s_call_b64 s[82:83], L_wc_X
    s_mov_b64 exec, -1
    s_waitcnt vmcnt(7)
    v_readfirstlane_b32 s68, v45
    s_nop 1
    s_cmp_eq_u32 s68, 0
    s_cbranch_scc1 L_nw_X
L_ng_X:
    s_barrier
    v_mov_b32 v3, s68
    buffer_store_dword v3, v1, s[44:47], 0 offen sc1
    s_waitcnt vmcnt(5)
    s_barrier
    buffer_store_dword v3, v46, s[44:47], 0 offen sc1
L_segX:
L_pl_X_0:
    s_cbranch_execz L_pl_X_4
    s_cmp_lt_u32 s75, 252
    s_cbranch_scc0 L_idle
    s_mov_b32 s56, s26
    s_and_b32 s57, s27, 0xffff
    s_mov_b32 s58, 1152
    s_mov_b32 s59, 0x20000
    v_mov_b32 v9, 0
    buffer_load_ushort v9, v9, s[56:59], s70 offen
    s_lshr_b32 s4, s2, 1
    s_and_b32 s4, s4, 3
    s_lshl2_add_u32 s4, s4, s3
    s_lshl_b32 s4, s4, 8
    s_add_u32 s4, s4, 12599296
    v_lshl_add_u32 v28, v2, 2, s4
    v_add_u32 v241, s74, v240
    v_cmp_eq_u32 vcc, 0, v2
    v_mov_b32 v196, 4136
    s_nop 0
    v_cndmask_b32 v196, v196, 30, vcc
    v_add_u32 v242, s74, v196
    v_bfe_u32 v196, v2, 3, 2
    v_mul_u32_u24 v196, 4160, v196
    v_and_b32 v197, 7, v2
    v_lshl_add_u32 v196, v197, 2, v196
    v_add_u32 v200, s74, v196
    v_mov_b32 v196, 0
    v_mov_b32 v197, 0
    v_mov_b32 v198, 0
    v_mov_b32 v199, 0
    ds_write_b32 v200, v196
    v_lshlrev_b32 v201, 4, v0
    ds_write_b128 v201, v[196:199]
    ds_write_b128 v201, v[196:199] offset:36864
    s_waitcnt vmcnt(3)
    ds_read_b128 v[212:215], v241 offset:32
    ds_read_b32 v216, v241 offset:48
    ds_read_b128 v[218:221], v241 offset:1056
    ds_read_b32 v222, v241 offset:1072
    ds_read_b128 v[224:227], v241 offset:2080
    ds_read_b32 v228, v241 offset:2096
    ds_read_b128 v[230:233], v241 offset:3104
    ds_read_b32 v234, v241 offset:3120
    v_lshrrev_b32 v202, 3, v2
    v_and_b32 v203, 7, v2
    v_lshrrev_b32 v204, 1, v202
    v_xor_b32 v203, v203, v204
    v_mul_u32_u24 v202, 9216, v202
    v_lshl_add_u32 v15, v203, 4, v202
    v_xor_b32 v16, 64, v15
    v_and_b32 v202, 15, v2
    v_add_u32 v202, 1, v202
    v_and_b32 v203, 1, v202
    v_mul_u32_u24 v203, 4160, v203
    v_lshrrev_b32 v202, 1, v202
    v_lshl_add_u32 v203, v202, 2, v203
    v_lshrrev_b32 v204, 4, v2
    v_lshl_add_u32 v203, v204, 4, v203
    v_add_u32 v236, s74, v203
    v_add_u32 v237, 1024, v236
    v_add_u32 v238, 1024, v237
    v_add_u32 v239, 1024, v238
    s_waitcnt lgkmcnt(0)
    s_waitcnt vmcnt(0)
    v_lshlrev_b32 v9, 16, v9
    v_lshlrev_b32 v208, 16, v212
    v_add_f32 v9, v9, v208
    v_cvt_pk_bf16_f32 v9, v9, v9
    ds_write_b16 v242, v9 offset:4160
    ds_write_b16 v242, v9 offset:2
    v_alignbit_b32 v212, v213, v212, 16
    v_alignbit_b32 v213, v214, v213, 16
    v_alignbit_b32 v214, v215, v214, 16
    v_alignbit_b32 v215, v216, v215, 16
    ds_write_b128 v241, v[212:215] offset:4192
    v_alignbit_b32 v218, v219, v218, 16
    v_alignbit_b32 v219, v220, v219, 16
    v_alignbit_b32 v220, v221, v220, 16
    v_alignbit_b32 v221, v222, v221, 16
    ds_write_b128 v241, v[218:221] offset:5216
    v_alignbit_b32 v224, v225, v224, 16
    v_alignbit_b32 v225, v226, v225, 16
    v_alignbit_b32 v226, v227, v226, 16
    v_alignbit_b32 v227, v228, v227, 16
    ds_write_b128 v241, v[224:227] offset:6240
    v_alignbit_b32 v230, v231, v230, 16
    v_alignbit_b32 v231, v232, v231, 16
    v_alignbit_b32 v232, v233, v232, 16
    v_alignbit_b32 v233, v234, v233, 16
    ds_write_b128 v241, v[230:233] offset:7264
    v_and_b32 v202, 15, v2
    v_lshlrev_b32 v202, 1, v202
    v_sub_u32 v202, v202, v204
    v_add_u32 v202, 17, v202
    v_bfe_u32 v203, v202, 1, 3
    v_xor_b32 v203, s3, v203
    v_lshlrev_b32 v203, 4, v203
    v_lshl_add_u32 v244, v202, 7, v203
    v_and_b32 v202, 15, v2
    v_lshlrev_b32 v202, 1, v202
    v_sub_u32 v202, v202, v204
    v_add_u32 v202, 13, v202
    v_bfe_u32 v203, v202, 1, 3
    v_xor_b32 v203, s3, v203
    v_lshlrev_b32 v203, 4, v203
    v_lshl_add_u32 v245, v202, 7, v203
    v_and_b32 v202, 15, v2
    v_lshlrev_b32 v202, 1, v202
    v_sub_u32 v202, v202, v204
    v_add_u32 v202, 9, v202
    v_bfe_u32 v203, v202, 1, 3
    v_xor_b32 v203, s3, v203
    v_lshlrev_b32 v203, 4, v203
    v_lshl_add_u32 v246, v202, 7, v203
    v_and_b32 v202, 15, v2
    v_lshlrev_b32 v202, 1, v202
    v_sub_u32 v202, v202, v204
    v_add_u32 v202, 5, v202
    v_bfe_u32 v203, v202, 1, 3
    v_xor_b32 v203, s3, v203
    v_lshlrev_b32 v203, 4, v203
    v_lshl_add_u32 v247, v202, 7, v203
    v_and_b32 v202, 15, v2
    v_lshlrev_b32 v202, 5, v202
    v_lshl_add_u32 v8, v204, 3, v202
    s_mul_i32 s7, s3, 589824
    s_lshl_b32 s8, s69, 8
    s_add_u32 s7, s7, s8
    s_add_u32 s10, s7, 2359296
    s_lshl_b32 s9, s3, 13
    s_add_u32 s9, s9, 4096
    ds_read2_b32 v[64:65], v236 offset0:0 offset1:1
    ds_read2_b32 v[66:67], v236 offset0:2 offset1:3
    ds_read2_b32 v[68:69], v236 offset0:128 offset1:129
    ds_read2_b32 v[70:71], v236 offset0:130 offset1:131
    ds_read2_b32 v[72:73], v237 offset0:0 offset1:1
    ds_read2_b32 v[74:75], v237 offset0:2 offset1:3
    ds_read2_b32 v[76:77], v237 offset0:128 offset1:129
    ds_read2_b32 v[78:79], v237 offset0:130 offset1:131
    ds_read2_b32 v[80:81], v238 offset0:0 offset1:1
    ds_read2_b32 v[82:83], v238 offset0:2 offset1:3
    ds_read2_b32 v[84:85], v238 offset0:128 offset1:129
    ds_read2_b32 v[86:87], v238 offset0:130 offset1:131
    ds_read2_b32 v[88:89], v239 offset0:0 offset1:1
    ds_read2_b32 v[90:91], v239 offset0:2 offset1:3
    ds_read2_b32 v[92:93], v239 offset0:128 offset1:129
    ds_read2_b32 v[94:95], v239 offset0:130 offset1:131
    v_mov_b32 v29, 0
    buffer_atomic_add v29, v28, s[44:47], 0 offen sc0 sc1
    s_waitcnt vmcnt(0)
    v_cmp_ne_u32 vcc, s68, v29
    s_cbranch_vccnz L_rs_p1X
L_ok_p1X:
    s_add_u32 m0, s9, 0
    s_add_u32 s13, s10, 0
    buffer_load_dwordx4 v15, s[44:47], s13 offen sc1 lds
    s_add_u32 m0, s9, 1024
    s_add_u32 s13, s10, 73728
    buffer_load_dwordx4 v16, s[44:47], s13 offen sc1 lds
    s_add_u32 m0, s9, 2048
    s_add_u32 s13, s10, 147456
    buffer_load_dwordx4 v15, s[44:47], s13 offen sc1 lds
    s_add_u32 m0, s9, 3072
    s_add_u32 s13, s10, 221184
    buffer_load_dwordx4 v16, s[44:47], s13 offen sc1 lds
    s_add_u32 m0, s9, 4096
    s_add_u32 s13, s10, 294912
    buffer_load_dwordx4 v15, s[44:47], s13 offen sc1 lds
    s_add_u32 m0, s9, 5120
    s_add_u32 s13, s10, 368640
    buffer_load_dwordx4 v16, s[44:47], s13 offen sc1 lds
    s_add_u32 m0, s9, 6144
    s_add_u32 s13, s10, 442368
    buffer_load_dwordx4 v15, s[44:47], s13 offen sc1 lds
    s_add_u32 m0, s9, 7168
    s_add_u32 s13, s10, 516096
    buffer_load_dwordx4 v16, s[44:47], s13 offen sc1 lds
    s_mov_b64 exec, 0
    s_call_b64 s[82:83], L_wc_D
    s_mov_b64 exec, -1
    s_mov_b32 s60, s36
    s_and_b32 s61, s37, 0xffff
    s_mov_b32 s62, 4096
    s_mov_b32 s63, 0x20000
    v_and_b32 v24, 15, v2
    s_lshl_b32 s7, s71, 6
    v_add_u32 v24, s7, v24
    s_and_b32 s8, s3, 1
    s_lshl_b32 s4, s8, 5
    v_add_u32 v25, s4, v24
    v_lshlrev_b32 v26, 3, v25
    v_mul_u32_u24 v25, 1152, v25
    v_bfe_u32 v31, v2, 4, 1
    v_lshl_add_u32 v25, v31, 5, v25
    v_lshrrev_b32 v31, 5, v2
    v_lshl_add_u32 v25, v31, 4, v25
    s_bfe_u32 s7, s2, 0x20003
    s_mul_i32 s7, s7, 288
    s_lshl_b32 s4, s72, 6
    s_add_u32 s4, s4, s7
    v_add_u32 v252, s4, v25
    s_xor_b32 s8, s3, s72
    s_and_b32 s4, s72, 1
    s_lshl1_add_u32 s4, s4, s8
    v_lshl_add_u32 v24, s4, 4, v24
    s_add_u32 s7, s7, 256
    s_cmp_lt_u32 s8, 2
    s_cselect_b32 s7, s7, 0x40000000
    v_lshlrev_b32 v18, 3, v24
    v_mul_u32_u24 v24, 1152, v24
    v_lshrrev_b32 v31, 4, v2
    v_lshl_add_u32 v24, v31, 3, v24
    v_add_u32 v253, s7, v24
    v_lshrrev_b32 v24, 3, v2
    v_and_b32 v25, 7, v2
    v_bfe_u32 v31, v2, 4, 2
    v_lshlrev_b32 v31, 1, v31
    v_xor_b32 v25, v25, v31
    v_lshlrev_b32 v24, 12, v24
    v_lshl_add_u32 v24, v25, 4, v24
    s_mul_i32 s7, s72, 36
    s_bitcmp1_b32 s3, 0
L_pl_X_1:
    s_cbranch_execz L_pl_X_5
    s_addc_u32 s7, s7, 0
    s_lshl_b32 s7, s7, 17
    s_lshl_b32 s8, s71, 7
    s_add_u32 s7, s7, s8
    v_add_u32 v4, s7, v24
    v_add_u32 v5, 31744, v4
    v_add_u32 v6, 31744, v5
    v_add_u32 v7, 31744, v6
    v_lshrrev_b32 v24, 2, v2
    v_lshlrev_b32 v24, 7, v24
    v_and_b32 v25, 3, v2
    v_lshl_add_u32 v24, v25, 3, v24
    s_and_b32 s7, s73, 8192
    v_add_u32 v24, s7, v24
    v_bfe_u32 v31, v2, 3, 2
    s_and_b32 s7, s3, 1
    s_lshl_b32 s7, s7, 1
    v_xor_b32 v31, s7, v31
    v_lshl_add_u32 v10, v31, 5, v24
    v_xor_b32 v11, 32, v10
    v_and_b32 v24, 15, v2
    v_lshrrev_b32 v25, 4, v2
    v_mul_u32_u24 v25, 17408, v25
    v_lshl_add_u32 v24, v24, 4, v25
    s_mul_i32 s7, s72, 36
    s_and_b32 s8, s3, 1
    s_add_u32 s7, s7, s8
    s_mul_i32 s7, s7, 69632
    s_bfe_u32 s8, s2, 0x20003
    s_lshl_b32 s8, s8, 12
    s_add_u32 s7, s7, s8
    s_add_u32 s7, s7, 12795904
    v_add_u32 v23, s7, v24
    s_xor_b32 s7, s72, 0
    v_lshl_add_u32 v19, s7, 10, v23
    s_xor_b32 s7, s72, 1
    v_lshl_add_u32 v20, s7, 10, v23
    s_xor_b32 s7, s72, 2
    v_lshl_add_u32 v21, s7, 10, v23
    s_xor_b32 s7, s72, 3
    v_lshl_add_u32 v22, s7, 10, v23
    v_lshlrev_b32 v14, 4, v2
    v_add_u32 v14, 98304, v14
    v_add_u32 v1, 0x10000, v14
    s_bitcmp1_b32 s3, 1
    s_cselect_b32 s18, s85, s84
    s_mul_i32 s18, s18, 139264
    s_cselect_b32 s19, s87, s86
    s_mul_i32 s19, s19, 139264
    s_cselect_b32 s20, s89, s88
    s_mul_i32 s20, s20, 139264
    s_cselect_b32 s21, s91, s90
    s_mul_i32 s21, s21, 139264
    s_cselect_b32 s22, s93, s92
    s_mul_i32 s22, s22, 139264
    s_cselect_b32 s23, s95, s94
    s_mul_i32 s23, s23, 139264
    s_cselect_b32 s24, s97, s96
    s_mul_i32 s24, s24, 139264
    s_cselect_b32 s25, s99, s98
    s_mul_i32 s25, s25, 139264
    s_cselect_b32 s26, s101, s100
    s_mul_i32 s26, s26, 139264
    v_add_u32 v10, 131072, v10
    v_add_u32 v11, 131072, v11
    s_waitcnt vmcnt(0) lgkmcnt(0)
    s_barrier
    ds_read_b128 v[96:99], v244 offset:2048
    ds_read_b128 v[100:103], v244 offset:6144
    ds_read_b128 v[104:107], v244 offset:10240
    ds_read_b128 v[108:111], v244 offset:14336
    ds_read_b128 v[112:115], v244 offset:18432
    ds_read_b128 v[116:119], v244 offset:22528
    ds_read_b128 v[120:123], v244 offset:26624
    ds_read_b128 v[124:127], v244 offset:30720
    s_waitcnt lgkmcnt(0)
    v_mfma_f32_16x16x32_bf16 v[32:35], v[64:67], v[96:99], 0
    s_lshl_b32 s14, s84, 18
    ds_read_b128 v[160:163], v245 offset:2048
    v_mfma_f32_16x16x32_bf16 v[36:39], v[68:71], v[96:99], 0
    s_add_u32 m0, s73, 147456
    v_mfma_f32_16x16x32_bf16 v[36:39], v[64:67], v[100:103], v[36:39]
    buffer_load_dwordx4 v4, s[52:55], s14 offen offset:0 lds
    ds_read2_b32 v[128:129], v236 offset0:16 offset1:17
    v_mfma_f32_16x16x32_bf16 v[40:43], v[64:67], v[104:107], 0
    ds_read2_b32 v[130:131], v236 offset0:18 offset1:19
    v_mfma_f32_16x16x32_bf16 v[40:43], v[68:71], v[100:103], v[40:43]
    v_mfma_f32_16x16x32_bf16 v[40:43], v[72:75], v[96:99], v[40:43]
    ds_read_b128 v[164:167], v245 offset:6144
    v_mfma_f32_16x16x32_bf16 v[44:47], v[76:79], v[96:99], 0
    ds_read2_b32 v[132:133], v236 offset0:144 offset1:145
    v_mfma_f32_16x16x32_bf16 v[44:47], v[72:75], v[100:103], v[44:47]
    s_add_u32 s13, s12, 16384
    v_mfma_f32_16x16x32_bf16 v[44:47], v[68:71], v[104:107], v[44:47]
    ds_read2_b32 v[134:135], v236 offset0:146 offset1:147
    v_mfma_f32_16x16x32_bf16 v[44:47], v[64:67], v[108:111], v[44:47]
    s_add_u32 m0, s74, 8352
    ds_read_b128 v[168:171], v245 offset:10240
    v_mfma_f32_16x16x32_bf16 v[48:51], v[64:67], v[112:115], 0
    buffer_load_dwordx4 v240, s[48:51], s13 offen offset:0 lds
    ds_read2_b32 v[136:137], v237 offset0:16 offset1:17
    v_mfma_f32_16x16x32_bf16 v[48:51], v[68:71], v[108:111], v[48:51]
    v_mfma_f32_16x16x32_bf16 v[48:51], v[72:75], v[104:107], v[48:51]
    s_add_u32 m0, s73, 147456
    ds_read2_b32 v[138:139], v237 offset0:18 offset1:19
    v_mfma_f32_16x16x32_bf16 v[48:51], v[76:79], v[100:103], v[48:51]
    buffer_load_dwordx4 v5, s[52:55], s14 offen offset:1024 lds
    ds_read_b128 v[172:175], v245 offset:14336
    v_mfma_f32_16x16x32_bf16 v[48:51], v[80:83], v[96:99], v[48:51]
    v_mfma_f32_16x16x32_bf16 v[52:55], v[84:87], v[96:99], 0
    ds_read2_b32 v[140:141], v237 offset0:144 offset1:145
    v_mfma_f32_16x16x32_bf16 v[52:55], v[80:83], v[100:103], v[52:55]
    s_add_u32 m0, s74, 8352
    ds_read2_b32 v[142:143], v237 offset0:146 offset1:147
    v_mfma_f32_16x16x32_bf16 v[52:55], v[76:79], v[104:107], v[52:55]
    buffer_load_dwordx4 v240, s[48:51], s13 offen offset:1024 lds
    v_mfma_f32_16x16x32_bf16 v[52:55], v[72:75], v[108:111], v[52:55]
    ds_read_b128 v[176:179], v245 offset:18432
    v_mfma_f32_16x16x32_bf16 v[52:55], v[68:71], v[112:115], v[52:55]
    ds_read2_b32 v[144:145], v238 offset0:16 offset1:17
    v_mfma_f32_16x16x32_bf16 v[52:55], v[64:67], v[116:119], v[52:55]
    v_mfma_f32_16x16x32_bf16 v[56:59], v[64:67], v[120:123], 0
    ds_read2_b32 v[146:147], v238 offset0:18 offset1:19
    v_mfma_f32_16x16x32_bf16 v[56:59], v[68:71], v[116:119], v[56:59]
    ds_read_b128 v[180:183], v245 offset:22528
    v_mfma_f32_16x16x32_bf16 v[56:59], v[72:75], v[112:115], v[56:59]
    v_mfma_f32_16x16x32_bf16 v[56:59], v[76:79], v[108:111], v[56:59]
    s_add_u32 m0, s73, 147456
    ds_read2_b32 v[148:149], v238 offset0:144 offset1:145
    v_mfma_f32_16x16x32_bf16 v[56:59], v[80:83], v[104:107], v[56:59]
    buffer_load_dwordx4 v6, s[52:55], s14 offen offset:2048 lds
    ds_read2_b32 v[150:151], v238 offset0:146 offset1:147
    v_mfma_f32_16x16x32_bf16 v[56:59], v[84:87], v[100:103], v[56:59]
    s_add_u32 m0, s74, 8352
    ds_read_b128 v[184:187], v245 offset:26624
    v_mfma_f32_16x16x32_bf16 v[56:59], v[88:91], v[96:99], v[56:59]
    buffer_load_dwordx4 v240, s[48:51], s13 offen offset:2048 lds
    v_mfma_f32_16x16x32_bf16 v[60:63], v[92:95], v[96:99], 0
    ds_read2_b32 v[152:153], v239 offset0:16 offset1:17
    v_mfma_f32_16x16x32_bf16 v[60:63], v[88:91], v[100:103], v[60:63]
    ds_read2_b32 v[154:155], v239 offset0:18 offset1:19
    v_mfma_f32_16x16x32_bf16 v[60:63], v[84:87], v[104:107], v[60:63]
    v_mfma_f32_16x16x32_bf16 v[60:63], v[80:83], v[108:111], v[60:63]
    ds_read_b128 v[188:191], v245 offset:30720
    v_mfma_f32_16x16x32_bf16 v[60:63], v[76:79], v[112:115], v[60:63]
    s_add_u32 m0, s74, 8352
    ds_read2_b32 v[156:157], v239 offset0:144 offset1:145
    v_mfma_f32_16x16x32_bf16 v[60:63], v[72:75], v[116:119], v[60:63]
    buffer_load_dwordx4 v240, s[48:51], s13 offen offset:3072 lds
    v_mfma_f32_16x16x32_bf16 v[60:63], v[68:71], v[120:123], v[60:63]
    ds_read2_b32 v[158:159], v239 offset0:146 offset1:147
    v_mfma_f32_16x16x32_bf16 v[60:63], v[64:67], v[124:127], v[60:63]
    s_waitcnt lgkmcnt(12)
    v_mfma_f32_16x16x32_bf16 v[32:35], v[128:131], v[160:163], v[32:35]
    s_add_u32 m0, s73, 147456
    ds_read_b128 v[96:99], v246 offset:2048
    v_mfma_f32_16x16x32_bf16 v[36:39], v[132:135], v[160:163], v[36:39]
    buffer_load_dwordx4 v7, s[52:55], s14 offen offset:3072 lds
    v_mfma_f32_16x16x32_bf16 v[36:39], v[128:131], v[164:167], v[36:39]
    ds_read2_b32 v[64:65], v236 offset0:32 offset1:33
    v_mfma_f32_16x16x32_bf16 v[40:43], v[128:131], v[168:171], v[40:43]
    ds_read2_b32 v[66:67], v236 offset0:34 offset1:35
    v_mfma_f32_16x16x32_bf16 v[40:43], v[132:135], v[164:167], v[40:43]
    v_mfma_f32_16x16x32_bf16 v[40:43], v[136:139], v[160:163], v[40:43]
    ds_read_b128 v[100:103], v246 offset:6144
    v_mfma_f32_16x16x32_bf16 v[44:47], v[140:143], v[160:163], v[44:47]
    ds_read2_b32 v[68:69], v236 offset0:160 offset1:161
    v_mfma_f32_16x16x32_bf16 v[44:47], v[136:139], v[164:167], v[44:47]
    v_mfma_f32_16x16x32_bf16 v[44:47], v[132:135], v[168:171], v[44:47]
    ds_read2_b32 v[70:71], v236 offset0:162 offset1:163
    v_mfma_f32_16x16x32_bf16 v[44:47], v[128:131], v[172:175], v[44:47]
    ds_read_b128 v[104:107], v246 offset:10240
    s_waitcnt lgkmcnt(7)
    v_mfma_f32_16x16x32_bf16 v[48:51], v[128:131], v[176:179], v[48:51]
    ds_read2_b32 v[72:73], v237 offset0:32 offset1:33
    v_mfma_f32_16x16x32_bf16 v[48:51], v[132:135], v[172:175], v[48:51]
    ds_read2_b32 v[74:75], v237 offset0:34 offset1:35
    v_mfma_f32_16x16x32_bf16 v[48:51], v[136:139], v[168:171], v[48:51]
    v_mov_b32 v9, 8
    buffer_load_ushort v9, v9, s[56:59], s70 offen
    v_mfma_f32_16x16x32_bf16 v[48:51], v[140:143], v[164:167], v[48:51]
    ds_read_b128 v[108:111], v246 offset:14336
    v_mfma_f32_16x16x32_bf16 v[48:51], v[144:147], v[160:163], v[48:51]
    v_mfma_f32_16x16x32_bf16 v[52:55], v[148:151], v[160:163], v[52:55]
    ds_read2_b32 v[76:77], v237 offset0:160 offset1:161
    v_mfma_f32_16x16x32_bf16 v[52:55], v[144:147], v[164:167], v[52:55]
    ds_read2_b32 v[78:79], v237 offset0:162 offset1:163
    v_mfma_f32_16x16x32_bf16 v[52:55], v[140:143], v[168:171], v[52:55]
    v_mfma_f32_16x16x32_bf16 v[52:55], v[136:139], v[172:175], v[52:55]
    ds_read_b128 v[112:115], v246 offset:18432
    v_mfma_f32_16x16x32_bf16 v[52:55], v[132:135], v[176:179], v[52:55]
    ds_read2_b32 v[80:81], v238 offset0:32 offset1:33
    v_mfma_f32_16x16x32_bf16 v[52:55], v[128:131], v[180:183], v[52:55]
    v_mfma_f32_16x16x32_bf16 v[56:59], v[128:131], v[184:187], v[56:59]
    ds_read2_b32 v[82:83], v238 offset0:34 offset1:35
    v_mfma_f32_16x16x32_bf16 v[56:59], v[132:135], v[180:183], v[56:59]
    ds_read_b128 v[116:119], v246 offset:22528
    v_mfma_f32_16x16x32_bf16 v[56:59], v[136:139], v[176:179], v[56:59]
    v_mfma_f32_16x16x32_bf16 v[56:59], v[140:143], v[172:175], v[56:59]
    ds_read2_b32 v[84:85], v238 offset0:160 offset1:161
    v_mfma_f32_16x16x32_bf16 v[56:59], v[144:147], v[168:171], v[56:59]
    ds_read2_b32 v[86:87], v238 offset0:162 offset1:163
    v_mfma_f32_16x16x32_bf16 v[56:59], v[148:151], v[164:167], v[56:59]
    ds_read_b128 v[120:123], v246 offset:26624
    v_mfma_f32_16x16x32_bf16 v[56:59], v[152:155], v[160:163], v[56:59]
    v_mfma_f32_16x16x32_bf16 v[60:63], v[156:159], v[160:163], v[60:63]
    ds_read2_b32 v[88:89], v239 offset0:32 offset1:33
    v_mfma_f32_16x16x32_bf16 v[60:63], v[152:155], v[164:167], v[60:63]
    ds_read2_b32 v[90:91], v239 offset0:34 offset1:35
    v_mfma_f32_16x16x32_bf16 v[60:63], v[148:151], v[168:171], v[60:63]
    v_mfma_f32_16x16x32_bf16 v[60:63], v[144:147], v[172:175], v[60:63]
    ds_read_b128 v[124:127], v246 offset:30720
    v_mfma_f32_16x16x32_bf16 v[60:63], v[140:143], v[176:179], v[60:63]
    ds_read2_b32 v[92:93], v239 offset0:160 offset1:161
    v_mfma_f32_16x16x32_bf16 v[60:63], v[136:139], v[180:183], v[60:63]
    v_mfma_f32_16x16x32_bf16 v[60:63], v[132:135], v[184:187], v[60:63]
    ds_read2_b32 v[94:95], v239 offset0:162 offset1:163
    v_mfma_f32_16x16x32_bf16 v[60:63], v[128:131], v[188:191], v[60:63]
    s_waitcnt lgkmcnt(12)
    v_mfma_f32_16x16x32_bf16 v[32:35], v[64:67], v[96:99], v[32:35]
    s_lshl_b32 s14, s85, 18
    ds_read_b128 v[160:163], v247 offset:2048
    v_mfma_f32_16x16x32_bf16 v[36:39], v[68:71], v[96:99], v[36:39]
    s_add_u32 m0, s73, 49152
    v_mfma_f32_16x16x32_bf16 v[36:39], v[64:67], v[100:103], v[36:39]
    buffer_load_dwordx4 v4, s[52:55], s14 offen offset:0 lds
    ds_read2_b32 v[128:129], v236 offset0:48 offset1:49
    v_mfma_f32_16x16x32_bf16 v[40:43], v[64:67], v[104:107], v[40:43]
    ds_read2_b32 v[130:131], v236 offset0:50 offset1:51
    v_mfma_f32_16x16x32_bf16 v[40:43], v[68:71], v[100:103], v[40:43]
    v_mfma_f32_16x16x32_bf16 v[40:43], v[72:75], v[96:99], v[40:43]
    ds_read_b128 v[164:167], v247 offset:6144
    v_mfma_f32_16x16x32_bf16 v[44:47], v[76:79], v[96:99], v[44:47]
    ds_read2_b32 v[132:133], v236 offset0:176 offset1:177
    v_mfma_f32_16x16x32_bf16 v[44:47], v[72:75], v[100:103], v[44:47]
    v_mfma_f32_16x16x32_bf16 v[44:47], v[68:71], v[104:107], v[44:47]
    ds_read2_b32 v[134:135], v236 offset0:178 offset1:179
    v_mfma_f32_16x16x32_bf16 v[44:47], v[64:67], v[108:111], v[44:47]
    ds_read_b128 v[168:171], v247 offset:10240
    s_waitcnt lgkmcnt(7)
    v_mfma_f32_16x16x32_bf16 v[48:51], v[64:67], v[112:115], v[48:51]
    ds_read2_b32 v[136:137], v237 offset0:48 offset1:49
    v_mfma_f32_16x16x32_bf16 v[48:51], v[68:71], v[108:111], v[48:51]
    v_mfma_f32_16x16x32_bf16 v[48:51], v[72:75], v[104:107], v[48:51]
    s_add_u32 m0, s73, 49152
    ds_read2_b32 v[138:139], v237 offset0:50 offset1:51
    v_mfma_f32_16x16x32_bf16 v[48:51], v[76:79], v[100:103], v[48:51]
    buffer_load_dwordx4 v5, s[52:55], s14 offen offset:1024 lds
    ds_read_b128 v[172:175], v247 offset:14336
    v_mfma_f32_16x16x32_bf16 v[48:51], v[80:83], v[96:99], v[48:51]
    v_mfma_f32_16x16x32_bf16 v[52:55], v[84:87], v[96:99], v[52:55]
    ds_read2_b32 v[140:141], v237 offset0:176 offset1:177
    v_mfma_f32_16x16x32_bf16 v[52:55], v[80:83], v[100:103], v[52:55]
    ds_read2_b32 v[142:143], v237 offset0:178 offset1:179
    v_mfma_f32_16x16x32_bf16 v[52:55], v[76:79], v[104:107], v[52:55]
    v_mfma_f32_16x16x32_bf16 v[52:55], v[72:75], v[108:111], v[52:55]
    ds_read_b128 v[176:179], v247 offset:18432
    v_mfma_f32_16x16x32_bf16 v[52:55], v[68:71], v[112:115], v[52:55]
    ds_read2_b32 v[144:145], v238 offset0:48 offset1:49
    v_mfma_f32_16x16x32_bf16 v[52:55], v[64:67], v[116:119], v[52:55]
    v_mfma_f32_16x16x32_bf16 v[56:59], v[64:67], v[120:123], v[56:59]
    ds_read2_b32 v[146:147], v238 offset0:50 offset1:51
    v_mfma_f32_16x16x32_bf16 v[56:59], v[68:71], v[116:119], v[56:59]
    ds_read_b128 v[180:183], v247 offset:22528
    v_mfma_f32_16x16x32_bf16 v[56:59], v[72:75], v[112:115], v[56:59]
    v_mfma_f32_16x16x32_bf16 v[56:59], v[76:79], v[108:111], v[56:59]
    s_add_u32 m0, s73, 49152
    ds_read2_b32 v[148:149], v238 offset0:176 offset1:177
    v_mfma_f32_16x16x32_bf16 v[56:59], v[80:83], v[104:107], v[56:59]
    buffer_load_dwordx4 v6, s[52:55], s14 offen offset:2048 lds
    ds_read2_b32 v[150:151], v238 offset0:178 offset1:179
    v_mfma_f32_16x16x32_bf16 v[56:59], v[84:87], v[100:103], v[56:59]
    ds_read_b128 v[184:187], v247 offset:26624
    v_mfma_f32_16x16x32_bf16 v[56:59], v[88:91], v[96:99], v[56:59]
    v_mfma_f32_16x16x32_bf16 v[60:63], v[92:95], v[96:99], v[60:63]
    ds_read2_b32 v[152:153], v239 offset0:48 offset1:49
    v_mfma_f32_16x16x32_bf16 v[60:63], v[88:91], v[100:103], v[60:63]
    ds_read2_b32 v[154:155], v239 offset0:50 offset1:51
    v_mfma_f32_16x16x32_bf16 v[60:63], v[84:87], v[104:107], v[60:63]
    v_mfma_f32_16x16x32_bf16 v[60:63], v[80:83], v[108:111], v[60:63]
    ds_read_b128 v[188:191], v247 offset:30720
    v_mfma_f32_16x16x32_bf16 v[60:63], v[76:79], v[112:115], v[60:63]
    ds_read2_b32 v[156:157], v239 offset0:176 offset1:177
    v_mfma_f32_16x16x32_bf16 v[60:63], v[72:75], v[116:119], v[60:63]
    v_mfma_f32_16x16x32_bf16 v[60:63], v[68:71], v[120:123], v[60:63]
    ds_read2_b32 v[158:159], v239 offset0:178 offset1:179
    v_mfma_f32_16x16x32_bf16 v[60:63], v[64:67], v[124:127], v[60:63]
    s_waitcnt lgkmcnt(12)
    v_mfma_f32_16x16x32_bf16 v[32:35], v[128:131], v[160:163], v[32:35]
    s_add_u32 m0, s73, 49152
    ds_read_b128 v[96:99], v244 offset:0
    v_mfma_f32_16x16x32_bf16 v[36:39], v[132:135], v[160:163], v[36:39]
    buffer_load_dwordx4 v7, s[52:55], s14 offen offset:3072 lds
    v_mfma_f32_16x16x32_bf16 v[36:39], v[128:131], v[164:167], v[36:39]
    ds_read2_b32 v[64:65], v236 offset0:64 offset1:65
    v_mfma_f32_16x16x32_bf16 v[40:43], v[128:131], v[168:171], v[40:43]
    ds_read2_b32 v[66:67], v236 offset0:66 offset1:67
    v_mfma_f32_16x16x32_bf16 v[40:43], v[132:135], v[164:167], v[40:43]
    v_mfma_f32_16x16x32_bf16 v[40:43], v[136:139], v[160:163], v[40:43]
    ds_read_b128 v[100:103], v244 offset:4096
    v_mfma_f32_16x16x32_bf16 v[44:47], v[140:143], v[160:163], v[44:47]
    ds_read2_b32 v[68:69], v236 offset0:192 offset1:193
    v_mfma_f32_16x16x32_bf16 v[44:47], v[136:139], v[164:167], v[44:47]
    v_mfma_f32_16x16x32_bf16 v[44:47], v[132:135], v[168:171], v[44:47]
    ds_read2_b32 v[70:71], v236 offset0:194 offset1:195
    v_mfma_f32_16x16x32_bf16 v[44:47], v[128:131], v[172:175], v[44:47]
    ds_read_b128 v[104:107], v244 offset:8192
    s_waitcnt lgkmcnt(7)
    v_mfma_f32_16x16x32_bf16 v[48:51], v[128:131], v[176:179], v[48:51]
    ds_read2_b32 v[72:73], v237 offset0:64 offset1:65
    v_mfma_f32_16x16x32_bf16 v[48:51], v[132:135], v[172:175], v[48:51]
    ds_read2_b32 v[74:75], v237 offset0:66 offset1:67
    v_mfma_f32_16x16x32_bf16 v[48:51], v[136:139], v[168:171], v[48:51]
    ds_read_b128 v[108:111], v244 offset:12288
    v_mfma_f32_16x16x32_bf16 v[48:51], v[140:143], v[164:167], v[48:51]
    ds_read2_b32 v[76:77], v237 offset0:192 offset1:193
    v_mfma_f32_16x16x32_bf16 v[48:51], v[144:147], v[160:163], v[48:51]
    ds_read2_b32 v[78:79], v237 offset0:194 offset1:195
    v_mfma_f32_16x16x32_bf16 v[52:55], v[148:151], v[160:163], v[52:55]
    ds_read_b128 v[112:115], v244 offset:16384
    v_mfma_f32_16x16x32_bf16 v[52:55], v[144:147], v[164:167], v[52:55]
    ds_read2_b32 v[80:81], v238 offset0:64 offset1:65
    v_mfma_f32_16x16x32_bf16 v[52:55], v[140:143], v[168:171], v[52:55]
    ds_read2_b32 v[82:83], v238 offset0:66 offset1:67
    v_mfma_f32_16x16x32_bf16 v[52:55], v[136:139], v[172:175], v[52:55]
    ds_read_b128 v[116:119], v244 offset:20480
    v_mfma_f32_16x16x32_bf16 v[52:55], v[132:135], v[176:179], v[52:55]
    ds_read2_b32 v[84:85], v238 offset0:192 offset1:193
    v_mfma_f32_16x16x32_bf16 v[52:55], v[128:131], v[180:183], v[52:55]
    ds_read2_b32 v[86:87], v238 offset0:194 offset1:195
    v_mfma_f32_16x16x32_bf16 v[56:59], v[128:131], v[184:187], v[56:59]
    ds_read_b128 v[120:123], v244 offset:24576
    s_waitcnt vmcnt(5)
    s_barrier
    v_mfma_f32_16x16x32_bf16 v[56:59], v[132:135], v[180:183], v[56:59]
    ds_read2_b32 v[88:89], v239 offset0:64 offset1:65
    v_mfma_f32_16x16x32_bf16 v[56:59], v[136:139], v[176:179], v[56:59]
    ds_read_b64_tr_b16 a[0:1], v10 offset:16384
    v_mfma_f32_16x16x32_bf16 v[56:59], v[140:143], v[172:175], v[56:59]
    ds_read_b64_tr_b16 a[2:3], v10 offset:18432
    v_mfma_f32_16x16x32_bf16 v[56:59], v[144:147], v[168:171], v[56:59]
    ds_read_b64_tr_b16 a[8:9], v10 offset:20480
    v_mfma_f32_16x16x32_bf16 v[56:59], v[148:151], v[164:167], v[56:59]
    ds_read2_b32 v[90:91], v239 offset0:66 offset1:67
    v_mfma_f32_16x16x32_bf16 v[56:59], v[152:155], v[160:163], v[56:59]
    ds_read_b64_tr_b16 a[10:11], v10 offset:22528
    v_mfma_f32_16x16x32_bf16 v[60:63], v[156:159], v[160:163], v[60:63]
    ds_read_b64_tr_b16 a[4:5], v11 offset:16384
    v_mfma_f32_16x16x32_bf16 v[60:63], v[152:155], v[164:167], v[60:63]
    ds_read_b128 v[124:127], v244 offset:28672
    v_mfma_f32_16x16x32_bf16 v[60:63], v[148:151], v[168:171], v[60:63]
    ds_read_b64_tr_b16 a[6:7], v11 offset:18432
    v_mfma_f32_16x16x32_bf16 v[60:63], v[144:147], v[172:175], v[60:63]
    ds_read_b64_tr_b16 a[12:13], v11 offset:20480
    v_mfma_f32_16x16x32_bf16 v[60:63], v[140:143], v[176:179], v[60:63]
    ds_read2_b32 v[92:93], v239 offset0:192 offset1:193
    v_mfma_f32_16x16x32_bf16 v[60:63], v[136:139], v[180:183], v[60:63]
    ds_read_b64_tr_b16 a[14:15], v11 offset:22528
    v_mfma_f32_16x16x32_bf16 v[60:63], v[132:135], v[184:187], v[60:63]
    ds_read2_b32 v[94:95], v239 offset0:194 offset1:195
    v_mfma_f32_16x16x32_bf16 v[60:63], v[128:131], v[188:191], v[60:63]
    s_waitcnt lgkmcnt(15)
    v_mfma_f32_16x16x32_bf16 v[32:35], v[64:67], v[96:99], v[32:35]
    ds_read_b128 v[160:163], v245 offset:0
    s_waitcnt lgkmcnt(2)
    s_barrier
    v_mfma_f32_16x16x32_bf16 v[36:39], v[68:71], v[96:99], v[36:39]
    v_mfma_f32_16x16x32_bf16 v[36:39], v[64:67], v[100:103], v[36:39]
    ds_read2_b32 v[128:129], v236 offset0:80 offset1:81
    v_mfma_f32_16x16x32_bf16 v[40:43], v[64:67], v[104:107], v[40:43]
    s_lshl_b32 s14, s86, 18
    ds_read2_b32 v[130:131], v236 offset0:82 offset1:83
    v_mfma_f32_16x16x32_bf16 v[40:43], v[68:71], v[100:103], v[40:43]
    s_add_u32 m0, s73, 147456
    v_mfma_f32_16x16x32_bf16 v[40:43], v[72:75], v[96:99], v[40:43]
    buffer_load_dwordx4 v4, s[52:55], s14 offen offset:0 lds
    ds_read_b128 v[164:167], v245 offset:4096
    v_mfma_f32_16x16x32_bf16 v[44:47], v[76:79], v[96:99], v[44:47]
    ds_read2_b32 v[132:133], v236 offset0:208 offset1:209
    v_mfma_f32_16x16x32_bf16 v[44:47], v[72:75], v[100:103], v[44:47]
    v_mfma_f32_16x16x32_bf16 v[44:47], v[68:71], v[104:107], v[44:47]
    ds_read2_b32 v[134:135], v236 offset0:210 offset1:211
    v_mfma_f32_16x16x32_bf16 v[44:47], v[64:67], v[108:111], v[44:47]
    ds_read_b128 v[168:171], v245 offset:8192
    s_waitcnt lgkmcnt(7)
    v_mfma_f32_16x16x32_bf16 v[48:51], v[64:67], v[112:115], v[48:51]
    ds_read2_b32 v[136:137], v237 offset0:80 offset1:81
    v_mfma_f32_16x16x32_bf16 v[48:51], v[68:71], v[108:111], v[48:51]
    ds_read2_b32 v[138:139], v237 offset0:82 offset1:83
    v_mfma_f32_16x16x32_bf16 v[48:51], v[72:75], v[104:107], v[48:51]
    ds_read_b128 v[172:175], v245 offset:12288
    v_mfma_f32_16x16x32_bf16 v[48:51], v[76:79], v[100:103], v[48:51]
    ds_read2_b32 v[140:141], v237 offset0:208 offset1:209
    v_mfma_f32_16x16x32_bf16 v[48:51], v[80:83], v[96:99], v[48:51]
    ds_read2_b32 v[142:143], v237 offset0:210 offset1:211
    v_mfma_f32_16x16x32_bf16 v[52:55], v[84:87], v[96:99], v[52:55]
    ds_read_b128 v[176:179], v245 offset:16384
    v_mfma_f32_16x16x32_bf16 v[52:55], v[80:83], v[100:103], v[52:55]
    s_add_u32 m0, s73, 147456
    ds_read2_b32 v[144:145], v238 offset0:80 offset1:81
    v_mfma_f32_16x16x32_bf16 v[52:55], v[76:79], v[104:107], v[52:55]
    buffer_load_dwordx4 v5, s[52:55], s14 offen offset:1024 lds
    ds_read2_b32 v[146:147], v238 offset0:82 offset1:83
    v_mfma_f32_16x16x32_bf16 v[52:55], v[72:75], v[108:111], v[52:55]
    ds_read_b128 v[180:183], v245 offset:20480
    v_mfma_f32_16x16x32_bf16 v[52:55], v[68:71], v[112:115], v[52:55]
    ds_read_b128 v[212:215], v241 offset:8352
    v_mfma_f32_16x16x32_bf16 v[52:55], v[64:67], v[116:119], v[52:55]
    ds_read2_b32 v[148:149], v238 offset0:208 offset1:209
    v_mfma_f32_16x16x32_bf16 v[56:59], v[64:67], v[120:123], v[56:59]
    ds_read_b32 v216, v241 offset:8368
    v_mfma_f32_16x16x32_bf16 v[56:59], v[68:71], v[116:119], v[56:59]
    ds_read2_b32 v[150:151], v238 offset0:210 offset1:211
    v_mfma_f32_16x16x32_bf16 v[56:59], v[72:75], v[112:115], v[56:59]
    ds_read_b128 v[218:221], v241 offset:9376
    v_mfma_f32_16x16x32_bf16 v[56:59], v[76:79], v[108:111], v[56:59]
    ds_read_b128 v[184:187], v245 offset:24576
    v_mfma_f32_16x16x32_bf16 v[56:59], v[80:83], v[104:107], v[56:59]
    ds_read2_b32 v[152:153], v239 offset0:80 offset1:81
    v_mfma_f32_16x16x32_bf16 v[56:59], v[84:87], v[100:103], v[56:59]
    ds_read_b32 v222, v241 offset:9392
    v_mfma_f32_16x16x32_bf16 v[56:59], v[88:91], v[96:99], v[56:59]
    ds_read2_b32 v[154:155], v239 offset0:82 offset1:83
    v_mfma_f32_16x16x32_bf16 v[60:63], v[92:95], v[96:99], v[60:63]
    s_add_u32 m0, s73, 147456
    ds_read_b128 v[224:227], v241 offset:10400
    v_mfma_f32_16x16x32_bf16 v[60:63], v[88:91], v[100:103], v[60:63]
    buffer_load_dwordx4 v6, s[52:55], s14 offen offset:2048 lds
    ds_read_b128 v[188:191], v245 offset:28672
    v_mfma_f32_16x16x32_bf16 v[60:63], v[84:87], v[104:107], v[60:63]
    ds_read_b32 v228, v241 offset:10416
    v_mfma_f32_16x16x32_bf16 v[60:63], v[80:83], v[108:111], v[60:63]
    ds_read2_b32 v[156:157], v239 offset0:208 offset1:209
    v_mfma_f32_16x16x32_bf16 v[60:63], v[76:79], v[112:115], v[60:63]
    ds_read_b128 v[230:233], v241 offset:11424
    v_mfma_f32_16x16x32_bf16 v[60:63], v[72:75], v[116:119], v[60:63]
    ds_read2_b32 v[158:159], v239 offset0:210 offset1:211
    v_mfma_f32_16x16x32_bf16 v[60:63], v[68:71], v[120:123], v[60:63]
    ds_read_b32 v234, v241 offset:11440
    v_mfma_f32_16x16x32_bf16 v[60:63], v[64:67], v[124:127], v[60:63]
    s_waitcnt lgkmcnt(15)
    v_mfma_f32_16x16x32_bf16 v[32:35], v[128:131], v[160:163], v[32:35]
    ds_read_b128 v[96:99], v246 offset:0
    v_mfma_f32_16x16x32_bf16 v[36:39], v[132:135], v[160:163], v[36:39]
    ds_read2_b32 v[64:65], v236 offset0:96 offset1:97
    v_mfma_f32_16x16x32_bf16 v[36:39], v[128:131], v[164:167], v[36:39]
    ds_read2_b32 v[66:67], v236 offset0:98 offset1:99
    v_mfma_f32_16x16x32_bf16 v[40:43], v[128:131], v[168:171], v[40:43]
    s_add_u32 m0, s73, 147456
    ds_read_b128 v[100:103], v246 offset:4096
    v_mfma_f32_16x16x32_bf16 v[40:43], v[132:135], v[164:167], v[40:43]
    buffer_load_dwordx4 v7, s[52:55], s14 offen offset:3072 lds
    ds_read2_b32 v[68:69], v236 offset0:224 offset1:225
    s_waitcnt lgkmcnt(5)
    v_mfma_f32_16x16x32_bf16 v[40:43], v[136:139], v[160:163], v[40:43]
    ds_read2_b32 v[70:71], v236 offset0:226 offset1:227
    v_mfma_f32_16x16x32_bf16 v[44:47], v[140:143], v[160:163], v[44:47]
    s_waitcnt vmcnt(8)
    ds_read_b128 v[104:107], v246 offset:8192
    v_mfma_f32_16x16x32_bf16 v[44:47], v[136:139], v[164:167], v[44:47]
    ds_read2_b32 v[72:73], v237 offset0:96 offset1:97
    v_mfma_f32_16x16x32_bf16 v[44:47], v[132:135], v[168:171], v[44:47]
    ds_read2_b32 v[74:75], v237 offset0:98 offset1:99
    v_lshlrev_b32 v9, 16, v9
    v_mfma_f32_16x16x32_bf16 v[44:47], v[128:131], v[172:175], v[44:47]
    ds_read_b128 v[108:111], v246 offset:12288
    v_mfma_f32_16x16x32_bf16 v[48:51], v[128:131], v[176:179], v[48:51]
    ds_read2_b32 v[76:77], v237 offset0:224 offset1:225
    v_lshlrev_b32 v208, 16, v212
    v_mfma_f32_16x16x32_bf16 v[48:51], v[132:135], v[172:175], v[48:51]
    ds_read2_b32 v[78:79], v237 offset0:226 offset1:227
    v_mfma_f32_16x16x32_bf16 v[48:51], v[136:139], v[168:171], v[48:51]
    ds_read_b128 v[112:115], v246 offset:16384
    v_add_f32 v9, v9, v208
    v_mfma_f32_16x16x32_bf16 v[48:51], v[140:143], v[164:167], v[48:51]
    ds_read2_b32 v[80:81], v238 offset0:96 offset1:97
    v_cvt_pk_bf16_f32 v9, v9, v9
    v_mfma_f32_16x16x32_bf16 v[48:51], v[144:147], v[160:163], v[48:51]
    ds_read2_b32 v[82:83], v238 offset0:98 offset1:99
    v_mfma_f32_16x16x32_bf16 v[52:55], v[148:151], v[160:163], v[52:55]
    ds_write_b16 v242, v9 offset:12480
    v_mfma_f32_16x16x32_bf16 v[52:55], v[144:147], v[164:167], v[52:55]
    ds_read_b128 v[116:119], v246 offset:20480
    v_mfma_f32_16x16x32_bf16 v[52:55], v[140:143], v[168:171], v[52:55]
    ds_write_b16 v242, v9 offset:8322
    v_mfma_f32_16x16x32_bf16 v[52:55], v[136:139], v[172:175], v[52:55]
    ds_read2_b32 v[84:85], v238 offset0:224 offset1:225
    v_mfma_f32_16x16x32_bf16 v[52:55], v[132:135], v[176:179], v[52:55]
    ds_read2_b32 v[86:87], v238 offset0:226 offset1:227
    v_alignbit_b32 v212, v213, v212, 16
    v_mfma_f32_16x16x32_bf16 v[52:55], v[128:131], v[180:183], v[52:55]
    ds_read_b128 v[120:123], v246 offset:24576
    v_alignbit_b32 v213, v214, v213, 16
    v_mfma_f32_16x16x32_bf16 v[56:59], v[128:131], v[184:187], v[56:59]
    ds_read2_b32 v[88:89], v239 offset0:96 offset1:97
    s_waitcnt vmcnt(4)
    s_barrier
    v_mfma_f32_16x16x32_bf16 v[56:59], v[132:135], v[180:183], v[56:59]
    v_add_u32 v10, -131072, v10
    v_alignbit_b32 v214, v215, v214, 16
    v_mfma_f32_16x16x32_bf16 v[56:59], v[136:139], v[176:179], v[56:59]
    ds_read_b64_tr_b16 a[16:17], v10 offset:49152
    v_alignbit_b32 v215, v216, v215, 16
    v_mfma_f32_16x16x32_bf16 v[56:59], v[140:143], v[172:175], v[56:59]
    ds_write_b128 v241, v[212:215] offset:12512
    v_mfma_f32_16x16x32_bf16 v[56:59], v[144:147], v[168:171], v[56:59]
    ds_read_b64_tr_b16 a[18:19], v10 offset:51200
    v_mfma_f32_16x16x32_bf16 v[56:59], v[148:151], v[164:167], v[56:59]
    ds_read_b64_tr_b16 a[24:25], v10 offset:53248
    v_mfma_f32_16x16x32_bf16 v[56:59], v[152:155], v[160:163], v[56:59]
    ds_read_b64_tr_b16 a[26:27], v10 offset:55296
    v_mfma_f32_16x16x32_bf16 v[60:63], v[156:159], v[160:163], v[60:63]
    ds_read2_b32 v[90:91], v239 offset0:98 offset1:99
    v_add_u32 v11, -131072, v11
    v_alignbit_b32 v218, v219, v218, 16
    v_mfma_f32_16x16x32_bf16 v[60:63], v[152:155], v[164:167], v[60:63]
    ds_read_b64_tr_b16 a[20:21], v11 offset:49152
    v_alignbit_b32 v219, v220, v219, 16
    v_mfma_f32_16x16x32_bf16 v[60:63], v[148:151], v[168:171], v[60:63]
    ds_read_b128 v[124:127], v246 offset:28672
    ds_read2_b32 v[92:93], v239 offset0:224 offset1:225
    v_mfma_f32_16x16x32_bf16 v[60:63], v[144:147], v[172:175], v[60:63]
    ds_read_b64_tr_b16 a[22:23], v11 offset:51200
    v_alignbit_b32 v220, v221, v220, 16
    v_mfma_f32_16x16x32_bf16 v[60:63], v[140:143], v[176:179], v[60:63]
    ds_read_b64_tr_b16 a[28:29], v11 offset:53248
    ds_read2_b32 v[94:95], v239 offset0:226 offset1:227
    v_mfma_f32_16x16x32_bf16 v[60:63], v[136:139], v[180:183], v[60:63]
    ds_read_b64_tr_b16 a[30:31], v11 offset:55296
    v_alignbit_b32 v221, v222, v221, 16
    v_mfma_f32_16x16x32_bf16 v[60:63], v[132:135], v[184:187], v[60:63]
    ds_write_b128 v241, v[218:221] offset:13536
    v_mfma_f32_16x16x32_bf16 v[60:63], v[128:131], v[188:191], v[60:63]
    s_waitcnt lgkmcnt(15)
    v_mfma_f32_16x16x32_bf16 v[32:35], v[64:67], v[96:99], v[32:35]
    ds_read_b128 v[160:163], v247 offset:0
    s_waitcnt lgkmcnt(2)
    s_barrier
    v_mfma_f32_16x16x32_bf16 v[36:39], v[68:71], v[96:99], v[36:39]
    v_alignbit_b32 v224, v225, v224, 16
    v_mfma_f32_16x16x32_bf16 v[36:39], v[64:67], v[100:103], v[36:39]
    ds_read_b128 v[164:167], v247 offset:4096
    v_mfma_f32_16x16x32_bf16 v[40:43], v[64:67], v[104:107], v[40:43]
    s_lshl_b32 s14, s87, 18
    ds_read_b128 v[168:171], v247 offset:8192
L_pl_X_2:
    s_cbranch_execz L_pl_X_6
    v_mfma_f32_16x16x32_bf16 v[40:43], v[68:71], v[100:103], v[40:43]
    s_add_u32 m0, s73, 49152
    ds_read_b128 v[172:175], v247 offset:12288
    v_mfma_f32_16x16x32_bf16 v[40:43], v[72:75], v[96:99], v[40:43]
    buffer_load_dwordx4 v4, s[52:55], s14 offen offset:0 lds
    v_alignbit_b32 v225, v226, v225, 16
    v_mfma_f32_16x16x32_bf16 v[44:47], v[76:79], v[96:99], v[44:47]
    ds_read_b128 v[176:179], v247 offset:16384
    v_mfma_f32_16x16x32_bf16 v[44:47], v[72:75], v[100:103], v[44:47]
    ds_read_b128 v[180:183], v247 offset:20480
    v_mfma_f32_16x16x32_bf16 v[44:47], v[68:71], v[104:107], v[44:47]
    ds_read_b128 v[184:187], v247 offset:24576
    v_mfma_f32_16x16x32_bf16 v[44:47], v[64:67], v[108:111], v[44:47]
    v_alignbit_b32 v226, v227, v226, 16
    v_mfma_f32_16x16x32_bf16 v[48:51], v[64:67], v[112:115], v[48:51]
    ds_read_b128 v[188:191], v247 offset:28672
    v_mfma_f32_16x16x32_bf16 v[48:51], v[68:71], v[108:111], v[48:51]
    ds_read2_b32 v[128:129], v236 offset0:112 offset1:113
    v_mfma_f32_16x16x32_bf16 v[48:51], v[72:75], v[104:107], v[48:51]
    v_alignbit_b32 v227, v228, v227, 16
    v_mfma_f32_16x16x32_bf16 v[48:51], v[76:79], v[100:103], v[48:51]
    ds_read2_b32 v[130:131], v236 offset0:114 offset1:115
    v_mfma_f32_16x16x32_bf16 v[48:51], v[80:83], v[96:99], v[48:51]
    ds_read2_b32 v[132:133], v236 offset0:240 offset1:241
    v_mfma_f32_16x16x32_bf16 v[52:55], v[84:87], v[96:99], v[52:55]
    ds_write_b128 v241, v[224:227] offset:14560
    v_mfma_f32_16x16x32_bf16 v[52:55], v[80:83], v[100:103], v[52:55]
    s_add_u32 m0, s73, 49152
    ds_read2_b32 v[134:135], v236 offset0:242 offset1:243
    v_mfma_f32_16x16x32_bf16 v[52:55], v[76:79], v[104:107], v[52:55]
    buffer_load_dwordx4 v5, s[52:55], s14 offen offset:1024 lds
    ds_read2_b32 v[136:137], v237 offset0:112 offset1:113
    v_mfma_f32_16x16x32_bf16 v[52:55], v[72:75], v[108:111], v[52:55]
    s_add_u32 s6, s12, 4718592
    ds_read2_b32 v[138:139], v237 offset0:114 offset1:115
    v_mfma_f32_16x16x32_bf16 v[52:55], v[68:71], v[112:115], v[52:55]
    ds_read2_b32 v[140:141], v237 offset0:240 offset1:241
    v_alignbit_b32 v230, v231, v230, 16
    v_mfma_f32_16x16x32_bf16 v[52:55], v[64:67], v[116:119], v[52:55]
    ds_read2_b32 v[142:143], v237 offset0:242 offset1:243
    v_xor_b32 v244, 64, v244
    v_mfma_f32_16x16x32_bf16 v[56:59], v[64:67], v[120:123], v[56:59]
    ds_read2_b32 v[144:145], v238 offset0:112 offset1:113
    v_mfma_f32_16x16x32_bf16 v[56:59], v[68:71], v[116:119], v[56:59]
    ds_read2_b32 v[146:147], v238 offset0:114 offset1:115
    v_mfma_f32_16x16x32_bf16 v[56:59], v[72:75], v[112:115], v[56:59]
    ds_read2_b32 v[148:149], v238 offset0:240 offset1:241
    v_alignbit_b32 v231, v232, v231, 16
    v_mfma_f32_16x16x32_bf16 v[56:59], v[76:79], v[108:111], v[56:59]
    ds_read2_b32 v[150:151], v238 offset0:242 offset1:243
    v_xor_b32 v245, 64, v245
    v_mfma_f32_16x16x32_bf16 v[56:59], v[80:83], v[104:107], v[56:59]
    ds_read2_b32 v[152:153], v239 offset0:112 offset1:113
    v_mfma_f32_16x16x32_bf16 v[56:59], v[84:87], v[100:103], v[56:59]
    ds_read2_b32 v[154:155], v239 offset0:114 offset1:115
    v_mfma_f32_16x16x32_bf16 v[56:59], v[88:91], v[96:99], v[56:59]
    ds_read2_b32 v[156:157], v239 offset0:240 offset1:241
    v_alignbit_b32 v232, v233, v232, 16
    v_mfma_f32_16x16x32_bf16 v[60:63], v[92:95], v[96:99], v[60:63]
    s_add_u32 m0, s73, 49152
    ds_read2_b32 v[158:159], v239 offset0:242 offset1:243
    v_mfma_f32_16x16x32_bf16 v[60:63], v[88:91], v[100:103], v[60:63]
    buffer_load_dwordx4 v6, s[52:55], s14 offen offset:2048 lds
    v_xor_b32 v246, 64, v246
    v_mfma_f32_16x16x32_bf16 v[60:63], v[84:87], v[104:107], v[60:63]
    v_alignbit_b32 v233, v234, v233, 16
    v_add_u32 v236, 8320, v236
    v_mfma_f32_16x16x32_bf16 v[60:63], v[80:83], v[108:111], v[60:63]
    v_add_u32 v237, 8320, v237
    v_mfma_f32_16x16x32_bf16 v[60:63], v[76:79], v[112:115], v[60:63]
    v_mfma_f32_16x16x32_bf16 v[60:63], v[72:75], v[116:119], v[60:63]
    v_xor_b32 v247, 64, v247
    v_add_u32 v238, 8320, v238
    v_mfma_f32_16x16x32_bf16 v[60:63], v[68:71], v[120:123], v[60:63]
    ds_write_b128 v241, v[230:233] offset:15584
    v_mfma_f32_16x16x32_bf16 v[60:63], v[64:67], v[124:127], v[60:63]
    v_add_u32 v239, 8320, v239
    s_waitcnt lgkmcnt(1)
    v_mfma_f32_16x16x32_bf16 v[60:63], v[128:131], v[188:191], v[60:63]
    ds_read_b128 v[96:99], v244 offset:2048
    v_mfma_f32_16x16x32_bf16 v[60:63], v[132:135], v[184:187], v[60:63]
    ds_read2_b32 v[64:65], v236 offset0:0 offset1:1
    v_mfma_f32_16x16x32_bf16 v[60:63], v[136:139], v[180:183], v[60:63]
    ds_read2_b32 v[66:67], v236 offset0:2 offset1:3
    v_mfma_f32_16x16x32_bf16 v[60:63], v[140:143], v[176:179], v[60:63]
    s_add_u32 m0, s73, 49152
    ds_read_b128 v[100:103], v244 offset:6144
    v_mfma_f32_16x16x32_bf16 v[60:63], v[144:147], v[172:175], v[60:63]
    buffer_load_dwordx4 v7, s[52:55], s14 offen offset:3072 lds
    ds_read2_b32 v[68:69], v236 offset0:128 offset1:129
    v_mfma_f32_16x16x32_bf16 v[60:63], v[148:151], v[168:171], v[60:63]
    ds_read2_b32 v[70:71], v236 offset0:130 offset1:131
    v_mfma_f32_16x16x32_bf16 v[60:63], v[152:155], v[164:167], v[60:63]
    ds_read_b128 v[104:107], v244 offset:10240
    v_mfma_f32_16x16x32_bf16 v[60:63], v[156:159], v[160:163], v[60:63]
    ds_read2_b32 v[72:73], v237 offset0:0 offset1:1
    v_mfma_f32_16x16x32_bf16 v[56:59], v[128:131], v[184:187], v[56:59]
    ds_read2_b32 v[74:75], v237 offset0:2 offset1:3
    v_mfma_f32_16x16x32_bf16 v[56:59], v[132:135], v[180:183], v[56:59]
    ds_read_b128 v[108:111], v244 offset:14336
    v_mfma_f32_16x16x32_bf16 v[56:59], v[136:139], v[176:179], v[56:59]
    ds_read2_b32 v[76:77], v237 offset0:128 offset1:129
    v_mfma_f32_16x16x32_bf16 v[56:59], v[140:143], v[172:175], v[56:59]
    ds_read2_b32 v[78:79], v237 offset0:130 offset1:131
    v_mfma_f32_16x16x32_bf16 v[56:59], v[144:147], v[168:171], v[56:59]
    ds_read_b128 v[112:115], v244 offset:18432
    v_mfma_f32_16x16x32_bf16 v[56:59], v[148:151], v[164:167], v[56:59]
    ds_read2_b32 v[80:81], v238 offset0:0 offset1:1
    v_cvt_pk_bf16_f32 v206, v60, v61
    v_mfma_f32_16x16x32_bf16 v[56:59], v[152:155], v[160:163], v[56:59]
    ds_read2_b32 v[82:83], v238 offset0:2 offset1:3
    v_mfma_f32_16x16x32_bf16 v[52:55], v[128:131], v[180:183], v[52:55]
    ds_read_b128 v[116:119], v244 offset:22528
    v_mfma_f32_16x16x32_bf16 v[52:55], v[132:135], v[176:179], v[52:55]
    ds_read2_b32 v[84:85], v238 offset0:128 offset1:129
    v_cvt_pk_bf16_f32 v207, v62, v63
    v_mfma_f32_16x16x32_bf16 v[52:55], v[136:139], v[172:175], v[52:55]
    ds_read2_b32 v[86:87], v238 offset0:130 offset1:131
    v_mfma_f32_16x16x32_bf16 v[52:55], v[140:143], v[168:171], v[52:55]
    buffer_store_dwordx2 v[206:207], v8, s[44:47], s6 offen offset:3584 sc1
    ds_read_b128 v[120:123], v244 offset:26624
    v_mfma_f32_16x16x32_bf16 v[52:55], v[144:147], v[164:167], v[52:55]
    ds_read2_b32 v[88:89], v239 offset0:0 offset1:1
    v_mfma_f32_16x16x32_bf16 v[52:55], v[148:151], v[160:163], v[52:55]
    ds_read2_b32 v[90:91], v239 offset0:2 offset1:3
    v_mfma_f32_16x16x32_bf16 v[48:51], v[128:131], v[176:179], v[48:51]
    s_waitcnt vmcnt(5)
    s_barrier
    v_cvt_pk_bf16_f32 v204, v56, v57
    v_mfma_f32_16x16x32_bf16 v[48:51], v[132:135], v[172:175], v[48:51]
    ds_read_b128 v[124:127], v244 offset:30720
    v_add_u32 v10, 131072, v10
    v_mfma_f32_16x16x32_bf16 v[48:51], v[136:139], v[168:171], v[48:51]
    ds_read_b64_tr_b16 a[32:33], v10 offset:16384
    v_mfma_f32_16x16x32_bf16 v[48:51], v[140:143], v[164:167], v[48:51]
    ds_read2_b32 v[92:93], v239 offset0:128 offset1:129
    v_cvt_pk_bf16_f32 v205, v58, v59
    v_mfma_f32_16x16x32_bf16 v[48:51], v[144:147], v[160:163], v[48:51]
    ds_read_b64_tr_b16 a[34:35], v10 offset:18432
    v_mfma_f32_16x16x32_bf16 v[44:47], v[128:131], v[172:175], v[44:47]
    buffer_store_dwordx2 v[204:205], v8, s[44:47], s6 offen offset:3072 sc1
    ds_read_b64_tr_b16 a[40:41], v10 offset:20480
    v_mfma_f32_16x16x32_bf16 v[44:47], v[132:135], v[168:171], v[44:47]
    ds_read_b64_tr_b16 a[42:43], v10 offset:22528
    v_mfma_f32_16x16x32_bf16 v[44:47], v[136:139], v[164:167], v[44:47]
    ds_read2_b32 v[94:95], v239 offset0:130 offset1:131
    v_add_u32 v11, 131072, v11
    v_mfma_f32_16x16x32_bf16 v[44:47], v[140:143], v[160:163], v[44:47]
    ds_read_b64_tr_b16 a[36:37], v11 offset:16384
    v_cvt_pk_bf16_f32 v202, v52, v53
    v_mfma_f32_16x16x32_bf16 v[40:43], v[128:131], v[168:171], v[40:43]
    v_mfma_f32_16x16x32_bf16 v[40:43], v[132:135], v[164:167], v[40:43]
    ds_read_b64_tr_b16 a[38:39], v11 offset:18432
    v_mfma_f32_16x16x32_bf16 v[40:43], v[136:139], v[160:163], v[40:43]
    ds_read_b64_tr_b16 a[44:45], v11 offset:20480
    v_cvt_pk_bf16_f32 v203, v54, v55
    v_mfma_f32_16x16x32_bf16 v[36:39], v[128:131], v[164:167], v[36:39]
    ds_read_b64_tr_b16 a[46:47], v11 offset:22528
    v_mfma_f32_16x16x32_bf16 v[36:39], v[132:135], v[160:163], v[36:39]
    buffer_store_dwordx2 v[202:203], v8, s[44:47], s6 offen offset:2560 sc1
    v_mfma_f32_16x16x32_bf16 v[32:35], v[128:131], v[160:163], v[32:35]
    s_waitcnt lgkmcnt(4)
    v_mfma_f32_16x16x32_bf16 v[60:63], v[64:67], v[124:127], 0
    ds_read_b128 v[160:163], v245 offset:2048
    s_waitcnt lgkmcnt(1)
    s_barrier
    v_mfma_f32_16x16x32_bf16 v[60:63], v[68:71], v[120:123], v[60:63]
    v_cvt_pk_bf16_f32 v200, v48, v49
    v_mfma_f32_16x16x32_bf16 v[60:63], v[72:75], v[116:119], v[60:63]
    ds_read2_b32 v[128:129], v236 offset0:16 offset1:17
    v_mfma_f32_16x16x32_bf16 v[60:63], v[76:79], v[112:115], v[60:63]
    ds_read2_b32 v[130:131], v236 offset0:18 offset1:19
    s_lshl_b32 s14, s88, 18
    v_cvt_pk_bf16_f32 v201, v50, v51
    v_mfma_f32_16x16x32_bf16 v[60:63], v[80:83], v[108:111], v[60:63]
    s_add_u32 m0, s73, 147456
    v_mfma_f32_16x16x32_bf16 v[60:63], v[84:87], v[104:107], v[60:63]
    buffer_load_dwordx4 v4, s[52:55], s14 offen offset:0 lds
    ds_read_b128 v[164:167], v245 offset:6144
    v_mfma_f32_16x16x32_bf16 v[60:63], v[88:91], v[100:103], v[60:63]
    buffer_store_dwordx2 v[200:201], v8, s[44:47], s6 offen offset:2048 sc1
    ds_read2_b32 v[132:133], v236 offset0:144 offset1:145
    v_mfma_f32_16x16x32_bf16 v[60:63], v[92:95], v[96:99], v[60:63]
    s_add_u32 s13, s12, 32768
    v_cvt_pk_bf16_f32 v198, v44, v45
    v_mfma_f32_16x16x32_bf16 v[56:59], v[64:67], v[120:123], 0
    ds_read2_b32 v[134:135], v236 offset0:146 offset1:147
    v_mfma_f32_16x16x32_bf16 v[56:59], v[68:71], v[116:119], v[56:59]
    s_add_u32 m0, s74, 32
    ds_read_b128 v[168:171], v245 offset:10240
    v_mfma_f32_16x16x32_bf16 v[56:59], v[72:75], v[112:115], v[56:59]
    buffer_load_dwordx4 v240, s[48:51], s13 offen offset:0 lds
    v_cvt_pk_bf16_f32 v199, v46, v47
    v_mfma_f32_16x16x32_bf16 v[56:59], v[76:79], v[108:111], v[56:59]
    ds_read2_b32 v[136:137], v237 offset0:16 offset1:17
    v_mfma_f32_16x16x32_bf16 v[56:59], v[80:83], v[104:107], v[56:59]
    buffer_store_dwordx2 v[198:199], v8, s[44:47], s6 offen offset:1536 sc1
    ds_read2_b32 v[138:139], v237 offset0:18 offset1:19
    v_mfma_f32_16x16x32_bf16 v[56:59], v[84:87], v[100:103], v[56:59]
    ds_read_b128 v[172:175], v245 offset:14336
    v_mfma_f32_16x16x32_bf16 v[56:59], v[88:91], v[96:99], v[56:59]
    v_cvt_pk_bf16_f32 v196, v40, v41
    v_mfma_f32_16x16x32_bf16 v[52:55], v[64:67], v[116:119], 0
    ds_read2_b32 v[140:141], v237 offset0:144 offset1:145
    v_mfma_f32_16x16x32_bf16 v[52:55], v[68:71], v[112:115], v[52:55]
    ds_read2_b32 v[142:143], v237 offset0:146 offset1:147
    s_add_u32 m0, s73, 147456
    v_cvt_pk_bf16_f32 v197, v42, v43
    v_mfma_f32_16x16x32_bf16 v[52:55], v[72:75], v[108:111], v[52:55]
    buffer_load_dwordx4 v5, s[52:55], s14 offen offset:1024 lds
    v_mfma_f32_16x16x32_bf16 v[52:55], v[76:79], v[104:107], v[52:55]
    buffer_store_dwordx2 v[196:197], v8, s[44:47], s6 offen offset:1024 sc1
    ds_read_b128 v[176:179], v245 offset:18432
    s_add_u32 m0, s74, 32
    v_mfma_f32_16x16x32_bf16 v[52:55], v[80:83], v[100:103], v[52:55]
    buffer_load_dwordx4 v240, s[48:51], s13 offen offset:1024 lds
    ds_read2_b32 v[144:145], v238 offset0:16 offset1:17
    v_mfma_f32_16x16x32_bf16 v[52:55], v[84:87], v[96:99], v[52:55]
    v_mfma_f32_16x16x32_bf16 v[48:51], v[64:67], v[112:115], 0
    ds_read2_b32 v[146:147], v238 offset0:18 offset1:19
    v_cvt_pk_bf16_f32 v194, v36, v37
    v_mfma_f32_16x16x32_bf16 v[48:51], v[68:71], v[108:111], v[48:51]
    ds_read_b128 v[180:183], v245 offset:22528
    v_mfma_f32_16x16x32_bf16 v[48:51], v[72:75], v[104:107], v[48:51]
    v_cvt_pk_bf16_f32 v195, v38, v39
    v_mfma_f32_16x16x32_bf16 v[48:51], v[76:79], v[100:103], v[48:51]
    buffer_store_dwordx2 v[194:195], v8, s[44:47], s6 offen offset:512 sc1
    ds_read2_b32 v[148:149], v238 offset0:144 offset1:145
    s_add_u32 m0, s74, 32
    v_mfma_f32_16x16x32_bf16 v[48:51], v[80:83], v[96:99], v[48:51]
    buffer_load_dwordx4 v240, s[48:51], s13 offen offset:2048 lds
    ds_read2_b32 v[150:151], v238 offset0:146 offset1:147
    v_mfma_f32_16x16x32_bf16 v[44:47], v[64:67], v[108:111], 0
    ds_read_b128 v[184:187], v245 offset:26624
    v_mfma_f32_16x16x32_bf16 v[44:47], v[68:71], v[104:107], v[44:47]
    v_cvt_pk_bf16_f32 v192, v32, v33
    v_mfma_f32_16x16x32_bf16 v[44:47], v[72:75], v[100:103], v[44:47]
    s_add_u32 m0, s73, 147456
    ds_read2_b32 v[152:153], v239 offset0:16 offset1:17
    v_mfma_f32_16x16x32_bf16 v[44:47], v[76:79], v[96:99], v[44:47]
    buffer_load_dwordx4 v6, s[52:55], s14 offen offset:2048 lds
    v_cvt_pk_bf16_f32 v193, v34, v35
    v_mfma_f32_16x16x32_bf16 v[40:43], v[64:67], v[104:107], 0
    ds_read2_b32 v[154:155], v239 offset0:18 offset1:19
    v_mfma_f32_16x16x32_bf16 v[40:43], v[68:71], v[100:103], v[40:43]
    buffer_store_dwordx2 v[192:193], v8, s[44:47], s6 offen offset:0 sc1
    ds_read_b128 v[188:191], v245 offset:30720
    v_mfma_f32_16x16x32_bf16 v[40:43], v[72:75], v[96:99], v[40:43]
    s_add_u32 m0, s74, 32
    ds_read2_b32 v[156:157], v239 offset0:144 offset1:145
    v_mfma_f32_16x16x32_bf16 v[36:39], v[64:67], v[100:103], 0
    buffer_load_dwordx4 v240, s[48:51], s13 offen offset:3072 lds
    v_mfma_f32_16x16x32_bf16 v[36:39], v[68:71], v[96:99], v[36:39]
    ds_read2_b32 v[158:159], v239 offset0:146 offset1:147
    v_mfma_f32_16x16x32_bf16 v[32:35], v[64:67], v[96:99], 0
    s_waitcnt lgkmcnt(12)
    v_mfma_f32_16x16x32_bf16 v[32:35], v[128:131], v[160:163], v[32:35]
    ds_read_b128 v[96:99], v246 offset:2048
    v_mfma_f32_16x16x32_bf16 v[36:39], v[132:135], v[160:163], v[36:39]
    v_mfma_f32_16x16x32_bf16 v[36:39], v[128:131], v[164:167], v[36:39]
    ds_read2_b32 v[64:65], v236 offset0:32 offset1:33
    v_mfma_f32_16x16x32_bf16 v[40:43], v[128:131], v[168:171], v[40:43]
    s_add_u32 m0, s73, 147456
    ds_read2_b32 v[66:67], v236 offset0:34 offset1:35
    v_mfma_f32_16x16x32_bf16 v[40:43], v[132:135], v[164:167], v[40:43]
    buffer_load_dwordx4 v7, s[52:55], s14 offen offset:3072 lds
    v_mfma_f32_16x16x32_bf16 v[40:43], v[136:139], v[160:163], v[40:43]
    ds_read_b128 v[100:103], v246 offset:6144
    v_mfma_f32_16x16x32_bf16 v[44:47], v[140:143], v[160:163], v[44:47]
    ds_read2_b32 v[68:69], v236 offset0:160 offset1:161
    v_mfma_f32_16x16x32_bf16 v[44:47], v[136:139], v[164:167], v[44:47]
    ds_read2_b32 v[70:71], v236 offset0:162 offset1:163
    v_mfma_f32_16x16x32_bf16 v[44:47], v[132:135], v[168:171], v[44:47]
    ds_read_b128 v[104:107], v246 offset:10240
    v_mfma_f32_16x16x32_bf16 v[44:47], v[128:131], v[172:175], v[44:47]
    ds_read2_b32 v[72:73], v237 offset0:32 offset1:33
    s_waitcnt lgkmcnt(8)
    v_mfma_f32_16x16x32_bf16 v[48:51], v[128:131], v[176:179], v[48:51]
    ds_read2_b32 v[74:75], v237 offset0:34 offset1:35
    v_mfma_f32_16x16x32_bf16 v[48:51], v[132:135], v[172:175], v[48:51]
    ds_read_b128 v[108:111], v246 offset:14336
    v_mfma_f32_16x16x32_bf16 v[48:51], v[136:139], v[168:171], v[48:51]
    v_mov_b32 v9, 16
    buffer_load_ushort v9, v9, s[56:59], s70 offen
    v_mfma_f32_16x16x32_bf16 v[48:51], v[140:143], v[164:167], v[48:51]
    ds_read2_b32 v[76:77], v237 offset0:160 offset1:161
    v_mfma_f32_16x16x32_bf16 v[48:51], v[144:147], v[160:163], v[48:51]
    ds_read2_b32 v[78:79], v237 offset0:162 offset1:163
    s_waitcnt vmcnt(17)
    s_barrier
    v_mfma_f32_16x16x32_bf16 v[52:55], v[148:151], v[160:163], v[52:55]
    ds_read_b128 v[112:115], v246 offset:18432
    v_add_u32 v10, -131072, v10
    v_mfma_f32_16x16x32_bf16 v[52:55], v[144:147], v[164:167], v[52:55]
    ds_read_b64_tr_b16 a[48:49], v10 offset:49152
    v_mfma_f32_16x16x32_bf16 v[52:55], v[140:143], v[168:171], v[52:55]
    ds_read_b64_tr_b16 a[50:51], v10 offset:51200
    v_mfma_f32_16x16x32_bf16 v[52:55], v[136:139], v[172:175], v[52:55]
    ds_read2_b32 v[80:81], v238 offset0:32 offset1:33
    v_mfma_f32_16x16x32_bf16 v[52:55], v[132:135], v[176:179], v[52:55]
    ds_read_b64_tr_b16 a[56:57], v10 offset:53248
    v_mfma_f32_16x16x32_bf16 v[52:55], v[128:131], v[180:183], v[52:55]
    ds_read_b64_tr_b16 a[58:59], v10 offset:55296
    v_mfma_f32_16x16x32_bf16 v[56:59], v[128:131], v[184:187], v[56:59]
    ds_read2_b32 v[82:83], v238 offset0:34 offset1:35
    v_add_u32 v11, -131072, v11
    v_mfma_f32_16x16x32_bf16 v[56:59], v[132:135], v[180:183], v[56:59]
    ds_read_b64_tr_b16 a[52:53], v11 offset:49152
    v_mfma_f32_16x16x32_bf16 v[56:59], v[136:139], v[176:179], v[56:59]
    ds_read_b64_tr_b16 a[54:55], v11 offset:51200
    v_mfma_f32_16x16x32_bf16 v[56:59], v[140:143], v[172:175], v[56:59]
    ds_read_b128 v[116:119], v246 offset:22528
    v_mfma_f32_16x16x32_bf16 v[56:59], v[144:147], v[168:171], v[56:59]
    ds_read_b64_tr_b16 a[60:61], v11 offset:53248
    v_mfma_f32_16x16x32_bf16 v[56:59], v[148:151], v[164:167], v[56:59]
    ds_read_b64_tr_b16 a[62:63], v11 offset:55296
    v_mfma_f32_16x16x32_bf16 v[56:59], v[152:155], v[160:163], v[56:59]
    ds_read2_b32 v[84:85], v238 offset0:160 offset1:161
    v_mfma_f32_16x16x32_bf16 v[60:63], v[156:159], v[160:163], v[60:63]
    ds_read2_b32 v[86:87], v238 offset0:162 offset1:163
    v_mfma_f32_16x16x32_bf16 v[60:63], v[152:155], v[164:167], v[60:63]
    ds_read_b128 v[120:123], v246 offset:26624
    v_mfma_f32_16x16x32_bf16 v[60:63], v[148:151], v[168:171], v[60:63]
    ds_read2_b32 v[88:89], v239 offset0:32 offset1:33
    v_mfma_f32_16x16x32_bf16 v[60:63], v[144:147], v[172:175], v[60:63]
    ds_read2_b32 v[90:91], v239 offset0:34 offset1:35
    v_mfma_f32_16x16x32_bf16 v[60:63], v[140:143], v[176:179], v[60:63]
    ds_read_b128 v[124:127], v246 offset:30720
    v_mfma_f32_16x16x32_bf16 v[60:63], v[136:139], v[180:183], v[60:63]
    ds_read2_b32 v[92:93], v239 offset0:160 offset1:161
    v_mfma_f32_16x16x32_bf16 v[60:63], v[132:135], v[184:187], v[60:63]
    ds_read2_b32 v[94:95], v239 offset0:162 offset1:163
    v_mfma_f32_16x16x32_bf16 v[60:63], v[128:131], v[188:191], v[60:63]
    s_waitcnt lgkmcnt(15)
    v_mfma_f32_16x16x32_bf16 v[32:35], v[64:67], v[96:99], v[32:35]
    ds_read_b128 v[160:163], v247 offset:2048
    v_mfma_f32_16x16x32_bf16 v[36:39], v[68:71], v[96:99], v[36:39]
    v_mfma_f32_16x16x32_bf16 v[36:39], v[64:67], v[100:103], v[36:39]
    ds_read2_b32 v[128:129], v236 offset0:48 offset1:49
    v_mfma_f32_16x16x32_bf16 v[40:43], v[64:67], v[104:107], v[40:43]
    ds_read2_b32 v[130:131], v236 offset0:50 offset1:51
    v_mfma_f32_16x16x32_bf16 v[40:43], v[68:71], v[100:103], v[40:43]
    v_mfma_f32_16x16x32_bf16 v[40:43], v[72:75], v[96:99], v[40:43]
    ds_read_b128 v[164:167], v247 offset:6144
    v_mfma_f32_16x16x32_bf16 v[44:47], v[76:79], v[96:99], v[44:47]
    ds_read2_b32 v[132:133], v236 offset0:176 offset1:177
    v_mfma_f32_16x16x32_bf16 v[44:47], v[72:75], v[100:103], v[44:47]
    s_waitcnt lgkmcnt(13)
    s_barrier
    v_mfma_f32_16x16x32_bf16 v[44:47], v[68:71], v[104:107], v[44:47]
    ds_read2_b32 v[134:135], v236 offset0:178 offset1:179
    v_mfma_f32_16x16x32_bf16 v[44:47], v[64:67], v[108:111], v[44:47]
    ds_read_b128 v[168:171], v247 offset:10240
    s_waitcnt lgkmcnt(7)
    v_mfma_f32_16x16x32_bf16 v[48:51], v[64:67], v[112:115], v[48:51]
    ds_read2_b32 v[136:137], v237 offset0:48 offset1:49
    v_mfma_f32_16x16x32_bf16 v[48:51], v[68:71], v[108:111], v[48:51]
    v_mfma_f32_16x16x32_bf16 v[48:51], v[72:75], v[104:107], v[48:51]
    ds_read2_b32 v[138:139], v237 offset0:50 offset1:51
    v_mfma_f32_16x16x32_bf16 v[48:51], v[76:79], v[100:103], v[48:51]
    ds_read_b128 v[172:175], v247 offset:14336
    v_mfma_f32_16x16x32_bf16 v[48:51], v[80:83], v[96:99], v[48:51]
    v_mfma_f32_16x16x32_bf16 v[52:55], v[84:87], v[96:99], v[52:55]
    ds_read2_b32 v[140:141], v237 offset0:176 offset1:177
    v_mfma_f32_16x16x32_bf16 v[52:55], v[80:83], v[100:103], v[52:55]
    ds_read2_b32 v[142:143], v237 offset0:178 offset1:179
    v_mfma_f32_16x16x32_bf16 v[52:55], v[76:79], v[104:107], v[52:55]
    v_mfma_f32_16x16x32_bf16 v[52:55], v[72:75], v[108:111], v[52:55]
    ds_read_b128 v[176:179], v247 offset:18432
    v_mfma_f32_16x16x32_bf16 v[52:55], v[68:71], v[112:115], v[52:55]
    ds_read2_b32 v[144:145], v238 offset0:48 offset1:49
    v_mfma_f32_16x16x32_bf16 v[52:55], v[64:67], v[116:119], v[52:55]
    v_mfma_f32_16x16x32_bf16 v[56:59], v[64:67], v[120:123], v[56:59]
    ds_read2_b32 v[146:147], v238 offset0:50 offset1:51
    v_mfma_f32_16x16x32_bf16 v[56:59], v[68:71], v[116:119], v[56:59]
    ds_read_b128 v[180:183], v247 offset:22528
    v_mfma_f32_16x16x32_bf16 v[56:59], v[72:75], v[112:115], v[56:59]
    v_mfma_f32_16x16x32_bf16 v[56:59], v[76:79], v[108:111], v[56:59]
    ds_read2_b32 v[148:149], v238 offset0:176 offset1:177
    v_mfma_f32_16x16x32_bf16 v[56:59], v[80:83], v[104:107], v[56:59]
    ds_read2_b32 v[150:151], v238 offset0:178 offset1:179
    v_mfma_f32_16x16x32_bf16 v[56:59], v[84:87], v[100:103], v[56:59]
    ds_read_b128 v[184:187], v247 offset:26624
    v_mfma_f32_16x16x32_bf16 v[56:59], v[88:91], v[96:99], v[56:59]
    v_mfma_f32_16x16x32_bf16 v[60:63], v[92:95], v[96:99], v[60:63]
    ds_read2_b32 v[152:153], v239 offset0:48 offset1:49
    v_mfma_f32_16x16x32_bf16 v[60:63], v[88:91], v[100:103], v[60:63]
    ds_read2_b32 v[154:155], v239 offset0:50 offset1:51
    v_mfma_f32_16x16x32_bf16 v[60:63], v[84:87], v[104:107], v[60:63]
    v_mfma_f32_16x16x32_bf16 v[60:63], v[80:83], v[108:111], v[60:63]
    ds_read_b128 v[188:191], v247 offset:30720
    v_mfma_f32_16x16x32_bf16 v[60:63], v[76:79], v[112:115], v[60:63]
    ds_read2_b32 v[156:157], v239 offset0:176 offset1:177
    v_mfma_f32_16x16x32_bf16 v[60:63], v[72:75], v[116:119], v[60:63]
    v_mfma_f32_16x16x32_bf16 v[60:63], v[68:71], v[120:123], v[60:63]
    ds_read2_b32 v[158:159], v239 offset0:178 offset1:179
    v_mfma_f32_16x16x32_bf16 v[60:63], v[64:67], v[124:127], v[60:63]
    s_waitcnt lgkmcnt(12)
    v_mfma_f32_16x16x32_bf16 v[32:35], v[128:131], v[160:163], v[32:35]
    ds_read_b128 v[96:99], v244 offset:0
    v_mfma_f32_16x16x32_bf16 v[36:39], v[132:135], v[160:163], v[36:39]
    v_mfma_f32_16x16x32_bf16 v[36:39], v[128:131], v[164:167], v[36:39]
    ds_read2_b32 v[64:65], v236 offset0:64 offset1:65
    v_mfma_f32_16x16x32_bf16 v[40:43], v[128:131], v[168:171], v[40:43]
    ds_read2_b32 v[66:67], v236 offset0:66 offset1:67
    v_mfma_f32_16x16x32_bf16 v[40:43], v[132:135], v[164:167], v[40:43]
    v_mfma_f32_16x16x32_bf16 v[40:43], v[136:139], v[160:163], v[40:43]
    ds_read_b128 v[100:103], v244 offset:4096
    v_mfma_f32_16x16x32_bf16 v[44:47], v[140:143], v[160:163], v[44:47]
    ds_read2_b32 v[68:69], v236 offset0:192 offset1:193
    v_mfma_f32_16x16x32_bf16 v[44:47], v[136:139], v[164:167], v[44:47]
    s_add_u32 m0, s9, 36864
    s_add_u32 s13, s10, 128
    v_mfma_f32_16x16x32_bf16 v[44:47], v[132:135], v[168:171], v[44:47]
    buffer_load_dwordx4 v15, s[44:47], s13 offen sc1 lds
    ds_read2_b32 v[70:71], v236 offset0:194 offset1:195
    v_mfma_f32_16x16x32_bf16 v[44:47], v[128:131], v[172:175], v[44:47]
    ds_read_b128 v[104:107], v244 offset:8192
    s_waitcnt lgkmcnt(7)
    v_mfma_f32_16x16x32_bf16 v[48:51], v[128:131], v[176:179], v[48:51]
    ds_read2_b32 v[72:73], v237 offset0:64 offset1:65
    v_mfma_f32_16x16x32_bf16 v[48:51], v[132:135], v[172:175], v[48:51]
    ds_read2_b32 v[74:75], v237 offset0:66 offset1:67
    v_mfma_f32_16x16x32_bf16 v[48:51], v[136:139], v[168:171], v[48:51]
    ds_read_b128 v[108:111], v244 offset:12288
    v_mfma_f32_16x16x32_bf16 v[48:51], v[140:143], v[164:167], v[48:51]
    ds_read2_b32 v[76:77], v237 offset0:192 offset1:193
    v_mfma_f32_16x16x32_bf16 v[48:51], v[144:147], v[160:163], v[48:51]
    ds_read2_b32 v[78:79], v237 offset0:194 offset1:195
    v_mfma_f32_16x16x32_bf16 v[52:55], v[148:151], v[160:163], v[52:55]
    ds_read_b128 v[112:115], v244 offset:16384
    v_mfma_f32_16x16x32_bf16 v[52:55], v[144:147], v[164:167], v[52:55]
    ds_read2_b32 v[80:81], v238 offset0:64 offset1:65
    s_add_u32 m0, s9, 37888
    s_add_u32 s13, s10, 73856
    v_mfma_f32_16x16x32_bf16 v[52:55], v[140:143], v[168:171], v[52:55]
    buffer_load_dwordx4 v16, s[44:47], s13 offen sc1 lds
    ds_read2_b32 v[82:83], v238 offset0:66 offset1:67
    v_mfma_f32_16x16x32_bf16 v[52:55], v[136:139], v[172:175], v[52:55]
    ds_read_b128 v[116:119], v244 offset:20480
    v_mfma_f32_16x16x32_bf16 v[52:55], v[132:135], v[176:179], v[52:55]
    ds_read2_b32 v[84:85], v238 offset0:192 offset1:193
    v_mfma_f32_16x16x32_bf16 v[52:55], v[128:131], v[180:183], v[52:55]
    ds_read2_b32 v[86:87], v238 offset0:194 offset1:195
    v_mfma_f32_16x16x32_bf16 v[56:59], v[128:131], v[184:187], v[56:59]
    ds_read_b128 v[120:123], v244 offset:24576
    s_waitcnt vmcnt(3)
    s_barrier
    v_mfma_f32_16x16x32_bf16 v[56:59], v[132:135], v[180:183], v[56:59]
    ds_read2_b32 v[88:89], v239 offset0:64 offset1:65
    v_add_u32 v10, 131072, v10
    v_mfma_f32_16x16x32_bf16 v[56:59], v[136:139], v[176:179], v[56:59]
    ds_read_b64_tr_b16 a[64:65], v10 offset:16384
    v_mfma_f32_16x16x32_bf16 v[56:59], v[140:143], v[172:175], v[56:59]
    ds_read2_b32 v[90:91], v239 offset0:66 offset1:67
    v_mfma_f32_16x16x32_bf16 v[56:59], v[144:147], v[168:171], v[56:59]
    ds_read_b64_tr_b16 a[66:67], v10 offset:18432
    s_add_u32 m0, s9, 38912
    s_add_u32 s13, s10, 147584
    v_mfma_f32_16x16x32_bf16 v[56:59], v[148:151], v[164:167], v[56:59]
    ds_read_b64_tr_b16 a[72:73], v10 offset:20480
    buffer_load_dwordx4 v15, s[44:47], s13 offen sc1 lds
    v_mfma_f32_16x16x32_bf16 v[56:59], v[152:155], v[160:163], v[56:59]
    ds_read_b64_tr_b16 a[74:75], v10 offset:22528
    v_mfma_f32_16x16x32_bf16 v[60:63], v[156:159], v[160:163], v[60:63]
    ds_read_b128 v[124:127], v244 offset:28672
    v_add_u32 v11, 131072, v11
    v_mfma_f32_16x16x32_bf16 v[60:63], v[152:155], v[164:167], v[60:63]
    ds_read_b64_tr_b16 a[68:69], v11 offset:16384
    v_mfma_f32_16x16x32_bf16 v[60:63], v[148:151], v[168:171], v[60:63]
    ds_read2_b32 v[92:93], v239 offset0:192 offset1:193
    v_mfma_f32_16x16x32_bf16 v[60:63], v[144:147], v[172:175], v[60:63]
    ds_read_b64_tr_b16 a[70:71], v11 offset:18432
    v_mfma_f32_16x16x32_bf16 v[60:63], v[140:143], v[176:179], v[60:63]
    ds_read_b64_tr_b16 a[76:77], v11 offset:20480
    v_mfma_f32_16x16x32_bf16 v[60:63], v[136:139], v[180:183], v[60:63]
    ds_read_b64_tr_b16 a[78:79], v11 offset:22528
    v_mfma_f32_16x16x32_bf16 v[60:63], v[132:135], v[184:187], v[60:63]
    ds_read2_b32 v[94:95], v239 offset0:194 offset1:195
    s_add_u32 m0, s9, 39936
    s_add_u32 s13, s10, 221312
    v_mfma_f32_16x16x32_bf16 v[60:63], v[128:131], v[188:191], v[60:63]
    buffer_load_dwordx4 v16, s[44:47], s13 offen sc1 lds
    s_waitcnt lgkmcnt(15)
    v_mfma_f32_16x16x32_bf16 v[32:35], v[64:67], v[96:99], v[32:35]
    ds_read_b128 v[160:163], v245 offset:0
    s_waitcnt lgkmcnt(2)
    s_barrier
    v_mfma_f32_16x16x32_bf16 v[36:39], v[68:71], v[96:99], v[36:39]
    v_mfma_f32_16x16x32_bf16 v[36:39], v[64:67], v[100:103], v[36:39]
    ds_read2_b32 v[128:129], v236 offset0:80 offset1:81
    v_mfma_f32_16x16x32_bf16 v[40:43], v[64:67], v[104:107], v[40:43]
    s_lshl_b32 s14, s89, 18
    ds_read2_b32 v[130:131], v236 offset0:82 offset1:83
    v_mfma_f32_16x16x32_bf16 v[40:43], v[68:71], v[100:103], v[40:43]
    s_add_u32 m0, s73, 147456
    v_mfma_f32_16x16x32_bf16 v[40:43], v[72:75], v[96:99], v[40:43]
    buffer_load_dwordx4 v4, s[52:55], s14 offen offset:0 lds
    ds_read_b128 v[164:167], v245 offset:4096
    v_mfma_f32_16x16x32_bf16 v[44:47], v[76:79], v[96:99], v[44:47]
    ds_read2_b32 v[132:133], v236 offset0:208 offset1:209
    v_mfma_f32_16x16x32_bf16 v[44:47], v[72:75], v[100:103], v[44:47]
    s_add_u32 m0, s9, 40960
    s_add_u32 s13, s10, 295040
    v_mfma_f32_16x16x32_bf16 v[44:47], v[68:71], v[104:107], v[44:47]
    buffer_load_dwordx4 v15, s[44:47], s13 offen sc1 lds
    ds_read2_b32 v[134:135], v236 offset0:210 offset1:211
    v_mfma_f32_16x16x32_bf16 v[44:47], v[64:67], v[108:111], v[44:47]
    ds_read_b128 v[168:171], v245 offset:8192
    s_waitcnt lgkmcnt(7)
    v_mfma_f32_16x16x32_bf16 v[48:51], v[64:67], v[112:115], v[48:51]
    ds_read2_b32 v[136:137], v237 offset0:80 offset1:81
    v_mfma_f32_16x16x32_bf16 v[48:51], v[68:71], v[108:111], v[48:51]
    ds_read2_b32 v[138:139], v237 offset0:82 offset1:83
    v_mfma_f32_16x16x32_bf16 v[48:51], v[72:75], v[104:107], v[48:51]
    ds_read_b128 v[172:175], v245 offset:12288
    v_mfma_f32_16x16x32_bf16 v[48:51], v[76:79], v[100:103], v[48:51]
    ds_read2_b32 v[140:141], v237 offset0:208 offset1:209
    v_mfma_f32_16x16x32_bf16 v[48:51], v[80:83], v[96:99], v[48:51]
    ds_read2_b32 v[142:143], v237 offset0:210 offset1:211
    v_mfma_f32_16x16x32_bf16 v[52:55], v[84:87], v[96:99], v[52:55]
    ds_read_b128 v[176:179], v245 offset:16384
    v_mfma_f32_16x16x32_bf16 v[52:55], v[80:83], v[100:103], v[52:55]
    s_add_u32 m0, s73, 147456
    ds_read2_b32 v[144:145], v238 offset0:80 offset1:81
    v_mfma_f32_16x16x32_bf16 v[52:55], v[76:79], v[104:107], v[52:55]
    buffer_load_dwordx4 v5, s[52:55], s14 offen offset:1024 lds
    ds_read2_b32 v[146:147], v238 offset0:82 offset1:83
L_pl_X_3:
    s_cbranch_execz L_pl_X_7
    v_mfma_f32_16x16x32_bf16 v[52:55], v[72:75], v[108:111], v[52:55]
    ds_read_b128 v[180:183], v245 offset:20480
    s_add_u32 m0, s9, 41984
    s_add_u32 s13, s10, 368768
    v_mfma_f32_16x16x32_bf16 v[52:55], v[68:71], v[112:115], v[52:55]
    buffer_load_dwordx4 v16, s[44:47], s13 offen sc1 lds
    ds_read_b128 v[212:215], v241 offset:32
    v_mfma_f32_16x16x32_bf16 v[52:55], v[64:67], v[116:119], v[52:55]
    ds_read2_b32 v[148:149], v238 offset0:208 offset1:209
    v_mfma_f32_16x16x32_bf16 v[56:59], v[64:67], v[120:123], v[56:59]
    ds_read_b32 v216, v241 offset:48
    v_mfma_f32_16x16x32_bf16 v[56:59], v[68:71], v[116:119], v[56:59]
    ds_read2_b32 v[150:151], v238 offset0:210 offset1:211
    v_mfma_f32_16x16x32_bf16 v[56:59], v[72:75], v[112:115], v[56:59]
    ds_read_b128 v[218:221], v241 offset:1056
    v_mfma_f32_16x16x32_bf16 v[56:59], v[76:79], v[108:111], v[56:59]
    ds_read_b128 v[184:187], v245 offset:24576
    v_mfma_f32_16x16x32_bf16 v[56:59], v[80:83], v[104:107], v[56:59]
    ds_read2_b32 v[152:153], v239 offset0:80 offset1:81
    s_add_u32 m0, s9, 43008
    s_add_u32 s13, s10, 442496
    v_mfma_f32_16x16x32_bf16 v[56:59], v[84:87], v[100:103], v[56:59]
    buffer_load_dwordx4 v15, s[44:47], s13 offen sc1 lds
    ds_read_b32 v222, v241 offset:1072
    v_mfma_f32_16x16x32_bf16 v[56:59], v[88:91], v[96:99], v[56:59]
    ds_read2_b32 v[154:155], v239 offset0:82 offset1:83
    v_mfma_f32_16x16x32_bf16 v[60:63], v[92:95], v[96:99], v[60:63]
    s_add_u32 m0, s73, 147456
    ds_read_b128 v[224:227], v241 offset:2080
    v_mfma_f32_16x16x32_bf16 v[60:63], v[88:91], v[100:103], v[60:63]
    buffer_load_dwordx4 v6, s[52:55], s14 offen offset:2048 lds
    ds_read_b128 v[188:191], v245 offset:28672
    v_mfma_f32_16x16x32_bf16 v[60:63], v[84:87], v[104:107], v[60:63]
    ds_read_b32 v228, v241 offset:2096
    v_mfma_f32_16x16x32_bf16 v[60:63], v[80:83], v[108:111], v[60:63]
    ds_read2_b32 v[156:157], v239 offset0:208 offset1:209
    v_mfma_f32_16x16x32_bf16 v[60:63], v[76:79], v[112:115], v[60:63]
    ds_read_b128 v[230:233], v241 offset:3104
    v_mfma_f32_16x16x32_bf16 v[60:63], v[72:75], v[116:119], v[60:63]
    ds_read2_b32 v[158:159], v239 offset0:210 offset1:211
    v_mfma_f32_16x16x32_bf16 v[60:63], v[68:71], v[120:123], v[60:63]
    ds_read_b32 v234, v241 offset:3120
    s_add_u32 m0, s9, 44032
    s_add_u32 s13, s10, 516224
    v_mfma_f32_16x16x32_bf16 v[60:63], v[64:67], v[124:127], v[60:63]
    buffer_load_dwordx4 v16, s[44:47], s13 offen sc1 lds
    s_waitcnt lgkmcnt(15)
    v_mfma_f32_16x16x32_bf16 v[32:35], v[128:131], v[160:163], v[32:35]
    ds_read_b128 v[96:99], v246 offset:0
    v_mfma_f32_16x16x32_bf16 v[36:39], v[132:135], v[160:163], v[36:39]
    v_mfma_f32_16x16x32_bf16 v[36:39], v[128:131], v[164:167], v[36:39]
    ds_read2_b32 v[64:65], v236 offset0:96 offset1:97
    v_mfma_f32_16x16x32_bf16 v[40:43], v[128:131], v[168:171], v[40:43]
    s_add_u32 m0, s73, 147456
    ds_read2_b32 v[66:67], v236 offset0:98 offset1:99
    v_mfma_f32_16x16x32_bf16 v[40:43], v[132:135], v[164:167], v[40:43]
    buffer_load_dwordx4 v7, s[52:55], s14 offen offset:3072 lds
    s_waitcnt lgkmcnt(3)
    v_mfma_f32_16x16x32_bf16 v[40:43], v[136:139], v[160:163], v[40:43]
    ds_read_b128 v[100:103], v246 offset:4096
    v_mfma_f32_16x16x32_bf16 v[44:47], v[140:143], v[160:163], v[44:47]
    s_waitcnt vmcnt(12)
    ds_read2_b32 v[68:69], v236 offset0:224 offset1:225
    v_mfma_f32_16x16x32_bf16 v[44:47], v[136:139], v[164:167], v[44:47]
    v_mfma_f32_16x16x32_bf16 v[44:47], v[132:135], v[168:171], v[44:47]
    ds_read2_b32 v[70:71], v236 offset0:226 offset1:227
    v_lshlrev_b32 v9, 16, v9
    v_mfma_f32_16x16x32_bf16 v[44:47], v[128:131], v[172:175], v[44:47]
    ds_read_b128 v[104:107], v246 offset:8192
    v_mfma_f32_16x16x32_bf16 v[48:51], v[128:131], v[176:179], v[48:51]
    ds_read2_b32 v[72:73], v237 offset0:96 offset1:97
    v_lshlrev_b32 v208, 16, v212
    v_mfma_f32_16x16x32_bf16 v[48:51], v[132:135], v[172:175], v[48:51]
    v_mfma_f32_16x16x32_bf16 v[48:51], v[136:139], v[168:171], v[48:51]
    ds_read2_b32 v[74:75], v237 offset0:98 offset1:99
    v_add_f32 v9, v9, v208
    v_mfma_f32_16x16x32_bf16 v[48:51], v[140:143], v[164:167], v[48:51]
    ds_read_b128 v[108:111], v246 offset:12288
    v_cvt_pk_bf16_f32 v9, v9, v9
    v_mfma_f32_16x16x32_bf16 v[48:51], v[144:147], v[160:163], v[48:51]
    ds_read2_b32 v[76:77], v237 offset0:224 offset1:225
    v_mfma_f32_16x16x32_bf16 v[52:55], v[148:151], v[160:163], v[52:55]
    ds_write_b16 v242, v9 offset:4160
    v_mfma_f32_16x16x32_bf16 v[52:55], v[144:147], v[164:167], v[52:55]
    ds_read2_b32 v[78:79], v237 offset0:226 offset1:227
    v_mfma_f32_16x16x32_bf16 v[52:55], v[140:143], v[168:171], v[52:55]
    ds_write_b16 v242, v9 offset:2
    v_mfma_f32_16x16x32_bf16 v[52:55], v[136:139], v[172:175], v[52:55]
    ds_read_b128 v[112:115], v246 offset:16384
    v_mfma_f32_16x16x32_bf16 v[52:55], v[132:135], v[176:179], v[52:55]
    ds_read2_b32 v[80:81], v238 offset0:96 offset1:97
    v_alignbit_b32 v212, v213, v212, 16
    v_mfma_f32_16x16x32_bf16 v[52:55], v[128:131], v[180:183], v[52:55]
    v_alignbit_b32 v213, v214, v213, 16
    v_mfma_f32_16x16x32_bf16 v[56:59], v[128:131], v[184:187], v[56:59]
    ds_read2_b32 v[82:83], v238 offset0:98 offset1:99
    v_mfma_f32_16x16x32_bf16 v[56:59], v[132:135], v[180:183], v[56:59]
    ds_read_b128 v[116:119], v246 offset:20480
    v_alignbit_b32 v214, v215, v214, 16
    v_mfma_f32_16x16x32_bf16 v[56:59], v[136:139], v[176:179], v[56:59]
    v_mfma_f32_16x16x32_bf16 v[56:59], v[140:143], v[172:175], v[56:59]
    ds_read2_b32 v[84:85], v238 offset0:224 offset1:225
    v_alignbit_b32 v215, v216, v215, 16
    v_mfma_f32_16x16x32_bf16 v[56:59], v[144:147], v[168:171], v[56:59]
    ds_read2_b32 v[86:87], v238 offset0:226 offset1:227
    v_mfma_f32_16x16x32_bf16 v[56:59], v[148:151], v[164:167], v[56:59]
    ds_write_b128 v241, v[212:215] offset:4192
    v_mfma_f32_16x16x32_bf16 v[56:59], v[152:155], v[160:163], v[56:59]
    ds_read_b128 v[120:123], v246 offset:24576
    v_mfma_f32_16x16x32_bf16 v[60:63], v[156:159], v[160:163], v[60:63]
    ds_read2_b32 v[88:89], v239 offset0:96 offset1:97
    v_alignbit_b32 v218, v219, v218, 16
    v_mfma_f32_16x16x32_bf16 v[60:63], v[152:155], v[164:167], v[60:63]
    ds_read2_b32 v[90:91], v239 offset0:98 offset1:99
    v_alignbit_b32 v219, v220, v219, 16
    v_mfma_f32_16x16x32_bf16 v[60:63], v[148:151], v[168:171], v[60:63]
    v_mfma_f32_16x16x32_bf16 v[60:63], v[144:147], v[172:175], v[60:63]
    ds_read_b128 v[124:127], v246 offset:28672
    v_alignbit_b32 v220, v221, v220, 16
    v_mfma_f32_16x16x32_bf16 v[60:63], v[140:143], v[176:179], v[60:63]
    ds_read2_b32 v[92:93], v239 offset0:224 offset1:225
    v_mfma_f32_16x16x32_bf16 v[60:63], v[136:139], v[180:183], v[60:63]
    ds_read2_b32 v[94:95], v239 offset0:226 offset1:227
    v_alignbit_b32 v221, v222, v221, 16
    v_mfma_f32_16x16x32_bf16 v[60:63], v[132:135], v[184:187], v[60:63]
    ds_write_b128 v241, v[218:221] offset:5216
    v_mfma_f32_16x16x32_bf16 v[60:63], v[128:131], v[188:191], v[60:63]
    s_waitcnt lgkmcnt(15)
    v_mfma_f32_16x16x32_bf16 v[32:35], v[64:67], v[96:99], v[32:35]
    ds_read_b128 v[160:163], v247 offset:0
    v_mfma_f32_16x16x32_bf16 v[36:39], v[68:71], v[96:99], v[36:39]
    v_alignbit_b32 v224, v225, v224, 16
    v_mfma_f32_16x16x32_bf16 v[36:39], v[64:67], v[100:103], v[36:39]
    ds_read_b128 v[164:167], v247 offset:4096
    v_mfma_f32_16x16x32_bf16 v[40:43], v[64:67], v[104:107], v[40:43]
    ds_read_b128 v[168:171], v247 offset:8192
    v_mfma_f32_16x16x32_bf16 v[40:43], v[68:71], v[100:103], v[40:43]
    ds_read_b128 v[172:175], v247 offset:12288
    v_mfma_f32_16x16x32_bf16 v[40:43], v[72:75], v[96:99], v[40:43]
    v_alignbit_b32 v225, v226, v225, 16
    v_mfma_f32_16x16x32_bf16 v[44:47], v[76:79], v[96:99], v[44:47]
    ds_read_b128 v[176:179], v247 offset:16384
    v_mfma_f32_16x16x32_bf16 v[44:47], v[72:75], v[100:103], v[44:47]
    ds_read_b128 v[180:183], v247 offset:20480
    v_mfma_f32_16x16x32_bf16 v[44:47], v[68:71], v[104:107], v[44:47]
    ds_read_b128 v[184:187], v247 offset:24576
    v_mfma_f32_16x16x32_bf16 v[44:47], v[64:67], v[108:111], v[44:47]
    v_alignbit_b32 v226, v227, v226, 16
    s_waitcnt lgkmcnt(8)
    v_mfma_f32_16x16x32_bf16 v[48:51], v[64:67], v[112:115], v[48:51]
    ds_read_b128 v[188:191], v247 offset:28672
    v_mfma_f32_16x16x32_bf16 v[48:51], v[68:71], v[108:111], v[48:51]
    ds_read2_b32 v[128:129], v236 offset0:112 offset1:113
    v_mfma_f32_16x16x32_bf16 v[48:51], v[72:75], v[104:107], v[48:51]
    v_alignbit_b32 v227, v228, v227, 16
    v_mfma_f32_16x16x32_bf16 v[48:51], v[76:79], v[100:103], v[48:51]
    ds_read2_b32 v[130:131], v236 offset0:114 offset1:115
    v_mfma_f32_16x16x32_bf16 v[48:51], v[80:83], v[96:99], v[48:51]
    ds_read2_b32 v[132:133], v236 offset0:240 offset1:241
    v_mfma_f32_16x16x32_bf16 v[52:55], v[84:87], v[96:99], v[52:55]
    ds_read2_b32 v[134:135], v236 offset0:242 offset1:243
    v_mfma_f32_16x16x32_bf16 v[52:55], v[80:83], v[100:103], v[52:55]
    ds_write_b128 v241, v[224:227] offset:6240
    v_mfma_f32_16x16x32_bf16 v[52:55], v[76:79], v[104:107], v[52:55]
    ds_read2_b32 v[136:137], v237 offset0:112 offset1:113
    ds_read2_b32 v[138:139], v237 offset0:114 offset1:115
    v_mfma_f32_16x16x32_bf16 v[52:55], v[72:75], v[108:111], v[52:55]
    s_add_u32 s6, s12, 4734976
    ds_read2_b32 v[140:141], v237 offset0:240 offset1:241
    v_mfma_f32_16x16x32_bf16 v[52:55], v[68:71], v[112:115], v[52:55]
    ds_read2_b32 v[142:143], v237 offset0:242 offset1:243
    v_alignbit_b32 v230, v231, v230, 16
    v_xor_b32 v244, 64, v244
    v_mfma_f32_16x16x32_bf16 v[52:55], v[64:67], v[116:119], v[52:55]
    ds_read2_b32 v[144:145], v238 offset0:112 offset1:113
    v_mfma_f32_16x16x32_bf16 v[56:59], v[64:67], v[120:123], v[56:59]
    ds_read2_b32 v[146:147], v238 offset0:114 offset1:115
    v_xor_b32 v245, 64, v245
    v_mfma_f32_16x16x32_bf16 v[56:59], v[68:71], v[116:119], v[56:59]
    ds_read2_b32 v[148:149], v238 offset0:240 offset1:241
    v_mfma_f32_16x16x32_bf16 v[56:59], v[72:75], v[112:115], v[56:59]
    v_alignbit_b32 v231, v232, v231, 16
    v_xor_b32 v246, 64, v246
    v_mfma_f32_16x16x32_bf16 v[56:59], v[76:79], v[108:111], v[56:59]
    ds_read2_b32 v[150:151], v238 offset0:242 offset1:243
    v_mfma_f32_16x16x32_bf16 v[56:59], v[80:83], v[104:107], v[56:59]
    ds_read2_b32 v[152:153], v239 offset0:112 offset1:113
    v_xor_b32 v247, 64, v247
    v_mfma_f32_16x16x32_bf16 v[56:59], v[84:87], v[100:103], v[56:59]
    ds_read2_b32 v[154:155], v239 offset0:114 offset1:115
    v_mfma_f32_16x16x32_bf16 v[56:59], v[88:91], v[96:99], v[56:59]
    ds_read2_b32 v[156:157], v239 offset0:240 offset1:241
    v_alignbit_b32 v232, v233, v232, 16
    v_mfma_f32_16x16x32_bf16 v[60:63], v[92:95], v[96:99], v[60:63]
    ds_read2_b32 v[158:159], v239 offset0:242 offset1:243
    v_add_u32 v244, 36864, v244
    v_mfma_f32_16x16x32_bf16 v[60:63], v[88:91], v[100:103], v[60:63]
    v_add_u32 v236, -8320, v236
    v_mfma_f32_16x16x32_bf16 v[60:63], v[84:87], v[104:107], v[60:63]
    v_alignbit_b32 v233, v234, v233, 16
    v_add_u32 v245, 36864, v245
    v_mfma_f32_16x16x32_bf16 v[60:63], v[80:83], v[108:111], v[60:63]
    v_add_u32 v237, -8320, v237
    v_mfma_f32_16x16x32_bf16 v[60:63], v[76:79], v[112:115], v[60:63]
    s_waitcnt vmcnt(1)
    s_barrier
    v_add_u32 v246, 36864, v246
    v_mfma_f32_16x16x32_bf16 v[60:63], v[72:75], v[116:119], v[60:63]
    v_add_u32 v238, -8320, v238
    v_add_u32 v239, -8320, v239
    v_mfma_f32_16x16x32_bf16 v[60:63], v[68:71], v[120:123], v[60:63]
    ds_write_b128 v241, v[230:233] offset:7264
    v_mfma_f32_16x16x32_bf16 v[60:63], v[64:67], v[124:127], v[60:63]
    v_add_u32 v247, 36864, v247
    s_waitcnt lgkmcnt(1)
    v_mfma_f32_16x16x32_bf16 v[60:63], v[128:131], v[188:191], v[60:63]
    ds_read_b128 v[96:99], v244 offset:2048
    v_mfma_f32_16x16x32_bf16 v[60:63], v[132:135], v[184:187], v[60:63]
    ds_read2_b32 v[64:65], v236 offset0:0 offset1:1
    v_mfma_f32_16x16x32_bf16 v[60:63], v[136:139], v[180:183], v[60:63]
    ds_read2_b32 v[66:67], v236 offset0:2 offset1:3
    v_mfma_f32_16x16x32_bf16 v[60:63], v[140:143], v[176:179], v[60:63]
    ds_read_b128 v[100:103], v244 offset:6144
    v_mfma_f32_16x16x32_bf16 v[60:63], v[144:147], v[172:175], v[60:63]
    ds_read2_b32 v[68:69], v236 offset0:128 offset1:129
    v_mfma_f32_16x16x32_bf16 v[60:63], v[148:151], v[168:171], v[60:63]
    ds_read2_b32 v[70:71], v236 offset0:130 offset1:131
    v_mfma_f32_16x16x32_bf16 v[60:63], v[152:155], v[164:167], v[60:63]
    ds_read_b128 v[104:107], v244 offset:10240
    v_mfma_f32_16x16x32_bf16 v[60:63], v[156:159], v[160:163], v[60:63]
    ds_read2_b32 v[72:73], v237 offset0:0 offset1:1
    v_mfma_f32_16x16x32_bf16 v[56:59], v[128:131], v[184:187], v[56:59]
    ds_read2_b32 v[74:75], v237 offset0:2 offset1:3
    v_mfma_f32_16x16x32_bf16 v[56:59], v[132:135], v[180:183], v[56:59]
    ds_read_b128 v[108:111], v244 offset:14336
    v_mfma_f32_16x16x32_bf16 v[56:59], v[136:139], v[176:179], v[56:59]
    ds_read2_b32 v[76:77], v237 offset0:128 offset1:129
    v_mfma_f32_16x16x32_bf16 v[56:59], v[140:143], v[172:175], v[56:59]
    ds_read2_b32 v[78:79], v237 offset0:130 offset1:131
    v_mfma_f32_16x16x32_bf16 v[56:59], v[144:147], v[168:171], v[56:59]
    ds_read_b128 v[112:115], v244 offset:18432
    v_mfma_f32_16x16x32_bf16 v[56:59], v[148:151], v[164:167], v[56:59]
    ds_read2_b32 v[80:81], v238 offset0:0 offset1:1
    v_cvt_pk_bf16_f32 v206, v60, v61
    v_mfma_f32_16x16x32_bf16 v[56:59], v[152:155], v[160:163], v[56:59]
    ds_read2_b32 v[82:83], v238 offset0:2 offset1:3
    v_mfma_f32_16x16x32_bf16 v[52:55], v[128:131], v[180:183], v[52:55]
    ds_read_b128 v[116:119], v244 offset:22528
    v_mfma_f32_16x16x32_bf16 v[52:55], v[132:135], v[176:179], v[52:55]
    ds_read2_b32 v[84:85], v238 offset0:128 offset1:129
    v_cvt_pk_bf16_f32 v207, v62, v63
    v_mfma_f32_16x16x32_bf16 v[52:55], v[136:139], v[172:175], v[52:55]
    ds_read2_b32 v[86:87], v238 offset0:130 offset1:131
    v_mfma_f32_16x16x32_bf16 v[52:55], v[140:143], v[168:171], v[52:55]
    buffer_store_dwordx2 v[206:207], v8, s[44:47], s6 offen offset:3584 sc1
    ds_read_b128 v[120:123], v244 offset:26624
    v_mfma_f32_16x16x32_bf16 v[52:55], v[144:147], v[164:167], v[52:55]
    ds_read2_b32 v[88:89], v239 offset0:0 offset1:1
    v_mfma_f32_16x16x32_bf16 v[52:55], v[148:151], v[160:163], v[52:55]
    ds_read2_b32 v[90:91], v239 offset0:2 offset1:3
    v_mfma_f32_16x16x32_bf16 v[48:51], v[128:131], v[176:179], v[48:51]
    s_waitcnt vmcnt(1)
    s_barrier
    v_cvt_pk_bf16_f32 v204, v56, v57
    v_mfma_f32_16x16x32_bf16 v[48:51], v[132:135], v[172:175], v[48:51]
    ds_read_b128 v[124:127], v244 offset:30720
    v_mfma_f32_16x16x32_bf16 v[48:51], v[136:139], v[168:171], v[48:51]
    ds_read_b64_tr_b16 a[80:81], v10 offset:16384
    v_mfma_f32_16x16x32_bf16 v[48:51], v[140:143], v[164:167], v[48:51]
    ds_read_b64_tr_b16 a[82:83], v10 offset:18432
    v_cvt_pk_bf16_f32 v205, v58, v59
    v_mfma_f32_16x16x32_bf16 v[48:51], v[144:147], v[160:163], v[48:51]
    ds_read_b64_tr_b16 a[88:89], v10 offset:20480
    v_mfma_f32_16x16x32_bf16 v[44:47], v[128:131], v[172:175], v[44:47]
    buffer_store_dwordx2 v[204:205], v8, s[44:47], s6 offen offset:3072 sc1
    ds_read2_b32 v[92:93], v239 offset0:128 offset1:129
    v_mfma_f32_16x16x32_bf16 v[44:47], v[132:135], v[168:171], v[44:47]
    ds_read_b64_tr_b16 a[90:91], v10 offset:22528
    v_mfma_f32_16x16x32_bf16 v[44:47], v[136:139], v[164:167], v[44:47]
    ds_read_b64_tr_b16 a[84:85], v11 offset:16384
    ds_read2_b32 v[94:95], v239 offset0:130 offset1:131
    v_mfma_f32_16x16x32_bf16 v[44:47], v[140:143], v[160:163], v[44:47]
    v_cvt_pk_bf16_f32 v202, v52, v53
    v_mfma_f32_16x16x32_bf16 v[40:43], v[128:131], v[168:171], v[40:43]
    ds_read_b64_tr_b16 a[86:87], v11 offset:18432
    v_mfma_f32_16x16x32_bf16 v[40:43], v[132:135], v[164:167], v[40:43]
    ds_read_b64_tr_b16 a[92:93], v11 offset:20480
    v_mfma_f32_16x16x32_bf16 v[40:43], v[136:139], v[160:163], v[40:43]
    v_cvt_pk_bf16_f32 v203, v54, v55
    v_mfma_f32_16x16x32_bf16 v[36:39], v[128:131], v[164:167], v[36:39]
    ds_read_b64_tr_b16 a[94:95], v11 offset:22528
    v_mfma_f32_16x16x32_bf16 v[36:39], v[132:135], v[160:163], v[36:39]
    buffer_store_dwordx2 v[202:203], v8, s[44:47], s6 offen offset:2560 sc1
    v_mfma_f32_16x16x32_bf16 v[32:35], v[128:131], v[160:163], v[32:35]
    s_waitcnt lgkmcnt(3)
    v_mfma_f32_16x16x32_bf16 v[60:63], v[64:67], v[124:127], 0
    ds_read_b128 v[160:163], v245 offset:2048
    s_waitcnt lgkmcnt(1)
    s_barrier
    v_mfma_f32_16x16x32_bf16 v[60:63], v[68:71], v[120:123], v[60:63]
    v_cvt_pk_bf16_f32 v200, v48, v49
    v_mfma_f32_16x16x32_bf16 v[60:63], v[72:75], v[116:119], v[60:63]
    ds_read2_b32 v[128:129], v236 offset0:16 offset1:17
    v_mfma_f32_16x16x32_bf16 v[60:63], v[76:79], v[112:115], v[60:63]
    ds_read2_b32 v[130:131], v236 offset0:18 offset1:19
    s_lshl_b32 s14, s90, 18
    v_cvt_pk_bf16_f32 v201, v50, v51
    v_mfma_f32_16x16x32_bf16 v[60:63], v[80:83], v[108:111], v[60:63]
    s_add_u32 m0, s73, 147456
    v_mfma_f32_16x16x32_bf16 v[60:63], v[84:87], v[104:107], v[60:63]
    buffer_load_dwordx4 v4, s[52:55], s14 offen offset:0 lds
    ds_read_b128 v[164:167], v245 offset:6144
    v_mfma_f32_16x16x32_bf16 v[60:63], v[88:91], v[100:103], v[60:63]
    buffer_store_dwordx2 v[200:201], v8, s[44:47], s6 offen offset:2048 sc1
    ds_read2_b32 v[132:133], v236 offset0:144 offset1:145
    v_mfma_f32_16x16x32_bf16 v[60:63], v[92:95], v[96:99], v[60:63]
    s_add_u32 s13, s12, 49152
    v_cvt_pk_bf16_f32 v198, v44, v45
    v_mfma_f32_16x16x32_bf16 v[56:59], v[64:67], v[120:123], 0
    ds_read2_b32 v[134:135], v236 offset0:146 offset1:147
    v_mfma_f32_16x16x32_bf16 v[56:59], v[68:71], v[116:119], v[56:59]
    s_add_u32 m0, s74, 8352
    ds_read_b128 v[168:171], v245 offset:10240
    v_mfma_f32_16x16x32_bf16 v[56:59], v[72:75], v[112:115], v[56:59]
    buffer_load_dwordx4 v240, s[48:51], s13 offen offset:0 lds
    v_cvt_pk_bf16_f32 v199, v46, v47
    v_mfma_f32_16x16x32_bf16 v[56:59], v[76:79], v[108:111], v[56:59]
    ds_read2_b32 v[136:137], v237 offset0:16 offset1:17
    v_mfma_f32_16x16x32_bf16 v[56:59], v[80:83], v[104:107], v[56:59]
    buffer_store_dwordx2 v[198:199], v8, s[44:47], s6 offen offset:1536 sc1
    ds_read2_b32 v[138:139], v237 offset0:18 offset1:19
    v_mfma_f32_16x16x32_bf16 v[56:59], v[84:87], v[100:103], v[56:59]
    ds_read_b128 v[172:175], v245 offset:14336
    v_mfma_f32_16x16x32_bf16 v[56:59], v[88:91], v[96:99], v[56:59]
    v_cvt_pk_bf16_f32 v196, v40, v41
    v_mfma_f32_16x16x32_bf16 v[52:55], v[64:67], v[116:119], 0
    ds_read2_b32 v[140:141], v237 offset0:144 offset1:145
    v_mfma_f32_16x16x32_bf16 v[52:55], v[68:71], v[112:115], v[52:55]
    ds_read2_b32 v[142:143], v237 offset0:146 offset1:147
    s_add_u32 m0, s73, 147456
    v_cvt_pk_bf16_f32 v197, v42, v43
    v_mfma_f32_16x16x32_bf16 v[52:55], v[72:75], v[108:111], v[52:55]
    buffer_load_dwordx4 v5, s[52:55], s14 offen offset:1024 lds
    v_mfma_f32_16x16x32_bf16 v[52:55], v[76:79], v[104:107], v[52:55]
    buffer_store_dwordx2 v[196:197], v8, s[44:47], s6 offen offset:1024 sc1
    ds_read_b128 v[176:179], v245 offset:18432
    s_add_u32 m0, s74, 8352
    v_mfma_f32_16x16x32_bf16 v[52:55], v[80:83], v[100:103], v[52:55]
    buffer_load_dwordx4 v240, s[48:51], s13 offen offset:1024 lds
    ds_read2_b32 v[144:145], v238 offset0:16 offset1:17
    v_mfma_f32_16x16x32_bf16 v[52:55], v[84:87], v[96:99], v[52:55]
    v_mfma_f32_16x16x32_bf16 v[48:51], v[64:67], v[112:115], 0
    ds_read2_b32 v[146:147], v238 offset0:18 offset1:19
    v_cvt_pk_bf16_f32 v194, v36, v37
    v_mfma_f32_16x16x32_bf16 v[48:51], v[68:71], v[108:111], v[48:51]
    ds_read_b128 v[180:183], v245 offset:22528
    v_mfma_f32_16x16x32_bf16 v[48:51], v[72:75], v[104:107], v[48:51]
    v_cvt_pk_bf16_f32 v195, v38, v39
    v_mfma_f32_16x16x32_bf16 v[48:51], v[76:79], v[100:103], v[48:51]
    buffer_store_dwordx2 v[194:195], v8, s[44:47], s6 offen offset:512 sc1
    ds_read2_b32 v[148:149], v238 offset0:144 offset1:145
    s_add_u32 m0, s74, 8352
    v_mfma_f32_16x16x32_bf16 v[48:51], v[80:83], v[96:99], v[48:51]
    buffer_load_dwordx4 v240, s[48:51], s13 offen offset:2048 lds
    ds_read2_b32 v[150:151], v238 offset0:146 offset1:147
    v_mfma_f32_16x16x32_bf16 v[44:47], v[64:67], v[108:111], 0
    ds_read_b128 v[184:187], v245 offset:26624
    v_mfma_f32_16x16x32_bf16 v[44:47], v[68:71], v[104:107], v[44:47]
    v_cvt_pk_bf16_f32 v192, v32, v33
    v_mfma_f32_16x16x32_bf16 v[44:47], v[72:75], v[100:103], v[44:47]
    s_add_u32 m0, s73, 147456
    ds_read2_b32 v[152:153], v239 offset0:16 offset1:17
    v_mfma_f32_16x16x32_bf16 v[44:47], v[76:79], v[96:99], v[44:47]
    buffer_load_dwordx4 v6, s[52:55], s14 offen offset:2048 lds
    v_cvt_pk_bf16_f32 v193, v34, v35
    v_mfma_f32_16x16x32_bf16 v[40:43], v[64:67], v[104:107], 0
    ds_read2_b32 v[154:155], v239 offset0:18 offset1:19
    v_mfma_f32_16x16x32_bf16 v[40:43], v[68:71], v[100:103], v[40:43]
    buffer_store_dwordx2 v[192:193], v8, s[44:47], s6 offen offset:0 sc1
    ds_read_b128 v[188:191], v245 offset:30720
    v_mfma_f32_16x16x32_bf16 v[40:43], v[72:75], v[96:99], v[40:43]
    s_add_u32 m0, s74, 8352
    ds_read2_b32 v[156:157], v239 offset0:144 offset1:145
    v_mfma_f32_16x16x32_bf16 v[36:39], v[64:67], v[100:103], 0
    buffer_load_dwordx4 v240, s[48:51], s13 offen offset:3072 lds
    v_mfma_f32_16x16x32_bf16 v[36:39], v[68:71], v[96:99], v[36:39]
    ds_read2_b32 v[158:159], v239 offset0:146 offset1:147
    v_mfma_f32_16x16x32_bf16 v[32:35], v[64:67], v[96:99], 0
    s_waitcnt lgkmcnt(12)
    v_mfma_f32_16x16x32_bf16 v[32:35], v[128:131], v[160:163], v[32:35]
    ds_read_b128 v[96:99], v246 offset:2048
    v_mfma_f32_16x16x32_bf16 v[36:39], v[132:135], v[160:163], v[36:39]
    v_mfma_f32_16x16x32_bf16 v[36:39], v[128:131], v[164:167], v[36:39]
    ds_read2_b32 v[64:65], v236 offset0:32 offset1:33
    v_mfma_f32_16x16x32_bf16 v[40:43], v[128:131], v[168:171], v[40:43]
    s_barrier
    ds_read2_b32 v[66:67], v236 offset0:34 offset1:35
    s_add_u32 m0, s73, 147456
    v_mfma_f32_16x16x32_bf16 v[40:43], v[132:135], v[164:167], v[40:43]
    buffer_load_dwordx4 v7, s[52:55], s14 offen offset:3072 lds
    v_mfma_f32_16x16x32_bf16 v[40:43], v[136:139], v[160:163], v[40:43]
    ds_read_b128 v[100:103], v246 offset:6144
    v_mfma_f32_16x16x32_bf16 v[44:47], v[140:143], v[160:163], v[44:47]
    ds_read2_b32 v[68:69], v236 offset0:160 offset1:161
    v_mfma_f32_16x16x32_bf16 v[44:47], v[136:139], v[164:167], v[44:47]
    v_mfma_f32_16x16x32_bf16 v[44:47], v[132:135], v[168:171], v[44:47]
    ds_read2_b32 v[70:71], v236 offset0:162 offset1:163
    v_mfma_f32_16x16x32_bf16 v[44:47], v[128:131], v[172:175], v[44:47]
    ds_read_b128 v[104:107], v246 offset:10240
    s_waitcnt lgkmcnt(7)
    v_mfma_f32_16x16x32_bf16 v[48:51], v[128:131], v[176:179], v[48:51]
    ds_read2_b32 v[72:73], v237 offset0:32 offset1:33
    v_mfma_f32_16x16x32_bf16 v[48:51], v[132:135], v[172:175], v[48:51]
    ds_read2_b32 v[74:75], v237 offset0:34 offset1:35
    v_mfma_f32_16x16x32_bf16 v[48:51], v[136:139], v[168:171], v[48:51]
    v_mov_b32 v9, 24
    buffer_load_ushort v9, v9, s[56:59], s70 offen
    v_mfma_f32_16x16x32_bf16 v[48:51], v[140:143], v[164:167], v[48:51]
    ds_read_b128 v[108:111], v246 offset:14336
    v_mfma_f32_16x16x32_bf16 v[48:51], v[144:147], v[160:163], v[48:51]
    v_mfma_f32_16x16x32_bf16 v[52:55], v[148:151], v[160:163], v[52:55]
    ds_read2_b32 v[76:77], v237 offset0:160 offset1:161
    v_mfma_f32_16x16x32_bf16 v[52:55], v[144:147], v[164:167], v[52:55]
    ds_read2_b32 v[78:79], v237 offset0:162 offset1:163
    v_mfma_f32_16x16x32_bf16 v[52:55], v[140:143], v[168:171], v[52:55]
    v_mfma_f32_16x16x32_bf16 v[52:55], v[136:139], v[172:175], v[52:55]
    s_lshl_b32 s14, s91, 18
    ds_read_b128 v[112:115], v246 offset:18432
    v_mfma_f32_16x16x32_bf16 v[52:55], v[132:135], v[176:179], v[52:55]
    s_add_u32 m0, s73, 0
    ds_read2_b32 v[80:81], v238 offset0:32 offset1:33
    v_mfma_f32_16x16x32_bf16 v[52:55], v[128:131], v[180:183], v[52:55]
    buffer_load_dwordx4 v4, s[52:55], s14 offen offset:0 lds
    v_mfma_f32_16x16x32_bf16 v[56:59], v[128:131], v[184:187], v[56:59]
    ds_read2_b32 v[82:83], v238 offset0:34 offset1:35
    v_mfma_f32_16x16x32_bf16 v[56:59], v[132:135], v[180:183], v[56:59]
    ds_read_b128 v[116:119], v246 offset:22528
    v_mfma_f32_16x16x32_bf16 v[56:59], v[136:139], v[176:179], v[56:59]
    v_mfma_f32_16x16x32_bf16 v[56:59], v[140:143], v[172:175], v[56:59]
    ds_read2_b32 v[84:85], v238 offset0:160 offset1:161
    v_mfma_f32_16x16x32_bf16 v[56:59], v[144:147], v[168:171], v[56:59]
    ds_read2_b32 v[86:87], v238 offset0:162 offset1:163
    v_mfma_f32_16x16x32_bf16 v[56:59], v[148:151], v[164:167], v[56:59]
    ds_read_b128 v[120:123], v246 offset:26624
    v_mfma_f32_16x16x32_bf16 v[56:59], v[152:155], v[160:163], v[56:59]
    v_mfma_f32_16x16x32_bf16 v[60:63], v[156:159], v[160:163], v[60:63]
    ds_read2_b32 v[88:89], v239 offset0:32 offset1:33
    v_mfma_f32_16x16x32_bf16 v[60:63], v[152:155], v[164:167], v[60:63]
    ds_read2_b32 v[90:91], v239 offset0:34 offset1:35
    v_mfma_f32_16x16x32_bf16 v[60:63], v[148:151], v[168:171], v[60:63]
    s_add_u32 m0, s73, 0
    v_mfma_f32_16x16x32_bf16 v[60:63], v[144:147], v[172:175], v[60:63]
    buffer_load_dwordx4 v5, s[52:55], s14 offen offset:1024 lds
    ds_read_b128 v[124:127], v246 offset:30720
    v_mfma_f32_16x16x32_bf16 v[60:63], v[140:143], v[176:179], v[60:63]
    ds_read2_b32 v[92:93], v239 offset0:160 offset1:161
    v_mfma_f32_16x16x32_bf16 v[60:63], v[136:139], v[180:183], v[60:63]
    v_mfma_f32_16x16x32_bf16 v[60:63], v[132:135], v[184:187], v[60:63]
    ds_read2_b32 v[94:95], v239 offset0:162 offset1:163
    v_mfma_f32_16x16x32_bf16 v[60:63], v[128:131], v[188:191], v[60:63]
    s_waitcnt lgkmcnt(12)
    v_mfma_f32_16x16x32_bf16 v[32:35], v[64:67], v[96:99], v[32:35]
    ds_read_b128 v[160:163], v247 offset:2048
    v_mfma_f32_16x16x32_bf16 v[36:39], v[68:71], v[96:99], v[36:39]
    v_mfma_f32_16x16x32_bf16 v[36:39], v[64:67], v[100:103], v[36:39]
    ds_read2_b32 v[128:129], v236 offset0:48 offset1:49
    v_mfma_f32_16x16x32_bf16 v[40:43], v[64:67], v[104:107], v[40:43]
    ds_read2_b32 v[130:131], v236 offset0:50 offset1:51
    v_mfma_f32_16x16x32_bf16 v[40:43], v[68:71], v[100:103], v[40:43]
    v_mfma_f32_16x16x32_bf16 v[40:43], v[72:75], v[96:99], v[40:43]
    ds_read_b128 v[164:167], v247 offset:6144
    v_mfma_f32_16x16x32_bf16 v[44:47], v[76:79], v[96:99], v[44:47]
    s_add_u32 m0, s73, 0
    ds_read2_b32 v[132:133], v236 offset0:176 offset1:177
    v_mfma_f32_16x16x32_bf16 v[44:47], v[72:75], v[100:103], v[44:47]
    buffer_load_dwordx4 v6, s[52:55], s14 offen offset:2048 lds
    v_mfma_f32_16x16x32_bf16 v[44:47], v[68:71], v[104:107], v[44:47]
    ds_read2_b32 v[134:135], v236 offset0:178 offset1:179
    v_mfma_f32_16x16x32_bf16 v[44:47], v[64:67], v[108:111], v[44:47]
    ds_read_b128 v[168:171], v247 offset:10240
    s_waitcnt lgkmcnt(7)
    v_mfma_f32_16x16x32_bf16 v[48:51], v[64:67], v[112:115], v[48:51]
    ds_read2_b32 v[136:137], v237 offset0:48 offset1:49
    v_mfma_f32_16x16x32_bf16 v[48:51], v[68:71], v[108:111], v[48:51]
    v_mfma_f32_16x16x32_bf16 v[48:51], v[72:75], v[104:107], v[48:51]
    ds_read2_b32 v[138:139], v237 offset0:50 offset1:51
    v_mfma_f32_16x16x32_bf16 v[48:51], v[76:79], v[100:103], v[48:51]
    ds_read_b128 v[172:175], v247 offset:14336
    v_mfma_f32_16x16x32_bf16 v[48:51], v[80:83], v[96:99], v[48:51]
    v_mfma_f32_16x16x32_bf16 v[52:55], v[84:87], v[96:99], v[52:55]
    ds_read2_b32 v[140:141], v237 offset0:176 offset1:177
    v_mfma_f32_16x16x32_bf16 v[52:55], v[80:83], v[100:103], v[52:55]
    ds_read2_b32 v[142:143], v237 offset0:178 offset1:179
    v_mfma_f32_16x16x32_bf16 v[52:55], v[76:79], v[104:107], v[52:55]
    v_mfma_f32_16x16x32_bf16 v[52:55], v[72:75], v[108:111], v[52:55]
    s_add_u32 m0, s73, 0
    ds_read_b128 v[176:179], v247 offset:18432
    v_mfma_f32_16x16x32_bf16 v[52:55], v[68:71], v[112:115], v[52:55]
    buffer_load_dwordx4 v7, s[52:55], s14 offen offset:3072 lds
    ds_read2_b32 v[144:145], v238 offset0:48 offset1:49
    v_mfma_f32_16x16x32_bf16 v[52:55], v[64:67], v[116:119], v[52:55]
    v_mfma_f32_16x16x32_bf16 v[56:59], v[64:67], v[120:123], v[56:59]
    ds_read2_b32 v[146:147], v238 offset0:50 offset1:51
    v_mfma_f32_16x16x32_bf16 v[56:59], v[68:71], v[116:119], v[56:59]
    ds_read_b128 v[180:183], v247 offset:22528
    v_mfma_f32_16x16x32_bf16 v[56:59], v[72:75], v[112:115], v[56:59]
    v_mfma_f32_16x16x32_bf16 v[56:59], v[76:79], v[108:111], v[56:59]
    ds_read2_b32 v[148:149], v238 offset0:176 offset1:177
    v_mfma_f32_16x16x32_bf16 v[56:59], v[80:83], v[104:107], v[56:59]
    ds_read2_b32 v[150:151], v238 offset0:178 offset1:179
    v_mfma_f32_16x16x32_bf16 v[56:59], v[84:87], v[100:103], v[56:59]
    ds_read_b128 v[184:187], v247 offset:26624
    v_mfma_f32_16x16x32_bf16 v[56:59], v[88:91], v[96:99], v[56:59]
    v_mfma_f32_16x16x32_bf16 v[60:63], v[92:95], v[96:99], v[60:63]
    s_lshl_b32 s14, s92, 18
    ds_read2_b32 v[152:153], v239 offset0:48 offset1:49
    v_mfma_f32_16x16x32_bf16 v[60:63], v[88:91], v[100:103], v[60:63]
    s_add_u32 m0, s73, 16384
    ds_read2_b32 v[154:155], v239 offset0:50 offset1:51
    v_mfma_f32_16x16x32_bf16 v[60:63], v[84:87], v[104:107], v[60:63]
    buffer_load_dwordx4 v4, s[52:55], s14 offen offset:0 lds
    v_mfma_f32_16x16x32_bf16 v[60:63], v[80:83], v[108:111], v[60:63]
    ds_read_b128 v[188:191], v247 offset:30720
    v_mfma_f32_16x16x32_bf16 v[60:63], v[76:79], v[112:115], v[60:63]
    ds_read2_b32 v[156:157], v239 offset0:176 offset1:177
    v_mfma_f32_16x16x32_bf16 v[60:63], v[72:75], v[116:119], v[60:63]
    v_mfma_f32_16x16x32_bf16 v[60:63], v[68:71], v[120:123], v[60:63]
    ds_read2_b32 v[158:159], v239 offset0:178 offset1:179
L_pl_X_4:
    s_cbranch_execz L_wret
    v_mfma_f32_16x16x32_bf16 v[60:63], v[64:67], v[124:127], v[60:63]
    s_waitcnt lgkmcnt(12)
    v_mfma_f32_16x16x32_bf16 v[32:35], v[128:131], v[160:163], v[32:35]
    ds_read_b128 v[96:99], v244 offset:0
    v_mfma_f32_16x16x32_bf16 v[36:39], v[132:135], v[160:163], v[36:39]
    ds_read2_b32 v[64:65], v236 offset0:64 offset1:65
    v_mfma_f32_16x16x32_bf16 v[36:39], v[128:131], v[164:167], v[36:39]
    ds_read2_b32 v[66:67], v236 offset0:66 offset1:67
    v_mfma_f32_16x16x32_bf16 v[40:43], v[128:131], v[168:171], v[40:43]
    ds_read_b128 v[100:103], v244 offset:4096
    v_mfma_f32_16x16x32_bf16 v[40:43], v[132:135], v[164:167], v[40:43]
    ds_read2_b32 v[68:69], v236 offset0:192 offset1:193
    v_mfma_f32_16x16x32_bf16 v[40:43], v[136:139], v[160:163], v[40:43]
    s_add_u32 m0, s73, 16384
    ds_read2_b32 v[70:71], v236 offset0:194 offset1:195
    v_mfma_f32_16x16x32_bf16 v[44:47], v[140:143], v[160:163], v[44:47]
    buffer_load_dwordx4 v5, s[52:55], s14 offen offset:1024 lds
    ds_read_b128 v[104:107], v244 offset:8192
    v_mfma_f32_16x16x32_bf16 v[44:47], v[136:139], v[164:167], v[44:47]
    ds_read2_b32 v[72:73], v237 offset0:64 offset1:65
    s_waitcnt vmcnt(7)
    s_barrier
    v_mfma_f32_16x16x32_bf16 v[44:47], v[132:135], v[168:171], v[44:47]
    ds_read_b64_tr_b16 a[96:97], v10 offset:16384
    v_mfma_f32_16x16x32_bf16 v[44:47], v[128:131], v[172:175], v[44:47]
    ds_read2_b32 v[74:75], v237 offset0:66 offset1:67
    s_waitcnt lgkmcnt(10)
    v_mfma_f32_16x16x32_bf16 v[48:51], v[128:131], v[176:179], v[48:51]
    ds_read_b64_tr_b16 a[98:99], v10 offset:18432
    v_mfma_f32_16x16x32_bf16 v[48:51], v[132:135], v[172:175], v[48:51]
    ds_read_b64_tr_b16 a[104:105], v10 offset:20480
    v_mfma_f32_16x16x32_bf16 v[48:51], v[136:139], v[168:171], v[48:51]
    ds_read_b64_tr_b16 a[106:107], v10 offset:22528
    v_mfma_f32_16x16x32_bf16 v[48:51], v[140:143], v[164:167], v[48:51]
    ds_read_b128 v[108:111], v244 offset:12288
    v_mfma_f32_16x16x32_bf16 v[48:51], v[144:147], v[160:163], v[48:51]
    ds_read_b64_tr_b16 a[100:101], v11 offset:16384
    v_mfma_f32_16x16x32_bf16 v[52:55], v[148:151], v[160:163], v[52:55]
    ds_read_b64_tr_b16 a[102:103], v11 offset:18432
    v_mfma_f32_16x16x32_bf16 v[52:55], v[144:147], v[164:167], v[52:55]
    ds_read2_b32 v[76:77], v237 offset0:192 offset1:193
    v_mfma_f32_16x16x32_bf16 v[52:55], v[140:143], v[168:171], v[52:55]
    ds_read_b64_tr_b16 a[108:109], v11 offset:20480
    s_add_u32 m0, s73, 16384
    v_mfma_f32_16x16x32_bf16 v[52:55], v[136:139], v[172:175], v[52:55]
    ds_read_b64_tr_b16 a[110:111], v11 offset:22528
    buffer_load_dwordx4 v6, s[52:55], s14 offen offset:2048 lds
    v_mfma_f32_16x16x32_bf16 v[52:55], v[132:135], v[176:179], v[52:55]
    ds_read2_b32 v[78:79], v237 offset0:194 offset1:195
    v_mfma_f32_16x16x32_bf16 v[52:55], v[128:131], v[180:183], v[52:55]
    ds_read_b128 v[112:115], v244 offset:16384
    v_mfma_f32_16x16x32_bf16 v[56:59], v[128:131], v[184:187], v[56:59]
    ds_read2_b32 v[80:81], v238 offset0:64 offset1:65
    v_mfma_f32_16x16x32_bf16 v[56:59], v[132:135], v[180:183], v[56:59]
    ds_read2_b32 v[82:83], v238 offset0:66 offset1:67
    v_mfma_f32_16x16x32_bf16 v[56:59], v[136:139], v[176:179], v[56:59]
    ds_read_b128 v[116:119], v244 offset:20480
    v_mfma_f32_16x16x32_bf16 v[56:59], v[140:143], v[172:175], v[56:59]
    ds_read2_b32 v[84:85], v238 offset0:192 offset1:193
    v_mfma_f32_16x16x32_bf16 v[56:59], v[144:147], v[168:171], v[56:59]
    ds_read2_b32 v[86:87], v238 offset0:194 offset1:195
    v_mfma_f32_16x16x32_bf16 v[56:59], v[148:151], v[164:167], v[56:59]
    ds_read_b128 v[120:123], v244 offset:24576
    v_mfma_f32_16x16x32_bf16 v[56:59], v[152:155], v[160:163], v[56:59]
    v_mfma_f32_16x16x32_bf16 v[60:63], v[156:159], v[160:163], v[60:63]
    s_add_u32 m0, s73, 16384
    ds_read2_b32 v[88:89], v239 offset0:64 offset1:65
    v_mfma_f32_16x16x32_bf16 v[60:63], v[152:155], v[164:167], v[60:63]
    buffer_load_dwordx4 v7, s[52:55], s14 offen offset:3072 lds
    ds_read2_b32 v[90:91], v239 offset0:66 offset1:67
    v_mfma_f32_16x16x32_bf16 v[60:63], v[148:151], v[168:171], v[60:63]
    v_mfma_f32_16x16x32_bf16 v[60:63], v[144:147], v[172:175], v[60:63]
    ds_read_b128 v[124:127], v244 offset:28672
    v_mfma_f32_16x16x32_bf16 v[60:63], v[140:143], v[176:179], v[60:63]
    ds_read2_b32 v[92:93], v239 offset0:192 offset1:193
    v_mfma_f32_16x16x32_bf16 v[60:63], v[136:139], v[180:183], v[60:63]
    v_mfma_f32_16x16x32_bf16 v[60:63], v[132:135], v[184:187], v[60:63]
    ds_read2_b32 v[94:95], v239 offset0:194 offset1:195
    v_mfma_f32_16x16x32_bf16 v[60:63], v[128:131], v[188:191], v[60:63]
    s_waitcnt lgkmcnt(12)
    v_mfma_f32_16x16x32_bf16 v[32:35], v[64:67], v[96:99], v[32:35]
    ds_read_b128 v[160:163], v245 offset:0
    v_mfma_f32_16x16x32_bf16 v[36:39], v[68:71], v[96:99], v[36:39]
    ds_read2_b32 v[128:129], v236 offset0:80 offset1:81
    v_mfma_f32_16x16x32_bf16 v[36:39], v[64:67], v[100:103], v[36:39]
    ds_read2_b32 v[130:131], v236 offset0:82 offset1:83
    v_mfma_f32_16x16x32_bf16 v[40:43], v[64:67], v[104:107], v[40:43]
    ds_read_b128 v[164:167], v245 offset:4096
    s_barrier
    v_mfma_f32_16x16x32_bf16 v[40:43], v[68:71], v[100:103], v[40:43]
    ds_read2_b32 v[132:133], v236 offset0:208 offset1:209
    v_mfma_f32_16x16x32_bf16 v[40:43], v[72:75], v[96:99], v[40:43]
    ds_read2_b32 v[134:135], v236 offset0:210 offset1:211
    v_mfma_f32_16x16x32_bf16 v[44:47], v[76:79], v[96:99], v[44:47]
    ds_read_b128 v[168:171], v245 offset:8192
    v_mfma_f32_16x16x32_bf16 v[44:47], v[72:75], v[100:103], v[44:47]
    s_lshl_b32 s14, s93, 18
    ds_read2_b32 v[136:137], v237 offset0:80 offset1:81
    v_mfma_f32_16x16x32_bf16 v[44:47], v[68:71], v[104:107], v[44:47]
    s_add_u32 m0, s73, 147456
    ds_read2_b32 v[138:139], v237 offset0:82 offset1:83
    v_mfma_f32_16x16x32_bf16 v[44:47], v[64:67], v[108:111], v[44:47]
    buffer_load_dwordx4 v4, s[52:55], s14 offen offset:0 lds
    ds_read_b128 v[172:175], v245 offset:12288
    s_waitcnt lgkmcnt(10)
    v_mfma_f32_16x16x32_bf16 v[48:51], v[64:67], v[112:115], v[48:51]
    ds_read2_b32 v[140:141], v237 offset0:208 offset1:209
    v_mfma_f32_16x16x32_bf16 v[48:51], v[68:71], v[108:111], v[48:51]
    ds_read2_b32 v[142:143], v237 offset0:210 offset1:211
    v_mfma_f32_16x16x32_bf16 v[48:51], v[72:75], v[104:107], v[48:51]
    ds_read_b128 v[176:179], v245 offset:16384
    v_mfma_f32_16x16x32_bf16 v[48:51], v[76:79], v[100:103], v[48:51]
    ds_read2_b32 v[144:145], v238 offset0:80 offset1:81
    v_mfma_f32_16x16x32_bf16 v[48:51], v[80:83], v[96:99], v[48:51]
    ds_read2_b32 v[146:147], v238 offset0:82 offset1:83
    v_mfma_f32_16x16x32_bf16 v[52:55], v[84:87], v[96:99], v[52:55]
    ds_read_b128 v[180:183], v245 offset:20480
    v_mfma_f32_16x16x32_bf16 v[52:55], v[80:83], v[100:103], v[52:55]
    ds_read2_b32 v[148:149], v238 offset0:208 offset1:209
    v_mfma_f32_16x16x32_bf16 v[52:55], v[76:79], v[104:107], v[52:55]
    ds_read2_b32 v[150:151], v238 offset0:210 offset1:211
    v_mfma_f32_16x16x32_bf16 v[52:55], v[72:75], v[108:111], v[52:55]
    ds_read_b128 v[184:187], v245 offset:24576
    v_mfma_f32_16x16x32_bf16 v[52:55], v[68:71], v[112:115], v[52:55]
    s_add_u32 m0, s73, 147456
    ds_read_b128 v[212:215], v241 offset:8352
    v_mfma_f32_16x16x32_bf16 v[52:55], v[64:67], v[116:119], v[52:55]
    buffer_load_dwordx4 v5, s[52:55], s14 offen offset:1024 lds
    ds_read2_b32 v[152:153], v239 offset0:80 offset1:81
    v_mfma_f32_16x16x32_bf16 v[56:59], v[64:67], v[120:123], v[56:59]
    ds_read_b32 v216, v241 offset:8368
    v_mfma_f32_16x16x32_bf16 v[56:59], v[68:71], v[116:119], v[56:59]
    ds_read_b128 v[218:221], v241 offset:9376
    v_mfma_f32_16x16x32_bf16 v[56:59], v[72:75], v[112:115], v[56:59]
    ds_read_b32 v222, v241 offset:9392
    v_mfma_f32_16x16x32_bf16 v[56:59], v[76:79], v[108:111], v[56:59]
    ds_read_b128 v[224:227], v241 offset:10400
    v_mfma_f32_16x16x32_bf16 v[56:59], v[80:83], v[104:107], v[56:59]
    ds_read_b32 v228, v241 offset:10416
    s_waitcnt vmcnt(6)
    s_barrier
    v_mfma_f32_16x16x32_bf16 v[56:59], v[84:87], v[100:103], v[56:59]
    ds_read_b128 v[230:233], v241 offset:11424
    v_add_u32 v10, -131072, v10
    v_mfma_f32_16x16x32_bf16 v[56:59], v[88:91], v[96:99], v[56:59]
    ds_read_b64_tr_b16 a[112:113], v10 offset:0
    v_mfma_f32_16x16x32_bf16 v[60:63], v[92:95], v[96:99], v[60:63]
    ds_read_b64_tr_b16 a[114:115], v10 offset:2048
    v_mfma_f32_16x16x32_bf16 v[60:63], v[88:91], v[100:103], v[60:63]
    ds_read_b64_tr_b16 a[120:121], v10 offset:4096
    ds_read2_b32 v[154:155], v239 offset0:82 offset1:83
    v_mfma_f32_16x16x32_bf16 v[60:63], v[84:87], v[104:107], v[60:63]
    ds_read_b32 v234, v241 offset:11440
    v_mfma_f32_16x16x32_bf16 v[60:63], v[80:83], v[108:111], v[60:63]
    ds_read_b64_tr_b16 a[122:123], v10 offset:6144
    s_add_u32 m0, s73, 147456
    ds_read_b128 v[188:191], v245 offset:28672
    v_mfma_f32_16x16x32_bf16 v[60:63], v[76:79], v[112:115], v[60:63]
    v_add_u32 v11, -131072, v11
    buffer_load_dwordx4 v6, s[52:55], s14 offen offset:2048 lds
    ds_read2_b32 v[156:157], v239 offset0:208 offset1:209
    v_mfma_f32_16x16x32_bf16 v[60:63], v[72:75], v[116:119], v[60:63]
    ds_read_b64_tr_b16 a[116:117], v11 offset:0
    v_mfma_f32_16x16x32_bf16 v[60:63], v[68:71], v[120:123], v[60:63]
    ds_read_b64_tr_b16 a[118:119], v11 offset:2048
    ds_read2_b32 v[158:159], v239 offset0:210 offset1:211
    v_mfma_f32_16x16x32_bf16 v[60:63], v[64:67], v[124:127], v[60:63]
    ds_read_b64_tr_b16 a[124:125], v11 offset:4096
    s_waitcnt lgkmcnt(15)
    v_mfma_f32_16x16x32_bf16 v[32:35], v[128:131], v[160:163], v[32:35]
    ds_read_b64_tr_b16 a[126:127], v11 offset:6144
    v_mfma_f32_16x16x32_bf16 v[36:39], v[132:135], v[160:163], v[36:39]
    ds_read_b128 v[96:99], v246 offset:0
    v_mfma_f32_16x16x32_bf16 v[36:39], v[128:131], v[164:167], v[36:39]
    ds_read2_b32 v[64:65], v236 offset0:96 offset1:97
    v_mfma_f32_16x16x32_bf16 v[40:43], v[128:131], v[168:171], v[40:43]
    ds_read2_b32 v[66:67], v236 offset0:98 offset1:99
    v_mfma_f32_16x16x32_bf16 v[40:43], v[132:135], v[164:167], v[40:43]
    s_waitcnt lgkmcnt(11)
    v_mfma_f32_16x16x32_bf16 v[40:43], v[136:139], v[160:163], v[40:43]
    ds_read_b128 v[100:103], v246 offset:4096
    v_mfma_f32_16x16x32_bf16 v[44:47], v[140:143], v[160:163], v[44:47]
    ds_read2_b32 v[68:69], v236 offset0:224 offset1:225
    v_mfma_f32_16x16x32_bf16 v[44:47], v[136:139], v[164:167], v[44:47]
    s_add_u32 m0, s73, 147456
    ds_read2_b32 v[70:71], v236 offset0:226 offset1:227
    v_mfma_f32_16x16x32_bf16 v[44:47], v[132:135], v[168:171], v[44:47]
    buffer_load_dwordx4 v7, s[52:55], s14 offen offset:3072 lds
    v_lshlrev_b32 v9, 16, v9
    v_mfma_f32_16x16x32_bf16 v[44:47], v[128:131], v[172:175], v[44:47]
    ds_read_b128 v[104:107], v246 offset:8192
    s_waitcnt lgkmcnt(9)
    v_mfma_f32_16x16x32_bf16 v[48:51], v[128:131], v[176:179], v[48:51]
    ds_read2_b32 v[72:73], v237 offset0:96 offset1:97
    v_lshlrev_b32 v208, 16, v212
    v_mfma_f32_16x16x32_bf16 v[48:51], v[132:135], v[172:175], v[48:51]
    v_mfma_f32_16x16x32_bf16 v[48:51], v[136:139], v[168:171], v[48:51]
    ds_read2_b32 v[74:75], v237 offset0:98 offset1:99
    v_add_f32 v9, v9, v208
    v_mfma_f32_16x16x32_bf16 v[48:51], v[140:143], v[164:167], v[48:51]
    ds_read_b128 v[108:111], v246 offset:12288
    v_cvt_pk_bf16_f32 v9, v9, v9
    v_mfma_f32_16x16x32_bf16 v[48:51], v[144:147], v[160:163], v[48:51]
    ds_read2_b32 v[76:77], v237 offset0:224 offset1:225
    s_waitcnt lgkmcnt(11)
    s_barrier
    v_mfma_f32_16x16x32_bf16 v[52:55], v[148:151], v[160:163], v[52:55]
    ds_write_b16 v242, v9 offset:12480
    v_mfma_f32_16x16x32_bf16 v[52:55], v[144:147], v[164:167], v[52:55]
    ds_read2_b32 v[78:79], v237 offset0:226 offset1:227
    v_mfma_f32_16x16x32_bf16 v[52:55], v[140:143], v[168:171], v[52:55]
    ds_write_b16 v242, v9 offset:8322
    v_mfma_f32_16x16x32_bf16 v[52:55], v[136:139], v[172:175], v[52:55]
    s_lshl_b32 s14, s94, 18
    ds_read_b128 v[112:115], v246 offset:16384
    v_mfma_f32_16x16x32_bf16 v[52:55], v[132:135], v[176:179], v[52:55]
    ds_read2_b32 v[80:81], v238 offset0:96 offset1:97
    s_add_u32 m0, s73, 0
    v_alignbit_b32 v212, v213, v212, 16
    v_mfma_f32_16x16x32_bf16 v[52:55], v[128:131], v[180:183], v[52:55]
    buffer_load_dwordx4 v4, s[52:55], s14 offen offset:0 lds
    v_alignbit_b32 v213, v214, v213, 16
    v_mfma_f32_16x16x32_bf16 v[56:59], v[128:131], v[184:187], v[56:59]
    ds_read2_b32 v[82:83], v238 offset0:98 offset1:99
    v_mfma_f32_16x16x32_bf16 v[56:59], v[132:135], v[180:183], v[56:59]
    ds_read_b128 v[116:119], v246 offset:20480
    v_alignbit_b32 v214, v215, v214, 16
    v_mfma_f32_16x16x32_bf16 v[56:59], v[136:139], v[176:179], v[56:59]
    v_mfma_f32_16x16x32_bf16 v[56:59], v[140:143], v[172:175], v[56:59]
    ds_read2_b32 v[84:85], v238 offset0:224 offset1:225
    v_alignbit_b32 v215, v216, v215, 16
    v_mfma_f32_16x16x32_bf16 v[56:59], v[144:147], v[168:171], v[56:59]
    ds_read2_b32 v[86:87], v238 offset0:226 offset1:227
    v_mfma_f32_16x16x32_bf16 v[56:59], v[148:151], v[164:167], v[56:59]
    ds_write_b128 v241, v[212:215] offset:12512
    v_mfma_f32_16x16x32_bf16 v[56:59], v[152:155], v[160:163], v[56:59]
    ds_read_b128 v[120:123], v246 offset:24576
    v_mfma_f32_16x16x32_bf16 v[60:63], v[156:159], v[160:163], v[60:63]
    ds_read2_b32 v[88:89], v239 offset0:96 offset1:97
    v_alignbit_b32 v218, v219, v218, 16
    v_mfma_f32_16x16x32_bf16 v[60:63], v[152:155], v[164:167], v[60:63]
    ds_read2_b32 v[90:91], v239 offset0:98 offset1:99
    v_alignbit_b32 v219, v220, v219, 16
    v_mfma_f32_16x16x32_bf16 v[60:63], v[148:151], v[168:171], v[60:63]
    s_add_u32 m0, s73, 0
    ds_read_b128 v[124:127], v246 offset:28672
    v_mfma_f32_16x16x32_bf16 v[60:63], v[144:147], v[172:175], v[60:63]
    buffer_load_dwordx4 v5, s[52:55], s14 offen offset:1024 lds
    v_alignbit_b32 v220, v221, v220, 16
    v_mfma_f32_16x16x32_bf16 v[60:63], v[140:143], v[176:179], v[60:63]
    ds_read2_b32 v[92:93], v239 offset0:224 offset1:225
    v_mfma_f32_16x16x32_bf16 v[60:63], v[136:139], v[180:183], v[60:63]
    ds_read2_b32 v[94:95], v239 offset0:226 offset1:227
    v_alignbit_b32 v221, v222, v221, 16
    v_mfma_f32_16x16x32_bf16 v[60:63], v[132:135], v[184:187], v[60:63]
    ds_write_b128 v241, v[218:221] offset:13536
    v_mfma_f32_16x16x32_bf16 v[60:63], v[128:131], v[188:191], v[60:63]
    s_waitcnt lgkmcnt(15)
    v_mfma_f32_16x16x32_bf16 v[32:35], v[64:67], v[96:99], v[32:35]
    ds_read_b128 v[160:163], v247 offset:0
    s_waitcnt vmcnt(6)
    s_barrier
    v_mfma_f32_16x16x32_bf16 v[36:39], v[68:71], v[96:99], v[36:39]
    ds_read_b64_tr_b16 a[128:129], v10 offset:16384
    v_alignbit_b32 v224, v225, v224, 16
    v_mfma_f32_16x16x32_bf16 v[36:39], v[64:67], v[100:103], v[36:39]
    ds_read_b64_tr_b16 a[130:131], v10 offset:18432
    ds_read_b128 v[164:167], v247 offset:4096
    v_mfma_f32_16x16x32_bf16 v[40:43], v[64:67], v[104:107], v[40:43]
    ds_read_b128 v[168:171], v247 offset:8192
    v_mfma_f32_16x16x32_bf16 v[40:43], v[68:71], v[100:103], v[40:43]
    ds_read_b64_tr_b16 a[136:137], v10 offset:20480
    ds_read_b128 v[172:175], v247 offset:12288
    v_mfma_f32_16x16x32_bf16 v[40:43], v[72:75], v[96:99], v[40:43]
    ds_read_b64_tr_b16 a[138:139], v10 offset:22528
    v_alignbit_b32 v225, v226, v225, 16
    v_mfma_f32_16x16x32_bf16 v[44:47], v[76:79], v[96:99], v[44:47]
    s_add_u32 m0, s73, 0
    ds_read_b128 v[176:179], v247 offset:16384
    v_mfma_f32_16x16x32_bf16 v[44:47], v[72:75], v[100:103], v[44:47]
    ds_read_b64_tr_b16 a[132:133], v11 offset:16384
    buffer_load_dwordx4 v6, s[52:55], s14 offen offset:2048 lds
    ds_read_b128 v[180:183], v247 offset:20480
    v_mfma_f32_16x16x32_bf16 v[44:47], v[68:71], v[104:107], v[44:47]
    ds_read_b64_tr_b16 a[134:135], v11 offset:18432
    v_mfma_f32_16x16x32_bf16 v[44:47], v[64:67], v[108:111], v[44:47]
    ds_read_b128 v[184:187], v247 offset:24576
    v_alignbit_b32 v226, v227, v226, 16
    s_waitcnt lgkmcnt(14)
    v_mfma_f32_16x16x32_bf16 v[48:51], v[64:67], v[112:115], v[48:51]
    ds_read_b64_tr_b16 a[140:141], v11 offset:20480
    ds_read_b128 v[188:191], v247 offset:28672
    v_mfma_f32_16x16x32_bf16 v[48:51], v[68:71], v[108:111], v[48:51]
    ds_read_b64_tr_b16 a[142:143], v11 offset:22528
    v_mfma_f32_16x16x32_bf16 v[48:51], v[72:75], v[104:107], v[48:51]
    ds_read2_b32 v[128:129], v236 offset0:112 offset1:113
    v_alignbit_b32 v227, v228, v227, 16
    v_mfma_f32_16x16x32_bf16 v[48:51], v[76:79], v[100:103], v[48:51]
    ds_read2_b32 v[130:131], v236 offset0:114 offset1:115
    v_mfma_f32_16x16x32_bf16 v[48:51], v[80:83], v[96:99], v[48:51]
    ds_read2_b32 v[132:133], v236 offset0:240 offset1:241
    v_mfma_f32_16x16x32_bf16 v[52:55], v[84:87], v[96:99], v[52:55]
    ds_read2_b32 v[134:135], v236 offset0:242 offset1:243
    v_mfma_f32_16x16x32_bf16 v[52:55], v[80:83], v[100:103], v[52:55]
    ds_write_b128 v241, v[224:227] offset:14560
    v_mfma_f32_16x16x32_bf16 v[52:55], v[76:79], v[104:107], v[52:55]
    ds_read2_b32 v[136:137], v237 offset0:112 offset1:113
    ds_read2_b32 v[138:139], v237 offset0:114 offset1:115
    v_mfma_f32_16x16x32_bf16 v[52:55], v[72:75], v[108:111], v[52:55]
    s_add_u32 m0, s73, 0
    ds_read2_b32 v[140:141], v237 offset0:240 offset1:241
    s_add_u32 s6, s12, 4751360
    v_mfma_f32_16x16x32_bf16 v[52:55], v[68:71], v[112:115], v[52:55]
    buffer_load_dwordx4 v7, s[52:55], s14 offen offset:3072 lds
    v_alignbit_b32 v230, v231, v230, 16
    v_mfma_f32_16x16x32_bf16 v[52:55], v[64:67], v[116:119], v[52:55]
    ds_read2_b32 v[142:143], v237 offset0:242 offset1:243
    v_xor_b32 v244, 64, v244
    v_mfma_f32_16x16x32_bf16 v[56:59], v[64:67], v[120:123], v[56:59]
    ds_read2_b32 v[144:145], v238 offset0:112 offset1:113
    v_mfma_f32_16x16x32_bf16 v[56:59], v[68:71], v[116:119], v[56:59]
    ds_read2_b32 v[146:147], v238 offset0:114 offset1:115
    v_mfma_f32_16x16x32_bf16 v[56:59], v[72:75], v[112:115], v[56:59]
    ds_read2_b32 v[148:149], v238 offset0:240 offset1:241
    v_alignbit_b32 v231, v232, v231, 16
    v_mfma_f32_16x16x32_bf16 v[56:59], v[76:79], v[108:111], v[56:59]
    ds_read2_b32 v[150:151], v238 offset0:242 offset1:243
    v_xor_b32 v245, 64, v245
    v_mfma_f32_16x16x32_bf16 v[56:59], v[80:83], v[104:107], v[56:59]
    ds_read2_b32 v[152:153], v239 offset0:112 offset1:113
    s_waitcnt lgkmcnt(14)
    s_barrier
    v_mfma_f32_16x16x32_bf16 v[56:59], v[84:87], v[100:103], v[56:59]
    ds_read2_b32 v[154:155], v239 offset0:114 offset1:115
    v_mfma_f32_16x16x32_bf16 v[56:59], v[88:91], v[96:99], v[56:59]
    ds_read2_b32 v[156:157], v239 offset0:240 offset1:241
    v_alignbit_b32 v232, v233, v232, 16
    v_mfma_f32_16x16x32_bf16 v[60:63], v[92:95], v[96:99], v[60:63]
    s_lshl_b32 s14, s95, 18
    ds_read2_b32 v[158:159], v239 offset0:242 offset1:243
    v_mfma_f32_16x16x32_bf16 v[60:63], v[88:91], v[100:103], v[60:63]
    s_add_u32 m0, s73, 16384
    v_xor_b32 v246, 64, v246
    v_add_u32 v236, 8320, v236
    v_mfma_f32_16x16x32_bf16 v[60:63], v[84:87], v[104:107], v[60:63]
    buffer_load_dwordx4 v4, s[52:55], s14 offen offset:0 lds
    v_alignbit_b32 v233, v234, v233, 16
    v_mfma_f32_16x16x32_bf16 v[60:63], v[80:83], v[108:111], v[60:63]
    v_add_u32 v237, 8320, v237
    v_mfma_f32_16x16x32_bf16 v[60:63], v[76:79], v[112:115], v[60:63]
    v_mfma_f32_16x16x32_bf16 v[60:63], v[72:75], v[116:119], v[60:63]
    v_xor_b32 v247, 64, v247
    v_add_u32 v238, 8320, v238
    v_mfma_f32_16x16x32_bf16 v[60:63], v[68:71], v[120:123], v[60:63]
    ds_write_b128 v241, v[230:233] offset:15584
    v_mfma_f32_16x16x32_bf16 v[60:63], v[64:67], v[124:127], v[60:63]
    v_add_u32 v239, 8320, v239
    s_waitcnt lgkmcnt(1)
    v_mfma_f32_16x16x32_bf16 v[60:63], v[128:131], v[188:191], v[60:63]
    ds_read_b128 v[96:99], v244 offset:2048
    v_mfma_f32_16x16x32_bf16 v[60:63], v[132:135], v[184:187], v[60:63]
    ds_read2_b32 v[64:65], v236 offset0:0 offset1:1
    v_mfma_f32_16x16x32_bf16 v[60:63], v[136:139], v[180:183], v[60:63]
    ds_read2_b32 v[66:67], v236 offset0:2 offset1:3
    v_mfma_f32_16x16x32_bf16 v[60:63], v[140:143], v[176:179], v[60:63]
    ds_read_b128 v[100:103], v244 offset:6144
    v_mfma_f32_16x16x32_bf16 v[60:63], v[144:147], v[172:175], v[60:63]
    ds_read2_b32 v[68:69], v236 offset0:128 offset1:129
    v_mfma_f32_16x16x32_bf16 v[60:63], v[148:151], v[168:171], v[60:63]
    s_add_u32 m0, s73, 16384
    ds_read2_b32 v[70:71], v236 offset0:130 offset1:131
    v_mfma_f32_16x16x32_bf16 v[60:63], v[152:155], v[164:167], v[60:63]
    buffer_load_dwordx4 v5, s[52:55], s14 offen offset:1024 lds
    ds_read_b128 v[104:107], v244 offset:10240
    v_mfma_f32_16x16x32_bf16 v[60:63], v[156:159], v[160:163], v[60:63]
    ds_read2_b32 v[72:73], v237 offset0:0 offset1:1
    v_mfma_f32_16x16x32_bf16 v[56:59], v[128:131], v[184:187], v[56:59]
    ds_read2_b32 v[74:75], v237 offset0:2 offset1:3
    v_mfma_f32_16x16x32_bf16 v[56:59], v[132:135], v[180:183], v[56:59]
    ds_read_b128 v[108:111], v244 offset:14336
    v_mfma_f32_16x16x32_bf16 v[56:59], v[136:139], v[176:179], v[56:59]
    ds_read2_b32 v[76:77], v237 offset0:128 offset1:129
    v_mfma_f32_16x16x32_bf16 v[56:59], v[140:143], v[172:175], v[56:59]
    ds_read2_b32 v[78:79], v237 offset0:130 offset1:131
    v_mfma_f32_16x16x32_bf16 v[56:59], v[144:147], v[168:171], v[56:59]
    ds_read_b128 v[112:115], v244 offset:18432
    v_mfma_f32_16x16x32_bf16 v[56:59], v[148:151], v[164:167], v[56:59]
    ds_read2_b32 v[80:81], v238 offset0:0 offset1:1
    v_cvt_pk_bf16_f32 v206, v60, v61
    v_mfma_f32_16x16x32_bf16 v[56:59], v[152:155], v[160:163], v[56:59]
    ds_read2_b32 v[82:83], v238 offset0:2 offset1:3
    s_waitcnt vmcnt(6)
    s_barrier
    v_mfma_f32_16x16x32_bf16 v[52:55], v[128:131], v[180:183], v[52:55]
    ds_read_b128 v[116:119], v244 offset:22528
    v_add_u32 v10, 131072, v10
    v_mfma_f32_16x16x32_bf16 v[52:55], v[132:135], v[176:179], v[52:55]
    ds_read_b64_tr_b16 a[144:145], v10 offset:16384
    v_cvt_pk_bf16_f32 v207, v62, v63
    v_mfma_f32_16x16x32_bf16 v[52:55], v[136:139], v[172:175], v[52:55]
    ds_read_b64_tr_b16 a[146:147], v10 offset:18432
    s_add_u32 m0, s73, 16384
    v_mfma_f32_16x16x32_bf16 v[52:55], v[140:143], v[168:171], v[52:55]
    buffer_load_dwordx4 v6, s[52:55], s14 offen offset:2048 lds
    ds_read2_b32 v[84:85], v238 offset0:128 offset1:129
    v_mfma_f32_16x16x32_bf16 v[52:55], v[144:147], v[164:167], v[52:55]
    buffer_store_dwordx2 v[206:207], v8, s[44:47], s6 offen offset:3584 sc1
    ds_read_b64_tr_b16 a[152:153], v10 offset:20480
    v_mfma_f32_16x16x32_bf16 v[52:55], v[148:151], v[160:163], v[52:55]
    ds_read_b64_tr_b16 a[154:155], v10 offset:22528
    v_mfma_f32_16x16x32_bf16 v[48:51], v[128:131], v[176:179], v[48:51]
    ds_read2_b32 v[86:87], v238 offset0:130 offset1:131
    v_add_u32 v11, 131072, v11
    v_cvt_pk_bf16_f32 v204, v56, v57
    v_mfma_f32_16x16x32_bf16 v[48:51], v[132:135], v[172:175], v[48:51]
    ds_read_b64_tr_b16 a[148:149], v11 offset:16384
    ds_read_b128 v[120:123], v244 offset:26624
    v_mfma_f32_16x16x32_bf16 v[48:51], v[136:139], v[168:171], v[48:51]
    ds_read_b64_tr_b16 a[150:151], v11 offset:18432
    ds_read2_b32 v[88:89], v239 offset0:0 offset1:1
    v_mfma_f32_16x16x32_bf16 v[48:51], v[140:143], v[164:167], v[48:51]
    ds_read2_b32 v[90:91], v239 offset0:2 offset1:3
    v_cvt_pk_bf16_f32 v205, v58, v59
    v_mfma_f32_16x16x32_bf16 v[48:51], v[144:147], v[160:163], v[48:51]
    ds_read_b64_tr_b16 a[156:157], v11 offset:20480
    ds_read_b128 v[124:127], v244 offset:30720
    v_mfma_f32_16x16x32_bf16 v[44:47], v[128:131], v[172:175], v[44:47]
    buffer_store_dwordx2 v[204:205], v8, s[44:47], s6 offen offset:3072 sc1
    ds_read_b64_tr_b16 a[158:159], v11 offset:22528
    v_mfma_f32_16x16x32_bf16 v[44:47], v[132:135], v[168:171], v[44:47]
    ds_read2_b32 v[92:93], v239 offset0:128 offset1:129
    v_mfma_f32_16x16x32_bf16 v[44:47], v[136:139], v[164:167], v[44:47]
    s_add_u32 m0, s73, 16384
    ds_read2_b32 v[94:95], v239 offset0:130 offset1:131
    v_mfma_f32_16x16x32_bf16 v[44:47], v[140:143], v[160:163], v[44:47]
    buffer_load_dwordx4 v7, s[52:55], s14 offen offset:3072 lds
    v_cvt_pk_bf16_f32 v202, v52, v53
    v_mfma_f32_16x16x32_bf16 v[40:43], v[128:131], v[168:171], v[40:43]
    v_mfma_f32_16x16x32_bf16 v[40:43], v[132:135], v[164:167], v[40:43]
    v_mfma_f32_16x16x32_bf16 v[40:43], v[136:139], v[160:163], v[40:43]
    v_cvt_pk_bf16_f32 v203, v54, v55
    v_mfma_f32_16x16x32_bf16 v[36:39], v[128:131], v[164:167], v[36:39]
    v_mfma_f32_16x16x32_bf16 v[36:39], v[132:135], v[160:163], v[36:39]
    buffer_store_dwordx2 v[202:203], v8, s[44:47], s6 offen offset:2560 sc1
    v_mfma_f32_16x16x32_bf16 v[32:35], v[128:131], v[160:163], v[32:35]
    s_waitcnt lgkmcnt(0)
    v_mfma_f32_16x16x32_bf16 v[60:63], v[64:67], v[124:127], 0
    ds_read_b128 v[160:163], v245 offset:2048
    v_mfma_f32_16x16x32_bf16 v[60:63], v[68:71], v[120:123], v[60:63]
    v_cvt_pk_bf16_f32 v200, v48, v49
    v_mfma_f32_16x16x32_bf16 v[60:63], v[72:75], v[116:119], v[60:63]
    ds_read2_b32 v[128:129], v236 offset0:16 offset1:17
    v_mfma_f32_16x16x32_bf16 v[60:63], v[76:79], v[112:115], v[60:63]
    s_barrier
    v_cvt_pk_bf16_f32 v201, v50, v51
    v_mfma_f32_16x16x32_bf16 v[60:63], v[80:83], v[108:111], v[60:63]
    ds_read2_b32 v[130:131], v236 offset0:18 offset1:19
    v_mfma_f32_16x16x32_bf16 v[60:63], v[84:87], v[104:107], v[60:63]
    buffer_store_dwordx2 v[200:201], v8, s[44:47], s6 offen offset:2048 sc1
    ds_read_b128 v[164:167], v245 offset:6144
    v_mfma_f32_16x16x32_bf16 v[60:63], v[88:91], v[100:103], v[60:63]
    ds_read2_b32 v[132:133], v236 offset0:144 offset1:145
    v_mfma_f32_16x16x32_bf16 v[60:63], v[92:95], v[96:99], v[60:63]
    ds_read2_b32 v[134:135], v236 offset0:146 offset1:147
    s_lshl_b32 s14, s96, 18
    v_cvt_pk_bf16_f32 v198, v44, v45
    v_mfma_f32_16x16x32_bf16 v[56:59], v[64:67], v[120:123], 0
    s_add_u32 m0, s73, 147456
    ds_read_b128 v[168:171], v245 offset:10240
    v_mfma_f32_16x16x32_bf16 v[56:59], v[68:71], v[116:119], v[56:59]
    buffer_load_dwordx4 v4, s[52:55], s14 offen offset:0 lds
    ds_read2_b32 v[136:137], v237 offset0:16 offset1:17
    v_mfma_f32_16x16x32_bf16 v[56:59], v[72:75], v[112:115], v[56:59]
    ds_read2_b32 v[138:139], v237 offset0:18 offset1:19
    v_cvt_pk_bf16_f32 v199, v46, v47
    v_mfma_f32_16x16x32_bf16 v[56:59], v[76:79], v[108:111], v[56:59]
    ds_read_b128 v[172:175], v245 offset:14336
    v_mfma_f32_16x16x32_bf16 v[56:59], v[80:83], v[104:107], v[56:59]
    buffer_store_dwordx2 v[198:199], v8, s[44:47], s6 offen offset:1536 sc1
    ds_read2_b32 v[140:141], v237 offset0:144 offset1:145
    v_mfma_f32_16x16x32_bf16 v[56:59], v[84:87], v[100:103], v[56:59]
    ds_read2_b32 v[142:143], v237 offset0:146 offset1:147
    v_mfma_f32_16x16x32_bf16 v[56:59], v[88:91], v[96:99], v[56:59]
    ds_read_b128 v[176:179], v245 offset:18432
    v_cvt_pk_bf16_f32 v196, v40, v41
    v_mfma_f32_16x16x32_bf16 v[52:55], v[64:67], v[116:119], 0
    ds_read2_b32 v[144:145], v238 offset0:16 offset1:17
    v_mfma_f32_16x16x32_bf16 v[52:55], v[68:71], v[112:115], v[52:55]
    ds_read2_b32 v[146:147], v238 offset0:18 offset1:19
    v_cvt_pk_bf16_f32 v197, v42, v43
    v_mfma_f32_16x16x32_bf16 v[52:55], v[72:75], v[108:111], v[52:55]
    ds_read_b128 v[180:183], v245 offset:22528
    v_mfma_f32_16x16x32_bf16 v[52:55], v[76:79], v[104:107], v[52:55]
    buffer_store_dwordx2 v[196:197], v8, s[44:47], s6 offen offset:1024 sc1
    ds_read2_b32 v[148:149], v238 offset0:144 offset1:145
    v_mfma_f32_16x16x32_bf16 v[52:55], v[80:83], v[100:103], v[52:55]
    s_add_u32 m0, s73, 147456
    ds_read2_b32 v[150:151], v238 offset0:146 offset1:147
    v_mfma_f32_16x16x32_bf16 v[52:55], v[84:87], v[96:99], v[52:55]
    buffer_load_dwordx4 v5, s[52:55], s14 offen offset:1024 lds
    ds_read_b128 v[184:187], v245 offset:26624
    v_mfma_f32_16x16x32_bf16 v[48:51], v[64:67], v[112:115], 0
    ds_read2_b32 v[152:153], v239 offset0:16 offset1:17
    v_cvt_pk_bf16_f32 v194, v36, v37
    v_mfma_f32_16x16x32_bf16 v[48:51], v[68:71], v[108:111], v[48:51]
    ds_read2_b32 v[154:155], v239 offset0:18 offset1:19
    v_mfma_f32_16x16x32_bf16 v[48:51], v[72:75], v[104:107], v[48:51]
    ds_read_b128 v[188:191], v245 offset:30720
    v_cvt_pk_bf16_f32 v195, v38, v39
    v_mfma_f32_16x16x32_bf16 v[48:51], v[76:79], v[100:103], v[48:51]
    ds_read2_b32 v[156:157], v239 offset0:144 offset1:145
    v_mfma_f32_16x16x32_bf16 v[48:51], v[80:83], v[96:99], v[48:51]
    buffer_store_dwordx2 v[194:195], v8, s[44:47], s6 offen offset:512 sc1
    s_waitcnt vmcnt(13)
    s_barrier
    v_mfma_f32_16x16x32_bf16 v[44:47], v[64:67], v[108:111], 0
    v_add_u32 v10, -131072, v10
    v_cvt_pk_bf16_f32 v192, v32, v33
    v_mfma_f32_16x16x32_bf16 v[44:47], v[68:71], v[104:107], v[44:47]
    ds_read_b64_tr_b16 a[160:161], v10 offset:0
    v_mfma_f32_16x16x32_bf16 v[44:47], v[72:75], v[100:103], v[44:47]
    ds_read_b64_tr_b16 a[162:163], v10 offset:2048
    v_mfma_f32_16x16x32_bf16 v[44:47], v[76:79], v[96:99], v[44:47]
    ds_read_b64_tr_b16 a[168:169], v10 offset:4096
    v_cvt_pk_bf16_f32 v193, v34, v35
    v_mfma_f32_16x16x32_bf16 v[40:43], v[64:67], v[104:107], 0
    ds_read2_b32 v[158:159], v239 offset0:146 offset1:147
    v_mfma_f32_16x16x32_bf16 v[40:43], v[68:71], v[100:103], v[40:43]
    buffer_store_dwordx2 v[192:193], v8, s[44:47], s6 offen offset:0 sc1
    ds_read_b64_tr_b16 a[170:171], v10 offset:6144
    s_add_u32 m0, s73, 147456
    v_mfma_f32_16x16x32_bf16 v[40:43], v[72:75], v[96:99], v[40:43]
    v_add_u32 v11, -131072, v11
L_pl_X_5:
    s_cbranch_execz L_wret
    buffer_load_dwordx4 v6, s[52:55], s14 offen offset:2048 lds
    v_mfma_f32_16x16x32_bf16 v[36:39], v[64:67], v[100:103], 0
    ds_read_b64_tr_b16 a[164:165], v11 offset:0
    v_mfma_f32_16x16x32_bf16 v[36:39], v[68:71], v[96:99], v[36:39]
    ds_read_b64_tr_b16 a[166:167], v11 offset:2048
    v_mfma_f32_16x16x32_bf16 v[32:35], v[64:67], v[96:99], 0
    ds_read_b64_tr_b16 a[172:173], v11 offset:4096
    s_waitcnt lgkmcnt(15)
    v_mfma_f32_16x16x32_bf16 v[32:35], v[128:131], v[160:163], v[32:35]
    ds_read_b64_tr_b16 a[174:175], v11 offset:6144
    v_mfma_f32_16x16x32_bf16 v[36:39], v[132:135], v[160:163], v[36:39]
    ds_read_b128 v[96:99], v246 offset:2048
    v_mfma_f32_16x16x32_bf16 v[36:39], v[128:131], v[164:167], v[36:39]
    ds_read2_b32 v[64:65], v236 offset0:32 offset1:33
    v_mfma_f32_16x16x32_bf16 v[40:43], v[128:131], v[168:171], v[40:43]
    ds_read2_b32 v[66:67], v236 offset0:34 offset1:35
    v_mfma_f32_16x16x32_bf16 v[40:43], v[132:135], v[164:167], v[40:43]
    v_mfma_f32_16x16x32_bf16 v[40:43], v[136:139], v[160:163], v[40:43]
    ds_read_b128 v[100:103], v246 offset:6144
    v_mfma_f32_16x16x32_bf16 v[44:47], v[140:143], v[160:163], v[44:47]
    ds_read2_b32 v[68:69], v236 offset0:160 offset1:161
    v_mfma_f32_16x16x32_bf16 v[44:47], v[136:139], v[164:167], v[44:47]
    s_add_u32 m0, s73, 147456
    v_mfma_f32_16x16x32_bf16 v[44:47], v[132:135], v[168:171], v[44:47]
    buffer_load_dwordx4 v7, s[52:55], s14 offen offset:3072 lds
    ds_read2_b32 v[70:71], v236 offset0:162 offset1:163
    v_mfma_f32_16x16x32_bf16 v[44:47], v[128:131], v[172:175], v[44:47]
    ds_read_b128 v[104:107], v246 offset:10240
    s_waitcnt lgkmcnt(12)
    v_mfma_f32_16x16x32_bf16 v[48:51], v[128:131], v[176:179], v[48:51]
    ds_read2_b32 v[72:73], v237 offset0:32 offset1:33
    v_mfma_f32_16x16x32_bf16 v[48:51], v[132:135], v[172:175], v[48:51]
    v_mfma_f32_16x16x32_bf16 v[48:51], v[136:139], v[168:171], v[48:51]
    ds_read2_b32 v[74:75], v237 offset0:34 offset1:35
    v_mfma_f32_16x16x32_bf16 v[48:51], v[140:143], v[164:167], v[48:51]
    ds_read_b128 v[108:111], v246 offset:14336
    v_mfma_f32_16x16x32_bf16 v[48:51], v[144:147], v[160:163], v[48:51]
    s_waitcnt lgkmcnt(10)
    s_barrier
    v_mfma_f32_16x16x32_bf16 v[52:55], v[148:151], v[160:163], v[52:55]
    ds_read2_b32 v[76:77], v237 offset0:160 offset1:161
    v_mfma_f32_16x16x32_bf16 v[52:55], v[144:147], v[164:167], v[52:55]
    ds_read2_b32 v[78:79], v237 offset0:162 offset1:163
    v_mfma_f32_16x16x32_bf16 v[52:55], v[140:143], v[168:171], v[52:55]
    v_mfma_f32_16x16x32_bf16 v[52:55], v[136:139], v[172:175], v[52:55]
    s_lshl_b32 s14, s97, 18
    ds_read_b128 v[112:115], v246 offset:18432
    v_mfma_f32_16x16x32_bf16 v[52:55], v[132:135], v[176:179], v[52:55]
    s_add_u32 m0, s73, 0
    ds_read2_b32 v[80:81], v238 offset0:32 offset1:33
    v_mfma_f32_16x16x32_bf16 v[52:55], v[128:131], v[180:183], v[52:55]
    buffer_load_dwordx4 v4, s[52:55], s14 offen offset:0 lds
    v_mfma_f32_16x16x32_bf16 v[56:59], v[128:131], v[184:187], v[56:59]
    ds_read2_b32 v[82:83], v238 offset0:34 offset1:35
    v_mfma_f32_16x16x32_bf16 v[56:59], v[132:135], v[180:183], v[56:59]
    ds_read_b128 v[116:119], v246 offset:22528
    v_mfma_f32_16x16x32_bf16 v[56:59], v[136:139], v[176:179], v[56:59]
    v_mfma_f32_16x16x32_bf16 v[56:59], v[140:143], v[172:175], v[56:59]
    ds_read2_b32 v[84:85], v238 offset0:160 offset1:161
    v_mfma_f32_16x16x32_bf16 v[56:59], v[144:147], v[168:171], v[56:59]
    ds_read2_b32 v[86:87], v238 offset0:162 offset1:163
    v_mfma_f32_16x16x32_bf16 v[56:59], v[148:151], v[164:167], v[56:59]
    ds_read_b128 v[120:123], v246 offset:26624
    v_mfma_f32_16x16x32_bf16 v[56:59], v[152:155], v[160:163], v[56:59]
    v_mfma_f32_16x16x32_bf16 v[60:63], v[156:159], v[160:163], v[60:63]
    ds_read2_b32 v[88:89], v239 offset0:32 offset1:33
    v_mfma_f32_16x16x32_bf16 v[60:63], v[152:155], v[164:167], v[60:63]
    ds_read2_b32 v[90:91], v239 offset0:34 offset1:35
    v_mfma_f32_16x16x32_bf16 v[60:63], v[148:151], v[168:171], v[60:63]
    s_add_u32 m0, s73, 0
    v_mfma_f32_16x16x32_bf16 v[60:63], v[144:147], v[172:175], v[60:63]
    buffer_load_dwordx4 v5, s[52:55], s14 offen offset:1024 lds
    ds_read_b128 v[124:127], v246 offset:30720
    v_mfma_f32_16x16x32_bf16 v[60:63], v[140:143], v[176:179], v[60:63]
    ds_read2_b32 v[92:93], v239 offset0:160 offset1:161
    v_mfma_f32_16x16x32_bf16 v[60:63], v[136:139], v[180:183], v[60:63]
    v_mfma_f32_16x16x32_bf16 v[60:63], v[132:135], v[184:187], v[60:63]
    ds_read2_b32 v[94:95], v239 offset0:162 offset1:163
    v_mfma_f32_16x16x32_bf16 v[60:63], v[128:131], v[188:191], v[60:63]
    s_waitcnt lgkmcnt(12)
    v_mfma_f32_16x16x32_bf16 v[32:35], v[64:67], v[96:99], v[32:35]
    ds_read_b128 v[160:163], v247 offset:2048
    s_waitcnt vmcnt(12)
    s_barrier
    v_mfma_f32_16x16x32_bf16 v[36:39], v[68:71], v[96:99], v[36:39]
    ds_read_b64_tr_b16 a[176:177], v10 offset:16384
    v_mfma_f32_16x16x32_bf16 v[36:39], v[64:67], v[100:103], v[36:39]
    ds_read_b64_tr_b16 a[178:179], v10 offset:18432
    v_mfma_f32_16x16x32_bf16 v[40:43], v[64:67], v[104:107], v[40:43]
    ds_read2_b32 v[128:129], v236 offset0:48 offset1:49
    v_mfma_f32_16x16x32_bf16 v[40:43], v[68:71], v[100:103], v[40:43]
    ds_read_b64_tr_b16 a[184:185], v10 offset:20480
    v_mfma_f32_16x16x32_bf16 v[40:43], v[72:75], v[96:99], v[40:43]
    ds_read_b64_tr_b16 a[186:187], v10 offset:22528
    v_mfma_f32_16x16x32_bf16 v[44:47], v[76:79], v[96:99], v[44:47]
    s_add_u32 m0, s73, 0
    ds_read2_b32 v[130:131], v236 offset0:50 offset1:51
    v_mfma_f32_16x16x32_bf16 v[44:47], v[72:75], v[100:103], v[44:47]
    ds_read_b64_tr_b16 a[180:181], v11 offset:16384
    buffer_load_dwordx4 v6, s[52:55], s14 offen offset:2048 lds
    v_mfma_f32_16x16x32_bf16 v[44:47], v[68:71], v[104:107], v[44:47]
    ds_read_b64_tr_b16 a[182:183], v11 offset:18432
    v_mfma_f32_16x16x32_bf16 v[44:47], v[64:67], v[108:111], v[44:47]
    ds_read_b128 v[164:167], v247 offset:6144
    s_waitcnt lgkmcnt(10)
    v_mfma_f32_16x16x32_bf16 v[48:51], v[64:67], v[112:115], v[48:51]
    ds_read_b64_tr_b16 a[188:189], v11 offset:20480
    v_mfma_f32_16x16x32_bf16 v[48:51], v[68:71], v[108:111], v[48:51]
    ds_read_b64_tr_b16 a[190:191], v11 offset:22528
    v_mfma_f32_16x16x32_bf16 v[48:51], v[72:75], v[104:107], v[48:51]
    ds_read2_b32 v[132:133], v236 offset0:176 offset1:177
    v_mfma_f32_16x16x32_bf16 v[48:51], v[76:79], v[100:103], v[48:51]
    ds_read2_b32 v[134:135], v236 offset0:178 offset1:179
    v_mfma_f32_16x16x32_bf16 v[48:51], v[80:83], v[96:99], v[48:51]
    ds_read_b128 v[168:171], v247 offset:10240
    v_mfma_f32_16x16x32_bf16 v[52:55], v[84:87], v[96:99], v[52:55]
    ds_read2_b32 v[136:137], v237 offset0:48 offset1:49
    v_mfma_f32_16x16x32_bf16 v[52:55], v[80:83], v[100:103], v[52:55]
    ds_read2_b32 v[138:139], v237 offset0:50 offset1:51
    v_mfma_f32_16x16x32_bf16 v[52:55], v[76:79], v[104:107], v[52:55]
    ds_read_b128 v[172:175], v247 offset:14336
    v_mfma_f32_16x16x32_bf16 v[52:55], v[72:75], v[108:111], v[52:55]
    s_add_u32 m0, s73, 0
    ds_read2_b32 v[140:141], v237 offset0:176 offset1:177
    v_mfma_f32_16x16x32_bf16 v[52:55], v[68:71], v[112:115], v[52:55]
    buffer_load_dwordx4 v7, s[52:55], s14 offen offset:3072 lds
    ds_read2_b32 v[142:143], v237 offset0:178 offset1:179
    v_mfma_f32_16x16x32_bf16 v[52:55], v[64:67], v[116:119], v[52:55]
    ds_read_b128 v[176:179], v247 offset:18432
    v_mfma_f32_16x16x32_bf16 v[56:59], v[64:67], v[120:123], v[56:59]
    ds_read2_b32 v[144:145], v238 offset0:48 offset1:49
    v_mfma_f32_16x16x32_bf16 v[56:59], v[68:71], v[116:119], v[56:59]
    ds_read2_b32 v[146:147], v238 offset0:50 offset1:51
    v_mfma_f32_16x16x32_bf16 v[56:59], v[72:75], v[112:115], v[56:59]
    ds_read_b128 v[180:183], v247 offset:22528
    v_mfma_f32_16x16x32_bf16 v[56:59], v[76:79], v[108:111], v[56:59]
    ds_read2_b32 v[148:149], v238 offset0:176 offset1:177
    v_mfma_f32_16x16x32_bf16 v[56:59], v[80:83], v[104:107], v[56:59]
    ds_read2_b32 v[150:151], v238 offset0:178 offset1:179
    s_waitcnt lgkmcnt(14)
    s_barrier
    v_mfma_f32_16x16x32_bf16 v[56:59], v[84:87], v[100:103], v[56:59]
    ds_read_b128 v[184:187], v247 offset:26624
    v_mfma_f32_16x16x32_bf16 v[56:59], v[88:91], v[96:99], v[56:59]
    v_mfma_f32_16x16x32_bf16 v[60:63], v[92:95], v[96:99], v[60:63]
    s_lshl_b32 s14, s98, 18
    ds_read2_b32 v[152:153], v239 offset0:48 offset1:49
    v_mfma_f32_16x16x32_bf16 v[60:63], v[88:91], v[100:103], v[60:63]
    s_add_u32 m0, s73, 16384
    ds_read2_b32 v[154:155], v239 offset0:50 offset1:51
    v_mfma_f32_16x16x32_bf16 v[60:63], v[84:87], v[104:107], v[60:63]
    buffer_load_dwordx4 v4, s[52:55], s14 offen offset:0 lds
    v_mfma_f32_16x16x32_bf16 v[60:63], v[80:83], v[108:111], v[60:63]
    ds_read_b128 v[188:191], v247 offset:30720
    v_mfma_f32_16x16x32_bf16 v[60:63], v[76:79], v[112:115], v[60:63]
    ds_read2_b32 v[156:157], v239 offset0:176 offset1:177
    v_mfma_f32_16x16x32_bf16 v[60:63], v[72:75], v[116:119], v[60:63]
    v_mfma_f32_16x16x32_bf16 v[60:63], v[68:71], v[120:123], v[60:63]
    ds_read2_b32 v[158:159], v239 offset0:178 offset1:179
    v_mfma_f32_16x16x32_bf16 v[60:63], v[64:67], v[124:127], v[60:63]
    s_waitcnt lgkmcnt(12)
    v_mfma_f32_16x16x32_bf16 v[32:35], v[128:131], v[160:163], v[32:35]
    ds_read_b128 v[96:99], v244 offset:0
    v_mfma_f32_16x16x32_bf16 v[36:39], v[132:135], v[160:163], v[36:39]
    v_mfma_f32_16x16x32_bf16 v[36:39], v[128:131], v[164:167], v[36:39]
    ds_read2_b32 v[64:65], v236 offset0:64 offset1:65
    v_mfma_f32_16x16x32_bf16 v[40:43], v[128:131], v[168:171], v[40:43]
    ds_read2_b32 v[66:67], v236 offset0:66 offset1:67
    v_mfma_f32_16x16x32_bf16 v[40:43], v[132:135], v[164:167], v[40:43]
    v_mfma_f32_16x16x32_bf16 v[40:43], v[136:139], v[160:163], v[40:43]
    s_add_u32 m0, s73, 16384
    ds_read_b128 v[100:103], v244 offset:4096
    v_mfma_f32_16x16x32_bf16 v[44:47], v[140:143], v[160:163], v[44:47]
    buffer_load_dwordx4 v5, s[52:55], s14 offen offset:1024 lds
    ds_read2_b32 v[68:69], v236 offset0:192 offset1:193
    v_mfma_f32_16x16x32_bf16 v[44:47], v[136:139], v[164:167], v[44:47]
    v_mfma_f32_16x16x32_bf16 v[44:47], v[132:135], v[168:171], v[44:47]
    ds_read2_b32 v[70:71], v236 offset0:194 offset1:195
    v_mfma_f32_16x16x32_bf16 v[44:47], v[128:131], v[172:175], v[44:47]
    ds_read_b128 v[104:107], v244 offset:8192
    s_waitcnt lgkmcnt(7)
    v_mfma_f32_16x16x32_bf16 v[48:51], v[128:131], v[176:179], v[48:51]
    ds_read2_b32 v[72:73], v237 offset0:64 offset1:65
    v_mfma_f32_16x16x32_bf16 v[48:51], v[132:135], v[172:175], v[48:51]
    ds_read2_b32 v[74:75], v237 offset0:66 offset1:67
    v_mfma_f32_16x16x32_bf16 v[48:51], v[136:139], v[168:171], v[48:51]
    ds_read_b128 v[108:111], v244 offset:12288
    v_mfma_f32_16x16x32_bf16 v[48:51], v[140:143], v[164:167], v[48:51]
    ds_read2_b32 v[76:77], v237 offset0:192 offset1:193
    v_mfma_f32_16x16x32_bf16 v[48:51], v[144:147], v[160:163], v[48:51]
    ds_read2_b32 v[78:79], v237 offset0:194 offset1:195
    s_waitcnt vmcnt(6)
    s_barrier
    v_mfma_f32_16x16x32_bf16 v[52:55], v[148:151], v[160:163], v[52:55]
    ds_read_b128 v[112:115], v244 offset:16384
    v_add_u32 v10, 131072, v10
    v_mfma_f32_16x16x32_bf16 v[52:55], v[144:147], v[164:167], v[52:55]
    ds_read_b64_tr_b16 a[192:193], v10 offset:16384
    v_mfma_f32_16x16x32_bf16 v[52:55], v[140:143], v[168:171], v[52:55]
    ds_read_b64_tr_b16 a[194:195], v10 offset:18432
    s_add_u32 m0, s73, 16384
    v_mfma_f32_16x16x32_bf16 v[52:55], v[136:139], v[172:175], v[52:55]
    buffer_load_dwordx4 v6, s[52:55], s14 offen offset:2048 lds
    ds_read2_b32 v[80:81], v238 offset0:64 offset1:65
    v_mfma_f32_16x16x32_bf16 v[52:55], v[132:135], v[176:179], v[52:55]
    ds_read_b64_tr_b16 a[200:201], v10 offset:20480
    v_mfma_f32_16x16x32_bf16 v[52:55], v[128:131], v[180:183], v[52:55]
    ds_read_b64_tr_b16 a[202:203], v10 offset:22528
    v_mfma_f32_16x16x32_bf16 v[56:59], v[128:131], v[184:187], v[56:59]
    ds_read2_b32 v[82:83], v238 offset0:66 offset1:67
    v_add_u32 v11, 131072, v11
    v_mfma_f32_16x16x32_bf16 v[56:59], v[132:135], v[180:183], v[56:59]
    ds_read_b64_tr_b16 a[196:197], v11 offset:16384
    v_mfma_f32_16x16x32_bf16 v[56:59], v[136:139], v[176:179], v[56:59]
    ds_read_b64_tr_b16 a[198:199], v11 offset:18432
    v_mfma_f32_16x16x32_bf16 v[56:59], v[140:143], v[172:175], v[56:59]
    ds_read_b128 v[116:119], v244 offset:20480
    v_mfma_f32_16x16x32_bf16 v[56:59], v[144:147], v[168:171], v[56:59]
    ds_read_b64_tr_b16 a[204:205], v11 offset:20480
    v_mfma_f32_16x16x32_bf16 v[56:59], v[148:151], v[164:167], v[56:59]
    ds_read_b64_tr_b16 a[206:207], v11 offset:22528
    v_mfma_f32_16x16x32_bf16 v[56:59], v[152:155], v[160:163], v[56:59]
    ds_read2_b32 v[84:85], v238 offset0:192 offset1:193
    v_mfma_f32_16x16x32_bf16 v[60:63], v[156:159], v[160:163], v[60:63]
    s_add_u32 m0, s73, 16384
    ds_read2_b32 v[86:87], v238 offset0:194 offset1:195
    v_mfma_f32_16x16x32_bf16 v[60:63], v[152:155], v[164:167], v[60:63]
    buffer_load_dwordx4 v7, s[52:55], s14 offen offset:3072 lds
    ds_read_b128 v[120:123], v244 offset:24576
    v_mfma_f32_16x16x32_bf16 v[60:63], v[148:151], v[168:171], v[60:63]
    ds_read2_b32 v[88:89], v239 offset0:64 offset1:65
    v_mfma_f32_16x16x32_bf16 v[60:63], v[144:147], v[172:175], v[60:63]
    ds_read2_b32 v[90:91], v239 offset0:66 offset1:67
    v_mfma_f32_16x16x32_bf16 v[60:63], v[140:143], v[176:179], v[60:63]
    ds_read_b128 v[124:127], v244 offset:28672
    v_mfma_f32_16x16x32_bf16 v[60:63], v[136:139], v[180:183], v[60:63]
    ds_read2_b32 v[92:93], v239 offset0:192 offset1:193
    v_mfma_f32_16x16x32_bf16 v[60:63], v[132:135], v[184:187], v[60:63]
    ds_read2_b32 v[94:95], v239 offset0:194 offset1:195
    v_mfma_f32_16x16x32_bf16 v[60:63], v[128:131], v[188:191], v[60:63]
    s_waitcnt lgkmcnt(15)
    v_mfma_f32_16x16x32_bf16 v[32:35], v[64:67], v[96:99], v[32:35]
    ds_read_b128 v[160:163], v245 offset:0
    v_mfma_f32_16x16x32_bf16 v[36:39], v[68:71], v[96:99], v[36:39]
    v_mfma_f32_16x16x32_bf16 v[36:39], v[64:67], v[100:103], v[36:39]
    ds_read2_b32 v[128:129], v236 offset0:80 offset1:81
    v_mfma_f32_16x16x32_bf16 v[40:43], v[64:67], v[104:107], v[40:43]
    ds_read2_b32 v[130:131], v236 offset0:82 offset1:83
    s_waitcnt lgkmcnt(11)
    s_barrier
    v_mfma_f32_16x16x32_bf16 v[40:43], v[68:71], v[100:103], v[40:43]
    v_mfma_f32_16x16x32_bf16 v[40:43], v[72:75], v[96:99], v[40:43]
    ds_read_b128 v[164:167], v245 offset:4096
    v_mfma_f32_16x16x32_bf16 v[44:47], v[76:79], v[96:99], v[44:47]
    ds_read2_b32 v[132:133], v236 offset0:208 offset1:209
    v_mfma_f32_16x16x32_bf16 v[44:47], v[72:75], v[100:103], v[44:47]
    s_lshl_b32 s14, s99, 18
    v_mfma_f32_16x16x32_bf16 v[44:47], v[68:71], v[104:107], v[44:47]
    s_add_u32 m0, s73, 147456
    ds_read2_b32 v[134:135], v236 offset0:210 offset1:211
    v_mfma_f32_16x16x32_bf16 v[44:47], v[64:67], v[108:111], v[44:47]
    buffer_load_dwordx4 v4, s[52:55], s14 offen offset:0 lds
    ds_read_b128 v[168:171], v245 offset:8192
    s_waitcnt lgkmcnt(7)
    v_mfma_f32_16x16x32_bf16 v[48:51], v[64:67], v[112:115], v[48:51]
    ds_read2_b32 v[136:137], v237 offset0:80 offset1:81
    v_mfma_f32_16x16x32_bf16 v[48:51], v[68:71], v[108:111], v[48:51]
    v_mfma_f32_16x16x32_bf16 v[48:51], v[72:75], v[104:107], v[48:51]
    ds_read2_b32 v[138:139], v237 offset0:82 offset1:83
    v_mfma_f32_16x16x32_bf16 v[48:51], v[76:79], v[100:103], v[48:51]
    ds_read_b128 v[172:175], v245 offset:12288
    v_mfma_f32_16x16x32_bf16 v[48:51], v[80:83], v[96:99], v[48:51]
    ds_read2_b32 v[140:141], v237 offset0:208 offset1:209
    v_mfma_f32_16x16x32_bf16 v[52:55], v[84:87], v[96:99], v[52:55]
    ds_read2_b32 v[142:143], v237 offset0:210 offset1:211
    v_mfma_f32_16x16x32_bf16 v[52:55], v[80:83], v[100:103], v[52:55]
    ds_read_b128 v[176:179], v245 offset:16384
    v_mfma_f32_16x16x32_bf16 v[52:55], v[76:79], v[104:107], v[52:55]
    ds_read2_b32 v[144:145], v238 offset0:80 offset1:81
    v_mfma_f32_16x16x32_bf16 v[52:55], v[72:75], v[108:111], v[52:55]
    ds_read2_b32 v[146:147], v238 offset0:82 offset1:83
    v_mfma_f32_16x16x32_bf16 v[52:55], v[68:71], v[112:115], v[52:55]
    s_add_u32 m0, s73, 147456
    ds_read_b128 v[180:183], v245 offset:20480
    v_mfma_f32_16x16x32_bf16 v[52:55], v[64:67], v[116:119], v[52:55]
    buffer_load_dwordx4 v5, s[52:55], s14 offen offset:1024 lds
    ds_read2_b32 v[148:149], v238 offset0:208 offset1:209
    v_mfma_f32_16x16x32_bf16 v[56:59], v[64:67], v[120:123], v[56:59]
    ds_read2_b32 v[150:151], v238 offset0:210 offset1:211
    v_mfma_f32_16x16x32_bf16 v[56:59], v[68:71], v[116:119], v[56:59]
    ds_read_b128 v[184:187], v245 offset:24576
    v_mfma_f32_16x16x32_bf16 v[56:59], v[72:75], v[112:115], v[56:59]
    ds_read2_b32 v[152:153], v239 offset0:80 offset1:81
    v_mfma_f32_16x16x32_bf16 v[56:59], v[76:79], v[108:111], v[56:59]
    ds_read2_b32 v[154:155], v239 offset0:82 offset1:83
    v_mfma_f32_16x16x32_bf16 v[56:59], v[80:83], v[104:107], v[56:59]
    ds_read_b128 v[188:191], v245 offset:28672
    s_waitcnt vmcnt(6)
    s_barrier
    v_mfma_f32_16x16x32_bf16 v[56:59], v[84:87], v[100:103], v[56:59]
    ds_read2_b32 v[156:157], v239 offset0:208 offset1:209
    v_add_u32 v10, -131072, v10
    v_mfma_f32_16x16x32_bf16 v[56:59], v[88:91], v[96:99], v[56:59]
    ds_read_b64_tr_b16 a[208:209], v10 offset:0
    v_mfma_f32_16x16x32_bf16 v[60:63], v[92:95], v[96:99], v[60:63]
    ds_read_b64_tr_b16 a[210:211], v10 offset:2048
    v_mfma_f32_16x16x32_bf16 v[60:63], v[88:91], v[100:103], v[60:63]
    ds_read_b64_tr_b16 a[216:217], v10 offset:4096
    v_mfma_f32_16x16x32_bf16 v[60:63], v[84:87], v[104:107], v[60:63]
    ds_read2_b32 v[158:159], v239 offset0:210 offset1:211
    v_mfma_f32_16x16x32_bf16 v[60:63], v[80:83], v[108:111], v[60:63]
    ds_read_b64_tr_b16 a[218:219], v10 offset:6144
    s_add_u32 m0, s73, 147456
    v_mfma_f32_16x16x32_bf16 v[60:63], v[76:79], v[112:115], v[60:63]
    v_add_u32 v11, -131072, v11
    buffer_load_dwordx4 v6, s[52:55], s14 offen offset:2048 lds
    v_mfma_f32_16x16x32_bf16 v[60:63], v[72:75], v[116:119], v[60:63]
    ds_read_b64_tr_b16 a[212:213], v11 offset:0
    v_mfma_f32_16x16x32_bf16 v[60:63], v[68:71], v[120:123], v[60:63]
    ds_read_b64_tr_b16 a[214:215], v11 offset:2048
    v_mfma_f32_16x16x32_bf16 v[60:63], v[64:67], v[124:127], v[60:63]
    ds_read_b64_tr_b16 a[220:221], v11 offset:4096
    s_waitcnt lgkmcnt(15)
    v_mfma_f32_16x16x32_bf16 v[32:35], v[128:131], v[160:163], v[32:35]
    ds_read_b64_tr_b16 a[222:223], v11 offset:6144
    v_mfma_f32_16x16x32_bf16 v[36:39], v[132:135], v[160:163], v[36:39]
    ds_read_b128 v[96:99], v246 offset:0
    v_mfma_f32_16x16x32_bf16 v[36:39], v[128:131], v[164:167], v[36:39]
    ds_read2_b32 v[64:65], v236 offset0:96 offset1:97
    v_mfma_f32_16x16x32_bf16 v[40:43], v[128:131], v[168:171], v[40:43]
    ds_read2_b32 v[66:67], v236 offset0:98 offset1:99
    v_mfma_f32_16x16x32_bf16 v[40:43], v[132:135], v[164:167], v[40:43]
    v_mfma_f32_16x16x32_bf16 v[40:43], v[136:139], v[160:163], v[40:43]
    ds_read_b128 v[100:103], v246 offset:4096
    v_mfma_f32_16x16x32_bf16 v[44:47], v[140:143], v[160:163], v[44:47]
    ds_read2_b32 v[68:69], v236 offset0:224 offset1:225
    v_mfma_f32_16x16x32_bf16 v[44:47], v[136:139], v[164:167], v[44:47]
    s_add_u32 m0, s73, 147456
    v_mfma_f32_16x16x32_bf16 v[44:47], v[132:135], v[168:171], v[44:47]
    buffer_load_dwordx4 v7, s[52:55], s14 offen offset:3072 lds
    ds_read2_b32 v[70:71], v236 offset0:226 offset1:227
    v_mfma_f32_16x16x32_bf16 v[44:47], v[128:131], v[172:175], v[44:47]
    ds_read_b128 v[104:107], v246 offset:8192
    s_waitcnt lgkmcnt(12)
    v_mfma_f32_16x16x32_bf16 v[48:51], v[128:131], v[176:179], v[48:51]
    ds_read2_b32 v[72:73], v237 offset0:96 offset1:97
    v_mfma_f32_16x16x32_bf16 v[48:51], v[132:135], v[172:175], v[48:51]
    v_mfma_f32_16x16x32_bf16 v[48:51], v[136:139], v[168:171], v[48:51]
    ds_read2_b32 v[74:75], v237 offset0:98 offset1:99
    v_mfma_f32_16x16x32_bf16 v[48:51], v[140:143], v[164:167], v[48:51]
    ds_read_b128 v[108:111], v246 offset:12288
    v_mfma_f32_16x16x32_bf16 v[48:51], v[144:147], v[160:163], v[48:51]
    s_waitcnt lgkmcnt(10)
    s_barrier
    v_mfma_f32_16x16x32_bf16 v[52:55], v[148:151], v[160:163], v[52:55]
    ds_read2_b32 v[76:77], v237 offset0:224 offset1:225
    v_mfma_f32_16x16x32_bf16 v[52:55], v[144:147], v[164:167], v[52:55]
    ds_read2_b32 v[78:79], v237 offset0:226 offset1:227
    v_mfma_f32_16x16x32_bf16 v[52:55], v[140:143], v[168:171], v[52:55]
    v_mfma_f32_16x16x32_bf16 v[52:55], v[136:139], v[172:175], v[52:55]
    s_lshl_b32 s14, s100, 18
    ds_read_b128 v[112:115], v246 offset:16384
    v_mfma_f32_16x16x32_bf16 v[52:55], v[132:135], v[176:179], v[52:55]
    s_add_u32 m0, s73, 0
    ds_read2_b32 v[80:81], v238 offset0:96 offset1:97
    v_mfma_f32_16x16x32_bf16 v[52:55], v[128:131], v[180:183], v[52:55]
    buffer_load_dwordx4 v4, s[52:55], s14 offen offset:0 lds
    v_mfma_f32_16x16x32_bf16 v[56:59], v[128:131], v[184:187], v[56:59]
    ds_read2_b32 v[82:83], v238 offset0:98 offset1:99
    v_mfma_f32_16x16x32_bf16 v[56:59], v[132:135], v[180:183], v[56:59]
    ds_read_b128 v[116:119], v246 offset:20480
    v_mfma_f32_16x16x32_bf16 v[56:59], v[136:139], v[176:179], v[56:59]
    v_mfma_f32_16x16x32_bf16 v[56:59], v[140:143], v[172:175], v[56:59]
    ds_read2_b32 v[84:85], v238 offset0:224 offset1:225
    v_mfma_f32_16x16x32_bf16 v[56:59], v[144:147], v[168:171], v[56:59]
    ds_read2_b32 v[86:87], v238 offset0:226 offset1:227
    v_mfma_f32_16x16x32_bf16 v[56:59], v[148:151], v[164:167], v[56:59]
    ds_read_b128 v[120:123], v246 offset:24576
    v_mfma_f32_16x16x32_bf16 v[56:59], v[152:155], v[160:163], v[56:59]
    v_mfma_f32_16x16x32_bf16 v[60:63], v[156:159], v[160:163], v[60:63]
    ds_read2_b32 v[88:89], v239 offset0:96 offset1:97
    v_mfma_f32_16x16x32_bf16 v[60:63], v[152:155], v[164:167], v[60:63]
    s_add_u32 m0, s73, 0
    ds_read2_b32 v[90:91], v239 offset0:98 offset1:99
    v_mfma_f32_16x16x32_bf16 v[60:63], v[148:151], v[168:171], v[60:63]
    buffer_load_dwordx4 v5, s[52:55], s14 offen offset:1024 lds
    v_mfma_f32_16x16x32_bf16 v[60:63], v[144:147], v[172:175], v[60:63]
    ds_read_b128 v[124:127], v246 offset:28672
    v_mfma_f32_16x16x32_bf16 v[60:63], v[140:143], v[176:179], v[60:63]
    ds_read2_b32 v[92:93], v239 offset0:224 offset1:225
    v_mfma_f32_16x16x32_bf16 v[60:63], v[136:139], v[180:183], v[60:63]
    v_mfma_f32_16x16x32_bf16 v[60:63], v[132:135], v[184:187], v[60:63]
    ds_read2_b32 v[94:95], v239 offset0:226 offset1:227
    v_mfma_f32_16x16x32_bf16 v[60:63], v[128:131], v[188:191], v[60:63]
    s_waitcnt lgkmcnt(12)
    v_mfma_f32_16x16x32_bf16 v[32:35], v[64:67], v[96:99], v[32:35]
    ds_read_b128 v[160:163], v247 offset:0
    s_waitcnt vmcnt(6)
    s_barrier
    v_mfma_f32_16x16x32_bf16 v[36:39], v[68:71], v[96:99], v[36:39]
    ds_read_b64_tr_b16 a[224:225], v10 offset:16384
    s_bfe_u32 s4, s2, 0x20003
    v_mfma_f32_16x16x32_bf16 v[36:39], v[64:67], v[100:103], v[36:39]
    ds_read_b64_tr_b16 a[226:227], v10 offset:18432
    ds_read_b128 v[164:167], v247 offset:4096
    v_mfma_f32_16x16x32_bf16 v[40:43], v[64:67], v[104:107], v[40:43]
    s_lshl2_add_u32 s4, s72, s4
    ds_read_b128 v[168:171], v247 offset:8192
    v_mfma_f32_16x16x32_bf16 v[40:43], v[68:71], v[100:103], v[40:43]
    ds_read_b64_tr_b16 a[232:233], v10 offset:20480
    s_add_u32 m0, s73, 0
    ds_read_b128 v[172:175], v247 offset:12288
    v_mfma_f32_16x16x32_bf16 v[40:43], v[72:75], v[96:99], v[40:43]
    ds_read_b64_tr_b16 a[234:235], v10 offset:22528
    buffer_load_dwordx4 v6, s[52:55], s14 offen offset:2048 lds
    s_lshl_b32 s4, s4, 3
    v_mfma_f32_16x16x32_bf16 v[44:47], v[76:79], v[96:99], v[44:47]
    ds_read_b128 v[176:179], v247 offset:16384
    v_mfma_f32_16x16x32_bf16 v[44:47], v[72:75], v[100:103], v[44:47]
    ds_read_b64_tr_b16 a[228:229], v11 offset:16384
    s_lshr_b32 s5, s2, 4
    ds_read_b128 v[180:183], v247 offset:20480
    v_mfma_f32_16x16x32_bf16 v[44:47], v[68:71], v[104:107], v[44:47]
    ds_read_b64_tr_b16 a[230:231], v11 offset:18432
    v_mfma_f32_16x16x32_bf16 v[44:47], v[64:67], v[108:111], v[44:47]
    s_and_b32 s5, s5, 6
    ds_read_b128 v[184:187], v247 offset:24576
    s_waitcnt lgkmcnt(13)
    v_mfma_f32_16x16x32_bf16 v[48:51], v[64:67], v[112:115], v[48:51]
    ds_read_b64_tr_b16 a[236:237], v11 offset:20480
    ds_read_b128 v[188:191], v247 offset:28672
    v_mfma_f32_16x16x32_bf16 v[48:51], v[68:71], v[108:111], v[48:51]
    ds_read_b64_tr_b16 a[238:239], v11 offset:22528
    s_add_u32 s4, s4, s5
    v_mfma_f32_16x16x32_bf16 v[48:51], v[72:75], v[104:107], v[48:51]
    ds_read2_b32 v[128:129], v236 offset0:112 offset1:113
    v_mfma_f32_16x16x32_bf16 v[48:51], v[76:79], v[100:103], v[48:51]
    s_and_b32 s5, s2, 1
    ds_read2_b32 v[130:131], v236 offset0:114 offset1:115
    v_mfma_f32_16x16x32_bf16 v[48:51], v[80:83], v[96:99], v[48:51]
    ds_read2_b32 v[132:133], v236 offset0:240 offset1:241
    v_mfma_f32_16x16x32_bf16 v[52:55], v[84:87], v[96:99], v[52:55]
    s_add_u32 m0, s73, 0
    ds_read2_b32 v[134:135], v236 offset0:242 offset1:243
    s_add_u32 s4, s4, s5
    v_mfma_f32_16x16x32_bf16 v[52:55], v[80:83], v[100:103], v[52:55]
    buffer_load_dwordx4 v7, s[52:55], s14 offen offset:3072 lds
    ds_read2_b32 v[136:137], v237 offset0:112 offset1:113
    v_mfma_f32_16x16x32_bf16 v[52:55], v[76:79], v[104:107], v[52:55]
    s_lshl_b32 s4, s4, 7
    ds_read2_b32 v[138:139], v237 offset0:114 offset1:115
    v_mfma_f32_16x16x32_bf16 v[52:55], v[72:75], v[108:111], v[52:55]
    s_add_u32 s4, s4, 12566528
    ds_read2_b32 v[140:141], v237 offset0:240 offset1:241
    s_add_u32 s6, s12, 4767744
    v_mfma_f32_16x16x32_bf16 v[52:55], v[68:71], v[112:115], v[52:55]
    ds_read2_b32 v[142:143], v237 offset0:242 offset1:243
    v_mfma_f32_16x16x32_bf16 v[52:55], v[64:67], v[116:119], v[52:55]
    ds_read2_b32 v[144:145], v238 offset0:112 offset1:113
    v_lshl_add_u32 v28, v2, 2, s4
    v_mfma_f32_16x16x32_bf16 v[56:59], v[64:67], v[120:123], v[56:59]
    s_waitcnt lgkmcnt(9)
    s_barrier
    v_mfma_f32_16x16x32_bf16 v[56:59], v[68:71], v[116:119], v[56:59]
    ds_read2_b32 v[146:147], v238 offset0:114 offset1:115
    s_cmp_eq_u32 s3, 0
    s_cselect_b32 s4, 18, 0
    v_mfma_f32_16x16x32_bf16 v[56:59], v[72:75], v[112:115], v[56:59]
    ds_read2_b32 v[148:149], v238 offset0:240 offset1:241
    v_mfma_f32_16x16x32_bf16 v[56:59], v[76:79], v[108:111], v[56:59]
    ds_read2_b32 v[150:151], v238 offset0:242 offset1:243
    v_cmp_gt_u32 vcc, s4, v2
    v_mfma_f32_16x16x32_bf16 v[56:59], v[80:83], v[104:107], v[56:59]
    s_lshl_b32 s14, s101, 18
    ds_read2_b32 v[152:153], v239 offset0:112 offset1:113
    v_mfma_f32_16x16x32_bf16 v[56:59], v[84:87], v[100:103], v[56:59]
    ds_read2_b32 v[154:155], v239 offset0:114 offset1:115
    s_add_u32 m0, s73, 16384
    v_mov_b32 v13, 0x40000000
    v_mfma_f32_16x16x32_bf16 v[56:59], v[88:91], v[96:99], v[56:59]
    buffer_load_dwordx4 v4, s[52:55], s14 offen offset:0 lds
    ds_read2_b32 v[156:157], v239 offset0:240 offset1:241
    v_mfma_f32_16x16x32_bf16 v[60:63], v[92:95], v[96:99], v[60:63]
    ds_read2_b32 v[158:159], v239 offset0:242 offset1:243
    v_cndmask_b32 v28, v13, v28, vcc
    v_mfma_f32_16x16x32_bf16 v[60:63], v[88:91], v[100:103], v[60:63]
    v_mfma_f32_16x16x32_bf16 v[60:63], v[84:87], v[104:107], v[60:63]
    v_mov_b32 v13, s68
    v_mfma_f32_16x16x32_bf16 v[60:63], v[80:83], v[108:111], v[60:63]
    v_mfma_f32_16x16x32_bf16 v[60:63], v[76:79], v[112:115], v[60:63]
    v_cndmask_b32 v13, 0, v13, vcc
    v_mfma_f32_16x16x32_bf16 v[60:63], v[72:75], v[116:119], v[60:63]
    v_mfma_f32_16x16x32_bf16 v[60:63], v[68:71], v[120:123], v[60:63]
    v_mfma_f32_16x16x32_bf16 v[60:63], v[64:67], v[124:127], v[60:63]
    s_waitcnt lgkmcnt(0)
    v_mfma_f32_16x16x32_bf16 v[60:63], v[128:131], v[188:191], v[60:63]
    v_mfma_f32_16x16x32_bf16 v[60:63], v[132:135], v[184:187], v[60:63]
    s_add_u32 m0, s73, 16384
    v_mfma_f32_16x16x32_bf16 v[60:63], v[136:139], v[180:183], v[60:63]
    buffer_load_dwordx4 v5, s[52:55], s14 offen offset:1024 lds
    v_mfma_f32_16x16x32_bf16 v[60:63], v[140:143], v[176:179], v[60:63]
    v_mfma_f32_16x16x32_bf16 v[60:63], v[144:147], v[172:175], v[60:63]
    v_mfma_f32_16x16x32_bf16 v[60:63], v[148:151], v[168:171], v[60:63]
    v_mfma_f32_16x16x32_bf16 v[60:63], v[152:155], v[164:167], v[60:63]
    v_mfma_f32_16x16x32_bf16 v[60:63], v[156:159], v[160:163], v[60:63]
    v_mfma_f32_16x16x32_bf16 v[56:59], v[128:131], v[184:187], v[56:59]
    v_mfma_f32_16x16x32_bf16 v[56:59], v[132:135], v[180:183], v[56:59]
    v_mfma_f32_16x16x32_bf16 v[56:59], v[136:139], v[176:179], v[56:59]
    v_mfma_f32_16x16x32_bf16 v[56:59], v[140:143], v[172:175], v[56:59]
    s_add_u32 m0, s73, 16384
    v_mfma_f32_16x16x32_bf16 v[56:59], v[144:147], v[168:171], v[56:59]
    buffer_load_dwordx4 v6, s[52:55], s14 offen offset:2048 lds
    v_mfma_f32_16x16x32_bf16 v[56:59], v[148:151], v[164:167], v[56:59]
    v_cvt_pk_bf16_f32 v206, v60, v61
    v_mfma_f32_16x16x32_bf16 v[56:59], v[152:155], v[160:163], v[56:59]
    s_waitcnt vmcnt(7)
    s_barrier
    v_mfma_f32_16x16x32_bf16 v[52:55], v[128:131], v[180:183], v[52:55]
    v_add_u32 v10, 131072, v10
    v_mfma_f32_16x16x32_bf16 v[52:55], v[132:135], v[176:179], v[52:55]
    ds_read_b64_tr_b16 a[240:241], v10 offset:16384
    v_cvt_pk_bf16_f32 v207, v62, v63
    v_mfma_f32_16x16x32_bf16 v[52:55], v[136:139], v[172:175], v[52:55]
    ds_read_b64_tr_b16 a[242:243], v10 offset:18432
    v_mfma_f32_16x16x32_bf16 v[52:55], v[140:143], v[168:171], v[52:55]
    buffer_store_dwordx2 v[206:207], v8, s[44:47], s6 offen offset:3584 sc1
    v_mfma_f32_16x16x32_bf16 v[52:55], v[144:147], v[164:167], v[52:55]
    ds_read_b64_tr_b16 a[248:249], v10 offset:20480
    v_mfma_f32_16x16x32_bf16 v[52:55], v[148:151], v[160:163], v[52:55]
    ds_read_b64_tr_b16 a[250:251], v10 offset:22528
    v_mfma_f32_16x16x32_bf16 v[48:51], v[128:131], v[176:179], v[48:51]
    v_add_u32 v11, 131072, v11
    v_cvt_pk_bf16_f32 v204, v56, v57
    v_mfma_f32_16x16x32_bf16 v[48:51], v[132:135], v[172:175], v[48:51]
    ds_read_b64_tr_b16 a[244:245], v11 offset:16384
    s_add_u32 m0, s73, 16384
    v_mfma_f32_16x16x32_bf16 v[48:51], v[136:139], v[168:171], v[48:51]
    ds_read_b64_tr_b16 a[246:247], v11 offset:18432
    buffer_load_dwordx4 v7, s[52:55], s14 offen offset:3072 lds
    v_mfma_f32_16x16x32_bf16 v[48:51], v[140:143], v[164:167], v[48:51]
    v_cvt_pk_bf16_f32 v205, v58, v59
    v_mfma_f32_16x16x32_bf16 v[48:51], v[144:147], v[160:163], v[48:51]
L_pl_X_6:
    s_cbranch_execz L_wret
    ds_read_b64_tr_b16 a[252:253], v11 offset:20480
    v_mfma_f32_16x16x32_bf16 v[44:47], v[128:131], v[172:175], v[44:47]
    buffer_store_dwordx2 v[204:205], v8, s[44:47], s6 offen offset:3072 sc1
    ds_read_b64_tr_b16 a[254:255], v11 offset:22528
    v_mfma_f32_16x16x32_bf16 v[44:47], v[132:135], v[168:171], v[44:47]
    v_mfma_f32_16x16x32_bf16 v[44:47], v[136:139], v[164:167], v[44:47]
    v_mfma_f32_16x16x32_bf16 v[44:47], v[140:143], v[160:163], v[44:47]
    v_cvt_pk_bf16_f32 v202, v52, v53
    v_mfma_f32_16x16x32_bf16 v[40:43], v[128:131], v[168:171], v[40:43]
    v_mfma_f32_16x16x32_bf16 v[40:43], v[132:135], v[164:167], v[40:43]
    v_mfma_f32_16x16x32_bf16 v[40:43], v[136:139], v[160:163], v[40:43]
    v_cvt_pk_bf16_f32 v203, v54, v55
    v_mfma_f32_16x16x32_bf16 v[36:39], v[128:131], v[164:167], v[36:39]
    v_mfma_f32_16x16x32_bf16 v[36:39], v[132:135], v[160:163], v[36:39]
    buffer_store_dwordx2 v[202:203], v8, s[44:47], s6 offen offset:2560 sc1
    v_mfma_f32_16x16x32_bf16 v[32:35], v[128:131], v[160:163], v[32:35]
    v_mov_b32 v29, 0
    buffer_atomic_add v29, v28, s[44:47], 0 offen sc0 sc1
    v_cvt_pk_bf16_f32 v200, v48, v49
    v_cvt_pk_bf16_f32 v201, v50, v51
    buffer_store_dwordx2 v[200:201], v8, s[44:47], s6 offen offset:2048 sc1
    v_cvt_pk_bf16_f32 v198, v44, v45
    v_cvt_pk_bf16_f32 v199, v46, v47
    buffer_store_dwordx2 v[198:199], v8, s[44:47], s6 offen offset:1536 sc1
    v_cvt_pk_bf16_f32 v196, v40, v41
    v_cvt_pk_bf16_f32 v197, v42, v43
    buffer_store_dwordx2 v[196:197], v8, s[44:47], s6 offen offset:1024 sc1
    v_cvt_pk_bf16_f32 v194, v36, v37
    v_cvt_pk_bf16_f32 v195, v38, v39
    buffer_store_dwordx2 v[194:195], v8, s[44:47], s6 offen offset:512 sc1
    v_cvt_pk_bf16_f32 v192, v32, v33
    v_cvt_pk_bf16_f32 v193, v34, v35
    buffer_store_dwordx2 v[192:193], v8, s[44:47], s6 offen offset:0 sc1
    v_add_u32 v10, -131072, v10
    v_add_u32 v11, -131072, v11
    s_waitcnt lgkmcnt(0)
    s_barrier
L_DX:
    s_waitcnt vmcnt(0)
    v_cmp_ne_u32 vcc, v13, v29
    s_cbranch_vccnz L_rs_p2X
L_ok_p2X:
    s_barrier
    s_add_u32 m0, s73, 97536
    s_nop 0
    buffer_load_dwordx4 v23, s[44:47], s18 offen offset:768 sc1 lds
    s_add_u32 m0, s73, 99328
    s_nop 0
    buffer_load_dwordx4 v20, s[44:47], s18 offen offset:0 sc1 lds
    s_add_u32 m0, s73, 99840
    s_nop 0
    buffer_load_dwordx4 v20, s[44:47], s18 offen offset:512 sc1 lds
    s_add_u32 m0, s73, 100608
    s_nop 0
    buffer_load_dwordx4 v23, s[44:47], s19 offen offset:768 sc1 lds
    s_add_u32 m0, s73, 114688
    s_nop 0
    buffer_load_dwordx4 v20, s[44:47], s19 offen offset:0 sc1 lds
    s_add_u32 m0, s73, 115200
    s_nop 0
    buffer_load_dwordx4 v20, s[44:47], s19 offen offset:512 sc1 lds
    s_add_u32 m0, s73, 115968
    s_nop 0
    buffer_load_dwordx4 v23, s[44:47], s20 offen offset:768 sc1 lds
    s_add_u32 m0, s73, 117760
    s_nop 0
    buffer_load_dwordx4 v20, s[44:47], s20 offen offset:0 sc1 lds
    s_mov_b32 s56, s16
    s_and_b32 s57, s17, 0xffff
    s_mov_b32 s58, 2359296
    s_mov_b32 s59, 0x20000
    s_mov_b32 s40, 18432
    s_mov_b32 s42, 12386304
    s_mov_b32 s64, s38
    s_and_b32 s65, s39, 0xffff
    s_mov_b32 s66, 2359296
    s_mov_b32 s67, 0x20000
    v_lshlrev_b32 v136, 4, v2
    s_mul_i32 s7, s72, 36
    s_bitcmp1_b32 s3, 0
    s_addc_u32 s7, s7, 0
    s_lshl_b32 s7, s7, 17
    v_subrev_u32 v184, s7, v4
    v_subrev_u32 v185, s7, v5
    s_bfe_u32 s4, s2, 0x20003
    s_mul_i32 s4, s4, 9
    s_lshl1_add_u32 s7, s72, s4
    s_and_b32 s8, s3, 1
    s_add_u32 s7, s7, s8
    s_lshl_b32 s37, s7, 16
    s_add_u32 s37, s37, 4718592
    s_add_u32 s4, s4, 8
    s_lshl_b32 s16, s4, 16
    s_add_u32 s16, s16, 4718592
    s_sub_u32 s4, s4, s7
    s_lshl_b32 s4, s4, 7
    s_lshl_b32 s7, s7, 7
    s_add_u32 s7, s7, 12582912
    v_bfe_u32 v24, v2, 2, 1
    v_mul_u32_u24 v24, s4, v24
    v_and_b32 v25, 3, v2
    v_lshl_add_u32 v24, v25, 2, v24
    v_add_u32 v188, s7, v24
    s_lshl2_add_u32 s7, s2, s3
    s_mul_i32 s8, s7, 3072
    s_add_u32 s34, s8, 40828928
    s_add_u32 s11, s8, 43974656
    s_add_u32 s12, s8, 47120384
    s_lshl_b32 s35, s7, 12
    s_add_u32 s35, s35, 50266112
    s_xor_b32 s8, s7, 8
    s_mul_i32 s8, s8, 3072
    s_add_u32 s30, s8, 40828928
    s_xor_b32 s8, s7, 16
    s_mul_i32 s8, s8, 3072
    s_add_u32 s15, s8, 43974656
    s_xor_b32 s8, s7, 24
    s_mul_i32 s8, s8, 3072
    s_add_u32 s31, s8, 47120384
    s_andn2_b32 s7, s7, 24
    s_lshl3_add_u32 s7, s3, s7
    s_lshl2_add_u32 s8, s7, s72
    s_lshl_b32 s8, s8, 10
    s_add_u32 s32, s8, 50266112
    s_xor_b32 s8, s8, 4096
    s_add_u32 s33, s8, 50266112
    s_xor_b32 s8, s3, s72
    s_cmp_lt_u32 s8, 2
    s_cselect_b32 s35, s35, 0x40000000
    s_cselect_b32 s16, s16, 0x40000000
    s_cselect_b32 s36, s68, 0
    s_mov_b32 s38, 0xbfb8aa3b
    s_and_b32 s8, s8, 1
    s_mul_i32 s41, s8, 96
    s_and_b32 s43, s73, 4096
    v_lshlrev_b32 v24, 10, v2
    v_add_u32 v24, s35, v24
    s_add_u32 s7, s34, 2048
    v_mov_b32 v25, s36
    v_cmp_gt_u32 vcc, 4, v2
    s_nop 1
    v_cndmask_b32 v138, 0, v25, vcc
    v_mov_b32 v25, 0x40000000
    v_cndmask_b32 v137, v25, v24, vcc
    v_writelane_b32 v137, s7, 4
    v_writelane_b32 v138, s68, 4
    v_min_u32 v139, 1, v2
    v_lshlrev_b32 v139, 30, v139
    v_mov_b32 v140, 0
    v_writelane_b32 v140, s68, 0
    v_mov_b32 v195, s68
    v_mov_b32 v199, s68
    v_mov_b32 v202, s68
    v_mov_b32 v203, s68
    s_waitcnt vmcnt(4)
    s_barrier
    ds_read_b128 v[104:107], v14 offset:0
    ds_read_b128 v[108:111], v14 offset:4096
    ds_read_b128 v[112:115], v14 offset:8192
    ds_read_b128 v[116:119], v14 offset:12288
    s_waitcnt lgkmcnt(2)
    v_mfma_f32_16x16x32_bf16 v[32:35], v[104:107], a[0:3], 0
    s_add_u32 m0, s73, 130560
    s_sub_u32 s4, s75, 216
    s_lshl_b32 s7, s4, 7
    v_mfma_f32_16x16x32_bf16 v[32:35], v[108:111], a[8:11], v[32:35]
    buffer_load_dwordx4 v20, s[44:47], s20 offen offset:512 sc1 lds
    s_waitcnt lgkmcnt(0)
    v_mfma_f32_16x16x32_bf16 v[32:35], v[112:115], a[16:19], v[32:35]
    ds_read_b128 v[120:123], v14 offset:1024
    s_lshl2_add_u32 s7, s3, s7
    s_add_u32 s7, s7, 12582912
    v_mfma_f32_16x16x32_bf16 v[32:35], v[116:119], a[24:27], v[32:35]
    ds_read_b128 v[124:127], v14 offset:5120
    v_mfma_f32_16x16x32_bf16 v[36:39], v[116:119], a[28:31], 0
    ds_read_b128 v[128:131], v14 offset:9216
    s_cmp_lt_u32 s4, 36
    s_cselect_b32 s7, s7, 0x40000000
    v_mfma_f32_16x16x32_bf16 v[36:39], v[112:115], a[20:23], v[36:39]
    ds_read_b128 v[132:135], v14 offset:13312
    v_min_u32 v28, 1, v2
    v_mfma_f32_16x16x32_bf16 v[36:39], v[108:111], a[12:15], v[36:39]
    s_add_u32 m0, s73, 131328
    v_lshlrev_b32 v28, 30, v28
    v_mov_b32 v29, s68
    v_mfma_f32_16x16x32_bf16 v[36:39], v[104:107], a[4:7], v[36:39]
    buffer_load_dwordx4 v23, s[44:47], s21 offen offset:768 sc1 lds
    s_waitcnt lgkmcnt(2)
    v_mfma_f32_16x16x32_bf16 v[44:47], v[120:123], a[4:7], 0
    buffer_store_dword v29, v28, s[44:47], s7 offen sc1
    s_add_u32 m0, s73, 133120
    v_mfma_f32_16x16x32_bf16 v[44:47], v[124:127], a[12:15], v[44:47]
    buffer_load_dwordx4 v20, s[44:47], s21 offen offset:0 sc1 lds
    s_waitcnt lgkmcnt(0)
    v_mfma_f32_16x16x32_bf16 v[44:47], v[128:131], a[20:23], v[44:47]
    ds_read_b128 v[104:107], v14 offset:2048
    v_mfma_f32_16x16x32_bf16 v[44:47], v[132:135], a[28:31], v[44:47]
    ds_read_b128 v[108:111], v14 offset:6144
    v_mfma_f32_16x16x32_bf16 v[40:43], v[132:135], a[24:27], 0
    ds_read_b128 v[112:115], v14 offset:10240
    v_mfma_f32_16x16x32_bf16 v[40:43], v[128:131], a[16:19], v[40:43]
    ds_read_b128 v[116:119], v14 offset:14336
    v_mfma_f32_16x16x32_bf16 v[40:43], v[124:127], a[8:11], v[40:43]
    s_add_u32 m0, s73, 133632
    v_mfma_f32_16x16x32_bf16 v[40:43], v[120:123], a[0:3], v[40:43]
    buffer_load_dwordx4 v20, s[44:47], s21 offen offset:512 sc1 lds
    s_waitcnt lgkmcnt(2)
    v_mfma_f32_16x16x32_bf16 v[48:51], v[104:107], a[0:3], 0
    s_add_u32 m0, s73, 146688
    v_mfma_f32_16x16x32_bf16 v[48:51], v[108:111], a[8:11], v[48:51]
    buffer_load_dwordx4 v23, s[44:47], s22 offen offset:768 sc1 lds
    s_waitcnt lgkmcnt(0)
    v_mfma_f32_16x16x32_bf16 v[48:51], v[112:115], a[16:19], v[48:51]
    ds_read_b128 v[120:123], v14 offset:3072
    v_mfma_f32_16x16x32_bf16 v[48:51], v[116:119], a[24:27], v[48:51]
    ds_read_b128 v[124:127], v14 offset:7168
    v_mfma_f32_16x16x32_bf16 v[52:55], v[116:119], a[28:31], 0
    ds_read_b128 v[128:131], v14 offset:11264
    v_mfma_f32_16x16x32_bf16 v[52:55], v[112:115], a[20:23], v[52:55]
    ds_read_b128 v[132:135], v14 offset:15360
    v_mfma_f32_16x16x32_bf16 v[52:55], v[108:111], a[12:15], v[52:55]
    s_add_u32 m0, s73, 148480
    v_mfma_f32_16x16x32_bf16 v[52:55], v[104:107], a[4:7], v[52:55]
    buffer_load_dwordx4 v20, s[44:47], s22 offen offset:0 sc1 lds
    s_waitcnt lgkmcnt(2)
    v_mfma_f32_16x16x32_bf16 v[36:39], v[120:123], a[36:39], v[36:39]
    s_add_u32 m0, s73, 148992
    v_mfma_f32_16x16x32_bf16 v[36:39], v[124:127], a[44:47], v[36:39]
    buffer_load_dwordx4 v20, s[44:47], s22 offen offset:512 sc1 lds
    s_waitcnt lgkmcnt(0)
    v_mfma_f32_16x16x32_bf16 v[36:39], v[128:131], a[52:55], v[36:39]
    s_waitcnt vmcnt(8)
    s_barrier
    v_mfma_f32_16x16x32_bf16 v[36:39], v[132:135], a[60:63], v[36:39]
    ds_read_b128 v[104:107], v14 offset:16384
    v_mfma_f32_16x16x32_bf16 v[32:35], v[132:135], a[56:59], v[32:35]
    ds_read_b128 v[108:111], v14 offset:20480
    v_mfma_f32_16x16x32_bf16 v[32:35], v[128:131], a[48:51], v[32:35]
    ds_read_b128 v[112:115], v14 offset:24576
    v_mfma_f32_16x16x32_bf16 v[32:35], v[124:127], a[40:43], v[32:35]
    ds_read_b128 v[116:119], v14 offset:28672
    s_add_u32 m0, s73, 149760
    v_mfma_f32_16x16x32_bf16 v[32:35], v[120:123], a[32:35], v[32:35]
    buffer_load_dwordx4 v23, s[44:47], s23 offen offset:768 sc1 lds
    ds_read_b64_tr_b16 v[220:221], v10 offset:0
    s_waitcnt lgkmcnt(3)
    v_mfma_f32_16x16x32_bf16 v[40:43], v[104:107], a[32:35], v[40:43]
    s_add_u32 m0, s73, 98304
    ds_read_b64_tr_b16 v[222:223], v10 offset:2048
    v_mfma_f32_16x16x32_bf16 v[40:43], v[108:111], a[40:43], v[40:43]
    buffer_load_dwordx4 v20, s[44:47], s23 offen offset:0 sc1 lds
    s_waitcnt lgkmcnt(2)
    v_mfma_f32_16x16x32_bf16 v[40:43], v[112:115], a[48:51], v[40:43]
    ds_read_b128 v[120:123], v14 offset:17408
    v_mfma_f32_16x16x32_bf16 v[40:43], v[116:119], a[56:59], v[40:43]
    ds_read_b128 v[124:127], v14 offset:21504
    v_mfma_f32_16x16x32_bf16 v[44:47], v[116:119], a[60:63], v[44:47]
    ds_read_b128 v[128:131], v14 offset:25600
    v_mfma_f32_16x16x32_bf16 v[44:47], v[112:115], a[52:55], v[44:47]
    ds_read_b128 v[132:135], v14 offset:29696
    v_mfma_f32_16x16x32_bf16 v[44:47], v[108:111], a[44:47], v[44:47]
    s_add_u32 m0, s73, 98816
    ds_read_b64_tr_b16 v[228:229], v10 offset:4096
    v_mfma_f32_16x16x32_bf16 v[44:47], v[104:107], a[36:39], v[44:47]
    buffer_load_dwordx4 v20, s[44:47], s23 offen offset:512 sc1 lds
    s_waitcnt lgkmcnt(3)
    v_mfma_f32_16x16x32_bf16 v[52:55], v[120:123], a[36:39], v[52:55]
    s_add_u32 m0, s73, 99584
    ds_read_b64_tr_b16 v[230:231], v10 offset:6144
    v_mfma_f32_16x16x32_bf16 v[52:55], v[124:127], a[44:47], v[52:55]
    buffer_load_dwordx4 v23, s[44:47], s24 offen offset:768 sc1 lds
    s_waitcnt lgkmcnt(2)
    v_mfma_f32_16x16x32_bf16 v[52:55], v[128:131], a[52:55], v[52:55]
    ds_read_b128 v[104:107], v14 offset:18432
    v_mfma_f32_16x16x32_bf16 v[52:55], v[132:135], a[60:63], v[52:55]
    ds_read_b128 v[108:111], v14 offset:22528
    v_mfma_f32_16x16x32_bf16 v[48:51], v[132:135], a[56:59], v[48:51]
    ds_read_b128 v[112:115], v14 offset:26624
    v_mfma_f32_16x16x32_bf16 v[48:51], v[128:131], a[48:51], v[48:51]
    ds_read_b128 v[116:119], v14 offset:30720
    v_mfma_f32_16x16x32_bf16 v[48:51], v[124:127], a[40:43], v[48:51]
    s_add_u32 m0, s73, 101376
    ds_read_b64_tr_b16 v[224:225], v11 offset:0
    v_mfma_f32_16x16x32_bf16 v[48:51], v[120:123], a[32:35], v[48:51]
    buffer_load_dwordx4 v20, s[44:47], s24 offen offset:0 sc1 lds
    s_waitcnt lgkmcnt(3)
    v_mfma_f32_16x16x32_bf16 v[32:35], v[104:107], a[64:67], v[32:35]
    ds_read_b64_tr_b16 v[226:227], v11 offset:2048
    v_mfma_f32_16x16x32_bf16 v[32:35], v[108:111], a[72:75], v[32:35]
    s_waitcnt lgkmcnt(2)
    v_mfma_f32_16x16x32_bf16 v[32:35], v[112:115], a[80:83], v[32:35]
    ds_read_b128 v[120:123], v14 offset:19456
    v_mfma_f32_16x16x32_bf16 v[32:35], v[116:119], a[88:91], v[32:35]
    ds_read_b128 v[124:127], v14 offset:23552
    v_mfma_f32_16x16x32_bf16 v[36:39], v[116:119], a[92:95], v[36:39]
    ds_read_b128 v[128:131], v14 offset:27648
    v_mfma_f32_16x16x32_bf16 v[36:39], v[112:115], a[84:87], v[36:39]
    ds_read_b128 v[132:135], v14 offset:31744
    v_mfma_f32_16x16x32_bf16 v[36:39], v[108:111], a[76:79], v[36:39]
    ds_read_b64_tr_b16 v[232:233], v11 offset:4096
    v_mfma_f32_16x16x32_bf16 v[36:39], v[104:107], a[68:71], v[36:39]
    s_waitcnt lgkmcnt(3)
    v_mfma_f32_16x16x32_bf16 v[44:47], v[120:123], a[68:71], v[44:47]
    ds_read_b64_tr_b16 v[234:235], v11 offset:6144
    v_mfma_f32_16x16x32_bf16 v[44:47], v[124:127], a[76:79], v[44:47]
    s_waitcnt lgkmcnt(2)
    v_mfma_f32_16x16x32_bf16 v[44:47], v[128:131], a[84:87], v[44:47]
    s_waitcnt vmcnt(8) lgkmcnt(0)
    s_barrier
    v_mfma_f32_16x16x32_bf16 v[44:47], v[132:135], a[92:95], v[44:47]
    ds_read_b128 v[104:107], v14 offset:32768
    v_mfma_f32_16x16x32_bf16 v[40:43], v[132:135], a[88:91], v[40:43]
    ds_read_b128 v[108:111], v14 offset:36864
    v_mfma_f32_16x16x32_bf16 v[40:43], v[128:131], a[80:83], v[40:43]
    ds_read_b128 v[112:115], v14 offset:40960
    v_mfma_f32_16x16x32_bf16 v[40:43], v[124:127], a[72:75], v[40:43]
    ds_read_b128 v[116:119], v14 offset:45056
    v_mfma_f32_16x16x32_bf16 v[40:43], v[120:123], a[64:67], v[40:43]
    ds_read_b64_tr_b16 v[236:237], v10 offset:16384
    s_waitcnt lgkmcnt(3)
    v_mfma_f32_16x16x32_bf16 v[48:51], v[104:107], a[64:67], v[48:51]
    s_add_u32 m0, s73, 114176
    ds_read_b64_tr_b16 v[238:239], v10 offset:18432
    v_mfma_f32_16x16x32_bf16 v[48:51], v[108:111], a[72:75], v[48:51]
    buffer_load_dwordx4 v20, s[44:47], s24 offen offset:512 sc1 lds
    s_waitcnt lgkmcnt(2)
    v_mfma_f32_16x16x32_bf16 v[48:51], v[112:115], a[80:83], v[48:51]
    ds_read_b128 v[120:123], v14 offset:33792
    v_mfma_f32_16x16x32_bf16 v[48:51], v[116:119], a[88:91], v[48:51]
    ds_read_b128 v[124:127], v14 offset:37888
    v_lshrrev_b32 v30, 2, v26
    v_mfma_f32_16x16x32_bf16 v[52:55], v[116:119], a[92:95], v[52:55]
    ds_read_b128 v[128:131], v14 offset:41984
    v_mfma_f32_16x16x32_bf16 v[52:55], v[112:115], a[84:87], v[52:55]
    ds_read_b128 v[132:135], v14 offset:46080
    v_mfma_f32_16x16x32_bf16 v[52:55], v[108:111], a[76:79], v[52:55]
    s_add_u32 m0, s73, 114944
    ds_read_b64_tr_b16 v[244:245], v10 offset:20480
    v_mfma_f32_16x16x32_bf16 v[52:55], v[104:107], a[68:71], v[52:55]
    buffer_load_dwordx4 v23, s[44:47], s25 offen offset:768 sc1 lds
    s_waitcnt lgkmcnt(3)
    v_mfma_f32_16x16x32_bf16 v[36:39], v[120:123], a[100:103], v[36:39]
    s_add_u32 m0, s73, 116736
    ds_read_b64_tr_b16 v[246:247], v10 offset:22528
    v_mfma_f32_16x16x32_bf16 v[36:39], v[124:127], a[108:111], v[36:39]
    buffer_load_dwordx4 v20, s[44:47], s25 offen offset:0 sc1 lds
    s_waitcnt lgkmcnt(2)
    v_mfma_f32_16x16x32_bf16 v[36:39], v[128:131], a[116:119], v[36:39]
    ds_read_b128 v[104:107], v14 offset:34816
    v_lshrrev_b32 v31, 2, v18
    v_mfma_f32_16x16x32_bf16 v[36:39], v[132:135], a[124:127], v[36:39]
    ds_read_b128 v[108:111], v14 offset:38912
    v_mfma_f32_16x16x32_bf16 v[32:35], v[132:135], a[120:123], v[32:35]
    ds_read_b128 v[112:115], v14 offset:43008
    v_mfma_f32_16x16x32_bf16 v[32:35], v[128:131], a[112:115], v[32:35]
    ds_read_b128 v[116:119], v14 offset:47104
    v_mfma_f32_16x16x32_bf16 v[32:35], v[124:127], a[104:107], v[32:35]
    s_add_u32 m0, s73, 117248
    ds_read_b64_tr_b16 v[240:241], v11 offset:16384
    v_mfma_f32_16x16x32_bf16 v[32:35], v[120:123], a[96:99], v[32:35]
    buffer_load_dwordx4 v20, s[44:47], s25 offen offset:512 sc1 lds
    s_waitcnt lgkmcnt(3)
    v_mfma_f32_16x16x32_bf16 v[40:43], v[104:107], a[96:99], v[40:43]
    ds_read_b64_tr_b16 v[242:243], v11 offset:18432
    buffer_load_ushort v102, v30, s[60:63], 0 offen offset:0
    v_mfma_f32_16x16x32_bf16 v[40:43], v[108:111], a[104:107], v[40:43]
    s_waitcnt lgkmcnt(2)
    v_mfma_f32_16x16x32_bf16 v[40:43], v[112:115], a[112:115], v[40:43]
    ds_read_b128 v[120:123], v14 offset:35840
    v_mfma_f32_16x16x32_bf16 v[40:43], v[116:119], a[120:123], v[40:43]
    ds_read_b128 v[124:127], v14 offset:39936
    v_mfma_f32_16x16x32_bf16 v[44:47], v[116:119], a[124:127], v[44:47]
    ds_read_b128 v[128:131], v14 offset:44032
    v_mfma_f32_16x16x32_bf16 v[44:47], v[112:115], a[116:119], v[44:47]
    ds_read_b128 v[132:135], v14 offset:48128
    v_mfma_f32_16x16x32_bf16 v[44:47], v[108:111], a[108:111], v[44:47]
    ds_read_b64_tr_b16 v[248:249], v11 offset:20480
    buffer_load_ushort v103, v30, s[60:63], 0 offen offset:32
    v_mfma_f32_16x16x32_bf16 v[44:47], v[104:107], a[100:103], v[44:47]
    s_waitcnt lgkmcnt(3)
    v_mfma_f32_16x16x32_bf16 v[52:55], v[120:123], a[100:103], v[52:55]
    ds_read_b64_tr_b16 v[250:251], v11 offset:22528
    v_mfma_f32_16x16x32_bf16 v[52:55], v[124:127], a[108:111], v[52:55]
    s_waitcnt lgkmcnt(2)
    v_mfma_f32_16x16x32_bf16 v[52:55], v[128:131], a[116:119], v[52:55]
    s_waitcnt vmcnt(10) lgkmcnt(0)
    s_barrier
    v_mfma_f32_16x16x32_bf16 v[52:55], v[132:135], a[124:127], v[52:55]
    ds_read_b128 v[104:107], v14 offset:49152
    v_mfma_f32_16x16x32_bf16 v[48:51], v[132:135], a[120:123], v[48:51]
    ds_read_b128 v[108:111], v14 offset:53248
    buffer_load_ushort v27, v31, s[60:63], 0 offen offset:0
    v_mfma_f32_16x16x32_bf16 v[48:51], v[128:131], a[112:115], v[48:51]
    ds_read_b128 v[112:115], v14 offset:57344
    v_mfma_f32_16x16x32_bf16 v[48:51], v[124:127], a[104:107], v[48:51]
    ds_read_b128 v[116:119], v14 offset:61440
    v_mfma_f32_16x16x32_bf16 v[48:51], v[120:123], a[96:99], v[48:51]
    s_waitcnt lgkmcnt(2)
    v_mfma_f32_16x16x32_bf16 v[32:35], v[104:107], a[128:131], v[32:35]
    s_add_u32 m0, s73, 130304
    v_mfma_f32_16x16x32_bf16 v[32:35], v[108:111], a[136:139], v[32:35]
    buffer_load_dwordx4 v23, s[44:47], s26 offen offset:768 sc1 lds
    s_waitcnt lgkmcnt(0)
    v_mfma_f32_16x16x32_bf16 v[32:35], v[112:115], a[144:147], v[32:35]
    ds_read_b128 v[120:123], v14 offset:50176
    v_mfma_f32_16x16x32_bf16 v[32:35], v[116:119], a[152:155], v[32:35]
    ds_read_b128 v[124:127], v14 offset:54272
    v_mfma_f32_16x16x32_bf16 v[36:39], v[116:119], a[156:159], v[36:39]
    ds_read_b128 v[128:131], v14 offset:58368
    v_mfma_f32_16x16x32_bf16 v[36:39], v[112:115], a[148:151], v[36:39]
    ds_read_b128 v[132:135], v14 offset:62464
    v_mfma_f32_16x16x32_bf16 v[36:39], v[108:111], a[140:143], v[36:39]
    s_add_u32 m0, s73, 132096
    v_mfma_f32_16x16x32_bf16 v[36:39], v[104:107], a[132:135], v[36:39]
    buffer_load_dwordx4 v20, s[44:47], s26 offen offset:0 sc1 lds
    s_waitcnt lgkmcnt(2)
    v_mfma_f32_16x16x32_bf16 v[44:47], v[120:123], a[132:135], v[44:47]
    s_add_u32 m0, s73, 132608
    buffer_load_dwordx4 v[88:91], v252, s[56:59], 0 offen
    v_mfma_f32_16x16x32_bf16 v[44:47], v[124:127], a[140:143], v[44:47]
    buffer_load_dwordx4 v20, s[44:47], s26 offen offset:512 sc1 lds
    s_waitcnt lgkmcnt(0)
    v_mfma_f32_16x16x32_bf16 v[44:47], v[128:131], a[148:151], v[44:47]
    ds_read_b128 v[104:107], v14 offset:51200
    v_mfma_f32_16x16x32_bf16 v[44:47], v[132:135], a[156:159], v[44:47]
    ds_read_b128 v[108:111], v14 offset:55296
    v_mfma_f32_16x16x32_bf16 v[40:43], v[132:135], a[152:155], v[40:43]
    ds_read_b128 v[112:115], v14 offset:59392
    v_mfma_f32_16x16x32_bf16 v[40:43], v[128:131], a[144:147], v[40:43]
    ds_read_b128 v[116:119], v14 offset:63488
    v_mfma_f32_16x16x32_bf16 v[40:43], v[124:127], a[136:139], v[40:43]
    s_add_u32 m0, s73, 134144
    v_mfma_f32_16x16x32_bf16 v[40:43], v[120:123], a[128:131], v[40:43]
    buffer_load_dwordx4 v21, s[44:47], s18 offen offset:0 sc1 lds
    s_waitcnt lgkmcnt(2)
    v_mfma_f32_16x16x32_bf16 v[48:51], v[104:107], a[128:131], v[48:51]
    v_mfma_f32_16x16x32_bf16 v[48:51], v[108:111], a[136:139], v[48:51]
    s_waitcnt lgkmcnt(0)
    v_mfma_f32_16x16x32_bf16 v[48:51], v[112:115], a[144:147], v[48:51]
    ds_read_b128 v[120:123], v14 offset:52224
    v_mfma_f32_16x16x32_bf16 v[48:51], v[116:119], a[152:155], v[48:51]
    ds_read_b128 v[124:127], v14 offset:56320
    v_mfma_f32_16x16x32_bf16 v[52:55], v[116:119], a[156:159], v[52:55]
    ds_read_b128 v[128:131], v14 offset:60416
    v_mfma_f32_16x16x32_bf16 v[52:55], v[112:115], a[148:151], v[52:55]
    ds_read_b128 v[132:135], v14 offset:64512
    v_mfma_f32_16x16x32_bf16 v[52:55], v[108:111], a[140:143], v[52:55]
    v_mfma_f32_16x16x32_bf16 v[52:55], v[104:107], a[132:135], v[52:55]
    s_waitcnt lgkmcnt(2)
    v_mfma_f32_16x16x32_bf16 v[36:39], v[120:123], a[164:167], v[36:39]
    buffer_load_dwordx4 v[92:95], v252, s[56:59], s40 offen
    v_mfma_f32_16x16x32_bf16 v[36:39], v[124:127], a[172:175], v[36:39]
    s_waitcnt lgkmcnt(0)
    v_mfma_f32_16x16x32_bf16 v[36:39], v[128:131], a[180:183], v[36:39]
    s_waitcnt vmcnt(13)
    s_barrier
    v_mfma_f32_16x16x32_bf16 v[36:39], v[132:135], a[188:191], v[36:39]
    ds_read_b128 v[104:107], v14 offset:0
    v_mfma_f32_16x16x32_bf16 v[32:35], v[132:135], a[184:187], v[32:35]
    ds_read_b128 v[108:111], v14 offset:4096
    v_mfma_f32_16x16x32_bf16 v[32:35], v[128:131], a[176:179], v[32:35]
    ds_read_b128 v[112:115], v14 offset:8192
    v_mfma_f32_16x16x32_bf16 v[32:35], v[124:127], a[168:171], v[32:35]
    ds_read_b128 v[116:119], v14 offset:12288
    v_mfma_f32_16x16x32_bf16 v[32:35], v[120:123], a[160:163], v[32:35]
    s_waitcnt lgkmcnt(2)
    v_mfma_f32_16x16x32_bf16 v[40:43], v[104:107], a[160:163], v[40:43]
    s_add_u32 m0, s73, 146944
    v_mfma_f32_16x16x32_bf16 v[40:43], v[108:111], a[168:171], v[40:43]
    buffer_load_dwordx4 v21, s[44:47], s18 offen offset:512 sc1 lds
    s_waitcnt lgkmcnt(0)
    v_mfma_f32_16x16x32_bf16 v[40:43], v[112:115], a[176:179], v[40:43]
    ds_read_b128 v[120:123], v14 offset:1024
    v_mfma_f32_16x16x32_bf16 v[40:43], v[116:119], a[184:187], v[40:43]
    ds_read_b128 v[124:127], v14 offset:5120
    v_mfma_f32_16x16x32_bf16 v[44:47], v[116:119], a[188:191], v[44:47]
    ds_read_b128 v[128:131], v14 offset:9216
    v_mfma_f32_16x16x32_bf16 v[44:47], v[112:115], a[180:183], v[44:47]
    ds_read_b128 v[132:135], v14 offset:13312
    v_mfma_f32_16x16x32_bf16 v[44:47], v[108:111], a[172:175], v[44:47]
    s_add_u32 m0, s73, 148480
    v_mfma_f32_16x16x32_bf16 v[44:47], v[104:107], a[164:167], v[44:47]
    buffer_load_dwordx4 v21, s[44:47], s19 offen offset:0 sc1 lds
    s_waitcnt lgkmcnt(2)
    v_mfma_f32_16x16x32_bf16 v[52:55], v[120:123], a[164:167], v[52:55]
    s_add_u32 m0, s73, 148992
    buffer_load_dwordx2 v[142:143], v253, s[56:59], 0 offen
    v_mfma_f32_16x16x32_bf16 v[52:55], v[124:127], a[172:175], v[52:55]
    buffer_load_dwordx4 v21, s[44:47], s19 offen offset:512 sc1 lds
    s_waitcnt lgkmcnt(0)
    v_mfma_f32_16x16x32_bf16 v[52:55], v[128:131], a[180:183], v[52:55]
    ds_read_b128 v[104:107], v14 offset:2048
    v_mfma_f32_16x16x32_bf16 v[52:55], v[132:135], a[188:191], v[52:55]
    ds_read_b128 v[108:111], v14 offset:6144
    v_mfma_f32_16x16x32_bf16 v[48:51], v[132:135], a[184:187], v[48:51]
    ds_read_b128 v[112:115], v14 offset:10240
    v_mfma_f32_16x16x32_bf16 v[48:51], v[128:131], a[176:179], v[48:51]
    ds_read_b128 v[116:119], v14 offset:14336
    v_mfma_f32_16x16x32_bf16 v[48:51], v[124:127], a[168:171], v[48:51]
    s_add_u32 m0, s73, 150528
    v_mfma_f32_16x16x32_bf16 v[48:51], v[120:123], a[160:163], v[48:51]
    buffer_load_dwordx4 v21, s[44:47], s20 offen offset:0 sc1 lds
    s_waitcnt lgkmcnt(2)
    v_mfma_f32_16x16x32_bf16 v[32:35], v[104:107], a[192:195], v[32:35]
    v_mfma_f32_16x16x32_bf16 v[32:35], v[108:111], a[200:203], v[32:35]
    s_waitcnt vmcnt(11)
    s_waitcnt lgkmcnt(0)
    v_mfma_f32_16x16x32_bf16 v[32:35], v[112:115], a[208:211], v[32:35]
    ds_read_b128 v[120:123], v14 offset:3072
    v_mfma_f32_16x16x32_bf16 v[32:35], v[116:119], a[216:219], v[32:35]
    ds_read_b128 v[124:127], v14 offset:7168
    v_mfma_f32_16x16x32_bf16 v[36:39], v[116:119], a[220:223], v[36:39]
    ds_read_b128 v[128:131], v14 offset:11264
    v_lshlrev_b32 v72, 16, v102
    v_mfma_f32_16x16x32_bf16 v[36:39], v[112:115], a[212:215], v[36:39]
    ds_read_b128 v[132:135], v14 offset:15360
    v_mfma_f32_16x16x32_bf16 v[36:39], v[108:111], a[204:207], v[36:39]
    v_lshlrev_b32 v73, 16, v102
    v_mfma_f32_16x16x32_bf16 v[36:39], v[104:107], a[196:199], v[36:39]
    buffer_load_dwordx2 v[96:97], v26, s[44:47], s42 offen offset:0 sc1
    s_waitcnt lgkmcnt(2)
    v_mfma_f32_16x16x32_bf16 v[44:47], v[120:123], a[196:199], v[44:47]
    v_mfma_f32_16x16x32_bf16 v[44:47], v[124:127], a[204:207], v[44:47]
    v_lshlrev_b32 v74, 16, v102
    s_waitcnt lgkmcnt(0)
    v_mfma_f32_16x16x32_bf16 v[44:47], v[128:131], a[212:215], v[44:47]
    s_barrier
    v_mfma_f32_16x16x32_bf16 v[44:47], v[132:135], a[220:223], v[44:47]
    ds_read_b128 v[104:107], v14 offset:16384
    v_mfma_f32_16x16x32_bf16 v[40:43], v[132:135], a[216:219], v[40:43]
    ds_read_b128 v[108:111], v14 offset:20480
    v_lshlrev_b32 v75, 16, v102
    v_mfma_f32_16x16x32_bf16 v[40:43], v[128:131], a[208:211], v[40:43]
    ds_read_b128 v[112:115], v14 offset:24576
    v_mfma_f32_16x16x32_bf16 v[40:43], v[124:127], a[200:203], v[40:43]
    ds_read_b128 v[116:119], v14 offset:28672
    v_lshlrev_b32 v76, 16, v103
    v_mfma_f32_16x16x32_bf16 v[40:43], v[120:123], a[192:195], v[40:43]
    s_waitcnt lgkmcnt(2)
    v_mfma_f32_16x16x32_bf16 v[48:51], v[104:107], a[192:195], v[48:51]
    s_add_u32 m0, s73, 97792
    v_lshlrev_b32 v77, 16, v103
    v_mfma_f32_16x16x32_bf16 v[48:51], v[108:111], a[200:203], v[48:51]
    buffer_load_dwordx4 v21, s[44:47], s20 offen offset:512 sc1 lds
    s_waitcnt lgkmcnt(0)
    v_mfma_f32_16x16x32_bf16 v[48:51], v[112:115], a[208:211], v[48:51]
    ds_read_b128 v[120:123], v14 offset:17408
    v_mfma_f32_16x16x32_bf16 v[48:51], v[116:119], a[216:219], v[48:51]
    ds_read_b128 v[124:127], v14 offset:21504
    v_mfma_f32_16x16x32_bf16 v[52:55], v[116:119], a[220:223], v[52:55]
    ds_read_b128 v[128:131], v14 offset:25600
    v_lshlrev_b32 v78, 16, v103
    v_mfma_f32_16x16x32_bf16 v[52:55], v[112:115], a[212:215], v[52:55]
    ds_read_b128 v[132:135], v14 offset:29696
    v_mfma_f32_16x16x32_bf16 v[52:55], v[108:111], a[204:207], v[52:55]
    s_add_u32 m0, s73, 99328
    v_lshlrev_b32 v79, 16, v103
    v_mfma_f32_16x16x32_bf16 v[52:55], v[104:107], a[196:199], v[52:55]
    buffer_load_dwordx4 v21, s[44:47], s21 offen offset:0 sc1 lds
    s_waitcnt lgkmcnt(2)
    v_mfma_f32_16x16x32_bf16 v[36:39], v[120:123], a[228:231], v[36:39]
    buffer_load_dwordx2 v[98:99], v26, s[44:47], s42 offen offset:128 sc1
    s_add_u32 m0, s73, 99840
    v_lshlrev_b32 v80, 16, v102
    v_mfma_f32_16x16x32_bf16 v[36:39], v[124:127], a[236:239], v[36:39]
    buffer_load_dwordx4 v21, s[44:47], s21 offen offset:512 sc1 lds
    s_waitcnt lgkmcnt(0)
    v_mfma_f32_16x16x32_bf16 v[36:39], v[128:131], a[244:247], v[36:39]
    ds_read_b128 v[104:107], v14 offset:18432
    v_mfma_f32_16x16x32_bf16 v[36:39], v[132:135], a[252:255], v[36:39]
    ds_read_b128 v[108:111], v14 offset:22528
    v_mfma_f32_16x16x32_bf16 v[32:35], v[132:135], a[248:251], v[32:35]
    ds_read_b128 v[112:115], v14 offset:26624
    v_lshlrev_b32 v81, 16, v102
    v_mfma_f32_16x16x32_bf16 v[32:35], v[128:131], a[240:243], v[32:35]
    ds_read_b128 v[116:119], v14 offset:30720
    v_mfma_f32_16x16x32_bf16 v[32:35], v[124:127], a[232:235], v[32:35]
    s_add_u32 m0, s73, 101376
    v_lshlrev_b32 v82, 16, v102
    v_mfma_f32_16x16x32_bf16 v[32:35], v[120:123], a[224:227], v[32:35]
    buffer_load_dwordx4 v21, s[44:47], s22 offen offset:0 sc1 lds
    s_waitcnt lgkmcnt(2)
    v_mfma_f32_16x16x32_bf16 v[40:43], v[104:107], a[224:227], v[40:43]
    v_mfma_f32_16x16x32_bf16 v[40:43], v[108:111], a[232:235], v[40:43]
    v_lshlrev_b32 v83, 16, v102
    s_waitcnt lgkmcnt(0)
L_pl_X_7:
    s_cbranch_execz L_wret
    v_mfma_f32_16x16x32_bf16 v[40:43], v[112:115], a[240:243], v[40:43]
    ds_read_b128 v[120:123], v14 offset:19456
    v_mfma_f32_16x16x32_bf16 v[40:43], v[116:119], a[248:251], v[40:43]
    ds_read_b128 v[124:127], v14 offset:23552
    v_mfma_f32_16x16x32_bf16 v[44:47], v[116:119], a[252:255], v[44:47]
    ds_read_b128 v[128:131], v14 offset:27648
    v_lshlrev_b32 v84, 16, v103
    v_mfma_f32_16x16x32_bf16 v[44:47], v[112:115], a[244:247], v[44:47]
    ds_read_b128 v[132:135], v14 offset:31744
    v_mfma_f32_16x16x32_bf16 v[44:47], v[108:111], a[236:239], v[44:47]
    v_lshlrev_b32 v85, 16, v103
    v_mfma_f32_16x16x32_bf16 v[44:47], v[104:107], a[228:231], v[44:47]
    buffer_load_dwordx2 v[100:101], v18, s[44:47], s42 offen offset:0 sc1
    s_waitcnt lgkmcnt(2)
    v_mfma_f32_16x16x32_bf16 v[52:55], v[120:123], a[228:231], v[52:55]
    v_mfma_f32_16x16x32_bf16 v[52:55], v[124:127], a[236:239], v[52:55]
    v_lshlrev_b32 v86, 16, v103
    s_waitcnt lgkmcnt(0)
    v_mfma_f32_16x16x32_bf16 v[52:55], v[128:131], a[244:247], v[52:55]
    s_waitcnt vmcnt(13)
    s_barrier
    v_mfma_f32_16x16x32_bf16 v[52:55], v[132:135], a[252:255], v[52:55]
    ds_read_b128 v[104:107], v14 offset:32768
    v_lshlrev_b32 v87, 16, v103
    v_mfma_f32_16x16x32_bf16 v[48:51], v[132:135], a[248:251], v[48:51]
    ds_read_b128 v[108:111], v14 offset:36864
    v_add_u32 v10, 65536, v10
    v_mfma_f32_16x16x32_bf16 v[48:51], v[128:131], a[240:243], v[48:51]
    ds_read_b128 v[112:115], v14 offset:40960
    v_mfma_f32_16x16x32_bf16 v[48:51], v[124:127], a[232:235], v[48:51]
    ds_read_b128 v[116:119], v14 offset:45056
    v_add_u32 v11, 65536, v11
    v_mfma_f32_16x16x32_bf16 v[48:51], v[120:123], a[224:227], v[48:51]
    v_lshlrev_b32 v27, 16, v27
    s_branch L_Dc
L_idle:
    s_waitcnt vmcnt(0)
    s_barrier
    s_mov_b64 exec, 0
    s_call_b64 s[82:83], L_wc_D
    s_mov_b64 exec, -1
    s_mov_b32 s60, s36
    s_and_b32 s61, s37, 0xffff
    s_mov_b32 s62, 4096
    s_mov_b32 s63, 0x20000
    v_and_b32 v24, 15, v2
    s_lshl_b32 s7, s71, 6
    v_add_u32 v24, s7, v24
    s_and_b32 s8, s3, 1
    s_lshl_b32 s4, s8, 5
    v_add_u32 v25, s4, v24
    v_lshlrev_b32 v26, 3, v25
    v_mul_u32_u24 v25, 1152, v25
    v_bfe_u32 v31, v2, 4, 1
    v_lshl_add_u32 v25, v31, 5, v25
    v_lshrrev_b32 v31, 5, v2
    v_lshl_add_u32 v25, v31, 4, v25
    s_bfe_u32 s7, s2, 0x20003
    s_mul_i32 s7, s7, 288
    s_lshl_b32 s4, s72, 6
    s_add_u32 s4, s4, s7
    v_add_u32 v252, s4, v25
    s_xor_b32 s8, s3, s72
    s_and_b32 s4, s72, 1
    s_lshl1_add_u32 s4, s4, s8
    v_lshl_add_u32 v24, s4, 4, v24
    s_add_u32 s7, s7, 256
    s_cmp_lt_u32 s8, 2
    s_cselect_b32 s7, s7, 0x40000000
    v_lshlrev_b32 v18, 3, v24
    v_mul_u32_u24 v24, 1152, v24
    v_lshrrev_b32 v31, 4, v2
    v_lshl_add_u32 v24, v31, 3, v24
    v_add_u32 v253, s7, v24
    v_lshrrev_b32 v24, 3, v2
    v_and_b32 v25, 7, v2
    v_bfe_u32 v31, v2, 4, 2
    v_lshlrev_b32 v31, 1, v31
    v_xor_b32 v25, v25, v31
    v_lshlrev_b32 v24, 12, v24
    v_lshl_add_u32 v24, v25, 4, v24
    s_mul_i32 s7, s72, 36
    s_bitcmp1_b32 s3, 0
    s_addc_u32 s7, s7, 0
    s_lshl_b32 s7, s7, 17
    s_lshl_b32 s8, s71, 7
    s_add_u32 s7, s7, s8
    v_add_u32 v4, s7, v24
    v_add_u32 v5, 31744, v4
    v_add_u32 v6, 31744, v5
    v_add_u32 v7, 31744, v6
    v_lshrrev_b32 v24, 2, v2
    v_lshlrev_b32 v24, 7, v24
    v_and_b32 v25, 3, v2
    v_lshl_add_u32 v24, v25, 3, v24
    s_and_b32 s7, s73, 8192
    v_add_u32 v24, s7, v24
    v_bfe_u32 v31, v2, 3, 2
    s_and_b32 s7, s3, 1
    s_lshl_b32 s7, s7, 1
    v_xor_b32 v31, s7, v31
    v_lshl_add_u32 v10, v31, 5, v24
    v_xor_b32 v11, 32, v10
    v_and_b32 v24, 15, v2
    v_lshrrev_b32 v25, 4, v2
    v_mul_u32_u24 v25, 17408, v25
    v_lshl_add_u32 v24, v24, 4, v25
    s_mul_i32 s7, s72, 36
    s_and_b32 s8, s3, 1
    s_add_u32 s7, s7, s8
    s_mul_i32 s7, s7, 69632
    s_bfe_u32 s8, s2, 0x20003
    s_lshl_b32 s8, s8, 12
    s_add_u32 s7, s7, s8
    s_add_u32 s7, s7, 12795904
    v_add_u32 v23, s7, v24
    s_xor_b32 s7, s72, 0
    v_lshl_add_u32 v19, s7, 10, v23
    s_xor_b32 s7, s72, 1
    v_lshl_add_u32 v20, s7, 10, v23
    s_xor_b32 s7, s72, 2
    v_lshl_add_u32 v21, s7, 10, v23
    s_xor_b32 s7, s72, 3
    v_lshl_add_u32 v22, s7, 10, v23
    v_lshlrev_b32 v14, 4, v2
    v_add_u32 v14, 98304, v14
    v_add_u32 v1, 0x10000, v14
    s_bitcmp1_b32 s3, 1
    s_cselect_b32 s18, s85, s84
    s_mul_i32 s18, s18, 139264
    s_cselect_b32 s19, s87, s86
    s_mul_i32 s19, s19, 139264
    s_cselect_b32 s20, s89, s88
    s_mul_i32 s20, s20, 139264
    s_cselect_b32 s21, s91, s90
    s_mul_i32 s21, s21, 139264
    s_cselect_b32 s22, s93, s92
    s_mul_i32 s22, s22, 139264
    s_cselect_b32 s23, s95, s94
    s_mul_i32 s23, s23, 139264
    s_cselect_b32 s24, s97, s96
    s_mul_i32 s24, s24, 139264
    s_cselect_b32 s25, s99, s98
    s_mul_i32 s25, s25, 139264
    s_cselect_b32 s26, s101, s100
    s_mul_i32 s26, s26, 139264
    s_sub_u32 s4, s75, 252
    s_mul_i32 s4, s4, 1152
    s_mul_i32 s5, s3, 64
    s_add_u32 s4, s4, s5
    s_add_u32 s4, s4, 896
    s_lshl_b32 s4, s4, 12
    s_add_u32 s4, s4, 384
    v_lshlrev_b32 v24, 10, v2
    buffer_load_dword v255, v24, s[52:55], s4 offen
    s_add_u32 s4, s4, 65536
    buffer_load_dword v255, v24, s[52:55], s4 offen
    s_add_u32 s4, s4, 65536
    buffer_load_dword v255, v24, s[52:55], s4 offen
    s_add_u32 s4, s4, 65536
    buffer_load_dword v255, v24, s[52:55], s4 offen
    s_add_u32 s4, s4, 65536
    s_add_u32 m0, s73, 32768
    s_lshl_b32 s14, s84, 18
    buffer_load_dwordx4 v4, s[52:55], s14 offen offset:0 lds
    buffer_load_dwordx4 v5, s[52:55], s14 offen offset:1024 lds
    buffer_load_dwordx4 v6, s[52:55], s14 offen offset:2048 lds
    buffer_load_dwordx4 v7, s[52:55], s14 offen offset:3072 lds
    s_add_u32 m0, s73, 49152
    s_lshl_b32 s14, s85, 18
    buffer_load_dwordx4 v4, s[52:55], s14 offen offset:0 lds
    buffer_load_dwordx4 v5, s[52:55], s14 offen offset:1024 lds
    buffer_load_dwordx4 v6, s[52:55], s14 offen offset:2048 lds
    buffer_load_dwordx4 v7, s[52:55], s14 offen offset:3072 lds
    s_add_u32 m0, s73, 65536
    s_lshl_b32 s14, s86, 18
    buffer_load_dwordx4 v4, s[52:55], s14 offen offset:0 lds
    buffer_load_dwordx4 v5, s[52:55], s14 offen offset:1024 lds
    buffer_load_dwordx4 v6, s[52:55], s14 offen offset:2048 lds
    buffer_load_dwordx4 v7, s[52:55], s14 offen offset:3072 lds
    s_add_u32 m0, s73, 81920
    s_lshl_b32 s14, s87, 18
    buffer_load_dwordx4 v4, s[52:55], s14 offen offset:0 lds
    buffer_load_dwordx4 v5, s[52:55], s14 offen offset:1024 lds
    buffer_load_dwordx4 v6, s[52:55], s14 offen offset:2048 lds
    buffer_load_dwordx4 v7, s[52:55], s14 offen offset:3072 lds
    s_add_u32 m0, s73, 98304
    s_lshl_b32 s14, s88, 18
    buffer_load_dwordx4 v4, s[52:55], s14 offen offset:0 lds
    buffer_load_dwordx4 v5, s[52:55], s14 offen offset:1024 lds
    buffer_load_dwordx4 v6, s[52:55], s14 offen offset:2048 lds
    buffer_load_dwordx4 v7, s[52:55], s14 offen offset:3072 lds
    s_add_u32 m0, s73, 114688
    s_lshl_b32 s14, s89, 18
    buffer_load_dwordx4 v4, s[52:55], s14 offen offset:0 lds
    buffer_load_dwordx4 v5, s[52:55], s14 offen offset:1024 lds
    buffer_load_dwordx4 v6, s[52:55], s14 offen offset:2048 lds
    buffer_load_dwordx4 v7, s[52:55], s14 offen offset:3072 lds
    s_add_u32 m0, s73, 131072
    s_lshl_b32 s14, s90, 18
    buffer_load_dwordx4 v4, s[52:55], s14 offen offset:0 lds
    buffer_load_dwordx4 v5, s[52:55], s14 offen offset:1024 lds
    buffer_load_dwordx4 v6, s[52:55], s14 offen offset:2048 lds
    buffer_load_dwordx4 v7, s[52:55], s14 offen offset:3072 lds
    s_add_u32 m0, s73, 147456
    s_lshl_b32 s14, s91, 18
    buffer_load_dwordx4 v4, s[52:55], s14 offen offset:0 lds
    buffer_load_dwordx4 v5, s[52:55], s14 offen offset:1024 lds
    buffer_load_dwordx4 v6, s[52:55], s14 offen offset:2048 lds
    buffer_load_dwordx4 v7, s[52:55], s14 offen offset:3072 lds
    s_waitcnt vmcnt(28)
    s_barrier
    ds_read_b64_tr_b16 a[0:1], v10 offset:32768
    ds_read_b64_tr_b16 a[2:3], v10 offset:34816
    ds_read_b64_tr_b16 a[8:9], v10 offset:36864
    ds_read_b64_tr_b16 a[10:11], v10 offset:38912
    ds_read_b64_tr_b16 a[4:5], v11 offset:32768
    ds_read_b64_tr_b16 a[6:7], v11 offset:34816
    ds_read_b64_tr_b16 a[12:13], v11 offset:36864
    ds_read_b64_tr_b16 a[14:15], v11 offset:38912
    s_waitcnt vmcnt(24) lgkmcnt(0)
    s_barrier
    ds_read_b64_tr_b16 a[16:17], v10 offset:49152
    s_add_u32 m0, s73, 32768
    s_lshl_b32 s14, s92, 18
    ds_read_b64_tr_b16 a[18:19], v10 offset:51200
    buffer_load_dwordx4 v4, s[52:55], s14 offen offset:0 lds
    ds_read_b64_tr_b16 a[24:25], v10 offset:53248
    ds_read_b64_tr_b16 a[26:27], v10 offset:55296
    buffer_load_dwordx4 v5, s[52:55], s14 offen offset:1024 lds
    ds_read_b64_tr_b16 a[20:21], v11 offset:49152
    buffer_load_dwordx4 v6, s[52:55], s14 offen offset:2048 lds
    ds_read_b64_tr_b16 a[22:23], v11 offset:51200
    ds_read_b64_tr_b16 a[28:29], v11 offset:53248
    buffer_load_dwordx4 v7, s[52:55], s14 offen offset:3072 lds
    ds_read_b64_tr_b16 a[30:31], v11 offset:55296
    s_waitcnt vmcnt(24) lgkmcnt(0)
    s_barrier
    v_add_u32 v10, 65536, v10
    ds_read_b64_tr_b16 a[32:33], v10 offset:0
    s_add_u32 m0, s73, 49152
    s_lshl_b32 s14, s93, 18
    ds_read_b64_tr_b16 a[34:35], v10 offset:2048
    buffer_load_dwordx4 v4, s[52:55], s14 offen offset:0 lds
    ds_read_b64_tr_b16 a[40:41], v10 offset:4096
    ds_read_b64_tr_b16 a[42:43], v10 offset:6144
    buffer_load_dwordx4 v5, s[52:55], s14 offen offset:1024 lds
    v_add_u32 v11, 65536, v11
    ds_read_b64_tr_b16 a[36:37], v11 offset:0
    buffer_load_dwordx4 v6, s[52:55], s14 offen offset:2048 lds
    ds_read_b64_tr_b16 a[38:39], v11 offset:2048
    ds_read_b64_tr_b16 a[44:45], v11 offset:4096
    buffer_load_dwordx4 v7, s[52:55], s14 offen offset:3072 lds
    ds_read_b64_tr_b16 a[46:47], v11 offset:6144
    s_waitcnt vmcnt(24) lgkmcnt(0)
    s_barrier
    ds_read_b64_tr_b16 a[48:49], v10 offset:16384
    s_add_u32 m0, s73, 65536
    s_lshl_b32 s14, s94, 18
    ds_read_b64_tr_b16 a[50:51], v10 offset:18432
    buffer_load_dwordx4 v4, s[52:55], s14 offen offset:0 lds
    ds_read_b64_tr_b16 a[56:57], v10 offset:20480
    ds_read_b64_tr_b16 a[58:59], v10 offset:22528
    buffer_load_dwordx4 v5, s[52:55], s14 offen offset:1024 lds
    ds_read_b64_tr_b16 a[52:53], v11 offset:16384
    buffer_load_dwordx4 v6, s[52:55], s14 offen offset:2048 lds
    ds_read_b64_tr_b16 a[54:55], v11 offset:18432
    ds_read_b64_tr_b16 a[60:61], v11 offset:20480
    buffer_load_dwordx4 v7, s[52:55], s14 offen offset:3072 lds
    ds_read_b64_tr_b16 a[62:63], v11 offset:22528
    s_waitcnt vmcnt(24) lgkmcnt(0)
    s_barrier
    ds_read_b64_tr_b16 a[64:65], v10 offset:32768
    s_add_u32 m0, s73, 81920
    s_lshl_b32 s14, s95, 18
    ds_read_b64_tr_b16 a[66:67], v10 offset:34816
    buffer_load_dwordx4 v4, s[52:55], s14 offen offset:0 lds
    ds_read_b64_tr_b16 a[72:73], v10 offset:36864
    ds_read_b64_tr_b16 a[74:75], v10 offset:38912
    buffer_load_dwordx4 v5, s[52:55], s14 offen offset:1024 lds
    ds_read_b64_tr_b16 a[68:69], v11 offset:32768
    buffer_load_dwordx4 v6, s[52:55], s14 offen offset:2048 lds
    ds_read_b64_tr_b16 a[70:71], v11 offset:34816
    ds_read_b64_tr_b16 a[76:77], v11 offset:36864
    buffer_load_dwordx4 v7, s[52:55], s14 offen offset:3072 lds
    ds_read_b64_tr_b16 a[78:79], v11 offset:38912
    s_waitcnt vmcnt(24) lgkmcnt(0)
    s_barrier
    ds_read_b64_tr_b16 a[80:81], v10 offset:49152
    s_add_u32 m0, s73, 98304
    s_lshl_b32 s14, s96, 18
    ds_read_b64_tr_b16 a[82:83], v10 offset:51200
    buffer_load_dwordx4 v4, s[52:55], s14 offen offset:0 lds
    ds_read_b64_tr_b16 a[88:89], v10 offset:53248
    ds_read_b64_tr_b16 a[90:91], v10 offset:55296
    buffer_load_dwordx4 v5, s[52:55], s14 offen offset:1024 lds
    ds_read_b64_tr_b16 a[84:85], v11 offset:49152
    buffer_load_dwordx4 v6, s[52:55], s14 offen offset:2048 lds
    ds_read_b64_tr_b16 a[86:87], v11 offset:51200
    ds_read_b64_tr_b16 a[92:93], v11 offset:53248
    buffer_load_dwordx4 v7, s[52:55], s14 offen offset:3072 lds
    ds_read_b64_tr_b16 a[94:95], v11 offset:55296
    s_waitcnt vmcnt(24) lgkmcnt(0)
    s_barrier
    v_add_u32 v10, 65536, v10
    ds_read_b64_tr_b16 a[96:97], v10 offset:0
    s_add_u32 m0, s73, 114688
    s_lshl_b32 s14, s97, 18
    ds_read_b64_tr_b16 a[98:99], v10 offset:2048
    buffer_load_dwordx4 v4, s[52:55], s14 offen offset:0 lds
    ds_read_b64_tr_b16 a[104:105], v10 offset:4096
    ds_read_b64_tr_b16 a[106:107], v10 offset:6144
    buffer_load_dwordx4 v5, s[52:55], s14 offen offset:1024 lds
    v_add_u32 v11, 65536, v11
    ds_read_b64_tr_b16 a[100:101], v11 offset:0
    buffer_load_dwordx4 v6, s[52:55], s14 offen offset:2048 lds
    ds_read_b64_tr_b16 a[102:103], v11 offset:2048
    ds_read_b64_tr_b16 a[108:109], v11 offset:4096
    buffer_load_dwordx4 v7, s[52:55], s14 offen offset:3072 lds
    ds_read_b64_tr_b16 a[110:111], v11 offset:6144
    s_waitcnt vmcnt(24) lgkmcnt(0)
    s_barrier
    ds_read_b64_tr_b16 a[112:113], v10 offset:16384
    s_add_u32 m0, s73, 131072
    s_lshl_b32 s14, s98, 18
    ds_read_b64_tr_b16 a[114:115], v10 offset:18432
    buffer_load_dwordx4 v4, s[52:55], s14 offen offset:0 lds
    ds_read_b64_tr_b16 a[120:121], v10 offset:20480
    ds_read_b64_tr_b16 a[122:123], v10 offset:22528
    buffer_load_dwordx4 v5, s[52:55], s14 offen offset:1024 lds
    ds_read_b64_tr_b16 a[116:117], v11 offset:16384
    buffer_load_dwordx4 v6, s[52:55], s14 offen offset:2048 lds
    ds_read_b64_tr_b16 a[118:119], v11 offset:18432
    ds_read_b64_tr_b16 a[124:125], v11 offset:20480
    buffer_load_dwordx4 v7, s[52:55], s14 offen offset:3072 lds
    ds_read_b64_tr_b16 a[126:127], v11 offset:22528
    s_waitcnt vmcnt(24) lgkmcnt(0)
    s_barrier
    v_add_u32 v10, -131072, v10
    ds_read_b64_tr_b16 a[128:129], v10 offset:32768
    s_add_u32 m0, s73, 147456
    s_lshl_b32 s14, s99, 18
    ds_read_b64_tr_b16 a[130:131], v10 offset:34816
    buffer_load_dwordx4 v4, s[52:55], s14 offen offset:0 lds
    ds_read_b64_tr_b16 a[136:137], v10 offset:36864
    ds_read_b64_tr_b16 a[138:139], v10 offset:38912
    buffer_load_dwordx4 v5, s[52:55], s14 offen offset:1024 lds
    v_add_u32 v11, -131072, v11
    ds_read_b64_tr_b16 a[132:133], v11 offset:32768
    buffer_load_dwordx4 v6, s[52:55], s14 offen offset:2048 lds
    ds_read_b64_tr_b16 a[134:135], v11 offset:34816
    ds_read_b64_tr_b16 a[140:141], v11 offset:36864
    buffer_load_dwordx4 v7, s[52:55], s14 offen offset:3072 lds
    ds_read_b64_tr_b16 a[142:143], v11 offset:38912
    s_waitcnt vmcnt(24) lgkmcnt(0)
    s_barrier
    ds_read_b64_tr_b16 a[144:145], v10 offset:49152
    s_add_u32 m0, s73, 0
    s_lshl_b32 s14, s100, 18
    ds_read_b64_tr_b16 a[146:147], v10 offset:51200
    buffer_load_dwordx4 v4, s[52:55], s14 offen offset:0 lds
    ds_read_b64_tr_b16 a[152:153], v10 offset:53248
    ds_read_b64_tr_b16 a[154:155], v10 offset:55296
    buffer_load_dwordx4 v5, s[52:55], s14 offen offset:1024 lds
    ds_read_b64_tr_b16 a[148:149], v11 offset:49152
    buffer_load_dwordx4 v6, s[52:55], s14 offen offset:2048 lds
    ds_read_b64_tr_b16 a[150:151], v11 offset:51200
    ds_read_b64_tr_b16 a[156:157], v11 offset:53248
    buffer_load_dwordx4 v7, s[52:55], s14 offen offset:3072 lds
    ds_read_b64_tr_b16 a[158:159], v11 offset:55296
    s_waitcnt vmcnt(24) lgkmcnt(0)
    s_barrier
    v_add_u32 v10, 65536, v10
    ds_read_b64_tr_b16 a[160:161], v10 offset:0
    s_add_u32 m0, s73, 16384
    s_lshl_b32 s14, s101, 18
    ds_read_b64_tr_b16 a[162:163], v10 offset:2048
    buffer_load_dwordx4 v4, s[52:55], s14 offen offset:0 lds
    ds_read_b64_tr_b16 a[168:169], v10 offset:4096
    ds_read_b64_tr_b16 a[170:171], v10 offset:6144
    buffer_load_dwordx4 v5, s[52:55], s14 offen offset:1024 lds
    v_add_u32 v11, 65536, v11
    ds_read_b64_tr_b16 a[164:165], v11 offset:0
    buffer_load_dwordx4 v6, s[52:55], s14 offen offset:2048 lds
    ds_read_b64_tr_b16 a[166:167], v11 offset:2048
    ds_read_b64_tr_b16 a[172:173], v11 offset:4096
    buffer_load_dwordx4 v7, s[52:55], s14 offen offset:3072 lds
    ds_read_b64_tr_b16 a[174:175], v11 offset:6144
    s_waitcnt vmcnt(24) lgkmcnt(0)
    s_barrier
    ds_read_b64_tr_b16 a[176:177], v10 offset:16384
    ds_read_b64_tr_b16 a[178:179], v10 offset:18432
    ds_read_b64_tr_b16 a[184:185], v10 offset:20480
    ds_read_b64_tr_b16 a[186:187], v10 offset:22528
    ds_read_b64_tr_b16 a[180:181], v11 offset:16384
    ds_read_b64_tr_b16 a[182:183], v11 offset:18432
    ds_read_b64_tr_b16 a[188:189], v11 offset:20480
    ds_read_b64_tr_b16 a[190:191], v11 offset:22528
    s_waitcnt vmcnt(20) lgkmcnt(0)
    s_barrier
    ds_read_b64_tr_b16 a[192:193], v10 offset:32768
    ds_read_b64_tr_b16 a[194:195], v10 offset:34816
    ds_read_b64_tr_b16 a[200:201], v10 offset:36864
    ds_read_b64_tr_b16 a[202:203], v10 offset:38912
    ds_read_b64_tr_b16 a[196:197], v11 offset:32768
    ds_read_b64_tr_b16 a[198:199], v11 offset:34816
    ds_read_b64_tr_b16 a[204:205], v11 offset:36864
    ds_read_b64_tr_b16 a[206:207], v11 offset:38912
    s_waitcnt vmcnt(16) lgkmcnt(0)
    s_barrier
    ds_read_b64_tr_b16 a[208:209], v10 offset:49152
    ds_read_b64_tr_b16 a[210:211], v10 offset:51200
    ds_read_b64_tr_b16 a[216:217], v10 offset:53248
    ds_read_b64_tr_b16 a[218:219], v10 offset:55296
    ds_read_b64_tr_b16 a[212:213], v11 offset:49152
    ds_read_b64_tr_b16 a[214:215], v11 offset:51200
    ds_read_b64_tr_b16 a[220:221], v11 offset:53248
    ds_read_b64_tr_b16 a[222:223], v11 offset:55296
    s_waitcnt vmcnt(12) lgkmcnt(0)
    s_barrier
    v_add_u32 v10, 65536, v10
    ds_read_b64_tr_b16 a[224:225], v10 offset:0
    ds_read_b64_tr_b16 a[226:227], v10 offset:2048
    ds_read_b64_tr_b16 a[232:233], v10 offset:4096
    ds_read_b64_tr_b16 a[234:235], v10 offset:6144
    v_add_u32 v11, 65536, v11
    ds_read_b64_tr_b16 a[228:229], v11 offset:0
    ds_read_b64_tr_b16 a[230:231], v11 offset:2048
    ds_read_b64_tr_b16 a[236:237], v11 offset:4096
    ds_read_b64_tr_b16 a[238:239], v11 offset:6144
    s_waitcnt vmcnt(8) lgkmcnt(0)
    s_barrier
    ds_read_b64_tr_b16 a[240:241], v10 offset:16384
    ds_read_b64_tr_b16 a[242:243], v10 offset:18432
    ds_read_b64_tr_b16 a[248:249], v10 offset:20480
    ds_read_b64_tr_b16 a[250:251], v10 offset:22528
    ds_read_b64_tr_b16 a[244:245], v11 offset:16384
    ds_read_b64_tr_b16 a[246:247], v11 offset:18432
    ds_read_b64_tr_b16 a[252:253], v11 offset:20480
    ds_read_b64_tr_b16 a[254:255], v11 offset:22528
    s_waitcnt lgkmcnt(0)
    s_barrier
    v_add_u32 v10, -131072, v10
    v_add_u32 v11, -131072, v11
    s_mov_b64 exec, 0
    s_call_b64 s[82:83], L_wc_D
    s_mov_b64 exec, -1
    s_bfe_u32 s4, s2, 0x20003
    s_lshl2_add_u32 s4, s72, s4
    s_lshl_b32 s4, s4, 3
    s_lshr_b32 s5, s2, 4
    s_and_b32 s5, s5, 6
    s_add_u32 s4, s4, s5
    s_and_b32 s5, s2, 1
    s_add_u32 s4, s4, s5
    s_lshl_b32 s4, s4, 7
    s_add_u32 s4, s4, 12566528
    v_lshl_add_u32 v28, v2, 2, s4
    s_cmp_eq_u32 s3, 0
    s_cselect_b32 s4, 18, 0
    v_cmp_gt_u32 vcc, s4, v2
    v_mov_b32 v13, 0x40000000
    s_nop 0
    v_cndmask_b32 v28, v13, v28, vcc
    v_mov_b32 v13, s68
    v_cndmask_b32 v13, 0, v13, vcc
    s_mov_b32 s5, 0
L_iw:
    s_sleep 16
    v_mov_b32 v29, 0
    buffer_atomic_add v29, v28, s[44:47], 0 offen sc0 sc1
    s_waitcnt vmcnt(0)
    v_cmp_eq_u32 vcc, 0, v13
    s_nop 1
    s_mov_b64 s[6:7], vcc
    v_cmp_ne_u32 vcc, v13, v29
    s_nop 1
    s_andn2_b64 s[8:9], exec, vcc
    s_andn2_b64 s[8:9], s[8:9], s[6:7]
    s_cbranch_scc1 L_ix
    s_cmp_eq_u64 s[6:7], exec
    s_cbranch_scc1 L_ix
    s_add_u32 s5, s5, 1
    s_cmp_lt_u32 s5, 100000
    s_cbranch_scc1 L_iw
L_ix:
    v_mov_b32 v29, 0
    buffer_atomic_add v29, v28, s[44:47], 0 offen sc0 sc1
    s_branch L_DX
L_end:
.section .rodata,"a"
.p2align 6
.amdhsa_kernel recurrent_scan__ssm_conv_h3__mixer_token_mlp__prompt_kernel
  .amdhsa_next_free_vgpr 512
  .amdhsa_next_free_sgpr 102
  .amdhsa_accum_offset 256
  .amdhsa_group_segment_fixed_size 0
  .amdhsa_kernarg_size 112
  .amdhsa_user_sgpr_count 2
  .amdhsa_user_sgpr_kernarg_segment_ptr 1
  .amdhsa_system_sgpr_workgroup_id_x 1
  .amdhsa_float_denorm_mode_32 3
.end_amdhsa_kernel
```

```asm
; @launch grid=(256,1,1) block=(256,1,1) lds=163840
.amdgcn_target "amdgcn-amd-amdhsa--gfx950"
.text
.globl recurrent_scan__ssm_conv_h3__mixer_token_mlp__prompt_kernel
.p2align 8
.type recurrent_scan__ssm_conv_h3__mixer_token_mlp__prompt_kernel,@function
recurrent_scan__ssm_conv_h3__mixer_token_mlp__prompt_kernel:
    s_cmp_lt_u32 s2, 256
    s_cbranch_scc0 L_exit
    s_load_dwordx2 s[56:57], s[0:1], 0
    s_load_dwordx2 s[48:49], s[0:1], 8
    s_load_dwordx2 s[52:53], s[0:1], 16
    s_load_dwordx2 s[60:61], s[0:1], 24
    s_load_dwordx16 s[16:31], s[0:1], 0
    s_load_dwordx8 s[32:39], s[0:1], 64
    s_load_dwordx4 s[40:43], s[0:1], 96
    s_memrealtime s[12:13]
    v_lshrrev_b32 v1, 6, v0
    v_and_b32 v2, 63, v0
    s_getpc_b64 s[6:7]
L_pc:
    s_lshr_b32 s4, s2, 1
    s_and_b32 s4, s4, 124
    v_add_u32 v22, s4, v1
    v_lshl_add_u32 v22, v2, 7, v22
    v_lshlrev_b32 v22, 7, v22
    v_min_u32 v22, L_end-L_pc-4, v22
    s_mov_b64 exec, 31
    global_load_dword v255, v22, s[6:7]
    s_mov_b64 exec, -1
    v_readfirstlane_b32 s3, v1
    s_and_b32 s4, s2, 7
    s_lshr_b32 s5, s2, 3
    s_lshl_b32 s4, s4, 5
    s_add_u32 s68, s4, s5
    v_lshrrev_b32 v3, 5, v0
    v_and_b32 v4, 31, v0
    v_mul_u32_u24 v5, 1152, v3
    v_mad_u32_u24 v5, v4, 12, v5
    s_mul_i32 s15, s68, 9216
    s_mul_i32 s4, s3, 3072
    s_add_u32 s5, s4, s15
    s_sub_u32 s5, s5, 3456
    v_lshlrev_b32 v6, 4, v2
    v_add_u32 v7, s5, v6
    v_add_u32 v58, 1024, v7
    s_add_u32 s4, s4, 114688
    s_lshl_b32 s5, s3, 11
    s_add_u32 s11, s5, s15
    s_add_u32 s5, s5, 127360
    s_cmp_lt_u32 s2, 216
    s_cselect_b32 s9, 0, 106496
    s_sub_u32 s4, s4, s9
    s_sub_u32 s5, s5, s9
    s_mov_b32 m0, s4
    s_mov_b32 s58, 2359296
    s_mov_b32 s59, 0x20000
    s_mov_b32 s50, 2359296
    s_mov_b32 s51, 0x20000
    s_mov_b32 s54, 2359296
    s_mov_b32 s55, 0x20000
    s_mov_b32 s62, 4608
    s_mov_b32 s63, 0x20000
    v_lshlrev_b32 v59, 3, v0
    s_movk_i32 s10, 4096
    v_lshlrev_b32 v91, 3, v2
    v_or_b32 v22, s2, v0
    v_lshlrev_b32 v22, 8, v22
    s_mov_b32 s66, 256
    s_mov_b32 s67, 0x20000
    s_waitcnt lgkmcnt(0)
    buffer_load_dwordx3 v[8:10], v5, s[56:59], s15 offen offset:0
    buffer_load_dwordx3 v[12:14], v5, s[56:59], s15 offen offset:384
    buffer_load_dwordx3 v[16:18], v5, s[56:59], s15 offen offset:768
    s_mov_b32 s64, s40
    s_and_b32 s65, s41, 0xffff
    s_or_b32 s12, s12, 1
    v_mov_b32 v23, s12
    buffer_store_dword v23, v22, s[64:67], 0 offen sc1
    buffer_load_dwordx4 v7, s[48:51], 0 offen lds
    s_add_u32 m0, s4, 1024
    s_cmp_eq_u32 s3, 3
    buffer_load_dwordx4 v58, s[48:51], 0 offen lds
    buffer_load_dwordx4 v58, s[48:51], 0 offen offset:1024 lds
    s_cbranch_scc1 L_xld
L_nox:
    s_mov_b32 m0, s5
    buffer_load_dwordx2 v[98:99], v59, s[60:63], 0 offen
    buffer_load_dwordx4 v6, s[52:55], s11 offen lds
    buffer_load_dwordx4 v6, s[52:55], s11 offen offset:1024 lds
    buffer_load_dwordx2 v[100:101], v59, s[60:63], 0 offen offset:2048
    buffer_load_dwordx2 v[102:103], v59, s[60:63], s10 offen
    s_mov_b32 s44, s42
    s_and_b32 s45, s43, 0xffff
    s_mov_b32 s46, 57606144
    s_mov_b32 s47, 0x20000
    s_and_b32 s5, s2, 7
    s_lshr_b32 s6, s2, 3
    s_lshr_b32 s7, s6, 2
    s_lshr_b32 s8, s3, 1
    s_lshl1_add_u32 s9, s7, s8
    s_cmp_ge_u32 s9, 10
    s_addc_u32 s14, s9, 0
    s_cmp_ge_u32 s9, 3
    s_addc_u32 s14, s14, 0
    s_lshl3_add_u32 s8, s8, 3
    s_cmp_eq_u32 s7, 7
    s_cselect_b32 s14, s8, s14
    s_and_b32 s4, s5, 1
    s_lshl4_add_u32 s71, s4, s14
    s_lshr_b32 s13, s5, 1
    s_mov_b32 s72, s13
    s_and_b32 s101, s6, 3
    s_lshl_b32 s73, s3, 12
    s_mov_b32 s52, s34
    s_and_b32 s53, s35, 0xffff
    s_mov_b32 s54, 18874368
    s_mov_b32 s55, 0x20000
    s_cmp_lt_u32 s6, 27
    s_cbranch_scc0 L_aux
    s_branch L_org
L_exit:
    s_endpgm
L_xld:
    s_mov_b64 exec, 0xffffff
    buffer_load_dwordx4 v58, s[48:51], 0 offen offset:2048 lds
    s_mov_b64 exec, -1
    s_mov_b32 m0, s5
    s_nop 0
    buffer_load_dwordx4 v6, s[52:55], s11 offen offset:2048 lds
    s_branch L_nox
L_nw_G:
    s_mov_b32 s5, 0
L_nl_G:
    buffer_load_dword v45, v54, s[64:67], 0 offen sc1
    s_waitcnt vmcnt(0)
    v_readfirstlane_b32 s68, v45
    s_nop 1
    s_cmp_lg_u32 s68, 0
    s_cbranch_scc1 L_ng_G
    s_add_u32 s5, s5, 1
    s_cmp_lt_u32 s5, 100000
    s_cbranch_scc1 L_nl_G
    s_branch L_ng_G
L_rs_p1G:
    s_mov_b32 s5, 0
L_rt_p1G:
    s_mov_b64 exec, vcc
    v_mov_b32 v29, 0
    buffer_atomic_add v29, v28, s[44:47], 0 offen sc0 sc1
    s_waitcnt vmcnt(0)
    v_cmp_ne_u32 vcc, v12, v29
    s_cbranch_vccz L_rx_p1G
    s_add_u32 s5, s5, 1
    s_cmp_lt_u32 s5, 100000
    s_cbranch_scc1 L_rt_p1G
L_rx_p1G:
    s_mov_b64 exec, -1
    s_branch L_ok_p1G
L_rs_p5:
    s_mov_b32 s5, 0
L_rt_p5:
    s_mov_b64 exec, vcc
    buffer_load_dword v29, v28, s[44:47], 0 offen sc1
    s_waitcnt vmcnt(0)
    v_cmp_ne_u32 vcc, s68, v29
    s_cbranch_vccz L_rx_p5
    s_add_u32 s5, s5, 1
    s_cmp_lt_u32 s5, 100000
    s_cbranch_scc1 L_rt_p5
L_rx_p5:
    s_mov_b64 exec, -1
    s_branch L_ok_p5
L_nw_X:
    s_mov_b32 s5, 0
L_nl_X:
    buffer_load_dword v45, v54, s[64:67], 0 offen sc1
    s_waitcnt vmcnt(0)
    v_readfirstlane_b32 s68, v45
    s_nop 1
    s_cmp_lg_u32 s68, 0
    s_cbranch_scc1 L_ng_X
    s_add_u32 s5, s5, 1
    s_cmp_lt_u32 s5, 100000
    s_cbranch_scc1 L_nl_X
    s_branch L_ng_X
L_rs_p1X:
    s_mov_b32 s5, 0
L_rt_p1X:
    s_mov_b64 exec, vcc
    v_mov_b32 v29, 0
    buffer_atomic_add v29, v28, s[44:47], 0 offen sc0 sc1
    s_waitcnt vmcnt(0)
    v_cmp_ne_u32 vcc, s68, v29
    s_cbranch_vccz L_rx_p1X
    s_add_u32 s5, s5, 1
    s_cmp_lt_u32 s5, 100000
    s_cbranch_scc1 L_rt_p1X
L_rx_p1X:
    s_mov_b64 exec, -1
    s_branch L_ok_p1X
L_rs_p2G:
    s_mov_b32 s5, 0
L_rt_p2G:
    s_mov_b64 exec, vcc
    v_mov_b32 v16, 0
    buffer_atomic_add v16, v15, s[44:47], 0 offen sc0 sc1
    s_waitcnt vmcnt(0)
    v_cmp_ne_u32 vcc, v13, v16
    s_cbranch_vccz L_rx_p2G
    s_add_u32 s5, s5, 1
    s_cmp_lt_u32 s5, 100000
    s_cbranch_scc1 L_rt_p2G
L_rx_p2G:
    s_mov_b64 exec, -1
    s_branch L_ok_p2G
L_xs_a:
    s_mov_b32 s5, 0
L_xt_a:
    buffer_load_dwordx4 v[40:43], v136, s[44:47], s34 offen offset:0 sc1
    buffer_load_dwordx4 v[44:47], v136, s[44:47], s34 offen offset:1024 sc1
    buffer_load_dwordx4 v[48:51], v136, s[44:47], s34 offen offset:2048 sc1
    s_waitcnt vmcnt(0)
    v_bitop3_b32 v43, v43, v47, s68 bitop3:0x7e
    v_bitop3_b32 v43, v43, v51, s68 bitop3:0xf6
    v_cmp_ne_u32 vcc, 0, v43
    s_cbranch_vccz L_xo_a
    s_add_u32 s5, s5, 1
    s_cmp_lt_u32 s5, 100000
    s_cbranch_scc1 L_xt_a
    s_branch L_xo_a
L_as_b:
    s_mov_b32 s5, 0
L_at_b:
    v_mov_b32 v141, 0
    buffer_atomic_add v141, v139, s[44:47], s11 offen offset:2060 sc0 sc1
    s_waitcnt vmcnt(0)
    v_cmp_ne_u32 vcc, v140, v141
    s_cbranch_vccz L_ao_b
    s_add_u32 s5, s5, 1
    s_cmp_lt_u32 s5, 100000
    s_cbranch_scc1 L_at_b
    s_branch L_ao_b
L_xs_b:
    s_mov_b32 s5, 0
L_xt_b:
    buffer_load_dwordx4 v[56:59], v136, s[44:47], s11 offen offset:0 sc1
    buffer_load_dwordx4 v[60:63], v136, s[44:47], s11 offen offset:1024 sc1
    buffer_load_dwordx4 v[64:67], v136, s[44:47], s11 offen offset:2048 sc1
    s_waitcnt vmcnt(0)
    v_bitop3_b32 v59, v59, v63, s68 bitop3:0x7e
    v_bitop3_b32 v59, v59, v67, s68 bitop3:0xf6
    v_cmp_ne_u32 vcc, 0, v59
    s_cbranch_vccz L_xo_b
    s_add_u32 s5, s5, 1
    s_cmp_lt_u32 s5, 100000
    s_cbranch_scc1 L_xt_b
    s_branch L_xo_b
L_xs_z:
    s_mov_b32 s5, 0
L_xt_z:
    buffer_load_dwordx4 v[72:75], v136, s[44:47], s12 offen offset:0 sc1
    buffer_load_dwordx4 v[76:79], v136, s[44:47], s12 offen offset:1024 sc1
    buffer_load_dwordx4 v[80:83], v136, s[44:47], s12 offen offset:2048 sc1
    s_waitcnt vmcnt(0)
    v_bitop3_b32 v75, v75, v79, s68 bitop3:0x7e
    v_bitop3_b32 v75, v75, v83, s68 bitop3:0xf6
    v_cmp_ne_u32 vcc, 0, v75
    s_cbranch_vccz L_xo_z
    s_add_u32 s5, s5, 1
    s_cmp_lt_u32 s5, 100000
    s_cbranch_scc1 L_xt_z
    s_branch L_xo_z
L_rs_p3:
    s_mov_b32 s5, 0
L_rt_p3:
    s_mov_b64 exec, vcc
    buffer_load_dword v189, v188, s[44:47], 0 offen sc1
    s_waitcnt vmcnt(0)
    v_cmp_ne_u32 vcc, s68, v189
    s_cbranch_vccz L_rx_p3
    s_add_u32 s5, s5, 1
    s_cmp_lt_u32 s5, 100000
    s_cbranch_scc1 L_rt_p3
L_rx_p3:
    s_mov_b64 exec, -1
    s_branch L_ok_p3
L_xs_8:
    s_mov_b32 s5, 0
L_xt_8:
    buffer_load_dwordx4 v[204:207], v136, s[44:47], s35 offen offset:0 sc1
    buffer_load_dwordx4 v[208:211], v136, s[44:47], s35 offen offset:1024 sc1
    buffer_load_dwordx4 v[212:215], v136, s[44:47], s35 offen offset:2048 sc1
    buffer_load_dwordx4 v[216:219], v136, s[44:47], s35 offen offset:3072 sc1
    s_waitcnt vmcnt(0)
    v_bitop3_b32 v207, v207, v211, s36 bitop3:0x7e
    v_bitop3_b32 v207, v207, v215, s36 bitop3:0xf6
    v_bitop3_b32 v207, v207, v219, s36 bitop3:0xf6
    v_cmp_ne_u32 vcc, 0, v207
    s_cbranch_vccz L_xo_8
    s_add_u32 s5, s5, 1
    s_cmp_lt_u32 s5, 100000
    s_cbranch_scc1 L_xt_8
    s_branch L_xo_8
L_rs_p2X:
    s_mov_b32 s5, 0
L_rt_p2X:
    s_mov_b64 exec, vcc
    v_mov_b32 v29, 0
    buffer_atomic_add v29, v28, s[44:47], 0 offen sc0 sc1
    s_waitcnt vmcnt(0)
    v_cmp_ne_u32 vcc, v13, v29
    s_cbranch_vccz L_rx_p2X
    s_add_u32 s5, s5, 1
    s_cmp_lt_u32 s5, 100000
    s_cbranch_scc1 L_rt_p2X
L_rx_p2X:
    s_mov_b64 exec, -1
    s_branch L_ok_p2X
L_wc_G:
    s_cmp_eq_u32 s3, 0
    s_cbranch_scc1 L_pl_G_0
    s_cmp_eq_u32 s3, 1
    s_cbranch_scc1 L_pl_G_1
    s_cmp_eq_u32 s3, 2
    s_cbranch_scc1 L_pl_G_2
    s_branch L_pl_G_3
L_wc_X:
    s_cmp_eq_u32 s3, 0
    s_cbranch_scc1 L_pl_X_0
    s_cmp_eq_u32 s3, 1
    s_cbranch_scc1 L_pl_X_1
    s_cmp_eq_u32 s3, 2
    s_cbranch_scc1 L_pl_X_2
    s_branch L_pl_X_3
L_wc_D:
    s_cmp_eq_u32 s3, 0
    s_cbranch_scc1 L_pl_D_0
    s_cmp_eq_u32 s3, 1
    s_cbranch_scc1 L_pl_D_1
    s_cmp_eq_u32 s3, 2
    s_cbranch_scc1 L_pl_D_2
    s_branch L_wret
L_wret:
    s_setpc_b64 s[82:83]
.p2align 12
L_org:
    s_mul_i32 s7, s6, 21846
    s_lshr_b32 s7, s7, 16
    s_mul_i32 s8, s7, 3
    s_sub_u32 s12, s6, s8
    s_mul_i32 s8, s13, 9
    s_add_u32 s69, s8, s7
    s_lshl1_add_u32 s70, s12, s4
    s_mul_i32 s8, s69, 6
    s_add_u32 s75, s8, s70
    s_mov_b32 s48, s30
    s_and_b32 s49, s31, 0xffff
    s_mov_b32 s50, 18874368
    s_mov_b32 s51, 0x20000
    s_add_u32 s12, s12, s7
    s_mul_i32 s8, s12, 21846
    s_lshr_b32 s8, s8, 16
    s_mul_i32 s8, s8, 3
    s_sub_u32 s12, s12, s8
    s_mul_i32 s4, s4, 1179648
    s_mul_i32 s7, s12, 65538
    s_lshr_b32 s7, s7, 16
    s_mul_i32 s7, s7, 73728
    s_add_u32 s5, s4, 0
    s_add_u32 s18, s7, s5
    s_add_u32 s8, s5, 221184
    s_add_u32 s19, s18, 73728
    s_cmp_eq_u32 s19, s8
    s_cselect_b32 s19, s5, s19
    s_add_u32 s20, s19, 73728
    s_cmp_eq_u32 s20, s8
    s_cselect_b32 s20, s5, s20
    s_mul_i32 s7, s12, 65538
    s_lshr_b32 s7, s7, 16
    s_mul_i32 s7, s7, 73728
    s_add_u32 s5, s4, 221184
    s_add_u32 s21, s7, s5
    s_add_u32 s8, s5, 221184
    s_add_u32 s22, s21, 73728
    s_cmp_eq_u32 s22, s8
    s_cselect_b32 s22, s5, s22
    s_add_u32 s23, s22, 73728
    s_cmp_eq_u32 s23, s8
    s_cselect_b32 s23, s5, s23
    s_mul_i32 s7, s12, 87384
    s_lshr_b32 s7, s7, 16
    s_mul_i32 s7, s7, 73728
    s_add_u32 s5, s4, 442368
    s_add_u32 s24, s7, s5
    s_add_u32 s8, s5, 294912
    s_add_u32 s25, s24, 73728
    s_cmp_eq_u32 s25, s8
    s_cselect_b32 s25, s5, s25
    s_add_u32 s26, s25, 73728
    s_cmp_eq_u32 s26, s8
    s_cselect_b32 s26, s5, s26
    s_add_u32 s27, s26, 73728
    s_cmp_eq_u32 s27, s8
    s_cselect_b32 s27, s5, s27
    s_mul_i32 s7, s12, 131076
    s_lshr_b32 s7, s7, 16
    s_mul_i32 s7, s7, 73728
    s_add_u32 s5, s4, 737280
    s_add_u32 s76, s7, s5
    s_add_u32 s8, s5, 442368
    s_add_u32 s77, s76, 73728
    s_cmp_eq_u32 s77, s8
    s_cselect_b32 s77, s5, s77
    s_add_u32 s78, s77, 73728
    s_cmp_eq_u32 s78, s8
    s_cselect_b32 s78, s5, s78
    s_add_u32 s79, s78, 73728
    s_cmp_eq_u32 s79, s8
    s_cselect_b32 s79, s5, s79
    s_add_u32 s80, s79, 73728
    s_cmp_eq_u32 s80, s8
    s_cselect_b32 s80, s5, s80
    s_add_u32 s81, s80, 73728
    s_cmp_eq_u32 s81, s8
    s_cselect_b32 s81, s5, s81
    v_lshrrev_b32 v24, 4, v2
    v_and_b32 v25, 15, v2
    v_lshlrev_b32 v26, 1, v24
    v_xor_b32 v25, v25, v26
    v_mul_u32_u24 v24, 9216, v24
    v_lshl_add_u32 v24, v25, 4, v24
    s_mul_i32 s7, s3, 147456
    s_lshl_b32 s8, s69, 8
    s_add_u32 s7, s7, s8
    v_add_u32 v148, s7, v24
    v_add_u32 v149, 35840, v148
    v_xor_b32 v24, 128, v148
    v_add_u32 v150, 71680, v24
    v_add_u32 v151, 35840, v150
    s_mov_b32 s9, 144896
    s_mov_b32 s11, 114688
    v_mul_u32_u24 v48, 1216, v3
    v_mad_u32_u24 v48, v4, 12, v48
    v_add_u32 v48, s9, v48
    v_mov_b32 v47, 0x40000000
    v_lshlrev_b32 v3, 3, v3
    s_lshl_b32 s5, s68, 6
    s_add_u32 s5, s5, 12386304
    v_cmp_eq_u32 vcc, 0, v4
    s_nop 1
    v_cndmask_b32 v49, v47, v3, vcc
    v_lshrrev_b32 v5, 4, v0
    v_and_b32 v4, 3, v2
    v_lshlrev_b32 v4, 3, v4
    v_lshl_add_u32 v5, v5, 5, v4
    v_bfe_u32 v6, v2, 2, 2
    v_mul_u32_u24 v4, 1216, v6
    v_mul_u32_u24 v6, 1152, v6
    v_add3_u32 v50, v4, v5, s9
    v_add3_u32 v51, v6, v5, s11
    s_mul_i32 s4, s3, 2176
    v_add_u32 v55, s4, v51
    v_lshlrev_b32 v52, 4, v0
    s_add_u32 s7, s15, 4096
    s_add_u32 s8, s15, 8192
    s_cmp_eq_u32 s3, 0
    s_cselect_b32 s8, s8, 0x40000000
    v_add_u32 v53, 2359296, v52
    v_mov_b32 v54, 0
    s_mul_i32 s4, s3, 1028
    s_sub_u32 s4, 8204, s4
    v_add_u32 v90, s4, v53
    s_bfe_u32 s6, s68, 0x20001
    s_lshl_b32 s6, s6, 6
    s_lshr_b32 s9, s68, 3
    s_lshl1_add_u32 s6, s9, s6
    s_and_b32 s9, s68, 1
    s_add_u32 s6, s6, s9
    s_lshl_b32 s4, s6, 2
    s_add_u32 s4, s4, 12533760
    v_lshl_add_u32 v1, v0, 10, s4
    s_lshl_b32 s4, s68, 2
    s_add_u32 s4, s4, 12599296
    v_lshl_add_u32 v46, v0, 10, s4
    v_cmp_gt_u32 vcc, 8, v0
    s_nop 1
    v_cndmask_b32 v1, v47, v1, vcc
    v_cmp_gt_u32 vcc, 4, v0
    s_nop 1
    v_cndmask_b32 v46, v47, v46, vcc
    s_waitcnt vmcnt(9)
    v_and_b32 v21, 0xffff0000, v8
    s_add_u32 m0, s73, 81920
    s_lshl_b32 s14, s18, 3
    buffer_load_dwordx4 v148, s[48:51], s14 offen offset:0 lds
    v_lshlrev_b32 v20, 16, v8
    v_and_b32 v23, 0xffff0000, v9
    v_lshlrev_b32 v22, 16, v9
    v_and_b32 v25, 0xffff0000, v10
    v_lshlrev_b32 v24, 16, v10
    v_and_b32 v27, 0xffff0000, v12
    v_lshlrev_b32 v26, 16, v12
    v_and_b32 v29, 0xffff0000, v13
    v_lshlrev_b32 v28, 16, v13
    v_and_b32 v31, 0xffff0000, v14
    v_lshlrev_b32 v30, 16, v14
    v_and_b32 v33, 0xffff0000, v16
    v_lshlrev_b32 v32, 16, v16
    v_and_b32 v35, 0xffff0000, v17
    v_lshlrev_b32 v34, 16, v17
    v_and_b32 v37, 0xffff0000, v18
    v_lshlrev_b32 v36, 16, v18
    v_pk_add_f32 v[38:39], v[20:21], v[22:23]
    v_pk_add_f32 v[40:41], v[24:25], v[26:27]
    v_pk_add_f32 v[42:43], v[28:29], v[30:31]
    v_pk_add_f32 v[44:45], v[32:33], v[34:35]
    v_pk_add_f32 v[38:39], v[38:39], v[40:41]
    v_pk_add_f32 v[42:43], v[42:43], v[44:45]
    v_pk_add_f32 v[38:39], v[38:39], v[36:37]
    v_pk_add_f32 v[38:39], v[38:39], v[42:43]
    v_add_f32 v56, v38, v39
    buffer_load_dwordx4 v149, s[48:51], s14 offen offset:1024 lds
    s_nop 0
    v_add_f32_dpp v56, v56, v56 row_ror:8 row_mask:0xf bank_mask:0xf
    s_nop 1
    v_add_f32_dpp v56, v56, v56 row_ror:4 row_mask:0xf bank_mask:0xf
    s_nop 1
    v_add_f32_dpp v56, v56, v56 row_ror:2 row_mask:0xf bank_mask:0xf
    s_nop 1
    v_add_f32_dpp v56, v56, v56 row_ror:1 row_mask:0xf bank_mask:0xf
    v_mov_b32 v57, v56
    s_nop 1
    v_permlane16_swap_b32 v56, v57
    v_add_f32 v56, v56, v57
    v_mul_f32 v56, 0x3ae38e39, v56
    v_pk_add_f32 v[20:21], v[20:21], v[56:57] op_sel_hi:[1,0] neg_lo:[0,1] neg_hi:[0,1]
    v_pk_add_f32 v[22:23], v[22:23], v[56:57] op_sel_hi:[1,0] neg_lo:[0,1] neg_hi:[0,1]
    v_pk_add_f32 v[24:25], v[24:25], v[56:57] op_sel_hi:[1,0] neg_lo:[0,1] neg_hi:[0,1]
    v_pk_add_f32 v[26:27], v[26:27], v[56:57] op_sel_hi:[1,0] neg_lo:[0,1] neg_hi:[0,1]
    v_pk_add_f32 v[28:29], v[28:29], v[56:57] op_sel_hi:[1,0] neg_lo:[0,1] neg_hi:[0,1]
    v_pk_add_f32 v[30:31], v[30:31], v[56:57] op_sel_hi:[1,0] neg_lo:[0,1] neg_hi:[0,1]
    v_pk_add_f32 v[32:33], v[32:33], v[56:57] op_sel_hi:[1,0] neg_lo:[0,1] neg_hi:[0,1]
    v_pk_add_f32 v[34:35], v[34:35], v[56:57] op_sel_hi:[1,0] neg_lo:[0,1] neg_hi:[0,1]
    v_pk_add_f32 v[36:37], v[36:37], v[56:57] op_sel_hi:[1,0] neg_lo:[0,1] neg_hi:[0,1]
    v_pk_mul_f32 v[38:39], v[20:21], v[20:21]
    v_pk_mul_f32 v[40:41], v[22:23], v[22:23]
    v_pk_fma_f32 v[38:39], v[24:25], v[24:25], v[38:39]
    v_pk_fma_f32 v[40:41], v[26:27], v[26:27], v[40:41]
    v_pk_fma_f32 v[38:39], v[28:29], v[28:29], v[38:39]
    v_pk_fma_f32 v[40:41], v[30:31], v[30:31], v[40:41]
    v_pk_fma_f32 v[38:39], v[32:33], v[32:33], v[38:39]
    v_pk_fma_f32 v[40:41], v[34:35], v[34:35], v[40:41]
    v_pk_fma_f32 v[38:39], v[36:37], v[36:37], v[38:39]
    buffer_load_dwordx4 v150, s[48:51], s14 offen offset:2048 lds
    v_pk_add_f32 v[38:39], v[38:39], v[40:41]
    v_add_f32 v18, v38, v39
    s_nop 1
    v_add_f32_dpp v18, v18, v18 row_ror:8 row_mask:0xf bank_mask:0xf
    s_nop 1
    v_add_f32_dpp v18, v18, v18 row_ror:4 row_mask:0xf bank_mask:0xf
    s_nop 1
    v_add_f32_dpp v18, v18, v18 row_ror:2 row_mask:0xf bank_mask:0xf
    s_nop 1
    v_add_f32_dpp v18, v18, v18 row_ror:1 row_mask:0xf bank_mask:0xf
    v_mov_b32 v19, v18
    s_nop 1
    v_permlane16_swap_b32 v18, v19
    v_add_f32 v18, v18, v19
    v_mul_f32 v18, 0x3ae38e39, v18
    v_cvt_pk_bf16_f32 v38, v56, v18
    v_lshlrev_b32 v106, 16, v38
    v_and_b32 v38, 0xffff0000, v38
    v_add_f32 v38, 0x3727c5ac, v38
    v_sub_f32 v56, v56, v106
    v_cvt_pk_bf16_f32 v38, v38, v38
    v_lshlrev_b32 v38, 16, v38
    v_sqrt_f32 v38, v38
    s_nop 0
    v_cvt_pk_bf16_f32 v38, v38, v38
    v_lshlrev_b32 v38, 16, v38
    v_rcp_f32 v107, v38
    s_nop 0
    v_mul_f32 v56, v56, v107
    v_mul_f32 v18, v18, v107
    v_mul_f32 v18, v18, v107
    v_cvt_pk_bf16_f32 v38, v56, v18
    v_lshlrev_b32 v39, 16, v38
    buffer_load_dwordx4 v151, s[48:51], s14 offen offset:3072 lds
    v_and_b32 v38, 0xffff0000, v38
    v_add_f32 v38, 0x3727c5ac, v38
    v_sub_f32 v56, v56, v39
    v_cvt_pk_bf16_f32 v38, v38, v38
    v_lshlrev_b32 v38, 16, v38
    v_sqrt_f32 v38, v38
    s_nop 0
    v_cvt_pk_bf16_f32 v38, v38, v38
    v_lshlrev_b32 v38, 16, v38
    v_rcp_f32 v38, v38
    s_nop 0
    v_mul_f32 v18, v107, v38
    v_mul_f32 v56, v56, v38
    v_pk_fma_f32 v[20:21], v[20:21], v[18:19], v[56:57] op_sel_hi:[1,0,0]
    v_pk_fma_f32 v[22:23], v[22:23], v[18:19], v[56:57] op_sel_hi:[1,0,0]
    v_pk_fma_f32 v[24:25], v[24:25], v[18:19], v[56:57] op_sel_hi:[1,0,0]
    v_pk_fma_f32 v[26:27], v[26:27], v[18:19], v[56:57] op_sel_hi:[1,0,0]
    v_pk_fma_f32 v[28:29], v[28:29], v[18:19], v[56:57] op_sel_hi:[1,0,0]
    v_pk_fma_f32 v[30:31], v[30:31], v[18:19], v[56:57] op_sel_hi:[1,0,0]
    v_pk_fma_f32 v[32:33], v[32:33], v[18:19], v[56:57] op_sel_hi:[1,0,0]
    v_pk_fma_f32 v[34:35], v[34:35], v[18:19], v[56:57] op_sel_hi:[1,0,0]
    v_pk_fma_f32 v[36:37], v[36:37], v[18:19], v[56:57] op_sel_hi:[1,0,0]
    v_cvt_pk_bf16_f32 v8, v20, v21
    v_cvt_pk_bf16_f32 v9, v22, v23
    v_cvt_pk_bf16_f32 v10, v24, v25
    v_cvt_pk_bf16_f32 v11, v26, v27
    v_cvt_pk_bf16_f32 v12, v28, v29
    v_cvt_pk_bf16_f32 v13, v30, v31
    v_cvt_pk_bf16_f32 v14, v32, v33
    v_cvt_pk_bf16_f32 v15, v34, v35
    v_cvt_pk_bf16_f32 v16, v36, v37
    ds_write_b32 v48, v8 offset:0
    ds_write_b32 v48, v9 offset:4
    ds_write_b32 v48, v10 offset:8
    ds_write_b32 v48, v11 offset:384
    ds_write_b32 v48, v12 offset:388
    ds_write_b32 v48, v13 offset:392
    ds_write_b32 v48, v14 offset:768
    ds_write_b32 v48, v15 offset:772
    ds_write_b32 v48, v16 offset:776
    buffer_store_dwordx2 v[106:107], v49, s[44:47], s5 offen sc1
    s_waitcnt lgkmcnt(0)
    s_barrier
    ds_read_b64_tr_b16 v[20:21], v50 offset:0
    ds_read_b64_tr_b16 v[22:23], v50 offset:4864
    ds_read_b64_tr_b16 v[24:25], v50 offset:512
    ds_read_b64_tr_b16 v[26:27], v50 offset:5376
    ds_read_b64_tr_b16 v[28:29], v50 offset:1024
    ds_read_b64_tr_b16 v[30:31], v50 offset:5888
    s_waitcnt lgkmcnt(4)
    buffer_store_dwordx4 v[20:23], v52, s[44:47], s15 offen sc1
    s_waitcnt lgkmcnt(2)
    buffer_store_dwordx4 v[24:27], v52, s[44:47], s7 offen sc1
    s_waitcnt lgkmcnt(0)
    buffer_store_dwordx4 v[28:31], v52, s[44:47], s8 offen sc1
    buffer_load_dword v45, v54, s[64:67], 0 offen sc1
    s_waitcnt vmcnt(9)
    s_barrier
    ds_read_b64_tr_b16 v[60:61], v51 offset:0
    ds_read_b64_tr_b16 v[62:63], v51 offset:4608
    ds_read_b64_tr_b16 v[64:65], v51 offset:9216
    ds_read_b64_tr_b16 v[66:67], v51 offset:12672
    ds_read_b64_tr_b16 v[68:69], v51 offset:17280
    ds_read_b64_tr_b16 v[70:71], v51 offset:512
    ds_read_b64_tr_b16 v[72:73], v51 offset:5120
    ds_read_b64_tr_b16 v[74:75], v51 offset:9728
    ds_read_b64_tr_b16 v[76:77], v51 offset:13184
    ds_read_b64_tr_b16 v[78:79], v51 offset:17792
    v_alignbit_b32 v114, v99, v99, 16
    v_alignbit_b32 v115, v98, v98, 16
    s_waitcnt lgkmcnt(5)
    v_alignbit_b32 v108, v61, v60, 16
    v_alignbit_b32 v109, v62, v61, 16
    v_alignbit_b32 v110, v63, v62, 16
    v_alignbit_b32 v111, v64, v63, 16
    v_alignbit_b32 v112, v65, v64, 16
    v_dot2_f32_bf16 v116, v60, v114, 0
    ds_read_b64_tr_b16 v[80:81], v51 offset:1024
    v_dot2_f32_bf16 v117, v108, v114, 0
    v_dot2_f32_bf16 v118, v61, v114, 0
    v_dot2_f32_bf16 v119, v109, v114, 0
    v_dot2_f32_bf16 v120, v62, v114, 0
    ds_read_b64_tr_b16 v[82:83], v51 offset:5632
    v_dot2_f32_bf16 v121, v110, v114, 0
    v_dot2_f32_bf16 v122, v63, v114, 0
    v_dot2_f32_bf16 v123, v111, v114, 0
    v_dot2_f32_bf16 v116, v61, v115, v116
    v_dot2_f32_bf16 v117, v109, v115, v117
    ds_read_b64_tr_b16 v[84:85], v51 offset:10240
    v_dot2_f32_bf16 v118, v62, v115, v118
    v_dot2_f32_bf16 v119, v110, v115, v119
    v_dot2_f32_bf16 v120, v63, v115, v120
    v_dot2_f32_bf16 v121, v111, v115, v121
    v_dot2_f32_bf16 v122, v64, v115, v122
    ds_read_b64_tr_b16 v[86:87], v51 offset:13696
    v_dot2_f32_bf16 v123, v112, v115, v123
    v_and_b32 v133, 0xffff0000, v66
    v_lshlrev_b32 v132, 16, v66
    v_and_b32 v135, 0xffff0000, v67
    v_lshlrev_b32 v134, 16, v67
    ds_read_b64_tr_b16 v[88:89], v51 offset:18304
    v_and_b32 v137, 0xffff0000, v68
    v_lshlrev_b32 v136, 16, v68
    v_and_b32 v139, 0xffff0000, v69
    v_lshlrev_b32 v138, 16, v69
    v_pk_mul_f32 v[116:117], v[116:117], v[132:133]
    v_pk_mul_f32 v[118:119], v[118:119], v[134:135]
    v_pk_mul_f32 v[120:121], v[120:121], v[136:137]
    v_pk_mul_f32 v[122:123], v[122:123], v[138:139]
    v_cvt_pk_bf16_f32 v160, v123, v122
    v_cvt_pk_bf16_f32 v161, v121, v120
    v_cvt_pk_bf16_f32 v162, v119, v118
    v_cvt_pk_bf16_f32 v163, v117, v116
    buffer_store_dwordx4 v[160:163], v53, s[44:47], s15 offen sc1
    v_alignbit_b32 v114, v101, v101, 16
    v_alignbit_b32 v115, v100, v100, 16
    s_waitcnt lgkmcnt(5)
    v_alignbit_b32 v108, v71, v70, 16
    v_alignbit_b32 v109, v72, v71, 16
    v_alignbit_b32 v110, v73, v72, 16
    v_alignbit_b32 v111, v74, v73, 16
    v_alignbit_b32 v112, v75, v74, 16
    v_dot2_f32_bf16 v124, v70, v114, 0
    v_dot2_f32_bf16 v125, v108, v114, 0
    v_dot2_f32_bf16 v126, v71, v114, 0
    v_dot2_f32_bf16 v127, v109, v114, 0
    v_dot2_f32_bf16 v128, v72, v114, 0
    v_dot2_f32_bf16 v129, v110, v114, 0
    v_dot2_f32_bf16 v130, v73, v114, 0
    v_dot2_f32_bf16 v131, v111, v114, 0
    v_dot2_f32_bf16 v124, v71, v115, v124
    v_dot2_f32_bf16 v125, v109, v115, v125
    v_dot2_f32_bf16 v126, v72, v115, v126
    v_dot2_f32_bf16 v127, v110, v115, v127
    v_dot2_f32_bf16 v128, v73, v115, v128
    v_dot2_f32_bf16 v129, v111, v115, v129
    v_dot2_f32_bf16 v130, v74, v115, v130
    v_dot2_f32_bf16 v131, v112, v115, v131
    v_and_b32 v133, 0xffff0000, v76
    v_lshlrev_b32 v132, 16, v76
    v_and_b32 v135, 0xffff0000, v77
    v_lshlrev_b32 v134, 16, v77
    v_and_b32 v137, 0xffff0000, v78
    v_lshlrev_b32 v136, 16, v78
    v_and_b32 v139, 0xffff0000, v79
    v_lshlrev_b32 v138, 16, v79
    v_pk_mul_f32 v[124:125], v[124:125], v[132:133]
    v_pk_mul_f32 v[126:127], v[126:127], v[134:135]
    v_pk_mul_f32 v[128:129], v[128:129], v[136:137]
    v_pk_mul_f32 v[130:131], v[130:131], v[138:139]
    v_cvt_pk_bf16_f32 v164, v131, v130
    v_cvt_pk_bf16_f32 v165, v129, v128
    v_cvt_pk_bf16_f32 v166, v127, v126
    v_cvt_pk_bf16_f32 v167, v125, v124
    buffer_store_dwordx4 v[164:167], v53, s[44:47], s7 offen sc1
    v_alignbit_b32 v114, v103, v103, 16
    v_alignbit_b32 v115, v102, v102, 16
    s_waitcnt lgkmcnt(0)
    v_alignbit_b32 v108, v81, v80, 16
    v_alignbit_b32 v109, v82, v81, 16
    v_alignbit_b32 v110, v83, v82, 16
    v_alignbit_b32 v111, v84, v83, 16
    v_alignbit_b32 v112, v85, v84, 16
    v_dot2_f32_bf16 v116, v80, v114, 0
    v_dot2_f32_bf16 v117, v108, v114, 0
    v_dot2_f32_bf16 v118, v81, v114, 0
    v_dot2_f32_bf16 v119, v109, v114, 0
    v_dot2_f32_bf16 v120, v82, v114, 0
    v_dot2_f32_bf16 v121, v110, v114, 0
    v_dot2_f32_bf16 v122, v83, v114, 0
    v_dot2_f32_bf16 v123, v111, v114, 0
    v_dot2_f32_bf16 v116, v81, v115, v116
    v_dot2_f32_bf16 v117, v109, v115, v117
    v_dot2_f32_bf16 v118, v82, v115, v118
    v_dot2_f32_bf16 v119, v110, v115, v119
    v_dot2_f32_bf16 v120, v83, v115, v120
    v_dot2_f32_bf16 v121, v111, v115, v121
    v_dot2_f32_bf16 v122, v84, v115, v122
    v_dot2_f32_bf16 v123, v112, v115, v123
    v_and_b32 v133, 0xffff0000, v86
    v_lshlrev_b32 v132, 16, v86
    v_and_b32 v135, 0xffff0000, v87
    v_lshlrev_b32 v134, 16, v87
    v_and_b32 v137, 0xffff0000, v88
    v_lshlrev_b32 v136, 16, v88
    v_and_b32 v139, 0xffff0000, v89
    v_lshlrev_b32 v138, 16, v89
    v_pk_mul_f32 v[116:117], v[116:117], v[132:133]
    v_pk_mul_f32 v[118:119], v[118:119], v[134:135]
    v_pk_mul_f32 v[120:121], v[120:121], v[136:137]
    v_pk_mul_f32 v[122:123], v[122:123], v[138:139]
    v_cvt_pk_bf16_f32 v168, v123, v122
    v_cvt_pk_bf16_f32 v169, v121, v120
    v_cvt_pk_bf16_f32 v170, v119, v118
    v_cvt_pk_bf16_f32 v171, v117, v116
    buffer_store_dwordx4 v[168:171], v53, s[44:47], s8 offen sc1
    s_add_u32 m0, s73, 98304
    s_lshl_b32 s14, s19, 3
    buffer_load_dwordx4 v148, s[48:51], s14 offen offset:0 lds
    buffer_load_dwordx4 v149, s[48:51], s14 offen offset:1024 lds
    buffer_load_dwordx4 v150, s[48:51], s14 offen offset:2048 lds
    buffer_load_dwordx4 v151, s[48:51], s14 offen offset:3072 lds
    s_add_u32 m0, s73, 0
    s_lshl_b32 s14, s20, 3
    buffer_load_dwordx4 v148, s[48:51], s14 offen offset:0 lds
    buffer_load_dwordx4 v149, s[48:51], s14 offen offset:1024 lds
    buffer_load_dwordx4 v150, s[48:51], s14 offen offset:2048 lds
    buffer_load_dwordx4 v151, s[48:51], s14 offen offset:3072 lds
    s_add_u32 m0, s73, 16384
    s_lshl_b32 s14, s21, 3
    buffer_load_dwordx4 v148, s[48:51], s14 offen offset:0 lds
    buffer_load_dwordx4 v149, s[48:51], s14 offen offset:1024 lds
    s_waitcnt vmcnt(13)
    v_readfirstlane_b32 s68, v45
    s_nop 1
    s_cmp_eq_u32 s68, 0
    s_cbranch_scc1 L_nw_G
L_ng_G:
    s_barrier
    v_mov_b32 v3, s68
    buffer_store_dword v3, v1, s[44:47], 0 offen sc1
    s_mov_b64 exec, 0
    s_call_b64 s[82:83], L_wc_G
    s_mov_b64 exec, -1
    s_waitcnt vmcnt(11)
    s_barrier
    buffer_store_dword v3, v46, s[44:47], 0 offen sc1
L_segG:
L_pl_G_0:
    s_cbranch_execz L_pl_G_4
    buffer_load_dwordx4 v150, s[48:51], s14 offen offset:2048 lds
    buffer_load_dwordx4 v151, s[48:51], s14 offen offset:3072 lds
    s_add_u32 m0, s73, 32768
    s_lshl_b32 s14, s22, 3
    buffer_load_dwordx4 v148, s[48:51], s14 offen offset:0 lds
    buffer_load_dwordx4 v149, s[48:51], s14 offen offset:1024 lds
    buffer_load_dwordx4 v150, s[48:51], s14 offen offset:2048 lds
    buffer_load_dwordx4 v151, s[48:51], s14 offen offset:3072 lds
    s_add_u32 m0, s73, 49152
    s_lshl_b32 s14, s23, 3
    buffer_load_dwordx4 v148, s[48:51], s14 offen offset:0 lds
    buffer_load_dwordx4 v149, s[48:51], s14 offen offset:1024 lds
    buffer_load_dwordx4 v150, s[48:51], s14 offen offset:2048 lds
    buffer_load_dwordx4 v151, s[48:51], s14 offen offset:3072 lds
    s_add_u32 m0, s73, 65536
    s_lshl_b32 s14, s24, 3
    buffer_load_dwordx4 v148, s[48:51], s14 offen offset:0 lds
    buffer_load_dwordx4 v149, s[48:51], s14 offen offset:1024 lds
    buffer_load_dwordx4 v150, s[48:51], s14 offen offset:2048 lds
    buffer_load_dwordx4 v151, s[48:51], s14 offen offset:3072 lds
    v_bfe_u32 v140, v2, 2, 2
    v_lshrrev_b32 v141, 4, v2
    v_lshl_add_u32 v142, v141, 3, v140
    v_lshlrev_b32 v142, 8, v142
    v_and_b32 v143, 3, v2
    v_lshl_add_u32 v142, v143, 3, v142
    v_and_b32 v141, 1, v141
    v_lshl_add_u32 v140, v141, 2, v140
    s_lshl_b32 s7, s3, 1
    v_xor_b32 v140, s7, v140
    v_lshl_add_u32 v152, v140, 5, v142
    v_xor_b32 v153, 32, v152
    v_add_u32 v154, 0x10000, v152
    v_add_u32 v155, 0x10000, v153
    v_and_b32 v24, 15, v2
    v_lshrrev_b32 v25, 4, v2
    v_mul_u32_u24 v26, 17408, v25
    v_lshl_add_u32 v26, v24, 4, v26
    v_mul_u32_u24 v25, 1536, v25
    v_lshl_add_u32 v25, v24, 4, v25
    v_add_u32 v159, 81920, v25
    v_add_u32 v250, 36864, v159
    s_mul_i32 s7, s3, 18432
    s_xor_b32 s8, s70, 1
    s_mul_i32 s8, s8, 1536
    s_add_u32 s7, s7, s8
    v_lshlrev_b32 v246, 4, v2
    v_add_u32 v156, s7, v246
    v_lshrrev_b32 v25, 5, v2
    v_mul_u32_u24 v25, 7680, v25
    v_add_u32 v157, v156, v25
    v_add_u32 v158, 7680, v156
    s_mul_i32 s74, s3, 3072
    s_add_u32 s74, s74, 81920
    v_mov_b32 v245, v26
    s_mov_b64 exec, 0
    s_call_b64 s[82:83], L_wc_D
    s_mov_b64 exec, -1
    s_mov_b32 s56, s32
    s_and_b32 s57, s33, 0xffff
    s_mov_b32 s58, 9216
    s_mov_b32 s59, 0x20000
    s_mov_b32 s60, s36
    s_and_b32 s61, s37, 0xffff
    s_mov_b32 s62, 4096
    s_mov_b32 s63, 0x20000
    s_and_b32 s4, s70, 1
    s_lshl1_add_u32 s4, s3, s4
    s_lshl_b32 s4, s4, 7
    s_bfe_u32 s5, s2, 0x10003
    s_lshl1_add_u32 s5, s72, s5
    s_lshr_b32 s5, s5, 0
    s_lshl_b32 s5, s5, 10
    s_add_u32 s4, s4, s5
    s_add_u32 s4, s4, 12533760
    v_lshl_add_u32 v28, v2, 2, s4
    v_cmp_gt_u32 vcc, 32, v2
    v_mov_b32 v12, 0x40000000
    s_nop 0
    v_cndmask_b32 v28, v12, v28, vcc
    v_mov_b32 v12, s68
    v_cndmask_b32 v12, 0, v12, vcc
    v_lshrrev_b32 v24, 4, v2
    v_lshlrev_b32 v25, 3, v24
    s_lshl_b32 s7, s69, 8
    s_lshl_b32 s8, s3, 6
    s_add_u32 s7, s7, s8
    buffer_load_dwordx2 v[144:145], v25, s[56:59], s7 offen
    buffer_load_dwordx2 v[146:147], v25, s[56:59], s7 offen offset:32
    s_waitcnt vmcnt(24)
    s_barrier
    ds_read_b64_tr_b16 a[0:1], v154 offset:16384
    ds_read_b64_tr_b16 a[2:3], v154 offset:17408
    ds_read_b64_tr_b16 a[4:5], v155 offset:16384
    ds_read_b64_tr_b16 a[6:7], v155 offset:17408
    ds_read_b64_tr_b16 a[8:9], v154 offset:24576
    ds_read_b64_tr_b16 a[10:11], v154 offset:25600
    ds_read_b64_tr_b16 a[12:13], v155 offset:24576
    ds_read_b64_tr_b16 a[14:15], v155 offset:25600
    ds_read_b64_tr_b16 a[16:17], v154 offset:32768
    ds_read_b64_tr_b16 a[18:19], v154 offset:33792
    ds_read_b64_tr_b16 a[20:21], v155 offset:32768
    ds_read_b64_tr_b16 a[22:23], v155 offset:33792
    ds_read_b64_tr_b16 a[24:25], v154 offset:40960
    ds_read_b64_tr_b16 a[26:27], v154 offset:41984
    ds_read_b64_tr_b16 a[28:29], v155 offset:40960
    ds_read_b64_tr_b16 a[30:31], v155 offset:41984
    s_waitcnt vmcnt(20)
    s_barrier
    ds_read_b64_tr_b16 a[32:33], v152 offset:0
    ds_read_b64_tr_b16 a[34:35], v152 offset:1024
    ds_read_b64_tr_b16 a[36:37], v153 offset:0
    ds_read_b64_tr_b16 a[38:39], v153 offset:1024
    ds_read_b64_tr_b16 a[40:41], v152 offset:8192
    ds_read_b64_tr_b16 a[42:43], v152 offset:9216
    ds_read_b64_tr_b16 a[44:45], v153 offset:8192
    ds_read_b64_tr_b16 a[46:47], v153 offset:9216
    s_waitcnt vmcnt(14)
    s_barrier
    ds_read_b64_tr_b16 a[48:49], v152 offset:16384
    ds_read_b64_tr_b16 a[50:51], v152 offset:17408
    ds_read_b64_tr_b16 a[52:53], v153 offset:16384
    ds_read_b64_tr_b16 a[54:55], v153 offset:17408
    ds_read_b64_tr_b16 a[56:57], v152 offset:24576
    ds_read_b64_tr_b16 a[58:59], v152 offset:25600
    ds_read_b64_tr_b16 a[60:61], v153 offset:24576
    ds_read_b64_tr_b16 a[62:63], v153 offset:25600
    v_mov_b32 v29, 0
    buffer_atomic_add v29, v28, s[44:47], 0 offen sc0 sc1
    s_waitcnt vmcnt(11)
    s_barrier
    ds_read_b64_tr_b16 a[64:65], v152 offset:32768
    ds_read_b64_tr_b16 a[66:67], v152 offset:33792
    ds_read_b64_tr_b16 a[68:69], v153 offset:32768
    ds_read_b64_tr_b16 a[70:71], v153 offset:33792
    ds_read_b64_tr_b16 a[72:73], v152 offset:40960
    ds_read_b64_tr_b16 a[74:75], v152 offset:41984
    ds_read_b64_tr_b16 a[76:77], v153 offset:40960
    ds_read_b64_tr_b16 a[78:79], v153 offset:41984
    s_waitcnt lgkmcnt(0)
    s_barrier
    s_waitcnt vmcnt(0)
    v_cmp_ne_u32 vcc, v12, v29
    s_cbranch_vccnz L_rs_p1G
L_ok_p1G:
    s_add_u32 m0, s74, 0
    s_nop 0
    buffer_load_dwordx4 v156, s[44:47], s18 offen offset:0 sc1 lds
    buffer_load_dwordx4 v157, s[44:47], s18 offen offset:1024 sc1 lds
    buffer_load_dwordx4 v158, s[44:47], s18 offen offset:2048 sc1 lds
    s_add_u32 m0, s74, 12288
    s_nop 0
    buffer_load_dwordx4 v156, s[44:47], s19 offen offset:0 sc1 lds
    buffer_load_dwordx4 v157, s[44:47], s19 offen offset:1024 sc1 lds
    buffer_load_dwordx4 v158, s[44:47], s19 offen offset:2048 sc1 lds
    s_add_u32 m0, s74, 24576
    s_nop 0
    buffer_load_dwordx4 v156, s[44:47], s20 offen offset:0 sc1 lds
    buffer_load_dwordx4 v157, s[44:47], s20 offen offset:1024 sc1 lds
    buffer_load_dwordx4 v158, s[44:47], s20 offen offset:2048 sc1 lds
L_pl_G_1:
    s_cbranch_execz L_pl_G_5
    s_add_u32 m0, s74, 36864
    s_nop 0
    buffer_load_dwordx4 v156, s[44:47], s21 offen offset:0 sc1 lds
    buffer_load_dwordx4 v157, s[44:47], s21 offen offset:1024 sc1 lds
    buffer_load_dwordx4 v158, s[44:47], s21 offen offset:2048 sc1 lds
    s_add_u32 m0, s73, 0
    s_lshl_b32 s14, s25, 3
    buffer_load_dwordx4 v148, s[48:51], s14 offen offset:0 lds
    buffer_load_dwordx4 v149, s[48:51], s14 offen offset:1024 lds
    buffer_load_dwordx4 v150, s[48:51], s14 offen offset:2048 lds
    buffer_load_dwordx4 v151, s[48:51], s14 offen offset:3072 lds
    s_waitcnt vmcnt(13) lgkmcnt(0)
    s_barrier
    ds_read_b128 v[80:83], v159 offset:0
    ds_read_b128 v[84:87], v159 offset:6144
    ds_read_b128 v[88:91], v159 offset:256
    ds_read_b128 v[92:95], v159 offset:6400
    ds_read_b128 v[96:99], v159 offset:512
    ds_read_b128 v[100:103], v159 offset:6656
    s_waitcnt lgkmcnt(0)
    v_mfma_f32_16x16x32_bf16 v[192:195], a[0:3], v[80:83], 0
    v_mfma_f32_16x16x32_bf16 v[192:195], a[8:11], v[84:87], v[192:195]
    ds_read_b128 v[104:107], v159 offset:768
    v_mfma_f32_16x16x32_bf16 v[196:199], a[12:15], v[84:87], 0
    ds_read_b128 v[108:111], v159 offset:6912
    v_mfma_f32_16x16x32_bf16 v[196:199], a[4:7], v[80:83], v[196:199]
    ds_read_b128 v[112:115], v159 offset:1024
    v_mfma_f32_16x16x32_bf16 v[204:207], a[4:7], v[88:91], 0
    ds_read_b128 v[116:119], v159 offset:7168
    v_mfma_f32_16x16x32_bf16 v[204:207], a[12:15], v[92:95], v[204:207]
    ds_read_b128 v[120:123], v159 offset:1280
    v_mfma_f32_16x16x32_bf16 v[200:203], a[8:11], v[92:95], 0
    ds_read_b128 v[124:127], v159 offset:7424
    v_and_b32 v24, 15, v2
    s_lshl_b32 s7, s71, 6
    v_add_u32 v24, s7, v24
    s_and_b32 s8, s3, 1
    s_lshl_b32 s4, s8, 5
    v_add_u32 v25, s4, v24
    v_lshlrev_b32 v26, 3, v25
    v_mul_u32_u24 v25, 1152, v25
    v_bfe_u32 v31, v2, 4, 1
    v_lshl_add_u32 v25, v31, 5, v25
    v_lshrrev_b32 v31, 5, v2
    v_lshl_add_u32 v25, v31, 4, v25
    s_bfe_u32 s7, s2, 0x20003
    s_mul_i32 s7, s7, 288
    s_lshl_b32 s4, s72, 6
    s_add_u32 s4, s4, s7
    v_add_u32 v252, s4, v25
    s_xor_b32 s8, s3, s72
    s_and_b32 s4, s72, 1
    s_lshl1_add_u32 s4, s4, s8
    v_lshl_add_u32 v24, s4, 4, v24
    s_add_u32 s7, s7, 256
    s_cmp_lt_u32 s8, 2
    s_cselect_b32 s7, s7, 0x40000000
    v_lshlrev_b32 v18, 3, v24
    v_mul_u32_u24 v24, 1152, v24
    v_lshrrev_b32 v31, 4, v2
    v_mfma_f32_16x16x32_bf16 v[200:203], a[0:3], v[88:91], v[200:203]
    v_mfma_f32_16x16x32_bf16 v[208:211], a[0:3], v[96:99], 0
    v_mfma_f32_16x16x32_bf16 v[208:211], a[8:11], v[100:103], v[208:211]
    v_mfma_f32_16x16x32_bf16 v[212:215], a[12:15], v[100:103], 0
    v_mfma_f32_16x16x32_bf16 v[212:215], a[4:7], v[96:99], v[212:215]
    s_waitcnt lgkmcnt(0)
    v_mfma_f32_16x16x32_bf16 v[220:223], a[4:7], v[104:107], 0
    s_waitcnt vmcnt(10)
    s_barrier
    v_mfma_f32_16x16x32_bf16 v[220:223], a[12:15], v[108:111], v[220:223]
    ds_read_b128 v[80:83], v159 offset:12288
    s_add_u32 m0, s74, 49152
    v_mfma_f32_16x16x32_bf16 v[216:219], a[8:11], v[108:111], 0
    ds_read_b128 v[84:87], v159 offset:18432
    buffer_load_dwordx4 v156, s[44:47], s22 offen offset:0 sc1 lds
    v_mfma_f32_16x16x32_bf16 v[216:219], a[0:3], v[104:107], v[216:219]
    ds_read_b128 v[88:91], v159 offset:12544
    v_mfma_f32_16x16x32_bf16 v[224:227], a[0:3], v[112:115], 0
    ds_read_b128 v[92:95], v159 offset:18688
    buffer_load_dwordx4 v157, s[44:47], s22 offen offset:1024 sc1 lds
    v_mfma_f32_16x16x32_bf16 v[224:227], a[8:11], v[116:119], v[224:227]
    ds_read_b128 v[96:99], v159 offset:12800
    v_mfma_f32_16x16x32_bf16 v[228:231], a[12:15], v[116:119], 0
    ds_read_b128 v[100:103], v159 offset:18944
    buffer_load_dwordx4 v158, s[44:47], s22 offen offset:2048 sc1 lds
    v_lshl_add_u32 v24, v31, 3, v24
    v_add_u32 v253, s7, v24
    v_lshrrev_b32 v24, 3, v2
    v_and_b32 v25, 7, v2
    v_bfe_u32 v31, v2, 4, 2
    v_lshlrev_b32 v31, 1, v31
    v_xor_b32 v25, v25, v31
    v_lshlrev_b32 v24, 12, v24
    v_lshl_add_u32 v24, v25, 4, v24
    s_mul_i32 s7, s72, 36
    s_bitcmp1_b32 s3, 0
    s_addc_u32 s7, s7, 0
    s_lshl_b32 s7, s7, 17
    s_lshl_b32 s8, s71, 7
    s_add_u32 s7, s7, s8
    v_add_u32 v4, s7, v24
    v_add_u32 v5, 31744, v4
    v_add_u32 v6, 31744, v5
    v_add_u32 v7, 31744, v6
    v_lshrrev_b32 v24, 2, v2
    v_lshlrev_b32 v24, 7, v24
    v_and_b32 v25, 3, v2
    v_lshl_add_u32 v24, v25, 3, v24
    s_and_b32 s7, s73, 8192
    v_add_u32 v24, s7, v24
    v_bfe_u32 v31, v2, 3, 2
    s_and_b32 s7, s3, 1
    v_mfma_f32_16x16x32_bf16 v[228:231], a[4:7], v[112:115], v[228:231]
    ds_read_b64_tr_b16 a[80:81], v152 offset:49152
    v_mfma_f32_16x16x32_bf16 v[236:239], a[4:7], v[120:123], 0
    ds_read_b64_tr_b16 a[82:83], v152 offset:50176
    s_add_u32 m0, s74, 61440
    v_mfma_f32_16x16x32_bf16 v[236:239], a[12:15], v[124:127], v[236:239]
    v_mfma_f32_16x16x32_bf16 v[232:235], a[8:11], v[124:127], 0
    ds_read_b64_tr_b16 a[84:85], v153 offset:49152
    buffer_load_dwordx4 v156, s[44:47], s23 offen offset:0 sc1 lds
    v_mfma_f32_16x16x32_bf16 v[232:235], a[0:3], v[120:123], v[232:235]
    ds_read_b64_tr_b16 a[86:87], v153 offset:50176
    s_waitcnt lgkmcnt(4)
    v_mfma_f32_16x16x32_bf16 v[192:195], a[16:19], v[80:83], v[192:195]
    buffer_load_dwordx4 v157, s[44:47], s23 offen offset:1024 sc1 lds
    v_mfma_f32_16x16x32_bf16 v[192:195], a[24:27], v[84:87], v[192:195]
    ds_read_b128 v[104:107], v159 offset:13056
    buffer_load_dwordx4 v158, s[44:47], s23 offen offset:2048 sc1 lds
    v_mfma_f32_16x16x32_bf16 v[196:199], a[28:31], v[84:87], v[196:199]
    ds_read_b128 v[108:111], v159 offset:19200
    v_mfma_f32_16x16x32_bf16 v[196:199], a[20:23], v[80:83], v[196:199]
    ds_read_b128 v[112:115], v159 offset:13312
    s_add_u32 m0, s73, 16384
    s_lshl_b32 s14, s26, 3
    v_mfma_f32_16x16x32_bf16 v[204:207], a[20:23], v[88:91], v[204:207]
    ds_read_b128 v[116:119], v159 offset:19456
    v_mfma_f32_16x16x32_bf16 v[204:207], a[28:31], v[92:95], v[204:207]
    ds_read_b128 v[120:123], v159 offset:13568
    buffer_load_dwordx4 v148, s[48:51], s14 offen offset:0 lds
    v_mfma_f32_16x16x32_bf16 v[200:203], a[24:27], v[92:95], v[200:203]
    ds_read_b128 v[124:127], v159 offset:19712
    buffer_load_dwordx4 v149, s[48:51], s14 offen offset:1024 lds
    s_lshl_b32 s7, s7, 1
    v_xor_b32 v31, s7, v31
    v_lshl_add_u32 v10, v31, 5, v24
    v_xor_b32 v11, 32, v10
    s_mul_i32 s84, s101, 14
    s_lshr_b32 s84, s84, 2
    s_add_u32 s84, s84, 0
    s_add_u32 s85, s84, 1
    s_cmp_eq_u32 s85, 14
    s_cselect_b32 s85, 0, s85
    s_add_u32 s86, s85, 1
    s_cmp_eq_u32 s86, 14
    s_cselect_b32 s86, 0, s86
    s_add_u32 s87, s86, 1
    s_cmp_eq_u32 s87, 14
    s_cselect_b32 s87, 0, s87
    s_add_u32 s88, s87, 1
    s_cmp_eq_u32 s88, 14
    s_cselect_b32 s88, 0, s88
    s_add_u32 s89, s88, 1
    s_cmp_eq_u32 s89, 14
    s_cselect_b32 s89, 0, s89
    s_add_u32 s90, s89, 1
    s_cmp_eq_u32 s90, 14
    s_cselect_b32 s90, 0, s90
    s_add_u32 s91, s90, 1
    s_cmp_eq_u32 s91, 14
    s_cselect_b32 s91, 0, s91
    s_add_u32 s92, s91, 1
    s_cmp_eq_u32 s92, 14
    s_cselect_b32 s92, 0, s92
    s_add_u32 s93, s92, 1
    s_cmp_eq_u32 s93, 14
    s_cselect_b32 s93, 0, s93
    s_add_u32 s94, s93, 1
    s_cmp_eq_u32 s94, 14
    s_cselect_b32 s94, 0, s94
    s_add_u32 s95, s94, 1
    s_cmp_eq_u32 s95, 14
    s_cselect_b32 s95, 0, s95
    s_add_u32 s96, s95, 1
    s_cmp_eq_u32 s96, 14
    s_cselect_b32 s96, 0, s96
    s_add_u32 s97, s96, 1
    s_cmp_eq_u32 s97, 14
    s_cselect_b32 s97, 0, s97
    s_mul_i32 s98, s101, 4
    s_lshr_b32 s98, s98, 2
    s_add_u32 s98, s98, 14
    s_add_u32 s99, s98, 1
    s_cmp_eq_u32 s99, 18
    s_cselect_b32 s99, 14, s99
    s_add_u32 s100, s99, 1
    s_cmp_eq_u32 s100, 18
    s_cselect_b32 s100, 14, s100
    s_add_u32 s101, s100, 1
    s_cmp_eq_u32 s101, 18
    s_cselect_b32 s101, 14, s101
    s_mul_i32 s7, s70, 6
    s_add_u32 s7, s7, 0
    s_mul_i32 s8, s7, 7282
    s_lshr_b32 s8, s8, 16
    v_mfma_f32_16x16x32_bf16 v[200:203], a[16:19], v[88:91], v[200:203]
    ds_read_b64_tr_b16 a[88:89], v152 offset:57344
    v_mfma_f32_16x16x32_bf16 v[208:211], a[16:19], v[96:99], v[208:211]
    ds_read_b64_tr_b16 a[90:91], v152 offset:58368
    buffer_load_dwordx4 v150, s[48:51], s14 offen offset:2048 lds
    v_mfma_f32_16x16x32_bf16 v[208:211], a[24:27], v[100:103], v[208:211]
    v_mfma_f32_16x16x32_bf16 v[212:215], a[28:31], v[100:103], v[212:215]
    ds_read_b64_tr_b16 a[92:93], v153 offset:57344
    buffer_load_dwordx4 v151, s[48:51], s14 offen offset:3072 lds
    v_mfma_f32_16x16x32_bf16 v[212:215], a[20:23], v[96:99], v[212:215]
    ds_read_b64_tr_b16 a[94:95], v153 offset:58368
    s_waitcnt lgkmcnt(4)
    v_mfma_f32_16x16x32_bf16 v[220:223], a[20:23], v[104:107], v[220:223]
    s_waitcnt vmcnt(17)
    s_barrier
    v_mfma_f32_16x16x32_bf16 v[220:223], a[28:31], v[108:111], v[220:223]
    ds_read_b128 v[80:83], v159 offset:24576
    s_add_u32 m0, s74, 0
    v_mfma_f32_16x16x32_bf16 v[216:219], a[24:27], v[108:111], v[216:219]
    ds_read_b128 v[84:87], v159 offset:30720
    buffer_load_dwordx4 v156, s[44:47], s24 offen offset:0 sc1 lds
    v_mfma_f32_16x16x32_bf16 v[216:219], a[16:19], v[104:107], v[216:219]
    ds_read_b128 v[88:91], v159 offset:24832
    v_mfma_f32_16x16x32_bf16 v[224:227], a[16:19], v[112:115], v[224:227]
    ds_read_b128 v[92:95], v159 offset:30976
    buffer_load_dwordx4 v157, s[44:47], s24 offen offset:1024 sc1 lds
    v_mfma_f32_16x16x32_bf16 v[224:227], a[24:27], v[116:119], v[224:227]
    ds_read_b128 v[96:99], v159 offset:25088
    v_mfma_f32_16x16x32_bf16 v[228:231], a[28:31], v[116:119], v[228:231]
    ds_read_b128 v[100:103], v159 offset:31232
    buffer_load_dwordx4 v158, s[44:47], s24 offen offset:2048 sc1 lds
    s_mul_i32 s5, s8, 9
    s_sub_u32 s7, s7, s5
    s_lshl_b32 s7, s7, 2
    s_mov_b32 s4, 0xeca86420
    s_mov_b32 s5, 3
    s_lshr_b64 s[4:5], s[4:5], s7
    s_and_b32 s4, s4, 15
    s_lshl4_add_u32 s4, s8, s4
    v_lshl_add_u32 v240, s4, 8, v245
    s_mul_i32 s7, s70, 6
    s_add_u32 s7, s7, 1
    s_mul_i32 s8, s7, 7282
    s_lshr_b32 s8, s8, 16
    s_mul_i32 s5, s8, 9
    s_sub_u32 s7, s7, s5
    s_lshl_b32 s7, s7, 2
    s_mov_b32 s4, 0xeca86420
    s_mov_b32 s5, 3
    s_lshr_b64 s[4:5], s[4:5], s7
    s_and_b32 s4, s4, 15
    s_lshl4_add_u32 s4, s8, s4
    v_lshl_add_u32 v241, s4, 8, v245
    s_mul_i32 s7, s70, 6
    s_add_u32 s7, s7, 2
    s_mul_i32 s8, s7, 7282
    s_lshr_b32 s8, s8, 16
    s_mul_i32 s5, s8, 9
    v_mfma_f32_16x16x32_bf16 v[228:231], a[20:23], v[112:115], v[228:231]
    ds_read_b64_tr_b16 a[96:97], v154 offset:0
    v_mfma_f32_16x16x32_bf16 v[236:239], a[20:23], v[120:123], v[236:239]
    ds_read_b64_tr_b16 a[98:99], v154 offset:1024
    s_add_u32 m0, s74, 12288
    v_mfma_f32_16x16x32_bf16 v[236:239], a[28:31], v[124:127], v[236:239]
    v_mfma_f32_16x16x32_bf16 v[232:235], a[24:27], v[124:127], v[232:235]
    ds_read_b64_tr_b16 a[100:101], v155 offset:0
    buffer_load_dwordx4 v156, s[44:47], s25 offen offset:0 sc1 lds
    v_mfma_f32_16x16x32_bf16 v[232:235], a[16:19], v[120:123], v[232:235]
    ds_read_b64_tr_b16 a[102:103], v155 offset:1024
    s_waitcnt lgkmcnt(4)
    v_mfma_f32_16x16x32_bf16 v[192:195], a[32:35], v[80:83], v[192:195]
    buffer_load_dwordx4 v157, s[44:47], s25 offen offset:1024 sc1 lds
    v_mfma_f32_16x16x32_bf16 v[192:195], a[40:43], v[84:87], v[192:195]
    ds_read_b128 v[104:107], v159 offset:25344
    buffer_load_dwordx4 v158, s[44:47], s25 offen offset:2048 sc1 lds
    v_mfma_f32_16x16x32_bf16 v[196:199], a[44:47], v[84:87], v[196:199]
    ds_read_b128 v[108:111], v159 offset:31488
    v_mfma_f32_16x16x32_bf16 v[196:199], a[36:39], v[80:83], v[196:199]
    ds_read_b128 v[112:115], v159 offset:25600
    s_add_u32 m0, s73, 32768
    s_lshl_b32 s14, s27, 3
    v_mfma_f32_16x16x32_bf16 v[204:207], a[36:39], v[88:91], v[204:207]
    ds_read_b128 v[116:119], v159 offset:31744
    v_mfma_f32_16x16x32_bf16 v[204:207], a[44:47], v[92:95], v[204:207]
    ds_read_b128 v[120:123], v159 offset:25856
    buffer_load_dwordx4 v148, s[48:51], s14 offen offset:0 lds
    v_mfma_f32_16x16x32_bf16 v[200:203], a[40:43], v[92:95], v[200:203]
    ds_read_b128 v[124:127], v159 offset:32000
    buffer_load_dwordx4 v149, s[48:51], s14 offen offset:1024 lds
    s_sub_u32 s7, s7, s5
    s_lshl_b32 s7, s7, 2
    s_mov_b32 s4, 0xeca86420
    s_mov_b32 s5, 3
    s_lshr_b64 s[4:5], s[4:5], s7
    s_and_b32 s4, s4, 15
    s_lshl4_add_u32 s4, s8, s4
    v_lshl_add_u32 v242, s4, 8, v245
    s_mul_i32 s7, s70, 6
    s_add_u32 s7, s7, 3
    s_mul_i32 s8, s7, 7282
    s_lshr_b32 s8, s8, 16
    s_mul_i32 s5, s8, 9
    s_sub_u32 s7, s7, s5
    s_lshl_b32 s7, s7, 2
    s_mov_b32 s4, 0xeca86420
    s_mov_b32 s5, 3
    s_lshr_b64 s[4:5], s[4:5], s7
    s_and_b32 s4, s4, 15
    s_lshl4_add_u32 s4, s8, s4
    v_lshl_add_u32 v243, s4, 8, v245
    s_mul_i32 s7, s70, 6
    s_add_u32 s7, s7, 4
    s_mul_i32 s8, s7, 7282
    s_lshr_b32 s8, s8, 16
    s_mul_i32 s5, s8, 9
    v_mfma_f32_16x16x32_bf16 v[200:203], a[32:35], v[88:91], v[200:203]
    ds_read_b64_tr_b16 a[104:105], v154 offset:8192
    v_mfma_f32_16x16x32_bf16 v[208:211], a[32:35], v[96:99], v[208:211]
    ds_read_b64_tr_b16 a[106:107], v154 offset:9216
    buffer_load_dwordx4 v150, s[48:51], s14 offen offset:2048 lds
    v_mfma_f32_16x16x32_bf16 v[208:211], a[40:43], v[100:103], v[208:211]
    v_mfma_f32_16x16x32_bf16 v[212:215], a[44:47], v[100:103], v[212:215]
    ds_read_b64_tr_b16 a[108:109], v155 offset:8192
    buffer_load_dwordx4 v151, s[48:51], s14 offen offset:3072 lds
    v_mfma_f32_16x16x32_bf16 v[212:215], a[36:39], v[96:99], v[212:215]
    ds_read_b64_tr_b16 a[110:111], v155 offset:9216
    s_waitcnt lgkmcnt(4)
    v_mfma_f32_16x16x32_bf16 v[220:223], a[36:39], v[104:107], v[220:223]
    s_waitcnt vmcnt(20)
    s_barrier
    v_mfma_f32_16x16x32_bf16 v[220:223], a[44:47], v[108:111], v[220:223]
    ds_read_b128 v[80:83], v250 offset:0
    s_add_u32 m0, s74, 24576
    v_mfma_f32_16x16x32_bf16 v[216:219], a[40:43], v[108:111], v[216:219]
    ds_read_b128 v[84:87], v250 offset:6144
    v_mfma_f32_16x16x32_bf16 v[216:219], a[32:35], v[104:107], v[216:219]
    ds_read_b128 v[88:91], v250 offset:256
    buffer_load_dwordx4 v156, s[44:47], s26 offen offset:0 sc1 lds
    v_mfma_f32_16x16x32_bf16 v[224:227], a[32:35], v[112:115], v[224:227]
    ds_read_b128 v[92:95], v250 offset:6400
    v_mfma_f32_16x16x32_bf16 v[224:227], a[40:43], v[116:119], v[224:227]
    ds_read_b128 v[96:99], v250 offset:512
    v_mfma_f32_16x16x32_bf16 v[228:231], a[44:47], v[116:119], v[228:231]
    ds_read_b128 v[100:103], v250 offset:6656
    buffer_load_dwordx4 v157, s[44:47], s26 offen offset:1024 sc1 lds
    s_sub_u32 s7, s7, s5
    s_lshl_b32 s7, s7, 2
    s_mov_b32 s4, 0xeca86420
    s_mov_b32 s5, 3
    s_lshr_b64 s[4:5], s[4:5], s7
    s_and_b32 s4, s4, 15
    s_lshl4_add_u32 s4, s8, s4
    v_lshl_add_u32 v244, s4, 8, v245
    s_mul_i32 s7, s70, 6
    s_add_u32 s7, s7, 5
    s_mul_i32 s8, s7, 7282
    s_lshr_b32 s8, s8, 16
    s_mul_i32 s5, s8, 9
    s_sub_u32 s7, s7, s5
    s_lshl_b32 s7, s7, 2
    s_mov_b32 s4, 0xeca86420
    s_mov_b32 s5, 3
    s_lshr_b64 s[4:5], s[4:5], s7
    s_and_b32 s4, s4, 15
    s_lshl4_add_u32 s4, s8, s4
    v_lshl_add_u32 v245, s4, 8, v245
    s_xor_b32 s7, s75, 1
    s_lshl2_add_u32 s7, s7, s3
    s_mul_i32 s9, s7, 6144
    s_add_u32 s9, s9, 28065792
    s_lshl_b32 s7, s7, 7
    s_add_u32 s6, s7, 33374208
    s_lshl2_add_u32 s7, s75, s3
    s_mul_i32 s10, s7, 6144
    s_add_u32 s10, s10, 28065792
    s_lshl_b32 s7, s7, 7
    v_mfma_f32_16x16x32_bf16 v[228:231], a[36:39], v[112:115], v[228:231]
    ds_read_b64_tr_b16 a[112:113], v152 offset:0
    v_mfma_f32_16x16x32_bf16 v[236:239], a[36:39], v[120:123], v[236:239]
    ds_read_b64_tr_b16 a[114:115], v152 offset:1024
    v_mfma_f32_16x16x32_bf16 v[236:239], a[44:47], v[124:127], v[236:239]
    buffer_load_dwordx4 v158, s[44:47], s26 offen offset:2048 sc1 lds
    v_mfma_f32_16x16x32_bf16 v[232:235], a[40:43], v[124:127], v[232:235]
    ds_read_b64_tr_b16 a[116:117], v153 offset:0
    v_mfma_f32_16x16x32_bf16 v[232:235], a[32:35], v[120:123], v[232:235]
    ds_read_b64_tr_b16 a[118:119], v153 offset:1024
    s_waitcnt lgkmcnt(4)
    v_mfma_f32_16x16x32_bf16 v[192:195], a[48:51], v[80:83], v[192:195]
    s_add_u32 m0, s73, 49152
    s_lshl_b32 s14, s76, 3
    v_mfma_f32_16x16x32_bf16 v[192:195], a[56:59], v[84:87], v[192:195]
    ds_read_b128 v[104:107], v250 offset:768
    v_mfma_f32_16x16x32_bf16 v[196:199], a[60:63], v[84:87], v[196:199]
    ds_read_b128 v[108:111], v250 offset:6912
    buffer_load_dwordx4 v148, s[48:51], s14 offen offset:0 lds
    v_mfma_f32_16x16x32_bf16 v[196:199], a[52:55], v[80:83], v[196:199]
    ds_read_b128 v[112:115], v250 offset:1024
    v_mfma_f32_16x16x32_bf16 v[204:207], a[52:55], v[88:91], v[204:207]
    ds_read_b128 v[116:119], v250 offset:7168
    buffer_load_dwordx4 v149, s[48:51], s14 offen offset:1024 lds
    v_mfma_f32_16x16x32_bf16 v[204:207], a[60:63], v[92:95], v[204:207]
    ds_read_b128 v[120:123], v250 offset:1280
    v_mfma_f32_16x16x32_bf16 v[200:203], a[56:59], v[92:95], v[200:203]
    ds_read_b128 v[124:127], v250 offset:7424
    s_add_u32 s7, s7, 33374208
    v_mov_b32 v28, s7
    v_add_u32 v247, 3072, v246
    v_cmp_eq_u32 vcc, 0, v2
    v_mov_b32 v248, 0x40000000
    s_nop 0
    v_cndmask_b32 v248, v248, 0, vcc
    v_mov_b32 v249, s68
    v_and_b32 v129, 0xffff0000, v144
    v_lshlrev_b32 v128, 16, v144
    v_and_b32 v131, 0xffff0000, v145
    v_lshlrev_b32 v130, 16, v145
    v_and_b32 v133, 0xffff0000, v146
    v_lshlrev_b32 v132, 16, v146
    v_and_b32 v135, 0xffff0000, v147
    v_lshlrev_b32 v134, 16, v147
    s_mul_i32 s4, s70, 43691
    s_lshr_b32 s4, s4, 16
    s_mul_i32 s5, s70, 21846
    s_lshr_b32 s5, s5, 16
    s_mul_i32 s5, s5, 3
    s_sub_u32 s5, s70, s5
    s_lshl2_add_u32 s4, s72, s4
    s_lshl_b32 s4, s4, 10
    s_mul_i32 s7, s72, 9
    s_sub_u32 s7, s69, s7
    s_lshl3_add_u32 s4, s7, s4
    v_mfma_f32_16x16x32_bf16 v[200:203], a[48:51], v[88:91], v[200:203]
    ds_read_b64_tr_b16 a[120:121], v152 offset:8192
    buffer_load_dwordx4 v150, s[48:51], s14 offen offset:2048 lds
    v_mfma_f32_16x16x32_bf16 v[208:211], a[48:51], v[96:99], v[208:211]
    ds_read_b64_tr_b16 a[122:123], v152 offset:9216
    v_mfma_f32_16x16x32_bf16 v[208:211], a[56:59], v[100:103], v[208:211]
    buffer_load_dwordx4 v151, s[48:51], s14 offen offset:3072 lds
    v_mfma_f32_16x16x32_bf16 v[212:215], a[60:63], v[100:103], v[212:215]
    ds_read_b64_tr_b16 a[124:125], v153 offset:8192
    v_mfma_f32_16x16x32_bf16 v[212:215], a[52:55], v[96:99], v[212:215]
    ds_read_b64_tr_b16 a[126:127], v153 offset:9216
    s_waitcnt lgkmcnt(4)
    v_mfma_f32_16x16x32_bf16 v[220:223], a[52:55], v[104:107], v[220:223]
    s_waitcnt vmcnt(17)
    s_barrier
    v_mfma_f32_16x16x32_bf16 v[220:223], a[60:63], v[108:111], v[220:223]
    ds_read_b128 v[80:83], v250 offset:12288
    s_add_u32 m0, s74, 36864
    v_mfma_f32_16x16x32_bf16 v[216:219], a[56:59], v[108:111], v[216:219]
    ds_read_b128 v[84:87], v250 offset:18432
    v_mfma_f32_16x16x32_bf16 v[216:219], a[48:51], v[104:107], v[216:219]
    ds_read_b128 v[88:91], v250 offset:12544
    buffer_load_dwordx4 v156, s[44:47], s27 offen offset:0 sc1 lds
    v_mfma_f32_16x16x32_bf16 v[224:227], a[48:51], v[112:115], v[224:227]
    ds_read_b128 v[92:95], v250 offset:18688
    v_mfma_f32_16x16x32_bf16 v[224:227], a[56:59], v[116:119], v[224:227]
    ds_read_b128 v[96:99], v250 offset:12800
    v_mfma_f32_16x16x32_bf16 v[228:231], a[60:63], v[116:119], v[228:231]
    ds_read_b128 v[100:103], v250 offset:18944
    buffer_load_dwordx4 v157, s[44:47], s27 offen offset:1024 sc1 lds
    s_add_u32 s4, s4, 12566528
    s_cmp_eq_u32 s5, 1
    s_cselect_b32 s7, 16, 8
    s_cmp_lg_u32 s5, 0
    s_cselect_b32 s5, 4, 0
    v_lshlrev_b32 v17, 7, v0
    v_add_u32 v17, s4, v17
    v_cmp_gt_u32 vcc, 8, v0
    v_mov_b32 v24, s5
    s_nop 0
    v_cndmask_b32 v24, 0, v24, vcc
    v_add_u32 v17, v17, v24
    v_cmp_gt_u32 vcc, s7, v0
    v_mov_b32 v24, 0x40000000
    s_nop 0
    v_cndmask_b32 v17, v24, v17, vcc
    s_bfe_u32 s4, s2, 0x20003
    s_lshl2_add_u32 s4, s72, s4
    s_lshl_b32 s4, s4, 3
    s_lshr_b32 s5, s2, 4
    s_and_b32 s5, s5, 6
    s_add_u32 s4, s4, s5
    s_and_b32 s5, s2, 1
    s_add_u32 s4, s4, s5
    s_lshl_b32 s4, s4, 7
    s_add_u32 s4, s4, 12566528
    v_lshl_add_u32 v15, v2, 2, s4
    s_cmp_eq_u32 s3, 0
    s_cselect_b32 s4, 18, 0
    v_cmp_gt_u32 vcc, s4, v2
    v_mov_b32 v13, 0x40000000
    v_mfma_f32_16x16x32_bf16 v[228:231], a[52:55], v[112:115], v[228:231]
    ds_read_b64_tr_b16 a[128:129], v152 offset:16384
    v_mfma_f32_16x16x32_bf16 v[236:239], a[52:55], v[120:123], v[236:239]
    ds_read_b64_tr_b16 a[130:131], v152 offset:17408
    v_mfma_f32_16x16x32_bf16 v[236:239], a[60:63], v[124:127], v[236:239]
    buffer_load_dwordx4 v158, s[44:47], s27 offen offset:2048 sc1 lds
    v_mfma_f32_16x16x32_bf16 v[232:235], a[56:59], v[124:127], v[232:235]
    ds_read_b64_tr_b16 a[132:133], v153 offset:16384
    v_mfma_f32_16x16x32_bf16 v[232:235], a[48:51], v[120:123], v[232:235]
    ds_read_b64_tr_b16 a[134:135], v153 offset:17408
    s_waitcnt lgkmcnt(4)
    v_mfma_f32_16x16x32_bf16 v[192:195], a[64:67], v[80:83], v[192:195]
    s_add_u32 m0, s73, 65536
    s_lshl_b32 s14, s77, 3
    v_mfma_f32_16x16x32_bf16 v[192:195], a[72:75], v[84:87], v[192:195]
    ds_read_b128 v[104:107], v250 offset:13056
    v_mfma_f32_16x16x32_bf16 v[196:199], a[76:79], v[84:87], v[196:199]
    ds_read_b128 v[108:111], v250 offset:19200
    buffer_load_dwordx4 v148, s[48:51], s14 offen offset:0 lds
    v_mfma_f32_16x16x32_bf16 v[196:199], a[68:71], v[80:83], v[196:199]
    ds_read_b128 v[112:115], v250 offset:13312
    v_mfma_f32_16x16x32_bf16 v[204:207], a[68:71], v[88:91], v[204:207]
    ds_read_b128 v[116:119], v250 offset:19456
    buffer_load_dwordx4 v149, s[48:51], s14 offen offset:1024 lds
    v_mfma_f32_16x16x32_bf16 v[204:207], a[76:79], v[92:95], v[204:207]
    ds_read_b128 v[120:123], v250 offset:13568
    v_mfma_f32_16x16x32_bf16 v[200:203], a[72:75], v[92:95], v[200:203]
    ds_read_b128 v[124:127], v250 offset:19712
    v_cndmask_b32 v15, v13, v15, vcc
    v_mov_b32 v13, s68
    v_cndmask_b32 v13, 0, v13, vcc
    v_and_b32 v24, 15, v2
    v_lshrrev_b32 v25, 4, v2
    v_mul_u32_u24 v25, 17408, v25
    v_lshl_add_u32 v24, v24, 4, v25
    s_mul_i32 s7, s72, 36
    s_and_b32 s8, s3, 1
    s_add_u32 s7, s7, s8
    s_mul_i32 s7, s7, 69632
    s_bfe_u32 s8, s2, 0x20003
    s_lshl_b32 s8, s8, 12
    s_add_u32 s7, s7, s8
    s_add_u32 s7, s7, 12795904
    v_add_u32 v23, s7, v24
    s_xor_b32 s7, s72, 0
    v_lshl_add_u32 v19, s7, 10, v23
    s_xor_b32 s7, s72, 1
    v_lshl_add_u32 v20, s7, 10, v23
    s_xor_b32 s7, s72, 2
    v_lshl_add_u32 v21, s7, 10, v23
    s_xor_b32 s7, s72, 3
    v_lshl_add_u32 v22, s7, 10, v23
    v_lshlrev_b32 v14, 4, v2
    v_add_u32 v14, 98304, v14
    v_add_u32 v1, 0x10000, v14
    v_mfma_f32_16x16x32_bf16 v[200:203], a[64:67], v[88:91], v[200:203]
    ds_read_b64_tr_b16 a[136:137], v152 offset:24576
    buffer_load_dwordx4 v150, s[48:51], s14 offen offset:2048 lds
    v_mfma_f32_16x16x32_bf16 v[208:211], a[64:67], v[96:99], v[208:211]
    ds_read_b64_tr_b16 a[138:139], v152 offset:25600
    v_mfma_f32_16x16x32_bf16 v[208:211], a[72:75], v[100:103], v[208:211]
    buffer_load_dwordx4 v151, s[48:51], s14 offen offset:3072 lds
    v_mfma_f32_16x16x32_bf16 v[212:215], a[76:79], v[100:103], v[212:215]
    ds_read_b64_tr_b16 a[140:141], v153 offset:24576
    v_mfma_f32_16x16x32_bf16 v[212:215], a[68:71], v[96:99], v[212:215]
    ds_read_b64_tr_b16 a[142:143], v153 offset:25600
    s_waitcnt lgkmcnt(4)
    v_mfma_f32_16x16x32_bf16 v[220:223], a[68:71], v[104:107], v[220:223]
    s_waitcnt vmcnt(14)
    s_barrier
    v_mfma_f32_16x16x32_bf16 v[220:223], a[76:79], v[108:111], v[220:223]
    ds_read_b128 v[80:83], v250 offset:24576
    s_add_u32 m0, s74, 49152
    v_mfma_f32_16x16x32_bf16 v[216:219], a[72:75], v[108:111], v[216:219]
    ds_read_b128 v[84:87], v250 offset:30720
    v_mfma_f32_16x16x32_bf16 v[216:219], a[64:67], v[104:107], v[216:219]
    ds_read_b128 v[88:91], v250 offset:24832
    buffer_load_dwordx4 v156, s[44:47], s76 offen offset:0 sc1 lds
    v_mfma_f32_16x16x32_bf16 v[224:227], a[64:67], v[112:115], v[224:227]
    ds_read_b128 v[92:95], v250 offset:30976
    v_mfma_f32_16x16x32_bf16 v[224:227], a[72:75], v[116:119], v[224:227]
    ds_read_b128 v[96:99], v250 offset:25088
    v_mfma_f32_16x16x32_bf16 v[228:231], a[76:79], v[116:119], v[228:231]
    ds_read_b128 v[100:103], v250 offset:31232
    buffer_load_dwordx4 v157, s[44:47], s76 offen offset:1024 sc1 lds
    s_mov_b32 s56, s16
    s_and_b32 s57, s17, 0xffff
    s_mov_b32 s58, 2359296
    s_mov_b32 s59, 0x20000
    s_mov_b32 s40, 18432
    s_mov_b32 s42, 12386304
    s_mov_b32 s64, s38
    s_and_b32 s65, s39, 0xffff
    s_mov_b32 s66, 2359296
    s_mov_b32 s67, 0x20000
    v_lshlrev_b32 v136, 4, v2
    s_mul_i32 s7, s72, 36
    s_bitcmp1_b32 s3, 0
    s_addc_u32 s7, s7, 0
    s_lshl_b32 s7, s7, 17
    v_subrev_u32 v184, s7, v4
    v_subrev_u32 v185, s7, v5
    s_bfe_u32 s4, s2, 0x20003
    s_mul_i32 s4, s4, 9
    s_lshl1_add_u32 s7, s72, s4
    s_and_b32 s8, s3, 1
    s_add_u32 s7, s7, s8
    s_lshl_b32 s37, s7, 16
    s_add_u32 s37, s37, 4718592
    s_add_u32 s4, s4, 8
    s_lshl_b32 s16, s4, 16
    s_add_u32 s16, s16, 4718592
    v_mfma_f32_16x16x32_bf16 v[228:231], a[68:71], v[112:115], v[228:231]
    ds_read_b64_tr_b16 a[144:145], v152 offset:32768
    v_mfma_f32_16x16x32_bf16 v[236:239], a[68:71], v[120:123], v[236:239]
    ds_read_b64_tr_b16 a[146:147], v152 offset:33792
    v_mfma_f32_16x16x32_bf16 v[236:239], a[76:79], v[124:127], v[236:239]
    buffer_load_dwordx4 v158, s[44:47], s76 offen offset:2048 sc1 lds
    v_mfma_f32_16x16x32_bf16 v[232:235], a[72:75], v[124:127], v[232:235]
    ds_read_b64_tr_b16 a[148:149], v153 offset:32768
    v_mfma_f32_16x16x32_bf16 v[232:235], a[64:67], v[120:123], v[232:235]
    ds_read_b64_tr_b16 a[150:151], v153 offset:33792
    s_waitcnt lgkmcnt(4)
    v_mfma_f32_16x16x32_bf16 v[192:195], a[80:83], v[80:83], v[192:195]
    s_add_u32 m0, s73, 0
    s_lshl_b32 s14, s78, 3
    v_mfma_f32_16x16x32_bf16 v[192:195], a[88:91], v[84:87], v[192:195]
    ds_read_b128 v[104:107], v250 offset:25344
    v_mfma_f32_16x16x32_bf16 v[196:199], a[92:95], v[84:87], v[196:199]
    ds_read_b128 v[108:111], v250 offset:31488
    buffer_load_dwordx4 v148, s[48:51], s14 offen offset:0 lds
    v_mfma_f32_16x16x32_bf16 v[196:199], a[84:87], v[80:83], v[196:199]
    ds_read_b128 v[112:115], v250 offset:25600
    v_mfma_f32_16x16x32_bf16 v[204:207], a[84:87], v[88:91], v[204:207]
    ds_read_b128 v[116:119], v250 offset:31744
    buffer_load_dwordx4 v149, s[48:51], s14 offen offset:1024 lds
    v_mfma_f32_16x16x32_bf16 v[204:207], a[92:95], v[92:95], v[204:207]
    ds_read_b128 v[120:123], v250 offset:25856
    v_mfma_f32_16x16x32_bf16 v[200:203], a[88:91], v[92:95], v[200:203]
    ds_read_b128 v[124:127], v250 offset:32000
    s_sub_u32 s4, s4, s7
    s_lshl_b32 s4, s4, 7
    s_lshl_b32 s7, s7, 7
    s_add_u32 s7, s7, 12582912
    v_bfe_u32 v24, v2, 2, 1
    v_mul_u32_u24 v24, s4, v24
    v_and_b32 v25, 3, v2
    v_lshl_add_u32 v24, v25, 2, v24
    v_add_u32 v188, s7, v24
    s_lshl2_add_u32 s7, s2, s3
    s_mul_i32 s8, s7, 3072
    s_add_u32 s34, s8, 40828928
L_pl_G_2:
    s_cbranch_execz L_pl_G_6
    s_add_u32 s11, s8, 43974656
    s_add_u32 s12, s8, 47120384
    s_lshl_b32 s35, s7, 12
    s_add_u32 s35, s35, 50266112
    s_xor_b32 s8, s7, 8
    s_mul_i32 s8, s8, 3072
    s_add_u32 s30, s8, 40828928
    s_xor_b32 s8, s7, 16
    s_mul_i32 s8, s8, 3072
    s_add_u32 s15, s8, 43974656
    s_xor_b32 s8, s7, 24
    s_mul_i32 s8, s8, 3072
    s_add_u32 s31, s8, 47120384
    s_andn2_b32 s7, s7, 24
    v_mfma_f32_16x16x32_bf16 v[200:203], a[80:83], v[88:91], v[200:203]
    ds_read_b64_tr_b16 a[152:153], v152 offset:40960
    buffer_load_dwordx4 v150, s[48:51], s14 offen offset:2048 lds
    v_mfma_f32_16x16x32_bf16 v[208:211], a[80:83], v[96:99], v[208:211]
    ds_read_b64_tr_b16 a[154:155], v152 offset:41984
    v_mfma_f32_16x16x32_bf16 v[208:211], a[88:91], v[100:103], v[208:211]
    buffer_load_dwordx4 v151, s[48:51], s14 offen offset:3072 lds
    v_mfma_f32_16x16x32_bf16 v[212:215], a[92:95], v[100:103], v[212:215]
    ds_read_b64_tr_b16 a[156:157], v153 offset:40960
    v_mfma_f32_16x16x32_bf16 v[212:215], a[84:87], v[96:99], v[212:215]
    ds_read_b64_tr_b16 a[158:159], v153 offset:41984
    s_waitcnt lgkmcnt(4)
    v_mfma_f32_16x16x32_bf16 v[220:223], a[84:87], v[104:107], v[220:223]
    s_waitcnt vmcnt(14)
    s_barrier
    v_mfma_f32_16x16x32_bf16 v[220:223], a[92:95], v[108:111], v[220:223]
    ds_read_b128 v[80:83], v159 offset:0
    s_add_u32 m0, s74, 61440
    v_mfma_f32_16x16x32_bf16 v[216:219], a[88:91], v[108:111], v[216:219]
    ds_read_b128 v[84:87], v159 offset:6144
    v_mfma_f32_16x16x32_bf16 v[216:219], a[80:83], v[104:107], v[216:219]
    ds_read_b128 v[88:91], v159 offset:256
    buffer_load_dwordx4 v156, s[44:47], s77 offen offset:0 sc1 lds
    v_mfma_f32_16x16x32_bf16 v[224:227], a[80:83], v[112:115], v[224:227]
    ds_read_b128 v[92:95], v159 offset:6400
    v_mfma_f32_16x16x32_bf16 v[224:227], a[88:91], v[116:119], v[224:227]
    ds_read_b128 v[96:99], v159 offset:512
    v_mfma_f32_16x16x32_bf16 v[228:231], a[92:95], v[116:119], v[228:231]
    ds_read_b128 v[100:103], v159 offset:6656
    buffer_load_dwordx4 v157, s[44:47], s77 offen offset:1024 sc1 lds
    s_lshl3_add_u32 s7, s3, s7
    s_lshl2_add_u32 s8, s7, s72
    s_lshl_b32 s8, s8, 10
    s_add_u32 s32, s8, 50266112
    s_xor_b32 s8, s8, 4096
    s_add_u32 s33, s8, 50266112
    s_xor_b32 s8, s3, s72
    s_cmp_lt_u32 s8, 2
    s_cselect_b32 s35, s35, 0x40000000
    s_cselect_b32 s16, s16, 0x40000000
    s_cselect_b32 s36, s68, 0
    s_mov_b32 s38, 0xbfb8aa3b
    s_and_b32 s8, s8, 1
    s_mul_i32 s41, s8, 96
    s_and_b32 s43, s73, 4096
    v_lshlrev_b32 v24, 10, v2
    v_add_u32 v24, s35, v24
    s_add_u32 s7, s34, 2048
    v_mov_b32 v25, s36
    v_cmp_gt_u32 vcc, 4, v2
    s_nop 1
    v_cndmask_b32 v138, 0, v25, vcc
    v_mov_b32 v25, 0x40000000
    v_cndmask_b32 v137, v25, v24, vcc
    v_writelane_b32 v137, s7, 4
    v_writelane_b32 v138, s68, 4
    v_min_u32 v139, 1, v2
    v_lshlrev_b32 v139, 30, v139
    v_mov_b32 v140, 0
    v_writelane_b32 v140, s68, 0
    v_mfma_f32_16x16x32_bf16 v[228:231], a[84:87], v[112:115], v[228:231]
    ds_read_b64_tr_b16 a[160:161], v152 offset:49152
    v_mfma_f32_16x16x32_bf16 v[236:239], a[84:87], v[120:123], v[236:239]
    ds_read_b64_tr_b16 a[162:163], v152 offset:50176
    v_mfma_f32_16x16x32_bf16 v[236:239], a[92:95], v[124:127], v[236:239]
    buffer_load_dwordx4 v158, s[44:47], s77 offen offset:2048 sc1 lds
    v_mfma_f32_16x16x32_bf16 v[232:235], a[88:91], v[124:127], v[232:235]
    ds_read_b64_tr_b16 a[164:165], v153 offset:49152
    v_mfma_f32_16x16x32_bf16 v[232:235], a[80:83], v[120:123], v[232:235]
    ds_read_b64_tr_b16 a[166:167], v153 offset:50176
    s_waitcnt lgkmcnt(4)
    v_mfma_f32_16x16x32_bf16 v[192:195], a[96:99], v[80:83], v[192:195]
    s_add_u32 m0, s73, 16384
    s_lshl_b32 s14, s79, 3
    v_mfma_f32_16x16x32_bf16 v[192:195], a[104:107], v[84:87], v[192:195]
    ds_read_b128 v[104:107], v159 offset:768
    v_mfma_f32_16x16x32_bf16 v[196:199], a[108:111], v[84:87], v[196:199]
    ds_read_b128 v[108:111], v159 offset:6912
    buffer_load_dwordx4 v148, s[48:51], s14 offen offset:0 lds
    v_mfma_f32_16x16x32_bf16 v[196:199], a[100:103], v[80:83], v[196:199]
    ds_read_b128 v[112:115], v159 offset:1024
    v_mfma_f32_16x16x32_bf16 v[204:207], a[100:103], v[88:91], v[204:207]
    ds_read_b128 v[116:119], v159 offset:7168
    buffer_load_dwordx4 v149, s[48:51], s14 offen offset:1024 lds
    v_mfma_f32_16x16x32_bf16 v[204:207], a[108:111], v[92:95], v[204:207]
    ds_read_b128 v[120:123], v159 offset:1280
    v_mfma_f32_16x16x32_bf16 v[200:203], a[104:107], v[92:95], v[200:203]
    ds_read_b128 v[124:127], v159 offset:7424
    v_mfma_f32_16x16x32_bf16 v[200:203], a[96:99], v[88:91], v[200:203]
    ds_read_b64_tr_b16 a[168:169], v152 offset:57344
    buffer_load_dwordx4 v150, s[48:51], s14 offen offset:2048 lds
    v_mfma_f32_16x16x32_bf16 v[208:211], a[96:99], v[96:99], v[208:211]
    ds_read_b64_tr_b16 a[170:171], v152 offset:58368
    v_mfma_f32_16x16x32_bf16 v[208:211], a[104:107], v[100:103], v[208:211]
    buffer_load_dwordx4 v151, s[48:51], s14 offen offset:3072 lds
    v_mfma_f32_16x16x32_bf16 v[212:215], a[108:111], v[100:103], v[212:215]
    ds_read_b64_tr_b16 a[172:173], v153 offset:57344
    v_mfma_f32_16x16x32_bf16 v[212:215], a[100:103], v[96:99], v[212:215]
    ds_read_b64_tr_b16 a[174:175], v153 offset:58368
    s_waitcnt lgkmcnt(4)
    v_mfma_f32_16x16x32_bf16 v[220:223], a[100:103], v[104:107], v[220:223]
    s_waitcnt vmcnt(14)
    s_barrier
    v_mfma_f32_16x16x32_bf16 v[220:223], a[108:111], v[108:111], v[220:223]
    ds_read_b128 v[80:83], v159 offset:12288
    s_add_u32 m0, s74, 0
    v_mfma_f32_16x16x32_bf16 v[216:219], a[104:107], v[108:111], v[216:219]
    ds_read_b128 v[84:87], v159 offset:18432
    v_mfma_f32_16x16x32_bf16 v[216:219], a[96:99], v[104:107], v[216:219]
    ds_read_b128 v[88:91], v159 offset:12544
    buffer_load_dwordx4 v156, s[44:47], s78 offen offset:0 sc1 lds
    v_mfma_f32_16x16x32_bf16 v[224:227], a[96:99], v[112:115], v[224:227]
    ds_read_b128 v[92:95], v159 offset:18688
    v_mfma_f32_16x16x32_bf16 v[224:227], a[104:107], v[116:119], v[224:227]
    ds_read_b128 v[96:99], v159 offset:12800
    v_mfma_f32_16x16x32_bf16 v[228:231], a[108:111], v[116:119], v[228:231]
    ds_read_b128 v[100:103], v159 offset:18944
    buffer_load_dwordx4 v157, s[44:47], s78 offen offset:1024 sc1 lds
    v_mfma_f32_16x16x32_bf16 v[228:231], a[100:103], v[112:115], v[228:231]
    ds_read_b64_tr_b16 a[176:177], v154 offset:0
    v_mfma_f32_16x16x32_bf16 v[236:239], a[100:103], v[120:123], v[236:239]
    ds_read_b64_tr_b16 a[178:179], v154 offset:1024
    v_mfma_f32_16x16x32_bf16 v[236:239], a[108:111], v[124:127], v[236:239]
    buffer_load_dwordx4 v158, s[44:47], s78 offen offset:2048 sc1 lds
    v_mfma_f32_16x16x32_bf16 v[232:235], a[104:107], v[124:127], v[232:235]
    ds_read_b64_tr_b16 a[180:181], v155 offset:0
    v_mfma_f32_16x16x32_bf16 v[232:235], a[96:99], v[120:123], v[232:235]
    ds_read_b64_tr_b16 a[182:183], v155 offset:1024
    s_waitcnt lgkmcnt(4)
    v_mfma_f32_16x16x32_bf16 v[192:195], a[112:115], v[80:83], v[192:195]
    s_add_u32 m0, s73, 32768
    s_lshl_b32 s14, s80, 3
    v_mfma_f32_16x16x32_bf16 v[192:195], a[120:123], v[84:87], v[192:195]
    ds_read_b128 v[104:107], v159 offset:13056
    v_mfma_f32_16x16x32_bf16 v[196:199], a[124:127], v[84:87], v[196:199]
    ds_read_b128 v[108:111], v159 offset:19200
    buffer_load_dwordx4 v148, s[48:51], s14 offen offset:0 lds
    v_mfma_f32_16x16x32_bf16 v[196:199], a[116:119], v[80:83], v[196:199]
    ds_read_b128 v[112:115], v159 offset:13312
    v_mfma_f32_16x16x32_bf16 v[204:207], a[116:119], v[88:91], v[204:207]
    ds_read_b128 v[116:119], v159 offset:19456
    buffer_load_dwordx4 v149, s[48:51], s14 offen offset:1024 lds
    v_mfma_f32_16x16x32_bf16 v[204:207], a[124:127], v[92:95], v[204:207]
    ds_read_b128 v[120:123], v159 offset:13568
    v_mfma_f32_16x16x32_bf16 v[200:203], a[120:123], v[92:95], v[200:203]
    ds_read_b128 v[124:127], v159 offset:19712
    v_mfma_f32_16x16x32_bf16 v[200:203], a[112:115], v[88:91], v[200:203]
    ds_read_b64_tr_b16 a[184:185], v154 offset:8192
    buffer_load_dwordx4 v150, s[48:51], s14 offen offset:2048 lds
    v_mfma_f32_16x16x32_bf16 v[208:211], a[112:115], v[96:99], v[208:211]
    ds_read_b64_tr_b16 a[186:187], v154 offset:9216
    v_mfma_f32_16x16x32_bf16 v[208:211], a[120:123], v[100:103], v[208:211]
    buffer_load_dwordx4 v151, s[48:51], s14 offen offset:3072 lds
    v_mfma_f32_16x16x32_bf16 v[212:215], a[124:127], v[100:103], v[212:215]
    ds_read_b64_tr_b16 a[188:189], v155 offset:8192
    v_mfma_f32_16x16x32_bf16 v[212:215], a[116:119], v[96:99], v[212:215]
    ds_read_b64_tr_b16 a[190:191], v155 offset:9216
    s_waitcnt lgkmcnt(4)
    v_mfma_f32_16x16x32_bf16 v[220:223], a[116:119], v[104:107], v[220:223]
    s_waitcnt vmcnt(14)
    s_barrier
    v_mfma_f32_16x16x32_bf16 v[220:223], a[124:127], v[108:111], v[220:223]
    ds_read_b128 v[80:83], v159 offset:24576
    s_add_u32 m0, s74, 12288
    v_mfma_f32_16x16x32_bf16 v[216:219], a[120:123], v[108:111], v[216:219]
    ds_read_b128 v[84:87], v159 offset:30720
    v_mfma_f32_16x16x32_bf16 v[216:219], a[112:115], v[104:107], v[216:219]
    ds_read_b128 v[88:91], v159 offset:24832
    buffer_load_dwordx4 v156, s[44:47], s79 offen offset:0 sc1 lds
    v_mfma_f32_16x16x32_bf16 v[224:227], a[112:115], v[112:115], v[224:227]
    ds_read_b128 v[92:95], v159 offset:30976
    v_mfma_f32_16x16x32_bf16 v[224:227], a[120:123], v[116:119], v[224:227]
    ds_read_b128 v[96:99], v159 offset:25088
    v_mfma_f32_16x16x32_bf16 v[228:231], a[124:127], v[116:119], v[228:231]
    ds_read_b128 v[100:103], v159 offset:31232
    buffer_load_dwordx4 v157, s[44:47], s79 offen offset:1024 sc1 lds
    v_mfma_f32_16x16x32_bf16 v[228:231], a[116:119], v[112:115], v[228:231]
    ds_read_b64_tr_b16 a[192:193], v152 offset:0
    v_mfma_f32_16x16x32_bf16 v[236:239], a[116:119], v[120:123], v[236:239]
    ds_read_b64_tr_b16 a[194:195], v152 offset:1024
    v_mfma_f32_16x16x32_bf16 v[236:239], a[124:127], v[124:127], v[236:239]
    buffer_load_dwordx4 v158, s[44:47], s79 offen offset:2048 sc1 lds
    v_mfma_f32_16x16x32_bf16 v[232:235], a[120:123], v[124:127], v[232:235]
    ds_read_b64_tr_b16 a[196:197], v153 offset:0
    v_mfma_f32_16x16x32_bf16 v[232:235], a[112:115], v[120:123], v[232:235]
    ds_read_b64_tr_b16 a[198:199], v153 offset:1024
    s_waitcnt lgkmcnt(4)
    v_mfma_f32_16x16x32_bf16 v[192:195], a[128:131], v[80:83], v[192:195]
    s_add_u32 m0, s73, 49152
    s_lshl_b32 s14, s81, 3
    v_mfma_f32_16x16x32_bf16 v[192:195], a[136:139], v[84:87], v[192:195]
    ds_read_b128 v[104:107], v159 offset:25344
    v_mfma_f32_16x16x32_bf16 v[196:199], a[140:143], v[84:87], v[196:199]
    ds_read_b128 v[108:111], v159 offset:31488
    buffer_load_dwordx4 v148, s[48:51], s14 offen offset:0 lds
    v_mfma_f32_16x16x32_bf16 v[196:199], a[132:135], v[80:83], v[196:199]
    ds_read_b128 v[112:115], v159 offset:25600
    v_mfma_f32_16x16x32_bf16 v[204:207], a[132:135], v[88:91], v[204:207]
    ds_read_b128 v[116:119], v159 offset:31744
    buffer_load_dwordx4 v149, s[48:51], s14 offen offset:1024 lds
    v_mfma_f32_16x16x32_bf16 v[204:207], a[140:143], v[92:95], v[204:207]
    ds_read_b128 v[120:123], v159 offset:25856
    v_mfma_f32_16x16x32_bf16 v[200:203], a[136:139], v[92:95], v[200:203]
    ds_read_b128 v[124:127], v159 offset:32000
    v_mfma_f32_16x16x32_bf16 v[200:203], a[128:131], v[88:91], v[200:203]
    ds_read_b64_tr_b16 a[200:201], v152 offset:8192
    buffer_load_dwordx4 v150, s[48:51], s14 offen offset:2048 lds
    v_mfma_f32_16x16x32_bf16 v[208:211], a[128:131], v[96:99], v[208:211]
    ds_read_b64_tr_b16 a[202:203], v152 offset:9216
    v_mfma_f32_16x16x32_bf16 v[208:211], a[136:139], v[100:103], v[208:211]
    buffer_load_dwordx4 v151, s[48:51], s14 offen offset:3072 lds
    v_mfma_f32_16x16x32_bf16 v[212:215], a[140:143], v[100:103], v[212:215]
    ds_read_b64_tr_b16 a[204:205], v153 offset:8192
    v_mfma_f32_16x16x32_bf16 v[212:215], a[132:135], v[96:99], v[212:215]
    ds_read_b64_tr_b16 a[206:207], v153 offset:9216
    s_waitcnt lgkmcnt(4)
    v_mfma_f32_16x16x32_bf16 v[220:223], a[132:135], v[104:107], v[220:223]
    s_waitcnt vmcnt(14)
    s_barrier
    v_mfma_f32_16x16x32_bf16 v[220:223], a[140:143], v[108:111], v[220:223]
    ds_read_b128 v[80:83], v250 offset:0
    s_add_u32 m0, s74, 24576
    v_mfma_f32_16x16x32_bf16 v[216:219], a[136:139], v[108:111], v[216:219]
    ds_read_b128 v[84:87], v250 offset:6144
    v_mfma_f32_16x16x32_bf16 v[216:219], a[128:131], v[104:107], v[216:219]
    ds_read_b128 v[88:91], v250 offset:256
    buffer_load_dwordx4 v156, s[44:47], s80 offen offset:0 sc1 lds
    v_mfma_f32_16x16x32_bf16 v[224:227], a[128:131], v[112:115], v[224:227]
    ds_read_b128 v[92:95], v250 offset:6400
    v_mfma_f32_16x16x32_bf16 v[224:227], a[136:139], v[116:119], v[224:227]
    ds_read_b128 v[96:99], v250 offset:512
    v_mfma_f32_16x16x32_bf16 v[228:231], a[140:143], v[116:119], v[228:231]
    ds_read_b128 v[100:103], v250 offset:6656
    buffer_load_dwordx4 v157, s[44:47], s80 offen offset:1024 sc1 lds
    v_mfma_f32_16x16x32_bf16 v[228:231], a[132:135], v[112:115], v[228:231]
    ds_read_b64_tr_b16 a[208:209], v152 offset:16384
    v_mfma_f32_16x16x32_bf16 v[236:239], a[132:135], v[120:123], v[236:239]
    ds_read_b64_tr_b16 a[210:211], v152 offset:17408
    v_mfma_f32_16x16x32_bf16 v[236:239], a[140:143], v[124:127], v[236:239]
    buffer_load_dwordx4 v158, s[44:47], s80 offen offset:2048 sc1 lds
    v_mfma_f32_16x16x32_bf16 v[232:235], a[136:139], v[124:127], v[232:235]
    ds_read_b64_tr_b16 a[212:213], v153 offset:16384
    v_mfma_f32_16x16x32_bf16 v[232:235], a[128:131], v[120:123], v[232:235]
    ds_read_b64_tr_b16 a[214:215], v153 offset:17408
    s_waitcnt lgkmcnt(4)
    v_mfma_f32_16x16x32_bf16 v[192:195], a[144:147], v[80:83], v[192:195]
    s_add_u32 m0, s73, 65536
    s_lshl_b32 s14, s84, 18
    v_mfma_f32_16x16x32_bf16 v[192:195], a[152:155], v[84:87], v[192:195]
    ds_read_b128 v[104:107], v250 offset:768
    v_mfma_f32_16x16x32_bf16 v[196:199], a[156:159], v[84:87], v[196:199]
    ds_read_b128 v[108:111], v250 offset:6912
    buffer_load_dwordx4 v4, s[52:55], s14 offen offset:0 lds
    v_mfma_f32_16x16x32_bf16 v[196:199], a[148:151], v[80:83], v[196:199]
    ds_read_b128 v[112:115], v250 offset:1024
    v_mfma_f32_16x16x32_bf16 v[204:207], a[148:151], v[88:91], v[204:207]
    ds_read_b128 v[116:119], v250 offset:7168
    buffer_load_dwordx4 v5, s[52:55], s14 offen offset:1024 lds
    v_mfma_f32_16x16x32_bf16 v[204:207], a[156:159], v[92:95], v[204:207]
    ds_read_b128 v[120:123], v250 offset:1280
    v_mfma_f32_16x16x32_bf16 v[200:203], a[152:155], v[92:95], v[200:203]
    ds_read_b128 v[124:127], v250 offset:7424
    v_mfma_f32_16x16x32_bf16 v[200:203], a[144:147], v[88:91], v[200:203]
    ds_read_b64_tr_b16 a[216:217], v152 offset:24576
    buffer_load_dwordx4 v6, s[52:55], s14 offen offset:2048 lds
    v_mfma_f32_16x16x32_bf16 v[208:211], a[144:147], v[96:99], v[208:211]
    ds_read_b64_tr_b16 a[218:219], v152 offset:25600
    v_mfma_f32_16x16x32_bf16 v[208:211], a[152:155], v[100:103], v[208:211]
    buffer_load_dwordx4 v7, s[52:55], s14 offen offset:3072 lds
    v_mfma_f32_16x16x32_bf16 v[212:215], a[156:159], v[100:103], v[212:215]
    ds_read_b64_tr_b16 a[220:221], v153 offset:24576
    v_mfma_f32_16x16x32_bf16 v[212:215], a[148:151], v[96:99], v[212:215]
    ds_read_b64_tr_b16 a[222:223], v153 offset:25600
    s_waitcnt lgkmcnt(4)
    v_mfma_f32_16x16x32_bf16 v[220:223], a[148:151], v[104:107], v[220:223]
    s_waitcnt vmcnt(14)
    s_barrier
    v_mfma_f32_16x16x32_bf16 v[220:223], a[156:159], v[108:111], v[220:223]
    ds_read_b128 v[80:83], v250 offset:12288
    v_mfma_f32_16x16x32_bf16 v[216:219], a[152:155], v[108:111], v[216:219]
    ds_read_b128 v[84:87], v250 offset:18432
    v_mfma_f32_16x16x32_bf16 v[216:219], a[144:147], v[104:107], v[216:219]
    ds_read_b128 v[88:91], v250 offset:12544
    v_mfma_f32_16x16x32_bf16 v[224:227], a[144:147], v[112:115], v[224:227]
    ds_read_b128 v[92:95], v250 offset:18688
    v_mfma_f32_16x16x32_bf16 v[224:227], a[152:155], v[116:119], v[224:227]
    ds_read_b128 v[96:99], v250 offset:12800
    v_mfma_f32_16x16x32_bf16 v[228:231], a[156:159], v[116:119], v[228:231]
    ds_read_b128 v[100:103], v250 offset:18944
    v_mfma_f32_16x16x32_bf16 v[228:231], a[148:151], v[112:115], v[228:231]
    ds_read_b64_tr_b16 a[224:225], v152 offset:32768
    v_mfma_f32_16x16x32_bf16 v[236:239], a[148:151], v[120:123], v[236:239]
    ds_read_b64_tr_b16 a[226:227], v152 offset:33792
    v_mfma_f32_16x16x32_bf16 v[236:239], a[156:159], v[124:127], v[236:239]
    v_mfma_f32_16x16x32_bf16 v[232:235], a[152:155], v[124:127], v[232:235]
    ds_read_b64_tr_b16 a[228:229], v153 offset:32768
    v_mfma_f32_16x16x32_bf16 v[232:235], a[144:147], v[120:123], v[232:235]
    ds_read_b64_tr_b16 a[230:231], v153 offset:33792
    s_waitcnt lgkmcnt(4)
    v_mfma_f32_16x16x32_bf16 v[192:195], a[160:163], v[80:83], v[192:195]
    v_mfma_f32_16x16x32_bf16 v[192:195], a[168:171], v[84:87], v[192:195]
    ds_read_b128 v[104:107], v250 offset:13056
    v_mfma_f32_16x16x32_bf16 v[196:199], a[172:175], v[84:87], v[196:199]
    ds_read_b128 v[108:111], v250 offset:19200
    v_mfma_f32_16x16x32_bf16 v[196:199], a[164:167], v[80:83], v[196:199]
    ds_read_b128 v[112:115], v250 offset:13312
    v_mfma_f32_16x16x32_bf16 v[204:207], a[164:167], v[88:91], v[204:207]
    ds_read_b128 v[116:119], v250 offset:19456
    v_mfma_f32_16x16x32_bf16 v[204:207], a[172:175], v[92:95], v[204:207]
    ds_read_b128 v[120:123], v250 offset:13568
    v_mfma_f32_16x16x32_bf16 v[200:203], a[168:171], v[92:95], v[200:203]
    ds_read_b128 v[124:127], v250 offset:19712
    v_mfma_f32_16x16x32_bf16 v[200:203], a[160:163], v[88:91], v[200:203]
    ds_read_b64_tr_b16 a[232:233], v152 offset:40960
    v_mfma_f32_16x16x32_bf16 v[208:211], a[160:163], v[96:99], v[208:211]
    ds_read_b64_tr_b16 a[234:235], v152 offset:41984
    v_mfma_f32_16x16x32_bf16 v[208:211], a[168:171], v[100:103], v[208:211]
    v_mfma_f32_16x16x32_bf16 v[212:215], a[172:175], v[100:103], v[212:215]
    ds_read_b64_tr_b16 a[236:237], v153 offset:40960
    v_mfma_f32_16x16x32_bf16 v[212:215], a[164:167], v[96:99], v[212:215]
    ds_read_b64_tr_b16 a[238:239], v153 offset:41984
    s_waitcnt lgkmcnt(4)
    v_mfma_f32_16x16x32_bf16 v[220:223], a[164:167], v[104:107], v[220:223]
    s_waitcnt vmcnt(7)
    s_barrier
    v_mfma_f32_16x16x32_bf16 v[220:223], a[172:175], v[108:111], v[220:223]
    ds_read_b128 v[80:83], v250 offset:24576
    v_mfma_f32_16x16x32_bf16 v[216:219], a[168:171], v[108:111], v[216:219]
    ds_read_b128 v[84:87], v250 offset:30720
    v_mfma_f32_16x16x32_bf16 v[216:219], a[160:163], v[104:107], v[216:219]
    ds_read_b128 v[88:91], v250 offset:24832
    v_mfma_f32_16x16x32_bf16 v[224:227], a[160:163], v[112:115], v[224:227]
    ds_read_b128 v[92:95], v250 offset:30976
    v_mfma_f32_16x16x32_bf16 v[224:227], a[168:171], v[116:119], v[224:227]
    ds_read_b128 v[96:99], v250 offset:25088
    v_mfma_f32_16x16x32_bf16 v[228:231], a[172:175], v[116:119], v[228:231]
    ds_read_b128 v[100:103], v250 offset:31232
    v_mfma_f32_16x16x32_bf16 v[228:231], a[164:167], v[112:115], v[228:231]
    ds_read_b64_tr_b16 a[240:241], v152 offset:49152
    v_mfma_f32_16x16x32_bf16 v[236:239], a[164:167], v[120:123], v[236:239]
    ds_read_b64_tr_b16 a[242:243], v152 offset:50176
    v_mfma_f32_16x16x32_bf16 v[236:239], a[172:175], v[124:127], v[236:239]
    v_mfma_f32_16x16x32_bf16 v[232:235], a[168:171], v[124:127], v[232:235]
    ds_read_b64_tr_b16 a[244:245], v153 offset:49152
    v_mfma_f32_16x16x32_bf16 v[232:235], a[160:163], v[120:123], v[232:235]
    ds_read_b64_tr_b16 a[246:247], v153 offset:50176
    s_waitcnt lgkmcnt(4)
    v_mfma_f32_16x16x32_bf16 v[192:195], a[176:179], v[80:83], v[192:195]
    v_mfma_f32_16x16x32_bf16 v[192:195], a[184:187], v[84:87], v[192:195]
    ds_read_b128 v[104:107], v250 offset:25344
    v_mfma_f32_16x16x32_bf16 v[196:199], a[188:191], v[84:87], v[196:199]
    ds_read_b128 v[108:111], v250 offset:31488
    v_mfma_f32_16x16x32_bf16 v[196:199], a[180:183], v[80:83], v[196:199]
    ds_read_b128 v[112:115], v250 offset:25600
    v_mfma_f32_16x16x32_bf16 v[204:207], a[180:183], v[88:91], v[204:207]
    ds_read_b128 v[116:119], v250 offset:31744
    v_mfma_f32_16x16x32_bf16 v[204:207], a[188:191], v[92:95], v[204:207]
    ds_read_b128 v[120:123], v250 offset:25856
    v_mfma_f32_16x16x32_bf16 v[200:203], a[184:187], v[92:95], v[200:203]
    ds_read_b128 v[124:127], v250 offset:32000
    v_mfma_f32_16x16x32_bf16 v[200:203], a[176:179], v[88:91], v[200:203]
    ds_read_b64_tr_b16 a[248:249], v152 offset:57344
    v_mfma_f32_16x16x32_bf16 v[208:211], a[176:179], v[96:99], v[208:211]
    ds_read_b64_tr_b16 a[250:251], v152 offset:58368
    v_mfma_f32_16x16x32_bf16 v[208:211], a[184:187], v[100:103], v[208:211]
    v_mfma_f32_16x16x32_bf16 v[212:215], a[188:191], v[100:103], v[212:215]
    ds_read_b64_tr_b16 a[252:253], v153 offset:57344
    v_mfma_f32_16x16x32_bf16 v[212:215], a[180:183], v[96:99], v[212:215]
    ds_read_b64_tr_b16 a[254:255], v153 offset:58368
    s_waitcnt lgkmcnt(4)
    v_mfma_f32_16x16x32_bf16 v[220:223], a[180:183], v[104:107], v[220:223]
    s_barrier
    v_mfma_f32_16x16x32_bf16 v[220:223], a[188:191], v[108:111], v[220:223]
    ds_read_b128 v[80:83], v159 offset:0
    s_add_u32 m0, s74, 36864
    v_mfma_f32_16x16x32_bf16 v[216:219], a[184:187], v[108:111], v[216:219]
    ds_read_b128 v[84:87], v159 offset:6144
    v_mfma_f32_16x16x32_bf16 v[216:219], a[176:179], v[104:107], v[216:219]
    ds_read_b128 v[88:91], v159 offset:256
    buffer_load_dwordx4 v156, s[44:47], s81 offen offset:0 sc1 lds
    v_mfma_f32_16x16x32_bf16 v[224:227], a[176:179], v[112:115], v[224:227]
    ds_read_b128 v[92:95], v159 offset:6400
    v_mfma_f32_16x16x32_bf16 v[224:227], a[184:187], v[116:119], v[224:227]
    ds_read_b128 v[96:99], v159 offset:512
    v_mfma_f32_16x16x32_bf16 v[228:231], a[188:191], v[116:119], v[228:231]
    ds_read_b128 v[100:103], v159 offset:6656
    buffer_load_dwordx4 v157, s[44:47], s81 offen offset:1024 sc1 lds
    v_mfma_f32_16x16x32_bf16 v[228:231], a[180:183], v[112:115], v[228:231]
    v_mfma_f32_16x16x32_bf16 v[236:239], a[180:183], v[120:123], v[236:239]
    v_mfma_f32_16x16x32_bf16 v[236:239], a[188:191], v[124:127], v[236:239]
    buffer_load_dwordx4 v158, s[44:47], s81 offen offset:2048 sc1 lds
    v_mfma_f32_16x16x32_bf16 v[232:235], a[184:187], v[124:127], v[232:235]
    v_mfma_f32_16x16x32_bf16 v[232:235], a[176:179], v[120:123], v[232:235]
    s_waitcnt lgkmcnt(0)
    v_mfma_f32_16x16x32_bf16 v[192:195], a[192:195], v[80:83], v[192:195]
    s_and_b32 s13, s70, 1
    s_mul_i32 s13, s13, 3072
    v_mfma_f32_16x16x32_bf16 v[192:195], a[200:203], v[84:87], v[192:195]
    ds_read_b128 v[104:107], v159 offset:768
    s_sub_u32 s13, s13, 1536
    v_mfma_f32_16x16x32_bf16 v[196:199], a[204:207], v[84:87], v[196:199]
    ds_read_b128 v[108:111], v159 offset:6912
    v_add_u32 v156, s13, v156
    v_mfma_f32_16x16x32_bf16 v[196:199], a[196:199], v[80:83], v[196:199]
    ds_read_b128 v[112:115], v159 offset:1024
    v_mfma_f32_16x16x32_bf16 v[204:207], a[196:199], v[88:91], v[204:207]
    ds_read_b128 v[116:119], v159 offset:7168
    v_add_u32 v157, s13, v157
    v_mfma_f32_16x16x32_bf16 v[204:207], a[204:207], v[92:95], v[204:207]
    ds_read_b128 v[120:123], v159 offset:1280
    v_add_u32 v158, s13, v158
    v_mfma_f32_16x16x32_bf16 v[200:203], a[200:203], v[92:95], v[200:203]
    ds_read_b128 v[124:127], v159 offset:7424
    s_add_u32 m0, s74, 49152
    v_mfma_f32_16x16x32_bf16 v[200:203], a[192:195], v[88:91], v[200:203]
    v_mfma_f32_16x16x32_bf16 v[208:211], a[192:195], v[96:99], v[208:211]
    buffer_load_dwordx4 v156, s[44:47], s18 offen offset:0 sc1 lds
    v_mfma_f32_16x16x32_bf16 v[208:211], a[200:203], v[100:103], v[208:211]
    buffer_load_dwordx4 v157, s[44:47], s18 offen offset:1024 sc1 lds
    v_mfma_f32_16x16x32_bf16 v[212:215], a[204:207], v[100:103], v[212:215]
    buffer_load_dwordx4 v158, s[44:47], s18 offen offset:2048 sc1 lds
    v_mfma_f32_16x16x32_bf16 v[212:215], a[196:199], v[96:99], v[212:215]
    s_waitcnt lgkmcnt(0)
    v_mfma_f32_16x16x32_bf16 v[220:223], a[196:199], v[104:107], v[220:223]
    s_barrier
    v_mfma_f32_16x16x32_bf16 v[220:223], a[204:207], v[108:111], v[220:223]
    ds_read_b128 v[80:83], v159 offset:12288
    s_add_u32 m0, s74, 61440
    v_mfma_f32_16x16x32_bf16 v[216:219], a[200:203], v[108:111], v[216:219]
    ds_read_b128 v[84:87], v159 offset:18432
    v_mfma_f32_16x16x32_bf16 v[216:219], a[192:195], v[104:107], v[216:219]
    ds_read_b128 v[88:91], v159 offset:12544
    buffer_load_dwordx4 v156, s[44:47], s19 offen offset:0 sc1 lds
    v_mfma_f32_16x16x32_bf16 v[224:227], a[192:195], v[112:115], v[224:227]
    ds_read_b128 v[92:95], v159 offset:18688
    v_mfma_f32_16x16x32_bf16 v[224:227], a[200:203], v[116:119], v[224:227]
    ds_read_b128 v[96:99], v159 offset:12800
    v_mfma_f32_16x16x32_bf16 v[228:231], a[204:207], v[116:119], v[228:231]
    ds_read_b128 v[100:103], v159 offset:18944
    buffer_load_dwordx4 v157, s[44:47], s19 offen offset:1024 sc1 lds
    v_mfma_f32_16x16x32_bf16 v[228:231], a[196:199], v[112:115], v[228:231]
    v_mfma_f32_16x16x32_bf16 v[236:239], a[196:199], v[120:123], v[236:239]
    v_mfma_f32_16x16x32_bf16 v[236:239], a[204:207], v[124:127], v[236:239]
    buffer_load_dwordx4 v158, s[44:47], s19 offen offset:2048 sc1 lds
    v_mfma_f32_16x16x32_bf16 v[232:235], a[200:203], v[124:127], v[232:235]
    v_mfma_f32_16x16x32_bf16 v[232:235], a[192:195], v[120:123], v[232:235]
    s_waitcnt lgkmcnt(0)
    v_mfma_f32_16x16x32_bf16 v[192:195], a[208:211], v[80:83], v[192:195]
    s_add_u32 m0, s74, 0
    v_mfma_f32_16x16x32_bf16 v[192:195], a[216:219], v[84:87], v[192:195]
    ds_read_b128 v[104:107], v159 offset:13056
    v_mfma_f32_16x16x32_bf16 v[196:199], a[220:223], v[84:87], v[196:199]
    ds_read_b128 v[108:111], v159 offset:19200
    v_mfma_f32_16x16x32_bf16 v[196:199], a[212:215], v[80:83], v[196:199]
    ds_read_b128 v[112:115], v159 offset:13312
    buffer_load_dwordx4 v156, s[44:47], s20 offen offset:0 sc1 lds
    v_mfma_f32_16x16x32_bf16 v[204:207], a[212:215], v[88:91], v[204:207]
    ds_read_b128 v[116:119], v159 offset:19456
    v_mfma_f32_16x16x32_bf16 v[204:207], a[220:223], v[92:95], v[204:207]
    ds_read_b128 v[120:123], v159 offset:13568
    v_mfma_f32_16x16x32_bf16 v[200:203], a[216:219], v[92:95], v[200:203]
    ds_read_b128 v[124:127], v159 offset:19712
    buffer_load_dwordx4 v157, s[44:47], s20 offen offset:1024 sc1 lds
    v_mfma_f32_16x16x32_bf16 v[200:203], a[208:211], v[88:91], v[200:203]
    v_mfma_f32_16x16x32_bf16 v[208:211], a[208:211], v[96:99], v[208:211]
    v_mfma_f32_16x16x32_bf16 v[208:211], a[216:219], v[100:103], v[208:211]
    buffer_load_dwordx4 v158, s[44:47], s20 offen offset:2048 sc1 lds
    v_mfma_f32_16x16x32_bf16 v[212:215], a[220:223], v[100:103], v[212:215]
    v_mfma_f32_16x16x32_bf16 v[212:215], a[212:215], v[96:99], v[212:215]
    s_waitcnt lgkmcnt(0)
    v_mfma_f32_16x16x32_bf16 v[220:223], a[212:215], v[104:107], v[220:223]
    s_waitcnt vmcnt(16)
    s_barrier
    v_mfma_f32_16x16x32_bf16 v[220:223], a[220:223], v[108:111], v[220:223]
    ds_read_b128 v[80:83], v159 offset:24576
    s_add_u32 m0, s74, 12288
    v_mfma_f32_16x16x32_bf16 v[216:219], a[216:219], v[108:111], v[216:219]
    ds_read_b128 v[84:87], v159 offset:30720
    v_mfma_f32_16x16x32_bf16 v[216:219], a[208:211], v[104:107], v[216:219]
    ds_read_b128 v[88:91], v159 offset:24832
    buffer_load_dwordx4 v156, s[44:47], s21 offen offset:0 sc1 lds
    v_mfma_f32_16x16x32_bf16 v[224:227], a[208:211], v[112:115], v[224:227]
    ds_read_b128 v[92:95], v159 offset:30976
    v_mfma_f32_16x16x32_bf16 v[224:227], a[216:219], v[116:119], v[224:227]
    ds_read_b128 v[96:99], v159 offset:25088
    v_mfma_f32_16x16x32_bf16 v[228:231], a[220:223], v[116:119], v[228:231]
    ds_read_b128 v[100:103], v159 offset:31232
    buffer_load_dwordx4 v157, s[44:47], s21 offen offset:1024 sc1 lds
    v_mfma_f32_16x16x32_bf16 v[228:231], a[212:215], v[112:115], v[228:231]
    v_mfma_f32_16x16x32_bf16 v[236:239], a[212:215], v[120:123], v[236:239]
    v_mfma_f32_16x16x32_bf16 v[236:239], a[220:223], v[124:127], v[236:239]
    buffer_load_dwordx4 v158, s[44:47], s21 offen offset:2048 sc1 lds
    v_mfma_f32_16x16x32_bf16 v[232:235], a[216:219], v[124:127], v[232:235]
    v_mfma_f32_16x16x32_bf16 v[232:235], a[208:211], v[120:123], v[232:235]
    s_waitcnt lgkmcnt(0)
    v_mfma_f32_16x16x32_bf16 v[192:195], a[224:227], v[80:83], v[192:195]
    s_add_u32 m0, s73, 0
    s_lshl_b32 s14, s85, 18
    v_mfma_f32_16x16x32_bf16 v[192:195], a[232:235], v[84:87], v[192:195]
    ds_read_b128 v[104:107], v159 offset:25344
    v_mfma_f32_16x16x32_bf16 v[196:199], a[236:239], v[84:87], v[196:199]
    ds_read_b128 v[108:111], v159 offset:31488
    buffer_load_dwordx4 v4, s[52:55], s14 offen offset:0 lds
    v_mfma_f32_16x16x32_bf16 v[196:199], a[228:231], v[80:83], v[196:199]
    ds_read_b128 v[112:115], v159 offset:25600
    v_mfma_f32_16x16x32_bf16 v[204:207], a[228:231], v[88:91], v[204:207]
    ds_read_b128 v[116:119], v159 offset:31744
    buffer_load_dwordx4 v5, s[52:55], s14 offen offset:1024 lds
    v_mfma_f32_16x16x32_bf16 v[204:207], a[236:239], v[92:95], v[204:207]
    ds_read_b128 v[120:123], v159 offset:25856
    v_mfma_f32_16x16x32_bf16 v[200:203], a[232:235], v[92:95], v[200:203]
    ds_read_b128 v[124:127], v159 offset:32000
    v_mfma_f32_16x16x32_bf16 v[200:203], a[224:227], v[88:91], v[200:203]
    buffer_load_dwordx4 v6, s[52:55], s14 offen offset:2048 lds
    v_mfma_f32_16x16x32_bf16 v[208:211], a[224:227], v[96:99], v[208:211]
    v_mfma_f32_16x16x32_bf16 v[208:211], a[232:235], v[100:103], v[208:211]
    buffer_load_dwordx4 v7, s[52:55], s14 offen offset:3072 lds
    v_mfma_f32_16x16x32_bf16 v[212:215], a[236:239], v[100:103], v[212:215]
    v_mfma_f32_16x16x32_bf16 v[212:215], a[228:231], v[96:99], v[212:215]
    s_waitcnt lgkmcnt(0)
    v_mfma_f32_16x16x32_bf16 v[220:223], a[228:231], v[104:107], v[220:223]
    s_waitcnt vmcnt(16)
    s_barrier
    v_mfma_f32_16x16x32_bf16 v[220:223], a[236:239], v[108:111], v[220:223]
    ds_read_b128 v[80:83], v250 offset:0
    v_mfma_f32_16x16x32_bf16 v[216:219], a[232:235], v[108:111], v[216:219]
    ds_read_b128 v[84:87], v250 offset:6144
    v_mfma_f32_16x16x32_bf16 v[216:219], a[224:227], v[104:107], v[216:219]
    ds_read_b128 v[88:91], v250 offset:256
    v_mfma_f32_16x16x32_bf16 v[224:227], a[224:227], v[112:115], v[224:227]
    ds_read_b128 v[92:95], v250 offset:6400
    v_mfma_f32_16x16x32_bf16 v[224:227], a[232:235], v[116:119], v[224:227]
    ds_read_b128 v[96:99], v250 offset:512
    v_mfma_f32_16x16x32_bf16 v[228:231], a[236:239], v[116:119], v[228:231]
L_pl_G_3:
    s_cbranch_execz L_wret
    ds_read_b128 v[100:103], v250 offset:6656
    v_mfma_f32_16x16x32_bf16 v[228:231], a[228:231], v[112:115], v[228:231]
    v_mfma_f32_16x16x32_bf16 v[236:239], a[228:231], v[120:123], v[236:239]
    v_mfma_f32_16x16x32_bf16 v[236:239], a[236:239], v[124:127], v[236:239]
    v_mfma_f32_16x16x32_bf16 v[232:235], a[232:235], v[124:127], v[232:235]
    v_mfma_f32_16x16x32_bf16 v[232:235], a[224:227], v[120:123], v[232:235]
    s_waitcnt lgkmcnt(0)
    v_mfma_f32_16x16x32_bf16 v[192:195], a[240:243], v[80:83], v[192:195]
    v_mfma_f32_16x16x32_bf16 v[192:195], a[248:251], v[84:87], v[192:195]
    ds_read_b128 v[104:107], v250 offset:768
    v_mfma_f32_16x16x32_bf16 v[196:199], a[252:255], v[84:87], v[196:199]
    ds_read_b128 v[108:111], v250 offset:6912
    v_mfma_f32_16x16x32_bf16 v[196:199], a[244:247], v[80:83], v[196:199]
    ds_read_b128 v[112:115], v250 offset:1024
    v_mfma_f32_16x16x32_bf16 v[204:207], a[244:247], v[88:91], v[204:207]
    ds_read_b128 v[116:119], v250 offset:7168
    v_mfma_f32_16x16x32_bf16 v[204:207], a[252:255], v[92:95], v[204:207]
    ds_read_b128 v[120:123], v250 offset:1280
    v_mfma_f32_16x16x32_bf16 v[200:203], a[248:251], v[92:95], v[200:203]
    ds_read_b128 v[124:127], v250 offset:7424
    v_mfma_f32_16x16x32_bf16 v[200:203], a[240:243], v[88:91], v[200:203]
    v_mfma_f32_16x16x32_bf16 v[208:211], a[240:243], v[96:99], v[208:211]
    v_mfma_f32_16x16x32_bf16 v[208:211], a[248:251], v[100:103], v[208:211]
    v_mfma_f32_16x16x32_bf16 v[212:215], a[252:255], v[100:103], v[212:215]
    v_mfma_f32_16x16x32_bf16 v[212:215], a[244:247], v[96:99], v[212:215]
    s_waitcnt lgkmcnt(0)
    v_mfma_f32_16x16x32_bf16 v[220:223], a[244:247], v[104:107], v[220:223]
    s_waitcnt vmcnt(13)
    s_barrier
    v_mfma_f32_16x16x32_bf16 v[220:223], a[252:255], v[108:111], v[220:223]
    ds_read_b128 v[80:83], v250 offset:12288
    v_mfma_f32_16x16x32_bf16 v[216:219], a[248:251], v[108:111], v[216:219]
    ds_read_b128 v[84:87], v250 offset:18432
    v_mfma_f32_16x16x32_bf16 v[216:219], a[240:243], v[104:107], v[216:219]
    ds_read_b128 v[88:91], v250 offset:12544
    v_mfma_f32_16x16x32_bf16 v[224:227], a[240:243], v[112:115], v[224:227]
    ds_read_b128 v[92:95], v250 offset:18688
    v_cvt_pk_bf16_f32 v192, v192, v193
    v_mfma_f32_16x16x32_bf16 v[224:227], a[248:251], v[116:119], v[224:227]
    ds_read_b128 v[96:99], v250 offset:12800
    v_mfma_f32_16x16x32_bf16 v[228:231], a[252:255], v[116:119], v[228:231]
    ds_read_b128 v[100:103], v250 offset:18944
    v_cvt_pk_bf16_f32 v193, v194, v195
    v_mfma_f32_16x16x32_bf16 v[228:231], a[244:247], v[112:115], v[228:231]
    v_mfma_f32_16x16x32_bf16 v[236:239], a[244:247], v[120:123], v[236:239]
    v_cvt_pk_bf16_f32 v194, v196, v197
    v_mfma_f32_16x16x32_bf16 v[236:239], a[252:255], v[124:127], v[236:239]
    v_cvt_pk_bf16_f32 v195, v198, v199
    v_mfma_f32_16x16x32_bf16 v[232:235], a[248:251], v[124:127], v[232:235]
    v_mfma_f32_16x16x32_bf16 v[232:235], a[240:243], v[120:123], v[232:235]
    buffer_store_dwordx4 v[192:195], v246, s[44:47], s9 offen offset:0 sc1
    s_waitcnt lgkmcnt(0)
    v_mfma_f32_16x16x32_bf16 v[32:35], a[0:3], v[80:83], v[128:131]
    v_mfma_f32_16x16x32_bf16 v[32:35], a[8:11], v[84:87], v[32:35]
    ds_read_b128 v[104:107], v250 offset:13056
    v_mfma_f32_16x16x32_bf16 v[36:39], a[12:15], v[84:87], v[132:135]
    ds_read_b128 v[108:111], v250 offset:19200
    v_mfma_f32_16x16x32_bf16 v[36:39], a[4:7], v[80:83], v[36:39]
    ds_read_b128 v[112:115], v250 offset:13312
    v_mfma_f32_16x16x32_bf16 v[44:47], a[4:7], v[88:91], v[132:135]
    ds_read_b128 v[116:119], v250 offset:19456
    v_cvt_pk_bf16_f32 v200, v200, v201
    v_mfma_f32_16x16x32_bf16 v[44:47], a[12:15], v[92:95], v[44:47]
    ds_read_b128 v[120:123], v250 offset:13568
    v_mfma_f32_16x16x32_bf16 v[40:43], a[8:11], v[92:95], v[128:131]
    ds_read_b128 v[124:127], v250 offset:19712
    v_cvt_pk_bf16_f32 v201, v202, v203
    v_mfma_f32_16x16x32_bf16 v[40:43], a[0:3], v[88:91], v[40:43]
    v_mfma_f32_16x16x32_bf16 v[48:51], a[0:3], v[96:99], v[128:131]
    v_cvt_pk_bf16_f32 v202, v204, v205
    v_mfma_f32_16x16x32_bf16 v[48:51], a[8:11], v[100:103], v[48:51]
    v_cvt_pk_bf16_f32 v203, v206, v207
    v_mfma_f32_16x16x32_bf16 v[52:55], a[12:15], v[100:103], v[132:135]
    v_mfma_f32_16x16x32_bf16 v[52:55], a[4:7], v[96:99], v[52:55]
    buffer_store_dwordx4 v[200:203], v246, s[44:47], s9 offen offset:1024 sc1
    s_waitcnt lgkmcnt(0)
    v_mfma_f32_16x16x32_bf16 v[60:63], a[4:7], v[104:107], v[132:135]
    s_waitcnt vmcnt(12)
    s_barrier
    v_mfma_f32_16x16x32_bf16 v[60:63], a[12:15], v[108:111], v[60:63]
    ds_read_b128 v[80:83], v250 offset:24576
    s_add_u32 m0, s74, 24576
    v_cvt_pk_bf16_f32 v208, v208, v209
    v_mfma_f32_16x16x32_bf16 v[56:59], a[8:11], v[108:111], v[128:131]
    ds_read_b128 v[84:87], v250 offset:30720
    v_mfma_f32_16x16x32_bf16 v[56:59], a[0:3], v[104:107], v[56:59]
    ds_read_b128 v[88:91], v250 offset:24832
    buffer_load_dwordx4 v156, s[44:47], s22 offen offset:0 sc1 lds
    v_mfma_f32_16x16x32_bf16 v[64:67], a[0:3], v[112:115], v[128:131]
    ds_read_b128 v[92:95], v250 offset:30976
    v_cvt_pk_bf16_f32 v209, v210, v211
    v_mfma_f32_16x16x32_bf16 v[64:67], a[8:11], v[116:119], v[64:67]
    ds_read_b128 v[96:99], v250 offset:25088
    v_cvt_pk_bf16_f32 v210, v212, v213
    v_mfma_f32_16x16x32_bf16 v[68:71], a[12:15], v[116:119], v[132:135]
    ds_read_b128 v[100:103], v250 offset:31232
    buffer_load_dwordx4 v157, s[44:47], s22 offen offset:1024 sc1 lds
    v_mfma_f32_16x16x32_bf16 v[68:71], a[4:7], v[112:115], v[68:71]
    v_mfma_f32_16x16x32_bf16 v[76:79], a[4:7], v[120:123], v[132:135]
    v_cvt_pk_bf16_f32 v211, v214, v215
    v_mfma_f32_16x16x32_bf16 v[76:79], a[12:15], v[124:127], v[76:79]
    buffer_load_dwordx4 v158, s[44:47], s22 offen offset:2048 sc1 lds
    v_mfma_f32_16x16x32_bf16 v[72:75], a[8:11], v[124:127], v[128:131]
    buffer_store_dwordx4 v[208:211], v246, s[44:47], s9 offen offset:2048 sc1
    v_mfma_f32_16x16x32_bf16 v[72:75], a[0:3], v[120:123], v[72:75]
    s_waitcnt lgkmcnt(0)
    v_mfma_f32_16x16x32_bf16 v[32:35], a[16:19], v[80:83], v[32:35]
    s_add_u32 m0, s74, 36864
    v_mfma_f32_16x16x32_bf16 v[32:35], a[24:27], v[84:87], v[32:35]
    ds_read_b128 v[104:107], v250 offset:25344
    v_cvt_pk_bf16_f32 v216, v216, v217
    v_mfma_f32_16x16x32_bf16 v[36:39], a[28:31], v[84:87], v[36:39]
    ds_read_b128 v[108:111], v250 offset:31488
    v_mfma_f32_16x16x32_bf16 v[36:39], a[20:23], v[80:83], v[36:39]
    ds_read_b128 v[112:115], v250 offset:25600
    buffer_load_dwordx4 v156, s[44:47], s23 offen offset:0 sc1 lds
    v_mfma_f32_16x16x32_bf16 v[44:47], a[20:23], v[88:91], v[44:47]
    ds_read_b128 v[116:119], v250 offset:31744
    v_cvt_pk_bf16_f32 v217, v218, v219
    v_mfma_f32_16x16x32_bf16 v[44:47], a[28:31], v[92:95], v[44:47]
    ds_read_b128 v[120:123], v250 offset:25856
    v_cvt_pk_bf16_f32 v218, v220, v221
    v_mfma_f32_16x16x32_bf16 v[40:43], a[24:27], v[92:95], v[40:43]
    ds_read_b128 v[124:127], v250 offset:32000
    buffer_load_dwordx4 v157, s[44:47], s23 offen offset:1024 sc1 lds
    v_mfma_f32_16x16x32_bf16 v[40:43], a[16:19], v[88:91], v[40:43]
    v_mfma_f32_16x16x32_bf16 v[48:51], a[16:19], v[96:99], v[48:51]
    v_cvt_pk_bf16_f32 v219, v222, v223
    v_mfma_f32_16x16x32_bf16 v[48:51], a[24:27], v[100:103], v[48:51]
    buffer_load_dwordx4 v158, s[44:47], s23 offen offset:2048 sc1 lds
    v_mfma_f32_16x16x32_bf16 v[52:55], a[28:31], v[100:103], v[52:55]
    buffer_store_dwordx4 v[216:219], v247, s[44:47], s9 offen offset:0 sc1
    v_mfma_f32_16x16x32_bf16 v[52:55], a[20:23], v[96:99], v[52:55]
    s_waitcnt lgkmcnt(0)
    v_mfma_f32_16x16x32_bf16 v[60:63], a[20:23], v[104:107], v[60:63]
    s_waitcnt vmcnt(17)
    s_barrier
    v_mfma_f32_16x16x32_bf16 v[60:63], a[28:31], v[108:111], v[60:63]
    ds_read_b128 v[80:83], v159 offset:0
    s_add_u32 m0, s74, 49152
    v_cvt_pk_bf16_f32 v224, v224, v225
    v_mfma_f32_16x16x32_bf16 v[56:59], a[24:27], v[108:111], v[56:59]
    ds_read_b128 v[84:87], v159 offset:6144
    v_mfma_f32_16x16x32_bf16 v[56:59], a[16:19], v[104:107], v[56:59]
    ds_read_b128 v[88:91], v159 offset:256
    buffer_load_dwordx4 v156, s[44:47], s24 offen offset:0 sc1 lds
    v_mfma_f32_16x16x32_bf16 v[64:67], a[16:19], v[112:115], v[64:67]
    ds_read_b128 v[92:95], v159 offset:6400
    v_cvt_pk_bf16_f32 v225, v226, v227
    v_mfma_f32_16x16x32_bf16 v[64:67], a[24:27], v[116:119], v[64:67]
    ds_read_b128 v[96:99], v159 offset:512
    v_cvt_pk_bf16_f32 v226, v228, v229
    v_mfma_f32_16x16x32_bf16 v[68:71], a[28:31], v[116:119], v[68:71]
    ds_read_b128 v[100:103], v159 offset:6656
    buffer_load_dwordx4 v157, s[44:47], s24 offen offset:1024 sc1 lds
    v_mfma_f32_16x16x32_bf16 v[68:71], a[20:23], v[112:115], v[68:71]
    v_add_u32 v10, 65536, v10
    v_mfma_f32_16x16x32_bf16 v[76:79], a[20:23], v[120:123], v[76:79]
    ds_read_b64_tr_b16 a[0:1], v10 offset:0
    v_cvt_pk_bf16_f32 v227, v230, v231
    v_mfma_f32_16x16x32_bf16 v[76:79], a[28:31], v[124:127], v[76:79]
    ds_read_b64_tr_b16 a[2:3], v10 offset:2048
    buffer_load_dwordx4 v158, s[44:47], s24 offen offset:2048 sc1 lds
    v_mfma_f32_16x16x32_bf16 v[72:75], a[24:27], v[124:127], v[72:75]
    buffer_store_dwordx4 v[224:227], v247, s[44:47], s9 offen offset:1024 sc1
    ds_read_b64_tr_b16 a[8:9], v10 offset:4096
    v_mfma_f32_16x16x32_bf16 v[72:75], a[16:19], v[120:123], v[72:75]
    ds_read_b64_tr_b16 a[10:11], v10 offset:6144
    s_waitcnt lgkmcnt(4)
    v_mfma_f32_16x16x32_bf16 v[32:35], a[32:35], v[80:83], v[32:35]
    s_add_u32 m0, s74, 61440
    v_mfma_f32_16x16x32_bf16 v[32:35], a[40:43], v[84:87], v[32:35]
    ds_read_b128 v[104:107], v159 offset:768
    v_cvt_pk_bf16_f32 v232, v232, v233
    v_mfma_f32_16x16x32_bf16 v[36:39], a[44:47], v[84:87], v[36:39]
    ds_read_b128 v[108:111], v159 offset:6912
    v_mfma_f32_16x16x32_bf16 v[36:39], a[36:39], v[80:83], v[36:39]
    ds_read_b128 v[112:115], v159 offset:1024
    buffer_load_dwordx4 v156, s[44:47], s25 offen offset:0 sc1 lds
    v_mfma_f32_16x16x32_bf16 v[44:47], a[36:39], v[88:91], v[44:47]
    ds_read_b128 v[116:119], v159 offset:7168
    v_cvt_pk_bf16_f32 v233, v234, v235
    v_mfma_f32_16x16x32_bf16 v[44:47], a[44:47], v[92:95], v[44:47]
    ds_read_b128 v[120:123], v159 offset:1280
    v_cvt_pk_bf16_f32 v234, v236, v237
    v_mfma_f32_16x16x32_bf16 v[40:43], a[40:43], v[92:95], v[40:43]
    ds_read_b128 v[124:127], v159 offset:7424
    buffer_load_dwordx4 v157, s[44:47], s25 offen offset:1024 sc1 lds
    v_mfma_f32_16x16x32_bf16 v[40:43], a[32:35], v[88:91], v[40:43]
    v_add_u32 v11, 65536, v11
    v_mfma_f32_16x16x32_bf16 v[48:51], a[32:35], v[96:99], v[48:51]
    ds_read_b64_tr_b16 a[4:5], v11 offset:0
    v_cvt_pk_bf16_f32 v235, v238, v239
    v_mfma_f32_16x16x32_bf16 v[48:51], a[40:43], v[100:103], v[48:51]
    ds_read_b64_tr_b16 a[6:7], v11 offset:2048
    buffer_load_dwordx4 v158, s[44:47], s25 offen offset:2048 sc1 lds
    v_mfma_f32_16x16x32_bf16 v[52:55], a[44:47], v[100:103], v[52:55]
    buffer_store_dwordx4 v[232:235], v247, s[44:47], s9 offen offset:2048 sc1
    ds_read_b64_tr_b16 a[12:13], v11 offset:4096
    v_mfma_f32_16x16x32_bf16 v[52:55], a[36:39], v[96:99], v[52:55]
    ds_read_b64_tr_b16 a[14:15], v11 offset:6144
    s_waitcnt lgkmcnt(4)
    v_mfma_f32_16x16x32_bf16 v[60:63], a[36:39], v[104:107], v[60:63]
    s_waitcnt vmcnt(18)
    s_barrier
    v_mfma_f32_16x16x32_bf16 v[60:63], a[44:47], v[108:111], v[60:63]
    ds_read_b128 v[80:83], v159 offset:12288
    s_add_u32 m0, s74, 0
    v_mfma_f32_16x16x32_bf16 v[56:59], a[40:43], v[108:111], v[56:59]
    ds_read_b128 v[84:87], v159 offset:18432
    v_mfma_f32_16x16x32_bf16 v[56:59], a[32:35], v[104:107], v[56:59]
    ds_read_b128 v[88:91], v159 offset:12544
    buffer_load_dwordx4 v156, s[44:47], s26 offen offset:0 sc1 lds
    v_mfma_f32_16x16x32_bf16 v[64:67], a[32:35], v[112:115], v[64:67]
    ds_read_b128 v[92:95], v159 offset:18688
    v_mfma_f32_16x16x32_bf16 v[64:67], a[40:43], v[116:119], v[64:67]
    ds_read_b128 v[96:99], v159 offset:12800
    v_mfma_f32_16x16x32_bf16 v[68:71], a[44:47], v[116:119], v[68:71]
    ds_read_b128 v[100:103], v159 offset:18944
    buffer_load_dwordx4 v157, s[44:47], s26 offen offset:1024 sc1 lds
    v_mfma_f32_16x16x32_bf16 v[68:71], a[36:39], v[112:115], v[68:71]
    v_add_u32 v10, -65536, v10
    v_mfma_f32_16x16x32_bf16 v[76:79], a[36:39], v[120:123], v[76:79]
    ds_read_b64_tr_b16 a[16:17], v10 offset:0
    v_mfma_f32_16x16x32_bf16 v[76:79], a[44:47], v[124:127], v[76:79]
    ds_read_b64_tr_b16 a[18:19], v10 offset:2048
    buffer_load_dwordx4 v158, s[44:47], s26 offen offset:2048 sc1 lds
    v_mfma_f32_16x16x32_bf16 v[72:75], a[40:43], v[124:127], v[72:75]
    ds_read_b64_tr_b16 a[24:25], v10 offset:4096
    v_mfma_f32_16x16x32_bf16 v[72:75], a[32:35], v[120:123], v[72:75]
    ds_read_b64_tr_b16 a[26:27], v10 offset:6144
    s_waitcnt lgkmcnt(4)
    v_mfma_f32_16x16x32_bf16 v[32:35], a[48:51], v[80:83], v[32:35]
    v_mfma_f32_16x16x32_bf16 v[32:35], a[56:59], v[84:87], v[32:35]
    ds_read_b128 v[104:107], v159 offset:13056
    v_mfma_f32_16x16x32_bf16 v[36:39], a[60:63], v[84:87], v[36:39]
    ds_read_b128 v[108:111], v159 offset:19200
    v_mfma_f32_16x16x32_bf16 v[36:39], a[52:55], v[80:83], v[36:39]
    ds_read_b128 v[112:115], v159 offset:13312
    v_mfma_f32_16x16x32_bf16 v[44:47], a[52:55], v[88:91], v[44:47]
    ds_read_b128 v[116:119], v159 offset:19456
    v_mfma_f32_16x16x32_bf16 v[44:47], a[60:63], v[92:95], v[44:47]
    ds_read_b128 v[120:123], v159 offset:13568
    v_mfma_f32_16x16x32_bf16 v[40:43], a[56:59], v[92:95], v[40:43]
    ds_read_b128 v[124:127], v159 offset:19712
    v_mfma_f32_16x16x32_bf16 v[40:43], a[48:51], v[88:91], v[40:43]
    v_add_u32 v11, -65536, v11
    v_mfma_f32_16x16x32_bf16 v[48:51], a[48:51], v[96:99], v[48:51]
    ds_read_b64_tr_b16 a[20:21], v11 offset:0
    v_mfma_f32_16x16x32_bf16 v[48:51], a[56:59], v[100:103], v[48:51]
    ds_read_b64_tr_b16 a[22:23], v11 offset:2048
    v_mfma_f32_16x16x32_bf16 v[52:55], a[60:63], v[100:103], v[52:55]
    ds_read_b64_tr_b16 a[28:29], v11 offset:4096
    v_mfma_f32_16x16x32_bf16 v[52:55], a[52:55], v[96:99], v[52:55]
    ds_read_b64_tr_b16 a[30:31], v11 offset:6144
    s_waitcnt lgkmcnt(4)
    v_mfma_f32_16x16x32_bf16 v[60:63], a[52:55], v[104:107], v[60:63]
    s_waitcnt vmcnt(16)
    s_barrier
    v_mfma_f32_16x16x32_bf16 v[60:63], a[60:63], v[108:111], v[60:63]
    ds_read_b128 v[80:83], v159 offset:24576
    s_add_u32 m0, s74, 12288
    v_mfma_f32_16x16x32_bf16 v[56:59], a[56:59], v[108:111], v[56:59]
    ds_read_b128 v[84:87], v159 offset:30720
    v_mfma_f32_16x16x32_bf16 v[56:59], a[48:51], v[104:107], v[56:59]
    ds_read_b128 v[88:91], v159 offset:24832
    buffer_load_dwordx4 v156, s[44:47], s27 offen offset:0 sc1 lds
    v_mfma_f32_16x16x32_bf16 v[64:67], a[48:51], v[112:115], v[64:67]
    ds_read_b128 v[92:95], v159 offset:30976
    v_mfma_f32_16x16x32_bf16 v[64:67], a[56:59], v[116:119], v[64:67]
    ds_read_b128 v[96:99], v159 offset:25088
    v_mfma_f32_16x16x32_bf16 v[68:71], a[60:63], v[116:119], v[68:71]
    ds_read_b128 v[100:103], v159 offset:31232
    buffer_load_dwordx4 v157, s[44:47], s27 offen offset:1024 sc1 lds
    v_mfma_f32_16x16x32_bf16 v[68:71], a[52:55], v[112:115], v[68:71]
    v_mfma_f32_16x16x32_bf16 v[76:79], a[52:55], v[120:123], v[76:79]
    v_mfma_f32_16x16x32_bf16 v[76:79], a[60:63], v[124:127], v[76:79]
    buffer_load_dwordx4 v158, s[44:47], s27 offen offset:2048 sc1 lds
    v_mfma_f32_16x16x32_bf16 v[72:75], a[56:59], v[124:127], v[72:75]
    v_mfma_f32_16x16x32_bf16 v[72:75], a[48:51], v[120:123], v[72:75]
    s_waitcnt lgkmcnt(0)
    v_mfma_f32_16x16x32_bf16 v[32:35], a[64:67], v[80:83], v[32:35]
    s_add_u32 m0, s73, 16384
    s_lshl_b32 s14, s86, 18
    v_mfma_f32_16x16x32_bf16 v[32:35], a[72:75], v[84:87], v[32:35]
    ds_read_b128 v[104:107], v159 offset:25344
    v_mfma_f32_16x16x32_bf16 v[36:39], a[76:79], v[84:87], v[36:39]
    ds_read_b128 v[108:111], v159 offset:31488
    buffer_load_dwordx4 v4, s[52:55], s14 offen offset:0 lds
    v_mfma_f32_16x16x32_bf16 v[36:39], a[68:71], v[80:83], v[36:39]
    ds_read_b128 v[112:115], v159 offset:25600
    v_mfma_f32_16x16x32_bf16 v[44:47], a[68:71], v[88:91], v[44:47]
    ds_read_b128 v[116:119], v159 offset:31744
    buffer_load_dwordx4 v5, s[52:55], s14 offen offset:1024 lds
    v_mfma_f32_16x16x32_bf16 v[44:47], a[76:79], v[92:95], v[44:47]
    ds_read_b128 v[120:123], v159 offset:25856
    v_mfma_f32_16x16x32_bf16 v[40:43], a[72:75], v[92:95], v[40:43]
    ds_read_b128 v[124:127], v159 offset:32000
    v_mfma_f32_16x16x32_bf16 v[40:43], a[64:67], v[88:91], v[40:43]
    buffer_load_dwordx4 v6, s[52:55], s14 offen offset:2048 lds
    v_mfma_f32_16x16x32_bf16 v[48:51], a[64:67], v[96:99], v[48:51]
    v_mfma_f32_16x16x32_bf16 v[48:51], a[72:75], v[100:103], v[48:51]
    buffer_load_dwordx4 v7, s[52:55], s14 offen offset:3072 lds
    v_mfma_f32_16x16x32_bf16 v[52:55], a[76:79], v[100:103], v[52:55]
    v_mfma_f32_16x16x32_bf16 v[52:55], a[68:71], v[96:99], v[52:55]
    s_waitcnt lgkmcnt(0)
    v_mfma_f32_16x16x32_bf16 v[60:63], a[68:71], v[104:107], v[60:63]
    s_waitcnt vmcnt(19)
    s_barrier
    v_mfma_f32_16x16x32_bf16 v[60:63], a[76:79], v[108:111], v[60:63]
    ds_read_b128 v[80:83], v250 offset:0
    v_mfma_f32_16x16x32_bf16 v[56:59], a[72:75], v[108:111], v[56:59]
    ds_read_b128 v[84:87], v250 offset:6144
    v_mfma_f32_16x16x32_bf16 v[56:59], a[64:67], v[104:107], v[56:59]
    ds_read_b128 v[88:91], v250 offset:256
    v_mfma_f32_16x16x32_bf16 v[64:67], a[64:67], v[112:115], v[64:67]
    ds_read_b128 v[92:95], v250 offset:6400
    v_mfma_f32_16x16x32_bf16 v[64:67], a[72:75], v[116:119], v[64:67]
    ds_read_b128 v[96:99], v250 offset:512
    v_mfma_f32_16x16x32_bf16 v[68:71], a[76:79], v[116:119], v[68:71]
    ds_read_b128 v[100:103], v250 offset:6656
    v_mfma_f32_16x16x32_bf16 v[68:71], a[68:71], v[112:115], v[68:71]
    v_mfma_f32_16x16x32_bf16 v[76:79], a[68:71], v[120:123], v[76:79]
    v_mfma_f32_16x16x32_bf16 v[76:79], a[76:79], v[124:127], v[76:79]
    v_mfma_f32_16x16x32_bf16 v[72:75], a[72:75], v[124:127], v[72:75]
    v_mfma_f32_16x16x32_bf16 v[72:75], a[64:67], v[120:123], v[72:75]
    s_waitcnt lgkmcnt(0)
    v_mfma_f32_16x16x32_bf16 v[32:35], a[80:83], v[80:83], v[32:35]
    v_mfma_f32_16x16x32_bf16 v[32:35], a[88:91], v[84:87], v[32:35]
    ds_read_b128 v[104:107], v250 offset:768
    v_mfma_f32_16x16x32_bf16 v[36:39], a[92:95], v[84:87], v[36:39]
    ds_read_b128 v[108:111], v250 offset:6912
    v_mfma_f32_16x16x32_bf16 v[36:39], a[84:87], v[80:83], v[36:39]
    ds_read_b128 v[112:115], v250 offset:1024
    v_mfma_f32_16x16x32_bf16 v[44:47], a[84:87], v[88:91], v[44:47]
    ds_read_b128 v[116:119], v250 offset:7168
    v_mfma_f32_16x16x32_bf16 v[44:47], a[92:95], v[92:95], v[44:47]
    ds_read_b128 v[120:123], v250 offset:1280
    v_mfma_f32_16x16x32_bf16 v[40:43], a[88:91], v[92:95], v[40:43]
    ds_read_b128 v[124:127], v250 offset:7424
    v_mfma_f32_16x16x32_bf16 v[40:43], a[80:83], v[88:91], v[40:43]
    s_waitcnt vmcnt(10)
    buffer_store_dword v249, v248, s[44:47], s6 offen sc1
    v_mfma_f32_16x16x32_bf16 v[48:51], a[80:83], v[96:99], v[48:51]
    v_mfma_f32_16x16x32_bf16 v[48:51], a[88:91], v[100:103], v[48:51]
    v_mfma_f32_16x16x32_bf16 v[52:55], a[92:95], v[100:103], v[52:55]
    v_mfma_f32_16x16x32_bf16 v[52:55], a[84:87], v[96:99], v[52:55]
    s_waitcnt lgkmcnt(0)
    v_mfma_f32_16x16x32_bf16 v[60:63], a[84:87], v[104:107], v[60:63]
    s_barrier
    v_mfma_f32_16x16x32_bf16 v[60:63], a[92:95], v[108:111], v[60:63]
    ds_read_b128 v[80:83], v250 offset:12288
    v_mfma_f32_16x16x32_bf16 v[56:59], a[88:91], v[108:111], v[56:59]
    ds_read_b128 v[84:87], v250 offset:18432
    v_mfma_f32_16x16x32_bf16 v[56:59], a[80:83], v[104:107], v[56:59]
    ds_read_b128 v[88:91], v250 offset:12544
    v_mfma_f32_16x16x32_bf16 v[64:67], a[80:83], v[112:115], v[64:67]
    ds_read_b128 v[92:95], v250 offset:18688
    v_mfma_f32_16x16x32_bf16 v[64:67], a[88:91], v[116:119], v[64:67]
    ds_read_b128 v[96:99], v250 offset:12800
    v_mfma_f32_16x16x32_bf16 v[68:71], a[92:95], v[116:119], v[68:71]
    ds_read_b128 v[100:103], v250 offset:18944
    v_mfma_f32_16x16x32_bf16 v[68:71], a[84:87], v[112:115], v[68:71]
    v_mfma_f32_16x16x32_bf16 v[76:79], a[84:87], v[120:123], v[76:79]
    v_mfma_f32_16x16x32_bf16 v[76:79], a[92:95], v[124:127], v[76:79]
    v_mfma_f32_16x16x32_bf16 v[72:75], a[88:91], v[124:127], v[72:75]
    v_mfma_f32_16x16x32_bf16 v[72:75], a[80:83], v[120:123], v[72:75]
    s_waitcnt lgkmcnt(0)
    v_mfma_f32_16x16x32_bf16 v[32:35], a[96:99], v[80:83], v[32:35]
    v_mfma_f32_16x16x32_bf16 v[32:35], a[104:107], v[84:87], v[32:35]
    ds_read_b128 v[104:107], v250 offset:13056
    v_mfma_f32_16x16x32_bf16 v[36:39], a[108:111], v[84:87], v[36:39]
    ds_read_b128 v[108:111], v250 offset:19200
    v_mfma_f32_16x16x32_bf16 v[36:39], a[100:103], v[80:83], v[36:39]
    ds_read_b128 v[112:115], v250 offset:13312
    v_mfma_f32_16x16x32_bf16 v[44:47], a[100:103], v[88:91], v[44:47]
    ds_read_b128 v[116:119], v250 offset:19456
    v_mfma_f32_16x16x32_bf16 v[44:47], a[108:111], v[92:95], v[44:47]
    ds_read_b128 v[120:123], v250 offset:13568
    v_mfma_f32_16x16x32_bf16 v[40:43], a[104:107], v[92:95], v[40:43]
    ds_read_b128 v[124:127], v250 offset:19712
    v_mfma_f32_16x16x32_bf16 v[40:43], a[96:99], v[88:91], v[40:43]
    v_mfma_f32_16x16x32_bf16 v[48:51], a[96:99], v[96:99], v[48:51]
    v_mfma_f32_16x16x32_bf16 v[48:51], a[104:107], v[100:103], v[48:51]
    v_mfma_f32_16x16x32_bf16 v[52:55], a[108:111], v[100:103], v[52:55]
    v_mfma_f32_16x16x32_bf16 v[52:55], a[100:103], v[96:99], v[52:55]
    s_waitcnt lgkmcnt(0)
    v_mfma_f32_16x16x32_bf16 v[60:63], a[100:103], v[104:107], v[60:63]
    s_barrier
    v_mfma_f32_16x16x32_bf16 v[60:63], a[108:111], v[108:111], v[60:63]
    ds_read_b128 v[80:83], v250 offset:24576
    s_add_u32 m0, s74, 24576
    v_mfma_f32_16x16x32_bf16 v[56:59], a[104:107], v[108:111], v[56:59]
    ds_read_b128 v[84:87], v250 offset:30720
    v_mfma_f32_16x16x32_bf16 v[56:59], a[96:99], v[104:107], v[56:59]
    ds_read_b128 v[88:91], v250 offset:24832
    buffer_load_dwordx4 v156, s[44:47], s76 offen offset:0 sc1 lds
    v_mfma_f32_16x16x32_bf16 v[64:67], a[96:99], v[112:115], v[64:67]
    ds_read_b128 v[92:95], v250 offset:30976
    v_mfma_f32_16x16x32_bf16 v[64:67], a[104:107], v[116:119], v[64:67]
    ds_read_b128 v[96:99], v250 offset:25088
    v_mfma_f32_16x16x32_bf16 v[68:71], a[108:111], v[116:119], v[68:71]
    ds_read_b128 v[100:103], v250 offset:31232
    buffer_load_dwordx4 v157, s[44:47], s76 offen offset:1024 sc1 lds
    v_mfma_f32_16x16x32_bf16 v[68:71], a[100:103], v[112:115], v[68:71]
    v_mfma_f32_16x16x32_bf16 v[76:79], a[100:103], v[120:123], v[76:79]
    v_mfma_f32_16x16x32_bf16 v[76:79], a[108:111], v[124:127], v[76:79]
    buffer_load_dwordx4 v158, s[44:47], s76 offen offset:2048 sc1 lds
    v_mfma_f32_16x16x32_bf16 v[72:75], a[104:107], v[124:127], v[72:75]
    v_mfma_f32_16x16x32_bf16 v[72:75], a[96:99], v[120:123], v[72:75]
    s_waitcnt lgkmcnt(0)
    v_mfma_f32_16x16x32_bf16 v[32:35], a[112:115], v[80:83], v[32:35]
    s_add_u32 m0, s74, 36864
    v_mfma_f32_16x16x32_bf16 v[32:35], a[120:123], v[84:87], v[32:35]
    ds_read_b128 v[104:107], v250 offset:25344
    v_mfma_f32_16x16x32_bf16 v[36:39], a[124:127], v[84:87], v[36:39]
    ds_read_b128 v[108:111], v250 offset:31488
    v_mfma_f32_16x16x32_bf16 v[36:39], a[116:119], v[80:83], v[36:39]
    ds_read_b128 v[112:115], v250 offset:25600
    buffer_load_dwordx4 v156, s[44:47], s77 offen offset:0 sc1 lds
    v_mfma_f32_16x16x32_bf16 v[44:47], a[116:119], v[88:91], v[44:47]
    ds_read_b128 v[116:119], v250 offset:31744
    v_mfma_f32_16x16x32_bf16 v[44:47], a[124:127], v[92:95], v[44:47]
    ds_read_b128 v[120:123], v250 offset:25856
    v_mfma_f32_16x16x32_bf16 v[40:43], a[120:123], v[92:95], v[40:43]
    ds_read_b128 v[124:127], v250 offset:32000
    buffer_load_dwordx4 v157, s[44:47], s77 offen offset:1024 sc1 lds
    v_mfma_f32_16x16x32_bf16 v[40:43], a[112:115], v[88:91], v[40:43]
    v_mfma_f32_16x16x32_bf16 v[48:51], a[112:115], v[96:99], v[48:51]
    v_mfma_f32_16x16x32_bf16 v[48:51], a[120:123], v[100:103], v[48:51]
    buffer_load_dwordx4 v158, s[44:47], s77 offen offset:2048 sc1 lds
    v_mfma_f32_16x16x32_bf16 v[52:55], a[124:127], v[100:103], v[52:55]
    v_mfma_f32_16x16x32_bf16 v[52:55], a[116:119], v[96:99], v[52:55]
    s_waitcnt lgkmcnt(0)
    v_mfma_f32_16x16x32_bf16 v[60:63], a[116:119], v[104:107], v[60:63]
    s_waitcnt vmcnt(14)
    s_barrier
    v_mfma_f32_16x16x32_bf16 v[60:63], a[124:127], v[108:111], v[60:63]
    ds_read_b128 v[80:83], v159 offset:0
    s_add_u32 m0, s74, 49152
    v_mfma_f32_16x16x32_bf16 v[56:59], a[120:123], v[108:111], v[56:59]
    ds_read_b128 v[84:87], v159 offset:6144
    v_mfma_f32_16x16x32_bf16 v[56:59], a[112:115], v[104:107], v[56:59]
    ds_read_b128 v[88:91], v159 offset:256
    buffer_load_dwordx4 v156, s[44:47], s78 offen offset:0 sc1 lds
    v_mfma_f32_16x16x32_bf16 v[64:67], a[112:115], v[112:115], v[64:67]
    ds_read_b128 v[92:95], v159 offset:6400
    v_mfma_f32_16x16x32_bf16 v[64:67], a[120:123], v[116:119], v[64:67]
    ds_read_b128 v[96:99], v159 offset:512
    v_mfma_f32_16x16x32_bf16 v[68:71], a[124:127], v[116:119], v[68:71]
    ds_read_b128 v[100:103], v159 offset:6656
    buffer_load_dwordx4 v157, s[44:47], s78 offen offset:1024 sc1 lds
    v_mfma_f32_16x16x32_bf16 v[68:71], a[116:119], v[112:115], v[68:71]
    v_mfma_f32_16x16x32_bf16 v[76:79], a[116:119], v[120:123], v[76:79]
    v_mfma_f32_16x16x32_bf16 v[76:79], a[124:127], v[124:127], v[76:79]
    buffer_load_dwordx4 v158, s[44:47], s78 offen offset:2048 sc1 lds
    v_mfma_f32_16x16x32_bf16 v[72:75], a[120:123], v[124:127], v[72:75]
    v_mfma_f32_16x16x32_bf16 v[72:75], a[112:115], v[120:123], v[72:75]
    s_waitcnt lgkmcnt(0)
    v_mfma_f32_16x16x32_bf16 v[32:35], a[128:131], v[80:83], v[32:35]
    s_add_u32 m0, s74, 61440
    v_mfma_f32_16x16x32_bf16 v[32:35], a[136:139], v[84:87], v[32:35]
    ds_read_b128 v[104:107], v159 offset:768
    v_mfma_f32_16x16x32_bf16 v[36:39], a[140:143], v[84:87], v[36:39]
    ds_read_b128 v[108:111], v159 offset:6912
    v_mfma_f32_16x16x32_bf16 v[36:39], a[132:135], v[80:83], v[36:39]
    ds_read_b128 v[112:115], v159 offset:1024
    buffer_load_dwordx4 v156, s[44:47], s79 offen offset:0 sc1 lds
    v_mfma_f32_16x16x32_bf16 v[44:47], a[132:135], v[88:91], v[44:47]
    ds_read_b128 v[116:119], v159 offset:7168
    v_mfma_f32_16x16x32_bf16 v[44:47], a[140:143], v[92:95], v[44:47]
    ds_read_b128 v[120:123], v159 offset:1280
    v_mfma_f32_16x16x32_bf16 v[40:43], a[136:139], v[92:95], v[40:43]
    ds_read_b128 v[124:127], v159 offset:7424
    buffer_load_dwordx4 v157, s[44:47], s79 offen offset:1024 sc1 lds
    v_mfma_f32_16x16x32_bf16 v[40:43], a[128:131], v[88:91], v[40:43]
    v_mfma_f32_16x16x32_bf16 v[48:51], a[128:131], v[96:99], v[48:51]
    v_mfma_f32_16x16x32_bf16 v[48:51], a[136:139], v[100:103], v[48:51]
    buffer_load_dwordx4 v158, s[44:47], s79 offen offset:2048 sc1 lds
    v_mfma_f32_16x16x32_bf16 v[52:55], a[140:143], v[100:103], v[52:55]
    v_mfma_f32_16x16x32_bf16 v[52:55], a[132:135], v[96:99], v[52:55]
    s_waitcnt lgkmcnt(0)
    v_mfma_f32_16x16x32_bf16 v[60:63], a[132:135], v[104:107], v[60:63]
    s_waitcnt vmcnt(13)
    s_barrier
    v_mfma_f32_16x16x32_bf16 v[60:63], a[140:143], v[108:111], v[60:63]
    ds_read_b128 v[80:83], v159 offset:12288
    s_add_u32 m0, s74, 0
    v_mfma_f32_16x16x32_bf16 v[56:59], a[136:139], v[108:111], v[56:59]
    ds_read_b128 v[84:87], v159 offset:18432
    v_mfma_f32_16x16x32_bf16 v[56:59], a[128:131], v[104:107], v[56:59]
    ds_read_b128 v[88:91], v159 offset:12544
    buffer_load_dwordx4 v156, s[44:47], s80 offen offset:0 sc1 lds
    v_mfma_f32_16x16x32_bf16 v[64:67], a[128:131], v[112:115], v[64:67]
    ds_read_b128 v[92:95], v159 offset:18688
    v_mfma_f32_16x16x32_bf16 v[64:67], a[136:139], v[116:119], v[64:67]
    ds_read_b128 v[96:99], v159 offset:12800
    buffer_load_dword v29, v28, s[44:47], 0 offen sc1
    v_mfma_f32_16x16x32_bf16 v[68:71], a[140:143], v[116:119], v[68:71]
    ds_read_b128 v[100:103], v159 offset:18944
    buffer_load_dwordx4 v157, s[44:47], s80 offen offset:1024 sc1 lds
    v_mfma_f32_16x16x32_bf16 v[68:71], a[132:135], v[112:115], v[68:71]
    ds_read_b64_tr_b16 a[32:33], v10 offset:16384
    v_mfma_f32_16x16x32_bf16 v[76:79], a[132:135], v[120:123], v[76:79]
    ds_read_b64_tr_b16 a[34:35], v10 offset:18432
    v_mfma_f32_16x16x32_bf16 v[76:79], a[140:143], v[124:127], v[76:79]
    buffer_load_dwordx4 v158, s[44:47], s80 offen offset:2048 sc1 lds
    v_mfma_f32_16x16x32_bf16 v[72:75], a[136:139], v[124:127], v[72:75]
    ds_read_b64_tr_b16 a[40:41], v10 offset:20480
    v_mfma_f32_16x16x32_bf16 v[72:75], a[128:131], v[120:123], v[72:75]
    ds_read_b64_tr_b16 a[42:43], v10 offset:22528
    s_waitcnt lgkmcnt(4)
    v_mfma_f32_16x16x32_bf16 v[32:35], a[144:147], v[80:83], v[32:35]
    s_add_u32 m0, s73, 32768
    s_lshl_b32 s14, s87, 18
    v_mfma_f32_16x16x32_bf16 v[32:35], a[152:155], v[84:87], v[32:35]
    ds_read_b128 v[104:107], v159 offset:13056
    v_mfma_f32_16x16x32_bf16 v[36:39], a[156:159], v[84:87], v[36:39]
    ds_read_b128 v[108:111], v159 offset:19200
    buffer_load_dwordx4 v4, s[52:55], s14 offen offset:0 lds
    v_mfma_f32_16x16x32_bf16 v[36:39], a[148:151], v[80:83], v[36:39]
    ds_read_b128 v[112:115], v159 offset:13312
    v_mfma_f32_16x16x32_bf16 v[44:47], a[148:151], v[88:91], v[44:47]
    ds_read_b128 v[116:119], v159 offset:19456
    buffer_load_dwordx4 v5, s[52:55], s14 offen offset:1024 lds
    v_mfma_f32_16x16x32_bf16 v[44:47], a[156:159], v[92:95], v[44:47]
    ds_read_b128 v[120:123], v159 offset:13568
    v_mfma_f32_16x16x32_bf16 v[40:43], a[152:155], v[92:95], v[40:43]
    ds_read_b128 v[124:127], v159 offset:19712
    v_mfma_f32_16x16x32_bf16 v[40:43], a[144:147], v[88:91], v[40:43]
    ds_read_b64_tr_b16 a[36:37], v11 offset:16384
    buffer_load_dwordx4 v6, s[52:55], s14 offen offset:2048 lds
    v_mfma_f32_16x16x32_bf16 v[48:51], a[144:147], v[96:99], v[48:51]
    ds_read_b64_tr_b16 a[38:39], v11 offset:18432
L_pl_G_4:
    s_cbranch_execz L_wret
    v_mfma_f32_16x16x32_bf16 v[48:51], a[152:155], v[100:103], v[48:51]
    buffer_load_dwordx4 v7, s[52:55], s14 offen offset:3072 lds
    v_mfma_f32_16x16x32_bf16 v[52:55], a[156:159], v[100:103], v[52:55]
    ds_read_b64_tr_b16 a[44:45], v11 offset:20480
    v_mfma_f32_16x16x32_bf16 v[52:55], a[148:151], v[96:99], v[52:55]
    ds_read_b64_tr_b16 a[46:47], v11 offset:22528
    s_waitcnt lgkmcnt(4)
    v_mfma_f32_16x16x32_bf16 v[60:63], a[148:151], v[104:107], v[60:63]
    s_waitcnt vmcnt(17)
    s_barrier
    v_mfma_f32_16x16x32_bf16 v[60:63], a[156:159], v[108:111], v[60:63]
    ds_read_b128 v[80:83], v159 offset:24576
    v_mfma_f32_16x16x32_bf16 v[56:59], a[152:155], v[108:111], v[56:59]
    ds_read_b128 v[84:87], v159 offset:30720
    v_mfma_f32_16x16x32_bf16 v[56:59], a[144:147], v[104:107], v[56:59]
    ds_read_b128 v[88:91], v159 offset:24832
    v_mfma_f32_16x16x32_bf16 v[64:67], a[144:147], v[112:115], v[64:67]
    ds_read_b128 v[92:95], v159 offset:30976
    v_mfma_f32_16x16x32_bf16 v[64:67], a[152:155], v[116:119], v[64:67]
    ds_read_b128 v[96:99], v159 offset:25088
    v_mfma_f32_16x16x32_bf16 v[68:71], a[156:159], v[116:119], v[68:71]
    ds_read_b128 v[100:103], v159 offset:31232
    v_mfma_f32_16x16x32_bf16 v[68:71], a[148:151], v[112:115], v[68:71]
    v_mfma_f32_16x16x32_bf16 v[76:79], a[148:151], v[120:123], v[76:79]
    v_mfma_f32_16x16x32_bf16 v[76:79], a[156:159], v[124:127], v[76:79]
    v_mfma_f32_16x16x32_bf16 v[72:75], a[152:155], v[124:127], v[72:75]
    v_mfma_f32_16x16x32_bf16 v[72:75], a[144:147], v[120:123], v[72:75]
    s_waitcnt lgkmcnt(0)
    v_mfma_f32_16x16x32_bf16 v[32:35], a[160:163], v[80:83], v[32:35]
    v_mfma_f32_16x16x32_bf16 v[32:35], a[168:171], v[84:87], v[32:35]
    ds_read_b128 v[104:107], v159 offset:25344
    v_mfma_f32_16x16x32_bf16 v[36:39], a[172:175], v[84:87], v[36:39]
    ds_read_b128 v[108:111], v159 offset:31488
    v_mfma_f32_16x16x32_bf16 v[36:39], a[164:167], v[80:83], v[36:39]
    ds_read_b128 v[112:115], v159 offset:25600
    v_mfma_f32_16x16x32_bf16 v[44:47], a[164:167], v[88:91], v[44:47]
    ds_read_b128 v[116:119], v159 offset:31744
    v_mfma_f32_16x16x32_bf16 v[44:47], a[172:175], v[92:95], v[44:47]
    ds_read_b128 v[120:123], v159 offset:25856
    v_mfma_f32_16x16x32_bf16 v[40:43], a[168:171], v[92:95], v[40:43]
    ds_read_b128 v[124:127], v159 offset:32000
    v_mfma_f32_16x16x32_bf16 v[40:43], a[160:163], v[88:91], v[40:43]
    v_mfma_f32_16x16x32_bf16 v[48:51], a[160:163], v[96:99], v[48:51]
    v_mfma_f32_16x16x32_bf16 v[48:51], a[168:171], v[100:103], v[48:51]
    v_mfma_f32_16x16x32_bf16 v[52:55], a[172:175], v[100:103], v[52:55]
    v_mfma_f32_16x16x32_bf16 v[52:55], a[164:167], v[96:99], v[52:55]
    s_waitcnt lgkmcnt(0)
    v_mfma_f32_16x16x32_bf16 v[60:63], a[164:167], v[104:107], v[60:63]
    s_waitcnt vmcnt(14)
    s_barrier
    v_mfma_f32_16x16x32_bf16 v[60:63], a[172:175], v[108:111], v[60:63]
    ds_read_b128 v[80:83], v250 offset:0
    s_waitcnt vmcnt(6)
    v_mfma_f32_16x16x32_bf16 v[56:59], a[168:171], v[108:111], v[56:59]
    ds_read_b128 v[84:87], v250 offset:6144
    v_cmp_ne_u32 vcc, s68, v29
    v_mfma_f32_16x16x32_bf16 v[56:59], a[160:163], v[104:107], v[56:59]
    ds_read_b128 v[88:91], v250 offset:256
    v_mfma_f32_16x16x32_bf16 v[64:67], a[160:163], v[112:115], v[64:67]
    ds_read_b128 v[92:95], v250 offset:6400
    v_mfma_f32_16x16x32_bf16 v[64:67], a[168:171], v[116:119], v[64:67]
    ds_read_b128 v[96:99], v250 offset:512
    s_cbranch_vccnz L_rs_p5
L_ok_p5:
    v_mfma_f32_16x16x32_bf16 v[68:71], a[172:175], v[116:119], v[68:71]
    ds_read_b128 v[100:103], v250 offset:6656
    buffer_load_dwordx4 v[160:163], v246, s[44:47], s10 offen offset:0 sc1
    v_mfma_f32_16x16x32_bf16 v[68:71], a[164:167], v[112:115], v[68:71]
    v_mfma_f32_16x16x32_bf16 v[76:79], a[164:167], v[120:123], v[76:79]
    v_mfma_f32_16x16x32_bf16 v[76:79], a[172:175], v[124:127], v[76:79]
    buffer_load_dwordx4 v[164:167], v246, s[44:47], s10 offen offset:1024 sc1
    v_mfma_f32_16x16x32_bf16 v[72:75], a[168:171], v[124:127], v[72:75]
    buffer_load_dwordx4 v[168:171], v246, s[44:47], s10 offen offset:2048 sc1
    v_mfma_f32_16x16x32_bf16 v[72:75], a[160:163], v[120:123], v[72:75]
    s_waitcnt lgkmcnt(0)
    v_mfma_f32_16x16x32_bf16 v[32:35], a[176:179], v[80:83], v[32:35]
    v_mfma_f32_16x16x32_bf16 v[32:35], a[184:187], v[84:87], v[32:35]
    ds_read_b128 v[104:107], v250 offset:768
    v_mfma_f32_16x16x32_bf16 v[36:39], a[188:191], v[84:87], v[36:39]
    ds_read_b128 v[108:111], v250 offset:6912
    buffer_load_dwordx4 v[172:175], v247, s[44:47], s10 offen offset:0 sc1
    v_mfma_f32_16x16x32_bf16 v[36:39], a[180:183], v[80:83], v[36:39]
    ds_read_b128 v[112:115], v250 offset:1024
    v_mfma_f32_16x16x32_bf16 v[44:47], a[180:183], v[88:91], v[44:47]
    ds_read_b128 v[116:119], v250 offset:7168
    v_mfma_f32_16x16x32_bf16 v[44:47], a[188:191], v[92:95], v[44:47]
    ds_read_b128 v[120:123], v250 offset:1280
    buffer_load_dwordx4 v[176:179], v247, s[44:47], s10 offen offset:1024 sc1
    v_mfma_f32_16x16x32_bf16 v[40:43], a[184:187], v[92:95], v[40:43]
    ds_read_b128 v[124:127], v250 offset:7424
    v_mfma_f32_16x16x32_bf16 v[40:43], a[176:179], v[88:91], v[40:43]
    v_mfma_f32_16x16x32_bf16 v[48:51], a[176:179], v[96:99], v[48:51]
    v_mfma_f32_16x16x32_bf16 v[48:51], a[184:187], v[100:103], v[48:51]
    v_mfma_f32_16x16x32_bf16 v[52:55], a[188:191], v[100:103], v[52:55]
    buffer_load_dwordx4 v[180:183], v247, s[44:47], s10 offen offset:2048 sc1
    v_mfma_f32_16x16x32_bf16 v[52:55], a[180:183], v[96:99], v[52:55]
    s_waitcnt lgkmcnt(0)
    v_mfma_f32_16x16x32_bf16 v[60:63], a[180:183], v[104:107], v[60:63]
    s_barrier
    v_mfma_f32_16x16x32_bf16 v[60:63], a[188:191], v[108:111], v[60:63]
    ds_read_b128 v[80:83], v250 offset:12288
    s_add_u32 m0, s74, 12288
    v_mfma_f32_16x16x32_bf16 v[56:59], a[184:187], v[108:111], v[56:59]
    ds_read_b128 v[84:87], v250 offset:18432
    v_mfma_f32_16x16x32_bf16 v[56:59], a[176:179], v[104:107], v[56:59]
    ds_read_b128 v[88:91], v250 offset:12544
    buffer_load_dwordx4 v156, s[44:47], s81 offen offset:0 sc1 lds
    v_mfma_f32_16x16x32_bf16 v[64:67], a[176:179], v[112:115], v[64:67]
    ds_read_b128 v[92:95], v250 offset:18688
    v_mfma_f32_16x16x32_bf16 v[64:67], a[184:187], v[116:119], v[64:67]
    ds_read_b128 v[96:99], v250 offset:12800
    v_mfma_f32_16x16x32_bf16 v[68:71], a[188:191], v[116:119], v[68:71]
    ds_read_b128 v[100:103], v250 offset:18944
    buffer_load_dwordx4 v157, s[44:47], s81 offen offset:1024 sc1 lds
    v_mfma_f32_16x16x32_bf16 v[68:71], a[180:183], v[112:115], v[68:71]
    v_mfma_f32_16x16x32_bf16 v[76:79], a[180:183], v[120:123], v[76:79]
    v_mfma_f32_16x16x32_bf16 v[76:79], a[188:191], v[124:127], v[76:79]
    buffer_load_dwordx4 v158, s[44:47], s81 offen offset:2048 sc1 lds
    v_mfma_f32_16x16x32_bf16 v[72:75], a[184:187], v[124:127], v[72:75]
    v_mfma_f32_16x16x32_bf16 v[72:75], a[176:179], v[120:123], v[72:75]
    s_waitcnt lgkmcnt(0)
    v_mfma_f32_16x16x32_bf16 v[32:35], a[192:195], v[80:83], v[32:35]
    s_add_u32 m0, s73, 49152
    s_lshl_b32 s14, s88, 18
    v_mfma_f32_16x16x32_bf16 v[32:35], a[200:203], v[84:87], v[32:35]
    ds_read_b128 v[104:107], v250 offset:13056
    v_mfma_f32_16x16x32_bf16 v[36:39], a[204:207], v[84:87], v[36:39]
    ds_read_b128 v[108:111], v250 offset:19200
    buffer_load_dwordx4 v4, s[52:55], s14 offen offset:0 lds
    v_mfma_f32_16x16x32_bf16 v[36:39], a[196:199], v[80:83], v[36:39]
    ds_read_b128 v[112:115], v250 offset:13312
    v_mfma_f32_16x16x32_bf16 v[44:47], a[196:199], v[88:91], v[44:47]
    ds_read_b128 v[116:119], v250 offset:19456
    buffer_load_dwordx4 v5, s[52:55], s14 offen offset:1024 lds
    v_mfma_f32_16x16x32_bf16 v[44:47], a[204:207], v[92:95], v[44:47]
    ds_read_b128 v[120:123], v250 offset:13568
    v_mfma_f32_16x16x32_bf16 v[40:43], a[200:203], v[92:95], v[40:43]
    ds_read_b128 v[124:127], v250 offset:19712
    v_mfma_f32_16x16x32_bf16 v[40:43], a[192:195], v[88:91], v[40:43]
    buffer_load_dwordx4 v6, s[52:55], s14 offen offset:2048 lds
    v_mfma_f32_16x16x32_bf16 v[48:51], a[192:195], v[96:99], v[48:51]
    v_mfma_f32_16x16x32_bf16 v[48:51], a[200:203], v[100:103], v[48:51]
    buffer_load_dwordx4 v7, s[52:55], s14 offen offset:3072 lds
    v_mfma_f32_16x16x32_bf16 v[52:55], a[204:207], v[100:103], v[52:55]
    v_mfma_f32_16x16x32_bf16 v[52:55], a[196:199], v[96:99], v[52:55]
    s_waitcnt lgkmcnt(0)
    v_mfma_f32_16x16x32_bf16 v[60:63], a[196:199], v[104:107], v[60:63]
    s_barrier
    v_mfma_f32_16x16x32_bf16 v[60:63], a[204:207], v[108:111], v[60:63]
    ds_read_b128 v[80:83], v250 offset:24576
    v_mfma_f32_16x16x32_bf16 v[56:59], a[200:203], v[108:111], v[56:59]
    ds_read_b128 v[84:87], v250 offset:30720
    v_mfma_f32_16x16x32_bf16 v[56:59], a[192:195], v[104:107], v[56:59]
    ds_read_b128 v[88:91], v250 offset:24832
    v_mfma_f32_16x16x32_bf16 v[64:67], a[192:195], v[112:115], v[64:67]
    ds_read_b128 v[92:95], v250 offset:30976
    v_mfma_f32_16x16x32_bf16 v[64:67], a[200:203], v[116:119], v[64:67]
    ds_read_b128 v[96:99], v250 offset:25088
    v_mfma_f32_16x16x32_bf16 v[68:71], a[204:207], v[116:119], v[68:71]
    ds_read_b128 v[100:103], v250 offset:31232
    s_waitcnt vmcnt(7)
    v_mfma_f32_16x16x32_bf16 v[68:71], a[196:199], v[112:115], v[68:71]
    v_mfma_f32_16x16x32_bf16 v[76:79], a[196:199], v[120:123], v[76:79]
    v_mfma_f32_16x16x32_bf16 v[76:79], a[204:207], v[124:127], v[76:79]
    v_mfma_f32_16x16x32_bf16 v[72:75], a[200:203], v[124:127], v[72:75]
    v_mfma_f32_16x16x32_bf16 v[72:75], a[192:195], v[120:123], v[72:75]
    s_waitcnt lgkmcnt(0)
    v_mfma_f32_16x16x32_bf16 v[32:35], a[208:211], v[80:83], v[32:35]
    s_add_u32 m0, s73, 65536
    s_lshl_b32 s14, s89, 18
    v_mfma_f32_16x16x32_bf16 v[32:35], a[216:219], v[84:87], v[32:35]
    ds_read_b128 v[104:107], v250 offset:25344
    v_mfma_f32_16x16x32_bf16 v[36:39], a[220:223], v[84:87], v[36:39]
    ds_read_b128 v[108:111], v250 offset:31488
    buffer_load_dwordx4 v4, s[52:55], s14 offen offset:0 lds
    v_and_b32 v193, 0xffff0000, v172
    v_lshlrev_b32 v192, 16, v172
    v_mfma_f32_16x16x32_bf16 v[36:39], a[212:215], v[80:83], v[36:39]
    ds_read_b128 v[112:115], v250 offset:25600
    v_and_b32 v195, 0xffff0000, v173
    v_lshlrev_b32 v194, 16, v173
    v_mfma_f32_16x16x32_bf16 v[44:47], a[212:215], v[88:91], v[44:47]
    ds_read_b128 v[116:119], v250 offset:31744
    buffer_load_dwordx4 v5, s[52:55], s14 offen offset:1024 lds
    v_add_f32 v56, v56, v192
    v_mfma_f32_16x16x32_bf16 v[44:47], a[220:223], v[92:95], v[44:47]
    ds_read_b128 v[120:123], v250 offset:25856
    v_add_f32 v57, v57, v193
    v_add_f32 v58, v58, v194
    v_mfma_f32_16x16x32_bf16 v[40:43], a[216:219], v[92:95], v[40:43]
    ds_read_b128 v[124:127], v250 offset:32000
    v_add_f32 v59, v59, v195
    v_and_b32 v197, 0xffff0000, v174
    v_mfma_f32_16x16x32_bf16 v[40:43], a[208:211], v[88:91], v[40:43]
    buffer_load_dwordx4 v6, s[52:55], s14 offen offset:2048 lds
    v_lshlrev_b32 v196, 16, v174
    v_and_b32 v199, 0xffff0000, v175
    v_mfma_f32_16x16x32_bf16 v[48:51], a[208:211], v[96:99], v[48:51]
    v_lshlrev_b32 v198, 16, v175
    v_add_f32 v60, v60, v196
    v_mfma_f32_16x16x32_bf16 v[48:51], a[216:219], v[100:103], v[48:51]
    buffer_load_dwordx4 v7, s[52:55], s14 offen offset:3072 lds
    v_add_f32 v61, v61, v197
    v_mfma_f32_16x16x32_bf16 v[52:55], a[220:223], v[100:103], v[52:55]
    v_add_f32 v62, v62, v198
    v_add_f32 v63, v63, v199
    v_mfma_f32_16x16x32_bf16 v[52:55], a[212:215], v[96:99], v[52:55]
    s_waitcnt lgkmcnt(0)
    v_mfma_f32_16x16x32_bf16 v[60:63], a[212:215], v[104:107], v[60:63]
    s_barrier
    v_mfma_f32_16x16x32_bf16 v[60:63], a[220:223], v[108:111], v[60:63]
    ds_read_b128 v[80:83], v159 offset:0
    v_mfma_f32_16x16x32_bf16 v[56:59], a[216:219], v[108:111], v[56:59]
    ds_read_b128 v[84:87], v159 offset:6144
    v_and_b32 v193, 0xffff0000, v160
    v_lshlrev_b32 v192, 16, v160
    v_mfma_f32_16x16x32_bf16 v[56:59], a[208:211], v[104:107], v[56:59]
    ds_read_b128 v[88:91], v159 offset:256
    v_and_b32 v195, 0xffff0000, v161
    v_lshlrev_b32 v194, 16, v161
    v_mfma_f32_16x16x32_bf16 v[64:67], a[208:211], v[112:115], v[64:67]
    ds_read_b128 v[92:95], v159 offset:6400
    v_add_f32 v32, v32, v192
    v_mfma_f32_16x16x32_bf16 v[64:67], a[216:219], v[116:119], v[64:67]
    ds_read_b128 v[96:99], v159 offset:512
    v_add_f32 v33, v33, v193
    v_add_f32 v34, v34, v194
    v_mfma_f32_16x16x32_bf16 v[68:71], a[220:223], v[116:119], v[68:71]
    ds_read_b128 v[100:103], v159 offset:6656
    v_add_f32 v35, v35, v195
    v_and_b32 v197, 0xffff0000, v162
    v_mfma_f32_16x16x32_bf16 v[68:71], a[212:215], v[112:115], v[68:71]
    ds_read_b64_tr_b16 a[48:49], v10 offset:32768
    v_lshlrev_b32 v196, 16, v162
    v_and_b32 v199, 0xffff0000, v163
    v_mfma_f32_16x16x32_bf16 v[76:79], a[212:215], v[120:123], v[76:79]
    ds_read_b64_tr_b16 a[50:51], v10 offset:34816
    v_lshlrev_b32 v198, 16, v163
    v_mfma_f32_16x16x32_bf16 v[76:79], a[220:223], v[124:127], v[76:79]
    v_add_f32 v36, v36, v196
    v_add_f32 v37, v37, v197
    v_mfma_f32_16x16x32_bf16 v[72:75], a[216:219], v[124:127], v[72:75]
    ds_read_b64_tr_b16 a[56:57], v10 offset:36864
    v_add_f32 v38, v38, v198
    v_add_f32 v39, v39, v199
    v_mfma_f32_16x16x32_bf16 v[72:75], a[208:211], v[120:123], v[72:75]
    ds_read_b64_tr_b16 a[58:59], v10 offset:38912
    s_waitcnt lgkmcnt(4)
    v_mfma_f32_16x16x32_bf16 v[32:35], a[224:227], v[80:83], v[32:35]
    s_add_u32 m0, s73, 0
    s_lshl_b32 s14, s90, 18
    v_mfma_f32_16x16x32_bf16 v[32:35], a[232:235], v[84:87], v[32:35]
    ds_read_b128 v[104:107], v159 offset:768
    v_mfma_f32_16x16x32_bf16 v[36:39], a[236:239], v[84:87], v[36:39]
    ds_read_b128 v[108:111], v159 offset:6912
    buffer_load_dwordx4 v4, s[52:55], s14 offen offset:0 lds
    v_and_b32 v193, 0xffff0000, v176
    v_lshlrev_b32 v192, 16, v176
    v_mfma_f32_16x16x32_bf16 v[36:39], a[228:231], v[80:83], v[36:39]
    ds_read_b128 v[112:115], v159 offset:1024
    v_and_b32 v195, 0xffff0000, v177
    v_lshlrev_b32 v194, 16, v177
    v_mfma_f32_16x16x32_bf16 v[44:47], a[228:231], v[88:91], v[44:47]
    ds_read_b128 v[116:119], v159 offset:7168
    buffer_load_dwordx4 v5, s[52:55], s14 offen offset:1024 lds
    v_add_f32 v64, v64, v192
    v_mfma_f32_16x16x32_bf16 v[44:47], a[236:239], v[92:95], v[44:47]
    ds_read_b128 v[120:123], v159 offset:1280
    v_add_f32 v65, v65, v193
    v_add_f32 v66, v66, v194
    v_mfma_f32_16x16x32_bf16 v[40:43], a[232:235], v[92:95], v[40:43]
    ds_read_b128 v[124:127], v159 offset:7424
    v_add_f32 v67, v67, v195
    v_and_b32 v197, 0xffff0000, v178
    v_mfma_f32_16x16x32_bf16 v[40:43], a[224:227], v[88:91], v[40:43]
    ds_read_b64_tr_b16 a[52:53], v11 offset:32768
    buffer_load_dwordx4 v6, s[52:55], s14 offen offset:2048 lds
    v_lshlrev_b32 v196, 16, v178
    v_and_b32 v199, 0xffff0000, v179
    v_mfma_f32_16x16x32_bf16 v[48:51], a[224:227], v[96:99], v[48:51]
    ds_read_b64_tr_b16 a[54:55], v11 offset:34816
    v_lshlrev_b32 v198, 16, v179
    v_mfma_f32_16x16x32_bf16 v[48:51], a[232:235], v[100:103], v[48:51]
    buffer_load_dwordx4 v7, s[52:55], s14 offen offset:3072 lds
    v_add_f32 v68, v68, v196
    v_add_f32 v69, v69, v197
    v_mfma_f32_16x16x32_bf16 v[52:55], a[236:239], v[100:103], v[52:55]
    ds_read_b64_tr_b16 a[60:61], v11 offset:36864
    v_add_f32 v70, v70, v198
    v_add_f32 v71, v71, v199
    v_mfma_f32_16x16x32_bf16 v[52:55], a[228:231], v[96:99], v[52:55]
    ds_read_b64_tr_b16 a[62:63], v11 offset:38912
    s_waitcnt lgkmcnt(4)
    v_mfma_f32_16x16x32_bf16 v[60:63], a[228:231], v[104:107], v[60:63]
    s_waitcnt vmcnt(12)
    s_barrier
    v_mfma_f32_16x16x32_bf16 v[60:63], a[236:239], v[108:111], v[60:63]
    ds_read_b128 v[80:83], v159 offset:12288
    v_mfma_f32_16x16x32_bf16 v[56:59], a[232:235], v[108:111], v[56:59]
    ds_read_b128 v[84:87], v159 offset:18432
    v_and_b32 v193, 0xffff0000, v164
    v_lshlrev_b32 v192, 16, v164
    v_mfma_f32_16x16x32_bf16 v[56:59], a[224:227], v[104:107], v[56:59]
    ds_read_b128 v[88:91], v159 offset:12544
    v_and_b32 v195, 0xffff0000, v165
    v_lshlrev_b32 v194, 16, v165
    v_mfma_f32_16x16x32_bf16 v[64:67], a[224:227], v[112:115], v[64:67]
    ds_read_b128 v[92:95], v159 offset:18688
    v_add_f32 v40, v40, v192
    v_mfma_f32_16x16x32_bf16 v[64:67], a[232:235], v[116:119], v[64:67]
    ds_read_b128 v[96:99], v159 offset:12800
    v_add_f32 v41, v41, v193
    v_add_f32 v42, v42, v194
    v_mfma_f32_16x16x32_bf16 v[68:71], a[236:239], v[116:119], v[68:71]
    ds_read_b128 v[100:103], v159 offset:18944
    v_add_f32 v43, v43, v195
    v_mfma_f32_16x16x32_bf16 v[68:71], a[228:231], v[112:115], v[68:71]
    v_and_b32 v197, 0xffff0000, v166
    v_lshlrev_b32 v196, 16, v166
    v_mfma_f32_16x16x32_bf16 v[76:79], a[228:231], v[120:123], v[76:79]
    v_and_b32 v199, 0xffff0000, v167
    v_lshlrev_b32 v198, 16, v167
    v_mfma_f32_16x16x32_bf16 v[76:79], a[236:239], v[124:127], v[76:79]
    v_add_f32 v44, v44, v196
    v_add_f32 v45, v45, v197
    v_mfma_f32_16x16x32_bf16 v[72:75], a[232:235], v[124:127], v[72:75]
    v_add_f32 v46, v46, v198
    v_add_f32 v47, v47, v199
    v_mfma_f32_16x16x32_bf16 v[72:75], a[224:227], v[120:123], v[72:75]
    s_waitcnt lgkmcnt(0)
    v_mfma_f32_16x16x32_bf16 v[32:35], a[240:243], v[80:83], v[32:35]
    s_add_u32 m0, s73, 16384
    s_lshl_b32 s14, s91, 18
    v_mfma_f32_16x16x32_bf16 v[32:35], a[248:251], v[84:87], v[32:35]
    ds_read_b128 v[104:107], v159 offset:13056
    v_mfma_f32_16x16x32_bf16 v[36:39], a[252:255], v[84:87], v[36:39]
    ds_read_b128 v[108:111], v159 offset:19200
    buffer_load_dwordx4 v4, s[52:55], s14 offen offset:0 lds
    v_and_b32 v193, 0xffff0000, v180
    v_lshlrev_b32 v192, 16, v180
    v_mfma_f32_16x16x32_bf16 v[36:39], a[244:247], v[80:83], v[36:39]
    ds_read_b128 v[112:115], v159 offset:13312
    v_and_b32 v195, 0xffff0000, v181
    v_lshlrev_b32 v194, 16, v181
    v_mfma_f32_16x16x32_bf16 v[44:47], a[244:247], v[88:91], v[44:47]
    ds_read_b128 v[116:119], v159 offset:19456
    buffer_load_dwordx4 v5, s[52:55], s14 offen offset:1024 lds
    v_add_f32 v72, v72, v192
    v_mfma_f32_16x16x32_bf16 v[44:47], a[252:255], v[92:95], v[44:47]
    ds_read_b128 v[120:123], v159 offset:13568
    v_add_f32 v73, v73, v193
    v_add_f32 v74, v74, v194
    v_mfma_f32_16x16x32_bf16 v[40:43], a[248:251], v[92:95], v[40:43]
    ds_read_b128 v[124:127], v159 offset:19712
    v_add_f32 v75, v75, v195
    v_and_b32 v197, 0xffff0000, v182
    v_mfma_f32_16x16x32_bf16 v[40:43], a[240:243], v[88:91], v[40:43]
    buffer_load_dwordx4 v6, s[52:55], s14 offen offset:2048 lds
    v_lshlrev_b32 v196, 16, v182
    v_and_b32 v199, 0xffff0000, v183
    v_mfma_f32_16x16x32_bf16 v[48:51], a[240:243], v[96:99], v[48:51]
    v_lshlrev_b32 v198, 16, v183
    v_add_f32 v76, v76, v196
    v_mfma_f32_16x16x32_bf16 v[48:51], a[248:251], v[100:103], v[48:51]
    buffer_load_dwordx4 v7, s[52:55], s14 offen offset:3072 lds
    v_add_f32 v77, v77, v197
    v_mfma_f32_16x16x32_bf16 v[52:55], a[252:255], v[100:103], v[52:55]
    v_add_f32 v78, v78, v198
    v_add_f32 v79, v79, v199
    v_mfma_f32_16x16x32_bf16 v[52:55], a[244:247], v[96:99], v[52:55]
    s_waitcnt lgkmcnt(0)
    v_mfma_f32_16x16x32_bf16 v[60:63], a[244:247], v[104:107], v[60:63]
    s_barrier
    v_mfma_f32_16x16x32_bf16 v[60:63], a[252:255], v[108:111], v[60:63]
    s_add_u32 m0, s73, 131072
    s_lshl_b32 s14, s92, 18
    v_mfma_f32_16x16x32_bf16 v[56:59], a[248:251], v[108:111], v[56:59]
    buffer_load_dwordx4 v4, s[52:55], s14 offen offset:0 lds
    v_and_b32 v193, 0xffff0000, v168
    v_lshlrev_b32 v192, 16, v168
    v_mfma_f32_16x16x32_bf16 v[56:59], a[240:243], v[104:107], v[56:59]
    buffer_load_dwordx4 v5, s[52:55], s14 offen offset:1024 lds
    v_and_b32 v195, 0xffff0000, v169
    v_lshlrev_b32 v194, 16, v169
    v_mfma_f32_16x16x32_bf16 v[64:67], a[240:243], v[112:115], v[64:67]
    buffer_load_dwordx4 v6, s[52:55], s14 offen offset:2048 lds
    v_add_f32 v48, v48, v192
    v_mfma_f32_16x16x32_bf16 v[64:67], a[248:251], v[116:119], v[64:67]
    buffer_load_dwordx4 v7, s[52:55], s14 offen offset:3072 lds
    v_add_f32 v49, v49, v193
    v_add_f32 v50, v50, v194
    v_mfma_f32_16x16x32_bf16 v[68:71], a[252:255], v[116:119], v[68:71]
    s_add_u32 m0, s73, 147456
    s_lshl_b32 s14, s93, 18
    v_add_f32 v51, v51, v195
    v_and_b32 v197, 0xffff0000, v170
    v_mfma_f32_16x16x32_bf16 v[68:71], a[244:247], v[112:115], v[68:71]
    buffer_load_dwordx4 v4, s[52:55], s14 offen offset:0 lds
    v_lshlrev_b32 v196, 16, v170
    v_and_b32 v199, 0xffff0000, v171
    v_mfma_f32_16x16x32_bf16 v[76:79], a[244:247], v[120:123], v[76:79]
    buffer_load_dwordx4 v5, s[52:55], s14 offen offset:1024 lds
    v_lshlrev_b32 v198, 16, v171
    v_mfma_f32_16x16x32_bf16 v[76:79], a[252:255], v[124:127], v[76:79]
    buffer_load_dwordx4 v6, s[52:55], s14 offen offset:2048 lds
    v_add_f32 v52, v52, v196
    v_add_f32 v53, v53, v197
    v_mfma_f32_16x16x32_bf16 v[72:75], a[248:251], v[124:127], v[72:75]
    buffer_load_dwordx4 v7, s[52:55], s14 offen offset:3072 lds
    v_add_f32 v54, v54, v198
    v_add_f32 v55, v55, v199
    v_mfma_f32_16x16x32_bf16 v[72:75], a[240:243], v[120:123], v[72:75]
    s_waitcnt lgkmcnt(0)
    v_mov_b32 v88, 0xc0135761
    s_mov_b32 s10, 0xbdd2d3e8
    s_lshl_b32 s9, s69, 2
    s_add_u32 s9, s9, s3
    s_mul_i32 s9, s9, 69632
    s_add_u32 s9, s9, 12795904
    v_pk_mul_f32 v[160:161], v[32:33], v[32:33]
    v_pk_mul_f32 v[162:163], v[34:35], v[34:35]
    v_pk_mul_f32 v[164:165], v[36:37], v[36:37]
    v_pk_mul_f32 v[166:167], v[38:39], v[38:39]
    v_pk_mul_f32 v[168:169], v[40:41], v[40:41]
    v_pk_mul_f32 v[170:171], v[42:43], v[42:43]
    v_pk_mul_f32 v[172:173], v[44:45], v[44:45]
    v_pk_mul_f32 v[174:175], v[46:47], v[46:47]
    v_pk_fma_f32 v[160:161], v[160:161], s[10:11], v[88:89] op_sel_hi:[1,0,0]
    v_pk_fma_f32 v[162:163], v[162:163], s[10:11], v[88:89] op_sel_hi:[1,0,0]
    v_pk_fma_f32 v[164:165], v[164:165], s[10:11], v[88:89] op_sel_hi:[1,0,0]
    v_pk_fma_f32 v[166:167], v[166:167], s[10:11], v[88:89] op_sel_hi:[1,0,0]
    v_pk_fma_f32 v[168:169], v[168:169], s[10:11], v[88:89] op_sel_hi:[1,0,0]
    v_pk_fma_f32 v[170:171], v[170:171], s[10:11], v[88:89] op_sel_hi:[1,0,0]
    v_pk_fma_f32 v[172:173], v[172:173], s[10:11], v[88:89] op_sel_hi:[1,0,0]
    v_pk_fma_f32 v[174:175], v[174:175], s[10:11], v[88:89] op_sel_hi:[1,0,0]
    v_pk_mul_f32 v[160:161], v[160:161], v[32:33]
    v_pk_mul_f32 v[162:163], v[162:163], v[34:35]
    v_pk_mul_f32 v[164:165], v[164:165], v[36:37]
    v_pk_mul_f32 v[166:167], v[166:167], v[38:39]
    v_pk_mul_f32 v[168:169], v[168:169], v[40:41]
    v_pk_mul_f32 v[170:171], v[170:171], v[42:43]
    v_pk_mul_f32 v[172:173], v[172:173], v[44:45]
    v_pk_mul_f32 v[174:175], v[174:175], v[46:47]
    v_exp_f32 v160, v160
    v_exp_f32 v161, v161
    v_exp_f32 v162, v162
    v_exp_f32 v163, v163
    v_exp_f32 v164, v164
    v_exp_f32 v165, v165
    v_exp_f32 v166, v166
    v_exp_f32 v167, v167
    v_exp_f32 v168, v168
    v_exp_f32 v169, v169
    v_exp_f32 v170, v170
    v_exp_f32 v171, v171
    v_exp_f32 v172, v172
    v_exp_f32 v173, v173
    v_exp_f32 v174, v174
    v_exp_f32 v175, v175
    v_pk_add_f32 v[160:161], v[160:161], 1.0 op_sel_hi:[1,0]
    v_pk_add_f32 v[162:163], v[162:163], 1.0 op_sel_hi:[1,0]
    v_pk_add_f32 v[164:165], v[164:165], 1.0 op_sel_hi:[1,0]
    v_pk_add_f32 v[166:167], v[166:167], 1.0 op_sel_hi:[1,0]
    v_pk_add_f32 v[168:169], v[168:169], 1.0 op_sel_hi:[1,0]
    v_pk_add_f32 v[170:171], v[170:171], 1.0 op_sel_hi:[1,0]
    v_pk_add_f32 v[172:173], v[172:173], 1.0 op_sel_hi:[1,0]
    v_pk_add_f32 v[174:175], v[174:175], 1.0 op_sel_hi:[1,0]
    v_rcp_f32 v160, v160
    v_rcp_f32 v161, v161
    v_rcp_f32 v162, v162
    v_rcp_f32 v163, v163
    v_rcp_f32 v164, v164
    v_rcp_f32 v165, v165
    v_rcp_f32 v166, v166
    v_rcp_f32 v167, v167
    v_rcp_f32 v168, v168
    v_rcp_f32 v169, v169
    v_rcp_f32 v170, v170
    v_rcp_f32 v171, v171
    v_rcp_f32 v172, v172
    v_rcp_f32 v173, v173
    v_rcp_f32 v174, v174
    v_rcp_f32 v175, v175
    v_pk_mul_f32 v[32:33], v[32:33], v[160:161]
    v_pk_mul_f32 v[34:35], v[34:35], v[162:163]
    v_pk_mul_f32 v[36:37], v[36:37], v[164:165]
    v_pk_mul_f32 v[38:39], v[38:39], v[166:167]
    v_pk_mul_f32 v[40:41], v[40:41], v[168:169]
    v_pk_mul_f32 v[42:43], v[42:43], v[170:171]
    v_pk_mul_f32 v[44:45], v[44:45], v[172:173]
    v_pk_mul_f32 v[46:47], v[46:47], v[174:175]
    v_cvt_pk_bf16_f32 v96, v32, v33
    v_cvt_pk_bf16_f32 v97, v34, v35
    v_cvt_pk_bf16_f32 v98, v36, v37
    v_cvt_pk_bf16_f32 v99, v38, v39
    v_cvt_pk_bf16_f32 v100, v40, v41
    v_cvt_pk_bf16_f32 v101, v42, v43
    v_cvt_pk_bf16_f32 v102, v44, v45
    v_cvt_pk_bf16_f32 v103, v46, v47
    buffer_store_dwordx4 v[96:99], v240, s[44:47], s9 offen sc1
    buffer_store_dwordx4 v[100:103], v241, s[44:47], s9 offen sc1
    v_pk_mul_f32 v[160:161], v[48:49], v[48:49]
    v_pk_mul_f32 v[162:163], v[50:51], v[50:51]
    v_pk_mul_f32 v[164:165], v[52:53], v[52:53]
    v_pk_mul_f32 v[166:167], v[54:55], v[54:55]
    v_pk_mul_f32 v[168:169], v[56:57], v[56:57]
    v_pk_mul_f32 v[170:171], v[58:59], v[58:59]
    v_pk_mul_f32 v[172:173], v[60:61], v[60:61]
    v_pk_mul_f32 v[174:175], v[62:63], v[62:63]
    v_pk_fma_f32 v[160:161], v[160:161], s[10:11], v[88:89] op_sel_hi:[1,0,0]
    v_pk_fma_f32 v[162:163], v[162:163], s[10:11], v[88:89] op_sel_hi:[1,0,0]
    v_pk_fma_f32 v[164:165], v[164:165], s[10:11], v[88:89] op_sel_hi:[1,0,0]
    v_pk_fma_f32 v[166:167], v[166:167], s[10:11], v[88:89] op_sel_hi:[1,0,0]
    v_pk_fma_f32 v[168:169], v[168:169], s[10:11], v[88:89] op_sel_hi:[1,0,0]
    v_pk_fma_f32 v[170:171], v[170:171], s[10:11], v[88:89] op_sel_hi:[1,0,0]
    v_pk_fma_f32 v[172:173], v[172:173], s[10:11], v[88:89] op_sel_hi:[1,0,0]
    v_pk_fma_f32 v[174:175], v[174:175], s[10:11], v[88:89] op_sel_hi:[1,0,0]
    v_pk_mul_f32 v[160:161], v[160:161], v[48:49]
    v_pk_mul_f32 v[162:163], v[162:163], v[50:51]
    v_pk_mul_f32 v[164:165], v[164:165], v[52:53]
    v_pk_mul_f32 v[166:167], v[166:167], v[54:55]
    v_pk_mul_f32 v[168:169], v[168:169], v[56:57]
    v_pk_mul_f32 v[170:171], v[170:171], v[58:59]
    v_pk_mul_f32 v[172:173], v[172:173], v[60:61]
    v_pk_mul_f32 v[174:175], v[174:175], v[62:63]
    v_exp_f32 v160, v160
    v_exp_f32 v161, v161
    v_exp_f32 v162, v162
    v_exp_f32 v163, v163
    v_exp_f32 v164, v164
    v_exp_f32 v165, v165
    v_exp_f32 v166, v166
    v_exp_f32 v167, v167
    v_exp_f32 v168, v168
    v_exp_f32 v169, v169
    v_exp_f32 v170, v170
    v_exp_f32 v171, v171
    v_exp_f32 v172, v172
    v_exp_f32 v173, v173
    v_exp_f32 v174, v174
    v_exp_f32 v175, v175
    v_pk_add_f32 v[160:161], v[160:161], 1.0 op_sel_hi:[1,0]
    v_pk_add_f32 v[162:163], v[162:163], 1.0 op_sel_hi:[1,0]
    v_pk_add_f32 v[164:165], v[164:165], 1.0 op_sel_hi:[1,0]
    v_pk_add_f32 v[166:167], v[166:167], 1.0 op_sel_hi:[1,0]
    v_pk_add_f32 v[168:169], v[168:169], 1.0 op_sel_hi:[1,0]
    v_pk_add_f32 v[170:171], v[170:171], 1.0 op_sel_hi:[1,0]
    v_pk_add_f32 v[172:173], v[172:173], 1.0 op_sel_hi:[1,0]
    v_pk_add_f32 v[174:175], v[174:175], 1.0 op_sel_hi:[1,0]
    v_rcp_f32 v160, v160
    v_rcp_f32 v161, v161
    v_rcp_f32 v162, v162
    v_rcp_f32 v163, v163
    v_rcp_f32 v164, v164
    v_rcp_f32 v165, v165
    v_rcp_f32 v166, v166
    v_rcp_f32 v167, v167
    v_rcp_f32 v168, v168
    v_rcp_f32 v169, v169
    v_rcp_f32 v170, v170
    v_rcp_f32 v171, v171
    v_rcp_f32 v172, v172
    v_rcp_f32 v173, v173
    v_rcp_f32 v174, v174
    v_rcp_f32 v175, v175
    v_pk_mul_f32 v[48:49], v[48:49], v[160:161]
    v_pk_mul_f32 v[50:51], v[50:51], v[162:163]
    v_pk_mul_f32 v[52:53], v[52:53], v[164:165]
    v_pk_mul_f32 v[54:55], v[54:55], v[166:167]
    v_pk_mul_f32 v[56:57], v[56:57], v[168:169]
    v_pk_mul_f32 v[58:59], v[58:59], v[170:171]
    v_pk_mul_f32 v[60:61], v[60:61], v[172:173]
    v_pk_mul_f32 v[62:63], v[62:63], v[174:175]
    v_cvt_pk_bf16_f32 v104, v48, v49
    v_cvt_pk_bf16_f32 v105, v50, v51
    v_cvt_pk_bf16_f32 v106, v52, v53
    v_cvt_pk_bf16_f32 v107, v54, v55
    v_cvt_pk_bf16_f32 v108, v56, v57
    v_cvt_pk_bf16_f32 v109, v58, v59
    v_cvt_pk_bf16_f32 v110, v60, v61
    v_cvt_pk_bf16_f32 v111, v62, v63
    buffer_store_dwordx4 v[104:107], v242, s[44:47], s9 offen sc1
    buffer_store_dwordx4 v[108:111], v243, s[44:47], s9 offen sc1
    v_pk_mul_f32 v[160:161], v[64:65], v[64:65]
    v_pk_mul_f32 v[162:163], v[66:67], v[66:67]
    v_pk_mul_f32 v[164:165], v[68:69], v[68:69]
    v_pk_mul_f32 v[166:167], v[70:71], v[70:71]
    v_pk_mul_f32 v[168:169], v[72:73], v[72:73]
    v_pk_mul_f32 v[170:171], v[74:75], v[74:75]
    v_pk_mul_f32 v[172:173], v[76:77], v[76:77]
    v_pk_mul_f32 v[174:175], v[78:79], v[78:79]
    v_pk_fma_f32 v[160:161], v[160:161], s[10:11], v[88:89] op_sel_hi:[1,0,0]
    v_pk_fma_f32 v[162:163], v[162:163], s[10:11], v[88:89] op_sel_hi:[1,0,0]
    v_pk_fma_f32 v[164:165], v[164:165], s[10:11], v[88:89] op_sel_hi:[1,0,0]
    v_pk_fma_f32 v[166:167], v[166:167], s[10:11], v[88:89] op_sel_hi:[1,0,0]
    v_pk_fma_f32 v[168:169], v[168:169], s[10:11], v[88:89] op_sel_hi:[1,0,0]
    v_pk_fma_f32 v[170:171], v[170:171], s[10:11], v[88:89] op_sel_hi:[1,0,0]
    v_pk_fma_f32 v[172:173], v[172:173], s[10:11], v[88:89] op_sel_hi:[1,0,0]
    v_pk_fma_f32 v[174:175], v[174:175], s[10:11], v[88:89] op_sel_hi:[1,0,0]
L_pl_G_5:
    s_cbranch_execz L_wret
    v_pk_mul_f32 v[160:161], v[160:161], v[64:65]
    v_pk_mul_f32 v[162:163], v[162:163], v[66:67]
    v_pk_mul_f32 v[164:165], v[164:165], v[68:69]
    v_pk_mul_f32 v[166:167], v[166:167], v[70:71]
    v_pk_mul_f32 v[168:169], v[168:169], v[72:73]
    v_pk_mul_f32 v[170:171], v[170:171], v[74:75]
    v_pk_mul_f32 v[172:173], v[172:173], v[76:77]
    v_pk_mul_f32 v[174:175], v[174:175], v[78:79]
    v_exp_f32 v160, v160
    v_exp_f32 v161, v161
    v_exp_f32 v162, v162
    v_exp_f32 v163, v163
    v_exp_f32 v164, v164
    v_exp_f32 v165, v165
    v_exp_f32 v166, v166
    v_exp_f32 v167, v167
    v_exp_f32 v168, v168
    v_exp_f32 v169, v169
    v_exp_f32 v170, v170
    v_exp_f32 v171, v171
    v_exp_f32 v172, v172
    v_exp_f32 v173, v173
    v_exp_f32 v174, v174
    v_exp_f32 v175, v175
    v_pk_add_f32 v[160:161], v[160:161], 1.0 op_sel_hi:[1,0]
    v_pk_add_f32 v[162:163], v[162:163], 1.0 op_sel_hi:[1,0]
    v_pk_add_f32 v[164:165], v[164:165], 1.0 op_sel_hi:[1,0]
    v_pk_add_f32 v[166:167], v[166:167], 1.0 op_sel_hi:[1,0]
    v_pk_add_f32 v[168:169], v[168:169], 1.0 op_sel_hi:[1,0]
    v_pk_add_f32 v[170:171], v[170:171], 1.0 op_sel_hi:[1,0]
    v_pk_add_f32 v[172:173], v[172:173], 1.0 op_sel_hi:[1,0]
    v_pk_add_f32 v[174:175], v[174:175], 1.0 op_sel_hi:[1,0]
    v_rcp_f32 v160, v160
    v_rcp_f32 v161, v161
    v_rcp_f32 v162, v162
    v_rcp_f32 v163, v163
    v_rcp_f32 v164, v164
    v_rcp_f32 v165, v165
    v_rcp_f32 v166, v166
    v_rcp_f32 v167, v167
    v_rcp_f32 v168, v168
    v_rcp_f32 v169, v169
    v_rcp_f32 v170, v170
    v_rcp_f32 v171, v171
    v_rcp_f32 v172, v172
    v_rcp_f32 v173, v173
    v_rcp_f32 v174, v174
    v_rcp_f32 v175, v175
    v_pk_mul_f32 v[64:65], v[64:65], v[160:161]
    v_pk_mul_f32 v[66:67], v[66:67], v[162:163]
    v_pk_mul_f32 v[68:69], v[68:69], v[164:165]
    v_pk_mul_f32 v[70:71], v[70:71], v[166:167]
    v_pk_mul_f32 v[72:73], v[72:73], v[168:169]
    v_pk_mul_f32 v[74:75], v[74:75], v[170:171]
    v_pk_mul_f32 v[76:77], v[76:77], v[172:173]
    v_pk_mul_f32 v[78:79], v[78:79], v[174:175]
    v_cvt_pk_bf16_f32 v112, v64, v65
    v_cvt_pk_bf16_f32 v113, v66, v67
    v_cvt_pk_bf16_f32 v114, v68, v69
    v_cvt_pk_bf16_f32 v115, v70, v71
    v_cvt_pk_bf16_f32 v116, v72, v73
    v_cvt_pk_bf16_f32 v117, v74, v75
    v_cvt_pk_bf16_f32 v118, v76, v77
    v_cvt_pk_bf16_f32 v119, v78, v79
    buffer_store_dwordx4 v[112:115], v244, s[44:47], s9 offen sc1
    buffer_store_dwordx4 v[116:119], v245, s[44:47], s9 offen sc1
    s_waitcnt vmcnt(6)
    s_barrier
    ds_read_b64_tr_b16 a[64:65], v10 offset:49152
    s_add_u32 m0, s73, 32768
    s_lshl_b32 s14, s94, 18
    ds_read_b64_tr_b16 a[66:67], v10 offset:51200
    ds_read_b64_tr_b16 a[72:73], v10 offset:53248
    ds_read_b64_tr_b16 a[74:75], v10 offset:55296
    ds_read_b64_tr_b16 a[68:69], v11 offset:49152
    buffer_load_dwordx4 v4, s[52:55], s14 offen offset:0 lds
    ds_read_b64_tr_b16 a[70:71], v11 offset:51200
    ds_read_b64_tr_b16 a[76:77], v11 offset:53248
    ds_read_b64_tr_b16 a[78:79], v11 offset:55296
    v_add_u32 v10, 65536, v10
    ds_read_b64_tr_b16 a[80:81], v10 offset:0
    ds_read_b64_tr_b16 a[82:83], v10 offset:2048
    buffer_load_dwordx4 v5, s[52:55], s14 offen offset:1024 lds
    ds_read_b64_tr_b16 a[88:89], v10 offset:4096
    ds_read_b64_tr_b16 a[90:91], v10 offset:6144
    v_add_u32 v11, 65536, v11
    ds_read_b64_tr_b16 a[84:85], v11 offset:0
    ds_read_b64_tr_b16 a[86:87], v11 offset:2048
    ds_read_b64_tr_b16 a[92:93], v11 offset:4096
    buffer_load_dwordx4 v6, s[52:55], s14 offen offset:2048 lds
    ds_read_b64_tr_b16 a[94:95], v11 offset:6144
    v_add_u32 v10, -65536, v10
    ds_read_b64_tr_b16 a[96:97], v10 offset:0
    ds_read_b64_tr_b16 a[98:99], v10 offset:2048
    ds_read_b64_tr_b16 a[104:105], v10 offset:4096
    ds_read_b64_tr_b16 a[106:107], v10 offset:6144
    buffer_load_dwordx4 v7, s[52:55], s14 offen offset:3072 lds
    v_add_u32 v11, -65536, v11
    ds_read_b64_tr_b16 a[100:101], v11 offset:0
    ds_read_b64_tr_b16 a[102:103], v11 offset:2048
    ds_read_b64_tr_b16 a[108:109], v11 offset:4096
    ds_read_b64_tr_b16 a[110:111], v11 offset:6144
    ds_read_b64_tr_b16 a[112:113], v10 offset:16384
    s_add_u32 m0, s73, 81920
    s_lshl_b32 s14, s95, 18
    ds_read_b64_tr_b16 a[114:115], v10 offset:18432
    ds_read_b64_tr_b16 a[120:121], v10 offset:20480
    ds_read_b64_tr_b16 a[122:123], v10 offset:22528
    ds_read_b64_tr_b16 a[116:117], v11 offset:16384
    buffer_load_dwordx4 v4, s[52:55], s14 offen offset:0 lds
    ds_read_b64_tr_b16 a[118:119], v11 offset:18432
    ds_read_b64_tr_b16 a[124:125], v11 offset:20480
    ds_read_b64_tr_b16 a[126:127], v11 offset:22528
    v_add_u32 v10, 131072, v10
    ds_read_b64_tr_b16 a[128:129], v10 offset:0
    ds_read_b64_tr_b16 a[130:131], v10 offset:2048
    buffer_load_dwordx4 v5, s[52:55], s14 offen offset:1024 lds
    ds_read_b64_tr_b16 a[136:137], v10 offset:4096
    ds_read_b64_tr_b16 a[138:139], v10 offset:6144
    v_add_u32 v11, 131072, v11
    ds_read_b64_tr_b16 a[132:133], v11 offset:0
    ds_read_b64_tr_b16 a[134:135], v11 offset:2048
    ds_read_b64_tr_b16 a[140:141], v11 offset:4096
    buffer_load_dwordx4 v6, s[52:55], s14 offen offset:2048 lds
    ds_read_b64_tr_b16 a[142:143], v11 offset:6144
    ds_read_b64_tr_b16 a[144:145], v10 offset:16384
    ds_read_b64_tr_b16 a[146:147], v10 offset:18432
    ds_read_b64_tr_b16 a[152:153], v10 offset:20480
    ds_read_b64_tr_b16 a[154:155], v10 offset:22528
    buffer_load_dwordx4 v7, s[52:55], s14 offen offset:3072 lds
    ds_read_b64_tr_b16 a[148:149], v11 offset:16384
    ds_read_b64_tr_b16 a[150:151], v11 offset:18432
    ds_read_b64_tr_b16 a[156:157], v11 offset:20480
    ds_read_b64_tr_b16 a[158:159], v11 offset:22528
    s_bitcmp1_b32 s3, 1
    s_cselect_b32 s18, s85, s84
    s_mul_i32 s18, s18, 139264
    s_cselect_b32 s19, s87, s86
    s_mul_i32 s19, s19, 139264
    s_cselect_b32 s20, s89, s88
    s_mul_i32 s20, s20, 139264
    s_cselect_b32 s21, s91, s90
    s_mul_i32 s21, s21, 139264
    s_cselect_b32 s22, s93, s92
    s_mul_i32 s22, s22, 139264
    s_cselect_b32 s23, s95, s94
    s_mul_i32 s23, s23, 139264
    s_cselect_b32 s24, s97, s96
    s_mul_i32 s24, s24, 139264
    s_cselect_b32 s25, s99, s98
    s_mul_i32 s25, s25, 139264
    s_cselect_b32 s26, s101, s100
    s_mul_i32 s26, s26, 139264
    s_waitcnt vmcnt(8) lgkmcnt(0)
    s_barrier
    buffer_store_dword v249, v17, s[44:47], 0 offen sc1
    s_add_u32 m0, s73, 0
    s_lshl_b32 s14, s96, 18
    buffer_load_dwordx4 v4, s[52:55], s14 offen offset:0 lds
    buffer_load_dwordx4 v5, s[52:55], s14 offen offset:1024 lds
    buffer_load_dwordx4 v6, s[52:55], s14 offen offset:2048 lds
    buffer_load_dwordx4 v7, s[52:55], s14 offen offset:3072 lds
    s_add_u32 m0, s73, 16384
    s_lshl_b32 s14, s97, 18
    buffer_load_dwordx4 v4, s[52:55], s14 offen offset:0 lds
    buffer_load_dwordx4 v5, s[52:55], s14 offen offset:1024 lds
    buffer_load_dwordx4 v6, s[52:55], s14 offen offset:2048 lds
    buffer_load_dwordx4 v7, s[52:55], s14 offen offset:3072 lds
    v_mov_b32 v16, 0
    buffer_atomic_add v16, v15, s[44:47], 0 offen sc0 sc1
    s_add_u32 m0, s73, 49152
    s_lshl_b32 s14, s98, 18
    buffer_load_dwordx4 v4, s[52:55], s14 offen offset:0 lds
    buffer_load_dwordx4 v5, s[52:55], s14 offen offset:1024 lds
    buffer_load_dwordx4 v6, s[52:55], s14 offen offset:2048 lds
    buffer_load_dwordx4 v7, s[52:55], s14 offen offset:3072 lds
    s_add_u32 m0, s73, 65536
    s_lshl_b32 s14, s99, 18
    buffer_load_dwordx4 v4, s[52:55], s14 offen offset:0 lds
    buffer_load_dwordx4 v5, s[52:55], s14 offen offset:1024 lds
    buffer_load_dwordx4 v6, s[52:55], s14 offen offset:2048 lds
    buffer_load_dwordx4 v7, s[52:55], s14 offen offset:3072 lds
L_DG:
    s_waitcnt vmcnt(8)
    v_cmp_ne_u32 vcc, v13, v16
    s_cbranch_vccnz L_rs_p2G
L_ok_p2G:
    s_barrier
    s_add_u32 m0, s73, 97536
    s_nop 0
    buffer_load_dwordx4 v23, s[44:47], s18 offen offset:768 sc1 lds
    s_add_u32 m0, s73, 99328
    s_nop 0
    buffer_load_dwordx4 v20, s[44:47], s18 offen offset:0 sc1 lds
    s_add_u32 m0, s73, 99840
    s_nop 0
    buffer_load_dwordx4 v20, s[44:47], s18 offen offset:512 sc1 lds
    s_add_u32 m0, s73, 100608
    s_nop 0
    buffer_load_dwordx4 v23, s[44:47], s19 offen offset:768 sc1 lds
    s_add_u32 m0, s73, 114688
    s_nop 0
    buffer_load_dwordx4 v20, s[44:47], s19 offen offset:0 sc1 lds
    s_add_u32 m0, s73, 115200
    s_nop 0
    buffer_load_dwordx4 v20, s[44:47], s19 offen offset:512 sc1 lds
    s_add_u32 m0, s73, 115968
    s_nop 0
    buffer_load_dwordx4 v23, s[44:47], s20 offen offset:768 sc1 lds
    s_add_u32 m0, s73, 117760
    s_nop 0
    buffer_load_dwordx4 v20, s[44:47], s20 offen offset:0 sc1 lds
    v_mov_b32 v195, s68
    v_mov_b32 v199, s68
    v_mov_b32 v202, s68
    v_mov_b32 v203, s68
    s_waitcnt vmcnt(4)
    s_barrier
    ds_read_b128 v[104:107], v14 offset:0
    ds_read_b128 v[108:111], v14 offset:4096
    ds_read_b128 v[112:115], v14 offset:8192
    ds_read_b128 v[116:119], v14 offset:12288
    s_waitcnt lgkmcnt(2)
    v_mfma_f32_16x16x32_bf16 v[32:35], v[104:107], a[0:3], 0
    s_add_u32 m0, s73, 130560
    v_mfma_f32_16x16x32_bf16 v[32:35], v[108:111], a[8:11], v[32:35]
    buffer_load_dwordx4 v20, s[44:47], s20 offen offset:512 sc1 lds
    s_waitcnt lgkmcnt(0)
    v_mfma_f32_16x16x32_bf16 v[32:35], v[112:115], a[16:19], v[32:35]
    ds_read_b128 v[120:123], v14 offset:1024
    v_mfma_f32_16x16x32_bf16 v[32:35], v[116:119], a[24:27], v[32:35]
    ds_read_b128 v[124:127], v14 offset:5120
    v_mfma_f32_16x16x32_bf16 v[36:39], v[116:119], a[28:31], 0
    ds_read_b128 v[128:131], v14 offset:9216
    v_mfma_f32_16x16x32_bf16 v[36:39], v[112:115], a[20:23], v[36:39]
    ds_read_b128 v[132:135], v14 offset:13312
    v_mfma_f32_16x16x32_bf16 v[36:39], v[108:111], a[12:15], v[36:39]
    s_add_u32 m0, s73, 131328
    v_mfma_f32_16x16x32_bf16 v[36:39], v[104:107], a[4:7], v[36:39]
    buffer_load_dwordx4 v23, s[44:47], s21 offen offset:768 sc1 lds
    s_waitcnt lgkmcnt(2)
    v_mfma_f32_16x16x32_bf16 v[44:47], v[120:123], a[4:7], 0
    s_add_u32 m0, s73, 133120
    v_mfma_f32_16x16x32_bf16 v[44:47], v[124:127], a[12:15], v[44:47]
    buffer_load_dwordx4 v20, s[44:47], s21 offen offset:0 sc1 lds
    s_waitcnt lgkmcnt(0)
    v_mfma_f32_16x16x32_bf16 v[44:47], v[128:131], a[20:23], v[44:47]
    ds_read_b128 v[104:107], v14 offset:2048
    v_mfma_f32_16x16x32_bf16 v[44:47], v[132:135], a[28:31], v[44:47]
    ds_read_b128 v[108:111], v14 offset:6144
    v_mfma_f32_16x16x32_bf16 v[40:43], v[132:135], a[24:27], 0
    ds_read_b128 v[112:115], v14 offset:10240
    v_mfma_f32_16x16x32_bf16 v[40:43], v[128:131], a[16:19], v[40:43]
    ds_read_b128 v[116:119], v14 offset:14336
    v_mfma_f32_16x16x32_bf16 v[40:43], v[124:127], a[8:11], v[40:43]
    s_add_u32 m0, s73, 133632
    v_mfma_f32_16x16x32_bf16 v[40:43], v[120:123], a[0:3], v[40:43]
    buffer_load_dwordx4 v20, s[44:47], s21 offen offset:512 sc1 lds
    s_waitcnt lgkmcnt(2)
    v_mfma_f32_16x16x32_bf16 v[48:51], v[104:107], a[0:3], 0
    s_add_u32 m0, s73, 146688
    v_mfma_f32_16x16x32_bf16 v[48:51], v[108:111], a[8:11], v[48:51]
    buffer_load_dwordx4 v23, s[44:47], s22 offen offset:768 sc1 lds
    s_waitcnt lgkmcnt(0)
    v_mfma_f32_16x16x32_bf16 v[48:51], v[112:115], a[16:19], v[48:51]
    ds_read_b128 v[120:123], v14 offset:3072
    v_mfma_f32_16x16x32_bf16 v[48:51], v[116:119], a[24:27], v[48:51]
    ds_read_b128 v[124:127], v14 offset:7168
    v_mfma_f32_16x16x32_bf16 v[52:55], v[116:119], a[28:31], 0
    ds_read_b128 v[128:131], v14 offset:11264
    v_mfma_f32_16x16x32_bf16 v[52:55], v[112:115], a[20:23], v[52:55]
    ds_read_b128 v[132:135], v14 offset:15360
    v_mfma_f32_16x16x32_bf16 v[52:55], v[108:111], a[12:15], v[52:55]
    s_add_u32 m0, s73, 148480
    v_mfma_f32_16x16x32_bf16 v[52:55], v[104:107], a[4:7], v[52:55]
    buffer_load_dwordx4 v20, s[44:47], s22 offen offset:0 sc1 lds
    s_waitcnt lgkmcnt(2)
    v_mfma_f32_16x16x32_bf16 v[36:39], v[120:123], a[36:39], v[36:39]
    s_add_u32 m0, s73, 148992
    v_mfma_f32_16x16x32_bf16 v[36:39], v[124:127], a[44:47], v[36:39]
    buffer_load_dwordx4 v20, s[44:47], s22 offen offset:512 sc1 lds
    s_waitcnt lgkmcnt(0)
    v_mfma_f32_16x16x32_bf16 v[36:39], v[128:131], a[52:55], v[36:39]
    s_waitcnt vmcnt(7)
    s_barrier
    v_mfma_f32_16x16x32_bf16 v[36:39], v[132:135], a[60:63], v[36:39]
    ds_read_b128 v[104:107], v14 offset:16384
    v_add_u32 v10, -131072, v10
    v_mfma_f32_16x16x32_bf16 v[32:35], v[132:135], a[56:59], v[32:35]
    ds_read_b128 v[108:111], v14 offset:20480
    v_mfma_f32_16x16x32_bf16 v[32:35], v[128:131], a[48:51], v[32:35]
    ds_read_b128 v[112:115], v14 offset:24576
    ds_read_b64_tr_b16 a[160:161], v10 offset:32768
    v_mfma_f32_16x16x32_bf16 v[32:35], v[124:127], a[40:43], v[32:35]
    ds_read_b128 v[116:119], v14 offset:28672
    s_add_u32 m0, s73, 149760
    v_mfma_f32_16x16x32_bf16 v[32:35], v[120:123], a[32:35], v[32:35]
    buffer_load_dwordx4 v23, s[44:47], s23 offen offset:768 sc1 lds
    ds_read_b64_tr_b16 a[162:163], v10 offset:34816
    s_waitcnt lgkmcnt(4)
    v_mfma_f32_16x16x32_bf16 v[40:43], v[104:107], a[32:35], v[40:43]
    s_add_u32 m0, s73, 98304
    ds_read_b64_tr_b16 a[168:169], v10 offset:36864
    v_mfma_f32_16x16x32_bf16 v[40:43], v[108:111], a[40:43], v[40:43]
    buffer_load_dwordx4 v20, s[44:47], s23 offen offset:0 sc1 lds
    ds_read_b64_tr_b16 a[170:171], v10 offset:38912
    s_waitcnt lgkmcnt(3)
    v_mfma_f32_16x16x32_bf16 v[40:43], v[112:115], a[48:51], v[40:43]
    ds_read_b128 v[120:123], v14 offset:17408
    v_mfma_f32_16x16x32_bf16 v[40:43], v[116:119], a[56:59], v[40:43]
    ds_read_b128 v[124:127], v14 offset:21504
    v_add_u32 v11, -131072, v11
    v_mfma_f32_16x16x32_bf16 v[44:47], v[116:119], a[60:63], v[44:47]
    ds_read_b128 v[128:131], v14 offset:25600
    v_mfma_f32_16x16x32_bf16 v[44:47], v[112:115], a[52:55], v[44:47]
    ds_read_b128 v[132:135], v14 offset:29696
    v_mfma_f32_16x16x32_bf16 v[44:47], v[108:111], a[44:47], v[44:47]
    s_add_u32 m0, s73, 98816
    ds_read_b64_tr_b16 a[164:165], v11 offset:32768
    v_mfma_f32_16x16x32_bf16 v[44:47], v[104:107], a[36:39], v[44:47]
    buffer_load_dwordx4 v20, s[44:47], s23 offen offset:512 sc1 lds
    ds_read_b64_tr_b16 a[166:167], v11 offset:34816
    s_waitcnt lgkmcnt(4)
    v_mfma_f32_16x16x32_bf16 v[52:55], v[120:123], a[36:39], v[52:55]
    s_add_u32 m0, s73, 99584
    ds_read_b64_tr_b16 a[172:173], v11 offset:36864
    v_mfma_f32_16x16x32_bf16 v[52:55], v[124:127], a[44:47], v[52:55]
    buffer_load_dwordx4 v23, s[44:47], s24 offen offset:768 sc1 lds
    ds_read_b64_tr_b16 a[174:175], v11 offset:38912
    s_waitcnt lgkmcnt(4)
    v_mfma_f32_16x16x32_bf16 v[52:55], v[128:131], a[52:55], v[52:55]
    ds_read_b128 v[104:107], v14 offset:18432
    v_mfma_f32_16x16x32_bf16 v[52:55], v[132:135], a[60:63], v[52:55]
    ds_read_b128 v[108:111], v14 offset:22528
    v_add_u32 v10, 65536, v10
    v_mfma_f32_16x16x32_bf16 v[48:51], v[132:135], a[56:59], v[48:51]
    ds_read_b128 v[112:115], v14 offset:26624
    v_mfma_f32_16x16x32_bf16 v[48:51], v[128:131], a[48:51], v[48:51]
    ds_read_b128 v[116:119], v14 offset:30720
    v_mfma_f32_16x16x32_bf16 v[48:51], v[124:127], a[40:43], v[48:51]
    s_add_u32 m0, s73, 101376
    ds_read_b64_tr_b16 a[176:177], v10 offset:16384
    v_mfma_f32_16x16x32_bf16 v[48:51], v[120:123], a[32:35], v[48:51]
    buffer_load_dwordx4 v20, s[44:47], s24 offen offset:0 sc1 lds
    ds_read_b64_tr_b16 a[178:179], v10 offset:18432
    s_waitcnt lgkmcnt(4)
    v_mfma_f32_16x16x32_bf16 v[32:35], v[104:107], a[64:67], v[32:35]
    ds_read_b64_tr_b16 a[184:185], v10 offset:20480
    v_mfma_f32_16x16x32_bf16 v[32:35], v[108:111], a[72:75], v[32:35]
    ds_read_b64_tr_b16 a[186:187], v10 offset:22528
    s_waitcnt lgkmcnt(4)
    v_mfma_f32_16x16x32_bf16 v[32:35], v[112:115], a[80:83], v[32:35]
    ds_read_b128 v[120:123], v14 offset:19456
    v_mfma_f32_16x16x32_bf16 v[32:35], v[116:119], a[88:91], v[32:35]
    ds_read_b128 v[124:127], v14 offset:23552
    v_add_u32 v11, 65536, v11
    v_mfma_f32_16x16x32_bf16 v[36:39], v[116:119], a[92:95], v[36:39]
    ds_read_b128 v[128:131], v14 offset:27648
    v_mfma_f32_16x16x32_bf16 v[36:39], v[112:115], a[84:87], v[36:39]
    ds_read_b128 v[132:135], v14 offset:31744
    v_mfma_f32_16x16x32_bf16 v[36:39], v[108:111], a[76:79], v[36:39]
    ds_read_b64_tr_b16 a[180:181], v11 offset:16384
    v_mfma_f32_16x16x32_bf16 v[36:39], v[104:107], a[68:71], v[36:39]
    ds_read_b64_tr_b16 a[182:183], v11 offset:18432
    s_waitcnt lgkmcnt(4)
    v_mfma_f32_16x16x32_bf16 v[44:47], v[120:123], a[68:71], v[44:47]
    ds_read_b64_tr_b16 a[188:189], v11 offset:20480
    v_mfma_f32_16x16x32_bf16 v[44:47], v[124:127], a[76:79], v[44:47]
    ds_read_b64_tr_b16 a[190:191], v11 offset:22528
    s_waitcnt lgkmcnt(4)
    v_mfma_f32_16x16x32_bf16 v[44:47], v[128:131], a[84:87], v[44:47]
    s_waitcnt vmcnt(8) lgkmcnt(0)
    s_barrier
    v_mfma_f32_16x16x32_bf16 v[44:47], v[132:135], a[92:95], v[44:47]
    ds_read_b128 v[104:107], v14 offset:32768
    s_lshl_b32 s14, s100, 18
    s_add_u32 m0, s73, 32768
    v_add_u32 v10, -65536, v10
    v_mfma_f32_16x16x32_bf16 v[40:43], v[132:135], a[88:91], v[40:43]
    ds_read_b128 v[108:111], v14 offset:36864
    buffer_load_dwordx4 v4, s[52:55], s14 offen offset:0 lds
    v_mfma_f32_16x16x32_bf16 v[40:43], v[128:131], a[80:83], v[40:43]
    ds_read_b128 v[112:115], v14 offset:40960
    ds_read_b64_tr_b16 a[192:193], v10 offset:0
    v_mfma_f32_16x16x32_bf16 v[40:43], v[124:127], a[72:75], v[40:43]
    ds_read_b128 v[116:119], v14 offset:45056
    v_mfma_f32_16x16x32_bf16 v[40:43], v[120:123], a[64:67], v[40:43]
    ds_read_b64_tr_b16 a[194:195], v10 offset:2048
    s_waitcnt lgkmcnt(4)
    v_mfma_f32_16x16x32_bf16 v[48:51], v[104:107], a[64:67], v[48:51]
    s_add_u32 m0, s73, 114176
    ds_read_b64_tr_b16 a[200:201], v10 offset:4096
    v_mfma_f32_16x16x32_bf16 v[48:51], v[108:111], a[72:75], v[48:51]
    buffer_load_dwordx4 v20, s[44:47], s24 offen offset:512 sc1 lds
    ds_read_b64_tr_b16 a[202:203], v10 offset:6144
    s_waitcnt lgkmcnt(3)
    v_mfma_f32_16x16x32_bf16 v[48:51], v[112:115], a[80:83], v[48:51]
    ds_read_b128 v[120:123], v14 offset:33792
    s_add_u32 m0, s73, 32768
    v_lshrrev_b32 v30, 2, v26
    v_mfma_f32_16x16x32_bf16 v[48:51], v[116:119], a[88:91], v[48:51]
    ds_read_b128 v[124:127], v14 offset:37888
    buffer_load_dwordx4 v5, s[52:55], s14 offen offset:1024 lds
    v_mfma_f32_16x16x32_bf16 v[52:55], v[116:119], a[92:95], v[52:55]
    ds_read_b128 v[128:131], v14 offset:41984
    v_add_u32 v11, -65536, v11
    v_mfma_f32_16x16x32_bf16 v[52:55], v[112:115], a[84:87], v[52:55]
    ds_read_b128 v[132:135], v14 offset:46080
    v_mfma_f32_16x16x32_bf16 v[52:55], v[108:111], a[76:79], v[52:55]
    s_add_u32 m0, s73, 114944
    ds_read_b64_tr_b16 a[196:197], v11 offset:0
    v_mfma_f32_16x16x32_bf16 v[52:55], v[104:107], a[68:71], v[52:55]
    buffer_load_dwordx4 v23, s[44:47], s25 offen offset:768 sc1 lds
    ds_read_b64_tr_b16 a[198:199], v11 offset:2048
    s_waitcnt lgkmcnt(4)
    v_mfma_f32_16x16x32_bf16 v[36:39], v[120:123], a[100:103], v[36:39]
    s_add_u32 m0, s73, 116736
    ds_read_b64_tr_b16 a[204:205], v11 offset:4096
    v_mfma_f32_16x16x32_bf16 v[36:39], v[124:127], a[108:111], v[36:39]
    buffer_load_dwordx4 v20, s[44:47], s25 offen offset:0 sc1 lds
    ds_read_b64_tr_b16 a[206:207], v11 offset:6144
    s_waitcnt lgkmcnt(4)
    v_mfma_f32_16x16x32_bf16 v[36:39], v[128:131], a[116:119], v[36:39]
    ds_read_b128 v[104:107], v14 offset:34816
    s_add_u32 m0, s73, 32768
    v_lshrrev_b32 v31, 2, v18
    v_mfma_f32_16x16x32_bf16 v[36:39], v[132:135], a[124:127], v[36:39]
    ds_read_b128 v[108:111], v14 offset:38912
    buffer_load_dwordx4 v6, s[52:55], s14 offen offset:2048 lds
    v_mfma_f32_16x16x32_bf16 v[32:35], v[132:135], a[120:123], v[32:35]
    ds_read_b128 v[112:115], v14 offset:43008
    v_mfma_f32_16x16x32_bf16 v[32:35], v[128:131], a[112:115], v[32:35]
    ds_read_b128 v[116:119], v14 offset:47104
    v_mfma_f32_16x16x32_bf16 v[32:35], v[124:127], a[104:107], v[32:35]
    s_add_u32 m0, s73, 117248
    ds_read_b64_tr_b16 a[208:209], v10 offset:16384
    v_mfma_f32_16x16x32_bf16 v[32:35], v[120:123], a[96:99], v[32:35]
    buffer_load_dwordx4 v20, s[44:47], s25 offen offset:512 sc1 lds
    ds_read_b64_tr_b16 a[210:211], v10 offset:18432
    s_waitcnt lgkmcnt(4)
    v_mfma_f32_16x16x32_bf16 v[40:43], v[104:107], a[96:99], v[40:43]
    ds_read_b64_tr_b16 a[216:217], v10 offset:20480
    buffer_load_ushort v102, v30, s[60:63], 0 offen offset:0
    s_add_u32 m0, s73, 32768
    v_mfma_f32_16x16x32_bf16 v[40:43], v[108:111], a[104:107], v[40:43]
    ds_read_b64_tr_b16 a[218:219], v10 offset:22528
    buffer_load_dwordx4 v7, s[52:55], s14 offen offset:3072 lds
    s_waitcnt lgkmcnt(4)
    v_mfma_f32_16x16x32_bf16 v[40:43], v[112:115], a[112:115], v[40:43]
    ds_read_b128 v[120:123], v14 offset:35840
    v_mfma_f32_16x16x32_bf16 v[40:43], v[116:119], a[120:123], v[40:43]
    ds_read_b128 v[124:127], v14 offset:39936
    v_mfma_f32_16x16x32_bf16 v[44:47], v[116:119], a[124:127], v[44:47]
    ds_read_b128 v[128:131], v14 offset:44032
    v_mfma_f32_16x16x32_bf16 v[44:47], v[112:115], a[116:119], v[44:47]
    ds_read_b128 v[132:135], v14 offset:48128
    v_mfma_f32_16x16x32_bf16 v[44:47], v[108:111], a[108:111], v[44:47]
    ds_read_b64_tr_b16 a[212:213], v11 offset:16384
    buffer_load_ushort v103, v30, s[60:63], 0 offen offset:32
    v_mfma_f32_16x16x32_bf16 v[44:47], v[104:107], a[100:103], v[44:47]
    ds_read_b64_tr_b16 a[214:215], v11 offset:18432
    s_waitcnt lgkmcnt(4)
    v_mfma_f32_16x16x32_bf16 v[52:55], v[120:123], a[100:103], v[52:55]
    ds_read_b64_tr_b16 a[220:221], v11 offset:20480
    v_mfma_f32_16x16x32_bf16 v[52:55], v[124:127], a[108:111], v[52:55]
    ds_read_b64_tr_b16 a[222:223], v11 offset:22528
    s_waitcnt lgkmcnt(4)
    v_mfma_f32_16x16x32_bf16 v[52:55], v[128:131], a[116:119], v[52:55]
    s_waitcnt vmcnt(14) lgkmcnt(0)
    s_barrier
    v_mfma_f32_16x16x32_bf16 v[52:55], v[132:135], a[124:127], v[52:55]
    ds_read_b128 v[104:107], v14 offset:49152
    s_lshl_b32 s14, s101, 18
    ds_read_b64_tr_b16 a[224:225], v10 offset:49152
    s_add_u32 m0, s73, 81920
    v_mfma_f32_16x16x32_bf16 v[48:51], v[132:135], a[120:123], v[48:51]
    ds_read_b128 v[108:111], v14 offset:53248
    buffer_load_dwordx4 v4, s[52:55], s14 offen offset:0 lds
    v_mfma_f32_16x16x32_bf16 v[48:51], v[128:131], a[112:115], v[48:51]
    ds_read_b128 v[112:115], v14 offset:57344
    buffer_load_ushort v27, v31, s[60:63], 0 offen offset:0
    v_mfma_f32_16x16x32_bf16 v[48:51], v[124:127], a[104:107], v[48:51]
    ds_read_b128 v[116:119], v14 offset:61440
    v_mfma_f32_16x16x32_bf16 v[48:51], v[120:123], a[96:99], v[48:51]
    ds_read_b64_tr_b16 a[226:227], v10 offset:51200
    s_waitcnt lgkmcnt(3)
    v_mfma_f32_16x16x32_bf16 v[32:35], v[104:107], a[128:131], v[32:35]
    s_add_u32 m0, s73, 130304
    ds_read_b64_tr_b16 a[232:233], v10 offset:53248
    v_mfma_f32_16x16x32_bf16 v[32:35], v[108:111], a[136:139], v[32:35]
    buffer_load_dwordx4 v23, s[44:47], s26 offen offset:768 sc1 lds
    ds_read_b64_tr_b16 a[234:235], v10 offset:55296
    s_waitcnt lgkmcnt(3)
    v_mfma_f32_16x16x32_bf16 v[32:35], v[112:115], a[144:147], v[32:35]
    ds_read_b128 v[120:123], v14 offset:50176
    s_add_u32 m0, s73, 81920
    v_mfma_f32_16x16x32_bf16 v[32:35], v[116:119], a[152:155], v[32:35]
    ds_read_b128 v[124:127], v14 offset:54272
    buffer_load_dwordx4 v5, s[52:55], s14 offen offset:1024 lds
    v_mfma_f32_16x16x32_bf16 v[36:39], v[116:119], a[156:159], v[36:39]
    ds_read_b128 v[128:131], v14 offset:58368
    v_mfma_f32_16x16x32_bf16 v[36:39], v[112:115], a[148:151], v[36:39]
    ds_read_b128 v[132:135], v14 offset:62464
    v_mfma_f32_16x16x32_bf16 v[36:39], v[108:111], a[140:143], v[36:39]
    s_add_u32 m0, s73, 132096
    ds_read_b64_tr_b16 a[228:229], v11 offset:49152
    v_mfma_f32_16x16x32_bf16 v[36:39], v[104:107], a[132:135], v[36:39]
    buffer_load_dwordx4 v20, s[44:47], s26 offen offset:0 sc1 lds
    ds_read_b64_tr_b16 a[230:231], v11 offset:51200
    s_waitcnt lgkmcnt(4)
    v_mfma_f32_16x16x32_bf16 v[44:47], v[120:123], a[132:135], v[44:47]
    ds_read_b64_tr_b16 a[236:237], v11 offset:53248
    buffer_load_dwordx4 v[88:91], v252, s[56:59], 0 offen
    s_add_u32 m0, s73, 132608
    v_mfma_f32_16x16x32_bf16 v[44:47], v[124:127], a[140:143], v[44:47]
    buffer_load_dwordx4 v20, s[44:47], s26 offen offset:512 sc1 lds
    ds_read_b64_tr_b16 a[238:239], v11 offset:55296
    s_waitcnt lgkmcnt(4)
    v_mfma_f32_16x16x32_bf16 v[44:47], v[128:131], a[148:151], v[44:47]
    ds_read_b128 v[104:107], v14 offset:51200
    s_add_u32 m0, s73, 81920
    v_add_u32 v10, 65536, v10
    v_mfma_f32_16x16x32_bf16 v[44:47], v[132:135], a[156:159], v[44:47]
    ds_read_b128 v[108:111], v14 offset:55296
    buffer_load_dwordx4 v6, s[52:55], s14 offen offset:2048 lds
    v_mfma_f32_16x16x32_bf16 v[40:43], v[132:135], a[152:155], v[40:43]
    ds_read_b128 v[112:115], v14 offset:59392
    v_mfma_f32_16x16x32_bf16 v[40:43], v[128:131], a[144:147], v[40:43]
    ds_read_b128 v[116:119], v14 offset:63488
    v_mfma_f32_16x16x32_bf16 v[40:43], v[124:127], a[136:139], v[40:43]
    s_add_u32 m0, s73, 134144
    ds_read_b64_tr_b16 a[240:241], v10 offset:0
    v_mfma_f32_16x16x32_bf16 v[40:43], v[120:123], a[128:131], v[40:43]
    buffer_load_dwordx4 v21, s[44:47], s18 offen offset:0 sc1 lds
    ds_read_b64_tr_b16 a[242:243], v10 offset:2048
    s_waitcnt lgkmcnt(4)
    v_mfma_f32_16x16x32_bf16 v[48:51], v[104:107], a[128:131], v[48:51]
    ds_read_b64_tr_b16 a[248:249], v10 offset:4096
    s_add_u32 m0, s73, 81920
    v_mfma_f32_16x16x32_bf16 v[48:51], v[108:111], a[136:139], v[48:51]
    ds_read_b64_tr_b16 a[250:251], v10 offset:6144
    buffer_load_dwordx4 v7, s[52:55], s14 offen offset:3072 lds
    s_waitcnt lgkmcnt(4)
    v_mfma_f32_16x16x32_bf16 v[48:51], v[112:115], a[144:147], v[48:51]
    ds_read_b128 v[120:123], v14 offset:52224
    v_add_u32 v11, 65536, v11
    v_mfma_f32_16x16x32_bf16 v[48:51], v[116:119], a[152:155], v[48:51]
    ds_read_b128 v[124:127], v14 offset:56320
    v_mfma_f32_16x16x32_bf16 v[52:55], v[116:119], a[156:159], v[52:55]
    ds_read_b128 v[128:131], v14 offset:60416
    v_mfma_f32_16x16x32_bf16 v[52:55], v[112:115], a[148:151], v[52:55]
    ds_read_b128 v[132:135], v14 offset:64512
    v_mfma_f32_16x16x32_bf16 v[52:55], v[108:111], a[140:143], v[52:55]
    ds_read_b64_tr_b16 a[244:245], v11 offset:0
    v_mfma_f32_16x16x32_bf16 v[52:55], v[104:107], a[132:135], v[52:55]
    ds_read_b64_tr_b16 a[246:247], v11 offset:2048
    s_waitcnt lgkmcnt(4)
    v_mfma_f32_16x16x32_bf16 v[36:39], v[120:123], a[164:167], v[36:39]
    ds_read_b64_tr_b16 a[252:253], v11 offset:4096
    buffer_load_dwordx4 v[92:95], v252, s[56:59], s40 offen
    v_mfma_f32_16x16x32_bf16 v[36:39], v[124:127], a[172:175], v[36:39]
    ds_read_b64_tr_b16 a[254:255], v11 offset:6144
    s_waitcnt lgkmcnt(4)
    v_mfma_f32_16x16x32_bf16 v[36:39], v[128:131], a[180:183], v[36:39]
    s_waitcnt vmcnt(12) lgkmcnt(0)
    s_barrier
    v_mfma_f32_16x16x32_bf16 v[36:39], v[132:135], a[188:191], v[36:39]
    ds_read_b128 v[104:107], v14 offset:0
    v_mfma_f32_16x16x32_bf16 v[32:35], v[132:135], a[184:187], v[32:35]
    ds_read_b128 v[108:111], v14 offset:4096
    v_add_u32 v10, -65536, v10
L_pl_G_6:
    s_cbranch_execz L_wret
    v_mfma_f32_16x16x32_bf16 v[32:35], v[128:131], a[176:179], v[32:35]
    ds_read_b128 v[112:115], v14 offset:8192
    v_mfma_f32_16x16x32_bf16 v[32:35], v[124:127], a[168:171], v[32:35]
    ds_read_b128 v[116:119], v14 offset:12288
    v_mfma_f32_16x16x32_bf16 v[32:35], v[120:123], a[160:163], v[32:35]
    ds_read_b64_tr_b16 v[220:221], v10 offset:32768
    s_waitcnt lgkmcnt(3)
    v_mfma_f32_16x16x32_bf16 v[40:43], v[104:107], a[160:163], v[40:43]
    s_add_u32 m0, s73, 146944
    v_mfma_f32_16x16x32_bf16 v[40:43], v[108:111], a[168:171], v[40:43]
    buffer_load_dwordx4 v21, s[44:47], s18 offen offset:512 sc1 lds
    ds_read_b64_tr_b16 v[222:223], v10 offset:34816
    s_waitcnt lgkmcnt(2)
    v_mfma_f32_16x16x32_bf16 v[40:43], v[112:115], a[176:179], v[40:43]
    ds_read_b128 v[120:123], v14 offset:1024
    v_mfma_f32_16x16x32_bf16 v[40:43], v[116:119], a[184:187], v[40:43]
    ds_read_b128 v[124:127], v14 offset:5120
    v_mfma_f32_16x16x32_bf16 v[44:47], v[116:119], a[188:191], v[44:47]
    ds_read_b128 v[128:131], v14 offset:9216
    v_mfma_f32_16x16x32_bf16 v[44:47], v[112:115], a[180:183], v[44:47]
    ds_read_b128 v[132:135], v14 offset:13312
    v_mfma_f32_16x16x32_bf16 v[44:47], v[108:111], a[172:175], v[44:47]
    s_add_u32 m0, s73, 148480
    ds_read_b64_tr_b16 v[228:229], v10 offset:36864
    v_mfma_f32_16x16x32_bf16 v[44:47], v[104:107], a[164:167], v[44:47]
    buffer_load_dwordx4 v21, s[44:47], s19 offen offset:0 sc1 lds
    s_waitcnt lgkmcnt(3)
    v_mfma_f32_16x16x32_bf16 v[52:55], v[120:123], a[164:167], v[52:55]
    ds_read_b64_tr_b16 v[230:231], v10 offset:38912
    buffer_load_dwordx2 v[142:143], v253, s[56:59], 0 offen
    s_add_u32 m0, s73, 148992
    v_mfma_f32_16x16x32_bf16 v[52:55], v[124:127], a[172:175], v[52:55]
    buffer_load_dwordx4 v21, s[44:47], s19 offen offset:512 sc1 lds
    s_waitcnt lgkmcnt(2)
    v_mfma_f32_16x16x32_bf16 v[52:55], v[128:131], a[180:183], v[52:55]
    ds_read_b128 v[104:107], v14 offset:2048
    v_mfma_f32_16x16x32_bf16 v[52:55], v[132:135], a[188:191], v[52:55]
    ds_read_b128 v[108:111], v14 offset:6144
    v_mfma_f32_16x16x32_bf16 v[48:51], v[132:135], a[184:187], v[48:51]
    ds_read_b128 v[112:115], v14 offset:10240
    v_add_u32 v11, -65536, v11
    v_mfma_f32_16x16x32_bf16 v[48:51], v[128:131], a[176:179], v[48:51]
    ds_read_b128 v[116:119], v14 offset:14336
    v_mfma_f32_16x16x32_bf16 v[48:51], v[124:127], a[168:171], v[48:51]
    s_add_u32 m0, s73, 150528
    v_mfma_f32_16x16x32_bf16 v[48:51], v[120:123], a[160:163], v[48:51]
    buffer_load_dwordx4 v21, s[44:47], s20 offen offset:0 sc1 lds
    ds_read_b64_tr_b16 v[224:225], v11 offset:32768
    s_waitcnt lgkmcnt(3)
    v_mfma_f32_16x16x32_bf16 v[32:35], v[104:107], a[192:195], v[32:35]
    v_mfma_f32_16x16x32_bf16 v[32:35], v[108:111], a[200:203], v[32:35]
    ds_read_b64_tr_b16 v[226:227], v11 offset:34816
    s_waitcnt vmcnt(14)
    s_waitcnt lgkmcnt(2)
    v_mfma_f32_16x16x32_bf16 v[32:35], v[112:115], a[208:211], v[32:35]
    ds_read_b128 v[120:123], v14 offset:3072
    v_mfma_f32_16x16x32_bf16 v[32:35], v[116:119], a[216:219], v[32:35]
    ds_read_b128 v[124:127], v14 offset:7168
    v_mfma_f32_16x16x32_bf16 v[36:39], v[116:119], a[220:223], v[36:39]
    ds_read_b128 v[128:131], v14 offset:11264
    v_lshlrev_b32 v72, 16, v102
    v_mfma_f32_16x16x32_bf16 v[36:39], v[112:115], a[212:215], v[36:39]
    ds_read_b128 v[132:135], v14 offset:15360
    v_mfma_f32_16x16x32_bf16 v[36:39], v[108:111], a[204:207], v[36:39]
    ds_read_b64_tr_b16 v[232:233], v11 offset:36864
    v_lshlrev_b32 v73, 16, v102
    v_mfma_f32_16x16x32_bf16 v[36:39], v[104:107], a[196:199], v[36:39]
    s_waitcnt lgkmcnt(3)
    v_mfma_f32_16x16x32_bf16 v[44:47], v[120:123], a[196:199], v[44:47]
    ds_read_b64_tr_b16 v[234:235], v11 offset:38912
    buffer_load_dwordx2 v[96:97], v26, s[44:47], s42 offen offset:0 sc1
    v_mfma_f32_16x16x32_bf16 v[44:47], v[124:127], a[204:207], v[44:47]
    v_lshlrev_b32 v74, 16, v102
    s_waitcnt lgkmcnt(2)
    v_mfma_f32_16x16x32_bf16 v[44:47], v[128:131], a[212:215], v[44:47]
    s_waitcnt vmcnt(7) lgkmcnt(0)
    s_barrier
    v_mfma_f32_16x16x32_bf16 v[44:47], v[132:135], a[220:223], v[44:47]
    ds_read_b128 v[104:107], v14 offset:16384
    v_lshlrev_b32 v75, 16, v102
    v_mfma_f32_16x16x32_bf16 v[40:43], v[132:135], a[216:219], v[40:43]
    ds_read_b128 v[108:111], v14 offset:20480
    v_add_u32 v10, 65536, v10
    v_mfma_f32_16x16x32_bf16 v[40:43], v[128:131], a[208:211], v[40:43]
    ds_read_b128 v[112:115], v14 offset:24576
    v_mfma_f32_16x16x32_bf16 v[40:43], v[124:127], a[200:203], v[40:43]
    ds_read_b128 v[116:119], v14 offset:28672
    v_lshlrev_b32 v76, 16, v103
    v_mfma_f32_16x16x32_bf16 v[40:43], v[120:123], a[192:195], v[40:43]
    ds_read_b64_tr_b16 v[236:237], v10 offset:16384
    s_waitcnt lgkmcnt(3)
    v_mfma_f32_16x16x32_bf16 v[48:51], v[104:107], a[192:195], v[48:51]
    s_add_u32 m0, s73, 97792
    v_lshlrev_b32 v77, 16, v103
    v_mfma_f32_16x16x32_bf16 v[48:51], v[108:111], a[200:203], v[48:51]
    buffer_load_dwordx4 v21, s[44:47], s20 offen offset:512 sc1 lds
    ds_read_b64_tr_b16 v[238:239], v10 offset:18432
    s_waitcnt lgkmcnt(2)
    v_mfma_f32_16x16x32_bf16 v[48:51], v[112:115], a[208:211], v[48:51]
    ds_read_b128 v[120:123], v14 offset:17408
    v_mfma_f32_16x16x32_bf16 v[48:51], v[116:119], a[216:219], v[48:51]
    ds_read_b128 v[124:127], v14 offset:21504
    v_mfma_f32_16x16x32_bf16 v[52:55], v[116:119], a[220:223], v[52:55]
    ds_read_b128 v[128:131], v14 offset:25600
    v_lshlrev_b32 v78, 16, v103
    v_mfma_f32_16x16x32_bf16 v[52:55], v[112:115], a[212:215], v[52:55]
    ds_read_b128 v[132:135], v14 offset:29696
    v_mfma_f32_16x16x32_bf16 v[52:55], v[108:111], a[204:207], v[52:55]
    ds_read_b64_tr_b16 v[244:245], v10 offset:20480
    s_add_u32 m0, s73, 99328
    v_lshlrev_b32 v79, 16, v103
    v_mfma_f32_16x16x32_bf16 v[52:55], v[104:107], a[196:199], v[52:55]
    buffer_load_dwordx4 v21, s[44:47], s21 offen offset:0 sc1 lds
    s_waitcnt lgkmcnt(3)
    v_mfma_f32_16x16x32_bf16 v[36:39], v[120:123], a[228:231], v[36:39]
    ds_read_b64_tr_b16 v[246:247], v10 offset:22528
    buffer_load_dwordx2 v[98:99], v26, s[44:47], s42 offen offset:128 sc1
    s_add_u32 m0, s73, 99840
    v_mfma_f32_16x16x32_bf16 v[36:39], v[124:127], a[236:239], v[36:39]
    buffer_load_dwordx4 v21, s[44:47], s21 offen offset:512 sc1 lds
    s_waitcnt lgkmcnt(2)
    v_mfma_f32_16x16x32_bf16 v[36:39], v[128:131], a[244:247], v[36:39]
    ds_read_b128 v[104:107], v14 offset:18432
    v_lshlrev_b32 v80, 16, v102
    v_mfma_f32_16x16x32_bf16 v[36:39], v[132:135], a[252:255], v[36:39]
    ds_read_b128 v[108:111], v14 offset:22528
    v_lshlrev_b32 v81, 16, v102
    v_mfma_f32_16x16x32_bf16 v[32:35], v[132:135], a[248:251], v[32:35]
    ds_read_b128 v[112:115], v14 offset:26624
    v_add_u32 v11, 65536, v11
    v_mfma_f32_16x16x32_bf16 v[32:35], v[128:131], a[240:243], v[32:35]
    ds_read_b128 v[116:119], v14 offset:30720
    v_mfma_f32_16x16x32_bf16 v[32:35], v[124:127], a[232:235], v[32:35]
    s_add_u32 m0, s73, 101376
    v_lshlrev_b32 v82, 16, v102
    v_mfma_f32_16x16x32_bf16 v[32:35], v[120:123], a[224:227], v[32:35]
    buffer_load_dwordx4 v21, s[44:47], s22 offen offset:0 sc1 lds
    ds_read_b64_tr_b16 v[240:241], v11 offset:16384
    s_waitcnt lgkmcnt(3)
    v_mfma_f32_16x16x32_bf16 v[40:43], v[104:107], a[224:227], v[40:43]
    v_lshlrev_b32 v83, 16, v102
    v_mfma_f32_16x16x32_bf16 v[40:43], v[108:111], a[232:235], v[40:43]
    ds_read_b64_tr_b16 v[242:243], v11 offset:18432
    s_waitcnt lgkmcnt(2)
    v_mfma_f32_16x16x32_bf16 v[40:43], v[112:115], a[240:243], v[40:43]
    ds_read_b128 v[120:123], v14 offset:19456
    v_mfma_f32_16x16x32_bf16 v[40:43], v[116:119], a[248:251], v[40:43]
    ds_read_b128 v[124:127], v14 offset:23552
    v_mfma_f32_16x16x32_bf16 v[44:47], v[116:119], a[252:255], v[44:47]
    ds_read_b128 v[128:131], v14 offset:27648
    v_lshlrev_b32 v84, 16, v103
    v_mfma_f32_16x16x32_bf16 v[44:47], v[112:115], a[244:247], v[44:47]
    ds_read_b128 v[132:135], v14 offset:31744
    v_mfma_f32_16x16x32_bf16 v[44:47], v[108:111], a[236:239], v[44:47]
    ds_read_b64_tr_b16 v[248:249], v11 offset:20480
    v_lshlrev_b32 v85, 16, v103
    v_mfma_f32_16x16x32_bf16 v[44:47], v[104:107], a[228:231], v[44:47]
    s_waitcnt lgkmcnt(3)
    v_mfma_f32_16x16x32_bf16 v[52:55], v[120:123], a[228:231], v[52:55]
    ds_read_b64_tr_b16 v[250:251], v11 offset:22528
    buffer_load_dwordx2 v[100:101], v18, s[44:47], s42 offen offset:0 sc1
    v_mfma_f32_16x16x32_bf16 v[52:55], v[124:127], a[236:239], v[52:55]
    v_lshlrev_b32 v86, 16, v103
    s_waitcnt lgkmcnt(2)
    v_mfma_f32_16x16x32_bf16 v[52:55], v[128:131], a[244:247], v[52:55]
    s_waitcnt lgkmcnt(0)
    s_barrier
    v_mfma_f32_16x16x32_bf16 v[52:55], v[132:135], a[252:255], v[52:55]
    ds_read_b128 v[104:107], v14 offset:32768
    v_mfma_f32_16x16x32_bf16 v[48:51], v[132:135], a[248:251], v[48:51]
    ds_read_b128 v[108:111], v14 offset:36864
    v_lshlrev_b32 v87, 16, v103
    v_mfma_f32_16x16x32_bf16 v[48:51], v[128:131], a[240:243], v[48:51]
    ds_read_b128 v[112:115], v14 offset:40960
    v_mfma_f32_16x16x32_bf16 v[48:51], v[124:127], a[232:235], v[48:51]
    ds_read_b128 v[116:119], v14 offset:45056
    v_lshlrev_b32 v27, 16, v27
    v_mfma_f32_16x16x32_bf16 v[48:51], v[120:123], a[224:227], v[48:51]
L_Dc:
L_pl_D_0:
    s_cbranch_execz L_wret
    s_waitcnt lgkmcnt(2)
    v_mfma_f32_16x16x32_bf16 v[32:35], v[104:107], v[220:223], v[32:35]
    s_add_u32 m0, s73, 114176
    v_mfma_f32_16x16x32_bf16 v[32:35], v[108:111], v[228:231], v[32:35]
    buffer_load_dwordx4 v21, s[44:47], s22 offen offset:512 sc1 lds
    s_waitcnt lgkmcnt(0)
    v_mfma_f32_16x16x32_bf16 v[32:35], v[112:115], v[236:239], v[32:35]
    ds_read_b128 v[120:123], v14 offset:33792
    v_mfma_f32_16x16x32_bf16 v[32:35], v[116:119], v[244:247], v[32:35]
    ds_read_b128 v[124:127], v14 offset:37888
    v_mfma_f32_16x16x32_bf16 v[36:39], v[116:119], v[248:251], v[36:39]
    ds_read_b128 v[128:131], v14 offset:41984
    buffer_load_dword v189, v188, s[44:47], 0 offen sc1
    v_mfma_f32_16x16x32_bf16 v[36:39], v[112:115], v[240:243], v[36:39]
    ds_read_b128 v[132:135], v14 offset:46080
    v_mfma_f32_16x16x32_bf16 v[36:39], v[108:111], v[232:235], v[36:39]
    s_add_u32 m0, s73, 115712
    v_mfma_f32_16x16x32_bf16 v[36:39], v[104:107], v[224:227], v[36:39]
    buffer_load_dwordx4 v21, s[44:47], s23 offen offset:0 sc1 lds
    s_waitcnt lgkmcnt(2)
    v_mfma_f32_16x16x32_bf16 v[44:47], v[120:123], v[224:227], v[44:47]
    s_add_u32 m0, s73, 116224
    v_mfma_f32_16x16x32_bf16 v[44:47], v[124:127], v[232:235], v[44:47]
    buffer_load_dwordx4 v21, s[44:47], s23 offen offset:512 sc1 lds
    s_waitcnt lgkmcnt(0)
    v_mfma_f32_16x16x32_bf16 v[44:47], v[128:131], v[240:243], v[44:47]
    ds_read_b128 v[104:107], v14 offset:34816
    v_mfma_f32_16x16x32_bf16 v[44:47], v[132:135], v[248:251], v[44:47]
    ds_read_b128 v[108:111], v14 offset:38912
    v_mfma_f32_16x16x32_bf16 v[40:43], v[132:135], v[244:247], v[40:43]
    ds_read_b128 v[112:115], v14 offset:43008
    v_mfma_f32_16x16x32_bf16 v[40:43], v[128:131], v[236:239], v[40:43]
    ds_read_b128 v[116:119], v14 offset:47104
    v_mfma_f32_16x16x32_bf16 v[40:43], v[124:127], v[228:231], v[40:43]
    s_add_u32 m0, s73, 117760
    v_mfma_f32_16x16x32_bf16 v[40:43], v[120:123], v[220:223], v[40:43]
    buffer_load_dwordx4 v21, s[44:47], s24 offen offset:0 sc1 lds
    s_waitcnt lgkmcnt(2)
    v_mfma_f32_16x16x32_bf16 v[48:51], v[104:107], v[220:223], v[48:51]
    v_mfma_f32_16x16x32_bf16 v[48:51], v[108:111], v[228:231], v[48:51]
    s_waitcnt lgkmcnt(0)
    v_mfma_f32_16x16x32_bf16 v[48:51], v[112:115], v[236:239], v[48:51]
    ds_read_b128 v[120:123], v14 offset:35840
    v_mfma_f32_16x16x32_bf16 v[48:51], v[116:119], v[244:247], v[48:51]
    ds_read_b128 v[124:127], v14 offset:39936
    v_mfma_f32_16x16x32_bf16 v[52:55], v[116:119], v[248:251], v[52:55]
    ds_read_b128 v[128:131], v14 offset:44032
    v_mfma_f32_16x16x32_bf16 v[52:55], v[112:115], v[240:243], v[52:55]
    ds_read_b128 v[132:135], v14 offset:48128
    v_mfma_f32_16x16x32_bf16 v[52:55], v[108:111], v[232:235], v[52:55]
    v_mfma_f32_16x16x32_bf16 v[52:55], v[104:107], v[224:227], v[52:55]
    s_waitcnt lgkmcnt(2)
    v_mfma_f32_16x16x32_bf16 v[60:63], v[120:123], a[4:7], 0
    v_mfma_f32_16x16x32_bf16 v[60:63], v[124:127], a[12:15], v[60:63]
    s_waitcnt lgkmcnt(0)
    v_mfma_f32_16x16x32_bf16 v[60:63], v[128:131], a[20:23], v[60:63]
    s_waitcnt vmcnt(12)
    s_barrier
    v_mfma_f32_16x16x32_bf16 v[60:63], v[132:135], a[28:31], v[60:63]
    ds_read_b128 v[104:107], v14 offset:49152
    v_mfma_f32_16x16x32_bf16 v[56:59], v[132:135], a[24:27], 0
    ds_read_b128 v[108:111], v14 offset:53248
    v_mfma_f32_16x16x32_bf16 v[56:59], v[128:131], a[16:19], v[56:59]
    ds_read_b128 v[112:115], v14 offset:57344
    v_cvt_pk_bf16_f32 v192, v32, v33
    v_mfma_f32_16x16x32_bf16 v[56:59], v[124:127], a[8:11], v[56:59]
    ds_read_b128 v[116:119], v14 offset:61440
    v_mfma_f32_16x16x32_bf16 v[56:59], v[120:123], a[0:3], v[56:59]
    s_waitcnt lgkmcnt(2)
    v_mfma_f32_16x16x32_bf16 v[64:67], v[104:107], a[0:3], 0
    s_add_u32 m0, s73, 130560
    v_mfma_f32_16x16x32_bf16 v[64:67], v[108:111], a[8:11], v[64:67]
    buffer_load_dwordx4 v21, s[44:47], s24 offen offset:512 sc1 lds
    s_waitcnt lgkmcnt(0)
    v_mfma_f32_16x16x32_bf16 v[64:67], v[112:115], a[16:19], v[64:67]
    ds_read_b128 v[120:123], v14 offset:50176
    v_cvt_pk_bf16_f32 v193, v34, v35
    v_mfma_f32_16x16x32_bf16 v[64:67], v[116:119], a[24:27], v[64:67]
    ds_read_b128 v[124:127], v14 offset:54272
    v_mfma_f32_16x16x32_bf16 v[68:71], v[116:119], a[28:31], 0
    ds_read_b128 v[128:131], v14 offset:58368
    v_mfma_f32_16x16x32_bf16 v[68:71], v[112:115], a[20:23], v[68:71]
    buffer_store_dwordx4 v[192:195], v136, s[44:47], s32 offen sc1
    ds_read_b128 v[132:135], v14 offset:62464
    v_mfma_f32_16x16x32_bf16 v[68:71], v[108:111], a[12:15], v[68:71]
    s_add_u32 m0, s73, 132096
    v_mfma_f32_16x16x32_bf16 v[68:71], v[104:107], a[4:7], v[68:71]
    buffer_load_dwordx4 v21, s[44:47], s25 offen offset:0 sc1 lds
    s_waitcnt lgkmcnt(2)
    v_mfma_f32_16x16x32_bf16 v[60:63], v[120:123], a[36:39], v[60:63]
    s_add_u32 m0, s73, 132608
    v_mfma_f32_16x16x32_bf16 v[60:63], v[124:127], a[44:47], v[60:63]
    buffer_load_dwordx4 v21, s[44:47], s25 offen offset:512 sc1 lds
    s_waitcnt lgkmcnt(0)
    v_mfma_f32_16x16x32_bf16 v[60:63], v[128:131], a[52:55], v[60:63]
    ds_read_b128 v[104:107], v14 offset:51200
    v_mfma_f32_16x16x32_bf16 v[60:63], v[132:135], a[60:63], v[60:63]
    ds_read_b128 v[108:111], v14 offset:55296
    v_mfma_f32_16x16x32_bf16 v[56:59], v[132:135], a[56:59], v[56:59]
    ds_read_b128 v[112:115], v14 offset:59392
    v_mfma_f32_16x16x32_bf16 v[56:59], v[128:131], a[48:51], v[56:59]
    ds_read_b128 v[116:119], v14 offset:63488
    v_mfma_f32_16x16x32_bf16 v[56:59], v[124:127], a[40:43], v[56:59]
    s_add_u32 m0, s73, 134144
    v_cvt_pk_bf16_f32 v196, v36, v37
    v_mfma_f32_16x16x32_bf16 v[56:59], v[120:123], a[32:35], v[56:59]
    buffer_load_dwordx4 v21, s[44:47], s26 offen offset:0 sc1 lds
    s_waitcnt lgkmcnt(2)
    v_mfma_f32_16x16x32_bf16 v[64:67], v[104:107], a[32:35], v[64:67]
    v_mfma_f32_16x16x32_bf16 v[64:67], v[108:111], a[40:43], v[64:67]
    s_waitcnt lgkmcnt(0)
    v_mfma_f32_16x16x32_bf16 v[64:67], v[112:115], a[48:51], v[64:67]
    ds_read_b128 v[120:123], v14 offset:52224
    v_cvt_pk_bf16_f32 v197, v38, v39
    v_mfma_f32_16x16x32_bf16 v[64:67], v[116:119], a[56:59], v[64:67]
    ds_read_b128 v[124:127], v14 offset:56320
    v_mfma_f32_16x16x32_bf16 v[68:71], v[116:119], a[60:63], v[68:71]
    ds_read_b128 v[128:131], v14 offset:60416
    v_mfma_f32_16x16x32_bf16 v[68:71], v[112:115], a[52:55], v[68:71]
    ds_read_b128 v[132:135], v14 offset:64512
    v_mfma_f32_16x16x32_bf16 v[68:71], v[108:111], a[44:47], v[68:71]
    buffer_store_dwordx4 v[196:199], v136, s[44:47], s33 offen sc1
    v_mfma_f32_16x16x32_bf16 v[68:71], v[104:107], a[36:39], v[68:71]
    s_waitcnt lgkmcnt(2)
    v_mfma_f32_16x16x32_bf16 v[60:63], v[120:123], a[68:71], v[60:63]
    v_mfma_f32_16x16x32_bf16 v[60:63], v[124:127], a[76:79], v[60:63]
    s_waitcnt lgkmcnt(0)
    v_mfma_f32_16x16x32_bf16 v[60:63], v[128:131], a[84:87], v[60:63]
    s_waitcnt vmcnt(12)
    s_barrier
    v_mfma_f32_16x16x32_bf16 v[60:63], v[132:135], a[92:95], v[60:63]
    ds_read_b128 v[104:107], v14 offset:0
    v_mfma_f32_16x16x32_bf16 v[56:59], v[132:135], a[88:91], v[56:59]
    ds_read_b128 v[108:111], v14 offset:4096
    v_mfma_f32_16x16x32_bf16 v[56:59], v[128:131], a[80:83], v[56:59]
    ds_read_b128 v[112:115], v14 offset:8192
    v_cvt_pk_bf16_f32 v192, v40, v41
    v_mfma_f32_16x16x32_bf16 v[56:59], v[124:127], a[72:75], v[56:59]
    ds_read_b128 v[116:119], v14 offset:12288
    v_mfma_f32_16x16x32_bf16 v[56:59], v[120:123], a[64:67], v[56:59]
    s_waitcnt lgkmcnt(2)
    v_mfma_f32_16x16x32_bf16 v[64:67], v[104:107], a[64:67], v[64:67]
    s_add_u32 m0, s73, 146944
    v_cvt_pk_bf16_f32 v193, v42, v43
    s_waitcnt vmcnt(11)
    v_mfma_f32_16x16x32_bf16 v[64:67], v[108:111], a[72:75], v[64:67]
    buffer_load_dwordx4 v21, s[44:47], s26 offen offset:512 sc1 lds
    s_waitcnt lgkmcnt(0)
    v_mfma_f32_16x16x32_bf16 v[64:67], v[112:115], a[80:83], v[64:67]
    ds_read_b128 v[120:123], v14 offset:1024
    v_mul_f32 v96, v96, v97
    v_mfma_f32_16x16x32_bf16 v[64:67], v[116:119], a[88:91], v[64:67]
    ds_read_b128 v[124:127], v14 offset:5120
    v_cvt_pk_bf16_f32 v194, v44, v45
    v_mfma_f32_16x16x32_bf16 v[68:71], v[116:119], a[92:95], v[68:71]
    ds_read_b128 v[128:131], v14 offset:9216
    v_mul_f32 v98, v98, v99
    v_mfma_f32_16x16x32_bf16 v[68:71], v[112:115], a[84:87], v[68:71]
    ds_read_b128 v[132:135], v14 offset:13312
    v_mul_f32 v100, v100, v101
    v_mfma_f32_16x16x32_bf16 v[68:71], v[108:111], a[76:79], v[68:71]
    buffer_store_dwordx4 v[192:195], v136, s[44:47], s30 offen offset:0 sc1
    s_add_u32 m0, s73, 148480
    v_permlane16_swap_b32 v88, v90
    v_mfma_f32_16x16x32_bf16 v[68:71], v[104:107], a[68:71], v[68:71]
    buffer_load_dwordx4 v22, s[44:47], s18 offen offset:0 sc1 lds
    s_waitcnt lgkmcnt(2)
    v_mfma_f32_16x16x32_bf16 v[60:63], v[120:123], a[100:103], v[60:63]
    s_add_u32 m0, s73, 148992
    v_permlane16_swap_b32 v89, v91
    v_permlane16_swap_b32 v92, v94
    v_mfma_f32_16x16x32_bf16 v[60:63], v[124:127], a[108:111], v[60:63]
    buffer_load_dwordx4 v22, s[44:47], s18 offen offset:512 sc1 lds
    s_waitcnt vmcnt(13)
    s_waitcnt lgkmcnt(0)
    v_mfma_f32_16x16x32_bf16 v[60:63], v[128:131], a[116:119], v[60:63]
    ds_read_b128 v[104:107], v14 offset:2048
    v_permlane16_swap_b32 v93, v95
    v_mfma_f32_16x16x32_bf16 v[60:63], v[132:135], a[124:127], v[60:63]
    ds_read_b128 v[108:111], v14 offset:6144
    v_cmp_ne_u32 vcc, s68, v189
    v_mfma_f32_16x16x32_bf16 v[56:59], v[132:135], a[120:123], v[56:59]
    ds_read_b128 v[112:115], v14 offset:10240
    v_and_b32 v145, 0xffff0000, v88
    v_mfma_f32_16x16x32_bf16 v[56:59], v[128:131], a[112:115], v[56:59]
    ds_read_b128 v[116:119], v14 offset:14336
    v_cvt_pk_bf16_f32 v196, v46, v47
    v_mfma_f32_16x16x32_bf16 v[56:59], v[124:127], a[104:107], v[56:59]
    s_add_u32 m0, s73, 150528
    s_cbranch_vccnz L_rs_p3
L_ok_p3:
    v_lshlrev_b32 v144, 16, v88
    v_mfma_f32_16x16x32_bf16 v[56:59], v[120:123], a[96:99], v[56:59]
    buffer_load_dwordx4 v22, s[44:47], s19 offen offset:0 sc1 lds
    s_waitcnt lgkmcnt(2)
    v_mfma_f32_16x16x32_bf16 v[64:67], v[104:107], a[96:99], v[64:67]
    s_add_u32 m0, s73, 81920
    v_cvt_pk_bf16_f32 v197, v48, v49
    v_and_b32 v147, 0xffff0000, v89
    v_mfma_f32_16x16x32_bf16 v[64:67], v[108:111], a[104:107], v[64:67]
    buffer_load_dwordx4 v184, s[44:47], s37 offen offset:0 sc1 lds
    s_waitcnt lgkmcnt(0)
    v_mfma_f32_16x16x32_bf16 v[64:67], v[112:115], a[112:115], v[64:67]
    ds_read_b128 v[120:123], v14 offset:3072
    buffer_load_dwordx4 v185, s[44:47], s37 offen offset:1024 sc1 lds
    v_mfma_f32_16x16x32_bf16 v[64:67], v[116:119], a[120:123], v[64:67]
    ds_read_b128 v[124:127], v14 offset:7168
    s_add_u32 m0, s73, 83968
    v_cvt_pk_bf16_f32 v198, v50, v51
    v_mfma_f32_16x16x32_bf16 v[68:71], v[116:119], a[124:127], v[68:71]
    ds_read_b128 v[128:131], v14 offset:11264
    buffer_load_dwordx4 v184, s[44:47], s16 offen offset:0 sc1 lds
    v_mfma_f32_16x16x32_bf16 v[68:71], v[112:115], a[116:119], v[68:71]
    ds_read_b128 v[132:135], v14 offset:15360
    buffer_load_dwordx4 v185, s[44:47], s16 offen offset:1024 sc1 lds
    v_mfma_f32_16x16x32_bf16 v[68:71], v[108:111], a[108:111], v[68:71]
    buffer_store_dwordx4 v[196:199], v136, s[44:47], s30 offen offset:1024 sc1
    v_lshlrev_b32 v146, 16, v89
    v_and_b32 v149, 0xffff0000, v92
    v_lshlrev_b32 v148, 16, v92
    v_mfma_f32_16x16x32_bf16 v[68:71], v[104:107], a[100:103], v[68:71]
    s_waitcnt lgkmcnt(2)
    v_mfma_f32_16x16x32_bf16 v[60:63], v[120:123], a[132:135], v[60:63]
    v_and_b32 v151, 0xffff0000, v93
    v_mfma_f32_16x16x32_bf16 v[60:63], v[124:127], a[140:143], v[60:63]
    v_lshlrev_b32 v150, 16, v93
    s_waitcnt lgkmcnt(0)
    v_mfma_f32_16x16x32_bf16 v[60:63], v[128:131], a[148:151], v[60:63]
    s_waitcnt vmcnt(16)
    s_barrier
    v_mfma_f32_16x16x32_bf16 v[60:63], v[132:135], a[156:159], v[60:63]
    ds_read_b128 v[104:107], v14 offset:16384
    v_and_b32 v153, 0xffff0000, v90
    v_mfma_f32_16x16x32_bf16 v[56:59], v[132:135], a[152:155], v[56:59]
    ds_read_b128 v[108:111], v14 offset:20480
    v_lshlrev_b32 v152, 16, v90
    v_mfma_f32_16x16x32_bf16 v[56:59], v[128:131], a[144:147], v[56:59]
    ds_read_b128 v[112:115], v14 offset:24576
    v_cvt_pk_bf16_f32 v200, v52, v53
    v_mfma_f32_16x16x32_bf16 v[56:59], v[124:127], a[136:139], v[56:59]
    ds_read_b128 v[116:119], v14 offset:28672
    v_and_b32 v155, 0xffff0000, v91
    v_mfma_f32_16x16x32_bf16 v[56:59], v[120:123], a[128:131], v[56:59]
    s_waitcnt lgkmcnt(2)
    v_mfma_f32_16x16x32_bf16 v[64:67], v[104:107], a[128:131], v[64:67]
    s_add_u32 m0, s73, 97792
    v_lshlrev_b32 v154, 16, v91
    v_mfma_f32_16x16x32_bf16 v[64:67], v[108:111], a[136:139], v[64:67]
    buffer_load_dwordx4 v22, s[44:47], s19 offen offset:512 sc1 lds
    s_waitcnt lgkmcnt(0)
    v_mfma_f32_16x16x32_bf16 v[64:67], v[112:115], a[144:147], v[64:67]
    ds_read_b128 v[120:123], v14 offset:17408
    v_cvt_pk_bf16_f32 v201, v54, v55
    v_mfma_f32_16x16x32_bf16 v[64:67], v[116:119], a[152:155], v[64:67]
    ds_read_b128 v[124:127], v14 offset:21504
    v_and_b32 v157, 0xffff0000, v94
    v_mfma_f32_16x16x32_bf16 v[68:71], v[116:119], a[156:159], v[68:71]
    ds_read_b128 v[128:131], v14 offset:25600
    v_lshlrev_b32 v156, 16, v94
    v_mfma_f32_16x16x32_bf16 v[68:71], v[112:115], a[148:151], v[68:71]
    buffer_store_dwordx4 v[200:203], v136, s[44:47], s30 offen offset:2048 sc1
    ds_read_b128 v[132:135], v14 offset:29696
    v_and_b32 v159, 0xffff0000, v95
    v_mfma_f32_16x16x32_bf16 v[68:71], v[108:111], a[140:143], v[68:71]
    s_add_u32 m0, s73, 99328
    v_lshlrev_b32 v158, 16, v95
    v_mfma_f32_16x16x32_bf16 v[68:71], v[104:107], a[132:135], v[68:71]
    buffer_load_dwordx4 v22, s[44:47], s20 offen offset:0 sc1 lds
    s_waitcnt lgkmcnt(2)
    v_mfma_f32_16x16x32_bf16 v[60:63], v[120:123], a[164:167], v[60:63]
    s_add_u32 m0, s73, 99840
    v_and_b32 v161, 0xffff0000, v142
    v_mfma_f32_16x16x32_bf16 v[60:63], v[124:127], a[172:175], v[60:63]
    buffer_load_dwordx4 v22, s[44:47], s20 offen offset:512 sc1 lds
    s_waitcnt lgkmcnt(0)
    v_mfma_f32_16x16x32_bf16 v[60:63], v[128:131], a[180:183], v[60:63]
    ds_read_b128 v[104:107], v14 offset:18432
    v_lshlrev_b32 v160, 16, v142
    v_mfma_f32_16x16x32_bf16 v[60:63], v[132:135], a[188:191], v[60:63]
    ds_read_b128 v[108:111], v14 offset:22528
    v_mfma_f32_16x16x32_bf16 v[56:59], v[132:135], a[184:187], v[56:59]
    ds_read_b128 v[112:115], v14 offset:26624
    v_and_b32 v163, 0xffff0000, v143
    v_mfma_f32_16x16x32_bf16 v[56:59], v[128:131], a[176:179], v[56:59]
    ds_read_b128 v[116:119], v14 offset:30720
    v_lshlrev_b32 v162, 16, v143
    v_mfma_f32_16x16x32_bf16 v[56:59], v[124:127], a[168:171], v[56:59]
    s_add_u32 m0, s73, 101376
    v_mfma_f32_16x16x32_bf16 v[56:59], v[120:123], a[160:163], v[56:59]
    buffer_load_dwordx4 v22, s[44:47], s21 offen offset:0 sc1 lds
    s_waitcnt lgkmcnt(2)
    v_mfma_f32_16x16x32_bf16 v[64:67], v[104:107], a[160:163], v[64:67]
    v_fma_f32 v164, v144, v97, -v96
    v_mfma_f32_16x16x32_bf16 v[64:67], v[108:111], a[168:171], v[64:67]
    v_fma_f32 v165, v145, v97, -v96
    s_waitcnt lgkmcnt(0)
    v_mfma_f32_16x16x32_bf16 v[64:67], v[112:115], a[176:179], v[64:67]
    ds_read_b128 v[120:123], v14 offset:19456
    v_fma_f32 v166, v146, v97, -v96
    v_mfma_f32_16x16x32_bf16 v[64:67], v[116:119], a[184:187], v[64:67]
    ds_read_b128 v[124:127], v14 offset:23552
    v_mfma_f32_16x16x32_bf16 v[68:71], v[116:119], a[188:191], v[68:71]
    ds_read_b128 v[128:131], v14 offset:27648
    v_fma_f32 v167, v147, v97, -v96
    v_mfma_f32_16x16x32_bf16 v[68:71], v[112:115], a[180:183], v[68:71]
    ds_read_b128 v[132:135], v14 offset:31744
    v_mfma_f32_16x16x32_bf16 v[68:71], v[108:111], a[172:175], v[68:71]
    v_fma_f32 v168, v148, v99, -v98
    v_mfma_f32_16x16x32_bf16 v[68:71], v[104:107], a[164:167], v[68:71]
    v_fma_f32 v169, v149, v99, -v98
    s_waitcnt lgkmcnt(2)
    v_mfma_f32_16x16x32_bf16 v[60:63], v[120:123], a[196:199], v[60:63]
    v_mfma_f32_16x16x32_bf16 v[60:63], v[124:127], a[204:207], v[60:63]
    v_fma_f32 v170, v150, v99, -v98
    s_waitcnt lgkmcnt(0)
    v_mfma_f32_16x16x32_bf16 v[60:63], v[128:131], a[212:215], v[60:63]
    s_waitcnt vmcnt(16)
    s_barrier
    v_mfma_f32_16x16x32_bf16 v[60:63], v[132:135], a[220:223], v[60:63]
    ds_read_b128 v[104:107], v14 offset:32768
    v_fma_f32 v171, v151, v99, -v98
    v_mfma_f32_16x16x32_bf16 v[56:59], v[132:135], a[216:219], v[56:59]
    ds_read_b128 v[108:111], v14 offset:36864
    v_fma_f32 v172, v152, v97, -v96
    v_mfma_f32_16x16x32_bf16 v[56:59], v[128:131], a[208:211], v[56:59]
    ds_read_b128 v[112:115], v14 offset:40960
    v_mfma_f32_16x16x32_bf16 v[56:59], v[124:127], a[200:203], v[56:59]
    ds_read_b128 v[116:119], v14 offset:45056
    v_fma_f32 v173, v153, v97, -v96
    v_mfma_f32_16x16x32_bf16 v[56:59], v[120:123], a[192:195], v[56:59]
    s_waitcnt lgkmcnt(2)
    v_mfma_f32_16x16x32_bf16 v[64:67], v[104:107], a[192:195], v[64:67]
    s_add_u32 m0, s73, 114176
    v_fma_f32 v174, v154, v97, -v96
    v_mfma_f32_16x16x32_bf16 v[64:67], v[108:111], a[200:203], v[64:67]
    buffer_load_dwordx4 v22, s[44:47], s21 offen offset:512 sc1 lds
    s_waitcnt lgkmcnt(0)
    v_mfma_f32_16x16x32_bf16 v[64:67], v[112:115], a[208:211], v[64:67]
    ds_read_b128 v[120:123], v14 offset:33792
    v_fma_f32 v175, v155, v97, -v96
    v_mfma_f32_16x16x32_bf16 v[64:67], v[116:119], a[216:219], v[64:67]
    ds_read_b128 v[124:127], v14 offset:37888
    v_fma_f32 v176, v156, v99, -v98
    v_mfma_f32_16x16x32_bf16 v[68:71], v[116:119], a[220:223], v[68:71]
    ds_read_b128 v[128:131], v14 offset:41984
    v_mfma_f32_16x16x32_bf16 v[68:71], v[112:115], a[212:215], v[68:71]
    ds_read_b128 v[132:135], v14 offset:46080
    v_fma_f32 v177, v157, v99, -v98
    v_mfma_f32_16x16x32_bf16 v[68:71], v[108:111], a[204:207], v[68:71]
    s_add_u32 m0, s73, 115712
    v_fma_f32 v178, v158, v99, -v98
    v_mfma_f32_16x16x32_bf16 v[68:71], v[104:107], a[196:199], v[68:71]
    buffer_load_dwordx4 v22, s[44:47], s22 offen offset:0 sc1 lds
    s_waitcnt lgkmcnt(2)
    v_mfma_f32_16x16x32_bf16 v[60:63], v[120:123], a[228:231], v[60:63]
    s_add_u32 m0, s73, 116224
    v_fma_f32 v179, v159, v99, -v98
    v_mfma_f32_16x16x32_bf16 v[60:63], v[124:127], a[236:239], v[60:63]
    buffer_load_dwordx4 v22, s[44:47], s22 offen offset:512 sc1 lds
    s_waitcnt lgkmcnt(0)
    v_mfma_f32_16x16x32_bf16 v[60:63], v[128:131], a[244:247], v[60:63]
    ds_read_b128 v[104:107], v14 offset:34816
    v_fma_f32 v180, v160, v101, -v100
    v_mfma_f32_16x16x32_bf16 v[60:63], v[132:135], a[252:255], v[60:63]
    ds_read_b128 v[108:111], v14 offset:38912
    v_fma_f32 v181, v161, v101, -v100
    v_mfma_f32_16x16x32_bf16 v[56:59], v[132:135], a[248:251], v[56:59]
    ds_read_b128 v[112:115], v14 offset:43008
    v_mfma_f32_16x16x32_bf16 v[56:59], v[128:131], a[240:243], v[56:59]
    ds_read_b128 v[116:119], v14 offset:47104
    v_fma_f32 v182, v162, v101, -v100
    v_mfma_f32_16x16x32_bf16 v[56:59], v[124:127], a[232:235], v[56:59]
    s_add_u32 m0, s73, 117760
    v_fma_f32 v183, v163, v101, -v100
    v_mfma_f32_16x16x32_bf16 v[56:59], v[120:123], a[224:227], v[56:59]
    buffer_load_dwordx4 v22, s[44:47], s23 offen offset:0 sc1 lds
    s_waitcnt lgkmcnt(2)
    v_mfma_f32_16x16x32_bf16 v[64:67], v[104:107], a[224:227], v[64:67]
    v_mfma_f32_16x16x32_bf16 v[64:67], v[108:111], a[232:235], v[64:67]
    s_waitcnt lgkmcnt(0)
    v_mfma_f32_16x16x32_bf16 v[64:67], v[112:115], a[240:243], v[64:67]
    ds_read_b128 v[120:123], v14 offset:35840
    v_mfma_f32_16x16x32_bf16 v[64:67], v[116:119], a[248:251], v[64:67]
    ds_read_b128 v[124:127], v14 offset:39936
    v_mfma_f32_16x16x32_bf16 v[68:71], v[116:119], a[252:255], v[68:71]
    ds_read_b128 v[128:131], v14 offset:44032
    v_mfma_f32_16x16x32_bf16 v[68:71], v[112:115], a[244:247], v[68:71]
L_pl_D_1:
    s_cbranch_execz L_wret
    ds_read_b128 v[132:135], v14 offset:48128
    v_mfma_f32_16x16x32_bf16 v[68:71], v[108:111], a[236:239], v[68:71]
    v_mfma_f32_16x16x32_bf16 v[68:71], v[104:107], a[228:231], v[68:71]
    s_waitcnt lgkmcnt(2)
    v_mfma_f32_16x16x32_bf16 v[60:63], v[120:123], v[224:227], v[60:63]
    v_mfma_f32_16x16x32_bf16 v[60:63], v[124:127], v[232:235], v[60:63]
    s_waitcnt lgkmcnt(0)
    v_mfma_f32_16x16x32_bf16 v[60:63], v[128:131], v[240:243], v[60:63]
    s_waitcnt vmcnt(10)
    s_barrier
    v_mfma_f32_16x16x32_bf16 v[60:63], v[132:135], v[248:251], v[60:63]
    ds_read_b128 v[104:107], v14 offset:49152
    v_mfma_f32_16x16x32_bf16 v[56:59], v[132:135], v[244:247], v[56:59]
    ds_read_b128 v[108:111], v14 offset:53248
    v_mfma_f32_16x16x32_bf16 v[56:59], v[128:131], v[236:239], v[56:59]
    ds_read_b128 v[112:115], v14 offset:57344
    v_mfma_f32_16x16x32_bf16 v[56:59], v[124:127], v[228:231], v[56:59]
    ds_read_b128 v[116:119], v14 offset:61440
    v_mfma_f32_16x16x32_bf16 v[56:59], v[120:123], v[220:223], v[56:59]
    s_waitcnt lgkmcnt(2)
    v_mfma_f32_16x16x32_bf16 v[64:67], v[104:107], v[220:223], v[64:67]
    s_add_u32 m0, s73, 130560
    v_xor_b32 v186, s41, v10
    v_add_u32 v186, s43, v186
    v_mfma_f32_16x16x32_bf16 v[64:67], v[108:111], v[228:231], v[64:67]
    buffer_load_dwordx4 v22, s[44:47], s23 offen offset:512 sc1 lds
    ds_read_b64_tr_b16 v[12:13], v10 offset:16384
    s_waitcnt lgkmcnt(1)
    v_mfma_f32_16x16x32_bf16 v[64:67], v[112:115], v[236:239], v[64:67]
    ds_read_b128 v[120:123], v14 offset:50176
    v_mfma_f32_16x16x32_bf16 v[64:67], v[116:119], v[244:247], v[64:67]
    ds_read_b128 v[124:127], v14 offset:54272
    v_mfma_f32_16x16x32_bf16 v[68:71], v[116:119], v[248:251], v[68:71]
    ds_read_b128 v[128:131], v14 offset:58368
    ds_read_b64_tr_b16 v[24:25], v11 offset:16384
    v_mfma_f32_16x16x32_bf16 v[68:71], v[112:115], v[240:243], v[68:71]
    ds_read_b128 v[132:135], v14 offset:62464
    ds_read_b64_tr_b16 v[28:29], v10 offset:20480
    v_mfma_f32_16x16x32_bf16 v[68:71], v[108:111], v[232:235], v[68:71]
    s_add_u32 m0, s73, 132096
    ds_read_b64_tr_b16 v[190:191], v11 offset:20480
    v_mfma_f32_16x16x32_bf16 v[68:71], v[104:107], v[224:227], v[68:71]
    buffer_load_dwordx4 v22, s[44:47], s24 offen offset:0 sc1 lds
    ds_read_b64_tr_b16 v[142:143], v186 offset:18432
    s_waitcnt lgkmcnt(6)
    v_mfma_f32_16x16x32_bf16 v[76:79], v[120:123], a[4:7], v[76:79]
    s_add_u32 m0, s73, 132608
    s_waitcnt lgkmcnt(0)
    v_mfma_f32_16x16x32_bf16 v[76:79], v[124:127], a[12:15], v[76:79]
    buffer_load_dwordx4 v22, s[44:47], s24 offen offset:512 sc1 lds
    v_mfma_f32_16x16x32_bf16 v[76:79], v[128:131], a[20:23], v[76:79]
    ds_read_b128 v[104:107], v14 offset:51200
    v_and_b32 v9, 0xffff0000, v12
    v_mfma_f32_16x16x32_bf16 v[76:79], v[132:135], a[28:31], v[76:79]
    ds_read_b128 v[108:111], v14 offset:55296
    v_mfma_f32_16x16x32_bf16 v[72:75], v[132:135], a[24:27], v[72:75]
    ds_read_b128 v[112:115], v14 offset:59392
    v_lshlrev_b32 v8, 16, v12
    v_mfma_f32_16x16x32_bf16 v[72:75], v[128:131], a[16:19], v[72:75]
    ds_read_b128 v[116:119], v14 offset:63488
    v_cvt_pk_bf16_f32 v192, v56, v57
    v_mfma_f32_16x16x32_bf16 v[72:75], v[124:127], a[8:11], v[72:75]
    s_add_u32 m0, s73, 134144
    v_mul_f32 v165, v165, v9
    v_mfma_f32_16x16x32_bf16 v[72:75], v[120:123], a[0:3], v[72:75]
    buffer_load_dwordx4 v22, s[44:47], s25 offen offset:0 sc1 lds
    s_waitcnt lgkmcnt(2)
    v_mfma_f32_16x16x32_bf16 v[80:83], v[104:107], a[0:3], v[80:83]
    v_cvt_pk_bf16_f32 v193, v58, v59
    v_mul_f32 v164, v164, v8
    v_mfma_f32_16x16x32_bf16 v[80:83], v[108:111], a[8:11], v[80:83]
    v_and_b32 v31, 0xffff0000, v13
    s_waitcnt lgkmcnt(0)
    v_mfma_f32_16x16x32_bf16 v[80:83], v[112:115], a[16:19], v[80:83]
    ds_read_b128 v[120:123], v14 offset:52224
    v_lshlrev_b32 v30, 16, v13
    v_mfma_f32_16x16x32_bf16 v[80:83], v[116:119], a[24:27], v[80:83]
    ds_read_b128 v[124:127], v14 offset:56320
    v_cvt_pk_bf16_f32 v194, v60, v61
    v_mfma_f32_16x16x32_bf16 v[84:87], v[116:119], a[28:31], v[84:87]
    ds_read_b128 v[128:131], v14 offset:60416
    v_mfma_f32_16x16x32_bf16 v[84:87], v[112:115], a[20:23], v[84:87]
    ds_read_b128 v[132:135], v14 offset:64512
    v_mul_f32 v167, v167, v31
    v_mfma_f32_16x16x32_bf16 v[84:87], v[108:111], a[12:15], v[84:87]
    buffer_store_dwordx4 v[192:195], v136, s[44:47], s15 offen offset:0 sc1
    v_mul_f32 v166, v166, v30
    v_mfma_f32_16x16x32_bf16 v[84:87], v[104:107], a[4:7], v[84:87]
    s_waitcnt lgkmcnt(2)
    v_mfma_f32_16x16x32_bf16 v[76:79], v[120:123], a[36:39], v[76:79]
    v_and_b32 v9, 0xffff0000, v24
    v_mfma_f32_16x16x32_bf16 v[76:79], v[124:127], a[44:47], v[76:79]
    v_cvt_pk_bf16_f32 v196, v62, v63
    s_waitcnt lgkmcnt(0)
    v_mfma_f32_16x16x32_bf16 v[76:79], v[128:131], a[52:55], v[76:79]
    s_waitcnt vmcnt(9)
    s_barrier
    v_lshlrev_b32 v8, 16, v24
    v_mfma_f32_16x16x32_bf16 v[76:79], v[132:135], a[60:63], v[76:79]
    ds_read_b128 v[104:107], v14 offset:0
    v_mul_f32 v169, v169, v9
    v_mfma_f32_16x16x32_bf16 v[72:75], v[132:135], a[56:59], v[72:75]
    ds_read_b128 v[108:111], v14 offset:4096
    v_cvt_pk_bf16_f32 v197, v64, v65
    v_mfma_f32_16x16x32_bf16 v[72:75], v[128:131], a[48:51], v[72:75]
    ds_read_b128 v[112:115], v14 offset:8192
    v_mul_f32 v168, v168, v8
    v_mfma_f32_16x16x32_bf16 v[72:75], v[124:127], a[40:43], v[72:75]
    ds_read_b128 v[116:119], v14 offset:12288
    v_mfma_f32_16x16x32_bf16 v[72:75], v[120:123], a[32:35], v[72:75]
    v_cvt_pk_bf16_f32 v198, v66, v67
    s_waitcnt lgkmcnt(2)
    v_mfma_f32_16x16x32_bf16 v[80:83], v[104:107], a[32:35], v[80:83]
    s_add_u32 m0, s73, 146944
    v_and_b32 v31, 0xffff0000, v25
    v_lshlrev_b32 v30, 16, v25
    v_mfma_f32_16x16x32_bf16 v[80:83], v[108:111], a[40:43], v[80:83]
    buffer_load_dwordx4 v22, s[44:47], s25 offen offset:512 sc1 lds
    s_waitcnt lgkmcnt(0)
    v_mfma_f32_16x16x32_bf16 v[80:83], v[112:115], a[48:51], v[80:83]
    buffer_store_dwordx4 v[196:199], v136, s[44:47], s15 offen offset:1024 sc1
    ds_read_b128 v[120:123], v14 offset:1024
    v_mfma_f32_16x16x32_bf16 v[80:83], v[116:119], a[56:59], v[80:83]
    ds_read_b128 v[124:127], v14 offset:5120
    v_mul_f32 v171, v171, v31
    v_mfma_f32_16x16x32_bf16 v[84:87], v[116:119], a[60:63], v[84:87]
    ds_read_b128 v[128:131], v14 offset:9216
    v_mul_f32 v170, v170, v30
    v_mfma_f32_16x16x32_bf16 v[84:87], v[112:115], a[52:55], v[84:87]
    ds_read_b128 v[132:135], v14 offset:13312
    v_mfma_f32_16x16x32_bf16 v[84:87], v[108:111], a[44:47], v[84:87]
    s_add_u32 m0, s73, 148480
    v_cvt_pk_bf16_f32 v200, v68, v69
    v_and_b32 v9, 0xffff0000, v28
    v_mfma_f32_16x16x32_bf16 v[84:87], v[104:107], a[36:39], v[84:87]
    buffer_load_dwordx4 v22, s[44:47], s26 offen offset:0 sc1 lds
    s_waitcnt lgkmcnt(2)
    v_mfma_f32_16x16x32_bf16 v[76:79], v[120:123], a[68:71], v[76:79]
    s_add_u32 m0, s73, 148992
    v_lshlrev_b32 v8, 16, v28
    v_mfma_f32_16x16x32_bf16 v[76:79], v[124:127], a[76:79], v[76:79]
    buffer_load_dwordx4 v22, s[44:47], s26 offen offset:512 sc1 lds
    s_waitcnt lgkmcnt(0)
    v_mfma_f32_16x16x32_bf16 v[76:79], v[128:131], a[84:87], v[76:79]
    ds_read_b128 v[104:107], v14 offset:2048
    v_cvt_pk_bf16_f32 v201, v70, v71
    v_mfma_f32_16x16x32_bf16 v[76:79], v[132:135], a[92:95], v[76:79]
    ds_read_b128 v[108:111], v14 offset:6144
    v_mul_f32 v173, v173, v9
    v_mfma_f32_16x16x32_bf16 v[72:75], v[132:135], a[88:91], v[72:75]
    ds_read_b128 v[112:115], v14 offset:10240
    v_mul_f32 v172, v172, v8
    v_mfma_f32_16x16x32_bf16 v[72:75], v[128:131], a[80:83], v[72:75]
    ds_read_b128 v[116:119], v14 offset:14336
    v_and_b32 v31, 0xffff0000, v29
    v_mfma_f32_16x16x32_bf16 v[72:75], v[124:127], a[72:75], v[72:75]
    buffer_store_dwordx4 v[200:203], v136, s[44:47], s15 offen offset:2048 sc1
    s_add_u32 m0, s73, 150528
    v_mfma_f32_16x16x32_bf16 v[72:75], v[120:123], a[64:67], v[72:75]
    buffer_load_dwordx4 v19, s[44:47], s18 offen offset:0 sc1 lds
    s_waitcnt lgkmcnt(2)
    v_mfma_f32_16x16x32_bf16 v[80:83], v[104:107], a[64:67], v[80:83]
    v_lshlrev_b32 v30, 16, v29
    v_mul_f32 v175, v175, v31
    v_mfma_f32_16x16x32_bf16 v[80:83], v[108:111], a[72:75], v[80:83]
    buffer_load_dwordx4 v[40:43], v136, s[44:47], s34 offen offset:0 sc1
    s_waitcnt lgkmcnt(0)
    v_mfma_f32_16x16x32_bf16 v[80:83], v[112:115], a[80:83], v[80:83]
    ds_read_b128 v[120:123], v14 offset:3072
    v_mfma_f32_16x16x32_bf16 v[80:83], v[116:119], a[88:91], v[80:83]
    ds_read_b128 v[124:127], v14 offset:7168
    v_mul_f32 v174, v174, v30
    v_mfma_f32_16x16x32_bf16 v[84:87], v[116:119], a[92:95], v[84:87]
    ds_read_b128 v[128:131], v14 offset:11264
    v_and_b32 v9, 0xffff0000, v190
    v_mfma_f32_16x16x32_bf16 v[84:87], v[112:115], a[84:87], v[84:87]
    ds_read_b128 v[132:135], v14 offset:15360
    buffer_load_dwordx4 v[44:47], v136, s[44:47], s34 offen offset:1024 sc1
    v_mfma_f32_16x16x32_bf16 v[84:87], v[108:111], a[76:79], v[84:87]
    v_lshlrev_b32 v8, 16, v190
    v_mfma_f32_16x16x32_bf16 v[84:87], v[104:107], a[68:71], v[84:87]
    s_waitcnt lgkmcnt(2)
    v_mfma_f32_16x16x32_bf16 v[76:79], v[120:123], a[100:103], v[76:79]
    buffer_load_dwordx4 v[48:51], v136, s[44:47], s34 offen offset:2048 sc1
    v_mul_f32 v177, v177, v9
    v_mfma_f32_16x16x32_bf16 v[76:79], v[124:127], a[108:111], v[76:79]
    s_waitcnt lgkmcnt(0)
    v_mfma_f32_16x16x32_bf16 v[76:79], v[128:131], a[116:119], v[76:79]
    s_waitcnt vmcnt(14)
    s_barrier
    v_mul_f32 v176, v176, v8
    v_mfma_f32_16x16x32_bf16 v[76:79], v[132:135], a[124:127], v[76:79]
    ds_read_b128 v[104:107], v14 offset:16384
    v_and_b32 v31, 0xffff0000, v191
    v_mfma_f32_16x16x32_bf16 v[72:75], v[132:135], a[120:123], v[72:75]
    ds_read_b128 v[108:111], v14 offset:20480
    buffer_load_dwordx4 v[204:207], v136, s[44:47], s35 offen offset:0 sc1
    v_mfma_f32_16x16x32_bf16 v[72:75], v[128:131], a[112:115], v[72:75]
    ds_read_b128 v[112:115], v14 offset:24576
    v_lshlrev_b32 v30, 16, v191
    v_mfma_f32_16x16x32_bf16 v[72:75], v[124:127], a[104:107], v[72:75]
    ds_read_b128 v[116:119], v14 offset:28672
    v_mul_f32 v179, v179, v31
    v_mfma_f32_16x16x32_bf16 v[72:75], v[120:123], a[96:99], v[72:75]
    buffer_load_dwordx4 v[208:211], v136, s[44:47], s35 offen offset:1024 sc1
    s_waitcnt lgkmcnt(2)
    v_mfma_f32_16x16x32_bf16 v[80:83], v[104:107], a[96:99], v[80:83]
    v_mfma_f32_16x16x32_bf16 v[80:83], v[108:111], a[104:107], v[80:83]
    v_mul_f32 v178, v178, v30
    s_waitcnt lgkmcnt(0)
    v_mfma_f32_16x16x32_bf16 v[80:83], v[112:115], a[112:115], v[80:83]
    ds_read_b128 v[120:123], v14 offset:17408
    buffer_load_dwordx4 v[212:215], v136, s[44:47], s35 offen offset:2048 sc1
    v_mfma_f32_16x16x32_bf16 v[80:83], v[116:119], a[120:123], v[80:83]
    ds_read_b128 v[124:127], v14 offset:21504
    v_and_b32 v9, 0xffff0000, v142
    v_mfma_f32_16x16x32_bf16 v[84:87], v[116:119], a[124:127], v[84:87]
    ds_read_b128 v[128:131], v14 offset:25600
    v_lshlrev_b32 v8, 16, v142
    v_mfma_f32_16x16x32_bf16 v[84:87], v[112:115], a[116:119], v[84:87]
    ds_read_b128 v[132:135], v14 offset:29696
    v_mfma_f32_16x16x32_bf16 v[84:87], v[108:111], a[108:111], v[84:87]
    buffer_load_dwordx4 v[216:219], v136, s[44:47], s35 offen offset:3072 sc1
    v_mul_f32 v181, v181, v9
    v_mfma_f32_16x16x32_bf16 v[84:87], v[104:107], a[100:103], v[84:87]
    s_waitcnt lgkmcnt(2)
    v_mfma_f32_16x16x32_bf16 v[76:79], v[120:123], a[132:135], v[76:79]
    v_mul_f32 v180, v180, v8
    v_mfma_f32_16x16x32_bf16 v[76:79], v[124:127], a[140:143], v[76:79]
    v_and_b32 v31, 0xffff0000, v143
    s_waitcnt lgkmcnt(0)
    v_mfma_f32_16x16x32_bf16 v[76:79], v[128:131], a[148:151], v[76:79]
    ds_read_b128 v[104:107], v14 offset:18432
    v_mfma_f32_16x16x32_bf16 v[76:79], v[132:135], a[156:159], v[76:79]
    ds_read_b128 v[108:111], v14 offset:22528
    v_lshlrev_b32 v30, 16, v143
    v_mfma_f32_16x16x32_bf16 v[72:75], v[132:135], a[152:155], v[72:75]
    ds_read_b128 v[112:115], v14 offset:26624
    v_mfma_f32_16x16x32_bf16 v[72:75], v[128:131], a[144:147], v[72:75]
    ds_read_b128 v[116:119], v14 offset:30720
    v_mul_f32 v183, v183, v31
    v_mfma_f32_16x16x32_bf16 v[72:75], v[124:127], a[136:139], v[72:75]
    v_mfma_f32_16x16x32_bf16 v[72:75], v[120:123], a[128:131], v[72:75]
    v_mul_f32 v182, v182, v30
    s_waitcnt lgkmcnt(2)
    v_mfma_f32_16x16x32_bf16 v[80:83], v[104:107], a[128:131], v[80:83]
    v_mfma_f32_16x16x32_bf16 v[80:83], v[108:111], a[136:139], v[80:83]
    s_waitcnt lgkmcnt(0)
    v_mfma_f32_16x16x32_bf16 v[80:83], v[112:115], a[144:147], v[80:83]
    ds_read_b128 v[120:123], v14 offset:19456
    v_mfma_f32_16x16x32_bf16 v[80:83], v[116:119], a[152:155], v[80:83]
    ds_read_b128 v[124:127], v14 offset:23552
    v_mfma_f32_16x16x32_bf16 v[84:87], v[116:119], a[156:159], v[84:87]
    ds_read_b128 v[128:131], v14 offset:27648
    v_mfma_f32_16x16x32_bf16 v[84:87], v[112:115], a[148:151], v[84:87]
    ds_read_b128 v[132:135], v14 offset:31744
    v_mfma_f32_16x16x32_bf16 v[84:87], v[108:111], a[140:143], v[84:87]
    v_mfma_f32_16x16x32_bf16 v[84:87], v[104:107], a[132:135], v[84:87]
    s_waitcnt lgkmcnt(2)
    v_mfma_f32_16x16x32_bf16 v[76:79], v[120:123], a[164:167], v[76:79]
    s_add_u32 m0, s73, 97792
    v_mfma_f32_16x16x32_bf16 v[76:79], v[124:127], a[172:175], v[76:79]
    buffer_load_dwordx4 v19, s[44:47], s18 offen offset:512 sc1 lds
    s_waitcnt lgkmcnt(0)
    v_mfma_f32_16x16x32_bf16 v[76:79], v[128:131], a[180:183], v[76:79]
    s_waitcnt vmcnt(15)
    s_barrier
    v_mfma_f32_16x16x32_bf16 v[76:79], v[132:135], a[188:191], v[76:79]
    ds_read_b128 v[104:107], v14 offset:32768
    v_mfma_f32_16x16x32_bf16 v[72:75], v[132:135], a[184:187], v[72:75]
    ds_read_b128 v[108:111], v14 offset:36864
    v_mfma_f32_16x16x32_bf16 v[72:75], v[128:131], a[176:179], v[72:75]
    ds_read_b128 v[112:115], v14 offset:40960
    v_mfma_f32_16x16x32_bf16 v[72:75], v[124:127], a[168:171], v[72:75]
    ds_read_b128 v[116:119], v14 offset:45056
    s_add_u32 m0, s73, 99328
    v_mfma_f32_16x16x32_bf16 v[72:75], v[120:123], a[160:163], v[72:75]
    buffer_load_dwordx4 v19, s[44:47], s19 offen offset:0 sc1 lds
    s_waitcnt lgkmcnt(2)
    v_mfma_f32_16x16x32_bf16 v[80:83], v[104:107], a[160:163], v[80:83]
    s_add_u32 m0, s73, 99840
    v_mfma_f32_16x16x32_bf16 v[80:83], v[108:111], a[168:171], v[80:83]
    buffer_load_dwordx4 v19, s[44:47], s19 offen offset:512 sc1 lds
    s_waitcnt lgkmcnt(0)
    v_mfma_f32_16x16x32_bf16 v[80:83], v[112:115], a[176:179], v[80:83]
    ds_read_b128 v[120:123], v14 offset:33792
    v_mfma_f32_16x16x32_bf16 v[80:83], v[116:119], a[184:187], v[80:83]
    ds_read_b128 v[124:127], v14 offset:37888
    v_mfma_f32_16x16x32_bf16 v[84:87], v[116:119], a[188:191], v[84:87]
    ds_read_b128 v[128:131], v14 offset:41984
    v_mfma_f32_16x16x32_bf16 v[84:87], v[112:115], a[180:183], v[84:87]
    ds_read_b128 v[132:135], v14 offset:46080
    v_mfma_f32_16x16x32_bf16 v[84:87], v[108:111], a[172:175], v[84:87]
    s_add_u32 m0, s73, 101376
    v_mfma_f32_16x16x32_bf16 v[84:87], v[104:107], a[164:167], v[84:87]
    buffer_load_dwordx4 v19, s[44:47], s20 offen offset:0 sc1 lds
    s_waitcnt lgkmcnt(2)
    v_mfma_f32_16x16x32_bf16 v[76:79], v[120:123], a[196:199], v[76:79]
    s_add_u32 m0, s73, 114176
    v_mov_b32 v141, 0
    v_mfma_f32_16x16x32_bf16 v[76:79], v[124:127], a[204:207], v[76:79]
    buffer_load_dwordx4 v19, s[44:47], s20 offen offset:512 sc1 lds
    s_waitcnt lgkmcnt(0)
    v_mfma_f32_16x16x32_bf16 v[76:79], v[128:131], a[212:215], v[76:79]
    ds_read_b128 v[104:107], v14 offset:34816
    v_mfma_f32_16x16x32_bf16 v[76:79], v[132:135], a[220:223], v[76:79]
    ds_read_b128 v[108:111], v14 offset:38912
    buffer_atomic_add v141, v139, s[44:47], s11 offen offset:2060 sc0 sc1
    v_mfma_f32_16x16x32_bf16 v[72:75], v[132:135], a[216:219], v[72:75]
    ds_read_b128 v[112:115], v14 offset:43008
    v_mfma_f32_16x16x32_bf16 v[72:75], v[128:131], a[208:211], v[72:75]
    ds_read_b128 v[116:119], v14 offset:47104
    v_mfma_f32_16x16x32_bf16 v[72:75], v[124:127], a[200:203], v[72:75]
    s_add_u32 m0, s73, 115712
    v_mfma_f32_16x16x32_bf16 v[72:75], v[120:123], a[192:195], v[72:75]
    buffer_load_dwordx4 v19, s[44:47], s21 offen offset:0 sc1 lds
    s_waitcnt lgkmcnt(2)
    v_mfma_f32_16x16x32_bf16 v[80:83], v[104:107], a[192:195], v[80:83]
    s_add_u32 m0, s73, 116224
    v_mfma_f32_16x16x32_bf16 v[80:83], v[108:111], a[200:203], v[80:83]
    buffer_load_dwordx4 v19, s[44:47], s21 offen offset:512 sc1 lds
    s_waitcnt lgkmcnt(0)
    v_mfma_f32_16x16x32_bf16 v[80:83], v[112:115], a[208:211], v[80:83]
    ds_read_b128 v[120:123], v14 offset:35840
    v_mfma_f32_16x16x32_bf16 v[80:83], v[116:119], a[216:219], v[80:83]
    ds_read_b128 v[124:127], v14 offset:39936
    v_mfma_f32_16x16x32_bf16 v[84:87], v[116:119], a[220:223], v[84:87]
    ds_read_b128 v[128:131], v14 offset:44032
    v_mfma_f32_16x16x32_bf16 v[84:87], v[112:115], a[212:215], v[84:87]
    ds_read_b128 v[132:135], v14 offset:48128
    v_mfma_f32_16x16x32_bf16 v[84:87], v[108:111], a[204:207], v[84:87]
    s_add_u32 m0, s73, 117760
    v_mfma_f32_16x16x32_bf16 v[84:87], v[104:107], a[196:199], v[84:87]
    buffer_load_dwordx4 v19, s[44:47], s22 offen offset:0 sc1 lds
    s_waitcnt lgkmcnt(2)
    v_mfma_f32_16x16x32_bf16 v[76:79], v[120:123], a[228:231], v[76:79]
    v_mfma_f32_16x16x32_bf16 v[76:79], v[124:127], a[236:239], v[76:79]
    s_waitcnt lgkmcnt(0)
    v_mfma_f32_16x16x32_bf16 v[76:79], v[128:131], a[244:247], v[76:79]
    s_waitcnt vmcnt(16)
    s_barrier
    v_mfma_f32_16x16x32_bf16 v[76:79], v[132:135], a[252:255], v[76:79]
    ds_read_b128 v[104:107], v14 offset:49152
    v_mfma_f32_16x16x32_bf16 v[72:75], v[132:135], a[248:251], v[72:75]
    ds_read_b128 v[108:111], v14 offset:53248
    v_mfma_f32_16x16x32_bf16 v[72:75], v[128:131], a[240:243], v[72:75]
    ds_read_b128 v[112:115], v14 offset:57344
    v_mfma_f32_16x16x32_bf16 v[72:75], v[124:127], a[232:235], v[72:75]
    ds_read_b128 v[116:119], v14 offset:61440
    v_mfma_f32_16x16x32_bf16 v[72:75], v[120:123], a[224:227], v[72:75]
    s_waitcnt lgkmcnt(2)
    v_mfma_f32_16x16x32_bf16 v[80:83], v[104:107], a[224:227], v[80:83]
    s_add_u32 m0, s73, 130560
    v_mfma_f32_16x16x32_bf16 v[80:83], v[108:111], a[232:235], v[80:83]
    buffer_load_dwordx4 v19, s[44:47], s22 offen offset:512 sc1 lds
    s_waitcnt lgkmcnt(0)
    v_mfma_f32_16x16x32_bf16 v[80:83], v[112:115], a[240:243], v[80:83]
    ds_read_b128 v[120:123], v14 offset:50176
    v_mfma_f32_16x16x32_bf16 v[80:83], v[116:119], a[248:251], v[80:83]
    ds_read_b128 v[124:127], v14 offset:54272
    v_mfma_f32_16x16x32_bf16 v[84:87], v[116:119], a[252:255], v[84:87]
    ds_read_b128 v[128:131], v14 offset:58368
    v_mfma_f32_16x16x32_bf16 v[84:87], v[112:115], a[244:247], v[84:87]
    ds_read_b128 v[132:135], v14 offset:62464
    v_mfma_f32_16x16x32_bf16 v[84:87], v[108:111], a[236:239], v[84:87]
    s_add_u32 m0, s73, 132096
    v_mfma_f32_16x16x32_bf16 v[84:87], v[104:107], a[228:231], v[84:87]
    buffer_load_dwordx4 v19, s[44:47], s23 offen offset:0 sc1 lds
    s_waitcnt lgkmcnt(2)
    v_mfma_f32_16x16x32_bf16 v[76:79], v[120:123], v[224:227], v[76:79]
    s_add_u32 m0, s73, 132608
    s_waitcnt vmcnt(15)
    v_bitop3_b32 v43, v43, v47, s68 bitop3:0x7e
    v_bitop3_b32 v43, v43, v51, s68 bitop3:0xf6
    v_cmp_ne_u32 vcc, 0, v43
    v_mfma_f32_16x16x32_bf16 v[76:79], v[124:127], v[232:235], v[76:79]
    buffer_load_dwordx4 v19, s[44:47], s23 offen offset:512 sc1 lds
    s_waitcnt lgkmcnt(0)
    v_mfma_f32_16x16x32_bf16 v[76:79], v[128:131], v[240:243], v[76:79]
    ds_read_b128 v[104:107], v14 offset:51200
    s_cbranch_vccnz L_xs_a
L_xo_a:
    v_and_b32 v89, 0xffff0000, v40
    v_mfma_f32_16x16x32_bf16 v[76:79], v[132:135], v[248:251], v[76:79]
    ds_read_b128 v[108:111], v14 offset:55296
    v_lshlrev_b32 v88, 16, v40
    v_mfma_f32_16x16x32_bf16 v[72:75], v[132:135], v[244:247], v[72:75]
    ds_read_b128 v[112:115], v14 offset:59392
    v_and_b32 v91, 0xffff0000, v41
    v_mfma_f32_16x16x32_bf16 v[72:75], v[128:131], v[236:239], v[72:75]
    ds_read_b128 v[116:119], v14 offset:63488
    v_lshlrev_b32 v90, 16, v41
    v_mfma_f32_16x16x32_bf16 v[72:75], v[124:127], v[228:231], v[72:75]
    s_add_u32 m0, s73, 134144
    v_and_b32 v93, 0xffff0000, v42
    v_lshlrev_b32 v92, 16, v42
    v_mfma_f32_16x16x32_bf16 v[72:75], v[120:123], v[220:223], v[72:75]
    buffer_load_dwordx4 v19, s[44:47], s24 offen offset:0 sc1 lds
    s_waitcnt lgkmcnt(2)
    v_mfma_f32_16x16x32_bf16 v[80:83], v[104:107], v[220:223], v[80:83]
    v_and_b32 v95, 0xffff0000, v44
    v_lshlrev_b32 v94, 16, v44
    v_mfma_f32_16x16x32_bf16 v[80:83], v[108:111], v[228:231], v[80:83]
    v_and_b32 v97, 0xffff0000, v45
    s_waitcnt lgkmcnt(0)
    v_mfma_f32_16x16x32_bf16 v[80:83], v[112:115], v[236:239], v[80:83]
    ds_read_b128 v[120:123], v14 offset:52224
    v_lshlrev_b32 v96, 16, v45
    v_mfma_f32_16x16x32_bf16 v[80:83], v[116:119], v[244:247], v[80:83]
    ds_read_b128 v[124:127], v14 offset:56320
    v_and_b32 v99, 0xffff0000, v46
    v_lshlrev_b32 v98, 16, v46
    v_mfma_f32_16x16x32_bf16 v[84:87], v[116:119], v[248:251], v[84:87]
    ds_read_b128 v[128:131], v14 offset:60416
    s_waitcnt vmcnt(7)
    v_and_b32 v101, 0xffff0000, v48
    v_mfma_f32_16x16x32_bf16 v[84:87], v[112:115], v[240:243], v[84:87]
    ds_read_b128 v[132:135], v14 offset:64512
    v_lshlrev_b32 v100, 16, v48
    v_cmp_ne_u32 vcc, v140, v141
    v_mfma_f32_16x16x32_bf16 v[84:87], v[108:111], v[232:235], v[84:87]
    v_and_b32 v103, 0xffff0000, v49
    v_lshlrev_b32 v102, 16, v49
    v_mfma_f32_16x16x32_bf16 v[84:87], v[104:107], v[224:227], v[84:87]
    s_cbranch_vccnz L_as_b
L_ao_b:
    s_waitcnt lgkmcnt(2)
    v_mfma_f32_16x16x32_bf16 v[92:95], v[120:123], a[4:7], v[92:95]
    buffer_load_dwordx4 v[56:59], v136, s[44:47], s11 offen offset:0 sc1
    v_mfma_f32_16x16x32_bf16 v[92:95], v[124:127], a[12:15], v[92:95]
    s_waitcnt lgkmcnt(0)
    v_mfma_f32_16x16x32_bf16 v[92:95], v[128:131], a[20:23], v[92:95]
    buffer_load_dwordx4 v[60:63], v136, s[44:47], s11 offen offset:1024 sc1
    s_barrier
    v_mfma_f32_16x16x32_bf16 v[92:95], v[132:135], a[28:31], v[92:95]
    ds_read_b128 v[104:107], v14 offset:0
    buffer_load_dwordx4 v[64:67], v136, s[44:47], s11 offen offset:2048 sc1
    v_mfma_f32_16x16x32_bf16 v[88:91], v[132:135], a[24:27], v[88:91]
    ds_read_b128 v[108:111], v14 offset:4096
    v_cvt_pk_bf16_f32 v192, v72, v73
    v_mfma_f32_16x16x32_bf16 v[88:91], v[128:131], a[16:19], v[88:91]
    ds_read_b128 v[112:115], v14 offset:8192
    v_cvt_pk_bf16_f32 v193, v74, v75
    v_mfma_f32_16x16x32_bf16 v[88:91], v[124:127], a[8:11], v[88:91]
    ds_read_b128 v[116:119], v14 offset:12288
    v_cvt_pk_bf16_f32 v194, v76, v77
    v_mfma_f32_16x16x32_bf16 v[88:91], v[120:123], a[0:3], v[88:91]
    buffer_store_dwordx4 v[192:195], v136, s[44:47], s31 offen offset:0 sc1
    s_waitcnt lgkmcnt(2)
    v_mfma_f32_16x16x32_bf16 v[96:99], v[104:107], a[0:3], v[96:99]
    s_add_u32 m0, s73, 146944
    v_cvt_pk_bf16_f32 v196, v78, v79
    v_cvt_pk_bf16_f32 v197, v80, v81
    v_mfma_f32_16x16x32_bf16 v[96:99], v[108:111], a[8:11], v[96:99]
    buffer_load_dwordx4 v19, s[44:47], s24 offen offset:512 sc1 lds
    s_waitcnt lgkmcnt(0)
    v_mfma_f32_16x16x32_bf16 v[96:99], v[112:115], a[16:19], v[96:99]
    ds_read_b128 v[120:123], v14 offset:1024
    v_cvt_pk_bf16_f32 v198, v82, v83
    v_mfma_f32_16x16x32_bf16 v[96:99], v[116:119], a[24:27], v[96:99]
    buffer_store_dwordx4 v[196:199], v136, s[44:47], s31 offen offset:1024 sc1
    ds_read_b128 v[124:127], v14 offset:5120
    v_bitop3_b32 v207, v207, v211, s36 bitop3:0x7e
    v_bitop3_b32 v207, v207, v215, s36 bitop3:0xf6
    v_mfma_f32_16x16x32_bf16 v[100:103], v[116:119], a[28:31], v[100:103]
    ds_read_b128 v[128:131], v14 offset:9216
    v_cvt_pk_bf16_f32 v200, v84, v85
    v_mfma_f32_16x16x32_bf16 v[100:103], v[112:115], a[20:23], v[100:103]
    ds_read_b128 v[132:135], v14 offset:13312
    v_cvt_pk_bf16_f32 v201, v86, v87
    v_mfma_f32_16x16x32_bf16 v[100:103], v[108:111], a[12:15], v[100:103]
    buffer_store_dwordx4 v[200:203], v136, s[44:47], s31 offen offset:2048 sc1
    s_add_u32 m0, s73, 148480
    v_bitop3_b32 v207, v207, v219, s36 bitop3:0xf6
    v_cmp_ne_u32 vcc, 0, v207
    v_mfma_f32_16x16x32_bf16 v[100:103], v[104:107], a[4:7], v[100:103]
    buffer_load_dwordx4 v19, s[44:47], s25 offen offset:0 sc1 lds
    s_waitcnt lgkmcnt(2)
    v_mfma_f32_16x16x32_bf16 v[92:95], v[120:123], a[36:39], v[92:95]
    s_add_u32 m0, s73, 148992
    s_cbranch_vccnz L_xs_8
L_xo_8:
    v_mfma_f32_16x16x32_bf16 v[92:95], v[124:127], a[44:47], v[92:95]
    buffer_load_dwordx4 v19, s[44:47], s25 offen offset:512 sc1 lds
    s_waitcnt lgkmcnt(0)
    v_mfma_f32_16x16x32_bf16 v[92:95], v[128:131], a[52:55], v[92:95]
    ds_read_b128 v[104:107], v14 offset:2048
    v_and_b32 v33, 0xffff0000, v204
    v_mfma_f32_16x16x32_bf16 v[92:95], v[132:135], a[60:63], v[92:95]
    ds_read_b128 v[108:111], v14 offset:6144
    v_lshlrev_b32 v32, 16, v204
    v_mfma_f32_16x16x32_bf16 v[88:91], v[132:135], a[56:59], v[88:91]
    ds_read_b128 v[112:115], v14 offset:10240
    v_and_b32 v35, 0xffff0000, v205
    v_mfma_f32_16x16x32_bf16 v[88:91], v[128:131], a[48:51], v[88:91]
    ds_read_b128 v[116:119], v14 offset:14336
    v_mfma_f32_16x16x32_bf16 v[88:91], v[124:127], a[40:43], v[88:91]
    s_add_u32 m0, s73, 150528
    v_lshlrev_b32 v34, 16, v205
    v_mfma_f32_16x16x32_bf16 v[88:91], v[120:123], a[32:35], v[88:91]
    buffer_load_dwordx4 v19, s[44:47], s26 offen offset:0 sc1 lds
    s_waitcnt lgkmcnt(2)
    v_mfma_f32_16x16x32_bf16 v[96:99], v[104:107], a[32:35], v[96:99]
    v_add_f32 v32, v32, v27
    v_mfma_f32_16x16x32_bf16 v[96:99], v[108:111], a[40:43], v[96:99]
    v_add_f32 v33, v33, v27
    s_waitcnt lgkmcnt(0)
    v_mfma_f32_16x16x32_bf16 v[96:99], v[112:115], a[48:51], v[96:99]
    ds_read_b128 v[120:123], v14 offset:3072
    v_add_f32 v34, v34, v27
    v_mfma_f32_16x16x32_bf16 v[96:99], v[116:119], a[56:59], v[96:99]
    ds_read_b128 v[124:127], v14 offset:7168
    v_mfma_f32_16x16x32_bf16 v[100:103], v[116:119], a[60:63], v[100:103]
    ds_read_b128 v[128:131], v14 offset:11264
    v_add_f32 v35, v35, v27
    v_mfma_f32_16x16x32_bf16 v[100:103], v[112:115], a[52:55], v[100:103]
    ds_read_b128 v[132:135], v14 offset:15360
    v_and_b32 v37, 0xffff0000, v208
    v_mfma_f32_16x16x32_bf16 v[100:103], v[108:111], a[44:47], v[100:103]
    v_mfma_f32_16x16x32_bf16 v[100:103], v[104:107], a[36:39], v[100:103]
    v_lshlrev_b32 v36, 16, v208
    s_waitcnt lgkmcnt(2)
    v_mfma_f32_16x16x32_bf16 v[92:95], v[120:123], a[68:71], v[92:95]
    v_and_b32 v39, 0xffff0000, v209
    v_mfma_f32_16x16x32_bf16 v[92:95], v[124:127], a[76:79], v[92:95]
    s_waitcnt lgkmcnt(0)
    v_mfma_f32_16x16x32_bf16 v[92:95], v[128:131], a[84:87], v[92:95]
    s_waitcnt vmcnt(14)
    s_barrier
    v_lshlrev_b32 v38, 16, v209
    v_mfma_f32_16x16x32_bf16 v[92:95], v[132:135], a[92:95], v[92:95]
    ds_read_b128 v[104:107], v14 offset:16384
    v_add_f32 v32, v32, v36
    v_mfma_f32_16x16x32_bf16 v[88:91], v[132:135], a[88:91], v[88:91]
    ds_read_b128 v[108:111], v14 offset:20480
    v_mfma_f32_16x16x32_bf16 v[88:91], v[128:131], a[80:83], v[88:91]
    ds_read_b128 v[112:115], v14 offset:24576
    v_add_f32 v33, v33, v37
    v_mfma_f32_16x16x32_bf16 v[88:91], v[124:127], a[72:75], v[88:91]
    ds_read_b128 v[116:119], v14 offset:28672
    v_add_f32 v34, v34, v38
    v_mfma_f32_16x16x32_bf16 v[88:91], v[120:123], a[64:67], v[88:91]
    s_waitcnt lgkmcnt(2)
    v_mfma_f32_16x16x32_bf16 v[96:99], v[104:107], a[64:67], v[96:99]
    s_add_u32 m0, s73, 97792
    v_add_f32 v35, v35, v39
    v_mfma_f32_16x16x32_bf16 v[96:99], v[108:111], a[72:75], v[96:99]
    buffer_load_dwordx4 v19, s[44:47], s26 offen offset:512 sc1 lds
    s_waitcnt lgkmcnt(0)
    v_mfma_f32_16x16x32_bf16 v[96:99], v[112:115], a[80:83], v[96:99]
    ds_read_b128 v[120:123], v14 offset:17408
    v_and_b32 v37, 0xffff0000, v212
    v_mfma_f32_16x16x32_bf16 v[96:99], v[116:119], a[88:91], v[96:99]
    ds_read_b128 v[124:127], v14 offset:21504
    v_lshlrev_b32 v36, 16, v212
    v_mfma_f32_16x16x32_bf16 v[100:103], v[116:119], a[92:95], v[100:103]
    ds_read_b128 v[128:131], v14 offset:25600
    v_and_b32 v39, 0xffff0000, v213
    v_mfma_f32_16x16x32_bf16 v[100:103], v[112:115], a[84:87], v[100:103]
    ds_read_b128 v[132:135], v14 offset:29696
    v_mfma_f32_16x16x32_bf16 v[100:103], v[108:111], a[76:79], v[100:103]
    v_lshlrev_b32 v38, 16, v213
    v_mfma_f32_16x16x32_bf16 v[100:103], v[104:107], a[68:71], v[100:103]
    v_add_f32 v32, v32, v36
    s_waitcnt lgkmcnt(2)
    v_mfma_f32_16x16x32_bf16 v[92:95], v[120:123], a[100:103], v[92:95]
    v_mfma_f32_16x16x32_bf16 v[92:95], v[124:127], a[108:111], v[92:95]
    v_add_f32 v33, v33, v37
    s_waitcnt lgkmcnt(0)
    v_mfma_f32_16x16x32_bf16 v[92:95], v[128:131], a[116:119], v[92:95]
    ds_read_b128 v[104:107], v14 offset:18432
    v_add_f32 v34, v34, v38
    v_mfma_f32_16x16x32_bf16 v[92:95], v[132:135], a[124:127], v[92:95]
    ds_read_b128 v[108:111], v14 offset:22528
    v_add_f32 v35, v35, v39
    v_mfma_f32_16x16x32_bf16 v[88:91], v[132:135], a[120:123], v[88:91]
    ds_read_b128 v[112:115], v14 offset:26624
    v_and_b32 v37, 0xffff0000, v216
    v_mfma_f32_16x16x32_bf16 v[88:91], v[128:131], a[112:115], v[88:91]
    ds_read_b128 v[116:119], v14 offset:30720
    v_lshlrev_b32 v36, 16, v216
    v_mfma_f32_16x16x32_bf16 v[88:91], v[124:127], a[104:107], v[88:91]
L_pl_D_2:
    s_cbranch_execz L_wret
    v_and_b32 v39, 0xffff0000, v217
    v_lshlrev_b32 v38, 16, v217
    v_mfma_f32_16x16x32_bf16 v[88:91], v[120:123], a[96:99], v[88:91]
    v_add_f32 v32, v32, v36
    s_waitcnt lgkmcnt(2)
    v_mfma_f32_16x16x32_bf16 v[96:99], v[104:107], a[96:99], v[96:99]
    v_add_f32 v33, v33, v37
    v_add_f32 v34, v34, v38
    v_mfma_f32_16x16x32_bf16 v[96:99], v[108:111], a[104:107], v[96:99]
    v_add_f32 v35, v35, v39
    s_waitcnt lgkmcnt(0)
    v_mfma_f32_16x16x32_bf16 v[96:99], v[112:115], a[112:115], v[96:99]
    ds_read_b128 v[120:123], v14 offset:19456
    v_mul_f32 v36, s38, v32
    v_mfma_f32_16x16x32_bf16 v[96:99], v[116:119], a[120:123], v[96:99]
    ds_read_b128 v[124:127], v14 offset:23552
    v_mul_f32 v37, s38, v33
    v_mfma_f32_16x16x32_bf16 v[100:103], v[116:119], a[124:127], v[100:103]
    ds_read_b128 v[128:131], v14 offset:27648
    v_mul_f32 v38, s38, v34
    v_mfma_f32_16x16x32_bf16 v[100:103], v[112:115], a[116:119], v[100:103]
    ds_read_b128 v[132:135], v14 offset:31744
    v_mul_f32 v39, s38, v35
    v_mfma_f32_16x16x32_bf16 v[100:103], v[108:111], a[108:111], v[100:103]
    v_exp_f32 v36, v36
    v_mfma_f32_16x16x32_bf16 v[100:103], v[104:107], a[100:103], v[100:103]
    s_waitcnt lgkmcnt(2)
    v_mfma_f32_16x16x32_bf16 v[92:95], v[120:123], a[132:135], v[92:95]
    v_exp_f32 v37, v37
    v_mfma_f32_16x16x32_bf16 v[92:95], v[124:127], a[140:143], v[92:95]
    s_waitcnt lgkmcnt(0)
    v_mfma_f32_16x16x32_bf16 v[92:95], v[128:131], a[148:151], v[92:95]
    s_waitcnt vmcnt(11)
    s_barrier
    v_mfma_f32_16x16x32_bf16 v[92:95], v[132:135], a[156:159], v[92:95]
    ds_read_b128 v[104:107], v14 offset:32768
    v_mfma_f32_16x16x32_bf16 v[88:91], v[132:135], a[152:155], v[88:91]
    ds_read_b128 v[108:111], v14 offset:36864
    v_exp_f32 v38, v38
    v_mfma_f32_16x16x32_bf16 v[88:91], v[128:131], a[144:147], v[88:91]
    ds_read_b128 v[112:115], v14 offset:40960
    v_exp_f32 v39, v39
    v_mfma_f32_16x16x32_bf16 v[88:91], v[124:127], a[136:139], v[88:91]
    ds_read_b128 v[116:119], v14 offset:45056
    v_mul_f32 v180, v180, v32
    v_mfma_f32_16x16x32_bf16 v[88:91], v[120:123], a[128:131], v[88:91]
    v_mul_f32 v181, v181, v33
    s_waitcnt lgkmcnt(2)
    v_mfma_f32_16x16x32_bf16 v[96:99], v[104:107], a[128:131], v[96:99]
    v_mul_f32 v182, v182, v34
    v_mul_f32 v183, v183, v35
    v_mfma_f32_16x16x32_bf16 v[96:99], v[108:111], a[136:139], v[96:99]
    v_add_f32 v36, 1.0, v36
    s_waitcnt lgkmcnt(0)
    v_mfma_f32_16x16x32_bf16 v[96:99], v[112:115], a[144:147], v[96:99]
    ds_read_b128 v[120:123], v14 offset:33792
    v_add_f32 v37, 1.0, v37
    v_mfma_f32_16x16x32_bf16 v[96:99], v[116:119], a[152:155], v[96:99]
    ds_read_b128 v[124:127], v14 offset:37888
    v_add_f32 v38, 1.0, v38
    v_mfma_f32_16x16x32_bf16 v[100:103], v[116:119], a[156:159], v[100:103]
    ds_read_b128 v[128:131], v14 offset:41984
    v_add_f32 v39, 1.0, v39
    v_mfma_f32_16x16x32_bf16 v[100:103], v[112:115], a[148:151], v[100:103]
    ds_read_b128 v[132:135], v14 offset:46080
    v_rcp_f32 v36, v36
    v_mfma_f32_16x16x32_bf16 v[100:103], v[108:111], a[140:143], v[100:103]
    v_rcp_f32 v37, v37
    v_mfma_f32_16x16x32_bf16 v[100:103], v[104:107], a[132:135], v[100:103]
    v_rcp_f32 v38, v38
    s_waitcnt lgkmcnt(2)
    v_mfma_f32_16x16x32_bf16 v[92:95], v[120:123], a[164:167], v[92:95]
    s_waitcnt vmcnt(8)
    v_bitop3_b32 v59, v59, v63, s68 bitop3:0x7e
    v_rcp_f32 v39, v39
    v_mfma_f32_16x16x32_bf16 v[92:95], v[124:127], a[172:175], v[92:95]
    buffer_load_dwordx4 v[72:75], v136, s[44:47], s12 offen offset:0 sc1
    s_waitcnt lgkmcnt(0)
    v_mfma_f32_16x16x32_bf16 v[92:95], v[128:131], a[180:183], v[92:95]
    ds_read_b128 v[104:107], v14 offset:34816
    v_bitop3_b32 v59, v59, v67, s68 bitop3:0xf6
    v_mfma_f32_16x16x32_bf16 v[92:95], v[132:135], a[188:191], v[92:95]
    ds_read_b128 v[108:111], v14 offset:38912
    v_cmp_ne_u32 vcc, 0, v59
    v_mfma_f32_16x16x32_bf16 v[88:91], v[132:135], a[184:187], v[88:91]
    ds_read_b128 v[112:115], v14 offset:43008
    buffer_load_dwordx4 v[76:79], v136, s[44:47], s12 offen offset:1024 sc1
    v_mfma_f32_16x16x32_bf16 v[88:91], v[128:131], a[176:179], v[88:91]
    ds_read_b128 v[116:119], v14 offset:47104
    s_cbranch_vccnz L_xs_b
L_xo_b:
    v_fma_f32 v180, v180, v36, v160
    v_mfma_f32_16x16x32_bf16 v[88:91], v[124:127], a[168:171], v[88:91]
    buffer_load_dwordx4 v[80:83], v136, s[44:47], s12 offen offset:2048 sc1
    v_and_b32 v41, 0xffff0000, v56
    v_mfma_f32_16x16x32_bf16 v[88:91], v[120:123], a[160:163], v[88:91]
    v_lshlrev_b32 v40, 16, v56
    s_waitcnt lgkmcnt(2)
    v_mfma_f32_16x16x32_bf16 v[96:99], v[104:107], a[160:163], v[96:99]
    v_and_b32 v43, 0xffff0000, v57
    v_fma_f32 v181, v181, v37, v161
    v_mfma_f32_16x16x32_bf16 v[96:99], v[108:111], a[168:171], v[96:99]
    v_lshlrev_b32 v42, 16, v57
    s_waitcnt lgkmcnt(0)
    v_mfma_f32_16x16x32_bf16 v[96:99], v[112:115], a[176:179], v[96:99]
    ds_read_b128 v[120:123], v14 offset:35840
    v_and_b32 v45, 0xffff0000, v58
    v_mfma_f32_16x16x32_bf16 v[96:99], v[116:119], a[184:187], v[96:99]
    ds_read_b128 v[124:127], v14 offset:39936
    v_fma_f32 v182, v182, v38, v162
    v_mfma_f32_16x16x32_bf16 v[100:103], v[116:119], a[188:191], v[100:103]
    ds_read_b128 v[128:131], v14 offset:44032
    v_lshlrev_b32 v44, 16, v58
    v_mfma_f32_16x16x32_bf16 v[100:103], v[112:115], a[180:183], v[100:103]
    ds_read_b128 v[132:135], v14 offset:48128
    v_and_b32 v47, 0xffff0000, v60
    v_mfma_f32_16x16x32_bf16 v[100:103], v[108:111], a[172:175], v[100:103]
    v_lshlrev_b32 v46, 16, v60
    v_fma_f32 v183, v183, v39, v163
    v_mfma_f32_16x16x32_bf16 v[100:103], v[104:107], a[164:167], v[100:103]
    v_and_b32 v49, 0xffff0000, v61
    s_waitcnt lgkmcnt(2)
    v_mfma_f32_16x16x32_bf16 v[92:95], v[120:123], a[196:199], v[92:95]
    v_lshlrev_b32 v48, 16, v61
    v_cvt_pk_bf16_f32 v142, v180, v181
    v_mfma_f32_16x16x32_bf16 v[92:95], v[124:127], a[204:207], v[92:95]
    v_and_b32 v51, 0xffff0000, v62
    s_waitcnt lgkmcnt(0)
    v_mfma_f32_16x16x32_bf16 v[92:95], v[128:131], a[212:215], v[92:95]
    s_waitcnt vmcnt(4)
    s_barrier
    v_lshlrev_b32 v50, 16, v62
    v_mfma_f32_16x16x32_bf16 v[92:95], v[132:135], a[220:223], v[92:95]
    ds_read_b128 v[104:107], v14 offset:49152
    v_cvt_pk_bf16_f32 v143, v182, v183
    v_mfma_f32_16x16x32_bf16 v[88:91], v[132:135], a[216:219], v[88:91]
    ds_read_b128 v[108:111], v14 offset:53248
    v_and_b32 v53, 0xffff0000, v64
    v_mfma_f32_16x16x32_bf16 v[88:91], v[128:131], a[208:211], v[88:91]
    ds_read_b128 v[112:115], v14 offset:57344
    v_lshlrev_b32 v52, 16, v64
    v_mfma_f32_16x16x32_bf16 v[88:91], v[124:127], a[200:203], v[88:91]
    ds_read_b128 v[116:119], v14 offset:61440
    v_and_b32 v55, 0xffff0000, v65
    v_mfma_f32_16x16x32_bf16 v[88:91], v[120:123], a[192:195], v[88:91]
    v_lshlrev_b32 v54, 16, v65
    s_waitcnt lgkmcnt(2)
    v_mfma_f32_16x16x32_bf16 v[96:99], v[104:107], a[192:195], v[96:99]
    v_mfma_f32_16x16x32_bf16 v[96:99], v[108:111], a[200:203], v[96:99]
    s_waitcnt lgkmcnt(0)
    v_mfma_f32_16x16x32_bf16 v[96:99], v[112:115], a[208:211], v[96:99]
    ds_read_b128 v[120:123], v14 offset:50176
    v_add_f32 v92, v92, v44
    v_add_f32 v93, v93, v45
    v_mfma_f32_16x16x32_bf16 v[96:99], v[116:119], a[216:219], v[96:99]
    ds_read_b128 v[124:127], v14 offset:54272
    v_add_f32 v94, v94, v46
    v_mfma_f32_16x16x32_bf16 v[100:103], v[116:119], a[220:223], v[100:103]
    ds_read_b128 v[128:131], v14 offset:58368
    v_add_f32 v95, v95, v47
    v_add_f32 v88, v88, v40
    v_mfma_f32_16x16x32_bf16 v[100:103], v[112:115], a[212:215], v[100:103]
    ds_read_b128 v[132:135], v14 offset:62464
    v_add_f32 v89, v89, v41
    v_mfma_f32_16x16x32_bf16 v[100:103], v[108:111], a[204:207], v[100:103]
    v_add_f32 v90, v90, v42
    v_add_f32 v91, v91, v43
    v_mfma_f32_16x16x32_bf16 v[100:103], v[104:107], a[196:199], v[100:103]
    s_waitcnt lgkmcnt(2)
    v_mfma_f32_16x16x32_bf16 v[92:95], v[120:123], a[228:231], v[92:95]
    v_mfma_f32_16x16x32_bf16 v[92:95], v[124:127], a[236:239], v[92:95]
    s_waitcnt lgkmcnt(0)
    v_mfma_f32_16x16x32_bf16 v[92:95], v[128:131], a[244:247], v[92:95]
    ds_read_b128 v[104:107], v14 offset:51200
    v_add_f32 v96, v96, v48
    v_add_f32 v97, v97, v49
    v_mfma_f32_16x16x32_bf16 v[92:95], v[132:135], a[252:255], v[92:95]
    ds_read_b128 v[108:111], v14 offset:55296
    v_add_f32 v98, v98, v50
    v_mfma_f32_16x16x32_bf16 v[88:91], v[132:135], a[248:251], v[88:91]
    ds_read_b128 v[112:115], v14 offset:59392
    v_add_f32 v99, v99, v51
    v_add_f32 v100, v100, v52
    v_mfma_f32_16x16x32_bf16 v[88:91], v[128:131], a[240:243], v[88:91]
    ds_read_b128 v[116:119], v14 offset:63488
    v_add_f32 v101, v101, v53
    v_mfma_f32_16x16x32_bf16 v[88:91], v[124:127], a[232:235], v[88:91]
    v_add_f32 v102, v102, v54
    v_add_f32 v103, v103, v55
    v_mfma_f32_16x16x32_bf16 v[88:91], v[120:123], a[224:227], v[88:91]
    s_waitcnt lgkmcnt(2)
    v_mfma_f32_16x16x32_bf16 v[96:99], v[104:107], a[224:227], v[96:99]
    v_mfma_f32_16x16x32_bf16 v[96:99], v[108:111], a[232:235], v[96:99]
    s_waitcnt lgkmcnt(0)
    v_mfma_f32_16x16x32_bf16 v[96:99], v[112:115], a[240:243], v[96:99]
    ds_read_b128 v[120:123], v14 offset:52224
    v_mfma_f32_16x16x32_bf16 v[96:99], v[116:119], a[248:251], v[96:99]
    ds_read_b128 v[124:127], v14 offset:56320
    v_mfma_f32_16x16x32_bf16 v[100:103], v[116:119], a[252:255], v[100:103]
    buffer_store_dwordx2 v[142:143], v253, s[64:67], 0 offen sc1
    ds_read_b128 v[128:131], v14 offset:60416
    v_mfma_f32_16x16x32_bf16 v[100:103], v[112:115], a[244:247], v[100:103]
    ds_read_b128 v[132:135], v14 offset:64512
    v_mfma_f32_16x16x32_bf16 v[100:103], v[108:111], a[236:239], v[100:103]
    v_mfma_f32_16x16x32_bf16 v[100:103], v[104:107], a[228:231], v[100:103]
    s_waitcnt lgkmcnt(2)
    v_mfma_f32_16x16x32_bf16 v[92:95], v[120:123], v[224:227], v[92:95]
    v_mfma_f32_16x16x32_bf16 v[92:95], v[124:127], v[232:235], v[92:95]
    s_waitcnt lgkmcnt(0)
    v_mfma_f32_16x16x32_bf16 v[92:95], v[128:131], v[240:243], v[92:95]
    s_waitcnt vmcnt(4)
    s_barrier
    v_mfma_f32_16x16x32_bf16 v[92:95], v[132:135], v[248:251], v[92:95]
    ds_read_b128 v[104:107], v14 offset:0
    v_mfma_f32_16x16x32_bf16 v[88:91], v[132:135], v[244:247], v[88:91]
    ds_read_b128 v[108:111], v14 offset:4096
    v_mfma_f32_16x16x32_bf16 v[88:91], v[128:131], v[236:239], v[88:91]
    ds_read_b128 v[112:115], v14 offset:8192
    v_mfma_f32_16x16x32_bf16 v[88:91], v[124:127], v[228:231], v[88:91]
    ds_read_b128 v[116:119], v14 offset:12288
    v_mfma_f32_16x16x32_bf16 v[88:91], v[120:123], v[220:223], v[88:91]
    s_waitcnt lgkmcnt(2)
    v_mfma_f32_16x16x32_bf16 v[96:99], v[104:107], v[220:223], v[96:99]
    v_mfma_f32_16x16x32_bf16 v[96:99], v[108:111], v[228:231], v[96:99]
    s_waitcnt lgkmcnt(0)
    v_mfma_f32_16x16x32_bf16 v[96:99], v[112:115], v[236:239], v[96:99]
    v_mfma_f32_16x16x32_bf16 v[96:99], v[116:119], v[244:247], v[96:99]
    v_mfma_f32_16x16x32_bf16 v[100:103], v[116:119], v[248:251], v[100:103]
    v_mfma_f32_16x16x32_bf16 v[100:103], v[112:115], v[240:243], v[100:103]
    v_mfma_f32_16x16x32_bf16 v[100:103], v[108:111], v[232:235], v[100:103]
    v_mfma_f32_16x16x32_bf16 v[100:103], v[104:107], v[224:227], v[100:103]
    s_waitcnt vmcnt(1)
    v_bitop3_b32 v75, v75, v79, s68 bitop3:0x7e
    v_bitop3_b32 v75, v75, v83, s68 bitop3:0xf6
    v_cmp_ne_u32 vcc, 0, v75
    s_cbranch_vccnz L_xs_z
L_xo_z:
    v_and_b32 v41, 0xffff0000, v72
    v_lshlrev_b32 v40, 16, v72
    v_and_b32 v43, 0xffff0000, v73
    v_lshlrev_b32 v42, 16, v73
    v_and_b32 v45, 0xffff0000, v74
    v_lshlrev_b32 v44, 16, v74
    v_and_b32 v47, 0xffff0000, v76
    v_lshlrev_b32 v46, 16, v76
    v_and_b32 v49, 0xffff0000, v77
    v_lshlrev_b32 v48, 16, v77
    v_and_b32 v51, 0xffff0000, v78
    v_lshlrev_b32 v50, 16, v78
    v_and_b32 v53, 0xffff0000, v80
    v_lshlrev_b32 v52, 16, v80
    v_and_b32 v55, 0xffff0000, v81
    v_lshlrev_b32 v54, 16, v81
    v_pk_add_f32 v[88:89], v[88:89], v[40:41]
    v_pk_add_f32 v[90:91], v[90:91], v[42:43]
    v_pk_add_f32 v[96:97], v[96:97], v[48:49]
    v_pk_add_f32 v[98:99], v[98:99], v[50:51]
    v_pk_mul_f32 v[56:57], v[88:89], s[38:39] op_sel_hi:[1,0]
    v_pk_mul_f32 v[58:59], v[90:91], s[38:39] op_sel_hi:[1,0]
    v_pk_mul_f32 v[64:65], v[96:97], s[38:39] op_sel_hi:[1,0]
    v_pk_mul_f32 v[66:67], v[98:99], s[38:39] op_sel_hi:[1,0]
    v_exp_f32 v56, v56
    v_exp_f32 v57, v57
    v_exp_f32 v58, v58
    v_exp_f32 v59, v59
    v_exp_f32 v64, v64
    v_exp_f32 v65, v65
    v_exp_f32 v66, v66
    v_exp_f32 v67, v67
    v_pk_mul_f32 v[164:165], v[164:165], v[88:89]
    v_pk_mul_f32 v[166:167], v[166:167], v[90:91]
    v_pk_mul_f32 v[172:173], v[172:173], v[96:97]
    v_pk_mul_f32 v[174:175], v[174:175], v[98:99]
    v_pk_add_f32 v[56:57], v[56:57], 1.0 op_sel_hi:[1,0]
    v_pk_add_f32 v[58:59], v[58:59], 1.0 op_sel_hi:[1,0]
    v_pk_add_f32 v[64:65], v[64:65], 1.0 op_sel_hi:[1,0]
    v_pk_add_f32 v[66:67], v[66:67], 1.0 op_sel_hi:[1,0]
    v_rcp_f32 v56, v56
    v_rcp_f32 v57, v57
    v_rcp_f32 v58, v58
    v_rcp_f32 v59, v59
    v_rcp_f32 v64, v64
    v_rcp_f32 v65, v65
    v_rcp_f32 v66, v66
    v_rcp_f32 v67, v67
    v_pk_fma_f32 v[164:165], v[164:165], v[56:57], v[144:145]
    v_pk_fma_f32 v[166:167], v[166:167], v[58:59], v[146:147]
    v_pk_fma_f32 v[172:173], v[172:173], v[64:65], v[152:153]
    v_pk_fma_f32 v[174:175], v[174:175], v[66:67], v[154:155]
    v_cvt_pk_bf16_f32 v88, v164, v165
    v_cvt_pk_bf16_f32 v90, v172, v173
    v_cvt_pk_bf16_f32 v89, v166, v167
    v_cvt_pk_bf16_f32 v91, v174, v175
    v_permlane16_swap_b32 v88, v90
    s_nop 0
    v_permlane16_swap_b32 v89, v91
    buffer_store_dwordx4 v[88:91], v252, s[64:67], 0 offen sc1
    v_pk_add_f32 v[92:93], v[92:93], v[44:45]
    v_pk_add_f32 v[94:95], v[94:95], v[46:47]
    v_pk_add_f32 v[100:101], v[100:101], v[52:53]
    v_pk_add_f32 v[102:103], v[102:103], v[54:55]
    v_pk_mul_f32 v[60:61], v[92:93], s[38:39] op_sel_hi:[1,0]
    v_pk_mul_f32 v[62:63], v[94:95], s[38:39] op_sel_hi:[1,0]
    v_pk_mul_f32 v[68:69], v[100:101], s[38:39] op_sel_hi:[1,0]
    v_pk_mul_f32 v[70:71], v[102:103], s[38:39] op_sel_hi:[1,0]
    v_exp_f32 v60, v60
    v_exp_f32 v61, v61
    v_exp_f32 v62, v62
    v_exp_f32 v63, v63
    v_exp_f32 v68, v68
    v_exp_f32 v69, v69
    v_exp_f32 v70, v70
    v_exp_f32 v71, v71
    v_pk_mul_f32 v[168:169], v[168:169], v[92:93]
    v_pk_mul_f32 v[170:171], v[170:171], v[94:95]
    v_pk_mul_f32 v[176:177], v[176:177], v[100:101]
    v_pk_mul_f32 v[178:179], v[178:179], v[102:103]
    v_pk_add_f32 v[60:61], v[60:61], 1.0 op_sel_hi:[1,0]
    v_pk_add_f32 v[62:63], v[62:63], 1.0 op_sel_hi:[1,0]
    v_pk_add_f32 v[68:69], v[68:69], 1.0 op_sel_hi:[1,0]
    v_pk_add_f32 v[70:71], v[70:71], 1.0 op_sel_hi:[1,0]
    v_rcp_f32 v60, v60
    v_rcp_f32 v61, v61
    v_rcp_f32 v62, v62
    v_rcp_f32 v63, v63
    v_rcp_f32 v68, v68
    v_rcp_f32 v69, v69
    v_rcp_f32 v70, v70
    v_rcp_f32 v71, v71
    v_pk_fma_f32 v[168:169], v[168:169], v[60:61], v[148:149]
    v_pk_fma_f32 v[170:171], v[170:171], v[62:63], v[150:151]
    v_pk_fma_f32 v[176:177], v[176:177], v[68:69], v[156:157]
    v_pk_fma_f32 v[178:179], v[178:179], v[70:71], v[158:159]
    v_cvt_pk_bf16_f32 v92, v168, v169
    v_cvt_pk_bf16_f32 v94, v176, v177
    v_cvt_pk_bf16_f32 v93, v170, v171
    v_cvt_pk_bf16_f32 v95, v178, v179
    v_permlane16_swap_b32 v92, v94
    s_nop 0
    v_permlane16_swap_b32 v93, v95
    buffer_store_dwordx4 v[92:95], v252, s[64:67], s40 offen sc1
    s_endpgm
L_segE:
.p2align 12
L_aux:
    s_mul_i32 s84, s101, 14
    s_lshr_b32 s84, s84, 2
    s_add_u32 s84, s84, 0
    s_add_u32 s85, s84, 1
    s_cmp_eq_u32 s85, 14
    s_cselect_b32 s85, 0, s85
    s_add_u32 s86, s85, 1
    s_cmp_eq_u32 s86, 14
    s_cselect_b32 s86, 0, s86
    s_add_u32 s87, s86, 1
    s_cmp_eq_u32 s87, 14
    s_cselect_b32 s87, 0, s87
    s_add_u32 s88, s87, 1
    s_cmp_eq_u32 s88, 14
    s_cselect_b32 s88, 0, s88
    s_add_u32 s89, s88, 1
    s_cmp_eq_u32 s89, 14
    s_cselect_b32 s89, 0, s89
    s_add_u32 s90, s89, 1
    s_cmp_eq_u32 s90, 14
    s_cselect_b32 s90, 0, s90
    s_add_u32 s91, s90, 1
    s_cmp_eq_u32 s91, 14
    s_cselect_b32 s91, 0, s91
    s_add_u32 s92, s91, 1
    s_cmp_eq_u32 s92, 14
    s_cselect_b32 s92, 0, s92
    s_add_u32 s93, s92, 1
    s_cmp_eq_u32 s93, 14
    s_cselect_b32 s93, 0, s93
    s_add_u32 s94, s93, 1
    s_cmp_eq_u32 s94, 14
    s_cselect_b32 s94, 0, s94
    s_add_u32 s95, s94, 1
    s_cmp_eq_u32 s95, 14
    s_cselect_b32 s95, 0, s95
    s_add_u32 s96, s95, 1
    s_cmp_eq_u32 s96, 14
    s_cselect_b32 s96, 0, s96
    s_add_u32 s97, s96, 1
    s_cmp_eq_u32 s97, 14
    s_cselect_b32 s97, 0, s97
    s_mul_i32 s98, s101, 4
    s_lshr_b32 s98, s98, 2
    s_add_u32 s98, s98, 14
    s_add_u32 s99, s98, 1
    s_cmp_eq_u32 s99, 18
    s_cselect_b32 s99, 14, s99
    s_add_u32 s100, s99, 1
    s_cmp_eq_u32 s100, 18
    s_cselect_b32 s100, 14, s100
    s_add_u32 s101, s100, 1
    s_cmp_eq_u32 s101, 18
    s_cselect_b32 s101, 14, s101
    s_lshl2_add_u32 s7, s5, s6
    s_add_u32 s7, s7, 188
    s_add_u32 s8, s5, 248
    s_cmp_eq_u32 s6, 27
    s_cselect_b32 s75, s8, s7
    s_mov_b32 s48, s24
    s_and_b32 s49, s25, 0xffff
    s_mov_b32 s50, 2359296
    s_mov_b32 s51, 0x20000
    v_lshlrev_b32 v240, 4, v2
    s_mul_i32 s74, s3, 16640
    s_add_u32 s74, s74, 73728
    s_sub_u32 s69, s75, 216
    s_lshl_b32 s70, s69, 4
    s_add_u32 s70, s70, s3
    s_lshl_b32 s12, s70, 12
    s_lshl_b32 s70, s70, 1
    s_mov_b32 s9, 144896
    s_mov_b32 s11, 8192
    v_mul_u32_u24 v48, 1216, v3
    v_mad_u32_u24 v48, v4, 12, v48
    v_add_u32 v48, s9, v48
    v_mov_b32 v47, 0x40000000
    v_lshlrev_b32 v3, 3, v3
    s_lshl_b32 s5, s68, 6
    s_add_u32 s5, s5, 12386304
    v_cmp_eq_u32 vcc, 0, v4
    s_nop 1
    v_cndmask_b32 v49, v47, v3, vcc
    v_lshrrev_b32 v5, 4, v0
    v_and_b32 v4, 3, v2
    v_lshlrev_b32 v4, 3, v4
    v_lshl_add_u32 v5, v5, 5, v4
    v_bfe_u32 v6, v2, 2, 2
    v_mul_u32_u24 v4, 1216, v6
    v_mul_u32_u24 v6, 1152, v6
    v_add3_u32 v50, v4, v5, s9
    v_add3_u32 v51, v6, v5, s11
    s_mul_i32 s4, s3, 2176
    v_add_u32 v55, s4, v51
    v_lshlrev_b32 v52, 4, v0
    s_add_u32 s7, s15, 4096
    s_add_u32 s8, s15, 8192
    s_cmp_eq_u32 s3, 0
    s_cselect_b32 s8, s8, 0x40000000
    v_add_u32 v53, 2359296, v52
    v_mov_b32 v54, 0
    s_mul_i32 s4, s3, 1028
    s_sub_u32 s4, 8204, s4
    v_add_u32 v90, s4, v53
    s_bfe_u32 s6, s68, 0x20001
    s_lshl_b32 s6, s6, 6
    s_lshr_b32 s9, s68, 3
    s_lshl1_add_u32 s6, s9, s6
    s_and_b32 s9, s68, 1
    s_add_u32 s6, s6, s9
    s_lshl_b32 s4, s6, 2
    s_add_u32 s4, s4, 12533760
    v_lshl_add_u32 v1, v0, 10, s4
    s_lshl_b32 s4, s68, 2
    s_add_u32 s4, s4, 12599296
    v_lshl_add_u32 v46, v0, 10, s4
    v_cmp_gt_u32 vcc, 8, v0
    s_nop 1
    v_cndmask_b32 v1, v47, v1, vcc
    v_cmp_gt_u32 vcc, 4, v0
    s_nop 1
    v_cndmask_b32 v46, v47, v46, vcc
    s_waitcnt vmcnt(9)
    v_and_b32 v21, 0xffff0000, v8
    v_lshlrev_b32 v20, 16, v8
    v_and_b32 v23, 0xffff0000, v9
    v_lshlrev_b32 v22, 16, v9
    v_and_b32 v25, 0xffff0000, v10
    v_lshlrev_b32 v24, 16, v10
    v_and_b32 v27, 0xffff0000, v12
    v_lshlrev_b32 v26, 16, v12
    v_and_b32 v29, 0xffff0000, v13
    v_lshlrev_b32 v28, 16, v13
    v_and_b32 v31, 0xffff0000, v14
    v_lshlrev_b32 v30, 16, v14
    v_and_b32 v33, 0xffff0000, v16
    v_lshlrev_b32 v32, 16, v16
    v_and_b32 v35, 0xffff0000, v17
    v_lshlrev_b32 v34, 16, v17
    v_and_b32 v37, 0xffff0000, v18
    v_lshlrev_b32 v36, 16, v18
    v_pk_add_f32 v[38:39], v[20:21], v[22:23]
    v_pk_add_f32 v[40:41], v[24:25], v[26:27]
    v_pk_add_f32 v[42:43], v[28:29], v[30:31]
    v_pk_add_f32 v[44:45], v[32:33], v[34:35]
    v_pk_add_f32 v[38:39], v[38:39], v[40:41]
    v_pk_add_f32 v[42:43], v[42:43], v[44:45]
    v_pk_add_f32 v[38:39], v[38:39], v[36:37]
    v_pk_add_f32 v[38:39], v[38:39], v[42:43]
    v_add_f32 v56, v38, v39
    s_nop 1
    v_add_f32_dpp v56, v56, v56 row_ror:8 row_mask:0xf bank_mask:0xf
    s_nop 1
    v_add_f32_dpp v56, v56, v56 row_ror:4 row_mask:0xf bank_mask:0xf
    s_nop 1
    v_add_f32_dpp v56, v56, v56 row_ror:2 row_mask:0xf bank_mask:0xf
    s_nop 1
    v_add_f32_dpp v56, v56, v56 row_ror:1 row_mask:0xf bank_mask:0xf
    v_mov_b32 v57, v56
    s_nop 1
    v_permlane16_swap_b32 v56, v57
    v_add_f32 v56, v56, v57
    v_mul_f32 v56, 0x3ae38e39, v56
    v_pk_add_f32 v[20:21], v[20:21], v[56:57] op_sel_hi:[1,0] neg_lo:[0,1] neg_hi:[0,1]
    v_pk_add_f32 v[22:23], v[22:23], v[56:57] op_sel_hi:[1,0] neg_lo:[0,1] neg_hi:[0,1]
    v_pk_add_f32 v[24:25], v[24:25], v[56:57] op_sel_hi:[1,0] neg_lo:[0,1] neg_hi:[0,1]
    v_pk_add_f32 v[26:27], v[26:27], v[56:57] op_sel_hi:[1,0] neg_lo:[0,1] neg_hi:[0,1]
    v_pk_add_f32 v[28:29], v[28:29], v[56:57] op_sel_hi:[1,0] neg_lo:[0,1] neg_hi:[0,1]
    v_pk_add_f32 v[30:31], v[30:31], v[56:57] op_sel_hi:[1,0] neg_lo:[0,1] neg_hi:[0,1]
    v_pk_add_f32 v[32:33], v[32:33], v[56:57] op_sel_hi:[1,0] neg_lo:[0,1] neg_hi:[0,1]
    v_pk_add_f32 v[34:35], v[34:35], v[56:57] op_sel_hi:[1,0] neg_lo:[0,1] neg_hi:[0,1]
    v_pk_add_f32 v[36:37], v[36:37], v[56:57] op_sel_hi:[1,0] neg_lo:[0,1] neg_hi:[0,1]
    v_pk_mul_f32 v[38:39], v[20:21], v[20:21]
    v_pk_mul_f32 v[40:41], v[22:23], v[22:23]
    v_pk_fma_f32 v[38:39], v[24:25], v[24:25], v[38:39]
    v_pk_fma_f32 v[40:41], v[26:27], v[26:27], v[40:41]
    v_pk_fma_f32 v[38:39], v[28:29], v[28:29], v[38:39]
    v_pk_fma_f32 v[40:41], v[30:31], v[30:31], v[40:41]
    v_pk_fma_f32 v[38:39], v[32:33], v[32:33], v[38:39]
    v_pk_fma_f32 v[40:41], v[34:35], v[34:35], v[40:41]
    v_pk_fma_f32 v[38:39], v[36:37], v[36:37], v[38:39]
    v_pk_add_f32 v[38:39], v[38:39], v[40:41]
    v_add_f32 v18, v38, v39
    s_nop 1
    v_add_f32_dpp v18, v18, v18 row_ror:8 row_mask:0xf bank_mask:0xf
    s_nop 1
    v_add_f32_dpp v18, v18, v18 row_ror:4 row_mask:0xf bank_mask:0xf
    s_nop 1
    v_add_f32_dpp v18, v18, v18 row_ror:2 row_mask:0xf bank_mask:0xf
    s_nop 1
    v_add_f32_dpp v18, v18, v18 row_ror:1 row_mask:0xf bank_mask:0xf
    v_mov_b32 v19, v18
    s_nop 1
    v_permlane16_swap_b32 v18, v19
    v_add_f32 v18, v18, v19
    v_mul_f32 v18, 0x3ae38e39, v18
    v_cvt_pk_bf16_f32 v38, v56, v18
    v_lshlrev_b32 v106, 16, v38
    v_and_b32 v38, 0xffff0000, v38
    v_add_f32 v38, 0x3727c5ac, v38
    v_sub_f32 v56, v56, v106
    v_cvt_pk_bf16_f32 v38, v38, v38
    v_lshlrev_b32 v38, 16, v38
    v_sqrt_f32 v38, v38
    s_nop 0
    v_cvt_pk_bf16_f32 v38, v38, v38
    v_lshlrev_b32 v38, 16, v38
    v_rcp_f32 v107, v38
    s_nop 0
    v_mul_f32 v56, v56, v107
    v_mul_f32 v18, v18, v107
    v_mul_f32 v18, v18, v107
    v_cvt_pk_bf16_f32 v38, v56, v18
    v_lshlrev_b32 v39, 16, v38
    v_and_b32 v38, 0xffff0000, v38
    v_add_f32 v38, 0x3727c5ac, v38
    v_sub_f32 v56, v56, v39
    v_cvt_pk_bf16_f32 v38, v38, v38
    v_lshlrev_b32 v38, 16, v38
    v_sqrt_f32 v38, v38
    s_nop 0
    v_cvt_pk_bf16_f32 v38, v38, v38
    v_lshlrev_b32 v38, 16, v38
    v_rcp_f32 v38, v38
    s_nop 0
    v_mul_f32 v18, v107, v38
    v_mul_f32 v56, v56, v38
    v_pk_fma_f32 v[20:21], v[20:21], v[18:19], v[56:57] op_sel_hi:[1,0,0]
    v_pk_fma_f32 v[22:23], v[22:23], v[18:19], v[56:57] op_sel_hi:[1,0,0]
    v_pk_fma_f32 v[24:25], v[24:25], v[18:19], v[56:57] op_sel_hi:[1,0,0]
    v_pk_fma_f32 v[26:27], v[26:27], v[18:19], v[56:57] op_sel_hi:[1,0,0]
    v_pk_fma_f32 v[28:29], v[28:29], v[18:19], v[56:57] op_sel_hi:[1,0,0]
    v_pk_fma_f32 v[30:31], v[30:31], v[18:19], v[56:57] op_sel_hi:[1,0,0]
    v_pk_fma_f32 v[32:33], v[32:33], v[18:19], v[56:57] op_sel_hi:[1,0,0]
    v_pk_fma_f32 v[34:35], v[34:35], v[18:19], v[56:57] op_sel_hi:[1,0,0]
    v_pk_fma_f32 v[36:37], v[36:37], v[18:19], v[56:57] op_sel_hi:[1,0,0]
    v_cvt_pk_bf16_f32 v8, v20, v21
    v_cvt_pk_bf16_f32 v9, v22, v23
    v_cvt_pk_bf16_f32 v10, v24, v25
    v_cvt_pk_bf16_f32 v11, v26, v27
    v_cvt_pk_bf16_f32 v12, v28, v29
    v_cvt_pk_bf16_f32 v13, v30, v31
    v_cvt_pk_bf16_f32 v14, v32, v33
    v_cvt_pk_bf16_f32 v15, v34, v35
    v_cvt_pk_bf16_f32 v16, v36, v37
    ds_write_b32 v48, v8 offset:0
    ds_write_b32 v48, v9 offset:4
    ds_write_b32 v48, v10 offset:8
    ds_write_b32 v48, v11 offset:384
    ds_write_b32 v48, v12 offset:388
    ds_write_b32 v48, v13 offset:392
    ds_write_b32 v48, v14 offset:768
    ds_write_b32 v48, v15 offset:772
    ds_write_b32 v48, v16 offset:776
    buffer_store_dwordx2 v[106:107], v49, s[44:47], s5 offen sc1
    s_waitcnt lgkmcnt(0)
    s_barrier
    ds_read_b64_tr_b16 v[20:21], v50 offset:0
    ds_read_b64_tr_b16 v[22:23], v50 offset:4864
    ds_read_b64_tr_b16 v[24:25], v50 offset:512
    ds_read_b64_tr_b16 v[26:27], v50 offset:5376
    ds_read_b64_tr_b16 v[28:29], v50 offset:1024
    ds_read_b64_tr_b16 v[30:31], v50 offset:5888
    s_waitcnt lgkmcnt(4)
    buffer_store_dwordx4 v[20:23], v52, s[44:47], s15 offen sc1
    s_waitcnt lgkmcnt(2)
    buffer_store_dwordx4 v[24:27], v52, s[44:47], s7 offen sc1
    s_waitcnt lgkmcnt(0)
    buffer_store_dwordx4 v[28:31], v52, s[44:47], s8 offen sc1
    buffer_load_dword v45, v54, s[64:67], 0 offen sc1
    s_waitcnt vmcnt(5)
    s_barrier
    ds_read_b64_tr_b16 v[60:61], v51 offset:0
    ds_read_b64_tr_b16 v[62:63], v51 offset:4608
    ds_read_b64_tr_b16 v[64:65], v51 offset:9216
    ds_read_b64_tr_b16 v[66:67], v51 offset:12672
    ds_read_b64_tr_b16 v[68:69], v51 offset:17280
    ds_read_b64_tr_b16 v[70:71], v51 offset:512
    ds_read_b64_tr_b16 v[72:73], v51 offset:5120
    ds_read_b64_tr_b16 v[74:75], v51 offset:9728
    ds_read_b64_tr_b16 v[76:77], v51 offset:13184
    ds_read_b64_tr_b16 v[78:79], v51 offset:17792
    v_alignbit_b32 v114, v99, v99, 16
    v_alignbit_b32 v115, v98, v98, 16
    s_waitcnt lgkmcnt(5)
    v_alignbit_b32 v108, v61, v60, 16
    v_alignbit_b32 v109, v62, v61, 16
    v_alignbit_b32 v110, v63, v62, 16
    v_alignbit_b32 v111, v64, v63, 16
    v_alignbit_b32 v112, v65, v64, 16
    v_dot2_f32_bf16 v116, v60, v114, 0
    ds_read_b64_tr_b16 v[80:81], v51 offset:1024
    v_dot2_f32_bf16 v117, v108, v114, 0
    v_dot2_f32_bf16 v118, v61, v114, 0
    v_dot2_f32_bf16 v119, v109, v114, 0
    v_dot2_f32_bf16 v120, v62, v114, 0
    ds_read_b64_tr_b16 v[82:83], v51 offset:5632
    v_dot2_f32_bf16 v121, v110, v114, 0
    v_dot2_f32_bf16 v122, v63, v114, 0
    v_dot2_f32_bf16 v123, v111, v114, 0
    v_dot2_f32_bf16 v116, v61, v115, v116
    v_dot2_f32_bf16 v117, v109, v115, v117
    ds_read_b64_tr_b16 v[84:85], v51 offset:10240
    v_dot2_f32_bf16 v118, v62, v115, v118
    v_dot2_f32_bf16 v119, v110, v115, v119
    v_dot2_f32_bf16 v120, v63, v115, v120
    v_dot2_f32_bf16 v121, v111, v115, v121
    v_dot2_f32_bf16 v122, v64, v115, v122
    ds_read_b64_tr_b16 v[86:87], v51 offset:13696
    v_dot2_f32_bf16 v123, v112, v115, v123
    v_and_b32 v133, 0xffff0000, v66
    v_lshlrev_b32 v132, 16, v66
    v_and_b32 v135, 0xffff0000, v67
    v_lshlrev_b32 v134, 16, v67
    ds_read_b64_tr_b16 v[88:89], v51 offset:18304
    v_and_b32 v137, 0xffff0000, v68
    v_lshlrev_b32 v136, 16, v68
    v_and_b32 v139, 0xffff0000, v69
    v_lshlrev_b32 v138, 16, v69
    v_pk_mul_f32 v[116:117], v[116:117], v[132:133]
    v_pk_mul_f32 v[118:119], v[118:119], v[134:135]
    v_pk_mul_f32 v[120:121], v[120:121], v[136:137]
    v_pk_mul_f32 v[122:123], v[122:123], v[138:139]
    v_cvt_pk_bf16_f32 v160, v123, v122
    v_cvt_pk_bf16_f32 v161, v121, v120
    v_cvt_pk_bf16_f32 v162, v119, v118
    v_cvt_pk_bf16_f32 v163, v117, v116
    buffer_store_dwordx4 v[160:163], v53, s[44:47], s15 offen sc1
    v_alignbit_b32 v114, v101, v101, 16
    v_alignbit_b32 v115, v100, v100, 16
    s_waitcnt lgkmcnt(5)
    v_alignbit_b32 v108, v71, v70, 16
    v_alignbit_b32 v109, v72, v71, 16
    v_alignbit_b32 v110, v73, v72, 16
    v_alignbit_b32 v111, v74, v73, 16
    v_alignbit_b32 v112, v75, v74, 16
    v_dot2_f32_bf16 v124, v70, v114, 0
    v_dot2_f32_bf16 v125, v108, v114, 0
    v_dot2_f32_bf16 v126, v71, v114, 0
    v_dot2_f32_bf16 v127, v109, v114, 0
    v_dot2_f32_bf16 v128, v72, v114, 0
    v_dot2_f32_bf16 v129, v110, v114, 0
    v_dot2_f32_bf16 v130, v73, v114, 0
    v_dot2_f32_bf16 v131, v111, v114, 0
    v_dot2_f32_bf16 v124, v71, v115, v124
    v_dot2_f32_bf16 v125, v109, v115, v125
    v_dot2_f32_bf16 v126, v72, v115, v126
    v_dot2_f32_bf16 v127, v110, v115, v127
    v_dot2_f32_bf16 v128, v73, v115, v128
    v_dot2_f32_bf16 v129, v111, v115, v129
    v_dot2_f32_bf16 v130, v74, v115, v130
    v_dot2_f32_bf16 v131, v112, v115, v131
    v_and_b32 v133, 0xffff0000, v76
    v_lshlrev_b32 v132, 16, v76
    v_and_b32 v135, 0xffff0000, v77
    v_lshlrev_b32 v134, 16, v77
    v_and_b32 v137, 0xffff0000, v78
    v_lshlrev_b32 v136, 16, v78
    v_and_b32 v139, 0xffff0000, v79
    v_lshlrev_b32 v138, 16, v79
    v_pk_mul_f32 v[124:125], v[124:125], v[132:133]
    v_pk_mul_f32 v[126:127], v[126:127], v[134:135]
    v_pk_mul_f32 v[128:129], v[128:129], v[136:137]
    v_pk_mul_f32 v[130:131], v[130:131], v[138:139]
    v_cvt_pk_bf16_f32 v164, v131, v130
    v_cvt_pk_bf16_f32 v165, v129, v128
    v_cvt_pk_bf16_f32 v166, v127, v126
    v_cvt_pk_bf16_f32 v167, v125, v124
    buffer_store_dwordx4 v[164:167], v53, s[44:47], s7 offen sc1
    v_alignbit_b32 v114, v103, v103, 16
    v_alignbit_b32 v115, v102, v102, 16
    s_waitcnt lgkmcnt(0)
    v_alignbit_b32 v108, v81, v80, 16
    v_alignbit_b32 v109, v82, v81, 16
    v_alignbit_b32 v110, v83, v82, 16
    v_alignbit_b32 v111, v84, v83, 16
    v_alignbit_b32 v112, v85, v84, 16
    v_dot2_f32_bf16 v116, v80, v114, 0
    v_dot2_f32_bf16 v117, v108, v114, 0
    v_dot2_f32_bf16 v118, v81, v114, 0
    v_dot2_f32_bf16 v119, v109, v114, 0
    v_dot2_f32_bf16 v120, v82, v114, 0
    v_dot2_f32_bf16 v121, v110, v114, 0
    v_dot2_f32_bf16 v122, v83, v114, 0
    v_dot2_f32_bf16 v123, v111, v114, 0
    v_dot2_f32_bf16 v116, v81, v115, v116
    v_dot2_f32_bf16 v117, v109, v115, v117
    v_dot2_f32_bf16 v118, v82, v115, v118
    v_dot2_f32_bf16 v119, v110, v115, v119
    v_dot2_f32_bf16 v120, v83, v115, v120
    v_dot2_f32_bf16 v121, v111, v115, v121
    v_dot2_f32_bf16 v122, v84, v115, v122
    v_dot2_f32_bf16 v123, v112, v115, v123
    v_and_b32 v133, 0xffff0000, v86
    v_lshlrev_b32 v132, 16, v86
    v_and_b32 v135, 0xffff0000, v87
    v_lshlrev_b32 v134, 16, v87
    v_and_b32 v137, 0xffff0000, v88
    v_lshlrev_b32 v136, 16, v88
    v_and_b32 v139, 0xffff0000, v89
    v_lshlrev_b32 v138, 16, v89
    v_pk_mul_f32 v[116:117], v[116:117], v[132:133]
    v_pk_mul_f32 v[118:119], v[118:119], v[134:135]
    v_pk_mul_f32 v[120:121], v[120:121], v[136:137]
    v_pk_mul_f32 v[122:123], v[122:123], v[138:139]
    v_cvt_pk_bf16_f32 v168, v123, v122
    v_cvt_pk_bf16_f32 v169, v121, v120
    v_cvt_pk_bf16_f32 v170, v119, v118
    v_cvt_pk_bf16_f32 v171, v117, v116
    buffer_store_dwordx4 v[168:171], v53, s[44:47], s8 offen sc1
    s_add_u32 m0, s74, 32
    s_add_u32 s13, s12, 0
    buffer_load_dwordx4 v240, s[48:51], s13 offen offset:0 lds
    buffer_load_dwordx4 v240, s[48:51], s13 offen offset:1024 lds
    buffer_load_dwordx4 v240, s[48:51], s13 offen offset:2048 lds
    buffer_load_dwordx4 v240, s[48:51], s13 offen offset:3072 lds
    s_mov_b64 exec, 0
    s_call_b64 s[82:83], L_wc_X
    s_mov_b64 exec, -1
    s_waitcnt vmcnt(7)
    v_readfirstlane_b32 s68, v45
    s_nop 1
    s_cmp_eq_u32 s68, 0
    s_cbranch_scc1 L_nw_X
L_ng_X:
    s_barrier
    v_mov_b32 v3, s68
    buffer_store_dword v3, v1, s[44:47], 0 offen sc1
    s_waitcnt vmcnt(5)
    s_barrier
    buffer_store_dword v3, v46, s[44:47], 0 offen sc1
L_segX:
L_pl_X_0:
    s_cbranch_execz L_pl_X_4
    s_cmp_lt_u32 s75, 252
    s_cbranch_scc0 L_idle
    s_mov_b32 s56, s26
    s_and_b32 s57, s27, 0xffff
    s_mov_b32 s58, 1152
    s_mov_b32 s59, 0x20000
    v_mov_b32 v9, 0
    buffer_load_ushort v9, v9, s[56:59], s70 offen
    s_lshr_b32 s4, s2, 1
    s_and_b32 s4, s4, 3
    s_lshl2_add_u32 s4, s4, s3
    s_lshl_b32 s4, s4, 8
    s_add_u32 s4, s4, 12599296
    v_lshl_add_u32 v28, v2, 2, s4
    v_add_u32 v241, s74, v240
    v_cmp_eq_u32 vcc, 0, v2
    v_mov_b32 v196, 4136
    s_nop 0
    v_cndmask_b32 v196, v196, 30, vcc
    v_add_u32 v242, s74, v196
    v_bfe_u32 v196, v2, 3, 2
    v_mul_u32_u24 v196, 4160, v196
    v_and_b32 v197, 7, v2
    v_lshl_add_u32 v196, v197, 2, v196
    v_add_u32 v200, s74, v196
    v_mov_b32 v196, 0
    v_mov_b32 v197, 0
    v_mov_b32 v198, 0
    v_mov_b32 v199, 0
    ds_write_b32 v200, v196
    v_lshlrev_b32 v201, 4, v0
    ds_write_b128 v201, v[196:199]
    ds_write_b128 v201, v[196:199] offset:36864
    s_waitcnt vmcnt(3)
    ds_read_b128 v[212:215], v241 offset:32
    ds_read_b32 v216, v241 offset:48
    ds_read_b128 v[218:221], v241 offset:1056
    ds_read_b32 v222, v241 offset:1072
    ds_read_b128 v[224:227], v241 offset:2080
    ds_read_b32 v228, v241 offset:2096
    ds_read_b128 v[230:233], v241 offset:3104
    ds_read_b32 v234, v241 offset:3120
    v_lshrrev_b32 v202, 3, v2
    v_and_b32 v203, 7, v2
    v_lshrrev_b32 v204, 1, v202
    v_xor_b32 v203, v203, v204
    v_mul_u32_u24 v202, 9216, v202
    v_lshl_add_u32 v15, v203, 4, v202
    v_xor_b32 v16, 64, v15
    v_and_b32 v202, 15, v2
    v_add_u32 v202, 1, v202
    v_and_b32 v203, 1, v202
    v_mul_u32_u24 v203, 4160, v203
    v_lshrrev_b32 v202, 1, v202
    v_lshl_add_u32 v203, v202, 2, v203
    v_lshrrev_b32 v204, 4, v2
    v_lshl_add_u32 v203, v204, 4, v203
    v_add_u32 v236, s74, v203
    v_add_u32 v237, 1024, v236
    v_add_u32 v238, 1024, v237
    v_add_u32 v239, 1024, v238
    s_waitcnt lgkmcnt(0)
    s_waitcnt vmcnt(0)
    v_lshlrev_b32 v9, 16, v9
    v_lshlrev_b32 v208, 16, v212
    v_add_f32 v9, v9, v208
    v_cvt_pk_bf16_f32 v9, v9, v9
    ds_write_b16 v242, v9 offset:4160
    ds_write_b16 v242, v9 offset:2
    v_alignbit_b32 v212, v213, v212, 16
    v_alignbit_b32 v213, v214, v213, 16
    v_alignbit_b32 v214, v215, v214, 16
    v_alignbit_b32 v215, v216, v215, 16
    ds_write_b128 v241, v[212:215] offset:4192
    v_alignbit_b32 v218, v219, v218, 16
    v_alignbit_b32 v219, v220, v219, 16
    v_alignbit_b32 v220, v221, v220, 16
    v_alignbit_b32 v221, v222, v221, 16
    ds_write_b128 v241, v[218:221] offset:5216
    v_alignbit_b32 v224, v225, v224, 16
    v_alignbit_b32 v225, v226, v225, 16
    v_alignbit_b32 v226, v227, v226, 16
    v_alignbit_b32 v227, v228, v227, 16
    ds_write_b128 v241, v[224:227] offset:6240
    v_alignbit_b32 v230, v231, v230, 16
    v_alignbit_b32 v231, v232, v231, 16
    v_alignbit_b32 v232, v233, v232, 16
    v_alignbit_b32 v233, v234, v233, 16
    ds_write_b128 v241, v[230:233] offset:7264
    v_and_b32 v202, 15, v2
    v_lshlrev_b32 v202, 1, v202
    v_sub_u32 v202, v202, v204
    v_add_u32 v202, 17, v202
    v_bfe_u32 v203, v202, 1, 3
    v_xor_b32 v203, s3, v203
    v_lshlrev_b32 v203, 4, v203
    v_lshl_add_u32 v244, v202, 7, v203
    v_and_b32 v202, 15, v2
    v_lshlrev_b32 v202, 1, v202
    v_sub_u32 v202, v202, v204
    v_add_u32 v202, 13, v202
    v_bfe_u32 v203, v202, 1, 3
    v_xor_b32 v203, s3, v203
    v_lshlrev_b32 v203, 4, v203
    v_lshl_add_u32 v245, v202, 7, v203
    v_and_b32 v202, 15, v2
    v_lshlrev_b32 v202, 1, v202
    v_sub_u32 v202, v202, v204
    v_add_u32 v202, 9, v202
    v_bfe_u32 v203, v202, 1, 3
    v_xor_b32 v203, s3, v203
    v_lshlrev_b32 v203, 4, v203
    v_lshl_add_u32 v246, v202, 7, v203
    v_and_b32 v202, 15, v2
    v_lshlrev_b32 v202, 1, v202
    v_sub_u32 v202, v202, v204
    v_add_u32 v202, 5, v202
    v_bfe_u32 v203, v202, 1, 3
    v_xor_b32 v203, s3, v203
    v_lshlrev_b32 v203, 4, v203
    v_lshl_add_u32 v247, v202, 7, v203
    v_and_b32 v202, 15, v2
    v_lshlrev_b32 v202, 5, v202
    v_lshl_add_u32 v8, v204, 3, v202
    s_mul_i32 s7, s3, 589824
    s_lshl_b32 s8, s69, 8
    s_add_u32 s7, s7, s8
    s_add_u32 s10, s7, 2359296
    s_lshl_b32 s9, s3, 13
    s_add_u32 s9, s9, 4096
    ds_read2_b32 v[64:65], v236 offset0:0 offset1:1
    ds_read2_b32 v[66:67], v236 offset0:2 offset1:3
    ds_read2_b32 v[68:69], v236 offset0:128 offset1:129
    ds_read2_b32 v[70:71], v236 offset0:130 offset1:131
    ds_read2_b32 v[72:73], v237 offset0:0 offset1:1
    ds_read2_b32 v[74:75], v237 offset0:2 offset1:3
    ds_read2_b32 v[76:77], v237 offset0:128 offset1:129
    ds_read2_b32 v[78:79], v237 offset0:130 offset1:131
    ds_read2_b32 v[80:81], v238 offset0:0 offset1:1
    ds_read2_b32 v[82:83], v238 offset0:2 offset1:3
    ds_read2_b32 v[84:85], v238 offset0:128 offset1:129
    ds_read2_b32 v[86:87], v238 offset0:130 offset1:131
    ds_read2_b32 v[88:89], v239 offset0:0 offset1:1
    ds_read2_b32 v[90:91], v239 offset0:2 offset1:3
    ds_read2_b32 v[92:93], v239 offset0:128 offset1:129
    ds_read2_b32 v[94:95], v239 offset0:130 offset1:131
    v_mov_b32 v29, 0
    buffer_atomic_add v29, v28, s[44:47], 0 offen sc0 sc1
    s_waitcnt vmcnt(0)
    v_cmp_ne_u32 vcc, s68, v29
    s_cbranch_vccnz L_rs_p1X
L_ok_p1X:
    s_add_u32 m0, s9, 0
    s_add_u32 s13, s10, 0
    buffer_load_dwordx4 v15, s[44:47], s13 offen sc1 lds
    s_add_u32 m0, s9, 1024
    s_add_u32 s13, s10, 73728
    buffer_load_dwordx4 v16, s[44:47], s13 offen sc1 lds
    s_add_u32 m0, s9, 2048
    s_add_u32 s13, s10, 147456
    buffer_load_dwordx4 v15, s[44:47], s13 offen sc1 lds
    s_add_u32 m0, s9, 3072
    s_add_u32 s13, s10, 221184
    buffer_load_dwordx4 v16, s[44:47], s13 offen sc1 lds
    s_add_u32 m0, s9, 4096
    s_add_u32 s13, s10, 294912
    buffer_load_dwordx4 v15, s[44:47], s13 offen sc1 lds
    s_add_u32 m0, s9, 5120
    s_add_u32 s13, s10, 368640
    buffer_load_dwordx4 v16, s[44:47], s13 offen sc1 lds
    s_add_u32 m0, s9, 6144
    s_add_u32 s13, s10, 442368
    buffer_load_dwordx4 v15, s[44:47], s13 offen sc1 lds
    s_add_u32 m0, s9, 7168
    s_add_u32 s13, s10, 516096
    buffer_load_dwordx4 v16, s[44:47], s13 offen sc1 lds
    s_mov_b64 exec, 0
    s_call_b64 s[82:83], L_wc_D
    s_mov_b64 exec, -1
    s_mov_b32 s60, s36
    s_and_b32 s61, s37, 0xffff
    s_mov_b32 s62, 4096
    s_mov_b32 s63, 0x20000
    v_and_b32 v24, 15, v2
    s_lshl_b32 s7, s71, 6
    v_add_u32 v24, s7, v24
    s_and_b32 s8, s3, 1
    s_lshl_b32 s4, s8, 5
    v_add_u32 v25, s4, v24
    v_lshlrev_b32 v26, 3, v25
    v_mul_u32_u24 v25, 1152, v25
    v_bfe_u32 v31, v2, 4, 1
    v_lshl_add_u32 v25, v31, 5, v25
    v_lshrrev_b32 v31, 5, v2
    v_lshl_add_u32 v25, v31, 4, v25
    s_bfe_u32 s7, s2, 0x20003
    s_mul_i32 s7, s7, 288
    s_lshl_b32 s4, s72, 6
    s_add_u32 s4, s4, s7
    v_add_u32 v252, s4, v25
    s_xor_b32 s8, s3, s72
    s_and_b32 s4, s72, 1
    s_lshl1_add_u32 s4, s4, s8
    v_lshl_add_u32 v24, s4, 4, v24
    s_add_u32 s7, s7, 256
    s_cmp_lt_u32 s8, 2
    s_cselect_b32 s7, s7, 0x40000000
    v_lshlrev_b32 v18, 3, v24
    v_mul_u32_u24 v24, 1152, v24
    v_lshrrev_b32 v31, 4, v2
    v_lshl_add_u32 v24, v31, 3, v24
    v_add_u32 v253, s7, v24
    v_lshrrev_b32 v24, 3, v2
    v_and_b32 v25, 7, v2
    v_bfe_u32 v31, v2, 4, 2
    v_lshlrev_b32 v31, 1, v31
    v_xor_b32 v25, v25, v31
    v_lshlrev_b32 v24, 12, v24
    v_lshl_add_u32 v24, v25, 4, v24
    s_mul_i32 s7, s72, 36
    s_bitcmp1_b32 s3, 0
L_pl_X_1:
    s_cbranch_execz L_pl_X_5
    s_addc_u32 s7, s7, 0
    s_lshl_b32 s7, s7, 17
    s_lshl_b32 s8, s71, 7
    s_add_u32 s7, s7, s8
    v_add_u32 v4, s7, v24
    v_add_u32 v5, 31744, v4
    v_add_u32 v6, 31744, v5
    v_add_u32 v7, 31744, v6
    v_lshrrev_b32 v24, 2, v2
    v_lshlrev_b32 v24, 7, v24
    v_and_b32 v25, 3, v2
    v_lshl_add_u32 v24, v25, 3, v24
    s_and_b32 s7, s73, 8192
    v_add_u32 v24, s7, v24
    v_bfe_u32 v31, v2, 3, 2
    s_and_b32 s7, s3, 1
    s_lshl_b32 s7, s7, 1
    v_xor_b32 v31, s7, v31
    v_lshl_add_u32 v10, v31, 5, v24
    v_xor_b32 v11, 32, v10
    v_and_b32 v24, 15, v2
    v_lshrrev_b32 v25, 4, v2
    v_mul_u32_u24 v25, 17408, v25
    v_lshl_add_u32 v24, v24, 4, v25
    s_mul_i32 s7, s72, 36
    s_and_b32 s8, s3, 1
    s_add_u32 s7, s7, s8
    s_mul_i32 s7, s7, 69632
    s_bfe_u32 s8, s2, 0x20003
    s_lshl_b32 s8, s8, 12
    s_add_u32 s7, s7, s8
    s_add_u32 s7, s7, 12795904
    v_add_u32 v23, s7, v24
    s_xor_b32 s7, s72, 0
    v_lshl_add_u32 v19, s7, 10, v23
    s_xor_b32 s7, s72, 1
    v_lshl_add_u32 v20, s7, 10, v23
    s_xor_b32 s7, s72, 2
    v_lshl_add_u32 v21, s7, 10, v23
    s_xor_b32 s7, s72, 3
    v_lshl_add_u32 v22, s7, 10, v23
    v_lshlrev_b32 v14, 4, v2
    v_add_u32 v14, 98304, v14
    v_add_u32 v1, 0x10000, v14
    s_bitcmp1_b32 s3, 1
    s_cselect_b32 s18, s85, s84
    s_mul_i32 s18, s18, 139264
    s_cselect_b32 s19, s87, s86
    s_mul_i32 s19, s19, 139264
    s_cselect_b32 s20, s89, s88
    s_mul_i32 s20, s20, 139264
    s_cselect_b32 s21, s91, s90
    s_mul_i32 s21, s21, 139264
    s_cselect_b32 s22, s93, s92
    s_mul_i32 s22, s22, 139264
    s_cselect_b32 s23, s95, s94
    s_mul_i32 s23, s23, 139264
    s_cselect_b32 s24, s97, s96
    s_mul_i32 s24, s24, 139264
    s_cselect_b32 s25, s99, s98
    s_mul_i32 s25, s25, 139264
    s_cselect_b32 s26, s101, s100
    s_mul_i32 s26, s26, 139264
    v_add_u32 v10, 131072, v10
    v_add_u32 v11, 131072, v11
    s_waitcnt vmcnt(0) lgkmcnt(0)
    s_barrier
    ds_read_b128 v[96:99], v244 offset:2048
    ds_read_b128 v[100:103], v244 offset:6144
    ds_read_b128 v[104:107], v244 offset:10240
    ds_read_b128 v[108:111], v244 offset:14336
    ds_read_b128 v[112:115], v244 offset:18432
    ds_read_b128 v[116:119], v244 offset:22528
    ds_read_b128 v[120:123], v244 offset:26624
    ds_read_b128 v[124:127], v244 offset:30720
    s_waitcnt lgkmcnt(0)
    v_mfma_f32_16x16x32_bf16 v[32:35], v[64:67], v[96:99], 0
    s_lshl_b32 s14, s84, 18
    ds_read_b128 v[160:163], v245 offset:2048
    v_mfma_f32_16x16x32_bf16 v[36:39], v[68:71], v[96:99], 0
    s_add_u32 m0, s73, 147456
    v_mfma_f32_16x16x32_bf16 v[36:39], v[64:67], v[100:103], v[36:39]
    buffer_load_dwordx4 v4, s[52:55], s14 offen offset:0 lds
    ds_read2_b32 v[128:129], v236 offset0:16 offset1:17
    v_mfma_f32_16x16x32_bf16 v[40:43], v[64:67], v[104:107], 0
    ds_read2_b32 v[130:131], v236 offset0:18 offset1:19
    v_mfma_f32_16x16x32_bf16 v[40:43], v[68:71], v[100:103], v[40:43]
    v_mfma_f32_16x16x32_bf16 v[40:43], v[72:75], v[96:99], v[40:43]
    ds_read_b128 v[164:167], v245 offset:6144
    v_mfma_f32_16x16x32_bf16 v[44:47], v[76:79], v[96:99], 0
    ds_read2_b32 v[132:133], v236 offset0:144 offset1:145
    v_mfma_f32_16x16x32_bf16 v[44:47], v[72:75], v[100:103], v[44:47]
    s_add_u32 s13, s12, 16384
    v_mfma_f32_16x16x32_bf16 v[44:47], v[68:71], v[104:107], v[44:47]
    ds_read2_b32 v[134:135], v236 offset0:146 offset1:147
    v_mfma_f32_16x16x32_bf16 v[44:47], v[64:67], v[108:111], v[44:47]
    s_add_u32 m0, s74, 8352
    ds_read_b128 v[168:171], v245 offset:10240
    v_mfma_f32_16x16x32_bf16 v[48:51], v[64:67], v[112:115], 0
    buffer_load_dwordx4 v240, s[48:51], s13 offen offset:0 lds
    ds_read2_b32 v[136:137], v237 offset0:16 offset1:17
    v_mfma_f32_16x16x32_bf16 v[48:51], v[68:71], v[108:111], v[48:51]
    v_mfma_f32_16x16x32_bf16 v[48:51], v[72:75], v[104:107], v[48:51]
    s_add_u32 m0, s73, 147456
    ds_read2_b32 v[138:139], v237 offset0:18 offset1:19
    v_mfma_f32_16x16x32_bf16 v[48:51], v[76:79], v[100:103], v[48:51]
    buffer_load_dwordx4 v5, s[52:55], s14 offen offset:1024 lds
    ds_read_b128 v[172:175], v245 offset:14336
    v_mfma_f32_16x16x32_bf16 v[48:51], v[80:83], v[96:99], v[48:51]
    v_mfma_f32_16x16x32_bf16 v[52:55], v[84:87], v[96:99], 0
    ds_read2_b32 v[140:141], v237 offset0:144 offset1:145
    v_mfma_f32_16x16x32_bf16 v[52:55], v[80:83], v[100:103], v[52:55]
    s_add_u32 m0, s74, 8352
    ds_read2_b32 v[142:143], v237 offset0:146 offset1:147
    v_mfma_f32_16x16x32_bf16 v[52:55], v[76:79], v[104:107], v[52:55]
    buffer_load_dwordx4 v240, s[48:51], s13 offen offset:1024 lds
    v_mfma_f32_16x16x32_bf16 v[52:55], v[72:75], v[108:111], v[52:55]
    ds_read_b128 v[176:179], v245 offset:18432
    v_mfma_f32_16x16x32_bf16 v[52:55], v[68:71], v[112:115], v[52:55]
    ds_read2_b32 v[144:145], v238 offset0:16 offset1:17
    v_mfma_f32_16x16x32_bf16 v[52:55], v[64:67], v[116:119], v[52:55]
    v_mfma_f32_16x16x32_bf16 v[56:59], v[64:67], v[120:123], 0
    ds_read2_b32 v[146:147], v238 offset0:18 offset1:19
    v_mfma_f32_16x16x32_bf16 v[56:59], v[68:71], v[116:119], v[56:59]
    ds_read_b128 v[180:183], v245 offset:22528
    v_mfma_f32_16x16x32_bf16 v[56:59], v[72:75], v[112:115], v[56:59]
    v_mfma_f32_16x16x32_bf16 v[56:59], v[76:79], v[108:111], v[56:59]
    s_add_u32 m0, s73, 147456
    ds_read2_b32 v[148:149], v238 offset0:144 offset1:145
    v_mfma_f32_16x16x32_bf16 v[56:59], v[80:83], v[104:107], v[56:59]
    buffer_load_dwordx4 v6, s[52:55], s14 offen offset:2048 lds
    ds_read2_b32 v[150:151], v238 offset0:146 offset1:147
    v_mfma_f32_16x16x32_bf16 v[56:59], v[84:87], v[100:103], v[56:59]
    s_add_u32 m0, s74, 8352
    ds_read_b128 v[184:187], v245 offset:26624
    v_mfma_f32_16x16x32_bf16 v[56:59], v[88:91], v[96:99], v[56:59]
    buffer_load_dwordx4 v240, s[48:51], s13 offen offset:2048 lds
    v_mfma_f32_16x16x32_bf16 v[60:63], v[92:95], v[96:99], 0
    ds_read2_b32 v[152:153], v239 offset0:16 offset1:17
    v_mfma_f32_16x16x32_bf16 v[60:63], v[88:91], v[100:103], v[60:63]
    ds_read2_b32 v[154:155], v239 offset0:18 offset1:19
    v_mfma_f32_16x16x32_bf16 v[60:63], v[84:87], v[104:107], v[60:63]
    v_mfma_f32_16x16x32_bf16 v[60:63], v[80:83], v[108:111], v[60:63]
    ds_read_b128 v[188:191], v245 offset:30720
    v_mfma_f32_16x16x32_bf16 v[60:63], v[76:79], v[112:115], v[60:63]
    s_add_u32 m0, s74, 8352
    ds_read2_b32 v[156:157], v239 offset0:144 offset1:145
    v_mfma_f32_16x16x32_bf16 v[60:63], v[72:75], v[116:119], v[60:63]
    buffer_load_dwordx4 v240, s[48:51], s13 offen offset:3072 lds
    v_mfma_f32_16x16x32_bf16 v[60:63], v[68:71], v[120:123], v[60:63]
    ds_read2_b32 v[158:159], v239 offset0:146 offset1:147
    v_mfma_f32_16x16x32_bf16 v[60:63], v[64:67], v[124:127], v[60:63]
    s_waitcnt lgkmcnt(12)
    v_mfma_f32_16x16x32_bf16 v[32:35], v[128:131], v[160:163], v[32:35]
    s_add_u32 m0, s73, 147456
    ds_read_b128 v[96:99], v246 offset:2048
    v_mfma_f32_16x16x32_bf16 v[36:39], v[132:135], v[160:163], v[36:39]
    buffer_load_dwordx4 v7, s[52:55], s14 offen offset:3072 lds
    v_mfma_f32_16x16x32_bf16 v[36:39], v[128:131], v[164:167], v[36:39]
    ds_read2_b32 v[64:65], v236 offset0:32 offset1:33
    v_mfma_f32_16x16x32_bf16 v[40:43], v[128:131], v[168:171], v[40:43]
    ds_read2_b32 v[66:67], v236 offset0:34 offset1:35
    v_mfma_f32_16x16x32_bf16 v[40:43], v[132:135], v[164:167], v[40:43]
    v_mfma_f32_16x16x32_bf16 v[40:43], v[136:139], v[160:163], v[40:43]
    ds_read_b128 v[100:103], v246 offset:6144
    v_mfma_f32_16x16x32_bf16 v[44:47], v[140:143], v[160:163], v[44:47]
    ds_read2_b32 v[68:69], v236 offset0:160 offset1:161
    v_mfma_f32_16x16x32_bf16 v[44:47], v[136:139], v[164:167], v[44:47]
    v_mfma_f32_16x16x32_bf16 v[44:47], v[132:135], v[168:171], v[44:47]
    ds_read2_b32 v[70:71], v236 offset0:162 offset1:163
    v_mfma_f32_16x16x32_bf16 v[44:47], v[128:131], v[172:175], v[44:47]
    ds_read_b128 v[104:107], v246 offset:10240
    s_waitcnt lgkmcnt(7)
    v_mfma_f32_16x16x32_bf16 v[48:51], v[128:131], v[176:179], v[48:51]
    ds_read2_b32 v[72:73], v237 offset0:32 offset1:33
    v_mfma_f32_16x16x32_bf16 v[48:51], v[132:135], v[172:175], v[48:51]
    ds_read2_b32 v[74:75], v237 offset0:34 offset1:35
    v_mfma_f32_16x16x32_bf16 v[48:51], v[136:139], v[168:171], v[48:51]
    v_mov_b32 v9, 8
    buffer_load_ushort v9, v9, s[56:59], s70 offen
    v_mfma_f32_16x16x32_bf16 v[48:51], v[140:143], v[164:167], v[48:51]
    ds_read_b128 v[108:111], v246 offset:14336
    v_mfma_f32_16x16x32_bf16 v[48:51], v[144:147], v[160:163], v[48:51]
    v_mfma_f32_16x16x32_bf16 v[52:55], v[148:151], v[160:163], v[52:55]
    ds_read2_b32 v[76:77], v237 offset0:160 offset1:161
    v_mfma_f32_16x16x32_bf16 v[52:55], v[144:147], v[164:167], v[52:55]
    ds_read2_b32 v[78:79], v237 offset0:162 offset1:163
    v_mfma_f32_16x16x32_bf16 v[52:55], v[140:143], v[168:171], v[52:55]
    v_mfma_f32_16x16x32_bf16 v[52:55], v[136:139], v[172:175], v[52:55]
    ds_read_b128 v[112:115], v246 offset:18432
    v_mfma_f32_16x16x32_bf16 v[52:55], v[132:135], v[176:179], v[52:55]
    ds_read2_b32 v[80:81], v238 offset0:32 offset1:33
    v_mfma_f32_16x16x32_bf16 v[52:55], v[128:131], v[180:183], v[52:55]
    v_mfma_f32_16x16x32_bf16 v[56:59], v[128:131], v[184:187], v[56:59]
    ds_read2_b32 v[82:83], v238 offset0:34 offset1:35
    v_mfma_f32_16x16x32_bf16 v[56:59], v[132:135], v[180:183], v[56:59]
    ds_read_b128 v[116:119], v246 offset:22528
    v_mfma_f32_16x16x32_bf16 v[56:59], v[136:139], v[176:179], v[56:59]
    v_mfma_f32_16x16x32_bf16 v[56:59], v[140:143], v[172:175], v[56:59]
    ds_read2_b32 v[84:85], v238 offset0:160 offset1:161
    v_mfma_f32_16x16x32_bf16 v[56:59], v[144:147], v[168:171], v[56:59]
    ds_read2_b32 v[86:87], v238 offset0:162 offset1:163
    v_mfma_f32_16x16x32_bf16 v[56:59], v[148:151], v[164:167], v[56:59]
    ds_read_b128 v[120:123], v246 offset:26624
    v_mfma_f32_16x16x32_bf16 v[56:59], v[152:155], v[160:163], v[56:59]
    v_mfma_f32_16x16x32_bf16 v[60:63], v[156:159], v[160:163], v[60:63]
    ds_read2_b32 v[88:89], v239 offset0:32 offset1:33
    v_mfma_f32_16x16x32_bf16 v[60:63], v[152:155], v[164:167], v[60:63]
    ds_read2_b32 v[90:91], v239 offset0:34 offset1:35
    v_mfma_f32_16x16x32_bf16 v[60:63], v[148:151], v[168:171], v[60:63]
    v_mfma_f32_16x16x32_bf16 v[60:63], v[144:147], v[172:175], v[60:63]
    ds_read_b128 v[124:127], v246 offset:30720
    v_mfma_f32_16x16x32_bf16 v[60:63], v[140:143], v[176:179], v[60:63]
    ds_read2_b32 v[92:93], v239 offset0:160 offset1:161
    v_mfma_f32_16x16x32_bf16 v[60:63], v[136:139], v[180:183], v[60:63]
    v_mfma_f32_16x16x32_bf16 v[60:63], v[132:135], v[184:187], v[60:63]
    ds_read2_b32 v[94:95], v239 offset0:162 offset1:163
    v_mfma_f32_16x16x32_bf16 v[60:63], v[128:131], v[188:191], v[60:63]
    s_waitcnt lgkmcnt(12)
    v_mfma_f32_16x16x32_bf16 v[32:35], v[64:67], v[96:99], v[32:35]
    s_lshl_b32 s14, s85, 18
    ds_read_b128 v[160:163], v247 offset:2048
    v_mfma_f32_16x16x32_bf16 v[36:39], v[68:71], v[96:99], v[36:39]
    s_add_u32 m0, s73, 49152
    v_mfma_f32_16x16x32_bf16 v[36:39], v[64:67], v[100:103], v[36:39]
    buffer_load_dwordx4 v4, s[52:55], s14 offen offset:0 lds
    ds_read2_b32 v[128:129], v236 offset0:48 offset1:49
    v_mfma_f32_16x16x32_bf16 v[40:43], v[64:67], v[104:107], v[40:43]
    ds_read2_b32 v[130:131], v236 offset0:50 offset1:51
    v_mfma_f32_16x16x32_bf16 v[40:43], v[68:71], v[100:103], v[40:43]
    v_mfma_f32_16x16x32_bf16 v[40:43], v[72:75], v[96:99], v[40:43]
    ds_read_b128 v[164:167], v247 offset:6144
    v_mfma_f32_16x16x32_bf16 v[44:47], v[76:79], v[96:99], v[44:47]
    ds_read2_b32 v[132:133], v236 offset0:176 offset1:177
    v_mfma_f32_16x16x32_bf16 v[44:47], v[72:75], v[100:103], v[44:47]
    v_mfma_f32_16x16x32_bf16 v[44:47], v[68:71], v[104:107], v[44:47]
    ds_read2_b32 v[134:135], v236 offset0:178 offset1:179
    v_mfma_f32_16x16x32_bf16 v[44:47], v[64:67], v[108:111], v[44:47]
    ds_read_b128 v[168:171], v247 offset:10240
    s_waitcnt lgkmcnt(7)
    v_mfma_f32_16x16x32_bf16 v[48:51], v[64:67], v[112:115], v[48:51]
    ds_read2_b32 v[136:137], v237 offset0:48 offset1:49
    v_mfma_f32_16x16x32_bf16 v[48:51], v[68:71], v[108:111], v[48:51]
    v_mfma_f32_16x16x32_bf16 v[48:51], v[72:75], v[104:107], v[48:51]
    s_add_u32 m0, s73, 49152
    ds_read2_b32 v[138:139], v237 offset0:50 offset1:51
    v_mfma_f32_16x16x32_bf16 v[48:51], v[76:79], v[100:103], v[48:51]
    buffer_load_dwordx4 v5, s[52:55], s14 offen offset:1024 lds
    ds_read_b128 v[172:175], v247 offset:14336
    v_mfma_f32_16x16x32_bf16 v[48:51], v[80:83], v[96:99], v[48:51]
    v_mfma_f32_16x16x32_bf16 v[52:55], v[84:87], v[96:99], v[52:55]
    ds_read2_b32 v[140:141], v237 offset0:176 offset1:177
    v_mfma_f32_16x16x32_bf16 v[52:55], v[80:83], v[100:103], v[52:55]
    ds_read2_b32 v[142:143], v237 offset0:178 offset1:179
    v_mfma_f32_16x16x32_bf16 v[52:55], v[76:79], v[104:107], v[52:55]
    v_mfma_f32_16x16x32_bf16 v[52:55], v[72:75], v[108:111], v[52:55]
    ds_read_b128 v[176:179], v247 offset:18432
    v_mfma_f32_16x16x32_bf16 v[52:55], v[68:71], v[112:115], v[52:55]
    ds_read2_b32 v[144:145], v238 offset0:48 offset1:49
    v_mfma_f32_16x16x32_bf16 v[52:55], v[64:67], v[116:119], v[52:55]
    v_mfma_f32_16x16x32_bf16 v[56:59], v[64:67], v[120:123], v[56:59]
    ds_read2_b32 v[146:147], v238 offset0:50 offset1:51
    v_mfma_f32_16x16x32_bf16 v[56:59], v[68:71], v[116:119], v[56:59]
    ds_read_b128 v[180:183], v247 offset:22528
    v_mfma_f32_16x16x32_bf16 v[56:59], v[72:75], v[112:115], v[56:59]
    v_mfma_f32_16x16x32_bf16 v[56:59], v[76:79], v[108:111], v[56:59]
    s_add_u32 m0, s73, 49152
    ds_read2_b32 v[148:149], v238 offset0:176 offset1:177
    v_mfma_f32_16x16x32_bf16 v[56:59], v[80:83], v[104:107], v[56:59]
    buffer_load_dwordx4 v6, s[52:55], s14 offen offset:2048 lds
    ds_read2_b32 v[150:151], v238 offset0:178 offset1:179
    v_mfma_f32_16x16x32_bf16 v[56:59], v[84:87], v[100:103], v[56:59]
    ds_read_b128 v[184:187], v247 offset:26624
    v_mfma_f32_16x16x32_bf16 v[56:59], v[88:91], v[96:99], v[56:59]
    v_mfma_f32_16x16x32_bf16 v[60:63], v[92:95], v[96:99], v[60:63]
    ds_read2_b32 v[152:153], v239 offset0:48 offset1:49
    v_mfma_f32_16x16x32_bf16 v[60:63], v[88:91], v[100:103], v[60:63]
    ds_read2_b32 v[154:155], v239 offset0:50 offset1:51
    v_mfma_f32_16x16x32_bf16 v[60:63], v[84:87], v[104:107], v[60:63]
    v_mfma_f32_16x16x32_bf16 v[60:63], v[80:83], v[108:111], v[60:63]
    ds_read_b128 v[188:191], v247 offset:30720
    v_mfma_f32_16x16x32_bf16 v[60:63], v[76:79], v[112:115], v[60:63]
    ds_read2_b32 v[156:157], v239 offset0:176 offset1:177
    v_mfma_f32_16x16x32_bf16 v[60:63], v[72:75], v[116:119], v[60:63]
    v_mfma_f32_16x16x32_bf16 v[60:63], v[68:71], v[120:123], v[60:63]
    ds_read2_b32 v[158:159], v239 offset0:178 offset1:179
    v_mfma_f32_16x16x32_bf16 v[60:63], v[64:67], v[124:127], v[60:63]
    s_waitcnt lgkmcnt(12)
    v_mfma_f32_16x16x32_bf16 v[32:35], v[128:131], v[160:163], v[32:35]
    s_add_u32 m0, s73, 49152
    ds_read_b128 v[96:99], v244 offset:0
    v_mfma_f32_16x16x32_bf16 v[36:39], v[132:135], v[160:163], v[36:39]
    buffer_load_dwordx4 v7, s[52:55], s14 offen offset:3072 lds
    v_mfma_f32_16x16x32_bf16 v[36:39], v[128:131], v[164:167], v[36:39]
    ds_read2_b32 v[64:65], v236 offset0:64 offset1:65
    v_mfma_f32_16x16x32_bf16 v[40:43], v[128:131], v[168:171], v[40:43]
    ds_read2_b32 v[66:67], v236 offset0:66 offset1:67
    v_mfma_f32_16x16x32_bf16 v[40:43], v[132:135], v[164:167], v[40:43]
    v_mfma_f32_16x16x32_bf16 v[40:43], v[136:139], v[160:163], v[40:43]
    ds_read_b128 v[100:103], v244 offset:4096
    v_mfma_f32_16x16x32_bf16 v[44:47], v[140:143], v[160:163], v[44:47]
    ds_read2_b32 v[68:69], v236 offset0:192 offset1:193
    v_mfma_f32_16x16x32_bf16 v[44:47], v[136:139], v[164:167], v[44:47]
    v_mfma_f32_16x16x32_bf16 v[44:47], v[132:135], v[168:171], v[44:47]
    ds_read2_b32 v[70:71], v236 offset0:194 offset1:195
    v_mfma_f32_16x16x32_bf16 v[44:47], v[128:131], v[172:175], v[44:47]
    ds_read_b128 v[104:107], v244 offset:8192
    s_waitcnt lgkmcnt(7)
    v_mfma_f32_16x16x32_bf16 v[48:51], v[128:131], v[176:179], v[48:51]
    ds_read2_b32 v[72:73], v237 offset0:64 offset1:65
    v_mfma_f32_16x16x32_bf16 v[48:51], v[132:135], v[172:175], v[48:51]
    ds_read2_b32 v[74:75], v237 offset0:66 offset1:67
    v_mfma_f32_16x16x32_bf16 v[48:51], v[136:139], v[168:171], v[48:51]
    ds_read_b128 v[108:111], v244 offset:12288
    v_mfma_f32_16x16x32_bf16 v[48:51], v[140:143], v[164:167], v[48:51]
    ds_read2_b32 v[76:77], v237 offset0:192 offset1:193
    v_mfma_f32_16x16x32_bf16 v[48:51], v[144:147], v[160:163], v[48:51]
    ds_read2_b32 v[78:79], v237 offset0:194 offset1:195
    v_mfma_f32_16x16x32_bf16 v[52:55], v[148:151], v[160:163], v[52:55]
    ds_read_b128 v[112:115], v244 offset:16384
    v_mfma_f32_16x16x32_bf16 v[52:55], v[144:147], v[164:167], v[52:55]
    ds_read2_b32 v[80:81], v238 offset0:64 offset1:65
    v_mfma_f32_16x16x32_bf16 v[52:55], v[140:143], v[168:171], v[52:55]
    ds_read2_b32 v[82:83], v238 offset0:66 offset1:67
    v_mfma_f32_16x16x32_bf16 v[52:55], v[136:139], v[172:175], v[52:55]
    ds_read_b128 v[116:119], v244 offset:20480
    v_mfma_f32_16x16x32_bf16 v[52:55], v[132:135], v[176:179], v[52:55]
    ds_read2_b32 v[84:85], v238 offset0:192 offset1:193
    v_mfma_f32_16x16x32_bf16 v[52:55], v[128:131], v[180:183], v[52:55]
    ds_read2_b32 v[86:87], v238 offset0:194 offset1:195
    v_mfma_f32_16x16x32_bf16 v[56:59], v[128:131], v[184:187], v[56:59]
    ds_read_b128 v[120:123], v244 offset:24576
    s_waitcnt vmcnt(5)
    s_barrier
    v_mfma_f32_16x16x32_bf16 v[56:59], v[132:135], v[180:183], v[56:59]
    ds_read2_b32 v[88:89], v239 offset0:64 offset1:65
    v_mfma_f32_16x16x32_bf16 v[56:59], v[136:139], v[176:179], v[56:59]
    ds_read_b64_tr_b16 a[0:1], v10 offset:16384
    v_mfma_f32_16x16x32_bf16 v[56:59], v[140:143], v[172:175], v[56:59]
    ds_read_b64_tr_b16 a[2:3], v10 offset:18432
    v_mfma_f32_16x16x32_bf16 v[56:59], v[144:147], v[168:171], v[56:59]
    ds_read_b64_tr_b16 a[8:9], v10 offset:20480
    v_mfma_f32_16x16x32_bf16 v[56:59], v[148:151], v[164:167], v[56:59]
    ds_read2_b32 v[90:91], v239 offset0:66 offset1:67
    v_mfma_f32_16x16x32_bf16 v[56:59], v[152:155], v[160:163], v[56:59]
    ds_read_b64_tr_b16 a[10:11], v10 offset:22528
    v_mfma_f32_16x16x32_bf16 v[60:63], v[156:159], v[160:163], v[60:63]
    ds_read_b64_tr_b16 a[4:5], v11 offset:16384
    v_mfma_f32_16x16x32_bf16 v[60:63], v[152:155], v[164:167], v[60:63]
    ds_read_b128 v[124:127], v244 offset:28672
    v_mfma_f32_16x16x32_bf16 v[60:63], v[148:151], v[168:171], v[60:63]
    ds_read_b64_tr_b16 a[6:7], v11 offset:18432
    v_mfma_f32_16x16x32_bf16 v[60:63], v[144:147], v[172:175], v[60:63]
    ds_read_b64_tr_b16 a[12:13], v11 offset:20480
    v_mfma_f32_16x16x32_bf16 v[60:63], v[140:143], v[176:179], v[60:63]
    ds_read2_b32 v[92:93], v239 offset0:192 offset1:193
    v_mfma_f32_16x16x32_bf16 v[60:63], v[136:139], v[180:183], v[60:63]
    ds_read_b64_tr_b16 a[14:15], v11 offset:22528
    v_mfma_f32_16x16x32_bf16 v[60:63], v[132:135], v[184:187], v[60:63]
    ds_read2_b32 v[94:95], v239 offset0:194 offset1:195
    v_mfma_f32_16x16x32_bf16 v[60:63], v[128:131], v[188:191], v[60:63]
    s_waitcnt lgkmcnt(15)
    v_mfma_f32_16x16x32_bf16 v[32:35], v[64:67], v[96:99], v[32:35]
    ds_read_b128 v[160:163], v245 offset:0
    s_waitcnt lgkmcnt(2)
    s_barrier
    v_mfma_f32_16x16x32_bf16 v[36:39], v[68:71], v[96:99], v[36:39]
    v_mfma_f32_16x16x32_bf16 v[36:39], v[64:67], v[100:103], v[36:39]
    ds_read2_b32 v[128:129], v236 offset0:80 offset1:81
    v_mfma_f32_16x16x32_bf16 v[40:43], v[64:67], v[104:107], v[40:43]
    s_lshl_b32 s14, s86, 18
    ds_read2_b32 v[130:131], v236 offset0:82 offset1:83
    v_mfma_f32_16x16x32_bf16 v[40:43], v[68:71], v[100:103], v[40:43]
    s_add_u32 m0, s73, 147456
    v_mfma_f32_16x16x32_bf16 v[40:43], v[72:75], v[96:99], v[40:43]
    buffer_load_dwordx4 v4, s[52:55], s14 offen offset:0 lds
    ds_read_b128 v[164:167], v245 offset:4096
    v_mfma_f32_16x16x32_bf16 v[44:47], v[76:79], v[96:99], v[44:47]
    ds_read2_b32 v[132:133], v236 offset0:208 offset1:209
    v_mfma_f32_16x16x32_bf16 v[44:47], v[72:75], v[100:103], v[44:47]
    v_mfma_f32_16x16x32_bf16 v[44:47], v[68:71], v[104:107], v[44:47]
    ds_read2_b32 v[134:135], v236 offset0:210 offset1:211
    v_mfma_f32_16x16x32_bf16 v[44:47], v[64:67], v[108:111], v[44:47]
    ds_read_b128 v[168:171], v245 offset:8192
    s_waitcnt lgkmcnt(7)
    v_mfma_f32_16x16x32_bf16 v[48:51], v[64:67], v[112:115], v[48:51]
    ds_read2_b32 v[136:137], v237 offset0:80 offset1:81
    v_mfma_f32_16x16x32_bf16 v[48:51], v[68:71], v[108:111], v[48:51]
    ds_read2_b32 v[138:139], v237 offset0:82 offset1:83
    v_mfma_f32_16x16x32_bf16 v[48:51], v[72:75], v[104:107], v[48:51]
    ds_read_b128 v[172:175], v245 offset:12288
    v_mfma_f32_16x16x32_bf16 v[48:51], v[76:79], v[100:103], v[48:51]
    ds_read2_b32 v[140:141], v237 offset0:208 offset1:209
    v_mfma_f32_16x16x32_bf16 v[48:51], v[80:83], v[96:99], v[48:51]
    ds_read2_b32 v[142:143], v237 offset0:210 offset1:211
    v_mfma_f32_16x16x32_bf16 v[52:55], v[84:87], v[96:99], v[52:55]
    ds_read_b128 v[176:179], v245 offset:16384
    v_mfma_f32_16x16x32_bf16 v[52:55], v[80:83], v[100:103], v[52:55]
    s_add_u32 m0, s73, 147456
    ds_read2_b32 v[144:145], v238 offset0:80 offset1:81
    v_mfma_f32_16x16x32_bf16 v[52:55], v[76:79], v[104:107], v[52:55]
    buffer_load_dwordx4 v5, s[52:55], s14 offen offset:1024 lds
    ds_read2_b32 v[146:147], v238 offset0:82 offset1:83
    v_mfma_f32_16x16x32_bf16 v[52:55], v[72:75], v[108:111], v[52:55]
    ds_read_b128 v[180:183], v245 offset:20480
    v_mfma_f32_16x16x32_bf16 v[52:55], v[68:71], v[112:115], v[52:55]
    ds_read_b128 v[212:215], v241 offset:8352
    v_mfma_f32_16x16x32_bf16 v[52:55], v[64:67], v[116:119], v[52:55]
    ds_read2_b32 v[148:149], v238 offset0:208 offset1:209
    v_mfma_f32_16x16x32_bf16 v[56:59], v[64:67], v[120:123], v[56:59]
    ds_read_b32 v216, v241 offset:8368
    v_mfma_f32_16x16x32_bf16 v[56:59], v[68:71], v[116:119], v[56:59]
    ds_read2_b32 v[150:151], v238 offset0:210 offset1:211
    v_mfma_f32_16x16x32_bf16 v[56:59], v[72:75], v[112:115], v[56:59]
    ds_read_b128 v[218:221], v241 offset:9376
    v_mfma_f32_16x16x32_bf16 v[56:59], v[76:79], v[108:111], v[56:59]
    ds_read_b128 v[184:187], v245 offset:24576
    v_mfma_f32_16x16x32_bf16 v[56:59], v[80:83], v[104:107], v[56:59]
    ds_read2_b32 v[152:153], v239 offset0:80 offset1:81
    v_mfma_f32_16x16x32_bf16 v[56:59], v[84:87], v[100:103], v[56:59]
    ds_read_b32 v222, v241 offset:9392
    v_mfma_f32_16x16x32_bf16 v[56:59], v[88:91], v[96:99], v[56:59]
    ds_read2_b32 v[154:155], v239 offset0:82 offset1:83
    v_mfma_f32_16x16x32_bf16 v[60:63], v[92:95], v[96:99], v[60:63]
    s_add_u32 m0, s73, 147456
    ds_read_b128 v[224:227], v241 offset:10400
    v_mfma_f32_16x16x32_bf16 v[60:63], v[88:91], v[100:103], v[60:63]
    buffer_load_dwordx4 v6, s[52:55], s14 offen offset:2048 lds
    ds_read_b128 v[188:191], v245 offset:28672
    v_mfma_f32_16x16x32_bf16 v[60:63], v[84:87], v[104:107], v[60:63]
    ds_read_b32 v228, v241 offset:10416
    v_mfma_f32_16x16x32_bf16 v[60:63], v[80:83], v[108:111], v[60:63]
    ds_read2_b32 v[156:157], v239 offset0:208 offset1:209
    v_mfma_f32_16x16x32_bf16 v[60:63], v[76:79], v[112:115], v[60:63]
    ds_read_b128 v[230:233], v241 offset:11424
    v_mfma_f32_16x16x32_bf16 v[60:63], v[72:75], v[116:119], v[60:63]
    ds_read2_b32 v[158:159], v239 offset0:210 offset1:211
    v_mfma_f32_16x16x32_bf16 v[60:63], v[68:71], v[120:123], v[60:63]
    ds_read_b32 v234, v241 offset:11440
    v_mfma_f32_16x16x32_bf16 v[60:63], v[64:67], v[124:127], v[60:63]
    s_waitcnt lgkmcnt(15)
    v_mfma_f32_16x16x32_bf16 v[32:35], v[128:131], v[160:163], v[32:35]
    ds_read_b128 v[96:99], v246 offset:0
    v_mfma_f32_16x16x32_bf16 v[36:39], v[132:135], v[160:163], v[36:39]
    ds_read2_b32 v[64:65], v236 offset0:96 offset1:97
    v_mfma_f32_16x16x32_bf16 v[36:39], v[128:131], v[164:167], v[36:39]
    ds_read2_b32 v[66:67], v236 offset0:98 offset1:99
    v_mfma_f32_16x16x32_bf16 v[40:43], v[128:131], v[168:171], v[40:43]
    s_add_u32 m0, s73, 147456
    ds_read_b128 v[100:103], v246 offset:4096
    v_mfma_f32_16x16x32_bf16 v[40:43], v[132:135], v[164:167], v[40:43]
    buffer_load_dwordx4 v7, s[52:55], s14 offen offset:3072 lds
    ds_read2_b32 v[68:69], v236 offset0:224 offset1:225
    s_waitcnt lgkmcnt(5)
    v_mfma_f32_16x16x32_bf16 v[40:43], v[136:139], v[160:163], v[40:43]
    ds_read2_b32 v[70:71], v236 offset0:226 offset1:227
    v_mfma_f32_16x16x32_bf16 v[44:47], v[140:143], v[160:163], v[44:47]
    s_waitcnt vmcnt(8)
    ds_read_b128 v[104:107], v246 offset:8192
    v_mfma_f32_16x16x32_bf16 v[44:47], v[136:139], v[164:167], v[44:47]
    ds_read2_b32 v[72:73], v237 offset0:96 offset1:97
    v_mfma_f32_16x16x32_bf16 v[44:47], v[132:135], v[168:171], v[44:47]
    ds_read2_b32 v[74:75], v237 offset0:98 offset1:99
    v_lshlrev_b32 v9, 16, v9
    v_mfma_f32_16x16x32_bf16 v[44:47], v[128:131], v[172:175], v[44:47]
    ds_read_b128 v[108:111], v246 offset:12288
    v_mfma_f32_16x16x32_bf16 v[48:51], v[128:131], v[176:179], v[48:51]
    ds_read2_b32 v[76:77], v237 offset0:224 offset1:225
    v_lshlrev_b32 v208, 16, v212
    v_mfma_f32_16x16x32_bf16 v[48:51], v[132:135], v[172:175], v[48:51]
    ds_read2_b32 v[78:79], v237 offset0:226 offset1:227
    v_mfma_f32_16x16x32_bf16 v[48:51], v[136:139], v[168:171], v[48:51]
    ds_read_b128 v[112:115], v246 offset:16384
    v_add_f32 v9, v9, v208
    v_mfma_f32_16x16x32_bf16 v[48:51], v[140:143], v[164:167], v[48:51]
    ds_read2_b32 v[80:81], v238 offset0:96 offset1:97
    v_cvt_pk_bf16_f32 v9, v9, v9
    v_mfma_f32_16x16x32_bf16 v[48:51], v[144:147], v[160:163], v[48:51]
    ds_read2_b32 v[82:83], v238 offset0:98 offset1:99
    v_mfma_f32_16x16x32_bf16 v[52:55], v[148:151], v[160:163], v[52:55]
    ds_write_b16 v242, v9 offset:12480
    v_mfma_f32_16x16x32_bf16 v[52:55], v[144:147], v[164:167], v[52:55]
    ds_read_b128 v[116:119], v246 offset:20480
    v_mfma_f32_16x16x32_bf16 v[52:55], v[140:143], v[168:171], v[52:55]
    ds_write_b16 v242, v9 offset:8322
    v_mfma_f32_16x16x32_bf16 v[52:55], v[136:139], v[172:175], v[52:55]
    ds_read2_b32 v[84:85], v238 offset0:224 offset1:225
    v_mfma_f32_16x16x32_bf16 v[52:55], v[132:135], v[176:179], v[52:55]
    ds_read2_b32 v[86:87], v238 offset0:226 offset1:227
    v_alignbit_b32 v212, v213, v212, 16
    v_mfma_f32_16x16x32_bf16 v[52:55], v[128:131], v[180:183], v[52:55]
    ds_read_b128 v[120:123], v246 offset:24576
    v_alignbit_b32 v213, v214, v213, 16
    v_mfma_f32_16x16x32_bf16 v[56:59], v[128:131], v[184:187], v[56:59]
    ds_read2_b32 v[88:89], v239 offset0:96 offset1:97
    s_waitcnt vmcnt(4)
    s_barrier
    v_mfma_f32_16x16x32_bf16 v[56:59], v[132:135], v[180:183], v[56:59]
    v_add_u32 v10, -131072, v10
    v_alignbit_b32 v214, v215, v214, 16
    v_mfma_f32_16x16x32_bf16 v[56:59], v[136:139], v[176:179], v[56:59]
    ds_read_b64_tr_b16 a[16:17], v10 offset:49152
    v_alignbit_b32 v215, v216, v215, 16
    v_mfma_f32_16x16x32_bf16 v[56:59], v[140:143], v[172:175], v[56:59]
    ds_write_b128 v241, v[212:215] offset:12512
    v_mfma_f32_16x16x32_bf16 v[56:59], v[144:147], v[168:171], v[56:59]
    ds_read_b64_tr_b16 a[18:19], v10 offset:51200
    v_mfma_f32_16x16x32_bf16 v[56:59], v[148:151], v[164:167], v[56:59]
    ds_read_b64_tr_b16 a[24:25], v10 offset:53248
    v_mfma_f32_16x16x32_bf16 v[56:59], v[152:155], v[160:163], v[56:59]
    ds_read_b64_tr_b16 a[26:27], v10 offset:55296
    v_mfma_f32_16x16x32_bf16 v[60:63], v[156:159], v[160:163], v[60:63]
    ds_read2_b32 v[90:91], v239 offset0:98 offset1:99
    v_add_u32 v11, -131072, v11
    v_alignbit_b32 v218, v219, v218, 16
    v_mfma_f32_16x16x32_bf16 v[60:63], v[152:155], v[164:167], v[60:63]
    ds_read_b64_tr_b16 a[20:21], v11 offset:49152
    v_alignbit_b32 v219, v220, v219, 16
    v_mfma_f32_16x16x32_bf16 v[60:63], v[148:151], v[168:171], v[60:63]
    ds_read_b128 v[124:127], v246 offset:28672
    ds_read2_b32 v[92:93], v239 offset0:224 offset1:225
    v_mfma_f32_16x16x32_bf16 v[60:63], v[144:147], v[172:175], v[60:63]
    ds_read_b64_tr_b16 a[22:23], v11 offset:51200
    v_alignbit_b32 v220, v221, v220, 16
    v_mfma_f32_16x16x32_bf16 v[60:63], v[140:143], v[176:179], v[60:63]
    ds_read_b64_tr_b16 a[28:29], v11 offset:53248
    ds_read2_b32 v[94:95], v239 offset0:226 offset1:227
    v_mfma_f32_16x16x32_bf16 v[60:63], v[136:139], v[180:183], v[60:63]
    ds_read_b64_tr_b16 a[30:31], v11 offset:55296
    v_alignbit_b32 v221, v222, v221, 16
    v_mfma_f32_16x16x32_bf16 v[60:63], v[132:135], v[184:187], v[60:63]
    ds_write_b128 v241, v[218:221] offset:13536
    v_mfma_f32_16x16x32_bf16 v[60:63], v[128:131], v[188:191], v[60:63]
    s_waitcnt lgkmcnt(15)
    v_mfma_f32_16x16x32_bf16 v[32:35], v[64:67], v[96:99], v[32:35]
    ds_read_b128 v[160:163], v247 offset:0
    s_waitcnt lgkmcnt(2)
    s_barrier
    v_mfma_f32_16x16x32_bf16 v[36:39], v[68:71], v[96:99], v[36:39]
    v_alignbit_b32 v224, v225, v224, 16
    v_mfma_f32_16x16x32_bf16 v[36:39], v[64:67], v[100:103], v[36:39]
    ds_read_b128 v[164:167], v247 offset:4096
    v_mfma_f32_16x16x32_bf16 v[40:43], v[64:67], v[104:107], v[40:43]
    s_lshl_b32 s14, s87, 18
    ds_read_b128 v[168:171], v247 offset:8192
L_pl_X_2:
    s_cbranch_execz L_pl_X_6
    v_mfma_f32_16x16x32_bf16 v[40:43], v[68:71], v[100:103], v[40:43]
    s_add_u32 m0, s73, 49152
    ds_read_b128 v[172:175], v247 offset:12288
    v_mfma_f32_16x16x32_bf16 v[40:43], v[72:75], v[96:99], v[40:43]
    buffer_load_dwordx4 v4, s[52:55], s14 offen offset:0 lds
    v_alignbit_b32 v225, v226, v225, 16
    v_mfma_f32_16x16x32_bf16 v[44:47], v[76:79], v[96:99], v[44:47]
    ds_read_b128 v[176:179], v247 offset:16384
    v_mfma_f32_16x16x32_bf16 v[44:47], v[72:75], v[100:103], v[44:47]
    ds_read_b128 v[180:183], v247 offset:20480
    v_mfma_f32_16x16x32_bf16 v[44:47], v[68:71], v[104:107], v[44:47]
    ds_read_b128 v[184:187], v247 offset:24576
    v_mfma_f32_16x16x32_bf16 v[44:47], v[64:67], v[108:111], v[44:47]
    v_alignbit_b32 v226, v227, v226, 16
    v_mfma_f32_16x16x32_bf16 v[48:51], v[64:67], v[112:115], v[48:51]
    ds_read_b128 v[188:191], v247 offset:28672
    v_mfma_f32_16x16x32_bf16 v[48:51], v[68:71], v[108:111], v[48:51]
    ds_read2_b32 v[128:129], v236 offset0:112 offset1:113
    v_mfma_f32_16x16x32_bf16 v[48:51], v[72:75], v[104:107], v[48:51]
    v_alignbit_b32 v227, v228, v227, 16
    v_mfma_f32_16x16x32_bf16 v[48:51], v[76:79], v[100:103], v[48:51]
    ds_read2_b32 v[130:131], v236 offset0:114 offset1:115
    v_mfma_f32_16x16x32_bf16 v[48:51], v[80:83], v[96:99], v[48:51]
    ds_read2_b32 v[132:133], v236 offset0:240 offset1:241
    v_mfma_f32_16x16x32_bf16 v[52:55], v[84:87], v[96:99], v[52:55]
    ds_write_b128 v241, v[224:227] offset:14560
    v_mfma_f32_16x16x32_bf16 v[52:55], v[80:83], v[100:103], v[52:55]
    s_add_u32 m0, s73, 49152
    ds_read2_b32 v[134:135], v236 offset0:242 offset1:243
    v_mfma_f32_16x16x32_bf16 v[52:55], v[76:79], v[104:107], v[52:55]
    buffer_load_dwordx4 v5, s[52:55], s14 offen offset:1024 lds
    ds_read2_b32 v[136:137], v237 offset0:112 offset1:113
    v_mfma_f32_16x16x32_bf16 v[52:55], v[72:75], v[108:111], v[52:55]
    s_add_u32 s6, s12, 4718592
    ds_read2_b32 v[138:139], v237 offset0:114 offset1:115
    v_mfma_f32_16x16x32_bf16 v[52:55], v[68:71], v[112:115], v[52:55]
    ds_read2_b32 v[140:141], v237 offset0:240 offset1:241
    v_alignbit_b32 v230, v231, v230, 16
    v_mfma_f32_16x16x32_bf16 v[52:55], v[64:67], v[116:119], v[52:55]
    ds_read2_b32 v[142:143], v237 offset0:242 offset1:243
    v_xor_b32 v244, 64, v244
    v_mfma_f32_16x16x32_bf16 v[56:59], v[64:67], v[120:123], v[56:59]
    ds_read2_b32 v[144:145], v238 offset0:112 offset1:113
    v_mfma_f32_16x16x32_bf16 v[56:59], v[68:71], v[116:119], v[56:59]
    ds_read2_b32 v[146:147], v238 offset0:114 offset1:115
    v_mfma_f32_16x16x32_bf16 v[56:59], v[72:75], v[112:115], v[56:59]
    ds_read2_b32 v[148:149], v238 offset0:240 offset1:241
    v_alignbit_b32 v231, v232, v231, 16
    v_mfma_f32_16x16x32_bf16 v[56:59], v[76:79], v[108:111], v[56:59]
    ds_read2_b32 v[150:151], v238 offset0:242 offset1:243
    v_xor_b32 v245, 64, v245
    v_mfma_f32_16x16x32_bf16 v[56:59], v[80:83], v[104:107], v[56:59]
    ds_read2_b32 v[152:153], v239 offset0:112 offset1:113
    v_mfma_f32_16x16x32_bf16 v[56:59], v[84:87], v[100:103], v[56:59]
    ds_read2_b32 v[154:155], v239 offset0:114 offset1:115
    v_mfma_f32_16x16x32_bf16 v[56:59], v[88:91], v[96:99], v[56:59]
    ds_read2_b32 v[156:157], v239 offset0:240 offset1:241
    v_alignbit_b32 v232, v233, v232, 16
    v_mfma_f32_16x16x32_bf16 v[60:63], v[92:95], v[96:99], v[60:63]
    s_add_u32 m0, s73, 49152
    ds_read2_b32 v[158:159], v239 offset0:242 offset1:243
    v_mfma_f32_16x16x32_bf16 v[60:63], v[88:91], v[100:103], v[60:63]
    buffer_load_dwordx4 v6, s[52:55], s14 offen offset:2048 lds
    v_xor_b32 v246, 64, v246
    v_mfma_f32_16x16x32_bf16 v[60:63], v[84:87], v[104:107], v[60:63]
    v_alignbit_b32 v233, v234, v233, 16
    v_add_u32 v236, 8320, v236
    v_mfma_f32_16x16x32_bf16 v[60:63], v[80:83], v[108:111], v[60:63]
    v_add_u32 v237, 8320, v237
    v_mfma_f32_16x16x32_bf16 v[60:63], v[76:79], v[112:115], v[60:63]
    v_mfma_f32_16x16x32_bf16 v[60:63], v[72:75], v[116:119], v[60:63]
    v_xor_b32 v247, 64, v247
    v_add_u32 v238, 8320, v238
    v_mfma_f32_16x16x32_bf16 v[60:63], v[68:71], v[120:123], v[60:63]
    ds_write_b128 v241, v[230:233] offset:15584
    v_mfma_f32_16x16x32_bf16 v[60:63], v[64:67], v[124:127], v[60:63]
    v_add_u32 v239, 8320, v239
    s_waitcnt lgkmcnt(1)
    v_mfma_f32_16x16x32_bf16 v[60:63], v[128:131], v[188:191], v[60:63]
    ds_read_b128 v[96:99], v244 offset:2048
    v_mfma_f32_16x16x32_bf16 v[60:63], v[132:135], v[184:187], v[60:63]
    ds_read2_b32 v[64:65], v236 offset0:0 offset1:1
    v_mfma_f32_16x16x32_bf16 v[60:63], v[136:139], v[180:183], v[60:63]
    ds_read2_b32 v[66:67], v236 offset0:2 offset1:3
    v_mfma_f32_16x16x32_bf16 v[60:63], v[140:143], v[176:179], v[60:63]
    s_add_u32 m0, s73, 49152
    ds_read_b128 v[100:103], v244 offset:6144
    v_mfma_f32_16x16x32_bf16 v[60:63], v[144:147], v[172:175], v[60:63]
    buffer_load_dwordx4 v7, s[52:55], s14 offen offset:3072 lds
    ds_read2_b32 v[68:69], v236 offset0:128 offset1:129
    v_mfma_f32_16x16x32_bf16 v[60:63], v[148:151], v[168:171], v[60:63]
    ds_read2_b32 v[70:71], v236 offset0:130 offset1:131
    v_mfma_f32_16x16x32_bf16 v[60:63], v[152:155], v[164:167], v[60:63]
    ds_read_b128 v[104:107], v244 offset:10240
    v_mfma_f32_16x16x32_bf16 v[60:63], v[156:159], v[160:163], v[60:63]
    ds_read2_b32 v[72:73], v237 offset0:0 offset1:1
    v_mfma_f32_16x16x32_bf16 v[56:59], v[128:131], v[184:187], v[56:59]
    ds_read2_b32 v[74:75], v237 offset0:2 offset1:3
    v_mfma_f32_16x16x32_bf16 v[56:59], v[132:135], v[180:183], v[56:59]
    ds_read_b128 v[108:111], v244 offset:14336
    v_mfma_f32_16x16x32_bf16 v[56:59], v[136:139], v[176:179], v[56:59]
    ds_read2_b32 v[76:77], v237 offset0:128 offset1:129
    v_mfma_f32_16x16x32_bf16 v[56:59], v[140:143], v[172:175], v[56:59]
    ds_read2_b32 v[78:79], v237 offset0:130 offset1:131
    v_mfma_f32_16x16x32_bf16 v[56:59], v[144:147], v[168:171], v[56:59]
    ds_read_b128 v[112:115], v244 offset:18432
    v_mfma_f32_16x16x32_bf16 v[56:59], v[148:151], v[164:167], v[56:59]
    ds_read2_b32 v[80:81], v238 offset0:0 offset1:1
    v_cvt_pk_bf16_f32 v206, v60, v61
    v_mfma_f32_16x16x32_bf16 v[56:59], v[152:155], v[160:163], v[56:59]
    ds_read2_b32 v[82:83], v238 offset0:2 offset1:3
    v_mfma_f32_16x16x32_bf16 v[52:55], v[128:131], v[180:183], v[52:55]
    ds_read_b128 v[116:119], v244 offset:22528
    v_mfma_f32_16x16x32_bf16 v[52:55], v[132:135], v[176:179], v[52:55]
    ds_read2_b32 v[84:85], v238 offset0:128 offset1:129
    v_cvt_pk_bf16_f32 v207, v62, v63
    v_mfma_f32_16x16x32_bf16 v[52:55], v[136:139], v[172:175], v[52:55]
    ds_read2_b32 v[86:87], v238 offset0:130 offset1:131
    v_mfma_f32_16x16x32_bf16 v[52:55], v[140:143], v[168:171], v[52:55]
    buffer_store_dwordx2 v[206:207], v8, s[44:47], s6 offen offset:3584 sc1
    ds_read_b128 v[120:123], v244 offset:26624
    v_mfma_f32_16x16x32_bf16 v[52:55], v[144:147], v[164:167], v[52:55]
    ds_read2_b32 v[88:89], v239 offset0:0 offset1:1
    v_mfma_f32_16x16x32_bf16 v[52:55], v[148:151], v[160:163], v[52:55]
    ds_read2_b32 v[90:91], v239 offset0:2 offset1:3
    v_mfma_f32_16x16x32_bf16 v[48:51], v[128:131], v[176:179], v[48:51]
    s_waitcnt vmcnt(5)
    s_barrier
    v_cvt_pk_bf16_f32 v204, v56, v57
    v_mfma_f32_16x16x32_bf16 v[48:51], v[132:135], v[172:175], v[48:51]
    ds_read_b128 v[124:127], v244 offset:30720
    v_add_u32 v10, 131072, v10
    v_mfma_f32_16x16x32_bf16 v[48:51], v[136:139], v[168:171], v[48:51]
    ds_read_b64_tr_b16 a[32:33], v10 offset:16384
    v_mfma_f32_16x16x32_bf16 v[48:51], v[140:143], v[164:167], v[48:51]
    ds_read2_b32 v[92:93], v239 offset0:128 offset1:129
    v_cvt_pk_bf16_f32 v205, v58, v59
    v_mfma_f32_16x16x32_bf16 v[48:51], v[144:147], v[160:163], v[48:51]
    ds_read_b64_tr_b16 a[34:35], v10 offset:18432
    v_mfma_f32_16x16x32_bf16 v[44:47], v[128:131], v[172:175], v[44:47]
    buffer_store_dwordx2 v[204:205], v8, s[44:47], s6 offen offset:3072 sc1
    ds_read_b64_tr_b16 a[40:41], v10 offset:20480
    v_mfma_f32_16x16x32_bf16 v[44:47], v[132:135], v[168:171], v[44:47]
    ds_read_b64_tr_b16 a[42:43], v10 offset:22528
    v_mfma_f32_16x16x32_bf16 v[44:47], v[136:139], v[164:167], v[44:47]
    ds_read2_b32 v[94:95], v239 offset0:130 offset1:131
    v_add_u32 v11, 131072, v11
    v_mfma_f32_16x16x32_bf16 v[44:47], v[140:143], v[160:163], v[44:47]
    ds_read_b64_tr_b16 a[36:37], v11 offset:16384
    v_cvt_pk_bf16_f32 v202, v52, v53
    v_mfma_f32_16x16x32_bf16 v[40:43], v[128:131], v[168:171], v[40:43]
    v_mfma_f32_16x16x32_bf16 v[40:43], v[132:135], v[164:167], v[40:43]
    ds_read_b64_tr_b16 a[38:39], v11 offset:18432
    v_mfma_f32_16x16x32_bf16 v[40:43], v[136:139], v[160:163], v[40:43]
    ds_read_b64_tr_b16 a[44:45], v11 offset:20480
    v_cvt_pk_bf16_f32 v203, v54, v55
    v_mfma_f32_16x16x32_bf16 v[36:39], v[128:131], v[164:167], v[36:39]
    ds_read_b64_tr_b16 a[46:47], v11 offset:22528
    v_mfma_f32_16x16x32_bf16 v[36:39], v[132:135], v[160:163], v[36:39]
    buffer_store_dwordx2 v[202:203], v8, s[44:47], s6 offen offset:2560 sc1
    v_mfma_f32_16x16x32_bf16 v[32:35], v[128:131], v[160:163], v[32:35]
    s_waitcnt lgkmcnt(4)
    v_mfma_f32_16x16x32_bf16 v[60:63], v[64:67], v[124:127], 0
    ds_read_b128 v[160:163], v245 offset:2048
    s_waitcnt lgkmcnt(1)
    s_barrier
    v_mfma_f32_16x16x32_bf16 v[60:63], v[68:71], v[120:123], v[60:63]
    v_cvt_pk_bf16_f32 v200, v48, v49
    v_mfma_f32_16x16x32_bf16 v[60:63], v[72:75], v[116:119], v[60:63]
    ds_read2_b32 v[128:129], v236 offset0:16 offset1:17
    v_mfma_f32_16x16x32_bf16 v[60:63], v[76:79], v[112:115], v[60:63]
    ds_read2_b32 v[130:131], v236 offset0:18 offset1:19
    s_lshl_b32 s14, s88, 18
    v_cvt_pk_bf16_f32 v201, v50, v51
    v_mfma_f32_16x16x32_bf16 v[60:63], v[80:83], v[108:111], v[60:63]
    s_add_u32 m0, s73, 147456
    v_mfma_f32_16x16x32_bf16 v[60:63], v[84:87], v[104:107], v[60:63]
    buffer_load_dwordx4 v4, s[52:55], s14 offen offset:0 lds
    ds_read_b128 v[164:167], v245 offset:6144
    v_mfma_f32_16x16x32_bf16 v[60:63], v[88:91], v[100:103], v[60:63]
    buffer_store_dwordx2 v[200:201], v8, s[44:47], s6 offen offset:2048 sc1
    ds_read2_b32 v[132:133], v236 offset0:144 offset1:145
    v_mfma_f32_16x16x32_bf16 v[60:63], v[92:95], v[96:99], v[60:63]
    s_add_u32 s13, s12, 32768
    v_cvt_pk_bf16_f32 v198, v44, v45
    v_mfma_f32_16x16x32_bf16 v[56:59], v[64:67], v[120:123], 0
    ds_read2_b32 v[134:135], v236 offset0:146 offset1:147
    v_mfma_f32_16x16x32_bf16 v[56:59], v[68:71], v[116:119], v[56:59]
    s_add_u32 m0, s74, 32
    ds_read_b128 v[168:171], v245 offset:10240
    v_mfma_f32_16x16x32_bf16 v[56:59], v[72:75], v[112:115], v[56:59]
    buffer_load_dwordx4 v240, s[48:51], s13 offen offset:0 lds
    v_cvt_pk_bf16_f32 v199, v46, v47
    v_mfma_f32_16x16x32_bf16 v[56:59], v[76:79], v[108:111], v[56:59]
    ds_read2_b32 v[136:137], v237 offset0:16 offset1:17
    v_mfma_f32_16x16x32_bf16 v[56:59], v[80:83], v[104:107], v[56:59]
    buffer_store_dwordx2 v[198:199], v8, s[44:47], s6 offen offset:1536 sc1
    ds_read2_b32 v[138:139], v237 offset0:18 offset1:19
    v_mfma_f32_16x16x32_bf16 v[56:59], v[84:87], v[100:103], v[56:59]
    ds_read_b128 v[172:175], v245 offset:14336
    v_mfma_f32_16x16x32_bf16 v[56:59], v[88:91], v[96:99], v[56:59]
    v_cvt_pk_bf16_f32 v196, v40, v41
    v_mfma_f32_16x16x32_bf16 v[52:55], v[64:67], v[116:119], 0
    ds_read2_b32 v[140:141], v237 offset0:144 offset1:145
    v_mfma_f32_16x16x32_bf16 v[52:55], v[68:71], v[112:115], v[52:55]
    ds_read2_b32 v[142:143], v237 offset0:146 offset1:147
    s_add_u32 m0, s73, 147456
    v_cvt_pk_bf16_f32 v197, v42, v43
    v_mfma_f32_16x16x32_bf16 v[52:55], v[72:75], v[108:111], v[52:55]
    buffer_load_dwordx4 v5, s[52:55], s14 offen offset:1024 lds
    v_mfma_f32_16x16x32_bf16 v[52:55], v[76:79], v[104:107], v[52:55]
    buffer_store_dwordx2 v[196:197], v8, s[44:47], s6 offen offset:1024 sc1
    ds_read_b128 v[176:179], v245 offset:18432
    s_add_u32 m0, s74, 32
    v_mfma_f32_16x16x32_bf16 v[52:55], v[80:83], v[100:103], v[52:55]
    buffer_load_dwordx4 v240, s[48:51], s13 offen offset:1024 lds
    ds_read2_b32 v[144:145], v238 offset0:16 offset1:17
    v_mfma_f32_16x16x32_bf16 v[52:55], v[84:87], v[96:99], v[52:55]
    v_mfma_f32_16x16x32_bf16 v[48:51], v[64:67], v[112:115], 0
    ds_read2_b32 v[146:147], v238 offset0:18 offset1:19
    v_cvt_pk_bf16_f32 v194, v36, v37
    v_mfma_f32_16x16x32_bf16 v[48:51], v[68:71], v[108:111], v[48:51]
    ds_read_b128 v[180:183], v245 offset:22528
    v_mfma_f32_16x16x32_bf16 v[48:51], v[72:75], v[104:107], v[48:51]
    v_cvt_pk_bf16_f32 v195, v38, v39
    v_mfma_f32_16x16x32_bf16 v[48:51], v[76:79], v[100:103], v[48:51]
    buffer_store_dwordx2 v[194:195], v8, s[44:47], s6 offen offset:512 sc1
    ds_read2_b32 v[148:149], v238 offset0:144 offset1:145
    s_add_u32 m0, s74, 32
    v_mfma_f32_16x16x32_bf16 v[48:51], v[80:83], v[96:99], v[48:51]
    buffer_load_dwordx4 v240, s[48:51], s13 offen offset:2048 lds
    ds_read2_b32 v[150:151], v238 offset0:146 offset1:147
    v_mfma_f32_16x16x32_bf16 v[44:47], v[64:67], v[108:111], 0
    ds_read_b128 v[184:187], v245 offset:26624
    v_mfma_f32_16x16x32_bf16 v[44:47], v[68:71], v[104:107], v[44:47]
    v_cvt_pk_bf16_f32 v192, v32, v33
    v_mfma_f32_16x16x32_bf16 v[44:47], v[72:75], v[100:103], v[44:47]
    s_add_u32 m0, s73, 147456
    ds_read2_b32 v[152:153], v239 offset0:16 offset1:17
    v_mfma_f32_16x16x32_bf16 v[44:47], v[76:79], v[96:99], v[44:47]
    buffer_load_dwordx4 v6, s[52:55], s14 offen offset:2048 lds
    v_cvt_pk_bf16_f32 v193, v34, v35
    v_mfma_f32_16x16x32_bf16 v[40:43], v[64:67], v[104:107], 0
    ds_read2_b32 v[154:155], v239 offset0:18 offset1:19
    v_mfma_f32_16x16x32_bf16 v[40:43], v[68:71], v[100:103], v[40:43]
    buffer_store_dwordx2 v[192:193], v8, s[44:47], s6 offen offset:0 sc1
    ds_read_b128 v[188:191], v245 offset:30720
    v_mfma_f32_16x16x32_bf16 v[40:43], v[72:75], v[96:99], v[40:43]
    s_add_u32 m0, s74, 32
    ds_read2_b32 v[156:157], v239 offset0:144 offset1:145
    v_mfma_f32_16x16x32_bf16 v[36:39], v[64:67], v[100:103], 0
    buffer_load_dwordx4 v240, s[48:51], s13 offen offset:3072 lds
    v_mfma_f32_16x16x32_bf16 v[36:39], v[68:71], v[96:99], v[36:39]
    ds_read2_b32 v[158:159], v239 offset0:146 offset1:147
    v_mfma_f32_16x16x32_bf16 v[32:35], v[64:67], v[96:99], 0
    s_waitcnt lgkmcnt(12)
    v_mfma_f32_16x16x32_bf16 v[32:35], v[128:131], v[160:163], v[32:35]
    ds_read_b128 v[96:99], v246 offset:2048
    v_mfma_f32_16x16x32_bf16 v[36:39], v[132:135], v[160:163], v[36:39]
    v_mfma_f32_16x16x32_bf16 v[36:39], v[128:131], v[164:167], v[36:39]
    ds_read2_b32 v[64:65], v236 offset0:32 offset1:33
    v_mfma_f32_16x16x32_bf16 v[40:43], v[128:131], v[168:171], v[40:43]
    s_add_u32 m0, s73, 147456
    ds_read2_b32 v[66:67], v236 offset0:34 offset1:35
    v_mfma_f32_16x16x32_bf16 v[40:43], v[132:135], v[164:167], v[40:43]
    buffer_load_dwordx4 v7, s[52:55], s14 offen offset:3072 lds
    v_mfma_f32_16x16x32_bf16 v[40:43], v[136:139], v[160:163], v[40:43]
    ds_read_b128 v[100:103], v246 offset:6144
    v_mfma_f32_16x16x32_bf16 v[44:47], v[140:143], v[160:163], v[44:47]
    ds_read2_b32 v[68:69], v236 offset0:160 offset1:161
    v_mfma_f32_16x16x32_bf16 v[44:47], v[136:139], v[164:167], v[44:47]
    ds_read2_b32 v[70:71], v236 offset0:162 offset1:163
    v_mfma_f32_16x16x32_bf16 v[44:47], v[132:135], v[168:171], v[44:47]
    ds_read_b128 v[104:107], v246 offset:10240
    v_mfma_f32_16x16x32_bf16 v[44:47], v[128:131], v[172:175], v[44:47]
    ds_read2_b32 v[72:73], v237 offset0:32 offset1:33
    s_waitcnt lgkmcnt(8)
    v_mfma_f32_16x16x32_bf16 v[48:51], v[128:131], v[176:179], v[48:51]
    ds_read2_b32 v[74:75], v237 offset0:34 offset1:35
    v_mfma_f32_16x16x32_bf16 v[48:51], v[132:135], v[172:175], v[48:51]
    ds_read_b128 v[108:111], v246 offset:14336
    v_mfma_f32_16x16x32_bf16 v[48:51], v[136:139], v[168:171], v[48:51]
    v_mov_b32 v9, 16
    buffer_load_ushort v9, v9, s[56:59], s70 offen
    v_mfma_f32_16x16x32_bf16 v[48:51], v[140:143], v[164:167], v[48:51]
    ds_read2_b32 v[76:77], v237 offset0:160 offset1:161
    v_mfma_f32_16x16x32_bf16 v[48:51], v[144:147], v[160:163], v[48:51]
    ds_read2_b32 v[78:79], v237 offset0:162 offset1:163
    s_waitcnt vmcnt(17)
    s_barrier
    v_mfma_f32_16x16x32_bf16 v[52:55], v[148:151], v[160:163], v[52:55]
    ds_read_b128 v[112:115], v246 offset:18432
    v_add_u32 v10, -131072, v10
    v_mfma_f32_16x16x32_bf16 v[52:55], v[144:147], v[164:167], v[52:55]
    ds_read_b64_tr_b16 a[48:49], v10 offset:49152
    v_mfma_f32_16x16x32_bf16 v[52:55], v[140:143], v[168:171], v[52:55]
    ds_read_b64_tr_b16 a[50:51], v10 offset:51200
    v_mfma_f32_16x16x32_bf16 v[52:55], v[136:139], v[172:175], v[52:55]
    ds_read2_b32 v[80:81], v238 offset0:32 offset1:33
    v_mfma_f32_16x16x32_bf16 v[52:55], v[132:135], v[176:179], v[52:55]
    ds_read_b64_tr_b16 a[56:57], v10 offset:53248
    v_mfma_f32_16x16x32_bf16 v[52:55], v[128:131], v[180:183], v[52:55]
    ds_read_b64_tr_b16 a[58:59], v10 offset:55296
    v_mfma_f32_16x16x32_bf16 v[56:59], v[128:131], v[184:187], v[56:59]
    ds_read2_b32 v[82:83], v238 offset0:34 offset1:35
    v_add_u32 v11, -131072, v11
    v_mfma_f32_16x16x32_bf16 v[56:59], v[132:135], v[180:183], v[56:59]
    ds_read_b64_tr_b16 a[52:53], v11 offset:49152
    v_mfma_f32_16x16x32_bf16 v[56:59], v[136:139], v[176:179], v[56:59]
    ds_read_b64_tr_b16 a[54:55], v11 offset:51200
    v_mfma_f32_16x16x32_bf16 v[56:59], v[140:143], v[172:175], v[56:59]
    ds_read_b128 v[116:119], v246 offset:22528
    v_mfma_f32_16x16x32_bf16 v[56:59], v[144:147], v[168:171], v[56:59]
    ds_read_b64_tr_b16 a[60:61], v11 offset:53248
    v_mfma_f32_16x16x32_bf16 v[56:59], v[148:151], v[164:167], v[56:59]
    ds_read_b64_tr_b16 a[62:63], v11 offset:55296
    v_mfma_f32_16x16x32_bf16 v[56:59], v[152:155], v[160:163], v[56:59]
    ds_read2_b32 v[84:85], v238 offset0:160 offset1:161
    v_mfma_f32_16x16x32_bf16 v[60:63], v[156:159], v[160:163], v[60:63]
    ds_read2_b32 v[86:87], v238 offset0:162 offset1:163
    v_mfma_f32_16x16x32_bf16 v[60:63], v[152:155], v[164:167], v[60:63]
    ds_read_b128 v[120:123], v246 offset:26624
    v_mfma_f32_16x16x32_bf16 v[60:63], v[148:151], v[168:171], v[60:63]
    ds_read2_b32 v[88:89], v239 offset0:32 offset1:33
    v_mfma_f32_16x16x32_bf16 v[60:63], v[144:147], v[172:175], v[60:63]
    ds_read2_b32 v[90:91], v239 offset0:34 offset1:35
    v_mfma_f32_16x16x32_bf16 v[60:63], v[140:143], v[176:179], v[60:63]
    ds_read_b128 v[124:127], v246 offset:30720
    v_mfma_f32_16x16x32_bf16 v[60:63], v[136:139], v[180:183], v[60:63]
    ds_read2_b32 v[92:93], v239 offset0:160 offset1:161
    v_mfma_f32_16x16x32_bf16 v[60:63], v[132:135], v[184:187], v[60:63]
    ds_read2_b32 v[94:95], v239 offset0:162 offset1:163
    v_mfma_f32_16x16x32_bf16 v[60:63], v[128:131], v[188:191], v[60:63]
    s_waitcnt lgkmcnt(15)
    v_mfma_f32_16x16x32_bf16 v[32:35], v[64:67], v[96:99], v[32:35]
    ds_read_b128 v[160:163], v247 offset:2048
    v_mfma_f32_16x16x32_bf16 v[36:39], v[68:71], v[96:99], v[36:39]
    v_mfma_f32_16x16x32_bf16 v[36:39], v[64:67], v[100:103], v[36:39]
    ds_read2_b32 v[128:129], v236 offset0:48 offset1:49
    v_mfma_f32_16x16x32_bf16 v[40:43], v[64:67], v[104:107], v[40:43]
    ds_read2_b32 v[130:131], v236 offset0:50 offset1:51
    v_mfma_f32_16x16x32_bf16 v[40:43], v[68:71], v[100:103], v[40:43]
    v_mfma_f32_16x16x32_bf16 v[40:43], v[72:75], v[96:99], v[40:43]
    ds_read_b128 v[164:167], v247 offset:6144
    v_mfma_f32_16x16x32_bf16 v[44:47], v[76:79], v[96:99], v[44:47]
    ds_read2_b32 v[132:133], v236 offset0:176 offset1:177
    v_mfma_f32_16x16x32_bf16 v[44:47], v[72:75], v[100:103], v[44:47]
    s_waitcnt lgkmcnt(13)
    s_barrier
    v_mfma_f32_16x16x32_bf16 v[44:47], v[68:71], v[104:107], v[44:47]
    ds_read2_b32 v[134:135], v236 offset0:178 offset1:179
    v_mfma_f32_16x16x32_bf16 v[44:47], v[64:67], v[108:111], v[44:47]
    ds_read_b128 v[168:171], v247 offset:10240
    s_waitcnt lgkmcnt(7)
    v_mfma_f32_16x16x32_bf16 v[48:51], v[64:67], v[112:115], v[48:51]
    ds_read2_b32 v[136:137], v237 offset0:48 offset1:49
    v_mfma_f32_16x16x32_bf16 v[48:51], v[68:71], v[108:111], v[48:51]
    v_mfma_f32_16x16x32_bf16 v[48:51], v[72:75], v[104:107], v[48:51]
    ds_read2_b32 v[138:139], v237 offset0:50 offset1:51
    v_mfma_f32_16x16x32_bf16 v[48:51], v[76:79], v[100:103], v[48:51]
    ds_read_b128 v[172:175], v247 offset:14336
    v_mfma_f32_16x16x32_bf16 v[48:51], v[80:83], v[96:99], v[48:51]
    v_mfma_f32_16x16x32_bf16 v[52:55], v[84:87], v[96:99], v[52:55]
    ds_read2_b32 v[140:141], v237 offset0:176 offset1:177
    v_mfma_f32_16x16x32_bf16 v[52:55], v[80:83], v[100:103], v[52:55]
    ds_read2_b32 v[142:143], v237 offset0:178 offset1:179
    v_mfma_f32_16x16x32_bf16 v[52:55], v[76:79], v[104:107], v[52:55]
    v_mfma_f32_16x16x32_bf16 v[52:55], v[72:75], v[108:111], v[52:55]
    ds_read_b128 v[176:179], v247 offset:18432
    v_mfma_f32_16x16x32_bf16 v[52:55], v[68:71], v[112:115], v[52:55]
    ds_read2_b32 v[144:145], v238 offset0:48 offset1:49
    v_mfma_f32_16x16x32_bf16 v[52:55], v[64:67], v[116:119], v[52:55]
    v_mfma_f32_16x16x32_bf16 v[56:59], v[64:67], v[120:123], v[56:59]
    ds_read2_b32 v[146:147], v238 offset0:50 offset1:51
    v_mfma_f32_16x16x32_bf16 v[56:59], v[68:71], v[116:119], v[56:59]
    ds_read_b128 v[180:183], v247 offset:22528
    v_mfma_f32_16x16x32_bf16 v[56:59], v[72:75], v[112:115], v[56:59]
    v_mfma_f32_16x16x32_bf16 v[56:59], v[76:79], v[108:111], v[56:59]
    ds_read2_b32 v[148:149], v238 offset0:176 offset1:177
    v_mfma_f32_16x16x32_bf16 v[56:59], v[80:83], v[104:107], v[56:59]
    ds_read2_b32 v[150:151], v238 offset0:178 offset1:179
    v_mfma_f32_16x16x32_bf16 v[56:59], v[84:87], v[100:103], v[56:59]
    ds_read_b128 v[184:187], v247 offset:26624
    v_mfma_f32_16x16x32_bf16 v[56:59], v[88:91], v[96:99], v[56:59]
    v_mfma_f32_16x16x32_bf16 v[60:63], v[92:95], v[96:99], v[60:63]
    ds_read2_b32 v[152:153], v239 offset0:48 offset1:49
    v_mfma_f32_16x16x32_bf16 v[60:63], v[88:91], v[100:103], v[60:63]
    ds_read2_b32 v[154:155], v239 offset0:50 offset1:51
    v_mfma_f32_16x16x32_bf16 v[60:63], v[84:87], v[104:107], v[60:63]
    v_mfma_f32_16x16x32_bf16 v[60:63], v[80:83], v[108:111], v[60:63]
    ds_read_b128 v[188:191], v247 offset:30720
    v_mfma_f32_16x16x32_bf16 v[60:63], v[76:79], v[112:115], v[60:63]
    ds_read2_b32 v[156:157], v239 offset0:176 offset1:177
    v_mfma_f32_16x16x32_bf16 v[60:63], v[72:75], v[116:119], v[60:63]
    v_mfma_f32_16x16x32_bf16 v[60:63], v[68:71], v[120:123], v[60:63]
    ds_read2_b32 v[158:159], v239 offset0:178 offset1:179
    v_mfma_f32_16x16x32_bf16 v[60:63], v[64:67], v[124:127], v[60:63]
    s_waitcnt lgkmcnt(12)
    v_mfma_f32_16x16x32_bf16 v[32:35], v[128:131], v[160:163], v[32:35]
    ds_read_b128 v[96:99], v244 offset:0
    v_mfma_f32_16x16x32_bf16 v[36:39], v[132:135], v[160:163], v[36:39]
    v_mfma_f32_16x16x32_bf16 v[36:39], v[128:131], v[164:167], v[36:39]
    ds_read2_b32 v[64:65], v236 offset0:64 offset1:65
    v_mfma_f32_16x16x32_bf16 v[40:43], v[128:131], v[168:171], v[40:43]
    ds_read2_b32 v[66:67], v236 offset0:66 offset1:67
    v_mfma_f32_16x16x32_bf16 v[40:43], v[132:135], v[164:167], v[40:43]
    v_mfma_f32_16x16x32_bf16 v[40:43], v[136:139], v[160:163], v[40:43]
    ds_read_b128 v[100:103], v244 offset:4096
    v_mfma_f32_16x16x32_bf16 v[44:47], v[140:143], v[160:163], v[44:47]
    ds_read2_b32 v[68:69], v236 offset0:192 offset1:193
    v_mfma_f32_16x16x32_bf16 v[44:47], v[136:139], v[164:167], v[44:47]
    s_add_u32 m0, s9, 36864
    s_add_u32 s13, s10, 128
    v_mfma_f32_16x16x32_bf16 v[44:47], v[132:135], v[168:171], v[44:47]
    buffer_load_dwordx4 v15, s[44:47], s13 offen sc1 lds
    ds_read2_b32 v[70:71], v236 offset0:194 offset1:195
    v_mfma_f32_16x16x32_bf16 v[44:47], v[128:131], v[172:175], v[44:47]
    ds_read_b128 v[104:107], v244 offset:8192
    s_waitcnt lgkmcnt(7)
    v_mfma_f32_16x16x32_bf16 v[48:51], v[128:131], v[176:179], v[48:51]
    ds_read2_b32 v[72:73], v237 offset0:64 offset1:65
    v_mfma_f32_16x16x32_bf16 v[48:51], v[132:135], v[172:175], v[48:51]
    ds_read2_b32 v[74:75], v237 offset0:66 offset1:67
    v_mfma_f32_16x16x32_bf16 v[48:51], v[136:139], v[168:171], v[48:51]
    ds_read_b128 v[108:111], v244 offset:12288
    v_mfma_f32_16x16x32_bf16 v[48:51], v[140:143], v[164:167], v[48:51]
    ds_read2_b32 v[76:77], v237 offset0:192 offset1:193
    v_mfma_f32_16x16x32_bf16 v[48:51], v[144:147], v[160:163], v[48:51]
    ds_read2_b32 v[78:79], v237 offset0:194 offset1:195
    v_mfma_f32_16x16x32_bf16 v[52:55], v[148:151], v[160:163], v[52:55]
    ds_read_b128 v[112:115], v244 offset:16384
    v_mfma_f32_16x16x32_bf16 v[52:55], v[144:147], v[164:167], v[52:55]
    ds_read2_b32 v[80:81], v238 offset0:64 offset1:65
    s_add_u32 m0, s9, 37888
    s_add_u32 s13, s10, 73856
    v_mfma_f32_16x16x32_bf16 v[52:55], v[140:143], v[168:171], v[52:55]
    buffer_load_dwordx4 v16, s[44:47], s13 offen sc1 lds
    ds_read2_b32 v[82:83], v238 offset0:66 offset1:67
    v_mfma_f32_16x16x32_bf16 v[52:55], v[136:139], v[172:175], v[52:55]
    ds_read_b128 v[116:119], v244 offset:20480
    v_mfma_f32_16x16x32_bf16 v[52:55], v[132:135], v[176:179], v[52:55]
    ds_read2_b32 v[84:85], v238 offset0:192 offset1:193
    v_mfma_f32_16x16x32_bf16 v[52:55], v[128:131], v[180:183], v[52:55]
    ds_read2_b32 v[86:87], v238 offset0:194 offset1:195
    v_mfma_f32_16x16x32_bf16 v[56:59], v[128:131], v[184:187], v[56:59]
    ds_read_b128 v[120:123], v244 offset:24576
    s_waitcnt vmcnt(3)
    s_barrier
    v_mfma_f32_16x16x32_bf16 v[56:59], v[132:135], v[180:183], v[56:59]
    ds_read2_b32 v[88:89], v239 offset0:64 offset1:65
    v_add_u32 v10, 131072, v10
    v_mfma_f32_16x16x32_bf16 v[56:59], v[136:139], v[176:179], v[56:59]
    ds_read_b64_tr_b16 a[64:65], v10 offset:16384
    v_mfma_f32_16x16x32_bf16 v[56:59], v[140:143], v[172:175], v[56:59]
    ds_read2_b32 v[90:91], v239 offset0:66 offset1:67
    v_mfma_f32_16x16x32_bf16 v[56:59], v[144:147], v[168:171], v[56:59]
    ds_read_b64_tr_b16 a[66:67], v10 offset:18432
    s_add_u32 m0, s9, 38912
    s_add_u32 s13, s10, 147584
    v_mfma_f32_16x16x32_bf16 v[56:59], v[148:151], v[164:167], v[56:59]
    ds_read_b64_tr_b16 a[72:73], v10 offset:20480
    buffer_load_dwordx4 v15, s[44:47], s13 offen sc1 lds
    v_mfma_f32_16x16x32_bf16 v[56:59], v[152:155], v[160:163], v[56:59]
    ds_read_b64_tr_b16 a[74:75], v10 offset:22528
    v_mfma_f32_16x16x32_bf16 v[60:63], v[156:159], v[160:163], v[60:63]
    ds_read_b128 v[124:127], v244 offset:28672
    v_add_u32 v11, 131072, v11
    v_mfma_f32_16x16x32_bf16 v[60:63], v[152:155], v[164:167], v[60:63]
    ds_read_b64_tr_b16 a[68:69], v11 offset:16384
    v_mfma_f32_16x16x32_bf16 v[60:63], v[148:151], v[168:171], v[60:63]
    ds_read2_b32 v[92:93], v239 offset0:192 offset1:193
    v_mfma_f32_16x16x32_bf16 v[60:63], v[144:147], v[172:175], v[60:63]
    ds_read_b64_tr_b16 a[70:71], v11 offset:18432
    v_mfma_f32_16x16x32_bf16 v[60:63], v[140:143], v[176:179], v[60:63]
    ds_read_b64_tr_b16 a[76:77], v11 offset:20480
    v_mfma_f32_16x16x32_bf16 v[60:63], v[136:139], v[180:183], v[60:63]
    ds_read_b64_tr_b16 a[78:79], v11 offset:22528
    v_mfma_f32_16x16x32_bf16 v[60:63], v[132:135], v[184:187], v[60:63]
    ds_read2_b32 v[94:95], v239 offset0:194 offset1:195
    s_add_u32 m0, s9, 39936
    s_add_u32 s13, s10, 221312
    v_mfma_f32_16x16x32_bf16 v[60:63], v[128:131], v[188:191], v[60:63]
    buffer_load_dwordx4 v16, s[44:47], s13 offen sc1 lds
    s_waitcnt lgkmcnt(15)
    v_mfma_f32_16x16x32_bf16 v[32:35], v[64:67], v[96:99], v[32:35]
    ds_read_b128 v[160:163], v245 offset:0
    s_waitcnt lgkmcnt(2)
    s_barrier
    v_mfma_f32_16x16x32_bf16 v[36:39], v[68:71], v[96:99], v[36:39]
    v_mfma_f32_16x16x32_bf16 v[36:39], v[64:67], v[100:103], v[36:39]
    ds_read2_b32 v[128:129], v236 offset0:80 offset1:81
    v_mfma_f32_16x16x32_bf16 v[40:43], v[64:67], v[104:107], v[40:43]
    s_lshl_b32 s14, s89, 18
    ds_read2_b32 v[130:131], v236 offset0:82 offset1:83
    v_mfma_f32_16x16x32_bf16 v[40:43], v[68:71], v[100:103], v[40:43]
    s_add_u32 m0, s73, 147456
    v_mfma_f32_16x16x32_bf16 v[40:43], v[72:75], v[96:99], v[40:43]
    buffer_load_dwordx4 v4, s[52:55], s14 offen offset:0 lds
    ds_read_b128 v[164:167], v245 offset:4096
    v_mfma_f32_16x16x32_bf16 v[44:47], v[76:79], v[96:99], v[44:47]
    ds_read2_b32 v[132:133], v236 offset0:208 offset1:209
    v_mfma_f32_16x16x32_bf16 v[44:47], v[72:75], v[100:103], v[44:47]
    s_add_u32 m0, s9, 40960
    s_add_u32 s13, s10, 295040
    v_mfma_f32_16x16x32_bf16 v[44:47], v[68:71], v[104:107], v[44:47]
    buffer_load_dwordx4 v15, s[44:47], s13 offen sc1 lds
    ds_read2_b32 v[134:135], v236 offset0:210 offset1:211
    v_mfma_f32_16x16x32_bf16 v[44:47], v[64:67], v[108:111], v[44:47]
    ds_read_b128 v[168:171], v245 offset:8192
    s_waitcnt lgkmcnt(7)
    v_mfma_f32_16x16x32_bf16 v[48:51], v[64:67], v[112:115], v[48:51]
    ds_read2_b32 v[136:137], v237 offset0:80 offset1:81
    v_mfma_f32_16x16x32_bf16 v[48:51], v[68:71], v[108:111], v[48:51]
    ds_read2_b32 v[138:139], v237 offset0:82 offset1:83
    v_mfma_f32_16x16x32_bf16 v[48:51], v[72:75], v[104:107], v[48:51]
    ds_read_b128 v[172:175], v245 offset:12288
    v_mfma_f32_16x16x32_bf16 v[48:51], v[76:79], v[100:103], v[48:51]
    ds_read2_b32 v[140:141], v237 offset0:208 offset1:209
    v_mfma_f32_16x16x32_bf16 v[48:51], v[80:83], v[96:99], v[48:51]
    ds_read2_b32 v[142:143], v237 offset0:210 offset1:211
    v_mfma_f32_16x16x32_bf16 v[52:55], v[84:87], v[96:99], v[52:55]
    ds_read_b128 v[176:179], v245 offset:16384
    v_mfma_f32_16x16x32_bf16 v[52:55], v[80:83], v[100:103], v[52:55]
    s_add_u32 m0, s73, 147456
    ds_read2_b32 v[144:145], v238 offset0:80 offset1:81
    v_mfma_f32_16x16x32_bf16 v[52:55], v[76:79], v[104:107], v[52:55]
    buffer_load_dwordx4 v5, s[52:55], s14 offen offset:1024 lds
    ds_read2_b32 v[146:147], v238 offset0:82 offset1:83
L_pl_X_3:
    s_cbranch_execz L_pl_X_7
    v_mfma_f32_16x16x32_bf16 v[52:55], v[72:75], v[108:111], v[52:55]
    ds_read_b128 v[180:183], v245 offset:20480
    s_add_u32 m0, s9, 41984
    s_add_u32 s13, s10, 368768
    v_mfma_f32_16x16x32_bf16 v[52:55], v[68:71], v[112:115], v[52:55]
    buffer_load_dwordx4 v16, s[44:47], s13 offen sc1 lds
    ds_read_b128 v[212:215], v241 offset:32
    v_mfma_f32_16x16x32_bf16 v[52:55], v[64:67], v[116:119], v[52:55]
    ds_read2_b32 v[148:149], v238 offset0:208 offset1:209
    v_mfma_f32_16x16x32_bf16 v[56:59], v[64:67], v[120:123], v[56:59]
    ds_read_b32 v216, v241 offset:48
    v_mfma_f32_16x16x32_bf16 v[56:59], v[68:71], v[116:119], v[56:59]
    ds_read2_b32 v[150:151], v238 offset0:210 offset1:211
    v_mfma_f32_16x16x32_bf16 v[56:59], v[72:75], v[112:115], v[56:59]
    ds_read_b128 v[218:221], v241 offset:1056
    v_mfma_f32_16x16x32_bf16 v[56:59], v[76:79], v[108:111], v[56:59]
    ds_read_b128 v[184:187], v245 offset:24576
    v_mfma_f32_16x16x32_bf16 v[56:59], v[80:83], v[104:107], v[56:59]
    ds_read2_b32 v[152:153], v239 offset0:80 offset1:81
    s_add_u32 m0, s9, 43008
    s_add_u32 s13, s10, 442496
    v_mfma_f32_16x16x32_bf16 v[56:59], v[84:87], v[100:103], v[56:59]
    buffer_load_dwordx4 v15, s[44:47], s13 offen sc1 lds
    ds_read_b32 v222, v241 offset:1072
    v_mfma_f32_16x16x32_bf16 v[56:59], v[88:91], v[96:99], v[56:59]
    ds_read2_b32 v[154:155], v239 offset0:82 offset1:83
    v_mfma_f32_16x16x32_bf16 v[60:63], v[92:95], v[96:99], v[60:63]
    s_add_u32 m0, s73, 147456
    ds_read_b128 v[224:227], v241 offset:2080
    v_mfma_f32_16x16x32_bf16 v[60:63], v[88:91], v[100:103], v[60:63]
    buffer_load_dwordx4 v6, s[52:55], s14 offen offset:2048 lds
    ds_read_b128 v[188:191], v245 offset:28672
    v_mfma_f32_16x16x32_bf16 v[60:63], v[84:87], v[104:107], v[60:63]
    ds_read_b32 v228, v241 offset:2096
    v_mfma_f32_16x16x32_bf16 v[60:63], v[80:83], v[108:111], v[60:63]
    ds_read2_b32 v[156:157], v239 offset0:208 offset1:209
    v_mfma_f32_16x16x32_bf16 v[60:63], v[76:79], v[112:115], v[60:63]
    ds_read_b128 v[230:233], v241 offset:3104
    v_mfma_f32_16x16x32_bf16 v[60:63], v[72:75], v[116:119], v[60:63]
    ds_read2_b32 v[158:159], v239 offset0:210 offset1:211
    v_mfma_f32_16x16x32_bf16 v[60:63], v[68:71], v[120:123], v[60:63]
    ds_read_b32 v234, v241 offset:3120
    s_add_u32 m0, s9, 44032
    s_add_u32 s13, s10, 516224
    v_mfma_f32_16x16x32_bf16 v[60:63], v[64:67], v[124:127], v[60:63]
    buffer_load_dwordx4 v16, s[44:47], s13 offen sc1 lds
    s_waitcnt lgkmcnt(15)
    v_mfma_f32_16x16x32_bf16 v[32:35], v[128:131], v[160:163], v[32:35]
    ds_read_b128 v[96:99], v246 offset:0
    v_mfma_f32_16x16x32_bf16 v[36:39], v[132:135], v[160:163], v[36:39]
    v_mfma_f32_16x16x32_bf16 v[36:39], v[128:131], v[164:167], v[36:39]
    ds_read2_b32 v[64:65], v236 offset0:96 offset1:97
    v_mfma_f32_16x16x32_bf16 v[40:43], v[128:131], v[168:171], v[40:43]
    s_add_u32 m0, s73, 147456
    ds_read2_b32 v[66:67], v236 offset0:98 offset1:99
    v_mfma_f32_16x16x32_bf16 v[40:43], v[132:135], v[164:167], v[40:43]
    buffer_load_dwordx4 v7, s[52:55], s14 offen offset:3072 lds
    s_waitcnt lgkmcnt(3)
    v_mfma_f32_16x16x32_bf16 v[40:43], v[136:139], v[160:163], v[40:43]
    ds_read_b128 v[100:103], v246 offset:4096
    v_mfma_f32_16x16x32_bf16 v[44:47], v[140:143], v[160:163], v[44:47]
    s_waitcnt vmcnt(12)
    ds_read2_b32 v[68:69], v236 offset0:224 offset1:225
    v_mfma_f32_16x16x32_bf16 v[44:47], v[136:139], v[164:167], v[44:47]
    v_mfma_f32_16x16x32_bf16 v[44:47], v[132:135], v[168:171], v[44:47]
    ds_read2_b32 v[70:71], v236 offset0:226 offset1:227
    v_lshlrev_b32 v9, 16, v9
    v_mfma_f32_16x16x32_bf16 v[44:47], v[128:131], v[172:175], v[44:47]
    ds_read_b128 v[104:107], v246 offset:8192
    v_mfma_f32_16x16x32_bf16 v[48:51], v[128:131], v[176:179], v[48:51]
    ds_read2_b32 v[72:73], v237 offset0:96 offset1:97
    v_lshlrev_b32 v208, 16, v212
    v_mfma_f32_16x16x32_bf16 v[48:51], v[132:135], v[172:175], v[48:51]
    v_mfma_f32_16x16x32_bf16 v[48:51], v[136:139], v[168:171], v[48:51]
    ds_read2_b32 v[74:75], v237 offset0:98 offset1:99
    v_add_f32 v9, v9, v208
    v_mfma_f32_16x16x32_bf16 v[48:51], v[140:143], v[164:167], v[48:51]
    ds_read_b128 v[108:111], v246 offset:12288
    v_cvt_pk_bf16_f32 v9, v9, v9
    v_mfma_f32_16x16x32_bf16 v[48:51], v[144:147], v[160:163], v[48:51]
    ds_read2_b32 v[76:77], v237 offset0:224 offset1:225
    v_mfma_f32_16x16x32_bf16 v[52:55], v[148:151], v[160:163], v[52:55]
    ds_write_b16 v242, v9 offset:4160
    v_mfma_f32_16x16x32_bf16 v[52:55], v[144:147], v[164:167], v[52:55]
    ds_read2_b32 v[78:79], v237 offset0:226 offset1:227
    v_mfma_f32_16x16x32_bf16 v[52:55], v[140:143], v[168:171], v[52:55]
    ds_write_b16 v242, v9 offset:2
    v_mfma_f32_16x16x32_bf16 v[52:55], v[136:139], v[172:175], v[52:55]
    ds_read_b128 v[112:115], v246 offset:16384
    v_mfma_f32_16x16x32_bf16 v[52:55], v[132:135], v[176:179], v[52:55]
    ds_read2_b32 v[80:81], v238 offset0:96 offset1:97
    v_alignbit_b32 v212, v213, v212, 16
    v_mfma_f32_16x16x32_bf16 v[52:55], v[128:131], v[180:183], v[52:55]
    v_alignbit_b32 v213, v214, v213, 16
    v_mfma_f32_16x16x32_bf16 v[56:59], v[128:131], v[184:187], v[56:59]
    ds_read2_b32 v[82:83], v238 offset0:98 offset1:99
    v_mfma_f32_16x16x32_bf16 v[56:59], v[132:135], v[180:183], v[56:59]
    ds_read_b128 v[116:119], v246 offset:20480
    v_alignbit_b32 v214, v215, v214, 16
    v_mfma_f32_16x16x32_bf16 v[56:59], v[136:139], v[176:179], v[56:59]
    v_mfma_f32_16x16x32_bf16 v[56:59], v[140:143], v[172:175], v[56:59]
    ds_read2_b32 v[84:85], v238 offset0:224 offset1:225
    v_alignbit_b32 v215, v216, v215, 16
    v_mfma_f32_16x16x32_bf16 v[56:59], v[144:147], v[168:171], v[56:59]
    ds_read2_b32 v[86:87], v238 offset0:226 offset1:227
    v_mfma_f32_16x16x32_bf16 v[56:59], v[148:151], v[164:167], v[56:59]
    ds_write_b128 v241, v[212:215] offset:4192
    v_mfma_f32_16x16x32_bf16 v[56:59], v[152:155], v[160:163], v[56:59]
    ds_read_b128 v[120:123], v246 offset:24576
    v_mfma_f32_16x16x32_bf16 v[60:63], v[156:159], v[160:163], v[60:63]
    ds_read2_b32 v[88:89], v239 offset0:96 offset1:97
    v_alignbit_b32 v218, v219, v218, 16
    v_mfma_f32_16x16x32_bf16 v[60:63], v[152:155], v[164:167], v[60:63]
    ds_read2_b32 v[90:91], v239 offset0:98 offset1:99
    v_alignbit_b32 v219, v220, v219, 16
    v_mfma_f32_16x16x32_bf16 v[60:63], v[148:151], v[168:171], v[60:63]
    v_mfma_f32_16x16x32_bf16 v[60:63], v[144:147], v[172:175], v[60:63]
    ds_read_b128 v[124:127], v246 offset:28672
    v_alignbit_b32 v220, v221, v220, 16
    v_mfma_f32_16x16x32_bf16 v[60:63], v[140:143], v[176:179], v[60:63]
    ds_read2_b32 v[92:93], v239 offset0:224 offset1:225
    v_mfma_f32_16x16x32_bf16 v[60:63], v[136:139], v[180:183], v[60:63]
    ds_read2_b32 v[94:95], v239 offset0:226 offset1:227
    v_alignbit_b32 v221, v222, v221, 16
    v_mfma_f32_16x16x32_bf16 v[60:63], v[132:135], v[184:187], v[60:63]
    ds_write_b128 v241, v[218:221] offset:5216
    v_mfma_f32_16x16x32_bf16 v[60:63], v[128:131], v[188:191], v[60:63]
    s_waitcnt lgkmcnt(15)
    v_mfma_f32_16x16x32_bf16 v[32:35], v[64:67], v[96:99], v[32:35]
    ds_read_b128 v[160:163], v247 offset:0
    v_mfma_f32_16x16x32_bf16 v[36:39], v[68:71], v[96:99], v[36:39]
    v_alignbit_b32 v224, v225, v224, 16
    v_mfma_f32_16x16x32_bf16 v[36:39], v[64:67], v[100:103], v[36:39]
    ds_read_b128 v[164:167], v247 offset:4096
    v_mfma_f32_16x16x32_bf16 v[40:43], v[64:67], v[104:107], v[40:43]
    ds_read_b128 v[168:171], v247 offset:8192
    v_mfma_f32_16x16x32_bf16 v[40:43], v[68:71], v[100:103], v[40:43]
    ds_read_b128 v[172:175], v247 offset:12288
    v_mfma_f32_16x16x32_bf16 v[40:43], v[72:75], v[96:99], v[40:43]
    v_alignbit_b32 v225, v226, v225, 16
    v_mfma_f32_16x16x32_bf16 v[44:47], v[76:79], v[96:99], v[44:47]
    ds_read_b128 v[176:179], v247 offset:16384
    v_mfma_f32_16x16x32_bf16 v[44:47], v[72:75], v[100:103], v[44:47]
    ds_read_b128 v[180:183], v247 offset:20480
    v_mfma_f32_16x16x32_bf16 v[44:47], v[68:71], v[104:107], v[44:47]
    ds_read_b128 v[184:187], v247 offset:24576
    v_mfma_f32_16x16x32_bf16 v[44:47], v[64:67], v[108:111], v[44:47]
    v_alignbit_b32 v226, v227, v226, 16
    s_waitcnt lgkmcnt(8)
    v_mfma_f32_16x16x32_bf16 v[48:51], v[64:67], v[112:115], v[48:51]
    ds_read_b128 v[188:191], v247 offset:28672
    v_mfma_f32_16x16x32_bf16 v[48:51], v[68:71], v[108:111], v[48:51]
    ds_read2_b32 v[128:129], v236 offset0:112 offset1:113
    v_mfma_f32_16x16x32_bf16 v[48:51], v[72:75], v[104:107], v[48:51]
    v_alignbit_b32 v227, v228, v227, 16
    v_mfma_f32_16x16x32_bf16 v[48:51], v[76:79], v[100:103], v[48:51]
    ds_read2_b32 v[130:131], v236 offset0:114 offset1:115
    v_mfma_f32_16x16x32_bf16 v[48:51], v[80:83], v[96:99], v[48:51]
    ds_read2_b32 v[132:133], v236 offset0:240 offset1:241
    v_mfma_f32_16x16x32_bf16 v[52:55], v[84:87], v[96:99], v[52:55]
    ds_read2_b32 v[134:135], v236 offset0:242 offset1:243
    v_mfma_f32_16x16x32_bf16 v[52:55], v[80:83], v[100:103], v[52:55]
    ds_write_b128 v241, v[224:227] offset:6240
    v_mfma_f32_16x16x32_bf16 v[52:55], v[76:79], v[104:107], v[52:55]
    ds_read2_b32 v[136:137], v237 offset0:112 offset1:113
    ds_read2_b32 v[138:139], v237 offset0:114 offset1:115
    v_mfma_f32_16x16x32_bf16 v[52:55], v[72:75], v[108:111], v[52:55]
    s_add_u32 s6, s12, 4734976
    ds_read2_b32 v[140:141], v237 offset0:240 offset1:241
    v_mfma_f32_16x16x32_bf16 v[52:55], v[68:71], v[112:115], v[52:55]
    ds_read2_b32 v[142:143], v237 offset0:242 offset1:243
    v_alignbit_b32 v230, v231, v230, 16
    v_xor_b32 v244, 64, v244
    v_mfma_f32_16x16x32_bf16 v[52:55], v[64:67], v[116:119], v[52:55]
    ds_read2_b32 v[144:145], v238 offset0:112 offset1:113
    v_mfma_f32_16x16x32_bf16 v[56:59], v[64:67], v[120:123], v[56:59]
    ds_read2_b32 v[146:147], v238 offset0:114 offset1:115
    v_xor_b32 v245, 64, v245
    v_mfma_f32_16x16x32_bf16 v[56:59], v[68:71], v[116:119], v[56:59]
    ds_read2_b32 v[148:149], v238 offset0:240 offset1:241
    v_mfma_f32_16x16x32_bf16 v[56:59], v[72:75], v[112:115], v[56:59]
    v_alignbit_b32 v231, v232, v231, 16
    v_xor_b32 v246, 64, v246
    v_mfma_f32_16x16x32_bf16 v[56:59], v[76:79], v[108:111], v[56:59]
    ds_read2_b32 v[150:151], v238 offset0:242 offset1:243
    v_mfma_f32_16x16x32_bf16 v[56:59], v[80:83], v[104:107], v[56:59]
    ds_read2_b32 v[152:153], v239 offset0:112 offset1:113
    v_xor_b32 v247, 64, v247
    v_mfma_f32_16x16x32_bf16 v[56:59], v[84:87], v[100:103], v[56:59]
    ds_read2_b32 v[154:155], v239 offset0:114 offset1:115
    v_mfma_f32_16x16x32_bf16 v[56:59], v[88:91], v[96:99], v[56:59]
    ds_read2_b32 v[156:157], v239 offset0:240 offset1:241
    v_alignbit_b32 v232, v233, v232, 16
    v_mfma_f32_16x16x32_bf16 v[60:63], v[92:95], v[96:99], v[60:63]
    ds_read2_b32 v[158:159], v239 offset0:242 offset1:243
    v_add_u32 v244, 36864, v244
    v_mfma_f32_16x16x32_bf16 v[60:63], v[88:91], v[100:103], v[60:63]
    v_add_u32 v236, -8320, v236
    v_mfma_f32_16x16x32_bf16 v[60:63], v[84:87], v[104:107], v[60:63]
    v_alignbit_b32 v233, v234, v233, 16
    v_add_u32 v245, 36864, v245
    v_mfma_f32_16x16x32_bf16 v[60:63], v[80:83], v[108:111], v[60:63]
    v_add_u32 v237, -8320, v237
    v_mfma_f32_16x16x32_bf16 v[60:63], v[76:79], v[112:115], v[60:63]
    s_waitcnt vmcnt(1)
    s_barrier
    v_add_u32 v246, 36864, v246
    v_mfma_f32_16x16x32_bf16 v[60:63], v[72:75], v[116:119], v[60:63]
    v_add_u32 v238, -8320, v238
    v_add_u32 v239, -8320, v239
    v_mfma_f32_16x16x32_bf16 v[60:63], v[68:71], v[120:123], v[60:63]
    ds_write_b128 v241, v[230:233] offset:7264
    v_mfma_f32_16x16x32_bf16 v[60:63], v[64:67], v[124:127], v[60:63]
    v_add_u32 v247, 36864, v247
    s_waitcnt lgkmcnt(1)
    v_mfma_f32_16x16x32_bf16 v[60:63], v[128:131], v[188:191], v[60:63]
    ds_read_b128 v[96:99], v244 offset:2048
    v_mfma_f32_16x16x32_bf16 v[60:63], v[132:135], v[184:187], v[60:63]
    ds_read2_b32 v[64:65], v236 offset0:0 offset1:1
    v_mfma_f32_16x16x32_bf16 v[60:63], v[136:139], v[180:183], v[60:63]
    ds_read2_b32 v[66:67], v236 offset0:2 offset1:3
    v_mfma_f32_16x16x32_bf16 v[60:63], v[140:143], v[176:179], v[60:63]
    ds_read_b128 v[100:103], v244 offset:6144
    v_mfma_f32_16x16x32_bf16 v[60:63], v[144:147], v[172:175], v[60:63]
    ds_read2_b32 v[68:69], v236 offset0:128 offset1:129
    v_mfma_f32_16x16x32_bf16 v[60:63], v[148:151], v[168:171], v[60:63]
    ds_read2_b32 v[70:71], v236 offset0:130 offset1:131
    v_mfma_f32_16x16x32_bf16 v[60:63], v[152:155], v[164:167], v[60:63]
    ds_read_b128 v[104:107], v244 offset:10240
    v_mfma_f32_16x16x32_bf16 v[60:63], v[156:159], v[160:163], v[60:63]
    ds_read2_b32 v[72:73], v237 offset0:0 offset1:1
    v_mfma_f32_16x16x32_bf16 v[56:59], v[128:131], v[184:187], v[56:59]
    ds_read2_b32 v[74:75], v237 offset0:2 offset1:3
    v_mfma_f32_16x16x32_bf16 v[56:59], v[132:135], v[180:183], v[56:59]
    ds_read_b128 v[108:111], v244 offset:14336
    v_mfma_f32_16x16x32_bf16 v[56:59], v[136:139], v[176:179], v[56:59]
    ds_read2_b32 v[76:77], v237 offset0:128 offset1:129
    v_mfma_f32_16x16x32_bf16 v[56:59], v[140:143], v[172:175], v[56:59]
    ds_read2_b32 v[78:79], v237 offset0:130 offset1:131
    v_mfma_f32_16x16x32_bf16 v[56:59], v[144:147], v[168:171], v[56:59]
    ds_read_b128 v[112:115], v244 offset:18432
    v_mfma_f32_16x16x32_bf16 v[56:59], v[148:151], v[164:167], v[56:59]
    ds_read2_b32 v[80:81], v238 offset0:0 offset1:1
    v_cvt_pk_bf16_f32 v206, v60, v61
    v_mfma_f32_16x16x32_bf16 v[56:59], v[152:155], v[160:163], v[56:59]
    ds_read2_b32 v[82:83], v238 offset0:2 offset1:3
    v_mfma_f32_16x16x32_bf16 v[52:55], v[128:131], v[180:183], v[52:55]
    ds_read_b128 v[116:119], v244 offset:22528
    v_mfma_f32_16x16x32_bf16 v[52:55], v[132:135], v[176:179], v[52:55]
    ds_read2_b32 v[84:85], v238 offset0:128 offset1:129
    v_cvt_pk_bf16_f32 v207, v62, v63
    v_mfma_f32_16x16x32_bf16 v[52:55], v[136:139], v[172:175], v[52:55]
    ds_read2_b32 v[86:87], v238 offset0:130 offset1:131
    v_mfma_f32_16x16x32_bf16 v[52:55], v[140:143], v[168:171], v[52:55]
    buffer_store_dwordx2 v[206:207], v8, s[44:47], s6 offen offset:3584 sc1
    ds_read_b128 v[120:123], v244 offset:26624
    v_mfma_f32_16x16x32_bf16 v[52:55], v[144:147], v[164:167], v[52:55]
    ds_read2_b32 v[88:89], v239 offset0:0 offset1:1
    v_mfma_f32_16x16x32_bf16 v[52:55], v[148:151], v[160:163], v[52:55]
    ds_read2_b32 v[90:91], v239 offset0:2 offset1:3
    v_mfma_f32_16x16x32_bf16 v[48:51], v[128:131], v[176:179], v[48:51]
    s_waitcnt vmcnt(1)
    s_barrier
    v_cvt_pk_bf16_f32 v204, v56, v57
    v_mfma_f32_16x16x32_bf16 v[48:51], v[132:135], v[172:175], v[48:51]
    ds_read_b128 v[124:127], v244 offset:30720
    v_mfma_f32_16x16x32_bf16 v[48:51], v[136:139], v[168:171], v[48:51]
    ds_read_b64_tr_b16 a[80:81], v10 offset:16384
    v_mfma_f32_16x16x32_bf16 v[48:51], v[140:143], v[164:167], v[48:51]
    ds_read_b64_tr_b16 a[82:83], v10 offset:18432
    v_cvt_pk_bf16_f32 v205, v58, v59
    v_mfma_f32_16x16x32_bf16 v[48:51], v[144:147], v[160:163], v[48:51]
    ds_read_b64_tr_b16 a[88:89], v10 offset:20480
    v_mfma_f32_16x16x32_bf16 v[44:47], v[128:131], v[172:175], v[44:47]
    buffer_store_dwordx2 v[204:205], v8, s[44:47], s6 offen offset:3072 sc1
    ds_read2_b32 v[92:93], v239 offset0:128 offset1:129
    v_mfma_f32_16x16x32_bf16 v[44:47], v[132:135], v[168:171], v[44:47]
    ds_read_b64_tr_b16 a[90:91], v10 offset:22528
    v_mfma_f32_16x16x32_bf16 v[44:47], v[136:139], v[164:167], v[44:47]
    ds_read_b64_tr_b16 a[84:85], v11 offset:16384
    ds_read2_b32 v[94:95], v239 offset0:130 offset1:131
    v_mfma_f32_16x16x32_bf16 v[44:47], v[140:143], v[160:163], v[44:47]
    v_cvt_pk_bf16_f32 v202, v52, v53
    v_mfma_f32_16x16x32_bf16 v[40:43], v[128:131], v[168:171], v[40:43]
    ds_read_b64_tr_b16 a[86:87], v11 offset:18432
    v_mfma_f32_16x16x32_bf16 v[40:43], v[132:135], v[164:167], v[40:43]
    ds_read_b64_tr_b16 a[92:93], v11 offset:20480
    v_mfma_f32_16x16x32_bf16 v[40:43], v[136:139], v[160:163], v[40:43]
    v_cvt_pk_bf16_f32 v203, v54, v55
    v_mfma_f32_16x16x32_bf16 v[36:39], v[128:131], v[164:167], v[36:39]
    ds_read_b64_tr_b16 a[94:95], v11 offset:22528
    v_mfma_f32_16x16x32_bf16 v[36:39], v[132:135], v[160:163], v[36:39]
    buffer_store_dwordx2 v[202:203], v8, s[44:47], s6 offen offset:2560 sc1
    v_mfma_f32_16x16x32_bf16 v[32:35], v[128:131], v[160:163], v[32:35]
    s_waitcnt lgkmcnt(3)
    v_mfma_f32_16x16x32_bf16 v[60:63], v[64:67], v[124:127], 0
    ds_read_b128 v[160:163], v245 offset:2048
    s_waitcnt lgkmcnt(1)
    s_barrier
    v_mfma_f32_16x16x32_bf16 v[60:63], v[68:71], v[120:123], v[60:63]
    v_cvt_pk_bf16_f32 v200, v48, v49
    v_mfma_f32_16x16x32_bf16 v[60:63], v[72:75], v[116:119], v[60:63]
    ds_read2_b32 v[128:129], v236 offset0:16 offset1:17
    v_mfma_f32_16x16x32_bf16 v[60:63], v[76:79], v[112:115], v[60:63]
    ds_read2_b32 v[130:131], v236 offset0:18 offset1:19
    s_lshl_b32 s14, s90, 18
    v_cvt_pk_bf16_f32 v201, v50, v51
    v_mfma_f32_16x16x32_bf16 v[60:63], v[80:83], v[108:111], v[60:63]
    s_add_u32 m0, s73, 147456
    v_mfma_f32_16x16x32_bf16 v[60:63], v[84:87], v[104:107], v[60:63]
    buffer_load_dwordx4 v4, s[52:55], s14 offen offset:0 lds
    ds_read_b128 v[164:167], v245 offset:6144
    v_mfma_f32_16x16x32_bf16 v[60:63], v[88:91], v[100:103], v[60:63]
    buffer_store_dwordx2 v[200:201], v8, s[44:47], s6 offen offset:2048 sc1
    ds_read2_b32 v[132:133], v236 offset0:144 offset1:145
    v_mfma_f32_16x16x32_bf16 v[60:63], v[92:95], v[96:99], v[60:63]
    s_add_u32 s13, s12, 49152
    v_cvt_pk_bf16_f32 v198, v44, v45
    v_mfma_f32_16x16x32_bf16 v[56:59], v[64:67], v[120:123], 0
    ds_read2_b32 v[134:135], v236 offset0:146 offset1:147
    v_mfma_f32_16x16x32_bf16 v[56:59], v[68:71], v[116:119], v[56:59]
    s_add_u32 m0, s74, 8352
    ds_read_b128 v[168:171], v245 offset:10240
    v_mfma_f32_16x16x32_bf16 v[56:59], v[72:75], v[112:115], v[56:59]
    buffer_load_dwordx4 v240, s[48:51], s13 offen offset:0 lds
    v_cvt_pk_bf16_f32 v199, v46, v47
    v_mfma_f32_16x16x32_bf16 v[56:59], v[76:79], v[108:111], v[56:59]
    ds_read2_b32 v[136:137], v237 offset0:16 offset1:17
    v_mfma_f32_16x16x32_bf16 v[56:59], v[80:83], v[104:107], v[56:59]
    buffer_store_dwordx2 v[198:199], v8, s[44:47], s6 offen offset:1536 sc1
    ds_read2_b32 v[138:139], v237 offset0:18 offset1:19
    v_mfma_f32_16x16x32_bf16 v[56:59], v[84:87], v[100:103], v[56:59]
    ds_read_b128 v[172:175], v245 offset:14336
    v_mfma_f32_16x16x32_bf16 v[56:59], v[88:91], v[96:99], v[56:59]
    v_cvt_pk_bf16_f32 v196, v40, v41
    v_mfma_f32_16x16x32_bf16 v[52:55], v[64:67], v[116:119], 0
    ds_read2_b32 v[140:141], v237 offset0:144 offset1:145
    v_mfma_f32_16x16x32_bf16 v[52:55], v[68:71], v[112:115], v[52:55]
    ds_read2_b32 v[142:143], v237 offset0:146 offset1:147
    s_add_u32 m0, s73, 147456
    v_cvt_pk_bf16_f32 v197, v42, v43
    v_mfma_f32_16x16x32_bf16 v[52:55], v[72:75], v[108:111], v[52:55]
    buffer_load_dwordx4 v5, s[52:55], s14 offen offset:1024 lds
    v_mfma_f32_16x16x32_bf16 v[52:55], v[76:79], v[104:107], v[52:55]
    buffer_store_dwordx2 v[196:197], v8, s[44:47], s6 offen offset:1024 sc1
    ds_read_b128 v[176:179], v245 offset:18432
    s_add_u32 m0, s74, 8352
    v_mfma_f32_16x16x32_bf16 v[52:55], v[80:83], v[100:103], v[52:55]
    buffer_load_dwordx4 v240, s[48:51], s13 offen offset:1024 lds
    ds_read2_b32 v[144:145], v238 offset0:16 offset1:17
    v_mfma_f32_16x16x32_bf16 v[52:55], v[84:87], v[96:99], v[52:55]
    v_mfma_f32_16x16x32_bf16 v[48:51], v[64:67], v[112:115], 0
    ds_read2_b32 v[146:147], v238 offset0:18 offset1:19
    v_cvt_pk_bf16_f32 v194, v36, v37
    v_mfma_f32_16x16x32_bf16 v[48:51], v[68:71], v[108:111], v[48:51]
    ds_read_b128 v[180:183], v245 offset:22528
    v_mfma_f32_16x16x32_bf16 v[48:51], v[72:75], v[104:107], v[48:51]
    v_cvt_pk_bf16_f32 v195, v38, v39
    v_mfma_f32_16x16x32_bf16 v[48:51], v[76:79], v[100:103], v[48:51]
    buffer_store_dwordx2 v[194:195], v8, s[44:47], s6 offen offset:512 sc1
    ds_read2_b32 v[148:149], v238 offset0:144 offset1:145
    s_add_u32 m0, s74, 8352
    v_mfma_f32_16x16x32_bf16 v[48:51], v[80:83], v[96:99], v[48:51]
    buffer_load_dwordx4 v240, s[48:51], s13 offen offset:2048 lds
    ds_read2_b32 v[150:151], v238 offset0:146 offset1:147
    v_mfma_f32_16x16x32_bf16 v[44:47], v[64:67], v[108:111], 0
    ds_read_b128 v[184:187], v245 offset:26624
    v_mfma_f32_16x16x32_bf16 v[44:47], v[68:71], v[104:107], v[44:47]
    v_cvt_pk_bf16_f32 v192, v32, v33
    v_mfma_f32_16x16x32_bf16 v[44:47], v[72:75], v[100:103], v[44:47]
    s_add_u32 m0, s73, 147456
    ds_read2_b32 v[152:153], v239 offset0:16 offset1:17
    v_mfma_f32_16x16x32_bf16 v[44:47], v[76:79], v[96:99], v[44:47]
    buffer_load_dwordx4 v6, s[52:55], s14 offen offset:2048 lds
    v_cvt_pk_bf16_f32 v193, v34, v35
    v_mfma_f32_16x16x32_bf16 v[40:43], v[64:67], v[104:107], 0
    ds_read2_b32 v[154:155], v239 offset0:18 offset1:19
    v_mfma_f32_16x16x32_bf16 v[40:43], v[68:71], v[100:103], v[40:43]
    buffer_store_dwordx2 v[192:193], v8, s[44:47], s6 offen offset:0 sc1
    ds_read_b128 v[188:191], v245 offset:30720
    v_mfma_f32_16x16x32_bf16 v[40:43], v[72:75], v[96:99], v[40:43]
    s_add_u32 m0, s74, 8352
    ds_read2_b32 v[156:157], v239 offset0:144 offset1:145
    v_mfma_f32_16x16x32_bf16 v[36:39], v[64:67], v[100:103], 0
    buffer_load_dwordx4 v240, s[48:51], s13 offen offset:3072 lds
    v_mfma_f32_16x16x32_bf16 v[36:39], v[68:71], v[96:99], v[36:39]
    ds_read2_b32 v[158:159], v239 offset0:146 offset1:147
    v_mfma_f32_16x16x32_bf16 v[32:35], v[64:67], v[96:99], 0
    s_waitcnt lgkmcnt(12)
    v_mfma_f32_16x16x32_bf16 v[32:35], v[128:131], v[160:163], v[32:35]
    ds_read_b128 v[96:99], v246 offset:2048
    v_mfma_f32_16x16x32_bf16 v[36:39], v[132:135], v[160:163], v[36:39]
    v_mfma_f32_16x16x32_bf16 v[36:39], v[128:131], v[164:167], v[36:39]
    ds_read2_b32 v[64:65], v236 offset0:32 offset1:33
    v_mfma_f32_16x16x32_bf16 v[40:43], v[128:131], v[168:171], v[40:43]
    s_barrier
    ds_read2_b32 v[66:67], v236 offset0:34 offset1:35
    s_add_u32 m0, s73, 147456
    v_mfma_f32_16x16x32_bf16 v[40:43], v[132:135], v[164:167], v[40:43]
    buffer_load_dwordx4 v7, s[52:55], s14 offen offset:3072 lds
    v_mfma_f32_16x16x32_bf16 v[40:43], v[136:139], v[160:163], v[40:43]
    ds_read_b128 v[100:103], v246 offset:6144
    v_mfma_f32_16x16x32_bf16 v[44:47], v[140:143], v[160:163], v[44:47]
    ds_read2_b32 v[68:69], v236 offset0:160 offset1:161
    v_mfma_f32_16x16x32_bf16 v[44:47], v[136:139], v[164:167], v[44:47]
    v_mfma_f32_16x16x32_bf16 v[44:47], v[132:135], v[168:171], v[44:47]
    ds_read2_b32 v[70:71], v236 offset0:162 offset1:163
    v_mfma_f32_16x16x32_bf16 v[44:47], v[128:131], v[172:175], v[44:47]
    ds_read_b128 v[104:107], v246 offset:10240
    s_waitcnt lgkmcnt(7)
    v_mfma_f32_16x16x32_bf16 v[48:51], v[128:131], v[176:179], v[48:51]
    ds_read2_b32 v[72:73], v237 offset0:32 offset1:33
    v_mfma_f32_16x16x32_bf16 v[48:51], v[132:135], v[172:175], v[48:51]
    ds_read2_b32 v[74:75], v237 offset0:34 offset1:35
    v_mfma_f32_16x16x32_bf16 v[48:51], v[136:139], v[168:171], v[48:51]
    v_mov_b32 v9, 24
    buffer_load_ushort v9, v9, s[56:59], s70 offen
    v_mfma_f32_16x16x32_bf16 v[48:51], v[140:143], v[164:167], v[48:51]
    ds_read_b128 v[108:111], v246 offset:14336
    v_mfma_f32_16x16x32_bf16 v[48:51], v[144:147], v[160:163], v[48:51]
    v_mfma_f32_16x16x32_bf16 v[52:55], v[148:151], v[160:163], v[52:55]
    ds_read2_b32 v[76:77], v237 offset0:160 offset1:161
    v_mfma_f32_16x16x32_bf16 v[52:55], v[144:147], v[164:167], v[52:55]
    ds_read2_b32 v[78:79], v237 offset0:162 offset1:163
    v_mfma_f32_16x16x32_bf16 v[52:55], v[140:143], v[168:171], v[52:55]
    v_mfma_f32_16x16x32_bf16 v[52:55], v[136:139], v[172:175], v[52:55]
    s_lshl_b32 s14, s91, 18
    ds_read_b128 v[112:115], v246 offset:18432
    v_mfma_f32_16x16x32_bf16 v[52:55], v[132:135], v[176:179], v[52:55]
    s_add_u32 m0, s73, 0
    ds_read2_b32 v[80:81], v238 offset0:32 offset1:33
    v_mfma_f32_16x16x32_bf16 v[52:55], v[128:131], v[180:183], v[52:55]
    buffer_load_dwordx4 v4, s[52:55], s14 offen offset:0 lds
    v_mfma_f32_16x16x32_bf16 v[56:59], v[128:131], v[184:187], v[56:59]
    ds_read2_b32 v[82:83], v238 offset0:34 offset1:35
    v_mfma_f32_16x16x32_bf16 v[56:59], v[132:135], v[180:183], v[56:59]
    ds_read_b128 v[116:119], v246 offset:22528
    v_mfma_f32_16x16x32_bf16 v[56:59], v[136:139], v[176:179], v[56:59]
    v_mfma_f32_16x16x32_bf16 v[56:59], v[140:143], v[172:175], v[56:59]
    ds_read2_b32 v[84:85], v238 offset0:160 offset1:161
    v_mfma_f32_16x16x32_bf16 v[56:59], v[144:147], v[168:171], v[56:59]
    ds_read2_b32 v[86:87], v238 offset0:162 offset1:163
    v_mfma_f32_16x16x32_bf16 v[56:59], v[148:151], v[164:167], v[56:59]
    ds_read_b128 v[120:123], v246 offset:26624
    v_mfma_f32_16x16x32_bf16 v[56:59], v[152:155], v[160:163], v[56:59]
    v_mfma_f32_16x16x32_bf16 v[60:63], v[156:159], v[160:163], v[60:63]
    ds_read2_b32 v[88:89], v239 offset0:32 offset1:33
    v_mfma_f32_16x16x32_bf16 v[60:63], v[152:155], v[164:167], v[60:63]
    ds_read2_b32 v[90:91], v239 offset0:34 offset1:35
    v_mfma_f32_16x16x32_bf16 v[60:63], v[148:151], v[168:171], v[60:63]
    s_add_u32 m0, s73, 0
    v_mfma_f32_16x16x32_bf16 v[60:63], v[144:147], v[172:175], v[60:63]
    buffer_load_dwordx4 v5, s[52:55], s14 offen offset:1024 lds
    ds_read_b128 v[124:127], v246 offset:30720
    v_mfma_f32_16x16x32_bf16 v[60:63], v[140:143], v[176:179], v[60:63]
    ds_read2_b32 v[92:93], v239 offset0:160 offset1:161
    v_mfma_f32_16x16x32_bf16 v[60:63], v[136:139], v[180:183], v[60:63]
    v_mfma_f32_16x16x32_bf16 v[60:63], v[132:135], v[184:187], v[60:63]
    ds_read2_b32 v[94:95], v239 offset0:162 offset1:163
    v_mfma_f32_16x16x32_bf16 v[60:63], v[128:131], v[188:191], v[60:63]
    s_waitcnt lgkmcnt(12)
    v_mfma_f32_16x16x32_bf16 v[32:35], v[64:67], v[96:99], v[32:35]
    ds_read_b128 v[160:163], v247 offset:2048
    v_mfma_f32_16x16x32_bf16 v[36:39], v[68:71], v[96:99], v[36:39]
    v_mfma_f32_16x16x32_bf16 v[36:39], v[64:67], v[100:103], v[36:39]
    ds_read2_b32 v[128:129], v236 offset0:48 offset1:49
    v_mfma_f32_16x16x32_bf16 v[40:43], v[64:67], v[104:107], v[40:43]
    ds_read2_b32 v[130:131], v236 offset0:50 offset1:51
    v_mfma_f32_16x16x32_bf16 v[40:43], v[68:71], v[100:103], v[40:43]
    v_mfma_f32_16x16x32_bf16 v[40:43], v[72:75], v[96:99], v[40:43]
    ds_read_b128 v[164:167], v247 offset:6144
    v_mfma_f32_16x16x32_bf16 v[44:47], v[76:79], v[96:99], v[44:47]
    s_add_u32 m0, s73, 0
    ds_read2_b32 v[132:133], v236 offset0:176 offset1:177
    v_mfma_f32_16x16x32_bf16 v[44:47], v[72:75], v[100:103], v[44:47]
    buffer_load_dwordx4 v6, s[52:55], s14 offen offset:2048 lds
    v_mfma_f32_16x16x32_bf16 v[44:47], v[68:71], v[104:107], v[44:47]
    ds_read2_b32 v[134:135], v236 offset0:178 offset1:179
    v_mfma_f32_16x16x32_bf16 v[44:47], v[64:67], v[108:111], v[44:47]
    ds_read_b128 v[168:171], v247 offset:10240
    s_waitcnt lgkmcnt(7)
    v_mfma_f32_16x16x32_bf16 v[48:51], v[64:67], v[112:115], v[48:51]
    ds_read2_b32 v[136:137], v237 offset0:48 offset1:49
    v_mfma_f32_16x16x32_bf16 v[48:51], v[68:71], v[108:111], v[48:51]
    v_mfma_f32_16x16x32_bf16 v[48:51], v[72:75], v[104:107], v[48:51]
    ds_read2_b32 v[138:139], v237 offset0:50 offset1:51
    v_mfma_f32_16x16x32_bf16 v[48:51], v[76:79], v[100:103], v[48:51]
    ds_read_b128 v[172:175], v247 offset:14336
    v_mfma_f32_16x16x32_bf16 v[48:51], v[80:83], v[96:99], v[48:51]
    v_mfma_f32_16x16x32_bf16 v[52:55], v[84:87], v[96:99], v[52:55]
    ds_read2_b32 v[140:141], v237 offset0:176 offset1:177
    v_mfma_f32_16x16x32_bf16 v[52:55], v[80:83], v[100:103], v[52:55]
    ds_read2_b32 v[142:143], v237 offset0:178 offset1:179
    v_mfma_f32_16x16x32_bf16 v[52:55], v[76:79], v[104:107], v[52:55]
    v_mfma_f32_16x16x32_bf16 v[52:55], v[72:75], v[108:111], v[52:55]
    s_add_u32 m0, s73, 0
    ds_read_b128 v[176:179], v247 offset:18432
    v_mfma_f32_16x16x32_bf16 v[52:55], v[68:71], v[112:115], v[52:55]
    buffer_load_dwordx4 v7, s[52:55], s14 offen offset:3072 lds
    ds_read2_b32 v[144:145], v238 offset0:48 offset1:49
    v_mfma_f32_16x16x32_bf16 v[52:55], v[64:67], v[116:119], v[52:55]
    v_mfma_f32_16x16x32_bf16 v[56:59], v[64:67], v[120:123], v[56:59]
    ds_read2_b32 v[146:147], v238 offset0:50 offset1:51
    v_mfma_f32_16x16x32_bf16 v[56:59], v[68:71], v[116:119], v[56:59]
    ds_read_b128 v[180:183], v247 offset:22528
    v_mfma_f32_16x16x32_bf16 v[56:59], v[72:75], v[112:115], v[56:59]
    v_mfma_f32_16x16x32_bf16 v[56:59], v[76:79], v[108:111], v[56:59]
    ds_read2_b32 v[148:149], v238 offset0:176 offset1:177
    v_mfma_f32_16x16x32_bf16 v[56:59], v[80:83], v[104:107], v[56:59]
    ds_read2_b32 v[150:151], v238 offset0:178 offset1:179
    v_mfma_f32_16x16x32_bf16 v[56:59], v[84:87], v[100:103], v[56:59]
    ds_read_b128 v[184:187], v247 offset:26624
    v_mfma_f32_16x16x32_bf16 v[56:59], v[88:91], v[96:99], v[56:59]
    v_mfma_f32_16x16x32_bf16 v[60:63], v[92:95], v[96:99], v[60:63]
    s_lshl_b32 s14, s92, 18
    ds_read2_b32 v[152:153], v239 offset0:48 offset1:49
    v_mfma_f32_16x16x32_bf16 v[60:63], v[88:91], v[100:103], v[60:63]
    s_add_u32 m0, s73, 16384
    ds_read2_b32 v[154:155], v239 offset0:50 offset1:51
    v_mfma_f32_16x16x32_bf16 v[60:63], v[84:87], v[104:107], v[60:63]
    buffer_load_dwordx4 v4, s[52:55], s14 offen offset:0 lds
    v_mfma_f32_16x16x32_bf16 v[60:63], v[80:83], v[108:111], v[60:63]
    ds_read_b128 v[188:191], v247 offset:30720
    v_mfma_f32_16x16x32_bf16 v[60:63], v[76:79], v[112:115], v[60:63]
    ds_read2_b32 v[156:157], v239 offset0:176 offset1:177
    v_mfma_f32_16x16x32_bf16 v[60:63], v[72:75], v[116:119], v[60:63]
    v_mfma_f32_16x16x32_bf16 v[60:63], v[68:71], v[120:123], v[60:63]
    ds_read2_b32 v[158:159], v239 offset0:178 offset1:179
L_pl_X_4:
    s_cbranch_execz L_wret
    v_mfma_f32_16x16x32_bf16 v[60:63], v[64:67], v[124:127], v[60:63]
    s_waitcnt lgkmcnt(12)
    v_mfma_f32_16x16x32_bf16 v[32:35], v[128:131], v[160:163], v[32:35]
    ds_read_b128 v[96:99], v244 offset:0
    v_mfma_f32_16x16x32_bf16 v[36:39], v[132:135], v[160:163], v[36:39]
    ds_read2_b32 v[64:65], v236 offset0:64 offset1:65
    v_mfma_f32_16x16x32_bf16 v[36:39], v[128:131], v[164:167], v[36:39]
    ds_read2_b32 v[66:67], v236 offset0:66 offset1:67
    v_mfma_f32_16x16x32_bf16 v[40:43], v[128:131], v[168:171], v[40:43]
    ds_read_b128 v[100:103], v244 offset:4096
    v_mfma_f32_16x16x32_bf16 v[40:43], v[132:135], v[164:167], v[40:43]
    ds_read2_b32 v[68:69], v236 offset0:192 offset1:193
    v_mfma_f32_16x16x32_bf16 v[40:43], v[136:139], v[160:163], v[40:43]
    s_add_u32 m0, s73, 16384
    ds_read2_b32 v[70:71], v236 offset0:194 offset1:195
    v_mfma_f32_16x16x32_bf16 v[44:47], v[140:143], v[160:163], v[44:47]
    buffer_load_dwordx4 v5, s[52:55], s14 offen offset:1024 lds
    ds_read_b128 v[104:107], v244 offset:8192
    v_mfma_f32_16x16x32_bf16 v[44:47], v[136:139], v[164:167], v[44:47]
    ds_read2_b32 v[72:73], v237 offset0:64 offset1:65
    s_waitcnt vmcnt(7)
    s_barrier
    v_mfma_f32_16x16x32_bf16 v[44:47], v[132:135], v[168:171], v[44:47]
    ds_read_b64_tr_b16 a[96:97], v10 offset:16384
    v_mfma_f32_16x16x32_bf16 v[44:47], v[128:131], v[172:175], v[44:47]
    ds_read2_b32 v[74:75], v237 offset0:66 offset1:67
    s_waitcnt lgkmcnt(10)
    v_mfma_f32_16x16x32_bf16 v[48:51], v[128:131], v[176:179], v[48:51]
    ds_read_b64_tr_b16 a[98:99], v10 offset:18432
    v_mfma_f32_16x16x32_bf16 v[48:51], v[132:135], v[172:175], v[48:51]
    ds_read_b64_tr_b16 a[104:105], v10 offset:20480
    v_mfma_f32_16x16x32_bf16 v[48:51], v[136:139], v[168:171], v[48:51]
    ds_read_b64_tr_b16 a[106:107], v10 offset:22528
    v_mfma_f32_16x16x32_bf16 v[48:51], v[140:143], v[164:167], v[48:51]
    ds_read_b128 v[108:111], v244 offset:12288
    v_mfma_f32_16x16x32_bf16 v[48:51], v[144:147], v[160:163], v[48:51]
    ds_read_b64_tr_b16 a[100:101], v11 offset:16384
    v_mfma_f32_16x16x32_bf16 v[52:55], v[148:151], v[160:163], v[52:55]
    ds_read_b64_tr_b16 a[102:103], v11 offset:18432
    v_mfma_f32_16x16x32_bf16 v[52:55], v[144:147], v[164:167], v[52:55]
    ds_read2_b32 v[76:77], v237 offset0:192 offset1:193
    v_mfma_f32_16x16x32_bf16 v[52:55], v[140:143], v[168:171], v[52:55]
    ds_read_b64_tr_b16 a[108:109], v11 offset:20480
    s_add_u32 m0, s73, 16384
    v_mfma_f32_16x16x32_bf16 v[52:55], v[136:139], v[172:175], v[52:55]
    ds_read_b64_tr_b16 a[110:111], v11 offset:22528
    buffer_load_dwordx4 v6, s[52:55], s14 offen offset:2048 lds
    v_mfma_f32_16x16x32_bf16 v[52:55], v[132:135], v[176:179], v[52:55]
    ds_read2_b32 v[78:79], v237 offset0:194 offset1:195
    v_mfma_f32_16x16x32_bf16 v[52:55], v[128:131], v[180:183], v[52:55]
    ds_read_b128 v[112:115], v244 offset:16384
    v_mfma_f32_16x16x32_bf16 v[56:59], v[128:131], v[184:187], v[56:59]
    ds_read2_b32 v[80:81], v238 offset0:64 offset1:65
    v_mfma_f32_16x16x32_bf16 v[56:59], v[132:135], v[180:183], v[56:59]
    ds_read2_b32 v[82:83], v238 offset0:66 offset1:67
    v_mfma_f32_16x16x32_bf16 v[56:59], v[136:139], v[176:179], v[56:59]
    ds_read_b128 v[116:119], v244 offset:20480
    v_mfma_f32_16x16x32_bf16 v[56:59], v[140:143], v[172:175], v[56:59]
    ds_read2_b32 v[84:85], v238 offset0:192 offset1:193
    v_mfma_f32_16x16x32_bf16 v[56:59], v[144:147], v[168:171], v[56:59]
    ds_read2_b32 v[86:87], v238 offset0:194 offset1:195
    v_mfma_f32_16x16x32_bf16 v[56:59], v[148:151], v[164:167], v[56:59]
    ds_read_b128 v[120:123], v244 offset:24576
    v_mfma_f32_16x16x32_bf16 v[56:59], v[152:155], v[160:163], v[56:59]
    v_mfma_f32_16x16x32_bf16 v[60:63], v[156:159], v[160:163], v[60:63]
    s_add_u32 m0, s73, 16384
    ds_read2_b32 v[88:89], v239 offset0:64 offset1:65
    v_mfma_f32_16x16x32_bf16 v[60:63], v[152:155], v[164:167], v[60:63]
    buffer_load_dwordx4 v7, s[52:55], s14 offen offset:3072 lds
    ds_read2_b32 v[90:91], v239 offset0:66 offset1:67
    v_mfma_f32_16x16x32_bf16 v[60:63], v[148:151], v[168:171], v[60:63]
    v_mfma_f32_16x16x32_bf16 v[60:63], v[144:147], v[172:175], v[60:63]
    ds_read_b128 v[124:127], v244 offset:28672
    v_mfma_f32_16x16x32_bf16 v[60:63], v[140:143], v[176:179], v[60:63]
    ds_read2_b32 v[92:93], v239 offset0:192 offset1:193
    v_mfma_f32_16x16x32_bf16 v[60:63], v[136:139], v[180:183], v[60:63]
    v_mfma_f32_16x16x32_bf16 v[60:63], v[132:135], v[184:187], v[60:63]
    ds_read2_b32 v[94:95], v239 offset0:194 offset1:195
    v_mfma_f32_16x16x32_bf16 v[60:63], v[128:131], v[188:191], v[60:63]
    s_waitcnt lgkmcnt(12)
    v_mfma_f32_16x16x32_bf16 v[32:35], v[64:67], v[96:99], v[32:35]
    ds_read_b128 v[160:163], v245 offset:0
    v_mfma_f32_16x16x32_bf16 v[36:39], v[68:71], v[96:99], v[36:39]
    ds_read2_b32 v[128:129], v236 offset0:80 offset1:81
    v_mfma_f32_16x16x32_bf16 v[36:39], v[64:67], v[100:103], v[36:39]
    ds_read2_b32 v[130:131], v236 offset0:82 offset1:83
    v_mfma_f32_16x16x32_bf16 v[40:43], v[64:67], v[104:107], v[40:43]
    ds_read_b128 v[164:167], v245 offset:4096
    s_barrier
    v_mfma_f32_16x16x32_bf16 v[40:43], v[68:71], v[100:103], v[40:43]
    ds_read2_b32 v[132:133], v236 offset0:208 offset1:209
    v_mfma_f32_16x16x32_bf16 v[40:43], v[72:75], v[96:99], v[40:43]
    ds_read2_b32 v[134:135], v236 offset0:210 offset1:211
    v_mfma_f32_16x16x32_bf16 v[44:47], v[76:79], v[96:99], v[44:47]
    ds_read_b128 v[168:171], v245 offset:8192
    v_mfma_f32_16x16x32_bf16 v[44:47], v[72:75], v[100:103], v[44:47]
    s_lshl_b32 s14, s93, 18
    ds_read2_b32 v[136:137], v237 offset0:80 offset1:81
    v_mfma_f32_16x16x32_bf16 v[44:47], v[68:71], v[104:107], v[44:47]
    s_add_u32 m0, s73, 147456
    ds_read2_b32 v[138:139], v237 offset0:82 offset1:83
    v_mfma_f32_16x16x32_bf16 v[44:47], v[64:67], v[108:111], v[44:47]
    buffer_load_dwordx4 v4, s[52:55], s14 offen offset:0 lds
    ds_read_b128 v[172:175], v245 offset:12288
    s_waitcnt lgkmcnt(10)
    v_mfma_f32_16x16x32_bf16 v[48:51], v[64:67], v[112:115], v[48:51]
    ds_read2_b32 v[140:141], v237 offset0:208 offset1:209
    v_mfma_f32_16x16x32_bf16 v[48:51], v[68:71], v[108:111], v[48:51]
    ds_read2_b32 v[142:143], v237 offset0:210 offset1:211
    v_mfma_f32_16x16x32_bf16 v[48:51], v[72:75], v[104:107], v[48:51]
    ds_read_b128 v[176:179], v245 offset:16384
    v_mfma_f32_16x16x32_bf16 v[48:51], v[76:79], v[100:103], v[48:51]
    ds_read2_b32 v[144:145], v238 offset0:80 offset1:81
    v_mfma_f32_16x16x32_bf16 v[48:51], v[80:83], v[96:99], v[48:51]
    ds_read2_b32 v[146:147], v238 offset0:82 offset1:83
    v_mfma_f32_16x16x32_bf16 v[52:55], v[84:87], v[96:99], v[52:55]
    ds_read_b128 v[180:183], v245 offset:20480
    v_mfma_f32_16x16x32_bf16 v[52:55], v[80:83], v[100:103], v[52:55]
    ds_read2_b32 v[148:149], v238 offset0:208 offset1:209
    v_mfma_f32_16x16x32_bf16 v[52:55], v[76:79], v[104:107], v[52:55]
    ds_read2_b32 v[150:151], v238 offset0:210 offset1:211
    v_mfma_f32_16x16x32_bf16 v[52:55], v[72:75], v[108:111], v[52:55]
    ds_read_b128 v[184:187], v245 offset:24576
    v_mfma_f32_16x16x32_bf16 v[52:55], v[68:71], v[112:115], v[52:55]
    s_add_u32 m0, s73, 147456
    ds_read_b128 v[212:215], v241 offset:8352
    v_mfma_f32_16x16x32_bf16 v[52:55], v[64:67], v[116:119], v[52:55]
    buffer_load_dwordx4 v5, s[52:55], s14 offen offset:1024 lds
    ds_read2_b32 v[152:153], v239 offset0:80 offset1:81
    v_mfma_f32_16x16x32_bf16 v[56:59], v[64:67], v[120:123], v[56:59]
    ds_read_b32 v216, v241 offset:8368
    v_mfma_f32_16x16x32_bf16 v[56:59], v[68:71], v[116:119], v[56:59]
    ds_read_b128 v[218:221], v241 offset:9376
    v_mfma_f32_16x16x32_bf16 v[56:59], v[72:75], v[112:115], v[56:59]
    ds_read_b32 v222, v241 offset:9392
    v_mfma_f32_16x16x32_bf16 v[56:59], v[76:79], v[108:111], v[56:59]
    ds_read_b128 v[224:227], v241 offset:10400
    v_mfma_f32_16x16x32_bf16 v[56:59], v[80:83], v[104:107], v[56:59]
    ds_read_b32 v228, v241 offset:10416
    s_waitcnt vmcnt(6)
    s_barrier
    v_mfma_f32_16x16x32_bf16 v[56:59], v[84:87], v[100:103], v[56:59]
    ds_read_b128 v[230:233], v241 offset:11424
    v_add_u32 v10, -131072, v10
    v_mfma_f32_16x16x32_bf16 v[56:59], v[88:91], v[96:99], v[56:59]
    ds_read_b64_tr_b16 a[112:113], v10 offset:0
    v_mfma_f32_16x16x32_bf16 v[60:63], v[92:95], v[96:99], v[60:63]
    ds_read_b64_tr_b16 a[114:115], v10 offset:2048
    v_mfma_f32_16x16x32_bf16 v[60:63], v[88:91], v[100:103], v[60:63]
    ds_read_b64_tr_b16 a[120:121], v10 offset:4096
    ds_read2_b32 v[154:155], v239 offset0:82 offset1:83
    v_mfma_f32_16x16x32_bf16 v[60:63], v[84:87], v[104:107], v[60:63]
    ds_read_b32 v234, v241 offset:11440
    v_mfma_f32_16x16x32_bf16 v[60:63], v[80:83], v[108:111], v[60:63]
    ds_read_b64_tr_b16 a[122:123], v10 offset:6144
    s_add_u32 m0, s73, 147456
    ds_read_b128 v[188:191], v245 offset:28672
    v_mfma_f32_16x16x32_bf16 v[60:63], v[76:79], v[112:115], v[60:63]
    v_add_u32 v11, -131072, v11
    buffer_load_dwordx4 v6, s[52:55], s14 offen offset:2048 lds
    ds_read2_b32 v[156:157], v239 offset0:208 offset1:209
    v_mfma_f32_16x16x32_bf16 v[60:63], v[72:75], v[116:119], v[60:63]
    ds_read_b64_tr_b16 a[116:117], v11 offset:0
    v_mfma_f32_16x16x32_bf16 v[60:63], v[68:71], v[120:123], v[60:63]
    ds_read_b64_tr_b16 a[118:119], v11 offset:2048
    ds_read2_b32 v[158:159], v239 offset0:210 offset1:211
    v_mfma_f32_16x16x32_bf16 v[60:63], v[64:67], v[124:127], v[60:63]
    ds_read_b64_tr_b16 a[124:125], v11 offset:4096
    s_waitcnt lgkmcnt(15)
    v_mfma_f32_16x16x32_bf16 v[32:35], v[128:131], v[160:163], v[32:35]
    ds_read_b64_tr_b16 a[126:127], v11 offset:6144
    v_mfma_f32_16x16x32_bf16 v[36:39], v[132:135], v[160:163], v[36:39]
    ds_read_b128 v[96:99], v246 offset:0
    v_mfma_f32_16x16x32_bf16 v[36:39], v[128:131], v[164:167], v[36:39]
    ds_read2_b32 v[64:65], v236 offset0:96 offset1:97
    v_mfma_f32_16x16x32_bf16 v[40:43], v[128:131], v[168:171], v[40:43]
    ds_read2_b32 v[66:67], v236 offset0:98 offset1:99
    v_mfma_f32_16x16x32_bf16 v[40:43], v[132:135], v[164:167], v[40:43]
    s_waitcnt lgkmcnt(11)
    v_mfma_f32_16x16x32_bf16 v[40:43], v[136:139], v[160:163], v[40:43]
    ds_read_b128 v[100:103], v246 offset:4096
    v_mfma_f32_16x16x32_bf16 v[44:47], v[140:143], v[160:163], v[44:47]
    ds_read2_b32 v[68:69], v236 offset0:224 offset1:225
    v_mfma_f32_16x16x32_bf16 v[44:47], v[136:139], v[164:167], v[44:47]
    s_add_u32 m0, s73, 147456
    ds_read2_b32 v[70:71], v236 offset0:226 offset1:227
    v_mfma_f32_16x16x32_bf16 v[44:47], v[132:135], v[168:171], v[44:47]
    buffer_load_dwordx4 v7, s[52:55], s14 offen offset:3072 lds
    v_lshlrev_b32 v9, 16, v9
    v_mfma_f32_16x16x32_bf16 v[44:47], v[128:131], v[172:175], v[44:47]
    ds_read_b128 v[104:107], v246 offset:8192
    s_waitcnt lgkmcnt(9)
    v_mfma_f32_16x16x32_bf16 v[48:51], v[128:131], v[176:179], v[48:51]
    ds_read2_b32 v[72:73], v237 offset0:96 offset1:97
    v_lshlrev_b32 v208, 16, v212
    v_mfma_f32_16x16x32_bf16 v[48:51], v[132:135], v[172:175], v[48:51]
    v_mfma_f32_16x16x32_bf16 v[48:51], v[136:139], v[168:171], v[48:51]
    ds_read2_b32 v[74:75], v237 offset0:98 offset1:99
    v_add_f32 v9, v9, v208
    v_mfma_f32_16x16x32_bf16 v[48:51], v[140:143], v[164:167], v[48:51]
    ds_read_b128 v[108:111], v246 offset:12288
    v_cvt_pk_bf16_f32 v9, v9, v9
    v_mfma_f32_16x16x32_bf16 v[48:51], v[144:147], v[160:163], v[48:51]
    ds_read2_b32 v[76:77], v237 offset0:224 offset1:225
    s_waitcnt lgkmcnt(11)
    s_barrier
    v_mfma_f32_16x16x32_bf16 v[52:55], v[148:151], v[160:163], v[52:55]
    ds_write_b16 v242, v9 offset:12480
    v_mfma_f32_16x16x32_bf16 v[52:55], v[144:147], v[164:167], v[52:55]
    ds_read2_b32 v[78:79], v237 offset0:226 offset1:227
    v_mfma_f32_16x16x32_bf16 v[52:55], v[140:143], v[168:171], v[52:55]
    ds_write_b16 v242, v9 offset:8322
    v_mfma_f32_16x16x32_bf16 v[52:55], v[136:139], v[172:175], v[52:55]
    s_lshl_b32 s14, s94, 18
    ds_read_b128 v[112:115], v246 offset:16384
    v_mfma_f32_16x16x32_bf16 v[52:55], v[132:135], v[176:179], v[52:55]
    ds_read2_b32 v[80:81], v238 offset0:96 offset1:97
    s_add_u32 m0, s73, 0
    v_alignbit_b32 v212, v213, v212, 16
    v_mfma_f32_16x16x32_bf16 v[52:55], v[128:131], v[180:183], v[52:55]
    buffer_load_dwordx4 v4, s[52:55], s14 offen offset:0 lds
    v_alignbit_b32 v213, v214, v213, 16
    v_mfma_f32_16x16x32_bf16 v[56:59], v[128:131], v[184:187], v[56:59]
    ds_read2_b32 v[82:83], v238 offset0:98 offset1:99
    v_mfma_f32_16x16x32_bf16 v[56:59], v[132:135], v[180:183], v[56:59]
    ds_read_b128 v[116:119], v246 offset:20480
    v_alignbit_b32 v214, v215, v214, 16
    v_mfma_f32_16x16x32_bf16 v[56:59], v[136:139], v[176:179], v[56:59]
    v_mfma_f32_16x16x32_bf16 v[56:59], v[140:143], v[172:175], v[56:59]
    ds_read2_b32 v[84:85], v238 offset0:224 offset1:225
    v_alignbit_b32 v215, v216, v215, 16
    v_mfma_f32_16x16x32_bf16 v[56:59], v[144:147], v[168:171], v[56:59]
    ds_read2_b32 v[86:87], v238 offset0:226 offset1:227
    v_mfma_f32_16x16x32_bf16 v[56:59], v[148:151], v[164:167], v[56:59]
    ds_write_b128 v241, v[212:215] offset:12512
    v_mfma_f32_16x16x32_bf16 v[56:59], v[152:155], v[160:163], v[56:59]
    ds_read_b128 v[120:123], v246 offset:24576
    v_mfma_f32_16x16x32_bf16 v[60:63], v[156:159], v[160:163], v[60:63]
    ds_read2_b32 v[88:89], v239 offset0:96 offset1:97
    v_alignbit_b32 v218, v219, v218, 16
    v_mfma_f32_16x16x32_bf16 v[60:63], v[152:155], v[164:167], v[60:63]
    ds_read2_b32 v[90:91], v239 offset0:98 offset1:99
    v_alignbit_b32 v219, v220, v219, 16
    v_mfma_f32_16x16x32_bf16 v[60:63], v[148:151], v[168:171], v[60:63]
    s_add_u32 m0, s73, 0
    ds_read_b128 v[124:127], v246 offset:28672
    v_mfma_f32_16x16x32_bf16 v[60:63], v[144:147], v[172:175], v[60:63]
    buffer_load_dwordx4 v5, s[52:55], s14 offen offset:1024 lds
    v_alignbit_b32 v220, v221, v220, 16
    v_mfma_f32_16x16x32_bf16 v[60:63], v[140:143], v[176:179], v[60:63]
    ds_read2_b32 v[92:93], v239 offset0:224 offset1:225
    v_mfma_f32_16x16x32_bf16 v[60:63], v[136:139], v[180:183], v[60:63]
    ds_read2_b32 v[94:95], v239 offset0:226 offset1:227
    v_alignbit_b32 v221, v222, v221, 16
    v_mfma_f32_16x16x32_bf16 v[60:63], v[132:135], v[184:187], v[60:63]
    ds_write_b128 v241, v[218:221] offset:13536
    v_mfma_f32_16x16x32_bf16 v[60:63], v[128:131], v[188:191], v[60:63]
    s_waitcnt lgkmcnt(15)
    v_mfma_f32_16x16x32_bf16 v[32:35], v[64:67], v[96:99], v[32:35]
    ds_read_b128 v[160:163], v247 offset:0
    s_waitcnt vmcnt(6)
    s_barrier
    v_mfma_f32_16x16x32_bf16 v[36:39], v[68:71], v[96:99], v[36:39]
    ds_read_b64_tr_b16 a[128:129], v10 offset:16384
    v_alignbit_b32 v224, v225, v224, 16
    v_mfma_f32_16x16x32_bf16 v[36:39], v[64:67], v[100:103], v[36:39]
    ds_read_b64_tr_b16 a[130:131], v10 offset:18432
    ds_read_b128 v[164:167], v247 offset:4096
    v_mfma_f32_16x16x32_bf16 v[40:43], v[64:67], v[104:107], v[40:43]
    ds_read_b128 v[168:171], v247 offset:8192
    v_mfma_f32_16x16x32_bf16 v[40:43], v[68:71], v[100:103], v[40:43]
    ds_read_b64_tr_b16 a[136:137], v10 offset:20480
    ds_read_b128 v[172:175], v247 offset:12288
    v_mfma_f32_16x16x32_bf16 v[40:43], v[72:75], v[96:99], v[40:43]
    ds_read_b64_tr_b16 a[138:139], v10 offset:22528
    v_alignbit_b32 v225, v226, v225, 16
    v_mfma_f32_16x16x32_bf16 v[44:47], v[76:79], v[96:99], v[44:47]
    s_add_u32 m0, s73, 0
    ds_read_b128 v[176:179], v247 offset:16384
    v_mfma_f32_16x16x32_bf16 v[44:47], v[72:75], v[100:103], v[44:47]
    ds_read_b64_tr_b16 a[132:133], v11 offset:16384
    buffer_load_dwordx4 v6, s[52:55], s14 offen offset:2048 lds
    ds_read_b128 v[180:183], v247 offset:20480
    v_mfma_f32_16x16x32_bf16 v[44:47], v[68:71], v[104:107], v[44:47]
    ds_read_b64_tr_b16 a[134:135], v11 offset:18432
    v_mfma_f32_16x16x32_bf16 v[44:47], v[64:67], v[108:111], v[44:47]
    ds_read_b128 v[184:187], v247 offset:24576
    v_alignbit_b32 v226, v227, v226, 16
    s_waitcnt lgkmcnt(14)
    v_mfma_f32_16x16x32_bf16 v[48:51], v[64:67], v[112:115], v[48:51]
    ds_read_b64_tr_b16 a[140:141], v11 offset:20480
    ds_read_b128 v[188:191], v247 offset:28672
    v_mfma_f32_16x16x32_bf16 v[48:51], v[68:71], v[108:111], v[48:51]
    ds_read_b64_tr_b16 a[142:143], v11 offset:22528
    v_mfma_f32_16x16x32_bf16 v[48:51], v[72:75], v[104:107], v[48:51]
    ds_read2_b32 v[128:129], v236 offset0:112 offset1:113
    v_alignbit_b32 v227, v228, v227, 16
    v_mfma_f32_16x16x32_bf16 v[48:51], v[76:79], v[100:103], v[48:51]
    ds_read2_b32 v[130:131], v236 offset0:114 offset1:115
    v_mfma_f32_16x16x32_bf16 v[48:51], v[80:83], v[96:99], v[48:51]
    ds_read2_b32 v[132:133], v236 offset0:240 offset1:241
    v_mfma_f32_16x16x32_bf16 v[52:55], v[84:87], v[96:99], v[52:55]
    ds_read2_b32 v[134:135], v236 offset0:242 offset1:243
    v_mfma_f32_16x16x32_bf16 v[52:55], v[80:83], v[100:103], v[52:55]
    ds_write_b128 v241, v[224:227] offset:14560
    v_mfma_f32_16x16x32_bf16 v[52:55], v[76:79], v[104:107], v[52:55]
    ds_read2_b32 v[136:137], v237 offset0:112 offset1:113
    ds_read2_b32 v[138:139], v237 offset0:114 offset1:115
    v_mfma_f32_16x16x32_bf16 v[52:55], v[72:75], v[108:111], v[52:55]
    s_add_u32 m0, s73, 0
    ds_read2_b32 v[140:141], v237 offset0:240 offset1:241
    s_add_u32 s6, s12, 4751360
    v_mfma_f32_16x16x32_bf16 v[52:55], v[68:71], v[112:115], v[52:55]
    buffer_load_dwordx4 v7, s[52:55], s14 offen offset:3072 lds
    v_alignbit_b32 v230, v231, v230, 16
    v_mfma_f32_16x16x32_bf16 v[52:55], v[64:67], v[116:119], v[52:55]
    ds_read2_b32 v[142:143], v237 offset0:242 offset1:243
    v_xor_b32 v244, 64, v244
    v_mfma_f32_16x16x32_bf16 v[56:59], v[64:67], v[120:123], v[56:59]
    ds_read2_b32 v[144:145], v238 offset0:112 offset1:113
    v_mfma_f32_16x16x32_bf16 v[56:59], v[68:71], v[116:119], v[56:59]
    ds_read2_b32 v[146:147], v238 offset0:114 offset1:115
    v_mfma_f32_16x16x32_bf16 v[56:59], v[72:75], v[112:115], v[56:59]
    ds_read2_b32 v[148:149], v238 offset0:240 offset1:241
    v_alignbit_b32 v231, v232, v231, 16
    v_mfma_f32_16x16x32_bf16 v[56:59], v[76:79], v[108:111], v[56:59]
    ds_read2_b32 v[150:151], v238 offset0:242 offset1:243
    v_xor_b32 v245, 64, v245
    v_mfma_f32_16x16x32_bf16 v[56:59], v[80:83], v[104:107], v[56:59]
    ds_read2_b32 v[152:153], v239 offset0:112 offset1:113
    s_waitcnt lgkmcnt(14)
    s_barrier
    v_mfma_f32_16x16x32_bf16 v[56:59], v[84:87], v[100:103], v[56:59]
    ds_read2_b32 v[154:155], v239 offset0:114 offset1:115
    v_mfma_f32_16x16x32_bf16 v[56:59], v[88:91], v[96:99], v[56:59]
    ds_read2_b32 v[156:157], v239 offset0:240 offset1:241
    v_alignbit_b32 v232, v233, v232, 16
    v_mfma_f32_16x16x32_bf16 v[60:63], v[92:95], v[96:99], v[60:63]
    s_lshl_b32 s14, s95, 18
    ds_read2_b32 v[158:159], v239 offset0:242 offset1:243
    v_mfma_f32_16x16x32_bf16 v[60:63], v[88:91], v[100:103], v[60:63]
    s_add_u32 m0, s73, 16384
    v_xor_b32 v246, 64, v246
    v_add_u32 v236, 8320, v236
    v_mfma_f32_16x16x32_bf16 v[60:63], v[84:87], v[104:107], v[60:63]
    buffer_load_dwordx4 v4, s[52:55], s14 offen offset:0 lds
    v_alignbit_b32 v233, v234, v233, 16
    v_mfma_f32_16x16x32_bf16 v[60:63], v[80:83], v[108:111], v[60:63]
    v_add_u32 v237, 8320, v237
    v_mfma_f32_16x16x32_bf16 v[60:63], v[76:79], v[112:115], v[60:63]
    v_mfma_f32_16x16x32_bf16 v[60:63], v[72:75], v[116:119], v[60:63]
    v_xor_b32 v247, 64, v247
    v_add_u32 v238, 8320, v238
    v_mfma_f32_16x16x32_bf16 v[60:63], v[68:71], v[120:123], v[60:63]
    ds_write_b128 v241, v[230:233] offset:15584
    v_mfma_f32_16x16x32_bf16 v[60:63], v[64:67], v[124:127], v[60:63]
    v_add_u32 v239, 8320, v239
    s_waitcnt lgkmcnt(1)
    v_mfma_f32_16x16x32_bf16 v[60:63], v[128:131], v[188:191], v[60:63]
    ds_read_b128 v[96:99], v244 offset:2048
    v_mfma_f32_16x16x32_bf16 v[60:63], v[132:135], v[184:187], v[60:63]
    ds_read2_b32 v[64:65], v236 offset0:0 offset1:1
    v_mfma_f32_16x16x32_bf16 v[60:63], v[136:139], v[180:183], v[60:63]
    ds_read2_b32 v[66:67], v236 offset0:2 offset1:3
    v_mfma_f32_16x16x32_bf16 v[60:63], v[140:143], v[176:179], v[60:63]
    ds_read_b128 v[100:103], v244 offset:6144
    v_mfma_f32_16x16x32_bf16 v[60:63], v[144:147], v[172:175], v[60:63]
    ds_read2_b32 v[68:69], v236 offset0:128 offset1:129
    v_mfma_f32_16x16x32_bf16 v[60:63], v[148:151], v[168:171], v[60:63]
    s_add_u32 m0, s73, 16384
    ds_read2_b32 v[70:71], v236 offset0:130 offset1:131
    v_mfma_f32_16x16x32_bf16 v[60:63], v[152:155], v[164:167], v[60:63]
    buffer_load_dwordx4 v5, s[52:55], s14 offen offset:1024 lds
    ds_read_b128 v[104:107], v244 offset:10240
    v_mfma_f32_16x16x32_bf16 v[60:63], v[156:159], v[160:163], v[60:63]
    ds_read2_b32 v[72:73], v237 offset0:0 offset1:1
    v_mfma_f32_16x16x32_bf16 v[56:59], v[128:131], v[184:187], v[56:59]
    ds_read2_b32 v[74:75], v237 offset0:2 offset1:3
    v_mfma_f32_16x16x32_bf16 v[56:59], v[132:135], v[180:183], v[56:59]
    ds_read_b128 v[108:111], v244 offset:14336
    v_mfma_f32_16x16x32_bf16 v[56:59], v[136:139], v[176:179], v[56:59]
    ds_read2_b32 v[76:77], v237 offset0:128 offset1:129
    v_mfma_f32_16x16x32_bf16 v[56:59], v[140:143], v[172:175], v[56:59]
    ds_read2_b32 v[78:79], v237 offset0:130 offset1:131
    v_mfma_f32_16x16x32_bf16 v[56:59], v[144:147], v[168:171], v[56:59]
    ds_read_b128 v[112:115], v244 offset:18432
    v_mfma_f32_16x16x32_bf16 v[56:59], v[148:151], v[164:167], v[56:59]
    ds_read2_b32 v[80:81], v238 offset0:0 offset1:1
    v_cvt_pk_bf16_f32 v206, v60, v61
    v_mfma_f32_16x16x32_bf16 v[56:59], v[152:155], v[160:163], v[56:59]
    ds_read2_b32 v[82:83], v238 offset0:2 offset1:3
    s_waitcnt vmcnt(6)
    s_barrier
    v_mfma_f32_16x16x32_bf16 v[52:55], v[128:131], v[180:183], v[52:55]
    ds_read_b128 v[116:119], v244 offset:22528
    v_add_u32 v10, 131072, v10
    v_mfma_f32_16x16x32_bf16 v[52:55], v[132:135], v[176:179], v[52:55]
    ds_read_b64_tr_b16 a[144:145], v10 offset:16384
    v_cvt_pk_bf16_f32 v207, v62, v63
    v_mfma_f32_16x16x32_bf16 v[52:55], v[136:139], v[172:175], v[52:55]
    ds_read_b64_tr_b16 a[146:147], v10 offset:18432
    s_add_u32 m0, s73, 16384
    v_mfma_f32_16x16x32_bf16 v[52:55], v[140:143], v[168:171], v[52:55]
    buffer_load_dwordx4 v6, s[52:55], s14 offen offset:2048 lds
    ds_read2_b32 v[84:85], v238 offset0:128 offset1:129
    v_mfma_f32_16x16x32_bf16 v[52:55], v[144:147], v[164:167], v[52:55]
    buffer_store_dwordx2 v[206:207], v8, s[44:47], s6 offen offset:3584 sc1
    ds_read_b64_tr_b16 a[152:153], v10 offset:20480
    v_mfma_f32_16x16x32_bf16 v[52:55], v[148:151], v[160:163], v[52:55]
    ds_read_b64_tr_b16 a[154:155], v10 offset:22528
    v_mfma_f32_16x16x32_bf16 v[48:51], v[128:131], v[176:179], v[48:51]
    ds_read2_b32 v[86:87], v238 offset0:130 offset1:131
    v_add_u32 v11, 131072, v11
    v_cvt_pk_bf16_f32 v204, v56, v57
    v_mfma_f32_16x16x32_bf16 v[48:51], v[132:135], v[172:175], v[48:51]
    ds_read_b64_tr_b16 a[148:149], v11 offset:16384
    ds_read_b128 v[120:123], v244 offset:26624
    v_mfma_f32_16x16x32_bf16 v[48:51], v[136:139], v[168:171], v[48:51]
    ds_read_b64_tr_b16 a[150:151], v11 offset:18432
    ds_read2_b32 v[88:89], v239 offset0:0 offset1:1
    v_mfma_f32_16x16x32_bf16 v[48:51], v[140:143], v[164:167], v[48:51]
    ds_read2_b32 v[90:91], v239 offset0:2 offset1:3
    v_cvt_pk_bf16_f32 v205, v58, v59
    v_mfma_f32_16x16x32_bf16 v[48:51], v[144:147], v[160:163], v[48:51]
    ds_read_b64_tr_b16 a[156:157], v11 offset:20480
    ds_read_b128 v[124:127], v244 offset:30720
    v_mfma_f32_16x16x32_bf16 v[44:47], v[128:131], v[172:175], v[44:47]
    buffer_store_dwordx2 v[204:205], v8, s[44:47], s6 offen offset:3072 sc1
    ds_read_b64_tr_b16 a[158:159], v11 offset:22528
    v_mfma_f32_16x16x32_bf16 v[44:47], v[132:135], v[168:171], v[44:47]
    ds_read2_b32 v[92:93], v239 offset0:128 offset1:129
    v_mfma_f32_16x16x32_bf16 v[44:47], v[136:139], v[164:167], v[44:47]
    s_add_u32 m0, s73, 16384
    ds_read2_b32 v[94:95], v239 offset0:130 offset1:131
    v_mfma_f32_16x16x32_bf16 v[44:47], v[140:143], v[160:163], v[44:47]
    buffer_load_dwordx4 v7, s[52:55], s14 offen offset:3072 lds
    v_cvt_pk_bf16_f32 v202, v52, v53
    v_mfma_f32_16x16x32_bf16 v[40:43], v[128:131], v[168:171], v[40:43]
    v_mfma_f32_16x16x32_bf16 v[40:43], v[132:135], v[164:167], v[40:43]
    v_mfma_f32_16x16x32_bf16 v[40:43], v[136:139], v[160:163], v[40:43]
    v_cvt_pk_bf16_f32 v203, v54, v55
    v_mfma_f32_16x16x32_bf16 v[36:39], v[128:131], v[164:167], v[36:39]
    v_mfma_f32_16x16x32_bf16 v[36:39], v[132:135], v[160:163], v[36:39]
    buffer_store_dwordx2 v[202:203], v8, s[44:47], s6 offen offset:2560 sc1
    v_mfma_f32_16x16x32_bf16 v[32:35], v[128:131], v[160:163], v[32:35]
    s_waitcnt lgkmcnt(0)
    v_mfma_f32_16x16x32_bf16 v[60:63], v[64:67], v[124:127], 0
    ds_read_b128 v[160:163], v245 offset:2048
    v_mfma_f32_16x16x32_bf16 v[60:63], v[68:71], v[120:123], v[60:63]
    v_cvt_pk_bf16_f32 v200, v48, v49
    v_mfma_f32_16x16x32_bf16 v[60:63], v[72:75], v[116:119], v[60:63]
    ds_read2_b32 v[128:129], v236 offset0:16 offset1:17
    v_mfma_f32_16x16x32_bf16 v[60:63], v[76:79], v[112:115], v[60:63]
    s_barrier
    v_cvt_pk_bf16_f32 v201, v50, v51
    v_mfma_f32_16x16x32_bf16 v[60:63], v[80:83], v[108:111], v[60:63]
    ds_read2_b32 v[130:131], v236 offset0:18 offset1:19
    v_mfma_f32_16x16x32_bf16 v[60:63], v[84:87], v[104:107], v[60:63]
    buffer_store_dwordx2 v[200:201], v8, s[44:47], s6 offen offset:2048 sc1
    ds_read_b128 v[164:167], v245 offset:6144
    v_mfma_f32_16x16x32_bf16 v[60:63], v[88:91], v[100:103], v[60:63]
    ds_read2_b32 v[132:133], v236 offset0:144 offset1:145
    v_mfma_f32_16x16x32_bf16 v[60:63], v[92:95], v[96:99], v[60:63]
    ds_read2_b32 v[134:135], v236 offset0:146 offset1:147
    s_lshl_b32 s14, s96, 18
    v_cvt_pk_bf16_f32 v198, v44, v45
    v_mfma_f32_16x16x32_bf16 v[56:59], v[64:67], v[120:123], 0
    s_add_u32 m0, s73, 147456
    ds_read_b128 v[168:171], v245 offset:10240
    v_mfma_f32_16x16x32_bf16 v[56:59], v[68:71], v[116:119], v[56:59]
    buffer_load_dwordx4 v4, s[52:55], s14 offen offset:0 lds
    ds_read2_b32 v[136:137], v237 offset0:16 offset1:17
    v_mfma_f32_16x16x32_bf16 v[56:59], v[72:75], v[112:115], v[56:59]
    ds_read2_b32 v[138:139], v237 offset0:18 offset1:19
    v_cvt_pk_bf16_f32 v199, v46, v47
    v_mfma_f32_16x16x32_bf16 v[56:59], v[76:79], v[108:111], v[56:59]
    ds_read_b128 v[172:175], v245 offset:14336
    v_mfma_f32_16x16x32_bf16 v[56:59], v[80:83], v[104:107], v[56:59]
    buffer_store_dwordx2 v[198:199], v8, s[44:47], s6 offen offset:1536 sc1
    ds_read2_b32 v[140:141], v237 offset0:144 offset1:145
    v_mfma_f32_16x16x32_bf16 v[56:59], v[84:87], v[100:103], v[56:59]
    ds_read2_b32 v[142:143], v237 offset0:146 offset1:147
    v_mfma_f32_16x16x32_bf16 v[56:59], v[88:91], v[96:99], v[56:59]
    ds_read_b128 v[176:179], v245 offset:18432
    v_cvt_pk_bf16_f32 v196, v40, v41
    v_mfma_f32_16x16x32_bf16 v[52:55], v[64:67], v[116:119], 0
    ds_read2_b32 v[144:145], v238 offset0:16 offset1:17
    v_mfma_f32_16x16x32_bf16 v[52:55], v[68:71], v[112:115], v[52:55]
    ds_read2_b32 v[146:147], v238 offset0:18 offset1:19
    v_cvt_pk_bf16_f32 v197, v42, v43
    v_mfma_f32_16x16x32_bf16 v[52:55], v[72:75], v[108:111], v[52:55]
    ds_read_b128 v[180:183], v245 offset:22528
    v_mfma_f32_16x16x32_bf16 v[52:55], v[76:79], v[104:107], v[52:55]
    buffer_store_dwordx2 v[196:197], v8, s[44:47], s6 offen offset:1024 sc1
    ds_read2_b32 v[148:149], v238 offset0:144 offset1:145
    v_mfma_f32_16x16x32_bf16 v[52:55], v[80:83], v[100:103], v[52:55]
    s_add_u32 m0, s73, 147456
    ds_read2_b32 v[150:151], v238 offset0:146 offset1:147
    v_mfma_f32_16x16x32_bf16 v[52:55], v[84:87], v[96:99], v[52:55]
    buffer_load_dwordx4 v5, s[52:55], s14 offen offset:1024 lds
    ds_read_b128 v[184:187], v245 offset:26624
    v_mfma_f32_16x16x32_bf16 v[48:51], v[64:67], v[112:115], 0
    ds_read2_b32 v[152:153], v239 offset0:16 offset1:17
    v_cvt_pk_bf16_f32 v194, v36, v37
    v_mfma_f32_16x16x32_bf16 v[48:51], v[68:71], v[108:111], v[48:51]
    ds_read2_b32 v[154:155], v239 offset0:18 offset1:19
    v_mfma_f32_16x16x32_bf16 v[48:51], v[72:75], v[104:107], v[48:51]
    ds_read_b128 v[188:191], v245 offset:30720
    v_cvt_pk_bf16_f32 v195, v38, v39
    v_mfma_f32_16x16x32_bf16 v[48:51], v[76:79], v[100:103], v[48:51]
    ds_read2_b32 v[156:157], v239 offset0:144 offset1:145
    v_mfma_f32_16x16x32_bf16 v[48:51], v[80:83], v[96:99], v[48:51]
    buffer_store_dwordx2 v[194:195], v8, s[44:47], s6 offen offset:512 sc1
    s_waitcnt vmcnt(13)
    s_barrier
    v_mfma_f32_16x16x32_bf16 v[44:47], v[64:67], v[108:111], 0
    v_add_u32 v10, -131072, v10
    v_cvt_pk_bf16_f32 v192, v32, v33
    v_mfma_f32_16x16x32_bf16 v[44:47], v[68:71], v[104:107], v[44:47]
    ds_read_b64_tr_b16 a[160:161], v10 offset:0
    v_mfma_f32_16x16x32_bf16 v[44:47], v[72:75], v[100:103], v[44:47]
    ds_read_b64_tr_b16 a[162:163], v10 offset:2048
    v_mfma_f32_16x16x32_bf16 v[44:47], v[76:79], v[96:99], v[44:47]
    ds_read_b64_tr_b16 a[168:169], v10 offset:4096
    v_cvt_pk_bf16_f32 v193, v34, v35
    v_mfma_f32_16x16x32_bf16 v[40:43], v[64:67], v[104:107], 0
    ds_read2_b32 v[158:159], v239 offset0:146 offset1:147
    v_mfma_f32_16x16x32_bf16 v[40:43], v[68:71], v[100:103], v[40:43]
    buffer_store_dwordx2 v[192:193], v8, s[44:47], s6 offen offset:0 sc1
    ds_read_b64_tr_b16 a[170:171], v10 offset:6144
    s_add_u32 m0, s73, 147456
    v_mfma_f32_16x16x32_bf16 v[40:43], v[72:75], v[96:99], v[40:43]
    v_add_u32 v11, -131072, v11
L_pl_X_5:
    s_cbranch_execz L_wret
    buffer_load_dwordx4 v6, s[52:55], s14 offen offset:2048 lds
    v_mfma_f32_16x16x32_bf16 v[36:39], v[64:67], v[100:103], 0
    ds_read_b64_tr_b16 a[164:165], v11 offset:0
    v_mfma_f32_16x16x32_bf16 v[36:39], v[68:71], v[96:99], v[36:39]
    ds_read_b64_tr_b16 a[166:167], v11 offset:2048
    v_mfma_f32_16x16x32_bf16 v[32:35], v[64:67], v[96:99], 0
    ds_read_b64_tr_b16 a[172:173], v11 offset:4096
    s_waitcnt lgkmcnt(15)
    v_mfma_f32_16x16x32_bf16 v[32:35], v[128:131], v[160:163], v[32:35]
    ds_read_b64_tr_b16 a[174:175], v11 offset:6144
    v_mfma_f32_16x16x32_bf16 v[36:39], v[132:135], v[160:163], v[36:39]
    ds_read_b128 v[96:99], v246 offset:2048
    v_mfma_f32_16x16x32_bf16 v[36:39], v[128:131], v[164:167], v[36:39]
    ds_read2_b32 v[64:65], v236 offset0:32 offset1:33
    v_mfma_f32_16x16x32_bf16 v[40:43], v[128:131], v[168:171], v[40:43]
    ds_read2_b32 v[66:67], v236 offset0:34 offset1:35
    v_mfma_f32_16x16x32_bf16 v[40:43], v[132:135], v[164:167], v[40:43]
    v_mfma_f32_16x16x32_bf16 v[40:43], v[136:139], v[160:163], v[40:43]
    ds_read_b128 v[100:103], v246 offset:6144
    v_mfma_f32_16x16x32_bf16 v[44:47], v[140:143], v[160:163], v[44:47]
    ds_read2_b32 v[68:69], v236 offset0:160 offset1:161
    v_mfma_f32_16x16x32_bf16 v[44:47], v[136:139], v[164:167], v[44:47]
    s_add_u32 m0, s73, 147456
    v_mfma_f32_16x16x32_bf16 v[44:47], v[132:135], v[168:171], v[44:47]
    buffer_load_dwordx4 v7, s[52:55], s14 offen offset:3072 lds
    ds_read2_b32 v[70:71], v236 offset0:162 offset1:163
    v_mfma_f32_16x16x32_bf16 v[44:47], v[128:131], v[172:175], v[44:47]
    ds_read_b128 v[104:107], v246 offset:10240
    s_waitcnt lgkmcnt(12)
    v_mfma_f32_16x16x32_bf16 v[48:51], v[128:131], v[176:179], v[48:51]
    ds_read2_b32 v[72:73], v237 offset0:32 offset1:33
    v_mfma_f32_16x16x32_bf16 v[48:51], v[132:135], v[172:175], v[48:51]
    v_mfma_f32_16x16x32_bf16 v[48:51], v[136:139], v[168:171], v[48:51]
    ds_read2_b32 v[74:75], v237 offset0:34 offset1:35
    v_mfma_f32_16x16x32_bf16 v[48:51], v[140:143], v[164:167], v[48:51]
    ds_read_b128 v[108:111], v246 offset:14336
    v_mfma_f32_16x16x32_bf16 v[48:51], v[144:147], v[160:163], v[48:51]
    s_waitcnt lgkmcnt(10)
    s_barrier
    v_mfma_f32_16x16x32_bf16 v[52:55], v[148:151], v[160:163], v[52:55]
    ds_read2_b32 v[76:77], v237 offset0:160 offset1:161
    v_mfma_f32_16x16x32_bf16 v[52:55], v[144:147], v[164:167], v[52:55]
    ds_read2_b32 v[78:79], v237 offset0:162 offset1:163
    v_mfma_f32_16x16x32_bf16 v[52:55], v[140:143], v[168:171], v[52:55]
    v_mfma_f32_16x16x32_bf16 v[52:55], v[136:139], v[172:175], v[52:55]
    s_lshl_b32 s14, s97, 18
    ds_read_b128 v[112:115], v246 offset:18432
    v_mfma_f32_16x16x32_bf16 v[52:55], v[132:135], v[176:179], v[52:55]
    s_add_u32 m0, s73, 0
    ds_read2_b32 v[80:81], v238 offset0:32 offset1:33
    v_mfma_f32_16x16x32_bf16 v[52:55], v[128:131], v[180:183], v[52:55]
    buffer_load_dwordx4 v4, s[52:55], s14 offen offset:0 lds
    v_mfma_f32_16x16x32_bf16 v[56:59], v[128:131], v[184:187], v[56:59]
    ds_read2_b32 v[82:83], v238 offset0:34 offset1:35
    v_mfma_f32_16x16x32_bf16 v[56:59], v[132:135], v[180:183], v[56:59]
    ds_read_b128 v[116:119], v246 offset:22528
    v_mfma_f32_16x16x32_bf16 v[56:59], v[136:139], v[176:179], v[56:59]
    v_mfma_f32_16x16x32_bf16 v[56:59], v[140:143], v[172:175], v[56:59]
    ds_read2_b32 v[84:85], v238 offset0:160 offset1:161
    v_mfma_f32_16x16x32_bf16 v[56:59], v[144:147], v[168:171], v[56:59]
    ds_read2_b32 v[86:87], v238 offset0:162 offset1:163
    v_mfma_f32_16x16x32_bf16 v[56:59], v[148:151], v[164:167], v[56:59]
    ds_read_b128 v[120:123], v246 offset:26624
    v_mfma_f32_16x16x32_bf16 v[56:59], v[152:155], v[160:163], v[56:59]
    v_mfma_f32_16x16x32_bf16 v[60:63], v[156:159], v[160:163], v[60:63]
    ds_read2_b32 v[88:89], v239 offset0:32 offset1:33
    v_mfma_f32_16x16x32_bf16 v[60:63], v[152:155], v[164:167], v[60:63]
    ds_read2_b32 v[90:91], v239 offset0:34 offset1:35
    v_mfma_f32_16x16x32_bf16 v[60:63], v[148:151], v[168:171], v[60:63]
    s_add_u32 m0, s73, 0
    v_mfma_f32_16x16x32_bf16 v[60:63], v[144:147], v[172:175], v[60:63]
    buffer_load_dwordx4 v5, s[52:55], s14 offen offset:1024 lds
    ds_read_b128 v[124:127], v246 offset:30720
    v_mfma_f32_16x16x32_bf16 v[60:63], v[140:143], v[176:179], v[60:63]
    ds_read2_b32 v[92:93], v239 offset0:160 offset1:161
    v_mfma_f32_16x16x32_bf16 v[60:63], v[136:139], v[180:183], v[60:63]
    v_mfma_f32_16x16x32_bf16 v[60:63], v[132:135], v[184:187], v[60:63]
    ds_read2_b32 v[94:95], v239 offset0:162 offset1:163
    v_mfma_f32_16x16x32_bf16 v[60:63], v[128:131], v[188:191], v[60:63]
    s_waitcnt lgkmcnt(12)
    v_mfma_f32_16x16x32_bf16 v[32:35], v[64:67], v[96:99], v[32:35]
    ds_read_b128 v[160:163], v247 offset:2048
    s_waitcnt vmcnt(12)
    s_barrier
    v_mfma_f32_16x16x32_bf16 v[36:39], v[68:71], v[96:99], v[36:39]
    ds_read_b64_tr_b16 a[176:177], v10 offset:16384
    v_mfma_f32_16x16x32_bf16 v[36:39], v[64:67], v[100:103], v[36:39]
    ds_read_b64_tr_b16 a[178:179], v10 offset:18432
    v_mfma_f32_16x16x32_bf16 v[40:43], v[64:67], v[104:107], v[40:43]
    ds_read2_b32 v[128:129], v236 offset0:48 offset1:49
    v_mfma_f32_16x16x32_bf16 v[40:43], v[68:71], v[100:103], v[40:43]
    ds_read_b64_tr_b16 a[184:185], v10 offset:20480
    v_mfma_f32_16x16x32_bf16 v[40:43], v[72:75], v[96:99], v[40:43]
    ds_read_b64_tr_b16 a[186:187], v10 offset:22528
    v_mfma_f32_16x16x32_bf16 v[44:47], v[76:79], v[96:99], v[44:47]
    s_add_u32 m0, s73, 0
    ds_read2_b32 v[130:131], v236 offset0:50 offset1:51
    v_mfma_f32_16x16x32_bf16 v[44:47], v[72:75], v[100:103], v[44:47]
    ds_read_b64_tr_b16 a[180:181], v11 offset:16384
    buffer_load_dwordx4 v6, s[52:55], s14 offen offset:2048 lds
    v_mfma_f32_16x16x32_bf16 v[44:47], v[68:71], v[104:107], v[44:47]
    ds_read_b64_tr_b16 a[182:183], v11 offset:18432
    v_mfma_f32_16x16x32_bf16 v[44:47], v[64:67], v[108:111], v[44:47]
    ds_read_b128 v[164:167], v247 offset:6144
    s_waitcnt lgkmcnt(10)
    v_mfma_f32_16x16x32_bf16 v[48:51], v[64:67], v[112:115], v[48:51]
    ds_read_b64_tr_b16 a[188:189], v11 offset:20480
    v_mfma_f32_16x16x32_bf16 v[48:51], v[68:71], v[108:111], v[48:51]
    ds_read_b64_tr_b16 a[190:191], v11 offset:22528
    v_mfma_f32_16x16x32_bf16 v[48:51], v[72:75], v[104:107], v[48:51]
    ds_read2_b32 v[132:133], v236 offset0:176 offset1:177
    v_mfma_f32_16x16x32_bf16 v[48:51], v[76:79], v[100:103], v[48:51]
    ds_read2_b32 v[134:135], v236 offset0:178 offset1:179
    v_mfma_f32_16x16x32_bf16 v[48:51], v[80:83], v[96:99], v[48:51]
    ds_read_b128 v[168:171], v247 offset:10240
    v_mfma_f32_16x16x32_bf16 v[52:55], v[84:87], v[96:99], v[52:55]
    ds_read2_b32 v[136:137], v237 offset0:48 offset1:49
    v_mfma_f32_16x16x32_bf16 v[52:55], v[80:83], v[100:103], v[52:55]
    ds_read2_b32 v[138:139], v237 offset0:50 offset1:51
    v_mfma_f32_16x16x32_bf16 v[52:55], v[76:79], v[104:107], v[52:55]
    ds_read_b128 v[172:175], v247 offset:14336
    v_mfma_f32_16x16x32_bf16 v[52:55], v[72:75], v[108:111], v[52:55]
    s_add_u32 m0, s73, 0
    ds_read2_b32 v[140:141], v237 offset0:176 offset1:177
    v_mfma_f32_16x16x32_bf16 v[52:55], v[68:71], v[112:115], v[52:55]
    buffer_load_dwordx4 v7, s[52:55], s14 offen offset:3072 lds
    ds_read2_b32 v[142:143], v237 offset0:178 offset1:179
    v_mfma_f32_16x16x32_bf16 v[52:55], v[64:67], v[116:119], v[52:55]
    ds_read_b128 v[176:179], v247 offset:18432
    v_mfma_f32_16x16x32_bf16 v[56:59], v[64:67], v[120:123], v[56:59]
    ds_read2_b32 v[144:145], v238 offset0:48 offset1:49
    v_mfma_f32_16x16x32_bf16 v[56:59], v[68:71], v[116:119], v[56:59]
    ds_read2_b32 v[146:147], v238 offset0:50 offset1:51
    v_mfma_f32_16x16x32_bf16 v[56:59], v[72:75], v[112:115], v[56:59]
    ds_read_b128 v[180:183], v247 offset:22528
    v_mfma_f32_16x16x32_bf16 v[56:59], v[76:79], v[108:111], v[56:59]
    ds_read2_b32 v[148:149], v238 offset0:176 offset1:177
    v_mfma_f32_16x16x32_bf16 v[56:59], v[80:83], v[104:107], v[56:59]
    ds_read2_b32 v[150:151], v238 offset0:178 offset1:179
    s_waitcnt lgkmcnt(14)
    s_barrier
    v_mfma_f32_16x16x32_bf16 v[56:59], v[84:87], v[100:103], v[56:59]
    ds_read_b128 v[184:187], v247 offset:26624
    v_mfma_f32_16x16x32_bf16 v[56:59], v[88:91], v[96:99], v[56:59]
    v_mfma_f32_16x16x32_bf16 v[60:63], v[92:95], v[96:99], v[60:63]
    s_lshl_b32 s14, s98, 18
    ds_read2_b32 v[152:153], v239 offset0:48 offset1:49
    v_mfma_f32_16x16x32_bf16 v[60:63], v[88:91], v[100:103], v[60:63]
    s_add_u32 m0, s73, 16384
    ds_read2_b32 v[154:155], v239 offset0:50 offset1:51
    v_mfma_f32_16x16x32_bf16 v[60:63], v[84:87], v[104:107], v[60:63]
    buffer_load_dwordx4 v4, s[52:55], s14 offen offset:0 lds
    v_mfma_f32_16x16x32_bf16 v[60:63], v[80:83], v[108:111], v[60:63]
    ds_read_b128 v[188:191], v247 offset:30720
    v_mfma_f32_16x16x32_bf16 v[60:63], v[76:79], v[112:115], v[60:63]
    ds_read2_b32 v[156:157], v239 offset0:176 offset1:177
    v_mfma_f32_16x16x32_bf16 v[60:63], v[72:75], v[116:119], v[60:63]
    v_mfma_f32_16x16x32_bf16 v[60:63], v[68:71], v[120:123], v[60:63]
    ds_read2_b32 v[158:159], v239 offset0:178 offset1:179
    v_mfma_f32_16x16x32_bf16 v[60:63], v[64:67], v[124:127], v[60:63]
    s_waitcnt lgkmcnt(12)
    v_mfma_f32_16x16x32_bf16 v[32:35], v[128:131], v[160:163], v[32:35]
    ds_read_b128 v[96:99], v244 offset:0
    v_mfma_f32_16x16x32_bf16 v[36:39], v[132:135], v[160:163], v[36:39]
    v_mfma_f32_16x16x32_bf16 v[36:39], v[128:131], v[164:167], v[36:39]
    ds_read2_b32 v[64:65], v236 offset0:64 offset1:65
    v_mfma_f32_16x16x32_bf16 v[40:43], v[128:131], v[168:171], v[40:43]
    ds_read2_b32 v[66:67], v236 offset0:66 offset1:67
    v_mfma_f32_16x16x32_bf16 v[40:43], v[132:135], v[164:167], v[40:43]
    v_mfma_f32_16x16x32_bf16 v[40:43], v[136:139], v[160:163], v[40:43]
    s_add_u32 m0, s73, 16384
    ds_read_b128 v[100:103], v244 offset:4096
    v_mfma_f32_16x16x32_bf16 v[44:47], v[140:143], v[160:163], v[44:47]
    buffer_load_dwordx4 v5, s[52:55], s14 offen offset:1024 lds
    ds_read2_b32 v[68:69], v236 offset0:192 offset1:193
    v_mfma_f32_16x16x32_bf16 v[44:47], v[136:139], v[164:167], v[44:47]
    v_mfma_f32_16x16x32_bf16 v[44:47], v[132:135], v[168:171], v[44:47]
    ds_read2_b32 v[70:71], v236 offset0:194 offset1:195
    v_mfma_f32_16x16x32_bf16 v[44:47], v[128:131], v[172:175], v[44:47]
    ds_read_b128 v[104:107], v244 offset:8192
    s_waitcnt lgkmcnt(7)
    v_mfma_f32_16x16x32_bf16 v[48:51], v[128:131], v[176:179], v[48:51]
    ds_read2_b32 v[72:73], v237 offset0:64 offset1:65
    v_mfma_f32_16x16x32_bf16 v[48:51], v[132:135], v[172:175], v[48:51]
    ds_read2_b32 v[74:75], v237 offset0:66 offset1:67
    v_mfma_f32_16x16x32_bf16 v[48:51], v[136:139], v[168:171], v[48:51]
    ds_read_b128 v[108:111], v244 offset:12288
    v_mfma_f32_16x16x32_bf16 v[48:51], v[140:143], v[164:167], v[48:51]
    ds_read2_b32 v[76:77], v237 offset0:192 offset1:193
    v_mfma_f32_16x16x32_bf16 v[48:51], v[144:147], v[160:163], v[48:51]
    ds_read2_b32 v[78:79], v237 offset0:194 offset1:195
    s_waitcnt vmcnt(6)
    s_barrier
    v_mfma_f32_16x16x32_bf16 v[52:55], v[148:151], v[160:163], v[52:55]
    ds_read_b128 v[112:115], v244 offset:16384
    v_add_u32 v10, 131072, v10
    v_mfma_f32_16x16x32_bf16 v[52:55], v[144:147], v[164:167], v[52:55]
    ds_read_b64_tr_b16 a[192:193], v10 offset:16384
    v_mfma_f32_16x16x32_bf16 v[52:55], v[140:143], v[168:171], v[52:55]
    ds_read_b64_tr_b16 a[194:195], v10 offset:18432
    s_add_u32 m0, s73, 16384
    v_mfma_f32_16x16x32_bf16 v[52:55], v[136:139], v[172:175], v[52:55]
    buffer_load_dwordx4 v6, s[52:55], s14 offen offset:2048 lds
    ds_read2_b32 v[80:81], v238 offset0:64 offset1:65
    v_mfma_f32_16x16x32_bf16 v[52:55], v[132:135], v[176:179], v[52:55]
    ds_read_b64_tr_b16 a[200:201], v10 offset:20480
    v_mfma_f32_16x16x32_bf16 v[52:55], v[128:131], v[180:183], v[52:55]
    ds_read_b64_tr_b16 a[202:203], v10 offset:22528
    v_mfma_f32_16x16x32_bf16 v[56:59], v[128:131], v[184:187], v[56:59]
    ds_read2_b32 v[82:83], v238 offset0:66 offset1:67
    v_add_u32 v11, 131072, v11
    v_mfma_f32_16x16x32_bf16 v[56:59], v[132:135], v[180:183], v[56:59]
    ds_read_b64_tr_b16 a[196:197], v11 offset:16384
    v_mfma_f32_16x16x32_bf16 v[56:59], v[136:139], v[176:179], v[56:59]
    ds_read_b64_tr_b16 a[198:199], v11 offset:18432
    v_mfma_f32_16x16x32_bf16 v[56:59], v[140:143], v[172:175], v[56:59]
    ds_read_b128 v[116:119], v244 offset:20480
    v_mfma_f32_16x16x32_bf16 v[56:59], v[144:147], v[168:171], v[56:59]
    ds_read_b64_tr_b16 a[204:205], v11 offset:20480
    v_mfma_f32_16x16x32_bf16 v[56:59], v[148:151], v[164:167], v[56:59]
    ds_read_b64_tr_b16 a[206:207], v11 offset:22528
    v_mfma_f32_16x16x32_bf16 v[56:59], v[152:155], v[160:163], v[56:59]
    ds_read2_b32 v[84:85], v238 offset0:192 offset1:193
    v_mfma_f32_16x16x32_bf16 v[60:63], v[156:159], v[160:163], v[60:63]
    s_add_u32 m0, s73, 16384
    ds_read2_b32 v[86:87], v238 offset0:194 offset1:195
    v_mfma_f32_16x16x32_bf16 v[60:63], v[152:155], v[164:167], v[60:63]
    buffer_load_dwordx4 v7, s[52:55], s14 offen offset:3072 lds
    ds_read_b128 v[120:123], v244 offset:24576
    v_mfma_f32_16x16x32_bf16 v[60:63], v[148:151], v[168:171], v[60:63]
    ds_read2_b32 v[88:89], v239 offset0:64 offset1:65
    v_mfma_f32_16x16x32_bf16 v[60:63], v[144:147], v[172:175], v[60:63]
    ds_read2_b32 v[90:91], v239 offset0:66 offset1:67
    v_mfma_f32_16x16x32_bf16 v[60:63], v[140:143], v[176:179], v[60:63]
    ds_read_b128 v[124:127], v244 offset:28672
    v_mfma_f32_16x16x32_bf16 v[60:63], v[136:139], v[180:183], v[60:63]
    ds_read2_b32 v[92:93], v239 offset0:192 offset1:193
    v_mfma_f32_16x16x32_bf16 v[60:63], v[132:135], v[184:187], v[60:63]
    ds_read2_b32 v[94:95], v239 offset0:194 offset1:195
    v_mfma_f32_16x16x32_bf16 v[60:63], v[128:131], v[188:191], v[60:63]
    s_waitcnt lgkmcnt(15)
    v_mfma_f32_16x16x32_bf16 v[32:35], v[64:67], v[96:99], v[32:35]
    ds_read_b128 v[160:163], v245 offset:0
    v_mfma_f32_16x16x32_bf16 v[36:39], v[68:71], v[96:99], v[36:39]
    v_mfma_f32_16x16x32_bf16 v[36:39], v[64:67], v[100:103], v[36:39]
    ds_read2_b32 v[128:129], v236 offset0:80 offset1:81
    v_mfma_f32_16x16x32_bf16 v[40:43], v[64:67], v[104:107], v[40:43]
    ds_read2_b32 v[130:131], v236 offset0:82 offset1:83
    s_waitcnt lgkmcnt(11)
    s_barrier
    v_mfma_f32_16x16x32_bf16 v[40:43], v[68:71], v[100:103], v[40:43]
    v_mfma_f32_16x16x32_bf16 v[40:43], v[72:75], v[96:99], v[40:43]
    ds_read_b128 v[164:167], v245 offset:4096
    v_mfma_f32_16x16x32_bf16 v[44:47], v[76:79], v[96:99], v[44:47]
    ds_read2_b32 v[132:133], v236 offset0:208 offset1:209
    v_mfma_f32_16x16x32_bf16 v[44:47], v[72:75], v[100:103], v[44:47]
    s_lshl_b32 s14, s99, 18
    v_mfma_f32_16x16x32_bf16 v[44:47], v[68:71], v[104:107], v[44:47]
    s_add_u32 m0, s73, 147456
    ds_read2_b32 v[134:135], v236 offset0:210 offset1:211
    v_mfma_f32_16x16x32_bf16 v[44:47], v[64:67], v[108:111], v[44:47]
    buffer_load_dwordx4 v4, s[52:55], s14 offen offset:0 lds
    ds_read_b128 v[168:171], v245 offset:8192
    s_waitcnt lgkmcnt(7)
    v_mfma_f32_16x16x32_bf16 v[48:51], v[64:67], v[112:115], v[48:51]
    ds_read2_b32 v[136:137], v237 offset0:80 offset1:81
    v_mfma_f32_16x16x32_bf16 v[48:51], v[68:71], v[108:111], v[48:51]
    v_mfma_f32_16x16x32_bf16 v[48:51], v[72:75], v[104:107], v[48:51]
    ds_read2_b32 v[138:139], v237 offset0:82 offset1:83
    v_mfma_f32_16x16x32_bf16 v[48:51], v[76:79], v[100:103], v[48:51]
    ds_read_b128 v[172:175], v245 offset:12288
    v_mfma_f32_16x16x32_bf16 v[48:51], v[80:83], v[96:99], v[48:51]
    ds_read2_b32 v[140:141], v237 offset0:208 offset1:209
    v_mfma_f32_16x16x32_bf16 v[52:55], v[84:87], v[96:99], v[52:55]
    ds_read2_b32 v[142:143], v237 offset0:210 offset1:211
    v_mfma_f32_16x16x32_bf16 v[52:55], v[80:83], v[100:103], v[52:55]
    ds_read_b128 v[176:179], v245 offset:16384
    v_mfma_f32_16x16x32_bf16 v[52:55], v[76:79], v[104:107], v[52:55]
    ds_read2_b32 v[144:145], v238 offset0:80 offset1:81
    v_mfma_f32_16x16x32_bf16 v[52:55], v[72:75], v[108:111], v[52:55]
    ds_read2_b32 v[146:147], v238 offset0:82 offset1:83
    v_mfma_f32_16x16x32_bf16 v[52:55], v[68:71], v[112:115], v[52:55]
    s_add_u32 m0, s73, 147456
    ds_read_b128 v[180:183], v245 offset:20480
    v_mfma_f32_16x16x32_bf16 v[52:55], v[64:67], v[116:119], v[52:55]
    buffer_load_dwordx4 v5, s[52:55], s14 offen offset:1024 lds
    ds_read2_b32 v[148:149], v238 offset0:208 offset1:209
    v_mfma_f32_16x16x32_bf16 v[56:59], v[64:67], v[120:123], v[56:59]
    ds_read2_b32 v[150:151], v238 offset0:210 offset1:211
    v_mfma_f32_16x16x32_bf16 v[56:59], v[68:71], v[116:119], v[56:59]
    ds_read_b128 v[184:187], v245 offset:24576
    v_mfma_f32_16x16x32_bf16 v[56:59], v[72:75], v[112:115], v[56:59]
    ds_read2_b32 v[152:153], v239 offset0:80 offset1:81
    v_mfma_f32_16x16x32_bf16 v[56:59], v[76:79], v[108:111], v[56:59]
    ds_read2_b32 v[154:155], v239 offset0:82 offset1:83
    v_mfma_f32_16x16x32_bf16 v[56:59], v[80:83], v[104:107], v[56:59]
    ds_read_b128 v[188:191], v245 offset:28672
    s_waitcnt vmcnt(6)
    s_barrier
    v_mfma_f32_16x16x32_bf16 v[56:59], v[84:87], v[100:103], v[56:59]
    ds_read2_b32 v[156:157], v239 offset0:208 offset1:209
    v_add_u32 v10, -131072, v10
    v_mfma_f32_16x16x32_bf16 v[56:59], v[88:91], v[96:99], v[56:59]
    ds_read_b64_tr_b16 a[208:209], v10 offset:0
    v_mfma_f32_16x16x32_bf16 v[60:63], v[92:95], v[96:99], v[60:63]
    ds_read_b64_tr_b16 a[210:211], v10 offset:2048
    v_mfma_f32_16x16x32_bf16 v[60:63], v[88:91], v[100:103], v[60:63]
    ds_read_b64_tr_b16 a[216:217], v10 offset:4096
    v_mfma_f32_16x16x32_bf16 v[60:63], v[84:87], v[104:107], v[60:63]
    ds_read2_b32 v[158:159], v239 offset0:210 offset1:211
    v_mfma_f32_16x16x32_bf16 v[60:63], v[80:83], v[108:111], v[60:63]
    ds_read_b64_tr_b16 a[218:219], v10 offset:6144
    s_add_u32 m0, s73, 147456
    v_mfma_f32_16x16x32_bf16 v[60:63], v[76:79], v[112:115], v[60:63]
    v_add_u32 v11, -131072, v11
    buffer_load_dwordx4 v6, s[52:55], s14 offen offset:2048 lds
    v_mfma_f32_16x16x32_bf16 v[60:63], v[72:75], v[116:119], v[60:63]
    ds_read_b64_tr_b16 a[212:213], v11 offset:0
    v_mfma_f32_16x16x32_bf16 v[60:63], v[68:71], v[120:123], v[60:63]
    ds_read_b64_tr_b16 a[214:215], v11 offset:2048
    v_mfma_f32_16x16x32_bf16 v[60:63], v[64:67], v[124:127], v[60:63]
    ds_read_b64_tr_b16 a[220:221], v11 offset:4096
    s_waitcnt lgkmcnt(15)
    v_mfma_f32_16x16x32_bf16 v[32:35], v[128:131], v[160:163], v[32:35]
    ds_read_b64_tr_b16 a[222:223], v11 offset:6144
    v_mfma_f32_16x16x32_bf16 v[36:39], v[132:135], v[160:163], v[36:39]
    ds_read_b128 v[96:99], v246 offset:0
    v_mfma_f32_16x16x32_bf16 v[36:39], v[128:131], v[164:167], v[36:39]
    ds_read2_b32 v[64:65], v236 offset0:96 offset1:97
    v_mfma_f32_16x16x32_bf16 v[40:43], v[128:131], v[168:171], v[40:43]
    ds_read2_b32 v[66:67], v236 offset0:98 offset1:99
    v_mfma_f32_16x16x32_bf16 v[40:43], v[132:135], v[164:167], v[40:43]
    v_mfma_f32_16x16x32_bf16 v[40:43], v[136:139], v[160:163], v[40:43]
    ds_read_b128 v[100:103], v246 offset:4096
    v_mfma_f32_16x16x32_bf16 v[44:47], v[140:143], v[160:163], v[44:47]
    ds_read2_b32 v[68:69], v236 offset0:224 offset1:225
    v_mfma_f32_16x16x32_bf16 v[44:47], v[136:139], v[164:167], v[44:47]
    s_add_u32 m0, s73, 147456
    v_mfma_f32_16x16x32_bf16 v[44:47], v[132:135], v[168:171], v[44:47]
    buffer_load_dwordx4 v7, s[52:55], s14 offen offset:3072 lds
    ds_read2_b32 v[70:71], v236 offset0:226 offset1:227
    v_mfma_f32_16x16x32_bf16 v[44:47], v[128:131], v[172:175], v[44:47]
    ds_read_b128 v[104:107], v246 offset:8192
    s_waitcnt lgkmcnt(12)
    v_mfma_f32_16x16x32_bf16 v[48:51], v[128:131], v[176:179], v[48:51]
    ds_read2_b32 v[72:73], v237 offset0:96 offset1:97
    v_mfma_f32_16x16x32_bf16 v[48:51], v[132:135], v[172:175], v[48:51]
    v_mfma_f32_16x16x32_bf16 v[48:51], v[136:139], v[168:171], v[48:51]
    ds_read2_b32 v[74:75], v237 offset0:98 offset1:99
    v_mfma_f32_16x16x32_bf16 v[48:51], v[140:143], v[164:167], v[48:51]
    ds_read_b128 v[108:111], v246 offset:12288
    v_mfma_f32_16x16x32_bf16 v[48:51], v[144:147], v[160:163], v[48:51]
    s_waitcnt lgkmcnt(10)
    s_barrier
    v_mfma_f32_16x16x32_bf16 v[52:55], v[148:151], v[160:163], v[52:55]
    ds_read2_b32 v[76:77], v237 offset0:224 offset1:225
    v_mfma_f32_16x16x32_bf16 v[52:55], v[144:147], v[164:167], v[52:55]
    ds_read2_b32 v[78:79], v237 offset0:226 offset1:227
    v_mfma_f32_16x16x32_bf16 v[52:55], v[140:143], v[168:171], v[52:55]
    v_mfma_f32_16x16x32_bf16 v[52:55], v[136:139], v[172:175], v[52:55]
    s_lshl_b32 s14, s100, 18
    ds_read_b128 v[112:115], v246 offset:16384
    v_mfma_f32_16x16x32_bf16 v[52:55], v[132:135], v[176:179], v[52:55]
    s_add_u32 m0, s73, 0
    ds_read2_b32 v[80:81], v238 offset0:96 offset1:97
    v_mfma_f32_16x16x32_bf16 v[52:55], v[128:131], v[180:183], v[52:55]
    buffer_load_dwordx4 v4, s[52:55], s14 offen offset:0 lds
    v_mfma_f32_16x16x32_bf16 v[56:59], v[128:131], v[184:187], v[56:59]
    ds_read2_b32 v[82:83], v238 offset0:98 offset1:99
    v_mfma_f32_16x16x32_bf16 v[56:59], v[132:135], v[180:183], v[56:59]
    ds_read_b128 v[116:119], v246 offset:20480
    v_mfma_f32_16x16x32_bf16 v[56:59], v[136:139], v[176:179], v[56:59]
    v_mfma_f32_16x16x32_bf16 v[56:59], v[140:143], v[172:175], v[56:59]
    ds_read2_b32 v[84:85], v238 offset0:224 offset1:225
    v_mfma_f32_16x16x32_bf16 v[56:59], v[144:147], v[168:171], v[56:59]
    ds_read2_b32 v[86:87], v238 offset0:226 offset1:227
    v_mfma_f32_16x16x32_bf16 v[56:59], v[148:151], v[164:167], v[56:59]
    ds_read_b128 v[120:123], v246 offset:24576
    v_mfma_f32_16x16x32_bf16 v[56:59], v[152:155], v[160:163], v[56:59]
    v_mfma_f32_16x16x32_bf16 v[60:63], v[156:159], v[160:163], v[60:63]
    ds_read2_b32 v[88:89], v239 offset0:96 offset1:97
    v_mfma_f32_16x16x32_bf16 v[60:63], v[152:155], v[164:167], v[60:63]
    s_add_u32 m0, s73, 0
    ds_read2_b32 v[90:91], v239 offset0:98 offset1:99
    v_mfma_f32_16x16x32_bf16 v[60:63], v[148:151], v[168:171], v[60:63]
    buffer_load_dwordx4 v5, s[52:55], s14 offen offset:1024 lds
    v_mfma_f32_16x16x32_bf16 v[60:63], v[144:147], v[172:175], v[60:63]
    ds_read_b128 v[124:127], v246 offset:28672
    v_mfma_f32_16x16x32_bf16 v[60:63], v[140:143], v[176:179], v[60:63]
    ds_read2_b32 v[92:93], v239 offset0:224 offset1:225
    v_mfma_f32_16x16x32_bf16 v[60:63], v[136:139], v[180:183], v[60:63]
    v_mfma_f32_16x16x32_bf16 v[60:63], v[132:135], v[184:187], v[60:63]
    ds_read2_b32 v[94:95], v239 offset0:226 offset1:227
    v_mfma_f32_16x16x32_bf16 v[60:63], v[128:131], v[188:191], v[60:63]
    s_waitcnt lgkmcnt(12)
    v_mfma_f32_16x16x32_bf16 v[32:35], v[64:67], v[96:99], v[32:35]
    ds_read_b128 v[160:163], v247 offset:0
    s_waitcnt vmcnt(6)
    s_barrier
    v_mfma_f32_16x16x32_bf16 v[36:39], v[68:71], v[96:99], v[36:39]
    ds_read_b64_tr_b16 a[224:225], v10 offset:16384
    s_bfe_u32 s4, s2, 0x20003
    v_mfma_f32_16x16x32_bf16 v[36:39], v[64:67], v[100:103], v[36:39]
    ds_read_b64_tr_b16 a[226:227], v10 offset:18432
    ds_read_b128 v[164:167], v247 offset:4096
    v_mfma_f32_16x16x32_bf16 v[40:43], v[64:67], v[104:107], v[40:43]
    s_lshl2_add_u32 s4, s72, s4
    ds_read_b128 v[168:171], v247 offset:8192
    v_mfma_f32_16x16x32_bf16 v[40:43], v[68:71], v[100:103], v[40:43]
    ds_read_b64_tr_b16 a[232:233], v10 offset:20480
    s_add_u32 m0, s73, 0
    ds_read_b128 v[172:175], v247 offset:12288
    v_mfma_f32_16x16x32_bf16 v[40:43], v[72:75], v[96:99], v[40:43]
    ds_read_b64_tr_b16 a[234:235], v10 offset:22528
    buffer_load_dwordx4 v6, s[52:55], s14 offen offset:2048 lds
    s_lshl_b32 s4, s4, 3
    v_mfma_f32_16x16x32_bf16 v[44:47], v[76:79], v[96:99], v[44:47]
    ds_read_b128 v[176:179], v247 offset:16384
    v_mfma_f32_16x16x32_bf16 v[44:47], v[72:75], v[100:103], v[44:47]
    ds_read_b64_tr_b16 a[228:229], v11 offset:16384
    s_lshr_b32 s5, s2, 4
    ds_read_b128 v[180:183], v247 offset:20480
    v_mfma_f32_16x16x32_bf16 v[44:47], v[68:71], v[104:107], v[44:47]
    ds_read_b64_tr_b16 a[230:231], v11 offset:18432
    v_mfma_f32_16x16x32_bf16 v[44:47], v[64:67], v[108:111], v[44:47]
    s_and_b32 s5, s5, 6
    ds_read_b128 v[184:187], v247 offset:24576
    s_waitcnt lgkmcnt(13)
    v_mfma_f32_16x16x32_bf16 v[48:51], v[64:67], v[112:115], v[48:51]
    ds_read_b64_tr_b16 a[236:237], v11 offset:20480
    ds_read_b128 v[188:191], v247 offset:28672
    v_mfma_f32_16x16x32_bf16 v[48:51], v[68:71], v[108:111], v[48:51]
    ds_read_b64_tr_b16 a[238:239], v11 offset:22528
    s_add_u32 s4, s4, s5
    v_mfma_f32_16x16x32_bf16 v[48:51], v[72:75], v[104:107], v[48:51]
    ds_read2_b32 v[128:129], v236 offset0:112 offset1:113
    v_mfma_f32_16x16x32_bf16 v[48:51], v[76:79], v[100:103], v[48:51]
    s_and_b32 s5, s2, 1
    ds_read2_b32 v[130:131], v236 offset0:114 offset1:115
    v_mfma_f32_16x16x32_bf16 v[48:51], v[80:83], v[96:99], v[48:51]
    ds_read2_b32 v[132:133], v236 offset0:240 offset1:241
    v_mfma_f32_16x16x32_bf16 v[52:55], v[84:87], v[96:99], v[52:55]
    s_add_u32 m0, s73, 0
    ds_read2_b32 v[134:135], v236 offset0:242 offset1:243
    s_add_u32 s4, s4, s5
    v_mfma_f32_16x16x32_bf16 v[52:55], v[80:83], v[100:103], v[52:55]
    buffer_load_dwordx4 v7, s[52:55], s14 offen offset:3072 lds
    ds_read2_b32 v[136:137], v237 offset0:112 offset1:113
    v_mfma_f32_16x16x32_bf16 v[52:55], v[76:79], v[104:107], v[52:55]
    s_lshl_b32 s4, s4, 7
    ds_read2_b32 v[138:139], v237 offset0:114 offset1:115
    v_mfma_f32_16x16x32_bf16 v[52:55], v[72:75], v[108:111], v[52:55]
    s_add_u32 s4, s4, 12566528
    ds_read2_b32 v[140:141], v237 offset0:240 offset1:241
    s_add_u32 s6, s12, 4767744
    v_mfma_f32_16x16x32_bf16 v[52:55], v[68:71], v[112:115], v[52:55]
    ds_read2_b32 v[142:143], v237 offset0:242 offset1:243
    v_mfma_f32_16x16x32_bf16 v[52:55], v[64:67], v[116:119], v[52:55]
    ds_read2_b32 v[144:145], v238 offset0:112 offset1:113
    v_lshl_add_u32 v28, v2, 2, s4
    v_mfma_f32_16x16x32_bf16 v[56:59], v[64:67], v[120:123], v[56:59]
    s_waitcnt lgkmcnt(9)
    s_barrier
    v_mfma_f32_16x16x32_bf16 v[56:59], v[68:71], v[116:119], v[56:59]
    ds_read2_b32 v[146:147], v238 offset0:114 offset1:115
    s_cmp_eq_u32 s3, 0
    s_cselect_b32 s4, 18, 0
    v_mfma_f32_16x16x32_bf16 v[56:59], v[72:75], v[112:115], v[56:59]
    ds_read2_b32 v[148:149], v238 offset0:240 offset1:241
    v_mfma_f32_16x16x32_bf16 v[56:59], v[76:79], v[108:111], v[56:59]
    ds_read2_b32 v[150:151], v238 offset0:242 offset1:243
    v_cmp_gt_u32 vcc, s4, v2
    v_mfma_f32_16x16x32_bf16 v[56:59], v[80:83], v[104:107], v[56:59]
    s_lshl_b32 s14, s101, 18
    ds_read2_b32 v[152:153], v239 offset0:112 offset1:113
    v_mfma_f32_16x16x32_bf16 v[56:59], v[84:87], v[100:103], v[56:59]
    ds_read2_b32 v[154:155], v239 offset0:114 offset1:115
    s_add_u32 m0, s73, 16384
    v_mov_b32 v13, 0x40000000
    v_mfma_f32_16x16x32_bf16 v[56:59], v[88:91], v[96:99], v[56:59]
    buffer_load_dwordx4 v4, s[52:55], s14 offen offset:0 lds
    ds_read2_b32 v[156:157], v239 offset0:240 offset1:241
    v_mfma_f32_16x16x32_bf16 v[60:63], v[92:95], v[96:99], v[60:63]
    ds_read2_b32 v[158:159], v239 offset0:242 offset1:243
    v_cndmask_b32 v28, v13, v28, vcc
    v_mfma_f32_16x16x32_bf16 v[60:63], v[88:91], v[100:103], v[60:63]
    v_mfma_f32_16x16x32_bf16 v[60:63], v[84:87], v[104:107], v[60:63]
    v_mov_b32 v13, s68
    v_mfma_f32_16x16x32_bf16 v[60:63], v[80:83], v[108:111], v[60:63]
    v_mfma_f32_16x16x32_bf16 v[60:63], v[76:79], v[112:115], v[60:63]
    v_cndmask_b32 v13, 0, v13, vcc
    v_mfma_f32_16x16x32_bf16 v[60:63], v[72:75], v[116:119], v[60:63]
    v_mfma_f32_16x16x32_bf16 v[60:63], v[68:71], v[120:123], v[60:63]
    v_mfma_f32_16x16x32_bf16 v[60:63], v[64:67], v[124:127], v[60:63]
    s_waitcnt lgkmcnt(0)
    v_mfma_f32_16x16x32_bf16 v[60:63], v[128:131], v[188:191], v[60:63]
    v_mfma_f32_16x16x32_bf16 v[60:63], v[132:135], v[184:187], v[60:63]
    s_add_u32 m0, s73, 16384
    v_mfma_f32_16x16x32_bf16 v[60:63], v[136:139], v[180:183], v[60:63]
    buffer_load_dwordx4 v5, s[52:55], s14 offen offset:1024 lds
    v_mfma_f32_16x16x32_bf16 v[60:63], v[140:143], v[176:179], v[60:63]
    v_mfma_f32_16x16x32_bf16 v[60:63], v[144:147], v[172:175], v[60:63]
    v_mfma_f32_16x16x32_bf16 v[60:63], v[148:151], v[168:171], v[60:63]
    v_mfma_f32_16x16x32_bf16 v[60:63], v[152:155], v[164:167], v[60:63]
    v_mfma_f32_16x16x32_bf16 v[60:63], v[156:159], v[160:163], v[60:63]
    v_mfma_f32_16x16x32_bf16 v[56:59], v[128:131], v[184:187], v[56:59]
    v_mfma_f32_16x16x32_bf16 v[56:59], v[132:135], v[180:183], v[56:59]
    v_mfma_f32_16x16x32_bf16 v[56:59], v[136:139], v[176:179], v[56:59]
    v_mfma_f32_16x16x32_bf16 v[56:59], v[140:143], v[172:175], v[56:59]
    s_add_u32 m0, s73, 16384
    v_mfma_f32_16x16x32_bf16 v[56:59], v[144:147], v[168:171], v[56:59]
    buffer_load_dwordx4 v6, s[52:55], s14 offen offset:2048 lds
    v_mfma_f32_16x16x32_bf16 v[56:59], v[148:151], v[164:167], v[56:59]
    v_cvt_pk_bf16_f32 v206, v60, v61
    v_mfma_f32_16x16x32_bf16 v[56:59], v[152:155], v[160:163], v[56:59]
    s_waitcnt vmcnt(7)
    s_barrier
    v_mfma_f32_16x16x32_bf16 v[52:55], v[128:131], v[180:183], v[52:55]
    v_add_u32 v10, 131072, v10
    v_mfma_f32_16x16x32_bf16 v[52:55], v[132:135], v[176:179], v[52:55]
    ds_read_b64_tr_b16 a[240:241], v10 offset:16384
    v_cvt_pk_bf16_f32 v207, v62, v63
    v_mfma_f32_16x16x32_bf16 v[52:55], v[136:139], v[172:175], v[52:55]
    ds_read_b64_tr_b16 a[242:243], v10 offset:18432
    v_mfma_f32_16x16x32_bf16 v[52:55], v[140:143], v[168:171], v[52:55]
    buffer_store_dwordx2 v[206:207], v8, s[44:47], s6 offen offset:3584 sc1
    v_mfma_f32_16x16x32_bf16 v[52:55], v[144:147], v[164:167], v[52:55]
    ds_read_b64_tr_b16 a[248:249], v10 offset:20480
    v_mfma_f32_16x16x32_bf16 v[52:55], v[148:151], v[160:163], v[52:55]
    ds_read_b64_tr_b16 a[250:251], v10 offset:22528
    v_mfma_f32_16x16x32_bf16 v[48:51], v[128:131], v[176:179], v[48:51]
    v_add_u32 v11, 131072, v11
    v_cvt_pk_bf16_f32 v204, v56, v57
    v_mfma_f32_16x16x32_bf16 v[48:51], v[132:135], v[172:175], v[48:51]
    ds_read_b64_tr_b16 a[244:245], v11 offset:16384
    s_add_u32 m0, s73, 16384
    v_mfma_f32_16x16x32_bf16 v[48:51], v[136:139], v[168:171], v[48:51]
    ds_read_b64_tr_b16 a[246:247], v11 offset:18432
    buffer_load_dwordx4 v7, s[52:55], s14 offen offset:3072 lds
    v_mfma_f32_16x16x32_bf16 v[48:51], v[140:143], v[164:167], v[48:51]
    v_cvt_pk_bf16_f32 v205, v58, v59
    v_mfma_f32_16x16x32_bf16 v[48:51], v[144:147], v[160:163], v[48:51]
L_pl_X_6:
    s_cbranch_execz L_wret
    ds_read_b64_tr_b16 a[252:253], v11 offset:20480
    v_mfma_f32_16x16x32_bf16 v[44:47], v[128:131], v[172:175], v[44:47]
    buffer_store_dwordx2 v[204:205], v8, s[44:47], s6 offen offset:3072 sc1
    ds_read_b64_tr_b16 a[254:255], v11 offset:22528
    v_mfma_f32_16x16x32_bf16 v[44:47], v[132:135], v[168:171], v[44:47]
    v_mfma_f32_16x16x32_bf16 v[44:47], v[136:139], v[164:167], v[44:47]
    v_mfma_f32_16x16x32_bf16 v[44:47], v[140:143], v[160:163], v[44:47]
    v_cvt_pk_bf16_f32 v202, v52, v53
    v_mfma_f32_16x16x32_bf16 v[40:43], v[128:131], v[168:171], v[40:43]
    v_mfma_f32_16x16x32_bf16 v[40:43], v[132:135], v[164:167], v[40:43]
    v_mfma_f32_16x16x32_bf16 v[40:43], v[136:139], v[160:163], v[40:43]
    v_cvt_pk_bf16_f32 v203, v54, v55
    v_mfma_f32_16x16x32_bf16 v[36:39], v[128:131], v[164:167], v[36:39]
    v_mfma_f32_16x16x32_bf16 v[36:39], v[132:135], v[160:163], v[36:39]
    buffer_store_dwordx2 v[202:203], v8, s[44:47], s6 offen offset:2560 sc1
    v_mfma_f32_16x16x32_bf16 v[32:35], v[128:131], v[160:163], v[32:35]
    v_mov_b32 v29, 0
    buffer_atomic_add v29, v28, s[44:47], 0 offen sc0 sc1
    v_cvt_pk_bf16_f32 v200, v48, v49
    v_cvt_pk_bf16_f32 v201, v50, v51
    buffer_store_dwordx2 v[200:201], v8, s[44:47], s6 offen offset:2048 sc1
    v_cvt_pk_bf16_f32 v198, v44, v45
    v_cvt_pk_bf16_f32 v199, v46, v47
    buffer_store_dwordx2 v[198:199], v8, s[44:47], s6 offen offset:1536 sc1
    v_cvt_pk_bf16_f32 v196, v40, v41
    v_cvt_pk_bf16_f32 v197, v42, v43
    buffer_store_dwordx2 v[196:197], v8, s[44:47], s6 offen offset:1024 sc1
    v_cvt_pk_bf16_f32 v194, v36, v37
    v_cvt_pk_bf16_f32 v195, v38, v39
    buffer_store_dwordx2 v[194:195], v8, s[44:47], s6 offen offset:512 sc1
    v_cvt_pk_bf16_f32 v192, v32, v33
    v_cvt_pk_bf16_f32 v193, v34, v35
    buffer_store_dwordx2 v[192:193], v8, s[44:47], s6 offen offset:0 sc1
    v_add_u32 v10, -131072, v10
    v_add_u32 v11, -131072, v11
    s_waitcnt lgkmcnt(0)
    s_barrier
L_DX:
    s_waitcnt vmcnt(0)
    v_cmp_ne_u32 vcc, v13, v29
    s_cbranch_vccnz L_rs_p2X
L_ok_p2X:
    s_barrier
    s_add_u32 m0, s73, 97536
    s_nop 0
    buffer_load_dwordx4 v23, s[44:47], s18 offen offset:768 sc1 lds
    s_add_u32 m0, s73, 99328
    s_nop 0
    buffer_load_dwordx4 v20, s[44:47], s18 offen offset:0 sc1 lds
    s_add_u32 m0, s73, 99840
    s_nop 0
    buffer_load_dwordx4 v20, s[44:47], s18 offen offset:512 sc1 lds
    s_add_u32 m0, s73, 100608
    s_nop 0
    buffer_load_dwordx4 v23, s[44:47], s19 offen offset:768 sc1 lds
    s_add_u32 m0, s73, 114688
    s_nop 0
    buffer_load_dwordx4 v20, s[44:47], s19 offen offset:0 sc1 lds
    s_add_u32 m0, s73, 115200
    s_nop 0
    buffer_load_dwordx4 v20, s[44:47], s19 offen offset:512 sc1 lds
    s_add_u32 m0, s73, 115968
    s_nop 0
    buffer_load_dwordx4 v23, s[44:47], s20 offen offset:768 sc1 lds
    s_add_u32 m0, s73, 117760
    s_nop 0
    buffer_load_dwordx4 v20, s[44:47], s20 offen offset:0 sc1 lds
    s_mov_b32 s56, s16
    s_and_b32 s57, s17, 0xffff
    s_mov_b32 s58, 2359296
    s_mov_b32 s59, 0x20000
    s_mov_b32 s40, 18432
    s_mov_b32 s42, 12386304
    s_mov_b32 s64, s38
    s_and_b32 s65, s39, 0xffff
    s_mov_b32 s66, 2359296
    s_mov_b32 s67, 0x20000
    v_lshlrev_b32 v136, 4, v2
    s_mul_i32 s7, s72, 36
    s_bitcmp1_b32 s3, 0
    s_addc_u32 s7, s7, 0
    s_lshl_b32 s7, s7, 17
    v_subrev_u32 v184, s7, v4
    v_subrev_u32 v185, s7, v5
    s_bfe_u32 s4, s2, 0x20003
    s_mul_i32 s4, s4, 9
    s_lshl1_add_u32 s7, s72, s4
    s_and_b32 s8, s3, 1
    s_add_u32 s7, s7, s8
    s_lshl_b32 s37, s7, 16
    s_add_u32 s37, s37, 4718592
    s_add_u32 s4, s4, 8
    s_lshl_b32 s16, s4, 16
    s_add_u32 s16, s16, 4718592
    s_sub_u32 s4, s4, s7
    s_lshl_b32 s4, s4, 7
    s_lshl_b32 s7, s7, 7
    s_add_u32 s7, s7, 12582912
    v_bfe_u32 v24, v2, 2, 1
    v_mul_u32_u24 v24, s4, v24
    v_and_b32 v25, 3, v2
    v_lshl_add_u32 v24, v25, 2, v24
    v_add_u32 v188, s7, v24
    s_lshl2_add_u32 s7, s2, s3
    s_mul_i32 s8, s7, 3072
    s_add_u32 s34, s8, 40828928
    s_add_u32 s11, s8, 43974656
    s_add_u32 s12, s8, 47120384
    s_lshl_b32 s35, s7, 12
    s_add_u32 s35, s35, 50266112
    s_xor_b32 s8, s7, 8
    s_mul_i32 s8, s8, 3072
    s_add_u32 s30, s8, 40828928
    s_xor_b32 s8, s7, 16
    s_mul_i32 s8, s8, 3072
    s_add_u32 s15, s8, 43974656
    s_xor_b32 s8, s7, 24
    s_mul_i32 s8, s8, 3072
    s_add_u32 s31, s8, 47120384
    s_andn2_b32 s7, s7, 24
    s_lshl3_add_u32 s7, s3, s7
    s_lshl2_add_u32 s8, s7, s72
    s_lshl_b32 s8, s8, 10
    s_add_u32 s32, s8, 50266112
    s_xor_b32 s8, s8, 4096
    s_add_u32 s33, s8, 50266112
    s_xor_b32 s8, s3, s72
    s_cmp_lt_u32 s8, 2
    s_cselect_b32 s35, s35, 0x40000000
    s_cselect_b32 s16, s16, 0x40000000
    s_cselect_b32 s36, s68, 0
    s_mov_b32 s38, 0xbfb8aa3b
    s_and_b32 s8, s8, 1
    s_mul_i32 s41, s8, 96
    s_and_b32 s43, s73, 4096
    v_lshlrev_b32 v24, 10, v2
    v_add_u32 v24, s35, v24
    s_add_u32 s7, s34, 2048
    v_mov_b32 v25, s36
    v_cmp_gt_u32 vcc, 4, v2
    s_nop 1
    v_cndmask_b32 v138, 0, v25, vcc
    v_mov_b32 v25, 0x40000000
    v_cndmask_b32 v137, v25, v24, vcc
    v_writelane_b32 v137, s7, 4
    v_writelane_b32 v138, s68, 4
    v_min_u32 v139, 1, v2
    v_lshlrev_b32 v139, 30, v139
    v_mov_b32 v140, 0
    v_writelane_b32 v140, s68, 0
    v_mov_b32 v195, s68
    v_mov_b32 v199, s68
    v_mov_b32 v202, s68
    v_mov_b32 v203, s68
    s_waitcnt vmcnt(4)
    s_barrier
    ds_read_b128 v[104:107], v14 offset:0
    ds_read_b128 v[108:111], v14 offset:4096
    ds_read_b128 v[112:115], v14 offset:8192
    ds_read_b128 v[116:119], v14 offset:12288
    s_waitcnt lgkmcnt(2)
    v_mfma_f32_16x16x32_bf16 v[32:35], v[104:107], a[0:3], 0
    s_add_u32 m0, s73, 130560
    s_sub_u32 s4, s75, 216
    s_lshl_b32 s7, s4, 7
    v_mfma_f32_16x16x32_bf16 v[32:35], v[108:111], a[8:11], v[32:35]
    buffer_load_dwordx4 v20, s[44:47], s20 offen offset:512 sc1 lds
    s_waitcnt lgkmcnt(0)
    v_mfma_f32_16x16x32_bf16 v[32:35], v[112:115], a[16:19], v[32:35]
    ds_read_b128 v[120:123], v14 offset:1024
    s_lshl2_add_u32 s7, s3, s7
    s_add_u32 s7, s7, 12582912
    v_mfma_f32_16x16x32_bf16 v[32:35], v[116:119], a[24:27], v[32:35]
    ds_read_b128 v[124:127], v14 offset:5120
    v_mfma_f32_16x16x32_bf16 v[36:39], v[116:119], a[28:31], 0
    ds_read_b128 v[128:131], v14 offset:9216
    s_cmp_lt_u32 s4, 36
    s_cselect_b32 s7, s7, 0x40000000
    v_mfma_f32_16x16x32_bf16 v[36:39], v[112:115], a[20:23], v[36:39]
    ds_read_b128 v[132:135], v14 offset:13312
    v_min_u32 v28, 1, v2
    v_mfma_f32_16x16x32_bf16 v[36:39], v[108:111], a[12:15], v[36:39]
    s_add_u32 m0, s73, 131328
    v_lshlrev_b32 v28, 30, v28
    v_mov_b32 v29, s68
    v_mfma_f32_16x16x32_bf16 v[36:39], v[104:107], a[4:7], v[36:39]
    buffer_load_dwordx4 v23, s[44:47], s21 offen offset:768 sc1 lds
    s_waitcnt lgkmcnt(2)
    v_mfma_f32_16x16x32_bf16 v[44:47], v[120:123], a[4:7], 0
    buffer_store_dword v29, v28, s[44:47], s7 offen sc1
    s_add_u32 m0, s73, 133120
    v_mfma_f32_16x16x32_bf16 v[44:47], v[124:127], a[12:15], v[44:47]
    buffer_load_dwordx4 v20, s[44:47], s21 offen offset:0 sc1 lds
    s_waitcnt lgkmcnt(0)
    v_mfma_f32_16x16x32_bf16 v[44:47], v[128:131], a[20:23], v[44:47]
    ds_read_b128 v[104:107], v14 offset:2048
    v_mfma_f32_16x16x32_bf16 v[44:47], v[132:135], a[28:31], v[44:47]
    ds_read_b128 v[108:111], v14 offset:6144
    v_mfma_f32_16x16x32_bf16 v[40:43], v[132:135], a[24:27], 0
    ds_read_b128 v[112:115], v14 offset:10240
    v_mfma_f32_16x16x32_bf16 v[40:43], v[128:131], a[16:19], v[40:43]
    ds_read_b128 v[116:119], v14 offset:14336
    v_mfma_f32_16x16x32_bf16 v[40:43], v[124:127], a[8:11], v[40:43]
    s_add_u32 m0, s73, 133632
    v_mfma_f32_16x16x32_bf16 v[40:43], v[120:123], a[0:3], v[40:43]
    buffer_load_dwordx4 v20, s[44:47], s21 offen offset:512 sc1 lds
    s_waitcnt lgkmcnt(2)
    v_mfma_f32_16x16x32_bf16 v[48:51], v[104:107], a[0:3], 0
    s_add_u32 m0, s73, 146688
    v_mfma_f32_16x16x32_bf16 v[48:51], v[108:111], a[8:11], v[48:51]
    buffer_load_dwordx4 v23, s[44:47], s22 offen offset:768 sc1 lds
    s_waitcnt lgkmcnt(0)
    v_mfma_f32_16x16x32_bf16 v[48:51], v[112:115], a[16:19], v[48:51]
    ds_read_b128 v[120:123], v14 offset:3072
    v_mfma_f32_16x16x32_bf16 v[48:51], v[116:119], a[24:27], v[48:51]
    ds_read_b128 v[124:127], v14 offset:7168
    v_mfma_f32_16x16x32_bf16 v[52:55], v[116:119], a[28:31], 0
    ds_read_b128 v[128:131], v14 offset:11264
    v_mfma_f32_16x16x32_bf16 v[52:55], v[112:115], a[20:23], v[52:55]
    ds_read_b128 v[132:135], v14 offset:15360
    v_mfma_f32_16x16x32_bf16 v[52:55], v[108:111], a[12:15], v[52:55]
    s_add_u32 m0, s73, 148480
    v_mfma_f32_16x16x32_bf16 v[52:55], v[104:107], a[4:7], v[52:55]
    buffer_load_dwordx4 v20, s[44:47], s22 offen offset:0 sc1 lds
    s_waitcnt lgkmcnt(2)
    v_mfma_f32_16x16x32_bf16 v[36:39], v[120:123], a[36:39], v[36:39]
    s_add_u32 m0, s73, 148992
    v_mfma_f32_16x16x32_bf16 v[36:39], v[124:127], a[44:47], v[36:39]
    buffer_load_dwordx4 v20, s[44:47], s22 offen offset:512 sc1 lds
    s_waitcnt lgkmcnt(0)
    v_mfma_f32_16x16x32_bf16 v[36:39], v[128:131], a[52:55], v[36:39]
    s_waitcnt vmcnt(8)
    s_barrier
    v_mfma_f32_16x16x32_bf16 v[36:39], v[132:135], a[60:63], v[36:39]
    ds_read_b128 v[104:107], v14 offset:16384
    v_mfma_f32_16x16x32_bf16 v[32:35], v[132:135], a[56:59], v[32:35]
    ds_read_b128 v[108:111], v14 offset:20480
    v_mfma_f32_16x16x32_bf16 v[32:35], v[128:131], a[48:51], v[32:35]
    ds_read_b128 v[112:115], v14 offset:24576
    v_mfma_f32_16x16x32_bf16 v[32:35], v[124:127], a[40:43], v[32:35]
    ds_read_b128 v[116:119], v14 offset:28672
    s_add_u32 m0, s73, 149760
    v_mfma_f32_16x16x32_bf16 v[32:35], v[120:123], a[32:35], v[32:35]
    buffer_load_dwordx4 v23, s[44:47], s23 offen offset:768 sc1 lds
    ds_read_b64_tr_b16 v[220:221], v10 offset:0
    s_waitcnt lgkmcnt(3)
    v_mfma_f32_16x16x32_bf16 v[40:43], v[104:107], a[32:35], v[40:43]
    s_add_u32 m0, s73, 98304
    ds_read_b64_tr_b16 v[222:223], v10 offset:2048
    v_mfma_f32_16x16x32_bf16 v[40:43], v[108:111], a[40:43], v[40:43]
    buffer_load_dwordx4 v20, s[44:47], s23 offen offset:0 sc1 lds
    s_waitcnt lgkmcnt(2)
    v_mfma_f32_16x16x32_bf16 v[40:43], v[112:115], a[48:51], v[40:43]
    ds_read_b128 v[120:123], v14 offset:17408
    v_mfma_f32_16x16x32_bf16 v[40:43], v[116:119], a[56:59], v[40:43]
    ds_read_b128 v[124:127], v14 offset:21504
    v_mfma_f32_16x16x32_bf16 v[44:47], v[116:119], a[60:63], v[44:47]
    ds_read_b128 v[128:131], v14 offset:25600
    v_mfma_f32_16x16x32_bf16 v[44:47], v[112:115], a[52:55], v[44:47]
    ds_read_b128 v[132:135], v14 offset:29696
    v_mfma_f32_16x16x32_bf16 v[44:47], v[108:111], a[44:47], v[44:47]
    s_add_u32 m0, s73, 98816
    ds_read_b64_tr_b16 v[228:229], v10 offset:4096
    v_mfma_f32_16x16x32_bf16 v[44:47], v[104:107], a[36:39], v[44:47]
    buffer_load_dwordx4 v20, s[44:47], s23 offen offset:512 sc1 lds
    s_waitcnt lgkmcnt(3)
    v_mfma_f32_16x16x32_bf16 v[52:55], v[120:123], a[36:39], v[52:55]
    s_add_u32 m0, s73, 99584
    ds_read_b64_tr_b16 v[230:231], v10 offset:6144
    v_mfma_f32_16x16x32_bf16 v[52:55], v[124:127], a[44:47], v[52:55]
    buffer_load_dwordx4 v23, s[44:47], s24 offen offset:768 sc1 lds
    s_waitcnt lgkmcnt(2)
    v_mfma_f32_16x16x32_bf16 v[52:55], v[128:131], a[52:55], v[52:55]
    ds_read_b128 v[104:107], v14 offset:18432
    v_mfma_f32_16x16x32_bf16 v[52:55], v[132:135], a[60:63], v[52:55]
    ds_read_b128 v[108:111], v14 offset:22528
    v_mfma_f32_16x16x32_bf16 v[48:51], v[132:135], a[56:59], v[48:51]
    ds_read_b128 v[112:115], v14 offset:26624
    v_mfma_f32_16x16x32_bf16 v[48:51], v[128:131], a[48:51], v[48:51]
    ds_read_b128 v[116:119], v14 offset:30720
    v_mfma_f32_16x16x32_bf16 v[48:51], v[124:127], a[40:43], v[48:51]
    s_add_u32 m0, s73, 101376
    ds_read_b64_tr_b16 v[224:225], v11 offset:0
    v_mfma_f32_16x16x32_bf16 v[48:51], v[120:123], a[32:35], v[48:51]
    buffer_load_dwordx4 v20, s[44:47], s24 offen offset:0 sc1 lds
    s_waitcnt lgkmcnt(3)
    v_mfma_f32_16x16x32_bf16 v[32:35], v[104:107], a[64:67], v[32:35]
    ds_read_b64_tr_b16 v[226:227], v11 offset:2048
    v_mfma_f32_16x16x32_bf16 v[32:35], v[108:111], a[72:75], v[32:35]
    s_waitcnt lgkmcnt(2)
    v_mfma_f32_16x16x32_bf16 v[32:35], v[112:115], a[80:83], v[32:35]
    ds_read_b128 v[120:123], v14 offset:19456
    v_mfma_f32_16x16x32_bf16 v[32:35], v[116:119], a[88:91], v[32:35]
    ds_read_b128 v[124:127], v14 offset:23552
    v_mfma_f32_16x16x32_bf16 v[36:39], v[116:119], a[92:95], v[36:39]
    ds_read_b128 v[128:131], v14 offset:27648
    v_mfma_f32_16x16x32_bf16 v[36:39], v[112:115], a[84:87], v[36:39]
    ds_read_b128 v[132:135], v14 offset:31744
    v_mfma_f32_16x16x32_bf16 v[36:39], v[108:111], a[76:79], v[36:39]
    ds_read_b64_tr_b16 v[232:233], v11 offset:4096
    v_mfma_f32_16x16x32_bf16 v[36:39], v[104:107], a[68:71], v[36:39]
    s_waitcnt lgkmcnt(3)
    v_mfma_f32_16x16x32_bf16 v[44:47], v[120:123], a[68:71], v[44:47]
    ds_read_b64_tr_b16 v[234:235], v11 offset:6144
    v_mfma_f32_16x16x32_bf16 v[44:47], v[124:127], a[76:79], v[44:47]
    s_waitcnt lgkmcnt(2)
    v_mfma_f32_16x16x32_bf16 v[44:47], v[128:131], a[84:87], v[44:47]
    s_waitcnt vmcnt(8) lgkmcnt(0)
    s_barrier
    v_mfma_f32_16x16x32_bf16 v[44:47], v[132:135], a[92:95], v[44:47]
    ds_read_b128 v[104:107], v14 offset:32768
    v_mfma_f32_16x16x32_bf16 v[40:43], v[132:135], a[88:91], v[40:43]
    ds_read_b128 v[108:111], v14 offset:36864
    v_mfma_f32_16x16x32_bf16 v[40:43], v[128:131], a[80:83], v[40:43]
    ds_read_b128 v[112:115], v14 offset:40960
    v_mfma_f32_16x16x32_bf16 v[40:43], v[124:127], a[72:75], v[40:43]
    ds_read_b128 v[116:119], v14 offset:45056
    v_mfma_f32_16x16x32_bf16 v[40:43], v[120:123], a[64:67], v[40:43]
    ds_read_b64_tr_b16 v[236:237], v10 offset:16384
    s_waitcnt lgkmcnt(3)
    v_mfma_f32_16x16x32_bf16 v[48:51], v[104:107], a[64:67], v[48:51]
    s_add_u32 m0, s73, 114176
    ds_read_b64_tr_b16 v[238:239], v10 offset:18432
    v_mfma_f32_16x16x32_bf16 v[48:51], v[108:111], a[72:75], v[48:51]
    buffer_load_dwordx4 v20, s[44:47], s24 offen offset:512 sc1 lds
    s_waitcnt lgkmcnt(2)
    v_mfma_f32_16x16x32_bf16 v[48:51], v[112:115], a[80:83], v[48:51]
    ds_read_b128 v[120:123], v14 offset:33792
    v_mfma_f32_16x16x32_bf16 v[48:51], v[116:119], a[88:91], v[48:51]
    ds_read_b128 v[124:127], v14 offset:37888
    v_lshrrev_b32 v30, 2, v26
    v_mfma_f32_16x16x32_bf16 v[52:55], v[116:119], a[92:95], v[52:55]
    ds_read_b128 v[128:131], v14 offset:41984
    v_mfma_f32_16x16x32_bf16 v[52:55], v[112:115], a[84:87], v[52:55]
    ds_read_b128 v[132:135], v14 offset:46080
    v_mfma_f32_16x16x32_bf16 v[52:55], v[108:111], a[76:79], v[52:55]
    s_add_u32 m0, s73, 114944
    ds_read_b64_tr_b16 v[244:245], v10 offset:20480
    v_mfma_f32_16x16x32_bf16 v[52:55], v[104:107], a[68:71], v[52:55]
    buffer_load_dwordx4 v23, s[44:47], s25 offen offset:768 sc1 lds
    s_waitcnt lgkmcnt(3)
    v_mfma_f32_16x16x32_bf16 v[36:39], v[120:123], a[100:103], v[36:39]
    s_add_u32 m0, s73, 116736
    ds_read_b64_tr_b16 v[246:247], v10 offset:22528
    v_mfma_f32_16x16x32_bf16 v[36:39], v[124:127], a[108:111], v[36:39]
    buffer_load_dwordx4 v20, s[44:47], s25 offen offset:0 sc1 lds
    s_waitcnt lgkmcnt(2)
    v_mfma_f32_16x16x32_bf16 v[36:39], v[128:131], a[116:119], v[36:39]
    ds_read_b128 v[104:107], v14 offset:34816
    v_lshrrev_b32 v31, 2, v18
    v_mfma_f32_16x16x32_bf16 v[36:39], v[132:135], a[124:127], v[36:39]
    ds_read_b128 v[108:111], v14 offset:38912
    v_mfma_f32_16x16x32_bf16 v[32:35], v[132:135], a[120:123], v[32:35]
    ds_read_b128 v[112:115], v14 offset:43008
    v_mfma_f32_16x16x32_bf16 v[32:35], v[128:131], a[112:115], v[32:35]
    ds_read_b128 v[116:119], v14 offset:47104
    v_mfma_f32_16x16x32_bf16 v[32:35], v[124:127], a[104:107], v[32:35]
    s_add_u32 m0, s73, 117248
    ds_read_b64_tr_b16 v[240:241], v11 offset:16384
    v_mfma_f32_16x16x32_bf16 v[32:35], v[120:123], a[96:99], v[32:35]
    buffer_load_dwordx4 v20, s[44:47], s25 offen offset:512 sc1 lds
    s_waitcnt lgkmcnt(3)
    v_mfma_f32_16x16x32_bf16 v[40:43], v[104:107], a[96:99], v[40:43]
    ds_read_b64_tr_b16 v[242:243], v11 offset:18432
    buffer_load_ushort v102, v30, s[60:63], 0 offen offset:0
    v_mfma_f32_16x16x32_bf16 v[40:43], v[108:111], a[104:107], v[40:43]
    s_waitcnt lgkmcnt(2)
    v_mfma_f32_16x16x32_bf16 v[40:43], v[112:115], a[112:115], v[40:43]
    ds_read_b128 v[120:123], v14 offset:35840
    v_mfma_f32_16x16x32_bf16 v[40:43], v[116:119], a[120:123], v[40:43]
    ds_read_b128 v[124:127], v14 offset:39936
    v_mfma_f32_16x16x32_bf16 v[44:47], v[116:119], a[124:127], v[44:47]
    ds_read_b128 v[128:131], v14 offset:44032
    v_mfma_f32_16x16x32_bf16 v[44:47], v[112:115], a[116:119], v[44:47]
    ds_read_b128 v[132:135], v14 offset:48128
    v_mfma_f32_16x16x32_bf16 v[44:47], v[108:111], a[108:111], v[44:47]
    ds_read_b64_tr_b16 v[248:249], v11 offset:20480
    buffer_load_ushort v103, v30, s[60:63], 0 offen offset:32
    v_mfma_f32_16x16x32_bf16 v[44:47], v[104:107], a[100:103], v[44:47]
    s_waitcnt lgkmcnt(3)
    v_mfma_f32_16x16x32_bf16 v[52:55], v[120:123], a[100:103], v[52:55]
    ds_read_b64_tr_b16 v[250:251], v11 offset:22528
    v_mfma_f32_16x16x32_bf16 v[52:55], v[124:127], a[108:111], v[52:55]
    s_waitcnt lgkmcnt(2)
    v_mfma_f32_16x16x32_bf16 v[52:55], v[128:131], a[116:119], v[52:55]
    s_waitcnt vmcnt(10) lgkmcnt(0)
    s_barrier
    v_mfma_f32_16x16x32_bf16 v[52:55], v[132:135], a[124:127], v[52:55]
    ds_read_b128 v[104:107], v14 offset:49152
    v_mfma_f32_16x16x32_bf16 v[48:51], v[132:135], a[120:123], v[48:51]
    ds_read_b128 v[108:111], v14 offset:53248
    buffer_load_ushort v27, v31, s[60:63], 0 offen offset:0
    v_mfma_f32_16x16x32_bf16 v[48:51], v[128:131], a[112:115], v[48:51]
    ds_read_b128 v[112:115], v14 offset:57344
    v_mfma_f32_16x16x32_bf16 v[48:51], v[124:127], a[104:107], v[48:51]
    ds_read_b128 v[116:119], v14 offset:61440
    v_mfma_f32_16x16x32_bf16 v[48:51], v[120:123], a[96:99], v[48:51]
    s_waitcnt lgkmcnt(2)
    v_mfma_f32_16x16x32_bf16 v[32:35], v[104:107], a[128:131], v[32:35]
    s_add_u32 m0, s73, 130304
    v_mfma_f32_16x16x32_bf16 v[32:35], v[108:111], a[136:139], v[32:35]
    buffer_load_dwordx4 v23, s[44:47], s26 offen offset:768 sc1 lds
    s_waitcnt lgkmcnt(0)
    v_mfma_f32_16x16x32_bf16 v[32:35], v[112:115], a[144:147], v[32:35]
    ds_read_b128 v[120:123], v14 offset:50176
    v_mfma_f32_16x16x32_bf16 v[32:35], v[116:119], a[152:155], v[32:35]
    ds_read_b128 v[124:127], v14 offset:54272
    v_mfma_f32_16x16x32_bf16 v[36:39], v[116:119], a[156:159], v[36:39]
    ds_read_b128 v[128:131], v14 offset:58368
    v_mfma_f32_16x16x32_bf16 v[36:39], v[112:115], a[148:151], v[36:39]
    ds_read_b128 v[132:135], v14 offset:62464
    v_mfma_f32_16x16x32_bf16 v[36:39], v[108:111], a[140:143], v[36:39]
    s_add_u32 m0, s73, 132096
    v_mfma_f32_16x16x32_bf16 v[36:39], v[104:107], a[132:135], v[36:39]
    buffer_load_dwordx4 v20, s[44:47], s26 offen offset:0 sc1 lds
    s_waitcnt lgkmcnt(2)
    v_mfma_f32_16x16x32_bf16 v[44:47], v[120:123], a[132:135], v[44:47]
    s_add_u32 m0, s73, 132608
    buffer_load_dwordx4 v[88:91], v252, s[56:59], 0 offen
    v_mfma_f32_16x16x32_bf16 v[44:47], v[124:127], a[140:143], v[44:47]
    buffer_load_dwordx4 v20, s[44:47], s26 offen offset:512 sc1 lds
    s_waitcnt lgkmcnt(0)
    v_mfma_f32_16x16x32_bf16 v[44:47], v[128:131], a[148:151], v[44:47]
    ds_read_b128 v[104:107], v14 offset:51200
    v_mfma_f32_16x16x32_bf16 v[44:47], v[132:135], a[156:159], v[44:47]
    ds_read_b128 v[108:111], v14 offset:55296
    v_mfma_f32_16x16x32_bf16 v[40:43], v[132:135], a[152:155], v[40:43]
    ds_read_b128 v[112:115], v14 offset:59392
    v_mfma_f32_16x16x32_bf16 v[40:43], v[128:131], a[144:147], v[40:43]
    ds_read_b128 v[116:119], v14 offset:63488
    v_mfma_f32_16x16x32_bf16 v[40:43], v[124:127], a[136:139], v[40:43]
    s_add_u32 m0, s73, 134144
    v_mfma_f32_16x16x32_bf16 v[40:43], v[120:123], a[128:131], v[40:43]
    buffer_load_dwordx4 v21, s[44:47], s18 offen offset:0 sc1 lds
    s_waitcnt lgkmcnt(2)
    v_mfma_f32_16x16x32_bf16 v[48:51], v[104:107], a[128:131], v[48:51]
    v_mfma_f32_16x16x32_bf16 v[48:51], v[108:111], a[136:139], v[48:51]
    s_waitcnt lgkmcnt(0)
    v_mfma_f32_16x16x32_bf16 v[48:51], v[112:115], a[144:147], v[48:51]
    ds_read_b128 v[120:123], v14 offset:52224
    v_mfma_f32_16x16x32_bf16 v[48:51], v[116:119], a[152:155], v[48:51]
    ds_read_b128 v[124:127], v14 offset:56320
    v_mfma_f32_16x16x32_bf16 v[52:55], v[116:119], a[156:159], v[52:55]
    ds_read_b128 v[128:131], v14 offset:60416
    v_mfma_f32_16x16x32_bf16 v[52:55], v[112:115], a[148:151], v[52:55]
    ds_read_b128 v[132:135], v14 offset:64512
    v_mfma_f32_16x16x32_bf16 v[52:55], v[108:111], a[140:143], v[52:55]
    v_mfma_f32_16x16x32_bf16 v[52:55], v[104:107], a[132:135], v[52:55]
    s_waitcnt lgkmcnt(2)
    v_mfma_f32_16x16x32_bf16 v[36:39], v[120:123], a[164:167], v[36:39]
    buffer_load_dwordx4 v[92:95], v252, s[56:59], s40 offen
    v_mfma_f32_16x16x32_bf16 v[36:39], v[124:127], a[172:175], v[36:39]
    s_waitcnt lgkmcnt(0)
    v_mfma_f32_16x16x32_bf16 v[36:39], v[128:131], a[180:183], v[36:39]
    s_waitcnt vmcnt(13)
    s_barrier
    v_mfma_f32_16x16x32_bf16 v[36:39], v[132:135], a[188:191], v[36:39]
    ds_read_b128 v[104:107], v14 offset:0
    v_mfma_f32_16x16x32_bf16 v[32:35], v[132:135], a[184:187], v[32:35]
    ds_read_b128 v[108:111], v14 offset:4096
    v_mfma_f32_16x16x32_bf16 v[32:35], v[128:131], a[176:179], v[32:35]
    ds_read_b128 v[112:115], v14 offset:8192
    v_mfma_f32_16x16x32_bf16 v[32:35], v[124:127], a[168:171], v[32:35]
    ds_read_b128 v[116:119], v14 offset:12288
    v_mfma_f32_16x16x32_bf16 v[32:35], v[120:123], a[160:163], v[32:35]
    s_waitcnt lgkmcnt(2)
    v_mfma_f32_16x16x32_bf16 v[40:43], v[104:107], a[160:163], v[40:43]
    s_add_u32 m0, s73, 146944
    v_mfma_f32_16x16x32_bf16 v[40:43], v[108:111], a[168:171], v[40:43]
    buffer_load_dwordx4 v21, s[44:47], s18 offen offset:512 sc1 lds
    s_waitcnt lgkmcnt(0)
    v_mfma_f32_16x16x32_bf16 v[40:43], v[112:115], a[176:179], v[40:43]
    ds_read_b128 v[120:123], v14 offset:1024
    v_mfma_f32_16x16x32_bf16 v[40:43], v[116:119], a[184:187], v[40:43]
    ds_read_b128 v[124:127], v14 offset:5120
    v_mfma_f32_16x16x32_bf16 v[44:47], v[116:119], a[188:191], v[44:47]
    ds_read_b128 v[128:131], v14 offset:9216
    v_mfma_f32_16x16x32_bf16 v[44:47], v[112:115], a[180:183], v[44:47]
    ds_read_b128 v[132:135], v14 offset:13312
    v_mfma_f32_16x16x32_bf16 v[44:47], v[108:111], a[172:175], v[44:47]
    s_add_u32 m0, s73, 148480
    v_mfma_f32_16x16x32_bf16 v[44:47], v[104:107], a[164:167], v[44:47]
    buffer_load_dwordx4 v21, s[44:47], s19 offen offset:0 sc1 lds
    s_waitcnt lgkmcnt(2)
    v_mfma_f32_16x16x32_bf16 v[52:55], v[120:123], a[164:167], v[52:55]
    s_add_u32 m0, s73, 148992
    buffer_load_dwordx2 v[142:143], v253, s[56:59], 0 offen
    v_mfma_f32_16x16x32_bf16 v[52:55], v[124:127], a[172:175], v[52:55]
    buffer_load_dwordx4 v21, s[44:47], s19 offen offset:512 sc1 lds
    s_waitcnt lgkmcnt(0)
    v_mfma_f32_16x16x32_bf16 v[52:55], v[128:131], a[180:183], v[52:55]
    ds_read_b128 v[104:107], v14 offset:2048
    v_mfma_f32_16x16x32_bf16 v[52:55], v[132:135], a[188:191], v[52:55]
    ds_read_b128 v[108:111], v14 offset:6144
    v_mfma_f32_16x16x32_bf16 v[48:51], v[132:135], a[184:187], v[48:51]
    ds_read_b128 v[112:115], v14 offset:10240
    v_mfma_f32_16x16x32_bf16 v[48:51], v[128:131], a[176:179], v[48:51]
    ds_read_b128 v[116:119], v14 offset:14336
    v_mfma_f32_16x16x32_bf16 v[48:51], v[124:127], a[168:171], v[48:51]
    s_add_u32 m0, s73, 150528
    v_mfma_f32_16x16x32_bf16 v[48:51], v[120:123], a[160:163], v[48:51]
    buffer_load_dwordx4 v21, s[44:47], s20 offen offset:0 sc1 lds
    s_waitcnt lgkmcnt(2)
    v_mfma_f32_16x16x32_bf16 v[32:35], v[104:107], a[192:195], v[32:35]
    v_mfma_f32_16x16x32_bf16 v[32:35], v[108:111], a[200:203], v[32:35]
    s_waitcnt vmcnt(11)
    s_waitcnt lgkmcnt(0)
    v_mfma_f32_16x16x32_bf16 v[32:35], v[112:115], a[208:211], v[32:35]
    ds_read_b128 v[120:123], v14 offset:3072
    v_mfma_f32_16x16x32_bf16 v[32:35], v[116:119], a[216:219], v[32:35]
    ds_read_b128 v[124:127], v14 offset:7168
    v_mfma_f32_16x16x32_bf16 v[36:39], v[116:119], a[220:223], v[36:39]
    ds_read_b128 v[128:131], v14 offset:11264
    v_lshlrev_b32 v72, 16, v102
    v_mfma_f32_16x16x32_bf16 v[36:39], v[112:115], a[212:215], v[36:39]
    ds_read_b128 v[132:135], v14 offset:15360
    v_mfma_f32_16x16x32_bf16 v[36:39], v[108:111], a[204:207], v[36:39]
    v_lshlrev_b32 v73, 16, v102
    v_mfma_f32_16x16x32_bf16 v[36:39], v[104:107], a[196:199], v[36:39]
    buffer_load_dwordx2 v[96:97], v26, s[44:47], s42 offen offset:0 sc1
    s_waitcnt lgkmcnt(2)
    v_mfma_f32_16x16x32_bf16 v[44:47], v[120:123], a[196:199], v[44:47]
    v_mfma_f32_16x16x32_bf16 v[44:47], v[124:127], a[204:207], v[44:47]
    v_lshlrev_b32 v74, 16, v102
    s_waitcnt lgkmcnt(0)
    v_mfma_f32_16x16x32_bf16 v[44:47], v[128:131], a[212:215], v[44:47]
    s_barrier
    v_mfma_f32_16x16x32_bf16 v[44:47], v[132:135], a[220:223], v[44:47]
    ds_read_b128 v[104:107], v14 offset:16384
    v_mfma_f32_16x16x32_bf16 v[40:43], v[132:135], a[216:219], v[40:43]
    ds_read_b128 v[108:111], v14 offset:20480
    v_lshlrev_b32 v75, 16, v102
    v_mfma_f32_16x16x32_bf16 v[40:43], v[128:131], a[208:211], v[40:43]
    ds_read_b128 v[112:115], v14 offset:24576
    v_mfma_f32_16x16x32_bf16 v[40:43], v[124:127], a[200:203], v[40:43]
    ds_read_b128 v[116:119], v14 offset:28672
    v_lshlrev_b32 v76, 16, v103
    v_mfma_f32_16x16x32_bf16 v[40:43], v[120:123], a[192:195], v[40:43]
    s_waitcnt lgkmcnt(2)
    v_mfma_f32_16x16x32_bf16 v[48:51], v[104:107], a[192:195], v[48:51]
    s_add_u32 m0, s73, 97792
    v_lshlrev_b32 v77, 16, v103
    v_mfma_f32_16x16x32_bf16 v[48:51], v[108:111], a[200:203], v[48:51]
    buffer_load_dwordx4 v21, s[44:47], s20 offen offset:512 sc1 lds
    s_waitcnt lgkmcnt(0)
    v_mfma_f32_16x16x32_bf16 v[48:51], v[112:115], a[208:211], v[48:51]
    ds_read_b128 v[120:123], v14 offset:17408
    v_mfma_f32_16x16x32_bf16 v[48:51], v[116:119], a[216:219], v[48:51]
    ds_read_b128 v[124:127], v14 offset:21504
    v_mfma_f32_16x16x32_bf16 v[52:55], v[116:119], a[220:223], v[52:55]
    ds_read_b128 v[128:131], v14 offset:25600
    v_lshlrev_b32 v78, 16, v103
    v_mfma_f32_16x16x32_bf16 v[52:55], v[112:115], a[212:215], v[52:55]
    ds_read_b128 v[132:135], v14 offset:29696
    v_mfma_f32_16x16x32_bf16 v[52:55], v[108:111], a[204:207], v[52:55]
    s_add_u32 m0, s73, 99328
    v_lshlrev_b32 v79, 16, v103
    v_mfma_f32_16x16x32_bf16 v[52:55], v[104:107], a[196:199], v[52:55]
    buffer_load_dwordx4 v21, s[44:47], s21 offen offset:0 sc1 lds
    s_waitcnt lgkmcnt(2)
    v_mfma_f32_16x16x32_bf16 v[36:39], v[120:123], a[228:231], v[36:39]
    buffer_load_dwordx2 v[98:99], v26, s[44:47], s42 offen offset:128 sc1
    s_add_u32 m0, s73, 99840
    v_lshlrev_b32 v80, 16, v102
    v_mfma_f32_16x16x32_bf16 v[36:39], v[124:127], a[236:239], v[36:39]
    buffer_load_dwordx4 v21, s[44:47], s21 offen offset:512 sc1 lds
    s_waitcnt lgkmcnt(0)
    v_mfma_f32_16x16x32_bf16 v[36:39], v[128:131], a[244:247], v[36:39]
    ds_read_b128 v[104:107], v14 offset:18432
    v_mfma_f32_16x16x32_bf16 v[36:39], v[132:135], a[252:255], v[36:39]
    ds_read_b128 v[108:111], v14 offset:22528
    v_mfma_f32_16x16x32_bf16 v[32:35], v[132:135], a[248:251], v[32:35]
    ds_read_b128 v[112:115], v14 offset:26624
    v_lshlrev_b32 v81, 16, v102
    v_mfma_f32_16x16x32_bf16 v[32:35], v[128:131], a[240:243], v[32:35]
    ds_read_b128 v[116:119], v14 offset:30720
    v_mfma_f32_16x16x32_bf16 v[32:35], v[124:127], a[232:235], v[32:35]
    s_add_u32 m0, s73, 101376
    v_lshlrev_b32 v82, 16, v102
    v_mfma_f32_16x16x32_bf16 v[32:35], v[120:123], a[224:227], v[32:35]
    buffer_load_dwordx4 v21, s[44:47], s22 offen offset:0 sc1 lds
    s_waitcnt lgkmcnt(2)
    v_mfma_f32_16x16x32_bf16 v[40:43], v[104:107], a[224:227], v[40:43]
    v_mfma_f32_16x16x32_bf16 v[40:43], v[108:111], a[232:235], v[40:43]
    v_lshlrev_b32 v83, 16, v102
    s_waitcnt lgkmcnt(0)
L_pl_X_7:
    s_cbranch_execz L_wret
    v_mfma_f32_16x16x32_bf16 v[40:43], v[112:115], a[240:243], v[40:43]
    ds_read_b128 v[120:123], v14 offset:19456
    v_mfma_f32_16x16x32_bf16 v[40:43], v[116:119], a[248:251], v[40:43]
    ds_read_b128 v[124:127], v14 offset:23552
    v_mfma_f32_16x16x32_bf16 v[44:47], v[116:119], a[252:255], v[44:47]
    ds_read_b128 v[128:131], v14 offset:27648
    v_lshlrev_b32 v84, 16, v103
    v_mfma_f32_16x16x32_bf16 v[44:47], v[112:115], a[244:247], v[44:47]
    ds_read_b128 v[132:135], v14 offset:31744
    v_mfma_f32_16x16x32_bf16 v[44:47], v[108:111], a[236:239], v[44:47]
    v_lshlrev_b32 v85, 16, v103
    v_mfma_f32_16x16x32_bf16 v[44:47], v[104:107], a[228:231], v[44:47]
    buffer_load_dwordx2 v[100:101], v18, s[44:47], s42 offen offset:0 sc1
    s_waitcnt lgkmcnt(2)
    v_mfma_f32_16x16x32_bf16 v[52:55], v[120:123], a[228:231], v[52:55]
    v_mfma_f32_16x16x32_bf16 v[52:55], v[124:127], a[236:239], v[52:55]
    v_lshlrev_b32 v86, 16, v103
    s_waitcnt lgkmcnt(0)
    v_mfma_f32_16x16x32_bf16 v[52:55], v[128:131], a[244:247], v[52:55]
    s_waitcnt vmcnt(13)
    s_barrier
    v_mfma_f32_16x16x32_bf16 v[52:55], v[132:135], a[252:255], v[52:55]
    ds_read_b128 v[104:107], v14 offset:32768
    v_lshlrev_b32 v87, 16, v103
    v_mfma_f32_16x16x32_bf16 v[48:51], v[132:135], a[248:251], v[48:51]
    ds_read_b128 v[108:111], v14 offset:36864
    v_add_u32 v10, 65536, v10
    v_mfma_f32_16x16x32_bf16 v[48:51], v[128:131], a[240:243], v[48:51]
    ds_read_b128 v[112:115], v14 offset:40960
    v_mfma_f32_16x16x32_bf16 v[48:51], v[124:127], a[232:235], v[48:51]
    ds_read_b128 v[116:119], v14 offset:45056
    v_add_u32 v11, 65536, v11
    v_mfma_f32_16x16x32_bf16 v[48:51], v[120:123], a[224:227], v[48:51]
    v_lshlrev_b32 v27, 16, v27
    s_branch L_Dc
L_idle:
    s_waitcnt vmcnt(0)
    s_barrier
    s_mov_b64 exec, 0
    s_call_b64 s[82:83], L_wc_D
    s_mov_b64 exec, -1
    s_mov_b32 s60, s36
    s_and_b32 s61, s37, 0xffff
    s_mov_b32 s62, 4096
    s_mov_b32 s63, 0x20000
    v_and_b32 v24, 15, v2
    s_lshl_b32 s7, s71, 6
    v_add_u32 v24, s7, v24
    s_and_b32 s8, s3, 1
    s_lshl_b32 s4, s8, 5
    v_add_u32 v25, s4, v24
    v_lshlrev_b32 v26, 3, v25
    v_mul_u32_u24 v25, 1152, v25
    v_bfe_u32 v31, v2, 4, 1
    v_lshl_add_u32 v25, v31, 5, v25
    v_lshrrev_b32 v31, 5, v2
    v_lshl_add_u32 v25, v31, 4, v25
    s_bfe_u32 s7, s2, 0x20003
    s_mul_i32 s7, s7, 288
    s_lshl_b32 s4, s72, 6
    s_add_u32 s4, s4, s7
    v_add_u32 v252, s4, v25
    s_xor_b32 s8, s3, s72
    s_and_b32 s4, s72, 1
    s_lshl1_add_u32 s4, s4, s8
    v_lshl_add_u32 v24, s4, 4, v24
    s_add_u32 s7, s7, 256
    s_cmp_lt_u32 s8, 2
    s_cselect_b32 s7, s7, 0x40000000
    v_lshlrev_b32 v18, 3, v24
    v_mul_u32_u24 v24, 1152, v24
    v_lshrrev_b32 v31, 4, v2
    v_lshl_add_u32 v24, v31, 3, v24
    v_add_u32 v253, s7, v24
    v_lshrrev_b32 v24, 3, v2
    v_and_b32 v25, 7, v2
    v_bfe_u32 v31, v2, 4, 2
    v_lshlrev_b32 v31, 1, v31
    v_xor_b32 v25, v25, v31
    v_lshlrev_b32 v24, 12, v24
    v_lshl_add_u32 v24, v25, 4, v24
    s_mul_i32 s7, s72, 36
    s_bitcmp1_b32 s3, 0
    s_addc_u32 s7, s7, 0
    s_lshl_b32 s7, s7, 17
    s_lshl_b32 s8, s71, 7
    s_add_u32 s7, s7, s8
    v_add_u32 v4, s7, v24
    v_add_u32 v5, 31744, v4
    v_add_u32 v6, 31744, v5
    v_add_u32 v7, 31744, v6
    v_lshrrev_b32 v24, 2, v2
    v_lshlrev_b32 v24, 7, v24
    v_and_b32 v25, 3, v2
    v_lshl_add_u32 v24, v25, 3, v24
    s_and_b32 s7, s73, 8192
    v_add_u32 v24, s7, v24
    v_bfe_u32 v31, v2, 3, 2
    s_and_b32 s7, s3, 1
    s_lshl_b32 s7, s7, 1
    v_xor_b32 v31, s7, v31
    v_lshl_add_u32 v10, v31, 5, v24
    v_xor_b32 v11, 32, v10
    v_and_b32 v24, 15, v2
    v_lshrrev_b32 v25, 4, v2
    v_mul_u32_u24 v25, 17408, v25
    v_lshl_add_u32 v24, v24, 4, v25
    s_mul_i32 s7, s72, 36
    s_and_b32 s8, s3, 1
    s_add_u32 s7, s7, s8
    s_mul_i32 s7, s7, 69632
    s_bfe_u32 s8, s2, 0x20003
    s_lshl_b32 s8, s8, 12
    s_add_u32 s7, s7, s8
    s_add_u32 s7, s7, 12795904
    v_add_u32 v23, s7, v24
    s_xor_b32 s7, s72, 0
    v_lshl_add_u32 v19, s7, 10, v23
    s_xor_b32 s7, s72, 1
    v_lshl_add_u32 v20, s7, 10, v23
    s_xor_b32 s7, s72, 2
    v_lshl_add_u32 v21, s7, 10, v23
    s_xor_b32 s7, s72, 3
    v_lshl_add_u32 v22, s7, 10, v23
    v_lshlrev_b32 v14, 4, v2
    v_add_u32 v14, 98304, v14
    v_add_u32 v1, 0x10000, v14
    s_bitcmp1_b32 s3, 1
    s_cselect_b32 s18, s85, s84
    s_mul_i32 s18, s18, 139264
    s_cselect_b32 s19, s87, s86
    s_mul_i32 s19, s19, 139264
    s_cselect_b32 s20, s89, s88
    s_mul_i32 s20, s20, 139264
    s_cselect_b32 s21, s91, s90
    s_mul_i32 s21, s21, 139264
    s_cselect_b32 s22, s93, s92
    s_mul_i32 s22, s22, 139264
    s_cselect_b32 s23, s95, s94
    s_mul_i32 s23, s23, 139264
    s_cselect_b32 s24, s97, s96
    s_mul_i32 s24, s24, 139264
    s_cselect_b32 s25, s99, s98
    s_mul_i32 s25, s25, 139264
    s_cselect_b32 s26, s101, s100
    s_mul_i32 s26, s26, 139264
    s_sub_u32 s4, s75, 252
    s_mul_i32 s4, s4, 1152
    s_mul_i32 s5, s3, 64
    s_add_u32 s4, s4, s5
    s_add_u32 s4, s4, 896
    s_lshl_b32 s4, s4, 12
    s_add_u32 s4, s4, 384
    v_lshlrev_b32 v24, 10, v2
    buffer_load_dword v255, v24, s[52:55], s4 offen
    s_add_u32 s4, s4, 65536
    buffer_load_dword v255, v24, s[52:55], s4 offen
    s_add_u32 s4, s4, 65536
    buffer_load_dword v255, v24, s[52:55], s4 offen
    s_add_u32 s4, s4, 65536
    buffer_load_dword v255, v24, s[52:55], s4 offen
    s_add_u32 s4, s4, 65536
    s_add_u32 m0, s73, 32768
    s_lshl_b32 s14, s84, 18
    buffer_load_dwordx4 v4, s[52:55], s14 offen offset:0 lds
    buffer_load_dwordx4 v5, s[52:55], s14 offen offset:1024 lds
    buffer_load_dwordx4 v6, s[52:55], s14 offen offset:2048 lds
    buffer_load_dwordx4 v7, s[52:55], s14 offen offset:3072 lds
    s_add_u32 m0, s73, 49152
    s_lshl_b32 s14, s85, 18
    buffer_load_dwordx4 v4, s[52:55], s14 offen offset:0 lds
    buffer_load_dwordx4 v5, s[52:55], s14 offen offset:1024 lds
    buffer_load_dwordx4 v6, s[52:55], s14 offen offset:2048 lds
    buffer_load_dwordx4 v7, s[52:55], s14 offen offset:3072 lds
    s_add_u32 m0, s73, 65536
    s_lshl_b32 s14, s86, 18
    buffer_load_dwordx4 v4, s[52:55], s14 offen offset:0 lds
    buffer_load_dwordx4 v5, s[52:55], s14 offen offset:1024 lds
    buffer_load_dwordx4 v6, s[52:55], s14 offen offset:2048 lds
    buffer_load_dwordx4 v7, s[52:55], s14 offen offset:3072 lds
    s_add_u32 m0, s73, 81920
    s_lshl_b32 s14, s87, 18
    buffer_load_dwordx4 v4, s[52:55], s14 offen offset:0 lds
    buffer_load_dwordx4 v5, s[52:55], s14 offen offset:1024 lds
    buffer_load_dwordx4 v6, s[52:55], s14 offen offset:2048 lds
    buffer_load_dwordx4 v7, s[52:55], s14 offen offset:3072 lds
    s_add_u32 m0, s73, 98304
    s_lshl_b32 s14, s88, 18
    buffer_load_dwordx4 v4, s[52:55], s14 offen offset:0 lds
    buffer_load_dwordx4 v5, s[52:55], s14 offen offset:1024 lds
    buffer_load_dwordx4 v6, s[52:55], s14 offen offset:2048 lds
    buffer_load_dwordx4 v7, s[52:55], s14 offen offset:3072 lds
    s_add_u32 m0, s73, 114688
    s_lshl_b32 s14, s89, 18
    buffer_load_dwordx4 v4, s[52:55], s14 offen offset:0 lds
    buffer_load_dwordx4 v5, s[52:55], s14 offen offset:1024 lds
    buffer_load_dwordx4 v6, s[52:55], s14 offen offset:2048 lds
    buffer_load_dwordx4 v7, s[52:55], s14 offen offset:3072 lds
    s_add_u32 m0, s73, 131072
    s_lshl_b32 s14, s90, 18
    buffer_load_dwordx4 v4, s[52:55], s14 offen offset:0 lds
    buffer_load_dwordx4 v5, s[52:55], s14 offen offset:1024 lds
    buffer_load_dwordx4 v6, s[52:55], s14 offen offset:2048 lds
    buffer_load_dwordx4 v7, s[52:55], s14 offen offset:3072 lds
    s_add_u32 m0, s73, 147456
    s_lshl_b32 s14, s91, 18
    buffer_load_dwordx4 v4, s[52:55], s14 offen offset:0 lds
    buffer_load_dwordx4 v5, s[52:55], s14 offen offset:1024 lds
    buffer_load_dwordx4 v6, s[52:55], s14 offen offset:2048 lds
    buffer_load_dwordx4 v7, s[52:55], s14 offen offset:3072 lds
    s_waitcnt vmcnt(28)
    s_barrier
    ds_read_b64_tr_b16 a[0:1], v10 offset:32768
    ds_read_b64_tr_b16 a[2:3], v10 offset:34816
    ds_read_b64_tr_b16 a[8:9], v10 offset:36864
    ds_read_b64_tr_b16 a[10:11], v10 offset:38912
    ds_read_b64_tr_b16 a[4:5], v11 offset:32768
    ds_read_b64_tr_b16 a[6:7], v11 offset:34816
    ds_read_b64_tr_b16 a[12:13], v11 offset:36864
    ds_read_b64_tr_b16 a[14:15], v11 offset:38912
    s_waitcnt vmcnt(24) lgkmcnt(0)
    s_barrier
    ds_read_b64_tr_b16 a[16:17], v10 offset:49152
    s_add_u32 m0, s73, 32768
    s_lshl_b32 s14, s92, 18
    ds_read_b64_tr_b16 a[18:19], v10 offset:51200
    buffer_load_dwordx4 v4, s[52:55], s14 offen offset:0 lds
    ds_read_b64_tr_b16 a[24:25], v10 offset:53248
    ds_read_b64_tr_b16 a[26:27], v10 offset:55296
    buffer_load_dwordx4 v5, s[52:55], s14 offen offset:1024 lds
    ds_read_b64_tr_b16 a[20:21], v11 offset:49152
    buffer_load_dwordx4 v6, s[52:55], s14 offen offset:2048 lds
    ds_read_b64_tr_b16 a[22:23], v11 offset:51200
    ds_read_b64_tr_b16 a[28:29], v11 offset:53248
    buffer_load_dwordx4 v7, s[52:55], s14 offen offset:3072 lds
    ds_read_b64_tr_b16 a[30:31], v11 offset:55296
    s_waitcnt vmcnt(24) lgkmcnt(0)
    s_barrier
    v_add_u32 v10, 65536, v10
    ds_read_b64_tr_b16 a[32:33], v10 offset:0
    s_add_u32 m0, s73, 49152
    s_lshl_b32 s14, s93, 18
    ds_read_b64_tr_b16 a[34:35], v10 offset:2048
    buffer_load_dwordx4 v4, s[52:55], s14 offen offset:0 lds
    ds_read_b64_tr_b16 a[40:41], v10 offset:4096
    ds_read_b64_tr_b16 a[42:43], v10 offset:6144
    buffer_load_dwordx4 v5, s[52:55], s14 offen offset:1024 lds
    v_add_u32 v11, 65536, v11
    ds_read_b64_tr_b16 a[36:37], v11 offset:0
    buffer_load_dwordx4 v6, s[52:55], s14 offen offset:2048 lds
    ds_read_b64_tr_b16 a[38:39], v11 offset:2048
    ds_read_b64_tr_b16 a[44:45], v11 offset:4096
    buffer_load_dwordx4 v7, s[52:55], s14 offen offset:3072 lds
    ds_read_b64_tr_b16 a[46:47], v11 offset:6144
    s_waitcnt vmcnt(24) lgkmcnt(0)
    s_barrier
    ds_read_b64_tr_b16 a[48:49], v10 offset:16384
    s_add_u32 m0, s73, 65536
    s_lshl_b32 s14, s94, 18
    ds_read_b64_tr_b16 a[50:51], v10 offset:18432
    buffer_load_dwordx4 v4, s[52:55], s14 offen offset:0 lds
    ds_read_b64_tr_b16 a[56:57], v10 offset:20480
    ds_read_b64_tr_b16 a[58:59], v10 offset:22528
    buffer_load_dwordx4 v5, s[52:55], s14 offen offset:1024 lds
    ds_read_b64_tr_b16 a[52:53], v11 offset:16384
    buffer_load_dwordx4 v6, s[52:55], s14 offen offset:2048 lds
    ds_read_b64_tr_b16 a[54:55], v11 offset:18432
    ds_read_b64_tr_b16 a[60:61], v11 offset:20480
    buffer_load_dwordx4 v7, s[52:55], s14 offen offset:3072 lds
    ds_read_b64_tr_b16 a[62:63], v11 offset:22528
    s_waitcnt vmcnt(24) lgkmcnt(0)
    s_barrier
    ds_read_b64_tr_b16 a[64:65], v10 offset:32768
    s_add_u32 m0, s73, 81920
    s_lshl_b32 s14, s95, 18
    ds_read_b64_tr_b16 a[66:67], v10 offset:34816
    buffer_load_dwordx4 v4, s[52:55], s14 offen offset:0 lds
    ds_read_b64_tr_b16 a[72:73], v10 offset:36864
    ds_read_b64_tr_b16 a[74:75], v10 offset:38912
    buffer_load_dwordx4 v5, s[52:55], s14 offen offset:1024 lds
    ds_read_b64_tr_b16 a[68:69], v11 offset:32768
    buffer_load_dwordx4 v6, s[52:55], s14 offen offset:2048 lds
    ds_read_b64_tr_b16 a[70:71], v11 offset:34816
    ds_read_b64_tr_b16 a[76:77], v11 offset:36864
    buffer_load_dwordx4 v7, s[52:55], s14 offen offset:3072 lds
    ds_read_b64_tr_b16 a[78:79], v11 offset:38912
    s_waitcnt vmcnt(24) lgkmcnt(0)
    s_barrier
    ds_read_b64_tr_b16 a[80:81], v10 offset:49152
    s_add_u32 m0, s73, 98304
    s_lshl_b32 s14, s96, 18
    ds_read_b64_tr_b16 a[82:83], v10 offset:51200
    buffer_load_dwordx4 v4, s[52:55], s14 offen offset:0 lds
    ds_read_b64_tr_b16 a[88:89], v10 offset:53248
    ds_read_b64_tr_b16 a[90:91], v10 offset:55296
    buffer_load_dwordx4 v5, s[52:55], s14 offen offset:1024 lds
    ds_read_b64_tr_b16 a[84:85], v11 offset:49152
    buffer_load_dwordx4 v6, s[52:55], s14 offen offset:2048 lds
    ds_read_b64_tr_b16 a[86:87], v11 offset:51200
    ds_read_b64_tr_b16 a[92:93], v11 offset:53248
    buffer_load_dwordx4 v7, s[52:55], s14 offen offset:3072 lds
    ds_read_b64_tr_b16 a[94:95], v11 offset:55296
    s_waitcnt vmcnt(24) lgkmcnt(0)
    s_barrier
    v_add_u32 v10, 65536, v10
    ds_read_b64_tr_b16 a[96:97], v10 offset:0
    s_add_u32 m0, s73, 114688
    s_lshl_b32 s14, s97, 18
    ds_read_b64_tr_b16 a[98:99], v10 offset:2048
    buffer_load_dwordx4 v4, s[52:55], s14 offen offset:0 lds
    ds_read_b64_tr_b16 a[104:105], v10 offset:4096
    ds_read_b64_tr_b16 a[106:107], v10 offset:6144
    buffer_load_dwordx4 v5, s[52:55], s14 offen offset:1024 lds
    v_add_u32 v11, 65536, v11
    ds_read_b64_tr_b16 a[100:101], v11 offset:0
    buffer_load_dwordx4 v6, s[52:55], s14 offen offset:2048 lds
    ds_read_b64_tr_b16 a[102:103], v11 offset:2048
    ds_read_b64_tr_b16 a[108:109], v11 offset:4096
    buffer_load_dwordx4 v7, s[52:55], s14 offen offset:3072 lds
    ds_read_b64_tr_b16 a[110:111], v11 offset:6144
    s_waitcnt vmcnt(24) lgkmcnt(0)
    s_barrier
    ds_read_b64_tr_b16 a[112:113], v10 offset:16384
    s_add_u32 m0, s73, 131072
    s_lshl_b32 s14, s98, 18
    ds_read_b64_tr_b16 a[114:115], v10 offset:18432
    buffer_load_dwordx4 v4, s[52:55], s14 offen offset:0 lds
    ds_read_b64_tr_b16 a[120:121], v10 offset:20480
    ds_read_b64_tr_b16 a[122:123], v10 offset:22528
    buffer_load_dwordx4 v5, s[52:55], s14 offen offset:1024 lds
    ds_read_b64_tr_b16 a[116:117], v11 offset:16384
    buffer_load_dwordx4 v6, s[52:55], s14 offen offset:2048 lds
    ds_read_b64_tr_b16 a[118:119], v11 offset:18432
    ds_read_b64_tr_b16 a[124:125], v11 offset:20480
    buffer_load_dwordx4 v7, s[52:55], s14 offen offset:3072 lds
    ds_read_b64_tr_b16 a[126:127], v11 offset:22528
    s_waitcnt vmcnt(24) lgkmcnt(0)
    s_barrier
    v_add_u32 v10, -131072, v10
    ds_read_b64_tr_b16 a[128:129], v10 offset:32768
    s_add_u32 m0, s73, 147456
    s_lshl_b32 s14, s99, 18
    ds_read_b64_tr_b16 a[130:131], v10 offset:34816
    buffer_load_dwordx4 v4, s[52:55], s14 offen offset:0 lds
    ds_read_b64_tr_b16 a[136:137], v10 offset:36864
    ds_read_b64_tr_b16 a[138:139], v10 offset:38912
    buffer_load_dwordx4 v5, s[52:55], s14 offen offset:1024 lds
    v_add_u32 v11, -131072, v11
    ds_read_b64_tr_b16 a[132:133], v11 offset:32768
    buffer_load_dwordx4 v6, s[52:55], s14 offen offset:2048 lds
    ds_read_b64_tr_b16 a[134:135], v11 offset:34816
    ds_read_b64_tr_b16 a[140:141], v11 offset:36864
    buffer_load_dwordx4 v7, s[52:55], s14 offen offset:3072 lds
    ds_read_b64_tr_b16 a[142:143], v11 offset:38912
    s_waitcnt vmcnt(24) lgkmcnt(0)
    s_barrier
    ds_read_b64_tr_b16 a[144:145], v10 offset:49152
    s_add_u32 m0, s73, 0
    s_lshl_b32 s14, s100, 18
    ds_read_b64_tr_b16 a[146:147], v10 offset:51200
    buffer_load_dwordx4 v4, s[52:55], s14 offen offset:0 lds
    ds_read_b64_tr_b16 a[152:153], v10 offset:53248
    ds_read_b64_tr_b16 a[154:155], v10 offset:55296
    buffer_load_dwordx4 v5, s[52:55], s14 offen offset:1024 lds
    ds_read_b64_tr_b16 a[148:149], v11 offset:49152
    buffer_load_dwordx4 v6, s[52:55], s14 offen offset:2048 lds
    ds_read_b64_tr_b16 a[150:151], v11 offset:51200
    ds_read_b64_tr_b16 a[156:157], v11 offset:53248
    buffer_load_dwordx4 v7, s[52:55], s14 offen offset:3072 lds
    ds_read_b64_tr_b16 a[158:159], v11 offset:55296
    s_waitcnt vmcnt(24) lgkmcnt(0)
    s_barrier
    v_add_u32 v10, 65536, v10
    ds_read_b64_tr_b16 a[160:161], v10 offset:0
    s_add_u32 m0, s73, 16384
    s_lshl_b32 s14, s101, 18
    ds_read_b64_tr_b16 a[162:163], v10 offset:2048
    buffer_load_dwordx4 v4, s[52:55], s14 offen offset:0 lds
    ds_read_b64_tr_b16 a[168:169], v10 offset:4096
    ds_read_b64_tr_b16 a[170:171], v10 offset:6144
    buffer_load_dwordx4 v5, s[52:55], s14 offen offset:1024 lds
    v_add_u32 v11, 65536, v11
    ds_read_b64_tr_b16 a[164:165], v11 offset:0
    buffer_load_dwordx4 v6, s[52:55], s14 offen offset:2048 lds
    ds_read_b64_tr_b16 a[166:167], v11 offset:2048
    ds_read_b64_tr_b16 a[172:173], v11 offset:4096
    buffer_load_dwordx4 v7, s[52:55], s14 offen offset:3072 lds
    ds_read_b64_tr_b16 a[174:175], v11 offset:6144
    s_waitcnt vmcnt(24) lgkmcnt(0)
    s_barrier
    ds_read_b64_tr_b16 a[176:177], v10 offset:16384
    ds_read_b64_tr_b16 a[178:179], v10 offset:18432
    ds_read_b64_tr_b16 a[184:185], v10 offset:20480
    ds_read_b64_tr_b16 a[186:187], v10 offset:22528
    ds_read_b64_tr_b16 a[180:181], v11 offset:16384
    ds_read_b64_tr_b16 a[182:183], v11 offset:18432
    ds_read_b64_tr_b16 a[188:189], v11 offset:20480
    ds_read_b64_tr_b16 a[190:191], v11 offset:22528
    s_waitcnt vmcnt(20) lgkmcnt(0)
    s_barrier
    ds_read_b64_tr_b16 a[192:193], v10 offset:32768
    ds_read_b64_tr_b16 a[194:195], v10 offset:34816
    ds_read_b64_tr_b16 a[200:201], v10 offset:36864
    ds_read_b64_tr_b16 a[202:203], v10 offset:38912
    ds_read_b64_tr_b16 a[196:197], v11 offset:32768
    ds_read_b64_tr_b16 a[198:199], v11 offset:34816
    ds_read_b64_tr_b16 a[204:205], v11 offset:36864
    ds_read_b64_tr_b16 a[206:207], v11 offset:38912
    s_waitcnt vmcnt(16) lgkmcnt(0)
    s_barrier
    ds_read_b64_tr_b16 a[208:209], v10 offset:49152
    ds_read_b64_tr_b16 a[210:211], v10 offset:51200
    ds_read_b64_tr_b16 a[216:217], v10 offset:53248
    ds_read_b64_tr_b16 a[218:219], v10 offset:55296
    ds_read_b64_tr_b16 a[212:213], v11 offset:49152
    ds_read_b64_tr_b16 a[214:215], v11 offset:51200
    ds_read_b64_tr_b16 a[220:221], v11 offset:53248
    ds_read_b64_tr_b16 a[222:223], v11 offset:55296
    s_waitcnt vmcnt(12) lgkmcnt(0)
    s_barrier
    v_add_u32 v10, 65536, v10
    ds_read_b64_tr_b16 a[224:225], v10 offset:0
    ds_read_b64_tr_b16 a[226:227], v10 offset:2048
    ds_read_b64_tr_b16 a[232:233], v10 offset:4096
    ds_read_b64_tr_b16 a[234:235], v10 offset:6144
    v_add_u32 v11, 65536, v11
    ds_read_b64_tr_b16 a[228:229], v11 offset:0
    ds_read_b64_tr_b16 a[230:231], v11 offset:2048
    ds_read_b64_tr_b16 a[236:237], v11 offset:4096
    ds_read_b64_tr_b16 a[238:239], v11 offset:6144
    s_waitcnt vmcnt(8) lgkmcnt(0)
    s_barrier
    ds_read_b64_tr_b16 a[240:241], v10 offset:16384
    ds_read_b64_tr_b16 a[242:243], v10 offset:18432
    ds_read_b64_tr_b16 a[248:249], v10 offset:20480
    ds_read_b64_tr_b16 a[250:251], v10 offset:22528
    ds_read_b64_tr_b16 a[244:245], v11 offset:16384
    ds_read_b64_tr_b16 a[246:247], v11 offset:18432
    ds_read_b64_tr_b16 a[252:253], v11 offset:20480
    ds_read_b64_tr_b16 a[254:255], v11 offset:22528
    s_waitcnt lgkmcnt(0)
    s_barrier
    v_add_u32 v10, -131072, v10
    v_add_u32 v11, -131072, v11
    s_mov_b64 exec, 0
    s_call_b64 s[82:83], L_wc_D
    s_mov_b64 exec, -1
    s_bfe_u32 s4, s2, 0x20003
    s_lshl2_add_u32 s4, s72, s4
    s_lshl_b32 s4, s4, 3
    s_lshr_b32 s5, s2, 4
    s_and_b32 s5, s5, 6
    s_add_u32 s4, s4, s5
    s_and_b32 s5, s2, 1
    s_add_u32 s4, s4, s5
    s_lshl_b32 s4, s4, 7
    s_add_u32 s4, s4, 12566528
    v_lshl_add_u32 v28, v2, 2, s4
    s_cmp_eq_u32 s3, 0
    s_cselect_b32 s4, 18, 0
    v_cmp_gt_u32 vcc, s4, v2
    v_mov_b32 v13, 0x40000000
    s_nop 0
    v_cndmask_b32 v28, v13, v28, vcc
    v_mov_b32 v13, s68
    v_cndmask_b32 v13, 0, v13, vcc
    s_mov_b32 s5, 0
L_iw:
    s_sleep 16
    v_mov_b32 v29, 0
    buffer_atomic_add v29, v28, s[44:47], 0 offen sc0 sc1
    s_waitcnt vmcnt(0)
    v_cmp_eq_u32 vcc, 0, v13
    s_nop 1
    s_mov_b64 s[6:7], vcc
    v_cmp_ne_u32 vcc, v13, v29
    s_nop 1
    s_andn2_b64 s[8:9], exec, vcc
    s_andn2_b64 s[8:9], s[8:9], s[6:7]
    s_cbranch_scc1 L_ix
    s_cmp_eq_u64 s[6:7], exec
    s_cbranch_scc1 L_ix
    s_add_u32 s5, s5, 1
    s_cmp_lt_u32 s5, 100000
    s_cbranch_scc1 L_iw
L_ix:
    v_mov_b32 v29, 0
    buffer_atomic_add v29, v28, s[44:47], 0 offen sc0 sc1
    s_branch L_DX
L_end:
.section .rodata,"a"
.p2align 6
.amdhsa_kernel recurrent_scan__ssm_conv_h3__mixer_token_mlp__prompt_kernel
  .amdhsa_next_free_vgpr 512
  .amdhsa_next_free_sgpr 102
  .amdhsa_accum_offset 256
  .amdhsa_group_segment_fixed_size 0
  .amdhsa_kernarg_size 112
  .amdhsa_user_sgpr_count 2
  .amdhsa_user_sgpr_kernarg_segment_ptr 1
  .amdhsa_system_sgpr_workgroup_id_x 1
  .amdhsa_float_denorm_mode_32 3
.end_amdhsa_kernel
```

```asm
; @launch grid=(256,1,1) block=(256,1,1) lds=163840
.amdgcn_target "amdgcn-amd-amdhsa--gfx950"
.text
.globl recurrent_scan__ssm_conv_h3__mixer_token_mlp__prompt_kernel
.p2align 8
.type recurrent_scan__ssm_conv_h3__mixer_token_mlp__prompt_kernel,@function
recurrent_scan__ssm_conv_h3__mixer_token_mlp__prompt_kernel:
    s_cmp_lt_u32 s2, 256
    s_cbranch_scc0 L_exit
    s_load_dwordx2 s[56:57], s[0:1], 0
    s_load_dwordx2 s[48:49], s[0:1], 8
    s_load_dwordx2 s[52:53], s[0:1], 16
    s_load_dwordx2 s[60:61], s[0:1], 24
    s_load_dwordx16 s[16:31], s[0:1], 0
    s_load_dwordx8 s[32:39], s[0:1], 64
    s_load_dwordx4 s[40:43], s[0:1], 96
    s_memrealtime s[12:13]
    v_lshrrev_b32 v1, 6, v0
    v_and_b32 v2, 63, v0
    s_getpc_b64 s[6:7]
L_pc:
    s_lshr_b32 s4, s2, 1
    s_and_b32 s4, s4, 124
    v_add_u32 v22, s4, v1
    v_lshl_add_u32 v22, v2, 7, v22
    v_lshlrev_b32 v22, 7, v22
    v_min_u32 v22, L_end-L_pc-4, v22
    s_mov_b64 exec, 31
    global_load_dword v255, v22, s[6:7]
    s_mov_b64 exec, -1
    v_readfirstlane_b32 s3, v1
    s_and_b32 s4, s2, 7
    s_lshr_b32 s5, s2, 3
    s_lshl_b32 s4, s4, 5
    s_add_u32 s68, s4, s5
    v_lshrrev_b32 v3, 5, v0
    v_and_b32 v4, 31, v0
    v_mul_u32_u24 v5, 1152, v3
    v_mad_u32_u24 v5, v4, 12, v5
    s_mul_i32 s15, s68, 9216
    s_mul_i32 s4, s3, 3072
    s_add_u32 s5, s4, s15
    s_sub_u32 s5, s5, 3456
    v_lshlrev_b32 v6, 4, v2
    v_add_u32 v7, s5, v6
    v_add_u32 v58, 1024, v7
    s_add_u32 s4, s4, 114688
    s_lshl_b32 s5, s3, 11
    s_add_u32 s11, s5, s15
    s_add_u32 s5, s5, 127360
    s_cmp_lt_u32 s2, 216
    s_cselect_b32 s9, 0, 106496
    s_sub_u32 s4, s4, s9
    s_sub_u32 s5, s5, s9
    s_mov_b32 m0, s4
    s_mov_b32 s58, 2359296
    s_mov_b32 s59, 0x20000
    s_mov_b32 s50, 2359296
    s_mov_b32 s51, 0x20000
    s_mov_b32 s54, 2359296
    s_mov_b32 s55, 0x20000
    s_mov_b32 s62, 4608
    s_mov_b32 s63, 0x20000
    v_lshlrev_b32 v59, 3, v0
    s_movk_i32 s10, 4096
    v_lshlrev_b32 v91, 3, v2
    v_or_b32 v22, s2, v0
    v_lshlrev_b32 v22, 8, v22
    s_mov_b32 s66, 256
    s_mov_b32 s67, 0x20000
    s_waitcnt lgkmcnt(0)
    buffer_load_dwordx3 v[8:10], v5, s[56:59], s15 offen offset:0
    buffer_load_dwordx3 v[12:14], v5, s[56:59], s15 offen offset:384
    buffer_load_dwordx3 v[16:18], v5, s[56:59], s15 offen offset:768
    s_mov_b32 s64, s40
    s_and_b32 s65, s41, 0xffff
    s_or_b32 s12, s12, 1
    v_mov_b32 v23, s12
    buffer_store_dword v23, v22, s[64:67], 0 offen sc1
    buffer_load_dwordx4 v7, s[48:51], 0 offen lds
    s_add_u32 m0, s4, 1024
    s_cmp_eq_u32 s3, 3
    buffer_load_dwordx4 v58, s[48:51], 0 offen lds
    buffer_load_dwordx4 v58, s[48:51], 0 offen offset:1024 lds
    s_cbranch_scc1 L_xld
L_nox:
    s_mov_b32 m0, s5
    buffer_load_dwordx2 v[98:99], v59, s[60:63], 0 offen
    buffer_load_dwordx4 v6, s[52:55], s11 offen lds
    buffer_load_dwordx4 v6, s[52:55], s11 offen offset:1024 lds
    buffer_load_dwordx2 v[100:101], v59, s[60:63], 0 offen offset:2048
    buffer_load_dwordx2 v[102:103], v59, s[60:63], s10 offen
    s_mov_b32 s44, s42
    s_and_b32 s45, s43, 0xffff
    s_mov_b32 s46, 36585472
    s_mov_b32 s47, 0x20000
    s_and_b32 s5, s2, 7
    s_lshr_b32 s6, s2, 3
    s_lshr_b32 s7, s6, 2
    s_lshr_b32 s8, s3, 1
    s_lshl1_add_u32 s9, s7, s8
    s_cmp_ge_u32 s9, 10
    s_addc_u32 s14, s9, 0
    s_cmp_ge_u32 s9, 3
    s_addc_u32 s14, s14, 0
    s_lshl3_add_u32 s8, s8, 3
    s_cmp_eq_u32 s7, 7
    s_cselect_b32 s14, s8, s14
    s_and_b32 s4, s5, 1
    s_lshl4_add_u32 s71, s4, s14
    s_lshr_b32 s13, s5, 1
    s_mov_b32 s72, s13
    s_and_b32 s101, s6, 3
    s_lshl_b32 s73, s3, 12
    s_mov_b32 s52, s34
    s_and_b32 s53, s35, 0xffff
    s_mov_b32 s54, 18874368
    s_mov_b32 s55, 0x20000
    s_cmp_lt_u32 s6, 27
    s_cbranch_scc0 L_aux
    s_branch L_org
L_exit:
    s_endpgm
L_xld:
    s_mov_b64 exec, 0xffffff
    buffer_load_dwordx4 v58, s[48:51], 0 offen offset:2048 lds
    s_mov_b64 exec, -1
    s_mov_b32 m0, s5
    s_nop 0
    buffer_load_dwordx4 v6, s[52:55], s11 offen offset:2048 lds
    s_branch L_nox
L_nw_G:
    s_mov_b32 s5, 0
L_nl_G:
    buffer_load_dword v45, v54, s[64:67], 0 offen sc1
    s_waitcnt vmcnt(0)
    v_readfirstlane_b32 s68, v45
    s_nop 1
    s_cmp_lg_u32 s68, 0
    s_cbranch_scc1 L_ng_G
    s_add_u32 s5, s5, 1
    s_cmp_lt_u32 s5, 100000
    s_cbranch_scc1 L_nl_G
    s_branch L_ng_G
L_rs_p1G:
    s_mov_b32 s5, 0
L_rt_p1G:
    s_mov_b64 exec, vcc
    v_mov_b32 v29, 0
    buffer_atomic_add v29, v28, s[44:47], 0 offen sc0 sc1
    s_waitcnt vmcnt(0)
    v_cmp_ne_u32 vcc, v12, v29
    s_cbranch_vccz L_rx_p1G
    s_add_u32 s5, s5, 1
    s_cmp_lt_u32 s5, 100000
    s_cbranch_scc1 L_rt_p1G
L_rx_p1G:
    s_mov_b64 exec, -1
    s_branch L_ok_p1G
L_rs_p5:
    s_mov_b32 s5, 0
L_rt_p5:
    s_mov_b64 exec, vcc
    buffer_load_dword v29, v28, s[44:47], 0 offen sc1
    s_waitcnt vmcnt(0)
    v_cmp_ne_u32 vcc, s68, v29
    s_cbranch_vccz L_rx_p5
    s_add_u32 s5, s5, 1
    s_cmp_lt_u32 s5, 100000
    s_cbranch_scc1 L_rt_p5
L_rx_p5:
    s_mov_b64 exec, -1
    s_branch L_ok_p5
L_nw_X:
    s_mov_b32 s5, 0
L_nl_X:
    buffer_load_dword v45, v54, s[64:67], 0 offen sc1
    s_waitcnt vmcnt(0)
    v_readfirstlane_b32 s68, v45
    s_nop 1
    s_cmp_lg_u32 s68, 0
    s_cbranch_scc1 L_ng_X
    s_add_u32 s5, s5, 1
    s_cmp_lt_u32 s5, 100000
    s_cbranch_scc1 L_nl_X
    s_branch L_ng_X
L_rs_p1X:
    s_mov_b32 s5, 0
L_rt_p1X:
    s_mov_b64 exec, vcc
    v_mov_b32 v29, 0
    buffer_atomic_add v29, v28, s[44:47], 0 offen sc0 sc1
    s_waitcnt vmcnt(0)
    v_cmp_ne_u32 vcc, s68, v29
    s_cbranch_vccz L_rx_p1X
    s_add_u32 s5, s5, 1
    s_cmp_lt_u32 s5, 100000
    s_cbranch_scc1 L_rt_p1X
L_rx_p1X:
    s_mov_b64 exec, -1
    s_branch L_ok_p1X
L_rs_p2G:
    s_mov_b32 s5, 0
L_rt_p2G:
    s_mov_b64 exec, vcc
    v_mov_b32 v16, 0
    buffer_atomic_add v16, v15, s[44:47], 0 offen sc0 sc1
    s_waitcnt vmcnt(0)
    v_cmp_ne_u32 vcc, v13, v16
    s_cbranch_vccz L_rx_p2G
    s_add_u32 s5, s5, 1
    s_cmp_lt_u32 s5, 100000
    s_cbranch_scc1 L_rt_p2G
L_rx_p2G:
    s_mov_b64 exec, -1
    s_branch L_ok_p2G
L_xs_a:
    s_mov_b32 s5, 0
L_xt_a:
    buffer_load_dwordx4 v[40:43], v136, s[44:47], s34 offen offset:0 sc1
    buffer_load_dwordx4 v[44:47], v136, s[44:47], s34 offen offset:1024 sc1
    buffer_load_dwordx4 v[48:51], v136, s[44:47], s34 offen offset:2048 sc1
    s_waitcnt vmcnt(0)
    v_bitop3_b32 v43, v43, v47, s68 bitop3:0x7e
    v_bitop3_b32 v43, v43, v51, s68 bitop3:0xf6
    v_cmp_ne_u32 vcc, 0, v43
    s_cbranch_vccz L_xo_a
    s_add_u32 s5, s5, 1
    s_cmp_lt_u32 s5, 100000
    s_cbranch_scc1 L_xt_a
    s_branch L_xo_a
L_as_b:
    s_mov_b32 s5, 0
L_at_b:
    v_mov_b32 v141, 0
    buffer_atomic_add v141, v139, s[44:47], s11 offen offset:2060 sc0 sc1
    s_waitcnt vmcnt(0)
    v_cmp_ne_u32 vcc, v140, v141
    s_cbranch_vccz L_ao_b
    s_add_u32 s5, s5, 1
    s_cmp_lt_u32 s5, 100000
    s_cbranch_scc1 L_at_b
    s_branch L_ao_b
L_xs_b:
    s_mov_b32 s5, 0
L_xt_b:
    buffer_load_dwordx4 v[56:59], v136, s[44:47], s11 offen offset:0 sc1
    buffer_load_dwordx4 v[60:63], v136, s[44:47], s11 offen offset:1024 sc1
    buffer_load_dwordx4 v[64:67], v136, s[44:47], s11 offen offset:2048 sc1
    s_waitcnt vmcnt(0)
    v_bitop3_b32 v59, v59, v63, s68 bitop3:0x7e
    v_bitop3_b32 v59, v59, v67, s68 bitop3:0xf6
    v_cmp_ne_u32 vcc, 0, v59
    s_cbranch_vccz L_xo_b
    s_add_u32 s5, s5, 1
    s_cmp_lt_u32 s5, 100000
    s_cbranch_scc1 L_xt_b
    s_branch L_xo_b
L_xs_z:
    s_mov_b32 s5, 0
L_xt_z:
    buffer_load_dwordx4 v[72:75], v136, s[44:47], s12 offen offset:0 sc1
    buffer_load_dwordx4 v[76:79], v136, s[44:47], s12 offen offset:1024 sc1
    buffer_load_dwordx4 v[80:83], v136, s[44:47], s12 offen offset:2048 sc1
    s_waitcnt vmcnt(0)
    v_bitop3_b32 v75, v75, v79, s68 bitop3:0x7e
    v_bitop3_b32 v75, v75, v83, s68 bitop3:0xf6
    v_cmp_ne_u32 vcc, 0, v75
    s_cbranch_vccz L_xo_z
    s_add_u32 s5, s5, 1
    s_cmp_lt_u32 s5, 100000
    s_cbranch_scc1 L_xt_z
    s_branch L_xo_z
L_rs_p3:
    s_mov_b32 s5, 0
L_rt_p3:
    s_mov_b64 exec, vcc
    buffer_load_dword v189, v188, s[44:47], 0 offen sc1
    s_waitcnt vmcnt(0)
    v_cmp_ne_u32 vcc, s68, v189
    s_cbranch_vccz L_rx_p3
    s_add_u32 s5, s5, 1
    s_cmp_lt_u32 s5, 100000
    s_cbranch_scc1 L_rt_p3
L_rx_p3:
    s_mov_b64 exec, -1
    s_branch L_ok_p3
L_xs_8:
    s_mov_b32 s5, 0
L_xt_8:
    buffer_load_dwordx4 v[204:207], v136, s[44:47], s35 offen offset:0 sc1
    buffer_load_dwordx4 v[208:211], v136, s[44:47], s35 offen offset:1024 sc1
    buffer_load_dwordx4 v[212:215], v136, s[44:47], s35 offen offset:2048 sc1
    buffer_load_dwordx4 v[216:219], v136, s[44:47], s35 offen offset:3072 sc1
    s_waitcnt vmcnt(0)
    v_bitop3_b32 v207, v207, v211, s36 bitop3:0x7e
    v_bitop3_b32 v207, v207, v215, s36 bitop3:0xf6
    v_bitop3_b32 v207, v207, v219, s36 bitop3:0xf6
    v_cmp_ne_u32 vcc, 0, v207
    s_cbranch_vccz L_xo_8
    s_add_u32 s5, s5, 1
    s_cmp_lt_u32 s5, 100000
    s_cbranch_scc1 L_xt_8
    s_branch L_xo_8
L_rs_p2X:
    s_mov_b32 s5, 0
L_rt_p2X:
    s_mov_b64 exec, vcc
    v_mov_b32 v29, 0
    buffer_atomic_add v29, v28, s[44:47], 0 offen sc0 sc1
    s_waitcnt vmcnt(0)
    v_cmp_ne_u32 vcc, v13, v29
    s_cbranch_vccz L_rx_p2X
    s_add_u32 s5, s5, 1
    s_cmp_lt_u32 s5, 100000
    s_cbranch_scc1 L_rt_p2X
L_rx_p2X:
    s_mov_b64 exec, -1
    s_branch L_ok_p2X
L_wc_G:
    s_cmp_eq_u32 s3, 0
    s_cbranch_scc1 L_pl_G_0
    s_cmp_eq_u32 s3, 1
    s_cbranch_scc1 L_pl_G_1
    s_cmp_eq_u32 s3, 2
    s_cbranch_scc1 L_pl_G_2
    s_branch L_pl_G_3
L_wc_X:
    s_cmp_eq_u32 s3, 0
    s_cbranch_scc1 L_pl_X_0
    s_cmp_eq_u32 s3, 1
    s_cbranch_scc1 L_pl_X_1
    s_cmp_eq_u32 s3, 2
    s_cbranch_scc1 L_pl_X_2
    s_branch L_pl_X_3
L_wc_D:
    s_cmp_eq_u32 s3, 0
    s_cbranch_scc1 L_pl_D_0
    s_cmp_eq_u32 s3, 1
    s_cbranch_scc1 L_pl_D_1
    s_cmp_eq_u32 s3, 2
    s_cbranch_scc1 L_pl_D_2
    s_branch L_wret
L_wret:
    s_setpc_b64 s[82:83]
.p2align 12
L_org:
    s_mul_i32 s7, s6, 21846
    s_lshr_b32 s7, s7, 16
    s_mul_i32 s8, s7, 3
    s_sub_u32 s12, s6, s8
    s_mul_i32 s8, s13, 9
    s_add_u32 s69, s8, s7
    s_lshl1_add_u32 s70, s12, s4
    s_mul_i32 s8, s69, 6
    s_add_u32 s75, s8, s70
    s_mov_b32 s48, s30
    s_and_b32 s49, s31, 0xffff
    s_mov_b32 s50, 18874368
    s_mov_b32 s51, 0x20000
    s_add_u32 s12, s12, s7
    s_mul_i32 s8, s12, 21846
    s_lshr_b32 s8, s8, 16
    s_mul_i32 s8, s8, 3
    s_sub_u32 s12, s12, s8
    s_mul_i32 s4, s4, 1179648
    s_mul_i32 s7, s12, 65538
    s_lshr_b32 s7, s7, 16
    s_mul_i32 s7, s7, 73728
    s_add_u32 s5, s4, 0
    s_add_u32 s18, s7, s5
    s_add_u32 s8, s5, 221184
    s_add_u32 s19, s18, 73728
    s_cmp_eq_u32 s19, s8
    s_cselect_b32 s19, s5, s19
    s_add_u32 s20, s19, 73728
    s_cmp_eq_u32 s20, s8
    s_cselect_b32 s20, s5, s20
    s_mul_i32 s7, s12, 65538
    s_lshr_b32 s7, s7, 16
    s_mul_i32 s7, s7, 73728
    s_add_u32 s5, s4, 221184
    s_add_u32 s21, s7, s5
    s_add_u32 s8, s5, 221184
    s_add_u32 s22, s21, 73728
    s_cmp_eq_u32 s22, s8
    s_cselect_b32 s22, s5, s22
    s_add_u32 s23, s22, 73728
    s_cmp_eq_u32 s23, s8
    s_cselect_b32 s23, s5, s23
    s_mul_i32 s7, s12, 87384
    s_lshr_b32 s7, s7, 16
    s_mul_i32 s7, s7, 73728
    s_add_u32 s5, s4, 442368
    s_add_u32 s24, s7, s5
    s_add_u32 s8, s5, 294912
    s_add_u32 s25, s24, 73728
    s_cmp_eq_u32 s25, s8
    s_cselect_b32 s25, s5, s25
    s_add_u32 s26, s25, 73728
    s_cmp_eq_u32 s26, s8
    s_cselect_b32 s26, s5, s26
    s_add_u32 s27, s26, 73728
    s_cmp_eq_u32 s27, s8
    s_cselect_b32 s27, s5, s27
    s_mul_i32 s7, s12, 131076
    s_lshr_b32 s7, s7, 16
    s_mul_i32 s7, s7, 73728
    s_add_u32 s5, s4, 737280
    s_add_u32 s76, s7, s5
    s_add_u32 s8, s5, 442368
    s_add_u32 s77, s76, 73728
    s_cmp_eq_u32 s77, s8
    s_cselect_b32 s77, s5, s77
    s_add_u32 s78, s77, 73728
    s_cmp_eq_u32 s78, s8
    s_cselect_b32 s78, s5, s78
    s_add_u32 s79, s78, 73728
    s_cmp_eq_u32 s79, s8
    s_cselect_b32 s79, s5, s79
    s_add_u32 s80, s79, 73728
    s_cmp_eq_u32 s80, s8
    s_cselect_b32 s80, s5, s80
    s_add_u32 s81, s80, 73728
    s_cmp_eq_u32 s81, s8
    s_cselect_b32 s81, s5, s81
    v_lshrrev_b32 v24, 4, v2
    v_and_b32 v25, 15, v2
    v_lshlrev_b32 v26, 1, v24
    v_xor_b32 v25, v25, v26
    v_mul_u32_u24 v24, 9216, v24
    v_lshl_add_u32 v24, v25, 4, v24
    s_mul_i32 s7, s3, 147456
    s_lshl_b32 s8, s69, 8
    s_add_u32 s7, s7, s8
    v_add_u32 v148, s7, v24
    v_add_u32 v149, 35840, v148
    v_xor_b32 v24, 128, v148
    v_add_u32 v150, 71680, v24
    v_add_u32 v151, 35840, v150
    s_mov_b32 s9, 144896
    s_mov_b32 s11, 114688
    v_mul_u32_u24 v48, 1216, v3
    v_mad_u32_u24 v48, v4, 12, v48
    v_add_u32 v48, s9, v48
    v_mov_b32 v47, 0x40000000
    v_lshlrev_b32 v3, 3, v3
    s_lshl_b32 s5, s68, 6
    s_add_u32 s5, s5, 12386304
    v_cmp_eq_u32 vcc, 0, v4
    s_nop 1
    v_cndmask_b32 v49, v47, v3, vcc
    v_lshrrev_b32 v5, 4, v0
    v_and_b32 v4, 3, v2
    v_lshlrev_b32 v4, 3, v4
    v_lshl_add_u32 v5, v5, 5, v4
    v_bfe_u32 v6, v2, 2, 2
    v_mul_u32_u24 v4, 1216, v6
    v_mul_u32_u24 v6, 1152, v6
    v_add3_u32 v50, v4, v5, s9
    v_add3_u32 v51, v6, v5, s11
    s_mul_i32 s4, s3, 2176
    v_add_u32 v55, s4, v51
    v_lshlrev_b32 v52, 4, v0
    s_add_u32 s7, s15, 4096
    s_add_u32 s8, s15, 8192
    s_cmp_eq_u32 s3, 0
    s_cselect_b32 s8, s8, 0x40000000
    v_add_u32 v53, 2359296, v52
    v_mov_b32 v54, 0
    s_mul_i32 s4, s3, 1028
    s_sub_u32 s4, 8204, s4
    v_add_u32 v90, s4, v53
    s_bfe_u32 s6, s68, 0x20001
    s_lshl_b32 s6, s6, 6
    s_lshr_b32 s9, s68, 3
    s_lshl1_add_u32 s6, s9, s6
    s_and_b32 s9, s68, 1
    s_add_u32 s6, s6, s9
    s_lshl_b32 s4, s6, 2
    s_add_u32 s4, s4, 12533760
    v_lshl_add_u32 v1, v0, 10, s4
    s_lshl_b32 s4, s68, 2
    s_add_u32 s4, s4, 12599296
    v_lshl_add_u32 v46, v0, 10, s4
    v_cmp_gt_u32 vcc, 8, v0
    s_nop 1
    v_cndmask_b32 v1, v47, v1, vcc
    v_cmp_gt_u32 vcc, 4, v0
    s_nop 1
    v_cndmask_b32 v46, v47, v46, vcc
    s_waitcnt vmcnt(9)
    v_and_b32 v21, 0xffff0000, v8
    s_add_u32 m0, s73, 81920
    s_lshl_b32 s14, s18, 3
    buffer_load_dwordx4 v148, s[48:51], s14 offen offset:0 lds
    v_lshlrev_b32 v20, 16, v8
    v_and_b32 v23, 0xffff0000, v9
    v_lshlrev_b32 v22, 16, v9
    v_and_b32 v25, 0xffff0000, v10
    v_lshlrev_b32 v24, 16, v10
    v_and_b32 v27, 0xffff0000, v12
    v_lshlrev_b32 v26, 16, v12
    v_and_b32 v29, 0xffff0000, v13
    v_lshlrev_b32 v28, 16, v13
    v_and_b32 v31, 0xffff0000, v14
    v_lshlrev_b32 v30, 16, v14
    v_and_b32 v33, 0xffff0000, v16
    v_lshlrev_b32 v32, 16, v16
    v_and_b32 v35, 0xffff0000, v17
    v_lshlrev_b32 v34, 16, v17
    v_and_b32 v37, 0xffff0000, v18
    v_lshlrev_b32 v36, 16, v18
    v_pk_add_f32 v[38:39], v[20:21], v[22:23]
    v_pk_add_f32 v[40:41], v[24:25], v[26:27]
    v_pk_add_f32 v[42:43], v[28:29], v[30:31]
    v_pk_add_f32 v[44:45], v[32:33], v[34:35]
    v_pk_add_f32 v[38:39], v[38:39], v[40:41]
    v_pk_add_f32 v[42:43], v[42:43], v[44:45]
    v_pk_add_f32 v[38:39], v[38:39], v[36:37]
    v_pk_add_f32 v[38:39], v[38:39], v[42:43]
    v_add_f32 v56, v38, v39
    buffer_load_dwordx4 v149, s[48:51], s14 offen offset:1024 lds
    s_nop 0
    v_add_f32_dpp v56, v56, v56 row_ror:8 row_mask:0xf bank_mask:0xf
    s_nop 1
    v_add_f32_dpp v56, v56, v56 row_ror:4 row_mask:0xf bank_mask:0xf
    s_nop 1
    v_add_f32_dpp v56, v56, v56 row_ror:2 row_mask:0xf bank_mask:0xf
    s_nop 1
    v_add_f32_dpp v56, v56, v56 row_ror:1 row_mask:0xf bank_mask:0xf
    v_mov_b32 v57, v56
    s_nop 1
    v_permlane16_swap_b32 v56, v57
    v_add_f32 v56, v56, v57
    v_mul_f32 v56, 0x3ae38e39, v56
    v_pk_add_f32 v[20:21], v[20:21], v[56:57] op_sel_hi:[1,0] neg_lo:[0,1] neg_hi:[0,1]
    v_pk_add_f32 v[22:23], v[22:23], v[56:57] op_sel_hi:[1,0] neg_lo:[0,1] neg_hi:[0,1]
    v_pk_add_f32 v[24:25], v[24:25], v[56:57] op_sel_hi:[1,0] neg_lo:[0,1] neg_hi:[0,1]
    v_pk_add_f32 v[26:27], v[26:27], v[56:57] op_sel_hi:[1,0] neg_lo:[0,1] neg_hi:[0,1]
    v_pk_add_f32 v[28:29], v[28:29], v[56:57] op_sel_hi:[1,0] neg_lo:[0,1] neg_hi:[0,1]
    v_pk_add_f32 v[30:31], v[30:31], v[56:57] op_sel_hi:[1,0] neg_lo:[0,1] neg_hi:[0,1]
    v_pk_add_f32 v[32:33], v[32:33], v[56:57] op_sel_hi:[1,0] neg_lo:[0,1] neg_hi:[0,1]
    v_pk_add_f32 v[34:35], v[34:35], v[56:57] op_sel_hi:[1,0] neg_lo:[0,1] neg_hi:[0,1]
    v_pk_add_f32 v[36:37], v[36:37], v[56:57] op_sel_hi:[1,0] neg_lo:[0,1] neg_hi:[0,1]
    v_pk_mul_f32 v[38:39], v[20:21], v[20:21]
    v_pk_mul_f32 v[40:41], v[22:23], v[22:23]
    v_pk_fma_f32 v[38:39], v[24:25], v[24:25], v[38:39]
    v_pk_fma_f32 v[40:41], v[26:27], v[26:27], v[40:41]
    v_pk_fma_f32 v[38:39], v[28:29], v[28:29], v[38:39]
    v_pk_fma_f32 v[40:41], v[30:31], v[30:31], v[40:41]
    v_pk_fma_f32 v[38:39], v[32:33], v[32:33], v[38:39]
    v_pk_fma_f32 v[40:41], v[34:35], v[34:35], v[40:41]
    v_pk_fma_f32 v[38:39], v[36:37], v[36:37], v[38:39]
    buffer_load_dwordx4 v150, s[48:51], s14 offen offset:2048 lds
    v_pk_add_f32 v[38:39], v[38:39], v[40:41]
    v_add_f32 v18, v38, v39
    s_nop 1
    v_add_f32_dpp v18, v18, v18 row_ror:8 row_mask:0xf bank_mask:0xf
    s_nop 1
    v_add_f32_dpp v18, v18, v18 row_ror:4 row_mask:0xf bank_mask:0xf
    s_nop 1
    v_add_f32_dpp v18, v18, v18 row_ror:2 row_mask:0xf bank_mask:0xf
    s_nop 1
    v_add_f32_dpp v18, v18, v18 row_ror:1 row_mask:0xf bank_mask:0xf
    v_mov_b32 v19, v18
    s_nop 1
    v_permlane16_swap_b32 v18, v19
    v_add_f32 v18, v18, v19
    v_mul_f32 v18, 0x3ae38e39, v18
    v_cvt_pk_bf16_f32 v38, v56, v18
    v_lshlrev_b32 v106, 16, v38
    v_and_b32 v38, 0xffff0000, v38
    v_add_f32 v38, 0x3727c5ac, v38
    v_sub_f32 v56, v56, v106
    v_cvt_pk_bf16_f32 v38, v38, v38
    v_lshlrev_b32 v38, 16, v38
    v_sqrt_f32 v38, v38
    s_nop 0
    v_cvt_pk_bf16_f32 v38, v38, v38
    v_lshlrev_b32 v38, 16, v38
    v_rcp_f32 v107, v38
    s_nop 0
    v_mul_f32 v56, v56, v107
    v_mul_f32 v18, v18, v107
    v_mul_f32 v18, v18, v107
    v_cvt_pk_bf16_f32 v38, v56, v18
    v_lshlrev_b32 v39, 16, v38
    buffer_load_dwordx4 v151, s[48:51], s14 offen offset:3072 lds
    v_and_b32 v38, 0xffff0000, v38
    v_add_f32 v38, 0x3727c5ac, v38
    v_sub_f32 v56, v56, v39
    v_cvt_pk_bf16_f32 v38, v38, v38
    v_lshlrev_b32 v38, 16, v38
    v_sqrt_f32 v38, v38
    s_nop 0
    v_cvt_pk_bf16_f32 v38, v38, v38
    v_lshlrev_b32 v38, 16, v38
    v_rcp_f32 v38, v38
    s_nop 0
    v_mul_f32 v18, v107, v38
    v_mul_f32 v56, v56, v38
    v_pk_fma_f32 v[20:21], v[20:21], v[18:19], v[56:57] op_sel_hi:[1,0,0]
    v_pk_fma_f32 v[22:23], v[22:23], v[18:19], v[56:57] op_sel_hi:[1,0,0]
    v_pk_fma_f32 v[24:25], v[24:25], v[18:19], v[56:57] op_sel_hi:[1,0,0]
    v_pk_fma_f32 v[26:27], v[26:27], v[18:19], v[56:57] op_sel_hi:[1,0,0]
    v_pk_fma_f32 v[28:29], v[28:29], v[18:19], v[56:57] op_sel_hi:[1,0,0]
    v_pk_fma_f32 v[30:31], v[30:31], v[18:19], v[56:57] op_sel_hi:[1,0,0]
    v_pk_fma_f32 v[32:33], v[32:33], v[18:19], v[56:57] op_sel_hi:[1,0,0]
    v_pk_fma_f32 v[34:35], v[34:35], v[18:19], v[56:57] op_sel_hi:[1,0,0]
    v_pk_fma_f32 v[36:37], v[36:37], v[18:19], v[56:57] op_sel_hi:[1,0,0]
    v_cvt_pk_bf16_f32 v8, v20, v21
    v_cvt_pk_bf16_f32 v9, v22, v23
    v_cvt_pk_bf16_f32 v10, v24, v25
    v_cvt_pk_bf16_f32 v11, v26, v27
    v_cvt_pk_bf16_f32 v12, v28, v29
    v_cvt_pk_bf16_f32 v13, v30, v31
    v_cvt_pk_bf16_f32 v14, v32, v33
    v_cvt_pk_bf16_f32 v15, v34, v35
    v_cvt_pk_bf16_f32 v16, v36, v37
    ds_write_b32 v48, v8 offset:0
    ds_write_b32 v48, v9 offset:4
    ds_write_b32 v48, v10 offset:8
    ds_write_b32 v48, v11 offset:384
    ds_write_b32 v48, v12 offset:388
    ds_write_b32 v48, v13 offset:392
    ds_write_b32 v48, v14 offset:768
    ds_write_b32 v48, v15 offset:772
    ds_write_b32 v48, v16 offset:776
    buffer_store_dwordx2 v[106:107], v49, s[44:47], s5 offen sc1
    s_waitcnt lgkmcnt(0)
    s_barrier
    ds_read_b64_tr_b16 v[20:21], v50 offset:0
    ds_read_b64_tr_b16 v[22:23], v50 offset:4864
    ds_read_b64_tr_b16 v[24:25], v50 offset:512
    ds_read_b64_tr_b16 v[26:27], v50 offset:5376
    ds_read_b64_tr_b16 v[28:29], v50 offset:1024
    ds_read_b64_tr_b16 v[30:31], v50 offset:5888
    s_waitcnt lgkmcnt(4)
    buffer_store_dwordx4 v[20:23], v52, s[44:47], s15 offen sc1
    s_waitcnt lgkmcnt(2)
    buffer_store_dwordx4 v[24:27], v52, s[44:47], s7 offen sc1
    s_waitcnt lgkmcnt(0)
    buffer_store_dwordx4 v[28:31], v52, s[44:47], s8 offen sc1
    buffer_load_dword v45, v54, s[64:67], 0 offen sc1
    s_waitcnt vmcnt(9)
    s_barrier
    ds_read_b64_tr_b16 v[60:61], v51 offset:0
    ds_read_b64_tr_b16 v[62:63], v51 offset:4608
    ds_read_b64_tr_b16 v[64:65], v51 offset:9216
    ds_read_b64_tr_b16 v[66:67], v51 offset:12672
    ds_read_b64_tr_b16 v[68:69], v51 offset:17280
    ds_read_b64_tr_b16 v[70:71], v51 offset:512
    ds_read_b64_tr_b16 v[72:73], v51 offset:5120
    ds_read_b64_tr_b16 v[74:75], v51 offset:9728
    ds_read_b64_tr_b16 v[76:77], v51 offset:13184
    ds_read_b64_tr_b16 v[78:79], v51 offset:17792
    v_alignbit_b32 v114, v99, v99, 16
    v_alignbit_b32 v115, v98, v98, 16
    s_waitcnt lgkmcnt(5)
    v_alignbit_b32 v108, v61, v60, 16
    v_alignbit_b32 v109, v62, v61, 16
    v_alignbit_b32 v110, v63, v62, 16
    v_alignbit_b32 v111, v64, v63, 16
    v_alignbit_b32 v112, v65, v64, 16
    v_dot2_f32_bf16 v116, v60, v114, 0
    ds_read_b64_tr_b16 v[80:81], v51 offset:1024
    v_dot2_f32_bf16 v117, v108, v114, 0
    v_dot2_f32_bf16 v118, v61, v114, 0
    v_dot2_f32_bf16 v119, v109, v114, 0
    v_dot2_f32_bf16 v120, v62, v114, 0
    ds_read_b64_tr_b16 v[82:83], v51 offset:5632
    v_dot2_f32_bf16 v121, v110, v114, 0
    v_dot2_f32_bf16 v122, v63, v114, 0
    v_dot2_f32_bf16 v123, v111, v114, 0
    v_dot2_f32_bf16 v116, v61, v115, v116
    v_dot2_f32_bf16 v117, v109, v115, v117
    ds_read_b64_tr_b16 v[84:85], v51 offset:10240
    v_dot2_f32_bf16 v118, v62, v115, v118
    v_dot2_f32_bf16 v119, v110, v115, v119
    v_dot2_f32_bf16 v120, v63, v115, v120
    v_dot2_f32_bf16 v121, v111, v115, v121
    v_dot2_f32_bf16 v122, v64, v115, v122
    ds_read_b64_tr_b16 v[86:87], v51 offset:13696
    v_dot2_f32_bf16 v123, v112, v115, v123
    v_and_b32 v133, 0xffff0000, v66
    v_lshlrev_b32 v132, 16, v66
    v_and_b32 v135, 0xffff0000, v67
    v_lshlrev_b32 v134, 16, v67
    ds_read_b64_tr_b16 v[88:89], v51 offset:18304
    v_and_b32 v137, 0xffff0000, v68
    v_lshlrev_b32 v136, 16, v68
    v_and_b32 v139, 0xffff0000, v69
    v_lshlrev_b32 v138, 16, v69
    v_pk_mul_f32 v[116:117], v[116:117], v[132:133]
    v_pk_mul_f32 v[118:119], v[118:119], v[134:135]
    v_pk_mul_f32 v[120:121], v[120:121], v[136:137]
    v_pk_mul_f32 v[122:123], v[122:123], v[138:139]
    v_cvt_pk_bf16_f32 v160, v123, v122
    v_cvt_pk_bf16_f32 v161, v121, v120
    v_cvt_pk_bf16_f32 v162, v119, v118
    v_cvt_pk_bf16_f32 v163, v117, v116
    buffer_store_dwordx4 v[160:163], v53, s[44:47], s15 offen sc1
    v_alignbit_b32 v114, v101, v101, 16
    v_alignbit_b32 v115, v100, v100, 16
    s_waitcnt lgkmcnt(5)
    v_alignbit_b32 v108, v71, v70, 16
    v_alignbit_b32 v109, v72, v71, 16
    v_alignbit_b32 v110, v73, v72, 16
    v_alignbit_b32 v111, v74, v73, 16
    v_alignbit_b32 v112, v75, v74, 16
    v_dot2_f32_bf16 v124, v70, v114, 0
    v_dot2_f32_bf16 v125, v108, v114, 0
    v_dot2_f32_bf16 v126, v71, v114, 0
    v_dot2_f32_bf16 v127, v109, v114, 0
    v_dot2_f32_bf16 v128, v72, v114, 0
    v_dot2_f32_bf16 v129, v110, v114, 0
    v_dot2_f32_bf16 v130, v73, v114, 0
    v_dot2_f32_bf16 v131, v111, v114, 0
    v_dot2_f32_bf16 v124, v71, v115, v124
    v_dot2_f32_bf16 v125, v109, v115, v125
    v_dot2_f32_bf16 v126, v72, v115, v126
    v_dot2_f32_bf16 v127, v110, v115, v127
    v_dot2_f32_bf16 v128, v73, v115, v128
    v_dot2_f32_bf16 v129, v111, v115, v129
    v_dot2_f32_bf16 v130, v74, v115, v130
    v_dot2_f32_bf16 v131, v112, v115, v131
    v_and_b32 v133, 0xffff0000, v76
    v_lshlrev_b32 v132, 16, v76
    v_and_b32 v135, 0xffff0000, v77
    v_lshlrev_b32 v134, 16, v77
    v_and_b32 v137, 0xffff0000, v78
    v_lshlrev_b32 v136, 16, v78
    v_and_b32 v139, 0xffff0000, v79
    v_lshlrev_b32 v138, 16, v79
    v_pk_mul_f32 v[124:125], v[124:125], v[132:133]
    v_pk_mul_f32 v[126:127], v[126:127], v[134:135]
    v_pk_mul_f32 v[128:129], v[128:129], v[136:137]
    v_pk_mul_f32 v[130:131], v[130:131], v[138:139]
    v_cvt_pk_bf16_f32 v164, v131, v130
    v_cvt_pk_bf16_f32 v165, v129, v128
    v_cvt_pk_bf16_f32 v166, v127, v126
    v_cvt_pk_bf16_f32 v167, v125, v124
    buffer_store_dwordx4 v[164:167], v53, s[44:47], s7 offen sc1
    v_alignbit_b32 v114, v103, v103, 16
    v_alignbit_b32 v115, v102, v102, 16
    s_waitcnt lgkmcnt(0)
    v_alignbit_b32 v108, v81, v80, 16
    v_alignbit_b32 v109, v82, v81, 16
    v_alignbit_b32 v110, v83, v82, 16
    v_alignbit_b32 v111, v84, v83, 16
    v_alignbit_b32 v112, v85, v84, 16
    v_dot2_f32_bf16 v116, v80, v114, 0
    v_dot2_f32_bf16 v117, v108, v114, 0
    v_dot2_f32_bf16 v118, v81, v114, 0
    v_dot2_f32_bf16 v119, v109, v114, 0
    v_dot2_f32_bf16 v120, v82, v114, 0
    v_dot2_f32_bf16 v121, v110, v114, 0
    v_dot2_f32_bf16 v122, v83, v114, 0
    v_dot2_f32_bf16 v123, v111, v114, 0
    v_dot2_f32_bf16 v116, v81, v115, v116
    v_dot2_f32_bf16 v117, v109, v115, v117
    v_dot2_f32_bf16 v118, v82, v115, v118
    v_dot2_f32_bf16 v119, v110, v115, v119
    v_dot2_f32_bf16 v120, v83, v115, v120
    v_dot2_f32_bf16 v121, v111, v115, v121
    v_dot2_f32_bf16 v122, v84, v115, v122
    v_dot2_f32_bf16 v123, v112, v115, v123
    v_and_b32 v133, 0xffff0000, v86
    v_lshlrev_b32 v132, 16, v86
    v_and_b32 v135, 0xffff0000, v87
    v_lshlrev_b32 v134, 16, v87
    v_and_b32 v137, 0xffff0000, v88
    v_lshlrev_b32 v136, 16, v88
    v_and_b32 v139, 0xffff0000, v89
    v_lshlrev_b32 v138, 16, v89
    v_pk_mul_f32 v[116:117], v[116:117], v[132:133]
    v_pk_mul_f32 v[118:119], v[118:119], v[134:135]
    v_pk_mul_f32 v[120:121], v[120:121], v[136:137]
    v_pk_mul_f32 v[122:123], v[122:123], v[138:139]
    v_cvt_pk_bf16_f32 v168, v123, v122
    v_cvt_pk_bf16_f32 v169, v121, v120
    v_cvt_pk_bf16_f32 v170, v119, v118
    v_cvt_pk_bf16_f32 v171, v117, v116
    buffer_store_dwordx4 v[168:171], v53, s[44:47], s8 offen sc1
    s_add_u32 m0, s73, 98304
    s_lshl_b32 s14, s19, 3
    buffer_load_dwordx4 v148, s[48:51], s14 offen offset:0 lds
    buffer_load_dwordx4 v149, s[48:51], s14 offen offset:1024 lds
    buffer_load_dwordx4 v150, s[48:51], s14 offen offset:2048 lds
    buffer_load_dwordx4 v151, s[48:51], s14 offen offset:3072 lds
    s_add_u32 m0, s73, 0
    s_lshl_b32 s14, s20, 3
    buffer_load_dwordx4 v148, s[48:51], s14 offen offset:0 lds
    buffer_load_dwordx4 v149, s[48:51], s14 offen offset:1024 lds
    buffer_load_dwordx4 v150, s[48:51], s14 offen offset:2048 lds
    buffer_load_dwordx4 v151, s[48:51], s14 offen offset:3072 lds
    s_add_u32 m0, s73, 16384
    s_lshl_b32 s14, s21, 3
    buffer_load_dwordx4 v148, s[48:51], s14 offen offset:0 lds
    buffer_load_dwordx4 v149, s[48:51], s14 offen offset:1024 lds
    s_waitcnt vmcnt(13)
    v_readfirstlane_b32 s68, v45
    s_nop 1
    s_cmp_eq_u32 s68, 0
    s_cbranch_scc1 L_nw_G
L_ng_G:
    s_barrier
    v_mov_b32 v3, s68
    buffer_store_dword v3, v1, s[44:47], 0 offen sc1
    s_mov_b64 exec, 0
    s_call_b64 s[82:83], L_wc_G
    s_mov_b64 exec, -1
    s_waitcnt vmcnt(11)
    s_barrier
    buffer_store_dword v3, v46, s[44:47], 0 offen sc1
L_segG:
L_pl_G_0:
    s_cbranch_execz L_pl_G_4
    buffer_load_dwordx4 v150, s[48:51], s14 offen offset:2048 lds
    buffer_load_dwordx4 v151, s[48:51], s14 offen offset:3072 lds
    s_add_u32 m0, s73, 32768
    s_lshl_b32 s14, s22, 3
    buffer_load_dwordx4 v148, s[48:51], s14 offen offset:0 lds
    buffer_load_dwordx4 v149, s[48:51], s14 offen offset:1024 lds
    buffer_load_dwordx4 v150, s[48:51], s14 offen offset:2048 lds
    buffer_load_dwordx4 v151, s[48:51], s14 offen offset:3072 lds
    s_add_u32 m0, s73, 49152
    s_lshl_b32 s14, s23, 3
    buffer_load_dwordx4 v148, s[48:51], s14 offen offset:0 lds
    buffer_load_dwordx4 v149, s[48:51], s14 offen offset:1024 lds
    buffer_load_dwordx4 v150, s[48:51], s14 offen offset:2048 lds
    buffer_load_dwordx4 v151, s[48:51], s14 offen offset:3072 lds
    s_add_u32 m0, s73, 65536
    s_lshl_b32 s14, s24, 3
    buffer_load_dwordx4 v148, s[48:51], s14 offen offset:0 lds
    buffer_load_dwordx4 v149, s[48:51], s14 offen offset:1024 lds
    buffer_load_dwordx4 v150, s[48:51], s14 offen offset:2048 lds
    buffer_load_dwordx4 v151, s[48:51], s14 offen offset:3072 lds
    v_bfe_u32 v140, v2, 2, 2
    v_lshrrev_b32 v141, 4, v2
    v_lshl_add_u32 v142, v141, 3, v140
    v_lshlrev_b32 v142, 8, v142
    v_and_b32 v143, 3, v2
    v_lshl_add_u32 v142, v143, 3, v142
    v_and_b32 v141, 1, v141
    v_lshl_add_u32 v140, v141, 2, v140
    s_lshl_b32 s7, s3, 1
    v_xor_b32 v140, s7, v140
    v_lshl_add_u32 v152, v140, 5, v142
    v_xor_b32 v153, 32, v152
    v_add_u32 v154, 0x10000, v152
    v_add_u32 v155, 0x10000, v153
    v_and_b32 v24, 15, v2
    v_lshrrev_b32 v25, 4, v2
    v_mul_u32_u24 v26, 17408, v25
    v_lshl_add_u32 v26, v24, 4, v26
    v_mul_u32_u24 v25, 1536, v25
    v_lshl_add_u32 v25, v24, 4, v25
    v_add_u32 v159, 81920, v25
    v_add_u32 v250, 36864, v159
    s_mul_i32 s7, s3, 18432
    s_xor_b32 s8, s70, 1
    s_mul_i32 s8, s8, 1536
    s_add_u32 s7, s7, s8
    v_lshlrev_b32 v246, 4, v2
    v_add_u32 v156, s7, v246
    v_lshrrev_b32 v25, 5, v2
    v_mul_u32_u24 v25, 7680, v25
    v_add_u32 v157, v156, v25
    v_add_u32 v158, 7680, v156
    s_mul_i32 s74, s3, 3072
    s_add_u32 s74, s74, 81920
    v_mov_b32 v245, v26
    s_mov_b64 exec, 0
    s_call_b64 s[82:83], L_wc_D
    s_mov_b64 exec, -1
    s_mov_b32 s56, s32
    s_and_b32 s57, s33, 0xffff
    s_mov_b32 s58, 9216
    s_mov_b32 s59, 0x20000
    s_mov_b32 s60, s36
    s_and_b32 s61, s37, 0xffff
    s_mov_b32 s62, 4096
    s_mov_b32 s63, 0x20000
    s_and_b32 s4, s70, 1
    s_lshl1_add_u32 s4, s3, s4
    s_lshl_b32 s4, s4, 7
    s_bfe_u32 s5, s2, 0x10003
    s_lshl1_add_u32 s5, s72, s5
    s_lshr_b32 s5, s5, 0
    s_lshl_b32 s5, s5, 10
    s_add_u32 s4, s4, s5
    s_add_u32 s4, s4, 12533760
    v_lshl_add_u32 v28, v2, 2, s4
    v_cmp_gt_u32 vcc, 32, v2
    v_mov_b32 v12, 0x40000000
    s_nop 0
    v_cndmask_b32 v28, v12, v28, vcc
    v_mov_b32 v12, s68
    v_cndmask_b32 v12, 0, v12, vcc
    v_lshrrev_b32 v24, 4, v2
    v_lshlrev_b32 v25, 3, v24
    s_lshl_b32 s7, s69, 8
    s_lshl_b32 s8, s3, 6
    s_add_u32 s7, s7, s8
    buffer_load_dwordx2 v[144:145], v25, s[56:59], s7 offen
    buffer_load_dwordx2 v[146:147], v25, s[56:59], s7 offen offset:32
    s_waitcnt vmcnt(24)
    s_barrier
    ds_read_b64_tr_b16 a[0:1], v154 offset:16384
    ds_read_b64_tr_b16 a[2:3], v154 offset:17408
    ds_read_b64_tr_b16 a[4:5], v155 offset:16384
    ds_read_b64_tr_b16 a[6:7], v155 offset:17408
    ds_read_b64_tr_b16 a[8:9], v154 offset:24576
    ds_read_b64_tr_b16 a[10:11], v154 offset:25600
    ds_read_b64_tr_b16 a[12:13], v155 offset:24576
    ds_read_b64_tr_b16 a[14:15], v155 offset:25600
    ds_read_b64_tr_b16 a[16:17], v154 offset:32768
    ds_read_b64_tr_b16 a[18:19], v154 offset:33792
    ds_read_b64_tr_b16 a[20:21], v155 offset:32768
    ds_read_b64_tr_b16 a[22:23], v155 offset:33792
    ds_read_b64_tr_b16 a[24:25], v154 offset:40960
    ds_read_b64_tr_b16 a[26:27], v154 offset:41984
    ds_read_b64_tr_b16 a[28:29], v155 offset:40960
    ds_read_b64_tr_b16 a[30:31], v155 offset:41984
    s_waitcnt vmcnt(20)
    s_barrier
    ds_read_b64_tr_b16 a[32:33], v152 offset:0
    ds_read_b64_tr_b16 a[34:35], v152 offset:1024
    ds_read_b64_tr_b16 a[36:37], v153 offset:0
    ds_read_b64_tr_b16 a[38:39], v153 offset:1024
    ds_read_b64_tr_b16 a[40:41], v152 offset:8192
    ds_read_b64_tr_b16 a[42:43], v152 offset:9216
    ds_read_b64_tr_b16 a[44:45], v153 offset:8192
    ds_read_b64_tr_b16 a[46:47], v153 offset:9216
    s_waitcnt vmcnt(14)
    s_barrier
    ds_read_b64_tr_b16 a[48:49], v152 offset:16384
    ds_read_b64_tr_b16 a[50:51], v152 offset:17408
    ds_read_b64_tr_b16 a[52:53], v153 offset:16384
    ds_read_b64_tr_b16 a[54:55], v153 offset:17408
    ds_read_b64_tr_b16 a[56:57], v152 offset:24576
    ds_read_b64_tr_b16 a[58:59], v152 offset:25600
    ds_read_b64_tr_b16 a[60:61], v153 offset:24576
    ds_read_b64_tr_b16 a[62:63], v153 offset:25600
    v_mov_b32 v29, 0
    buffer_atomic_add v29, v28, s[44:47], 0 offen sc0 sc1
    s_waitcnt vmcnt(11)
    s_barrier
    ds_read_b64_tr_b16 a[64:65], v152 offset:32768
    ds_read_b64_tr_b16 a[66:67], v152 offset:33792
    ds_read_b64_tr_b16 a[68:69], v153 offset:32768
    ds_read_b64_tr_b16 a[70:71], v153 offset:33792
    ds_read_b64_tr_b16 a[72:73], v152 offset:40960
    ds_read_b64_tr_b16 a[74:75], v152 offset:41984
    ds_read_b64_tr_b16 a[76:77], v153 offset:40960
    ds_read_b64_tr_b16 a[78:79], v153 offset:41984
    s_waitcnt lgkmcnt(0)
    s_barrier
    s_waitcnt vmcnt(0)
    v_cmp_ne_u32 vcc, v12, v29
    s_cbranch_vccnz L_rs_p1G
L_ok_p1G:
    s_add_u32 m0, s74, 0
    s_nop 0
    buffer_load_dwordx4 v156, s[44:47], s18 offen offset:0 sc1 lds
    buffer_load_dwordx4 v157, s[44:47], s18 offen offset:1024 sc1 lds
    buffer_load_dwordx4 v158, s[44:47], s18 offen offset:2048 sc1 lds
    s_add_u32 m0, s74, 12288
    s_nop 0
    buffer_load_dwordx4 v156, s[44:47], s19 offen offset:0 sc1 lds
    buffer_load_dwordx4 v157, s[44:47], s19 offen offset:1024 sc1 lds
    buffer_load_dwordx4 v158, s[44:47], s19 offen offset:2048 sc1 lds
    s_add_u32 m0, s74, 24576
    s_nop 0
    buffer_load_dwordx4 v156, s[44:47], s20 offen offset:0 sc1 lds
    buffer_load_dwordx4 v157, s[44:47], s20 offen offset:1024 sc1 lds
    buffer_load_dwordx4 v158, s[44:47], s20 offen offset:2048 sc1 lds
L_pl_G_1:
    s_cbranch_execz L_pl_G_5
    s_add_u32 m0, s74, 36864
    s_nop 0
    buffer_load_dwordx4 v156, s[44:47], s21 offen offset:0 sc1 lds
    buffer_load_dwordx4 v157, s[44:47], s21 offen offset:1024 sc1 lds
    buffer_load_dwordx4 v158, s[44:47], s21 offen offset:2048 sc1 lds
    s_add_u32 m0, s73, 0
    s_lshl_b32 s14, s25, 3
    buffer_load_dwordx4 v148, s[48:51], s14 offen offset:0 lds
    buffer_load_dwordx4 v149, s[48:51], s14 offen offset:1024 lds
    buffer_load_dwordx4 v150, s[48:51], s14 offen offset:2048 lds
    buffer_load_dwordx4 v151, s[48:51], s14 offen offset:3072 lds
    s_waitcnt vmcnt(13) lgkmcnt(0)
    s_barrier
    ds_read_b128 v[80:83], v159 offset:0
    ds_read_b128 v[84:87], v159 offset:6144
    ds_read_b128 v[88:91], v159 offset:256
    ds_read_b128 v[92:95], v159 offset:6400
    ds_read_b128 v[96:99], v159 offset:512
    ds_read_b128 v[100:103], v159 offset:6656
    s_waitcnt lgkmcnt(0)
    v_mfma_f32_16x16x32_bf16 v[192:195], a[0:3], v[80:83], 0
    v_mfma_f32_16x16x32_bf16 v[192:195], a[8:11], v[84:87], v[192:195]
    ds_read_b128 v[104:107], v159 offset:768
    v_mfma_f32_16x16x32_bf16 v[196:199], a[12:15], v[84:87], 0
    ds_read_b128 v[108:111], v159 offset:6912
    v_mfma_f32_16x16x32_bf16 v[196:199], a[4:7], v[80:83], v[196:199]
    ds_read_b128 v[112:115], v159 offset:1024
    v_mfma_f32_16x16x32_bf16 v[204:207], a[4:7], v[88:91], 0
    ds_read_b128 v[116:119], v159 offset:7168
    v_mfma_f32_16x16x32_bf16 v[204:207], a[12:15], v[92:95], v[204:207]
    ds_read_b128 v[120:123], v159 offset:1280
    v_mfma_f32_16x16x32_bf16 v[200:203], a[8:11], v[92:95], 0
    ds_read_b128 v[124:127], v159 offset:7424
    v_and_b32 v24, 15, v2
    s_lshl_b32 s7, s71, 6
    v_add_u32 v24, s7, v24
    s_and_b32 s8, s3, 1
    s_lshl_b32 s4, s8, 5
    v_add_u32 v25, s4, v24
    v_lshlrev_b32 v26, 3, v25
    v_mul_u32_u24 v25, 1152, v25
    v_bfe_u32 v31, v2, 4, 1
    v_lshl_add_u32 v25, v31, 5, v25
    v_lshrrev_b32 v31, 5, v2
    v_lshl_add_u32 v25, v31, 4, v25
    s_bfe_u32 s7, s2, 0x20003
    s_mul_i32 s7, s7, 288
    s_lshl_b32 s4, s72, 6
    s_add_u32 s4, s4, s7
    v_add_u32 v252, s4, v25
    s_xor_b32 s8, s3, s72
    s_and_b32 s4, s72, 1
    s_lshl1_add_u32 s4, s4, s8
    v_lshl_add_u32 v24, s4, 4, v24
    s_add_u32 s7, s7, 256
    s_cmp_lt_u32 s8, 2
    s_cselect_b32 s7, s7, 0x40000000
    v_lshlrev_b32 v18, 3, v24
    v_mul_u32_u24 v24, 1152, v24
    v_lshrrev_b32 v31, 4, v2
    v_mfma_f32_16x16x32_bf16 v[200:203], a[0:3], v[88:91], v[200:203]
    v_mfma_f32_16x16x32_bf16 v[208:211], a[0:3], v[96:99], 0
    v_mfma_f32_16x16x32_bf16 v[208:211], a[8:11], v[100:103], v[208:211]
    v_mfma_f32_16x16x32_bf16 v[212:215], a[12:15], v[100:103], 0
    v_mfma_f32_16x16x32_bf16 v[212:215], a[4:7], v[96:99], v[212:215]
    s_waitcnt lgkmcnt(0)
    v_mfma_f32_16x16x32_bf16 v[220:223], a[4:7], v[104:107], 0
    s_waitcnt vmcnt(10)
    s_barrier
    v_mfma_f32_16x16x32_bf16 v[220:223], a[12:15], v[108:111], v[220:223]
    ds_read_b128 v[80:83], v159 offset:12288
    s_add_u32 m0, s74, 49152
    v_mfma_f32_16x16x32_bf16 v[216:219], a[8:11], v[108:111], 0
    ds_read_b128 v[84:87], v159 offset:18432
    buffer_load_dwordx4 v156, s[44:47], s22 offen offset:0 sc1 lds
    v_mfma_f32_16x16x32_bf16 v[216:219], a[0:3], v[104:107], v[216:219]
    ds_read_b128 v[88:91], v159 offset:12544
    v_mfma_f32_16x16x32_bf16 v[224:227], a[0:3], v[112:115], 0
    ds_read_b128 v[92:95], v159 offset:18688
    buffer_load_dwordx4 v157, s[44:47], s22 offen offset:1024 sc1 lds
    v_mfma_f32_16x16x32_bf16 v[224:227], a[8:11], v[116:119], v[224:227]
    ds_read_b128 v[96:99], v159 offset:12800
    v_mfma_f32_16x16x32_bf16 v[228:231], a[12:15], v[116:119], 0
    ds_read_b128 v[100:103], v159 offset:18944
    buffer_load_dwordx4 v158, s[44:47], s22 offen offset:2048 sc1 lds
    v_lshl_add_u32 v24, v31, 3, v24
    v_add_u32 v253, s7, v24
    v_lshrrev_b32 v24, 3, v2
    v_and_b32 v25, 7, v2
    v_bfe_u32 v31, v2, 4, 2
    v_lshlrev_b32 v31, 1, v31
    v_xor_b32 v25, v25, v31
    v_lshlrev_b32 v24, 12, v24
    v_lshl_add_u32 v24, v25, 4, v24
    s_mul_i32 s7, s72, 36
    s_bitcmp1_b32 s3, 0
    s_addc_u32 s7, s7, 0
    s_lshl_b32 s7, s7, 17
    s_lshl_b32 s8, s71, 7
    s_add_u32 s7, s7, s8
    v_add_u32 v4, s7, v24
    v_add_u32 v5, 31744, v4
    v_add_u32 v6, 31744, v5
    v_add_u32 v7, 31744, v6
    v_lshrrev_b32 v24, 2, v2
    v_lshlrev_b32 v24, 7, v24
    v_and_b32 v25, 3, v2
    v_lshl_add_u32 v24, v25, 3, v24
    s_and_b32 s7, s73, 8192
    v_add_u32 v24, s7, v24
    v_bfe_u32 v31, v2, 3, 2
    s_and_b32 s7, s3, 1
    v_mfma_f32_16x16x32_bf16 v[228:231], a[4:7], v[112:115], v[228:231]
    ds_read_b64_tr_b16 a[80:81], v152 offset:49152
    v_mfma_f32_16x16x32_bf16 v[236:239], a[4:7], v[120:123], 0
    ds_read_b64_tr_b16 a[82:83], v152 offset:50176
    s_add_u32 m0, s74, 61440
    v_mfma_f32_16x16x32_bf16 v[236:239], a[12:15], v[124:127], v[236:239]
    v_mfma_f32_16x16x32_bf16 v[232:235], a[8:11], v[124:127], 0
    ds_read_b64_tr_b16 a[84:85], v153 offset:49152
    buffer_load_dwordx4 v156, s[44:47], s23 offen offset:0 sc1 lds
    v_mfma_f32_16x16x32_bf16 v[232:235], a[0:3], v[120:123], v[232:235]
    ds_read_b64_tr_b16 a[86:87], v153 offset:50176
    s_waitcnt lgkmcnt(4)
    v_mfma_f32_16x16x32_bf16 v[192:195], a[16:19], v[80:83], v[192:195]
    buffer_load_dwordx4 v157, s[44:47], s23 offen offset:1024 sc1 lds
    v_mfma_f32_16x16x32_bf16 v[192:195], a[24:27], v[84:87], v[192:195]
    ds_read_b128 v[104:107], v159 offset:13056
    buffer_load_dwordx4 v158, s[44:47], s23 offen offset:2048 sc1 lds
    v_mfma_f32_16x16x32_bf16 v[196:199], a[28:31], v[84:87], v[196:199]
    ds_read_b128 v[108:111], v159 offset:19200
    v_mfma_f32_16x16x32_bf16 v[196:199], a[20:23], v[80:83], v[196:199]
    ds_read_b128 v[112:115], v159 offset:13312
    s_add_u32 m0, s73, 16384
    s_lshl_b32 s14, s26, 3
    v_mfma_f32_16x16x32_bf16 v[204:207], a[20:23], v[88:91], v[204:207]
    ds_read_b128 v[116:119], v159 offset:19456
    v_mfma_f32_16x16x32_bf16 v[204:207], a[28:31], v[92:95], v[204:207]
    ds_read_b128 v[120:123], v159 offset:13568
    buffer_load_dwordx4 v148, s[48:51], s14 offen offset:0 lds
    v_mfma_f32_16x16x32_bf16 v[200:203], a[24:27], v[92:95], v[200:203]
    ds_read_b128 v[124:127], v159 offset:19712
    buffer_load_dwordx4 v149, s[48:51], s14 offen offset:1024 lds
    s_lshl_b32 s7, s7, 1
    v_xor_b32 v31, s7, v31
    v_lshl_add_u32 v10, v31, 5, v24
    v_xor_b32 v11, 32, v10
    s_mul_i32 s84, s101, 14
    s_lshr_b32 s84, s84, 2
    s_add_u32 s84, s84, 0
    s_add_u32 s85, s84, 1
    s_cmp_eq_u32 s85, 14
    s_cselect_b32 s85, 0, s85
    s_add_u32 s86, s85, 1
    s_cmp_eq_u32 s86, 14
    s_cselect_b32 s86, 0, s86
    s_add_u32 s87, s86, 1
    s_cmp_eq_u32 s87, 14
    s_cselect_b32 s87, 0, s87
    s_add_u32 s88, s87, 1
    s_cmp_eq_u32 s88, 14
    s_cselect_b32 s88, 0, s88
    s_add_u32 s89, s88, 1
    s_cmp_eq_u32 s89, 14
    s_cselect_b32 s89, 0, s89
    s_add_u32 s90, s89, 1
    s_cmp_eq_u32 s90, 14
    s_cselect_b32 s90, 0, s90
    s_add_u32 s91, s90, 1
    s_cmp_eq_u32 s91, 14
    s_cselect_b32 s91, 0, s91
    s_add_u32 s92, s91, 1
    s_cmp_eq_u32 s92, 14
    s_cselect_b32 s92, 0, s92
    s_add_u32 s93, s92, 1
    s_cmp_eq_u32 s93, 14
    s_cselect_b32 s93, 0, s93
    s_add_u32 s94, s93, 1
    s_cmp_eq_u32 s94, 14
    s_cselect_b32 s94, 0, s94
    s_add_u32 s95, s94, 1
    s_cmp_eq_u32 s95, 14
    s_cselect_b32 s95, 0, s95
    s_add_u32 s96, s95, 1
    s_cmp_eq_u32 s96, 14
    s_cselect_b32 s96, 0, s96
    s_add_u32 s97, s96, 1
    s_cmp_eq_u32 s97, 14
    s_cselect_b32 s97, 0, s97
    s_mul_i32 s98, s101, 4
    s_lshr_b32 s98, s98, 2
    s_add_u32 s98, s98, 14
    s_add_u32 s99, s98, 1
    s_cmp_eq_u32 s99, 18
    s_cselect_b32 s99, 14, s99
    s_add_u32 s100, s99, 1
    s_cmp_eq_u32 s100, 18
    s_cselect_b32 s100, 14, s100
    s_add_u32 s101, s100, 1
    s_cmp_eq_u32 s101, 18
    s_cselect_b32 s101, 14, s101
    s_mul_i32 s7, s70, 6
    s_add_u32 s7, s7, 0
    s_mul_i32 s8, s7, 7282
    s_lshr_b32 s8, s8, 16
    v_mfma_f32_16x16x32_bf16 v[200:203], a[16:19], v[88:91], v[200:203]
    ds_read_b64_tr_b16 a[88:89], v152 offset:57344
    v_mfma_f32_16x16x32_bf16 v[208:211], a[16:19], v[96:99], v[208:211]
    ds_read_b64_tr_b16 a[90:91], v152 offset:58368
    buffer_load_dwordx4 v150, s[48:51], s14 offen offset:2048 lds
    v_mfma_f32_16x16x32_bf16 v[208:211], a[24:27], v[100:103], v[208:211]
    v_mfma_f32_16x16x32_bf16 v[212:215], a[28:31], v[100:103], v[212:215]
    ds_read_b64_tr_b16 a[92:93], v153 offset:57344
    buffer_load_dwordx4 v151, s[48:51], s14 offen offset:3072 lds
    v_mfma_f32_16x16x32_bf16 v[212:215], a[20:23], v[96:99], v[212:215]
    ds_read_b64_tr_b16 a[94:95], v153 offset:58368
    s_waitcnt lgkmcnt(4)
    v_mfma_f32_16x16x32_bf16 v[220:223], a[20:23], v[104:107], v[220:223]
    s_waitcnt vmcnt(17)
    s_barrier
    v_mfma_f32_16x16x32_bf16 v[220:223], a[28:31], v[108:111], v[220:223]
    ds_read_b128 v[80:83], v159 offset:24576
    s_add_u32 m0, s74, 0
    v_mfma_f32_16x16x32_bf16 v[216:219], a[24:27], v[108:111], v[216:219]
    ds_read_b128 v[84:87], v159 offset:30720
    buffer_load_dwordx4 v156, s[44:47], s24 offen offset:0 sc1 lds
    v_mfma_f32_16x16x32_bf16 v[216:219], a[16:19], v[104:107], v[216:219]
    ds_read_b128 v[88:91], v159 offset:24832
    v_mfma_f32_16x16x32_bf16 v[224:227], a[16:19], v[112:115], v[224:227]
    ds_read_b128 v[92:95], v159 offset:30976
    buffer_load_dwordx4 v157, s[44:47], s24 offen offset:1024 sc1 lds
    v_mfma_f32_16x16x32_bf16 v[224:227], a[24:27], v[116:119], v[224:227]
    ds_read_b128 v[96:99], v159 offset:25088
    v_mfma_f32_16x16x32_bf16 v[228:231], a[28:31], v[116:119], v[228:231]
    ds_read_b128 v[100:103], v159 offset:31232
    buffer_load_dwordx4 v158, s[44:47], s24 offen offset:2048 sc1 lds
    s_mul_i32 s5, s8, 9
    s_sub_u32 s7, s7, s5
    s_lshl_b32 s7, s7, 2
    s_mov_b32 s4, 0xeca86420
    s_mov_b32 s5, 3
    s_lshr_b64 s[4:5], s[4:5], s7
    s_and_b32 s4, s4, 15
    s_lshl4_add_u32 s4, s8, s4
    v_lshl_add_u32 v240, s4, 8, v245
    s_mul_i32 s7, s70, 6
    s_add_u32 s7, s7, 1
    s_mul_i32 s8, s7, 7282
    s_lshr_b32 s8, s8, 16
    s_mul_i32 s5, s8, 9
    s_sub_u32 s7, s7, s5
    s_lshl_b32 s7, s7, 2
    s_mov_b32 s4, 0xeca86420
    s_mov_b32 s5, 3
    s_lshr_b64 s[4:5], s[4:5], s7
    s_and_b32 s4, s4, 15
    s_lshl4_add_u32 s4, s8, s4
    v_lshl_add_u32 v241, s4, 8, v245
    s_mul_i32 s7, s70, 6
    s_add_u32 s7, s7, 2
    s_mul_i32 s8, s7, 7282
    s_lshr_b32 s8, s8, 16
    s_mul_i32 s5, s8, 9
    v_mfma_f32_16x16x32_bf16 v[228:231], a[20:23], v[112:115], v[228:231]
    ds_read_b64_tr_b16 a[96:97], v154 offset:0
    v_mfma_f32_16x16x32_bf16 v[236:239], a[20:23], v[120:123], v[236:239]
    ds_read_b64_tr_b16 a[98:99], v154 offset:1024
    s_add_u32 m0, s74, 12288
    v_mfma_f32_16x16x32_bf16 v[236:239], a[28:31], v[124:127], v[236:239]
    v_mfma_f32_16x16x32_bf16 v[232:235], a[24:27], v[124:127], v[232:235]
    ds_read_b64_tr_b16 a[100:101], v155 offset:0
    buffer_load_dwordx4 v156, s[44:47], s25 offen offset:0 sc1 lds
    v_mfma_f32_16x16x32_bf16 v[232:235], a[16:19], v[120:123], v[232:235]
    ds_read_b64_tr_b16 a[102:103], v155 offset:1024
    s_waitcnt lgkmcnt(4)
    v_mfma_f32_16x16x32_bf16 v[192:195], a[32:35], v[80:83], v[192:195]
    buffer_load_dwordx4 v157, s[44:47], s25 offen offset:1024 sc1 lds
    v_mfma_f32_16x16x32_bf16 v[192:195], a[40:43], v[84:87], v[192:195]
    ds_read_b128 v[104:107], v159 offset:25344
    buffer_load_dwordx4 v158, s[44:47], s25 offen offset:2048 sc1 lds
    v_mfma_f32_16x16x32_bf16 v[196:199], a[44:47], v[84:87], v[196:199]
    ds_read_b128 v[108:111], v159 offset:31488
    v_mfma_f32_16x16x32_bf16 v[196:199], a[36:39], v[80:83], v[196:199]
    ds_read_b128 v[112:115], v159 offset:25600
    s_add_u32 m0, s73, 32768
    s_lshl_b32 s14, s27, 3
    v_mfma_f32_16x16x32_bf16 v[204:207], a[36:39], v[88:91], v[204:207]
    ds_read_b128 v[116:119], v159 offset:31744
    v_mfma_f32_16x16x32_bf16 v[204:207], a[44:47], v[92:95], v[204:207]
    ds_read_b128 v[120:123], v159 offset:25856
    buffer_load_dwordx4 v148, s[48:51], s14 offen offset:0 lds
    v_mfma_f32_16x16x32_bf16 v[200:203], a[40:43], v[92:95], v[200:203]
    ds_read_b128 v[124:127], v159 offset:32000
    buffer_load_dwordx4 v149, s[48:51], s14 offen offset:1024 lds
    s_sub_u32 s7, s7, s5
    s_lshl_b32 s7, s7, 2
    s_mov_b32 s4, 0xeca86420
    s_mov_b32 s5, 3
    s_lshr_b64 s[4:5], s[4:5], s7
    s_and_b32 s4, s4, 15
    s_lshl4_add_u32 s4, s8, s4
    v_lshl_add_u32 v242, s4, 8, v245
    s_mul_i32 s7, s70, 6
    s_add_u32 s7, s7, 3
    s_mul_i32 s8, s7, 7282
    s_lshr_b32 s8, s8, 16
    s_mul_i32 s5, s8, 9
    s_sub_u32 s7, s7, s5
    s_lshl_b32 s7, s7, 2
    s_mov_b32 s4, 0xeca86420
    s_mov_b32 s5, 3
    s_lshr_b64 s[4:5], s[4:5], s7
    s_and_b32 s4, s4, 15
    s_lshl4_add_u32 s4, s8, s4
    v_lshl_add_u32 v243, s4, 8, v245
    s_mul_i32 s7, s70, 6
    s_add_u32 s7, s7, 4
    s_mul_i32 s8, s7, 7282
    s_lshr_b32 s8, s8, 16
    s_mul_i32 s5, s8, 9
    v_mfma_f32_16x16x32_bf16 v[200:203], a[32:35], v[88:91], v[200:203]
    ds_read_b64_tr_b16 a[104:105], v154 offset:8192
    v_mfma_f32_16x16x32_bf16 v[208:211], a[32:35], v[96:99], v[208:211]
    ds_read_b64_tr_b16 a[106:107], v154 offset:9216
    buffer_load_dwordx4 v150, s[48:51], s14 offen offset:2048 lds
    v_mfma_f32_16x16x32_bf16 v[208:211], a[40:43], v[100:103], v[208:211]
    v_mfma_f32_16x16x32_bf16 v[212:215], a[44:47], v[100:103], v[212:215]
    ds_read_b64_tr_b16 a[108:109], v155 offset:8192
    buffer_load_dwordx4 v151, s[48:51], s14 offen offset:3072 lds
    v_mfma_f32_16x16x32_bf16 v[212:215], a[36:39], v[96:99], v[212:215]
    ds_read_b64_tr_b16 a[110:111], v155 offset:9216
    s_waitcnt lgkmcnt(4)
    v_mfma_f32_16x16x32_bf16 v[220:223], a[36:39], v[104:107], v[220:223]
    s_waitcnt vmcnt(20)
    s_barrier
    v_mfma_f32_16x16x32_bf16 v[220:223], a[44:47], v[108:111], v[220:223]
    ds_read_b128 v[80:83], v250 offset:0
    s_add_u32 m0, s74, 24576
    v_mfma_f32_16x16x32_bf16 v[216:219], a[40:43], v[108:111], v[216:219]
    ds_read_b128 v[84:87], v250 offset:6144
    v_mfma_f32_16x16x32_bf16 v[216:219], a[32:35], v[104:107], v[216:219]
    ds_read_b128 v[88:91], v250 offset:256
    buffer_load_dwordx4 v156, s[44:47], s26 offen offset:0 sc1 lds
    v_mfma_f32_16x16x32_bf16 v[224:227], a[32:35], v[112:115], v[224:227]
    ds_read_b128 v[92:95], v250 offset:6400
    v_mfma_f32_16x16x32_bf16 v[224:227], a[40:43], v[116:119], v[224:227]
    ds_read_b128 v[96:99], v250 offset:512
    v_mfma_f32_16x16x32_bf16 v[228:231], a[44:47], v[116:119], v[228:231]
    ds_read_b128 v[100:103], v250 offset:6656
    buffer_load_dwordx4 v157, s[44:47], s26 offen offset:1024 sc1 lds
    s_sub_u32 s7, s7, s5
    s_lshl_b32 s7, s7, 2
    s_mov_b32 s4, 0xeca86420
    s_mov_b32 s5, 3
    s_lshr_b64 s[4:5], s[4:5], s7
    s_and_b32 s4, s4, 15
    s_lshl4_add_u32 s4, s8, s4
    v_lshl_add_u32 v244, s4, 8, v245
    s_mul_i32 s7, s70, 6
    s_add_u32 s7, s7, 5
    s_mul_i32 s8, s7, 7282
    s_lshr_b32 s8, s8, 16
    s_mul_i32 s5, s8, 9
    s_sub_u32 s7, s7, s5
    s_lshl_b32 s7, s7, 2
    s_mov_b32 s4, 0xeca86420
    s_mov_b32 s5, 3
    s_lshr_b64 s[4:5], s[4:5], s7
    s_and_b32 s4, s4, 15
    s_lshl4_add_u32 s4, s8, s4
    v_lshl_add_u32 v245, s4, 8, v245
    s_xor_b32 s7, s75, 1
    s_lshl2_add_u32 s7, s7, s3
    s_mul_i32 s9, s7, 6144
    s_add_u32 s9, s9, 7077888
    s_lshl_b32 s7, s7, 7
    s_add_u32 s6, s7, 22822912
    s_lshl2_add_u32 s7, s75, s3
    s_mul_i32 s10, s7, 6144
    s_add_u32 s10, s10, 7077888
    s_lshl_b32 s7, s7, 7
    v_mfma_f32_16x16x32_bf16 v[228:231], a[36:39], v[112:115], v[228:231]
    ds_read_b64_tr_b16 a[112:113], v152 offset:0
    v_mfma_f32_16x16x32_bf16 v[236:239], a[36:39], v[120:123], v[236:239]
    ds_read_b64_tr_b16 a[114:115], v152 offset:1024
    v_mfma_f32_16x16x32_bf16 v[236:239], a[44:47], v[124:127], v[236:239]
    buffer_load_dwordx4 v158, s[44:47], s26 offen offset:2048 sc1 lds
    v_mfma_f32_16x16x32_bf16 v[232:235], a[40:43], v[124:127], v[232:235]
    ds_read_b64_tr_b16 a[116:117], v153 offset:0
    v_mfma_f32_16x16x32_bf16 v[232:235], a[32:35], v[120:123], v[232:235]
    ds_read_b64_tr_b16 a[118:119], v153 offset:1024
    s_waitcnt lgkmcnt(4)
    v_mfma_f32_16x16x32_bf16 v[192:195], a[48:51], v[80:83], v[192:195]
    s_add_u32 m0, s73, 49152
    s_lshl_b32 s14, s76, 3
    v_mfma_f32_16x16x32_bf16 v[192:195], a[56:59], v[84:87], v[192:195]
    ds_read_b128 v[104:107], v250 offset:768
    v_mfma_f32_16x16x32_bf16 v[196:199], a[60:63], v[84:87], v[196:199]
    ds_read_b128 v[108:111], v250 offset:6912
    buffer_load_dwordx4 v148, s[48:51], s14 offen offset:0 lds
    v_mfma_f32_16x16x32_bf16 v[196:199], a[52:55], v[80:83], v[196:199]
    ds_read_b128 v[112:115], v250 offset:1024
    v_mfma_f32_16x16x32_bf16 v[204:207], a[52:55], v[88:91], v[204:207]
    ds_read_b128 v[116:119], v250 offset:7168
    buffer_load_dwordx4 v149, s[48:51], s14 offen offset:1024 lds
    v_mfma_f32_16x16x32_bf16 v[204:207], a[60:63], v[92:95], v[204:207]
    ds_read_b128 v[120:123], v250 offset:1280
    v_mfma_f32_16x16x32_bf16 v[200:203], a[56:59], v[92:95], v[200:203]
    ds_read_b128 v[124:127], v250 offset:7424
    s_add_u32 s7, s7, 22822912
    v_mov_b32 v28, s7
    v_add_u32 v247, 3072, v246
    v_cmp_eq_u32 vcc, 0, v2
    v_mov_b32 v248, 0x40000000
    s_nop 0
    v_cndmask_b32 v248, v248, 0, vcc
    v_mov_b32 v249, s68
    v_and_b32 v129, 0xffff0000, v144
    v_lshlrev_b32 v128, 16, v144
    v_and_b32 v131, 0xffff0000, v145
    v_lshlrev_b32 v130, 16, v145
    v_and_b32 v133, 0xffff0000, v146
    v_lshlrev_b32 v132, 16, v146
    v_and_b32 v135, 0xffff0000, v147
    v_lshlrev_b32 v134, 16, v147
    s_mul_i32 s4, s70, 43691
    s_lshr_b32 s4, s4, 16
    s_mul_i32 s5, s70, 21846
    s_lshr_b32 s5, s5, 16
    s_mul_i32 s5, s5, 3
    s_sub_u32 s5, s70, s5
    s_lshl2_add_u32 s4, s72, s4
    s_lshl_b32 s4, s4, 10
    s_mul_i32 s7, s72, 9
    s_sub_u32 s7, s69, s7
    s_lshl3_add_u32 s4, s7, s4
    v_mfma_f32_16x16x32_bf16 v[200:203], a[48:51], v[88:91], v[200:203]
    ds_read_b64_tr_b16 a[120:121], v152 offset:8192
    buffer_load_dwordx4 v150, s[48:51], s14 offen offset:2048 lds
    v_mfma_f32_16x16x32_bf16 v[208:211], a[48:51], v[96:99], v[208:211]
    ds_read_b64_tr_b16 a[122:123], v152 offset:9216
    v_mfma_f32_16x16x32_bf16 v[208:211], a[56:59], v[100:103], v[208:211]
    buffer_load_dwordx4 v151, s[48:51], s14 offen offset:3072 lds
    v_mfma_f32_16x16x32_bf16 v[212:215], a[60:63], v[100:103], v[212:215]
    ds_read_b64_tr_b16 a[124:125], v153 offset:8192
    v_mfma_f32_16x16x32_bf16 v[212:215], a[52:55], v[96:99], v[212:215]
    ds_read_b64_tr_b16 a[126:127], v153 offset:9216
    s_waitcnt lgkmcnt(4)
    v_mfma_f32_16x16x32_bf16 v[220:223], a[52:55], v[104:107], v[220:223]
    s_waitcnt vmcnt(17)
    s_barrier
    v_mfma_f32_16x16x32_bf16 v[220:223], a[60:63], v[108:111], v[220:223]
    ds_read_b128 v[80:83], v250 offset:12288
    s_add_u32 m0, s74, 36864
    v_mfma_f32_16x16x32_bf16 v[216:219], a[56:59], v[108:111], v[216:219]
    ds_read_b128 v[84:87], v250 offset:18432
    v_mfma_f32_16x16x32_bf16 v[216:219], a[48:51], v[104:107], v[216:219]
    ds_read_b128 v[88:91], v250 offset:12544
    buffer_load_dwordx4 v156, s[44:47], s27 offen offset:0 sc1 lds
    v_mfma_f32_16x16x32_bf16 v[224:227], a[48:51], v[112:115], v[224:227]
    ds_read_b128 v[92:95], v250 offset:18688
    v_mfma_f32_16x16x32_bf16 v[224:227], a[56:59], v[116:119], v[224:227]
    ds_read_b128 v[96:99], v250 offset:12800
    v_mfma_f32_16x16x32_bf16 v[228:231], a[60:63], v[116:119], v[228:231]
    ds_read_b128 v[100:103], v250 offset:18944
    buffer_load_dwordx4 v157, s[44:47], s27 offen offset:1024 sc1 lds
    s_add_u32 s4, s4, 12566528
    s_cmp_eq_u32 s5, 1
    s_cselect_b32 s7, 16, 8
    s_cmp_lg_u32 s5, 0
    s_cselect_b32 s5, 4, 0
    v_lshlrev_b32 v17, 7, v0
    v_add_u32 v17, s4, v17
    v_cmp_gt_u32 vcc, 8, v0
    v_mov_b32 v24, s5
    s_nop 0
    v_cndmask_b32 v24, 0, v24, vcc
    v_add_u32 v17, v17, v24
    v_cmp_gt_u32 vcc, s7, v0
    v_mov_b32 v24, 0x40000000
    s_nop 0
    v_cndmask_b32 v17, v24, v17, vcc
    s_bfe_u32 s4, s2, 0x20003
    s_lshl2_add_u32 s4, s72, s4
    s_lshl_b32 s4, s4, 3
    s_lshr_b32 s5, s2, 4
    s_and_b32 s5, s5, 6
    s_add_u32 s4, s4, s5
    s_and_b32 s5, s2, 1
    s_add_u32 s4, s4, s5
    s_lshl_b32 s4, s4, 7
    s_add_u32 s4, s4, 12566528
    v_lshl_add_u32 v15, v2, 2, s4
    s_cmp_eq_u32 s3, 0
    s_cselect_b32 s4, 18, 0
    v_cmp_gt_u32 vcc, s4, v2
    v_mov_b32 v13, 0x40000000
    v_mfma_f32_16x16x32_bf16 v[228:231], a[52:55], v[112:115], v[228:231]
    ds_read_b64_tr_b16 a[128:129], v152 offset:16384
    v_mfma_f32_16x16x32_bf16 v[236:239], a[52:55], v[120:123], v[236:239]
    ds_read_b64_tr_b16 a[130:131], v152 offset:17408
    v_mfma_f32_16x16x32_bf16 v[236:239], a[60:63], v[124:127], v[236:239]
    buffer_load_dwordx4 v158, s[44:47], s27 offen offset:2048 sc1 lds
    v_mfma_f32_16x16x32_bf16 v[232:235], a[56:59], v[124:127], v[232:235]
    ds_read_b64_tr_b16 a[132:133], v153 offset:16384
    v_mfma_f32_16x16x32_bf16 v[232:235], a[48:51], v[120:123], v[232:235]
    ds_read_b64_tr_b16 a[134:135], v153 offset:17408
    s_waitcnt lgkmcnt(4)
    v_mfma_f32_16x16x32_bf16 v[192:195], a[64:67], v[80:83], v[192:195]
    s_add_u32 m0, s73, 65536
    s_lshl_b32 s14, s77, 3
    v_mfma_f32_16x16x32_bf16 v[192:195], a[72:75], v[84:87], v[192:195]
    ds_read_b128 v[104:107], v250 offset:13056
    v_mfma_f32_16x16x32_bf16 v[196:199], a[76:79], v[84:87], v[196:199]
    ds_read_b128 v[108:111], v250 offset:19200
    buffer_load_dwordx4 v148, s[48:51], s14 offen offset:0 lds
    v_mfma_f32_16x16x32_bf16 v[196:199], a[68:71], v[80:83], v[196:199]
    ds_read_b128 v[112:115], v250 offset:13312
    v_mfma_f32_16x16x32_bf16 v[204:207], a[68:71], v[88:91], v[204:207]
    ds_read_b128 v[116:119], v250 offset:19456
    buffer_load_dwordx4 v149, s[48:51], s14 offen offset:1024 lds
    v_mfma_f32_16x16x32_bf16 v[204:207], a[76:79], v[92:95], v[204:207]
    ds_read_b128 v[120:123], v250 offset:13568
    v_mfma_f32_16x16x32_bf16 v[200:203], a[72:75], v[92:95], v[200:203]
    ds_read_b128 v[124:127], v250 offset:19712
    v_cndmask_b32 v15, v13, v15, vcc
    v_mov_b32 v13, s68
    v_cndmask_b32 v13, 0, v13, vcc
    v_and_b32 v24, 15, v2
    v_lshrrev_b32 v25, 4, v2
    v_mul_u32_u24 v25, 17408, v25
    v_lshl_add_u32 v24, v24, 4, v25
    s_mul_i32 s7, s72, 36
    s_and_b32 s8, s3, 1
    s_add_u32 s7, s7, s8
    s_mul_i32 s7, s7, 69632
    s_bfe_u32 s8, s2, 0x20003
    s_lshl_b32 s8, s8, 12
    s_add_u32 s7, s7, s8
    s_add_u32 s7, s7, 12795904
    v_add_u32 v23, s7, v24
    s_xor_b32 s7, s72, 0
    v_lshl_add_u32 v19, s7, 10, v23
    s_xor_b32 s7, s72, 1
    v_lshl_add_u32 v20, s7, 10, v23
    s_xor_b32 s7, s72, 2
    v_lshl_add_u32 v21, s7, 10, v23
    s_xor_b32 s7, s72, 3
    v_lshl_add_u32 v22, s7, 10, v23
    v_lshlrev_b32 v14, 4, v2
    v_add_u32 v14, 98304, v14
    v_add_u32 v1, 0x10000, v14
    v_mfma_f32_16x16x32_bf16 v[200:203], a[64:67], v[88:91], v[200:203]
    ds_read_b64_tr_b16 a[136:137], v152 offset:24576
    buffer_load_dwordx4 v150, s[48:51], s14 offen offset:2048 lds
    v_mfma_f32_16x16x32_bf16 v[208:211], a[64:67], v[96:99], v[208:211]
    ds_read_b64_tr_b16 a[138:139], v152 offset:25600
    v_mfma_f32_16x16x32_bf16 v[208:211], a[72:75], v[100:103], v[208:211]
    buffer_load_dwordx4 v151, s[48:51], s14 offen offset:3072 lds
    v_mfma_f32_16x16x32_bf16 v[212:215], a[76:79], v[100:103], v[212:215]
    ds_read_b64_tr_b16 a[140:141], v153 offset:24576
    v_mfma_f32_16x16x32_bf16 v[212:215], a[68:71], v[96:99], v[212:215]
    ds_read_b64_tr_b16 a[142:143], v153 offset:25600
    s_waitcnt lgkmcnt(4)
    v_mfma_f32_16x16x32_bf16 v[220:223], a[68:71], v[104:107], v[220:223]
    s_waitcnt vmcnt(14)
    s_barrier
    v_mfma_f32_16x16x32_bf16 v[220:223], a[76:79], v[108:111], v[220:223]
    ds_read_b128 v[80:83], v250 offset:24576
    s_add_u32 m0, s74, 49152
    v_mfma_f32_16x16x32_bf16 v[216:219], a[72:75], v[108:111], v[216:219]
    ds_read_b128 v[84:87], v250 offset:30720
    v_mfma_f32_16x16x32_bf16 v[216:219], a[64:67], v[104:107], v[216:219]
    ds_read_b128 v[88:91], v250 offset:24832
    buffer_load_dwordx4 v156, s[44:47], s76 offen offset:0 sc1 lds
    v_mfma_f32_16x16x32_bf16 v[224:227], a[64:67], v[112:115], v[224:227]
    ds_read_b128 v[92:95], v250 offset:30976
    v_mfma_f32_16x16x32_bf16 v[224:227], a[72:75], v[116:119], v[224:227]
    ds_read_b128 v[96:99], v250 offset:25088
    v_mfma_f32_16x16x32_bf16 v[228:231], a[76:79], v[116:119], v[228:231]
    ds_read_b128 v[100:103], v250 offset:31232
    buffer_load_dwordx4 v157, s[44:47], s76 offen offset:1024 sc1 lds
    s_mov_b32 s56, s16
    s_and_b32 s57, s17, 0xffff
    s_mov_b32 s58, 2359296
    s_mov_b32 s59, 0x20000
    s_mov_b32 s40, 18432
    s_mov_b32 s42, 12386304
    s_mov_b32 s64, s38
    s_and_b32 s65, s39, 0xffff
    s_mov_b32 s66, 2359296
    s_mov_b32 s67, 0x20000
    v_lshlrev_b32 v136, 4, v2
    s_mul_i32 s7, s72, 36
    s_bitcmp1_b32 s3, 0
    s_addc_u32 s7, s7, 0
    s_lshl_b32 s7, s7, 17
    v_subrev_u32 v184, s7, v4
    v_subrev_u32 v185, s7, v5
    s_bfe_u32 s4, s2, 0x20003
    s_mul_i32 s4, s4, 9
    s_lshl1_add_u32 s7, s72, s4
    s_and_b32 s8, s3, 1
    s_add_u32 s7, s7, s8
    s_lshl_b32 s37, s7, 16
    s_add_u32 s37, s37, 4718592
    s_add_u32 s4, s4, 8
    s_lshl_b32 s16, s4, 16
    s_add_u32 s16, s16, 4718592
    v_mfma_f32_16x16x32_bf16 v[228:231], a[68:71], v[112:115], v[228:231]
    ds_read_b64_tr_b16 a[144:145], v152 offset:32768
    v_mfma_f32_16x16x32_bf16 v[236:239], a[68:71], v[120:123], v[236:239]
    ds_read_b64_tr_b16 a[146:147], v152 offset:33792
    v_mfma_f32_16x16x32_bf16 v[236:239], a[76:79], v[124:127], v[236:239]
    buffer_load_dwordx4 v158, s[44:47], s76 offen offset:2048 sc1 lds
    v_mfma_f32_16x16x32_bf16 v[232:235], a[72:75], v[124:127], v[232:235]
    ds_read_b64_tr_b16 a[148:149], v153 offset:32768
    v_mfma_f32_16x16x32_bf16 v[232:235], a[64:67], v[120:123], v[232:235]
    ds_read_b64_tr_b16 a[150:151], v153 offset:33792
    s_waitcnt lgkmcnt(4)
    v_mfma_f32_16x16x32_bf16 v[192:195], a[80:83], v[80:83], v[192:195]
    s_add_u32 m0, s73, 0
    s_lshl_b32 s14, s78, 3
    v_mfma_f32_16x16x32_bf16 v[192:195], a[88:91], v[84:87], v[192:195]
    ds_read_b128 v[104:107], v250 offset:25344
    v_mfma_f32_16x16x32_bf16 v[196:199], a[92:95], v[84:87], v[196:199]
    ds_read_b128 v[108:111], v250 offset:31488
    buffer_load_dwordx4 v148, s[48:51], s14 offen offset:0 lds
    v_mfma_f32_16x16x32_bf16 v[196:199], a[84:87], v[80:83], v[196:199]
    ds_read_b128 v[112:115], v250 offset:25600
    v_mfma_f32_16x16x32_bf16 v[204:207], a[84:87], v[88:91], v[204:207]
    ds_read_b128 v[116:119], v250 offset:31744
    buffer_load_dwordx4 v149, s[48:51], s14 offen offset:1024 lds
    v_mfma_f32_16x16x32_bf16 v[204:207], a[92:95], v[92:95], v[204:207]
    ds_read_b128 v[120:123], v250 offset:25856
    v_mfma_f32_16x16x32_bf16 v[200:203], a[88:91], v[92:95], v[200:203]
    ds_read_b128 v[124:127], v250 offset:32000
    s_sub_u32 s4, s4, s7
    s_lshl_b32 s4, s4, 7
    s_lshl_b32 s7, s7, 7
    s_add_u32 s7, s7, 12582912
    v_bfe_u32 v24, v2, 2, 1
    v_mul_u32_u24 v24, s4, v24
    v_and_b32 v25, 3, v2
    v_lshl_add_u32 v24, v25, 2, v24
    v_add_u32 v188, s7, v24
    s_lshl2_add_u32 s7, s2, s3
    s_mul_i32 s8, s7, 3072
    s_add_u32 s34, s8, 22953984
L_pl_G_2:
    s_cbranch_execz L_pl_G_6
    s_add_u32 s11, s8, 26099712
    s_add_u32 s12, s8, 29245440
    s_lshl_b32 s35, s7, 12
    s_add_u32 s35, s35, 32391168
    s_xor_b32 s8, s7, 8
    s_mul_i32 s8, s8, 3072
    s_add_u32 s30, s8, 22953984
    s_xor_b32 s8, s7, 16
    s_mul_i32 s8, s8, 3072
    s_add_u32 s15, s8, 26099712
    s_xor_b32 s8, s7, 24
    s_mul_i32 s8, s8, 3072
    s_add_u32 s31, s8, 29245440
    s_andn2_b32 s7, s7, 24
    v_mfma_f32_16x16x32_bf16 v[200:203], a[80:83], v[88:91], v[200:203]
    ds_read_b64_tr_b16 a[152:153], v152 offset:40960
    buffer_load_dwordx4 v150, s[48:51], s14 offen offset:2048 lds
    v_mfma_f32_16x16x32_bf16 v[208:211], a[80:83], v[96:99], v[208:211]
    ds_read_b64_tr_b16 a[154:155], v152 offset:41984
    v_mfma_f32_16x16x32_bf16 v[208:211], a[88:91], v[100:103], v[208:211]
    buffer_load_dwordx4 v151, s[48:51], s14 offen offset:3072 lds
    v_mfma_f32_16x16x32_bf16 v[212:215], a[92:95], v[100:103], v[212:215]
    ds_read_b64_tr_b16 a[156:157], v153 offset:40960
    v_mfma_f32_16x16x32_bf16 v[212:215], a[84:87], v[96:99], v[212:215]
    ds_read_b64_tr_b16 a[158:159], v153 offset:41984
    s_waitcnt lgkmcnt(4)
    v_mfma_f32_16x16x32_bf16 v[220:223], a[84:87], v[104:107], v[220:223]
    s_waitcnt vmcnt(14)
    s_barrier
    v_mfma_f32_16x16x32_bf16 v[220:223], a[92:95], v[108:111], v[220:223]
    ds_read_b128 v[80:83], v159 offset:0
    s_add_u32 m0, s74, 61440
    v_mfma_f32_16x16x32_bf16 v[216:219], a[88:91], v[108:111], v[216:219]
    ds_read_b128 v[84:87], v159 offset:6144
    v_mfma_f32_16x16x32_bf16 v[216:219], a[80:83], v[104:107], v[216:219]
    ds_read_b128 v[88:91], v159 offset:256
    buffer_load_dwordx4 v156, s[44:47], s77 offen offset:0 sc1 lds
    v_mfma_f32_16x16x32_bf16 v[224:227], a[80:83], v[112:115], v[224:227]
    ds_read_b128 v[92:95], v159 offset:6400
    v_mfma_f32_16x16x32_bf16 v[224:227], a[88:91], v[116:119], v[224:227]
    ds_read_b128 v[96:99], v159 offset:512
    v_mfma_f32_16x16x32_bf16 v[228:231], a[92:95], v[116:119], v[228:231]
    ds_read_b128 v[100:103], v159 offset:6656
    buffer_load_dwordx4 v157, s[44:47], s77 offen offset:1024 sc1 lds
    s_lshl3_add_u32 s7, s3, s7
    s_lshl2_add_u32 s8, s7, s72
    s_lshl_b32 s8, s8, 10
    s_add_u32 s32, s8, 32391168
    s_xor_b32 s8, s8, 4096
    s_add_u32 s33, s8, 32391168
    s_xor_b32 s8, s3, s72
    s_cmp_lt_u32 s8, 2
    s_cselect_b32 s35, s35, 0x40000000
    s_cselect_b32 s16, s16, 0x40000000
    s_cselect_b32 s36, s68, 0
    s_mov_b32 s38, 0xbfb8aa3b
    s_and_b32 s8, s8, 1
    s_mul_i32 s41, s8, 96
    s_and_b32 s43, s73, 4096
    v_lshlrev_b32 v24, 10, v2
    v_add_u32 v24, s35, v24
    s_add_u32 s7, s34, 2048
    v_mov_b32 v25, s36
    v_cmp_gt_u32 vcc, 4, v2
    s_nop 1
    v_cndmask_b32 v138, 0, v25, vcc
    v_mov_b32 v25, 0x40000000
    v_cndmask_b32 v137, v25, v24, vcc
    v_writelane_b32 v137, s7, 4
    v_writelane_b32 v138, s68, 4
    v_min_u32 v139, 1, v2
    v_lshlrev_b32 v139, 30, v139
    v_mov_b32 v140, 0
    v_writelane_b32 v140, s68, 0
    v_mfma_f32_16x16x32_bf16 v[228:231], a[84:87], v[112:115], v[228:231]
    ds_read_b64_tr_b16 a[160:161], v152 offset:49152
    v_mfma_f32_16x16x32_bf16 v[236:239], a[84:87], v[120:123], v[236:239]
    ds_read_b64_tr_b16 a[162:163], v152 offset:50176
    v_mfma_f32_16x16x32_bf16 v[236:239], a[92:95], v[124:127], v[236:239]
    buffer_load_dwordx4 v158, s[44:47], s77 offen offset:2048 sc1 lds
    v_mfma_f32_16x16x32_bf16 v[232:235], a[88:91], v[124:127], v[232:235]
    ds_read_b64_tr_b16 a[164:165], v153 offset:49152
    v_mfma_f32_16x16x32_bf16 v[232:235], a[80:83], v[120:123], v[232:235]
    ds_read_b64_tr_b16 a[166:167], v153 offset:50176
    s_waitcnt lgkmcnt(4)
    v_mfma_f32_16x16x32_bf16 v[192:195], a[96:99], v[80:83], v[192:195]
    s_add_u32 m0, s73, 16384
    s_lshl_b32 s14, s79, 3
    v_mfma_f32_16x16x32_bf16 v[192:195], a[104:107], v[84:87], v[192:195]
    ds_read_b128 v[104:107], v159 offset:768
    v_mfma_f32_16x16x32_bf16 v[196:199], a[108:111], v[84:87], v[196:199]
    ds_read_b128 v[108:111], v159 offset:6912
    buffer_load_dwordx4 v148, s[48:51], s14 offen offset:0 lds
    v_mfma_f32_16x16x32_bf16 v[196:199], a[100:103], v[80:83], v[196:199]
    ds_read_b128 v[112:115], v159 offset:1024
    v_mfma_f32_16x16x32_bf16 v[204:207], a[100:103], v[88:91], v[204:207]
    ds_read_b128 v[116:119], v159 offset:7168
    buffer_load_dwordx4 v149, s[48:51], s14 offen offset:1024 lds
    v_mfma_f32_16x16x32_bf16 v[204:207], a[108:111], v[92:95], v[204:207]
    ds_read_b128 v[120:123], v159 offset:1280
    v_mfma_f32_16x16x32_bf16 v[200:203], a[104:107], v[92:95], v[200:203]
    ds_read_b128 v[124:127], v159 offset:7424
    v_mfma_f32_16x16x32_bf16 v[200:203], a[96:99], v[88:91], v[200:203]
    ds_read_b64_tr_b16 a[168:169], v152 offset:57344
    buffer_load_dwordx4 v150, s[48:51], s14 offen offset:2048 lds
    v_mfma_f32_16x16x32_bf16 v[208:211], a[96:99], v[96:99], v[208:211]
    ds_read_b64_tr_b16 a[170:171], v152 offset:58368
    v_mfma_f32_16x16x32_bf16 v[208:211], a[104:107], v[100:103], v[208:211]
    buffer_load_dwordx4 v151, s[48:51], s14 offen offset:3072 lds
    v_mfma_f32_16x16x32_bf16 v[212:215], a[108:111], v[100:103], v[212:215]
    ds_read_b64_tr_b16 a[172:173], v153 offset:57344
    v_mfma_f32_16x16x32_bf16 v[212:215], a[100:103], v[96:99], v[212:215]
    ds_read_b64_tr_b16 a[174:175], v153 offset:58368
    s_waitcnt lgkmcnt(4)
    v_mfma_f32_16x16x32_bf16 v[220:223], a[100:103], v[104:107], v[220:223]
    s_waitcnt vmcnt(14)
    s_barrier
    v_mfma_f32_16x16x32_bf16 v[220:223], a[108:111], v[108:111], v[220:223]
    ds_read_b128 v[80:83], v159 offset:12288
    s_add_u32 m0, s74, 0
    v_mfma_f32_16x16x32_bf16 v[216:219], a[104:107], v[108:111], v[216:219]
    ds_read_b128 v[84:87], v159 offset:18432
    v_mfma_f32_16x16x32_bf16 v[216:219], a[96:99], v[104:107], v[216:219]
    ds_read_b128 v[88:91], v159 offset:12544
    buffer_load_dwordx4 v156, s[44:47], s78 offen offset:0 sc1 lds
    v_mfma_f32_16x16x32_bf16 v[224:227], a[96:99], v[112:115], v[224:227]
    ds_read_b128 v[92:95], v159 offset:18688
    v_mfma_f32_16x16x32_bf16 v[224:227], a[104:107], v[116:119], v[224:227]
    ds_read_b128 v[96:99], v159 offset:12800
    v_mfma_f32_16x16x32_bf16 v[228:231], a[108:111], v[116:119], v[228:231]
    ds_read_b128 v[100:103], v159 offset:18944
    buffer_load_dwordx4 v157, s[44:47], s78 offen offset:1024 sc1 lds
    v_mfma_f32_16x16x32_bf16 v[228:231], a[100:103], v[112:115], v[228:231]
    ds_read_b64_tr_b16 a[176:177], v154 offset:0
    v_mfma_f32_16x16x32_bf16 v[236:239], a[100:103], v[120:123], v[236:239]
    ds_read_b64_tr_b16 a[178:179], v154 offset:1024
    v_mfma_f32_16x16x32_bf16 v[236:239], a[108:111], v[124:127], v[236:239]
    buffer_load_dwordx4 v158, s[44:47], s78 offen offset:2048 sc1 lds
    v_mfma_f32_16x16x32_bf16 v[232:235], a[104:107], v[124:127], v[232:235]
    ds_read_b64_tr_b16 a[180:181], v155 offset:0
    v_mfma_f32_16x16x32_bf16 v[232:235], a[96:99], v[120:123], v[232:235]
    ds_read_b64_tr_b16 a[182:183], v155 offset:1024
    s_waitcnt lgkmcnt(4)
    v_mfma_f32_16x16x32_bf16 v[192:195], a[112:115], v[80:83], v[192:195]
    s_add_u32 m0, s73, 32768
    s_lshl_b32 s14, s80, 3
    v_mfma_f32_16x16x32_bf16 v[192:195], a[120:123], v[84:87], v[192:195]
    ds_read_b128 v[104:107], v159 offset:13056
    v_mfma_f32_16x16x32_bf16 v[196:199], a[124:127], v[84:87], v[196:199]
    ds_read_b128 v[108:111], v159 offset:19200
    buffer_load_dwordx4 v148, s[48:51], s14 offen offset:0 lds
    v_mfma_f32_16x16x32_bf16 v[196:199], a[116:119], v[80:83], v[196:199]
    ds_read_b128 v[112:115], v159 offset:13312
    v_mfma_f32_16x16x32_bf16 v[204:207], a[116:119], v[88:91], v[204:207]
    ds_read_b128 v[116:119], v159 offset:19456
    buffer_load_dwordx4 v149, s[48:51], s14 offen offset:1024 lds
    v_mfma_f32_16x16x32_bf16 v[204:207], a[124:127], v[92:95], v[204:207]
    ds_read_b128 v[120:123], v159 offset:13568
    v_mfma_f32_16x16x32_bf16 v[200:203], a[120:123], v[92:95], v[200:203]
    ds_read_b128 v[124:127], v159 offset:19712
    v_mfma_f32_16x16x32_bf16 v[200:203], a[112:115], v[88:91], v[200:203]
    ds_read_b64_tr_b16 a[184:185], v154 offset:8192
    buffer_load_dwordx4 v150, s[48:51], s14 offen offset:2048 lds
    v_mfma_f32_16x16x32_bf16 v[208:211], a[112:115], v[96:99], v[208:211]
    ds_read_b64_tr_b16 a[186:187], v154 offset:9216
    v_mfma_f32_16x16x32_bf16 v[208:211], a[120:123], v[100:103], v[208:211]
    buffer_load_dwordx4 v151, s[48:51], s14 offen offset:3072 lds
    v_mfma_f32_16x16x32_bf16 v[212:215], a[124:127], v[100:103], v[212:215]
    ds_read_b64_tr_b16 a[188:189], v155 offset:8192
    v_mfma_f32_16x16x32_bf16 v[212:215], a[116:119], v[96:99], v[212:215]
    ds_read_b64_tr_b16 a[190:191], v155 offset:9216
    s_waitcnt lgkmcnt(4)
    v_mfma_f32_16x16x32_bf16 v[220:223], a[116:119], v[104:107], v[220:223]
    s_waitcnt vmcnt(14)
    s_barrier
    v_mfma_f32_16x16x32_bf16 v[220:223], a[124:127], v[108:111], v[220:223]
    ds_read_b128 v[80:83], v159 offset:24576
    s_add_u32 m0, s74, 12288
    v_mfma_f32_16x16x32_bf16 v[216:219], a[120:123], v[108:111], v[216:219]
    ds_read_b128 v[84:87], v159 offset:30720
    v_mfma_f32_16x16x32_bf16 v[216:219], a[112:115], v[104:107], v[216:219]
    ds_read_b128 v[88:91], v159 offset:24832
    buffer_load_dwordx4 v156, s[44:47], s79 offen offset:0 sc1 lds
    v_mfma_f32_16x16x32_bf16 v[224:227], a[112:115], v[112:115], v[224:227]
    ds_read_b128 v[92:95], v159 offset:30976
    v_mfma_f32_16x16x32_bf16 v[224:227], a[120:123], v[116:119], v[224:227]
    ds_read_b128 v[96:99], v159 offset:25088
    v_mfma_f32_16x16x32_bf16 v[228:231], a[124:127], v[116:119], v[228:231]
    ds_read_b128 v[100:103], v159 offset:31232
    buffer_load_dwordx4 v157, s[44:47], s79 offen offset:1024 sc1 lds
    v_mfma_f32_16x16x32_bf16 v[228:231], a[116:119], v[112:115], v[228:231]
    ds_read_b64_tr_b16 a[192:193], v152 offset:0
    v_mfma_f32_16x16x32_bf16 v[236:239], a[116:119], v[120:123], v[236:239]
    ds_read_b64_tr_b16 a[194:195], v152 offset:1024
    v_mfma_f32_16x16x32_bf16 v[236:239], a[124:127], v[124:127], v[236:239]
    buffer_load_dwordx4 v158, s[44:47], s79 offen offset:2048 sc1 lds
    v_mfma_f32_16x16x32_bf16 v[232:235], a[120:123], v[124:127], v[232:235]
    ds_read_b64_tr_b16 a[196:197], v153 offset:0
    v_mfma_f32_16x16x32_bf16 v[232:235], a[112:115], v[120:123], v[232:235]
    ds_read_b64_tr_b16 a[198:199], v153 offset:1024
    s_waitcnt lgkmcnt(4)
    v_mfma_f32_16x16x32_bf16 v[192:195], a[128:131], v[80:83], v[192:195]
    s_add_u32 m0, s73, 49152
    s_lshl_b32 s14, s81, 3
    v_mfma_f32_16x16x32_bf16 v[192:195], a[136:139], v[84:87], v[192:195]
    ds_read_b128 v[104:107], v159 offset:25344
    v_mfma_f32_16x16x32_bf16 v[196:199], a[140:143], v[84:87], v[196:199]
    ds_read_b128 v[108:111], v159 offset:31488
    buffer_load_dwordx4 v148, s[48:51], s14 offen offset:0 lds
    v_mfma_f32_16x16x32_bf16 v[196:199], a[132:135], v[80:83], v[196:199]
    ds_read_b128 v[112:115], v159 offset:25600
    v_mfma_f32_16x16x32_bf16 v[204:207], a[132:135], v[88:91], v[204:207]
    ds_read_b128 v[116:119], v159 offset:31744
    buffer_load_dwordx4 v149, s[48:51], s14 offen offset:1024 lds
    v_mfma_f32_16x16x32_bf16 v[204:207], a[140:143], v[92:95], v[204:207]
    ds_read_b128 v[120:123], v159 offset:25856
    v_mfma_f32_16x16x32_bf16 v[200:203], a[136:139], v[92:95], v[200:203]
    ds_read_b128 v[124:127], v159 offset:32000
    v_mfma_f32_16x16x32_bf16 v[200:203], a[128:131], v[88:91], v[200:203]
    ds_read_b64_tr_b16 a[200:201], v152 offset:8192
    buffer_load_dwordx4 v150, s[48:51], s14 offen offset:2048 lds
    v_mfma_f32_16x16x32_bf16 v[208:211], a[128:131], v[96:99], v[208:211]
    ds_read_b64_tr_b16 a[202:203], v152 offset:9216
    v_mfma_f32_16x16x32_bf16 v[208:211], a[136:139], v[100:103], v[208:211]
    buffer_load_dwordx4 v151, s[48:51], s14 offen offset:3072 lds
    v_mfma_f32_16x16x32_bf16 v[212:215], a[140:143], v[100:103], v[212:215]
    ds_read_b64_tr_b16 a[204:205], v153 offset:8192
    v_mfma_f32_16x16x32_bf16 v[212:215], a[132:135], v[96:99], v[212:215]
    ds_read_b64_tr_b16 a[206:207], v153 offset:9216
    s_waitcnt lgkmcnt(4)
    v_mfma_f32_16x16x32_bf16 v[220:223], a[132:135], v[104:107], v[220:223]
    s_waitcnt vmcnt(14)
    s_barrier
    v_mfma_f32_16x16x32_bf16 v[220:223], a[140:143], v[108:111], v[220:223]
    ds_read_b128 v[80:83], v250 offset:0
    s_add_u32 m0, s74, 24576
    v_mfma_f32_16x16x32_bf16 v[216:219], a[136:139], v[108:111], v[216:219]
    ds_read_b128 v[84:87], v250 offset:6144
    v_mfma_f32_16x16x32_bf16 v[216:219], a[128:131], v[104:107], v[216:219]
    ds_read_b128 v[88:91], v250 offset:256
    buffer_load_dwordx4 v156, s[44:47], s80 offen offset:0 sc1 lds
    v_mfma_f32_16x16x32_bf16 v[224:227], a[128:131], v[112:115], v[224:227]
    ds_read_b128 v[92:95], v250 offset:6400
    v_mfma_f32_16x16x32_bf16 v[224:227], a[136:139], v[116:119], v[224:227]
    ds_read_b128 v[96:99], v250 offset:512
    v_mfma_f32_16x16x32_bf16 v[228:231], a[140:143], v[116:119], v[228:231]
    ds_read_b128 v[100:103], v250 offset:6656
    buffer_load_dwordx4 v157, s[44:47], s80 offen offset:1024 sc1 lds
    v_mfma_f32_16x16x32_bf16 v[228:231], a[132:135], v[112:115], v[228:231]
    ds_read_b64_tr_b16 a[208:209], v152 offset:16384
    v_mfma_f32_16x16x32_bf16 v[236:239], a[132:135], v[120:123], v[236:239]
    ds_read_b64_tr_b16 a[210:211], v152 offset:17408
    v_mfma_f32_16x16x32_bf16 v[236:239], a[140:143], v[124:127], v[236:239]
    buffer_load_dwordx4 v158, s[44:47], s80 offen offset:2048 sc1 lds
    v_mfma_f32_16x16x32_bf16 v[232:235], a[136:139], v[124:127], v[232:235]
    ds_read_b64_tr_b16 a[212:213], v153 offset:16384
    v_mfma_f32_16x16x32_bf16 v[232:235], a[128:131], v[120:123], v[232:235]
    ds_read_b64_tr_b16 a[214:215], v153 offset:17408
    s_waitcnt lgkmcnt(4)
    v_mfma_f32_16x16x32_bf16 v[192:195], a[144:147], v[80:83], v[192:195]
    s_add_u32 m0, s73, 65536
    s_lshl_b32 s14, s84, 18
    v_mfma_f32_16x16x32_bf16 v[192:195], a[152:155], v[84:87], v[192:195]
    ds_read_b128 v[104:107], v250 offset:768
    v_mfma_f32_16x16x32_bf16 v[196:199], a[156:159], v[84:87], v[196:199]
    ds_read_b128 v[108:111], v250 offset:6912
    buffer_load_dwordx4 v4, s[52:55], s14 offen offset:0 lds
    v_mfma_f32_16x16x32_bf16 v[196:199], a[148:151], v[80:83], v[196:199]
    ds_read_b128 v[112:115], v250 offset:1024
    v_mfma_f32_16x16x32_bf16 v[204:207], a[148:151], v[88:91], v[204:207]
    ds_read_b128 v[116:119], v250 offset:7168
    buffer_load_dwordx4 v5, s[52:55], s14 offen offset:1024 lds
    v_mfma_f32_16x16x32_bf16 v[204:207], a[156:159], v[92:95], v[204:207]
    ds_read_b128 v[120:123], v250 offset:1280
    v_mfma_f32_16x16x32_bf16 v[200:203], a[152:155], v[92:95], v[200:203]
    ds_read_b128 v[124:127], v250 offset:7424
    v_mfma_f32_16x16x32_bf16 v[200:203], a[144:147], v[88:91], v[200:203]
    ds_read_b64_tr_b16 a[216:217], v152 offset:24576
    buffer_load_dwordx4 v6, s[52:55], s14 offen offset:2048 lds
    v_mfma_f32_16x16x32_bf16 v[208:211], a[144:147], v[96:99], v[208:211]
    ds_read_b64_tr_b16 a[218:219], v152 offset:25600
    v_mfma_f32_16x16x32_bf16 v[208:211], a[152:155], v[100:103], v[208:211]
    buffer_load_dwordx4 v7, s[52:55], s14 offen offset:3072 lds
    v_mfma_f32_16x16x32_bf16 v[212:215], a[156:159], v[100:103], v[212:215]
    ds_read_b64_tr_b16 a[220:221], v153 offset:24576
    v_mfma_f32_16x16x32_bf16 v[212:215], a[148:151], v[96:99], v[212:215]
    ds_read_b64_tr_b16 a[222:223], v153 offset:25600
    s_waitcnt lgkmcnt(4)
    v_mfma_f32_16x16x32_bf16 v[220:223], a[148:151], v[104:107], v[220:223]
    s_waitcnt vmcnt(14)
    s_barrier
    v_mfma_f32_16x16x32_bf16 v[220:223], a[156:159], v[108:111], v[220:223]
    ds_read_b128 v[80:83], v250 offset:12288
    v_mfma_f32_16x16x32_bf16 v[216:219], a[152:155], v[108:111], v[216:219]
    ds_read_b128 v[84:87], v250 offset:18432
    v_mfma_f32_16x16x32_bf16 v[216:219], a[144:147], v[104:107], v[216:219]
    ds_read_b128 v[88:91], v250 offset:12544
    v_mfma_f32_16x16x32_bf16 v[224:227], a[144:147], v[112:115], v[224:227]
    ds_read_b128 v[92:95], v250 offset:18688
    v_mfma_f32_16x16x32_bf16 v[224:227], a[152:155], v[116:119], v[224:227]
    ds_read_b128 v[96:99], v250 offset:12800
    v_mfma_f32_16x16x32_bf16 v[228:231], a[156:159], v[116:119], v[228:231]
    ds_read_b128 v[100:103], v250 offset:18944
    v_mfma_f32_16x16x32_bf16 v[228:231], a[148:151], v[112:115], v[228:231]
    ds_read_b64_tr_b16 a[224:225], v152 offset:32768
    v_mfma_f32_16x16x32_bf16 v[236:239], a[148:151], v[120:123], v[236:239]
    ds_read_b64_tr_b16 a[226:227], v152 offset:33792
    v_mfma_f32_16x16x32_bf16 v[236:239], a[156:159], v[124:127], v[236:239]
    v_mfma_f32_16x16x32_bf16 v[232:235], a[152:155], v[124:127], v[232:235]
    ds_read_b64_tr_b16 a[228:229], v153 offset:32768
    v_mfma_f32_16x16x32_bf16 v[232:235], a[144:147], v[120:123], v[232:235]
    ds_read_b64_tr_b16 a[230:231], v153 offset:33792
    s_waitcnt lgkmcnt(4)
    v_mfma_f32_16x16x32_bf16 v[192:195], a[160:163], v[80:83], v[192:195]
    v_mfma_f32_16x16x32_bf16 v[192:195], a[168:171], v[84:87], v[192:195]
    ds_read_b128 v[104:107], v250 offset:13056
    v_mfma_f32_16x16x32_bf16 v[196:199], a[172:175], v[84:87], v[196:199]
    ds_read_b128 v[108:111], v250 offset:19200
    v_mfma_f32_16x16x32_bf16 v[196:199], a[164:167], v[80:83], v[196:199]
    ds_read_b128 v[112:115], v250 offset:13312
    v_mfma_f32_16x16x32_bf16 v[204:207], a[164:167], v[88:91], v[204:207]
    ds_read_b128 v[116:119], v250 offset:19456
    v_mfma_f32_16x16x32_bf16 v[204:207], a[172:175], v[92:95], v[204:207]
    ds_read_b128 v[120:123], v250 offset:13568
    v_mfma_f32_16x16x32_bf16 v[200:203], a[168:171], v[92:95], v[200:203]
    ds_read_b128 v[124:127], v250 offset:19712
    v_mfma_f32_16x16x32_bf16 v[200:203], a[160:163], v[88:91], v[200:203]
    ds_read_b64_tr_b16 a[232:233], v152 offset:40960
    v_mfma_f32_16x16x32_bf16 v[208:211], a[160:163], v[96:99], v[208:211]
    ds_read_b64_tr_b16 a[234:235], v152 offset:41984
    v_mfma_f32_16x16x32_bf16 v[208:211], a[168:171], v[100:103], v[208:211]
    v_mfma_f32_16x16x32_bf16 v[212:215], a[172:175], v[100:103], v[212:215]
    ds_read_b64_tr_b16 a[236:237], v153 offset:40960
    v_mfma_f32_16x16x32_bf16 v[212:215], a[164:167], v[96:99], v[212:215]
    ds_read_b64_tr_b16 a[238:239], v153 offset:41984
    s_waitcnt lgkmcnt(4)
    v_mfma_f32_16x16x32_bf16 v[220:223], a[164:167], v[104:107], v[220:223]
    s_waitcnt vmcnt(7)
    s_barrier
    v_mfma_f32_16x16x32_bf16 v[220:223], a[172:175], v[108:111], v[220:223]
    ds_read_b128 v[80:83], v250 offset:24576
    v_mfma_f32_16x16x32_bf16 v[216:219], a[168:171], v[108:111], v[216:219]
    ds_read_b128 v[84:87], v250 offset:30720
    v_mfma_f32_16x16x32_bf16 v[216:219], a[160:163], v[104:107], v[216:219]
    ds_read_b128 v[88:91], v250 offset:24832
    v_mfma_f32_16x16x32_bf16 v[224:227], a[160:163], v[112:115], v[224:227]
    ds_read_b128 v[92:95], v250 offset:30976
    v_mfma_f32_16x16x32_bf16 v[224:227], a[168:171], v[116:119], v[224:227]
    ds_read_b128 v[96:99], v250 offset:25088
    v_mfma_f32_16x16x32_bf16 v[228:231], a[172:175], v[116:119], v[228:231]
    ds_read_b128 v[100:103], v250 offset:31232
    v_mfma_f32_16x16x32_bf16 v[228:231], a[164:167], v[112:115], v[228:231]
    ds_read_b64_tr_b16 a[240:241], v152 offset:49152
    v_mfma_f32_16x16x32_bf16 v[236:239], a[164:167], v[120:123], v[236:239]
    ds_read_b64_tr_b16 a[242:243], v152 offset:50176
    v_mfma_f32_16x16x32_bf16 v[236:239], a[172:175], v[124:127], v[236:239]
    v_mfma_f32_16x16x32_bf16 v[232:235], a[168:171], v[124:127], v[232:235]
    ds_read_b64_tr_b16 a[244:245], v153 offset:49152
    v_mfma_f32_16x16x32_bf16 v[232:235], a[160:163], v[120:123], v[232:235]
    ds_read_b64_tr_b16 a[246:247], v153 offset:50176
    s_waitcnt lgkmcnt(4)
    v_mfma_f32_16x16x32_bf16 v[192:195], a[176:179], v[80:83], v[192:195]
    v_mfma_f32_16x16x32_bf16 v[192:195], a[184:187], v[84:87], v[192:195]
    ds_read_b128 v[104:107], v250 offset:25344
    v_mfma_f32_16x16x32_bf16 v[196:199], a[188:191], v[84:87], v[196:199]
    ds_read_b128 v[108:111], v250 offset:31488
    v_mfma_f32_16x16x32_bf16 v[196:199], a[180:183], v[80:83], v[196:199]
    ds_read_b128 v[112:115], v250 offset:25600
    v_mfma_f32_16x16x32_bf16 v[204:207], a[180:183], v[88:91], v[204:207]
    ds_read_b128 v[116:119], v250 offset:31744
    v_mfma_f32_16x16x32_bf16 v[204:207], a[188:191], v[92:95], v[204:207]
    ds_read_b128 v[120:123], v250 offset:25856
    v_mfma_f32_16x16x32_bf16 v[200:203], a[184:187], v[92:95], v[200:203]
    ds_read_b128 v[124:127], v250 offset:32000
    v_mfma_f32_16x16x32_bf16 v[200:203], a[176:179], v[88:91], v[200:203]
    ds_read_b64_tr_b16 a[248:249], v152 offset:57344
    v_mfma_f32_16x16x32_bf16 v[208:211], a[176:179], v[96:99], v[208:211]
    ds_read_b64_tr_b16 a[250:251], v152 offset:58368
    v_mfma_f32_16x16x32_bf16 v[208:211], a[184:187], v[100:103], v[208:211]
    v_mfma_f32_16x16x32_bf16 v[212:215], a[188:191], v[100:103], v[212:215]
    ds_read_b64_tr_b16 a[252:253], v153 offset:57344
    v_mfma_f32_16x16x32_bf16 v[212:215], a[180:183], v[96:99], v[212:215]
    ds_read_b64_tr_b16 a[254:255], v153 offset:58368
    s_waitcnt lgkmcnt(4)
    v_mfma_f32_16x16x32_bf16 v[220:223], a[180:183], v[104:107], v[220:223]
    s_barrier
    v_mfma_f32_16x16x32_bf16 v[220:223], a[188:191], v[108:111], v[220:223]
    ds_read_b128 v[80:83], v159 offset:0
    s_add_u32 m0, s74, 36864
    v_mfma_f32_16x16x32_bf16 v[216:219], a[184:187], v[108:111], v[216:219]
    ds_read_b128 v[84:87], v159 offset:6144
    v_mfma_f32_16x16x32_bf16 v[216:219], a[176:179], v[104:107], v[216:219]
    ds_read_b128 v[88:91], v159 offset:256
    buffer_load_dwordx4 v156, s[44:47], s81 offen offset:0 sc1 lds
    v_mfma_f32_16x16x32_bf16 v[224:227], a[176:179], v[112:115], v[224:227]
    ds_read_b128 v[92:95], v159 offset:6400
    v_mfma_f32_16x16x32_bf16 v[224:227], a[184:187], v[116:119], v[224:227]
    ds_read_b128 v[96:99], v159 offset:512
    v_mfma_f32_16x16x32_bf16 v[228:231], a[188:191], v[116:119], v[228:231]
    ds_read_b128 v[100:103], v159 offset:6656
    buffer_load_dwordx4 v157, s[44:47], s81 offen offset:1024 sc1 lds
    v_mfma_f32_16x16x32_bf16 v[228:231], a[180:183], v[112:115], v[228:231]
    v_mfma_f32_16x16x32_bf16 v[236:239], a[180:183], v[120:123], v[236:239]
    v_mfma_f32_16x16x32_bf16 v[236:239], a[188:191], v[124:127], v[236:239]
    buffer_load_dwordx4 v158, s[44:47], s81 offen offset:2048 sc1 lds
    v_mfma_f32_16x16x32_bf16 v[232:235], a[184:187], v[124:127], v[232:235]
    v_mfma_f32_16x16x32_bf16 v[232:235], a[176:179], v[120:123], v[232:235]
    s_waitcnt lgkmcnt(0)
    v_mfma_f32_16x16x32_bf16 v[192:195], a[192:195], v[80:83], v[192:195]
    s_and_b32 s13, s70, 1
    s_mul_i32 s13, s13, 3072
    v_mfma_f32_16x16x32_bf16 v[192:195], a[200:203], v[84:87], v[192:195]
    ds_read_b128 v[104:107], v159 offset:768
    s_sub_u32 s13, s13, 1536
    v_mfma_f32_16x16x32_bf16 v[196:199], a[204:207], v[84:87], v[196:199]
    ds_read_b128 v[108:111], v159 offset:6912
    v_add_u32 v156, s13, v156
    v_mfma_f32_16x16x32_bf16 v[196:199], a[196:199], v[80:83], v[196:199]
    ds_read_b128 v[112:115], v159 offset:1024
    v_mfma_f32_16x16x32_bf16 v[204:207], a[196:199], v[88:91], v[204:207]
    ds_read_b128 v[116:119], v159 offset:7168
    v_add_u32 v157, s13, v157
    v_mfma_f32_16x16x32_bf16 v[204:207], a[204:207], v[92:95], v[204:207]
    ds_read_b128 v[120:123], v159 offset:1280
    v_add_u32 v158, s13, v158
    v_mfma_f32_16x16x32_bf16 v[200:203], a[200:203], v[92:95], v[200:203]
    ds_read_b128 v[124:127], v159 offset:7424
    s_add_u32 m0, s74, 49152
    v_mfma_f32_16x16x32_bf16 v[200:203], a[192:195], v[88:91], v[200:203]
    v_mfma_f32_16x16x32_bf16 v[208:211], a[192:195], v[96:99], v[208:211]
    buffer_load_dwordx4 v156, s[44:47], s18 offen offset:0 sc1 lds
    v_mfma_f32_16x16x32_bf16 v[208:211], a[200:203], v[100:103], v[208:211]
    buffer_load_dwordx4 v157, s[44:47], s18 offen offset:1024 sc1 lds
    v_mfma_f32_16x16x32_bf16 v[212:215], a[204:207], v[100:103], v[212:215]
    buffer_load_dwordx4 v158, s[44:47], s18 offen offset:2048 sc1 lds
    v_mfma_f32_16x16x32_bf16 v[212:215], a[196:199], v[96:99], v[212:215]
    s_waitcnt lgkmcnt(0)
    v_mfma_f32_16x16x32_bf16 v[220:223], a[196:199], v[104:107], v[220:223]
    s_barrier
    v_mfma_f32_16x16x32_bf16 v[220:223], a[204:207], v[108:111], v[220:223]
    ds_read_b128 v[80:83], v159 offset:12288
    s_add_u32 m0, s74, 61440
    v_mfma_f32_16x16x32_bf16 v[216:219], a[200:203], v[108:111], v[216:219]
    ds_read_b128 v[84:87], v159 offset:18432
    v_mfma_f32_16x16x32_bf16 v[216:219], a[192:195], v[104:107], v[216:219]
    ds_read_b128 v[88:91], v159 offset:12544
    buffer_load_dwordx4 v156, s[44:47], s19 offen offset:0 sc1 lds
    v_mfma_f32_16x16x32_bf16 v[224:227], a[192:195], v[112:115], v[224:227]
    ds_read_b128 v[92:95], v159 offset:18688
    v_mfma_f32_16x16x32_bf16 v[224:227], a[200:203], v[116:119], v[224:227]
    ds_read_b128 v[96:99], v159 offset:12800
    v_mfma_f32_16x16x32_bf16 v[228:231], a[204:207], v[116:119], v[228:231]
    ds_read_b128 v[100:103], v159 offset:18944
    buffer_load_dwordx4 v157, s[44:47], s19 offen offset:1024 sc1 lds
    v_mfma_f32_16x16x32_bf16 v[228:231], a[196:199], v[112:115], v[228:231]
    v_mfma_f32_16x16x32_bf16 v[236:239], a[196:199], v[120:123], v[236:239]
    v_mfma_f32_16x16x32_bf16 v[236:239], a[204:207], v[124:127], v[236:239]
    buffer_load_dwordx4 v158, s[44:47], s19 offen offset:2048 sc1 lds
    v_mfma_f32_16x16x32_bf16 v[232:235], a[200:203], v[124:127], v[232:235]
    v_mfma_f32_16x16x32_bf16 v[232:235], a[192:195], v[120:123], v[232:235]
    s_waitcnt lgkmcnt(0)
    v_mfma_f32_16x16x32_bf16 v[192:195], a[208:211], v[80:83], v[192:195]
    s_add_u32 m0, s74, 0
    v_mfma_f32_16x16x32_bf16 v[192:195], a[216:219], v[84:87], v[192:195]
    ds_read_b128 v[104:107], v159 offset:13056
    v_mfma_f32_16x16x32_bf16 v[196:199], a[220:223], v[84:87], v[196:199]
    ds_read_b128 v[108:111], v159 offset:19200
    v_mfma_f32_16x16x32_bf16 v[196:199], a[212:215], v[80:83], v[196:199]
    ds_read_b128 v[112:115], v159 offset:13312
    buffer_load_dwordx4 v156, s[44:47], s20 offen offset:0 sc1 lds
    v_mfma_f32_16x16x32_bf16 v[204:207], a[212:215], v[88:91], v[204:207]
    ds_read_b128 v[116:119], v159 offset:19456
    v_mfma_f32_16x16x32_bf16 v[204:207], a[220:223], v[92:95], v[204:207]
    ds_read_b128 v[120:123], v159 offset:13568
    v_mfma_f32_16x16x32_bf16 v[200:203], a[216:219], v[92:95], v[200:203]
    ds_read_b128 v[124:127], v159 offset:19712
    buffer_load_dwordx4 v157, s[44:47], s20 offen offset:1024 sc1 lds
    v_mfma_f32_16x16x32_bf16 v[200:203], a[208:211], v[88:91], v[200:203]
    v_mfma_f32_16x16x32_bf16 v[208:211], a[208:211], v[96:99], v[208:211]
    v_mfma_f32_16x16x32_bf16 v[208:211], a[216:219], v[100:103], v[208:211]
    buffer_load_dwordx4 v158, s[44:47], s20 offen offset:2048 sc1 lds
    v_mfma_f32_16x16x32_bf16 v[212:215], a[220:223], v[100:103], v[212:215]
    v_mfma_f32_16x16x32_bf16 v[212:215], a[212:215], v[96:99], v[212:215]
    s_waitcnt lgkmcnt(0)
    v_mfma_f32_16x16x32_bf16 v[220:223], a[212:215], v[104:107], v[220:223]
    s_waitcnt vmcnt(16)
    s_barrier
    v_mfma_f32_16x16x32_bf16 v[220:223], a[220:223], v[108:111], v[220:223]
    ds_read_b128 v[80:83], v159 offset:24576
    s_add_u32 m0, s74, 12288
    v_mfma_f32_16x16x32_bf16 v[216:219], a[216:219], v[108:111], v[216:219]
    ds_read_b128 v[84:87], v159 offset:30720
    v_mfma_f32_16x16x32_bf16 v[216:219], a[208:211], v[104:107], v[216:219]
    ds_read_b128 v[88:91], v159 offset:24832
    buffer_load_dwordx4 v156, s[44:47], s21 offen offset:0 sc1 lds
    v_mfma_f32_16x16x32_bf16 v[224:227], a[208:211], v[112:115], v[224:227]
    ds_read_b128 v[92:95], v159 offset:30976
    v_mfma_f32_16x16x32_bf16 v[224:227], a[216:219], v[116:119], v[224:227]
    ds_read_b128 v[96:99], v159 offset:25088
    v_mfma_f32_16x16x32_bf16 v[228:231], a[220:223], v[116:119], v[228:231]
    ds_read_b128 v[100:103], v159 offset:31232
    buffer_load_dwordx4 v157, s[44:47], s21 offen offset:1024 sc1 lds
    v_mfma_f32_16x16x32_bf16 v[228:231], a[212:215], v[112:115], v[228:231]
    v_mfma_f32_16x16x32_bf16 v[236:239], a[212:215], v[120:123], v[236:239]
    v_mfma_f32_16x16x32_bf16 v[236:239], a[220:223], v[124:127], v[236:239]
    buffer_load_dwordx4 v158, s[44:47], s21 offen offset:2048 sc1 lds
    v_mfma_f32_16x16x32_bf16 v[232:235], a[216:219], v[124:127], v[232:235]
    v_mfma_f32_16x16x32_bf16 v[232:235], a[208:211], v[120:123], v[232:235]
    s_waitcnt lgkmcnt(0)
    v_mfma_f32_16x16x32_bf16 v[192:195], a[224:227], v[80:83], v[192:195]
    s_add_u32 m0, s73, 0
    s_lshl_b32 s14, s85, 18
    v_mfma_f32_16x16x32_bf16 v[192:195], a[232:235], v[84:87], v[192:195]
    ds_read_b128 v[104:107], v159 offset:25344
    v_mfma_f32_16x16x32_bf16 v[196:199], a[236:239], v[84:87], v[196:199]
    ds_read_b128 v[108:111], v159 offset:31488
    buffer_load_dwordx4 v4, s[52:55], s14 offen offset:0 lds
    v_mfma_f32_16x16x32_bf16 v[196:199], a[228:231], v[80:83], v[196:199]
    ds_read_b128 v[112:115], v159 offset:25600
    v_mfma_f32_16x16x32_bf16 v[204:207], a[228:231], v[88:91], v[204:207]
    ds_read_b128 v[116:119], v159 offset:31744
    buffer_load_dwordx4 v5, s[52:55], s14 offen offset:1024 lds
    v_mfma_f32_16x16x32_bf16 v[204:207], a[236:239], v[92:95], v[204:207]
    ds_read_b128 v[120:123], v159 offset:25856
    v_mfma_f32_16x16x32_bf16 v[200:203], a[232:235], v[92:95], v[200:203]
    ds_read_b128 v[124:127], v159 offset:32000
    v_mfma_f32_16x16x32_bf16 v[200:203], a[224:227], v[88:91], v[200:203]
    buffer_load_dwordx4 v6, s[52:55], s14 offen offset:2048 lds
    v_mfma_f32_16x16x32_bf16 v[208:211], a[224:227], v[96:99], v[208:211]
    v_mfma_f32_16x16x32_bf16 v[208:211], a[232:235], v[100:103], v[208:211]
    buffer_load_dwordx4 v7, s[52:55], s14 offen offset:3072 lds
    v_mfma_f32_16x16x32_bf16 v[212:215], a[236:239], v[100:103], v[212:215]
    v_mfma_f32_16x16x32_bf16 v[212:215], a[228:231], v[96:99], v[212:215]
    s_waitcnt lgkmcnt(0)
    v_mfma_f32_16x16x32_bf16 v[220:223], a[228:231], v[104:107], v[220:223]
    s_waitcnt vmcnt(16)
    s_barrier
    v_mfma_f32_16x16x32_bf16 v[220:223], a[236:239], v[108:111], v[220:223]
    ds_read_b128 v[80:83], v250 offset:0
    v_mfma_f32_16x16x32_bf16 v[216:219], a[232:235], v[108:111], v[216:219]
    ds_read_b128 v[84:87], v250 offset:6144
    v_mfma_f32_16x16x32_bf16 v[216:219], a[224:227], v[104:107], v[216:219]
    ds_read_b128 v[88:91], v250 offset:256
    v_mfma_f32_16x16x32_bf16 v[224:227], a[224:227], v[112:115], v[224:227]
    ds_read_b128 v[92:95], v250 offset:6400
    v_mfma_f32_16x16x32_bf16 v[224:227], a[232:235], v[116:119], v[224:227]
    ds_read_b128 v[96:99], v250 offset:512
    v_mfma_f32_16x16x32_bf16 v[228:231], a[236:239], v[116:119], v[228:231]
L_pl_G_3:
    s_cbranch_execz L_wret
    ds_read_b128 v[100:103], v250 offset:6656
    v_mfma_f32_16x16x32_bf16 v[228:231], a[228:231], v[112:115], v[228:231]
    v_mfma_f32_16x16x32_bf16 v[236:239], a[228:231], v[120:123], v[236:239]
    v_mfma_f32_16x16x32_bf16 v[236:239], a[236:239], v[124:127], v[236:239]
    v_mfma_f32_16x16x32_bf16 v[232:235], a[232:235], v[124:127], v[232:235]
    v_mfma_f32_16x16x32_bf16 v[232:235], a[224:227], v[120:123], v[232:235]
    s_waitcnt lgkmcnt(0)
    v_mfma_f32_16x16x32_bf16 v[192:195], a[240:243], v[80:83], v[192:195]
    v_mfma_f32_16x16x32_bf16 v[192:195], a[248:251], v[84:87], v[192:195]
    ds_read_b128 v[104:107], v250 offset:768
    v_mfma_f32_16x16x32_bf16 v[196:199], a[252:255], v[84:87], v[196:199]
    ds_read_b128 v[108:111], v250 offset:6912
    v_mfma_f32_16x16x32_bf16 v[196:199], a[244:247], v[80:83], v[196:199]
    ds_read_b128 v[112:115], v250 offset:1024
    v_mfma_f32_16x16x32_bf16 v[204:207], a[244:247], v[88:91], v[204:207]
    ds_read_b128 v[116:119], v250 offset:7168
    v_mfma_f32_16x16x32_bf16 v[204:207], a[252:255], v[92:95], v[204:207]
    ds_read_b128 v[120:123], v250 offset:1280
    v_mfma_f32_16x16x32_bf16 v[200:203], a[248:251], v[92:95], v[200:203]
    ds_read_b128 v[124:127], v250 offset:7424
    v_mfma_f32_16x16x32_bf16 v[200:203], a[240:243], v[88:91], v[200:203]
    v_mfma_f32_16x16x32_bf16 v[208:211], a[240:243], v[96:99], v[208:211]
    v_mfma_f32_16x16x32_bf16 v[208:211], a[248:251], v[100:103], v[208:211]
    v_mfma_f32_16x16x32_bf16 v[212:215], a[252:255], v[100:103], v[212:215]
    v_mfma_f32_16x16x32_bf16 v[212:215], a[244:247], v[96:99], v[212:215]
    s_waitcnt lgkmcnt(0)
    v_mfma_f32_16x16x32_bf16 v[220:223], a[244:247], v[104:107], v[220:223]
    s_waitcnt vmcnt(13)
    s_barrier
    v_mfma_f32_16x16x32_bf16 v[220:223], a[252:255], v[108:111], v[220:223]
    ds_read_b128 v[80:83], v250 offset:12288
    v_mfma_f32_16x16x32_bf16 v[216:219], a[248:251], v[108:111], v[216:219]
    ds_read_b128 v[84:87], v250 offset:18432
    v_mfma_f32_16x16x32_bf16 v[216:219], a[240:243], v[104:107], v[216:219]
    ds_read_b128 v[88:91], v250 offset:12544
    v_mfma_f32_16x16x32_bf16 v[224:227], a[240:243], v[112:115], v[224:227]
    ds_read_b128 v[92:95], v250 offset:18688
    v_cvt_pk_bf16_f32 v192, v192, v193
    v_mfma_f32_16x16x32_bf16 v[224:227], a[248:251], v[116:119], v[224:227]
    ds_read_b128 v[96:99], v250 offset:12800
    v_mfma_f32_16x16x32_bf16 v[228:231], a[252:255], v[116:119], v[228:231]
    ds_read_b128 v[100:103], v250 offset:18944
    v_cvt_pk_bf16_f32 v193, v194, v195
    v_mfma_f32_16x16x32_bf16 v[228:231], a[244:247], v[112:115], v[228:231]
    v_mfma_f32_16x16x32_bf16 v[236:239], a[244:247], v[120:123], v[236:239]
    v_cvt_pk_bf16_f32 v194, v196, v197
    v_mfma_f32_16x16x32_bf16 v[236:239], a[252:255], v[124:127], v[236:239]
    v_cvt_pk_bf16_f32 v195, v198, v199
    v_mfma_f32_16x16x32_bf16 v[232:235], a[248:251], v[124:127], v[232:235]
    v_mfma_f32_16x16x32_bf16 v[232:235], a[240:243], v[120:123], v[232:235]
    buffer_store_dwordx4 v[192:195], v246, s[44:47], s9 offen offset:0 sc1
    s_waitcnt lgkmcnt(0)
    v_mfma_f32_16x16x32_bf16 v[32:35], a[0:3], v[80:83], v[128:131]
    v_mfma_f32_16x16x32_bf16 v[32:35], a[8:11], v[84:87], v[32:35]
    ds_read_b128 v[104:107], v250 offset:13056
    v_mfma_f32_16x16x32_bf16 v[36:39], a[12:15], v[84:87], v[132:135]
    ds_read_b128 v[108:111], v250 offset:19200
    v_mfma_f32_16x16x32_bf16 v[36:39], a[4:7], v[80:83], v[36:39]
    ds_read_b128 v[112:115], v250 offset:13312
    v_mfma_f32_16x16x32_bf16 v[44:47], a[4:7], v[88:91], v[132:135]
    ds_read_b128 v[116:119], v250 offset:19456
    v_cvt_pk_bf16_f32 v200, v200, v201
    v_mfma_f32_16x16x32_bf16 v[44:47], a[12:15], v[92:95], v[44:47]
    ds_read_b128 v[120:123], v250 offset:13568
    v_mfma_f32_16x16x32_bf16 v[40:43], a[8:11], v[92:95], v[128:131]
    ds_read_b128 v[124:127], v250 offset:19712
    v_cvt_pk_bf16_f32 v201, v202, v203
    v_mfma_f32_16x16x32_bf16 v[40:43], a[0:3], v[88:91], v[40:43]
    v_mfma_f32_16x16x32_bf16 v[48:51], a[0:3], v[96:99], v[128:131]
    v_cvt_pk_bf16_f32 v202, v204, v205
    v_mfma_f32_16x16x32_bf16 v[48:51], a[8:11], v[100:103], v[48:51]
    v_cvt_pk_bf16_f32 v203, v206, v207
    v_mfma_f32_16x16x32_bf16 v[52:55], a[12:15], v[100:103], v[132:135]
    v_mfma_f32_16x16x32_bf16 v[52:55], a[4:7], v[96:99], v[52:55]
    buffer_store_dwordx4 v[200:203], v246, s[44:47], s9 offen offset:1024 sc1
    s_waitcnt lgkmcnt(0)
    v_mfma_f32_16x16x32_bf16 v[60:63], a[4:7], v[104:107], v[132:135]
    s_waitcnt vmcnt(12)
    s_barrier
    v_mfma_f32_16x16x32_bf16 v[60:63], a[12:15], v[108:111], v[60:63]
    ds_read_b128 v[80:83], v250 offset:24576
    s_add_u32 m0, s74, 24576
    v_cvt_pk_bf16_f32 v208, v208, v209
    v_mfma_f32_16x16x32_bf16 v[56:59], a[8:11], v[108:111], v[128:131]
    ds_read_b128 v[84:87], v250 offset:30720
    v_mfma_f32_16x16x32_bf16 v[56:59], a[0:3], v[104:107], v[56:59]
    ds_read_b128 v[88:91], v250 offset:24832
    buffer_load_dwordx4 v156, s[44:47], s22 offen offset:0 sc1 lds
    v_mfma_f32_16x16x32_bf16 v[64:67], a[0:3], v[112:115], v[128:131]
    ds_read_b128 v[92:95], v250 offset:30976
    v_cvt_pk_bf16_f32 v209, v210, v211
    v_mfma_f32_16x16x32_bf16 v[64:67], a[8:11], v[116:119], v[64:67]
    ds_read_b128 v[96:99], v250 offset:25088
    v_cvt_pk_bf16_f32 v210, v212, v213
    v_mfma_f32_16x16x32_bf16 v[68:71], a[12:15], v[116:119], v[132:135]
    ds_read_b128 v[100:103], v250 offset:31232
    buffer_load_dwordx4 v157, s[44:47], s22 offen offset:1024 sc1 lds
    v_mfma_f32_16x16x32_bf16 v[68:71], a[4:7], v[112:115], v[68:71]
    v_mfma_f32_16x16x32_bf16 v[76:79], a[4:7], v[120:123], v[132:135]
    v_cvt_pk_bf16_f32 v211, v214, v215
    v_mfma_f32_16x16x32_bf16 v[76:79], a[12:15], v[124:127], v[76:79]
    buffer_load_dwordx4 v158, s[44:47], s22 offen offset:2048 sc1 lds
    v_mfma_f32_16x16x32_bf16 v[72:75], a[8:11], v[124:127], v[128:131]
    buffer_store_dwordx4 v[208:211], v246, s[44:47], s9 offen offset:2048 sc1
    v_mfma_f32_16x16x32_bf16 v[72:75], a[0:3], v[120:123], v[72:75]
    s_waitcnt lgkmcnt(0)
    v_mfma_f32_16x16x32_bf16 v[32:35], a[16:19], v[80:83], v[32:35]
    s_add_u32 m0, s74, 36864
    v_mfma_f32_16x16x32_bf16 v[32:35], a[24:27], v[84:87], v[32:35]
    ds_read_b128 v[104:107], v250 offset:25344
    v_cvt_pk_bf16_f32 v216, v216, v217
    v_mfma_f32_16x16x32_bf16 v[36:39], a[28:31], v[84:87], v[36:39]
    ds_read_b128 v[108:111], v250 offset:31488
    v_mfma_f32_16x16x32_bf16 v[36:39], a[20:23], v[80:83], v[36:39]
    ds_read_b128 v[112:115], v250 offset:25600
    buffer_load_dwordx4 v156, s[44:47], s23 offen offset:0 sc1 lds
    v_mfma_f32_16x16x32_bf16 v[44:47], a[20:23], v[88:91], v[44:47]
    ds_read_b128 v[116:119], v250 offset:31744
    v_cvt_pk_bf16_f32 v217, v218, v219
    v_mfma_f32_16x16x32_bf16 v[44:47], a[28:31], v[92:95], v[44:47]
    ds_read_b128 v[120:123], v250 offset:25856
    v_cvt_pk_bf16_f32 v218, v220, v221
    v_mfma_f32_16x16x32_bf16 v[40:43], a[24:27], v[92:95], v[40:43]
    ds_read_b128 v[124:127], v250 offset:32000
    buffer_load_dwordx4 v157, s[44:47], s23 offen offset:1024 sc1 lds
    v_mfma_f32_16x16x32_bf16 v[40:43], a[16:19], v[88:91], v[40:43]
    v_mfma_f32_16x16x32_bf16 v[48:51], a[16:19], v[96:99], v[48:51]
    v_cvt_pk_bf16_f32 v219, v222, v223
    v_mfma_f32_16x16x32_bf16 v[48:51], a[24:27], v[100:103], v[48:51]
    buffer_load_dwordx4 v158, s[44:47], s23 offen offset:2048 sc1 lds
    v_mfma_f32_16x16x32_bf16 v[52:55], a[28:31], v[100:103], v[52:55]
    buffer_store_dwordx4 v[216:219], v247, s[44:47], s9 offen offset:0 sc1
    v_mfma_f32_16x16x32_bf16 v[52:55], a[20:23], v[96:99], v[52:55]
    s_waitcnt lgkmcnt(0)
    v_mfma_f32_16x16x32_bf16 v[60:63], a[20:23], v[104:107], v[60:63]
    s_waitcnt vmcnt(17)
    s_barrier
    v_mfma_f32_16x16x32_bf16 v[60:63], a[28:31], v[108:111], v[60:63]
    ds_read_b128 v[80:83], v159 offset:0
    s_add_u32 m0, s74, 49152
    v_cvt_pk_bf16_f32 v224, v224, v225
    v_mfma_f32_16x16x32_bf16 v[56:59], a[24:27], v[108:111], v[56:59]
    ds_read_b128 v[84:87], v159 offset:6144
    v_mfma_f32_16x16x32_bf16 v[56:59], a[16:19], v[104:107], v[56:59]
    ds_read_b128 v[88:91], v159 offset:256
    buffer_load_dwordx4 v156, s[44:47], s24 offen offset:0 sc1 lds
    v_mfma_f32_16x16x32_bf16 v[64:67], a[16:19], v[112:115], v[64:67]
    ds_read_b128 v[92:95], v159 offset:6400
    v_cvt_pk_bf16_f32 v225, v226, v227
    v_mfma_f32_16x16x32_bf16 v[64:67], a[24:27], v[116:119], v[64:67]
    ds_read_b128 v[96:99], v159 offset:512
    v_cvt_pk_bf16_f32 v226, v228, v229
    v_mfma_f32_16x16x32_bf16 v[68:71], a[28:31], v[116:119], v[68:71]
    ds_read_b128 v[100:103], v159 offset:6656
    buffer_load_dwordx4 v157, s[44:47], s24 offen offset:1024 sc1 lds
    v_mfma_f32_16x16x32_bf16 v[68:71], a[20:23], v[112:115], v[68:71]
    v_add_u32 v10, 65536, v10
    v_mfma_f32_16x16x32_bf16 v[76:79], a[20:23], v[120:123], v[76:79]
    ds_read_b64_tr_b16 a[0:1], v10 offset:0
    v_cvt_pk_bf16_f32 v227, v230, v231
    v_mfma_f32_16x16x32_bf16 v[76:79], a[28:31], v[124:127], v[76:79]
    ds_read_b64_tr_b16 a[2:3], v10 offset:2048
    buffer_load_dwordx4 v158, s[44:47], s24 offen offset:2048 sc1 lds
    v_mfma_f32_16x16x32_bf16 v[72:75], a[24:27], v[124:127], v[72:75]
    buffer_store_dwordx4 v[224:227], v247, s[44:47], s9 offen offset:1024 sc1
    ds_read_b64_tr_b16 a[8:9], v10 offset:4096
    v_mfma_f32_16x16x32_bf16 v[72:75], a[16:19], v[120:123], v[72:75]
    ds_read_b64_tr_b16 a[10:11], v10 offset:6144
    s_waitcnt lgkmcnt(4)
    v_mfma_f32_16x16x32_bf16 v[32:35], a[32:35], v[80:83], v[32:35]
    s_add_u32 m0, s74, 61440
    v_mfma_f32_16x16x32_bf16 v[32:35], a[40:43], v[84:87], v[32:35]
    ds_read_b128 v[104:107], v159 offset:768
    v_cvt_pk_bf16_f32 v232, v232, v233
    v_mfma_f32_16x16x32_bf16 v[36:39], a[44:47], v[84:87], v[36:39]
    ds_read_b128 v[108:111], v159 offset:6912
    v_mfma_f32_16x16x32_bf16 v[36:39], a[36:39], v[80:83], v[36:39]
    ds_read_b128 v[112:115], v159 offset:1024
    buffer_load_dwordx4 v156, s[44:47], s25 offen offset:0 sc1 lds
    v_mfma_f32_16x16x32_bf16 v[44:47], a[36:39], v[88:91], v[44:47]
    ds_read_b128 v[116:119], v159 offset:7168
    v_cvt_pk_bf16_f32 v233, v234, v235
    v_mfma_f32_16x16x32_bf16 v[44:47], a[44:47], v[92:95], v[44:47]
    ds_read_b128 v[120:123], v159 offset:1280
    v_cvt_pk_bf16_f32 v234, v236, v237
    v_mfma_f32_16x16x32_bf16 v[40:43], a[40:43], v[92:95], v[40:43]
    ds_read_b128 v[124:127], v159 offset:7424
    buffer_load_dwordx4 v157, s[44:47], s25 offen offset:1024 sc1 lds
    v_mfma_f32_16x16x32_bf16 v[40:43], a[32:35], v[88:91], v[40:43]
    v_add_u32 v11, 65536, v11
    v_mfma_f32_16x16x32_bf16 v[48:51], a[32:35], v[96:99], v[48:51]
    ds_read_b64_tr_b16 a[4:5], v11 offset:0
    v_cvt_pk_bf16_f32 v235, v238, v239
    v_mfma_f32_16x16x32_bf16 v[48:51], a[40:43], v[100:103], v[48:51]
    ds_read_b64_tr_b16 a[6:7], v11 offset:2048
    buffer_load_dwordx4 v158, s[44:47], s25 offen offset:2048 sc1 lds
    v_mfma_f32_16x16x32_bf16 v[52:55], a[44:47], v[100:103], v[52:55]
    buffer_store_dwordx4 v[232:235], v247, s[44:47], s9 offen offset:2048 sc1
    ds_read_b64_tr_b16 a[12:13], v11 offset:4096
    v_mfma_f32_16x16x32_bf16 v[52:55], a[36:39], v[96:99], v[52:55]
    ds_read_b64_tr_b16 a[14:15], v11 offset:6144
    s_waitcnt lgkmcnt(4)
    v_mfma_f32_16x16x32_bf16 v[60:63], a[36:39], v[104:107], v[60:63]
    s_waitcnt vmcnt(18)
    s_barrier
    v_mfma_f32_16x16x32_bf16 v[60:63], a[44:47], v[108:111], v[60:63]
    ds_read_b128 v[80:83], v159 offset:12288
    s_add_u32 m0, s74, 0
    v_mfma_f32_16x16x32_bf16 v[56:59], a[40:43], v[108:111], v[56:59]
    ds_read_b128 v[84:87], v159 offset:18432
    v_mfma_f32_16x16x32_bf16 v[56:59], a[32:35], v[104:107], v[56:59]
    ds_read_b128 v[88:91], v159 offset:12544
    buffer_load_dwordx4 v156, s[44:47], s26 offen offset:0 sc1 lds
    v_mfma_f32_16x16x32_bf16 v[64:67], a[32:35], v[112:115], v[64:67]
    ds_read_b128 v[92:95], v159 offset:18688
    v_mfma_f32_16x16x32_bf16 v[64:67], a[40:43], v[116:119], v[64:67]
    ds_read_b128 v[96:99], v159 offset:12800
    v_mfma_f32_16x16x32_bf16 v[68:71], a[44:47], v[116:119], v[68:71]
    ds_read_b128 v[100:103], v159 offset:18944
    buffer_load_dwordx4 v157, s[44:47], s26 offen offset:1024 sc1 lds
    v_mfma_f32_16x16x32_bf16 v[68:71], a[36:39], v[112:115], v[68:71]
    v_add_u32 v10, -65536, v10
    v_mfma_f32_16x16x32_bf16 v[76:79], a[36:39], v[120:123], v[76:79]
    ds_read_b64_tr_b16 a[16:17], v10 offset:0
    v_mfma_f32_16x16x32_bf16 v[76:79], a[44:47], v[124:127], v[76:79]
    ds_read_b64_tr_b16 a[18:19], v10 offset:2048
    buffer_load_dwordx4 v158, s[44:47], s26 offen offset:2048 sc1 lds
    v_mfma_f32_16x16x32_bf16 v[72:75], a[40:43], v[124:127], v[72:75]
    ds_read_b64_tr_b16 a[24:25], v10 offset:4096
    v_mfma_f32_16x16x32_bf16 v[72:75], a[32:35], v[120:123], v[72:75]
    ds_read_b64_tr_b16 a[26:27], v10 offset:6144
    s_waitcnt lgkmcnt(4)
    v_mfma_f32_16x16x32_bf16 v[32:35], a[48:51], v[80:83], v[32:35]
    v_mfma_f32_16x16x32_bf16 v[32:35], a[56:59], v[84:87], v[32:35]
    ds_read_b128 v[104:107], v159 offset:13056
    v_mfma_f32_16x16x32_bf16 v[36:39], a[60:63], v[84:87], v[36:39]
    ds_read_b128 v[108:111], v159 offset:19200
    v_mfma_f32_16x16x32_bf16 v[36:39], a[52:55], v[80:83], v[36:39]
    ds_read_b128 v[112:115], v159 offset:13312
    v_mfma_f32_16x16x32_bf16 v[44:47], a[52:55], v[88:91], v[44:47]
    ds_read_b128 v[116:119], v159 offset:19456
    v_mfma_f32_16x16x32_bf16 v[44:47], a[60:63], v[92:95], v[44:47]
    ds_read_b128 v[120:123], v159 offset:13568
    v_mfma_f32_16x16x32_bf16 v[40:43], a[56:59], v[92:95], v[40:43]
    ds_read_b128 v[124:127], v159 offset:19712
    v_mfma_f32_16x16x32_bf16 v[40:43], a[48:51], v[88:91], v[40:43]
    v_add_u32 v11, -65536, v11
    v_mfma_f32_16x16x32_bf16 v[48:51], a[48:51], v[96:99], v[48:51]
    ds_read_b64_tr_b16 a[20:21], v11 offset:0
    v_mfma_f32_16x16x32_bf16 v[48:51], a[56:59], v[100:103], v[48:51]
    ds_read_b64_tr_b16 a[22:23], v11 offset:2048
    v_mfma_f32_16x16x32_bf16 v[52:55], a[60:63], v[100:103], v[52:55]
    ds_read_b64_tr_b16 a[28:29], v11 offset:4096
    v_mfma_f32_16x16x32_bf16 v[52:55], a[52:55], v[96:99], v[52:55]
    ds_read_b64_tr_b16 a[30:31], v11 offset:6144
    s_waitcnt lgkmcnt(4)
    v_mfma_f32_16x16x32_bf16 v[60:63], a[52:55], v[104:107], v[60:63]
    s_waitcnt vmcnt(16)
    s_barrier
    v_mfma_f32_16x16x32_bf16 v[60:63], a[60:63], v[108:111], v[60:63]
    ds_read_b128 v[80:83], v159 offset:24576
    s_add_u32 m0, s74, 12288
    v_mfma_f32_16x16x32_bf16 v[56:59], a[56:59], v[108:111], v[56:59]
    ds_read_b128 v[84:87], v159 offset:30720
    v_mfma_f32_16x16x32_bf16 v[56:59], a[48:51], v[104:107], v[56:59]
    ds_read_b128 v[88:91], v159 offset:24832
    buffer_load_dwordx4 v156, s[44:47], s27 offen offset:0 sc1 lds
    v_mfma_f32_16x16x32_bf16 v[64:67], a[48:51], v[112:115], v[64:67]
    ds_read_b128 v[92:95], v159 offset:30976
    v_mfma_f32_16x16x32_bf16 v[64:67], a[56:59], v[116:119], v[64:67]
    ds_read_b128 v[96:99], v159 offset:25088
    v_mfma_f32_16x16x32_bf16 v[68:71], a[60:63], v[116:119], v[68:71]
    ds_read_b128 v[100:103], v159 offset:31232
    buffer_load_dwordx4 v157, s[44:47], s27 offen offset:1024 sc1 lds
    v_mfma_f32_16x16x32_bf16 v[68:71], a[52:55], v[112:115], v[68:71]
    v_mfma_f32_16x16x32_bf16 v[76:79], a[52:55], v[120:123], v[76:79]
    v_mfma_f32_16x16x32_bf16 v[76:79], a[60:63], v[124:127], v[76:79]
    buffer_load_dwordx4 v158, s[44:47], s27 offen offset:2048 sc1 lds
    v_mfma_f32_16x16x32_bf16 v[72:75], a[56:59], v[124:127], v[72:75]
    v_mfma_f32_16x16x32_bf16 v[72:75], a[48:51], v[120:123], v[72:75]
    s_waitcnt lgkmcnt(0)
    v_mfma_f32_16x16x32_bf16 v[32:35], a[64:67], v[80:83], v[32:35]
    s_add_u32 m0, s73, 16384
    s_lshl_b32 s14, s86, 18
    v_mfma_f32_16x16x32_bf16 v[32:35], a[72:75], v[84:87], v[32:35]
    ds_read_b128 v[104:107], v159 offset:25344
    v_mfma_f32_16x16x32_bf16 v[36:39], a[76:79], v[84:87], v[36:39]
    ds_read_b128 v[108:111], v159 offset:31488
    buffer_load_dwordx4 v4, s[52:55], s14 offen offset:0 lds
    v_mfma_f32_16x16x32_bf16 v[36:39], a[68:71], v[80:83], v[36:39]
    ds_read_b128 v[112:115], v159 offset:25600
    v_mfma_f32_16x16x32_bf16 v[44:47], a[68:71], v[88:91], v[44:47]
    ds_read_b128 v[116:119], v159 offset:31744
    buffer_load_dwordx4 v5, s[52:55], s14 offen offset:1024 lds
    v_mfma_f32_16x16x32_bf16 v[44:47], a[76:79], v[92:95], v[44:47]
    ds_read_b128 v[120:123], v159 offset:25856
    v_mfma_f32_16x16x32_bf16 v[40:43], a[72:75], v[92:95], v[40:43]
    ds_read_b128 v[124:127], v159 offset:32000
    v_mfma_f32_16x16x32_bf16 v[40:43], a[64:67], v[88:91], v[40:43]
    buffer_load_dwordx4 v6, s[52:55], s14 offen offset:2048 lds
    v_mfma_f32_16x16x32_bf16 v[48:51], a[64:67], v[96:99], v[48:51]
    v_mfma_f32_16x16x32_bf16 v[48:51], a[72:75], v[100:103], v[48:51]
    buffer_load_dwordx4 v7, s[52:55], s14 offen offset:3072 lds
    v_mfma_f32_16x16x32_bf16 v[52:55], a[76:79], v[100:103], v[52:55]
    v_mfma_f32_16x16x32_bf16 v[52:55], a[68:71], v[96:99], v[52:55]
    s_waitcnt lgkmcnt(0)
    v_mfma_f32_16x16x32_bf16 v[60:63], a[68:71], v[104:107], v[60:63]
    s_waitcnt vmcnt(19)
    s_barrier
    v_mfma_f32_16x16x32_bf16 v[60:63], a[76:79], v[108:111], v[60:63]
    ds_read_b128 v[80:83], v250 offset:0
    v_mfma_f32_16x16x32_bf16 v[56:59], a[72:75], v[108:111], v[56:59]
    ds_read_b128 v[84:87], v250 offset:6144
    v_mfma_f32_16x16x32_bf16 v[56:59], a[64:67], v[104:107], v[56:59]
    ds_read_b128 v[88:91], v250 offset:256
    v_mfma_f32_16x16x32_bf16 v[64:67], a[64:67], v[112:115], v[64:67]
    ds_read_b128 v[92:95], v250 offset:6400
    v_mfma_f32_16x16x32_bf16 v[64:67], a[72:75], v[116:119], v[64:67]
    ds_read_b128 v[96:99], v250 offset:512
    v_mfma_f32_16x16x32_bf16 v[68:71], a[76:79], v[116:119], v[68:71]
    ds_read_b128 v[100:103], v250 offset:6656
    v_mfma_f32_16x16x32_bf16 v[68:71], a[68:71], v[112:115], v[68:71]
    v_mfma_f32_16x16x32_bf16 v[76:79], a[68:71], v[120:123], v[76:79]
    v_mfma_f32_16x16x32_bf16 v[76:79], a[76:79], v[124:127], v[76:79]
    v_mfma_f32_16x16x32_bf16 v[72:75], a[72:75], v[124:127], v[72:75]
    v_mfma_f32_16x16x32_bf16 v[72:75], a[64:67], v[120:123], v[72:75]
    s_waitcnt lgkmcnt(0)
    v_mfma_f32_16x16x32_bf16 v[32:35], a[80:83], v[80:83], v[32:35]
    v_mfma_f32_16x16x32_bf16 v[32:35], a[88:91], v[84:87], v[32:35]
    ds_read_b128 v[104:107], v250 offset:768
    v_mfma_f32_16x16x32_bf16 v[36:39], a[92:95], v[84:87], v[36:39]
    ds_read_b128 v[108:111], v250 offset:6912
    v_mfma_f32_16x16x32_bf16 v[36:39], a[84:87], v[80:83], v[36:39]
    ds_read_b128 v[112:115], v250 offset:1024
    v_mfma_f32_16x16x32_bf16 v[44:47], a[84:87], v[88:91], v[44:47]
    ds_read_b128 v[116:119], v250 offset:7168
    v_mfma_f32_16x16x32_bf16 v[44:47], a[92:95], v[92:95], v[44:47]
    ds_read_b128 v[120:123], v250 offset:1280
    v_mfma_f32_16x16x32_bf16 v[40:43], a[88:91], v[92:95], v[40:43]
    ds_read_b128 v[124:127], v250 offset:7424
    v_mfma_f32_16x16x32_bf16 v[40:43], a[80:83], v[88:91], v[40:43]
    s_waitcnt vmcnt(10)
    buffer_store_dword v249, v248, s[44:47], s6 offen sc1
    v_mfma_f32_16x16x32_bf16 v[48:51], a[80:83], v[96:99], v[48:51]
    v_mfma_f32_16x16x32_bf16 v[48:51], a[88:91], v[100:103], v[48:51]
    v_mfma_f32_16x16x32_bf16 v[52:55], a[92:95], v[100:103], v[52:55]
    v_mfma_f32_16x16x32_bf16 v[52:55], a[84:87], v[96:99], v[52:55]
    s_waitcnt lgkmcnt(0)
    v_mfma_f32_16x16x32_bf16 v[60:63], a[84:87], v[104:107], v[60:63]
    s_barrier
    v_mfma_f32_16x16x32_bf16 v[60:63], a[92:95], v[108:111], v[60:63]
    ds_read_b128 v[80:83], v250 offset:12288
    v_mfma_f32_16x16x32_bf16 v[56:59], a[88:91], v[108:111], v[56:59]
    ds_read_b128 v[84:87], v250 offset:18432
    v_mfma_f32_16x16x32_bf16 v[56:59], a[80:83], v[104:107], v[56:59]
    ds_read_b128 v[88:91], v250 offset:12544
    v_mfma_f32_16x16x32_bf16 v[64:67], a[80:83], v[112:115], v[64:67]
    ds_read_b128 v[92:95], v250 offset:18688
    v_mfma_f32_16x16x32_bf16 v[64:67], a[88:91], v[116:119], v[64:67]
    ds_read_b128 v[96:99], v250 offset:12800
    v_mfma_f32_16x16x32_bf16 v[68:71], a[92:95], v[116:119], v[68:71]
    ds_read_b128 v[100:103], v250 offset:18944
    v_mfma_f32_16x16x32_bf16 v[68:71], a[84:87], v[112:115], v[68:71]
    v_mfma_f32_16x16x32_bf16 v[76:79], a[84:87], v[120:123], v[76:79]
    v_mfma_f32_16x16x32_bf16 v[76:79], a[92:95], v[124:127], v[76:79]
    v_mfma_f32_16x16x32_bf16 v[72:75], a[88:91], v[124:127], v[72:75]
    v_mfma_f32_16x16x32_bf16 v[72:75], a[80:83], v[120:123], v[72:75]
    s_waitcnt lgkmcnt(0)
    v_mfma_f32_16x16x32_bf16 v[32:35], a[96:99], v[80:83], v[32:35]
    v_mfma_f32_16x16x32_bf16 v[32:35], a[104:107], v[84:87], v[32:35]
    ds_read_b128 v[104:107], v250 offset:13056
    v_mfma_f32_16x16x32_bf16 v[36:39], a[108:111], v[84:87], v[36:39]
    ds_read_b128 v[108:111], v250 offset:19200
    v_mfma_f32_16x16x32_bf16 v[36:39], a[100:103], v[80:83], v[36:39]
    ds_read_b128 v[112:115], v250 offset:13312
    v_mfma_f32_16x16x32_bf16 v[44:47], a[100:103], v[88:91], v[44:47]
    ds_read_b128 v[116:119], v250 offset:19456
    v_mfma_f32_16x16x32_bf16 v[44:47], a[108:111], v[92:95], v[44:47]
    ds_read_b128 v[120:123], v250 offset:13568
    v_mfma_f32_16x16x32_bf16 v[40:43], a[104:107], v[92:95], v[40:43]
    ds_read_b128 v[124:127], v250 offset:19712
    v_mfma_f32_16x16x32_bf16 v[40:43], a[96:99], v[88:91], v[40:43]
    v_mfma_f32_16x16x32_bf16 v[48:51], a[96:99], v[96:99], v[48:51]
    v_mfma_f32_16x16x32_bf16 v[48:51], a[104:107], v[100:103], v[48:51]
    v_mfma_f32_16x16x32_bf16 v[52:55], a[108:111], v[100:103], v[52:55]
    v_mfma_f32_16x16x32_bf16 v[52:55], a[100:103], v[96:99], v[52:55]
    s_waitcnt lgkmcnt(0)
    v_mfma_f32_16x16x32_bf16 v[60:63], a[100:103], v[104:107], v[60:63]
    s_barrier
    v_mfma_f32_16x16x32_bf16 v[60:63], a[108:111], v[108:111], v[60:63]
    ds_read_b128 v[80:83], v250 offset:24576
    s_add_u32 m0, s74, 24576
    v_mfma_f32_16x16x32_bf16 v[56:59], a[104:107], v[108:111], v[56:59]
    ds_read_b128 v[84:87], v250 offset:30720
    v_mfma_f32_16x16x32_bf16 v[56:59], a[96:99], v[104:107], v[56:59]
    ds_read_b128 v[88:91], v250 offset:24832
    buffer_load_dwordx4 v156, s[44:47], s76 offen offset:0 sc1 lds
    v_mfma_f32_16x16x32_bf16 v[64:67], a[96:99], v[112:115], v[64:67]
    ds_read_b128 v[92:95], v250 offset:30976
    v_mfma_f32_16x16x32_bf16 v[64:67], a[104:107], v[116:119], v[64:67]
    ds_read_b128 v[96:99], v250 offset:25088
    v_mfma_f32_16x16x32_bf16 v[68:71], a[108:111], v[116:119], v[68:71]
    ds_read_b128 v[100:103], v250 offset:31232
    buffer_load_dwordx4 v157, s[44:47], s76 offen offset:1024 sc1 lds
    v_mfma_f32_16x16x32_bf16 v[68:71], a[100:103], v[112:115], v[68:71]
    v_mfma_f32_16x16x32_bf16 v[76:79], a[100:103], v[120:123], v[76:79]
    v_mfma_f32_16x16x32_bf16 v[76:79], a[108:111], v[124:127], v[76:79]
    buffer_load_dwordx4 v158, s[44:47], s76 offen offset:2048 sc1 lds
    v_mfma_f32_16x16x32_bf16 v[72:75], a[104:107], v[124:127], v[72:75]
    v_mfma_f32_16x16x32_bf16 v[72:75], a[96:99], v[120:123], v[72:75]
    s_waitcnt lgkmcnt(0)
    v_mfma_f32_16x16x32_bf16 v[32:35], a[112:115], v[80:83], v[32:35]
    s_add_u32 m0, s74, 36864
    v_mfma_f32_16x16x32_bf16 v[32:35], a[120:123], v[84:87], v[32:35]
    ds_read_b128 v[104:107], v250 offset:25344
    v_mfma_f32_16x16x32_bf16 v[36:39], a[124:127], v[84:87], v[36:39]
    ds_read_b128 v[108:111], v250 offset:31488
    v_mfma_f32_16x16x32_bf16 v[36:39], a[116:119], v[80:83], v[36:39]
    ds_read_b128 v[112:115], v250 offset:25600
    buffer_load_dwordx4 v156, s[44:47], s77 offen offset:0 sc1 lds
    v_mfma_f32_16x16x32_bf16 v[44:47], a[116:119], v[88:91], v[44:47]
    ds_read_b128 v[116:119], v250 offset:31744
    v_mfma_f32_16x16x32_bf16 v[44:47], a[124:127], v[92:95], v[44:47]
    ds_read_b128 v[120:123], v250 offset:25856
    v_mfma_f32_16x16x32_bf16 v[40:43], a[120:123], v[92:95], v[40:43]
    ds_read_b128 v[124:127], v250 offset:32000
    buffer_load_dwordx4 v157, s[44:47], s77 offen offset:1024 sc1 lds
    v_mfma_f32_16x16x32_bf16 v[40:43], a[112:115], v[88:91], v[40:43]
    v_mfma_f32_16x16x32_bf16 v[48:51], a[112:115], v[96:99], v[48:51]
    v_mfma_f32_16x16x32_bf16 v[48:51], a[120:123], v[100:103], v[48:51]
    buffer_load_dwordx4 v158, s[44:47], s77 offen offset:2048 sc1 lds
    v_mfma_f32_16x16x32_bf16 v[52:55], a[124:127], v[100:103], v[52:55]
    v_mfma_f32_16x16x32_bf16 v[52:55], a[116:119], v[96:99], v[52:55]
    s_waitcnt lgkmcnt(0)
    v_mfma_f32_16x16x32_bf16 v[60:63], a[116:119], v[104:107], v[60:63]
    s_waitcnt vmcnt(14)
    s_barrier
    v_mfma_f32_16x16x32_bf16 v[60:63], a[124:127], v[108:111], v[60:63]
    ds_read_b128 v[80:83], v159 offset:0
    s_add_u32 m0, s74, 49152
    v_mfma_f32_16x16x32_bf16 v[56:59], a[120:123], v[108:111], v[56:59]
    ds_read_b128 v[84:87], v159 offset:6144
    v_mfma_f32_16x16x32_bf16 v[56:59], a[112:115], v[104:107], v[56:59]
    ds_read_b128 v[88:91], v159 offset:256
    buffer_load_dwordx4 v156, s[44:47], s78 offen offset:0 sc1 lds
    v_mfma_f32_16x16x32_bf16 v[64:67], a[112:115], v[112:115], v[64:67]
    ds_read_b128 v[92:95], v159 offset:6400
    v_mfma_f32_16x16x32_bf16 v[64:67], a[120:123], v[116:119], v[64:67]
    ds_read_b128 v[96:99], v159 offset:512
    v_mfma_f32_16x16x32_bf16 v[68:71], a[124:127], v[116:119], v[68:71]
    ds_read_b128 v[100:103], v159 offset:6656
    buffer_load_dwordx4 v157, s[44:47], s78 offen offset:1024 sc1 lds
    v_mfma_f32_16x16x32_bf16 v[68:71], a[116:119], v[112:115], v[68:71]
    v_mfma_f32_16x16x32_bf16 v[76:79], a[116:119], v[120:123], v[76:79]
    v_mfma_f32_16x16x32_bf16 v[76:79], a[124:127], v[124:127], v[76:79]
    buffer_load_dwordx4 v158, s[44:47], s78 offen offset:2048 sc1 lds
    v_mfma_f32_16x16x32_bf16 v[72:75], a[120:123], v[124:127], v[72:75]
    v_mfma_f32_16x16x32_bf16 v[72:75], a[112:115], v[120:123], v[72:75]
    s_waitcnt lgkmcnt(0)
    v_mfma_f32_16x16x32_bf16 v[32:35], a[128:131], v[80:83], v[32:35]
    s_add_u32 m0, s74, 61440
    v_mfma_f32_16x16x32_bf16 v[32:35], a[136:139], v[84:87], v[32:35]
    ds_read_b128 v[104:107], v159 offset:768
    v_mfma_f32_16x16x32_bf16 v[36:39], a[140:143], v[84:87], v[36:39]
    ds_read_b128 v[108:111], v159 offset:6912
    v_mfma_f32_16x16x32_bf16 v[36:39], a[132:135], v[80:83], v[36:39]
    ds_read_b128 v[112:115], v159 offset:1024
    buffer_load_dwordx4 v156, s[44:47], s79 offen offset:0 sc1 lds
    v_mfma_f32_16x16x32_bf16 v[44:47], a[132:135], v[88:91], v[44:47]
    ds_read_b128 v[116:119], v159 offset:7168
    v_mfma_f32_16x16x32_bf16 v[44:47], a[140:143], v[92:95], v[44:47]
    ds_read_b128 v[120:123], v159 offset:1280
    v_mfma_f32_16x16x32_bf16 v[40:43], a[136:139], v[92:95], v[40:43]
    ds_read_b128 v[124:127], v159 offset:7424
    buffer_load_dwordx4 v157, s[44:47], s79 offen offset:1024 sc1 lds
    v_mfma_f32_16x16x32_bf16 v[40:43], a[128:131], v[88:91], v[40:43]
    v_mfma_f32_16x16x32_bf16 v[48:51], a[128:131], v[96:99], v[48:51]
    v_mfma_f32_16x16x32_bf16 v[48:51], a[136:139], v[100:103], v[48:51]
    buffer_load_dwordx4 v158, s[44:47], s79 offen offset:2048 sc1 lds
    v_mfma_f32_16x16x32_bf16 v[52:55], a[140:143], v[100:103], v[52:55]
    v_mfma_f32_16x16x32_bf16 v[52:55], a[132:135], v[96:99], v[52:55]
    s_waitcnt lgkmcnt(0)
    v_mfma_f32_16x16x32_bf16 v[60:63], a[132:135], v[104:107], v[60:63]
    s_waitcnt vmcnt(13)
    s_barrier
    v_mfma_f32_16x16x32_bf16 v[60:63], a[140:143], v[108:111], v[60:63]
    ds_read_b128 v[80:83], v159 offset:12288
    s_add_u32 m0, s74, 0
    v_mfma_f32_16x16x32_bf16 v[56:59], a[136:139], v[108:111], v[56:59]
    ds_read_b128 v[84:87], v159 offset:18432
    v_mfma_f32_16x16x32_bf16 v[56:59], a[128:131], v[104:107], v[56:59]
    ds_read_b128 v[88:91], v159 offset:12544
    buffer_load_dwordx4 v156, s[44:47], s80 offen offset:0 sc1 lds
    v_mfma_f32_16x16x32_bf16 v[64:67], a[128:131], v[112:115], v[64:67]
    ds_read_b128 v[92:95], v159 offset:18688
    v_mfma_f32_16x16x32_bf16 v[64:67], a[136:139], v[116:119], v[64:67]
    ds_read_b128 v[96:99], v159 offset:12800
    buffer_load_dword v29, v28, s[44:47], 0 offen sc1
    v_mfma_f32_16x16x32_bf16 v[68:71], a[140:143], v[116:119], v[68:71]
    ds_read_b128 v[100:103], v159 offset:18944
    buffer_load_dwordx4 v157, s[44:47], s80 offen offset:1024 sc1 lds
    v_mfma_f32_16x16x32_bf16 v[68:71], a[132:135], v[112:115], v[68:71]
    ds_read_b64_tr_b16 a[32:33], v10 offset:16384
    v_mfma_f32_16x16x32_bf16 v[76:79], a[132:135], v[120:123], v[76:79]
    ds_read_b64_tr_b16 a[34:35], v10 offset:18432
    v_mfma_f32_16x16x32_bf16 v[76:79], a[140:143], v[124:127], v[76:79]
    buffer_load_dwordx4 v158, s[44:47], s80 offen offset:2048 sc1 lds
    v_mfma_f32_16x16x32_bf16 v[72:75], a[136:139], v[124:127], v[72:75]
    ds_read_b64_tr_b16 a[40:41], v10 offset:20480
    v_mfma_f32_16x16x32_bf16 v[72:75], a[128:131], v[120:123], v[72:75]
    ds_read_b64_tr_b16 a[42:43], v10 offset:22528
    s_waitcnt lgkmcnt(4)
    v_mfma_f32_16x16x32_bf16 v[32:35], a[144:147], v[80:83], v[32:35]
    s_add_u32 m0, s73, 32768
    s_lshl_b32 s14, s87, 18
    v_mfma_f32_16x16x32_bf16 v[32:35], a[152:155], v[84:87], v[32:35]
    ds_read_b128 v[104:107], v159 offset:13056
    v_mfma_f32_16x16x32_bf16 v[36:39], a[156:159], v[84:87], v[36:39]
    ds_read_b128 v[108:111], v159 offset:19200
    buffer_load_dwordx4 v4, s[52:55], s14 offen offset:0 lds
    v_mfma_f32_16x16x32_bf16 v[36:39], a[148:151], v[80:83], v[36:39]
    ds_read_b128 v[112:115], v159 offset:13312
    v_mfma_f32_16x16x32_bf16 v[44:47], a[148:151], v[88:91], v[44:47]
    ds_read_b128 v[116:119], v159 offset:19456
    buffer_load_dwordx4 v5, s[52:55], s14 offen offset:1024 lds
    v_mfma_f32_16x16x32_bf16 v[44:47], a[156:159], v[92:95], v[44:47]
    ds_read_b128 v[120:123], v159 offset:13568
    v_mfma_f32_16x16x32_bf16 v[40:43], a[152:155], v[92:95], v[40:43]
    ds_read_b128 v[124:127], v159 offset:19712
    v_mfma_f32_16x16x32_bf16 v[40:43], a[144:147], v[88:91], v[40:43]
    ds_read_b64_tr_b16 a[36:37], v11 offset:16384
    buffer_load_dwordx4 v6, s[52:55], s14 offen offset:2048 lds
    v_mfma_f32_16x16x32_bf16 v[48:51], a[144:147], v[96:99], v[48:51]
    ds_read_b64_tr_b16 a[38:39], v11 offset:18432
L_pl_G_4:
    s_cbranch_execz L_wret
    v_mfma_f32_16x16x32_bf16 v[48:51], a[152:155], v[100:103], v[48:51]
    buffer_load_dwordx4 v7, s[52:55], s14 offen offset:3072 lds
    v_mfma_f32_16x16x32_bf16 v[52:55], a[156:159], v[100:103], v[52:55]
    ds_read_b64_tr_b16 a[44:45], v11 offset:20480
    v_mfma_f32_16x16x32_bf16 v[52:55], a[148:151], v[96:99], v[52:55]
    ds_read_b64_tr_b16 a[46:47], v11 offset:22528
    s_waitcnt lgkmcnt(4)
    v_mfma_f32_16x16x32_bf16 v[60:63], a[148:151], v[104:107], v[60:63]
    s_waitcnt vmcnt(17)
    s_barrier
    v_mfma_f32_16x16x32_bf16 v[60:63], a[156:159], v[108:111], v[60:63]
    ds_read_b128 v[80:83], v159 offset:24576
    v_mfma_f32_16x16x32_bf16 v[56:59], a[152:155], v[108:111], v[56:59]
    ds_read_b128 v[84:87], v159 offset:30720
    v_mfma_f32_16x16x32_bf16 v[56:59], a[144:147], v[104:107], v[56:59]
    ds_read_b128 v[88:91], v159 offset:24832
    v_mfma_f32_16x16x32_bf16 v[64:67], a[144:147], v[112:115], v[64:67]
    ds_read_b128 v[92:95], v159 offset:30976
    v_mfma_f32_16x16x32_bf16 v[64:67], a[152:155], v[116:119], v[64:67]
    ds_read_b128 v[96:99], v159 offset:25088
    v_mfma_f32_16x16x32_bf16 v[68:71], a[156:159], v[116:119], v[68:71]
    ds_read_b128 v[100:103], v159 offset:31232
    v_mfma_f32_16x16x32_bf16 v[68:71], a[148:151], v[112:115], v[68:71]
    v_mfma_f32_16x16x32_bf16 v[76:79], a[148:151], v[120:123], v[76:79]
    v_mfma_f32_16x16x32_bf16 v[76:79], a[156:159], v[124:127], v[76:79]
    v_mfma_f32_16x16x32_bf16 v[72:75], a[152:155], v[124:127], v[72:75]
    v_mfma_f32_16x16x32_bf16 v[72:75], a[144:147], v[120:123], v[72:75]
    s_waitcnt lgkmcnt(0)
    v_mfma_f32_16x16x32_bf16 v[32:35], a[160:163], v[80:83], v[32:35]
    v_mfma_f32_16x16x32_bf16 v[32:35], a[168:171], v[84:87], v[32:35]
    ds_read_b128 v[104:107], v159 offset:25344
    v_mfma_f32_16x16x32_bf16 v[36:39], a[172:175], v[84:87], v[36:39]
    ds_read_b128 v[108:111], v159 offset:31488
    v_mfma_f32_16x16x32_bf16 v[36:39], a[164:167], v[80:83], v[36:39]
    ds_read_b128 v[112:115], v159 offset:25600
    v_mfma_f32_16x16x32_bf16 v[44:47], a[164:167], v[88:91], v[44:47]
    ds_read_b128 v[116:119], v159 offset:31744
    v_mfma_f32_16x16x32_bf16 v[44:47], a[172:175], v[92:95], v[44:47]
    ds_read_b128 v[120:123], v159 offset:25856
    v_mfma_f32_16x16x32_bf16 v[40:43], a[168:171], v[92:95], v[40:43]
    ds_read_b128 v[124:127], v159 offset:32000
    v_mfma_f32_16x16x32_bf16 v[40:43], a[160:163], v[88:91], v[40:43]
    v_mfma_f32_16x16x32_bf16 v[48:51], a[160:163], v[96:99], v[48:51]
    v_mfma_f32_16x16x32_bf16 v[48:51], a[168:171], v[100:103], v[48:51]
    v_mfma_f32_16x16x32_bf16 v[52:55], a[172:175], v[100:103], v[52:55]
    v_mfma_f32_16x16x32_bf16 v[52:55], a[164:167], v[96:99], v[52:55]
    s_waitcnt lgkmcnt(0)
    v_mfma_f32_16x16x32_bf16 v[60:63], a[164:167], v[104:107], v[60:63]
    s_waitcnt vmcnt(14)
    s_barrier
    v_mfma_f32_16x16x32_bf16 v[60:63], a[172:175], v[108:111], v[60:63]
    ds_read_b128 v[80:83], v250 offset:0
    s_waitcnt vmcnt(6)
    v_mfma_f32_16x16x32_bf16 v[56:59], a[168:171], v[108:111], v[56:59]
    ds_read_b128 v[84:87], v250 offset:6144
    v_cmp_ne_u32 vcc, s68, v29
    v_mfma_f32_16x16x32_bf16 v[56:59], a[160:163], v[104:107], v[56:59]
    ds_read_b128 v[88:91], v250 offset:256
    v_mfma_f32_16x16x32_bf16 v[64:67], a[160:163], v[112:115], v[64:67]
    ds_read_b128 v[92:95], v250 offset:6400
    v_mfma_f32_16x16x32_bf16 v[64:67], a[168:171], v[116:119], v[64:67]
    ds_read_b128 v[96:99], v250 offset:512
    s_cbranch_vccnz L_rs_p5
L_ok_p5:
    v_mfma_f32_16x16x32_bf16 v[68:71], a[172:175], v[116:119], v[68:71]
    ds_read_b128 v[100:103], v250 offset:6656
    buffer_load_dwordx4 v[160:163], v246, s[44:47], s10 offen offset:0 sc1
    v_mfma_f32_16x16x32_bf16 v[68:71], a[164:167], v[112:115], v[68:71]
    v_mfma_f32_16x16x32_bf16 v[76:79], a[164:167], v[120:123], v[76:79]
    v_mfma_f32_16x16x32_bf16 v[76:79], a[172:175], v[124:127], v[76:79]
    buffer_load_dwordx4 v[164:167], v246, s[44:47], s10 offen offset:1024 sc1
    v_mfma_f32_16x16x32_bf16 v[72:75], a[168:171], v[124:127], v[72:75]
    buffer_load_dwordx4 v[168:171], v246, s[44:47], s10 offen offset:2048 sc1
    v_mfma_f32_16x16x32_bf16 v[72:75], a[160:163], v[120:123], v[72:75]
    s_waitcnt lgkmcnt(0)
    v_mfma_f32_16x16x32_bf16 v[32:35], a[176:179], v[80:83], v[32:35]
    v_mfma_f32_16x16x32_bf16 v[32:35], a[184:187], v[84:87], v[32:35]
    ds_read_b128 v[104:107], v250 offset:768
    v_mfma_f32_16x16x32_bf16 v[36:39], a[188:191], v[84:87], v[36:39]
    ds_read_b128 v[108:111], v250 offset:6912
    buffer_load_dwordx4 v[172:175], v247, s[44:47], s10 offen offset:0 sc1
    v_mfma_f32_16x16x32_bf16 v[36:39], a[180:183], v[80:83], v[36:39]
    ds_read_b128 v[112:115], v250 offset:1024
    v_mfma_f32_16x16x32_bf16 v[44:47], a[180:183], v[88:91], v[44:47]
    ds_read_b128 v[116:119], v250 offset:7168
    v_mfma_f32_16x16x32_bf16 v[44:47], a[188:191], v[92:95], v[44:47]
    ds_read_b128 v[120:123], v250 offset:1280
    buffer_load_dwordx4 v[176:179], v247, s[44:47], s10 offen offset:1024 sc1
    v_mfma_f32_16x16x32_bf16 v[40:43], a[184:187], v[92:95], v[40:43]
    ds_read_b128 v[124:127], v250 offset:7424
    v_mfma_f32_16x16x32_bf16 v[40:43], a[176:179], v[88:91], v[40:43]
    v_mfma_f32_16x16x32_bf16 v[48:51], a[176:179], v[96:99], v[48:51]
    v_mfma_f32_16x16x32_bf16 v[48:51], a[184:187], v[100:103], v[48:51]
    v_mfma_f32_16x16x32_bf16 v[52:55], a[188:191], v[100:103], v[52:55]
    buffer_load_dwordx4 v[180:183], v247, s[44:47], s10 offen offset:2048 sc1
    v_mfma_f32_16x16x32_bf16 v[52:55], a[180:183], v[96:99], v[52:55]
    s_waitcnt lgkmcnt(0)
    v_mfma_f32_16x16x32_bf16 v[60:63], a[180:183], v[104:107], v[60:63]
    s_barrier
    v_mfma_f32_16x16x32_bf16 v[60:63], a[188:191], v[108:111], v[60:63]
    ds_read_b128 v[80:83], v250 offset:12288
    s_add_u32 m0, s74, 12288
    v_mfma_f32_16x16x32_bf16 v[56:59], a[184:187], v[108:111], v[56:59]
    ds_read_b128 v[84:87], v250 offset:18432
    v_mfma_f32_16x16x32_bf16 v[56:59], a[176:179], v[104:107], v[56:59]
    ds_read_b128 v[88:91], v250 offset:12544
    buffer_load_dwordx4 v156, s[44:47], s81 offen offset:0 sc1 lds
    v_mfma_f32_16x16x32_bf16 v[64:67], a[176:179], v[112:115], v[64:67]
    ds_read_b128 v[92:95], v250 offset:18688
    v_mfma_f32_16x16x32_bf16 v[64:67], a[184:187], v[116:119], v[64:67]
    ds_read_b128 v[96:99], v250 offset:12800
    v_mfma_f32_16x16x32_bf16 v[68:71], a[188:191], v[116:119], v[68:71]
    ds_read_b128 v[100:103], v250 offset:18944
    buffer_load_dwordx4 v157, s[44:47], s81 offen offset:1024 sc1 lds
    v_mfma_f32_16x16x32_bf16 v[68:71], a[180:183], v[112:115], v[68:71]
    v_mfma_f32_16x16x32_bf16 v[76:79], a[180:183], v[120:123], v[76:79]
    v_mfma_f32_16x16x32_bf16 v[76:79], a[188:191], v[124:127], v[76:79]
    buffer_load_dwordx4 v158, s[44:47], s81 offen offset:2048 sc1 lds
    v_mfma_f32_16x16x32_bf16 v[72:75], a[184:187], v[124:127], v[72:75]
    v_mfma_f32_16x16x32_bf16 v[72:75], a[176:179], v[120:123], v[72:75]
    s_waitcnt lgkmcnt(0)
    v_mfma_f32_16x16x32_bf16 v[32:35], a[192:195], v[80:83], v[32:35]
    s_add_u32 m0, s73, 49152
    s_lshl_b32 s14, s88, 18
    v_mfma_f32_16x16x32_bf16 v[32:35], a[200:203], v[84:87], v[32:35]
    ds_read_b128 v[104:107], v250 offset:13056
    v_mfma_f32_16x16x32_bf16 v[36:39], a[204:207], v[84:87], v[36:39]
    ds_read_b128 v[108:111], v250 offset:19200
    buffer_load_dwordx4 v4, s[52:55], s14 offen offset:0 lds
    v_mfma_f32_16x16x32_bf16 v[36:39], a[196:199], v[80:83], v[36:39]
    ds_read_b128 v[112:115], v250 offset:13312
    v_mfma_f32_16x16x32_bf16 v[44:47], a[196:199], v[88:91], v[44:47]
    ds_read_b128 v[116:119], v250 offset:19456
    buffer_load_dwordx4 v5, s[52:55], s14 offen offset:1024 lds
    v_mfma_f32_16x16x32_bf16 v[44:47], a[204:207], v[92:95], v[44:47]
    ds_read_b128 v[120:123], v250 offset:13568
    v_mfma_f32_16x16x32_bf16 v[40:43], a[200:203], v[92:95], v[40:43]
    ds_read_b128 v[124:127], v250 offset:19712
    v_mfma_f32_16x16x32_bf16 v[40:43], a[192:195], v[88:91], v[40:43]
    buffer_load_dwordx4 v6, s[52:55], s14 offen offset:2048 lds
    v_mfma_f32_16x16x32_bf16 v[48:51], a[192:195], v[96:99], v[48:51]
    v_mfma_f32_16x16x32_bf16 v[48:51], a[200:203], v[100:103], v[48:51]
    buffer_load_dwordx4 v7, s[52:55], s14 offen offset:3072 lds
    v_mfma_f32_16x16x32_bf16 v[52:55], a[204:207], v[100:103], v[52:55]
    v_mfma_f32_16x16x32_bf16 v[52:55], a[196:199], v[96:99], v[52:55]
    s_waitcnt lgkmcnt(0)
    v_mfma_f32_16x16x32_bf16 v[60:63], a[196:199], v[104:107], v[60:63]
    s_barrier
    v_mfma_f32_16x16x32_bf16 v[60:63], a[204:207], v[108:111], v[60:63]
    ds_read_b128 v[80:83], v250 offset:24576
    v_mfma_f32_16x16x32_bf16 v[56:59], a[200:203], v[108:111], v[56:59]
    ds_read_b128 v[84:87], v250 offset:30720
    v_mfma_f32_16x16x32_bf16 v[56:59], a[192:195], v[104:107], v[56:59]
    ds_read_b128 v[88:91], v250 offset:24832
    v_mfma_f32_16x16x32_bf16 v[64:67], a[192:195], v[112:115], v[64:67]
    ds_read_b128 v[92:95], v250 offset:30976
    v_mfma_f32_16x16x32_bf16 v[64:67], a[200:203], v[116:119], v[64:67]
    ds_read_b128 v[96:99], v250 offset:25088
    v_mfma_f32_16x16x32_bf16 v[68:71], a[204:207], v[116:119], v[68:71]
    ds_read_b128 v[100:103], v250 offset:31232
    s_waitcnt vmcnt(7)
    v_mfma_f32_16x16x32_bf16 v[68:71], a[196:199], v[112:115], v[68:71]
    v_mfma_f32_16x16x32_bf16 v[76:79], a[196:199], v[120:123], v[76:79]
    v_mfma_f32_16x16x32_bf16 v[76:79], a[204:207], v[124:127], v[76:79]
    v_mfma_f32_16x16x32_bf16 v[72:75], a[200:203], v[124:127], v[72:75]
    v_mfma_f32_16x16x32_bf16 v[72:75], a[192:195], v[120:123], v[72:75]
    s_waitcnt lgkmcnt(0)
    v_mfma_f32_16x16x32_bf16 v[32:35], a[208:211], v[80:83], v[32:35]
    s_add_u32 m0, s73, 65536
    s_lshl_b32 s14, s89, 18
    v_mfma_f32_16x16x32_bf16 v[32:35], a[216:219], v[84:87], v[32:35]
    ds_read_b128 v[104:107], v250 offset:25344
    v_mfma_f32_16x16x32_bf16 v[36:39], a[220:223], v[84:87], v[36:39]
    ds_read_b128 v[108:111], v250 offset:31488
    buffer_load_dwordx4 v4, s[52:55], s14 offen offset:0 lds
    v_and_b32 v193, 0xffff0000, v172
    v_lshlrev_b32 v192, 16, v172
    v_mfma_f32_16x16x32_bf16 v[36:39], a[212:215], v[80:83], v[36:39]
    ds_read_b128 v[112:115], v250 offset:25600
    v_and_b32 v195, 0xffff0000, v173
    v_lshlrev_b32 v194, 16, v173
    v_mfma_f32_16x16x32_bf16 v[44:47], a[212:215], v[88:91], v[44:47]
    ds_read_b128 v[116:119], v250 offset:31744
    buffer_load_dwordx4 v5, s[52:55], s14 offen offset:1024 lds
    v_add_f32 v56, v56, v192
    v_mfma_f32_16x16x32_bf16 v[44:47], a[220:223], v[92:95], v[44:47]
    ds_read_b128 v[120:123], v250 offset:25856
    v_add_f32 v57, v57, v193
    v_add_f32 v58, v58, v194
    v_mfma_f32_16x16x32_bf16 v[40:43], a[216:219], v[92:95], v[40:43]
    ds_read_b128 v[124:127], v250 offset:32000
    v_add_f32 v59, v59, v195
    v_and_b32 v197, 0xffff0000, v174
    v_mfma_f32_16x16x32_bf16 v[40:43], a[208:211], v[88:91], v[40:43]
    buffer_load_dwordx4 v6, s[52:55], s14 offen offset:2048 lds
    v_lshlrev_b32 v196, 16, v174
    v_and_b32 v199, 0xffff0000, v175
    v_mfma_f32_16x16x32_bf16 v[48:51], a[208:211], v[96:99], v[48:51]
    v_lshlrev_b32 v198, 16, v175
    v_add_f32 v60, v60, v196
    v_mfma_f32_16x16x32_bf16 v[48:51], a[216:219], v[100:103], v[48:51]
    buffer_load_dwordx4 v7, s[52:55], s14 offen offset:3072 lds
    v_add_f32 v61, v61, v197
    v_mfma_f32_16x16x32_bf16 v[52:55], a[220:223], v[100:103], v[52:55]
    v_add_f32 v62, v62, v198
    v_add_f32 v63, v63, v199
    v_mfma_f32_16x16x32_bf16 v[52:55], a[212:215], v[96:99], v[52:55]
    s_waitcnt lgkmcnt(0)
    v_mfma_f32_16x16x32_bf16 v[60:63], a[212:215], v[104:107], v[60:63]
    s_barrier
    v_mfma_f32_16x16x32_bf16 v[60:63], a[220:223], v[108:111], v[60:63]
    ds_read_b128 v[80:83], v159 offset:0
    v_mfma_f32_16x16x32_bf16 v[56:59], a[216:219], v[108:111], v[56:59]
    ds_read_b128 v[84:87], v159 offset:6144
    v_and_b32 v193, 0xffff0000, v160
    v_lshlrev_b32 v192, 16, v160
    v_mfma_f32_16x16x32_bf16 v[56:59], a[208:211], v[104:107], v[56:59]
    ds_read_b128 v[88:91], v159 offset:256
    v_and_b32 v195, 0xffff0000, v161
    v_lshlrev_b32 v194, 16, v161
    v_mfma_f32_16x16x32_bf16 v[64:67], a[208:211], v[112:115], v[64:67]
    ds_read_b128 v[92:95], v159 offset:6400
    v_add_f32 v32, v32, v192
    v_mfma_f32_16x16x32_bf16 v[64:67], a[216:219], v[116:119], v[64:67]
    ds_read_b128 v[96:99], v159 offset:512
    v_add_f32 v33, v33, v193
    v_add_f32 v34, v34, v194
    v_mfma_f32_16x16x32_bf16 v[68:71], a[220:223], v[116:119], v[68:71]
    ds_read_b128 v[100:103], v159 offset:6656
    v_add_f32 v35, v35, v195
    v_and_b32 v197, 0xffff0000, v162
    v_mfma_f32_16x16x32_bf16 v[68:71], a[212:215], v[112:115], v[68:71]
    ds_read_b64_tr_b16 a[48:49], v10 offset:32768
    v_lshlrev_b32 v196, 16, v162
    v_and_b32 v199, 0xffff0000, v163
    v_mfma_f32_16x16x32_bf16 v[76:79], a[212:215], v[120:123], v[76:79]
    ds_read_b64_tr_b16 a[50:51], v10 offset:34816
    v_lshlrev_b32 v198, 16, v163
    v_mfma_f32_16x16x32_bf16 v[76:79], a[220:223], v[124:127], v[76:79]
    v_add_f32 v36, v36, v196
    v_add_f32 v37, v37, v197
    v_mfma_f32_16x16x32_bf16 v[72:75], a[216:219], v[124:127], v[72:75]
    ds_read_b64_tr_b16 a[56:57], v10 offset:36864
    v_add_f32 v38, v38, v198
    v_add_f32 v39, v39, v199
    v_mfma_f32_16x16x32_bf16 v[72:75], a[208:211], v[120:123], v[72:75]
    ds_read_b64_tr_b16 a[58:59], v10 offset:38912
    s_waitcnt lgkmcnt(4)
    v_mfma_f32_16x16x32_bf16 v[32:35], a[224:227], v[80:83], v[32:35]
    s_add_u32 m0, s73, 0
    s_lshl_b32 s14, s90, 18
    v_mfma_f32_16x16x32_bf16 v[32:35], a[232:235], v[84:87], v[32:35]
    ds_read_b128 v[104:107], v159 offset:768
    v_mfma_f32_16x16x32_bf16 v[36:39], a[236:239], v[84:87], v[36:39]
    ds_read_b128 v[108:111], v159 offset:6912
    buffer_load_dwordx4 v4, s[52:55], s14 offen offset:0 lds
    v_and_b32 v193, 0xffff0000, v176
    v_lshlrev_b32 v192, 16, v176
    v_mfma_f32_16x16x32_bf16 v[36:39], a[228:231], v[80:83], v[36:39]
    ds_read_b128 v[112:115], v159 offset:1024
    v_and_b32 v195, 0xffff0000, v177
    v_lshlrev_b32 v194, 16, v177
    v_mfma_f32_16x16x32_bf16 v[44:47], a[228:231], v[88:91], v[44:47]
    ds_read_b128 v[116:119], v159 offset:7168
    buffer_load_dwordx4 v5, s[52:55], s14 offen offset:1024 lds
    v_add_f32 v64, v64, v192
    v_mfma_f32_16x16x32_bf16 v[44:47], a[236:239], v[92:95], v[44:47]
    ds_read_b128 v[120:123], v159 offset:1280
    v_add_f32 v65, v65, v193
    v_add_f32 v66, v66, v194
    v_mfma_f32_16x16x32_bf16 v[40:43], a[232:235], v[92:95], v[40:43]
    ds_read_b128 v[124:127], v159 offset:7424
    v_add_f32 v67, v67, v195
    v_and_b32 v197, 0xffff0000, v178
    v_mfma_f32_16x16x32_bf16 v[40:43], a[224:227], v[88:91], v[40:43]
    ds_read_b64_tr_b16 a[52:53], v11 offset:32768
    buffer_load_dwordx4 v6, s[52:55], s14 offen offset:2048 lds
    v_lshlrev_b32 v196, 16, v178
    v_and_b32 v199, 0xffff0000, v179
    v_mfma_f32_16x16x32_bf16 v[48:51], a[224:227], v[96:99], v[48:51]
    ds_read_b64_tr_b16 a[54:55], v11 offset:34816
    v_lshlrev_b32 v198, 16, v179
    v_mfma_f32_16x16x32_bf16 v[48:51], a[232:235], v[100:103], v[48:51]
    buffer_load_dwordx4 v7, s[52:55], s14 offen offset:3072 lds
    v_add_f32 v68, v68, v196
    v_add_f32 v69, v69, v197
    v_mfma_f32_16x16x32_bf16 v[52:55], a[236:239], v[100:103], v[52:55]
    ds_read_b64_tr_b16 a[60:61], v11 offset:36864
    v_add_f32 v70, v70, v198
    v_add_f32 v71, v71, v199
    v_mfma_f32_16x16x32_bf16 v[52:55], a[228:231], v[96:99], v[52:55]
    ds_read_b64_tr_b16 a[62:63], v11 offset:38912
    s_waitcnt lgkmcnt(4)
    v_mfma_f32_16x16x32_bf16 v[60:63], a[228:231], v[104:107], v[60:63]
    s_waitcnt vmcnt(12)
    s_barrier
    v_mfma_f32_16x16x32_bf16 v[60:63], a[236:239], v[108:111], v[60:63]
    ds_read_b128 v[80:83], v159 offset:12288
    v_mfma_f32_16x16x32_bf16 v[56:59], a[232:235], v[108:111], v[56:59]
    ds_read_b128 v[84:87], v159 offset:18432
    v_and_b32 v193, 0xffff0000, v164
    v_lshlrev_b32 v192, 16, v164
    v_mfma_f32_16x16x32_bf16 v[56:59], a[224:227], v[104:107], v[56:59]
    ds_read_b128 v[88:91], v159 offset:12544
    v_and_b32 v195, 0xffff0000, v165
    v_lshlrev_b32 v194, 16, v165
    v_mfma_f32_16x16x32_bf16 v[64:67], a[224:227], v[112:115], v[64:67]
    ds_read_b128 v[92:95], v159 offset:18688
    v_add_f32 v40, v40, v192
    v_mfma_f32_16x16x32_bf16 v[64:67], a[232:235], v[116:119], v[64:67]
    ds_read_b128 v[96:99], v159 offset:12800
    v_add_f32 v41, v41, v193
    v_add_f32 v42, v42, v194
    v_mfma_f32_16x16x32_bf16 v[68:71], a[236:239], v[116:119], v[68:71]
    ds_read_b128 v[100:103], v159 offset:18944
    v_add_f32 v43, v43, v195
    v_mfma_f32_16x16x32_bf16 v[68:71], a[228:231], v[112:115], v[68:71]
    v_and_b32 v197, 0xffff0000, v166
    v_lshlrev_b32 v196, 16, v166
    v_mfma_f32_16x16x32_bf16 v[76:79], a[228:231], v[120:123], v[76:79]
    v_and_b32 v199, 0xffff0000, v167
    v_lshlrev_b32 v198, 16, v167
    v_mfma_f32_16x16x32_bf16 v[76:79], a[236:239], v[124:127], v[76:79]
    v_add_f32 v44, v44, v196
    v_add_f32 v45, v45, v197
    v_mfma_f32_16x16x32_bf16 v[72:75], a[232:235], v[124:127], v[72:75]
    v_add_f32 v46, v46, v198
    v_add_f32 v47, v47, v199
    v_mfma_f32_16x16x32_bf16 v[72:75], a[224:227], v[120:123], v[72:75]
    s_waitcnt lgkmcnt(0)
    v_mfma_f32_16x16x32_bf16 v[32:35], a[240:243], v[80:83], v[32:35]
    s_add_u32 m0, s73, 16384
    s_lshl_b32 s14, s91, 18
    v_mfma_f32_16x16x32_bf16 v[32:35], a[248:251], v[84:87], v[32:35]
    ds_read_b128 v[104:107], v159 offset:13056
    v_mfma_f32_16x16x32_bf16 v[36:39], a[252:255], v[84:87], v[36:39]
    ds_read_b128 v[108:111], v159 offset:19200
    buffer_load_dwordx4 v4, s[52:55], s14 offen offset:0 lds
    v_and_b32 v193, 0xffff0000, v180
    v_lshlrev_b32 v192, 16, v180
    v_mfma_f32_16x16x32_bf16 v[36:39], a[244:247], v[80:83], v[36:39]
    ds_read_b128 v[112:115], v159 offset:13312
    v_and_b32 v195, 0xffff0000, v181
    v_lshlrev_b32 v194, 16, v181
    v_mfma_f32_16x16x32_bf16 v[44:47], a[244:247], v[88:91], v[44:47]
    ds_read_b128 v[116:119], v159 offset:19456
    buffer_load_dwordx4 v5, s[52:55], s14 offen offset:1024 lds
    v_add_f32 v72, v72, v192
    v_mfma_f32_16x16x32_bf16 v[44:47], a[252:255], v[92:95], v[44:47]
    ds_read_b128 v[120:123], v159 offset:13568
    v_add_f32 v73, v73, v193
    v_add_f32 v74, v74, v194
    v_mfma_f32_16x16x32_bf16 v[40:43], a[248:251], v[92:95], v[40:43]
    ds_read_b128 v[124:127], v159 offset:19712
    v_add_f32 v75, v75, v195
    v_and_b32 v197, 0xffff0000, v182
    v_mfma_f32_16x16x32_bf16 v[40:43], a[240:243], v[88:91], v[40:43]
    buffer_load_dwordx4 v6, s[52:55], s14 offen offset:2048 lds
    v_lshlrev_b32 v196, 16, v182
    v_and_b32 v199, 0xffff0000, v183
    v_mfma_f32_16x16x32_bf16 v[48:51], a[240:243], v[96:99], v[48:51]
    v_lshlrev_b32 v198, 16, v183
    v_add_f32 v76, v76, v196
    v_mfma_f32_16x16x32_bf16 v[48:51], a[248:251], v[100:103], v[48:51]
    buffer_load_dwordx4 v7, s[52:55], s14 offen offset:3072 lds
    v_add_f32 v77, v77, v197
    v_mfma_f32_16x16x32_bf16 v[52:55], a[252:255], v[100:103], v[52:55]
    v_add_f32 v78, v78, v198
    v_add_f32 v79, v79, v199
    v_mfma_f32_16x16x32_bf16 v[52:55], a[244:247], v[96:99], v[52:55]
    s_waitcnt lgkmcnt(0)
    v_mfma_f32_16x16x32_bf16 v[60:63], a[244:247], v[104:107], v[60:63]
    s_barrier
    v_mfma_f32_16x16x32_bf16 v[60:63], a[252:255], v[108:111], v[60:63]
    s_add_u32 m0, s73, 131072
    s_lshl_b32 s14, s92, 18
    v_mfma_f32_16x16x32_bf16 v[56:59], a[248:251], v[108:111], v[56:59]
    buffer_load_dwordx4 v4, s[52:55], s14 offen offset:0 lds
    v_and_b32 v193, 0xffff0000, v168
    v_lshlrev_b32 v192, 16, v168
    v_mfma_f32_16x16x32_bf16 v[56:59], a[240:243], v[104:107], v[56:59]
    buffer_load_dwordx4 v5, s[52:55], s14 offen offset:1024 lds
    v_and_b32 v195, 0xffff0000, v169
    v_lshlrev_b32 v194, 16, v169
    v_mfma_f32_16x16x32_bf16 v[64:67], a[240:243], v[112:115], v[64:67]
    buffer_load_dwordx4 v6, s[52:55], s14 offen offset:2048 lds
    v_add_f32 v48, v48, v192
    v_mfma_f32_16x16x32_bf16 v[64:67], a[248:251], v[116:119], v[64:67]
    buffer_load_dwordx4 v7, s[52:55], s14 offen offset:3072 lds
    v_add_f32 v49, v49, v193
    v_add_f32 v50, v50, v194
    v_mfma_f32_16x16x32_bf16 v[68:71], a[252:255], v[116:119], v[68:71]
    s_add_u32 m0, s73, 147456
    s_lshl_b32 s14, s93, 18
    v_add_f32 v51, v51, v195
    v_and_b32 v197, 0xffff0000, v170
    v_mfma_f32_16x16x32_bf16 v[68:71], a[244:247], v[112:115], v[68:71]
    buffer_load_dwordx4 v4, s[52:55], s14 offen offset:0 lds
    v_lshlrev_b32 v196, 16, v170
    v_and_b32 v199, 0xffff0000, v171
    v_mfma_f32_16x16x32_bf16 v[76:79], a[244:247], v[120:123], v[76:79]
    buffer_load_dwordx4 v5, s[52:55], s14 offen offset:1024 lds
    v_lshlrev_b32 v198, 16, v171
    v_mfma_f32_16x16x32_bf16 v[76:79], a[252:255], v[124:127], v[76:79]
    buffer_load_dwordx4 v6, s[52:55], s14 offen offset:2048 lds
    v_add_f32 v52, v52, v196
    v_add_f32 v53, v53, v197
    v_mfma_f32_16x16x32_bf16 v[72:75], a[248:251], v[124:127], v[72:75]
    buffer_load_dwordx4 v7, s[52:55], s14 offen offset:3072 lds
    v_add_f32 v54, v54, v198
    v_add_f32 v55, v55, v199
    v_mfma_f32_16x16x32_bf16 v[72:75], a[240:243], v[120:123], v[72:75]
    s_waitcnt lgkmcnt(0)
    v_mov_b32 v88, 0xc0135761
    s_mov_b32 s10, 0xbdd2d3e8
    s_lshl_b32 s9, s69, 2
    s_add_u32 s9, s9, s3
    s_mul_i32 s9, s9, 69632
    s_add_u32 s9, s9, 12795904
    v_pk_mul_f32 v[160:161], v[32:33], v[32:33]
    v_pk_mul_f32 v[162:163], v[34:35], v[34:35]
    v_pk_mul_f32 v[164:165], v[36:37], v[36:37]
    v_pk_mul_f32 v[166:167], v[38:39], v[38:39]
    v_pk_mul_f32 v[168:169], v[40:41], v[40:41]
    v_pk_mul_f32 v[170:171], v[42:43], v[42:43]
    v_pk_mul_f32 v[172:173], v[44:45], v[44:45]
    v_pk_mul_f32 v[174:175], v[46:47], v[46:47]
    v_pk_fma_f32 v[160:161], v[160:161], s[10:11], v[88:89] op_sel_hi:[1,0,0]
    v_pk_fma_f32 v[162:163], v[162:163], s[10:11], v[88:89] op_sel_hi:[1,0,0]
    v_pk_fma_f32 v[164:165], v[164:165], s[10:11], v[88:89] op_sel_hi:[1,0,0]
    v_pk_fma_f32 v[166:167], v[166:167], s[10:11], v[88:89] op_sel_hi:[1,0,0]
    v_pk_fma_f32 v[168:169], v[168:169], s[10:11], v[88:89] op_sel_hi:[1,0,0]
    v_pk_fma_f32 v[170:171], v[170:171], s[10:11], v[88:89] op_sel_hi:[1,0,0]
    v_pk_fma_f32 v[172:173], v[172:173], s[10:11], v[88:89] op_sel_hi:[1,0,0]
    v_pk_fma_f32 v[174:175], v[174:175], s[10:11], v[88:89] op_sel_hi:[1,0,0]
    v_pk_mul_f32 v[160:161], v[160:161], v[32:33]
    v_pk_mul_f32 v[162:163], v[162:163], v[34:35]
    v_pk_mul_f32 v[164:165], v[164:165], v[36:37]
    v_pk_mul_f32 v[166:167], v[166:167], v[38:39]
    v_pk_mul_f32 v[168:169], v[168:169], v[40:41]
    v_pk_mul_f32 v[170:171], v[170:171], v[42:43]
    v_pk_mul_f32 v[172:173], v[172:173], v[44:45]
    v_pk_mul_f32 v[174:175], v[174:175], v[46:47]
    v_exp_f32 v160, v160
    v_exp_f32 v161, v161
    v_exp_f32 v162, v162
    v_exp_f32 v163, v163
    v_exp_f32 v164, v164
    v_exp_f32 v165, v165
    v_exp_f32 v166, v166
    v_exp_f32 v167, v167
    v_exp_f32 v168, v168
    v_exp_f32 v169, v169
    v_exp_f32 v170, v170
    v_exp_f32 v171, v171
    v_exp_f32 v172, v172
    v_exp_f32 v173, v173
    v_exp_f32 v174, v174
    v_exp_f32 v175, v175
    v_pk_add_f32 v[160:161], v[160:161], 1.0 op_sel_hi:[1,0]
    v_pk_add_f32 v[162:163], v[162:163], 1.0 op_sel_hi:[1,0]
    v_pk_add_f32 v[164:165], v[164:165], 1.0 op_sel_hi:[1,0]
    v_pk_add_f32 v[166:167], v[166:167], 1.0 op_sel_hi:[1,0]
    v_pk_add_f32 v[168:169], v[168:169], 1.0 op_sel_hi:[1,0]
    v_pk_add_f32 v[170:171], v[170:171], 1.0 op_sel_hi:[1,0]
    v_pk_add_f32 v[172:173], v[172:173], 1.0 op_sel_hi:[1,0]
    v_pk_add_f32 v[174:175], v[174:175], 1.0 op_sel_hi:[1,0]
    v_rcp_f32 v160, v160
    v_rcp_f32 v161, v161
    v_rcp_f32 v162, v162
    v_rcp_f32 v163, v163
    v_rcp_f32 v164, v164
    v_rcp_f32 v165, v165
    v_rcp_f32 v166, v166
    v_rcp_f32 v167, v167
    v_rcp_f32 v168, v168
    v_rcp_f32 v169, v169
    v_rcp_f32 v170, v170
    v_rcp_f32 v171, v171
    v_rcp_f32 v172, v172
    v_rcp_f32 v173, v173
    v_rcp_f32 v174, v174
    v_rcp_f32 v175, v175
    v_pk_mul_f32 v[32:33], v[32:33], v[160:161]
    v_pk_mul_f32 v[34:35], v[34:35], v[162:163]
    v_pk_mul_f32 v[36:37], v[36:37], v[164:165]
    v_pk_mul_f32 v[38:39], v[38:39], v[166:167]
    v_pk_mul_f32 v[40:41], v[40:41], v[168:169]
    v_pk_mul_f32 v[42:43], v[42:43], v[170:171]
    v_pk_mul_f32 v[44:45], v[44:45], v[172:173]
    v_pk_mul_f32 v[46:47], v[46:47], v[174:175]
    v_cvt_pk_bf16_f32 v96, v32, v33
    v_cvt_pk_bf16_f32 v97, v34, v35
    v_cvt_pk_bf16_f32 v98, v36, v37
    v_cvt_pk_bf16_f32 v99, v38, v39
    v_cvt_pk_bf16_f32 v100, v40, v41
    v_cvt_pk_bf16_f32 v101, v42, v43
    v_cvt_pk_bf16_f32 v102, v44, v45
    v_cvt_pk_bf16_f32 v103, v46, v47
    buffer_store_dwordx4 v[96:99], v240, s[44:47], s9 offen sc1
    buffer_store_dwordx4 v[100:103], v241, s[44:47], s9 offen sc1
    v_pk_mul_f32 v[160:161], v[48:49], v[48:49]
    v_pk_mul_f32 v[162:163], v[50:51], v[50:51]
    v_pk_mul_f32 v[164:165], v[52:53], v[52:53]
    v_pk_mul_f32 v[166:167], v[54:55], v[54:55]
    v_pk_mul_f32 v[168:169], v[56:57], v[56:57]
    v_pk_mul_f32 v[170:171], v[58:59], v[58:59]
    v_pk_mul_f32 v[172:173], v[60:61], v[60:61]
    v_pk_mul_f32 v[174:175], v[62:63], v[62:63]
    v_pk_fma_f32 v[160:161], v[160:161], s[10:11], v[88:89] op_sel_hi:[1,0,0]
    v_pk_fma_f32 v[162:163], v[162:163], s[10:11], v[88:89] op_sel_hi:[1,0,0]
    v_pk_fma_f32 v[164:165], v[164:165], s[10:11], v[88:89] op_sel_hi:[1,0,0]
    v_pk_fma_f32 v[166:167], v[166:167], s[10:11], v[88:89] op_sel_hi:[1,0,0]
    v_pk_fma_f32 v[168:169], v[168:169], s[10:11], v[88:89] op_sel_hi:[1,0,0]
    v_pk_fma_f32 v[170:171], v[170:171], s[10:11], v[88:89] op_sel_hi:[1,0,0]
    v_pk_fma_f32 v[172:173], v[172:173], s[10:11], v[88:89] op_sel_hi:[1,0,0]
    v_pk_fma_f32 v[174:175], v[174:175], s[10:11], v[88:89] op_sel_hi:[1,0,0]
    v_pk_mul_f32 v[160:161], v[160:161], v[48:49]
    v_pk_mul_f32 v[162:163], v[162:163], v[50:51]
    v_pk_mul_f32 v[164:165], v[164:165], v[52:53]
    v_pk_mul_f32 v[166:167], v[166:167], v[54:55]
    v_pk_mul_f32 v[168:169], v[168:169], v[56:57]
    v_pk_mul_f32 v[170:171], v[170:171], v[58:59]
    v_pk_mul_f32 v[172:173], v[172:173], v[60:61]
    v_pk_mul_f32 v[174:175], v[174:175], v[62:63]
    v_exp_f32 v160, v160
    v_exp_f32 v161, v161
    v_exp_f32 v162, v162
    v_exp_f32 v163, v163
    v_exp_f32 v164, v164
    v_exp_f32 v165, v165
    v_exp_f32 v166, v166
    v_exp_f32 v167, v167
    v_exp_f32 v168, v168
    v_exp_f32 v169, v169
    v_exp_f32 v170, v170
    v_exp_f32 v171, v171
    v_exp_f32 v172, v172
    v_exp_f32 v173, v173
    v_exp_f32 v174, v174
    v_exp_f32 v175, v175
    v_pk_add_f32 v[160:161], v[160:161], 1.0 op_sel_hi:[1,0]
    v_pk_add_f32 v[162:163], v[162:163], 1.0 op_sel_hi:[1,0]
    v_pk_add_f32 v[164:165], v[164:165], 1.0 op_sel_hi:[1,0]
    v_pk_add_f32 v[166:167], v[166:167], 1.0 op_sel_hi:[1,0]
    v_pk_add_f32 v[168:169], v[168:169], 1.0 op_sel_hi:[1,0]
    v_pk_add_f32 v[170:171], v[170:171], 1.0 op_sel_hi:[1,0]
    v_pk_add_f32 v[172:173], v[172:173], 1.0 op_sel_hi:[1,0]
    v_pk_add_f32 v[174:175], v[174:175], 1.0 op_sel_hi:[1,0]
    v_rcp_f32 v160, v160
    v_rcp_f32 v161, v161
    v_rcp_f32 v162, v162
    v_rcp_f32 v163, v163
    v_rcp_f32 v164, v164
    v_rcp_f32 v165, v165
    v_rcp_f32 v166, v166
    v_rcp_f32 v167, v167
    v_rcp_f32 v168, v168
    v_rcp_f32 v169, v169
    v_rcp_f32 v170, v170
    v_rcp_f32 v171, v171
    v_rcp_f32 v172, v172
    v_rcp_f32 v173, v173
    v_rcp_f32 v174, v174
    v_rcp_f32 v175, v175
    v_pk_mul_f32 v[48:49], v[48:49], v[160:161]
    v_pk_mul_f32 v[50:51], v[50:51], v[162:163]
    v_pk_mul_f32 v[52:53], v[52:53], v[164:165]
    v_pk_mul_f32 v[54:55], v[54:55], v[166:167]
    v_pk_mul_f32 v[56:57], v[56:57], v[168:169]
    v_pk_mul_f32 v[58:59], v[58:59], v[170:171]
    v_pk_mul_f32 v[60:61], v[60:61], v[172:173]
    v_pk_mul_f32 v[62:63], v[62:63], v[174:175]
    v_cvt_pk_bf16_f32 v104, v48, v49
    v_cvt_pk_bf16_f32 v105, v50, v51
    v_cvt_pk_bf16_f32 v106, v52, v53
    v_cvt_pk_bf16_f32 v107, v54, v55
    v_cvt_pk_bf16_f32 v108, v56, v57
    v_cvt_pk_bf16_f32 v109, v58, v59
    v_cvt_pk_bf16_f32 v110, v60, v61
    v_cvt_pk_bf16_f32 v111, v62, v63
    buffer_store_dwordx4 v[104:107], v242, s[44:47], s9 offen sc1
    buffer_store_dwordx4 v[108:111], v243, s[44:47], s9 offen sc1
    v_pk_mul_f32 v[160:161], v[64:65], v[64:65]
    v_pk_mul_f32 v[162:163], v[66:67], v[66:67]
    v_pk_mul_f32 v[164:165], v[68:69], v[68:69]
    v_pk_mul_f32 v[166:167], v[70:71], v[70:71]
    v_pk_mul_f32 v[168:169], v[72:73], v[72:73]
    v_pk_mul_f32 v[170:171], v[74:75], v[74:75]
    v_pk_mul_f32 v[172:173], v[76:77], v[76:77]
    v_pk_mul_f32 v[174:175], v[78:79], v[78:79]
    v_pk_fma_f32 v[160:161], v[160:161], s[10:11], v[88:89] op_sel_hi:[1,0,0]
    v_pk_fma_f32 v[162:163], v[162:163], s[10:11], v[88:89] op_sel_hi:[1,0,0]
    v_pk_fma_f32 v[164:165], v[164:165], s[10:11], v[88:89] op_sel_hi:[1,0,0]
    v_pk_fma_f32 v[166:167], v[166:167], s[10:11], v[88:89] op_sel_hi:[1,0,0]
    v_pk_fma_f32 v[168:169], v[168:169], s[10:11], v[88:89] op_sel_hi:[1,0,0]
    v_pk_fma_f32 v[170:171], v[170:171], s[10:11], v[88:89] op_sel_hi:[1,0,0]
    v_pk_fma_f32 v[172:173], v[172:173], s[10:11], v[88:89] op_sel_hi:[1,0,0]
    v_pk_fma_f32 v[174:175], v[174:175], s[10:11], v[88:89] op_sel_hi:[1,0,0]
L_pl_G_5:
    s_cbranch_execz L_wret
    v_pk_mul_f32 v[160:161], v[160:161], v[64:65]
    v_pk_mul_f32 v[162:163], v[162:163], v[66:67]
    v_pk_mul_f32 v[164:165], v[164:165], v[68:69]
    v_pk_mul_f32 v[166:167], v[166:167], v[70:71]
    v_pk_mul_f32 v[168:169], v[168:169], v[72:73]
    v_pk_mul_f32 v[170:171], v[170:171], v[74:75]
    v_pk_mul_f32 v[172:173], v[172:173], v[76:77]
    v_pk_mul_f32 v[174:175], v[174:175], v[78:79]
    v_exp_f32 v160, v160
    v_exp_f32 v161, v161
    v_exp_f32 v162, v162
    v_exp_f32 v163, v163
    v_exp_f32 v164, v164
    v_exp_f32 v165, v165
    v_exp_f32 v166, v166
    v_exp_f32 v167, v167
    v_exp_f32 v168, v168
    v_exp_f32 v169, v169
    v_exp_f32 v170, v170
    v_exp_f32 v171, v171
    v_exp_f32 v172, v172
    v_exp_f32 v173, v173
    v_exp_f32 v174, v174
    v_exp_f32 v175, v175
    v_pk_add_f32 v[160:161], v[160:161], 1.0 op_sel_hi:[1,0]
    v_pk_add_f32 v[162:163], v[162:163], 1.0 op_sel_hi:[1,0]
    v_pk_add_f32 v[164:165], v[164:165], 1.0 op_sel_hi:[1,0]
    v_pk_add_f32 v[166:167], v[166:167], 1.0 op_sel_hi:[1,0]
    v_pk_add_f32 v[168:169], v[168:169], 1.0 op_sel_hi:[1,0]
    v_pk_add_f32 v[170:171], v[170:171], 1.0 op_sel_hi:[1,0]
    v_pk_add_f32 v[172:173], v[172:173], 1.0 op_sel_hi:[1,0]
    v_pk_add_f32 v[174:175], v[174:175], 1.0 op_sel_hi:[1,0]
    v_rcp_f32 v160, v160
    v_rcp_f32 v161, v161
    v_rcp_f32 v162, v162
    v_rcp_f32 v163, v163
    v_rcp_f32 v164, v164
    v_rcp_f32 v165, v165
    v_rcp_f32 v166, v166
    v_rcp_f32 v167, v167
    v_rcp_f32 v168, v168
    v_rcp_f32 v169, v169
    v_rcp_f32 v170, v170
    v_rcp_f32 v171, v171
    v_rcp_f32 v172, v172
    v_rcp_f32 v173, v173
    v_rcp_f32 v174, v174
    v_rcp_f32 v175, v175
    v_pk_mul_f32 v[64:65], v[64:65], v[160:161]
    v_pk_mul_f32 v[66:67], v[66:67], v[162:163]
    v_pk_mul_f32 v[68:69], v[68:69], v[164:165]
    v_pk_mul_f32 v[70:71], v[70:71], v[166:167]
    v_pk_mul_f32 v[72:73], v[72:73], v[168:169]
    v_pk_mul_f32 v[74:75], v[74:75], v[170:171]
    v_pk_mul_f32 v[76:77], v[76:77], v[172:173]
    v_pk_mul_f32 v[78:79], v[78:79], v[174:175]
    v_cvt_pk_bf16_f32 v112, v64, v65
    v_cvt_pk_bf16_f32 v113, v66, v67
    v_cvt_pk_bf16_f32 v114, v68, v69
    v_cvt_pk_bf16_f32 v115, v70, v71
    v_cvt_pk_bf16_f32 v116, v72, v73
    v_cvt_pk_bf16_f32 v117, v74, v75
    v_cvt_pk_bf16_f32 v118, v76, v77
    v_cvt_pk_bf16_f32 v119, v78, v79
    buffer_store_dwordx4 v[112:115], v244, s[44:47], s9 offen sc1
    buffer_store_dwordx4 v[116:119], v245, s[44:47], s9 offen sc1
    s_waitcnt vmcnt(6)
    s_barrier
    ds_read_b64_tr_b16 a[64:65], v10 offset:49152
    s_add_u32 m0, s73, 32768
    s_lshl_b32 s14, s94, 18
    ds_read_b64_tr_b16 a[66:67], v10 offset:51200
    ds_read_b64_tr_b16 a[72:73], v10 offset:53248
    ds_read_b64_tr_b16 a[74:75], v10 offset:55296
    ds_read_b64_tr_b16 a[68:69], v11 offset:49152
    buffer_load_dwordx4 v4, s[52:55], s14 offen offset:0 lds
    ds_read_b64_tr_b16 a[70:71], v11 offset:51200
    ds_read_b64_tr_b16 a[76:77], v11 offset:53248
    ds_read_b64_tr_b16 a[78:79], v11 offset:55296
    v_add_u32 v10, 65536, v10
    ds_read_b64_tr_b16 a[80:81], v10 offset:0
    ds_read_b64_tr_b16 a[82:83], v10 offset:2048
    buffer_load_dwordx4 v5, s[52:55], s14 offen offset:1024 lds
    ds_read_b64_tr_b16 a[88:89], v10 offset:4096
    ds_read_b64_tr_b16 a[90:91], v10 offset:6144
    v_add_u32 v11, 65536, v11
    ds_read_b64_tr_b16 a[84:85], v11 offset:0
    ds_read_b64_tr_b16 a[86:87], v11 offset:2048
    ds_read_b64_tr_b16 a[92:93], v11 offset:4096
    buffer_load_dwordx4 v6, s[52:55], s14 offen offset:2048 lds
    ds_read_b64_tr_b16 a[94:95], v11 offset:6144
    v_add_u32 v10, -65536, v10
    ds_read_b64_tr_b16 a[96:97], v10 offset:0
    ds_read_b64_tr_b16 a[98:99], v10 offset:2048
    ds_read_b64_tr_b16 a[104:105], v10 offset:4096
    ds_read_b64_tr_b16 a[106:107], v10 offset:6144
    buffer_load_dwordx4 v7, s[52:55], s14 offen offset:3072 lds
    v_add_u32 v11, -65536, v11
    ds_read_b64_tr_b16 a[100:101], v11 offset:0
    ds_read_b64_tr_b16 a[102:103], v11 offset:2048
    ds_read_b64_tr_b16 a[108:109], v11 offset:4096
    ds_read_b64_tr_b16 a[110:111], v11 offset:6144
    ds_read_b64_tr_b16 a[112:113], v10 offset:16384
    s_add_u32 m0, s73, 81920
    s_lshl_b32 s14, s95, 18
    ds_read_b64_tr_b16 a[114:115], v10 offset:18432
    ds_read_b64_tr_b16 a[120:121], v10 offset:20480
    ds_read_b64_tr_b16 a[122:123], v10 offset:22528
    ds_read_b64_tr_b16 a[116:117], v11 offset:16384
    buffer_load_dwordx4 v4, s[52:55], s14 offen offset:0 lds
    ds_read_b64_tr_b16 a[118:119], v11 offset:18432
    ds_read_b64_tr_b16 a[124:125], v11 offset:20480
    ds_read_b64_tr_b16 a[126:127], v11 offset:22528
    v_add_u32 v10, 131072, v10
    ds_read_b64_tr_b16 a[128:129], v10 offset:0
    ds_read_b64_tr_b16 a[130:131], v10 offset:2048
    buffer_load_dwordx4 v5, s[52:55], s14 offen offset:1024 lds
    ds_read_b64_tr_b16 a[136:137], v10 offset:4096
    ds_read_b64_tr_b16 a[138:139], v10 offset:6144
    v_add_u32 v11, 131072, v11
    ds_read_b64_tr_b16 a[132:133], v11 offset:0
    ds_read_b64_tr_b16 a[134:135], v11 offset:2048
    ds_read_b64_tr_b16 a[140:141], v11 offset:4096
    buffer_load_dwordx4 v6, s[52:55], s14 offen offset:2048 lds
    ds_read_b64_tr_b16 a[142:143], v11 offset:6144
    ds_read_b64_tr_b16 a[144:145], v10 offset:16384
    ds_read_b64_tr_b16 a[146:147], v10 offset:18432
    ds_read_b64_tr_b16 a[152:153], v10 offset:20480
    ds_read_b64_tr_b16 a[154:155], v10 offset:22528
    buffer_load_dwordx4 v7, s[52:55], s14 offen offset:3072 lds
    ds_read_b64_tr_b16 a[148:149], v11 offset:16384
    ds_read_b64_tr_b16 a[150:151], v11 offset:18432
    ds_read_b64_tr_b16 a[156:157], v11 offset:20480
    ds_read_b64_tr_b16 a[158:159], v11 offset:22528
    s_bitcmp1_b32 s3, 1
    s_cselect_b32 s18, s85, s84
    s_mul_i32 s18, s18, 139264
    s_cselect_b32 s19, s87, s86
    s_mul_i32 s19, s19, 139264
    s_cselect_b32 s20, s89, s88
    s_mul_i32 s20, s20, 139264
    s_cselect_b32 s21, s91, s90
    s_mul_i32 s21, s21, 139264
    s_cselect_b32 s22, s93, s92
    s_mul_i32 s22, s22, 139264
    s_cselect_b32 s23, s95, s94
    s_mul_i32 s23, s23, 139264
    s_cselect_b32 s24, s97, s96
    s_mul_i32 s24, s24, 139264
    s_cselect_b32 s25, s99, s98
    s_mul_i32 s25, s25, 139264
    s_cselect_b32 s26, s101, s100
    s_mul_i32 s26, s26, 139264
    s_waitcnt vmcnt(8) lgkmcnt(0)
    s_barrier
    buffer_store_dword v249, v17, s[44:47], 0 offen sc1
    s_add_u32 m0, s73, 0
    s_lshl_b32 s14, s96, 18
    buffer_load_dwordx4 v4, s[52:55], s14 offen offset:0 lds
    buffer_load_dwordx4 v5, s[52:55], s14 offen offset:1024 lds
    buffer_load_dwordx4 v6, s[52:55], s14 offen offset:2048 lds
    buffer_load_dwordx4 v7, s[52:55], s14 offen offset:3072 lds
    s_add_u32 m0, s73, 16384
    s_lshl_b32 s14, s97, 18
    buffer_load_dwordx4 v4, s[52:55], s14 offen offset:0 lds
    buffer_load_dwordx4 v5, s[52:55], s14 offen offset:1024 lds
    buffer_load_dwordx4 v6, s[52:55], s14 offen offset:2048 lds
    buffer_load_dwordx4 v7, s[52:55], s14 offen offset:3072 lds
    v_mov_b32 v16, 0
    buffer_atomic_add v16, v15, s[44:47], 0 offen sc0 sc1
    s_add_u32 m0, s73, 49152
    s_lshl_b32 s14, s98, 18
    buffer_load_dwordx4 v4, s[52:55], s14 offen offset:0 lds
    buffer_load_dwordx4 v5, s[52:55], s14 offen offset:1024 lds
    buffer_load_dwordx4 v6, s[52:55], s14 offen offset:2048 lds
    buffer_load_dwordx4 v7, s[52:55], s14 offen offset:3072 lds
    s_add_u32 m0, s73, 65536
    s_lshl_b32 s14, s99, 18
    buffer_load_dwordx4 v4, s[52:55], s14 offen offset:0 lds
    buffer_load_dwordx4 v5, s[52:55], s14 offen offset:1024 lds
    buffer_load_dwordx4 v6, s[52:55], s14 offen offset:2048 lds
    buffer_load_dwordx4 v7, s[52:55], s14 offen offset:3072 lds
L_DG:
    s_waitcnt vmcnt(8)
    v_cmp_ne_u32 vcc, v13, v16
    s_cbranch_vccnz L_rs_p2G
L_ok_p2G:
    s_barrier
    s_add_u32 m0, s73, 97536
    s_nop 0
    buffer_load_dwordx4 v23, s[44:47], s18 offen offset:768 sc1 lds
    s_add_u32 m0, s73, 99328
    s_nop 0
    buffer_load_dwordx4 v20, s[44:47], s18 offen offset:0 sc1 lds
    s_add_u32 m0, s73, 99840
    s_nop 0
    buffer_load_dwordx4 v20, s[44:47], s18 offen offset:512 sc1 lds
    s_add_u32 m0, s73, 100608
    s_nop 0
    buffer_load_dwordx4 v23, s[44:47], s19 offen offset:768 sc1 lds
    s_add_u32 m0, s73, 114688
    s_nop 0
    buffer_load_dwordx4 v20, s[44:47], s19 offen offset:0 sc1 lds
    s_add_u32 m0, s73, 115200
    s_nop 0
    buffer_load_dwordx4 v20, s[44:47], s19 offen offset:512 sc1 lds
    s_add_u32 m0, s73, 115968
    s_nop 0
    buffer_load_dwordx4 v23, s[44:47], s20 offen offset:768 sc1 lds
    s_add_u32 m0, s73, 117760
    s_nop 0
    buffer_load_dwordx4 v20, s[44:47], s20 offen offset:0 sc1 lds
    v_mov_b32 v195, s68
    v_mov_b32 v199, s68
    v_mov_b32 v202, s68
    v_mov_b32 v203, s68
    s_waitcnt vmcnt(4)
    s_barrier
    ds_read_b128 v[104:107], v14 offset:0
    ds_read_b128 v[108:111], v14 offset:4096
    ds_read_b128 v[112:115], v14 offset:8192
    ds_read_b128 v[116:119], v14 offset:12288
    s_waitcnt lgkmcnt(2)
    v_mfma_f32_16x16x32_bf16 v[32:35], v[104:107], a[0:3], 0
    s_add_u32 m0, s73, 130560
    v_mfma_f32_16x16x32_bf16 v[32:35], v[108:111], a[8:11], v[32:35]
    buffer_load_dwordx4 v20, s[44:47], s20 offen offset:512 sc1 lds
    s_waitcnt lgkmcnt(0)
    v_mfma_f32_16x16x32_bf16 v[32:35], v[112:115], a[16:19], v[32:35]
    ds_read_b128 v[120:123], v14 offset:1024
    v_mfma_f32_16x16x32_bf16 v[32:35], v[116:119], a[24:27], v[32:35]
    ds_read_b128 v[124:127], v14 offset:5120
    v_mfma_f32_16x16x32_bf16 v[36:39], v[116:119], a[28:31], 0
    ds_read_b128 v[128:131], v14 offset:9216
    v_mfma_f32_16x16x32_bf16 v[36:39], v[112:115], a[20:23], v[36:39]
    ds_read_b128 v[132:135], v14 offset:13312
    v_mfma_f32_16x16x32_bf16 v[36:39], v[108:111], a[12:15], v[36:39]
    s_add_u32 m0, s73, 131328
    v_mfma_f32_16x16x32_bf16 v[36:39], v[104:107], a[4:7], v[36:39]
    buffer_load_dwordx4 v23, s[44:47], s21 offen offset:768 sc1 lds
    s_waitcnt lgkmcnt(2)
    v_mfma_f32_16x16x32_bf16 v[44:47], v[120:123], a[4:7], 0
    s_add_u32 m0, s73, 133120
    v_mfma_f32_16x16x32_bf16 v[44:47], v[124:127], a[12:15], v[44:47]
    buffer_load_dwordx4 v20, s[44:47], s21 offen offset:0 sc1 lds
    s_waitcnt lgkmcnt(0)
    v_mfma_f32_16x16x32_bf16 v[44:47], v[128:131], a[20:23], v[44:47]
    ds_read_b128 v[104:107], v14 offset:2048
    v_mfma_f32_16x16x32_bf16 v[44:47], v[132:135], a[28:31], v[44:47]
    ds_read_b128 v[108:111], v14 offset:6144
    v_mfma_f32_16x16x32_bf16 v[40:43], v[132:135], a[24:27], 0
    ds_read_b128 v[112:115], v14 offset:10240
    v_mfma_f32_16x16x32_bf16 v[40:43], v[128:131], a[16:19], v[40:43]
    ds_read_b128 v[116:119], v14 offset:14336
    v_mfma_f32_16x16x32_bf16 v[40:43], v[124:127], a[8:11], v[40:43]
    s_add_u32 m0, s73, 133632
    v_mfma_f32_16x16x32_bf16 v[40:43], v[120:123], a[0:3], v[40:43]
    buffer_load_dwordx4 v20, s[44:47], s21 offen offset:512 sc1 lds
    s_waitcnt lgkmcnt(2)
    v_mfma_f32_16x16x32_bf16 v[48:51], v[104:107], a[0:3], 0
    s_add_u32 m0, s73, 146688
    v_mfma_f32_16x16x32_bf16 v[48:51], v[108:111], a[8:11], v[48:51]
    buffer_load_dwordx4 v23, s[44:47], s22 offen offset:768 sc1 lds
    s_waitcnt lgkmcnt(0)
    v_mfma_f32_16x16x32_bf16 v[48:51], v[112:115], a[16:19], v[48:51]
    ds_read_b128 v[120:123], v14 offset:3072
    v_mfma_f32_16x16x32_bf16 v[48:51], v[116:119], a[24:27], v[48:51]
    ds_read_b128 v[124:127], v14 offset:7168
    v_mfma_f32_16x16x32_bf16 v[52:55], v[116:119], a[28:31], 0
    ds_read_b128 v[128:131], v14 offset:11264
    v_mfma_f32_16x16x32_bf16 v[52:55], v[112:115], a[20:23], v[52:55]
    ds_read_b128 v[132:135], v14 offset:15360
    v_mfma_f32_16x16x32_bf16 v[52:55], v[108:111], a[12:15], v[52:55]
    s_add_u32 m0, s73, 148480
    v_mfma_f32_16x16x32_bf16 v[52:55], v[104:107], a[4:7], v[52:55]
    buffer_load_dwordx4 v20, s[44:47], s22 offen offset:0 sc1 lds
    s_waitcnt lgkmcnt(2)
    v_mfma_f32_16x16x32_bf16 v[36:39], v[120:123], a[36:39], v[36:39]
    s_add_u32 m0, s73, 148992
    v_mfma_f32_16x16x32_bf16 v[36:39], v[124:127], a[44:47], v[36:39]
    buffer_load_dwordx4 v20, s[44:47], s22 offen offset:512 sc1 lds
    s_waitcnt lgkmcnt(0)
    v_mfma_f32_16x16x32_bf16 v[36:39], v[128:131], a[52:55], v[36:39]
    s_waitcnt vmcnt(7)
    s_barrier
    v_mfma_f32_16x16x32_bf16 v[36:39], v[132:135], a[60:63], v[36:39]
    ds_read_b128 v[104:107], v14 offset:16384
    v_add_u32 v10, -131072, v10
    v_mfma_f32_16x16x32_bf16 v[32:35], v[132:135], a[56:59], v[32:35]
    ds_read_b128 v[108:111], v14 offset:20480
    v_mfma_f32_16x16x32_bf16 v[32:35], v[128:131], a[48:51], v[32:35]
    ds_read_b128 v[112:115], v14 offset:24576
    ds_read_b64_tr_b16 a[160:161], v10 offset:32768
    v_mfma_f32_16x16x32_bf16 v[32:35], v[124:127], a[40:43], v[32:35]
    ds_read_b128 v[116:119], v14 offset:28672
    s_add_u32 m0, s73, 149760
    v_mfma_f32_16x16x32_bf16 v[32:35], v[120:123], a[32:35], v[32:35]
    buffer_load_dwordx4 v23, s[44:47], s23 offen offset:768 sc1 lds
    ds_read_b64_tr_b16 a[162:163], v10 offset:34816
    s_waitcnt lgkmcnt(4)
    v_mfma_f32_16x16x32_bf16 v[40:43], v[104:107], a[32:35], v[40:43]
    s_add_u32 m0, s73, 98304
    ds_read_b64_tr_b16 a[168:169], v10 offset:36864
    v_mfma_f32_16x16x32_bf16 v[40:43], v[108:111], a[40:43], v[40:43]
    buffer_load_dwordx4 v20, s[44:47], s23 offen offset:0 sc1 lds
    ds_read_b64_tr_b16 a[170:171], v10 offset:38912
    s_waitcnt lgkmcnt(3)
    v_mfma_f32_16x16x32_bf16 v[40:43], v[112:115], a[48:51], v[40:43]
    ds_read_b128 v[120:123], v14 offset:17408
    v_mfma_f32_16x16x32_bf16 v[40:43], v[116:119], a[56:59], v[40:43]
    ds_read_b128 v[124:127], v14 offset:21504
    v_add_u32 v11, -131072, v11
    v_mfma_f32_16x16x32_bf16 v[44:47], v[116:119], a[60:63], v[44:47]
    ds_read_b128 v[128:131], v14 offset:25600
    v_mfma_f32_16x16x32_bf16 v[44:47], v[112:115], a[52:55], v[44:47]
    ds_read_b128 v[132:135], v14 offset:29696
    v_mfma_f32_16x16x32_bf16 v[44:47], v[108:111], a[44:47], v[44:47]
    s_add_u32 m0, s73, 98816
    ds_read_b64_tr_b16 a[164:165], v11 offset:32768
    v_mfma_f32_16x16x32_bf16 v[44:47], v[104:107], a[36:39], v[44:47]
    buffer_load_dwordx4 v20, s[44:47], s23 offen offset:512 sc1 lds
    ds_read_b64_tr_b16 a[166:167], v11 offset:34816
    s_waitcnt lgkmcnt(4)
    v_mfma_f32_16x16x32_bf16 v[52:55], v[120:123], a[36:39], v[52:55]
    s_add_u32 m0, s73, 99584
    ds_read_b64_tr_b16 a[172:173], v11 offset:36864
    v_mfma_f32_16x16x32_bf16 v[52:55], v[124:127], a[44:47], v[52:55]
    buffer_load_dwordx4 v23, s[44:47], s24 offen offset:768 sc1 lds
    ds_read_b64_tr_b16 a[174:175], v11 offset:38912
    s_waitcnt lgkmcnt(4)
    v_mfma_f32_16x16x32_bf16 v[52:55], v[128:131], a[52:55], v[52:55]
    ds_read_b128 v[104:107], v14 offset:18432
    v_mfma_f32_16x16x32_bf16 v[52:55], v[132:135], a[60:63], v[52:55]
    ds_read_b128 v[108:111], v14 offset:22528
    v_add_u32 v10, 65536, v10
    v_mfma_f32_16x16x32_bf16 v[48:51], v[132:135], a[56:59], v[48:51]
    ds_read_b128 v[112:115], v14 offset:26624
    v_mfma_f32_16x16x32_bf16 v[48:51], v[128:131], a[48:51], v[48:51]
    ds_read_b128 v[116:119], v14 offset:30720
    v_mfma_f32_16x16x32_bf16 v[48:51], v[124:127], a[40:43], v[48:51]
    s_add_u32 m0, s73, 101376
    ds_read_b64_tr_b16 a[176:177], v10 offset:16384
    v_mfma_f32_16x16x32_bf16 v[48:51], v[120:123], a[32:35], v[48:51]
    buffer_load_dwordx4 v20, s[44:47], s24 offen offset:0 sc1 lds
    ds_read_b64_tr_b16 a[178:179], v10 offset:18432
    s_waitcnt lgkmcnt(4)
    v_mfma_f32_16x16x32_bf16 v[32:35], v[104:107], a[64:67], v[32:35]
    ds_read_b64_tr_b16 a[184:185], v10 offset:20480
    v_mfma_f32_16x16x32_bf16 v[32:35], v[108:111], a[72:75], v[32:35]
    ds_read_b64_tr_b16 a[186:187], v10 offset:22528
    s_waitcnt lgkmcnt(4)
    v_mfma_f32_16x16x32_bf16 v[32:35], v[112:115], a[80:83], v[32:35]
    ds_read_b128 v[120:123], v14 offset:19456
    v_mfma_f32_16x16x32_bf16 v[32:35], v[116:119], a[88:91], v[32:35]
    ds_read_b128 v[124:127], v14 offset:23552
    v_add_u32 v11, 65536, v11
    v_mfma_f32_16x16x32_bf16 v[36:39], v[116:119], a[92:95], v[36:39]
    ds_read_b128 v[128:131], v14 offset:27648
    v_mfma_f32_16x16x32_bf16 v[36:39], v[112:115], a[84:87], v[36:39]
    ds_read_b128 v[132:135], v14 offset:31744
    v_mfma_f32_16x16x32_bf16 v[36:39], v[108:111], a[76:79], v[36:39]
    ds_read_b64_tr_b16 a[180:181], v11 offset:16384
    v_mfma_f32_16x16x32_bf16 v[36:39], v[104:107], a[68:71], v[36:39]
    ds_read_b64_tr_b16 a[182:183], v11 offset:18432
    s_waitcnt lgkmcnt(4)
    v_mfma_f32_16x16x32_bf16 v[44:47], v[120:123], a[68:71], v[44:47]
    ds_read_b64_tr_b16 a[188:189], v11 offset:20480
    v_mfma_f32_16x16x32_bf16 v[44:47], v[124:127], a[76:79], v[44:47]
    ds_read_b64_tr_b16 a[190:191], v11 offset:22528
    s_waitcnt lgkmcnt(4)
    v_mfma_f32_16x16x32_bf16 v[44:47], v[128:131], a[84:87], v[44:47]
    s_waitcnt vmcnt(8) lgkmcnt(0)
    s_barrier
    v_mfma_f32_16x16x32_bf16 v[44:47], v[132:135], a[92:95], v[44:47]
    ds_read_b128 v[104:107], v14 offset:32768
    s_lshl_b32 s14, s100, 18
    s_add_u32 m0, s73, 32768
    v_add_u32 v10, -65536, v10
    v_mfma_f32_16x16x32_bf16 v[40:43], v[132:135], a[88:91], v[40:43]
    ds_read_b128 v[108:111], v14 offset:36864
    buffer_load_dwordx4 v4, s[52:55], s14 offen offset:0 lds
    v_mfma_f32_16x16x32_bf16 v[40:43], v[128:131], a[80:83], v[40:43]
    ds_read_b128 v[112:115], v14 offset:40960
    ds_read_b64_tr_b16 a[192:193], v10 offset:0
    v_mfma_f32_16x16x32_bf16 v[40:43], v[124:127], a[72:75], v[40:43]
    ds_read_b128 v[116:119], v14 offset:45056
    v_mfma_f32_16x16x32_bf16 v[40:43], v[120:123], a[64:67], v[40:43]
    ds_read_b64_tr_b16 a[194:195], v10 offset:2048
    s_waitcnt lgkmcnt(4)
    v_mfma_f32_16x16x32_bf16 v[48:51], v[104:107], a[64:67], v[48:51]
    s_add_u32 m0, s73, 114176
    ds_read_b64_tr_b16 a[200:201], v10 offset:4096
    v_mfma_f32_16x16x32_bf16 v[48:51], v[108:111], a[72:75], v[48:51]
    buffer_load_dwordx4 v20, s[44:47], s24 offen offset:512 sc1 lds
    ds_read_b64_tr_b16 a[202:203], v10 offset:6144
    s_waitcnt lgkmcnt(3)
    v_mfma_f32_16x16x32_bf16 v[48:51], v[112:115], a[80:83], v[48:51]
    ds_read_b128 v[120:123], v14 offset:33792
    s_add_u32 m0, s73, 32768
    v_lshrrev_b32 v30, 2, v26
    v_mfma_f32_16x16x32_bf16 v[48:51], v[116:119], a[88:91], v[48:51]
    ds_read_b128 v[124:127], v14 offset:37888
    buffer_load_dwordx4 v5, s[52:55], s14 offen offset:1024 lds
    v_mfma_f32_16x16x32_bf16 v[52:55], v[116:119], a[92:95], v[52:55]
    ds_read_b128 v[128:131], v14 offset:41984
    v_add_u32 v11, -65536, v11
    v_mfma_f32_16x16x32_bf16 v[52:55], v[112:115], a[84:87], v[52:55]
    ds_read_b128 v[132:135], v14 offset:46080
    v_mfma_f32_16x16x32_bf16 v[52:55], v[108:111], a[76:79], v[52:55]
    s_add_u32 m0, s73, 114944
    ds_read_b64_tr_b16 a[196:197], v11 offset:0
    v_mfma_f32_16x16x32_bf16 v[52:55], v[104:107], a[68:71], v[52:55]
    buffer_load_dwordx4 v23, s[44:47], s25 offen offset:768 sc1 lds
    ds_read_b64_tr_b16 a[198:199], v11 offset:2048
    s_waitcnt lgkmcnt(4)
    v_mfma_f32_16x16x32_bf16 v[36:39], v[120:123], a[100:103], v[36:39]
    s_add_u32 m0, s73, 116736
    ds_read_b64_tr_b16 a[204:205], v11 offset:4096
    v_mfma_f32_16x16x32_bf16 v[36:39], v[124:127], a[108:111], v[36:39]
    buffer_load_dwordx4 v20, s[44:47], s25 offen offset:0 sc1 lds
    ds_read_b64_tr_b16 a[206:207], v11 offset:6144
    s_waitcnt lgkmcnt(4)
    v_mfma_f32_16x16x32_bf16 v[36:39], v[128:131], a[116:119], v[36:39]
    ds_read_b128 v[104:107], v14 offset:34816
    s_add_u32 m0, s73, 32768
    v_lshrrev_b32 v31, 2, v18
    v_mfma_f32_16x16x32_bf16 v[36:39], v[132:135], a[124:127], v[36:39]
    ds_read_b128 v[108:111], v14 offset:38912
    buffer_load_dwordx4 v6, s[52:55], s14 offen offset:2048 lds
    v_mfma_f32_16x16x32_bf16 v[32:35], v[132:135], a[120:123], v[32:35]
    ds_read_b128 v[112:115], v14 offset:43008
    v_mfma_f32_16x16x32_bf16 v[32:35], v[128:131], a[112:115], v[32:35]
    ds_read_b128 v[116:119], v14 offset:47104
    v_mfma_f32_16x16x32_bf16 v[32:35], v[124:127], a[104:107], v[32:35]
    s_add_u32 m0, s73, 117248
    ds_read_b64_tr_b16 a[208:209], v10 offset:16384
    v_mfma_f32_16x16x32_bf16 v[32:35], v[120:123], a[96:99], v[32:35]
    buffer_load_dwordx4 v20, s[44:47], s25 offen offset:512 sc1 lds
    ds_read_b64_tr_b16 a[210:211], v10 offset:18432
    s_waitcnt lgkmcnt(4)
    v_mfma_f32_16x16x32_bf16 v[40:43], v[104:107], a[96:99], v[40:43]
    ds_read_b64_tr_b16 a[216:217], v10 offset:20480
    buffer_load_ushort v102, v30, s[60:63], 0 offen offset:0
    s_add_u32 m0, s73, 32768
    v_mfma_f32_16x16x32_bf16 v[40:43], v[108:111], a[104:107], v[40:43]
    ds_read_b64_tr_b16 a[218:219], v10 offset:22528
    buffer_load_dwordx4 v7, s[52:55], s14 offen offset:3072 lds
    s_waitcnt lgkmcnt(4)
    v_mfma_f32_16x16x32_bf16 v[40:43], v[112:115], a[112:115], v[40:43]
    ds_read_b128 v[120:123], v14 offset:35840
    v_mfma_f32_16x16x32_bf16 v[40:43], v[116:119], a[120:123], v[40:43]
    ds_read_b128 v[124:127], v14 offset:39936
    v_mfma_f32_16x16x32_bf16 v[44:47], v[116:119], a[124:127], v[44:47]
    ds_read_b128 v[128:131], v14 offset:44032
    v_mfma_f32_16x16x32_bf16 v[44:47], v[112:115], a[116:119], v[44:47]
    ds_read_b128 v[132:135], v14 offset:48128
    v_mfma_f32_16x16x32_bf16 v[44:47], v[108:111], a[108:111], v[44:47]
    ds_read_b64_tr_b16 a[212:213], v11 offset:16384
    buffer_load_ushort v103, v30, s[60:63], 0 offen offset:32
    v_mfma_f32_16x16x32_bf16 v[44:47], v[104:107], a[100:103], v[44:47]
    ds_read_b64_tr_b16 a[214:215], v11 offset:18432
    s_waitcnt lgkmcnt(4)
    v_mfma_f32_16x16x32_bf16 v[52:55], v[120:123], a[100:103], v[52:55]
    ds_read_b64_tr_b16 a[220:221], v11 offset:20480
    v_mfma_f32_16x16x32_bf16 v[52:55], v[124:127], a[108:111], v[52:55]
    ds_read_b64_tr_b16 a[222:223], v11 offset:22528
    s_waitcnt lgkmcnt(4)
    v_mfma_f32_16x16x32_bf16 v[52:55], v[128:131], a[116:119], v[52:55]
    s_waitcnt vmcnt(14) lgkmcnt(0)
    s_barrier
    v_mfma_f32_16x16x32_bf16 v[52:55], v[132:135], a[124:127], v[52:55]
    ds_read_b128 v[104:107], v14 offset:49152
    s_lshl_b32 s14, s101, 18
    ds_read_b64_tr_b16 a[224:225], v10 offset:49152
    s_add_u32 m0, s73, 81920
    v_mfma_f32_16x16x32_bf16 v[48:51], v[132:135], a[120:123], v[48:51]
    ds_read_b128 v[108:111], v14 offset:53248
    buffer_load_dwordx4 v4, s[52:55], s14 offen offset:0 lds
    v_mfma_f32_16x16x32_bf16 v[48:51], v[128:131], a[112:115], v[48:51]
    ds_read_b128 v[112:115], v14 offset:57344
    buffer_load_ushort v27, v31, s[60:63], 0 offen offset:0
    v_mfma_f32_16x16x32_bf16 v[48:51], v[124:127], a[104:107], v[48:51]
    ds_read_b128 v[116:119], v14 offset:61440
    v_mfma_f32_16x16x32_bf16 v[48:51], v[120:123], a[96:99], v[48:51]
    ds_read_b64_tr_b16 a[226:227], v10 offset:51200
    s_waitcnt lgkmcnt(3)
    v_mfma_f32_16x16x32_bf16 v[32:35], v[104:107], a[128:131], v[32:35]
    s_add_u32 m0, s73, 130304
    ds_read_b64_tr_b16 a[232:233], v10 offset:53248
    v_mfma_f32_16x16x32_bf16 v[32:35], v[108:111], a[136:139], v[32:35]
    buffer_load_dwordx4 v23, s[44:47], s26 offen offset:768 sc1 lds
    ds_read_b64_tr_b16 a[234:235], v10 offset:55296
    s_waitcnt lgkmcnt(3)
    v_mfma_f32_16x16x32_bf16 v[32:35], v[112:115], a[144:147], v[32:35]
    ds_read_b128 v[120:123], v14 offset:50176
    s_add_u32 m0, s73, 81920
    v_mfma_f32_16x16x32_bf16 v[32:35], v[116:119], a[152:155], v[32:35]
    ds_read_b128 v[124:127], v14 offset:54272
    buffer_load_dwordx4 v5, s[52:55], s14 offen offset:1024 lds
    v_mfma_f32_16x16x32_bf16 v[36:39], v[116:119], a[156:159], v[36:39]
    ds_read_b128 v[128:131], v14 offset:58368
    v_mfma_f32_16x16x32_bf16 v[36:39], v[112:115], a[148:151], v[36:39]
    ds_read_b128 v[132:135], v14 offset:62464
    v_mfma_f32_16x16x32_bf16 v[36:39], v[108:111], a[140:143], v[36:39]
    s_add_u32 m0, s73, 132096
    ds_read_b64_tr_b16 a[228:229], v11 offset:49152
    v_mfma_f32_16x16x32_bf16 v[36:39], v[104:107], a[132:135], v[36:39]
    buffer_load_dwordx4 v20, s[44:47], s26 offen offset:0 sc1 lds
    ds_read_b64_tr_b16 a[230:231], v11 offset:51200
    s_waitcnt lgkmcnt(4)
    v_mfma_f32_16x16x32_bf16 v[44:47], v[120:123], a[132:135], v[44:47]
    ds_read_b64_tr_b16 a[236:237], v11 offset:53248
    buffer_load_dwordx4 v[88:91], v252, s[56:59], 0 offen
    s_add_u32 m0, s73, 132608
    v_mfma_f32_16x16x32_bf16 v[44:47], v[124:127], a[140:143], v[44:47]
    buffer_load_dwordx4 v20, s[44:47], s26 offen offset:512 sc1 lds
    ds_read_b64_tr_b16 a[238:239], v11 offset:55296
    s_waitcnt lgkmcnt(4)
    v_mfma_f32_16x16x32_bf16 v[44:47], v[128:131], a[148:151], v[44:47]
    ds_read_b128 v[104:107], v14 offset:51200
    s_add_u32 m0, s73, 81920
    v_add_u32 v10, 65536, v10
    v_mfma_f32_16x16x32_bf16 v[44:47], v[132:135], a[156:159], v[44:47]
    ds_read_b128 v[108:111], v14 offset:55296
    buffer_load_dwordx4 v6, s[52:55], s14 offen offset:2048 lds
    v_mfma_f32_16x16x32_bf16 v[40:43], v[132:135], a[152:155], v[40:43]
    ds_read_b128 v[112:115], v14 offset:59392
    v_mfma_f32_16x16x32_bf16 v[40:43], v[128:131], a[144:147], v[40:43]
    ds_read_b128 v[116:119], v14 offset:63488
    v_mfma_f32_16x16x32_bf16 v[40:43], v[124:127], a[136:139], v[40:43]
    s_add_u32 m0, s73, 134144
    ds_read_b64_tr_b16 a[240:241], v10 offset:0
    v_mfma_f32_16x16x32_bf16 v[40:43], v[120:123], a[128:131], v[40:43]
    buffer_load_dwordx4 v21, s[44:47], s18 offen offset:0 sc1 lds
    ds_read_b64_tr_b16 a[242:243], v10 offset:2048
    s_waitcnt lgkmcnt(4)
    v_mfma_f32_16x16x32_bf16 v[48:51], v[104:107], a[128:131], v[48:51]
    ds_read_b64_tr_b16 a[248:249], v10 offset:4096
    s_add_u32 m0, s73, 81920
    v_mfma_f32_16x16x32_bf16 v[48:51], v[108:111], a[136:139], v[48:51]
    ds_read_b64_tr_b16 a[250:251], v10 offset:6144
    buffer_load_dwordx4 v7, s[52:55], s14 offen offset:3072 lds
    s_waitcnt lgkmcnt(4)
    v_mfma_f32_16x16x32_bf16 v[48:51], v[112:115], a[144:147], v[48:51]
    ds_read_b128 v[120:123], v14 offset:52224
    v_add_u32 v11, 65536, v11
    v_mfma_f32_16x16x32_bf16 v[48:51], v[116:119], a[152:155], v[48:51]
    ds_read_b128 v[124:127], v14 offset:56320
    v_mfma_f32_16x16x32_bf16 v[52:55], v[116:119], a[156:159], v[52:55]
    ds_read_b128 v[128:131], v14 offset:60416
    v_mfma_f32_16x16x32_bf16 v[52:55], v[112:115], a[148:151], v[52:55]
    ds_read_b128 v[132:135], v14 offset:64512
    v_mfma_f32_16x16x32_bf16 v[52:55], v[108:111], a[140:143], v[52:55]
    ds_read_b64_tr_b16 a[244:245], v11 offset:0
    v_mfma_f32_16x16x32_bf16 v[52:55], v[104:107], a[132:135], v[52:55]
    ds_read_b64_tr_b16 a[246:247], v11 offset:2048
    s_waitcnt lgkmcnt(4)
    v_mfma_f32_16x16x32_bf16 v[36:39], v[120:123], a[164:167], v[36:39]
    ds_read_b64_tr_b16 a[252:253], v11 offset:4096
    buffer_load_dwordx4 v[92:95], v252, s[56:59], s40 offen
    v_mfma_f32_16x16x32_bf16 v[36:39], v[124:127], a[172:175], v[36:39]
    ds_read_b64_tr_b16 a[254:255], v11 offset:6144
    s_waitcnt lgkmcnt(4)
    v_mfma_f32_16x16x32_bf16 v[36:39], v[128:131], a[180:183], v[36:39]
    s_waitcnt vmcnt(12) lgkmcnt(0)
    s_barrier
    v_mfma_f32_16x16x32_bf16 v[36:39], v[132:135], a[188:191], v[36:39]
    ds_read_b128 v[104:107], v14 offset:0
    v_mfma_f32_16x16x32_bf16 v[32:35], v[132:135], a[184:187], v[32:35]
    ds_read_b128 v[108:111], v14 offset:4096
    v_add_u32 v10, -65536, v10
L_pl_G_6:
    s_cbranch_execz L_wret
    v_mfma_f32_16x16x32_bf16 v[32:35], v[128:131], a[176:179], v[32:35]
    ds_read_b128 v[112:115], v14 offset:8192
    v_mfma_f32_16x16x32_bf16 v[32:35], v[124:127], a[168:171], v[32:35]
    ds_read_b128 v[116:119], v14 offset:12288
    v_mfma_f32_16x16x32_bf16 v[32:35], v[120:123], a[160:163], v[32:35]
    ds_read_b64_tr_b16 v[220:221], v10 offset:32768
    s_waitcnt lgkmcnt(3)
    v_mfma_f32_16x16x32_bf16 v[40:43], v[104:107], a[160:163], v[40:43]
    s_add_u32 m0, s73, 146944
    v_mfma_f32_16x16x32_bf16 v[40:43], v[108:111], a[168:171], v[40:43]
    buffer_load_dwordx4 v21, s[44:47], s18 offen offset:512 sc1 lds
    ds_read_b64_tr_b16 v[222:223], v10 offset:34816
    s_waitcnt lgkmcnt(2)
    v_mfma_f32_16x16x32_bf16 v[40:43], v[112:115], a[176:179], v[40:43]
    ds_read_b128 v[120:123], v14 offset:1024
    v_mfma_f32_16x16x32_bf16 v[40:43], v[116:119], a[184:187], v[40:43]
    ds_read_b128 v[124:127], v14 offset:5120
    v_mfma_f32_16x16x32_bf16 v[44:47], v[116:119], a[188:191], v[44:47]
    ds_read_b128 v[128:131], v14 offset:9216
    v_mfma_f32_16x16x32_bf16 v[44:47], v[112:115], a[180:183], v[44:47]
    ds_read_b128 v[132:135], v14 offset:13312
    v_mfma_f32_16x16x32_bf16 v[44:47], v[108:111], a[172:175], v[44:47]
    s_add_u32 m0, s73, 148480
    ds_read_b64_tr_b16 v[228:229], v10 offset:36864
    v_mfma_f32_16x16x32_bf16 v[44:47], v[104:107], a[164:167], v[44:47]
    buffer_load_dwordx4 v21, s[44:47], s19 offen offset:0 sc1 lds
    s_waitcnt lgkmcnt(3)
    v_mfma_f32_16x16x32_bf16 v[52:55], v[120:123], a[164:167], v[52:55]
    ds_read_b64_tr_b16 v[230:231], v10 offset:38912
    buffer_load_dwordx2 v[142:143], v253, s[56:59], 0 offen
    s_add_u32 m0, s73, 148992
    v_mfma_f32_16x16x32_bf16 v[52:55], v[124:127], a[172:175], v[52:55]
    buffer_load_dwordx4 v21, s[44:47], s19 offen offset:512 sc1 lds
    s_waitcnt lgkmcnt(2)
    v_mfma_f32_16x16x32_bf16 v[52:55], v[128:131], a[180:183], v[52:55]
    ds_read_b128 v[104:107], v14 offset:2048
    v_mfma_f32_16x16x32_bf16 v[52:55], v[132:135], a[188:191], v[52:55]
    ds_read_b128 v[108:111], v14 offset:6144
    v_mfma_f32_16x16x32_bf16 v[48:51], v[132:135], a[184:187], v[48:51]
    ds_read_b128 v[112:115], v14 offset:10240
    v_add_u32 v11, -65536, v11
    v_mfma_f32_16x16x32_bf16 v[48:51], v[128:131], a[176:179], v[48:51]
    ds_read_b128 v[116:119], v14 offset:14336
    v_mfma_f32_16x16x32_bf16 v[48:51], v[124:127], a[168:171], v[48:51]
    s_add_u32 m0, s73, 150528
    v_mfma_f32_16x16x32_bf16 v[48:51], v[120:123], a[160:163], v[48:51]
    buffer_load_dwordx4 v21, s[44:47], s20 offen offset:0 sc1 lds
    ds_read_b64_tr_b16 v[224:225], v11 offset:32768
    s_waitcnt lgkmcnt(3)
    v_mfma_f32_16x16x32_bf16 v[32:35], v[104:107], a[192:195], v[32:35]
    v_mfma_f32_16x16x32_bf16 v[32:35], v[108:111], a[200:203], v[32:35]
    ds_read_b64_tr_b16 v[226:227], v11 offset:34816
    s_waitcnt vmcnt(14)
    s_waitcnt lgkmcnt(2)
    v_mfma_f32_16x16x32_bf16 v[32:35], v[112:115], a[208:211], v[32:35]
    ds_read_b128 v[120:123], v14 offset:3072
    v_mfma_f32_16x16x32_bf16 v[32:35], v[116:119], a[216:219], v[32:35]
    ds_read_b128 v[124:127], v14 offset:7168
    v_mfma_f32_16x16x32_bf16 v[36:39], v[116:119], a[220:223], v[36:39]
    ds_read_b128 v[128:131], v14 offset:11264
    v_lshlrev_b32 v72, 16, v102
    v_mfma_f32_16x16x32_bf16 v[36:39], v[112:115], a[212:215], v[36:39]
    ds_read_b128 v[132:135], v14 offset:15360
    v_mfma_f32_16x16x32_bf16 v[36:39], v[108:111], a[204:207], v[36:39]
    ds_read_b64_tr_b16 v[232:233], v11 offset:36864
    v_lshlrev_b32 v73, 16, v102
    v_mfma_f32_16x16x32_bf16 v[36:39], v[104:107], a[196:199], v[36:39]
    s_waitcnt lgkmcnt(3)
    v_mfma_f32_16x16x32_bf16 v[44:47], v[120:123], a[196:199], v[44:47]
    ds_read_b64_tr_b16 v[234:235], v11 offset:38912
    buffer_load_dwordx2 v[96:97], v26, s[44:47], s42 offen offset:0 sc1
    v_mfma_f32_16x16x32_bf16 v[44:47], v[124:127], a[204:207], v[44:47]
    v_lshlrev_b32 v74, 16, v102
    s_waitcnt lgkmcnt(2)
    v_mfma_f32_16x16x32_bf16 v[44:47], v[128:131], a[212:215], v[44:47]
    s_waitcnt vmcnt(7) lgkmcnt(0)
    s_barrier
    v_mfma_f32_16x16x32_bf16 v[44:47], v[132:135], a[220:223], v[44:47]
    ds_read_b128 v[104:107], v14 offset:16384
    v_lshlrev_b32 v75, 16, v102
    v_mfma_f32_16x16x32_bf16 v[40:43], v[132:135], a[216:219], v[40:43]
    ds_read_b128 v[108:111], v14 offset:20480
    v_add_u32 v10, 65536, v10
    v_mfma_f32_16x16x32_bf16 v[40:43], v[128:131], a[208:211], v[40:43]
    ds_read_b128 v[112:115], v14 offset:24576
    v_mfma_f32_16x16x32_bf16 v[40:43], v[124:127], a[200:203], v[40:43]
    ds_read_b128 v[116:119], v14 offset:28672
    v_lshlrev_b32 v76, 16, v103
    v_mfma_f32_16x16x32_bf16 v[40:43], v[120:123], a[192:195], v[40:43]
    ds_read_b64_tr_b16 v[236:237], v10 offset:16384
    s_waitcnt lgkmcnt(3)
    v_mfma_f32_16x16x32_bf16 v[48:51], v[104:107], a[192:195], v[48:51]
    s_add_u32 m0, s73, 97792
    v_lshlrev_b32 v77, 16, v103
    v_mfma_f32_16x16x32_bf16 v[48:51], v[108:111], a[200:203], v[48:51]
    buffer_load_dwordx4 v21, s[44:47], s20 offen offset:512 sc1 lds
    ds_read_b64_tr_b16 v[238:239], v10 offset:18432
    s_waitcnt lgkmcnt(2)
    v_mfma_f32_16x16x32_bf16 v[48:51], v[112:115], a[208:211], v[48:51]
    ds_read_b128 v[120:123], v14 offset:17408
    v_mfma_f32_16x16x32_bf16 v[48:51], v[116:119], a[216:219], v[48:51]
    ds_read_b128 v[124:127], v14 offset:21504
    v_mfma_f32_16x16x32_bf16 v[52:55], v[116:119], a[220:223], v[52:55]
    ds_read_b128 v[128:131], v14 offset:25600
    v_lshlrev_b32 v78, 16, v103
    v_mfma_f32_16x16x32_bf16 v[52:55], v[112:115], a[212:215], v[52:55]
    ds_read_b128 v[132:135], v14 offset:29696
    v_mfma_f32_16x16x32_bf16 v[52:55], v[108:111], a[204:207], v[52:55]
    ds_read_b64_tr_b16 v[244:245], v10 offset:20480
    s_add_u32 m0, s73, 99328
    v_lshlrev_b32 v79, 16, v103
    v_mfma_f32_16x16x32_bf16 v[52:55], v[104:107], a[196:199], v[52:55]
    buffer_load_dwordx4 v21, s[44:47], s21 offen offset:0 sc1 lds
    s_waitcnt lgkmcnt(3)
    v_mfma_f32_16x16x32_bf16 v[36:39], v[120:123], a[228:231], v[36:39]
    ds_read_b64_tr_b16 v[246:247], v10 offset:22528
    buffer_load_dwordx2 v[98:99], v26, s[44:47], s42 offen offset:128 sc1
    s_add_u32 m0, s73, 99840
    v_mfma_f32_16x16x32_bf16 v[36:39], v[124:127], a[236:239], v[36:39]
    buffer_load_dwordx4 v21, s[44:47], s21 offen offset:512 sc1 lds
    s_waitcnt lgkmcnt(2)
    v_mfma_f32_16x16x32_bf16 v[36:39], v[128:131], a[244:247], v[36:39]
    ds_read_b128 v[104:107], v14 offset:18432
    v_lshlrev_b32 v80, 16, v102
    v_mfma_f32_16x16x32_bf16 v[36:39], v[132:135], a[252:255], v[36:39]
    ds_read_b128 v[108:111], v14 offset:22528
    v_lshlrev_b32 v81, 16, v102
    v_mfma_f32_16x16x32_bf16 v[32:35], v[132:135], a[248:251], v[32:35]
    ds_read_b128 v[112:115], v14 offset:26624
    v_add_u32 v11, 65536, v11
    v_mfma_f32_16x16x32_bf16 v[32:35], v[128:131], a[240:243], v[32:35]
    ds_read_b128 v[116:119], v14 offset:30720
    v_mfma_f32_16x16x32_bf16 v[32:35], v[124:127], a[232:235], v[32:35]
    s_add_u32 m0, s73, 101376
    v_lshlrev_b32 v82, 16, v102
    v_mfma_f32_16x16x32_bf16 v[32:35], v[120:123], a[224:227], v[32:35]
    buffer_load_dwordx4 v21, s[44:47], s22 offen offset:0 sc1 lds
    ds_read_b64_tr_b16 v[240:241], v11 offset:16384
    s_waitcnt lgkmcnt(3)
    v_mfma_f32_16x16x32_bf16 v[40:43], v[104:107], a[224:227], v[40:43]
    v_lshlrev_b32 v83, 16, v102
    v_mfma_f32_16x16x32_bf16 v[40:43], v[108:111], a[232:235], v[40:43]
    ds_read_b64_tr_b16 v[242:243], v11 offset:18432
    s_waitcnt lgkmcnt(2)
    v_mfma_f32_16x16x32_bf16 v[40:43], v[112:115], a[240:243], v[40:43]
    ds_read_b128 v[120:123], v14 offset:19456
    v_mfma_f32_16x16x32_bf16 v[40:43], v[116:119], a[248:251], v[40:43]
    ds_read_b128 v[124:127], v14 offset:23552
    v_mfma_f32_16x16x32_bf16 v[44:47], v[116:119], a[252:255], v[44:47]
    ds_read_b128 v[128:131], v14 offset:27648
    v_lshlrev_b32 v84, 16, v103
    v_mfma_f32_16x16x32_bf16 v[44:47], v[112:115], a[244:247], v[44:47]
    ds_read_b128 v[132:135], v14 offset:31744
    v_mfma_f32_16x16x32_bf16 v[44:47], v[108:111], a[236:239], v[44:47]
    ds_read_b64_tr_b16 v[248:249], v11 offset:20480
    v_lshlrev_b32 v85, 16, v103
    v_mfma_f32_16x16x32_bf16 v[44:47], v[104:107], a[228:231], v[44:47]
    s_waitcnt lgkmcnt(3)
    v_mfma_f32_16x16x32_bf16 v[52:55], v[120:123], a[228:231], v[52:55]
    ds_read_b64_tr_b16 v[250:251], v11 offset:22528
    buffer_load_dwordx2 v[100:101], v18, s[44:47], s42 offen offset:0 sc1
    v_mfma_f32_16x16x32_bf16 v[52:55], v[124:127], a[236:239], v[52:55]
    v_lshlrev_b32 v86, 16, v103
    s_waitcnt lgkmcnt(2)
    v_mfma_f32_16x16x32_bf16 v[52:55], v[128:131], a[244:247], v[52:55]
    s_waitcnt lgkmcnt(0)
    s_barrier
    v_mfma_f32_16x16x32_bf16 v[52:55], v[132:135], a[252:255], v[52:55]
    ds_read_b128 v[104:107], v14 offset:32768
    v_mfma_f32_16x16x32_bf16 v[48:51], v[132:135], a[248:251], v[48:51]
    ds_read_b128 v[108:111], v14 offset:36864
    v_lshlrev_b32 v87, 16, v103
    v_mfma_f32_16x16x32_bf16 v[48:51], v[128:131], a[240:243], v[48:51]
    ds_read_b128 v[112:115], v14 offset:40960
    v_mfma_f32_16x16x32_bf16 v[48:51], v[124:127], a[232:235], v[48:51]
    ds_read_b128 v[116:119], v14 offset:45056
    v_lshlrev_b32 v27, 16, v27
    v_mfma_f32_16x16x32_bf16 v[48:51], v[120:123], a[224:227], v[48:51]
L_Dc:
L_pl_D_0:
    s_cbranch_execz L_wret
    s_waitcnt lgkmcnt(2)
    v_mfma_f32_16x16x32_bf16 v[32:35], v[104:107], v[220:223], v[32:35]
    s_add_u32 m0, s73, 114176
    v_mfma_f32_16x16x32_bf16 v[32:35], v[108:111], v[228:231], v[32:35]
    buffer_load_dwordx4 v21, s[44:47], s22 offen offset:512 sc1 lds
    s_waitcnt lgkmcnt(0)
    v_mfma_f32_16x16x32_bf16 v[32:35], v[112:115], v[236:239], v[32:35]
    ds_read_b128 v[120:123], v14 offset:33792
    v_mfma_f32_16x16x32_bf16 v[32:35], v[116:119], v[244:247], v[32:35]
    ds_read_b128 v[124:127], v14 offset:37888
    v_mfma_f32_16x16x32_bf16 v[36:39], v[116:119], v[248:251], v[36:39]
    ds_read_b128 v[128:131], v14 offset:41984
    buffer_load_dword v189, v188, s[44:47], 0 offen sc1
    v_mfma_f32_16x16x32_bf16 v[36:39], v[112:115], v[240:243], v[36:39]
    ds_read_b128 v[132:135], v14 offset:46080
    v_mfma_f32_16x16x32_bf16 v[36:39], v[108:111], v[232:235], v[36:39]
    s_add_u32 m0, s73, 115712
    v_mfma_f32_16x16x32_bf16 v[36:39], v[104:107], v[224:227], v[36:39]
    buffer_load_dwordx4 v21, s[44:47], s23 offen offset:0 sc1 lds
    s_waitcnt lgkmcnt(2)
    v_mfma_f32_16x16x32_bf16 v[44:47], v[120:123], v[224:227], v[44:47]
    s_add_u32 m0, s73, 116224
    v_mfma_f32_16x16x32_bf16 v[44:47], v[124:127], v[232:235], v[44:47]
    buffer_load_dwordx4 v21, s[44:47], s23 offen offset:512 sc1 lds
    s_waitcnt lgkmcnt(0)
    v_mfma_f32_16x16x32_bf16 v[44:47], v[128:131], v[240:243], v[44:47]
    ds_read_b128 v[104:107], v14 offset:34816
    v_mfma_f32_16x16x32_bf16 v[44:47], v[132:135], v[248:251], v[44:47]
    ds_read_b128 v[108:111], v14 offset:38912
    v_mfma_f32_16x16x32_bf16 v[40:43], v[132:135], v[244:247], v[40:43]
    ds_read_b128 v[112:115], v14 offset:43008
    v_mfma_f32_16x16x32_bf16 v[40:43], v[128:131], v[236:239], v[40:43]
    ds_read_b128 v[116:119], v14 offset:47104
    v_mfma_f32_16x16x32_bf16 v[40:43], v[124:127], v[228:231], v[40:43]
    s_add_u32 m0, s73, 117760
    v_mfma_f32_16x16x32_bf16 v[40:43], v[120:123], v[220:223], v[40:43]
    buffer_load_dwordx4 v21, s[44:47], s24 offen offset:0 sc1 lds
    s_waitcnt lgkmcnt(2)
    v_mfma_f32_16x16x32_bf16 v[48:51], v[104:107], v[220:223], v[48:51]
    v_mfma_f32_16x16x32_bf16 v[48:51], v[108:111], v[228:231], v[48:51]
    s_waitcnt lgkmcnt(0)
    v_mfma_f32_16x16x32_bf16 v[48:51], v[112:115], v[236:239], v[48:51]
    ds_read_b128 v[120:123], v14 offset:35840
    v_mfma_f32_16x16x32_bf16 v[48:51], v[116:119], v[244:247], v[48:51]
    ds_read_b128 v[124:127], v14 offset:39936
    v_mfma_f32_16x16x32_bf16 v[52:55], v[116:119], v[248:251], v[52:55]
    ds_read_b128 v[128:131], v14 offset:44032
    v_mfma_f32_16x16x32_bf16 v[52:55], v[112:115], v[240:243], v[52:55]
    ds_read_b128 v[132:135], v14 offset:48128
    v_mfma_f32_16x16x32_bf16 v[52:55], v[108:111], v[232:235], v[52:55]
    v_mfma_f32_16x16x32_bf16 v[52:55], v[104:107], v[224:227], v[52:55]
    s_waitcnt lgkmcnt(2)
    v_mfma_f32_16x16x32_bf16 v[60:63], v[120:123], a[4:7], 0
    v_mfma_f32_16x16x32_bf16 v[60:63], v[124:127], a[12:15], v[60:63]
    s_waitcnt lgkmcnt(0)
    v_mfma_f32_16x16x32_bf16 v[60:63], v[128:131], a[20:23], v[60:63]
    s_waitcnt vmcnt(12)
    s_barrier
    v_mfma_f32_16x16x32_bf16 v[60:63], v[132:135], a[28:31], v[60:63]
    ds_read_b128 v[104:107], v14 offset:49152
    v_mfma_f32_16x16x32_bf16 v[56:59], v[132:135], a[24:27], 0
    ds_read_b128 v[108:111], v14 offset:53248
    v_mfma_f32_16x16x32_bf16 v[56:59], v[128:131], a[16:19], v[56:59]
    ds_read_b128 v[112:115], v14 offset:57344
    v_cvt_pk_bf16_f32 v192, v32, v33
    v_mfma_f32_16x16x32_bf16 v[56:59], v[124:127], a[8:11], v[56:59]
    ds_read_b128 v[116:119], v14 offset:61440
    v_mfma_f32_16x16x32_bf16 v[56:59], v[120:123], a[0:3], v[56:59]
    s_waitcnt lgkmcnt(2)
    v_mfma_f32_16x16x32_bf16 v[64:67], v[104:107], a[0:3], 0
    s_add_u32 m0, s73, 130560
    v_mfma_f32_16x16x32_bf16 v[64:67], v[108:111], a[8:11], v[64:67]
    buffer_load_dwordx4 v21, s[44:47], s24 offen offset:512 sc1 lds
    s_waitcnt lgkmcnt(0)
    v_mfma_f32_16x16x32_bf16 v[64:67], v[112:115], a[16:19], v[64:67]
    ds_read_b128 v[120:123], v14 offset:50176
    v_cvt_pk_bf16_f32 v193, v34, v35
    v_mfma_f32_16x16x32_bf16 v[64:67], v[116:119], a[24:27], v[64:67]
    ds_read_b128 v[124:127], v14 offset:54272
    v_mfma_f32_16x16x32_bf16 v[68:71], v[116:119], a[28:31], 0
    ds_read_b128 v[128:131], v14 offset:58368
    v_mfma_f32_16x16x32_bf16 v[68:71], v[112:115], a[20:23], v[68:71]
    buffer_store_dwordx4 v[192:195], v136, s[44:47], s32 offen sc1
    ds_read_b128 v[132:135], v14 offset:62464
    v_mfma_f32_16x16x32_bf16 v[68:71], v[108:111], a[12:15], v[68:71]
    s_add_u32 m0, s73, 132096
    v_mfma_f32_16x16x32_bf16 v[68:71], v[104:107], a[4:7], v[68:71]
    buffer_load_dwordx4 v21, s[44:47], s25 offen offset:0 sc1 lds
    s_waitcnt lgkmcnt(2)
    v_mfma_f32_16x16x32_bf16 v[60:63], v[120:123], a[36:39], v[60:63]
    s_add_u32 m0, s73, 132608
    v_mfma_f32_16x16x32_bf16 v[60:63], v[124:127], a[44:47], v[60:63]
    buffer_load_dwordx4 v21, s[44:47], s25 offen offset:512 sc1 lds
    s_waitcnt lgkmcnt(0)
    v_mfma_f32_16x16x32_bf16 v[60:63], v[128:131], a[52:55], v[60:63]
    ds_read_b128 v[104:107], v14 offset:51200
    v_mfma_f32_16x16x32_bf16 v[60:63], v[132:135], a[60:63], v[60:63]
    ds_read_b128 v[108:111], v14 offset:55296
    v_mfma_f32_16x16x32_bf16 v[56:59], v[132:135], a[56:59], v[56:59]
    ds_read_b128 v[112:115], v14 offset:59392
    v_mfma_f32_16x16x32_bf16 v[56:59], v[128:131], a[48:51], v[56:59]
    ds_read_b128 v[116:119], v14 offset:63488
    v_mfma_f32_16x16x32_bf16 v[56:59], v[124:127], a[40:43], v[56:59]
    s_add_u32 m0, s73, 134144
    v_cvt_pk_bf16_f32 v196, v36, v37
    v_mfma_f32_16x16x32_bf16 v[56:59], v[120:123], a[32:35], v[56:59]
    buffer_load_dwordx4 v21, s[44:47], s26 offen offset:0 sc1 lds
    s_waitcnt lgkmcnt(2)
    v_mfma_f32_16x16x32_bf16 v[64:67], v[104:107], a[32:35], v[64:67]
    v_mfma_f32_16x16x32_bf16 v[64:67], v[108:111], a[40:43], v[64:67]
    s_waitcnt lgkmcnt(0)
    v_mfma_f32_16x16x32_bf16 v[64:67], v[112:115], a[48:51], v[64:67]
    ds_read_b128 v[120:123], v14 offset:52224
    v_cvt_pk_bf16_f32 v197, v38, v39
    v_mfma_f32_16x16x32_bf16 v[64:67], v[116:119], a[56:59], v[64:67]
    ds_read_b128 v[124:127], v14 offset:56320
    v_mfma_f32_16x16x32_bf16 v[68:71], v[116:119], a[60:63], v[68:71]
    ds_read_b128 v[128:131], v14 offset:60416
    v_mfma_f32_16x16x32_bf16 v[68:71], v[112:115], a[52:55], v[68:71]
    ds_read_b128 v[132:135], v14 offset:64512
    v_mfma_f32_16x16x32_bf16 v[68:71], v[108:111], a[44:47], v[68:71]
    buffer_store_dwordx4 v[196:199], v136, s[44:47], s33 offen sc1
    v_mfma_f32_16x16x32_bf16 v[68:71], v[104:107], a[36:39], v[68:71]
    s_waitcnt lgkmcnt(2)
    v_mfma_f32_16x16x32_bf16 v[60:63], v[120:123], a[68:71], v[60:63]
    v_mfma_f32_16x16x32_bf16 v[60:63], v[124:127], a[76:79], v[60:63]
    s_waitcnt lgkmcnt(0)
    v_mfma_f32_16x16x32_bf16 v[60:63], v[128:131], a[84:87], v[60:63]
    s_waitcnt vmcnt(12)
    s_barrier
    v_mfma_f32_16x16x32_bf16 v[60:63], v[132:135], a[92:95], v[60:63]
    ds_read_b128 v[104:107], v14 offset:0
    v_mfma_f32_16x16x32_bf16 v[56:59], v[132:135], a[88:91], v[56:59]
    ds_read_b128 v[108:111], v14 offset:4096
    v_mfma_f32_16x16x32_bf16 v[56:59], v[128:131], a[80:83], v[56:59]
    ds_read_b128 v[112:115], v14 offset:8192
    v_cvt_pk_bf16_f32 v192, v40, v41
    v_mfma_f32_16x16x32_bf16 v[56:59], v[124:127], a[72:75], v[56:59]
    ds_read_b128 v[116:119], v14 offset:12288
    v_mfma_f32_16x16x32_bf16 v[56:59], v[120:123], a[64:67], v[56:59]
    s_waitcnt lgkmcnt(2)
    v_mfma_f32_16x16x32_bf16 v[64:67], v[104:107], a[64:67], v[64:67]
    s_add_u32 m0, s73, 146944
    v_cvt_pk_bf16_f32 v193, v42, v43
    s_waitcnt vmcnt(11)
    v_mfma_f32_16x16x32_bf16 v[64:67], v[108:111], a[72:75], v[64:67]
    buffer_load_dwordx4 v21, s[44:47], s26 offen offset:512 sc1 lds
    s_waitcnt lgkmcnt(0)
    v_mfma_f32_16x16x32_bf16 v[64:67], v[112:115], a[80:83], v[64:67]
    ds_read_b128 v[120:123], v14 offset:1024
    v_mul_f32 v96, v96, v97
    v_mfma_f32_16x16x32_bf16 v[64:67], v[116:119], a[88:91], v[64:67]
    ds_read_b128 v[124:127], v14 offset:5120
    v_cvt_pk_bf16_f32 v194, v44, v45
    v_mfma_f32_16x16x32_bf16 v[68:71], v[116:119], a[92:95], v[68:71]
    ds_read_b128 v[128:131], v14 offset:9216
    v_mul_f32 v98, v98, v99
    v_mfma_f32_16x16x32_bf16 v[68:71], v[112:115], a[84:87], v[68:71]
    ds_read_b128 v[132:135], v14 offset:13312
    v_mul_f32 v100, v100, v101
    v_mfma_f32_16x16x32_bf16 v[68:71], v[108:111], a[76:79], v[68:71]
    buffer_store_dwordx4 v[192:195], v136, s[44:47], s30 offen offset:0 sc1
    s_add_u32 m0, s73, 148480
    v_permlane16_swap_b32 v88, v90
    v_mfma_f32_16x16x32_bf16 v[68:71], v[104:107], a[68:71], v[68:71]
    buffer_load_dwordx4 v22, s[44:47], s18 offen offset:0 sc1 lds
    s_waitcnt lgkmcnt(2)
    v_mfma_f32_16x16x32_bf16 v[60:63], v[120:123], a[100:103], v[60:63]
    s_add_u32 m0, s73, 148992
    v_permlane16_swap_b32 v89, v91
    v_permlane16_swap_b32 v92, v94
    v_mfma_f32_16x16x32_bf16 v[60:63], v[124:127], a[108:111], v[60:63]
    buffer_load_dwordx4 v22, s[44:47], s18 offen offset:512 sc1 lds
    s_waitcnt vmcnt(13)
    s_waitcnt lgkmcnt(0)
    v_mfma_f32_16x16x32_bf16 v[60:63], v[128:131], a[116:119], v[60:63]
    ds_read_b128 v[104:107], v14 offset:2048
    v_permlane16_swap_b32 v93, v95
    v_mfma_f32_16x16x32_bf16 v[60:63], v[132:135], a[124:127], v[60:63]
    ds_read_b128 v[108:111], v14 offset:6144
    v_cmp_ne_u32 vcc, s68, v189
    v_mfma_f32_16x16x32_bf16 v[56:59], v[132:135], a[120:123], v[56:59]
    ds_read_b128 v[112:115], v14 offset:10240
    v_and_b32 v145, 0xffff0000, v88
    v_mfma_f32_16x16x32_bf16 v[56:59], v[128:131], a[112:115], v[56:59]
    ds_read_b128 v[116:119], v14 offset:14336
    v_cvt_pk_bf16_f32 v196, v46, v47
    v_mfma_f32_16x16x32_bf16 v[56:59], v[124:127], a[104:107], v[56:59]
    s_add_u32 m0, s73, 150528
    s_cbranch_vccnz L_rs_p3
L_ok_p3:
    v_lshlrev_b32 v144, 16, v88
    v_mfma_f32_16x16x32_bf16 v[56:59], v[120:123], a[96:99], v[56:59]
    buffer_load_dwordx4 v22, s[44:47], s19 offen offset:0 sc1 lds
    s_waitcnt lgkmcnt(2)
    v_mfma_f32_16x16x32_bf16 v[64:67], v[104:107], a[96:99], v[64:67]
    s_add_u32 m0, s73, 81920
    v_cvt_pk_bf16_f32 v197, v48, v49
    v_and_b32 v147, 0xffff0000, v89
    v_mfma_f32_16x16x32_bf16 v[64:67], v[108:111], a[104:107], v[64:67]
    buffer_load_dwordx4 v184, s[44:47], s37 offen offset:0 sc1 lds
    s_waitcnt lgkmcnt(0)
    v_mfma_f32_16x16x32_bf16 v[64:67], v[112:115], a[112:115], v[64:67]
    ds_read_b128 v[120:123], v14 offset:3072
    buffer_load_dwordx4 v185, s[44:47], s37 offen offset:1024 sc1 lds
    v_mfma_f32_16x16x32_bf16 v[64:67], v[116:119], a[120:123], v[64:67]
    ds_read_b128 v[124:127], v14 offset:7168
    s_add_u32 m0, s73, 83968
    v_cvt_pk_bf16_f32 v198, v50, v51
    v_mfma_f32_16x16x32_bf16 v[68:71], v[116:119], a[124:127], v[68:71]
    ds_read_b128 v[128:131], v14 offset:11264
    buffer_load_dwordx4 v184, s[44:47], s16 offen offset:0 sc1 lds
    v_mfma_f32_16x16x32_bf16 v[68:71], v[112:115], a[116:119], v[68:71]
    ds_read_b128 v[132:135], v14 offset:15360
    buffer_load_dwordx4 v185, s[44:47], s16 offen offset:1024 sc1 lds
    v_mfma_f32_16x16x32_bf16 v[68:71], v[108:111], a[108:111], v[68:71]
    buffer_store_dwordx4 v[196:199], v136, s[44:47], s30 offen offset:1024 sc1
    v_lshlrev_b32 v146, 16, v89
    v_and_b32 v149, 0xffff0000, v92
    v_lshlrev_b32 v148, 16, v92
    v_mfma_f32_16x16x32_bf16 v[68:71], v[104:107], a[100:103], v[68:71]
    s_waitcnt lgkmcnt(2)
    v_mfma_f32_16x16x32_bf16 v[60:63], v[120:123], a[132:135], v[60:63]
    v_and_b32 v151, 0xffff0000, v93
    v_mfma_f32_16x16x32_bf16 v[60:63], v[124:127], a[140:143], v[60:63]
    v_lshlrev_b32 v150, 16, v93
    s_waitcnt lgkmcnt(0)
    v_mfma_f32_16x16x32_bf16 v[60:63], v[128:131], a[148:151], v[60:63]
    s_waitcnt vmcnt(16)
    s_barrier
    v_mfma_f32_16x16x32_bf16 v[60:63], v[132:135], a[156:159], v[60:63]
    ds_read_b128 v[104:107], v14 offset:16384
    v_and_b32 v153, 0xffff0000, v90
    v_mfma_f32_16x16x32_bf16 v[56:59], v[132:135], a[152:155], v[56:59]
    ds_read_b128 v[108:111], v14 offset:20480
    v_lshlrev_b32 v152, 16, v90
    v_mfma_f32_16x16x32_bf16 v[56:59], v[128:131], a[144:147], v[56:59]
    ds_read_b128 v[112:115], v14 offset:24576
    v_cvt_pk_bf16_f32 v200, v52, v53
    v_mfma_f32_16x16x32_bf16 v[56:59], v[124:127], a[136:139], v[56:59]
    ds_read_b128 v[116:119], v14 offset:28672
    v_and_b32 v155, 0xffff0000, v91
    v_mfma_f32_16x16x32_bf16 v[56:59], v[120:123], a[128:131], v[56:59]
    s_waitcnt lgkmcnt(2)
    v_mfma_f32_16x16x32_bf16 v[64:67], v[104:107], a[128:131], v[64:67]
    s_add_u32 m0, s73, 97792
    v_lshlrev_b32 v154, 16, v91
    v_mfma_f32_16x16x32_bf16 v[64:67], v[108:111], a[136:139], v[64:67]
    buffer_load_dwordx4 v22, s[44:47], s19 offen offset:512 sc1 lds
    s_waitcnt lgkmcnt(0)
    v_mfma_f32_16x16x32_bf16 v[64:67], v[112:115], a[144:147], v[64:67]
    ds_read_b128 v[120:123], v14 offset:17408
    v_cvt_pk_bf16_f32 v201, v54, v55
    v_mfma_f32_16x16x32_bf16 v[64:67], v[116:119], a[152:155], v[64:67]
    ds_read_b128 v[124:127], v14 offset:21504
    v_and_b32 v157, 0xffff0000, v94
    v_mfma_f32_16x16x32_bf16 v[68:71], v[116:119], a[156:159], v[68:71]
    ds_read_b128 v[128:131], v14 offset:25600
    v_lshlrev_b32 v156, 16, v94
    v_mfma_f32_16x16x32_bf16 v[68:71], v[112:115], a[148:151], v[68:71]
    buffer_store_dwordx4 v[200:203], v136, s[44:47], s30 offen offset:2048 sc1
    ds_read_b128 v[132:135], v14 offset:29696
    v_and_b32 v159, 0xffff0000, v95
    v_mfma_f32_16x16x32_bf16 v[68:71], v[108:111], a[140:143], v[68:71]
    s_add_u32 m0, s73, 99328
    v_lshlrev_b32 v158, 16, v95
    v_mfma_f32_16x16x32_bf16 v[68:71], v[104:107], a[132:135], v[68:71]
    buffer_load_dwordx4 v22, s[44:47], s20 offen offset:0 sc1 lds
    s_waitcnt lgkmcnt(2)
    v_mfma_f32_16x16x32_bf16 v[60:63], v[120:123], a[164:167], v[60:63]
    s_add_u32 m0, s73, 99840
    v_and_b32 v161, 0xffff0000, v142
    v_mfma_f32_16x16x32_bf16 v[60:63], v[124:127], a[172:175], v[60:63]
    buffer_load_dwordx4 v22, s[44:47], s20 offen offset:512 sc1 lds
    s_waitcnt lgkmcnt(0)
    v_mfma_f32_16x16x32_bf16 v[60:63], v[128:131], a[180:183], v[60:63]
    ds_read_b128 v[104:107], v14 offset:18432
    v_lshlrev_b32 v160, 16, v142
    v_mfma_f32_16x16x32_bf16 v[60:63], v[132:135], a[188:191], v[60:63]
    ds_read_b128 v[108:111], v14 offset:22528
    v_mfma_f32_16x16x32_bf16 v[56:59], v[132:135], a[184:187], v[56:59]
    ds_read_b128 v[112:115], v14 offset:26624
    v_and_b32 v163, 0xffff0000, v143
    v_mfma_f32_16x16x32_bf16 v[56:59], v[128:131], a[176:179], v[56:59]
    ds_read_b128 v[116:119], v14 offset:30720
    v_lshlrev_b32 v162, 16, v143
    v_mfma_f32_16x16x32_bf16 v[56:59], v[124:127], a[168:171], v[56:59]
    s_add_u32 m0, s73, 101376
    v_mfma_f32_16x16x32_bf16 v[56:59], v[120:123], a[160:163], v[56:59]
    buffer_load_dwordx4 v22, s[44:47], s21 offen offset:0 sc1 lds
    s_waitcnt lgkmcnt(2)
    v_mfma_f32_16x16x32_bf16 v[64:67], v[104:107], a[160:163], v[64:67]
    v_fma_f32 v164, v144, v97, -v96
    v_mfma_f32_16x16x32_bf16 v[64:67], v[108:111], a[168:171], v[64:67]
    v_fma_f32 v165, v145, v97, -v96
    s_waitcnt lgkmcnt(0)
    v_mfma_f32_16x16x32_bf16 v[64:67], v[112:115], a[176:179], v[64:67]
    ds_read_b128 v[120:123], v14 offset:19456
    v_fma_f32 v166, v146, v97, -v96
    v_mfma_f32_16x16x32_bf16 v[64:67], v[116:119], a[184:187], v[64:67]
    ds_read_b128 v[124:127], v14 offset:23552
    v_mfma_f32_16x16x32_bf16 v[68:71], v[116:119], a[188:191], v[68:71]
    ds_read_b128 v[128:131], v14 offset:27648
    v_fma_f32 v167, v147, v97, -v96
    v_mfma_f32_16x16x32_bf16 v[68:71], v[112:115], a[180:183], v[68:71]
    ds_read_b128 v[132:135], v14 offset:31744
    v_mfma_f32_16x16x32_bf16 v[68:71], v[108:111], a[172:175], v[68:71]
    v_fma_f32 v168, v148, v99, -v98
    v_mfma_f32_16x16x32_bf16 v[68:71], v[104:107], a[164:167], v[68:71]
    v_fma_f32 v169, v149, v99, -v98
    s_waitcnt lgkmcnt(2)
    v_mfma_f32_16x16x32_bf16 v[60:63], v[120:123], a[196:199], v[60:63]
    v_mfma_f32_16x16x32_bf16 v[60:63], v[124:127], a[204:207], v[60:63]
    v_fma_f32 v170, v150, v99, -v98
    s_waitcnt lgkmcnt(0)
    v_mfma_f32_16x16x32_bf16 v[60:63], v[128:131], a[212:215], v[60:63]
    s_waitcnt vmcnt(16)
    s_barrier
    v_mfma_f32_16x16x32_bf16 v[60:63], v[132:135], a[220:223], v[60:63]
    ds_read_b128 v[104:107], v14 offset:32768
    v_fma_f32 v171, v151, v99, -v98
    v_mfma_f32_16x16x32_bf16 v[56:59], v[132:135], a[216:219], v[56:59]
    ds_read_b128 v[108:111], v14 offset:36864
    v_fma_f32 v172, v152, v97, -v96
    v_mfma_f32_16x16x32_bf16 v[56:59], v[128:131], a[208:211], v[56:59]
    ds_read_b128 v[112:115], v14 offset:40960
    v_mfma_f32_16x16x32_bf16 v[56:59], v[124:127], a[200:203], v[56:59]
    ds_read_b128 v[116:119], v14 offset:45056
    v_fma_f32 v173, v153, v97, -v96
    v_mfma_f32_16x16x32_bf16 v[56:59], v[120:123], a[192:195], v[56:59]
    s_waitcnt lgkmcnt(2)
    v_mfma_f32_16x16x32_bf16 v[64:67], v[104:107], a[192:195], v[64:67]
    s_add_u32 m0, s73, 114176
    v_fma_f32 v174, v154, v97, -v96
    v_mfma_f32_16x16x32_bf16 v[64:67], v[108:111], a[200:203], v[64:67]
    buffer_load_dwordx4 v22, s[44:47], s21 offen offset:512 sc1 lds
    s_waitcnt lgkmcnt(0)
    v_mfma_f32_16x16x32_bf16 v[64:67], v[112:115], a[208:211], v[64:67]
    ds_read_b128 v[120:123], v14 offset:33792
    v_fma_f32 v175, v155, v97, -v96
    v_mfma_f32_16x16x32_bf16 v[64:67], v[116:119], a[216:219], v[64:67]
    ds_read_b128 v[124:127], v14 offset:37888
    v_fma_f32 v176, v156, v99, -v98
    v_mfma_f32_16x16x32_bf16 v[68:71], v[116:119], a[220:223], v[68:71]
    ds_read_b128 v[128:131], v14 offset:41984
    v_mfma_f32_16x16x32_bf16 v[68:71], v[112:115], a[212:215], v[68:71]
    ds_read_b128 v[132:135], v14 offset:46080
    v_fma_f32 v177, v157, v99, -v98
    v_mfma_f32_16x16x32_bf16 v[68:71], v[108:111], a[204:207], v[68:71]
    s_add_u32 m0, s73, 115712
    v_fma_f32 v178, v158, v99, -v98
    v_mfma_f32_16x16x32_bf16 v[68:71], v[104:107], a[196:199], v[68:71]
    buffer_load_dwordx4 v22, s[44:47], s22 offen offset:0 sc1 lds
    s_waitcnt lgkmcnt(2)
    v_mfma_f32_16x16x32_bf16 v[60:63], v[120:123], a[228:231], v[60:63]
    s_add_u32 m0, s73, 116224
    v_fma_f32 v179, v159, v99, -v98
    v_mfma_f32_16x16x32_bf16 v[60:63], v[124:127], a[236:239], v[60:63]
    buffer_load_dwordx4 v22, s[44:47], s22 offen offset:512 sc1 lds
    s_waitcnt lgkmcnt(0)
    v_mfma_f32_16x16x32_bf16 v[60:63], v[128:131], a[244:247], v[60:63]
    ds_read_b128 v[104:107], v14 offset:34816
    v_fma_f32 v180, v160, v101, -v100
    v_mfma_f32_16x16x32_bf16 v[60:63], v[132:135], a[252:255], v[60:63]
    ds_read_b128 v[108:111], v14 offset:38912
    v_fma_f32 v181, v161, v101, -v100
    v_mfma_f32_16x16x32_bf16 v[56:59], v[132:135], a[248:251], v[56:59]
    ds_read_b128 v[112:115], v14 offset:43008
    v_mfma_f32_16x16x32_bf16 v[56:59], v[128:131], a[240:243], v[56:59]
    ds_read_b128 v[116:119], v14 offset:47104
    v_fma_f32 v182, v162, v101, -v100
    v_mfma_f32_16x16x32_bf16 v[56:59], v[124:127], a[232:235], v[56:59]
    s_add_u32 m0, s73, 117760
    v_fma_f32 v183, v163, v101, -v100
    v_mfma_f32_16x16x32_bf16 v[56:59], v[120:123], a[224:227], v[56:59]
    buffer_load_dwordx4 v22, s[44:47], s23 offen offset:0 sc1 lds
    s_waitcnt lgkmcnt(2)
    v_mfma_f32_16x16x32_bf16 v[64:67], v[104:107], a[224:227], v[64:67]
    v_mfma_f32_16x16x32_bf16 v[64:67], v[108:111], a[232:235], v[64:67]
    s_waitcnt lgkmcnt(0)
    v_mfma_f32_16x16x32_bf16 v[64:67], v[112:115], a[240:243], v[64:67]
    ds_read_b128 v[120:123], v14 offset:35840
    v_mfma_f32_16x16x32_bf16 v[64:67], v[116:119], a[248:251], v[64:67]
    ds_read_b128 v[124:127], v14 offset:39936
    v_mfma_f32_16x16x32_bf16 v[68:71], v[116:119], a[252:255], v[68:71]
    ds_read_b128 v[128:131], v14 offset:44032
    v_mfma_f32_16x16x32_bf16 v[68:71], v[112:115], a[244:247], v[68:71]
L_pl_D_1:
    s_cbranch_execz L_wret
    ds_read_b128 v[132:135], v14 offset:48128
    v_mfma_f32_16x16x32_bf16 v[68:71], v[108:111], a[236:239], v[68:71]
    v_mfma_f32_16x16x32_bf16 v[68:71], v[104:107], a[228:231], v[68:71]
    s_waitcnt lgkmcnt(2)
    v_mfma_f32_16x16x32_bf16 v[60:63], v[120:123], v[224:227], v[60:63]
    v_mfma_f32_16x16x32_bf16 v[60:63], v[124:127], v[232:235], v[60:63]
    s_waitcnt lgkmcnt(0)
    v_mfma_f32_16x16x32_bf16 v[60:63], v[128:131], v[240:243], v[60:63]
    s_waitcnt vmcnt(10)
    s_barrier
    v_mfma_f32_16x16x32_bf16 v[60:63], v[132:135], v[248:251], v[60:63]
    ds_read_b128 v[104:107], v14 offset:49152
    v_mfma_f32_16x16x32_bf16 v[56:59], v[132:135], v[244:247], v[56:59]
    ds_read_b128 v[108:111], v14 offset:53248
    v_mfma_f32_16x16x32_bf16 v[56:59], v[128:131], v[236:239], v[56:59]
    ds_read_b128 v[112:115], v14 offset:57344
    v_mfma_f32_16x16x32_bf16 v[56:59], v[124:127], v[228:231], v[56:59]
    ds_read_b128 v[116:119], v14 offset:61440
    v_mfma_f32_16x16x32_bf16 v[56:59], v[120:123], v[220:223], v[56:59]
    s_waitcnt lgkmcnt(2)
    v_mfma_f32_16x16x32_bf16 v[64:67], v[104:107], v[220:223], v[64:67]
    s_add_u32 m0, s73, 130560
    v_xor_b32 v186, s41, v10
    v_add_u32 v186, s43, v186
    v_mfma_f32_16x16x32_bf16 v[64:67], v[108:111], v[228:231], v[64:67]
    buffer_load_dwordx4 v22, s[44:47], s23 offen offset:512 sc1 lds
    ds_read_b64_tr_b16 v[12:13], v10 offset:16384
    s_waitcnt lgkmcnt(1)
    v_mfma_f32_16x16x32_bf16 v[64:67], v[112:115], v[236:239], v[64:67]
    ds_read_b128 v[120:123], v14 offset:50176
    v_mfma_f32_16x16x32_bf16 v[64:67], v[116:119], v[244:247], v[64:67]
    ds_read_b128 v[124:127], v14 offset:54272
    v_mfma_f32_16x16x32_bf16 v[68:71], v[116:119], v[248:251], v[68:71]
    ds_read_b128 v[128:131], v14 offset:58368
    ds_read_b64_tr_b16 v[24:25], v11 offset:16384
    v_mfma_f32_16x16x32_bf16 v[68:71], v[112:115], v[240:243], v[68:71]
    ds_read_b128 v[132:135], v14 offset:62464
    ds_read_b64_tr_b16 v[28:29], v10 offset:20480
    v_mfma_f32_16x16x32_bf16 v[68:71], v[108:111], v[232:235], v[68:71]
    s_add_u32 m0, s73, 132096
    ds_read_b64_tr_b16 v[190:191], v11 offset:20480
    v_mfma_f32_16x16x32_bf16 v[68:71], v[104:107], v[224:227], v[68:71]
    buffer_load_dwordx4 v22, s[44:47], s24 offen offset:0 sc1 lds
    ds_read_b64_tr_b16 v[142:143], v186 offset:18432
    s_waitcnt lgkmcnt(6)
    v_mfma_f32_16x16x32_bf16 v[76:79], v[120:123], a[4:7], v[76:79]
    s_add_u32 m0, s73, 132608
    s_waitcnt lgkmcnt(0)
    v_mfma_f32_16x16x32_bf16 v[76:79], v[124:127], a[12:15], v[76:79]
    buffer_load_dwordx4 v22, s[44:47], s24 offen offset:512 sc1 lds
    v_mfma_f32_16x16x32_bf16 v[76:79], v[128:131], a[20:23], v[76:79]
    ds_read_b128 v[104:107], v14 offset:51200
    v_and_b32 v9, 0xffff0000, v12
    v_mfma_f32_16x16x32_bf16 v[76:79], v[132:135], a[28:31], v[76:79]
    ds_read_b128 v[108:111], v14 offset:55296
    v_mfma_f32_16x16x32_bf16 v[72:75], v[132:135], a[24:27], v[72:75]
    ds_read_b128 v[112:115], v14 offset:59392
    v_lshlrev_b32 v8, 16, v12
    v_mfma_f32_16x16x32_bf16 v[72:75], v[128:131], a[16:19], v[72:75]
    ds_read_b128 v[116:119], v14 offset:63488
    v_cvt_pk_bf16_f32 v192, v56, v57
    v_mfma_f32_16x16x32_bf16 v[72:75], v[124:127], a[8:11], v[72:75]
    s_add_u32 m0, s73, 134144
    v_mul_f32 v165, v165, v9
    v_mfma_f32_16x16x32_bf16 v[72:75], v[120:123], a[0:3], v[72:75]
    buffer_load_dwordx4 v22, s[44:47], s25 offen offset:0 sc1 lds
    s_waitcnt lgkmcnt(2)
    v_mfma_f32_16x16x32_bf16 v[80:83], v[104:107], a[0:3], v[80:83]
    v_cvt_pk_bf16_f32 v193, v58, v59
    v_mul_f32 v164, v164, v8
    v_mfma_f32_16x16x32_bf16 v[80:83], v[108:111], a[8:11], v[80:83]
    v_and_b32 v31, 0xffff0000, v13
    s_waitcnt lgkmcnt(0)
    v_mfma_f32_16x16x32_bf16 v[80:83], v[112:115], a[16:19], v[80:83]
    ds_read_b128 v[120:123], v14 offset:52224
    v_lshlrev_b32 v30, 16, v13
    v_mfma_f32_16x16x32_bf16 v[80:83], v[116:119], a[24:27], v[80:83]
    ds_read_b128 v[124:127], v14 offset:56320
    v_cvt_pk_bf16_f32 v194, v60, v61
    v_mfma_f32_16x16x32_bf16 v[84:87], v[116:119], a[28:31], v[84:87]
    ds_read_b128 v[128:131], v14 offset:60416
    v_mfma_f32_16x16x32_bf16 v[84:87], v[112:115], a[20:23], v[84:87]
    ds_read_b128 v[132:135], v14 offset:64512
    v_mul_f32 v167, v167, v31
    v_mfma_f32_16x16x32_bf16 v[84:87], v[108:111], a[12:15], v[84:87]
    buffer_store_dwordx4 v[192:195], v136, s[44:47], s15 offen offset:0 sc1
    v_mul_f32 v166, v166, v30
    v_mfma_f32_16x16x32_bf16 v[84:87], v[104:107], a[4:7], v[84:87]
    s_waitcnt lgkmcnt(2)
    v_mfma_f32_16x16x32_bf16 v[76:79], v[120:123], a[36:39], v[76:79]
    v_and_b32 v9, 0xffff0000, v24
    v_mfma_f32_16x16x32_bf16 v[76:79], v[124:127], a[44:47], v[76:79]
    v_cvt_pk_bf16_f32 v196, v62, v63
    s_waitcnt lgkmcnt(0)
    v_mfma_f32_16x16x32_bf16 v[76:79], v[128:131], a[52:55], v[76:79]
    s_waitcnt vmcnt(9)
    s_barrier
    v_lshlrev_b32 v8, 16, v24
    v_mfma_f32_16x16x32_bf16 v[76:79], v[132:135], a[60:63], v[76:79]
    ds_read_b128 v[104:107], v14 offset:0
    v_mul_f32 v169, v169, v9
    v_mfma_f32_16x16x32_bf16 v[72:75], v[132:135], a[56:59], v[72:75]
    ds_read_b128 v[108:111], v14 offset:4096
    v_cvt_pk_bf16_f32 v197, v64, v65
    v_mfma_f32_16x16x32_bf16 v[72:75], v[128:131], a[48:51], v[72:75]
    ds_read_b128 v[112:115], v14 offset:8192
    v_mul_f32 v168, v168, v8
    v_mfma_f32_16x16x32_bf16 v[72:75], v[124:127], a[40:43], v[72:75]
    ds_read_b128 v[116:119], v14 offset:12288
    v_mfma_f32_16x16x32_bf16 v[72:75], v[120:123], a[32:35], v[72:75]
    v_cvt_pk_bf16_f32 v198, v66, v67
    s_waitcnt lgkmcnt(2)
    v_mfma_f32_16x16x32_bf16 v[80:83], v[104:107], a[32:35], v[80:83]
    s_add_u32 m0, s73, 146944
    v_and_b32 v31, 0xffff0000, v25
    v_lshlrev_b32 v30, 16, v25
    v_mfma_f32_16x16x32_bf16 v[80:83], v[108:111], a[40:43], v[80:83]
    buffer_load_dwordx4 v22, s[44:47], s25 offen offset:512 sc1 lds
    s_waitcnt lgkmcnt(0)
    v_mfma_f32_16x16x32_bf16 v[80:83], v[112:115], a[48:51], v[80:83]
    buffer_store_dwordx4 v[196:199], v136, s[44:47], s15 offen offset:1024 sc1
    ds_read_b128 v[120:123], v14 offset:1024
    v_mfma_f32_16x16x32_bf16 v[80:83], v[116:119], a[56:59], v[80:83]
    ds_read_b128 v[124:127], v14 offset:5120
    v_mul_f32 v171, v171, v31
    v_mfma_f32_16x16x32_bf16 v[84:87], v[116:119], a[60:63], v[84:87]
    ds_read_b128 v[128:131], v14 offset:9216
    v_mul_f32 v170, v170, v30
    v_mfma_f32_16x16x32_bf16 v[84:87], v[112:115], a[52:55], v[84:87]
    ds_read_b128 v[132:135], v14 offset:13312
    v_mfma_f32_16x16x32_bf16 v[84:87], v[108:111], a[44:47], v[84:87]
    s_add_u32 m0, s73, 148480
    v_cvt_pk_bf16_f32 v200, v68, v69
    v_and_b32 v9, 0xffff0000, v28
    v_mfma_f32_16x16x32_bf16 v[84:87], v[104:107], a[36:39], v[84:87]
    buffer_load_dwordx4 v22, s[44:47], s26 offen offset:0 sc1 lds
    s_waitcnt lgkmcnt(2)
    v_mfma_f32_16x16x32_bf16 v[76:79], v[120:123], a[68:71], v[76:79]
    s_add_u32 m0, s73, 148992
    v_lshlrev_b32 v8, 16, v28
    v_mfma_f32_16x16x32_bf16 v[76:79], v[124:127], a[76:79], v[76:79]
    buffer_load_dwordx4 v22, s[44:47], s26 offen offset:512 sc1 lds
    s_waitcnt lgkmcnt(0)
    v_mfma_f32_16x16x32_bf16 v[76:79], v[128:131], a[84:87], v[76:79]
    ds_read_b128 v[104:107], v14 offset:2048
    v_cvt_pk_bf16_f32 v201, v70, v71
    v_mfma_f32_16x16x32_bf16 v[76:79], v[132:135], a[92:95], v[76:79]
    ds_read_b128 v[108:111], v14 offset:6144
    v_mul_f32 v173, v173, v9
    v_mfma_f32_16x16x32_bf16 v[72:75], v[132:135], a[88:91], v[72:75]
    ds_read_b128 v[112:115], v14 offset:10240
    v_mul_f32 v172, v172, v8
    v_mfma_f32_16x16x32_bf16 v[72:75], v[128:131], a[80:83], v[72:75]
    ds_read_b128 v[116:119], v14 offset:14336
    v_and_b32 v31, 0xffff0000, v29
    v_mfma_f32_16x16x32_bf16 v[72:75], v[124:127], a[72:75], v[72:75]
    buffer_store_dwordx4 v[200:203], v136, s[44:47], s15 offen offset:2048 sc1
    s_add_u32 m0, s73, 150528
    v_mfma_f32_16x16x32_bf16 v[72:75], v[120:123], a[64:67], v[72:75]
    buffer_load_dwordx4 v19, s[44:47], s18 offen offset:0 sc1 lds
    s_waitcnt lgkmcnt(2)
    v_mfma_f32_16x16x32_bf16 v[80:83], v[104:107], a[64:67], v[80:83]
    v_lshlrev_b32 v30, 16, v29
    v_mul_f32 v175, v175, v31
    v_mfma_f32_16x16x32_bf16 v[80:83], v[108:111], a[72:75], v[80:83]
    buffer_load_dwordx4 v[40:43], v136, s[44:47], s34 offen offset:0 sc1
    s_waitcnt lgkmcnt(0)
    v_mfma_f32_16x16x32_bf16 v[80:83], v[112:115], a[80:83], v[80:83]
    ds_read_b128 v[120:123], v14 offset:3072
    v_mfma_f32_16x16x32_bf16 v[80:83], v[116:119], a[88:91], v[80:83]
    ds_read_b128 v[124:127], v14 offset:7168
    v_mul_f32 v174, v174, v30
    v_mfma_f32_16x16x32_bf16 v[84:87], v[116:119], a[92:95], v[84:87]
    ds_read_b128 v[128:131], v14 offset:11264
    v_and_b32 v9, 0xffff0000, v190
    v_mfma_f32_16x16x32_bf16 v[84:87], v[112:115], a[84:87], v[84:87]
    ds_read_b128 v[132:135], v14 offset:15360
    buffer_load_dwordx4 v[44:47], v136, s[44:47], s34 offen offset:1024 sc1
    v_mfma_f32_16x16x32_bf16 v[84:87], v[108:111], a[76:79], v[84:87]
    v_lshlrev_b32 v8, 16, v190
    v_mfma_f32_16x16x32_bf16 v[84:87], v[104:107], a[68:71], v[84:87]
    s_waitcnt lgkmcnt(2)
    v_mfma_f32_16x16x32_bf16 v[76:79], v[120:123], a[100:103], v[76:79]
    buffer_load_dwordx4 v[48:51], v136, s[44:47], s34 offen offset:2048 sc1
    v_mul_f32 v177, v177, v9
    v_mfma_f32_16x16x32_bf16 v[76:79], v[124:127], a[108:111], v[76:79]
    s_waitcnt lgkmcnt(0)
    v_mfma_f32_16x16x32_bf16 v[76:79], v[128:131], a[116:119], v[76:79]
    s_waitcnt vmcnt(14)
    s_barrier
    v_mul_f32 v176, v176, v8
    v_mfma_f32_16x16x32_bf16 v[76:79], v[132:135], a[124:127], v[76:79]
    ds_read_b128 v[104:107], v14 offset:16384
    v_and_b32 v31, 0xffff0000, v191
    v_mfma_f32_16x16x32_bf16 v[72:75], v[132:135], a[120:123], v[72:75]
    ds_read_b128 v[108:111], v14 offset:20480
    buffer_load_dwordx4 v[204:207], v136, s[44:47], s35 offen offset:0 sc1
    v_mfma_f32_16x16x32_bf16 v[72:75], v[128:131], a[112:115], v[72:75]
    ds_read_b128 v[112:115], v14 offset:24576
    v_lshlrev_b32 v30, 16, v191
    v_mfma_f32_16x16x32_bf16 v[72:75], v[124:127], a[104:107], v[72:75]
    ds_read_b128 v[116:119], v14 offset:28672
    v_mul_f32 v179, v179, v31
    v_mfma_f32_16x16x32_bf16 v[72:75], v[120:123], a[96:99], v[72:75]
    buffer_load_dwordx4 v[208:211], v136, s[44:47], s35 offen offset:1024 sc1
    s_waitcnt lgkmcnt(2)
    v_mfma_f32_16x16x32_bf16 v[80:83], v[104:107], a[96:99], v[80:83]
    v_mfma_f32_16x16x32_bf16 v[80:83], v[108:111], a[104:107], v[80:83]
    v_mul_f32 v178, v178, v30
    s_waitcnt lgkmcnt(0)
    v_mfma_f32_16x16x32_bf16 v[80:83], v[112:115], a[112:115], v[80:83]
    ds_read_b128 v[120:123], v14 offset:17408
    buffer_load_dwordx4 v[212:215], v136, s[44:47], s35 offen offset:2048 sc1
    v_mfma_f32_16x16x32_bf16 v[80:83], v[116:119], a[120:123], v[80:83]
    ds_read_b128 v[124:127], v14 offset:21504
    v_and_b32 v9, 0xffff0000, v142
    v_mfma_f32_16x16x32_bf16 v[84:87], v[116:119], a[124:127], v[84:87]
    ds_read_b128 v[128:131], v14 offset:25600
    v_lshlrev_b32 v8, 16, v142
    v_mfma_f32_16x16x32_bf16 v[84:87], v[112:115], a[116:119], v[84:87]
    ds_read_b128 v[132:135], v14 offset:29696
    v_mfma_f32_16x16x32_bf16 v[84:87], v[108:111], a[108:111], v[84:87]
    buffer_load_dwordx4 v[216:219], v136, s[44:47], s35 offen offset:3072 sc1
    v_mul_f32 v181, v181, v9
    v_mfma_f32_16x16x32_bf16 v[84:87], v[104:107], a[100:103], v[84:87]
    s_waitcnt lgkmcnt(2)
    v_mfma_f32_16x16x32_bf16 v[76:79], v[120:123], a[132:135], v[76:79]
    v_mul_f32 v180, v180, v8
    v_mfma_f32_16x16x32_bf16 v[76:79], v[124:127], a[140:143], v[76:79]
    v_and_b32 v31, 0xffff0000, v143
    s_waitcnt lgkmcnt(0)
    v_mfma_f32_16x16x32_bf16 v[76:79], v[128:131], a[148:151], v[76:79]
    ds_read_b128 v[104:107], v14 offset:18432
    v_mfma_f32_16x16x32_bf16 v[76:79], v[132:135], a[156:159], v[76:79]
    ds_read_b128 v[108:111], v14 offset:22528
    v_lshlrev_b32 v30, 16, v143
    v_mfma_f32_16x16x32_bf16 v[72:75], v[132:135], a[152:155], v[72:75]
    ds_read_b128 v[112:115], v14 offset:26624
    v_mfma_f32_16x16x32_bf16 v[72:75], v[128:131], a[144:147], v[72:75]
    ds_read_b128 v[116:119], v14 offset:30720
    v_mul_f32 v183, v183, v31
    v_mfma_f32_16x16x32_bf16 v[72:75], v[124:127], a[136:139], v[72:75]
    v_mfma_f32_16x16x32_bf16 v[72:75], v[120:123], a[128:131], v[72:75]
    v_mul_f32 v182, v182, v30
    s_waitcnt lgkmcnt(2)
    v_mfma_f32_16x16x32_bf16 v[80:83], v[104:107], a[128:131], v[80:83]
    v_mfma_f32_16x16x32_bf16 v[80:83], v[108:111], a[136:139], v[80:83]
    s_waitcnt lgkmcnt(0)
    v_mfma_f32_16x16x32_bf16 v[80:83], v[112:115], a[144:147], v[80:83]
    ds_read_b128 v[120:123], v14 offset:19456
    v_mfma_f32_16x16x32_bf16 v[80:83], v[116:119], a[152:155], v[80:83]
    ds_read_b128 v[124:127], v14 offset:23552
    v_mfma_f32_16x16x32_bf16 v[84:87], v[116:119], a[156:159], v[84:87]
    ds_read_b128 v[128:131], v14 offset:27648
    v_mfma_f32_16x16x32_bf16 v[84:87], v[112:115], a[148:151], v[84:87]
    ds_read_b128 v[132:135], v14 offset:31744
    v_mfma_f32_16x16x32_bf16 v[84:87], v[108:111], a[140:143], v[84:87]
    v_mfma_f32_16x16x32_bf16 v[84:87], v[104:107], a[132:135], v[84:87]
    s_waitcnt lgkmcnt(2)
    v_mfma_f32_16x16x32_bf16 v[76:79], v[120:123], a[164:167], v[76:79]
    s_add_u32 m0, s73, 97792
    v_mfma_f32_16x16x32_bf16 v[76:79], v[124:127], a[172:175], v[76:79]
    buffer_load_dwordx4 v19, s[44:47], s18 offen offset:512 sc1 lds
    s_waitcnt lgkmcnt(0)
    v_mfma_f32_16x16x32_bf16 v[76:79], v[128:131], a[180:183], v[76:79]
    s_waitcnt vmcnt(15)
    s_barrier
    v_mfma_f32_16x16x32_bf16 v[76:79], v[132:135], a[188:191], v[76:79]
    ds_read_b128 v[104:107], v14 offset:32768
    v_mfma_f32_16x16x32_bf16 v[72:75], v[132:135], a[184:187], v[72:75]
    ds_read_b128 v[108:111], v14 offset:36864
    v_mfma_f32_16x16x32_bf16 v[72:75], v[128:131], a[176:179], v[72:75]
    ds_read_b128 v[112:115], v14 offset:40960
    v_mfma_f32_16x16x32_bf16 v[72:75], v[124:127], a[168:171], v[72:75]
    ds_read_b128 v[116:119], v14 offset:45056
    s_add_u32 m0, s73, 99328
    v_mfma_f32_16x16x32_bf16 v[72:75], v[120:123], a[160:163], v[72:75]
    buffer_load_dwordx4 v19, s[44:47], s19 offen offset:0 sc1 lds
    s_waitcnt lgkmcnt(2)
    v_mfma_f32_16x16x32_bf16 v[80:83], v[104:107], a[160:163], v[80:83]
    s_add_u32 m0, s73, 99840
    v_mfma_f32_16x16x32_bf16 v[80:83], v[108:111], a[168:171], v[80:83]
    buffer_load_dwordx4 v19, s[44:47], s19 offen offset:512 sc1 lds
    s_waitcnt lgkmcnt(0)
    v_mfma_f32_16x16x32_bf16 v[80:83], v[112:115], a[176:179], v[80:83]
    ds_read_b128 v[120:123], v14 offset:33792
    v_mfma_f32_16x16x32_bf16 v[80:83], v[116:119], a[184:187], v[80:83]
    ds_read_b128 v[124:127], v14 offset:37888
    v_mfma_f32_16x16x32_bf16 v[84:87], v[116:119], a[188:191], v[84:87]
    ds_read_b128 v[128:131], v14 offset:41984
    v_mfma_f32_16x16x32_bf16 v[84:87], v[112:115], a[180:183], v[84:87]
    ds_read_b128 v[132:135], v14 offset:46080
    v_mfma_f32_16x16x32_bf16 v[84:87], v[108:111], a[172:175], v[84:87]
    s_add_u32 m0, s73, 101376
    v_mfma_f32_16x16x32_bf16 v[84:87], v[104:107], a[164:167], v[84:87]
    buffer_load_dwordx4 v19, s[44:47], s20 offen offset:0 sc1 lds
    s_waitcnt lgkmcnt(2)
    v_mfma_f32_16x16x32_bf16 v[76:79], v[120:123], a[196:199], v[76:79]
    s_add_u32 m0, s73, 114176
    v_mov_b32 v141, 0
    v_mfma_f32_16x16x32_bf16 v[76:79], v[124:127], a[204:207], v[76:79]
    buffer_load_dwordx4 v19, s[44:47], s20 offen offset:512 sc1 lds
    s_waitcnt lgkmcnt(0)
    v_mfma_f32_16x16x32_bf16 v[76:79], v[128:131], a[212:215], v[76:79]
    ds_read_b128 v[104:107], v14 offset:34816
    v_mfma_f32_16x16x32_bf16 v[76:79], v[132:135], a[220:223], v[76:79]
    ds_read_b128 v[108:111], v14 offset:38912
    buffer_atomic_add v141, v139, s[44:47], s11 offen offset:2060 sc0 sc1
    v_mfma_f32_16x16x32_bf16 v[72:75], v[132:135], a[216:219], v[72:75]
    ds_read_b128 v[112:115], v14 offset:43008
    v_mfma_f32_16x16x32_bf16 v[72:75], v[128:131], a[208:211], v[72:75]
    ds_read_b128 v[116:119], v14 offset:47104
    v_mfma_f32_16x16x32_bf16 v[72:75], v[124:127], a[200:203], v[72:75]
    s_add_u32 m0, s73, 115712
    v_mfma_f32_16x16x32_bf16 v[72:75], v[120:123], a[192:195], v[72:75]
    buffer_load_dwordx4 v19, s[44:47], s21 offen offset:0 sc1 lds
    s_waitcnt lgkmcnt(2)
    v_mfma_f32_16x16x32_bf16 v[80:83], v[104:107], a[192:195], v[80:83]
    s_add_u32 m0, s73, 116224
    v_mfma_f32_16x16x32_bf16 v[80:83], v[108:111], a[200:203], v[80:83]
    buffer_load_dwordx4 v19, s[44:47], s21 offen offset:512 sc1 lds
    s_waitcnt lgkmcnt(0)
    v_mfma_f32_16x16x32_bf16 v[80:83], v[112:115], a[208:211], v[80:83]
    ds_read_b128 v[120:123], v14 offset:35840
    v_mfma_f32_16x16x32_bf16 v[80:83], v[116:119], a[216:219], v[80:83]
    ds_read_b128 v[124:127], v14 offset:39936
    v_mfma_f32_16x16x32_bf16 v[84:87], v[116:119], a[220:223], v[84:87]
    ds_read_b128 v[128:131], v14 offset:44032
    v_mfma_f32_16x16x32_bf16 v[84:87], v[112:115], a[212:215], v[84:87]
    ds_read_b128 v[132:135], v14 offset:48128
    v_mfma_f32_16x16x32_bf16 v[84:87], v[108:111], a[204:207], v[84:87]
    s_add_u32 m0, s73, 117760
    v_mfma_f32_16x16x32_bf16 v[84:87], v[104:107], a[196:199], v[84:87]
    buffer_load_dwordx4 v19, s[44:47], s22 offen offset:0 sc1 lds
    s_waitcnt lgkmcnt(2)
    v_mfma_f32_16x16x32_bf16 v[76:79], v[120:123], a[228:231], v[76:79]
    v_mfma_f32_16x16x32_bf16 v[76:79], v[124:127], a[236:239], v[76:79]
    s_waitcnt lgkmcnt(0)
    v_mfma_f32_16x16x32_bf16 v[76:79], v[128:131], a[244:247], v[76:79]
    s_waitcnt vmcnt(16)
    s_barrier
    v_mfma_f32_16x16x32_bf16 v[76:79], v[132:135], a[252:255], v[76:79]
    ds_read_b128 v[104:107], v14 offset:49152
    v_mfma_f32_16x16x32_bf16 v[72:75], v[132:135], a[248:251], v[72:75]
    ds_read_b128 v[108:111], v14 offset:53248
    v_mfma_f32_16x16x32_bf16 v[72:75], v[128:131], a[240:243], v[72:75]
    ds_read_b128 v[112:115], v14 offset:57344
    v_mfma_f32_16x16x32_bf16 v[72:75], v[124:127], a[232:235], v[72:75]
    ds_read_b128 v[116:119], v14 offset:61440
    v_mfma_f32_16x16x32_bf16 v[72:75], v[120:123], a[224:227], v[72:75]
    s_waitcnt lgkmcnt(2)
    v_mfma_f32_16x16x32_bf16 v[80:83], v[104:107], a[224:227], v[80:83]
    s_add_u32 m0, s73, 130560
    v_mfma_f32_16x16x32_bf16 v[80:83], v[108:111], a[232:235], v[80:83]
    buffer_load_dwordx4 v19, s[44:47], s22 offen offset:512 sc1 lds
    s_waitcnt lgkmcnt(0)
    v_mfma_f32_16x16x32_bf16 v[80:83], v[112:115], a[240:243], v[80:83]
    ds_read_b128 v[120:123], v14 offset:50176
    v_mfma_f32_16x16x32_bf16 v[80:83], v[116:119], a[248:251], v[80:83]
    ds_read_b128 v[124:127], v14 offset:54272
    v_mfma_f32_16x16x32_bf16 v[84:87], v[116:119], a[252:255], v[84:87]
    ds_read_b128 v[128:131], v14 offset:58368
    v_mfma_f32_16x16x32_bf16 v[84:87], v[112:115], a[244:247], v[84:87]
    ds_read_b128 v[132:135], v14 offset:62464
    v_mfma_f32_16x16x32_bf16 v[84:87], v[108:111], a[236:239], v[84:87]
    s_add_u32 m0, s73, 132096
    v_mfma_f32_16x16x32_bf16 v[84:87], v[104:107], a[228:231], v[84:87]
    buffer_load_dwordx4 v19, s[44:47], s23 offen offset:0 sc1 lds
    s_waitcnt lgkmcnt(2)
    v_mfma_f32_16x16x32_bf16 v[76:79], v[120:123], v[224:227], v[76:79]
    s_add_u32 m0, s73, 132608
    s_waitcnt vmcnt(15)
    v_bitop3_b32 v43, v43, v47, s68 bitop3:0x7e
    v_bitop3_b32 v43, v43, v51, s68 bitop3:0xf6
    v_cmp_ne_u32 vcc, 0, v43
    v_mfma_f32_16x16x32_bf16 v[76:79], v[124:127], v[232:235], v[76:79]
    buffer_load_dwordx4 v19, s[44:47], s23 offen offset:512 sc1 lds
    s_waitcnt lgkmcnt(0)
    v_mfma_f32_16x16x32_bf16 v[76:79], v[128:131], v[240:243], v[76:79]
    ds_read_b128 v[104:107], v14 offset:51200
    s_cbranch_vccnz L_xs_a
L_xo_a:
    v_and_b32 v89, 0xffff0000, v40
    v_mfma_f32_16x16x32_bf16 v[76:79], v[132:135], v[248:251], v[76:79]
    ds_read_b128 v[108:111], v14 offset:55296
    v_lshlrev_b32 v88, 16, v40
    v_mfma_f32_16x16x32_bf16 v[72:75], v[132:135], v[244:247], v[72:75]
    ds_read_b128 v[112:115], v14 offset:59392
    v_and_b32 v91, 0xffff0000, v41
    v_mfma_f32_16x16x32_bf16 v[72:75], v[128:131], v[236:239], v[72:75]
    ds_read_b128 v[116:119], v14 offset:63488
    v_lshlrev_b32 v90, 16, v41
    v_mfma_f32_16x16x32_bf16 v[72:75], v[124:127], v[228:231], v[72:75]
    s_add_u32 m0, s73, 134144
    v_and_b32 v93, 0xffff0000, v42
    v_lshlrev_b32 v92, 16, v42
    v_mfma_f32_16x16x32_bf16 v[72:75], v[120:123], v[220:223], v[72:75]
    buffer_load_dwordx4 v19, s[44:47], s24 offen offset:0 sc1 lds
    s_waitcnt lgkmcnt(2)
    v_mfma_f32_16x16x32_bf16 v[80:83], v[104:107], v[220:223], v[80:83]
    v_and_b32 v95, 0xffff0000, v44
    v_lshlrev_b32 v94, 16, v44
    v_mfma_f32_16x16x32_bf16 v[80:83], v[108:111], v[228:231], v[80:83]
    v_and_b32 v97, 0xffff0000, v45
    s_waitcnt lgkmcnt(0)
    v_mfma_f32_16x16x32_bf16 v[80:83], v[112:115], v[236:239], v[80:83]
    ds_read_b128 v[120:123], v14 offset:52224
    v_lshlrev_b32 v96, 16, v45
    v_mfma_f32_16x16x32_bf16 v[80:83], v[116:119], v[244:247], v[80:83]
    ds_read_b128 v[124:127], v14 offset:56320
    v_and_b32 v99, 0xffff0000, v46
    v_lshlrev_b32 v98, 16, v46
    v_mfma_f32_16x16x32_bf16 v[84:87], v[116:119], v[248:251], v[84:87]
    ds_read_b128 v[128:131], v14 offset:60416
    s_waitcnt vmcnt(7)
    v_and_b32 v101, 0xffff0000, v48
    v_mfma_f32_16x16x32_bf16 v[84:87], v[112:115], v[240:243], v[84:87]
    ds_read_b128 v[132:135], v14 offset:64512
    v_lshlrev_b32 v100, 16, v48
    v_cmp_ne_u32 vcc, v140, v141
    v_mfma_f32_16x16x32_bf16 v[84:87], v[108:111], v[232:235], v[84:87]
    v_and_b32 v103, 0xffff0000, v49
    v_lshlrev_b32 v102, 16, v49
    v_mfma_f32_16x16x32_bf16 v[84:87], v[104:107], v[224:227], v[84:87]
    s_cbranch_vccnz L_as_b
L_ao_b:
    s_waitcnt lgkmcnt(2)
    v_mfma_f32_16x16x32_bf16 v[92:95], v[120:123], a[4:7], v[92:95]
    buffer_load_dwordx4 v[56:59], v136, s[44:47], s11 offen offset:0 sc1
    v_mfma_f32_16x16x32_bf16 v[92:95], v[124:127], a[12:15], v[92:95]
    s_waitcnt lgkmcnt(0)
    v_mfma_f32_16x16x32_bf16 v[92:95], v[128:131], a[20:23], v[92:95]
    buffer_load_dwordx4 v[60:63], v136, s[44:47], s11 offen offset:1024 sc1
    s_barrier
    v_mfma_f32_16x16x32_bf16 v[92:95], v[132:135], a[28:31], v[92:95]
    ds_read_b128 v[104:107], v14 offset:0
    buffer_load_dwordx4 v[64:67], v136, s[44:47], s11 offen offset:2048 sc1
    v_mfma_f32_16x16x32_bf16 v[88:91], v[132:135], a[24:27], v[88:91]
    ds_read_b128 v[108:111], v14 offset:4096
    v_cvt_pk_bf16_f32 v192, v72, v73
    v_mfma_f32_16x16x32_bf16 v[88:91], v[128:131], a[16:19], v[88:91]
    ds_read_b128 v[112:115], v14 offset:8192
    v_cvt_pk_bf16_f32 v193, v74, v75
    v_mfma_f32_16x16x32_bf16 v[88:91], v[124:127], a[8:11], v[88:91]
    ds_read_b128 v[116:119], v14 offset:12288
    v_cvt_pk_bf16_f32 v194, v76, v77
    v_mfma_f32_16x16x32_bf16 v[88:91], v[120:123], a[0:3], v[88:91]
    buffer_store_dwordx4 v[192:195], v136, s[44:47], s31 offen offset:0 sc1
    s_waitcnt lgkmcnt(2)
    v_mfma_f32_16x16x32_bf16 v[96:99], v[104:107], a[0:3], v[96:99]
    s_add_u32 m0, s73, 146944
    v_cvt_pk_bf16_f32 v196, v78, v79
    v_cvt_pk_bf16_f32 v197, v80, v81
    v_mfma_f32_16x16x32_bf16 v[96:99], v[108:111], a[8:11], v[96:99]
    buffer_load_dwordx4 v19, s[44:47], s24 offen offset:512 sc1 lds
    s_waitcnt lgkmcnt(0)
    v_mfma_f32_16x16x32_bf16 v[96:99], v[112:115], a[16:19], v[96:99]
    ds_read_b128 v[120:123], v14 offset:1024
    v_cvt_pk_bf16_f32 v198, v82, v83
    v_mfma_f32_16x16x32_bf16 v[96:99], v[116:119], a[24:27], v[96:99]
    buffer_store_dwordx4 v[196:199], v136, s[44:47], s31 offen offset:1024 sc1
    ds_read_b128 v[124:127], v14 offset:5120
    v_bitop3_b32 v207, v207, v211, s36 bitop3:0x7e
    v_bitop3_b32 v207, v207, v215, s36 bitop3:0xf6
    v_mfma_f32_16x16x32_bf16 v[100:103], v[116:119], a[28:31], v[100:103]
    ds_read_b128 v[128:131], v14 offset:9216
    v_cvt_pk_bf16_f32 v200, v84, v85
    v_mfma_f32_16x16x32_bf16 v[100:103], v[112:115], a[20:23], v[100:103]
    ds_read_b128 v[132:135], v14 offset:13312
    v_cvt_pk_bf16_f32 v201, v86, v87
    v_mfma_f32_16x16x32_bf16 v[100:103], v[108:111], a[12:15], v[100:103]
    buffer_store_dwordx4 v[200:203], v136, s[44:47], s31 offen offset:2048 sc1
    s_add_u32 m0, s73, 148480
    v_bitop3_b32 v207, v207, v219, s36 bitop3:0xf6
    v_cmp_ne_u32 vcc, 0, v207
    v_mfma_f32_16x16x32_bf16 v[100:103], v[104:107], a[4:7], v[100:103]
    buffer_load_dwordx4 v19, s[44:47], s25 offen offset:0 sc1 lds
    s_waitcnt lgkmcnt(2)
    v_mfma_f32_16x16x32_bf16 v[92:95], v[120:123], a[36:39], v[92:95]
    s_add_u32 m0, s73, 148992
    s_cbranch_vccnz L_xs_8
L_xo_8:
    v_mfma_f32_16x16x32_bf16 v[92:95], v[124:127], a[44:47], v[92:95]
    buffer_load_dwordx4 v19, s[44:47], s25 offen offset:512 sc1 lds
    s_waitcnt lgkmcnt(0)
    v_mfma_f32_16x16x32_bf16 v[92:95], v[128:131], a[52:55], v[92:95]
    ds_read_b128 v[104:107], v14 offset:2048
    v_and_b32 v33, 0xffff0000, v204
    v_mfma_f32_16x16x32_bf16 v[92:95], v[132:135], a[60:63], v[92:95]
    ds_read_b128 v[108:111], v14 offset:6144
    v_lshlrev_b32 v32, 16, v204
    v_mfma_f32_16x16x32_bf16 v[88:91], v[132:135], a[56:59], v[88:91]
    ds_read_b128 v[112:115], v14 offset:10240
    v_and_b32 v35, 0xffff0000, v205
    v_mfma_f32_16x16x32_bf16 v[88:91], v[128:131], a[48:51], v[88:91]
    ds_read_b128 v[116:119], v14 offset:14336
    v_mfma_f32_16x16x32_bf16 v[88:91], v[124:127], a[40:43], v[88:91]
    s_add_u32 m0, s73, 150528
    v_lshlrev_b32 v34, 16, v205
    v_mfma_f32_16x16x32_bf16 v[88:91], v[120:123], a[32:35], v[88:91]
    buffer_load_dwordx4 v19, s[44:47], s26 offen offset:0 sc1 lds
    s_waitcnt lgkmcnt(2)
    v_mfma_f32_16x16x32_bf16 v[96:99], v[104:107], a[32:35], v[96:99]
    v_add_f32 v32, v32, v27
    v_mfma_f32_16x16x32_bf16 v[96:99], v[108:111], a[40:43], v[96:99]
    v_add_f32 v33, v33, v27
    s_waitcnt lgkmcnt(0)
    v_mfma_f32_16x16x32_bf16 v[96:99], v[112:115], a[48:51], v[96:99]
    ds_read_b128 v[120:123], v14 offset:3072
    v_add_f32 v34, v34, v27
    v_mfma_f32_16x16x32_bf16 v[96:99], v[116:119], a[56:59], v[96:99]
    ds_read_b128 v[124:127], v14 offset:7168
    v_mfma_f32_16x16x32_bf16 v[100:103], v[116:119], a[60:63], v[100:103]
    ds_read_b128 v[128:131], v14 offset:11264
    v_add_f32 v35, v35, v27
    v_mfma_f32_16x16x32_bf16 v[100:103], v[112:115], a[52:55], v[100:103]
    ds_read_b128 v[132:135], v14 offset:15360
    v_and_b32 v37, 0xffff0000, v208
    v_mfma_f32_16x16x32_bf16 v[100:103], v[108:111], a[44:47], v[100:103]
    v_mfma_f32_16x16x32_bf16 v[100:103], v[104:107], a[36:39], v[100:103]
    v_lshlrev_b32 v36, 16, v208
    s_waitcnt lgkmcnt(2)
    v_mfma_f32_16x16x32_bf16 v[92:95], v[120:123], a[68:71], v[92:95]
    v_and_b32 v39, 0xffff0000, v209
    v_mfma_f32_16x16x32_bf16 v[92:95], v[124:127], a[76:79], v[92:95]
    s_waitcnt lgkmcnt(0)
    v_mfma_f32_16x16x32_bf16 v[92:95], v[128:131], a[84:87], v[92:95]
    s_waitcnt vmcnt(14)
    s_barrier
    v_lshlrev_b32 v38, 16, v209
    v_mfma_f32_16x16x32_bf16 v[92:95], v[132:135], a[92:95], v[92:95]
    ds_read_b128 v[104:107], v14 offset:16384
    v_add_f32 v32, v32, v36
    v_mfma_f32_16x16x32_bf16 v[88:91], v[132:135], a[88:91], v[88:91]
    ds_read_b128 v[108:111], v14 offset:20480
    v_mfma_f32_16x16x32_bf16 v[88:91], v[128:131], a[80:83], v[88:91]
    ds_read_b128 v[112:115], v14 offset:24576
    v_add_f32 v33, v33, v37
    v_mfma_f32_16x16x32_bf16 v[88:91], v[124:127], a[72:75], v[88:91]
    ds_read_b128 v[116:119], v14 offset:28672
    v_add_f32 v34, v34, v38
    v_mfma_f32_16x16x32_bf16 v[88:91], v[120:123], a[64:67], v[88:91]
    s_waitcnt lgkmcnt(2)
    v_mfma_f32_16x16x32_bf16 v[96:99], v[104:107], a[64:67], v[96:99]
    s_add_u32 m0, s73, 97792
    v_add_f32 v35, v35, v39
    v_mfma_f32_16x16x32_bf16 v[96:99], v[108:111], a[72:75], v[96:99]
    buffer_load_dwordx4 v19, s[44:47], s26 offen offset:512 sc1 lds
    s_waitcnt lgkmcnt(0)
    v_mfma_f32_16x16x32_bf16 v[96:99], v[112:115], a[80:83], v[96:99]
    ds_read_b128 v[120:123], v14 offset:17408
    v_and_b32 v37, 0xffff0000, v212
    v_mfma_f32_16x16x32_bf16 v[96:99], v[116:119], a[88:91], v[96:99]
    ds_read_b128 v[124:127], v14 offset:21504
    v_lshlrev_b32 v36, 16, v212
    v_mfma_f32_16x16x32_bf16 v[100:103], v[116:119], a[92:95], v[100:103]
    ds_read_b128 v[128:131], v14 offset:25600
    v_and_b32 v39, 0xffff0000, v213
    v_mfma_f32_16x16x32_bf16 v[100:103], v[112:115], a[84:87], v[100:103]
    ds_read_b128 v[132:135], v14 offset:29696
    v_mfma_f32_16x16x32_bf16 v[100:103], v[108:111], a[76:79], v[100:103]
    v_lshlrev_b32 v38, 16, v213
    v_mfma_f32_16x16x32_bf16 v[100:103], v[104:107], a[68:71], v[100:103]
    v_add_f32 v32, v32, v36
    s_waitcnt lgkmcnt(2)
    v_mfma_f32_16x16x32_bf16 v[92:95], v[120:123], a[100:103], v[92:95]
    v_mfma_f32_16x16x32_bf16 v[92:95], v[124:127], a[108:111], v[92:95]
    v_add_f32 v33, v33, v37
    s_waitcnt lgkmcnt(0)
    v_mfma_f32_16x16x32_bf16 v[92:95], v[128:131], a[116:119], v[92:95]
    ds_read_b128 v[104:107], v14 offset:18432
    v_add_f32 v34, v34, v38
    v_mfma_f32_16x16x32_bf16 v[92:95], v[132:135], a[124:127], v[92:95]
    ds_read_b128 v[108:111], v14 offset:22528
    v_add_f32 v35, v35, v39
    v_mfma_f32_16x16x32_bf16 v[88:91], v[132:135], a[120:123], v[88:91]
    ds_read_b128 v[112:115], v14 offset:26624
    v_and_b32 v37, 0xffff0000, v216
    v_mfma_f32_16x16x32_bf16 v[88:91], v[128:131], a[112:115], v[88:91]
    ds_read_b128 v[116:119], v14 offset:30720
    v_lshlrev_b32 v36, 16, v216
    v_mfma_f32_16x16x32_bf16 v[88:91], v[124:127], a[104:107], v[88:91]
L_pl_D_2:
    s_cbranch_execz L_wret
    v_and_b32 v39, 0xffff0000, v217
    v_lshlrev_b32 v38, 16, v217
    v_mfma_f32_16x16x32_bf16 v[88:91], v[120:123], a[96:99], v[88:91]
    v_add_f32 v32, v32, v36
    s_waitcnt lgkmcnt(2)
    v_mfma_f32_16x16x32_bf16 v[96:99], v[104:107], a[96:99], v[96:99]
    v_add_f32 v33, v33, v37
    v_add_f32 v34, v34, v38
    v_mfma_f32_16x16x32_bf16 v[96:99], v[108:111], a[104:107], v[96:99]
    v_add_f32 v35, v35, v39
    s_waitcnt lgkmcnt(0)
    v_mfma_f32_16x16x32_bf16 v[96:99], v[112:115], a[112:115], v[96:99]
    ds_read_b128 v[120:123], v14 offset:19456
    v_mul_f32 v36, s38, v32
    v_mfma_f32_16x16x32_bf16 v[96:99], v[116:119], a[120:123], v[96:99]
    ds_read_b128 v[124:127], v14 offset:23552
    v_mul_f32 v37, s38, v33
    v_mfma_f32_16x16x32_bf16 v[100:103], v[116:119], a[124:127], v[100:103]
    ds_read_b128 v[128:131], v14 offset:27648
    v_mul_f32 v38, s38, v34
    v_mfma_f32_16x16x32_bf16 v[100:103], v[112:115], a[116:119], v[100:103]
    ds_read_b128 v[132:135], v14 offset:31744
    v_mul_f32 v39, s38, v35
    v_mfma_f32_16x16x32_bf16 v[100:103], v[108:111], a[108:111], v[100:103]
    v_exp_f32 v36, v36
    v_mfma_f32_16x16x32_bf16 v[100:103], v[104:107], a[100:103], v[100:103]
    s_waitcnt lgkmcnt(2)
    v_mfma_f32_16x16x32_bf16 v[92:95], v[120:123], a[132:135], v[92:95]
    v_exp_f32 v37, v37
    v_mfma_f32_16x16x32_bf16 v[92:95], v[124:127], a[140:143], v[92:95]
    s_waitcnt lgkmcnt(0)
    v_mfma_f32_16x16x32_bf16 v[92:95], v[128:131], a[148:151], v[92:95]
    s_waitcnt vmcnt(11)
    s_barrier
    v_mfma_f32_16x16x32_bf16 v[92:95], v[132:135], a[156:159], v[92:95]
    ds_read_b128 v[104:107], v14 offset:32768
    v_mfma_f32_16x16x32_bf16 v[88:91], v[132:135], a[152:155], v[88:91]
    ds_read_b128 v[108:111], v14 offset:36864
    v_exp_f32 v38, v38
    v_mfma_f32_16x16x32_bf16 v[88:91], v[128:131], a[144:147], v[88:91]
    ds_read_b128 v[112:115], v14 offset:40960
    v_exp_f32 v39, v39
    v_mfma_f32_16x16x32_bf16 v[88:91], v[124:127], a[136:139], v[88:91]
    ds_read_b128 v[116:119], v14 offset:45056
    v_mul_f32 v180, v180, v32
    v_mfma_f32_16x16x32_bf16 v[88:91], v[120:123], a[128:131], v[88:91]
    v_mul_f32 v181, v181, v33
    s_waitcnt lgkmcnt(2)
    v_mfma_f32_16x16x32_bf16 v[96:99], v[104:107], a[128:131], v[96:99]
    v_mul_f32 v182, v182, v34
    v_mul_f32 v183, v183, v35
    v_mfma_f32_16x16x32_bf16 v[96:99], v[108:111], a[136:139], v[96:99]
    v_add_f32 v36, 1.0, v36
    s_waitcnt lgkmcnt(0)
    v_mfma_f32_16x16x32_bf16 v[96:99], v[112:115], a[144:147], v[96:99]
    ds_read_b128 v[120:123], v14 offset:33792
    v_add_f32 v37, 1.0, v37
    v_mfma_f32_16x16x32_bf16 v[96:99], v[116:119], a[152:155], v[96:99]
    ds_read_b128 v[124:127], v14 offset:37888
    v_add_f32 v38, 1.0, v38
    v_mfma_f32_16x16x32_bf16 v[100:103], v[116:119], a[156:159], v[100:103]
    ds_read_b128 v[128:131], v14 offset:41984
    v_add_f32 v39, 1.0, v39
    v_mfma_f32_16x16x32_bf16 v[100:103], v[112:115], a[148:151], v[100:103]
    ds_read_b128 v[132:135], v14 offset:46080
    v_rcp_f32 v36, v36
    v_mfma_f32_16x16x32_bf16 v[100:103], v[108:111], a[140:143], v[100:103]
    v_rcp_f32 v37, v37
    v_mfma_f32_16x16x32_bf16 v[100:103], v[104:107], a[132:135], v[100:103]
    v_rcp_f32 v38, v38
    s_waitcnt lgkmcnt(2)
    v_mfma_f32_16x16x32_bf16 v[92:95], v[120:123], a[164:167], v[92:95]
    s_waitcnt vmcnt(8)
    v_bitop3_b32 v59, v59, v63, s68 bitop3:0x7e
    v_rcp_f32 v39, v39
    v_mfma_f32_16x16x32_bf16 v[92:95], v[124:127], a[172:175], v[92:95]
    buffer_load_dwordx4 v[72:75], v136, s[44:47], s12 offen offset:0 sc1
    s_waitcnt lgkmcnt(0)
    v_mfma_f32_16x16x32_bf16 v[92:95], v[128:131], a[180:183], v[92:95]
    ds_read_b128 v[104:107], v14 offset:34816
    v_bitop3_b32 v59, v59, v67, s68 bitop3:0xf6
    v_mfma_f32_16x16x32_bf16 v[92:95], v[132:135], a[188:191], v[92:95]
    ds_read_b128 v[108:111], v14 offset:38912
    v_cmp_ne_u32 vcc, 0, v59
    v_mfma_f32_16x16x32_bf16 v[88:91], v[132:135], a[184:187], v[88:91]
    ds_read_b128 v[112:115], v14 offset:43008
    buffer_load_dwordx4 v[76:79], v136, s[44:47], s12 offen offset:1024 sc1
    v_mfma_f32_16x16x32_bf16 v[88:91], v[128:131], a[176:179], v[88:91]
    ds_read_b128 v[116:119], v14 offset:47104
    s_cbranch_vccnz L_xs_b
L_xo_b:
    v_fma_f32 v180, v180, v36, v160
    v_mfma_f32_16x16x32_bf16 v[88:91], v[124:127], a[168:171], v[88:91]
    buffer_load_dwordx4 v[80:83], v136, s[44:47], s12 offen offset:2048 sc1
    v_and_b32 v41, 0xffff0000, v56
    v_mfma_f32_16x16x32_bf16 v[88:91], v[120:123], a[160:163], v[88:91]
    v_lshlrev_b32 v40, 16, v56
    s_waitcnt lgkmcnt(2)
    v_mfma_f32_16x16x32_bf16 v[96:99], v[104:107], a[160:163], v[96:99]
    v_and_b32 v43, 0xffff0000, v57
    v_fma_f32 v181, v181, v37, v161
    v_mfma_f32_16x16x32_bf16 v[96:99], v[108:111], a[168:171], v[96:99]
    v_lshlrev_b32 v42, 16, v57
    s_waitcnt lgkmcnt(0)
    v_mfma_f32_16x16x32_bf16 v[96:99], v[112:115], a[176:179], v[96:99]
    ds_read_b128 v[120:123], v14 offset:35840
    v_and_b32 v45, 0xffff0000, v58
    v_mfma_f32_16x16x32_bf16 v[96:99], v[116:119], a[184:187], v[96:99]
    ds_read_b128 v[124:127], v14 offset:39936
    v_fma_f32 v182, v182, v38, v162
    v_mfma_f32_16x16x32_bf16 v[100:103], v[116:119], a[188:191], v[100:103]
    ds_read_b128 v[128:131], v14 offset:44032
    v_lshlrev_b32 v44, 16, v58
    v_mfma_f32_16x16x32_bf16 v[100:103], v[112:115], a[180:183], v[100:103]
    ds_read_b128 v[132:135], v14 offset:48128
    v_and_b32 v47, 0xffff0000, v60
    v_mfma_f32_16x16x32_bf16 v[100:103], v[108:111], a[172:175], v[100:103]
    v_lshlrev_b32 v46, 16, v60
    v_fma_f32 v183, v183, v39, v163
    v_mfma_f32_16x16x32_bf16 v[100:103], v[104:107], a[164:167], v[100:103]
    v_and_b32 v49, 0xffff0000, v61
    s_waitcnt lgkmcnt(2)
    v_mfma_f32_16x16x32_bf16 v[92:95], v[120:123], a[196:199], v[92:95]
    v_lshlrev_b32 v48, 16, v61
    v_cvt_pk_bf16_f32 v142, v180, v181
    v_mfma_f32_16x16x32_bf16 v[92:95], v[124:127], a[204:207], v[92:95]
    v_and_b32 v51, 0xffff0000, v62
    s_waitcnt lgkmcnt(0)
    v_mfma_f32_16x16x32_bf16 v[92:95], v[128:131], a[212:215], v[92:95]
    s_waitcnt vmcnt(4)
    s_barrier
    v_lshlrev_b32 v50, 16, v62
    v_mfma_f32_16x16x32_bf16 v[92:95], v[132:135], a[220:223], v[92:95]
    ds_read_b128 v[104:107], v14 offset:49152
    v_cvt_pk_bf16_f32 v143, v182, v183
    v_mfma_f32_16x16x32_bf16 v[88:91], v[132:135], a[216:219], v[88:91]
    ds_read_b128 v[108:111], v14 offset:53248
    v_and_b32 v53, 0xffff0000, v64
    v_mfma_f32_16x16x32_bf16 v[88:91], v[128:131], a[208:211], v[88:91]
    ds_read_b128 v[112:115], v14 offset:57344
    v_lshlrev_b32 v52, 16, v64
    v_mfma_f32_16x16x32_bf16 v[88:91], v[124:127], a[200:203], v[88:91]
    ds_read_b128 v[116:119], v14 offset:61440
    v_and_b32 v55, 0xffff0000, v65
    v_mfma_f32_16x16x32_bf16 v[88:91], v[120:123], a[192:195], v[88:91]
    v_lshlrev_b32 v54, 16, v65
    s_waitcnt lgkmcnt(2)
    v_mfma_f32_16x16x32_bf16 v[96:99], v[104:107], a[192:195], v[96:99]
    v_mfma_f32_16x16x32_bf16 v[96:99], v[108:111], a[200:203], v[96:99]
    s_waitcnt lgkmcnt(0)
    v_mfma_f32_16x16x32_bf16 v[96:99], v[112:115], a[208:211], v[96:99]
    ds_read_b128 v[120:123], v14 offset:50176
    v_add_f32 v92, v92, v44
    v_add_f32 v93, v93, v45
    v_mfma_f32_16x16x32_bf16 v[96:99], v[116:119], a[216:219], v[96:99]
    ds_read_b128 v[124:127], v14 offset:54272
    v_add_f32 v94, v94, v46
    v_mfma_f32_16x16x32_bf16 v[100:103], v[116:119], a[220:223], v[100:103]
    ds_read_b128 v[128:131], v14 offset:58368
    v_add_f32 v95, v95, v47
    v_add_f32 v88, v88, v40
    v_mfma_f32_16x16x32_bf16 v[100:103], v[112:115], a[212:215], v[100:103]
    ds_read_b128 v[132:135], v14 offset:62464
    v_add_f32 v89, v89, v41
    v_mfma_f32_16x16x32_bf16 v[100:103], v[108:111], a[204:207], v[100:103]
    v_add_f32 v90, v90, v42
    v_add_f32 v91, v91, v43
    v_mfma_f32_16x16x32_bf16 v[100:103], v[104:107], a[196:199], v[100:103]
    s_waitcnt lgkmcnt(2)
    v_mfma_f32_16x16x32_bf16 v[92:95], v[120:123], a[228:231], v[92:95]
    v_mfma_f32_16x16x32_bf16 v[92:95], v[124:127], a[236:239], v[92:95]
    s_waitcnt lgkmcnt(0)
    v_mfma_f32_16x16x32_bf16 v[92:95], v[128:131], a[244:247], v[92:95]
    ds_read_b128 v[104:107], v14 offset:51200
    v_add_f32 v96, v96, v48
    v_add_f32 v97, v97, v49
    v_mfma_f32_16x16x32_bf16 v[92:95], v[132:135], a[252:255], v[92:95]
    ds_read_b128 v[108:111], v14 offset:55296
    v_add_f32 v98, v98, v50
    v_mfma_f32_16x16x32_bf16 v[88:91], v[132:135], a[248:251], v[88:91]
    ds_read_b128 v[112:115], v14 offset:59392
    v_add_f32 v99, v99, v51
    v_add_f32 v100, v100, v52
    v_mfma_f32_16x16x32_bf16 v[88:91], v[128:131], a[240:243], v[88:91]
    ds_read_b128 v[116:119], v14 offset:63488
    v_add_f32 v101, v101, v53
    v_mfma_f32_16x16x32_bf16 v[88:91], v[124:127], a[232:235], v[88:91]
    v_add_f32 v102, v102, v54
    v_add_f32 v103, v103, v55
    v_mfma_f32_16x16x32_bf16 v[88:91], v[120:123], a[224:227], v[88:91]
    s_waitcnt lgkmcnt(2)
    v_mfma_f32_16x16x32_bf16 v[96:99], v[104:107], a[224:227], v[96:99]
    v_mfma_f32_16x16x32_bf16 v[96:99], v[108:111], a[232:235], v[96:99]
    s_waitcnt lgkmcnt(0)
    v_mfma_f32_16x16x32_bf16 v[96:99], v[112:115], a[240:243], v[96:99]
    ds_read_b128 v[120:123], v14 offset:52224
    v_mfma_f32_16x16x32_bf16 v[96:99], v[116:119], a[248:251], v[96:99]
    ds_read_b128 v[124:127], v14 offset:56320
    v_mfma_f32_16x16x32_bf16 v[100:103], v[116:119], a[252:255], v[100:103]
    buffer_store_dwordx2 v[142:143], v253, s[64:67], 0 offen sc1
    ds_read_b128 v[128:131], v14 offset:60416
    v_mfma_f32_16x16x32_bf16 v[100:103], v[112:115], a[244:247], v[100:103]
    ds_read_b128 v[132:135], v14 offset:64512
    v_mfma_f32_16x16x32_bf16 v[100:103], v[108:111], a[236:239], v[100:103]
    v_mfma_f32_16x16x32_bf16 v[100:103], v[104:107], a[228:231], v[100:103]
    s_waitcnt lgkmcnt(2)
    v_mfma_f32_16x16x32_bf16 v[92:95], v[120:123], v[224:227], v[92:95]
    v_mfma_f32_16x16x32_bf16 v[92:95], v[124:127], v[232:235], v[92:95]
    s_waitcnt lgkmcnt(0)
    v_mfma_f32_16x16x32_bf16 v[92:95], v[128:131], v[240:243], v[92:95]
    s_waitcnt vmcnt(4)
    s_barrier
    v_mfma_f32_16x16x32_bf16 v[92:95], v[132:135], v[248:251], v[92:95]
    ds_read_b128 v[104:107], v14 offset:0
    v_mfma_f32_16x16x32_bf16 v[88:91], v[132:135], v[244:247], v[88:91]
    ds_read_b128 v[108:111], v14 offset:4096
    v_mfma_f32_16x16x32_bf16 v[88:91], v[128:131], v[236:239], v[88:91]
    ds_read_b128 v[112:115], v14 offset:8192
    v_mfma_f32_16x16x32_bf16 v[88:91], v[124:127], v[228:231], v[88:91]
    ds_read_b128 v[116:119], v14 offset:12288
    v_mfma_f32_16x16x32_bf16 v[88:91], v[120:123], v[220:223], v[88:91]
    s_waitcnt lgkmcnt(2)
    v_mfma_f32_16x16x32_bf16 v[96:99], v[104:107], v[220:223], v[96:99]
    v_mfma_f32_16x16x32_bf16 v[96:99], v[108:111], v[228:231], v[96:99]
    s_waitcnt lgkmcnt(0)
    v_mfma_f32_16x16x32_bf16 v[96:99], v[112:115], v[236:239], v[96:99]
    v_mfma_f32_16x16x32_bf16 v[96:99], v[116:119], v[244:247], v[96:99]
    v_mfma_f32_16x16x32_bf16 v[100:103], v[116:119], v[248:251], v[100:103]
    v_mfma_f32_16x16x32_bf16 v[100:103], v[112:115], v[240:243], v[100:103]
    v_mfma_f32_16x16x32_bf16 v[100:103], v[108:111], v[232:235], v[100:103]
    v_mfma_f32_16x16x32_bf16 v[100:103], v[104:107], v[224:227], v[100:103]
    s_waitcnt vmcnt(1)
    v_bitop3_b32 v75, v75, v79, s68 bitop3:0x7e
    v_bitop3_b32 v75, v75, v83, s68 bitop3:0xf6
    v_cmp_ne_u32 vcc, 0, v75
    s_cbranch_vccnz L_xs_z
L_xo_z:
    v_and_b32 v41, 0xffff0000, v72
    v_lshlrev_b32 v40, 16, v72
    v_and_b32 v43, 0xffff0000, v73
    v_lshlrev_b32 v42, 16, v73
    v_and_b32 v45, 0xffff0000, v74
    v_lshlrev_b32 v44, 16, v74
    v_and_b32 v47, 0xffff0000, v76
    v_lshlrev_b32 v46, 16, v76
    v_and_b32 v49, 0xffff0000, v77
    v_lshlrev_b32 v48, 16, v77
    v_and_b32 v51, 0xffff0000, v78
    v_lshlrev_b32 v50, 16, v78
    v_and_b32 v53, 0xffff0000, v80
    v_lshlrev_b32 v52, 16, v80
    v_and_b32 v55, 0xffff0000, v81
    v_lshlrev_b32 v54, 16, v81
    v_pk_add_f32 v[88:89], v[88:89], v[40:41]
    v_pk_add_f32 v[90:91], v[90:91], v[42:43]
    v_pk_add_f32 v[96:97], v[96:97], v[48:49]
    v_pk_add_f32 v[98:99], v[98:99], v[50:51]
    v_pk_mul_f32 v[56:57], v[88:89], s[38:39] op_sel_hi:[1,0]
    v_pk_mul_f32 v[58:59], v[90:91], s[38:39] op_sel_hi:[1,0]
    v_pk_mul_f32 v[64:65], v[96:97], s[38:39] op_sel_hi:[1,0]
    v_pk_mul_f32 v[66:67], v[98:99], s[38:39] op_sel_hi:[1,0]
    v_exp_f32 v56, v56
    v_exp_f32 v57, v57
    v_exp_f32 v58, v58
    v_exp_f32 v59, v59
    v_exp_f32 v64, v64
    v_exp_f32 v65, v65
    v_exp_f32 v66, v66
    v_exp_f32 v67, v67
    v_pk_mul_f32 v[164:165], v[164:165], v[88:89]
    v_pk_mul_f32 v[166:167], v[166:167], v[90:91]
    v_pk_mul_f32 v[172:173], v[172:173], v[96:97]
    v_pk_mul_f32 v[174:175], v[174:175], v[98:99]
    v_pk_add_f32 v[56:57], v[56:57], 1.0 op_sel_hi:[1,0]
    v_pk_add_f32 v[58:59], v[58:59], 1.0 op_sel_hi:[1,0]
    v_pk_add_f32 v[64:65], v[64:65], 1.0 op_sel_hi:[1,0]
    v_pk_add_f32 v[66:67], v[66:67], 1.0 op_sel_hi:[1,0]
    v_rcp_f32 v56, v56
    v_rcp_f32 v57, v57
    v_rcp_f32 v58, v58
    v_rcp_f32 v59, v59
    v_rcp_f32 v64, v64
    v_rcp_f32 v65, v65
    v_rcp_f32 v66, v66
    v_rcp_f32 v67, v67
    v_pk_fma_f32 v[164:165], v[164:165], v[56:57], v[144:145]
    v_pk_fma_f32 v[166:167], v[166:167], v[58:59], v[146:147]
    v_pk_fma_f32 v[172:173], v[172:173], v[64:65], v[152:153]
    v_pk_fma_f32 v[174:175], v[174:175], v[66:67], v[154:155]
    v_cvt_pk_bf16_f32 v88, v164, v165
    v_cvt_pk_bf16_f32 v90, v172, v173
    v_cvt_pk_bf16_f32 v89, v166, v167
    v_cvt_pk_bf16_f32 v91, v174, v175
    v_permlane16_swap_b32 v88, v90
    s_nop 0
    v_permlane16_swap_b32 v89, v91
    buffer_store_dwordx4 v[88:91], v252, s[64:67], 0 offen sc1
    v_pk_add_f32 v[92:93], v[92:93], v[44:45]
    v_pk_add_f32 v[94:95], v[94:95], v[46:47]
    v_pk_add_f32 v[100:101], v[100:101], v[52:53]
    v_pk_add_f32 v[102:103], v[102:103], v[54:55]
    v_pk_mul_f32 v[60:61], v[92:93], s[38:39] op_sel_hi:[1,0]
    v_pk_mul_f32 v[62:63], v[94:95], s[38:39] op_sel_hi:[1,0]
    v_pk_mul_f32 v[68:69], v[100:101], s[38:39] op_sel_hi:[1,0]
    v_pk_mul_f32 v[70:71], v[102:103], s[38:39] op_sel_hi:[1,0]
    v_exp_f32 v60, v60
    v_exp_f32 v61, v61
    v_exp_f32 v62, v62
    v_exp_f32 v63, v63
    v_exp_f32 v68, v68
    v_exp_f32 v69, v69
    v_exp_f32 v70, v70
    v_exp_f32 v71, v71
    v_pk_mul_f32 v[168:169], v[168:169], v[92:93]
    v_pk_mul_f32 v[170:171], v[170:171], v[94:95]
    v_pk_mul_f32 v[176:177], v[176:177], v[100:101]
    v_pk_mul_f32 v[178:179], v[178:179], v[102:103]
    v_pk_add_f32 v[60:61], v[60:61], 1.0 op_sel_hi:[1,0]
    v_pk_add_f32 v[62:63], v[62:63], 1.0 op_sel_hi:[1,0]
    v_pk_add_f32 v[68:69], v[68:69], 1.0 op_sel_hi:[1,0]
    v_pk_add_f32 v[70:71], v[70:71], 1.0 op_sel_hi:[1,0]
    v_rcp_f32 v60, v60
    v_rcp_f32 v61, v61
    v_rcp_f32 v62, v62
    v_rcp_f32 v63, v63
    v_rcp_f32 v68, v68
    v_rcp_f32 v69, v69
    v_rcp_f32 v70, v70
    v_rcp_f32 v71, v71
    v_pk_fma_f32 v[168:169], v[168:169], v[60:61], v[148:149]
    v_pk_fma_f32 v[170:171], v[170:171], v[62:63], v[150:151]
    v_pk_fma_f32 v[176:177], v[176:177], v[68:69], v[156:157]
    v_pk_fma_f32 v[178:179], v[178:179], v[70:71], v[158:159]
    v_cvt_pk_bf16_f32 v92, v168, v169
    v_cvt_pk_bf16_f32 v94, v176, v177
    v_cvt_pk_bf16_f32 v93, v170, v171
    v_cvt_pk_bf16_f32 v95, v178, v179
    v_permlane16_swap_b32 v92, v94
    s_nop 0
    v_permlane16_swap_b32 v93, v95
    buffer_store_dwordx4 v[92:95], v252, s[64:67], s40 offen sc1
    s_endpgm
L_segE:
.p2align 12
L_aux:
    s_mul_i32 s84, s101, 14
    s_lshr_b32 s84, s84, 2
    s_add_u32 s84, s84, 0
    s_add_u32 s85, s84, 1
    s_cmp_eq_u32 s85, 14
    s_cselect_b32 s85, 0, s85
    s_add_u32 s86, s85, 1
    s_cmp_eq_u32 s86, 14
    s_cselect_b32 s86, 0, s86
    s_add_u32 s87, s86, 1
    s_cmp_eq_u32 s87, 14
    s_cselect_b32 s87, 0, s87
    s_add_u32 s88, s87, 1
    s_cmp_eq_u32 s88, 14
    s_cselect_b32 s88, 0, s88
    s_add_u32 s89, s88, 1
    s_cmp_eq_u32 s89, 14
    s_cselect_b32 s89, 0, s89
    s_add_u32 s90, s89, 1
    s_cmp_eq_u32 s90, 14
    s_cselect_b32 s90, 0, s90
    s_add_u32 s91, s90, 1
    s_cmp_eq_u32 s91, 14
    s_cselect_b32 s91, 0, s91
    s_add_u32 s92, s91, 1
    s_cmp_eq_u32 s92, 14
    s_cselect_b32 s92, 0, s92
    s_add_u32 s93, s92, 1
    s_cmp_eq_u32 s93, 14
    s_cselect_b32 s93, 0, s93
    s_add_u32 s94, s93, 1
    s_cmp_eq_u32 s94, 14
    s_cselect_b32 s94, 0, s94
    s_add_u32 s95, s94, 1
    s_cmp_eq_u32 s95, 14
    s_cselect_b32 s95, 0, s95
    s_add_u32 s96, s95, 1
    s_cmp_eq_u32 s96, 14
    s_cselect_b32 s96, 0, s96
    s_add_u32 s97, s96, 1
    s_cmp_eq_u32 s97, 14
    s_cselect_b32 s97, 0, s97
    s_mul_i32 s98, s101, 4
    s_lshr_b32 s98, s98, 2
    s_add_u32 s98, s98, 14
    s_add_u32 s99, s98, 1
    s_cmp_eq_u32 s99, 18
    s_cselect_b32 s99, 14, s99
    s_add_u32 s100, s99, 1
    s_cmp_eq_u32 s100, 18
    s_cselect_b32 s100, 14, s100
    s_add_u32 s101, s100, 1
    s_cmp_eq_u32 s101, 18
    s_cselect_b32 s101, 14, s101
    s_lshl2_add_u32 s7, s5, s6
    s_add_u32 s7, s7, 188
    s_add_u32 s8, s5, 248
    s_cmp_eq_u32 s6, 27
    s_cselect_b32 s75, s8, s7
    s_mov_b32 s48, s24
    s_and_b32 s49, s25, 0xffff
    s_mov_b32 s50, 2359296
    s_mov_b32 s51, 0x20000
    v_lshlrev_b32 v240, 4, v2
    s_mul_i32 s74, s3, 16640
    s_add_u32 s74, s74, 73728
    s_sub_u32 s69, s75, 216
    s_lshl_b32 s70, s69, 4
    s_add_u32 s70, s70, s3
    s_lshl_b32 s12, s70, 12
    s_lshl_b32 s70, s70, 1
    s_mov_b32 s9, 144896
    s_mov_b32 s11, 8192
    v_mul_u32_u24 v48, 1216, v3
    v_mad_u32_u24 v48, v4, 12, v48
    v_add_u32 v48, s9, v48
    v_mov_b32 v47, 0x40000000
    v_lshlrev_b32 v3, 3, v3
    s_lshl_b32 s5, s68, 6
    s_add_u32 s5, s5, 12386304
    v_cmp_eq_u32 vcc, 0, v4
    s_nop 1
    v_cndmask_b32 v49, v47, v3, vcc
    v_lshrrev_b32 v5, 4, v0
    v_and_b32 v4, 3, v2
    v_lshlrev_b32 v4, 3, v4
    v_lshl_add_u32 v5, v5, 5, v4
    v_bfe_u32 v6, v2, 2, 2
    v_mul_u32_u24 v4, 1216, v6
    v_mul_u32_u24 v6, 1152, v6
    v_add3_u32 v50, v4, v5, s9
    v_add3_u32 v51, v6, v5, s11
    s_mul_i32 s4, s3, 2176
    v_add_u32 v55, s4, v51
    v_lshlrev_b32 v52, 4, v0
    s_add_u32 s7, s15, 4096
    s_add_u32 s8, s15, 8192
    s_cmp_eq_u32 s3, 0
    s_cselect_b32 s8, s8, 0x40000000
    v_add_u32 v53, 2359296, v52
    v_mov_b32 v54, 0
    s_mul_i32 s4, s3, 1028
    s_sub_u32 s4, 8204, s4
    v_add_u32 v90, s4, v53
    s_bfe_u32 s6, s68, 0x20001
    s_lshl_b32 s6, s6, 6
    s_lshr_b32 s9, s68, 3
    s_lshl1_add_u32 s6, s9, s6
    s_and_b32 s9, s68, 1
    s_add_u32 s6, s6, s9
    s_lshl_b32 s4, s6, 2
    s_add_u32 s4, s4, 12533760
    v_lshl_add_u32 v1, v0, 10, s4
    s_lshl_b32 s4, s68, 2
    s_add_u32 s4, s4, 12599296
    v_lshl_add_u32 v46, v0, 10, s4
    v_cmp_gt_u32 vcc, 8, v0
    s_nop 1
    v_cndmask_b32 v1, v47, v1, vcc
    v_cmp_gt_u32 vcc, 4, v0
    s_nop 1
    v_cndmask_b32 v46, v47, v46, vcc
    s_waitcnt vmcnt(9)
    v_and_b32 v21, 0xffff0000, v8
    v_lshlrev_b32 v20, 16, v8
    v_and_b32 v23, 0xffff0000, v9
    v_lshlrev_b32 v22, 16, v9
    v_and_b32 v25, 0xffff0000, v10
    v_lshlrev_b32 v24, 16, v10
    v_and_b32 v27, 0xffff0000, v12
    v_lshlrev_b32 v26, 16, v12
    v_and_b32 v29, 0xffff0000, v13
    v_lshlrev_b32 v28, 16, v13
    v_and_b32 v31, 0xffff0000, v14
    v_lshlrev_b32 v30, 16, v14
    v_and_b32 v33, 0xffff0000, v16
    v_lshlrev_b32 v32, 16, v16
    v_and_b32 v35, 0xffff0000, v17
    v_lshlrev_b32 v34, 16, v17
    v_and_b32 v37, 0xffff0000, v18
    v_lshlrev_b32 v36, 16, v18
    v_pk_add_f32 v[38:39], v[20:21], v[22:23]
    v_pk_add_f32 v[40:41], v[24:25], v[26:27]
    v_pk_add_f32 v[42:43], v[28:29], v[30:31]
    v_pk_add_f32 v[44:45], v[32:33], v[34:35]
    v_pk_add_f32 v[38:39], v[38:39], v[40:41]
    v_pk_add_f32 v[42:43], v[42:43], v[44:45]
    v_pk_add_f32 v[38:39], v[38:39], v[36:37]
    v_pk_add_f32 v[38:39], v[38:39], v[42:43]
    v_add_f32 v56, v38, v39
    s_nop 1
    v_add_f32_dpp v56, v56, v56 row_ror:8 row_mask:0xf bank_mask:0xf
    s_nop 1
    v_add_f32_dpp v56, v56, v56 row_ror:4 row_mask:0xf bank_mask:0xf
    s_nop 1
    v_add_f32_dpp v56, v56, v56 row_ror:2 row_mask:0xf bank_mask:0xf
    s_nop 1
    v_add_f32_dpp v56, v56, v56 row_ror:1 row_mask:0xf bank_mask:0xf
    v_mov_b32 v57, v56
    s_nop 1
    v_permlane16_swap_b32 v56, v57
    v_add_f32 v56, v56, v57
    v_mul_f32 v56, 0x3ae38e39, v56
    v_pk_add_f32 v[20:21], v[20:21], v[56:57] op_sel_hi:[1,0] neg_lo:[0,1] neg_hi:[0,1]
    v_pk_add_f32 v[22:23], v[22:23], v[56:57] op_sel_hi:[1,0] neg_lo:[0,1] neg_hi:[0,1]
    v_pk_add_f32 v[24:25], v[24:25], v[56:57] op_sel_hi:[1,0] neg_lo:[0,1] neg_hi:[0,1]
    v_pk_add_f32 v[26:27], v[26:27], v[56:57] op_sel_hi:[1,0] neg_lo:[0,1] neg_hi:[0,1]
    v_pk_add_f32 v[28:29], v[28:29], v[56:57] op_sel_hi:[1,0] neg_lo:[0,1] neg_hi:[0,1]
    v_pk_add_f32 v[30:31], v[30:31], v[56:57] op_sel_hi:[1,0] neg_lo:[0,1] neg_hi:[0,1]
    v_pk_add_f32 v[32:33], v[32:33], v[56:57] op_sel_hi:[1,0] neg_lo:[0,1] neg_hi:[0,1]
    v_pk_add_f32 v[34:35], v[34:35], v[56:57] op_sel_hi:[1,0] neg_lo:[0,1] neg_hi:[0,1]
    v_pk_add_f32 v[36:37], v[36:37], v[56:57] op_sel_hi:[1,0] neg_lo:[0,1] neg_hi:[0,1]
    v_pk_mul_f32 v[38:39], v[20:21], v[20:21]
    v_pk_mul_f32 v[40:41], v[22:23], v[22:23]
    v_pk_fma_f32 v[38:39], v[24:25], v[24:25], v[38:39]
    v_pk_fma_f32 v[40:41], v[26:27], v[26:27], v[40:41]
    v_pk_fma_f32 v[38:39], v[28:29], v[28:29], v[38:39]
    v_pk_fma_f32 v[40:41], v[30:31], v[30:31], v[40:41]
    v_pk_fma_f32 v[38:39], v[32:33], v[32:33], v[38:39]
    v_pk_fma_f32 v[40:41], v[34:35], v[34:35], v[40:41]
    v_pk_fma_f32 v[38:39], v[36:37], v[36:37], v[38:39]
    v_pk_add_f32 v[38:39], v[38:39], v[40:41]
    v_add_f32 v18, v38, v39
    s_nop 1
    v_add_f32_dpp v18, v18, v18 row_ror:8 row_mask:0xf bank_mask:0xf
    s_nop 1
    v_add_f32_dpp v18, v18, v18 row_ror:4 row_mask:0xf bank_mask:0xf
    s_nop 1
    v_add_f32_dpp v18, v18, v18 row_ror:2 row_mask:0xf bank_mask:0xf
    s_nop 1
    v_add_f32_dpp v18, v18, v18 row_ror:1 row_mask:0xf bank_mask:0xf
    v_mov_b32 v19, v18
    s_nop 1
    v_permlane16_swap_b32 v18, v19
    v_add_f32 v18, v18, v19
    v_mul_f32 v18, 0x3ae38e39, v18
    v_cvt_pk_bf16_f32 v38, v56, v18
    v_lshlrev_b32 v106, 16, v38
    v_and_b32 v38, 0xffff0000, v38
    v_add_f32 v38, 0x3727c5ac, v38
    v_sub_f32 v56, v56, v106
    v_cvt_pk_bf16_f32 v38, v38, v38
    v_lshlrev_b32 v38, 16, v38
    v_sqrt_f32 v38, v38
    s_nop 0
    v_cvt_pk_bf16_f32 v38, v38, v38
    v_lshlrev_b32 v38, 16, v38
    v_rcp_f32 v107, v38
    s_nop 0
    v_mul_f32 v56, v56, v107
    v_mul_f32 v18, v18, v107
    v_mul_f32 v18, v18, v107
    v_cvt_pk_bf16_f32 v38, v56, v18
    v_lshlrev_b32 v39, 16, v38
    v_and_b32 v38, 0xffff0000, v38
    v_add_f32 v38, 0x3727c5ac, v38
    v_sub_f32 v56, v56, v39
    v_cvt_pk_bf16_f32 v38, v38, v38
    v_lshlrev_b32 v38, 16, v38
    v_sqrt_f32 v38, v38
    s_nop 0
    v_cvt_pk_bf16_f32 v38, v38, v38
    v_lshlrev_b32 v38, 16, v38
    v_rcp_f32 v38, v38
    s_nop 0
    v_mul_f32 v18, v107, v38
    v_mul_f32 v56, v56, v38
    v_pk_fma_f32 v[20:21], v[20:21], v[18:19], v[56:57] op_sel_hi:[1,0,0]
    v_pk_fma_f32 v[22:23], v[22:23], v[18:19], v[56:57] op_sel_hi:[1,0,0]
    v_pk_fma_f32 v[24:25], v[24:25], v[18:19], v[56:57] op_sel_hi:[1,0,0]
    v_pk_fma_f32 v[26:27], v[26:27], v[18:19], v[56:57] op_sel_hi:[1,0,0]
    v_pk_fma_f32 v[28:29], v[28:29], v[18:19], v[56:57] op_sel_hi:[1,0,0]
    v_pk_fma_f32 v[30:31], v[30:31], v[18:19], v[56:57] op_sel_hi:[1,0,0]
    v_pk_fma_f32 v[32:33], v[32:33], v[18:19], v[56:57] op_sel_hi:[1,0,0]
    v_pk_fma_f32 v[34:35], v[34:35], v[18:19], v[56:57] op_sel_hi:[1,0,0]
    v_pk_fma_f32 v[36:37], v[36:37], v[18:19], v[56:57] op_sel_hi:[1,0,0]
    v_cvt_pk_bf16_f32 v8, v20, v21
    v_cvt_pk_bf16_f32 v9, v22, v23
    v_cvt_pk_bf16_f32 v10, v24, v25
    v_cvt_pk_bf16_f32 v11, v26, v27
    v_cvt_pk_bf16_f32 v12, v28, v29
    v_cvt_pk_bf16_f32 v13, v30, v31
    v_cvt_pk_bf16_f32 v14, v32, v33
    v_cvt_pk_bf16_f32 v15, v34, v35
    v_cvt_pk_bf16_f32 v16, v36, v37
    ds_write_b32 v48, v8 offset:0
    ds_write_b32 v48, v9 offset:4
    ds_write_b32 v48, v10 offset:8
    ds_write_b32 v48, v11 offset:384
    ds_write_b32 v48, v12 offset:388
    ds_write_b32 v48, v13 offset:392
    ds_write_b32 v48, v14 offset:768
    ds_write_b32 v48, v15 offset:772
    ds_write_b32 v48, v16 offset:776
    buffer_store_dwordx2 v[106:107], v49, s[44:47], s5 offen sc1
    s_waitcnt lgkmcnt(0)
    s_barrier
    ds_read_b64_tr_b16 v[20:21], v50 offset:0
    ds_read_b64_tr_b16 v[22:23], v50 offset:4864
    ds_read_b64_tr_b16 v[24:25], v50 offset:512
    ds_read_b64_tr_b16 v[26:27], v50 offset:5376
    ds_read_b64_tr_b16 v[28:29], v50 offset:1024
    ds_read_b64_tr_b16 v[30:31], v50 offset:5888
    s_waitcnt lgkmcnt(4)
    buffer_store_dwordx4 v[20:23], v52, s[44:47], s15 offen sc1
    s_waitcnt lgkmcnt(2)
    buffer_store_dwordx4 v[24:27], v52, s[44:47], s7 offen sc1
    s_waitcnt lgkmcnt(0)
    buffer_store_dwordx4 v[28:31], v52, s[44:47], s8 offen sc1
    buffer_load_dword v45, v54, s[64:67], 0 offen sc1
    s_waitcnt vmcnt(5)
    s_barrier
    ds_read_b64_tr_b16 v[60:61], v51 offset:0
    ds_read_b64_tr_b16 v[62:63], v51 offset:4608
    ds_read_b64_tr_b16 v[64:65], v51 offset:9216
    ds_read_b64_tr_b16 v[66:67], v51 offset:12672
    ds_read_b64_tr_b16 v[68:69], v51 offset:17280
    ds_read_b64_tr_b16 v[70:71], v51 offset:512
    ds_read_b64_tr_b16 v[72:73], v51 offset:5120
    ds_read_b64_tr_b16 v[74:75], v51 offset:9728
    ds_read_b64_tr_b16 v[76:77], v51 offset:13184
    ds_read_b64_tr_b16 v[78:79], v51 offset:17792
    v_alignbit_b32 v114, v99, v99, 16
    v_alignbit_b32 v115, v98, v98, 16
    s_waitcnt lgkmcnt(5)
    v_alignbit_b32 v108, v61, v60, 16
    v_alignbit_b32 v109, v62, v61, 16
    v_alignbit_b32 v110, v63, v62, 16
    v_alignbit_b32 v111, v64, v63, 16
    v_alignbit_b32 v112, v65, v64, 16
    v_dot2_f32_bf16 v116, v60, v114, 0
    ds_read_b64_tr_b16 v[80:81], v51 offset:1024
    v_dot2_f32_bf16 v117, v108, v114, 0
    v_dot2_f32_bf16 v118, v61, v114, 0
    v_dot2_f32_bf16 v119, v109, v114, 0
    v_dot2_f32_bf16 v120, v62, v114, 0
    ds_read_b64_tr_b16 v[82:83], v51 offset:5632
    v_dot2_f32_bf16 v121, v110, v114, 0
    v_dot2_f32_bf16 v122, v63, v114, 0
    v_dot2_f32_bf16 v123, v111, v114, 0
    v_dot2_f32_bf16 v116, v61, v115, v116
    v_dot2_f32_bf16 v117, v109, v115, v117
    ds_read_b64_tr_b16 v[84:85], v51 offset:10240
    v_dot2_f32_bf16 v118, v62, v115, v118
    v_dot2_f32_bf16 v119, v110, v115, v119
    v_dot2_f32_bf16 v120, v63, v115, v120
    v_dot2_f32_bf16 v121, v111, v115, v121
    v_dot2_f32_bf16 v122, v64, v115, v122
    ds_read_b64_tr_b16 v[86:87], v51 offset:13696
    v_dot2_f32_bf16 v123, v112, v115, v123
    v_and_b32 v133, 0xffff0000, v66
    v_lshlrev_b32 v132, 16, v66
    v_and_b32 v135, 0xffff0000, v67
    v_lshlrev_b32 v134, 16, v67
    ds_read_b64_tr_b16 v[88:89], v51 offset:18304
    v_and_b32 v137, 0xffff0000, v68
    v_lshlrev_b32 v136, 16, v68
    v_and_b32 v139, 0xffff0000, v69
    v_lshlrev_b32 v138, 16, v69
    v_pk_mul_f32 v[116:117], v[116:117], v[132:133]
    v_pk_mul_f32 v[118:119], v[118:119], v[134:135]
    v_pk_mul_f32 v[120:121], v[120:121], v[136:137]
    v_pk_mul_f32 v[122:123], v[122:123], v[138:139]
    v_cvt_pk_bf16_f32 v160, v123, v122
    v_cvt_pk_bf16_f32 v161, v121, v120
    v_cvt_pk_bf16_f32 v162, v119, v118
    v_cvt_pk_bf16_f32 v163, v117, v116
    buffer_store_dwordx4 v[160:163], v53, s[44:47], s15 offen sc1
    v_alignbit_b32 v114, v101, v101, 16
    v_alignbit_b32 v115, v100, v100, 16
    s_waitcnt lgkmcnt(5)
    v_alignbit_b32 v108, v71, v70, 16
    v_alignbit_b32 v109, v72, v71, 16
    v_alignbit_b32 v110, v73, v72, 16
    v_alignbit_b32 v111, v74, v73, 16
    v_alignbit_b32 v112, v75, v74, 16
    v_dot2_f32_bf16 v124, v70, v114, 0
    v_dot2_f32_bf16 v125, v108, v114, 0
    v_dot2_f32_bf16 v126, v71, v114, 0
    v_dot2_f32_bf16 v127, v109, v114, 0
    v_dot2_f32_bf16 v128, v72, v114, 0
    v_dot2_f32_bf16 v129, v110, v114, 0
    v_dot2_f32_bf16 v130, v73, v114, 0
    v_dot2_f32_bf16 v131, v111, v114, 0
    v_dot2_f32_bf16 v124, v71, v115, v124
    v_dot2_f32_bf16 v125, v109, v115, v125
    v_dot2_f32_bf16 v126, v72, v115, v126
    v_dot2_f32_bf16 v127, v110, v115, v127
    v_dot2_f32_bf16 v128, v73, v115, v128
    v_dot2_f32_bf16 v129, v111, v115, v129
    v_dot2_f32_bf16 v130, v74, v115, v130
    v_dot2_f32_bf16 v131, v112, v115, v131
    v_and_b32 v133, 0xffff0000, v76
    v_lshlrev_b32 v132, 16, v76
    v_and_b32 v135, 0xffff0000, v77
    v_lshlrev_b32 v134, 16, v77
    v_and_b32 v137, 0xffff0000, v78
    v_lshlrev_b32 v136, 16, v78
    v_and_b32 v139, 0xffff0000, v79
    v_lshlrev_b32 v138, 16, v79
    v_pk_mul_f32 v[124:125], v[124:125], v[132:133]
    v_pk_mul_f32 v[126:127], v[126:127], v[134:135]
    v_pk_mul_f32 v[128:129], v[128:129], v[136:137]
    v_pk_mul_f32 v[130:131], v[130:131], v[138:139]
    v_cvt_pk_bf16_f32 v164, v131, v130
    v_cvt_pk_bf16_f32 v165, v129, v128
    v_cvt_pk_bf16_f32 v166, v127, v126
    v_cvt_pk_bf16_f32 v167, v125, v124
    buffer_store_dwordx4 v[164:167], v53, s[44:47], s7 offen sc1
    v_alignbit_b32 v114, v103, v103, 16
    v_alignbit_b32 v115, v102, v102, 16
    s_waitcnt lgkmcnt(0)
    v_alignbit_b32 v108, v81, v80, 16
    v_alignbit_b32 v109, v82, v81, 16
    v_alignbit_b32 v110, v83, v82, 16
    v_alignbit_b32 v111, v84, v83, 16
    v_alignbit_b32 v112, v85, v84, 16
    v_dot2_f32_bf16 v116, v80, v114, 0
    v_dot2_f32_bf16 v117, v108, v114, 0
    v_dot2_f32_bf16 v118, v81, v114, 0
    v_dot2_f32_bf16 v119, v109, v114, 0
    v_dot2_f32_bf16 v120, v82, v114, 0
    v_dot2_f32_bf16 v121, v110, v114, 0
    v_dot2_f32_bf16 v122, v83, v114, 0
    v_dot2_f32_bf16 v123, v111, v114, 0
    v_dot2_f32_bf16 v116, v81, v115, v116
    v_dot2_f32_bf16 v117, v109, v115, v117
    v_dot2_f32_bf16 v118, v82, v115, v118
    v_dot2_f32_bf16 v119, v110, v115, v119
    v_dot2_f32_bf16 v120, v83, v115, v120
    v_dot2_f32_bf16 v121, v111, v115, v121
    v_dot2_f32_bf16 v122, v84, v115, v122
    v_dot2_f32_bf16 v123, v112, v115, v123
    v_and_b32 v133, 0xffff0000, v86
    v_lshlrev_b32 v132, 16, v86
    v_and_b32 v135, 0xffff0000, v87
    v_lshlrev_b32 v134, 16, v87
    v_and_b32 v137, 0xffff0000, v88
    v_lshlrev_b32 v136, 16, v88
    v_and_b32 v139, 0xffff0000, v89
    v_lshlrev_b32 v138, 16, v89
    v_pk_mul_f32 v[116:117], v[116:117], v[132:133]
    v_pk_mul_f32 v[118:119], v[118:119], v[134:135]
    v_pk_mul_f32 v[120:121], v[120:121], v[136:137]
    v_pk_mul_f32 v[122:123], v[122:123], v[138:139]
    v_cvt_pk_bf16_f32 v168, v123, v122
    v_cvt_pk_bf16_f32 v169, v121, v120
    v_cvt_pk_bf16_f32 v170, v119, v118
    v_cvt_pk_bf16_f32 v171, v117, v116
    buffer_store_dwordx4 v[168:171], v53, s[44:47], s8 offen sc1
    s_add_u32 m0, s74, 32
    s_add_u32 s13, s12, 0
    buffer_load_dwordx4 v240, s[48:51], s13 offen offset:0 lds
    buffer_load_dwordx4 v240, s[48:51], s13 offen offset:1024 lds
    buffer_load_dwordx4 v240, s[48:51], s13 offen offset:2048 lds
    buffer_load_dwordx4 v240, s[48:51], s13 offen offset:3072 lds
    s_mov_b64 exec, 0
    s_call_b64 s[82:83], L_wc_X
    s_mov_b64 exec, -1
    s_waitcnt vmcnt(7)
    v_readfirstlane_b32 s68, v45
    s_nop 1
    s_cmp_eq_u32 s68, 0
    s_cbranch_scc1 L_nw_X
L_ng_X:
    s_barrier
    v_mov_b32 v3, s68
    buffer_store_dword v3, v1, s[44:47], 0 offen sc1
    s_waitcnt vmcnt(5)
    s_barrier
    buffer_store_dword v3, v46, s[44:47], 0 offen sc1
L_segX:
L_pl_X_0:
    s_cbranch_execz L_pl_X_4
    s_cmp_lt_u32 s75, 252
    s_cbranch_scc0 L_idle
    s_mov_b32 s56, s26
    s_and_b32 s57, s27, 0xffff
    s_mov_b32 s58, 1152
    s_mov_b32 s59, 0x20000
    v_mov_b32 v9, 0
    buffer_load_ushort v9, v9, s[56:59], s70 offen
    s_lshr_b32 s4, s2, 1
    s_and_b32 s4, s4, 3
    s_lshl2_add_u32 s4, s4, s3
    s_lshl_b32 s4, s4, 8
    s_add_u32 s4, s4, 12599296
    v_lshl_add_u32 v28, v2, 2, s4
    v_add_u32 v241, s74, v240
    v_cmp_eq_u32 vcc, 0, v2
    v_mov_b32 v196, 4136
    s_nop 0
    v_cndmask_b32 v196, v196, 30, vcc
    v_add_u32 v242, s74, v196
    v_bfe_u32 v196, v2, 3, 2
    v_mul_u32_u24 v196, 4160, v196
    v_and_b32 v197, 7, v2
    v_lshl_add_u32 v196, v197, 2, v196
    v_add_u32 v200, s74, v196
    v_mov_b32 v196, 0
    v_mov_b32 v197, 0
    v_mov_b32 v198, 0
    v_mov_b32 v199, 0
    ds_write_b32 v200, v196
    v_lshlrev_b32 v201, 4, v0
    ds_write_b128 v201, v[196:199]
    ds_write_b128 v201, v[196:199] offset:36864
    s_waitcnt vmcnt(3)
    ds_read_b128 v[212:215], v241 offset:32
    ds_read_b32 v216, v241 offset:48
    ds_read_b128 v[218:221], v241 offset:1056
    ds_read_b32 v222, v241 offset:1072
    ds_read_b128 v[224:227], v241 offset:2080
    ds_read_b32 v228, v241 offset:2096
    ds_read_b128 v[230:233], v241 offset:3104
    ds_read_b32 v234, v241 offset:3120
    v_lshrrev_b32 v202, 3, v2
    v_and_b32 v203, 7, v2
    v_lshrrev_b32 v204, 1, v202
    v_xor_b32 v203, v203, v204
    v_mul_u32_u24 v202, 9216, v202
    v_lshl_add_u32 v15, v203, 4, v202
    v_xor_b32 v16, 64, v15
    v_and_b32 v202, 15, v2
    v_add_u32 v202, 1, v202
    v_and_b32 v203, 1, v202
    v_mul_u32_u24 v203, 4160, v203
    v_lshrrev_b32 v202, 1, v202
    v_lshl_add_u32 v203, v202, 2, v203
    v_lshrrev_b32 v204, 4, v2
    v_lshl_add_u32 v203, v204, 4, v203
    v_add_u32 v236, s74, v203
    v_add_u32 v237, 1024, v236
    v_add_u32 v238, 1024, v237
    v_add_u32 v239, 1024, v238
    s_waitcnt lgkmcnt(0)
    s_waitcnt vmcnt(0)
    v_lshlrev_b32 v9, 16, v9
    v_lshlrev_b32 v208, 16, v212
    v_add_f32 v9, v9, v208
    v_cvt_pk_bf16_f32 v9, v9, v9
    ds_write_b16 v242, v9 offset:4160
    ds_write_b16 v242, v9 offset:2
    v_alignbit_b32 v212, v213, v212, 16
    v_alignbit_b32 v213, v214, v213, 16
    v_alignbit_b32 v214, v215, v214, 16
    v_alignbit_b32 v215, v216, v215, 16
    ds_write_b128 v241, v[212:215] offset:4192
    v_alignbit_b32 v218, v219, v218, 16
    v_alignbit_b32 v219, v220, v219, 16
    v_alignbit_b32 v220, v221, v220, 16
    v_alignbit_b32 v221, v222, v221, 16
    ds_write_b128 v241, v[218:221] offset:5216
    v_alignbit_b32 v224, v225, v224, 16
    v_alignbit_b32 v225, v226, v225, 16
    v_alignbit_b32 v226, v227, v226, 16
    v_alignbit_b32 v227, v228, v227, 16
    ds_write_b128 v241, v[224:227] offset:6240
    v_alignbit_b32 v230, v231, v230, 16
    v_alignbit_b32 v231, v232, v231, 16
    v_alignbit_b32 v232, v233, v232, 16
    v_alignbit_b32 v233, v234, v233, 16
    ds_write_b128 v241, v[230:233] offset:7264
    v_and_b32 v202, 15, v2
    v_lshlrev_b32 v202, 1, v202
    v_sub_u32 v202, v202, v204
    v_add_u32 v202, 17, v202
    v_bfe_u32 v203, v202, 1, 3
    v_xor_b32 v203, s3, v203
    v_lshlrev_b32 v203, 4, v203
    v_lshl_add_u32 v244, v202, 7, v203
    v_and_b32 v202, 15, v2
    v_lshlrev_b32 v202, 1, v202
    v_sub_u32 v202, v202, v204
    v_add_u32 v202, 13, v202
    v_bfe_u32 v203, v202, 1, 3
    v_xor_b32 v203, s3, v203
    v_lshlrev_b32 v203, 4, v203
    v_lshl_add_u32 v245, v202, 7, v203
    v_and_b32 v202, 15, v2
    v_lshlrev_b32 v202, 1, v202
    v_sub_u32 v202, v202, v204
    v_add_u32 v202, 9, v202
    v_bfe_u32 v203, v202, 1, 3
    v_xor_b32 v203, s3, v203
    v_lshlrev_b32 v203, 4, v203
    v_lshl_add_u32 v246, v202, 7, v203
    v_and_b32 v202, 15, v2
    v_lshlrev_b32 v202, 1, v202
    v_sub_u32 v202, v202, v204
    v_add_u32 v202, 5, v202
    v_bfe_u32 v203, v202, 1, 3
    v_xor_b32 v203, s3, v203
    v_lshlrev_b32 v203, 4, v203
    v_lshl_add_u32 v247, v202, 7, v203
    v_and_b32 v202, 15, v2
    v_lshlrev_b32 v202, 5, v202
    v_lshl_add_u32 v8, v204, 3, v202
    s_mul_i32 s7, s3, 589824
    s_lshl_b32 s8, s69, 8
    s_add_u32 s7, s7, s8
    s_add_u32 s10, s7, 2359296
    s_lshl_b32 s9, s3, 13
    s_add_u32 s9, s9, 4096
    ds_read2_b32 v[64:65], v236 offset0:0 offset1:1
    ds_read2_b32 v[66:67], v236 offset0:2 offset1:3
    ds_read2_b32 v[68:69], v236 offset0:128 offset1:129
    ds_read2_b32 v[70:71], v236 offset0:130 offset1:131
    ds_read2_b32 v[72:73], v237 offset0:0 offset1:1
    ds_read2_b32 v[74:75], v237 offset0:2 offset1:3
    ds_read2_b32 v[76:77], v237 offset0:128 offset1:129
    ds_read2_b32 v[78:79], v237 offset0:130 offset1:131
    ds_read2_b32 v[80:81], v238 offset0:0 offset1:1
    ds_read2_b32 v[82:83], v238 offset0:2 offset1:3
    ds_read2_b32 v[84:85], v238 offset0:128 offset1:129
    ds_read2_b32 v[86:87], v238 offset0:130 offset1:131
    ds_read2_b32 v[88:89], v239 offset0:0 offset1:1
    ds_read2_b32 v[90:91], v239 offset0:2 offset1:3
    ds_read2_b32 v[92:93], v239 offset0:128 offset1:129
    ds_read2_b32 v[94:95], v239 offset0:130 offset1:131
    v_mov_b32 v29, 0
    buffer_atomic_add v29, v28, s[44:47], 0 offen sc0 sc1
    s_waitcnt vmcnt(0)
    v_cmp_ne_u32 vcc, s68, v29
    s_cbranch_vccnz L_rs_p1X
L_ok_p1X:
    s_add_u32 m0, s9, 0
    s_add_u32 s13, s10, 0
    buffer_load_dwordx4 v15, s[44:47], s13 offen sc1 lds
    s_add_u32 m0, s9, 1024
    s_add_u32 s13, s10, 73728
    buffer_load_dwordx4 v16, s[44:47], s13 offen sc1 lds
    s_add_u32 m0, s9, 2048
    s_add_u32 s13, s10, 147456
    buffer_load_dwordx4 v15, s[44:47], s13 offen sc1 lds
    s_add_u32 m0, s9, 3072
    s_add_u32 s13, s10, 221184
    buffer_load_dwordx4 v16, s[44:47], s13 offen sc1 lds
    s_add_u32 m0, s9, 4096
    s_add_u32 s13, s10, 294912
    buffer_load_dwordx4 v15, s[44:47], s13 offen sc1 lds
    s_add_u32 m0, s9, 5120
    s_add_u32 s13, s10, 368640
    buffer_load_dwordx4 v16, s[44:47], s13 offen sc1 lds
    s_add_u32 m0, s9, 6144
    s_add_u32 s13, s10, 442368
    buffer_load_dwordx4 v15, s[44:47], s13 offen sc1 lds
    s_add_u32 m0, s9, 7168
    s_add_u32 s13, s10, 516096
    buffer_load_dwordx4 v16, s[44:47], s13 offen sc1 lds
    s_mov_b64 exec, 0
    s_call_b64 s[82:83], L_wc_D
    s_mov_b64 exec, -1
    s_mov_b32 s60, s36
    s_and_b32 s61, s37, 0xffff
    s_mov_b32 s62, 4096
    s_mov_b32 s63, 0x20000
    v_and_b32 v24, 15, v2
    s_lshl_b32 s7, s71, 6
    v_add_u32 v24, s7, v24
    s_and_b32 s8, s3, 1
    s_lshl_b32 s4, s8, 5
    v_add_u32 v25, s4, v24
    v_lshlrev_b32 v26, 3, v25
    v_mul_u32_u24 v25, 1152, v25
    v_bfe_u32 v31, v2, 4, 1
    v_lshl_add_u32 v25, v31, 5, v25
    v_lshrrev_b32 v31, 5, v2
    v_lshl_add_u32 v25, v31, 4, v25
    s_bfe_u32 s7, s2, 0x20003
    s_mul_i32 s7, s7, 288
    s_lshl_b32 s4, s72, 6
    s_add_u32 s4, s4, s7
    v_add_u32 v252, s4, v25
    s_xor_b32 s8, s3, s72
    s_and_b32 s4, s72, 1
    s_lshl1_add_u32 s4, s4, s8
    v_lshl_add_u32 v24, s4, 4, v24
    s_add_u32 s7, s7, 256
    s_cmp_lt_u32 s8, 2
    s_cselect_b32 s7, s7, 0x40000000
    v_lshlrev_b32 v18, 3, v24
    v_mul_u32_u24 v24, 1152, v24
    v_lshrrev_b32 v31, 4, v2
    v_lshl_add_u32 v24, v31, 3, v24
    v_add_u32 v253, s7, v24
    v_lshrrev_b32 v24, 3, v2
    v_and_b32 v25, 7, v2
    v_bfe_u32 v31, v2, 4, 2
    v_lshlrev_b32 v31, 1, v31
    v_xor_b32 v25, v25, v31
    v_lshlrev_b32 v24, 12, v24
    v_lshl_add_u32 v24, v25, 4, v24
    s_mul_i32 s7, s72, 36
    s_bitcmp1_b32 s3, 0
L_pl_X_1:
    s_cbranch_execz L_pl_X_5
    s_addc_u32 s7, s7, 0
    s_lshl_b32 s7, s7, 17
    s_lshl_b32 s8, s71, 7
    s_add_u32 s7, s7, s8
    v_add_u32 v4, s7, v24
    v_add_u32 v5, 31744, v4
    v_add_u32 v6, 31744, v5
    v_add_u32 v7, 31744, v6
    v_lshrrev_b32 v24, 2, v2
    v_lshlrev_b32 v24, 7, v24
    v_and_b32 v25, 3, v2
    v_lshl_add_u32 v24, v25, 3, v24
    s_and_b32 s7, s73, 8192
    v_add_u32 v24, s7, v24
    v_bfe_u32 v31, v2, 3, 2
    s_and_b32 s7, s3, 1
    s_lshl_b32 s7, s7, 1
    v_xor_b32 v31, s7, v31
    v_lshl_add_u32 v10, v31, 5, v24
    v_xor_b32 v11, 32, v10
    v_and_b32 v24, 15, v2
    v_lshrrev_b32 v25, 4, v2
    v_mul_u32_u24 v25, 17408, v25
    v_lshl_add_u32 v24, v24, 4, v25
    s_mul_i32 s7, s72, 36
    s_and_b32 s8, s3, 1
    s_add_u32 s7, s7, s8
    s_mul_i32 s7, s7, 69632
    s_bfe_u32 s8, s2, 0x20003
    s_lshl_b32 s8, s8, 12
    s_add_u32 s7, s7, s8
    s_add_u32 s7, s7, 12795904
    v_add_u32 v23, s7, v24
    s_xor_b32 s7, s72, 0
    v_lshl_add_u32 v19, s7, 10, v23
    s_xor_b32 s7, s72, 1
    v_lshl_add_u32 v20, s7, 10, v23
    s_xor_b32 s7, s72, 2
    v_lshl_add_u32 v21, s7, 10, v23
    s_xor_b32 s7, s72, 3
    v_lshl_add_u32 v22, s7, 10, v23
    v_lshlrev_b32 v14, 4, v2
    v_add_u32 v14, 98304, v14
    v_add_u32 v1, 0x10000, v14
    s_bitcmp1_b32 s3, 1
    s_cselect_b32 s18, s85, s84
    s_mul_i32 s18, s18, 139264
    s_cselect_b32 s19, s87, s86
    s_mul_i32 s19, s19, 139264
    s_cselect_b32 s20, s89, s88
    s_mul_i32 s20, s20, 139264
    s_cselect_b32 s21, s91, s90
    s_mul_i32 s21, s21, 139264
    s_cselect_b32 s22, s93, s92
    s_mul_i32 s22, s22, 139264
    s_cselect_b32 s23, s95, s94
    s_mul_i32 s23, s23, 139264
    s_cselect_b32 s24, s97, s96
    s_mul_i32 s24, s24, 139264
    s_cselect_b32 s25, s99, s98
    s_mul_i32 s25, s25, 139264
    s_cselect_b32 s26, s101, s100
    s_mul_i32 s26, s26, 139264
    v_add_u32 v10, 131072, v10
    v_add_u32 v11, 131072, v11
    s_waitcnt vmcnt(0) lgkmcnt(0)
    s_barrier
    ds_read_b128 v[96:99], v244 offset:2048
    ds_read_b128 v[100:103], v244 offset:6144
    ds_read_b128 v[104:107], v244 offset:10240
    ds_read_b128 v[108:111], v244 offset:14336
    ds_read_b128 v[112:115], v244 offset:18432
    ds_read_b128 v[116:119], v244 offset:22528
    ds_read_b128 v[120:123], v244 offset:26624
    ds_read_b128 v[124:127], v244 offset:30720
    s_waitcnt lgkmcnt(0)
    v_mfma_f32_16x16x32_bf16 v[32:35], v[64:67], v[96:99], 0
    s_lshl_b32 s14, s84, 18
    ds_read_b128 v[160:163], v245 offset:2048
    v_mfma_f32_16x16x32_bf16 v[36:39], v[68:71], v[96:99], 0
    s_add_u32 m0, s73, 147456
    v_mfma_f32_16x16x32_bf16 v[36:39], v[64:67], v[100:103], v[36:39]
    buffer_load_dwordx4 v4, s[52:55], s14 offen offset:0 lds
    ds_read2_b32 v[128:129], v236 offset0:16 offset1:17
    v_mfma_f32_16x16x32_bf16 v[40:43], v[64:67], v[104:107], 0
    ds_read2_b32 v[130:131], v236 offset0:18 offset1:19
    v_mfma_f32_16x16x32_bf16 v[40:43], v[68:71], v[100:103], v[40:43]
    v_mfma_f32_16x16x32_bf16 v[40:43], v[72:75], v[96:99], v[40:43]
    ds_read_b128 v[164:167], v245 offset:6144
    v_mfma_f32_16x16x32_bf16 v[44:47], v[76:79], v[96:99], 0
    ds_read2_b32 v[132:133], v236 offset0:144 offset1:145
    v_mfma_f32_16x16x32_bf16 v[44:47], v[72:75], v[100:103], v[44:47]
    s_add_u32 s13, s12, 16384
    v_mfma_f32_16x16x32_bf16 v[44:47], v[68:71], v[104:107], v[44:47]
    ds_read2_b32 v[134:135], v236 offset0:146 offset1:147
    v_mfma_f32_16x16x32_bf16 v[44:47], v[64:67], v[108:111], v[44:47]
    s_add_u32 m0, s74, 8352
    ds_read_b128 v[168:171], v245 offset:10240
    v_mfma_f32_16x16x32_bf16 v[48:51], v[64:67], v[112:115], 0
    buffer_load_dwordx4 v240, s[48:51], s13 offen offset:0 lds
    ds_read2_b32 v[136:137], v237 offset0:16 offset1:17
    v_mfma_f32_16x16x32_bf16 v[48:51], v[68:71], v[108:111], v[48:51]
    v_mfma_f32_16x16x32_bf16 v[48:51], v[72:75], v[104:107], v[48:51]
    s_add_u32 m0, s73, 147456
    ds_read2_b32 v[138:139], v237 offset0:18 offset1:19
    v_mfma_f32_16x16x32_bf16 v[48:51], v[76:79], v[100:103], v[48:51]
    buffer_load_dwordx4 v5, s[52:55], s14 offen offset:1024 lds
    ds_read_b128 v[172:175], v245 offset:14336
    v_mfma_f32_16x16x32_bf16 v[48:51], v[80:83], v[96:99], v[48:51]
    v_mfma_f32_16x16x32_bf16 v[52:55], v[84:87], v[96:99], 0
    ds_read2_b32 v[140:141], v237 offset0:144 offset1:145
    v_mfma_f32_16x16x32_bf16 v[52:55], v[80:83], v[100:103], v[52:55]
    s_add_u32 m0, s74, 8352
    ds_read2_b32 v[142:143], v237 offset0:146 offset1:147
    v_mfma_f32_16x16x32_bf16 v[52:55], v[76:79], v[104:107], v[52:55]
    buffer_load_dwordx4 v240, s[48:51], s13 offen offset:1024 lds
    v_mfma_f32_16x16x32_bf16 v[52:55], v[72:75], v[108:111], v[52:55]
    ds_read_b128 v[176:179], v245 offset:18432
    v_mfma_f32_16x16x32_bf16 v[52:55], v[68:71], v[112:115], v[52:55]
    ds_read2_b32 v[144:145], v238 offset0:16 offset1:17
    v_mfma_f32_16x16x32_bf16 v[52:55], v[64:67], v[116:119], v[52:55]
    v_mfma_f32_16x16x32_bf16 v[56:59], v[64:67], v[120:123], 0
    ds_read2_b32 v[146:147], v238 offset0:18 offset1:19
    v_mfma_f32_16x16x32_bf16 v[56:59], v[68:71], v[116:119], v[56:59]
    ds_read_b128 v[180:183], v245 offset:22528
    v_mfma_f32_16x16x32_bf16 v[56:59], v[72:75], v[112:115], v[56:59]
    v_mfma_f32_16x16x32_bf16 v[56:59], v[76:79], v[108:111], v[56:59]
    s_add_u32 m0, s73, 147456
    ds_read2_b32 v[148:149], v238 offset0:144 offset1:145
    v_mfma_f32_16x16x32_bf16 v[56:59], v[80:83], v[104:107], v[56:59]
    buffer_load_dwordx4 v6, s[52:55], s14 offen offset:2048 lds
    ds_read2_b32 v[150:151], v238 offset0:146 offset1:147
    v_mfma_f32_16x16x32_bf16 v[56:59], v[84:87], v[100:103], v[56:59]
    s_add_u32 m0, s74, 8352
    ds_read_b128 v[184:187], v245 offset:26624
    v_mfma_f32_16x16x32_bf16 v[56:59], v[88:91], v[96:99], v[56:59]
    buffer_load_dwordx4 v240, s[48:51], s13 offen offset:2048 lds
    v_mfma_f32_16x16x32_bf16 v[60:63], v[92:95], v[96:99], 0
    ds_read2_b32 v[152:153], v239 offset0:16 offset1:17
    v_mfma_f32_16x16x32_bf16 v[60:63], v[88:91], v[100:103], v[60:63]
    ds_read2_b32 v[154:155], v239 offset0:18 offset1:19
    v_mfma_f32_16x16x32_bf16 v[60:63], v[84:87], v[104:107], v[60:63]
    v_mfma_f32_16x16x32_bf16 v[60:63], v[80:83], v[108:111], v[60:63]
    ds_read_b128 v[188:191], v245 offset:30720
    v_mfma_f32_16x16x32_bf16 v[60:63], v[76:79], v[112:115], v[60:63]
    s_add_u32 m0, s74, 8352
    ds_read2_b32 v[156:157], v239 offset0:144 offset1:145
    v_mfma_f32_16x16x32_bf16 v[60:63], v[72:75], v[116:119], v[60:63]
    buffer_load_dwordx4 v240, s[48:51], s13 offen offset:3072 lds
    v_mfma_f32_16x16x32_bf16 v[60:63], v[68:71], v[120:123], v[60:63]
    ds_read2_b32 v[158:159], v239 offset0:146 offset1:147
    v_mfma_f32_16x16x32_bf16 v[60:63], v[64:67], v[124:127], v[60:63]
    s_waitcnt lgkmcnt(12)
    v_mfma_f32_16x16x32_bf16 v[32:35], v[128:131], v[160:163], v[32:35]
    s_add_u32 m0, s73, 147456
    ds_read_b128 v[96:99], v246 offset:2048
    v_mfma_f32_16x16x32_bf16 v[36:39], v[132:135], v[160:163], v[36:39]
    buffer_load_dwordx4 v7, s[52:55], s14 offen offset:3072 lds
    v_mfma_f32_16x16x32_bf16 v[36:39], v[128:131], v[164:167], v[36:39]
    ds_read2_b32 v[64:65], v236 offset0:32 offset1:33
    v_mfma_f32_16x16x32_bf16 v[40:43], v[128:131], v[168:171], v[40:43]
    ds_read2_b32 v[66:67], v236 offset0:34 offset1:35
    v_mfma_f32_16x16x32_bf16 v[40:43], v[132:135], v[164:167], v[40:43]
    v_mfma_f32_16x16x32_bf16 v[40:43], v[136:139], v[160:163], v[40:43]
    ds_read_b128 v[100:103], v246 offset:6144
    v_mfma_f32_16x16x32_bf16 v[44:47], v[140:143], v[160:163], v[44:47]
    ds_read2_b32 v[68:69], v236 offset0:160 offset1:161
    v_mfma_f32_16x16x32_bf16 v[44:47], v[136:139], v[164:167], v[44:47]
    v_mfma_f32_16x16x32_bf16 v[44:47], v[132:135], v[168:171], v[44:47]
    ds_read2_b32 v[70:71], v236 offset0:162 offset1:163
    v_mfma_f32_16x16x32_bf16 v[44:47], v[128:131], v[172:175], v[44:47]
    ds_read_b128 v[104:107], v246 offset:10240
    s_waitcnt lgkmcnt(7)
    v_mfma_f32_16x16x32_bf16 v[48:51], v[128:131], v[176:179], v[48:51]
    ds_read2_b32 v[72:73], v237 offset0:32 offset1:33
    v_mfma_f32_16x16x32_bf16 v[48:51], v[132:135], v[172:175], v[48:51]
    ds_read2_b32 v[74:75], v237 offset0:34 offset1:35
    v_mfma_f32_16x16x32_bf16 v[48:51], v[136:139], v[168:171], v[48:51]
    v_mov_b32 v9, 8
    buffer_load_ushort v9, v9, s[56:59], s70 offen
    v_mfma_f32_16x16x32_bf16 v[48:51], v[140:143], v[164:167], v[48:51]
    ds_read_b128 v[108:111], v246 offset:14336
    v_mfma_f32_16x16x32_bf16 v[48:51], v[144:147], v[160:163], v[48:51]
    v_mfma_f32_16x16x32_bf16 v[52:55], v[148:151], v[160:163], v[52:55]
    ds_read2_b32 v[76:77], v237 offset0:160 offset1:161
    v_mfma_f32_16x16x32_bf16 v[52:55], v[144:147], v[164:167], v[52:55]
    ds_read2_b32 v[78:79], v237 offset0:162 offset1:163
    v_mfma_f32_16x16x32_bf16 v[52:55], v[140:143], v[168:171], v[52:55]
    v_mfma_f32_16x16x32_bf16 v[52:55], v[136:139], v[172:175], v[52:55]
    ds_read_b128 v[112:115], v246 offset:18432
    v_mfma_f32_16x16x32_bf16 v[52:55], v[132:135], v[176:179], v[52:55]
    ds_read2_b32 v[80:81], v238 offset0:32 offset1:33
    v_mfma_f32_16x16x32_bf16 v[52:55], v[128:131], v[180:183], v[52:55]
    v_mfma_f32_16x16x32_bf16 v[56:59], v[128:131], v[184:187], v[56:59]
    ds_read2_b32 v[82:83], v238 offset0:34 offset1:35
    v_mfma_f32_16x16x32_bf16 v[56:59], v[132:135], v[180:183], v[56:59]
    ds_read_b128 v[116:119], v246 offset:22528
    v_mfma_f32_16x16x32_bf16 v[56:59], v[136:139], v[176:179], v[56:59]
    v_mfma_f32_16x16x32_bf16 v[56:59], v[140:143], v[172:175], v[56:59]
    ds_read2_b32 v[84:85], v238 offset0:160 offset1:161
    v_mfma_f32_16x16x32_bf16 v[56:59], v[144:147], v[168:171], v[56:59]
    ds_read2_b32 v[86:87], v238 offset0:162 offset1:163
    v_mfma_f32_16x16x32_bf16 v[56:59], v[148:151], v[164:167], v[56:59]
    ds_read_b128 v[120:123], v246 offset:26624
    v_mfma_f32_16x16x32_bf16 v[56:59], v[152:155], v[160:163], v[56:59]
    v_mfma_f32_16x16x32_bf16 v[60:63], v[156:159], v[160:163], v[60:63]
    ds_read2_b32 v[88:89], v239 offset0:32 offset1:33
    v_mfma_f32_16x16x32_bf16 v[60:63], v[152:155], v[164:167], v[60:63]
    ds_read2_b32 v[90:91], v239 offset0:34 offset1:35
    v_mfma_f32_16x16x32_bf16 v[60:63], v[148:151], v[168:171], v[60:63]
    v_mfma_f32_16x16x32_bf16 v[60:63], v[144:147], v[172:175], v[60:63]
    ds_read_b128 v[124:127], v246 offset:30720
    v_mfma_f32_16x16x32_bf16 v[60:63], v[140:143], v[176:179], v[60:63]
    ds_read2_b32 v[92:93], v239 offset0:160 offset1:161
    v_mfma_f32_16x16x32_bf16 v[60:63], v[136:139], v[180:183], v[60:63]
    v_mfma_f32_16x16x32_bf16 v[60:63], v[132:135], v[184:187], v[60:63]
    ds_read2_b32 v[94:95], v239 offset0:162 offset1:163
    v_mfma_f32_16x16x32_bf16 v[60:63], v[128:131], v[188:191], v[60:63]
    s_waitcnt lgkmcnt(12)
    v_mfma_f32_16x16x32_bf16 v[32:35], v[64:67], v[96:99], v[32:35]
    s_lshl_b32 s14, s85, 18
    ds_read_b128 v[160:163], v247 offset:2048
    v_mfma_f32_16x16x32_bf16 v[36:39], v[68:71], v[96:99], v[36:39]
    s_add_u32 m0, s73, 49152
    v_mfma_f32_16x16x32_bf16 v[36:39], v[64:67], v[100:103], v[36:39]
    buffer_load_dwordx4 v4, s[52:55], s14 offen offset:0 lds
    ds_read2_b32 v[128:129], v236 offset0:48 offset1:49
    v_mfma_f32_16x16x32_bf16 v[40:43], v[64:67], v[104:107], v[40:43]
    ds_read2_b32 v[130:131], v236 offset0:50 offset1:51
    v_mfma_f32_16x16x32_bf16 v[40:43], v[68:71], v[100:103], v[40:43]
    v_mfma_f32_16x16x32_bf16 v[40:43], v[72:75], v[96:99], v[40:43]
    ds_read_b128 v[164:167], v247 offset:6144
    v_mfma_f32_16x16x32_bf16 v[44:47], v[76:79], v[96:99], v[44:47]
    ds_read2_b32 v[132:133], v236 offset0:176 offset1:177
    v_mfma_f32_16x16x32_bf16 v[44:47], v[72:75], v[100:103], v[44:47]
    v_mfma_f32_16x16x32_bf16 v[44:47], v[68:71], v[104:107], v[44:47]
    ds_read2_b32 v[134:135], v236 offset0:178 offset1:179
    v_mfma_f32_16x16x32_bf16 v[44:47], v[64:67], v[108:111], v[44:47]
    ds_read_b128 v[168:171], v247 offset:10240
    s_waitcnt lgkmcnt(7)
    v_mfma_f32_16x16x32_bf16 v[48:51], v[64:67], v[112:115], v[48:51]
    ds_read2_b32 v[136:137], v237 offset0:48 offset1:49
    v_mfma_f32_16x16x32_bf16 v[48:51], v[68:71], v[108:111], v[48:51]
    v_mfma_f32_16x16x32_bf16 v[48:51], v[72:75], v[104:107], v[48:51]
    s_add_u32 m0, s73, 49152
    ds_read2_b32 v[138:139], v237 offset0:50 offset1:51
    v_mfma_f32_16x16x32_bf16 v[48:51], v[76:79], v[100:103], v[48:51]
    buffer_load_dwordx4 v5, s[52:55], s14 offen offset:1024 lds
    ds_read_b128 v[172:175], v247 offset:14336
    v_mfma_f32_16x16x32_bf16 v[48:51], v[80:83], v[96:99], v[48:51]
    v_mfma_f32_16x16x32_bf16 v[52:55], v[84:87], v[96:99], v[52:55]
    ds_read2_b32 v[140:141], v237 offset0:176 offset1:177
    v_mfma_f32_16x16x32_bf16 v[52:55], v[80:83], v[100:103], v[52:55]
    ds_read2_b32 v[142:143], v237 offset0:178 offset1:179
    v_mfma_f32_16x16x32_bf16 v[52:55], v[76:79], v[104:107], v[52:55]
    v_mfma_f32_16x16x32_bf16 v[52:55], v[72:75], v[108:111], v[52:55]
    ds_read_b128 v[176:179], v247 offset:18432
    v_mfma_f32_16x16x32_bf16 v[52:55], v[68:71], v[112:115], v[52:55]
    ds_read2_b32 v[144:145], v238 offset0:48 offset1:49
    v_mfma_f32_16x16x32_bf16 v[52:55], v[64:67], v[116:119], v[52:55]
    v_mfma_f32_16x16x32_bf16 v[56:59], v[64:67], v[120:123], v[56:59]
    ds_read2_b32 v[146:147], v238 offset0:50 offset1:51
    v_mfma_f32_16x16x32_bf16 v[56:59], v[68:71], v[116:119], v[56:59]
    ds_read_b128 v[180:183], v247 offset:22528
    v_mfma_f32_16x16x32_bf16 v[56:59], v[72:75], v[112:115], v[56:59]
    v_mfma_f32_16x16x32_bf16 v[56:59], v[76:79], v[108:111], v[56:59]
    s_add_u32 m0, s73, 49152
    ds_read2_b32 v[148:149], v238 offset0:176 offset1:177
    v_mfma_f32_16x16x32_bf16 v[56:59], v[80:83], v[104:107], v[56:59]
    buffer_load_dwordx4 v6, s[52:55], s14 offen offset:2048 lds
    ds_read2_b32 v[150:151], v238 offset0:178 offset1:179
    v_mfma_f32_16x16x32_bf16 v[56:59], v[84:87], v[100:103], v[56:59]
    ds_read_b128 v[184:187], v247 offset:26624
    v_mfma_f32_16x16x32_bf16 v[56:59], v[88:91], v[96:99], v[56:59]
    v_mfma_f32_16x16x32_bf16 v[60:63], v[92:95], v[96:99], v[60:63]
    ds_read2_b32 v[152:153], v239 offset0:48 offset1:49
    v_mfma_f32_16x16x32_bf16 v[60:63], v[88:91], v[100:103], v[60:63]
    ds_read2_b32 v[154:155], v239 offset0:50 offset1:51
    v_mfma_f32_16x16x32_bf16 v[60:63], v[84:87], v[104:107], v[60:63]
    v_mfma_f32_16x16x32_bf16 v[60:63], v[80:83], v[108:111], v[60:63]
    ds_read_b128 v[188:191], v247 offset:30720
    v_mfma_f32_16x16x32_bf16 v[60:63], v[76:79], v[112:115], v[60:63]
    ds_read2_b32 v[156:157], v239 offset0:176 offset1:177
    v_mfma_f32_16x16x32_bf16 v[60:63], v[72:75], v[116:119], v[60:63]
    v_mfma_f32_16x16x32_bf16 v[60:63], v[68:71], v[120:123], v[60:63]
    ds_read2_b32 v[158:159], v239 offset0:178 offset1:179
    v_mfma_f32_16x16x32_bf16 v[60:63], v[64:67], v[124:127], v[60:63]
    s_waitcnt lgkmcnt(12)
    v_mfma_f32_16x16x32_bf16 v[32:35], v[128:131], v[160:163], v[32:35]
    s_add_u32 m0, s73, 49152
    ds_read_b128 v[96:99], v244 offset:0
    v_mfma_f32_16x16x32_bf16 v[36:39], v[132:135], v[160:163], v[36:39]
    buffer_load_dwordx4 v7, s[52:55], s14 offen offset:3072 lds
    v_mfma_f32_16x16x32_bf16 v[36:39], v[128:131], v[164:167], v[36:39]
    ds_read2_b32 v[64:65], v236 offset0:64 offset1:65
    v_mfma_f32_16x16x32_bf16 v[40:43], v[128:131], v[168:171], v[40:43]
    ds_read2_b32 v[66:67], v236 offset0:66 offset1:67
    v_mfma_f32_16x16x32_bf16 v[40:43], v[132:135], v[164:167], v[40:43]
    v_mfma_f32_16x16x32_bf16 v[40:43], v[136:139], v[160:163], v[40:43]
    ds_read_b128 v[100:103], v244 offset:4096
    v_mfma_f32_16x16x32_bf16 v[44:47], v[140:143], v[160:163], v[44:47]
    ds_read2_b32 v[68:69], v236 offset0:192 offset1:193
    v_mfma_f32_16x16x32_bf16 v[44:47], v[136:139], v[164:167], v[44:47]
    v_mfma_f32_16x16x32_bf16 v[44:47], v[132:135], v[168:171], v[44:47]
    ds_read2_b32 v[70:71], v236 offset0:194 offset1:195
    v_mfma_f32_16x16x32_bf16 v[44:47], v[128:131], v[172:175], v[44:47]
    ds_read_b128 v[104:107], v244 offset:8192
    s_waitcnt lgkmcnt(7)
    v_mfma_f32_16x16x32_bf16 v[48:51], v[128:131], v[176:179], v[48:51]
    ds_read2_b32 v[72:73], v237 offset0:64 offset1:65
    v_mfma_f32_16x16x32_bf16 v[48:51], v[132:135], v[172:175], v[48:51]
    ds_read2_b32 v[74:75], v237 offset0:66 offset1:67
    v_mfma_f32_16x16x32_bf16 v[48:51], v[136:139], v[168:171], v[48:51]
    ds_read_b128 v[108:111], v244 offset:12288
    v_mfma_f32_16x16x32_bf16 v[48:51], v[140:143], v[164:167], v[48:51]
    ds_read2_b32 v[76:77], v237 offset0:192 offset1:193
    v_mfma_f32_16x16x32_bf16 v[48:51], v[144:147], v[160:163], v[48:51]
    ds_read2_b32 v[78:79], v237 offset0:194 offset1:195
    v_mfma_f32_16x16x32_bf16 v[52:55], v[148:151], v[160:163], v[52:55]
    ds_read_b128 v[112:115], v244 offset:16384
    v_mfma_f32_16x16x32_bf16 v[52:55], v[144:147], v[164:167], v[52:55]
    ds_read2_b32 v[80:81], v238 offset0:64 offset1:65
    v_mfma_f32_16x16x32_bf16 v[52:55], v[140:143], v[168:171], v[52:55]
    ds_read2_b32 v[82:83], v238 offset0:66 offset1:67
    v_mfma_f32_16x16x32_bf16 v[52:55], v[136:139], v[172:175], v[52:55]
    ds_read_b128 v[116:119], v244 offset:20480
    v_mfma_f32_16x16x32_bf16 v[52:55], v[132:135], v[176:179], v[52:55]
    ds_read2_b32 v[84:85], v238 offset0:192 offset1:193
    v_mfma_f32_16x16x32_bf16 v[52:55], v[128:131], v[180:183], v[52:55]
    ds_read2_b32 v[86:87], v238 offset0:194 offset1:195
    v_mfma_f32_16x16x32_bf16 v[56:59], v[128:131], v[184:187], v[56:59]
    ds_read_b128 v[120:123], v244 offset:24576
    s_waitcnt vmcnt(5)
    s_barrier
    v_mfma_f32_16x16x32_bf16 v[56:59], v[132:135], v[180:183], v[56:59]
    ds_read2_b32 v[88:89], v239 offset0:64 offset1:65
    v_mfma_f32_16x16x32_bf16 v[56:59], v[136:139], v[176:179], v[56:59]
    ds_read_b64_tr_b16 a[0:1], v10 offset:16384
    v_mfma_f32_16x16x32_bf16 v[56:59], v[140:143], v[172:175], v[56:59]
    ds_read_b64_tr_b16 a[2:3], v10 offset:18432
    v_mfma_f32_16x16x32_bf16 v[56:59], v[144:147], v[168:171], v[56:59]
    ds_read_b64_tr_b16 a[8:9], v10 offset:20480
    v_mfma_f32_16x16x32_bf16 v[56:59], v[148:151], v[164:167], v[56:59]
    ds_read2_b32 v[90:91], v239 offset0:66 offset1:67
    v_mfma_f32_16x16x32_bf16 v[56:59], v[152:155], v[160:163], v[56:59]
    ds_read_b64_tr_b16 a[10:11], v10 offset:22528
    v_mfma_f32_16x16x32_bf16 v[60:63], v[156:159], v[160:163], v[60:63]
    ds_read_b64_tr_b16 a[4:5], v11 offset:16384
    v_mfma_f32_16x16x32_bf16 v[60:63], v[152:155], v[164:167], v[60:63]
    ds_read_b128 v[124:127], v244 offset:28672
    v_mfma_f32_16x16x32_bf16 v[60:63], v[148:151], v[168:171], v[60:63]
    ds_read_b64_tr_b16 a[6:7], v11 offset:18432
    v_mfma_f32_16x16x32_bf16 v[60:63], v[144:147], v[172:175], v[60:63]
    ds_read_b64_tr_b16 a[12:13], v11 offset:20480
    v_mfma_f32_16x16x32_bf16 v[60:63], v[140:143], v[176:179], v[60:63]
    ds_read2_b32 v[92:93], v239 offset0:192 offset1:193
    v_mfma_f32_16x16x32_bf16 v[60:63], v[136:139], v[180:183], v[60:63]
    ds_read_b64_tr_b16 a[14:15], v11 offset:22528
    v_mfma_f32_16x16x32_bf16 v[60:63], v[132:135], v[184:187], v[60:63]
    ds_read2_b32 v[94:95], v239 offset0:194 offset1:195
    v_mfma_f32_16x16x32_bf16 v[60:63], v[128:131], v[188:191], v[60:63]
    s_waitcnt lgkmcnt(15)
    v_mfma_f32_16x16x32_bf16 v[32:35], v[64:67], v[96:99], v[32:35]
    ds_read_b128 v[160:163], v245 offset:0
    s_waitcnt lgkmcnt(2)
    s_barrier
    v_mfma_f32_16x16x32_bf16 v[36:39], v[68:71], v[96:99], v[36:39]
    v_mfma_f32_16x16x32_bf16 v[36:39], v[64:67], v[100:103], v[36:39]
    ds_read2_b32 v[128:129], v236 offset0:80 offset1:81
    v_mfma_f32_16x16x32_bf16 v[40:43], v[64:67], v[104:107], v[40:43]
    s_lshl_b32 s14, s86, 18
    ds_read2_b32 v[130:131], v236 offset0:82 offset1:83
    v_mfma_f32_16x16x32_bf16 v[40:43], v[68:71], v[100:103], v[40:43]
    s_add_u32 m0, s73, 147456
    v_mfma_f32_16x16x32_bf16 v[40:43], v[72:75], v[96:99], v[40:43]
    buffer_load_dwordx4 v4, s[52:55], s14 offen offset:0 lds
    ds_read_b128 v[164:167], v245 offset:4096
    v_mfma_f32_16x16x32_bf16 v[44:47], v[76:79], v[96:99], v[44:47]
    ds_read2_b32 v[132:133], v236 offset0:208 offset1:209
    v_mfma_f32_16x16x32_bf16 v[44:47], v[72:75], v[100:103], v[44:47]
    v_mfma_f32_16x16x32_bf16 v[44:47], v[68:71], v[104:107], v[44:47]
    ds_read2_b32 v[134:135], v236 offset0:210 offset1:211
    v_mfma_f32_16x16x32_bf16 v[44:47], v[64:67], v[108:111], v[44:47]
    ds_read_b128 v[168:171], v245 offset:8192
    s_waitcnt lgkmcnt(7)
    v_mfma_f32_16x16x32_bf16 v[48:51], v[64:67], v[112:115], v[48:51]
    ds_read2_b32 v[136:137], v237 offset0:80 offset1:81
    v_mfma_f32_16x16x32_bf16 v[48:51], v[68:71], v[108:111], v[48:51]
    ds_read2_b32 v[138:139], v237 offset0:82 offset1:83
    v_mfma_f32_16x16x32_bf16 v[48:51], v[72:75], v[104:107], v[48:51]
    ds_read_b128 v[172:175], v245 offset:12288
    v_mfma_f32_16x16x32_bf16 v[48:51], v[76:79], v[100:103], v[48:51]
    ds_read2_b32 v[140:141], v237 offset0:208 offset1:209
    v_mfma_f32_16x16x32_bf16 v[48:51], v[80:83], v[96:99], v[48:51]
    ds_read2_b32 v[142:143], v237 offset0:210 offset1:211
    v_mfma_f32_16x16x32_bf16 v[52:55], v[84:87], v[96:99], v[52:55]
    ds_read_b128 v[176:179], v245 offset:16384
    v_mfma_f32_16x16x32_bf16 v[52:55], v[80:83], v[100:103], v[52:55]
    s_add_u32 m0, s73, 147456
    ds_read2_b32 v[144:145], v238 offset0:80 offset1:81
    v_mfma_f32_16x16x32_bf16 v[52:55], v[76:79], v[104:107], v[52:55]
    buffer_load_dwordx4 v5, s[52:55], s14 offen offset:1024 lds
    ds_read2_b32 v[146:147], v238 offset0:82 offset1:83
    v_mfma_f32_16x16x32_bf16 v[52:55], v[72:75], v[108:111], v[52:55]
    ds_read_b128 v[180:183], v245 offset:20480
    v_mfma_f32_16x16x32_bf16 v[52:55], v[68:71], v[112:115], v[52:55]
    ds_read_b128 v[212:215], v241 offset:8352
    v_mfma_f32_16x16x32_bf16 v[52:55], v[64:67], v[116:119], v[52:55]
    ds_read2_b32 v[148:149], v238 offset0:208 offset1:209
    v_mfma_f32_16x16x32_bf16 v[56:59], v[64:67], v[120:123], v[56:59]
    ds_read_b32 v216, v241 offset:8368
    v_mfma_f32_16x16x32_bf16 v[56:59], v[68:71], v[116:119], v[56:59]
    ds_read2_b32 v[150:151], v238 offset0:210 offset1:211
    v_mfma_f32_16x16x32_bf16 v[56:59], v[72:75], v[112:115], v[56:59]
    ds_read_b128 v[218:221], v241 offset:9376
    v_mfma_f32_16x16x32_bf16 v[56:59], v[76:79], v[108:111], v[56:59]
    ds_read_b128 v[184:187], v245 offset:24576
    v_mfma_f32_16x16x32_bf16 v[56:59], v[80:83], v[104:107], v[56:59]
    ds_read2_b32 v[152:153], v239 offset0:80 offset1:81
    v_mfma_f32_16x16x32_bf16 v[56:59], v[84:87], v[100:103], v[56:59]
    ds_read_b32 v222, v241 offset:9392
    v_mfma_f32_16x16x32_bf16 v[56:59], v[88:91], v[96:99], v[56:59]
    ds_read2_b32 v[154:155], v239 offset0:82 offset1:83
    v_mfma_f32_16x16x32_bf16 v[60:63], v[92:95], v[96:99], v[60:63]
    s_add_u32 m0, s73, 147456
    ds_read_b128 v[224:227], v241 offset:10400
    v_mfma_f32_16x16x32_bf16 v[60:63], v[88:91], v[100:103], v[60:63]
    buffer_load_dwordx4 v6, s[52:55], s14 offen offset:2048 lds
    ds_read_b128 v[188:191], v245 offset:28672
    v_mfma_f32_16x16x32_bf16 v[60:63], v[84:87], v[104:107], v[60:63]
    ds_read_b32 v228, v241 offset:10416
    v_mfma_f32_16x16x32_bf16 v[60:63], v[80:83], v[108:111], v[60:63]
    ds_read2_b32 v[156:157], v239 offset0:208 offset1:209
    v_mfma_f32_16x16x32_bf16 v[60:63], v[76:79], v[112:115], v[60:63]
    ds_read_b128 v[230:233], v241 offset:11424
    v_mfma_f32_16x16x32_bf16 v[60:63], v[72:75], v[116:119], v[60:63]
    ds_read2_b32 v[158:159], v239 offset0:210 offset1:211
    v_mfma_f32_16x16x32_bf16 v[60:63], v[68:71], v[120:123], v[60:63]
    ds_read_b32 v234, v241 offset:11440
    v_mfma_f32_16x16x32_bf16 v[60:63], v[64:67], v[124:127], v[60:63]
    s_waitcnt lgkmcnt(15)
    v_mfma_f32_16x16x32_bf16 v[32:35], v[128:131], v[160:163], v[32:35]
    ds_read_b128 v[96:99], v246 offset:0
    v_mfma_f32_16x16x32_bf16 v[36:39], v[132:135], v[160:163], v[36:39]
    ds_read2_b32 v[64:65], v236 offset0:96 offset1:97
    v_mfma_f32_16x16x32_bf16 v[36:39], v[128:131], v[164:167], v[36:39]
    ds_read2_b32 v[66:67], v236 offset0:98 offset1:99
    v_mfma_f32_16x16x32_bf16 v[40:43], v[128:131], v[168:171], v[40:43]
    s_add_u32 m0, s73, 147456
    ds_read_b128 v[100:103], v246 offset:4096
    v_mfma_f32_16x16x32_bf16 v[40:43], v[132:135], v[164:167], v[40:43]
    buffer_load_dwordx4 v7, s[52:55], s14 offen offset:3072 lds
    ds_read2_b32 v[68:69], v236 offset0:224 offset1:225
    s_waitcnt lgkmcnt(5)
    v_mfma_f32_16x16x32_bf16 v[40:43], v[136:139], v[160:163], v[40:43]
    ds_read2_b32 v[70:71], v236 offset0:226 offset1:227
    v_mfma_f32_16x16x32_bf16 v[44:47], v[140:143], v[160:163], v[44:47]
    s_waitcnt vmcnt(8)
    ds_read_b128 v[104:107], v246 offset:8192
    v_mfma_f32_16x16x32_bf16 v[44:47], v[136:139], v[164:167], v[44:47]
    ds_read2_b32 v[72:73], v237 offset0:96 offset1:97
    v_mfma_f32_16x16x32_bf16 v[44:47], v[132:135], v[168:171], v[44:47]
    ds_read2_b32 v[74:75], v237 offset0:98 offset1:99
    v_lshlrev_b32 v9, 16, v9
    v_mfma_f32_16x16x32_bf16 v[44:47], v[128:131], v[172:175], v[44:47]
    ds_read_b128 v[108:111], v246 offset:12288
    v_mfma_f32_16x16x32_bf16 v[48:51], v[128:131], v[176:179], v[48:51]
    ds_read2_b32 v[76:77], v237 offset0:224 offset1:225
    v_lshlrev_b32 v208, 16, v212
    v_mfma_f32_16x16x32_bf16 v[48:51], v[132:135], v[172:175], v[48:51]
    ds_read2_b32 v[78:79], v237 offset0:226 offset1:227
    v_mfma_f32_16x16x32_bf16 v[48:51], v[136:139], v[168:171], v[48:51]
    ds_read_b128 v[112:115], v246 offset:16384
    v_add_f32 v9, v9, v208
    v_mfma_f32_16x16x32_bf16 v[48:51], v[140:143], v[164:167], v[48:51]
    ds_read2_b32 v[80:81], v238 offset0:96 offset1:97
    v_cvt_pk_bf16_f32 v9, v9, v9
    v_mfma_f32_16x16x32_bf16 v[48:51], v[144:147], v[160:163], v[48:51]
    ds_read2_b32 v[82:83], v238 offset0:98 offset1:99
    v_mfma_f32_16x16x32_bf16 v[52:55], v[148:151], v[160:163], v[52:55]
    ds_write_b16 v242, v9 offset:12480
    v_mfma_f32_16x16x32_bf16 v[52:55], v[144:147], v[164:167], v[52:55]
    ds_read_b128 v[116:119], v246 offset:20480
    v_mfma_f32_16x16x32_bf16 v[52:55], v[140:143], v[168:171], v[52:55]
    ds_write_b16 v242, v9 offset:8322
    v_mfma_f32_16x16x32_bf16 v[52:55], v[136:139], v[172:175], v[52:55]
    ds_read2_b32 v[84:85], v238 offset0:224 offset1:225
    v_mfma_f32_16x16x32_bf16 v[52:55], v[132:135], v[176:179], v[52:55]
    ds_read2_b32 v[86:87], v238 offset0:226 offset1:227
    v_alignbit_b32 v212, v213, v212, 16
    v_mfma_f32_16x16x32_bf16 v[52:55], v[128:131], v[180:183], v[52:55]
    ds_read_b128 v[120:123], v246 offset:24576
    v_alignbit_b32 v213, v214, v213, 16
    v_mfma_f32_16x16x32_bf16 v[56:59], v[128:131], v[184:187], v[56:59]
    ds_read2_b32 v[88:89], v239 offset0:96 offset1:97
    s_waitcnt vmcnt(4)
    s_barrier
    v_mfma_f32_16x16x32_bf16 v[56:59], v[132:135], v[180:183], v[56:59]
    v_add_u32 v10, -131072, v10
    v_alignbit_b32 v214, v215, v214, 16
    v_mfma_f32_16x16x32_bf16 v[56:59], v[136:139], v[176:179], v[56:59]
    ds_read_b64_tr_b16 a[16:17], v10 offset:49152
    v_alignbit_b32 v215, v216, v215, 16
    v_mfma_f32_16x16x32_bf16 v[56:59], v[140:143], v[172:175], v[56:59]
    ds_write_b128 v241, v[212:215] offset:12512
    v_mfma_f32_16x16x32_bf16 v[56:59], v[144:147], v[168:171], v[56:59]
    ds_read_b64_tr_b16 a[18:19], v10 offset:51200
    v_mfma_f32_16x16x32_bf16 v[56:59], v[148:151], v[164:167], v[56:59]
    ds_read_b64_tr_b16 a[24:25], v10 offset:53248
    v_mfma_f32_16x16x32_bf16 v[56:59], v[152:155], v[160:163], v[56:59]
    ds_read_b64_tr_b16 a[26:27], v10 offset:55296
    v_mfma_f32_16x16x32_bf16 v[60:63], v[156:159], v[160:163], v[60:63]
    ds_read2_b32 v[90:91], v239 offset0:98 offset1:99
    v_add_u32 v11, -131072, v11
    v_alignbit_b32 v218, v219, v218, 16
    v_mfma_f32_16x16x32_bf16 v[60:63], v[152:155], v[164:167], v[60:63]
    ds_read_b64_tr_b16 a[20:21], v11 offset:49152
    v_alignbit_b32 v219, v220, v219, 16
    v_mfma_f32_16x16x32_bf16 v[60:63], v[148:151], v[168:171], v[60:63]
    ds_read_b128 v[124:127], v246 offset:28672
    ds_read2_b32 v[92:93], v239 offset0:224 offset1:225
    v_mfma_f32_16x16x32_bf16 v[60:63], v[144:147], v[172:175], v[60:63]
    ds_read_b64_tr_b16 a[22:23], v11 offset:51200
    v_alignbit_b32 v220, v221, v220, 16
    v_mfma_f32_16x16x32_bf16 v[60:63], v[140:143], v[176:179], v[60:63]
    ds_read_b64_tr_b16 a[28:29], v11 offset:53248
    ds_read2_b32 v[94:95], v239 offset0:226 offset1:227
    v_mfma_f32_16x16x32_bf16 v[60:63], v[136:139], v[180:183], v[60:63]
    ds_read_b64_tr_b16 a[30:31], v11 offset:55296
    v_alignbit_b32 v221, v222, v221, 16
    v_mfma_f32_16x16x32_bf16 v[60:63], v[132:135], v[184:187], v[60:63]
    ds_write_b128 v241, v[218:221] offset:13536
    v_mfma_f32_16x16x32_bf16 v[60:63], v[128:131], v[188:191], v[60:63]
    s_waitcnt lgkmcnt(15)
    v_mfma_f32_16x16x32_bf16 v[32:35], v[64:67], v[96:99], v[32:35]
    ds_read_b128 v[160:163], v247 offset:0
    s_waitcnt lgkmcnt(2)
    s_barrier
    v_mfma_f32_16x16x32_bf16 v[36:39], v[68:71], v[96:99], v[36:39]
    v_alignbit_b32 v224, v225, v224, 16
    v_mfma_f32_16x16x32_bf16 v[36:39], v[64:67], v[100:103], v[36:39]
    ds_read_b128 v[164:167], v247 offset:4096
    v_mfma_f32_16x16x32_bf16 v[40:43], v[64:67], v[104:107], v[40:43]
    s_lshl_b32 s14, s87, 18
    ds_read_b128 v[168:171], v247 offset:8192
L_pl_X_2:
    s_cbranch_execz L_pl_X_6
    v_mfma_f32_16x16x32_bf16 v[40:43], v[68:71], v[100:103], v[40:43]
    s_add_u32 m0, s73, 49152
    ds_read_b128 v[172:175], v247 offset:12288
    v_mfma_f32_16x16x32_bf16 v[40:43], v[72:75], v[96:99], v[40:43]
    buffer_load_dwordx4 v4, s[52:55], s14 offen offset:0 lds
    v_alignbit_b32 v225, v226, v225, 16
    v_mfma_f32_16x16x32_bf16 v[44:47], v[76:79], v[96:99], v[44:47]
    ds_read_b128 v[176:179], v247 offset:16384
    v_mfma_f32_16x16x32_bf16 v[44:47], v[72:75], v[100:103], v[44:47]
    ds_read_b128 v[180:183], v247 offset:20480
    v_mfma_f32_16x16x32_bf16 v[44:47], v[68:71], v[104:107], v[44:47]
    ds_read_b128 v[184:187], v247 offset:24576
    v_mfma_f32_16x16x32_bf16 v[44:47], v[64:67], v[108:111], v[44:47]
    v_alignbit_b32 v226, v227, v226, 16
    v_mfma_f32_16x16x32_bf16 v[48:51], v[64:67], v[112:115], v[48:51]
    ds_read_b128 v[188:191], v247 offset:28672
    v_mfma_f32_16x16x32_bf16 v[48:51], v[68:71], v[108:111], v[48:51]
    ds_read2_b32 v[128:129], v236 offset0:112 offset1:113
    v_mfma_f32_16x16x32_bf16 v[48:51], v[72:75], v[104:107], v[48:51]
    v_alignbit_b32 v227, v228, v227, 16
    v_mfma_f32_16x16x32_bf16 v[48:51], v[76:79], v[100:103], v[48:51]
    ds_read2_b32 v[130:131], v236 offset0:114 offset1:115
    v_mfma_f32_16x16x32_bf16 v[48:51], v[80:83], v[96:99], v[48:51]
    ds_read2_b32 v[132:133], v236 offset0:240 offset1:241
    v_mfma_f32_16x16x32_bf16 v[52:55], v[84:87], v[96:99], v[52:55]
    ds_write_b128 v241, v[224:227] offset:14560
    v_mfma_f32_16x16x32_bf16 v[52:55], v[80:83], v[100:103], v[52:55]
    s_add_u32 m0, s73, 49152
    ds_read2_b32 v[134:135], v236 offset0:242 offset1:243
    v_mfma_f32_16x16x32_bf16 v[52:55], v[76:79], v[104:107], v[52:55]
    buffer_load_dwordx4 v5, s[52:55], s14 offen offset:1024 lds
    ds_read2_b32 v[136:137], v237 offset0:112 offset1:113
    v_mfma_f32_16x16x32_bf16 v[52:55], v[72:75], v[108:111], v[52:55]
    s_add_u32 s6, s12, 4718592
    ds_read2_b32 v[138:139], v237 offset0:114 offset1:115
    v_mfma_f32_16x16x32_bf16 v[52:55], v[68:71], v[112:115], v[52:55]
    ds_read2_b32 v[140:141], v237 offset0:240 offset1:241
    v_alignbit_b32 v230, v231, v230, 16
    v_mfma_f32_16x16x32_bf16 v[52:55], v[64:67], v[116:119], v[52:55]
    ds_read2_b32 v[142:143], v237 offset0:242 offset1:243
    v_xor_b32 v244, 64, v244
    v_mfma_f32_16x16x32_bf16 v[56:59], v[64:67], v[120:123], v[56:59]
    ds_read2_b32 v[144:145], v238 offset0:112 offset1:113
    v_mfma_f32_16x16x32_bf16 v[56:59], v[68:71], v[116:119], v[56:59]
    ds_read2_b32 v[146:147], v238 offset0:114 offset1:115
    v_mfma_f32_16x16x32_bf16 v[56:59], v[72:75], v[112:115], v[56:59]
    ds_read2_b32 v[148:149], v238 offset0:240 offset1:241
    v_alignbit_b32 v231, v232, v231, 16
    v_mfma_f32_16x16x32_bf16 v[56:59], v[76:79], v[108:111], v[56:59]
    ds_read2_b32 v[150:151], v238 offset0:242 offset1:243
    v_xor_b32 v245, 64, v245
    v_mfma_f32_16x16x32_bf16 v[56:59], v[80:83], v[104:107], v[56:59]
    ds_read2_b32 v[152:153], v239 offset0:112 offset1:113
    v_mfma_f32_16x16x32_bf16 v[56:59], v[84:87], v[100:103], v[56:59]
    ds_read2_b32 v[154:155], v239 offset0:114 offset1:115
    v_mfma_f32_16x16x32_bf16 v[56:59], v[88:91], v[96:99], v[56:59]
    ds_read2_b32 v[156:157], v239 offset0:240 offset1:241
    v_alignbit_b32 v232, v233, v232, 16
    v_mfma_f32_16x16x32_bf16 v[60:63], v[92:95], v[96:99], v[60:63]
    s_add_u32 m0, s73, 49152
    ds_read2_b32 v[158:159], v239 offset0:242 offset1:243
    v_mfma_f32_16x16x32_bf16 v[60:63], v[88:91], v[100:103], v[60:63]
    buffer_load_dwordx4 v6, s[52:55], s14 offen offset:2048 lds
    v_xor_b32 v246, 64, v246
    v_mfma_f32_16x16x32_bf16 v[60:63], v[84:87], v[104:107], v[60:63]
    v_alignbit_b32 v233, v234, v233, 16
    v_add_u32 v236, 8320, v236
    v_mfma_f32_16x16x32_bf16 v[60:63], v[80:83], v[108:111], v[60:63]
    v_add_u32 v237, 8320, v237
    v_mfma_f32_16x16x32_bf16 v[60:63], v[76:79], v[112:115], v[60:63]
    v_mfma_f32_16x16x32_bf16 v[60:63], v[72:75], v[116:119], v[60:63]
    v_xor_b32 v247, 64, v247
    v_add_u32 v238, 8320, v238
    v_mfma_f32_16x16x32_bf16 v[60:63], v[68:71], v[120:123], v[60:63]
    ds_write_b128 v241, v[230:233] offset:15584
    v_mfma_f32_16x16x32_bf16 v[60:63], v[64:67], v[124:127], v[60:63]
    v_add_u32 v239, 8320, v239
    s_waitcnt lgkmcnt(1)
    v_mfma_f32_16x16x32_bf16 v[60:63], v[128:131], v[188:191], v[60:63]
    ds_read_b128 v[96:99], v244 offset:2048
    v_mfma_f32_16x16x32_bf16 v[60:63], v[132:135], v[184:187], v[60:63]
    ds_read2_b32 v[64:65], v236 offset0:0 offset1:1
    v_mfma_f32_16x16x32_bf16 v[60:63], v[136:139], v[180:183], v[60:63]
    ds_read2_b32 v[66:67], v236 offset0:2 offset1:3
    v_mfma_f32_16x16x32_bf16 v[60:63], v[140:143], v[176:179], v[60:63]
    s_add_u32 m0, s73, 49152
    ds_read_b128 v[100:103], v244 offset:6144
    v_mfma_f32_16x16x32_bf16 v[60:63], v[144:147], v[172:175], v[60:63]
    buffer_load_dwordx4 v7, s[52:55], s14 offen offset:3072 lds
    ds_read2_b32 v[68:69], v236 offset0:128 offset1:129
    v_mfma_f32_16x16x32_bf16 v[60:63], v[148:151], v[168:171], v[60:63]
    ds_read2_b32 v[70:71], v236 offset0:130 offset1:131
    v_mfma_f32_16x16x32_bf16 v[60:63], v[152:155], v[164:167], v[60:63]
    ds_read_b128 v[104:107], v244 offset:10240
    v_mfma_f32_16x16x32_bf16 v[60:63], v[156:159], v[160:163], v[60:63]
    ds_read2_b32 v[72:73], v237 offset0:0 offset1:1
    v_mfma_f32_16x16x32_bf16 v[56:59], v[128:131], v[184:187], v[56:59]
    ds_read2_b32 v[74:75], v237 offset0:2 offset1:3
    v_mfma_f32_16x16x32_bf16 v[56:59], v[132:135], v[180:183], v[56:59]
    ds_read_b128 v[108:111], v244 offset:14336
    v_mfma_f32_16x16x32_bf16 v[56:59], v[136:139], v[176:179], v[56:59]
    ds_read2_b32 v[76:77], v237 offset0:128 offset1:129
    v_mfma_f32_16x16x32_bf16 v[56:59], v[140:143], v[172:175], v[56:59]
    ds_read2_b32 v[78:79], v237 offset0:130 offset1:131
    v_mfma_f32_16x16x32_bf16 v[56:59], v[144:147], v[168:171], v[56:59]
    ds_read_b128 v[112:115], v244 offset:18432
    v_mfma_f32_16x16x32_bf16 v[56:59], v[148:151], v[164:167], v[56:59]
    ds_read2_b32 v[80:81], v238 offset0:0 offset1:1
    v_cvt_pk_bf16_f32 v206, v60, v61
    v_mfma_f32_16x16x32_bf16 v[56:59], v[152:155], v[160:163], v[56:59]
    ds_read2_b32 v[82:83], v238 offset0:2 offset1:3
    v_mfma_f32_16x16x32_bf16 v[52:55], v[128:131], v[180:183], v[52:55]
    ds_read_b128 v[116:119], v244 offset:22528
    v_mfma_f32_16x16x32_bf16 v[52:55], v[132:135], v[176:179], v[52:55]
    ds_read2_b32 v[84:85], v238 offset0:128 offset1:129
    v_cvt_pk_bf16_f32 v207, v62, v63
    v_mfma_f32_16x16x32_bf16 v[52:55], v[136:139], v[172:175], v[52:55]
    ds_read2_b32 v[86:87], v238 offset0:130 offset1:131
    v_mfma_f32_16x16x32_bf16 v[52:55], v[140:143], v[168:171], v[52:55]
    buffer_store_dwordx2 v[206:207], v8, s[44:47], s6 offen offset:3584 sc1
    ds_read_b128 v[120:123], v244 offset:26624
    v_mfma_f32_16x16x32_bf16 v[52:55], v[144:147], v[164:167], v[52:55]
    ds_read2_b32 v[88:89], v239 offset0:0 offset1:1
    v_mfma_f32_16x16x32_bf16 v[52:55], v[148:151], v[160:163], v[52:55]
    ds_read2_b32 v[90:91], v239 offset0:2 offset1:3
    v_mfma_f32_16x16x32_bf16 v[48:51], v[128:131], v[176:179], v[48:51]
    s_waitcnt vmcnt(5)
    s_barrier
    v_cvt_pk_bf16_f32 v204, v56, v57
    v_mfma_f32_16x16x32_bf16 v[48:51], v[132:135], v[172:175], v[48:51]
    ds_read_b128 v[124:127], v244 offset:30720
    v_add_u32 v10, 131072, v10
    v_mfma_f32_16x16x32_bf16 v[48:51], v[136:139], v[168:171], v[48:51]
    ds_read_b64_tr_b16 a[32:33], v10 offset:16384
    v_mfma_f32_16x16x32_bf16 v[48:51], v[140:143], v[164:167], v[48:51]
    ds_read2_b32 v[92:93], v239 offset0:128 offset1:129
    v_cvt_pk_bf16_f32 v205, v58, v59
    v_mfma_f32_16x16x32_bf16 v[48:51], v[144:147], v[160:163], v[48:51]
    ds_read_b64_tr_b16 a[34:35], v10 offset:18432
    v_mfma_f32_16x16x32_bf16 v[44:47], v[128:131], v[172:175], v[44:47]
    buffer_store_dwordx2 v[204:205], v8, s[44:47], s6 offen offset:3072 sc1
    ds_read_b64_tr_b16 a[40:41], v10 offset:20480
    v_mfma_f32_16x16x32_bf16 v[44:47], v[132:135], v[168:171], v[44:47]
    ds_read_b64_tr_b16 a[42:43], v10 offset:22528
    v_mfma_f32_16x16x32_bf16 v[44:47], v[136:139], v[164:167], v[44:47]
    ds_read2_b32 v[94:95], v239 offset0:130 offset1:131
    v_add_u32 v11, 131072, v11
    v_mfma_f32_16x16x32_bf16 v[44:47], v[140:143], v[160:163], v[44:47]
    ds_read_b64_tr_b16 a[36:37], v11 offset:16384
    v_cvt_pk_bf16_f32 v202, v52, v53
    v_mfma_f32_16x16x32_bf16 v[40:43], v[128:131], v[168:171], v[40:43]
    v_mfma_f32_16x16x32_bf16 v[40:43], v[132:135], v[164:167], v[40:43]
    ds_read_b64_tr_b16 a[38:39], v11 offset:18432
    v_mfma_f32_16x16x32_bf16 v[40:43], v[136:139], v[160:163], v[40:43]
    ds_read_b64_tr_b16 a[44:45], v11 offset:20480
    v_cvt_pk_bf16_f32 v203, v54, v55
    v_mfma_f32_16x16x32_bf16 v[36:39], v[128:131], v[164:167], v[36:39]
    ds_read_b64_tr_b16 a[46:47], v11 offset:22528
    v_mfma_f32_16x16x32_bf16 v[36:39], v[132:135], v[160:163], v[36:39]
    buffer_store_dwordx2 v[202:203], v8, s[44:47], s6 offen offset:2560 sc1
    v_mfma_f32_16x16x32_bf16 v[32:35], v[128:131], v[160:163], v[32:35]
    s_waitcnt lgkmcnt(4)
    v_mfma_f32_16x16x32_bf16 v[60:63], v[64:67], v[124:127], 0
    ds_read_b128 v[160:163], v245 offset:2048
    s_waitcnt lgkmcnt(1)
    s_barrier
    v_mfma_f32_16x16x32_bf16 v[60:63], v[68:71], v[120:123], v[60:63]
    v_cvt_pk_bf16_f32 v200, v48, v49
    v_mfma_f32_16x16x32_bf16 v[60:63], v[72:75], v[116:119], v[60:63]
    ds_read2_b32 v[128:129], v236 offset0:16 offset1:17
    v_mfma_f32_16x16x32_bf16 v[60:63], v[76:79], v[112:115], v[60:63]
    ds_read2_b32 v[130:131], v236 offset0:18 offset1:19
    s_lshl_b32 s14, s88, 18
    v_cvt_pk_bf16_f32 v201, v50, v51
    v_mfma_f32_16x16x32_bf16 v[60:63], v[80:83], v[108:111], v[60:63]
    s_add_u32 m0, s73, 147456
    v_mfma_f32_16x16x32_bf16 v[60:63], v[84:87], v[104:107], v[60:63]
    buffer_load_dwordx4 v4, s[52:55], s14 offen offset:0 lds
    ds_read_b128 v[164:167], v245 offset:6144
    v_mfma_f32_16x16x32_bf16 v[60:63], v[88:91], v[100:103], v[60:63]
    buffer_store_dwordx2 v[200:201], v8, s[44:47], s6 offen offset:2048 sc1
    ds_read2_b32 v[132:133], v236 offset0:144 offset1:145
    v_mfma_f32_16x16x32_bf16 v[60:63], v[92:95], v[96:99], v[60:63]
    s_add_u32 s13, s12, 32768
    v_cvt_pk_bf16_f32 v198, v44, v45
    v_mfma_f32_16x16x32_bf16 v[56:59], v[64:67], v[120:123], 0
    ds_read2_b32 v[134:135], v236 offset0:146 offset1:147
    v_mfma_f32_16x16x32_bf16 v[56:59], v[68:71], v[116:119], v[56:59]
    s_add_u32 m0, s74, 32
    ds_read_b128 v[168:171], v245 offset:10240
    v_mfma_f32_16x16x32_bf16 v[56:59], v[72:75], v[112:115], v[56:59]
    buffer_load_dwordx4 v240, s[48:51], s13 offen offset:0 lds
    v_cvt_pk_bf16_f32 v199, v46, v47
    v_mfma_f32_16x16x32_bf16 v[56:59], v[76:79], v[108:111], v[56:59]
    ds_read2_b32 v[136:137], v237 offset0:16 offset1:17
    v_mfma_f32_16x16x32_bf16 v[56:59], v[80:83], v[104:107], v[56:59]
    buffer_store_dwordx2 v[198:199], v8, s[44:47], s6 offen offset:1536 sc1
    ds_read2_b32 v[138:139], v237 offset0:18 offset1:19
    v_mfma_f32_16x16x32_bf16 v[56:59], v[84:87], v[100:103], v[56:59]
    ds_read_b128 v[172:175], v245 offset:14336
    v_mfma_f32_16x16x32_bf16 v[56:59], v[88:91], v[96:99], v[56:59]
    v_cvt_pk_bf16_f32 v196, v40, v41
    v_mfma_f32_16x16x32_bf16 v[52:55], v[64:67], v[116:119], 0
    ds_read2_b32 v[140:141], v237 offset0:144 offset1:145
    v_mfma_f32_16x16x32_bf16 v[52:55], v[68:71], v[112:115], v[52:55]
    ds_read2_b32 v[142:143], v237 offset0:146 offset1:147
    s_add_u32 m0, s73, 147456
    v_cvt_pk_bf16_f32 v197, v42, v43
    v_mfma_f32_16x16x32_bf16 v[52:55], v[72:75], v[108:111], v[52:55]
    buffer_load_dwordx4 v5, s[52:55], s14 offen offset:1024 lds
    v_mfma_f32_16x16x32_bf16 v[52:55], v[76:79], v[104:107], v[52:55]
    buffer_store_dwordx2 v[196:197], v8, s[44:47], s6 offen offset:1024 sc1
    ds_read_b128 v[176:179], v245 offset:18432
    s_add_u32 m0, s74, 32
    v_mfma_f32_16x16x32_bf16 v[52:55], v[80:83], v[100:103], v[52:55]
    buffer_load_dwordx4 v240, s[48:51], s13 offen offset:1024 lds
    ds_read2_b32 v[144:145], v238 offset0:16 offset1:17
    v_mfma_f32_16x16x32_bf16 v[52:55], v[84:87], v[96:99], v[52:55]
    v_mfma_f32_16x16x32_bf16 v[48:51], v[64:67], v[112:115], 0
    ds_read2_b32 v[146:147], v238 offset0:18 offset1:19
    v_cvt_pk_bf16_f32 v194, v36, v37
    v_mfma_f32_16x16x32_bf16 v[48:51], v[68:71], v[108:111], v[48:51]
    ds_read_b128 v[180:183], v245 offset:22528
    v_mfma_f32_16x16x32_bf16 v[48:51], v[72:75], v[104:107], v[48:51]
    v_cvt_pk_bf16_f32 v195, v38, v39
    v_mfma_f32_16x16x32_bf16 v[48:51], v[76:79], v[100:103], v[48:51]
    buffer_store_dwordx2 v[194:195], v8, s[44:47], s6 offen offset:512 sc1
    ds_read2_b32 v[148:149], v238 offset0:144 offset1:145
    s_add_u32 m0, s74, 32
    v_mfma_f32_16x16x32_bf16 v[48:51], v[80:83], v[96:99], v[48:51]
    buffer_load_dwordx4 v240, s[48:51], s13 offen offset:2048 lds
    ds_read2_b32 v[150:151], v238 offset0:146 offset1:147
    v_mfma_f32_16x16x32_bf16 v[44:47], v[64:67], v[108:111], 0
    ds_read_b128 v[184:187], v245 offset:26624
    v_mfma_f32_16x16x32_bf16 v[44:47], v[68:71], v[104:107], v[44:47]
    v_cvt_pk_bf16_f32 v192, v32, v33
    v_mfma_f32_16x16x32_bf16 v[44:47], v[72:75], v[100:103], v[44:47]
    s_add_u32 m0, s73, 147456
    ds_read2_b32 v[152:153], v239 offset0:16 offset1:17
    v_mfma_f32_16x16x32_bf16 v[44:47], v[76:79], v[96:99], v[44:47]
    buffer_load_dwordx4 v6, s[52:55], s14 offen offset:2048 lds
    v_cvt_pk_bf16_f32 v193, v34, v35
    v_mfma_f32_16x16x32_bf16 v[40:43], v[64:67], v[104:107], 0
    ds_read2_b32 v[154:155], v239 offset0:18 offset1:19
    v_mfma_f32_16x16x32_bf16 v[40:43], v[68:71], v[100:103], v[40:43]
    buffer_store_dwordx2 v[192:193], v8, s[44:47], s6 offen offset:0 sc1
    ds_read_b128 v[188:191], v245 offset:30720
    v_mfma_f32_16x16x32_bf16 v[40:43], v[72:75], v[96:99], v[40:43]
    s_add_u32 m0, s74, 32
    ds_read2_b32 v[156:157], v239 offset0:144 offset1:145
    v_mfma_f32_16x16x32_bf16 v[36:39], v[64:67], v[100:103], 0
    buffer_load_dwordx4 v240, s[48:51], s13 offen offset:3072 lds
    v_mfma_f32_16x16x32_bf16 v[36:39], v[68:71], v[96:99], v[36:39]
    ds_read2_b32 v[158:159], v239 offset0:146 offset1:147
    v_mfma_f32_16x16x32_bf16 v[32:35], v[64:67], v[96:99], 0
    s_waitcnt lgkmcnt(12)
    v_mfma_f32_16x16x32_bf16 v[32:35], v[128:131], v[160:163], v[32:35]
    ds_read_b128 v[96:99], v246 offset:2048
    v_mfma_f32_16x16x32_bf16 v[36:39], v[132:135], v[160:163], v[36:39]
    v_mfma_f32_16x16x32_bf16 v[36:39], v[128:131], v[164:167], v[36:39]
    ds_read2_b32 v[64:65], v236 offset0:32 offset1:33
    v_mfma_f32_16x16x32_bf16 v[40:43], v[128:131], v[168:171], v[40:43]
    s_add_u32 m0, s73, 147456
    ds_read2_b32 v[66:67], v236 offset0:34 offset1:35
    v_mfma_f32_16x16x32_bf16 v[40:43], v[132:135], v[164:167], v[40:43]
    buffer_load_dwordx4 v7, s[52:55], s14 offen offset:3072 lds
    v_mfma_f32_16x16x32_bf16 v[40:43], v[136:139], v[160:163], v[40:43]
    ds_read_b128 v[100:103], v246 offset:6144
    v_mfma_f32_16x16x32_bf16 v[44:47], v[140:143], v[160:163], v[44:47]
    ds_read2_b32 v[68:69], v236 offset0:160 offset1:161
    v_mfma_f32_16x16x32_bf16 v[44:47], v[136:139], v[164:167], v[44:47]
    ds_read2_b32 v[70:71], v236 offset0:162 offset1:163
    v_mfma_f32_16x16x32_bf16 v[44:47], v[132:135], v[168:171], v[44:47]
    ds_read_b128 v[104:107], v246 offset:10240
    v_mfma_f32_16x16x32_bf16 v[44:47], v[128:131], v[172:175], v[44:47]
    ds_read2_b32 v[72:73], v237 offset0:32 offset1:33
    s_waitcnt lgkmcnt(8)
    v_mfma_f32_16x16x32_bf16 v[48:51], v[128:131], v[176:179], v[48:51]
    ds_read2_b32 v[74:75], v237 offset0:34 offset1:35
    v_mfma_f32_16x16x32_bf16 v[48:51], v[132:135], v[172:175], v[48:51]
    ds_read_b128 v[108:111], v246 offset:14336
    v_mfma_f32_16x16x32_bf16 v[48:51], v[136:139], v[168:171], v[48:51]
    v_mov_b32 v9, 16
    buffer_load_ushort v9, v9, s[56:59], s70 offen
    v_mfma_f32_16x16x32_bf16 v[48:51], v[140:143], v[164:167], v[48:51]
    ds_read2_b32 v[76:77], v237 offset0:160 offset1:161
    v_mfma_f32_16x16x32_bf16 v[48:51], v[144:147], v[160:163], v[48:51]
    ds_read2_b32 v[78:79], v237 offset0:162 offset1:163
    s_waitcnt vmcnt(17)
    s_barrier
    v_mfma_f32_16x16x32_bf16 v[52:55], v[148:151], v[160:163], v[52:55]
    ds_read_b128 v[112:115], v246 offset:18432
    v_add_u32 v10, -131072, v10
    v_mfma_f32_16x16x32_bf16 v[52:55], v[144:147], v[164:167], v[52:55]
    ds_read_b64_tr_b16 a[48:49], v10 offset:49152
    v_mfma_f32_16x16x32_bf16 v[52:55], v[140:143], v[168:171], v[52:55]
    ds_read_b64_tr_b16 a[50:51], v10 offset:51200
    v_mfma_f32_16x16x32_bf16 v[52:55], v[136:139], v[172:175], v[52:55]
    ds_read2_b32 v[80:81], v238 offset0:32 offset1:33
    v_mfma_f32_16x16x32_bf16 v[52:55], v[132:135], v[176:179], v[52:55]
    ds_read_b64_tr_b16 a[56:57], v10 offset:53248
    v_mfma_f32_16x16x32_bf16 v[52:55], v[128:131], v[180:183], v[52:55]
    ds_read_b64_tr_b16 a[58:59], v10 offset:55296
    v_mfma_f32_16x16x32_bf16 v[56:59], v[128:131], v[184:187], v[56:59]
    ds_read2_b32 v[82:83], v238 offset0:34 offset1:35
    v_add_u32 v11, -131072, v11
    v_mfma_f32_16x16x32_bf16 v[56:59], v[132:135], v[180:183], v[56:59]
    ds_read_b64_tr_b16 a[52:53], v11 offset:49152
    v_mfma_f32_16x16x32_bf16 v[56:59], v[136:139], v[176:179], v[56:59]
    ds_read_b64_tr_b16 a[54:55], v11 offset:51200
    v_mfma_f32_16x16x32_bf16 v[56:59], v[140:143], v[172:175], v[56:59]
    ds_read_b128 v[116:119], v246 offset:22528
    v_mfma_f32_16x16x32_bf16 v[56:59], v[144:147], v[168:171], v[56:59]
    ds_read_b64_tr_b16 a[60:61], v11 offset:53248
    v_mfma_f32_16x16x32_bf16 v[56:59], v[148:151], v[164:167], v[56:59]
    ds_read_b64_tr_b16 a[62:63], v11 offset:55296
    v_mfma_f32_16x16x32_bf16 v[56:59], v[152:155], v[160:163], v[56:59]
    ds_read2_b32 v[84:85], v238 offset0:160 offset1:161
    v_mfma_f32_16x16x32_bf16 v[60:63], v[156:159], v[160:163], v[60:63]
    ds_read2_b32 v[86:87], v238 offset0:162 offset1:163
    v_mfma_f32_16x16x32_bf16 v[60:63], v[152:155], v[164:167], v[60:63]
    ds_read_b128 v[120:123], v246 offset:26624
    v_mfma_f32_16x16x32_bf16 v[60:63], v[148:151], v[168:171], v[60:63]
    ds_read2_b32 v[88:89], v239 offset0:32 offset1:33
    v_mfma_f32_16x16x32_bf16 v[60:63], v[144:147], v[172:175], v[60:63]
    ds_read2_b32 v[90:91], v239 offset0:34 offset1:35
    v_mfma_f32_16x16x32_bf16 v[60:63], v[140:143], v[176:179], v[60:63]
    ds_read_b128 v[124:127], v246 offset:30720
    v_mfma_f32_16x16x32_bf16 v[60:63], v[136:139], v[180:183], v[60:63]
    ds_read2_b32 v[92:93], v239 offset0:160 offset1:161
    v_mfma_f32_16x16x32_bf16 v[60:63], v[132:135], v[184:187], v[60:63]
    ds_read2_b32 v[94:95], v239 offset0:162 offset1:163
    v_mfma_f32_16x16x32_bf16 v[60:63], v[128:131], v[188:191], v[60:63]
    s_waitcnt lgkmcnt(15)
    v_mfma_f32_16x16x32_bf16 v[32:35], v[64:67], v[96:99], v[32:35]
    ds_read_b128 v[160:163], v247 offset:2048
    v_mfma_f32_16x16x32_bf16 v[36:39], v[68:71], v[96:99], v[36:39]
    v_mfma_f32_16x16x32_bf16 v[36:39], v[64:67], v[100:103], v[36:39]
    ds_read2_b32 v[128:129], v236 offset0:48 offset1:49
    v_mfma_f32_16x16x32_bf16 v[40:43], v[64:67], v[104:107], v[40:43]
    ds_read2_b32 v[130:131], v236 offset0:50 offset1:51
    v_mfma_f32_16x16x32_bf16 v[40:43], v[68:71], v[100:103], v[40:43]
    v_mfma_f32_16x16x32_bf16 v[40:43], v[72:75], v[96:99], v[40:43]
    ds_read_b128 v[164:167], v247 offset:6144
    v_mfma_f32_16x16x32_bf16 v[44:47], v[76:79], v[96:99], v[44:47]
    ds_read2_b32 v[132:133], v236 offset0:176 offset1:177
    v_mfma_f32_16x16x32_bf16 v[44:47], v[72:75], v[100:103], v[44:47]
    s_waitcnt lgkmcnt(13)
    s_barrier
    v_mfma_f32_16x16x32_bf16 v[44:47], v[68:71], v[104:107], v[44:47]
    ds_read2_b32 v[134:135], v236 offset0:178 offset1:179
    v_mfma_f32_16x16x32_bf16 v[44:47], v[64:67], v[108:111], v[44:47]
    ds_read_b128 v[168:171], v247 offset:10240
    s_waitcnt lgkmcnt(7)
    v_mfma_f32_16x16x32_bf16 v[48:51], v[64:67], v[112:115], v[48:51]
    ds_read2_b32 v[136:137], v237 offset0:48 offset1:49
    v_mfma_f32_16x16x32_bf16 v[48:51], v[68:71], v[108:111], v[48:51]
    v_mfma_f32_16x16x32_bf16 v[48:51], v[72:75], v[104:107], v[48:51]
    ds_read2_b32 v[138:139], v237 offset0:50 offset1:51
    v_mfma_f32_16x16x32_bf16 v[48:51], v[76:79], v[100:103], v[48:51]
    ds_read_b128 v[172:175], v247 offset:14336
    v_mfma_f32_16x16x32_bf16 v[48:51], v[80:83], v[96:99], v[48:51]
    v_mfma_f32_16x16x32_bf16 v[52:55], v[84:87], v[96:99], v[52:55]
    ds_read2_b32 v[140:141], v237 offset0:176 offset1:177
    v_mfma_f32_16x16x32_bf16 v[52:55], v[80:83], v[100:103], v[52:55]
    ds_read2_b32 v[142:143], v237 offset0:178 offset1:179
    v_mfma_f32_16x16x32_bf16 v[52:55], v[76:79], v[104:107], v[52:55]
    v_mfma_f32_16x16x32_bf16 v[52:55], v[72:75], v[108:111], v[52:55]
    ds_read_b128 v[176:179], v247 offset:18432
    v_mfma_f32_16x16x32_bf16 v[52:55], v[68:71], v[112:115], v[52:55]
    ds_read2_b32 v[144:145], v238 offset0:48 offset1:49
    v_mfma_f32_16x16x32_bf16 v[52:55], v[64:67], v[116:119], v[52:55]
    v_mfma_f32_16x16x32_bf16 v[56:59], v[64:67], v[120:123], v[56:59]
    ds_read2_b32 v[146:147], v238 offset0:50 offset1:51
    v_mfma_f32_16x16x32_bf16 v[56:59], v[68:71], v[116:119], v[56:59]
    ds_read_b128 v[180:183], v247 offset:22528
    v_mfma_f32_16x16x32_bf16 v[56:59], v[72:75], v[112:115], v[56:59]
    v_mfma_f32_16x16x32_bf16 v[56:59], v[76:79], v[108:111], v[56:59]
    ds_read2_b32 v[148:149], v238 offset0:176 offset1:177
    v_mfma_f32_16x16x32_bf16 v[56:59], v[80:83], v[104:107], v[56:59]
    ds_read2_b32 v[150:151], v238 offset0:178 offset1:179
    v_mfma_f32_16x16x32_bf16 v[56:59], v[84:87], v[100:103], v[56:59]
    ds_read_b128 v[184:187], v247 offset:26624
    v_mfma_f32_16x16x32_bf16 v[56:59], v[88:91], v[96:99], v[56:59]
    v_mfma_f32_16x16x32_bf16 v[60:63], v[92:95], v[96:99], v[60:63]
    ds_read2_b32 v[152:153], v239 offset0:48 offset1:49
    v_mfma_f32_16x16x32_bf16 v[60:63], v[88:91], v[100:103], v[60:63]
    ds_read2_b32 v[154:155], v239 offset0:50 offset1:51
    v_mfma_f32_16x16x32_bf16 v[60:63], v[84:87], v[104:107], v[60:63]
    v_mfma_f32_16x16x32_bf16 v[60:63], v[80:83], v[108:111], v[60:63]
    ds_read_b128 v[188:191], v247 offset:30720
    v_mfma_f32_16x16x32_bf16 v[60:63], v[76:79], v[112:115], v[60:63]
    ds_read2_b32 v[156:157], v239 offset0:176 offset1:177
    v_mfma_f32_16x16x32_bf16 v[60:63], v[72:75], v[116:119], v[60:63]
    v_mfma_f32_16x16x32_bf16 v[60:63], v[68:71], v[120:123], v[60:63]
    ds_read2_b32 v[158:159], v239 offset0:178 offset1:179
    v_mfma_f32_16x16x32_bf16 v[60:63], v[64:67], v[124:127], v[60:63]
    s_waitcnt lgkmcnt(12)
    v_mfma_f32_16x16x32_bf16 v[32:35], v[128:131], v[160:163], v[32:35]
    ds_read_b128 v[96:99], v244 offset:0
    v_mfma_f32_16x16x32_bf16 v[36:39], v[132:135], v[160:163], v[36:39]
    v_mfma_f32_16x16x32_bf16 v[36:39], v[128:131], v[164:167], v[36:39]
    ds_read2_b32 v[64:65], v236 offset0:64 offset1:65
    v_mfma_f32_16x16x32_bf16 v[40:43], v[128:131], v[168:171], v[40:43]
    ds_read2_b32 v[66:67], v236 offset0:66 offset1:67
    v_mfma_f32_16x16x32_bf16 v[40:43], v[132:135], v[164:167], v[40:43]
    v_mfma_f32_16x16x32_bf16 v[40:43], v[136:139], v[160:163], v[40:43]
    ds_read_b128 v[100:103], v244 offset:4096
    v_mfma_f32_16x16x32_bf16 v[44:47], v[140:143], v[160:163], v[44:47]
    ds_read2_b32 v[68:69], v236 offset0:192 offset1:193
    v_mfma_f32_16x16x32_bf16 v[44:47], v[136:139], v[164:167], v[44:47]
    s_add_u32 m0, s9, 36864
    s_add_u32 s13, s10, 128
    v_mfma_f32_16x16x32_bf16 v[44:47], v[132:135], v[168:171], v[44:47]
    buffer_load_dwordx4 v15, s[44:47], s13 offen sc1 lds
    ds_read2_b32 v[70:71], v236 offset0:194 offset1:195
    v_mfma_f32_16x16x32_bf16 v[44:47], v[128:131], v[172:175], v[44:47]
    ds_read_b128 v[104:107], v244 offset:8192
    s_waitcnt lgkmcnt(7)
    v_mfma_f32_16x16x32_bf16 v[48:51], v[128:131], v[176:179], v[48:51]
    ds_read2_b32 v[72:73], v237 offset0:64 offset1:65
    v_mfma_f32_16x16x32_bf16 v[48:51], v[132:135], v[172:175], v[48:51]
    ds_read2_b32 v[74:75], v237 offset0:66 offset1:67
    v_mfma_f32_16x16x32_bf16 v[48:51], v[136:139], v[168:171], v[48:51]
    ds_read_b128 v[108:111], v244 offset:12288
    v_mfma_f32_16x16x32_bf16 v[48:51], v[140:143], v[164:167], v[48:51]
    ds_read2_b32 v[76:77], v237 offset0:192 offset1:193
    v_mfma_f32_16x16x32_bf16 v[48:51], v[144:147], v[160:163], v[48:51]
    ds_read2_b32 v[78:79], v237 offset0:194 offset1:195
    v_mfma_f32_16x16x32_bf16 v[52:55], v[148:151], v[160:163], v[52:55]
    ds_read_b128 v[112:115], v244 offset:16384
    v_mfma_f32_16x16x32_bf16 v[52:55], v[144:147], v[164:167], v[52:55]
    ds_read2_b32 v[80:81], v238 offset0:64 offset1:65
    s_add_u32 m0, s9, 37888
    s_add_u32 s13, s10, 73856
    v_mfma_f32_16x16x32_bf16 v[52:55], v[140:143], v[168:171], v[52:55]
    buffer_load_dwordx4 v16, s[44:47], s13 offen sc1 lds
    ds_read2_b32 v[82:83], v238 offset0:66 offset1:67
    v_mfma_f32_16x16x32_bf16 v[52:55], v[136:139], v[172:175], v[52:55]
    ds_read_b128 v[116:119], v244 offset:20480
    v_mfma_f32_16x16x32_bf16 v[52:55], v[132:135], v[176:179], v[52:55]
    ds_read2_b32 v[84:85], v238 offset0:192 offset1:193
    v_mfma_f32_16x16x32_bf16 v[52:55], v[128:131], v[180:183], v[52:55]
    ds_read2_b32 v[86:87], v238 offset0:194 offset1:195
    v_mfma_f32_16x16x32_bf16 v[56:59], v[128:131], v[184:187], v[56:59]
    ds_read_b128 v[120:123], v244 offset:24576
    s_waitcnt vmcnt(3)
    s_barrier
    v_mfma_f32_16x16x32_bf16 v[56:59], v[132:135], v[180:183], v[56:59]
    ds_read2_b32 v[88:89], v239 offset0:64 offset1:65
    v_add_u32 v10, 131072, v10
    v_mfma_f32_16x16x32_bf16 v[56:59], v[136:139], v[176:179], v[56:59]
    ds_read_b64_tr_b16 a[64:65], v10 offset:16384
    v_mfma_f32_16x16x32_bf16 v[56:59], v[140:143], v[172:175], v[56:59]
    ds_read2_b32 v[90:91], v239 offset0:66 offset1:67
    v_mfma_f32_16x16x32_bf16 v[56:59], v[144:147], v[168:171], v[56:59]
    ds_read_b64_tr_b16 a[66:67], v10 offset:18432
    s_add_u32 m0, s9, 38912
    s_add_u32 s13, s10, 147584
    v_mfma_f32_16x16x32_bf16 v[56:59], v[148:151], v[164:167], v[56:59]
    ds_read_b64_tr_b16 a[72:73], v10 offset:20480
    buffer_load_dwordx4 v15, s[44:47], s13 offen sc1 lds
    v_mfma_f32_16x16x32_bf16 v[56:59], v[152:155], v[160:163], v[56:59]
    ds_read_b64_tr_b16 a[74:75], v10 offset:22528
    v_mfma_f32_16x16x32_bf16 v[60:63], v[156:159], v[160:163], v[60:63]
    ds_read_b128 v[124:127], v244 offset:28672
    v_add_u32 v11, 131072, v11
    v_mfma_f32_16x16x32_bf16 v[60:63], v[152:155], v[164:167], v[60:63]
    ds_read_b64_tr_b16 a[68:69], v11 offset:16384
    v_mfma_f32_16x16x32_bf16 v[60:63], v[148:151], v[168:171], v[60:63]
    ds_read2_b32 v[92:93], v239 offset0:192 offset1:193
    v_mfma_f32_16x16x32_bf16 v[60:63], v[144:147], v[172:175], v[60:63]
    ds_read_b64_tr_b16 a[70:71], v11 offset:18432
    v_mfma_f32_16x16x32_bf16 v[60:63], v[140:143], v[176:179], v[60:63]
    ds_read_b64_tr_b16 a[76:77], v11 offset:20480
    v_mfma_f32_16x16x32_bf16 v[60:63], v[136:139], v[180:183], v[60:63]
    ds_read_b64_tr_b16 a[78:79], v11 offset:22528
    v_mfma_f32_16x16x32_bf16 v[60:63], v[132:135], v[184:187], v[60:63]
    ds_read2_b32 v[94:95], v239 offset0:194 offset1:195
    s_add_u32 m0, s9, 39936
    s_add_u32 s13, s10, 221312
    v_mfma_f32_16x16x32_bf16 v[60:63], v[128:131], v[188:191], v[60:63]
    buffer_load_dwordx4 v16, s[44:47], s13 offen sc1 lds
    s_waitcnt lgkmcnt(15)
    v_mfma_f32_16x16x32_bf16 v[32:35], v[64:67], v[96:99], v[32:35]
    ds_read_b128 v[160:163], v245 offset:0
    s_waitcnt lgkmcnt(2)
    s_barrier
    v_mfma_f32_16x16x32_bf16 v[36:39], v[68:71], v[96:99], v[36:39]
    v_mfma_f32_16x16x32_bf16 v[36:39], v[64:67], v[100:103], v[36:39]
    ds_read2_b32 v[128:129], v236 offset0:80 offset1:81
    v_mfma_f32_16x16x32_bf16 v[40:43], v[64:67], v[104:107], v[40:43]
    s_lshl_b32 s14, s89, 18
    ds_read2_b32 v[130:131], v236 offset0:82 offset1:83
    v_mfma_f32_16x16x32_bf16 v[40:43], v[68:71], v[100:103], v[40:43]
    s_add_u32 m0, s73, 147456
    v_mfma_f32_16x16x32_bf16 v[40:43], v[72:75], v[96:99], v[40:43]
    buffer_load_dwordx4 v4, s[52:55], s14 offen offset:0 lds
    ds_read_b128 v[164:167], v245 offset:4096
    v_mfma_f32_16x16x32_bf16 v[44:47], v[76:79], v[96:99], v[44:47]
    ds_read2_b32 v[132:133], v236 offset0:208 offset1:209
    v_mfma_f32_16x16x32_bf16 v[44:47], v[72:75], v[100:103], v[44:47]
    s_add_u32 m0, s9, 40960
    s_add_u32 s13, s10, 295040
    v_mfma_f32_16x16x32_bf16 v[44:47], v[68:71], v[104:107], v[44:47]
    buffer_load_dwordx4 v15, s[44:47], s13 offen sc1 lds
    ds_read2_b32 v[134:135], v236 offset0:210 offset1:211
    v_mfma_f32_16x16x32_bf16 v[44:47], v[64:67], v[108:111], v[44:47]
    ds_read_b128 v[168:171], v245 offset:8192
    s_waitcnt lgkmcnt(7)
    v_mfma_f32_16x16x32_bf16 v[48:51], v[64:67], v[112:115], v[48:51]
    ds_read2_b32 v[136:137], v237 offset0:80 offset1:81
    v_mfma_f32_16x16x32_bf16 v[48:51], v[68:71], v[108:111], v[48:51]
    ds_read2_b32 v[138:139], v237 offset0:82 offset1:83
    v_mfma_f32_16x16x32_bf16 v[48:51], v[72:75], v[104:107], v[48:51]
    ds_read_b128 v[172:175], v245 offset:12288
    v_mfma_f32_16x16x32_bf16 v[48:51], v[76:79], v[100:103], v[48:51]
    ds_read2_b32 v[140:141], v237 offset0:208 offset1:209
    v_mfma_f32_16x16x32_bf16 v[48:51], v[80:83], v[96:99], v[48:51]
    ds_read2_b32 v[142:143], v237 offset0:210 offset1:211
    v_mfma_f32_16x16x32_bf16 v[52:55], v[84:87], v[96:99], v[52:55]
    ds_read_b128 v[176:179], v245 offset:16384
    v_mfma_f32_16x16x32_bf16 v[52:55], v[80:83], v[100:103], v[52:55]
    s_add_u32 m0, s73, 147456
    ds_read2_b32 v[144:145], v238 offset0:80 offset1:81
    v_mfma_f32_16x16x32_bf16 v[52:55], v[76:79], v[104:107], v[52:55]
    buffer_load_dwordx4 v5, s[52:55], s14 offen offset:1024 lds
    ds_read2_b32 v[146:147], v238 offset0:82 offset1:83
L_pl_X_3:
    s_cbranch_execz L_pl_X_7
    v_mfma_f32_16x16x32_bf16 v[52:55], v[72:75], v[108:111], v[52:55]
    ds_read_b128 v[180:183], v245 offset:20480
    s_add_u32 m0, s9, 41984
    s_add_u32 s13, s10, 368768
    v_mfma_f32_16x16x32_bf16 v[52:55], v[68:71], v[112:115], v[52:55]
    buffer_load_dwordx4 v16, s[44:47], s13 offen sc1 lds
    ds_read_b128 v[212:215], v241 offset:32
    v_mfma_f32_16x16x32_bf16 v[52:55], v[64:67], v[116:119], v[52:55]
    ds_read2_b32 v[148:149], v238 offset0:208 offset1:209
    v_mfma_f32_16x16x32_bf16 v[56:59], v[64:67], v[120:123], v[56:59]
    ds_read_b32 v216, v241 offset:48
    v_mfma_f32_16x16x32_bf16 v[56:59], v[68:71], v[116:119], v[56:59]
    ds_read2_b32 v[150:151], v238 offset0:210 offset1:211
    v_mfma_f32_16x16x32_bf16 v[56:59], v[72:75], v[112:115], v[56:59]
    ds_read_b128 v[218:221], v241 offset:1056
    v_mfma_f32_16x16x32_bf16 v[56:59], v[76:79], v[108:111], v[56:59]
    ds_read_b128 v[184:187], v245 offset:24576
    v_mfma_f32_16x16x32_bf16 v[56:59], v[80:83], v[104:107], v[56:59]
    ds_read2_b32 v[152:153], v239 offset0:80 offset1:81
    s_add_u32 m0, s9, 43008
    s_add_u32 s13, s10, 442496
    v_mfma_f32_16x16x32_bf16 v[56:59], v[84:87], v[100:103], v[56:59]
    buffer_load_dwordx4 v15, s[44:47], s13 offen sc1 lds
    ds_read_b32 v222, v241 offset:1072
    v_mfma_f32_16x16x32_bf16 v[56:59], v[88:91], v[96:99], v[56:59]
    ds_read2_b32 v[154:155], v239 offset0:82 offset1:83
    v_mfma_f32_16x16x32_bf16 v[60:63], v[92:95], v[96:99], v[60:63]
    s_add_u32 m0, s73, 147456
    ds_read_b128 v[224:227], v241 offset:2080
    v_mfma_f32_16x16x32_bf16 v[60:63], v[88:91], v[100:103], v[60:63]
    buffer_load_dwordx4 v6, s[52:55], s14 offen offset:2048 lds
    ds_read_b128 v[188:191], v245 offset:28672
    v_mfma_f32_16x16x32_bf16 v[60:63], v[84:87], v[104:107], v[60:63]
    ds_read_b32 v228, v241 offset:2096
    v_mfma_f32_16x16x32_bf16 v[60:63], v[80:83], v[108:111], v[60:63]
    ds_read2_b32 v[156:157], v239 offset0:208 offset1:209
    v_mfma_f32_16x16x32_bf16 v[60:63], v[76:79], v[112:115], v[60:63]
    ds_read_b128 v[230:233], v241 offset:3104
    v_mfma_f32_16x16x32_bf16 v[60:63], v[72:75], v[116:119], v[60:63]
    ds_read2_b32 v[158:159], v239 offset0:210 offset1:211
    v_mfma_f32_16x16x32_bf16 v[60:63], v[68:71], v[120:123], v[60:63]
    ds_read_b32 v234, v241 offset:3120
    s_add_u32 m0, s9, 44032
    s_add_u32 s13, s10, 516224
    v_mfma_f32_16x16x32_bf16 v[60:63], v[64:67], v[124:127], v[60:63]
    buffer_load_dwordx4 v16, s[44:47], s13 offen sc1 lds
    s_waitcnt lgkmcnt(15)
    v_mfma_f32_16x16x32_bf16 v[32:35], v[128:131], v[160:163], v[32:35]
    ds_read_b128 v[96:99], v246 offset:0
    v_mfma_f32_16x16x32_bf16 v[36:39], v[132:135], v[160:163], v[36:39]
    v_mfma_f32_16x16x32_bf16 v[36:39], v[128:131], v[164:167], v[36:39]
    ds_read2_b32 v[64:65], v236 offset0:96 offset1:97
    v_mfma_f32_16x16x32_bf16 v[40:43], v[128:131], v[168:171], v[40:43]
    s_add_u32 m0, s73, 147456
    ds_read2_b32 v[66:67], v236 offset0:98 offset1:99
    v_mfma_f32_16x16x32_bf16 v[40:43], v[132:135], v[164:167], v[40:43]
    buffer_load_dwordx4 v7, s[52:55], s14 offen offset:3072 lds
    s_waitcnt lgkmcnt(3)
    v_mfma_f32_16x16x32_bf16 v[40:43], v[136:139], v[160:163], v[40:43]
    ds_read_b128 v[100:103], v246 offset:4096
    v_mfma_f32_16x16x32_bf16 v[44:47], v[140:143], v[160:163], v[44:47]
    s_waitcnt vmcnt(12)
    ds_read2_b32 v[68:69], v236 offset0:224 offset1:225
    v_mfma_f32_16x16x32_bf16 v[44:47], v[136:139], v[164:167], v[44:47]
    v_mfma_f32_16x16x32_bf16 v[44:47], v[132:135], v[168:171], v[44:47]
    ds_read2_b32 v[70:71], v236 offset0:226 offset1:227
    v_lshlrev_b32 v9, 16, v9
    v_mfma_f32_16x16x32_bf16 v[44:47], v[128:131], v[172:175], v[44:47]
    ds_read_b128 v[104:107], v246 offset:8192
    v_mfma_f32_16x16x32_bf16 v[48:51], v[128:131], v[176:179], v[48:51]
    ds_read2_b32 v[72:73], v237 offset0:96 offset1:97
    v_lshlrev_b32 v208, 16, v212
    v_mfma_f32_16x16x32_bf16 v[48:51], v[132:135], v[172:175], v[48:51]
    v_mfma_f32_16x16x32_bf16 v[48:51], v[136:139], v[168:171], v[48:51]
    ds_read2_b32 v[74:75], v237 offset0:98 offset1:99
    v_add_f32 v9, v9, v208
    v_mfma_f32_16x16x32_bf16 v[48:51], v[140:143], v[164:167], v[48:51]
    ds_read_b128 v[108:111], v246 offset:12288
    v_cvt_pk_bf16_f32 v9, v9, v9
    v_mfma_f32_16x16x32_bf16 v[48:51], v[144:147], v[160:163], v[48:51]
    ds_read2_b32 v[76:77], v237 offset0:224 offset1:225
    v_mfma_f32_16x16x32_bf16 v[52:55], v[148:151], v[160:163], v[52:55]
    ds_write_b16 v242, v9 offset:4160
    v_mfma_f32_16x16x32_bf16 v[52:55], v[144:147], v[164:167], v[52:55]
    ds_read2_b32 v[78:79], v237 offset0:226 offset1:227
    v_mfma_f32_16x16x32_bf16 v[52:55], v[140:143], v[168:171], v[52:55]
    ds_write_b16 v242, v9 offset:2
    v_mfma_f32_16x16x32_bf16 v[52:55], v[136:139], v[172:175], v[52:55]
    ds_read_b128 v[112:115], v246 offset:16384
    v_mfma_f32_16x16x32_bf16 v[52:55], v[132:135], v[176:179], v[52:55]
    ds_read2_b32 v[80:81], v238 offset0:96 offset1:97
    v_alignbit_b32 v212, v213, v212, 16
    v_mfma_f32_16x16x32_bf16 v[52:55], v[128:131], v[180:183], v[52:55]
    v_alignbit_b32 v213, v214, v213, 16
    v_mfma_f32_16x16x32_bf16 v[56:59], v[128:131], v[184:187], v[56:59]
    ds_read2_b32 v[82:83], v238 offset0:98 offset1:99
    v_mfma_f32_16x16x32_bf16 v[56:59], v[132:135], v[180:183], v[56:59]
    ds_read_b128 v[116:119], v246 offset:20480
    v_alignbit_b32 v214, v215, v214, 16
    v_mfma_f32_16x16x32_bf16 v[56:59], v[136:139], v[176:179], v[56:59]
    v_mfma_f32_16x16x32_bf16 v[56:59], v[140:143], v[172:175], v[56:59]
    ds_read2_b32 v[84:85], v238 offset0:224 offset1:225
    v_alignbit_b32 v215, v216, v215, 16
    v_mfma_f32_16x16x32_bf16 v[56:59], v[144:147], v[168:171], v[56:59]
    ds_read2_b32 v[86:87], v238 offset0:226 offset1:227
    v_mfma_f32_16x16x32_bf16 v[56:59], v[148:151], v[164:167], v[56:59]
    ds_write_b128 v241, v[212:215] offset:4192
    v_mfma_f32_16x16x32_bf16 v[56:59], v[152:155], v[160:163], v[56:59]
    ds_read_b128 v[120:123], v246 offset:24576
    v_mfma_f32_16x16x32_bf16 v[60:63], v[156:159], v[160:163], v[60:63]
    ds_read2_b32 v[88:89], v239 offset0:96 offset1:97
    v_alignbit_b32 v218, v219, v218, 16
    v_mfma_f32_16x16x32_bf16 v[60:63], v[152:155], v[164:167], v[60:63]
    ds_read2_b32 v[90:91], v239 offset0:98 offset1:99
    v_alignbit_b32 v219, v220, v219, 16
    v_mfma_f32_16x16x32_bf16 v[60:63], v[148:151], v[168:171], v[60:63]
    v_mfma_f32_16x16x32_bf16 v[60:63], v[144:147], v[172:175], v[60:63]
    ds_read_b128 v[124:127], v246 offset:28672
    v_alignbit_b32 v220, v221, v220, 16
    v_mfma_f32_16x16x32_bf16 v[60:63], v[140:143], v[176:179], v[60:63]
    ds_read2_b32 v[92:93], v239 offset0:224 offset1:225
    v_mfma_f32_16x16x32_bf16 v[60:63], v[136:139], v[180:183], v[60:63]
    ds_read2_b32 v[94:95], v239 offset0:226 offset1:227
    v_alignbit_b32 v221, v222, v221, 16
    v_mfma_f32_16x16x32_bf16 v[60:63], v[132:135], v[184:187], v[60:63]
    ds_write_b128 v241, v[218:221] offset:5216
    v_mfma_f32_16x16x32_bf16 v[60:63], v[128:131], v[188:191], v[60:63]
    s_waitcnt lgkmcnt(15)
    v_mfma_f32_16x16x32_bf16 v[32:35], v[64:67], v[96:99], v[32:35]
    ds_read_b128 v[160:163], v247 offset:0
    v_mfma_f32_16x16x32_bf16 v[36:39], v[68:71], v[96:99], v[36:39]
    v_alignbit_b32 v224, v225, v224, 16
    v_mfma_f32_16x16x32_bf16 v[36:39], v[64:67], v[100:103], v[36:39]
    ds_read_b128 v[164:167], v247 offset:4096
    v_mfma_f32_16x16x32_bf16 v[40:43], v[64:67], v[104:107], v[40:43]
    ds_read_b128 v[168:171], v247 offset:8192
    v_mfma_f32_16x16x32_bf16 v[40:43], v[68:71], v[100:103], v[40:43]
    ds_read_b128 v[172:175], v247 offset:12288
    v_mfma_f32_16x16x32_bf16 v[40:43], v[72:75], v[96:99], v[40:43]
    v_alignbit_b32 v225, v226, v225, 16
    v_mfma_f32_16x16x32_bf16 v[44:47], v[76:79], v[96:99], v[44:47]
    ds_read_b128 v[176:179], v247 offset:16384
    v_mfma_f32_16x16x32_bf16 v[44:47], v[72:75], v[100:103], v[44:47]
    ds_read_b128 v[180:183], v247 offset:20480
    v_mfma_f32_16x16x32_bf16 v[44:47], v[68:71], v[104:107], v[44:47]
    ds_read_b128 v[184:187], v247 offset:24576
    v_mfma_f32_16x16x32_bf16 v[44:47], v[64:67], v[108:111], v[44:47]
    v_alignbit_b32 v226, v227, v226, 16
    s_waitcnt lgkmcnt(8)
    v_mfma_f32_16x16x32_bf16 v[48:51], v[64:67], v[112:115], v[48:51]
    ds_read_b128 v[188:191], v247 offset:28672
    v_mfma_f32_16x16x32_bf16 v[48:51], v[68:71], v[108:111], v[48:51]
    ds_read2_b32 v[128:129], v236 offset0:112 offset1:113
    v_mfma_f32_16x16x32_bf16 v[48:51], v[72:75], v[104:107], v[48:51]
    v_alignbit_b32 v227, v228, v227, 16
    v_mfma_f32_16x16x32_bf16 v[48:51], v[76:79], v[100:103], v[48:51]
    ds_read2_b32 v[130:131], v236 offset0:114 offset1:115
    v_mfma_f32_16x16x32_bf16 v[48:51], v[80:83], v[96:99], v[48:51]
    ds_read2_b32 v[132:133], v236 offset0:240 offset1:241
    v_mfma_f32_16x16x32_bf16 v[52:55], v[84:87], v[96:99], v[52:55]
    ds_read2_b32 v[134:135], v236 offset0:242 offset1:243
    v_mfma_f32_16x16x32_bf16 v[52:55], v[80:83], v[100:103], v[52:55]
    ds_write_b128 v241, v[224:227] offset:6240
    v_mfma_f32_16x16x32_bf16 v[52:55], v[76:79], v[104:107], v[52:55]
    ds_read2_b32 v[136:137], v237 offset0:112 offset1:113
    ds_read2_b32 v[138:139], v237 offset0:114 offset1:115
    v_mfma_f32_16x16x32_bf16 v[52:55], v[72:75], v[108:111], v[52:55]
    s_add_u32 s6, s12, 4734976
    ds_read2_b32 v[140:141], v237 offset0:240 offset1:241
    v_mfma_f32_16x16x32_bf16 v[52:55], v[68:71], v[112:115], v[52:55]
    ds_read2_b32 v[142:143], v237 offset0:242 offset1:243
    v_alignbit_b32 v230, v231, v230, 16
    v_xor_b32 v244, 64, v244
    v_mfma_f32_16x16x32_bf16 v[52:55], v[64:67], v[116:119], v[52:55]
    ds_read2_b32 v[144:145], v238 offset0:112 offset1:113
    v_mfma_f32_16x16x32_bf16 v[56:59], v[64:67], v[120:123], v[56:59]
    ds_read2_b32 v[146:147], v238 offset0:114 offset1:115
    v_xor_b32 v245, 64, v245
    v_mfma_f32_16x16x32_bf16 v[56:59], v[68:71], v[116:119], v[56:59]
    ds_read2_b32 v[148:149], v238 offset0:240 offset1:241
    v_mfma_f32_16x16x32_bf16 v[56:59], v[72:75], v[112:115], v[56:59]
    v_alignbit_b32 v231, v232, v231, 16
    v_xor_b32 v246, 64, v246
    v_mfma_f32_16x16x32_bf16 v[56:59], v[76:79], v[108:111], v[56:59]
    ds_read2_b32 v[150:151], v238 offset0:242 offset1:243
    v_mfma_f32_16x16x32_bf16 v[56:59], v[80:83], v[104:107], v[56:59]
    ds_read2_b32 v[152:153], v239 offset0:112 offset1:113
    v_xor_b32 v247, 64, v247
    v_mfma_f32_16x16x32_bf16 v[56:59], v[84:87], v[100:103], v[56:59]
    ds_read2_b32 v[154:155], v239 offset0:114 offset1:115
    v_mfma_f32_16x16x32_bf16 v[56:59], v[88:91], v[96:99], v[56:59]
    ds_read2_b32 v[156:157], v239 offset0:240 offset1:241
    v_alignbit_b32 v232, v233, v232, 16
    v_mfma_f32_16x16x32_bf16 v[60:63], v[92:95], v[96:99], v[60:63]
    ds_read2_b32 v[158:159], v239 offset0:242 offset1:243
    v_add_u32 v244, 36864, v244
    v_mfma_f32_16x16x32_bf16 v[60:63], v[88:91], v[100:103], v[60:63]
    v_add_u32 v236, -8320, v236
    v_mfma_f32_16x16x32_bf16 v[60:63], v[84:87], v[104:107], v[60:63]
    v_alignbit_b32 v233, v234, v233, 16
    v_add_u32 v245, 36864, v245
    v_mfma_f32_16x16x32_bf16 v[60:63], v[80:83], v[108:111], v[60:63]
    v_add_u32 v237, -8320, v237
    v_mfma_f32_16x16x32_bf16 v[60:63], v[76:79], v[112:115], v[60:63]
    s_waitcnt vmcnt(1)
    s_barrier
    v_add_u32 v246, 36864, v246
    v_mfma_f32_16x16x32_bf16 v[60:63], v[72:75], v[116:119], v[60:63]
    v_add_u32 v238, -8320, v238
    v_add_u32 v239, -8320, v239
    v_mfma_f32_16x16x32_bf16 v[60:63], v[68:71], v[120:123], v[60:63]
    ds_write_b128 v241, v[230:233] offset:7264
    v_mfma_f32_16x16x32_bf16 v[60:63], v[64:67], v[124:127], v[60:63]
    v_add_u32 v247, 36864, v247
    s_waitcnt lgkmcnt(1)
    v_mfma_f32_16x16x32_bf16 v[60:63], v[128:131], v[188:191], v[60:63]
    ds_read_b128 v[96:99], v244 offset:2048
    v_mfma_f32_16x16x32_bf16 v[60:63], v[132:135], v[184:187], v[60:63]
    ds_read2_b32 v[64:65], v236 offset0:0 offset1:1
    v_mfma_f32_16x16x32_bf16 v[60:63], v[136:139], v[180:183], v[60:63]
    ds_read2_b32 v[66:67], v236 offset0:2 offset1:3
    v_mfma_f32_16x16x32_bf16 v[60:63], v[140:143], v[176:179], v[60:63]
    ds_read_b128 v[100:103], v244 offset:6144
    v_mfma_f32_16x16x32_bf16 v[60:63], v[144:147], v[172:175], v[60:63]
    ds_read2_b32 v[68:69], v236 offset0:128 offset1:129
    v_mfma_f32_16x16x32_bf16 v[60:63], v[148:151], v[168:171], v[60:63]
    ds_read2_b32 v[70:71], v236 offset0:130 offset1:131
    v_mfma_f32_16x16x32_bf16 v[60:63], v[152:155], v[164:167], v[60:63]
    ds_read_b128 v[104:107], v244 offset:10240
    v_mfma_f32_16x16x32_bf16 v[60:63], v[156:159], v[160:163], v[60:63]
    ds_read2_b32 v[72:73], v237 offset0:0 offset1:1
    v_mfma_f32_16x16x32_bf16 v[56:59], v[128:131], v[184:187], v[56:59]
    ds_read2_b32 v[74:75], v237 offset0:2 offset1:3
    v_mfma_f32_16x16x32_bf16 v[56:59], v[132:135], v[180:183], v[56:59]
    ds_read_b128 v[108:111], v244 offset:14336
    v_mfma_f32_16x16x32_bf16 v[56:59], v[136:139], v[176:179], v[56:59]
    ds_read2_b32 v[76:77], v237 offset0:128 offset1:129
    v_mfma_f32_16x16x32_bf16 v[56:59], v[140:143], v[172:175], v[56:59]
    ds_read2_b32 v[78:79], v237 offset0:130 offset1:131
    v_mfma_f32_16x16x32_bf16 v[56:59], v[144:147], v[168:171], v[56:59]
    ds_read_b128 v[112:115], v244 offset:18432
    v_mfma_f32_16x16x32_bf16 v[56:59], v[148:151], v[164:167], v[56:59]
    ds_read2_b32 v[80:81], v238 offset0:0 offset1:1
    v_cvt_pk_bf16_f32 v206, v60, v61
    v_mfma_f32_16x16x32_bf16 v[56:59], v[152:155], v[160:163], v[56:59]
    ds_read2_b32 v[82:83], v238 offset0:2 offset1:3
    v_mfma_f32_16x16x32_bf16 v[52:55], v[128:131], v[180:183], v[52:55]
    ds_read_b128 v[116:119], v244 offset:22528
    v_mfma_f32_16x16x32_bf16 v[52:55], v[132:135], v[176:179], v[52:55]
    ds_read2_b32 v[84:85], v238 offset0:128 offset1:129
    v_cvt_pk_bf16_f32 v207, v62, v63
    v_mfma_f32_16x16x32_bf16 v[52:55], v[136:139], v[172:175], v[52:55]
    ds_read2_b32 v[86:87], v238 offset0:130 offset1:131
    v_mfma_f32_16x16x32_bf16 v[52:55], v[140:143], v[168:171], v[52:55]
    buffer_store_dwordx2 v[206:207], v8, s[44:47], s6 offen offset:3584 sc1
    ds_read_b128 v[120:123], v244 offset:26624
    v_mfma_f32_16x16x32_bf16 v[52:55], v[144:147], v[164:167], v[52:55]
    ds_read2_b32 v[88:89], v239 offset0:0 offset1:1
    v_mfma_f32_16x16x32_bf16 v[52:55], v[148:151], v[160:163], v[52:55]
    ds_read2_b32 v[90:91], v239 offset0:2 offset1:3
    v_mfma_f32_16x16x32_bf16 v[48:51], v[128:131], v[176:179], v[48:51]
    s_waitcnt vmcnt(1)
    s_barrier
    v_cvt_pk_bf16_f32 v204, v56, v57
    v_mfma_f32_16x16x32_bf16 v[48:51], v[132:135], v[172:175], v[48:51]
    ds_read_b128 v[124:127], v244 offset:30720
    v_mfma_f32_16x16x32_bf16 v[48:51], v[136:139], v[168:171], v[48:51]
    ds_read_b64_tr_b16 a[80:81], v10 offset:16384
    v_mfma_f32_16x16x32_bf16 v[48:51], v[140:143], v[164:167], v[48:51]
    ds_read_b64_tr_b16 a[82:83], v10 offset:18432
    v_cvt_pk_bf16_f32 v205, v58, v59
    v_mfma_f32_16x16x32_bf16 v[48:51], v[144:147], v[160:163], v[48:51]
    ds_read_b64_tr_b16 a[88:89], v10 offset:20480
    v_mfma_f32_16x16x32_bf16 v[44:47], v[128:131], v[172:175], v[44:47]
    buffer_store_dwordx2 v[204:205], v8, s[44:47], s6 offen offset:3072 sc1
    ds_read2_b32 v[92:93], v239 offset0:128 offset1:129
    v_mfma_f32_16x16x32_bf16 v[44:47], v[132:135], v[168:171], v[44:47]
    ds_read_b64_tr_b16 a[90:91], v10 offset:22528
    v_mfma_f32_16x16x32_bf16 v[44:47], v[136:139], v[164:167], v[44:47]
    ds_read_b64_tr_b16 a[84:85], v11 offset:16384
    ds_read2_b32 v[94:95], v239 offset0:130 offset1:131
    v_mfma_f32_16x16x32_bf16 v[44:47], v[140:143], v[160:163], v[44:47]
    v_cvt_pk_bf16_f32 v202, v52, v53
    v_mfma_f32_16x16x32_bf16 v[40:43], v[128:131], v[168:171], v[40:43]
    ds_read_b64_tr_b16 a[86:87], v11 offset:18432
    v_mfma_f32_16x16x32_bf16 v[40:43], v[132:135], v[164:167], v[40:43]
    ds_read_b64_tr_b16 a[92:93], v11 offset:20480
    v_mfma_f32_16x16x32_bf16 v[40:43], v[136:139], v[160:163], v[40:43]
    v_cvt_pk_bf16_f32 v203, v54, v55
    v_mfma_f32_16x16x32_bf16 v[36:39], v[128:131], v[164:167], v[36:39]
    ds_read_b64_tr_b16 a[94:95], v11 offset:22528
    v_mfma_f32_16x16x32_bf16 v[36:39], v[132:135], v[160:163], v[36:39]
    buffer_store_dwordx2 v[202:203], v8, s[44:47], s6 offen offset:2560 sc1
    v_mfma_f32_16x16x32_bf16 v[32:35], v[128:131], v[160:163], v[32:35]
    s_waitcnt lgkmcnt(3)
    v_mfma_f32_16x16x32_bf16 v[60:63], v[64:67], v[124:127], 0
    ds_read_b128 v[160:163], v245 offset:2048
    s_waitcnt lgkmcnt(1)
    s_barrier
    v_mfma_f32_16x16x32_bf16 v[60:63], v[68:71], v[120:123], v[60:63]
    v_cvt_pk_bf16_f32 v200, v48, v49
    v_mfma_f32_16x16x32_bf16 v[60:63], v[72:75], v[116:119], v[60:63]
    ds_read2_b32 v[128:129], v236 offset0:16 offset1:17
    v_mfma_f32_16x16x32_bf16 v[60:63], v[76:79], v[112:115], v[60:63]
    ds_read2_b32 v[130:131], v236 offset0:18 offset1:19
    s_lshl_b32 s14, s90, 18
    v_cvt_pk_bf16_f32 v201, v50, v51
    v_mfma_f32_16x16x32_bf16 v[60:63], v[80:83], v[108:111], v[60:63]
    s_add_u32 m0, s73, 147456
    v_mfma_f32_16x16x32_bf16 v[60:63], v[84:87], v[104:107], v[60:63]
    buffer_load_dwordx4 v4, s[52:55], s14 offen offset:0 lds
    ds_read_b128 v[164:167], v245 offset:6144
    v_mfma_f32_16x16x32_bf16 v[60:63], v[88:91], v[100:103], v[60:63]
    buffer_store_dwordx2 v[200:201], v8, s[44:47], s6 offen offset:2048 sc1
    ds_read2_b32 v[132:133], v236 offset0:144 offset1:145
    v_mfma_f32_16x16x32_bf16 v[60:63], v[92:95], v[96:99], v[60:63]
    s_add_u32 s13, s12, 49152
    v_cvt_pk_bf16_f32 v198, v44, v45
    v_mfma_f32_16x16x32_bf16 v[56:59], v[64:67], v[120:123], 0
    ds_read2_b32 v[134:135], v236 offset0:146 offset1:147
    v_mfma_f32_16x16x32_bf16 v[56:59], v[68:71], v[116:119], v[56:59]
    s_add_u32 m0, s74, 8352
    ds_read_b128 v[168:171], v245 offset:10240
    v_mfma_f32_16x16x32_bf16 v[56:59], v[72:75], v[112:115], v[56:59]
    buffer_load_dwordx4 v240, s[48:51], s13 offen offset:0 lds
    v_cvt_pk_bf16_f32 v199, v46, v47
    v_mfma_f32_16x16x32_bf16 v[56:59], v[76:79], v[108:111], v[56:59]
    ds_read2_b32 v[136:137], v237 offset0:16 offset1:17
    v_mfma_f32_16x16x32_bf16 v[56:59], v[80:83], v[104:107], v[56:59]
    buffer_store_dwordx2 v[198:199], v8, s[44:47], s6 offen offset:1536 sc1
    ds_read2_b32 v[138:139], v237 offset0:18 offset1:19
    v_mfma_f32_16x16x32_bf16 v[56:59], v[84:87], v[100:103], v[56:59]
    ds_read_b128 v[172:175], v245 offset:14336
    v_mfma_f32_16x16x32_bf16 v[56:59], v[88:91], v[96:99], v[56:59]
    v_cvt_pk_bf16_f32 v196, v40, v41
    v_mfma_f32_16x16x32_bf16 v[52:55], v[64:67], v[116:119], 0
    ds_read2_b32 v[140:141], v237 offset0:144 offset1:145
    v_mfma_f32_16x16x32_bf16 v[52:55], v[68:71], v[112:115], v[52:55]
    ds_read2_b32 v[142:143], v237 offset0:146 offset1:147
    s_add_u32 m0, s73, 147456
    v_cvt_pk_bf16_f32 v197, v42, v43
    v_mfma_f32_16x16x32_bf16 v[52:55], v[72:75], v[108:111], v[52:55]
    buffer_load_dwordx4 v5, s[52:55], s14 offen offset:1024 lds
    v_mfma_f32_16x16x32_bf16 v[52:55], v[76:79], v[104:107], v[52:55]
    buffer_store_dwordx2 v[196:197], v8, s[44:47], s6 offen offset:1024 sc1
    ds_read_b128 v[176:179], v245 offset:18432
    s_add_u32 m0, s74, 8352
    v_mfma_f32_16x16x32_bf16 v[52:55], v[80:83], v[100:103], v[52:55]
    buffer_load_dwordx4 v240, s[48:51], s13 offen offset:1024 lds
    ds_read2_b32 v[144:145], v238 offset0:16 offset1:17
    v_mfma_f32_16x16x32_bf16 v[52:55], v[84:87], v[96:99], v[52:55]
    v_mfma_f32_16x16x32_bf16 v[48:51], v[64:67], v[112:115], 0
    ds_read2_b32 v[146:147], v238 offset0:18 offset1:19
    v_cvt_pk_bf16_f32 v194, v36, v37
    v_mfma_f32_16x16x32_bf16 v[48:51], v[68:71], v[108:111], v[48:51]
    ds_read_b128 v[180:183], v245 offset:22528
    v_mfma_f32_16x16x32_bf16 v[48:51], v[72:75], v[104:107], v[48:51]
    v_cvt_pk_bf16_f32 v195, v38, v39
    v_mfma_f32_16x16x32_bf16 v[48:51], v[76:79], v[100:103], v[48:51]
    buffer_store_dwordx2 v[194:195], v8, s[44:47], s6 offen offset:512 sc1
    ds_read2_b32 v[148:149], v238 offset0:144 offset1:145
    s_add_u32 m0, s74, 8352
    v_mfma_f32_16x16x32_bf16 v[48:51], v[80:83], v[96:99], v[48:51]
    buffer_load_dwordx4 v240, s[48:51], s13 offen offset:2048 lds
    ds_read2_b32 v[150:151], v238 offset0:146 offset1:147
    v_mfma_f32_16x16x32_bf16 v[44:47], v[64:67], v[108:111], 0
    ds_read_b128 v[184:187], v245 offset:26624
    v_mfma_f32_16x16x32_bf16 v[44:47], v[68:71], v[104:107], v[44:47]
    v_cvt_pk_bf16_f32 v192, v32, v33
    v_mfma_f32_16x16x32_bf16 v[44:47], v[72:75], v[100:103], v[44:47]
    s_add_u32 m0, s73, 147456
    ds_read2_b32 v[152:153], v239 offset0:16 offset1:17
    v_mfma_f32_16x16x32_bf16 v[44:47], v[76:79], v[96:99], v[44:47]
    buffer_load_dwordx4 v6, s[52:55], s14 offen offset:2048 lds
    v_cvt_pk_bf16_f32 v193, v34, v35
    v_mfma_f32_16x16x32_bf16 v[40:43], v[64:67], v[104:107], 0
    ds_read2_b32 v[154:155], v239 offset0:18 offset1:19
    v_mfma_f32_16x16x32_bf16 v[40:43], v[68:71], v[100:103], v[40:43]
    buffer_store_dwordx2 v[192:193], v8, s[44:47], s6 offen offset:0 sc1
    ds_read_b128 v[188:191], v245 offset:30720
    v_mfma_f32_16x16x32_bf16 v[40:43], v[72:75], v[96:99], v[40:43]
    s_add_u32 m0, s74, 8352
    ds_read2_b32 v[156:157], v239 offset0:144 offset1:145
    v_mfma_f32_16x16x32_bf16 v[36:39], v[64:67], v[100:103], 0
    buffer_load_dwordx4 v240, s[48:51], s13 offen offset:3072 lds
    v_mfma_f32_16x16x32_bf16 v[36:39], v[68:71], v[96:99], v[36:39]
    ds_read2_b32 v[158:159], v239 offset0:146 offset1:147
    v_mfma_f32_16x16x32_bf16 v[32:35], v[64:67], v[96:99], 0
    s_waitcnt lgkmcnt(12)
    v_mfma_f32_16x16x32_bf16 v[32:35], v[128:131], v[160:163], v[32:35]
    ds_read_b128 v[96:99], v246 offset:2048
    v_mfma_f32_16x16x32_bf16 v[36:39], v[132:135], v[160:163], v[36:39]
    v_mfma_f32_16x16x32_bf16 v[36:39], v[128:131], v[164:167], v[36:39]
    ds_read2_b32 v[64:65], v236 offset0:32 offset1:33
    v_mfma_f32_16x16x32_bf16 v[40:43], v[128:131], v[168:171], v[40:43]
    s_barrier
    ds_read2_b32 v[66:67], v236 offset0:34 offset1:35
    s_add_u32 m0, s73, 147456
    v_mfma_f32_16x16x32_bf16 v[40:43], v[132:135], v[164:167], v[40:43]
    buffer_load_dwordx4 v7, s[52:55], s14 offen offset:3072 lds
    v_mfma_f32_16x16x32_bf16 v[40:43], v[136:139], v[160:163], v[40:43]
    ds_read_b128 v[100:103], v246 offset:6144
    v_mfma_f32_16x16x32_bf16 v[44:47], v[140:143], v[160:163], v[44:47]
    ds_read2_b32 v[68:69], v236 offset0:160 offset1:161
    v_mfma_f32_16x16x32_bf16 v[44:47], v[136:139], v[164:167], v[44:47]
    v_mfma_f32_16x16x32_bf16 v[44:47], v[132:135], v[168:171], v[44:47]
    ds_read2_b32 v[70:71], v236 offset0:162 offset1:163
    v_mfma_f32_16x16x32_bf16 v[44:47], v[128:131], v[172:175], v[44:47]
    ds_read_b128 v[104:107], v246 offset:10240
    s_waitcnt lgkmcnt(7)
    v_mfma_f32_16x16x32_bf16 v[48:51], v[128:131], v[176:179], v[48:51]
    ds_read2_b32 v[72:73], v237 offset0:32 offset1:33
    v_mfma_f32_16x16x32_bf16 v[48:51], v[132:135], v[172:175], v[48:51]
    ds_read2_b32 v[74:75], v237 offset0:34 offset1:35
    v_mfma_f32_16x16x32_bf16 v[48:51], v[136:139], v[168:171], v[48:51]
    v_mov_b32 v9, 24
    buffer_load_ushort v9, v9, s[56:59], s70 offen
    v_mfma_f32_16x16x32_bf16 v[48:51], v[140:143], v[164:167], v[48:51]
    ds_read_b128 v[108:111], v246 offset:14336
    v_mfma_f32_16x16x32_bf16 v[48:51], v[144:147], v[160:163], v[48:51]
    v_mfma_f32_16x16x32_bf16 v[52:55], v[148:151], v[160:163], v[52:55]
    ds_read2_b32 v[76:77], v237 offset0:160 offset1:161
    v_mfma_f32_16x16x32_bf16 v[52:55], v[144:147], v[164:167], v[52:55]
    ds_read2_b32 v[78:79], v237 offset0:162 offset1:163
    v_mfma_f32_16x16x32_bf16 v[52:55], v[140:143], v[168:171], v[52:55]
    v_mfma_f32_16x16x32_bf16 v[52:55], v[136:139], v[172:175], v[52:55]
    s_lshl_b32 s14, s91, 18
    ds_read_b128 v[112:115], v246 offset:18432
    v_mfma_f32_16x16x32_bf16 v[52:55], v[132:135], v[176:179], v[52:55]
    s_add_u32 m0, s73, 0
    ds_read2_b32 v[80:81], v238 offset0:32 offset1:33
    v_mfma_f32_16x16x32_bf16 v[52:55], v[128:131], v[180:183], v[52:55]
    buffer_load_dwordx4 v4, s[52:55], s14 offen offset:0 lds
    v_mfma_f32_16x16x32_bf16 v[56:59], v[128:131], v[184:187], v[56:59]
    ds_read2_b32 v[82:83], v238 offset0:34 offset1:35
    v_mfma_f32_16x16x32_bf16 v[56:59], v[132:135], v[180:183], v[56:59]
    ds_read_b128 v[116:119], v246 offset:22528
    v_mfma_f32_16x16x32_bf16 v[56:59], v[136:139], v[176:179], v[56:59]
    v_mfma_f32_16x16x32_bf16 v[56:59], v[140:143], v[172:175], v[56:59]
    ds_read2_b32 v[84:85], v238 offset0:160 offset1:161
    v_mfma_f32_16x16x32_bf16 v[56:59], v[144:147], v[168:171], v[56:59]
    ds_read2_b32 v[86:87], v238 offset0:162 offset1:163
    v_mfma_f32_16x16x32_bf16 v[56:59], v[148:151], v[164:167], v[56:59]
    ds_read_b128 v[120:123], v246 offset:26624
    v_mfma_f32_16x16x32_bf16 v[56:59], v[152:155], v[160:163], v[56:59]
    v_mfma_f32_16x16x32_bf16 v[60:63], v[156:159], v[160:163], v[60:63]
    ds_read2_b32 v[88:89], v239 offset0:32 offset1:33
    v_mfma_f32_16x16x32_bf16 v[60:63], v[152:155], v[164:167], v[60:63]
    ds_read2_b32 v[90:91], v239 offset0:34 offset1:35
    v_mfma_f32_16x16x32_bf16 v[60:63], v[148:151], v[168:171], v[60:63]
    s_add_u32 m0, s73, 0
    v_mfma_f32_16x16x32_bf16 v[60:63], v[144:147], v[172:175], v[60:63]
    buffer_load_dwordx4 v5, s[52:55], s14 offen offset:1024 lds
    ds_read_b128 v[124:127], v246 offset:30720
    v_mfma_f32_16x16x32_bf16 v[60:63], v[140:143], v[176:179], v[60:63]
    ds_read2_b32 v[92:93], v239 offset0:160 offset1:161
    v_mfma_f32_16x16x32_bf16 v[60:63], v[136:139], v[180:183], v[60:63]
    v_mfma_f32_16x16x32_bf16 v[60:63], v[132:135], v[184:187], v[60:63]
    ds_read2_b32 v[94:95], v239 offset0:162 offset1:163
    v_mfma_f32_16x16x32_bf16 v[60:63], v[128:131], v[188:191], v[60:63]
    s_waitcnt lgkmcnt(12)
    v_mfma_f32_16x16x32_bf16 v[32:35], v[64:67], v[96:99], v[32:35]
    ds_read_b128 v[160:163], v247 offset:2048
    v_mfma_f32_16x16x32_bf16 v[36:39], v[68:71], v[96:99], v[36:39]
    v_mfma_f32_16x16x32_bf16 v[36:39], v[64:67], v[100:103], v[36:39]
    ds_read2_b32 v[128:129], v236 offset0:48 offset1:49
    v_mfma_f32_16x16x32_bf16 v[40:43], v[64:67], v[104:107], v[40:43]
    ds_read2_b32 v[130:131], v236 offset0:50 offset1:51
    v_mfma_f32_16x16x32_bf16 v[40:43], v[68:71], v[100:103], v[40:43]
    v_mfma_f32_16x16x32_bf16 v[40:43], v[72:75], v[96:99], v[40:43]
    ds_read_b128 v[164:167], v247 offset:6144
    v_mfma_f32_16x16x32_bf16 v[44:47], v[76:79], v[96:99], v[44:47]
    s_add_u32 m0, s73, 0
    ds_read2_b32 v[132:133], v236 offset0:176 offset1:177
    v_mfma_f32_16x16x32_bf16 v[44:47], v[72:75], v[100:103], v[44:47]
    buffer_load_dwordx4 v6, s[52:55], s14 offen offset:2048 lds
    v_mfma_f32_16x16x32_bf16 v[44:47], v[68:71], v[104:107], v[44:47]
    ds_read2_b32 v[134:135], v236 offset0:178 offset1:179
    v_mfma_f32_16x16x32_bf16 v[44:47], v[64:67], v[108:111], v[44:47]
    ds_read_b128 v[168:171], v247 offset:10240
    s_waitcnt lgkmcnt(7)
    v_mfma_f32_16x16x32_bf16 v[48:51], v[64:67], v[112:115], v[48:51]
    ds_read2_b32 v[136:137], v237 offset0:48 offset1:49
    v_mfma_f32_16x16x32_bf16 v[48:51], v[68:71], v[108:111], v[48:51]
    v_mfma_f32_16x16x32_bf16 v[48:51], v[72:75], v[104:107], v[48:51]
    ds_read2_b32 v[138:139], v237 offset0:50 offset1:51
    v_mfma_f32_16x16x32_bf16 v[48:51], v[76:79], v[100:103], v[48:51]
    ds_read_b128 v[172:175], v247 offset:14336
    v_mfma_f32_16x16x32_bf16 v[48:51], v[80:83], v[96:99], v[48:51]
    v_mfma_f32_16x16x32_bf16 v[52:55], v[84:87], v[96:99], v[52:55]
    ds_read2_b32 v[140:141], v237 offset0:176 offset1:177
    v_mfma_f32_16x16x32_bf16 v[52:55], v[80:83], v[100:103], v[52:55]
    ds_read2_b32 v[142:143], v237 offset0:178 offset1:179
    v_mfma_f32_16x16x32_bf16 v[52:55], v[76:79], v[104:107], v[52:55]
    v_mfma_f32_16x16x32_bf16 v[52:55], v[72:75], v[108:111], v[52:55]
    s_add_u32 m0, s73, 0
    ds_read_b128 v[176:179], v247 offset:18432
    v_mfma_f32_16x16x32_bf16 v[52:55], v[68:71], v[112:115], v[52:55]
    buffer_load_dwordx4 v7, s[52:55], s14 offen offset:3072 lds
    ds_read2_b32 v[144:145], v238 offset0:48 offset1:49
    v_mfma_f32_16x16x32_bf16 v[52:55], v[64:67], v[116:119], v[52:55]
    v_mfma_f32_16x16x32_bf16 v[56:59], v[64:67], v[120:123], v[56:59]
    ds_read2_b32 v[146:147], v238 offset0:50 offset1:51
    v_mfma_f32_16x16x32_bf16 v[56:59], v[68:71], v[116:119], v[56:59]
    ds_read_b128 v[180:183], v247 offset:22528
    v_mfma_f32_16x16x32_bf16 v[56:59], v[72:75], v[112:115], v[56:59]
    v_mfma_f32_16x16x32_bf16 v[56:59], v[76:79], v[108:111], v[56:59]
    ds_read2_b32 v[148:149], v238 offset0:176 offset1:177
    v_mfma_f32_16x16x32_bf16 v[56:59], v[80:83], v[104:107], v[56:59]
    ds_read2_b32 v[150:151], v238 offset0:178 offset1:179
    v_mfma_f32_16x16x32_bf16 v[56:59], v[84:87], v[100:103], v[56:59]
    ds_read_b128 v[184:187], v247 offset:26624
    v_mfma_f32_16x16x32_bf16 v[56:59], v[88:91], v[96:99], v[56:59]
    v_mfma_f32_16x16x32_bf16 v[60:63], v[92:95], v[96:99], v[60:63]
    s_lshl_b32 s14, s92, 18
    ds_read2_b32 v[152:153], v239 offset0:48 offset1:49
    v_mfma_f32_16x16x32_bf16 v[60:63], v[88:91], v[100:103], v[60:63]
    s_add_u32 m0, s73, 16384
    ds_read2_b32 v[154:155], v239 offset0:50 offset1:51
    v_mfma_f32_16x16x32_bf16 v[60:63], v[84:87], v[104:107], v[60:63]
    buffer_load_dwordx4 v4, s[52:55], s14 offen offset:0 lds
    v_mfma_f32_16x16x32_bf16 v[60:63], v[80:83], v[108:111], v[60:63]
    ds_read_b128 v[188:191], v247 offset:30720
    v_mfma_f32_16x16x32_bf16 v[60:63], v[76:79], v[112:115], v[60:63]
    ds_read2_b32 v[156:157], v239 offset0:176 offset1:177
    v_mfma_f32_16x16x32_bf16 v[60:63], v[72:75], v[116:119], v[60:63]
    v_mfma_f32_16x16x32_bf16 v[60:63], v[68:71], v[120:123], v[60:63]
    ds_read2_b32 v[158:159], v239 offset0:178 offset1:179
L_pl_X_4:
    s_cbranch_execz L_wret
    v_mfma_f32_16x16x32_bf16 v[60:63], v[64:67], v[124:127], v[60:63]
    s_waitcnt lgkmcnt(12)
    v_mfma_f32_16x16x32_bf16 v[32:35], v[128:131], v[160:163], v[32:35]
    ds_read_b128 v[96:99], v244 offset:0
    v_mfma_f32_16x16x32_bf16 v[36:39], v[132:135], v[160:163], v[36:39]
    ds_read2_b32 v[64:65], v236 offset0:64 offset1:65
    v_mfma_f32_16x16x32_bf16 v[36:39], v[128:131], v[164:167], v[36:39]
    ds_read2_b32 v[66:67], v236 offset0:66 offset1:67
    v_mfma_f32_16x16x32_bf16 v[40:43], v[128:131], v[168:171], v[40:43]
    ds_read_b128 v[100:103], v244 offset:4096
    v_mfma_f32_16x16x32_bf16 v[40:43], v[132:135], v[164:167], v[40:43]
    ds_read2_b32 v[68:69], v236 offset0:192 offset1:193
    v_mfma_f32_16x16x32_bf16 v[40:43], v[136:139], v[160:163], v[40:43]
    s_add_u32 m0, s73, 16384
    ds_read2_b32 v[70:71], v236 offset0:194 offset1:195
    v_mfma_f32_16x16x32_bf16 v[44:47], v[140:143], v[160:163], v[44:47]
    buffer_load_dwordx4 v5, s[52:55], s14 offen offset:1024 lds
    ds_read_b128 v[104:107], v244 offset:8192
    v_mfma_f32_16x16x32_bf16 v[44:47], v[136:139], v[164:167], v[44:47]
    ds_read2_b32 v[72:73], v237 offset0:64 offset1:65
    s_waitcnt vmcnt(7)
    s_barrier
    v_mfma_f32_16x16x32_bf16 v[44:47], v[132:135], v[168:171], v[44:47]
    ds_read_b64_tr_b16 a[96:97], v10 offset:16384
    v_mfma_f32_16x16x32_bf16 v[44:47], v[128:131], v[172:175], v[44:47]
    ds_read2_b32 v[74:75], v237 offset0:66 offset1:67
    s_waitcnt lgkmcnt(10)
    v_mfma_f32_16x16x32_bf16 v[48:51], v[128:131], v[176:179], v[48:51]
    ds_read_b64_tr_b16 a[98:99], v10 offset:18432
    v_mfma_f32_16x16x32_bf16 v[48:51], v[132:135], v[172:175], v[48:51]
    ds_read_b64_tr_b16 a[104:105], v10 offset:20480
    v_mfma_f32_16x16x32_bf16 v[48:51], v[136:139], v[168:171], v[48:51]
    ds_read_b64_tr_b16 a[106:107], v10 offset:22528
    v_mfma_f32_16x16x32_bf16 v[48:51], v[140:143], v[164:167], v[48:51]
    ds_read_b128 v[108:111], v244 offset:12288
    v_mfma_f32_16x16x32_bf16 v[48:51], v[144:147], v[160:163], v[48:51]
    ds_read_b64_tr_b16 a[100:101], v11 offset:16384
    v_mfma_f32_16x16x32_bf16 v[52:55], v[148:151], v[160:163], v[52:55]
    ds_read_b64_tr_b16 a[102:103], v11 offset:18432
    v_mfma_f32_16x16x32_bf16 v[52:55], v[144:147], v[164:167], v[52:55]
    ds_read2_b32 v[76:77], v237 offset0:192 offset1:193
    v_mfma_f32_16x16x32_bf16 v[52:55], v[140:143], v[168:171], v[52:55]
    ds_read_b64_tr_b16 a[108:109], v11 offset:20480
    s_add_u32 m0, s73, 16384
    v_mfma_f32_16x16x32_bf16 v[52:55], v[136:139], v[172:175], v[52:55]
    ds_read_b64_tr_b16 a[110:111], v11 offset:22528
    buffer_load_dwordx4 v6, s[52:55], s14 offen offset:2048 lds
    v_mfma_f32_16x16x32_bf16 v[52:55], v[132:135], v[176:179], v[52:55]
    ds_read2_b32 v[78:79], v237 offset0:194 offset1:195
    v_mfma_f32_16x16x32_bf16 v[52:55], v[128:131], v[180:183], v[52:55]
    ds_read_b128 v[112:115], v244 offset:16384
    v_mfma_f32_16x16x32_bf16 v[56:59], v[128:131], v[184:187], v[56:59]
    ds_read2_b32 v[80:81], v238 offset0:64 offset1:65
    v_mfma_f32_16x16x32_bf16 v[56:59], v[132:135], v[180:183], v[56:59]
    ds_read2_b32 v[82:83], v238 offset0:66 offset1:67
    v_mfma_f32_16x16x32_bf16 v[56:59], v[136:139], v[176:179], v[56:59]
    ds_read_b128 v[116:119], v244 offset:20480
    v_mfma_f32_16x16x32_bf16 v[56:59], v[140:143], v[172:175], v[56:59]
    ds_read2_b32 v[84:85], v238 offset0:192 offset1:193
    v_mfma_f32_16x16x32_bf16 v[56:59], v[144:147], v[168:171], v[56:59]
    ds_read2_b32 v[86:87], v238 offset0:194 offset1:195
    v_mfma_f32_16x16x32_bf16 v[56:59], v[148:151], v[164:167], v[56:59]
    ds_read_b128 v[120:123], v244 offset:24576
    v_mfma_f32_16x16x32_bf16 v[56:59], v[152:155], v[160:163], v[56:59]
    v_mfma_f32_16x16x32_bf16 v[60:63], v[156:159], v[160:163], v[60:63]
    s_add_u32 m0, s73, 16384
    ds_read2_b32 v[88:89], v239 offset0:64 offset1:65
    v_mfma_f32_16x16x32_bf16 v[60:63], v[152:155], v[164:167], v[60:63]
    buffer_load_dwordx4 v7, s[52:55], s14 offen offset:3072 lds
    ds_read2_b32 v[90:91], v239 offset0:66 offset1:67
    v_mfma_f32_16x16x32_bf16 v[60:63], v[148:151], v[168:171], v[60:63]
    v_mfma_f32_16x16x32_bf16 v[60:63], v[144:147], v[172:175], v[60:63]
    ds_read_b128 v[124:127], v244 offset:28672
    v_mfma_f32_16x16x32_bf16 v[60:63], v[140:143], v[176:179], v[60:63]
    ds_read2_b32 v[92:93], v239 offset0:192 offset1:193
    v_mfma_f32_16x16x32_bf16 v[60:63], v[136:139], v[180:183], v[60:63]
    v_mfma_f32_16x16x32_bf16 v[60:63], v[132:135], v[184:187], v[60:63]
    ds_read2_b32 v[94:95], v239 offset0:194 offset1:195
    v_mfma_f32_16x16x32_bf16 v[60:63], v[128:131], v[188:191], v[60:63]
    s_waitcnt lgkmcnt(12)
    v_mfma_f32_16x16x32_bf16 v[32:35], v[64:67], v[96:99], v[32:35]
    ds_read_b128 v[160:163], v245 offset:0
    v_mfma_f32_16x16x32_bf16 v[36:39], v[68:71], v[96:99], v[36:39]
    ds_read2_b32 v[128:129], v236 offset0:80 offset1:81
    v_mfma_f32_16x16x32_bf16 v[36:39], v[64:67], v[100:103], v[36:39]
    ds_read2_b32 v[130:131], v236 offset0:82 offset1:83
    v_mfma_f32_16x16x32_bf16 v[40:43], v[64:67], v[104:107], v[40:43]
    ds_read_b128 v[164:167], v245 offset:4096
    s_barrier
    v_mfma_f32_16x16x32_bf16 v[40:43], v[68:71], v[100:103], v[40:43]
    ds_read2_b32 v[132:133], v236 offset0:208 offset1:209
    v_mfma_f32_16x16x32_bf16 v[40:43], v[72:75], v[96:99], v[40:43]
    ds_read2_b32 v[134:135], v236 offset0:210 offset1:211
    v_mfma_f32_16x16x32_bf16 v[44:47], v[76:79], v[96:99], v[44:47]
    ds_read_b128 v[168:171], v245 offset:8192
    v_mfma_f32_16x16x32_bf16 v[44:47], v[72:75], v[100:103], v[44:47]
    s_lshl_b32 s14, s93, 18
    ds_read2_b32 v[136:137], v237 offset0:80 offset1:81
    v_mfma_f32_16x16x32_bf16 v[44:47], v[68:71], v[104:107], v[44:47]
    s_add_u32 m0, s73, 147456
    ds_read2_b32 v[138:139], v237 offset0:82 offset1:83
    v_mfma_f32_16x16x32_bf16 v[44:47], v[64:67], v[108:111], v[44:47]
    buffer_load_dwordx4 v4, s[52:55], s14 offen offset:0 lds
    ds_read_b128 v[172:175], v245 offset:12288
    s_waitcnt lgkmcnt(10)
    v_mfma_f32_16x16x32_bf16 v[48:51], v[64:67], v[112:115], v[48:51]
    ds_read2_b32 v[140:141], v237 offset0:208 offset1:209
    v_mfma_f32_16x16x32_bf16 v[48:51], v[68:71], v[108:111], v[48:51]
    ds_read2_b32 v[142:143], v237 offset0:210 offset1:211
    v_mfma_f32_16x16x32_bf16 v[48:51], v[72:75], v[104:107], v[48:51]
    ds_read_b128 v[176:179], v245 offset:16384
    v_mfma_f32_16x16x32_bf16 v[48:51], v[76:79], v[100:103], v[48:51]
    ds_read2_b32 v[144:145], v238 offset0:80 offset1:81
    v_mfma_f32_16x16x32_bf16 v[48:51], v[80:83], v[96:99], v[48:51]
    ds_read2_b32 v[146:147], v238 offset0:82 offset1:83
    v_mfma_f32_16x16x32_bf16 v[52:55], v[84:87], v[96:99], v[52:55]
    ds_read_b128 v[180:183], v245 offset:20480
    v_mfma_f32_16x16x32_bf16 v[52:55], v[80:83], v[100:103], v[52:55]
    ds_read2_b32 v[148:149], v238 offset0:208 offset1:209
    v_mfma_f32_16x16x32_bf16 v[52:55], v[76:79], v[104:107], v[52:55]
    ds_read2_b32 v[150:151], v238 offset0:210 offset1:211
    v_mfma_f32_16x16x32_bf16 v[52:55], v[72:75], v[108:111], v[52:55]
    ds_read_b128 v[184:187], v245 offset:24576
    v_mfma_f32_16x16x32_bf16 v[52:55], v[68:71], v[112:115], v[52:55]
    s_add_u32 m0, s73, 147456
    ds_read_b128 v[212:215], v241 offset:8352
    v_mfma_f32_16x16x32_bf16 v[52:55], v[64:67], v[116:119], v[52:55]
    buffer_load_dwordx4 v5, s[52:55], s14 offen offset:1024 lds
    ds_read2_b32 v[152:153], v239 offset0:80 offset1:81
    v_mfma_f32_16x16x32_bf16 v[56:59], v[64:67], v[120:123], v[56:59]
    ds_read_b32 v216, v241 offset:8368
    v_mfma_f32_16x16x32_bf16 v[56:59], v[68:71], v[116:119], v[56:59]
    ds_read_b128 v[218:221], v241 offset:9376
    v_mfma_f32_16x16x32_bf16 v[56:59], v[72:75], v[112:115], v[56:59]
    ds_read_b32 v222, v241 offset:9392
    v_mfma_f32_16x16x32_bf16 v[56:59], v[76:79], v[108:111], v[56:59]
    ds_read_b128 v[224:227], v241 offset:10400
    v_mfma_f32_16x16x32_bf16 v[56:59], v[80:83], v[104:107], v[56:59]
    ds_read_b32 v228, v241 offset:10416
    s_waitcnt vmcnt(6)
    s_barrier
    v_mfma_f32_16x16x32_bf16 v[56:59], v[84:87], v[100:103], v[56:59]
    ds_read_b128 v[230:233], v241 offset:11424
    v_add_u32 v10, -131072, v10
    v_mfma_f32_16x16x32_bf16 v[56:59], v[88:91], v[96:99], v[56:59]
    ds_read_b64_tr_b16 a[112:113], v10 offset:0
    v_mfma_f32_16x16x32_bf16 v[60:63], v[92:95], v[96:99], v[60:63]
    ds_read_b64_tr_b16 a[114:115], v10 offset:2048
    v_mfma_f32_16x16x32_bf16 v[60:63], v[88:91], v[100:103], v[60:63]
    ds_read_b64_tr_b16 a[120:121], v10 offset:4096
    ds_read2_b32 v[154:155], v239 offset0:82 offset1:83
    v_mfma_f32_16x16x32_bf16 v[60:63], v[84:87], v[104:107], v[60:63]
    ds_read_b32 v234, v241 offset:11440
    v_mfma_f32_16x16x32_bf16 v[60:63], v[80:83], v[108:111], v[60:63]
    ds_read_b64_tr_b16 a[122:123], v10 offset:6144
    s_add_u32 m0, s73, 147456
    ds_read_b128 v[188:191], v245 offset:28672
    v_mfma_f32_16x16x32_bf16 v[60:63], v[76:79], v[112:115], v[60:63]
    v_add_u32 v11, -131072, v11
    buffer_load_dwordx4 v6, s[52:55], s14 offen offset:2048 lds
    ds_read2_b32 v[156:157], v239 offset0:208 offset1:209
    v_mfma_f32_16x16x32_bf16 v[60:63], v[72:75], v[116:119], v[60:63]
    ds_read_b64_tr_b16 a[116:117], v11 offset:0
    v_mfma_f32_16x16x32_bf16 v[60:63], v[68:71], v[120:123], v[60:63]
    ds_read_b64_tr_b16 a[118:119], v11 offset:2048
    ds_read2_b32 v[158:159], v239 offset0:210 offset1:211
    v_mfma_f32_16x16x32_bf16 v[60:63], v[64:67], v[124:127], v[60:63]
    ds_read_b64_tr_b16 a[124:125], v11 offset:4096
    s_waitcnt lgkmcnt(15)
    v_mfma_f32_16x16x32_bf16 v[32:35], v[128:131], v[160:163], v[32:35]
    ds_read_b64_tr_b16 a[126:127], v11 offset:6144
    v_mfma_f32_16x16x32_bf16 v[36:39], v[132:135], v[160:163], v[36:39]
    ds_read_b128 v[96:99], v246 offset:0
    v_mfma_f32_16x16x32_bf16 v[36:39], v[128:131], v[164:167], v[36:39]
    ds_read2_b32 v[64:65], v236 offset0:96 offset1:97
    v_mfma_f32_16x16x32_bf16 v[40:43], v[128:131], v[168:171], v[40:43]
    ds_read2_b32 v[66:67], v236 offset0:98 offset1:99
    v_mfma_f32_16x16x32_bf16 v[40:43], v[132:135], v[164:167], v[40:43]
    s_waitcnt lgkmcnt(11)
    v_mfma_f32_16x16x32_bf16 v[40:43], v[136:139], v[160:163], v[40:43]
    ds_read_b128 v[100:103], v246 offset:4096
    v_mfma_f32_16x16x32_bf16 v[44:47], v[140:143], v[160:163], v[44:47]
    ds_read2_b32 v[68:69], v236 offset0:224 offset1:225
    v_mfma_f32_16x16x32_bf16 v[44:47], v[136:139], v[164:167], v[44:47]
    s_add_u32 m0, s73, 147456
    ds_read2_b32 v[70:71], v236 offset0:226 offset1:227
    v_mfma_f32_16x16x32_bf16 v[44:47], v[132:135], v[168:171], v[44:47]
    buffer_load_dwordx4 v7, s[52:55], s14 offen offset:3072 lds
    v_lshlrev_b32 v9, 16, v9
    v_mfma_f32_16x16x32_bf16 v[44:47], v[128:131], v[172:175], v[44:47]
    ds_read_b128 v[104:107], v246 offset:8192
    s_waitcnt lgkmcnt(9)
    v_mfma_f32_16x16x32_bf16 v[48:51], v[128:131], v[176:179], v[48:51]
    ds_read2_b32 v[72:73], v237 offset0:96 offset1:97
    v_lshlrev_b32 v208, 16, v212
    v_mfma_f32_16x16x32_bf16 v[48:51], v[132:135], v[172:175], v[48:51]
    v_mfma_f32_16x16x32_bf16 v[48:51], v[136:139], v[168:171], v[48:51]
    ds_read2_b32 v[74:75], v237 offset0:98 offset1:99
    v_add_f32 v9, v9, v208
    v_mfma_f32_16x16x32_bf16 v[48:51], v[140:143], v[164:167], v[48:51]
    ds_read_b128 v[108:111], v246 offset:12288
    v_cvt_pk_bf16_f32 v9, v9, v9
    v_mfma_f32_16x16x32_bf16 v[48:51], v[144:147], v[160:163], v[48:51]
    ds_read2_b32 v[76:77], v237 offset0:224 offset1:225
    s_waitcnt lgkmcnt(11)
    s_barrier
    v_mfma_f32_16x16x32_bf16 v[52:55], v[148:151], v[160:163], v[52:55]
    ds_write_b16 v242, v9 offset:12480
    v_mfma_f32_16x16x32_bf16 v[52:55], v[144:147], v[164:167], v[52:55]
    ds_read2_b32 v[78:79], v237 offset0:226 offset1:227
    v_mfma_f32_16x16x32_bf16 v[52:55], v[140:143], v[168:171], v[52:55]
    ds_write_b16 v242, v9 offset:8322
    v_mfma_f32_16x16x32_bf16 v[52:55], v[136:139], v[172:175], v[52:55]
    s_lshl_b32 s14, s94, 18
    ds_read_b128 v[112:115], v246 offset:16384
    v_mfma_f32_16x16x32_bf16 v[52:55], v[132:135], v[176:179], v[52:55]
    ds_read2_b32 v[80:81], v238 offset0:96 offset1:97
    s_add_u32 m0, s73, 0
    v_alignbit_b32 v212, v213, v212, 16
    v_mfma_f32_16x16x32_bf16 v[52:55], v[128:131], v[180:183], v[52:55]
    buffer_load_dwordx4 v4, s[52:55], s14 offen offset:0 lds
    v_alignbit_b32 v213, v214, v213, 16
    v_mfma_f32_16x16x32_bf16 v[56:59], v[128:131], v[184:187], v[56:59]
    ds_read2_b32 v[82:83], v238 offset0:98 offset1:99
    v_mfma_f32_16x16x32_bf16 v[56:59], v[132:135], v[180:183], v[56:59]
    ds_read_b128 v[116:119], v246 offset:20480
    v_alignbit_b32 v214, v215, v214, 16
    v_mfma_f32_16x16x32_bf16 v[56:59], v[136:139], v[176:179], v[56:59]
    v_mfma_f32_16x16x32_bf16 v[56:59], v[140:143], v[172:175], v[56:59]
    ds_read2_b32 v[84:85], v238 offset0:224 offset1:225
    v_alignbit_b32 v215, v216, v215, 16
    v_mfma_f32_16x16x32_bf16 v[56:59], v[144:147], v[168:171], v[56:59]
    ds_read2_b32 v[86:87], v238 offset0:226 offset1:227
    v_mfma_f32_16x16x32_bf16 v[56:59], v[148:151], v[164:167], v[56:59]
    ds_write_b128 v241, v[212:215] offset:12512
    v_mfma_f32_16x16x32_bf16 v[56:59], v[152:155], v[160:163], v[56:59]
    ds_read_b128 v[120:123], v246 offset:24576
    v_mfma_f32_16x16x32_bf16 v[60:63], v[156:159], v[160:163], v[60:63]
    ds_read2_b32 v[88:89], v239 offset0:96 offset1:97
    v_alignbit_b32 v218, v219, v218, 16
    v_mfma_f32_16x16x32_bf16 v[60:63], v[152:155], v[164:167], v[60:63]
    ds_read2_b32 v[90:91], v239 offset0:98 offset1:99
    v_alignbit_b32 v219, v220, v219, 16
    v_mfma_f32_16x16x32_bf16 v[60:63], v[148:151], v[168:171], v[60:63]
    s_add_u32 m0, s73, 0
    ds_read_b128 v[124:127], v246 offset:28672
    v_mfma_f32_16x16x32_bf16 v[60:63], v[144:147], v[172:175], v[60:63]
    buffer_load_dwordx4 v5, s[52:55], s14 offen offset:1024 lds
    v_alignbit_b32 v220, v221, v220, 16
    v_mfma_f32_16x16x32_bf16 v[60:63], v[140:143], v[176:179], v[60:63]
    ds_read2_b32 v[92:93], v239 offset0:224 offset1:225
    v_mfma_f32_16x16x32_bf16 v[60:63], v[136:139], v[180:183], v[60:63]
    ds_read2_b32 v[94:95], v239 offset0:226 offset1:227
    v_alignbit_b32 v221, v222, v221, 16
    v_mfma_f32_16x16x32_bf16 v[60:63], v[132:135], v[184:187], v[60:63]
    ds_write_b128 v241, v[218:221] offset:13536
    v_mfma_f32_16x16x32_bf16 v[60:63], v[128:131], v[188:191], v[60:63]
    s_waitcnt lgkmcnt(15)
    v_mfma_f32_16x16x32_bf16 v[32:35], v[64:67], v[96:99], v[32:35]
    ds_read_b128 v[160:163], v247 offset:0
    s_waitcnt vmcnt(6)
    s_barrier
    v_mfma_f32_16x16x32_bf16 v[36:39], v[68:71], v[96:99], v[36:39]
    ds_read_b64_tr_b16 a[128:129], v10 offset:16384
    v_alignbit_b32 v224, v225, v224, 16
    v_mfma_f32_16x16x32_bf16 v[36:39], v[64:67], v[100:103], v[36:39]
    ds_read_b64_tr_b16 a[130:131], v10 offset:18432
    ds_read_b128 v[164:167], v247 offset:4096
    v_mfma_f32_16x16x32_bf16 v[40:43], v[64:67], v[104:107], v[40:43]
    ds_read_b128 v[168:171], v247 offset:8192
    v_mfma_f32_16x16x32_bf16 v[40:43], v[68:71], v[100:103], v[40:43]
    ds_read_b64_tr_b16 a[136:137], v10 offset:20480
    ds_read_b128 v[172:175], v247 offset:12288
    v_mfma_f32_16x16x32_bf16 v[40:43], v[72:75], v[96:99], v[40:43]
    ds_read_b64_tr_b16 a[138:139], v10 offset:22528
    v_alignbit_b32 v225, v226, v225, 16
    v_mfma_f32_16x16x32_bf16 v[44:47], v[76:79], v[96:99], v[44:47]
    s_add_u32 m0, s73, 0
    ds_read_b128 v[176:179], v247 offset:16384
    v_mfma_f32_16x16x32_bf16 v[44:47], v[72:75], v[100:103], v[44:47]
    ds_read_b64_tr_b16 a[132:133], v11 offset:16384
    buffer_load_dwordx4 v6, s[52:55], s14 offen offset:2048 lds
    ds_read_b128 v[180:183], v247 offset:20480
    v_mfma_f32_16x16x32_bf16 v[44:47], v[68:71], v[104:107], v[44:47]
    ds_read_b64_tr_b16 a[134:135], v11 offset:18432
    v_mfma_f32_16x16x32_bf16 v[44:47], v[64:67], v[108:111], v[44:47]
    ds_read_b128 v[184:187], v247 offset:24576
    v_alignbit_b32 v226, v227, v226, 16
    s_waitcnt lgkmcnt(14)
    v_mfma_f32_16x16x32_bf16 v[48:51], v[64:67], v[112:115], v[48:51]
    ds_read_b64_tr_b16 a[140:141], v11 offset:20480
    ds_read_b128 v[188:191], v247 offset:28672
    v_mfma_f32_16x16x32_bf16 v[48:51], v[68:71], v[108:111], v[48:51]
    ds_read_b64_tr_b16 a[142:143], v11 offset:22528
    v_mfma_f32_16x16x32_bf16 v[48:51], v[72:75], v[104:107], v[48:51]
    ds_read2_b32 v[128:129], v236 offset0:112 offset1:113
    v_alignbit_b32 v227, v228, v227, 16
    v_mfma_f32_16x16x32_bf16 v[48:51], v[76:79], v[100:103], v[48:51]
    ds_read2_b32 v[130:131], v236 offset0:114 offset1:115
    v_mfma_f32_16x16x32_bf16 v[48:51], v[80:83], v[96:99], v[48:51]
    ds_read2_b32 v[132:133], v236 offset0:240 offset1:241
    v_mfma_f32_16x16x32_bf16 v[52:55], v[84:87], v[96:99], v[52:55]
    ds_read2_b32 v[134:135], v236 offset0:242 offset1:243
    v_mfma_f32_16x16x32_bf16 v[52:55], v[80:83], v[100:103], v[52:55]
    ds_write_b128 v241, v[224:227] offset:14560
    v_mfma_f32_16x16x32_bf16 v[52:55], v[76:79], v[104:107], v[52:55]
    ds_read2_b32 v[136:137], v237 offset0:112 offset1:113
    ds_read2_b32 v[138:139], v237 offset0:114 offset1:115
    v_mfma_f32_16x16x32_bf16 v[52:55], v[72:75], v[108:111], v[52:55]
    s_add_u32 m0, s73, 0
    ds_read2_b32 v[140:141], v237 offset0:240 offset1:241
    s_add_u32 s6, s12, 4751360
    v_mfma_f32_16x16x32_bf16 v[52:55], v[68:71], v[112:115], v[52:55]
    buffer_load_dwordx4 v7, s[52:55], s14 offen offset:3072 lds
    v_alignbit_b32 v230, v231, v230, 16
    v_mfma_f32_16x16x32_bf16 v[52:55], v[64:67], v[116:119], v[52:55]
    ds_read2_b32 v[142:143], v237 offset0:242 offset1:243
    v_xor_b32 v244, 64, v244
    v_mfma_f32_16x16x32_bf16 v[56:59], v[64:67], v[120:123], v[56:59]
    ds_read2_b32 v[144:145], v238 offset0:112 offset1:113
    v_mfma_f32_16x16x32_bf16 v[56:59], v[68:71], v[116:119], v[56:59]
    ds_read2_b32 v[146:147], v238 offset0:114 offset1:115
    v_mfma_f32_16x16x32_bf16 v[56:59], v[72:75], v[112:115], v[56:59]
    ds_read2_b32 v[148:149], v238 offset0:240 offset1:241
    v_alignbit_b32 v231, v232, v231, 16
    v_mfma_f32_16x16x32_bf16 v[56:59], v[76:79], v[108:111], v[56:59]
    ds_read2_b32 v[150:151], v238 offset0:242 offset1:243
    v_xor_b32 v245, 64, v245
    v_mfma_f32_16x16x32_bf16 v[56:59], v[80:83], v[104:107], v[56:59]
    ds_read2_b32 v[152:153], v239 offset0:112 offset1:113
    s_waitcnt lgkmcnt(14)
    s_barrier
    v_mfma_f32_16x16x32_bf16 v[56:59], v[84:87], v[100:103], v[56:59]
    ds_read2_b32 v[154:155], v239 offset0:114 offset1:115
    v_mfma_f32_16x16x32_bf16 v[56:59], v[88:91], v[96:99], v[56:59]
    ds_read2_b32 v[156:157], v239 offset0:240 offset1:241
    v_alignbit_b32 v232, v233, v232, 16
    v_mfma_f32_16x16x32_bf16 v[60:63], v[92:95], v[96:99], v[60:63]
    s_lshl_b32 s14, s95, 18
    ds_read2_b32 v[158:159], v239 offset0:242 offset1:243
    v_mfma_f32_16x16x32_bf16 v[60:63], v[88:91], v[100:103], v[60:63]
    s_add_u32 m0, s73, 16384
    v_xor_b32 v246, 64, v246
    v_add_u32 v236, 8320, v236
    v_mfma_f32_16x16x32_bf16 v[60:63], v[84:87], v[104:107], v[60:63]
    buffer_load_dwordx4 v4, s[52:55], s14 offen offset:0 lds
    v_alignbit_b32 v233, v234, v233, 16
    v_mfma_f32_16x16x32_bf16 v[60:63], v[80:83], v[108:111], v[60:63]
    v_add_u32 v237, 8320, v237
    v_mfma_f32_16x16x32_bf16 v[60:63], v[76:79], v[112:115], v[60:63]
    v_mfma_f32_16x16x32_bf16 v[60:63], v[72:75], v[116:119], v[60:63]
    v_xor_b32 v247, 64, v247
    v_add_u32 v238, 8320, v238
    v_mfma_f32_16x16x32_bf16 v[60:63], v[68:71], v[120:123], v[60:63]
    ds_write_b128 v241, v[230:233] offset:15584
    v_mfma_f32_16x16x32_bf16 v[60:63], v[64:67], v[124:127], v[60:63]
    v_add_u32 v239, 8320, v239
    s_waitcnt lgkmcnt(1)
    v_mfma_f32_16x16x32_bf16 v[60:63], v[128:131], v[188:191], v[60:63]
    ds_read_b128 v[96:99], v244 offset:2048
    v_mfma_f32_16x16x32_bf16 v[60:63], v[132:135], v[184:187], v[60:63]
    ds_read2_b32 v[64:65], v236 offset0:0 offset1:1
    v_mfma_f32_16x16x32_bf16 v[60:63], v[136:139], v[180:183], v[60:63]
    ds_read2_b32 v[66:67], v236 offset0:2 offset1:3
    v_mfma_f32_16x16x32_bf16 v[60:63], v[140:143], v[176:179], v[60:63]
    ds_read_b128 v[100:103], v244 offset:6144
    v_mfma_f32_16x16x32_bf16 v[60:63], v[144:147], v[172:175], v[60:63]
    ds_read2_b32 v[68:69], v236 offset0:128 offset1:129
    v_mfma_f32_16x16x32_bf16 v[60:63], v[148:151], v[168:171], v[60:63]
    s_add_u32 m0, s73, 16384
    ds_read2_b32 v[70:71], v236 offset0:130 offset1:131
    v_mfma_f32_16x16x32_bf16 v[60:63], v[152:155], v[164:167], v[60:63]
    buffer_load_dwordx4 v5, s[52:55], s14 offen offset:1024 lds
    ds_read_b128 v[104:107], v244 offset:10240
    v_mfma_f32_16x16x32_bf16 v[60:63], v[156:159], v[160:163], v[60:63]
    ds_read2_b32 v[72:73], v237 offset0:0 offset1:1
    v_mfma_f32_16x16x32_bf16 v[56:59], v[128:131], v[184:187], v[56:59]
    ds_read2_b32 v[74:75], v237 offset0:2 offset1:3
    v_mfma_f32_16x16x32_bf16 v[56:59], v[132:135], v[180:183], v[56:59]
    ds_read_b128 v[108:111], v244 offset:14336
    v_mfma_f32_16x16x32_bf16 v[56:59], v[136:139], v[176:179], v[56:59]
    ds_read2_b32 v[76:77], v237 offset0:128 offset1:129
    v_mfma_f32_16x16x32_bf16 v[56:59], v[140:143], v[172:175], v[56:59]
    ds_read2_b32 v[78:79], v237 offset0:130 offset1:131
    v_mfma_f32_16x16x32_bf16 v[56:59], v[144:147], v[168:171], v[56:59]
    ds_read_b128 v[112:115], v244 offset:18432
    v_mfma_f32_16x16x32_bf16 v[56:59], v[148:151], v[164:167], v[56:59]
    ds_read2_b32 v[80:81], v238 offset0:0 offset1:1
    v_cvt_pk_bf16_f32 v206, v60, v61
    v_mfma_f32_16x16x32_bf16 v[56:59], v[152:155], v[160:163], v[56:59]
    ds_read2_b32 v[82:83], v238 offset0:2 offset1:3
    s_waitcnt vmcnt(6)
    s_barrier
    v_mfma_f32_16x16x32_bf16 v[52:55], v[128:131], v[180:183], v[52:55]
    ds_read_b128 v[116:119], v244 offset:22528
    v_add_u32 v10, 131072, v10
    v_mfma_f32_16x16x32_bf16 v[52:55], v[132:135], v[176:179], v[52:55]
    ds_read_b64_tr_b16 a[144:145], v10 offset:16384
    v_cvt_pk_bf16_f32 v207, v62, v63
    v_mfma_f32_16x16x32_bf16 v[52:55], v[136:139], v[172:175], v[52:55]
    ds_read_b64_tr_b16 a[146:147], v10 offset:18432
    s_add_u32 m0, s73, 16384
    v_mfma_f32_16x16x32_bf16 v[52:55], v[140:143], v[168:171], v[52:55]
    buffer_load_dwordx4 v6, s[52:55], s14 offen offset:2048 lds
    ds_read2_b32 v[84:85], v238 offset0:128 offset1:129
    v_mfma_f32_16x16x32_bf16 v[52:55], v[144:147], v[164:167], v[52:55]
    buffer_store_dwordx2 v[206:207], v8, s[44:47], s6 offen offset:3584 sc1
    ds_read_b64_tr_b16 a[152:153], v10 offset:20480
    v_mfma_f32_16x16x32_bf16 v[52:55], v[148:151], v[160:163], v[52:55]
    ds_read_b64_tr_b16 a[154:155], v10 offset:22528
    v_mfma_f32_16x16x32_bf16 v[48:51], v[128:131], v[176:179], v[48:51]
    ds_read2_b32 v[86:87], v238 offset0:130 offset1:131
    v_add_u32 v11, 131072, v11
    v_cvt_pk_bf16_f32 v204, v56, v57
    v_mfma_f32_16x16x32_bf16 v[48:51], v[132:135], v[172:175], v[48:51]
    ds_read_b64_tr_b16 a[148:149], v11 offset:16384
    ds_read_b128 v[120:123], v244 offset:26624
    v_mfma_f32_16x16x32_bf16 v[48:51], v[136:139], v[168:171], v[48:51]
    ds_read_b64_tr_b16 a[150:151], v11 offset:18432
    ds_read2_b32 v[88:89], v239 offset0:0 offset1:1
    v_mfma_f32_16x16x32_bf16 v[48:51], v[140:143], v[164:167], v[48:51]
    ds_read2_b32 v[90:91], v239 offset0:2 offset1:3
    v_cvt_pk_bf16_f32 v205, v58, v59
    v_mfma_f32_16x16x32_bf16 v[48:51], v[144:147], v[160:163], v[48:51]
    ds_read_b64_tr_b16 a[156:157], v11 offset:20480
    ds_read_b128 v[124:127], v244 offset:30720
    v_mfma_f32_16x16x32_bf16 v[44:47], v[128:131], v[172:175], v[44:47]
    buffer_store_dwordx2 v[204:205], v8, s[44:47], s6 offen offset:3072 sc1
    ds_read_b64_tr_b16 a[158:159], v11 offset:22528
    v_mfma_f32_16x16x32_bf16 v[44:47], v[132:135], v[168:171], v[44:47]
    ds_read2_b32 v[92:93], v239 offset0:128 offset1:129
    v_mfma_f32_16x16x32_bf16 v[44:47], v[136:139], v[164:167], v[44:47]
    s_add_u32 m0, s73, 16384
    ds_read2_b32 v[94:95], v239 offset0:130 offset1:131
    v_mfma_f32_16x16x32_bf16 v[44:47], v[140:143], v[160:163], v[44:47]
    buffer_load_dwordx4 v7, s[52:55], s14 offen offset:3072 lds
    v_cvt_pk_bf16_f32 v202, v52, v53
    v_mfma_f32_16x16x32_bf16 v[40:43], v[128:131], v[168:171], v[40:43]
    v_mfma_f32_16x16x32_bf16 v[40:43], v[132:135], v[164:167], v[40:43]
    v_mfma_f32_16x16x32_bf16 v[40:43], v[136:139], v[160:163], v[40:43]
    v_cvt_pk_bf16_f32 v203, v54, v55
    v_mfma_f32_16x16x32_bf16 v[36:39], v[128:131], v[164:167], v[36:39]
    v_mfma_f32_16x16x32_bf16 v[36:39], v[132:135], v[160:163], v[36:39]
    buffer_store_dwordx2 v[202:203], v8, s[44:47], s6 offen offset:2560 sc1
    v_mfma_f32_16x16x32_bf16 v[32:35], v[128:131], v[160:163], v[32:35]
    s_waitcnt lgkmcnt(0)
    v_mfma_f32_16x16x32_bf16 v[60:63], v[64:67], v[124:127], 0
    ds_read_b128 v[160:163], v245 offset:2048
    v_mfma_f32_16x16x32_bf16 v[60:63], v[68:71], v[120:123], v[60:63]
    v_cvt_pk_bf16_f32 v200, v48, v49
    v_mfma_f32_16x16x32_bf16 v[60:63], v[72:75], v[116:119], v[60:63]
    ds_read2_b32 v[128:129], v236 offset0:16 offset1:17
    v_mfma_f32_16x16x32_bf16 v[60:63], v[76:79], v[112:115], v[60:63]
    s_barrier
    v_cvt_pk_bf16_f32 v201, v50, v51
    v_mfma_f32_16x16x32_bf16 v[60:63], v[80:83], v[108:111], v[60:63]
    ds_read2_b32 v[130:131], v236 offset0:18 offset1:19
    v_mfma_f32_16x16x32_bf16 v[60:63], v[84:87], v[104:107], v[60:63]
    buffer_store_dwordx2 v[200:201], v8, s[44:47], s6 offen offset:2048 sc1
    ds_read_b128 v[164:167], v245 offset:6144
    v_mfma_f32_16x16x32_bf16 v[60:63], v[88:91], v[100:103], v[60:63]
    ds_read2_b32 v[132:133], v236 offset0:144 offset1:145
    v_mfma_f32_16x16x32_bf16 v[60:63], v[92:95], v[96:99], v[60:63]
    ds_read2_b32 v[134:135], v236 offset0:146 offset1:147
    s_lshl_b32 s14, s96, 18
    v_cvt_pk_bf16_f32 v198, v44, v45
    v_mfma_f32_16x16x32_bf16 v[56:59], v[64:67], v[120:123], 0
    s_add_u32 m0, s73, 147456
    ds_read_b128 v[168:171], v245 offset:10240
    v_mfma_f32_16x16x32_bf16 v[56:59], v[68:71], v[116:119], v[56:59]
    buffer_load_dwordx4 v4, s[52:55], s14 offen offset:0 lds
    ds_read2_b32 v[136:137], v237 offset0:16 offset1:17
    v_mfma_f32_16x16x32_bf16 v[56:59], v[72:75], v[112:115], v[56:59]
    ds_read2_b32 v[138:139], v237 offset0:18 offset1:19
    v_cvt_pk_bf16_f32 v199, v46, v47
    v_mfma_f32_16x16x32_bf16 v[56:59], v[76:79], v[108:111], v[56:59]
    ds_read_b128 v[172:175], v245 offset:14336
    v_mfma_f32_16x16x32_bf16 v[56:59], v[80:83], v[104:107], v[56:59]
    buffer_store_dwordx2 v[198:199], v8, s[44:47], s6 offen offset:1536 sc1
    ds_read2_b32 v[140:141], v237 offset0:144 offset1:145
    v_mfma_f32_16x16x32_bf16 v[56:59], v[84:87], v[100:103], v[56:59]
    ds_read2_b32 v[142:143], v237 offset0:146 offset1:147
    v_mfma_f32_16x16x32_bf16 v[56:59], v[88:91], v[96:99], v[56:59]
    ds_read_b128 v[176:179], v245 offset:18432
    v_cvt_pk_bf16_f32 v196, v40, v41
    v_mfma_f32_16x16x32_bf16 v[52:55], v[64:67], v[116:119], 0
    ds_read2_b32 v[144:145], v238 offset0:16 offset1:17
    v_mfma_f32_16x16x32_bf16 v[52:55], v[68:71], v[112:115], v[52:55]
    ds_read2_b32 v[146:147], v238 offset0:18 offset1:19
    v_cvt_pk_bf16_f32 v197, v42, v43
    v_mfma_f32_16x16x32_bf16 v[52:55], v[72:75], v[108:111], v[52:55]
    ds_read_b128 v[180:183], v245 offset:22528
    v_mfma_f32_16x16x32_bf16 v[52:55], v[76:79], v[104:107], v[52:55]
    buffer_store_dwordx2 v[196:197], v8, s[44:47], s6 offen offset:1024 sc1
    ds_read2_b32 v[148:149], v238 offset0:144 offset1:145
    v_mfma_f32_16x16x32_bf16 v[52:55], v[80:83], v[100:103], v[52:55]
    s_add_u32 m0, s73, 147456
    ds_read2_b32 v[150:151], v238 offset0:146 offset1:147
    v_mfma_f32_16x16x32_bf16 v[52:55], v[84:87], v[96:99], v[52:55]
    buffer_load_dwordx4 v5, s[52:55], s14 offen offset:1024 lds
    ds_read_b128 v[184:187], v245 offset:26624
    v_mfma_f32_16x16x32_bf16 v[48:51], v[64:67], v[112:115], 0
    ds_read2_b32 v[152:153], v239 offset0:16 offset1:17
    v_cvt_pk_bf16_f32 v194, v36, v37
    v_mfma_f32_16x16x32_bf16 v[48:51], v[68:71], v[108:111], v[48:51]
    ds_read2_b32 v[154:155], v239 offset0:18 offset1:19
    v_mfma_f32_16x16x32_bf16 v[48:51], v[72:75], v[104:107], v[48:51]
    ds_read_b128 v[188:191], v245 offset:30720
    v_cvt_pk_bf16_f32 v195, v38, v39
    v_mfma_f32_16x16x32_bf16 v[48:51], v[76:79], v[100:103], v[48:51]
    ds_read2_b32 v[156:157], v239 offset0:144 offset1:145
    v_mfma_f32_16x16x32_bf16 v[48:51], v[80:83], v[96:99], v[48:51]
    buffer_store_dwordx2 v[194:195], v8, s[44:47], s6 offen offset:512 sc1
    s_waitcnt vmcnt(13)
    s_barrier
    v_mfma_f32_16x16x32_bf16 v[44:47], v[64:67], v[108:111], 0
    v_add_u32 v10, -131072, v10
    v_cvt_pk_bf16_f32 v192, v32, v33
    v_mfma_f32_16x16x32_bf16 v[44:47], v[68:71], v[104:107], v[44:47]
    ds_read_b64_tr_b16 a[160:161], v10 offset:0
    v_mfma_f32_16x16x32_bf16 v[44:47], v[72:75], v[100:103], v[44:47]
    ds_read_b64_tr_b16 a[162:163], v10 offset:2048
    v_mfma_f32_16x16x32_bf16 v[44:47], v[76:79], v[96:99], v[44:47]
    ds_read_b64_tr_b16 a[168:169], v10 offset:4096
    v_cvt_pk_bf16_f32 v193, v34, v35
    v_mfma_f32_16x16x32_bf16 v[40:43], v[64:67], v[104:107], 0
    ds_read2_b32 v[158:159], v239 offset0:146 offset1:147
    v_mfma_f32_16x16x32_bf16 v[40:43], v[68:71], v[100:103], v[40:43]
    buffer_store_dwordx2 v[192:193], v8, s[44:47], s6 offen offset:0 sc1
    ds_read_b64_tr_b16 a[170:171], v10 offset:6144
    s_add_u32 m0, s73, 147456
    v_mfma_f32_16x16x32_bf16 v[40:43], v[72:75], v[96:99], v[40:43]
    v_add_u32 v11, -131072, v11
L_pl_X_5:
    s_cbranch_execz L_wret
    buffer_load_dwordx4 v6, s[52:55], s14 offen offset:2048 lds
    v_mfma_f32_16x16x32_bf16 v[36:39], v[64:67], v[100:103], 0
    ds_read_b64_tr_b16 a[164:165], v11 offset:0
    v_mfma_f32_16x16x32_bf16 v[36:39], v[68:71], v[96:99], v[36:39]
    ds_read_b64_tr_b16 a[166:167], v11 offset:2048
    v_mfma_f32_16x16x32_bf16 v[32:35], v[64:67], v[96:99], 0
    ds_read_b64_tr_b16 a[172:173], v11 offset:4096
    s_waitcnt lgkmcnt(15)
    v_mfma_f32_16x16x32_bf16 v[32:35], v[128:131], v[160:163], v[32:35]
    ds_read_b64_tr_b16 a[174:175], v11 offset:6144
    v_mfma_f32_16x16x32_bf16 v[36:39], v[132:135], v[160:163], v[36:39]
    ds_read_b128 v[96:99], v246 offset:2048
    v_mfma_f32_16x16x32_bf16 v[36:39], v[128:131], v[164:167], v[36:39]
    ds_read2_b32 v[64:65], v236 offset0:32 offset1:33
    v_mfma_f32_16x16x32_bf16 v[40:43], v[128:131], v[168:171], v[40:43]
    ds_read2_b32 v[66:67], v236 offset0:34 offset1:35
    v_mfma_f32_16x16x32_bf16 v[40:43], v[132:135], v[164:167], v[40:43]
    v_mfma_f32_16x16x32_bf16 v[40:43], v[136:139], v[160:163], v[40:43]
    ds_read_b128 v[100:103], v246 offset:6144
    v_mfma_f32_16x16x32_bf16 v[44:47], v[140:143], v[160:163], v[44:47]
    ds_read2_b32 v[68:69], v236 offset0:160 offset1:161
    v_mfma_f32_16x16x32_bf16 v[44:47], v[136:139], v[164:167], v[44:47]
    s_add_u32 m0, s73, 147456
    v_mfma_f32_16x16x32_bf16 v[44:47], v[132:135], v[168:171], v[44:47]
    buffer_load_dwordx4 v7, s[52:55], s14 offen offset:3072 lds
    ds_read2_b32 v[70:71], v236 offset0:162 offset1:163
    v_mfma_f32_16x16x32_bf16 v[44:47], v[128:131], v[172:175], v[44:47]
    ds_read_b128 v[104:107], v246 offset:10240
    s_waitcnt lgkmcnt(12)
    v_mfma_f32_16x16x32_bf16 v[48:51], v[128:131], v[176:179], v[48:51]
    ds_read2_b32 v[72:73], v237 offset0:32 offset1:33
    v_mfma_f32_16x16x32_bf16 v[48:51], v[132:135], v[172:175], v[48:51]
    v_mfma_f32_16x16x32_bf16 v[48:51], v[136:139], v[168:171], v[48:51]
    ds_read2_b32 v[74:75], v237 offset0:34 offset1:35
    v_mfma_f32_16x16x32_bf16 v[48:51], v[140:143], v[164:167], v[48:51]
    ds_read_b128 v[108:111], v246 offset:14336
    v_mfma_f32_16x16x32_bf16 v[48:51], v[144:147], v[160:163], v[48:51]
    s_waitcnt lgkmcnt(10)
    s_barrier
    v_mfma_f32_16x16x32_bf16 v[52:55], v[148:151], v[160:163], v[52:55]
    ds_read2_b32 v[76:77], v237 offset0:160 offset1:161
    v_mfma_f32_16x16x32_bf16 v[52:55], v[144:147], v[164:167], v[52:55]
    ds_read2_b32 v[78:79], v237 offset0:162 offset1:163
    v_mfma_f32_16x16x32_bf16 v[52:55], v[140:143], v[168:171], v[52:55]
    v_mfma_f32_16x16x32_bf16 v[52:55], v[136:139], v[172:175], v[52:55]
    s_lshl_b32 s14, s97, 18
    ds_read_b128 v[112:115], v246 offset:18432
    v_mfma_f32_16x16x32_bf16 v[52:55], v[132:135], v[176:179], v[52:55]
    s_add_u32 m0, s73, 0
    ds_read2_b32 v[80:81], v238 offset0:32 offset1:33
    v_mfma_f32_16x16x32_bf16 v[52:55], v[128:131], v[180:183], v[52:55]
    buffer_load_dwordx4 v4, s[52:55], s14 offen offset:0 lds
    v_mfma_f32_16x16x32_bf16 v[56:59], v[128:131], v[184:187], v[56:59]
    ds_read2_b32 v[82:83], v238 offset0:34 offset1:35
    v_mfma_f32_16x16x32_bf16 v[56:59], v[132:135], v[180:183], v[56:59]
    ds_read_b128 v[116:119], v246 offset:22528
    v_mfma_f32_16x16x32_bf16 v[56:59], v[136:139], v[176:179], v[56:59]
    v_mfma_f32_16x16x32_bf16 v[56:59], v[140:143], v[172:175], v[56:59]
    ds_read2_b32 v[84:85], v238 offset0:160 offset1:161
    v_mfma_f32_16x16x32_bf16 v[56:59], v[144:147], v[168:171], v[56:59]
    ds_read2_b32 v[86:87], v238 offset0:162 offset1:163
    v_mfma_f32_16x16x32_bf16 v[56:59], v[148:151], v[164:167], v[56:59]
    ds_read_b128 v[120:123], v246 offset:26624
    v_mfma_f32_16x16x32_bf16 v[56:59], v[152:155], v[160:163], v[56:59]
    v_mfma_f32_16x16x32_bf16 v[60:63], v[156:159], v[160:163], v[60:63]
    ds_read2_b32 v[88:89], v239 offset0:32 offset1:33
    v_mfma_f32_16x16x32_bf16 v[60:63], v[152:155], v[164:167], v[60:63]
    ds_read2_b32 v[90:91], v239 offset0:34 offset1:35
    v_mfma_f32_16x16x32_bf16 v[60:63], v[148:151], v[168:171], v[60:63]
    s_add_u32 m0, s73, 0
    v_mfma_f32_16x16x32_bf16 v[60:63], v[144:147], v[172:175], v[60:63]
    buffer_load_dwordx4 v5, s[52:55], s14 offen offset:1024 lds
    ds_read_b128 v[124:127], v246 offset:30720
    v_mfma_f32_16x16x32_bf16 v[60:63], v[140:143], v[176:179], v[60:63]
    ds_read2_b32 v[92:93], v239 offset0:160 offset1:161
    v_mfma_f32_16x16x32_bf16 v[60:63], v[136:139], v[180:183], v[60:63]
    v_mfma_f32_16x16x32_bf16 v[60:63], v[132:135], v[184:187], v[60:63]
    ds_read2_b32 v[94:95], v239 offset0:162 offset1:163
    v_mfma_f32_16x16x32_bf16 v[60:63], v[128:131], v[188:191], v[60:63]
    s_waitcnt lgkmcnt(12)
    v_mfma_f32_16x16x32_bf16 v[32:35], v[64:67], v[96:99], v[32:35]
    ds_read_b128 v[160:163], v247 offset:2048
    s_waitcnt vmcnt(12)
    s_barrier
    v_mfma_f32_16x16x32_bf16 v[36:39], v[68:71], v[96:99], v[36:39]
    ds_read_b64_tr_b16 a[176:177], v10 offset:16384
    v_mfma_f32_16x16x32_bf16 v[36:39], v[64:67], v[100:103], v[36:39]
    ds_read_b64_tr_b16 a[178:179], v10 offset:18432
    v_mfma_f32_16x16x32_bf16 v[40:43], v[64:67], v[104:107], v[40:43]
    ds_read2_b32 v[128:129], v236 offset0:48 offset1:49
    v_mfma_f32_16x16x32_bf16 v[40:43], v[68:71], v[100:103], v[40:43]
    ds_read_b64_tr_b16 a[184:185], v10 offset:20480
    v_mfma_f32_16x16x32_bf16 v[40:43], v[72:75], v[96:99], v[40:43]
    ds_read_b64_tr_b16 a[186:187], v10 offset:22528
    v_mfma_f32_16x16x32_bf16 v[44:47], v[76:79], v[96:99], v[44:47]
    s_add_u32 m0, s73, 0
    ds_read2_b32 v[130:131], v236 offset0:50 offset1:51
    v_mfma_f32_16x16x32_bf16 v[44:47], v[72:75], v[100:103], v[44:47]
    ds_read_b64_tr_b16 a[180:181], v11 offset:16384
    buffer_load_dwordx4 v6, s[52:55], s14 offen offset:2048 lds
    v_mfma_f32_16x16x32_bf16 v[44:47], v[68:71], v[104:107], v[44:47]
    ds_read_b64_tr_b16 a[182:183], v11 offset:18432
    v_mfma_f32_16x16x32_bf16 v[44:47], v[64:67], v[108:111], v[44:47]
    ds_read_b128 v[164:167], v247 offset:6144
    s_waitcnt lgkmcnt(10)
    v_mfma_f32_16x16x32_bf16 v[48:51], v[64:67], v[112:115], v[48:51]
    ds_read_b64_tr_b16 a[188:189], v11 offset:20480
    v_mfma_f32_16x16x32_bf16 v[48:51], v[68:71], v[108:111], v[48:51]
    ds_read_b64_tr_b16 a[190:191], v11 offset:22528
    v_mfma_f32_16x16x32_bf16 v[48:51], v[72:75], v[104:107], v[48:51]
    ds_read2_b32 v[132:133], v236 offset0:176 offset1:177
    v_mfma_f32_16x16x32_bf16 v[48:51], v[76:79], v[100:103], v[48:51]
    ds_read2_b32 v[134:135], v236 offset0:178 offset1:179
    v_mfma_f32_16x16x32_bf16 v[48:51], v[80:83], v[96:99], v[48:51]
    ds_read_b128 v[168:171], v247 offset:10240
    v_mfma_f32_16x16x32_bf16 v[52:55], v[84:87], v[96:99], v[52:55]
    ds_read2_b32 v[136:137], v237 offset0:48 offset1:49
    v_mfma_f32_16x16x32_bf16 v[52:55], v[80:83], v[100:103], v[52:55]
    ds_read2_b32 v[138:139], v237 offset0:50 offset1:51
    v_mfma_f32_16x16x32_bf16 v[52:55], v[76:79], v[104:107], v[52:55]
    ds_read_b128 v[172:175], v247 offset:14336
    v_mfma_f32_16x16x32_bf16 v[52:55], v[72:75], v[108:111], v[52:55]
    s_add_u32 m0, s73, 0
    ds_read2_b32 v[140:141], v237 offset0:176 offset1:177
    v_mfma_f32_16x16x32_bf16 v[52:55], v[68:71], v[112:115], v[52:55]
    buffer_load_dwordx4 v7, s[52:55], s14 offen offset:3072 lds
    ds_read2_b32 v[142:143], v237 offset0:178 offset1:179
    v_mfma_f32_16x16x32_bf16 v[52:55], v[64:67], v[116:119], v[52:55]
    ds_read_b128 v[176:179], v247 offset:18432
    v_mfma_f32_16x16x32_bf16 v[56:59], v[64:67], v[120:123], v[56:59]
    ds_read2_b32 v[144:145], v238 offset0:48 offset1:49
    v_mfma_f32_16x16x32_bf16 v[56:59], v[68:71], v[116:119], v[56:59]
    ds_read2_b32 v[146:147], v238 offset0:50 offset1:51
    v_mfma_f32_16x16x32_bf16 v[56:59], v[72:75], v[112:115], v[56:59]
    ds_read_b128 v[180:183], v247 offset:22528
    v_mfma_f32_16x16x32_bf16 v[56:59], v[76:79], v[108:111], v[56:59]
    ds_read2_b32 v[148:149], v238 offset0:176 offset1:177
    v_mfma_f32_16x16x32_bf16 v[56:59], v[80:83], v[104:107], v[56:59]
    ds_read2_b32 v[150:151], v238 offset0:178 offset1:179
    s_waitcnt lgkmcnt(14)
    s_barrier
    v_mfma_f32_16x16x32_bf16 v[56:59], v[84:87], v[100:103], v[56:59]
    ds_read_b128 v[184:187], v247 offset:26624
    v_mfma_f32_16x16x32_bf16 v[56:59], v[88:91], v[96:99], v[56:59]
    v_mfma_f32_16x16x32_bf16 v[60:63], v[92:95], v[96:99], v[60:63]
    s_lshl_b32 s14, s98, 18
    ds_read2_b32 v[152:153], v239 offset0:48 offset1:49
    v_mfma_f32_16x16x32_bf16 v[60:63], v[88:91], v[100:103], v[60:63]
    s_add_u32 m0, s73, 16384
    ds_read2_b32 v[154:155], v239 offset0:50 offset1:51
    v_mfma_f32_16x16x32_bf16 v[60:63], v[84:87], v[104:107], v[60:63]
    buffer_load_dwordx4 v4, s[52:55], s14 offen offset:0 lds
    v_mfma_f32_16x16x32_bf16 v[60:63], v[80:83], v[108:111], v[60:63]
    ds_read_b128 v[188:191], v247 offset:30720
    v_mfma_f32_16x16x32_bf16 v[60:63], v[76:79], v[112:115], v[60:63]
    ds_read2_b32 v[156:157], v239 offset0:176 offset1:177
    v_mfma_f32_16x16x32_bf16 v[60:63], v[72:75], v[116:119], v[60:63]
    v_mfma_f32_16x16x32_bf16 v[60:63], v[68:71], v[120:123], v[60:63]
    ds_read2_b32 v[158:159], v239 offset0:178 offset1:179
    v_mfma_f32_16x16x32_bf16 v[60:63], v[64:67], v[124:127], v[60:63]
    s_waitcnt lgkmcnt(12)
    v_mfma_f32_16x16x32_bf16 v[32:35], v[128:131], v[160:163], v[32:35]
    ds_read_b128 v[96:99], v244 offset:0
    v_mfma_f32_16x16x32_bf16 v[36:39], v[132:135], v[160:163], v[36:39]
    v_mfma_f32_16x16x32_bf16 v[36:39], v[128:131], v[164:167], v[36:39]
    ds_read2_b32 v[64:65], v236 offset0:64 offset1:65
    v_mfma_f32_16x16x32_bf16 v[40:43], v[128:131], v[168:171], v[40:43]
    ds_read2_b32 v[66:67], v236 offset0:66 offset1:67
    v_mfma_f32_16x16x32_bf16 v[40:43], v[132:135], v[164:167], v[40:43]
    v_mfma_f32_16x16x32_bf16 v[40:43], v[136:139], v[160:163], v[40:43]
    s_add_u32 m0, s73, 16384
    ds_read_b128 v[100:103], v244 offset:4096
    v_mfma_f32_16x16x32_bf16 v[44:47], v[140:143], v[160:163], v[44:47]
    buffer_load_dwordx4 v5, s[52:55], s14 offen offset:1024 lds
    ds_read2_b32 v[68:69], v236 offset0:192 offset1:193
    v_mfma_f32_16x16x32_bf16 v[44:47], v[136:139], v[164:167], v[44:47]
    v_mfma_f32_16x16x32_bf16 v[44:47], v[132:135], v[168:171], v[44:47]
    ds_read2_b32 v[70:71], v236 offset0:194 offset1:195
    v_mfma_f32_16x16x32_bf16 v[44:47], v[128:131], v[172:175], v[44:47]
    ds_read_b128 v[104:107], v244 offset:8192
    s_waitcnt lgkmcnt(7)
    v_mfma_f32_16x16x32_bf16 v[48:51], v[128:131], v[176:179], v[48:51]
    ds_read2_b32 v[72:73], v237 offset0:64 offset1:65
    v_mfma_f32_16x16x32_bf16 v[48:51], v[132:135], v[172:175], v[48:51]
    ds_read2_b32 v[74:75], v237 offset0:66 offset1:67
    v_mfma_f32_16x16x32_bf16 v[48:51], v[136:139], v[168:171], v[48:51]
    ds_read_b128 v[108:111], v244 offset:12288
    v_mfma_f32_16x16x32_bf16 v[48:51], v[140:143], v[164:167], v[48:51]
    ds_read2_b32 v[76:77], v237 offset0:192 offset1:193
    v_mfma_f32_16x16x32_bf16 v[48:51], v[144:147], v[160:163], v[48:51]
    ds_read2_b32 v[78:79], v237 offset0:194 offset1:195
    s_waitcnt vmcnt(6)
    s_barrier
    v_mfma_f32_16x16x32_bf16 v[52:55], v[148:151], v[160:163], v[52:55]
    ds_read_b128 v[112:115], v244 offset:16384
    v_add_u32 v10, 131072, v10
    v_mfma_f32_16x16x32_bf16 v[52:55], v[144:147], v[164:167], v[52:55]
    ds_read_b64_tr_b16 a[192:193], v10 offset:16384
    v_mfma_f32_16x16x32_bf16 v[52:55], v[140:143], v[168:171], v[52:55]
    ds_read_b64_tr_b16 a[194:195], v10 offset:18432
    s_add_u32 m0, s73, 16384
    v_mfma_f32_16x16x32_bf16 v[52:55], v[136:139], v[172:175], v[52:55]
    buffer_load_dwordx4 v6, s[52:55], s14 offen offset:2048 lds
    ds_read2_b32 v[80:81], v238 offset0:64 offset1:65
    v_mfma_f32_16x16x32_bf16 v[52:55], v[132:135], v[176:179], v[52:55]
    ds_read_b64_tr_b16 a[200:201], v10 offset:20480
    v_mfma_f32_16x16x32_bf16 v[52:55], v[128:131], v[180:183], v[52:55]
    ds_read_b64_tr_b16 a[202:203], v10 offset:22528
    v_mfma_f32_16x16x32_bf16 v[56:59], v[128:131], v[184:187], v[56:59]
    ds_read2_b32 v[82:83], v238 offset0:66 offset1:67
    v_add_u32 v11, 131072, v11
    v_mfma_f32_16x16x32_bf16 v[56:59], v[132:135], v[180:183], v[56:59]
    ds_read_b64_tr_b16 a[196:197], v11 offset:16384
    v_mfma_f32_16x16x32_bf16 v[56:59], v[136:139], v[176:179], v[56:59]
    ds_read_b64_tr_b16 a[198:199], v11 offset:18432
    v_mfma_f32_16x16x32_bf16 v[56:59], v[140:143], v[172:175], v[56:59]
    ds_read_b128 v[116:119], v244 offset:20480
    v_mfma_f32_16x16x32_bf16 v[56:59], v[144:147], v[168:171], v[56:59]
    ds_read_b64_tr_b16 a[204:205], v11 offset:20480
    v_mfma_f32_16x16x32_bf16 v[56:59], v[148:151], v[164:167], v[56:59]
    ds_read_b64_tr_b16 a[206:207], v11 offset:22528
    v_mfma_f32_16x16x32_bf16 v[56:59], v[152:155], v[160:163], v[56:59]
    ds_read2_b32 v[84:85], v238 offset0:192 offset1:193
    v_mfma_f32_16x16x32_bf16 v[60:63], v[156:159], v[160:163], v[60:63]
    s_add_u32 m0, s73, 16384
    ds_read2_b32 v[86:87], v238 offset0:194 offset1:195
    v_mfma_f32_16x16x32_bf16 v[60:63], v[152:155], v[164:167], v[60:63]
    buffer_load_dwordx4 v7, s[52:55], s14 offen offset:3072 lds
    ds_read_b128 v[120:123], v244 offset:24576
    v_mfma_f32_16x16x32_bf16 v[60:63], v[148:151], v[168:171], v[60:63]
    ds_read2_b32 v[88:89], v239 offset0:64 offset1:65
    v_mfma_f32_16x16x32_bf16 v[60:63], v[144:147], v[172:175], v[60:63]
    ds_read2_b32 v[90:91], v239 offset0:66 offset1:67
    v_mfma_f32_16x16x32_bf16 v[60:63], v[140:143], v[176:179], v[60:63]
    ds_read_b128 v[124:127], v244 offset:28672
    v_mfma_f32_16x16x32_bf16 v[60:63], v[136:139], v[180:183], v[60:63]
    ds_read2_b32 v[92:93], v239 offset0:192 offset1:193
    v_mfma_f32_16x16x32_bf16 v[60:63], v[132:135], v[184:187], v[60:63]
    ds_read2_b32 v[94:95], v239 offset0:194 offset1:195
    v_mfma_f32_16x16x32_bf16 v[60:63], v[128:131], v[188:191], v[60:63]
    s_waitcnt lgkmcnt(15)
    v_mfma_f32_16x16x32_bf16 v[32:35], v[64:67], v[96:99], v[32:35]
    ds_read_b128 v[160:163], v245 offset:0
    v_mfma_f32_16x16x32_bf16 v[36:39], v[68:71], v[96:99], v[36:39]
    v_mfma_f32_16x16x32_bf16 v[36:39], v[64:67], v[100:103], v[36:39]
    ds_read2_b32 v[128:129], v236 offset0:80 offset1:81
    v_mfma_f32_16x16x32_bf16 v[40:43], v[64:67], v[104:107], v[40:43]
    ds_read2_b32 v[130:131], v236 offset0:82 offset1:83
    s_waitcnt lgkmcnt(11)
    s_barrier
    v_mfma_f32_16x16x32_bf16 v[40:43], v[68:71], v[100:103], v[40:43]
    v_mfma_f32_16x16x32_bf16 v[40:43], v[72:75], v[96:99], v[40:43]
    ds_read_b128 v[164:167], v245 offset:4096
    v_mfma_f32_16x16x32_bf16 v[44:47], v[76:79], v[96:99], v[44:47]
    ds_read2_b32 v[132:133], v236 offset0:208 offset1:209
    v_mfma_f32_16x16x32_bf16 v[44:47], v[72:75], v[100:103], v[44:47]
    s_lshl_b32 s14, s99, 18
    v_mfma_f32_16x16x32_bf16 v[44:47], v[68:71], v[104:107], v[44:47]
    s_add_u32 m0, s73, 147456
    ds_read2_b32 v[134:135], v236 offset0:210 offset1:211
    v_mfma_f32_16x16x32_bf16 v[44:47], v[64:67], v[108:111], v[44:47]
    buffer_load_dwordx4 v4, s[52:55], s14 offen offset:0 lds
    ds_read_b128 v[168:171], v245 offset:8192
    s_waitcnt lgkmcnt(7)
    v_mfma_f32_16x16x32_bf16 v[48:51], v[64:67], v[112:115], v[48:51]
    ds_read2_b32 v[136:137], v237 offset0:80 offset1:81
    v_mfma_f32_16x16x32_bf16 v[48:51], v[68:71], v[108:111], v[48:51]
    v_mfma_f32_16x16x32_bf16 v[48:51], v[72:75], v[104:107], v[48:51]
    ds_read2_b32 v[138:139], v237 offset0:82 offset1:83
    v_mfma_f32_16x16x32_bf16 v[48:51], v[76:79], v[100:103], v[48:51]
    ds_read_b128 v[172:175], v245 offset:12288
    v_mfma_f32_16x16x32_bf16 v[48:51], v[80:83], v[96:99], v[48:51]
    ds_read2_b32 v[140:141], v237 offset0:208 offset1:209
    v_mfma_f32_16x16x32_bf16 v[52:55], v[84:87], v[96:99], v[52:55]
    ds_read2_b32 v[142:143], v237 offset0:210 offset1:211
    v_mfma_f32_16x16x32_bf16 v[52:55], v[80:83], v[100:103], v[52:55]
    ds_read_b128 v[176:179], v245 offset:16384
    v_mfma_f32_16x16x32_bf16 v[52:55], v[76:79], v[104:107], v[52:55]
    ds_read2_b32 v[144:145], v238 offset0:80 offset1:81
    v_mfma_f32_16x16x32_bf16 v[52:55], v[72:75], v[108:111], v[52:55]
    ds_read2_b32 v[146:147], v238 offset0:82 offset1:83
    v_mfma_f32_16x16x32_bf16 v[52:55], v[68:71], v[112:115], v[52:55]
    s_add_u32 m0, s73, 147456
    ds_read_b128 v[180:183], v245 offset:20480
    v_mfma_f32_16x16x32_bf16 v[52:55], v[64:67], v[116:119], v[52:55]
    buffer_load_dwordx4 v5, s[52:55], s14 offen offset:1024 lds
    ds_read2_b32 v[148:149], v238 offset0:208 offset1:209
    v_mfma_f32_16x16x32_bf16 v[56:59], v[64:67], v[120:123], v[56:59]
    ds_read2_b32 v[150:151], v238 offset0:210 offset1:211
    v_mfma_f32_16x16x32_bf16 v[56:59], v[68:71], v[116:119], v[56:59]
    ds_read_b128 v[184:187], v245 offset:24576
    v_mfma_f32_16x16x32_bf16 v[56:59], v[72:75], v[112:115], v[56:59]
    ds_read2_b32 v[152:153], v239 offset0:80 offset1:81
    v_mfma_f32_16x16x32_bf16 v[56:59], v[76:79], v[108:111], v[56:59]
    ds_read2_b32 v[154:155], v239 offset0:82 offset1:83
    v_mfma_f32_16x16x32_bf16 v[56:59], v[80:83], v[104:107], v[56:59]
    ds_read_b128 v[188:191], v245 offset:28672
    s_waitcnt vmcnt(6)
    s_barrier
    v_mfma_f32_16x16x32_bf16 v[56:59], v[84:87], v[100:103], v[56:59]
    ds_read2_b32 v[156:157], v239 offset0:208 offset1:209
    v_add_u32 v10, -131072, v10
    v_mfma_f32_16x16x32_bf16 v[56:59], v[88:91], v[96:99], v[56:59]
    ds_read_b64_tr_b16 a[208:209], v10 offset:0
    v_mfma_f32_16x16x32_bf16 v[60:63], v[92:95], v[96:99], v[60:63]
    ds_read_b64_tr_b16 a[210:211], v10 offset:2048
    v_mfma_f32_16x16x32_bf16 v[60:63], v[88:91], v[100:103], v[60:63]
    ds_read_b64_tr_b16 a[216:217], v10 offset:4096
    v_mfma_f32_16x16x32_bf16 v[60:63], v[84:87], v[104:107], v[60:63]
    ds_read2_b32 v[158:159], v239 offset0:210 offset1:211
    v_mfma_f32_16x16x32_bf16 v[60:63], v[80:83], v[108:111], v[60:63]
    ds_read_b64_tr_b16 a[218:219], v10 offset:6144
    s_add_u32 m0, s73, 147456
    v_mfma_f32_16x16x32_bf16 v[60:63], v[76:79], v[112:115], v[60:63]
    v_add_u32 v11, -131072, v11
    buffer_load_dwordx4 v6, s[52:55], s14 offen offset:2048 lds
    v_mfma_f32_16x16x32_bf16 v[60:63], v[72:75], v[116:119], v[60:63]
    ds_read_b64_tr_b16 a[212:213], v11 offset:0
    v_mfma_f32_16x16x32_bf16 v[60:63], v[68:71], v[120:123], v[60:63]
    ds_read_b64_tr_b16 a[214:215], v11 offset:2048
    v_mfma_f32_16x16x32_bf16 v[60:63], v[64:67], v[124:127], v[60:63]
    ds_read_b64_tr_b16 a[220:221], v11 offset:4096
    s_waitcnt lgkmcnt(15)
    v_mfma_f32_16x16x32_bf16 v[32:35], v[128:131], v[160:163], v[32:35]
    ds_read_b64_tr_b16 a[222:223], v11 offset:6144
    v_mfma_f32_16x16x32_bf16 v[36:39], v[132:135], v[160:163], v[36:39]
    ds_read_b128 v[96:99], v246 offset:0
    v_mfma_f32_16x16x32_bf16 v[36:39], v[128:131], v[164:167], v[36:39]
    ds_read2_b32 v[64:65], v236 offset0:96 offset1:97
    v_mfma_f32_16x16x32_bf16 v[40:43], v[128:131], v[168:171], v[40:43]
    ds_read2_b32 v[66:67], v236 offset0:98 offset1:99
    v_mfma_f32_16x16x32_bf16 v[40:43], v[132:135], v[164:167], v[40:43]
    v_mfma_f32_16x16x32_bf16 v[40:43], v[136:139], v[160:163], v[40:43]
    ds_read_b128 v[100:103], v246 offset:4096
    v_mfma_f32_16x16x32_bf16 v[44:47], v[140:143], v[160:163], v[44:47]
    ds_read2_b32 v[68:69], v236 offset0:224 offset1:225
    v_mfma_f32_16x16x32_bf16 v[44:47], v[136:139], v[164:167], v[44:47]
    s_add_u32 m0, s73, 147456
    v_mfma_f32_16x16x32_bf16 v[44:47], v[132:135], v[168:171], v[44:47]
    buffer_load_dwordx4 v7, s[52:55], s14 offen offset:3072 lds
    ds_read2_b32 v[70:71], v236 offset0:226 offset1:227
    v_mfma_f32_16x16x32_bf16 v[44:47], v[128:131], v[172:175], v[44:47]
    ds_read_b128 v[104:107], v246 offset:8192
    s_waitcnt lgkmcnt(12)
    v_mfma_f32_16x16x32_bf16 v[48:51], v[128:131], v[176:179], v[48:51]
    ds_read2_b32 v[72:73], v237 offset0:96 offset1:97
    v_mfma_f32_16x16x32_bf16 v[48:51], v[132:135], v[172:175], v[48:51]
    v_mfma_f32_16x16x32_bf16 v[48:51], v[136:139], v[168:171], v[48:51]
    ds_read2_b32 v[74:75], v237 offset0:98 offset1:99
    v_mfma_f32_16x16x32_bf16 v[48:51], v[140:143], v[164:167], v[48:51]
    ds_read_b128 v[108:111], v246 offset:12288
    v_mfma_f32_16x16x32_bf16 v[48:51], v[144:147], v[160:163], v[48:51]
    s_waitcnt lgkmcnt(10)
    s_barrier
    v_mfma_f32_16x16x32_bf16 v[52:55], v[148:151], v[160:163], v[52:55]
    ds_read2_b32 v[76:77], v237 offset0:224 offset1:225
    v_mfma_f32_16x16x32_bf16 v[52:55], v[144:147], v[164:167], v[52:55]
    ds_read2_b32 v[78:79], v237 offset0:226 offset1:227
    v_mfma_f32_16x16x32_bf16 v[52:55], v[140:143], v[168:171], v[52:55]
    v_mfma_f32_16x16x32_bf16 v[52:55], v[136:139], v[172:175], v[52:55]
    s_lshl_b32 s14, s100, 18
    ds_read_b128 v[112:115], v246 offset:16384
    v_mfma_f32_16x16x32_bf16 v[52:55], v[132:135], v[176:179], v[52:55]
    s_add_u32 m0, s73, 0
    ds_read2_b32 v[80:81], v238 offset0:96 offset1:97
    v_mfma_f32_16x16x32_bf16 v[52:55], v[128:131], v[180:183], v[52:55]
    buffer_load_dwordx4 v4, s[52:55], s14 offen offset:0 lds
    v_mfma_f32_16x16x32_bf16 v[56:59], v[128:131], v[184:187], v[56:59]
    ds_read2_b32 v[82:83], v238 offset0:98 offset1:99
    v_mfma_f32_16x16x32_bf16 v[56:59], v[132:135], v[180:183], v[56:59]
    ds_read_b128 v[116:119], v246 offset:20480
    v_mfma_f32_16x16x32_bf16 v[56:59], v[136:139], v[176:179], v[56:59]
    v_mfma_f32_16x16x32_bf16 v[56:59], v[140:143], v[172:175], v[56:59]
    ds_read2_b32 v[84:85], v238 offset0:224 offset1:225
    v_mfma_f32_16x16x32_bf16 v[56:59], v[144:147], v[168:171], v[56:59]
    ds_read2_b32 v[86:87], v238 offset0:226 offset1:227
    v_mfma_f32_16x16x32_bf16 v[56:59], v[148:151], v[164:167], v[56:59]
    ds_read_b128 v[120:123], v246 offset:24576
    v_mfma_f32_16x16x32_bf16 v[56:59], v[152:155], v[160:163], v[56:59]
    v_mfma_f32_16x16x32_bf16 v[60:63], v[156:159], v[160:163], v[60:63]
    ds_read2_b32 v[88:89], v239 offset0:96 offset1:97
    v_mfma_f32_16x16x32_bf16 v[60:63], v[152:155], v[164:167], v[60:63]
    s_add_u32 m0, s73, 0
    ds_read2_b32 v[90:91], v239 offset0:98 offset1:99
    v_mfma_f32_16x16x32_bf16 v[60:63], v[148:151], v[168:171], v[60:63]
    buffer_load_dwordx4 v5, s[52:55], s14 offen offset:1024 lds
    v_mfma_f32_16x16x32_bf16 v[60:63], v[144:147], v[172:175], v[60:63]
    ds_read_b128 v[124:127], v246 offset:28672
    v_mfma_f32_16x16x32_bf16 v[60:63], v[140:143], v[176:179], v[60:63]
    ds_read2_b32 v[92:93], v239 offset0:224 offset1:225
    v_mfma_f32_16x16x32_bf16 v[60:63], v[136:139], v[180:183], v[60:63]
    v_mfma_f32_16x16x32_bf16 v[60:63], v[132:135], v[184:187], v[60:63]
    ds_read2_b32 v[94:95], v239 offset0:226 offset1:227
    v_mfma_f32_16x16x32_bf16 v[60:63], v[128:131], v[188:191], v[60:63]
    s_waitcnt lgkmcnt(12)
    v_mfma_f32_16x16x32_bf16 v[32:35], v[64:67], v[96:99], v[32:35]
    ds_read_b128 v[160:163], v247 offset:0
    s_waitcnt vmcnt(6)
    s_barrier
    v_mfma_f32_16x16x32_bf16 v[36:39], v[68:71], v[96:99], v[36:39]
    ds_read_b64_tr_b16 a[224:225], v10 offset:16384
    s_bfe_u32 s4, s2, 0x20003
    v_mfma_f32_16x16x32_bf16 v[36:39], v[64:67], v[100:103], v[36:39]
    ds_read_b64_tr_b16 a[226:227], v10 offset:18432
    ds_read_b128 v[164:167], v247 offset:4096
    v_mfma_f32_16x16x32_bf16 v[40:43], v[64:67], v[104:107], v[40:43]
    s_lshl2_add_u32 s4, s72, s4
    ds_read_b128 v[168:171], v247 offset:8192
    v_mfma_f32_16x16x32_bf16 v[40:43], v[68:71], v[100:103], v[40:43]
    ds_read_b64_tr_b16 a[232:233], v10 offset:20480
    s_add_u32 m0, s73, 0
    ds_read_b128 v[172:175], v247 offset:12288
    v_mfma_f32_16x16x32_bf16 v[40:43], v[72:75], v[96:99], v[40:43]
    ds_read_b64_tr_b16 a[234:235], v10 offset:22528
    buffer_load_dwordx4 v6, s[52:55], s14 offen offset:2048 lds
    s_lshl_b32 s4, s4, 3
    v_mfma_f32_16x16x32_bf16 v[44:47], v[76:79], v[96:99], v[44:47]
    ds_read_b128 v[176:179], v247 offset:16384
    v_mfma_f32_16x16x32_bf16 v[44:47], v[72:75], v[100:103], v[44:47]
    ds_read_b64_tr_b16 a[228:229], v11 offset:16384
    s_lshr_b32 s5, s2, 4
    ds_read_b128 v[180:183], v247 offset:20480
    v_mfma_f32_16x16x32_bf16 v[44:47], v[68:71], v[104:107], v[44:47]
    ds_read_b64_tr_b16 a[230:231], v11 offset:18432
    v_mfma_f32_16x16x32_bf16 v[44:47], v[64:67], v[108:111], v[44:47]
    s_and_b32 s5, s5, 6
    ds_read_b128 v[184:187], v247 offset:24576
    s_waitcnt lgkmcnt(13)
    v_mfma_f32_16x16x32_bf16 v[48:51], v[64:67], v[112:115], v[48:51]
    ds_read_b64_tr_b16 a[236:237], v11 offset:20480
    ds_read_b128 v[188:191], v247 offset:28672
    v_mfma_f32_16x16x32_bf16 v[48:51], v[68:71], v[108:111], v[48:51]
    ds_read_b64_tr_b16 a[238:239], v11 offset:22528
    s_add_u32 s4, s4, s5
    v_mfma_f32_16x16x32_bf16 v[48:51], v[72:75], v[104:107], v[48:51]
    ds_read2_b32 v[128:129], v236 offset0:112 offset1:113
    v_mfma_f32_16x16x32_bf16 v[48:51], v[76:79], v[100:103], v[48:51]
    s_and_b32 s5, s2, 1
    ds_read2_b32 v[130:131], v236 offset0:114 offset1:115
    v_mfma_f32_16x16x32_bf16 v[48:51], v[80:83], v[96:99], v[48:51]
    ds_read2_b32 v[132:133], v236 offset0:240 offset1:241
    v_mfma_f32_16x16x32_bf16 v[52:55], v[84:87], v[96:99], v[52:55]
    s_add_u32 m0, s73, 0
    ds_read2_b32 v[134:135], v236 offset0:242 offset1:243
    s_add_u32 s4, s4, s5
    v_mfma_f32_16x16x32_bf16 v[52:55], v[80:83], v[100:103], v[52:55]
    buffer_load_dwordx4 v7, s[52:55], s14 offen offset:3072 lds
    ds_read2_b32 v[136:137], v237 offset0:112 offset1:113
    v_mfma_f32_16x16x32_bf16 v[52:55], v[76:79], v[104:107], v[52:55]
    s_lshl_b32 s4, s4, 7
    ds_read2_b32 v[138:139], v237 offset0:114 offset1:115
    v_mfma_f32_16x16x32_bf16 v[52:55], v[72:75], v[108:111], v[52:55]
    s_add_u32 s4, s4, 12566528
    ds_read2_b32 v[140:141], v237 offset0:240 offset1:241
    s_add_u32 s6, s12, 4767744
    v_mfma_f32_16x16x32_bf16 v[52:55], v[68:71], v[112:115], v[52:55]
    ds_read2_b32 v[142:143], v237 offset0:242 offset1:243
    v_mfma_f32_16x16x32_bf16 v[52:55], v[64:67], v[116:119], v[52:55]
    ds_read2_b32 v[144:145], v238 offset0:112 offset1:113
    v_lshl_add_u32 v28, v2, 2, s4
    v_mfma_f32_16x16x32_bf16 v[56:59], v[64:67], v[120:123], v[56:59]
    s_waitcnt lgkmcnt(9)
    s_barrier
    v_mfma_f32_16x16x32_bf16 v[56:59], v[68:71], v[116:119], v[56:59]
    ds_read2_b32 v[146:147], v238 offset0:114 offset1:115
    s_cmp_eq_u32 s3, 0
    s_cselect_b32 s4, 18, 0
    v_mfma_f32_16x16x32_bf16 v[56:59], v[72:75], v[112:115], v[56:59]
    ds_read2_b32 v[148:149], v238 offset0:240 offset1:241
    v_mfma_f32_16x16x32_bf16 v[56:59], v[76:79], v[108:111], v[56:59]
    ds_read2_b32 v[150:151], v238 offset0:242 offset1:243
    v_cmp_gt_u32 vcc, s4, v2
    v_mfma_f32_16x16x32_bf16 v[56:59], v[80:83], v[104:107], v[56:59]
    s_lshl_b32 s14, s101, 18
    ds_read2_b32 v[152:153], v239 offset0:112 offset1:113
    v_mfma_f32_16x16x32_bf16 v[56:59], v[84:87], v[100:103], v[56:59]
    ds_read2_b32 v[154:155], v239 offset0:114 offset1:115
    s_add_u32 m0, s73, 16384
    v_mov_b32 v13, 0x40000000
    v_mfma_f32_16x16x32_bf16 v[56:59], v[88:91], v[96:99], v[56:59]
    buffer_load_dwordx4 v4, s[52:55], s14 offen offset:0 lds
    ds_read2_b32 v[156:157], v239 offset0:240 offset1:241
    v_mfma_f32_16x16x32_bf16 v[60:63], v[92:95], v[96:99], v[60:63]
    ds_read2_b32 v[158:159], v239 offset0:242 offset1:243
    v_cndmask_b32 v28, v13, v28, vcc
    v_mfma_f32_16x16x32_bf16 v[60:63], v[88:91], v[100:103], v[60:63]
    v_mfma_f32_16x16x32_bf16 v[60:63], v[84:87], v[104:107], v[60:63]
    v_mov_b32 v13, s68
    v_mfma_f32_16x16x32_bf16 v[60:63], v[80:83], v[108:111], v[60:63]
    v_mfma_f32_16x16x32_bf16 v[60:63], v[76:79], v[112:115], v[60:63]
    v_cndmask_b32 v13, 0, v13, vcc
    v_mfma_f32_16x16x32_bf16 v[60:63], v[72:75], v[116:119], v[60:63]
    v_mfma_f32_16x16x32_bf16 v[60:63], v[68:71], v[120:123], v[60:63]
    v_mfma_f32_16x16x32_bf16 v[60:63], v[64:67], v[124:127], v[60:63]
    s_waitcnt lgkmcnt(0)
    v_mfma_f32_16x16x32_bf16 v[60:63], v[128:131], v[188:191], v[60:63]
    v_mfma_f32_16x16x32_bf16 v[60:63], v[132:135], v[184:187], v[60:63]
    s_add_u32 m0, s73, 16384
    v_mfma_f32_16x16x32_bf16 v[60:63], v[136:139], v[180:183], v[60:63]
    buffer_load_dwordx4 v5, s[52:55], s14 offen offset:1024 lds
    v_mfma_f32_16x16x32_bf16 v[60:63], v[140:143], v[176:179], v[60:63]
    v_mfma_f32_16x16x32_bf16 v[60:63], v[144:147], v[172:175], v[60:63]
    v_mfma_f32_16x16x32_bf16 v[60:63], v[148:151], v[168:171], v[60:63]
    v_mfma_f32_16x16x32_bf16 v[60:63], v[152:155], v[164:167], v[60:63]
    v_mfma_f32_16x16x32_bf16 v[60:63], v[156:159], v[160:163], v[60:63]
    v_mfma_f32_16x16x32_bf16 v[56:59], v[128:131], v[184:187], v[56:59]
    v_mfma_f32_16x16x32_bf16 v[56:59], v[132:135], v[180:183], v[56:59]
    v_mfma_f32_16x16x32_bf16 v[56:59], v[136:139], v[176:179], v[56:59]
    v_mfma_f32_16x16x32_bf16 v[56:59], v[140:143], v[172:175], v[56:59]
    s_add_u32 m0, s73, 16384
    v_mfma_f32_16x16x32_bf16 v[56:59], v[144:147], v[168:171], v[56:59]
    buffer_load_dwordx4 v6, s[52:55], s14 offen offset:2048 lds
    v_mfma_f32_16x16x32_bf16 v[56:59], v[148:151], v[164:167], v[56:59]
    v_cvt_pk_bf16_f32 v206, v60, v61
    v_mfma_f32_16x16x32_bf16 v[56:59], v[152:155], v[160:163], v[56:59]
    s_waitcnt vmcnt(7)
    s_barrier
    v_mfma_f32_16x16x32_bf16 v[52:55], v[128:131], v[180:183], v[52:55]
    v_add_u32 v10, 131072, v10
    v_mfma_f32_16x16x32_bf16 v[52:55], v[132:135], v[176:179], v[52:55]
    ds_read_b64_tr_b16 a[240:241], v10 offset:16384
    v_cvt_pk_bf16_f32 v207, v62, v63
    v_mfma_f32_16x16x32_bf16 v[52:55], v[136:139], v[172:175], v[52:55]
    ds_read_b64_tr_b16 a[242:243], v10 offset:18432
    v_mfma_f32_16x16x32_bf16 v[52:55], v[140:143], v[168:171], v[52:55]
    buffer_store_dwordx2 v[206:207], v8, s[44:47], s6 offen offset:3584 sc1
    v_mfma_f32_16x16x32_bf16 v[52:55], v[144:147], v[164:167], v[52:55]
    ds_read_b64_tr_b16 a[248:249], v10 offset:20480
    v_mfma_f32_16x16x32_bf16 v[52:55], v[148:151], v[160:163], v[52:55]
    ds_read_b64_tr_b16 a[250:251], v10 offset:22528
    v_mfma_f32_16x16x32_bf16 v[48:51], v[128:131], v[176:179], v[48:51]
    v_add_u32 v11, 131072, v11
    v_cvt_pk_bf16_f32 v204, v56, v57
    v_mfma_f32_16x16x32_bf16 v[48:51], v[132:135], v[172:175], v[48:51]
    ds_read_b64_tr_b16 a[244:245], v11 offset:16384
    s_add_u32 m0, s73, 16384
    v_mfma_f32_16x16x32_bf16 v[48:51], v[136:139], v[168:171], v[48:51]
    ds_read_b64_tr_b16 a[246:247], v11 offset:18432
    buffer_load_dwordx4 v7, s[52:55], s14 offen offset:3072 lds
    v_mfma_f32_16x16x32_bf16 v[48:51], v[140:143], v[164:167], v[48:51]
    v_cvt_pk_bf16_f32 v205, v58, v59
    v_mfma_f32_16x16x32_bf16 v[48:51], v[144:147], v[160:163], v[48:51]
L_pl_X_6:
    s_cbranch_execz L_wret
    ds_read_b64_tr_b16 a[252:253], v11 offset:20480
    v_mfma_f32_16x16x32_bf16 v[44:47], v[128:131], v[172:175], v[44:47]
    buffer_store_dwordx2 v[204:205], v8, s[44:47], s6 offen offset:3072 sc1
    ds_read_b64_tr_b16 a[254:255], v11 offset:22528
    v_mfma_f32_16x16x32_bf16 v[44:47], v[132:135], v[168:171], v[44:47]
    v_mfma_f32_16x16x32_bf16 v[44:47], v[136:139], v[164:167], v[44:47]
    v_mfma_f32_16x16x32_bf16 v[44:47], v[140:143], v[160:163], v[44:47]
    v_cvt_pk_bf16_f32 v202, v52, v53
    v_mfma_f32_16x16x32_bf16 v[40:43], v[128:131], v[168:171], v[40:43]
    v_mfma_f32_16x16x32_bf16 v[40:43], v[132:135], v[164:167], v[40:43]
    v_mfma_f32_16x16x32_bf16 v[40:43], v[136:139], v[160:163], v[40:43]
    v_cvt_pk_bf16_f32 v203, v54, v55
    v_mfma_f32_16x16x32_bf16 v[36:39], v[128:131], v[164:167], v[36:39]
    v_mfma_f32_16x16x32_bf16 v[36:39], v[132:135], v[160:163], v[36:39]
    buffer_store_dwordx2 v[202:203], v8, s[44:47], s6 offen offset:2560 sc1
    v_mfma_f32_16x16x32_bf16 v[32:35], v[128:131], v[160:163], v[32:35]
    v_mov_b32 v29, 0
    buffer_atomic_add v29, v28, s[44:47], 0 offen sc0 sc1
    v_cvt_pk_bf16_f32 v200, v48, v49
    v_cvt_pk_bf16_f32 v201, v50, v51
    buffer_store_dwordx2 v[200:201], v8, s[44:47], s6 offen offset:2048 sc1
    v_cvt_pk_bf16_f32 v198, v44, v45
    v_cvt_pk_bf16_f32 v199, v46, v47
    buffer_store_dwordx2 v[198:199], v8, s[44:47], s6 offen offset:1536 sc1
    v_cvt_pk_bf16_f32 v196, v40, v41
    v_cvt_pk_bf16_f32 v197, v42, v43
    buffer_store_dwordx2 v[196:197], v8, s[44:47], s6 offen offset:1024 sc1
    v_cvt_pk_bf16_f32 v194, v36, v37
    v_cvt_pk_bf16_f32 v195, v38, v39
    buffer_store_dwordx2 v[194:195], v8, s[44:47], s6 offen offset:512 sc1
    v_cvt_pk_bf16_f32 v192, v32, v33
    v_cvt_pk_bf16_f32 v193, v34, v35
    buffer_store_dwordx2 v[192:193], v8, s[44:47], s6 offen offset:0 sc1
    v_add_u32 v10, -131072, v10
    v_add_u32 v11, -131072, v11
    s_waitcnt lgkmcnt(0)
    s_barrier
L_DX:
    s_waitcnt vmcnt(0)
    v_cmp_ne_u32 vcc, v13, v29
    s_cbranch_vccnz L_rs_p2X
L_ok_p2X:
    s_barrier
    s_add_u32 m0, s73, 97536
    s_nop 0
    buffer_load_dwordx4 v23, s[44:47], s18 offen offset:768 sc1 lds
    s_add_u32 m0, s73, 99328
    s_nop 0
    buffer_load_dwordx4 v20, s[44:47], s18 offen offset:0 sc1 lds
    s_add_u32 m0, s73, 99840
    s_nop 0
    buffer_load_dwordx4 v20, s[44:47], s18 offen offset:512 sc1 lds
    s_add_u32 m0, s73, 100608
    s_nop 0
    buffer_load_dwordx4 v23, s[44:47], s19 offen offset:768 sc1 lds
    s_add_u32 m0, s73, 114688
    s_nop 0
    buffer_load_dwordx4 v20, s[44:47], s19 offen offset:0 sc1 lds
    s_add_u32 m0, s73, 115200
    s_nop 0
    buffer_load_dwordx4 v20, s[44:47], s19 offen offset:512 sc1 lds
    s_add_u32 m0, s73, 115968
    s_nop 0
    buffer_load_dwordx4 v23, s[44:47], s20 offen offset:768 sc1 lds
    s_add_u32 m0, s73, 117760
    s_nop 0
    buffer_load_dwordx4 v20, s[44:47], s20 offen offset:0 sc1 lds
    s_mov_b32 s56, s16
    s_and_b32 s57, s17, 0xffff
    s_mov_b32 s58, 2359296
    s_mov_b32 s59, 0x20000
    s_mov_b32 s40, 18432
    s_mov_b32 s42, 12386304
    s_mov_b32 s64, s38
    s_and_b32 s65, s39, 0xffff
    s_mov_b32 s66, 2359296
    s_mov_b32 s67, 0x20000
    v_lshlrev_b32 v136, 4, v2
    s_mul_i32 s7, s72, 36
    s_bitcmp1_b32 s3, 0
    s_addc_u32 s7, s7, 0
    s_lshl_b32 s7, s7, 17
    v_subrev_u32 v184, s7, v4
    v_subrev_u32 v185, s7, v5
    s_bfe_u32 s4, s2, 0x20003
    s_mul_i32 s4, s4, 9
    s_lshl1_add_u32 s7, s72, s4
    s_and_b32 s8, s3, 1
    s_add_u32 s7, s7, s8
    s_lshl_b32 s37, s7, 16
    s_add_u32 s37, s37, 4718592
    s_add_u32 s4, s4, 8
    s_lshl_b32 s16, s4, 16
    s_add_u32 s16, s16, 4718592
    s_sub_u32 s4, s4, s7
    s_lshl_b32 s4, s4, 7
    s_lshl_b32 s7, s7, 7
    s_add_u32 s7, s7, 12582912
    v_bfe_u32 v24, v2, 2, 1
    v_mul_u32_u24 v24, s4, v24
    v_and_b32 v25, 3, v2
    v_lshl_add_u32 v24, v25, 2, v24
    v_add_u32 v188, s7, v24
    s_lshl2_add_u32 s7, s2, s3
    s_mul_i32 s8, s7, 3072
    s_add_u32 s34, s8, 22953984
    s_add_u32 s11, s8, 26099712
    s_add_u32 s12, s8, 29245440
    s_lshl_b32 s35, s7, 12
    s_add_u32 s35, s35, 32391168
    s_xor_b32 s8, s7, 8
    s_mul_i32 s8, s8, 3072
    s_add_u32 s30, s8, 22953984
    s_xor_b32 s8, s7, 16
    s_mul_i32 s8, s8, 3072
    s_add_u32 s15, s8, 26099712
    s_xor_b32 s8, s7, 24
    s_mul_i32 s8, s8, 3072
    s_add_u32 s31, s8, 29245440
    s_andn2_b32 s7, s7, 24
    s_lshl3_add_u32 s7, s3, s7
    s_lshl2_add_u32 s8, s7, s72
    s_lshl_b32 s8, s8, 10
    s_add_u32 s32, s8, 32391168
    s_xor_b32 s8, s8, 4096
    s_add_u32 s33, s8, 32391168
    s_xor_b32 s8, s3, s72
    s_cmp_lt_u32 s8, 2
    s_cselect_b32 s35, s35, 0x40000000
    s_cselect_b32 s16, s16, 0x40000000
    s_cselect_b32 s36, s68, 0
    s_mov_b32 s38, 0xbfb8aa3b
    s_and_b32 s8, s8, 1
    s_mul_i32 s41, s8, 96
    s_and_b32 s43, s73, 4096
    v_lshlrev_b32 v24, 10, v2
    v_add_u32 v24, s35, v24
    s_add_u32 s7, s34, 2048
    v_mov_b32 v25, s36
    v_cmp_gt_u32 vcc, 4, v2
    s_nop 1
    v_cndmask_b32 v138, 0, v25, vcc
    v_mov_b32 v25, 0x40000000
    v_cndmask_b32 v137, v25, v24, vcc
    v_writelane_b32 v137, s7, 4
    v_writelane_b32 v138, s68, 4
    v_min_u32 v139, 1, v2
    v_lshlrev_b32 v139, 30, v139
    v_mov_b32 v140, 0
    v_writelane_b32 v140, s68, 0
    v_mov_b32 v195, s68
    v_mov_b32 v199, s68
    v_mov_b32 v202, s68
    v_mov_b32 v203, s68
    s_waitcnt vmcnt(4)
    s_barrier
    ds_read_b128 v[104:107], v14 offset:0
    ds_read_b128 v[108:111], v14 offset:4096
    ds_read_b128 v[112:115], v14 offset:8192
    ds_read_b128 v[116:119], v14 offset:12288
    s_waitcnt lgkmcnt(2)
    v_mfma_f32_16x16x32_bf16 v[32:35], v[104:107], a[0:3], 0
    s_add_u32 m0, s73, 130560
    s_sub_u32 s4, s75, 216
    s_lshl_b32 s7, s4, 7
    v_mfma_f32_16x16x32_bf16 v[32:35], v[108:111], a[8:11], v[32:35]
    buffer_load_dwordx4 v20, s[44:47], s20 offen offset:512 sc1 lds
    s_waitcnt lgkmcnt(0)
    v_mfma_f32_16x16x32_bf16 v[32:35], v[112:115], a[16:19], v[32:35]
    ds_read_b128 v[120:123], v14 offset:1024
    s_lshl2_add_u32 s7, s3, s7
    s_add_u32 s7, s7, 12582912
    v_mfma_f32_16x16x32_bf16 v[32:35], v[116:119], a[24:27], v[32:35]
    ds_read_b128 v[124:127], v14 offset:5120
    v_mfma_f32_16x16x32_bf16 v[36:39], v[116:119], a[28:31], 0
    ds_read_b128 v[128:131], v14 offset:9216
    s_cmp_lt_u32 s4, 36
    s_cselect_b32 s7, s7, 0x40000000
    v_mfma_f32_16x16x32_bf16 v[36:39], v[112:115], a[20:23], v[36:39]
    ds_read_b128 v[132:135], v14 offset:13312
    v_min_u32 v28, 1, v2
    v_mfma_f32_16x16x32_bf16 v[36:39], v[108:111], a[12:15], v[36:39]
    s_add_u32 m0, s73, 131328
    v_lshlrev_b32 v28, 30, v28
    v_mov_b32 v29, s68
    v_mfma_f32_16x16x32_bf16 v[36:39], v[104:107], a[4:7], v[36:39]
    buffer_load_dwordx4 v23, s[44:47], s21 offen offset:768 sc1 lds
    s_waitcnt lgkmcnt(2)
    v_mfma_f32_16x16x32_bf16 v[44:47], v[120:123], a[4:7], 0
    buffer_store_dword v29, v28, s[44:47], s7 offen sc1
    s_add_u32 m0, s73, 133120
    v_mfma_f32_16x16x32_bf16 v[44:47], v[124:127], a[12:15], v[44:47]
    buffer_load_dwordx4 v20, s[44:47], s21 offen offset:0 sc1 lds
    s_waitcnt lgkmcnt(0)
    v_mfma_f32_16x16x32_bf16 v[44:47], v[128:131], a[20:23], v[44:47]
    ds_read_b128 v[104:107], v14 offset:2048
    v_mfma_f32_16x16x32_bf16 v[44:47], v[132:135], a[28:31], v[44:47]
    ds_read_b128 v[108:111], v14 offset:6144
    v_mfma_f32_16x16x32_bf16 v[40:43], v[132:135], a[24:27], 0
    ds_read_b128 v[112:115], v14 offset:10240
    v_mfma_f32_16x16x32_bf16 v[40:43], v[128:131], a[16:19], v[40:43]
    ds_read_b128 v[116:119], v14 offset:14336
    v_mfma_f32_16x16x32_bf16 v[40:43], v[124:127], a[8:11], v[40:43]
    s_add_u32 m0, s73, 133632
    v_mfma_f32_16x16x32_bf16 v[40:43], v[120:123], a[0:3], v[40:43]
    buffer_load_dwordx4 v20, s[44:47], s21 offen offset:512 sc1 lds
    s_waitcnt lgkmcnt(2)
    v_mfma_f32_16x16x32_bf16 v[48:51], v[104:107], a[0:3], 0
    s_add_u32 m0, s73, 146688
    v_mfma_f32_16x16x32_bf16 v[48:51], v[108:111], a[8:11], v[48:51]
    buffer_load_dwordx4 v23, s[44:47], s22 offen offset:768 sc1 lds
    s_waitcnt lgkmcnt(0)
    v_mfma_f32_16x16x32_bf16 v[48:51], v[112:115], a[16:19], v[48:51]
    ds_read_b128 v[120:123], v14 offset:3072
    v_mfma_f32_16x16x32_bf16 v[48:51], v[116:119], a[24:27], v[48:51]
    ds_read_b128 v[124:127], v14 offset:7168
    v_mfma_f32_16x16x32_bf16 v[52:55], v[116:119], a[28:31], 0
    ds_read_b128 v[128:131], v14 offset:11264
    v_mfma_f32_16x16x32_bf16 v[52:55], v[112:115], a[20:23], v[52:55]
    ds_read_b128 v[132:135], v14 offset:15360
    v_mfma_f32_16x16x32_bf16 v[52:55], v[108:111], a[12:15], v[52:55]
    s_add_u32 m0, s73, 148480
    v_mfma_f32_16x16x32_bf16 v[52:55], v[104:107], a[4:7], v[52:55]
    buffer_load_dwordx4 v20, s[44:47], s22 offen offset:0 sc1 lds
    s_waitcnt lgkmcnt(2)
    v_mfma_f32_16x16x32_bf16 v[36:39], v[120:123], a[36:39], v[36:39]
    s_add_u32 m0, s73, 148992
    v_mfma_f32_16x16x32_bf16 v[36:39], v[124:127], a[44:47], v[36:39]
    buffer_load_dwordx4 v20, s[44:47], s22 offen offset:512 sc1 lds
    s_waitcnt lgkmcnt(0)
    v_mfma_f32_16x16x32_bf16 v[36:39], v[128:131], a[52:55], v[36:39]
    s_waitcnt vmcnt(8)
    s_barrier
    v_mfma_f32_16x16x32_bf16 v[36:39], v[132:135], a[60:63], v[36:39]
    ds_read_b128 v[104:107], v14 offset:16384
    v_mfma_f32_16x16x32_bf16 v[32:35], v[132:135], a[56:59], v[32:35]
    ds_read_b128 v[108:111], v14 offset:20480
    v_mfma_f32_16x16x32_bf16 v[32:35], v[128:131], a[48:51], v[32:35]
    ds_read_b128 v[112:115], v14 offset:24576
    v_mfma_f32_16x16x32_bf16 v[32:35], v[124:127], a[40:43], v[32:35]
    ds_read_b128 v[116:119], v14 offset:28672
    s_add_u32 m0, s73, 149760
    v_mfma_f32_16x16x32_bf16 v[32:35], v[120:123], a[32:35], v[32:35]
    buffer_load_dwordx4 v23, s[44:47], s23 offen offset:768 sc1 lds
    ds_read_b64_tr_b16 v[220:221], v10 offset:0
    s_waitcnt lgkmcnt(3)
    v_mfma_f32_16x16x32_bf16 v[40:43], v[104:107], a[32:35], v[40:43]
    s_add_u32 m0, s73, 98304
    ds_read_b64_tr_b16 v[222:223], v10 offset:2048
    v_mfma_f32_16x16x32_bf16 v[40:43], v[108:111], a[40:43], v[40:43]
    buffer_load_dwordx4 v20, s[44:47], s23 offen offset:0 sc1 lds
    s_waitcnt lgkmcnt(2)
    v_mfma_f32_16x16x32_bf16 v[40:43], v[112:115], a[48:51], v[40:43]
    ds_read_b128 v[120:123], v14 offset:17408
    v_mfma_f32_16x16x32_bf16 v[40:43], v[116:119], a[56:59], v[40:43]
    ds_read_b128 v[124:127], v14 offset:21504
    v_mfma_f32_16x16x32_bf16 v[44:47], v[116:119], a[60:63], v[44:47]
    ds_read_b128 v[128:131], v14 offset:25600
    v_mfma_f32_16x16x32_bf16 v[44:47], v[112:115], a[52:55], v[44:47]
    ds_read_b128 v[132:135], v14 offset:29696
    v_mfma_f32_16x16x32_bf16 v[44:47], v[108:111], a[44:47], v[44:47]
    s_add_u32 m0, s73, 98816
    ds_read_b64_tr_b16 v[228:229], v10 offset:4096
    v_mfma_f32_16x16x32_bf16 v[44:47], v[104:107], a[36:39], v[44:47]
    buffer_load_dwordx4 v20, s[44:47], s23 offen offset:512 sc1 lds
    s_waitcnt lgkmcnt(3)
    v_mfma_f32_16x16x32_bf16 v[52:55], v[120:123], a[36:39], v[52:55]
    s_add_u32 m0, s73, 99584
    ds_read_b64_tr_b16 v[230:231], v10 offset:6144
    v_mfma_f32_16x16x32_bf16 v[52:55], v[124:127], a[44:47], v[52:55]
    buffer_load_dwordx4 v23, s[44:47], s24 offen offset:768 sc1 lds
    s_waitcnt lgkmcnt(2)
    v_mfma_f32_16x16x32_bf16 v[52:55], v[128:131], a[52:55], v[52:55]
    ds_read_b128 v[104:107], v14 offset:18432
    v_mfma_f32_16x16x32_bf16 v[52:55], v[132:135], a[60:63], v[52:55]
    ds_read_b128 v[108:111], v14 offset:22528
    v_mfma_f32_16x16x32_bf16 v[48:51], v[132:135], a[56:59], v[48:51]
    ds_read_b128 v[112:115], v14 offset:26624
    v_mfma_f32_16x16x32_bf16 v[48:51], v[128:131], a[48:51], v[48:51]
    ds_read_b128 v[116:119], v14 offset:30720
    v_mfma_f32_16x16x32_bf16 v[48:51], v[124:127], a[40:43], v[48:51]
    s_add_u32 m0, s73, 101376
    ds_read_b64_tr_b16 v[224:225], v11 offset:0
    v_mfma_f32_16x16x32_bf16 v[48:51], v[120:123], a[32:35], v[48:51]
    buffer_load_dwordx4 v20, s[44:47], s24 offen offset:0 sc1 lds
    s_waitcnt lgkmcnt(3)
    v_mfma_f32_16x16x32_bf16 v[32:35], v[104:107], a[64:67], v[32:35]
    ds_read_b64_tr_b16 v[226:227], v11 offset:2048
    v_mfma_f32_16x16x32_bf16 v[32:35], v[108:111], a[72:75], v[32:35]
    s_waitcnt lgkmcnt(2)
    v_mfma_f32_16x16x32_bf16 v[32:35], v[112:115], a[80:83], v[32:35]
    ds_read_b128 v[120:123], v14 offset:19456
    v_mfma_f32_16x16x32_bf16 v[32:35], v[116:119], a[88:91], v[32:35]
    ds_read_b128 v[124:127], v14 offset:23552
    v_mfma_f32_16x16x32_bf16 v[36:39], v[116:119], a[92:95], v[36:39]
    ds_read_b128 v[128:131], v14 offset:27648
    v_mfma_f32_16x16x32_bf16 v[36:39], v[112:115], a[84:87], v[36:39]
    ds_read_b128 v[132:135], v14 offset:31744
    v_mfma_f32_16x16x32_bf16 v[36:39], v[108:111], a[76:79], v[36:39]
    ds_read_b64_tr_b16 v[232:233], v11 offset:4096
    v_mfma_f32_16x16x32_bf16 v[36:39], v[104:107], a[68:71], v[36:39]
    s_waitcnt lgkmcnt(3)
    v_mfma_f32_16x16x32_bf16 v[44:47], v[120:123], a[68:71], v[44:47]
    ds_read_b64_tr_b16 v[234:235], v11 offset:6144
    v_mfma_f32_16x16x32_bf16 v[44:47], v[124:127], a[76:79], v[44:47]
    s_waitcnt lgkmcnt(2)
    v_mfma_f32_16x16x32_bf16 v[44:47], v[128:131], a[84:87], v[44:47]
    s_waitcnt vmcnt(8) lgkmcnt(0)
    s_barrier
    v_mfma_f32_16x16x32_bf16 v[44:47], v[132:135], a[92:95], v[44:47]
    ds_read_b128 v[104:107], v14 offset:32768
    v_mfma_f32_16x16x32_bf16 v[40:43], v[132:135], a[88:91], v[40:43]
    ds_read_b128 v[108:111], v14 offset:36864
    v_mfma_f32_16x16x32_bf16 v[40:43], v[128:131], a[80:83], v[40:43]
    ds_read_b128 v[112:115], v14 offset:40960
    v_mfma_f32_16x16x32_bf16 v[40:43], v[124:127], a[72:75], v[40:43]
    ds_read_b128 v[116:119], v14 offset:45056
    v_mfma_f32_16x16x32_bf16 v[40:43], v[120:123], a[64:67], v[40:43]
    ds_read_b64_tr_b16 v[236:237], v10 offset:16384
    s_waitcnt lgkmcnt(3)
    v_mfma_f32_16x16x32_bf16 v[48:51], v[104:107], a[64:67], v[48:51]
    s_add_u32 m0, s73, 114176
    ds_read_b64_tr_b16 v[238:239], v10 offset:18432
    v_mfma_f32_16x16x32_bf16 v[48:51], v[108:111], a[72:75], v[48:51]
    buffer_load_dwordx4 v20, s[44:47], s24 offen offset:512 sc1 lds
    s_waitcnt lgkmcnt(2)
    v_mfma_f32_16x16x32_bf16 v[48:51], v[112:115], a[80:83], v[48:51]
    ds_read_b128 v[120:123], v14 offset:33792
    v_mfma_f32_16x16x32_bf16 v[48:51], v[116:119], a[88:91], v[48:51]
    ds_read_b128 v[124:127], v14 offset:37888
    v_lshrrev_b32 v30, 2, v26
    v_mfma_f32_16x16x32_bf16 v[52:55], v[116:119], a[92:95], v[52:55]
    ds_read_b128 v[128:131], v14 offset:41984
    v_mfma_f32_16x16x32_bf16 v[52:55], v[112:115], a[84:87], v[52:55]
    ds_read_b128 v[132:135], v14 offset:46080
    v_mfma_f32_16x16x32_bf16 v[52:55], v[108:111], a[76:79], v[52:55]
    s_add_u32 m0, s73, 114944
    ds_read_b64_tr_b16 v[244:245], v10 offset:20480
    v_mfma_f32_16x16x32_bf16 v[52:55], v[104:107], a[68:71], v[52:55]
    buffer_load_dwordx4 v23, s[44:47], s25 offen offset:768 sc1 lds
    s_waitcnt lgkmcnt(3)
    v_mfma_f32_16x16x32_bf16 v[36:39], v[120:123], a[100:103], v[36:39]
    s_add_u32 m0, s73, 116736
    ds_read_b64_tr_b16 v[246:247], v10 offset:22528
    v_mfma_f32_16x16x32_bf16 v[36:39], v[124:127], a[108:111], v[36:39]
    buffer_load_dwordx4 v20, s[44:47], s25 offen offset:0 sc1 lds
    s_waitcnt lgkmcnt(2)
    v_mfma_f32_16x16x32_bf16 v[36:39], v[128:131], a[116:119], v[36:39]
    ds_read_b128 v[104:107], v14 offset:34816
    v_lshrrev_b32 v31, 2, v18
    v_mfma_f32_16x16x32_bf16 v[36:39], v[132:135], a[124:127], v[36:39]
    ds_read_b128 v[108:111], v14 offset:38912
    v_mfma_f32_16x16x32_bf16 v[32:35], v[132:135], a[120:123], v[32:35]
    ds_read_b128 v[112:115], v14 offset:43008
    v_mfma_f32_16x16x32_bf16 v[32:35], v[128:131], a[112:115], v[32:35]
    ds_read_b128 v[116:119], v14 offset:47104
    v_mfma_f32_16x16x32_bf16 v[32:35], v[124:127], a[104:107], v[32:35]
    s_add_u32 m0, s73, 117248
    ds_read_b64_tr_b16 v[240:241], v11 offset:16384
    v_mfma_f32_16x16x32_bf16 v[32:35], v[120:123], a[96:99], v[32:35]
    buffer_load_dwordx4 v20, s[44:47], s25 offen offset:512 sc1 lds
    s_waitcnt lgkmcnt(3)
    v_mfma_f32_16x16x32_bf16 v[40:43], v[104:107], a[96:99], v[40:43]
    ds_read_b64_tr_b16 v[242:243], v11 offset:18432
    buffer_load_ushort v102, v30, s[60:63], 0 offen offset:0
    v_mfma_f32_16x16x32_bf16 v[40:43], v[108:111], a[104:107], v[40:43]
    s_waitcnt lgkmcnt(2)
    v_mfma_f32_16x16x32_bf16 v[40:43], v[112:115], a[112:115], v[40:43]
    ds_read_b128 v[120:123], v14 offset:35840
    v_mfma_f32_16x16x32_bf16 v[40:43], v[116:119], a[120:123], v[40:43]
    ds_read_b128 v[124:127], v14 offset:39936
    v_mfma_f32_16x16x32_bf16 v[44:47], v[116:119], a[124:127], v[44:47]
    ds_read_b128 v[128:131], v14 offset:44032
    v_mfma_f32_16x16x32_bf16 v[44:47], v[112:115], a[116:119], v[44:47]
    ds_read_b128 v[132:135], v14 offset:48128
    v_mfma_f32_16x16x32_bf16 v[44:47], v[108:111], a[108:111], v[44:47]
    ds_read_b64_tr_b16 v[248:249], v11 offset:20480
    buffer_load_ushort v103, v30, s[60:63], 0 offen offset:32
    v_mfma_f32_16x16x32_bf16 v[44:47], v[104:107], a[100:103], v[44:47]
    s_waitcnt lgkmcnt(3)
    v_mfma_f32_16x16x32_bf16 v[52:55], v[120:123], a[100:103], v[52:55]
    ds_read_b64_tr_b16 v[250:251], v11 offset:22528
    v_mfma_f32_16x16x32_bf16 v[52:55], v[124:127], a[108:111], v[52:55]
    s_waitcnt lgkmcnt(2)
    v_mfma_f32_16x16x32_bf16 v[52:55], v[128:131], a[116:119], v[52:55]
    s_waitcnt vmcnt(10) lgkmcnt(0)
    s_barrier
    v_mfma_f32_16x16x32_bf16 v[52:55], v[132:135], a[124:127], v[52:55]
    ds_read_b128 v[104:107], v14 offset:49152
    v_mfma_f32_16x16x32_bf16 v[48:51], v[132:135], a[120:123], v[48:51]
    ds_read_b128 v[108:111], v14 offset:53248
    buffer_load_ushort v27, v31, s[60:63], 0 offen offset:0
    v_mfma_f32_16x16x32_bf16 v[48:51], v[128:131], a[112:115], v[48:51]
    ds_read_b128 v[112:115], v14 offset:57344
    v_mfma_f32_16x16x32_bf16 v[48:51], v[124:127], a[104:107], v[48:51]
    ds_read_b128 v[116:119], v14 offset:61440
    v_mfma_f32_16x16x32_bf16 v[48:51], v[120:123], a[96:99], v[48:51]
    s_waitcnt lgkmcnt(2)
    v_mfma_f32_16x16x32_bf16 v[32:35], v[104:107], a[128:131], v[32:35]
    s_add_u32 m0, s73, 130304
    v_mfma_f32_16x16x32_bf16 v[32:35], v[108:111], a[136:139], v[32:35]
    buffer_load_dwordx4 v23, s[44:47], s26 offen offset:768 sc1 lds
    s_waitcnt lgkmcnt(0)
    v_mfma_f32_16x16x32_bf16 v[32:35], v[112:115], a[144:147], v[32:35]
    ds_read_b128 v[120:123], v14 offset:50176
    v_mfma_f32_16x16x32_bf16 v[32:35], v[116:119], a[152:155], v[32:35]
    ds_read_b128 v[124:127], v14 offset:54272
    v_mfma_f32_16x16x32_bf16 v[36:39], v[116:119], a[156:159], v[36:39]
    ds_read_b128 v[128:131], v14 offset:58368
    v_mfma_f32_16x16x32_bf16 v[36:39], v[112:115], a[148:151], v[36:39]
    ds_read_b128 v[132:135], v14 offset:62464
    v_mfma_f32_16x16x32_bf16 v[36:39], v[108:111], a[140:143], v[36:39]
    s_add_u32 m0, s73, 132096
    v_mfma_f32_16x16x32_bf16 v[36:39], v[104:107], a[132:135], v[36:39]
    buffer_load_dwordx4 v20, s[44:47], s26 offen offset:0 sc1 lds
    s_waitcnt lgkmcnt(2)
    v_mfma_f32_16x16x32_bf16 v[44:47], v[120:123], a[132:135], v[44:47]
    s_add_u32 m0, s73, 132608
    buffer_load_dwordx4 v[88:91], v252, s[56:59], 0 offen
    v_mfma_f32_16x16x32_bf16 v[44:47], v[124:127], a[140:143], v[44:47]
    buffer_load_dwordx4 v20, s[44:47], s26 offen offset:512 sc1 lds
    s_waitcnt lgkmcnt(0)
    v_mfma_f32_16x16x32_bf16 v[44:47], v[128:131], a[148:151], v[44:47]
    ds_read_b128 v[104:107], v14 offset:51200
    v_mfma_f32_16x16x32_bf16 v[44:47], v[132:135], a[156:159], v[44:47]
    ds_read_b128 v[108:111], v14 offset:55296
    v_mfma_f32_16x16x32_bf16 v[40:43], v[132:135], a[152:155], v[40:43]
    ds_read_b128 v[112:115], v14 offset:59392
    v_mfma_f32_16x16x32_bf16 v[40:43], v[128:131], a[144:147], v[40:43]
    ds_read_b128 v[116:119], v14 offset:63488
    v_mfma_f32_16x16x32_bf16 v[40:43], v[124:127], a[136:139], v[40:43]
    s_add_u32 m0, s73, 134144
    v_mfma_f32_16x16x32_bf16 v[40:43], v[120:123], a[128:131], v[40:43]
    buffer_load_dwordx4 v21, s[44:47], s18 offen offset:0 sc1 lds
    s_waitcnt lgkmcnt(2)
    v_mfma_f32_16x16x32_bf16 v[48:51], v[104:107], a[128:131], v[48:51]
    v_mfma_f32_16x16x32_bf16 v[48:51], v[108:111], a[136:139], v[48:51]
    s_waitcnt lgkmcnt(0)
    v_mfma_f32_16x16x32_bf16 v[48:51], v[112:115], a[144:147], v[48:51]
    ds_read_b128 v[120:123], v14 offset:52224
    v_mfma_f32_16x16x32_bf16 v[48:51], v[116:119], a[152:155], v[48:51]
    ds_read_b128 v[124:127], v14 offset:56320
    v_mfma_f32_16x16x32_bf16 v[52:55], v[116:119], a[156:159], v[52:55]
    ds_read_b128 v[128:131], v14 offset:60416
    v_mfma_f32_16x16x32_bf16 v[52:55], v[112:115], a[148:151], v[52:55]
    ds_read_b128 v[132:135], v14 offset:64512
    v_mfma_f32_16x16x32_bf16 v[52:55], v[108:111], a[140:143], v[52:55]
    v_mfma_f32_16x16x32_bf16 v[52:55], v[104:107], a[132:135], v[52:55]
    s_waitcnt lgkmcnt(2)
    v_mfma_f32_16x16x32_bf16 v[36:39], v[120:123], a[164:167], v[36:39]
    buffer_load_dwordx4 v[92:95], v252, s[56:59], s40 offen
    v_mfma_f32_16x16x32_bf16 v[36:39], v[124:127], a[172:175], v[36:39]
    s_waitcnt lgkmcnt(0)
    v_mfma_f32_16x16x32_bf16 v[36:39], v[128:131], a[180:183], v[36:39]
    s_waitcnt vmcnt(13)
    s_barrier
    v_mfma_f32_16x16x32_bf16 v[36:39], v[132:135], a[188:191], v[36:39]
    ds_read_b128 v[104:107], v14 offset:0
    v_mfma_f32_16x16x32_bf16 v[32:35], v[132:135], a[184:187], v[32:35]
    ds_read_b128 v[108:111], v14 offset:4096
    v_mfma_f32_16x16x32_bf16 v[32:35], v[128:131], a[176:179], v[32:35]
    ds_read_b128 v[112:115], v14 offset:8192
    v_mfma_f32_16x16x32_bf16 v[32:35], v[124:127], a[168:171], v[32:35]
    ds_read_b128 v[116:119], v14 offset:12288
    v_mfma_f32_16x16x32_bf16 v[32:35], v[120:123], a[160:163], v[32:35]
    s_waitcnt lgkmcnt(2)
    v_mfma_f32_16x16x32_bf16 v[40:43], v[104:107], a[160:163], v[40:43]
    s_add_u32 m0, s73, 146944
    v_mfma_f32_16x16x32_bf16 v[40:43], v[108:111], a[168:171], v[40:43]
    buffer_load_dwordx4 v21, s[44:47], s18 offen offset:512 sc1 lds
    s_waitcnt lgkmcnt(0)
    v_mfma_f32_16x16x32_bf16 v[40:43], v[112:115], a[176:179], v[40:43]
    ds_read_b128 v[120:123], v14 offset:1024
    v_mfma_f32_16x16x32_bf16 v[40:43], v[116:119], a[184:187], v[40:43]
    ds_read_b128 v[124:127], v14 offset:5120
    v_mfma_f32_16x16x32_bf16 v[44:47], v[116:119], a[188:191], v[44:47]
    ds_read_b128 v[128:131], v14 offset:9216
    v_mfma_f32_16x16x32_bf16 v[44:47], v[112:115], a[180:183], v[44:47]
    ds_read_b128 v[132:135], v14 offset:13312
    v_mfma_f32_16x16x32_bf16 v[44:47], v[108:111], a[172:175], v[44:47]
    s_add_u32 m0, s73, 148480
    v_mfma_f32_16x16x32_bf16 v[44:47], v[104:107], a[164:167], v[44:47]
    buffer_load_dwordx4 v21, s[44:47], s19 offen offset:0 sc1 lds
    s_waitcnt lgkmcnt(2)
    v_mfma_f32_16x16x32_bf16 v[52:55], v[120:123], a[164:167], v[52:55]
    s_add_u32 m0, s73, 148992
    buffer_load_dwordx2 v[142:143], v253, s[56:59], 0 offen
    v_mfma_f32_16x16x32_bf16 v[52:55], v[124:127], a[172:175], v[52:55]
    buffer_load_dwordx4 v21, s[44:47], s19 offen offset:512 sc1 lds
    s_waitcnt lgkmcnt(0)
    v_mfma_f32_16x16x32_bf16 v[52:55], v[128:131], a[180:183], v[52:55]
    ds_read_b128 v[104:107], v14 offset:2048
    v_mfma_f32_16x16x32_bf16 v[52:55], v[132:135], a[188:191], v[52:55]
    ds_read_b128 v[108:111], v14 offset:6144
    v_mfma_f32_16x16x32_bf16 v[48:51], v[132:135], a[184:187], v[48:51]
    ds_read_b128 v[112:115], v14 offset:10240
    v_mfma_f32_16x16x32_bf16 v[48:51], v[128:131], a[176:179], v[48:51]
    ds_read_b128 v[116:119], v14 offset:14336
    v_mfma_f32_16x16x32_bf16 v[48:51], v[124:127], a[168:171], v[48:51]
    s_add_u32 m0, s73, 150528
    v_mfma_f32_16x16x32_bf16 v[48:51], v[120:123], a[160:163], v[48:51]
    buffer_load_dwordx4 v21, s[44:47], s20 offen offset:0 sc1 lds
    s_waitcnt lgkmcnt(2)
    v_mfma_f32_16x16x32_bf16 v[32:35], v[104:107], a[192:195], v[32:35]
    v_mfma_f32_16x16x32_bf16 v[32:35], v[108:111], a[200:203], v[32:35]
    s_waitcnt vmcnt(11)
    s_waitcnt lgkmcnt(0)
    v_mfma_f32_16x16x32_bf16 v[32:35], v[112:115], a[208:211], v[32:35]
    ds_read_b128 v[120:123], v14 offset:3072
    v_mfma_f32_16x16x32_bf16 v[32:35], v[116:119], a[216:219], v[32:35]
    ds_read_b128 v[124:127], v14 offset:7168
    v_mfma_f32_16x16x32_bf16 v[36:39], v[116:119], a[220:223], v[36:39]
    ds_read_b128 v[128:131], v14 offset:11264
    v_lshlrev_b32 v72, 16, v102
    v_mfma_f32_16x16x32_bf16 v[36:39], v[112:115], a[212:215], v[36:39]
    ds_read_b128 v[132:135], v14 offset:15360
    v_mfma_f32_16x16x32_bf16 v[36:39], v[108:111], a[204:207], v[36:39]
    v_lshlrev_b32 v73, 16, v102
    v_mfma_f32_16x16x32_bf16 v[36:39], v[104:107], a[196:199], v[36:39]
    buffer_load_dwordx2 v[96:97], v26, s[44:47], s42 offen offset:0 sc1
    s_waitcnt lgkmcnt(2)
    v_mfma_f32_16x16x32_bf16 v[44:47], v[120:123], a[196:199], v[44:47]
    v_mfma_f32_16x16x32_bf16 v[44:47], v[124:127], a[204:207], v[44:47]
    v_lshlrev_b32 v74, 16, v102
    s_waitcnt lgkmcnt(0)
    v_mfma_f32_16x16x32_bf16 v[44:47], v[128:131], a[212:215], v[44:47]
    s_barrier
    v_mfma_f32_16x16x32_bf16 v[44:47], v[132:135], a[220:223], v[44:47]
    ds_read_b128 v[104:107], v14 offset:16384
    v_mfma_f32_16x16x32_bf16 v[40:43], v[132:135], a[216:219], v[40:43]
    ds_read_b128 v[108:111], v14 offset:20480
    v_lshlrev_b32 v75, 16, v102
    v_mfma_f32_16x16x32_bf16 v[40:43], v[128:131], a[208:211], v[40:43]
    ds_read_b128 v[112:115], v14 offset:24576
    v_mfma_f32_16x16x32_bf16 v[40:43], v[124:127], a[200:203], v[40:43]
    ds_read_b128 v[116:119], v14 offset:28672
    v_lshlrev_b32 v76, 16, v103
    v_mfma_f32_16x16x32_bf16 v[40:43], v[120:123], a[192:195], v[40:43]
    s_waitcnt lgkmcnt(2)
    v_mfma_f32_16x16x32_bf16 v[48:51], v[104:107], a[192:195], v[48:51]
    s_add_u32 m0, s73, 97792
    v_lshlrev_b32 v77, 16, v103
    v_mfma_f32_16x16x32_bf16 v[48:51], v[108:111], a[200:203], v[48:51]
    buffer_load_dwordx4 v21, s[44:47], s20 offen offset:512 sc1 lds
    s_waitcnt lgkmcnt(0)
    v_mfma_f32_16x16x32_bf16 v[48:51], v[112:115], a[208:211], v[48:51]
    ds_read_b128 v[120:123], v14 offset:17408
    v_mfma_f32_16x16x32_bf16 v[48:51], v[116:119], a[216:219], v[48:51]
    ds_read_b128 v[124:127], v14 offset:21504
    v_mfma_f32_16x16x32_bf16 v[52:55], v[116:119], a[220:223], v[52:55]
    ds_read_b128 v[128:131], v14 offset:25600
    v_lshlrev_b32 v78, 16, v103
    v_mfma_f32_16x16x32_bf16 v[52:55], v[112:115], a[212:215], v[52:55]
    ds_read_b128 v[132:135], v14 offset:29696
    v_mfma_f32_16x16x32_bf16 v[52:55], v[108:111], a[204:207], v[52:55]
    s_add_u32 m0, s73, 99328
    v_lshlrev_b32 v79, 16, v103
    v_mfma_f32_16x16x32_bf16 v[52:55], v[104:107], a[196:199], v[52:55]
    buffer_load_dwordx4 v21, s[44:47], s21 offen offset:0 sc1 lds
    s_waitcnt lgkmcnt(2)
    v_mfma_f32_16x16x32_bf16 v[36:39], v[120:123], a[228:231], v[36:39]
    buffer_load_dwordx2 v[98:99], v26, s[44:47], s42 offen offset:128 sc1
    s_add_u32 m0, s73, 99840
    v_lshlrev_b32 v80, 16, v102
    v_mfma_f32_16x16x32_bf16 v[36:39], v[124:127], a[236:239], v[36:39]
    buffer_load_dwordx4 v21, s[44:47], s21 offen offset:512 sc1 lds
    s_waitcnt lgkmcnt(0)
    v_mfma_f32_16x16x32_bf16 v[36:39], v[128:131], a[244:247], v[36:39]
    ds_read_b128 v[104:107], v14 offset:18432
    v_mfma_f32_16x16x32_bf16 v[36:39], v[132:135], a[252:255], v[36:39]
    ds_read_b128 v[108:111], v14 offset:22528
    v_mfma_f32_16x16x32_bf16 v[32:35], v[132:135], a[248:251], v[32:35]
    ds_read_b128 v[112:115], v14 offset:26624
    v_lshlrev_b32 v81, 16, v102
    v_mfma_f32_16x16x32_bf16 v[32:35], v[128:131], a[240:243], v[32:35]
    ds_read_b128 v[116:119], v14 offset:30720
    v_mfma_f32_16x16x32_bf16 v[32:35], v[124:127], a[232:235], v[32:35]
    s_add_u32 m0, s73, 101376
    v_lshlrev_b32 v82, 16, v102
    v_mfma_f32_16x16x32_bf16 v[32:35], v[120:123], a[224:227], v[32:35]
    buffer_load_dwordx4 v21, s[44:47], s22 offen offset:0 sc1 lds
    s_waitcnt lgkmcnt(2)
    v_mfma_f32_16x16x32_bf16 v[40:43], v[104:107], a[224:227], v[40:43]
    v_mfma_f32_16x16x32_bf16 v[40:43], v[108:111], a[232:235], v[40:43]
    v_lshlrev_b32 v83, 16, v102
    s_waitcnt lgkmcnt(0)
L_pl_X_7:
    s_cbranch_execz L_wret
    v_mfma_f32_16x16x32_bf16 v[40:43], v[112:115], a[240:243], v[40:43]
    ds_read_b128 v[120:123], v14 offset:19456
    v_mfma_f32_16x16x32_bf16 v[40:43], v[116:119], a[248:251], v[40:43]
    ds_read_b128 v[124:127], v14 offset:23552
    v_mfma_f32_16x16x32_bf16 v[44:47], v[116:119], a[252:255], v[44:47]
    ds_read_b128 v[128:131], v14 offset:27648
    v_lshlrev_b32 v84, 16, v103
    v_mfma_f32_16x16x32_bf16 v[44:47], v[112:115], a[244:247], v[44:47]
    ds_read_b128 v[132:135], v14 offset:31744
    v_mfma_f32_16x16x32_bf16 v[44:47], v[108:111], a[236:239], v[44:47]
    v_lshlrev_b32 v85, 16, v103
    v_mfma_f32_16x16x32_bf16 v[44:47], v[104:107], a[228:231], v[44:47]
    buffer_load_dwordx2 v[100:101], v18, s[44:47], s42 offen offset:0 sc1
    s_waitcnt lgkmcnt(2)
    v_mfma_f32_16x16x32_bf16 v[52:55], v[120:123], a[228:231], v[52:55]
    v_mfma_f32_16x16x32_bf16 v[52:55], v[124:127], a[236:239], v[52:55]
    v_lshlrev_b32 v86, 16, v103
    s_waitcnt lgkmcnt(0)
    v_mfma_f32_16x16x32_bf16 v[52:55], v[128:131], a[244:247], v[52:55]
    s_waitcnt vmcnt(13)
    s_barrier
    v_mfma_f32_16x16x32_bf16 v[52:55], v[132:135], a[252:255], v[52:55]
    ds_read_b128 v[104:107], v14 offset:32768
    v_lshlrev_b32 v87, 16, v103
    v_mfma_f32_16x16x32_bf16 v[48:51], v[132:135], a[248:251], v[48:51]
    ds_read_b128 v[108:111], v14 offset:36864
    v_add_u32 v10, 65536, v10
    v_mfma_f32_16x16x32_bf16 v[48:51], v[128:131], a[240:243], v[48:51]
    ds_read_b128 v[112:115], v14 offset:40960
    v_mfma_f32_16x16x32_bf16 v[48:51], v[124:127], a[232:235], v[48:51]
    ds_read_b128 v[116:119], v14 offset:45056
    v_add_u32 v11, 65536, v11
    v_mfma_f32_16x16x32_bf16 v[48:51], v[120:123], a[224:227], v[48:51]
    v_lshlrev_b32 v27, 16, v27
    s_branch L_Dc
L_idle:
    s_waitcnt vmcnt(0)
    s_barrier
    s_mov_b64 exec, 0
    s_call_b64 s[82:83], L_wc_D
    s_mov_b64 exec, -1
    s_mov_b32 s60, s36
    s_and_b32 s61, s37, 0xffff
    s_mov_b32 s62, 4096
    s_mov_b32 s63, 0x20000
    v_and_b32 v24, 15, v2
    s_lshl_b32 s7, s71, 6
    v_add_u32 v24, s7, v24
    s_and_b32 s8, s3, 1
    s_lshl_b32 s4, s8, 5
    v_add_u32 v25, s4, v24
    v_lshlrev_b32 v26, 3, v25
    v_mul_u32_u24 v25, 1152, v25
    v_bfe_u32 v31, v2, 4, 1
    v_lshl_add_u32 v25, v31, 5, v25
    v_lshrrev_b32 v31, 5, v2
    v_lshl_add_u32 v25, v31, 4, v25
    s_bfe_u32 s7, s2, 0x20003
    s_mul_i32 s7, s7, 288
    s_lshl_b32 s4, s72, 6
    s_add_u32 s4, s4, s7
    v_add_u32 v252, s4, v25
    s_xor_b32 s8, s3, s72
    s_and_b32 s4, s72, 1
    s_lshl1_add_u32 s4, s4, s8
    v_lshl_add_u32 v24, s4, 4, v24
    s_add_u32 s7, s7, 256
    s_cmp_lt_u32 s8, 2
    s_cselect_b32 s7, s7, 0x40000000
    v_lshlrev_b32 v18, 3, v24
    v_mul_u32_u24 v24, 1152, v24
    v_lshrrev_b32 v31, 4, v2
    v_lshl_add_u32 v24, v31, 3, v24
    v_add_u32 v253, s7, v24
    v_lshrrev_b32 v24, 3, v2
    v_and_b32 v25, 7, v2
    v_bfe_u32 v31, v2, 4, 2
    v_lshlrev_b32 v31, 1, v31
    v_xor_b32 v25, v25, v31
    v_lshlrev_b32 v24, 12, v24
    v_lshl_add_u32 v24, v25, 4, v24
    s_mul_i32 s7, s72, 36
    s_bitcmp1_b32 s3, 0
    s_addc_u32 s7, s7, 0
    s_lshl_b32 s7, s7, 17
    s_lshl_b32 s8, s71, 7
    s_add_u32 s7, s7, s8
    v_add_u32 v4, s7, v24
    v_add_u32 v5, 31744, v4
    v_add_u32 v6, 31744, v5
    v_add_u32 v7, 31744, v6
    v_lshrrev_b32 v24, 2, v2
    v_lshlrev_b32 v24, 7, v24
    v_and_b32 v25, 3, v2
    v_lshl_add_u32 v24, v25, 3, v24
    s_and_b32 s7, s73, 8192
    v_add_u32 v24, s7, v24
    v_bfe_u32 v31, v2, 3, 2
    s_and_b32 s7, s3, 1
    s_lshl_b32 s7, s7, 1
    v_xor_b32 v31, s7, v31
    v_lshl_add_u32 v10, v31, 5, v24
    v_xor_b32 v11, 32, v10
    v_and_b32 v24, 15, v2
    v_lshrrev_b32 v25, 4, v2
    v_mul_u32_u24 v25, 17408, v25
    v_lshl_add_u32 v24, v24, 4, v25
    s_mul_i32 s7, s72, 36
    s_and_b32 s8, s3, 1
    s_add_u32 s7, s7, s8
    s_mul_i32 s7, s7, 69632
    s_bfe_u32 s8, s2, 0x20003
    s_lshl_b32 s8, s8, 12
    s_add_u32 s7, s7, s8
    s_add_u32 s7, s7, 12795904
    v_add_u32 v23, s7, v24
    s_xor_b32 s7, s72, 0
    v_lshl_add_u32 v19, s7, 10, v23
    s_xor_b32 s7, s72, 1
    v_lshl_add_u32 v20, s7, 10, v23
    s_xor_b32 s7, s72, 2
    v_lshl_add_u32 v21, s7, 10, v23
    s_xor_b32 s7, s72, 3
    v_lshl_add_u32 v22, s7, 10, v23
    v_lshlrev_b32 v14, 4, v2
    v_add_u32 v14, 98304, v14
    v_add_u32 v1, 0x10000, v14
    s_bitcmp1_b32 s3, 1
    s_cselect_b32 s18, s85, s84
    s_mul_i32 s18, s18, 139264
    s_cselect_b32 s19, s87, s86
    s_mul_i32 s19, s19, 139264
    s_cselect_b32 s20, s89, s88
    s_mul_i32 s20, s20, 139264
    s_cselect_b32 s21, s91, s90
    s_mul_i32 s21, s21, 139264
    s_cselect_b32 s22, s93, s92
    s_mul_i32 s22, s22, 139264
    s_cselect_b32 s23, s95, s94
    s_mul_i32 s23, s23, 139264
    s_cselect_b32 s24, s97, s96
    s_mul_i32 s24, s24, 139264
    s_cselect_b32 s25, s99, s98
    s_mul_i32 s25, s25, 139264
    s_cselect_b32 s26, s101, s100
    s_mul_i32 s26, s26, 139264
    s_sub_u32 s4, s75, 252
    s_mul_i32 s4, s4, 1152
    s_mul_i32 s5, s3, 64
    s_add_u32 s4, s4, s5
    s_add_u32 s4, s4, 896
    s_lshl_b32 s4, s4, 12
    s_add_u32 s4, s4, 384
    v_lshlrev_b32 v24, 10, v2
    buffer_load_dword v255, v24, s[52:55], s4 offen
    s_add_u32 s4, s4, 65536
    buffer_load_dword v255, v24, s[52:55], s4 offen
    s_add_u32 s4, s4, 65536
    buffer_load_dword v255, v24, s[52:55], s4 offen
    s_add_u32 s4, s4, 65536
    buffer_load_dword v255, v24, s[52:55], s4 offen
    s_add_u32 s4, s4, 65536
    s_add_u32 m0, s73, 32768
    s_lshl_b32 s14, s84, 18
    buffer_load_dwordx4 v4, s[52:55], s14 offen offset:0 lds
    buffer_load_dwordx4 v5, s[52:55], s14 offen offset:1024 lds
    buffer_load_dwordx4 v6, s[52:55], s14 offen offset:2048 lds
    buffer_load_dwordx4 v7, s[52:55], s14 offen offset:3072 lds
    s_add_u32 m0, s73, 49152
    s_lshl_b32 s14, s85, 18
    buffer_load_dwordx4 v4, s[52:55], s14 offen offset:0 lds
    buffer_load_dwordx4 v5, s[52:55], s14 offen offset:1024 lds
    buffer_load_dwordx4 v6, s[52:55], s14 offen offset:2048 lds
    buffer_load_dwordx4 v7, s[52:55], s14 offen offset:3072 lds
    s_add_u32 m0, s73, 65536
    s_lshl_b32 s14, s86, 18
    buffer_load_dwordx4 v4, s[52:55], s14 offen offset:0 lds
    buffer_load_dwordx4 v5, s[52:55], s14 offen offset:1024 lds
    buffer_load_dwordx4 v6, s[52:55], s14 offen offset:2048 lds
    buffer_load_dwordx4 v7, s[52:55], s14 offen offset:3072 lds
    s_add_u32 m0, s73, 81920
    s_lshl_b32 s14, s87, 18
    buffer_load_dwordx4 v4, s[52:55], s14 offen offset:0 lds
    buffer_load_dwordx4 v5, s[52:55], s14 offen offset:1024 lds
    buffer_load_dwordx4 v6, s[52:55], s14 offen offset:2048 lds
    buffer_load_dwordx4 v7, s[52:55], s14 offen offset:3072 lds
    s_add_u32 m0, s73, 98304
    s_lshl_b32 s14, s88, 18
    buffer_load_dwordx4 v4, s[52:55], s14 offen offset:0 lds
    buffer_load_dwordx4 v5, s[52:55], s14 offen offset:1024 lds
    buffer_load_dwordx4 v6, s[52:55], s14 offen offset:2048 lds
    buffer_load_dwordx4 v7, s[52:55], s14 offen offset:3072 lds
    s_add_u32 m0, s73, 114688
    s_lshl_b32 s14, s89, 18
    buffer_load_dwordx4 v4, s[52:55], s14 offen offset:0 lds
    buffer_load_dwordx4 v5, s[52:55], s14 offen offset:1024 lds
    buffer_load_dwordx4 v6, s[52:55], s14 offen offset:2048 lds
    buffer_load_dwordx4 v7, s[52:55], s14 offen offset:3072 lds
    s_add_u32 m0, s73, 131072
    s_lshl_b32 s14, s90, 18
    buffer_load_dwordx4 v4, s[52:55], s14 offen offset:0 lds
    buffer_load_dwordx4 v5, s[52:55], s14 offen offset:1024 lds
    buffer_load_dwordx4 v6, s[52:55], s14 offen offset:2048 lds
    buffer_load_dwordx4 v7, s[52:55], s14 offen offset:3072 lds
    s_add_u32 m0, s73, 147456
    s_lshl_b32 s14, s91, 18
    buffer_load_dwordx4 v4, s[52:55], s14 offen offset:0 lds
    buffer_load_dwordx4 v5, s[52:55], s14 offen offset:1024 lds
    buffer_load_dwordx4 v6, s[52:55], s14 offen offset:2048 lds
    buffer_load_dwordx4 v7, s[52:55], s14 offen offset:3072 lds
    s_waitcnt vmcnt(28)
    s_barrier
    ds_read_b64_tr_b16 a[0:1], v10 offset:32768
    ds_read_b64_tr_b16 a[2:3], v10 offset:34816
    ds_read_b64_tr_b16 a[8:9], v10 offset:36864
    ds_read_b64_tr_b16 a[10:11], v10 offset:38912
    ds_read_b64_tr_b16 a[4:5], v11 offset:32768
    ds_read_b64_tr_b16 a[6:7], v11 offset:34816
    ds_read_b64_tr_b16 a[12:13], v11 offset:36864
    ds_read_b64_tr_b16 a[14:15], v11 offset:38912
    s_waitcnt vmcnt(24) lgkmcnt(0)
    s_barrier
    ds_read_b64_tr_b16 a[16:17], v10 offset:49152
    s_add_u32 m0, s73, 32768
    s_lshl_b32 s14, s92, 18
    ds_read_b64_tr_b16 a[18:19], v10 offset:51200
    buffer_load_dwordx4 v4, s[52:55], s14 offen offset:0 lds
    ds_read_b64_tr_b16 a[24:25], v10 offset:53248
    ds_read_b64_tr_b16 a[26:27], v10 offset:55296
    buffer_load_dwordx4 v5, s[52:55], s14 offen offset:1024 lds
    ds_read_b64_tr_b16 a[20:21], v11 offset:49152
    buffer_load_dwordx4 v6, s[52:55], s14 offen offset:2048 lds
    ds_read_b64_tr_b16 a[22:23], v11 offset:51200
    ds_read_b64_tr_b16 a[28:29], v11 offset:53248
    buffer_load_dwordx4 v7, s[52:55], s14 offen offset:3072 lds
    ds_read_b64_tr_b16 a[30:31], v11 offset:55296
    s_waitcnt vmcnt(24) lgkmcnt(0)
    s_barrier
    v_add_u32 v10, 65536, v10
    ds_read_b64_tr_b16 a[32:33], v10 offset:0
    s_add_u32 m0, s73, 49152
    s_lshl_b32 s14, s93, 18
    ds_read_b64_tr_b16 a[34:35], v10 offset:2048
    buffer_load_dwordx4 v4, s[52:55], s14 offen offset:0 lds
    ds_read_b64_tr_b16 a[40:41], v10 offset:4096
    ds_read_b64_tr_b16 a[42:43], v10 offset:6144
    buffer_load_dwordx4 v5, s[52:55], s14 offen offset:1024 lds
    v_add_u32 v11, 65536, v11
    ds_read_b64_tr_b16 a[36:37], v11 offset:0
    buffer_load_dwordx4 v6, s[52:55], s14 offen offset:2048 lds
    ds_read_b64_tr_b16 a[38:39], v11 offset:2048
    ds_read_b64_tr_b16 a[44:45], v11 offset:4096
    buffer_load_dwordx4 v7, s[52:55], s14 offen offset:3072 lds
    ds_read_b64_tr_b16 a[46:47], v11 offset:6144
    s_waitcnt vmcnt(24) lgkmcnt(0)
    s_barrier
    ds_read_b64_tr_b16 a[48:49], v10 offset:16384
    s_add_u32 m0, s73, 65536
    s_lshl_b32 s14, s94, 18
    ds_read_b64_tr_b16 a[50:51], v10 offset:18432
    buffer_load_dwordx4 v4, s[52:55], s14 offen offset:0 lds
    ds_read_b64_tr_b16 a[56:57], v10 offset:20480
    ds_read_b64_tr_b16 a[58:59], v10 offset:22528
    buffer_load_dwordx4 v5, s[52:55], s14 offen offset:1024 lds
    ds_read_b64_tr_b16 a[52:53], v11 offset:16384
    buffer_load_dwordx4 v6, s[52:55], s14 offen offset:2048 lds
    ds_read_b64_tr_b16 a[54:55], v11 offset:18432
    ds_read_b64_tr_b16 a[60:61], v11 offset:20480
    buffer_load_dwordx4 v7, s[52:55], s14 offen offset:3072 lds
    ds_read_b64_tr_b16 a[62:63], v11 offset:22528
    s_waitcnt vmcnt(24) lgkmcnt(0)
    s_barrier
    ds_read_b64_tr_b16 a[64:65], v10 offset:32768
    s_add_u32 m0, s73, 81920
    s_lshl_b32 s14, s95, 18
    ds_read_b64_tr_b16 a[66:67], v10 offset:34816
    buffer_load_dwordx4 v4, s[52:55], s14 offen offset:0 lds
    ds_read_b64_tr_b16 a[72:73], v10 offset:36864
    ds_read_b64_tr_b16 a[74:75], v10 offset:38912
    buffer_load_dwordx4 v5, s[52:55], s14 offen offset:1024 lds
    ds_read_b64_tr_b16 a[68:69], v11 offset:32768
    buffer_load_dwordx4 v6, s[52:55], s14 offen offset:2048 lds
    ds_read_b64_tr_b16 a[70:71], v11 offset:34816
    ds_read_b64_tr_b16 a[76:77], v11 offset:36864
    buffer_load_dwordx4 v7, s[52:55], s14 offen offset:3072 lds
    ds_read_b64_tr_b16 a[78:79], v11 offset:38912
    s_waitcnt vmcnt(24) lgkmcnt(0)
    s_barrier
    ds_read_b64_tr_b16 a[80:81], v10 offset:49152
    s_add_u32 m0, s73, 98304
    s_lshl_b32 s14, s96, 18
    ds_read_b64_tr_b16 a[82:83], v10 offset:51200
    buffer_load_dwordx4 v4, s[52:55], s14 offen offset:0 lds
    ds_read_b64_tr_b16 a[88:89], v10 offset:53248
    ds_read_b64_tr_b16 a[90:91], v10 offset:55296
    buffer_load_dwordx4 v5, s[52:55], s14 offen offset:1024 lds
    ds_read_b64_tr_b16 a[84:85], v11 offset:49152
    buffer_load_dwordx4 v6, s[52:55], s14 offen offset:2048 lds
    ds_read_b64_tr_b16 a[86:87], v11 offset:51200
    ds_read_b64_tr_b16 a[92:93], v11 offset:53248
    buffer_load_dwordx4 v7, s[52:55], s14 offen offset:3072 lds
    ds_read_b64_tr_b16 a[94:95], v11 offset:55296
    s_waitcnt vmcnt(24) lgkmcnt(0)
    s_barrier
    v_add_u32 v10, 65536, v10
    ds_read_b64_tr_b16 a[96:97], v10 offset:0
    s_add_u32 m0, s73, 114688
    s_lshl_b32 s14, s97, 18
    ds_read_b64_tr_b16 a[98:99], v10 offset:2048
    buffer_load_dwordx4 v4, s[52:55], s14 offen offset:0 lds
    ds_read_b64_tr_b16 a[104:105], v10 offset:4096
    ds_read_b64_tr_b16 a[106:107], v10 offset:6144
    buffer_load_dwordx4 v5, s[52:55], s14 offen offset:1024 lds
    v_add_u32 v11, 65536, v11
    ds_read_b64_tr_b16 a[100:101], v11 offset:0
    buffer_load_dwordx4 v6, s[52:55], s14 offen offset:2048 lds
    ds_read_b64_tr_b16 a[102:103], v11 offset:2048
    ds_read_b64_tr_b16 a[108:109], v11 offset:4096
    buffer_load_dwordx4 v7, s[52:55], s14 offen offset:3072 lds
    ds_read_b64_tr_b16 a[110:111], v11 offset:6144
    s_waitcnt vmcnt(24) lgkmcnt(0)
    s_barrier
    ds_read_b64_tr_b16 a[112:113], v10 offset:16384
    s_add_u32 m0, s73, 131072
    s_lshl_b32 s14, s98, 18
    ds_read_b64_tr_b16 a[114:115], v10 offset:18432
    buffer_load_dwordx4 v4, s[52:55], s14 offen offset:0 lds
    ds_read_b64_tr_b16 a[120:121], v10 offset:20480
    ds_read_b64_tr_b16 a[122:123], v10 offset:22528
    buffer_load_dwordx4 v5, s[52:55], s14 offen offset:1024 lds
    ds_read_b64_tr_b16 a[116:117], v11 offset:16384
    buffer_load_dwordx4 v6, s[52:55], s14 offen offset:2048 lds
    ds_read_b64_tr_b16 a[118:119], v11 offset:18432
    ds_read_b64_tr_b16 a[124:125], v11 offset:20480
    buffer_load_dwordx4 v7, s[52:55], s14 offen offset:3072 lds
    ds_read_b64_tr_b16 a[126:127], v11 offset:22528
    s_waitcnt vmcnt(24) lgkmcnt(0)
    s_barrier
    v_add_u32 v10, -131072, v10
    ds_read_b64_tr_b16 a[128:129], v10 offset:32768
    s_add_u32 m0, s73, 147456
    s_lshl_b32 s14, s99, 18
    ds_read_b64_tr_b16 a[130:131], v10 offset:34816
    buffer_load_dwordx4 v4, s[52:55], s14 offen offset:0 lds
    ds_read_b64_tr_b16 a[136:137], v10 offset:36864
    ds_read_b64_tr_b16 a[138:139], v10 offset:38912
    buffer_load_dwordx4 v5, s[52:55], s14 offen offset:1024 lds
    v_add_u32 v11, -131072, v11
    ds_read_b64_tr_b16 a[132:133], v11 offset:32768
    buffer_load_dwordx4 v6, s[52:55], s14 offen offset:2048 lds
    ds_read_b64_tr_b16 a[134:135], v11 offset:34816
    ds_read_b64_tr_b16 a[140:141], v11 offset:36864
    buffer_load_dwordx4 v7, s[52:55], s14 offen offset:3072 lds
    ds_read_b64_tr_b16 a[142:143], v11 offset:38912
    s_waitcnt vmcnt(24) lgkmcnt(0)
    s_barrier
    ds_read_b64_tr_b16 a[144:145], v10 offset:49152
    s_add_u32 m0, s73, 0
    s_lshl_b32 s14, s100, 18
    ds_read_b64_tr_b16 a[146:147], v10 offset:51200
    buffer_load_dwordx4 v4, s[52:55], s14 offen offset:0 lds
    ds_read_b64_tr_b16 a[152:153], v10 offset:53248
    ds_read_b64_tr_b16 a[154:155], v10 offset:55296
    buffer_load_dwordx4 v5, s[52:55], s14 offen offset:1024 lds
    ds_read_b64_tr_b16 a[148:149], v11 offset:49152
    buffer_load_dwordx4 v6, s[52:55], s14 offen offset:2048 lds
    ds_read_b64_tr_b16 a[150:151], v11 offset:51200
    ds_read_b64_tr_b16 a[156:157], v11 offset:53248
    buffer_load_dwordx4 v7, s[52:55], s14 offen offset:3072 lds
    ds_read_b64_tr_b16 a[158:159], v11 offset:55296
    s_waitcnt vmcnt(24) lgkmcnt(0)
    s_barrier
    v_add_u32 v10, 65536, v10
    ds_read_b64_tr_b16 a[160:161], v10 offset:0
    s_add_u32 m0, s73, 16384
    s_lshl_b32 s14, s101, 18
    ds_read_b64_tr_b16 a[162:163], v10 offset:2048
    buffer_load_dwordx4 v4, s[52:55], s14 offen offset:0 lds
    ds_read_b64_tr_b16 a[168:169], v10 offset:4096
    ds_read_b64_tr_b16 a[170:171], v10 offset:6144
    buffer_load_dwordx4 v5, s[52:55], s14 offen offset:1024 lds
    v_add_u32 v11, 65536, v11
    ds_read_b64_tr_b16 a[164:165], v11 offset:0
    buffer_load_dwordx4 v6, s[52:55], s14 offen offset:2048 lds
    ds_read_b64_tr_b16 a[166:167], v11 offset:2048
    ds_read_b64_tr_b16 a[172:173], v11 offset:4096
    buffer_load_dwordx4 v7, s[52:55], s14 offen offset:3072 lds
    ds_read_b64_tr_b16 a[174:175], v11 offset:6144
    s_waitcnt vmcnt(24) lgkmcnt(0)
    s_barrier
    ds_read_b64_tr_b16 a[176:177], v10 offset:16384
    ds_read_b64_tr_b16 a[178:179], v10 offset:18432
    ds_read_b64_tr_b16 a[184:185], v10 offset:20480
    ds_read_b64_tr_b16 a[186:187], v10 offset:22528
    ds_read_b64_tr_b16 a[180:181], v11 offset:16384
    ds_read_b64_tr_b16 a[182:183], v11 offset:18432
    ds_read_b64_tr_b16 a[188:189], v11 offset:20480
    ds_read_b64_tr_b16 a[190:191], v11 offset:22528
    s_waitcnt vmcnt(20) lgkmcnt(0)
    s_barrier
    ds_read_b64_tr_b16 a[192:193], v10 offset:32768
    ds_read_b64_tr_b16 a[194:195], v10 offset:34816
    ds_read_b64_tr_b16 a[200:201], v10 offset:36864
    ds_read_b64_tr_b16 a[202:203], v10 offset:38912
    ds_read_b64_tr_b16 a[196:197], v11 offset:32768
    ds_read_b64_tr_b16 a[198:199], v11 offset:34816
    ds_read_b64_tr_b16 a[204:205], v11 offset:36864
    ds_read_b64_tr_b16 a[206:207], v11 offset:38912
    s_waitcnt vmcnt(16) lgkmcnt(0)
    s_barrier
    ds_read_b64_tr_b16 a[208:209], v10 offset:49152
    ds_read_b64_tr_b16 a[210:211], v10 offset:51200
    ds_read_b64_tr_b16 a[216:217], v10 offset:53248
    ds_read_b64_tr_b16 a[218:219], v10 offset:55296
    ds_read_b64_tr_b16 a[212:213], v11 offset:49152
    ds_read_b64_tr_b16 a[214:215], v11 offset:51200
    ds_read_b64_tr_b16 a[220:221], v11 offset:53248
    ds_read_b64_tr_b16 a[222:223], v11 offset:55296
    s_waitcnt vmcnt(12) lgkmcnt(0)
    s_barrier
    v_add_u32 v10, 65536, v10
    ds_read_b64_tr_b16 a[224:225], v10 offset:0
    ds_read_b64_tr_b16 a[226:227], v10 offset:2048
    ds_read_b64_tr_b16 a[232:233], v10 offset:4096
    ds_read_b64_tr_b16 a[234:235], v10 offset:6144
    v_add_u32 v11, 65536, v11
    ds_read_b64_tr_b16 a[228:229], v11 offset:0
    ds_read_b64_tr_b16 a[230:231], v11 offset:2048
    ds_read_b64_tr_b16 a[236:237], v11 offset:4096
    ds_read_b64_tr_b16 a[238:239], v11 offset:6144
    s_waitcnt vmcnt(8) lgkmcnt(0)
    s_barrier
    ds_read_b64_tr_b16 a[240:241], v10 offset:16384
    ds_read_b64_tr_b16 a[242:243], v10 offset:18432
    ds_read_b64_tr_b16 a[248:249], v10 offset:20480
    ds_read_b64_tr_b16 a[250:251], v10 offset:22528
    ds_read_b64_tr_b16 a[244:245], v11 offset:16384
    ds_read_b64_tr_b16 a[246:247], v11 offset:18432
    ds_read_b64_tr_b16 a[252:253], v11 offset:20480
    ds_read_b64_tr_b16 a[254:255], v11 offset:22528
    s_waitcnt lgkmcnt(0)
    s_barrier
    v_add_u32 v10, -131072, v10
    v_add_u32 v11, -131072, v11
    s_mov_b64 exec, 0
    s_call_b64 s[82:83], L_wc_D
    s_mov_b64 exec, -1
    s_bfe_u32 s4, s2, 0x20003
    s_lshl2_add_u32 s4, s72, s4
    s_lshl_b32 s4, s4, 3
    s_lshr_b32 s5, s2, 4
    s_and_b32 s5, s5, 6
    s_add_u32 s4, s4, s5
    s_and_b32 s5, s2, 1
    s_add_u32 s4, s4, s5
    s_lshl_b32 s4, s4, 7
    s_add_u32 s4, s4, 12566528
    v_lshl_add_u32 v28, v2, 2, s4
    s_cmp_eq_u32 s3, 0
    s_cselect_b32 s4, 18, 0
    v_cmp_gt_u32 vcc, s4, v2
    v_mov_b32 v13, 0x40000000
    s_nop 0
    v_cndmask_b32 v28, v13, v28, vcc
    v_mov_b32 v13, s68
    v_cndmask_b32 v13, 0, v13, vcc
    s_mov_b32 s5, 0
L_iw:
    s_sleep 16
    v_mov_b32 v29, 0
    buffer_atomic_add v29, v28, s[44:47], 0 offen sc0 sc1
    s_waitcnt vmcnt(0)
    v_cmp_eq_u32 vcc, 0, v13
    s_nop 1
    s_mov_b64 s[6:7], vcc
    v_cmp_ne_u32 vcc, v13, v29
    s_nop 1
    s_andn2_b64 s[8:9], exec, vcc
    s_andn2_b64 s[8:9], s[8:9], s[6:7]
    s_cbranch_scc1 L_ix
    s_cmp_eq_u64 s[6:7], exec
    s_cbranch_scc1 L_ix
    s_add_u32 s5, s5, 1
    s_cmp_lt_u32 s5, 100000
    s_cbranch_scc1 L_iw
L_ix:
    v_mov_b32 v29, 0
    buffer_atomic_add v29, v28, s[44:47], 0 offen sc0 sc1
    s_branch L_DX
L_end:
.section .rodata,"a"
.p2align 6
.amdhsa_kernel recurrent_scan__ssm_conv_h3__mixer_token_mlp__prompt_kernel
  .amdhsa_next_free_vgpr 512
  .amdhsa_next_free_sgpr 102
  .amdhsa_accum_offset 256
  .amdhsa_group_segment_fixed_size 0
  .amdhsa_kernarg_size 112
  .amdhsa_user_sgpr_count 2
  .amdhsa_user_sgpr_kernarg_segment_ptr 1
  .amdhsa_system_sgpr_workgroup_id_x 1
  .amdhsa_float_denorm_mode_32 3
.end_amdhsa_kernel
```

```asm
; @launch grid=(256,1,1) block=(256,1,1) lds=163840
.amdgcn_target "amdgcn-amd-amdhsa--gfx950"
.text
.globl recurrent_scan__ssm_conv_h3__mixer_token_mlp__prompt_kernel
.p2align 8
.type recurrent_scan__ssm_conv_h3__mixer_token_mlp__prompt_kernel,@function
recurrent_scan__ssm_conv_h3__mixer_token_mlp__prompt_kernel:
    s_cmp_lt_u32 s2, 256
    s_cbranch_scc0 L_exit
    s_load_dwordx2 s[56:57], s[0:1], 0
    s_load_dwordx2 s[48:49], s[0:1], 8
    s_load_dwordx2 s[52:53], s[0:1], 16
    s_load_dwordx2 s[60:61], s[0:1], 24
    s_load_dwordx16 s[16:31], s[0:1], 0
    s_load_dwordx8 s[32:39], s[0:1], 64
    s_load_dwordx4 s[40:43], s[0:1], 96
    s_memrealtime s[12:13]
    v_lshrrev_b32 v1, 6, v0
    v_and_b32 v2, 63, v0
    s_getpc_b64 s[6:7]
L_pc:
    s_lshr_b32 s4, s2, 1
    s_and_b32 s4, s4, 124
    v_add_u32 v22, s4, v1
    v_lshl_add_u32 v22, v2, 7, v22
    v_lshlrev_b32 v22, 7, v22
    v_min_u32 v22, L_end-L_pc-4, v22
    s_mov_b64 exec, 31
    global_load_dword v255, v22, s[6:7]
    s_mov_b64 exec, -1
    v_readfirstlane_b32 s3, v1
    s_and_b32 s4, s2, 7
    s_lshr_b32 s5, s2, 3
    s_lshl_b32 s4, s4, 5
    s_add_u32 s68, s4, s5
    v_lshrrev_b32 v3, 5, v0
    v_and_b32 v4, 31, v0
    v_mul_u32_u24 v5, 1152, v3
    v_mad_u32_u24 v5, v4, 12, v5
    s_mul_i32 s15, s68, 9216
    s_mul_i32 s4, s3, 3072
    s_add_u32 s5, s4, s15
    s_sub_u32 s5, s5, 3456
    v_lshlrev_b32 v6, 4, v2
    v_add_u32 v7, s5, v6
    v_add_u32 v58, 1024, v7
    s_add_u32 s4, s4, 114688
    s_lshl_b32 s5, s3, 11
    s_add_u32 s11, s5, s15
    s_add_u32 s5, s5, 127360
    s_cmp_lt_u32 s2, 216
    s_cselect_b32 s9, 0, 106496
    s_sub_u32 s4, s4, s9
    s_sub_u32 s5, s5, s9
    s_mov_b32 m0, s4
    s_mov_b32 s58, 2359296
    s_mov_b32 s59, 0x20000
    s_mov_b32 s50, 2359296
    s_mov_b32 s51, 0x20000
    s_mov_b32 s54, 2359296
    s_mov_b32 s55, 0x20000
    s_mov_b32 s62, 4608
    s_mov_b32 s63, 0x20000
    v_lshlrev_b32 v59, 3, v0
    s_movk_i32 s10, 4096
    v_lshlrev_b32 v91, 3, v2
    v_or_b32 v22, s2, v0
    v_lshlrev_b32 v22, 8, v22
    s_mov_b32 s66, 256
    s_mov_b32 s67, 0x20000
    s_waitcnt lgkmcnt(0)
    buffer_load_dwordx3 v[8:10], v5, s[56:59], s15 offen offset:0
    buffer_load_dwordx3 v[12:14], v5, s[56:59], s15 offen offset:384
    buffer_load_dwordx3 v[16:18], v5, s[56:59], s15 offen offset:768
    s_mov_b32 s64, s40
    s_and_b32 s65, s41, 0xffff
    s_or_b32 s12, s12, 1
    v_mov_b32 v23, s12
    buffer_store_dword v23, v22, s[64:67], 0 offen sc1
    buffer_load_dwordx4 v7, s[48:51], 0 offen lds
    s_add_u32 m0, s4, 1024
    s_cmp_eq_u32 s3, 3
    buffer_load_dwordx4 v58, s[48:51], 0 offen lds
    buffer_load_dwordx4 v58, s[48:51], 0 offen offset:1024 lds
    s_cbranch_scc1 L_xld
L_nox:
    s_mov_b32 m0, s5
    buffer_load_dwordx2 v[98:99], v59, s[60:63], 0 offen
    buffer_load_dwordx4 v6, s[52:55], s11 offen lds
    buffer_load_dwordx4 v6, s[52:55], s11 offen offset:1024 lds
    buffer_load_dwordx2 v[100:101], v59, s[60:63], 0 offen offset:2048
    buffer_load_dwordx2 v[102:103], v59, s[60:63], s10 offen
    s_mov_b32 s44, s42
    s_and_b32 s45, s43, 0xffff
    s_mov_b32 s46, 36585472
    s_mov_b32 s47, 0x20000
    s_and_b32 s5, s2, 7
    s_lshr_b32 s6, s2, 3
    s_lshr_b32 s7, s6, 2
    s_lshr_b32 s8, s3, 1
    s_lshl1_add_u32 s9, s7, s8
    s_cmp_ge_u32 s9, 10
    s_addc_u32 s14, s9, 0
    s_cmp_ge_u32 s9, 3
    s_addc_u32 s14, s14, 0
    s_lshl3_add_u32 s8, s8, 3
    s_cmp_eq_u32 s7, 7
    s_cselect_b32 s14, s8, s14
    s_and_b32 s4, s5, 1
    s_lshl4_add_u32 s71, s4, s14
    s_lshr_b32 s13, s5, 1
    s_mov_b32 s72, s13
    s_and_b32 s101, s6, 3
    s_lshl_b32 s73, s3, 12
    s_mov_b32 s52, s34
    s_and_b32 s53, s35, 0xffff
    s_mov_b32 s54, 18874368
    s_mov_b32 s55, 0x20000
    s_cmp_lt_u32 s6, 27
    s_cbranch_scc0 L_aux
    s_branch L_org
L_exit:
    s_endpgm
L_xld:
    s_mov_b64 exec, 0xffffff
    buffer_load_dwordx4 v58, s[48:51], 0 offen offset:2048 lds
    s_mov_b64 exec, -1
    s_mov_b32 m0, s5
    s_nop 0
    buffer_load_dwordx4 v6, s[52:55], s11 offen offset:2048 lds
    s_branch L_nox
L_nw_G:
    s_mov_b32 s5, 0
L_nl_G:
    buffer_load_dword v45, v54, s[64:67], 0 offen sc1
    s_waitcnt vmcnt(0)
    v_readfirstlane_b32 s68, v45
    s_nop 1
    s_cmp_lg_u32 s68, 0
    s_cbranch_scc1 L_ng_G
    s_add_u32 s5, s5, 1
    s_cmp_lt_u32 s5, 100000
    s_cbranch_scc1 L_nl_G
    s_branch L_ng_G
L_rs_p1G:
    s_mov_b32 s5, 0
L_rt_p1G:
    s_mov_b64 exec, vcc
    v_mov_b32 v29, 0
    buffer_atomic_add v29, v28, s[44:47], 0 offen sc0 sc1
    s_waitcnt vmcnt(0)
    v_cmp_ne_u32 vcc, v12, v29
    s_cbranch_vccz L_rx_p1G
    s_add_u32 s5, s5, 1
    s_cmp_lt_u32 s5, 100000
    s_cbranch_scc1 L_rt_p1G
L_rx_p1G:
    s_mov_b64 exec, -1
    s_branch L_ok_p1G
L_rs_p5:
    s_mov_b32 s5, 0
L_rt_p5:
    s_mov_b64 exec, vcc
    buffer_load_dword v29, v28, s[44:47], 0 offen sc1
    s_waitcnt vmcnt(0)
    v_cmp_ne_u32 vcc, s68, v29
    s_cbranch_vccz L_rx_p5
    s_add_u32 s5, s5, 1
    s_cmp_lt_u32 s5, 100000
    s_cbranch_scc1 L_rt_p5
L_rx_p5:
    s_mov_b64 exec, -1
    s_branch L_ok_p5
L_nw_X:
    s_mov_b32 s5, 0
L_nl_X:
    buffer_load_dword v45, v54, s[64:67], 0 offen sc1
    s_waitcnt vmcnt(0)
    v_readfirstlane_b32 s68, v45
    s_nop 1
    s_cmp_lg_u32 s68, 0
    s_cbranch_scc1 L_ng_X
    s_add_u32 s5, s5, 1
    s_cmp_lt_u32 s5, 100000
    s_cbranch_scc1 L_nl_X
    s_branch L_ng_X
L_rs_p1X:
    s_mov_b32 s5, 0
L_rt_p1X:
    s_mov_b64 exec, vcc
    v_mov_b32 v29, 0
    buffer_atomic_add v29, v28, s[44:47], 0 offen sc0 sc1
    s_waitcnt vmcnt(0)
    v_cmp_ne_u32 vcc, s68, v29
    s_cbranch_vccz L_rx_p1X
    s_add_u32 s5, s5, 1
    s_cmp_lt_u32 s5, 100000
    s_cbranch_scc1 L_rt_p1X
L_rx_p1X:
    s_mov_b64 exec, -1
    s_branch L_ok_p1X
L_rs_p2G:
    s_mov_b32 s5, 0
L_rt_p2G:
    s_mov_b64 exec, vcc
    v_mov_b32 v16, 0
    buffer_atomic_add v16, v15, s[44:47], 0 offen sc0 sc1
    s_waitcnt vmcnt(0)
    v_cmp_ne_u32 vcc, v13, v16
    s_cbranch_vccz L_rx_p2G
    s_add_u32 s5, s5, 1
    s_cmp_lt_u32 s5, 100000
    s_cbranch_scc1 L_rt_p2G
L_rx_p2G:
    s_mov_b64 exec, -1
    s_branch L_ok_p2G
L_xs_a:
    s_mov_b32 s5, 0
L_xt_a:
    v_mov_b32 v187, 0
    buffer_atomic_add v187, v137, s[44:47], 0 offen offset:12 sc0 sc1
    s_waitcnt vmcnt(0)
    v_cmp_ne_u32 vcc, v138, v187
    s_cbranch_vccz L_xr_a
    s_add_u32 s5, s5, 1
    s_cmp_lt_u32 s5, 100000
    s_cbranch_scc1 L_xt_a
L_xr_a:
    buffer_load_dwordx4 v[40:43], v136, s[44:47], s34 offen offset:0 sc1
    buffer_load_dwordx4 v[44:47], v136, s[44:47], s34 offen offset:1024 sc1
    buffer_load_dwordx4 v[48:51], v136, s[44:47], s34 offen offset:2048 sc1
    s_waitcnt vmcnt(0)
    v_bitop3_b32 v43, v43, v47, s68 bitop3:0x7e
    v_bitop3_b32 v43, v43, v51, s68 bitop3:0xf6
    v_cmp_ne_u32 vcc, 0, v43
    s_cbranch_vccz L_xo_a
    s_add_u32 s5, s5, 1
    s_cmp_lt_u32 s5, 100000
    s_cbranch_scc1 L_xt_a
    s_branch L_xo_a
L_as_b:
    s_mov_b32 s5, 0
L_at_b:
    v_mov_b32 v141, 0
    buffer_atomic_add v141, v139, s[44:47], s11 offen offset:2060 sc0 sc1
    s_waitcnt vmcnt(0)
    v_cmp_ne_u32 vcc, v140, v141
    s_cbranch_vccz L_ao_b
    s_add_u32 s5, s5, 1
    s_cmp_lt_u32 s5, 100000
    s_cbranch_scc1 L_at_b
    s_branch L_ao_b
L_xs_b:
    s_mov_b32 s5, 0
L_xt_b:
    buffer_load_dwordx4 v[56:59], v136, s[44:47], s11 offen offset:0 sc1
    buffer_load_dwordx4 v[60:63], v136, s[44:47], s11 offen offset:1024 sc1
    buffer_load_dwordx4 v[64:67], v136, s[44:47], s11 offen offset:2048 sc1
    s_waitcnt vmcnt(0)
    v_bitop3_b32 v59, v59, v63, s68 bitop3:0x7e
    v_bitop3_b32 v59, v59, v67, s68 bitop3:0xf6
    v_cmp_ne_u32 vcc, 0, v59
    s_cbranch_vccz L_xo_b
    s_add_u32 s5, s5, 1
    s_cmp_lt_u32 s5, 100000
    s_cbranch_scc1 L_xt_b
    s_branch L_xo_b
L_xs_z:
    s_mov_b32 s5, 0
L_xt_z:
    buffer_load_dwordx4 v[72:75], v136, s[44:47], s12 offen offset:0 sc1
    buffer_load_dwordx4 v[76:79], v136, s[44:47], s12 offen offset:1024 sc1
    buffer_load_dwordx4 v[80:83], v136, s[44:47], s12 offen offset:2048 sc1
    s_waitcnt vmcnt(0)
    v_bitop3_b32 v75, v75, v79, s68 bitop3:0x7e
    v_bitop3_b32 v75, v75, v83, s68 bitop3:0xf6
    v_cmp_ne_u32 vcc, 0, v75
    s_cbranch_vccz L_xo_z
    s_add_u32 s5, s5, 1
    s_cmp_lt_u32 s5, 100000
    s_cbranch_scc1 L_xt_z
    s_branch L_xo_z
L_rs_p3:
    s_mov_b32 s5, 0
L_rt_p3:
    s_mov_b64 exec, vcc
    buffer_load_dword v189, v188, s[44:47], 0 offen sc1
    s_waitcnt vmcnt(0)
    v_cmp_ne_u32 vcc, s68, v189
    s_cbranch_vccz L_rx_p3
    s_add_u32 s5, s5, 1
    s_cmp_lt_u32 s5, 100000
    s_cbranch_scc1 L_rt_p3
L_rx_p3:
    s_mov_b64 exec, -1
    s_branch L_ok_p3
L_xs_8:
    s_mov_b32 s5, 0
L_xt_8:
    v_mov_b32 v187, 0
    buffer_atomic_add v187, v137, s[44:47], 0 offen offset:12 sc0 sc1
    s_waitcnt vmcnt(0)
    v_cmp_ne_u32 vcc, v138, v187
    s_cbranch_vccz L_xr_8
    s_add_u32 s5, s5, 1
    s_cmp_lt_u32 s5, 100000
    s_cbranch_scc1 L_xt_8
L_xr_8:
    buffer_load_dwordx4 v[204:207], v136, s[44:47], s35 offen offset:0 sc1
    buffer_load_dwordx4 v[208:211], v136, s[44:47], s35 offen offset:1024 sc1
    buffer_load_dwordx4 v[212:215], v136, s[44:47], s35 offen offset:2048 sc1
    buffer_load_dwordx4 v[216:219], v136, s[44:47], s35 offen offset:3072 sc1
    s_waitcnt vmcnt(0)
    v_bitop3_b32 v207, v207, v211, s36 bitop3:0x7e
    v_bitop3_b32 v207, v207, v215, s36 bitop3:0xf6
    v_bitop3_b32 v207, v207, v219, s36 bitop3:0xf6
    v_cmp_ne_u32 vcc, 0, v207
    s_cbranch_vccz L_xo_8
    s_add_u32 s5, s5, 1
    s_cmp_lt_u32 s5, 100000
    s_cbranch_scc1 L_xt_8
    s_branch L_xo_8
L_rs_p2X:
    s_mov_b32 s5, 0
L_rt_p2X:
    s_mov_b64 exec, vcc
    v_mov_b32 v29, 0
    buffer_atomic_add v29, v28, s[44:47], 0 offen sc0 sc1
    s_waitcnt vmcnt(0)
    v_cmp_ne_u32 vcc, v13, v29
    s_cbranch_vccz L_rx_p2X
    s_add_u32 s5, s5, 1
    s_cmp_lt_u32 s5, 100000
    s_cbranch_scc1 L_rt_p2X
L_rx_p2X:
    s_mov_b64 exec, -1
    s_branch L_ok_p2X
L_wc_G:
    s_cmp_eq_u32 s3, 0
    s_cbranch_scc1 L_pl_G_0
    s_cmp_eq_u32 s3, 1
    s_cbranch_scc1 L_pl_G_1
    s_cmp_eq_u32 s3, 2
    s_cbranch_scc1 L_pl_G_2
    s_branch L_pl_G_3
L_wc_X:
    s_cmp_eq_u32 s3, 0
    s_cbranch_scc1 L_pl_X_0
    s_cmp_eq_u32 s3, 1
    s_cbranch_scc1 L_pl_X_1
    s_cmp_eq_u32 s3, 2
    s_cbranch_scc1 L_pl_X_2
    s_branch L_pl_X_3
L_wc_D:
    s_cmp_eq_u32 s3, 0
    s_cbranch_scc1 L_pl_D_0
    s_cmp_eq_u32 s3, 1
    s_cbranch_scc1 L_pl_D_1
    s_cmp_eq_u32 s3, 2
    s_cbranch_scc1 L_pl_D_2
    s_branch L_wret
L_wret:
    s_setpc_b64 s[82:83]
.p2align 12
L_org:
    s_mul_i32 s7, s6, 21846
    s_lshr_b32 s7, s7, 16
    s_mul_i32 s8, s7, 3
    s_sub_u32 s12, s6, s8
    s_mul_i32 s8, s13, 9
    s_add_u32 s69, s8, s7
    s_lshl1_add_u32 s70, s12, s4
    s_mul_i32 s8, s69, 6
    s_add_u32 s75, s8, s70
    s_mov_b32 s48, s30
    s_and_b32 s49, s31, 0xffff
    s_mov_b32 s50, 18874368
    s_mov_b32 s51, 0x20000
    s_add_u32 s12, s12, s7
    s_mul_i32 s8, s12, 21846
    s_lshr_b32 s8, s8, 16
    s_mul_i32 s8, s8, 3
    s_sub_u32 s12, s12, s8
    s_mul_i32 s4, s4, 1179648
    s_mul_i32 s7, s12, 65538
    s_lshr_b32 s7, s7, 16
    s_mul_i32 s7, s7, 73728
    s_add_u32 s5, s4, 0
    s_add_u32 s18, s7, s5
    s_add_u32 s8, s5, 221184
    s_add_u32 s19, s18, 73728
    s_cmp_eq_u32 s19, s8
    s_cselect_b32 s19, s5, s19
    s_add_u32 s20, s19, 73728
    s_cmp_eq_u32 s20, s8
    s_cselect_b32 s20, s5, s20
    s_mul_i32 s7, s12, 65538
    s_lshr_b32 s7, s7, 16
    s_mul_i32 s7, s7, 73728
    s_add_u32 s5, s4, 221184
    s_add_u32 s21, s7, s5
    s_add_u32 s8, s5, 221184
    s_add_u32 s22, s21, 73728
    s_cmp_eq_u32 s22, s8
    s_cselect_b32 s22, s5, s22
    s_add_u32 s23, s22, 73728
    s_cmp_eq_u32 s23, s8
    s_cselect_b32 s23, s5, s23
    s_mul_i32 s7, s12, 87384
    s_lshr_b32 s7, s7, 16
    s_mul_i32 s7, s7, 73728
    s_add_u32 s5, s4, 442368
    s_add_u32 s24, s7, s5
    s_add_u32 s8, s5, 294912
    s_add_u32 s25, s24, 73728
    s_cmp_eq_u32 s25, s8
    s_cselect_b32 s25, s5, s25
    s_add_u32 s26, s25, 73728
    s_cmp_eq_u32 s26, s8
    s_cselect_b32 s26, s5, s26
    s_add_u32 s27, s26, 73728
    s_cmp_eq_u32 s27, s8
    s_cselect_b32 s27, s5, s27
    s_mul_i32 s7, s12, 131076
    s_lshr_b32 s7, s7, 16
    s_mul_i32 s7, s7, 73728
    s_add_u32 s5, s4, 737280
    s_add_u32 s76, s7, s5
    s_add_u32 s8, s5, 442368
    s_add_u32 s77, s76, 73728
    s_cmp_eq_u32 s77, s8
    s_cselect_b32 s77, s5, s77
    s_add_u32 s78, s77, 73728
    s_cmp_eq_u32 s78, s8
    s_cselect_b32 s78, s5, s78
    s_add_u32 s79, s78, 73728
    s_cmp_eq_u32 s79, s8
    s_cselect_b32 s79, s5, s79
    s_add_u32 s80, s79, 73728
    s_cmp_eq_u32 s80, s8
    s_cselect_b32 s80, s5, s80
    s_add_u32 s81, s80, 73728
    s_cmp_eq_u32 s81, s8
    s_cselect_b32 s81, s5, s81
    v_lshrrev_b32 v24, 4, v2
    v_and_b32 v25, 15, v2
    v_lshlrev_b32 v26, 1, v24
    v_xor_b32 v25, v25, v26
    v_mul_u32_u24 v24, 9216, v24
    v_lshl_add_u32 v24, v25, 4, v24
    s_mul_i32 s7, s3, 147456
    s_lshl_b32 s8, s69, 8
    s_add_u32 s7, s7, s8
    v_add_u32 v148, s7, v24
    v_add_u32 v149, 35840, v148
    v_xor_b32 v24, 128, v148
    v_add_u32 v150, 71680, v24
    v_add_u32 v151, 35840, v150
    s_mov_b32 s9, 144896
    s_mov_b32 s11, 114688
    v_mul_u32_u24 v48, 1216, v3
    v_mad_u32_u24 v48, v4, 12, v48
    v_add_u32 v48, s9, v48
    v_mov_b32 v47, 0x40000000
    v_lshlrev_b32 v3, 3, v3
    s_lshl_b32 s5, s68, 6
    s_add_u32 s5, s5, 12386304
    v_cmp_eq_u32 vcc, 0, v4
    s_nop 1
    v_cndmask_b32 v49, v47, v3, vcc
    v_lshrrev_b32 v5, 4, v0
    v_and_b32 v4, 3, v2
    v_lshlrev_b32 v4, 3, v4
    v_lshl_add_u32 v5, v5, 5, v4
    v_bfe_u32 v6, v2, 2, 2
    v_mul_u32_u24 v4, 1216, v6
    v_mul_u32_u24 v6, 1152, v6
    v_add3_u32 v50, v4, v5, s9
    v_add3_u32 v51, v6, v5, s11
    s_mul_i32 s4, s3, 2176
    v_add_u32 v55, s4, v51
    v_lshlrev_b32 v52, 4, v0
    s_add_u32 s7, s15, 4096
    s_add_u32 s8, s15, 8192
    s_cmp_eq_u32 s3, 0
    s_cselect_b32 s8, s8, 0x40000000
    v_add_u32 v53, 2359296, v52
    v_mov_b32 v54, 0
    s_mul_i32 s4, s3, 1028
    s_sub_u32 s4, 8204, s4
    v_add_u32 v90, s4, v53
    s_bfe_u32 s6, s68, 0x20001
    s_lshl_b32 s6, s6, 6
    s_lshr_b32 s9, s68, 3
    s_lshl1_add_u32 s6, s9, s6
    s_and_b32 s9, s68, 1
    s_add_u32 s6, s6, s9
    s_lshl_b32 s4, s6, 2
    s_add_u32 s4, s4, 12533760
    v_lshl_add_u32 v1, v0, 10, s4
    s_lshl_b32 s4, s68, 2
    s_add_u32 s4, s4, 12599296
    v_lshl_add_u32 v46, v0, 10, s4
    v_cmp_gt_u32 vcc, 8, v0
    s_nop 1
    v_cndmask_b32 v1, v47, v1, vcc
    v_cmp_gt_u32 vcc, 4, v0
    s_nop 1
    v_cndmask_b32 v46, v47, v46, vcc
    s_waitcnt vmcnt(9)
    v_and_b32 v21, 0xffff0000, v8
    s_add_u32 m0, s73, 81920
    s_lshl_b32 s14, s18, 3
    buffer_load_dwordx4 v148, s[48:51], s14 offen offset:0 lds
    v_lshlrev_b32 v20, 16, v8
    v_and_b32 v23, 0xffff0000, v9
    v_lshlrev_b32 v22, 16, v9
    v_and_b32 v25, 0xffff0000, v10
    v_lshlrev_b32 v24, 16, v10
    v_and_b32 v27, 0xffff0000, v12
    v_lshlrev_b32 v26, 16, v12
    v_and_b32 v29, 0xffff0000, v13
    v_lshlrev_b32 v28, 16, v13
    v_and_b32 v31, 0xffff0000, v14
    v_lshlrev_b32 v30, 16, v14
    v_and_b32 v33, 0xffff0000, v16
    v_lshlrev_b32 v32, 16, v16
    v_and_b32 v35, 0xffff0000, v17
    v_lshlrev_b32 v34, 16, v17
    v_and_b32 v37, 0xffff0000, v18
    v_lshlrev_b32 v36, 16, v18
    v_pk_add_f32 v[38:39], v[20:21], v[22:23]
    v_pk_add_f32 v[40:41], v[24:25], v[26:27]
    v_pk_add_f32 v[42:43], v[28:29], v[30:31]
    v_pk_add_f32 v[44:45], v[32:33], v[34:35]
    v_pk_add_f32 v[38:39], v[38:39], v[40:41]
    v_pk_add_f32 v[42:43], v[42:43], v[44:45]
    v_pk_add_f32 v[38:39], v[38:39], v[36:37]
    v_pk_add_f32 v[38:39], v[38:39], v[42:43]
    v_add_f32 v56, v38, v39
    buffer_load_dwordx4 v149, s[48:51], s14 offen offset:1024 lds
    s_nop 0
    v_add_f32_dpp v56, v56, v56 row_ror:8 row_mask:0xf bank_mask:0xf
    s_nop 1
    v_add_f32_dpp v56, v56, v56 row_ror:4 row_mask:0xf bank_mask:0xf
    s_nop 1
    v_add_f32_dpp v56, v56, v56 row_ror:2 row_mask:0xf bank_mask:0xf
    s_nop 1
    v_add_f32_dpp v56, v56, v56 row_ror:1 row_mask:0xf bank_mask:0xf
    v_mov_b32 v57, v56
    s_nop 1
    v_permlane16_swap_b32 v56, v57
    v_add_f32 v56, v56, v57
    v_mul_f32 v56, 0x3ae38e39, v56
    v_pk_add_f32 v[20:21], v[20:21], v[56:57] op_sel_hi:[1,0] neg_lo:[0,1] neg_hi:[0,1]
    v_pk_add_f32 v[22:23], v[22:23], v[56:57] op_sel_hi:[1,0] neg_lo:[0,1] neg_hi:[0,1]
    v_pk_add_f32 v[24:25], v[24:25], v[56:57] op_sel_hi:[1,0] neg_lo:[0,1] neg_hi:[0,1]
    v_pk_add_f32 v[26:27], v[26:27], v[56:57] op_sel_hi:[1,0] neg_lo:[0,1] neg_hi:[0,1]
    v_pk_add_f32 v[28:29], v[28:29], v[56:57] op_sel_hi:[1,0] neg_lo:[0,1] neg_hi:[0,1]
    v_pk_add_f32 v[30:31], v[30:31], v[56:57] op_sel_hi:[1,0] neg_lo:[0,1] neg_hi:[0,1]
    v_pk_add_f32 v[32:33], v[32:33], v[56:57] op_sel_hi:[1,0] neg_lo:[0,1] neg_hi:[0,1]
    v_pk_add_f32 v[34:35], v[34:35], v[56:57] op_sel_hi:[1,0] neg_lo:[0,1] neg_hi:[0,1]
    v_pk_add_f32 v[36:37], v[36:37], v[56:57] op_sel_hi:[1,0] neg_lo:[0,1] neg_hi:[0,1]
    v_pk_mul_f32 v[38:39], v[20:21], v[20:21]
    v_pk_mul_f32 v[40:41], v[22:23], v[22:23]
    v_pk_fma_f32 v[38:39], v[24:25], v[24:25], v[38:39]
    v_pk_fma_f32 v[40:41], v[26:27], v[26:27], v[40:41]
    v_pk_fma_f32 v[38:39], v[28:29], v[28:29], v[38:39]
    v_pk_fma_f32 v[40:41], v[30:31], v[30:31], v[40:41]
    v_pk_fma_f32 v[38:39], v[32:33], v[32:33], v[38:39]
    v_pk_fma_f32 v[40:41], v[34:35], v[34:35], v[40:41]
    v_pk_fma_f32 v[38:39], v[36:37], v[36:37], v[38:39]
    buffer_load_dwordx4 v150, s[48:51], s14 offen offset:2048 lds
    v_pk_add_f32 v[38:39], v[38:39], v[40:41]
    v_add_f32 v18, v38, v39
    s_nop 1
    v_add_f32_dpp v18, v18, v18 row_ror:8 row_mask:0xf bank_mask:0xf
    s_nop 1
    v_add_f32_dpp v18, v18, v18 row_ror:4 row_mask:0xf bank_mask:0xf
    s_nop 1
    v_add_f32_dpp v18, v18, v18 row_ror:2 row_mask:0xf bank_mask:0xf
    s_nop 1
    v_add_f32_dpp v18, v18, v18 row_ror:1 row_mask:0xf bank_mask:0xf
    v_mov_b32 v19, v18
    s_nop 1
    v_permlane16_swap_b32 v18, v19
    v_add_f32 v18, v18, v19
    v_mul_f32 v18, 0x3ae38e39, v18
    v_cvt_pk_bf16_f32 v38, v56, v18
    v_lshlrev_b32 v106, 16, v38
    v_and_b32 v38, 0xffff0000, v38
    v_add_f32 v38, 0x3727c5ac, v38
    v_sub_f32 v56, v56, v106
    v_cvt_pk_bf16_f32 v38, v38, v38
    v_lshlrev_b32 v38, 16, v38
    v_sqrt_f32 v38, v38
    s_nop 0
    v_cvt_pk_bf16_f32 v38, v38, v38
    v_lshlrev_b32 v38, 16, v38
    v_rcp_f32 v107, v38
    s_nop 0
    v_mul_f32 v56, v56, v107
    v_mul_f32 v18, v18, v107
    v_mul_f32 v18, v18, v107
    v_cvt_pk_bf16_f32 v38, v56, v18
    v_lshlrev_b32 v39, 16, v38
    buffer_load_dwordx4 v151, s[48:51], s14 offen offset:3072 lds
    v_and_b32 v38, 0xffff0000, v38
    v_add_f32 v38, 0x3727c5ac, v38
    v_sub_f32 v56, v56, v39
    v_cvt_pk_bf16_f32 v38, v38, v38
    v_lshlrev_b32 v38, 16, v38
    v_sqrt_f32 v38, v38
    s_nop 0
    v_cvt_pk_bf16_f32 v38, v38, v38
    v_lshlrev_b32 v38, 16, v38
    v_rcp_f32 v38, v38
    s_nop 0
    v_mul_f32 v18, v107, v38
    v_mul_f32 v56, v56, v38
    v_pk_fma_f32 v[20:21], v[20:21], v[18:19], v[56:57] op_sel_hi:[1,0,0]
    v_pk_fma_f32 v[22:23], v[22:23], v[18:19], v[56:57] op_sel_hi:[1,0,0]
    v_pk_fma_f32 v[24:25], v[24:25], v[18:19], v[56:57] op_sel_hi:[1,0,0]
    v_pk_fma_f32 v[26:27], v[26:27], v[18:19], v[56:57] op_sel_hi:[1,0,0]
    v_pk_fma_f32 v[28:29], v[28:29], v[18:19], v[56:57] op_sel_hi:[1,0,0]
    v_pk_fma_f32 v[30:31], v[30:31], v[18:19], v[56:57] op_sel_hi:[1,0,0]
    v_pk_fma_f32 v[32:33], v[32:33], v[18:19], v[56:57] op_sel_hi:[1,0,0]
    v_pk_fma_f32 v[34:35], v[34:35], v[18:19], v[56:57] op_sel_hi:[1,0,0]
    v_pk_fma_f32 v[36:37], v[36:37], v[18:19], v[56:57] op_sel_hi:[1,0,0]
    v_cvt_pk_bf16_f32 v8, v20, v21
    v_cvt_pk_bf16_f32 v9, v22, v23
    v_cvt_pk_bf16_f32 v10, v24, v25
    v_cvt_pk_bf16_f32 v11, v26, v27
    v_cvt_pk_bf16_f32 v12, v28, v29
    v_cvt_pk_bf16_f32 v13, v30, v31
    v_cvt_pk_bf16_f32 v14, v32, v33
    v_cvt_pk_bf16_f32 v15, v34, v35
    v_cvt_pk_bf16_f32 v16, v36, v37
    ds_write_b32 v48, v8 offset:0
    ds_write_b32 v48, v9 offset:4
    ds_write_b32 v48, v10 offset:8
    ds_write_b32 v48, v11 offset:384
    ds_write_b32 v48, v12 offset:388
    ds_write_b32 v48, v13 offset:392
    ds_write_b32 v48, v14 offset:768
    ds_write_b32 v48, v15 offset:772
    ds_write_b32 v48, v16 offset:776
    buffer_store_dwordx2 v[106:107], v49, s[44:47], s5 offen sc1
    s_waitcnt lgkmcnt(0)
    s_barrier
    ds_read_b64_tr_b16 v[20:21], v50 offset:0
    ds_read_b64_tr_b16 v[22:23], v50 offset:4864
    ds_read_b64_tr_b16 v[24:25], v50 offset:512
    ds_read_b64_tr_b16 v[26:27], v50 offset:5376
    ds_read_b64_tr_b16 v[28:29], v50 offset:1024
    ds_read_b64_tr_b16 v[30:31], v50 offset:5888
    s_waitcnt lgkmcnt(4)
    buffer_store_dwordx4 v[20:23], v52, s[44:47], s15 offen sc1
    s_waitcnt lgkmcnt(2)
    buffer_store_dwordx4 v[24:27], v52, s[44:47], s7 offen sc1
    s_waitcnt lgkmcnt(0)
    buffer_store_dwordx4 v[28:31], v52, s[44:47], s8 offen sc1
    buffer_load_dword v45, v54, s[64:67], 0 offen sc1
    s_waitcnt vmcnt(9)
    s_barrier
    ds_read_b64_tr_b16 v[60:61], v51 offset:0
    ds_read_b64_tr_b16 v[62:63], v51 offset:4608
    ds_read_b64_tr_b16 v[64:65], v51 offset:9216
    ds_read_b64_tr_b16 v[66:67], v51 offset:12672
    ds_read_b64_tr_b16 v[68:69], v51 offset:17280
    ds_read_b64_tr_b16 v[70:71], v51 offset:512
    ds_read_b64_tr_b16 v[72:73], v51 offset:5120
    ds_read_b64_tr_b16 v[74:75], v51 offset:9728
    ds_read_b64_tr_b16 v[76:77], v51 offset:13184
    ds_read_b64_tr_b16 v[78:79], v51 offset:17792
    v_alignbit_b32 v114, v99, v99, 16
    v_alignbit_b32 v115, v98, v98, 16
    s_waitcnt lgkmcnt(5)
    v_alignbit_b32 v108, v61, v60, 16
    v_alignbit_b32 v109, v62, v61, 16
    v_alignbit_b32 v110, v63, v62, 16
    v_alignbit_b32 v111, v64, v63, 16
    v_alignbit_b32 v112, v65, v64, 16
    v_dot2_f32_bf16 v116, v60, v114, 0
    ds_read_b64_tr_b16 v[80:81], v51 offset:1024
    v_dot2_f32_bf16 v117, v108, v114, 0
    v_dot2_f32_bf16 v118, v61, v114, 0
    v_dot2_f32_bf16 v119, v109, v114, 0
    v_dot2_f32_bf16 v120, v62, v114, 0
    ds_read_b64_tr_b16 v[82:83], v51 offset:5632
    v_dot2_f32_bf16 v121, v110, v114, 0
    v_dot2_f32_bf16 v122, v63, v114, 0
    v_dot2_f32_bf16 v123, v111, v114, 0
    v_dot2_f32_bf16 v116, v61, v115, v116
    v_dot2_f32_bf16 v117, v109, v115, v117
    ds_read_b64_tr_b16 v[84:85], v51 offset:10240
    v_dot2_f32_bf16 v118, v62, v115, v118
    v_dot2_f32_bf16 v119, v110, v115, v119
    v_dot2_f32_bf16 v120, v63, v115, v120
    v_dot2_f32_bf16 v121, v111, v115, v121
    v_dot2_f32_bf16 v122, v64, v115, v122
    ds_read_b64_tr_b16 v[86:87], v51 offset:13696
    v_dot2_f32_bf16 v123, v112, v115, v123
    v_and_b32 v133, 0xffff0000, v66
    v_lshlrev_b32 v132, 16, v66
    v_and_b32 v135, 0xffff0000, v67
    v_lshlrev_b32 v134, 16, v67
    ds_read_b64_tr_b16 v[88:89], v51 offset:18304
    v_and_b32 v137, 0xffff0000, v68
    v_lshlrev_b32 v136, 16, v68
    v_and_b32 v139, 0xffff0000, v69
    v_lshlrev_b32 v138, 16, v69
    v_pk_mul_f32 v[116:117], v[116:117], v[132:133]
    v_pk_mul_f32 v[118:119], v[118:119], v[134:135]
    v_pk_mul_f32 v[120:121], v[120:121], v[136:137]
    v_pk_mul_f32 v[122:123], v[122:123], v[138:139]
    v_cvt_pk_bf16_f32 v160, v123, v122
    v_cvt_pk_bf16_f32 v161, v121, v120
    v_cvt_pk_bf16_f32 v162, v119, v118
    v_cvt_pk_bf16_f32 v163, v117, v116
    buffer_store_dwordx4 v[160:163], v53, s[44:47], s15 offen sc1
    v_alignbit_b32 v114, v101, v101, 16
    v_alignbit_b32 v115, v100, v100, 16
    s_waitcnt lgkmcnt(5)
    v_alignbit_b32 v108, v71, v70, 16
    v_alignbit_b32 v109, v72, v71, 16
    v_alignbit_b32 v110, v73, v72, 16
    v_alignbit_b32 v111, v74, v73, 16
    v_alignbit_b32 v112, v75, v74, 16
    v_dot2_f32_bf16 v124, v70, v114, 0
    v_dot2_f32_bf16 v125, v108, v114, 0
    v_dot2_f32_bf16 v126, v71, v114, 0
    v_dot2_f32_bf16 v127, v109, v114, 0
    v_dot2_f32_bf16 v128, v72, v114, 0
    v_dot2_f32_bf16 v129, v110, v114, 0
    v_dot2_f32_bf16 v130, v73, v114, 0
    v_dot2_f32_bf16 v131, v111, v114, 0
    v_dot2_f32_bf16 v124, v71, v115, v124
    v_dot2_f32_bf16 v125, v109, v115, v125
    v_dot2_f32_bf16 v126, v72, v115, v126
    v_dot2_f32_bf16 v127, v110, v115, v127
    v_dot2_f32_bf16 v128, v73, v115, v128
    v_dot2_f32_bf16 v129, v111, v115, v129
    v_dot2_f32_bf16 v130, v74, v115, v130
    v_dot2_f32_bf16 v131, v112, v115, v131
    v_and_b32 v133, 0xffff0000, v76
    v_lshlrev_b32 v132, 16, v76
    v_and_b32 v135, 0xffff0000, v77
    v_lshlrev_b32 v134, 16, v77
    v_and_b32 v137, 0xffff0000, v78
    v_lshlrev_b32 v136, 16, v78
    v_and_b32 v139, 0xffff0000, v79
    v_lshlrev_b32 v138, 16, v79
    v_pk_mul_f32 v[124:125], v[124:125], v[132:133]
    v_pk_mul_f32 v[126:127], v[126:127], v[134:135]
    v_pk_mul_f32 v[128:129], v[128:129], v[136:137]
    v_pk_mul_f32 v[130:131], v[130:131], v[138:139]
    v_cvt_pk_bf16_f32 v164, v131, v130
    v_cvt_pk_bf16_f32 v165, v129, v128
    v_cvt_pk_bf16_f32 v166, v127, v126
    v_cvt_pk_bf16_f32 v167, v125, v124
    buffer_store_dwordx4 v[164:167], v53, s[44:47], s7 offen sc1
    v_alignbit_b32 v114, v103, v103, 16
    v_alignbit_b32 v115, v102, v102, 16
    s_waitcnt lgkmcnt(0)
    v_alignbit_b32 v108, v81, v80, 16
    v_alignbit_b32 v109, v82, v81, 16
    v_alignbit_b32 v110, v83, v82, 16
    v_alignbit_b32 v111, v84, v83, 16
    v_alignbit_b32 v112, v85, v84, 16
    v_dot2_f32_bf16 v116, v80, v114, 0
    v_dot2_f32_bf16 v117, v108, v114, 0
    v_dot2_f32_bf16 v118, v81, v114, 0
    v_dot2_f32_bf16 v119, v109, v114, 0
    v_dot2_f32_bf16 v120, v82, v114, 0
    v_dot2_f32_bf16 v121, v110, v114, 0
    v_dot2_f32_bf16 v122, v83, v114, 0
    v_dot2_f32_bf16 v123, v111, v114, 0
    v_dot2_f32_bf16 v116, v81, v115, v116
    v_dot2_f32_bf16 v117, v109, v115, v117
    v_dot2_f32_bf16 v118, v82, v115, v118
    v_dot2_f32_bf16 v119, v110, v115, v119
    v_dot2_f32_bf16 v120, v83, v115, v120
    v_dot2_f32_bf16 v121, v111, v115, v121
    v_dot2_f32_bf16 v122, v84, v115, v122
    v_dot2_f32_bf16 v123, v112, v115, v123
    v_and_b32 v133, 0xffff0000, v86
    v_lshlrev_b32 v132, 16, v86
    v_and_b32 v135, 0xffff0000, v87
    v_lshlrev_b32 v134, 16, v87
    v_and_b32 v137, 0xffff0000, v88
    v_lshlrev_b32 v136, 16, v88
    v_and_b32 v139, 0xffff0000, v89
    v_lshlrev_b32 v138, 16, v89
    v_pk_mul_f32 v[116:117], v[116:117], v[132:133]
    v_pk_mul_f32 v[118:119], v[118:119], v[134:135]
    v_pk_mul_f32 v[120:121], v[120:121], v[136:137]
    v_pk_mul_f32 v[122:123], v[122:123], v[138:139]
    v_cvt_pk_bf16_f32 v168, v123, v122
    v_cvt_pk_bf16_f32 v169, v121, v120
    v_cvt_pk_bf16_f32 v170, v119, v118
    v_cvt_pk_bf16_f32 v171, v117, v116
    buffer_store_dwordx4 v[168:171], v53, s[44:47], s8 offen sc1
    s_add_u32 m0, s73, 98304
    s_lshl_b32 s14, s19, 3
    buffer_load_dwordx4 v148, s[48:51], s14 offen offset:0 lds
    buffer_load_dwordx4 v149, s[48:51], s14 offen offset:1024 lds
    buffer_load_dwordx4 v150, s[48:51], s14 offen offset:2048 lds
    buffer_load_dwordx4 v151, s[48:51], s14 offen offset:3072 lds
    s_add_u32 m0, s73, 0
    s_lshl_b32 s14, s20, 3
    buffer_load_dwordx4 v148, s[48:51], s14 offen offset:0 lds
    buffer_load_dwordx4 v149, s[48:51], s14 offen offset:1024 lds
    buffer_load_dwordx4 v150, s[48:51], s14 offen offset:2048 lds
    buffer_load_dwordx4 v151, s[48:51], s14 offen offset:3072 lds
    s_add_u32 m0, s73, 16384
    s_lshl_b32 s14, s21, 3
    buffer_load_dwordx4 v148, s[48:51], s14 offen offset:0 lds
    buffer_load_dwordx4 v149, s[48:51], s14 offen offset:1024 lds
    s_waitcnt vmcnt(13)
    v_readfirstlane_b32 s68, v45
    s_nop 1
    s_cmp_eq_u32 s68, 0
    s_cbranch_scc1 L_nw_G
L_ng_G:
    s_barrier
    v_mov_b32 v3, s68
    buffer_store_dword v3, v1, s[44:47], 0 offen sc1
    s_mov_b64 exec, 0
    s_call_b64 s[82:83], L_wc_G
    s_mov_b64 exec, -1
    s_waitcnt vmcnt(11)
    s_barrier
    buffer_store_dword v3, v46, s[44:47], 0 offen sc1
L_segG:
L_pl_G_0:
    s_cbranch_execz L_pl_G_4
    buffer_load_dwordx4 v150, s[48:51], s14 offen offset:2048 lds
    buffer_load_dwordx4 v151, s[48:51], s14 offen offset:3072 lds
    s_add_u32 m0, s73, 32768
    s_lshl_b32 s14, s22, 3
    buffer_load_dwordx4 v148, s[48:51], s14 offen offset:0 lds
    buffer_load_dwordx4 v149, s[48:51], s14 offen offset:1024 lds
    buffer_load_dwordx4 v150, s[48:51], s14 offen offset:2048 lds
    buffer_load_dwordx4 v151, s[48:51], s14 offen offset:3072 lds
    s_add_u32 m0, s73, 49152
    s_lshl_b32 s14, s23, 3
    buffer_load_dwordx4 v148, s[48:51], s14 offen offset:0 lds
    buffer_load_dwordx4 v149, s[48:51], s14 offen offset:1024 lds
    buffer_load_dwordx4 v150, s[48:51], s14 offen offset:2048 lds
    buffer_load_dwordx4 v151, s[48:51], s14 offen offset:3072 lds
    s_add_u32 m0, s73, 65536
    s_lshl_b32 s14, s24, 3
    buffer_load_dwordx4 v148, s[48:51], s14 offen offset:0 lds
    buffer_load_dwordx4 v149, s[48:51], s14 offen offset:1024 lds
    buffer_load_dwordx4 v150, s[48:51], s14 offen offset:2048 lds
    buffer_load_dwordx4 v151, s[48:51], s14 offen offset:3072 lds
    v_bfe_u32 v140, v2, 2, 2
    v_lshrrev_b32 v141, 4, v2
    v_lshl_add_u32 v142, v141, 3, v140
    v_lshlrev_b32 v142, 8, v142
    v_and_b32 v143, 3, v2
    v_lshl_add_u32 v142, v143, 3, v142
    v_and_b32 v141, 1, v141
    v_lshl_add_u32 v140, v141, 2, v140
    s_lshl_b32 s7, s3, 1
    v_xor_b32 v140, s7, v140
    v_lshl_add_u32 v152, v140, 5, v142
    v_xor_b32 v153, 32, v152
    v_add_u32 v154, 0x10000, v152
    v_add_u32 v155, 0x10000, v153
    v_and_b32 v24, 15, v2
    v_lshrrev_b32 v25, 4, v2
    v_mul_u32_u24 v26, 17408, v25
    v_lshl_add_u32 v26, v24, 4, v26
    v_mul_u32_u24 v25, 1536, v25
    v_lshl_add_u32 v25, v24, 4, v25
    v_add_u32 v159, 81920, v25
    v_add_u32 v250, 36864, v159
    s_mul_i32 s7, s3, 18432
    s_xor_b32 s8, s70, 1
    s_mul_i32 s8, s8, 1536
    s_add_u32 s7, s7, s8
    v_lshlrev_b32 v246, 4, v2
    v_add_u32 v156, s7, v246
    v_lshrrev_b32 v25, 5, v2
    v_mul_u32_u24 v25, 7680, v25
    v_add_u32 v157, v156, v25
    v_add_u32 v158, 7680, v156
    s_mul_i32 s74, s3, 3072
    s_add_u32 s74, s74, 81920
    v_mov_b32 v245, v26
    s_mov_b64 exec, 0
    s_call_b64 s[82:83], L_wc_D
    s_mov_b64 exec, -1
    s_mov_b32 s56, s32
    s_and_b32 s57, s33, 0xffff
    s_mov_b32 s58, 9216
    s_mov_b32 s59, 0x20000
    s_mov_b32 s60, s36
    s_and_b32 s61, s37, 0xffff
    s_mov_b32 s62, 4096
    s_mov_b32 s63, 0x20000
    s_and_b32 s4, s70, 1
    s_lshl1_add_u32 s4, s3, s4
    s_lshl_b32 s4, s4, 7
    s_bfe_u32 s5, s2, 0x10003
    s_lshl1_add_u32 s5, s72, s5
    s_lshr_b32 s5, s5, 0
    s_lshl_b32 s5, s5, 10
    s_add_u32 s4, s4, s5
    s_add_u32 s4, s4, 12533760
    v_lshl_add_u32 v28, v2, 2, s4
    v_cmp_gt_u32 vcc, 32, v2
    v_mov_b32 v12, 0x40000000
    s_nop 0
    v_cndmask_b32 v28, v12, v28, vcc
    v_mov_b32 v12, s68
    v_cndmask_b32 v12, 0, v12, vcc
    v_lshrrev_b32 v24, 4, v2
    v_lshlrev_b32 v25, 3, v24
    s_lshl_b32 s7, s69, 8
    s_lshl_b32 s8, s3, 6
    s_add_u32 s7, s7, s8
    buffer_load_dwordx2 v[144:145], v25, s[56:59], s7 offen
    buffer_load_dwordx2 v[146:147], v25, s[56:59], s7 offen offset:32
    s_waitcnt vmcnt(24)
    s_barrier
    ds_read_b64_tr_b16 a[0:1], v154 offset:16384
    ds_read_b64_tr_b16 a[2:3], v154 offset:17408
    ds_read_b64_tr_b16 a[4:5], v155 offset:16384
    ds_read_b64_tr_b16 a[6:7], v155 offset:17408
    ds_read_b64_tr_b16 a[8:9], v154 offset:24576
    ds_read_b64_tr_b16 a[10:11], v154 offset:25600
    ds_read_b64_tr_b16 a[12:13], v155 offset:24576
    ds_read_b64_tr_b16 a[14:15], v155 offset:25600
    ds_read_b64_tr_b16 a[16:17], v154 offset:32768
    ds_read_b64_tr_b16 a[18:19], v154 offset:33792
    ds_read_b64_tr_b16 a[20:21], v155 offset:32768
    ds_read_b64_tr_b16 a[22:23], v155 offset:33792
    ds_read_b64_tr_b16 a[24:25], v154 offset:40960
    ds_read_b64_tr_b16 a[26:27], v154 offset:41984
    ds_read_b64_tr_b16 a[28:29], v155 offset:40960
    ds_read_b64_tr_b16 a[30:31], v155 offset:41984
    s_waitcnt vmcnt(20)
    s_barrier
    ds_read_b64_tr_b16 a[32:33], v152 offset:0
    ds_read_b64_tr_b16 a[34:35], v152 offset:1024
    ds_read_b64_tr_b16 a[36:37], v153 offset:0
    ds_read_b64_tr_b16 a[38:39], v153 offset:1024
    ds_read_b64_tr_b16 a[40:41], v152 offset:8192
    ds_read_b64_tr_b16 a[42:43], v152 offset:9216
    ds_read_b64_tr_b16 a[44:45], v153 offset:8192
    ds_read_b64_tr_b16 a[46:47], v153 offset:9216
    s_waitcnt vmcnt(14)
    s_barrier
    ds_read_b64_tr_b16 a[48:49], v152 offset:16384
    ds_read_b64_tr_b16 a[50:51], v152 offset:17408
    ds_read_b64_tr_b16 a[52:53], v153 offset:16384
    ds_read_b64_tr_b16 a[54:55], v153 offset:17408
    ds_read_b64_tr_b16 a[56:57], v152 offset:24576
    ds_read_b64_tr_b16 a[58:59], v152 offset:25600
    ds_read_b64_tr_b16 a[60:61], v153 offset:24576
    ds_read_b64_tr_b16 a[62:63], v153 offset:25600
    v_mov_b32 v29, 0
    buffer_atomic_add v29, v28, s[44:47], 0 offen sc0 sc1
    s_waitcnt vmcnt(11)
    s_barrier
    ds_read_b64_tr_b16 a[64:65], v152 offset:32768
    ds_read_b64_tr_b16 a[66:67], v152 offset:33792
    ds_read_b64_tr_b16 a[68:69], v153 offset:32768
    ds_read_b64_tr_b16 a[70:71], v153 offset:33792
    ds_read_b64_tr_b16 a[72:73], v152 offset:40960
    ds_read_b64_tr_b16 a[74:75], v152 offset:41984
    ds_read_b64_tr_b16 a[76:77], v153 offset:40960
    ds_read_b64_tr_b16 a[78:79], v153 offset:41984
    s_waitcnt lgkmcnt(0)
    s_barrier
    s_waitcnt vmcnt(0)
    v_cmp_ne_u32 vcc, v12, v29
    s_cbranch_vccnz L_rs_p1G
L_ok_p1G:
    s_add_u32 m0, s74, 0
    s_nop 0
    buffer_load_dwordx4 v156, s[44:47], s18 offen offset:0 sc1 lds
    buffer_load_dwordx4 v157, s[44:47], s18 offen offset:1024 sc1 lds
    buffer_load_dwordx4 v158, s[44:47], s18 offen offset:2048 sc1 lds
    s_add_u32 m0, s74, 12288
    s_nop 0
    buffer_load_dwordx4 v156, s[44:47], s19 offen offset:0 sc1 lds
    buffer_load_dwordx4 v157, s[44:47], s19 offen offset:1024 sc1 lds
    buffer_load_dwordx4 v158, s[44:47], s19 offen offset:2048 sc1 lds
    s_add_u32 m0, s74, 24576
    s_nop 0
    buffer_load_dwordx4 v156, s[44:47], s20 offen offset:0 sc1 lds
    buffer_load_dwordx4 v157, s[44:47], s20 offen offset:1024 sc1 lds
    buffer_load_dwordx4 v158, s[44:47], s20 offen offset:2048 sc1 lds
L_pl_G_1:
    s_cbranch_execz L_pl_G_5
    s_add_u32 m0, s74, 36864
    s_nop 0
    buffer_load_dwordx4 v156, s[44:47], s21 offen offset:0 sc1 lds
    buffer_load_dwordx4 v157, s[44:47], s21 offen offset:1024 sc1 lds
    buffer_load_dwordx4 v158, s[44:47], s21 offen offset:2048 sc1 lds
    s_add_u32 m0, s73, 0
    s_lshl_b32 s14, s25, 3
    buffer_load_dwordx4 v148, s[48:51], s14 offen offset:0 lds
    buffer_load_dwordx4 v149, s[48:51], s14 offen offset:1024 lds
    buffer_load_dwordx4 v150, s[48:51], s14 offen offset:2048 lds
    buffer_load_dwordx4 v151, s[48:51], s14 offen offset:3072 lds
    s_waitcnt vmcnt(13) lgkmcnt(0)
    s_barrier
    ds_read_b128 v[80:83], v159 offset:0
    ds_read_b128 v[84:87], v159 offset:6144
    ds_read_b128 v[88:91], v159 offset:256
    ds_read_b128 v[92:95], v159 offset:6400
    ds_read_b128 v[96:99], v159 offset:512
    ds_read_b128 v[100:103], v159 offset:6656
    s_waitcnt lgkmcnt(0)
    v_mfma_f32_16x16x32_bf16 v[192:195], a[0:3], v[80:83], 0
    v_mfma_f32_16x16x32_bf16 v[192:195], a[8:11], v[84:87], v[192:195]
    ds_read_b128 v[104:107], v159 offset:768
    v_mfma_f32_16x16x32_bf16 v[196:199], a[12:15], v[84:87], 0
    ds_read_b128 v[108:111], v159 offset:6912
    v_mfma_f32_16x16x32_bf16 v[196:199], a[4:7], v[80:83], v[196:199]
    ds_read_b128 v[112:115], v159 offset:1024
    v_mfma_f32_16x16x32_bf16 v[204:207], a[4:7], v[88:91], 0
    ds_read_b128 v[116:119], v159 offset:7168
    v_mfma_f32_16x16x32_bf16 v[204:207], a[12:15], v[92:95], v[204:207]
    ds_read_b128 v[120:123], v159 offset:1280
    v_mfma_f32_16x16x32_bf16 v[200:203], a[8:11], v[92:95], 0
    ds_read_b128 v[124:127], v159 offset:7424
    v_and_b32 v24, 15, v2
    s_lshl_b32 s7, s71, 6
    v_add_u32 v24, s7, v24
    s_and_b32 s8, s3, 1
    s_lshl_b32 s4, s8, 5
    v_add_u32 v25, s4, v24
    v_lshlrev_b32 v26, 3, v25
    v_mul_u32_u24 v25, 1152, v25
    v_bfe_u32 v31, v2, 4, 1
    v_lshl_add_u32 v25, v31, 5, v25
    v_lshrrev_b32 v31, 5, v2
    v_lshl_add_u32 v25, v31, 4, v25
    s_bfe_u32 s7, s2, 0x20003
    s_mul_i32 s7, s7, 288
    s_lshl_b32 s4, s72, 6
    s_add_u32 s4, s4, s7
    v_add_u32 v252, s4, v25
    s_xor_b32 s8, s3, s72
    s_and_b32 s4, s72, 1
    s_lshl1_add_u32 s4, s4, s8
    v_lshl_add_u32 v24, s4, 4, v24
    s_add_u32 s7, s7, 256
    s_cmp_lt_u32 s8, 2
    s_cselect_b32 s7, s7, 0x40000000
    v_lshlrev_b32 v18, 3, v24
    v_mul_u32_u24 v24, 1152, v24
    v_lshrrev_b32 v31, 4, v2
    v_lshl_add_u32 v24, v31, 3, v24
    v_add_u32 v253, s7, v24
    v_lshrrev_b32 v24, 3, v2
    v_mfma_f32_16x16x32_bf16 v[200:203], a[0:3], v[88:91], v[200:203]
    v_mfma_f32_16x16x32_bf16 v[208:211], a[0:3], v[96:99], 0
    v_mfma_f32_16x16x32_bf16 v[208:211], a[8:11], v[100:103], v[208:211]
    v_mfma_f32_16x16x32_bf16 v[212:215], a[12:15], v[100:103], 0
    v_mfma_f32_16x16x32_bf16 v[212:215], a[4:7], v[96:99], v[212:215]
    s_waitcnt lgkmcnt(0)
    v_mfma_f32_16x16x32_bf16 v[220:223], a[4:7], v[104:107], 0
    s_waitcnt vmcnt(10)
    s_barrier
    v_mfma_f32_16x16x32_bf16 v[220:223], a[12:15], v[108:111], v[220:223]
    ds_read_b128 v[80:83], v159 offset:12288
    s_add_u32 m0, s74, 49152
    v_mfma_f32_16x16x32_bf16 v[216:219], a[8:11], v[108:111], 0
    ds_read_b128 v[84:87], v159 offset:18432
    buffer_load_dwordx4 v156, s[44:47], s22 offen offset:0 sc1 lds
    v_mfma_f32_16x16x32_bf16 v[216:219], a[0:3], v[104:107], v[216:219]
    ds_read_b128 v[88:91], v159 offset:12544
    v_mfma_f32_16x16x32_bf16 v[224:227], a[0:3], v[112:115], 0
    ds_read_b128 v[92:95], v159 offset:18688
    buffer_load_dwordx4 v157, s[44:47], s22 offen offset:1024 sc1 lds
    v_mfma_f32_16x16x32_bf16 v[224:227], a[8:11], v[116:119], v[224:227]
    ds_read_b128 v[96:99], v159 offset:12800
    v_mfma_f32_16x16x32_bf16 v[228:231], a[12:15], v[116:119], 0
    ds_read_b128 v[100:103], v159 offset:18944
    buffer_load_dwordx4 v158, s[44:47], s22 offen offset:2048 sc1 lds
    v_and_b32 v25, 7, v2
    v_bfe_u32 v31, v2, 4, 2
    v_lshlrev_b32 v31, 1, v31
    v_xor_b32 v25, v25, v31
    v_lshlrev_b32 v24, 12, v24
    v_lshl_add_u32 v24, v25, 4, v24
    s_mul_i32 s7, s72, 36
    s_bitcmp1_b32 s3, 0
    s_addc_u32 s7, s7, 0
    s_lshl_b32 s7, s7, 17
    s_lshl_b32 s8, s71, 7
    s_add_u32 s7, s7, s8
    v_add_u32 v4, s7, v24
    v_add_u32 v5, 31744, v4
    v_add_u32 v6, 31744, v5
    v_add_u32 v7, 31744, v6
    v_lshrrev_b32 v24, 2, v2
    v_lshlrev_b32 v24, 7, v24
    v_and_b32 v25, 3, v2
    v_lshl_add_u32 v24, v25, 3, v24
    s_and_b32 s7, s73, 8192
    v_add_u32 v24, s7, v24
    v_bfe_u32 v31, v2, 3, 2
    s_and_b32 s7, s3, 1
    s_lshl_b32 s7, s7, 1
    v_xor_b32 v31, s7, v31
    v_lshl_add_u32 v10, v31, 5, v24
    v_xor_b32 v11, 32, v10
    s_mul_i32 s84, s101, 14
    s_lshr_b32 s84, s84, 2
    s_add_u32 s84, s84, 0
    s_add_u32 s85, s84, 1
    s_cmp_eq_u32 s85, 14
    s_cselect_b32 s85, 0, s85
    v_mfma_f32_16x16x32_bf16 v[228:231], a[4:7], v[112:115], v[228:231]
    ds_read_b64_tr_b16 a[80:81], v152 offset:49152
    v_mfma_f32_16x16x32_bf16 v[236:239], a[4:7], v[120:123], 0
    ds_read_b64_tr_b16 a[82:83], v152 offset:50176
    s_add_u32 m0, s74, 61440
    v_mfma_f32_16x16x32_bf16 v[236:239], a[12:15], v[124:127], v[236:239]
    v_mfma_f32_16x16x32_bf16 v[232:235], a[8:11], v[124:127], 0
    ds_read_b64_tr_b16 a[84:85], v153 offset:49152
    buffer_load_dwordx4 v156, s[44:47], s23 offen offset:0 sc1 lds
    v_mfma_f32_16x16x32_bf16 v[232:235], a[0:3], v[120:123], v[232:235]
    ds_read_b64_tr_b16 a[86:87], v153 offset:50176
    s_waitcnt lgkmcnt(4)
    v_mfma_f32_16x16x32_bf16 v[192:195], a[16:19], v[80:83], v[192:195]
    buffer_load_dwordx4 v157, s[44:47], s23 offen offset:1024 sc1 lds
    v_mfma_f32_16x16x32_bf16 v[192:195], a[24:27], v[84:87], v[192:195]
    ds_read_b128 v[104:107], v159 offset:13056
    buffer_load_dwordx4 v158, s[44:47], s23 offen offset:2048 sc1 lds
    v_mfma_f32_16x16x32_bf16 v[196:199], a[28:31], v[84:87], v[196:199]
    ds_read_b128 v[108:111], v159 offset:19200
    v_mfma_f32_16x16x32_bf16 v[196:199], a[20:23], v[80:83], v[196:199]
    ds_read_b128 v[112:115], v159 offset:13312
    s_add_u32 m0, s73, 16384
    s_lshl_b32 s14, s26, 3
    v_mfma_f32_16x16x32_bf16 v[204:207], a[20:23], v[88:91], v[204:207]
    ds_read_b128 v[116:119], v159 offset:19456
    v_mfma_f32_16x16x32_bf16 v[204:207], a[28:31], v[92:95], v[204:207]
    ds_read_b128 v[120:123], v159 offset:13568
    buffer_load_dwordx4 v148, s[48:51], s14 offen offset:0 lds
    v_mfma_f32_16x16x32_bf16 v[200:203], a[24:27], v[92:95], v[200:203]
    ds_read_b128 v[124:127], v159 offset:19712
    buffer_load_dwordx4 v149, s[48:51], s14 offen offset:1024 lds
    s_add_u32 s86, s85, 1
    s_cmp_eq_u32 s86, 14
    s_cselect_b32 s86, 0, s86
    s_add_u32 s87, s86, 1
    s_cmp_eq_u32 s87, 14
    s_cselect_b32 s87, 0, s87
    s_add_u32 s88, s87, 1
    s_cmp_eq_u32 s88, 14
    s_cselect_b32 s88, 0, s88
    s_add_u32 s89, s88, 1
    s_cmp_eq_u32 s89, 14
    s_cselect_b32 s89, 0, s89
    s_add_u32 s90, s89, 1
    s_cmp_eq_u32 s90, 14
    s_cselect_b32 s90, 0, s90
    s_add_u32 s91, s90, 1
    s_cmp_eq_u32 s91, 14
    s_cselect_b32 s91, 0, s91
    s_add_u32 s92, s91, 1
    s_cmp_eq_u32 s92, 14
    s_cselect_b32 s92, 0, s92
    s_add_u32 s93, s92, 1
    s_cmp_eq_u32 s93, 14
    s_cselect_b32 s93, 0, s93
    s_add_u32 s94, s93, 1
    s_cmp_eq_u32 s94, 14
    s_cselect_b32 s94, 0, s94
    s_add_u32 s95, s94, 1
    s_cmp_eq_u32 s95, 14
    s_cselect_b32 s95, 0, s95
    s_add_u32 s96, s95, 1
    s_cmp_eq_u32 s96, 14
    s_cselect_b32 s96, 0, s96
    s_add_u32 s97, s96, 1
    s_cmp_eq_u32 s97, 14
    s_cselect_b32 s97, 0, s97
    s_mul_i32 s98, s101, 4
    s_lshr_b32 s98, s98, 2
    s_add_u32 s98, s98, 14
    s_add_u32 s99, s98, 1
    s_cmp_eq_u32 s99, 18
    s_cselect_b32 s99, 14, s99
    s_add_u32 s100, s99, 1
    s_cmp_eq_u32 s100, 18
    s_cselect_b32 s100, 14, s100
    s_add_u32 s101, s100, 1
    s_cmp_eq_u32 s101, 18
    s_cselect_b32 s101, 14, s101
    s_mul_i32 s7, s70, 6
    s_add_u32 s7, s7, 0
    s_mul_i32 s8, s7, 7282
    s_lshr_b32 s8, s8, 16
    s_mul_i32 s5, s8, 9
    s_sub_u32 s7, s7, s5
    s_lshl_b32 s7, s7, 2
    s_mov_b32 s4, 0xeca86420
    s_mov_b32 s5, 3
    s_lshr_b64 s[4:5], s[4:5], s7
    v_mfma_f32_16x16x32_bf16 v[200:203], a[16:19], v[88:91], v[200:203]
    ds_read_b64_tr_b16 a[88:89], v152 offset:57344
    v_mfma_f32_16x16x32_bf16 v[208:211], a[16:19], v[96:99], v[208:211]
    ds_read_b64_tr_b16 a[90:91], v152 offset:58368
    buffer_load_dwordx4 v150, s[48:51], s14 offen offset:2048 lds
    v_mfma_f32_16x16x32_bf16 v[208:211], a[24:27], v[100:103], v[208:211]
    v_mfma_f32_16x16x32_bf16 v[212:215], a[28:31], v[100:103], v[212:215]
    ds_read_b64_tr_b16 a[92:93], v153 offset:57344
    buffer_load_dwordx4 v151, s[48:51], s14 offen offset:3072 lds
    v_mfma_f32_16x16x32_bf16 v[212:215], a[20:23], v[96:99], v[212:215]
    ds_read_b64_tr_b16 a[94:95], v153 offset:58368
    s_waitcnt lgkmcnt(4)
    v_mfma_f32_16x16x32_bf16 v[220:223], a[20:23], v[104:107], v[220:223]
    s_waitcnt vmcnt(17)
    s_barrier
    v_mfma_f32_16x16x32_bf16 v[220:223], a[28:31], v[108:111], v[220:223]
    ds_read_b128 v[80:83], v159 offset:24576
    s_add_u32 m0, s74, 0
    v_mfma_f32_16x16x32_bf16 v[216:219], a[24:27], v[108:111], v[216:219]
    ds_read_b128 v[84:87], v159 offset:30720
    buffer_load_dwordx4 v156, s[44:47], s24 offen offset:0 sc1 lds
    v_mfma_f32_16x16x32_bf16 v[216:219], a[16:19], v[104:107], v[216:219]
    ds_read_b128 v[88:91], v159 offset:24832
    v_mfma_f32_16x16x32_bf16 v[224:227], a[16:19], v[112:115], v[224:227]
    ds_read_b128 v[92:95], v159 offset:30976
    buffer_load_dwordx4 v157, s[44:47], s24 offen offset:1024 sc1 lds
    v_mfma_f32_16x16x32_bf16 v[224:227], a[24:27], v[116:119], v[224:227]
    ds_read_b128 v[96:99], v159 offset:25088
    v_mfma_f32_16x16x32_bf16 v[228:231], a[28:31], v[116:119], v[228:231]
    ds_read_b128 v[100:103], v159 offset:31232
    buffer_load_dwordx4 v158, s[44:47], s24 offen offset:2048 sc1 lds
    s_and_b32 s4, s4, 15
    s_lshl4_add_u32 s4, s8, s4
    v_lshl_add_u32 v240, s4, 8, v245
    s_mul_i32 s7, s70, 6
    s_add_u32 s7, s7, 1
    s_mul_i32 s8, s7, 7282
    s_lshr_b32 s8, s8, 16
    s_mul_i32 s5, s8, 9
    s_sub_u32 s7, s7, s5
    s_lshl_b32 s7, s7, 2
    s_mov_b32 s4, 0xeca86420
    s_mov_b32 s5, 3
    s_lshr_b64 s[4:5], s[4:5], s7
    s_and_b32 s4, s4, 15
    s_lshl4_add_u32 s4, s8, s4
    v_lshl_add_u32 v241, s4, 8, v245
    s_mul_i32 s7, s70, 6
    s_add_u32 s7, s7, 2
    s_mul_i32 s8, s7, 7282
    s_lshr_b32 s8, s8, 16
    s_mul_i32 s5, s8, 9
    s_sub_u32 s7, s7, s5
    s_lshl_b32 s7, s7, 2
    s_mov_b32 s4, 0xeca86420
    s_mov_b32 s5, 3
    s_lshr_b64 s[4:5], s[4:5], s7
    v_mfma_f32_16x16x32_bf16 v[228:231], a[20:23], v[112:115], v[228:231]
    ds_read_b64_tr_b16 a[96:97], v154 offset:0
    v_mfma_f32_16x16x32_bf16 v[236:239], a[20:23], v[120:123], v[236:239]
    ds_read_b64_tr_b16 a[98:99], v154 offset:1024
    s_add_u32 m0, s74, 12288
    v_mfma_f32_16x16x32_bf16 v[236:239], a[28:31], v[124:127], v[236:239]
    v_mfma_f32_16x16x32_bf16 v[232:235], a[24:27], v[124:127], v[232:235]
    ds_read_b64_tr_b16 a[100:101], v155 offset:0
    buffer_load_dwordx4 v156, s[44:47], s25 offen offset:0 sc1 lds
    v_mfma_f32_16x16x32_bf16 v[232:235], a[16:19], v[120:123], v[232:235]
    ds_read_b64_tr_b16 a[102:103], v155 offset:1024
    s_waitcnt lgkmcnt(4)
    v_mfma_f32_16x16x32_bf16 v[192:195], a[32:35], v[80:83], v[192:195]
    buffer_load_dwordx4 v157, s[44:47], s25 offen offset:1024 sc1 lds
    v_mfma_f32_16x16x32_bf16 v[192:195], a[40:43], v[84:87], v[192:195]
    ds_read_b128 v[104:107], v159 offset:25344
    buffer_load_dwordx4 v158, s[44:47], s25 offen offset:2048 sc1 lds
    v_mfma_f32_16x16x32_bf16 v[196:199], a[44:47], v[84:87], v[196:199]
    ds_read_b128 v[108:111], v159 offset:31488
    v_mfma_f32_16x16x32_bf16 v[196:199], a[36:39], v[80:83], v[196:199]
    ds_read_b128 v[112:115], v159 offset:25600
    s_add_u32 m0, s73, 32768
    s_lshl_b32 s14, s27, 3
    v_mfma_f32_16x16x32_bf16 v[204:207], a[36:39], v[88:91], v[204:207]
    ds_read_b128 v[116:119], v159 offset:31744
    v_mfma_f32_16x16x32_bf16 v[204:207], a[44:47], v[92:95], v[204:207]
    ds_read_b128 v[120:123], v159 offset:25856
    buffer_load_dwordx4 v148, s[48:51], s14 offen offset:0 lds
    v_mfma_f32_16x16x32_bf16 v[200:203], a[40:43], v[92:95], v[200:203]
    ds_read_b128 v[124:127], v159 offset:32000
    buffer_load_dwordx4 v149, s[48:51], s14 offen offset:1024 lds
    s_and_b32 s4, s4, 15
    s_lshl4_add_u32 s4, s8, s4
    v_lshl_add_u32 v242, s4, 8, v245
    s_mul_i32 s7, s70, 6
    s_add_u32 s7, s7, 3
    s_mul_i32 s8, s7, 7282
    s_lshr_b32 s8, s8, 16
    s_mul_i32 s5, s8, 9
    s_sub_u32 s7, s7, s5
    s_lshl_b32 s7, s7, 2
    s_mov_b32 s4, 0xeca86420
    s_mov_b32 s5, 3
    s_lshr_b64 s[4:5], s[4:5], s7
    s_and_b32 s4, s4, 15
    s_lshl4_add_u32 s4, s8, s4
    v_lshl_add_u32 v243, s4, 8, v245
    s_mul_i32 s7, s70, 6
    s_add_u32 s7, s7, 4
    s_mul_i32 s8, s7, 7282
    s_lshr_b32 s8, s8, 16
    s_mul_i32 s5, s8, 9
    s_sub_u32 s7, s7, s5
    s_lshl_b32 s7, s7, 2
    s_mov_b32 s4, 0xeca86420
    v_mfma_f32_16x16x32_bf16 v[200:203], a[32:35], v[88:91], v[200:203]
    ds_read_b64_tr_b16 a[104:105], v154 offset:8192
    v_mfma_f32_16x16x32_bf16 v[208:211], a[32:35], v[96:99], v[208:211]
    ds_read_b64_tr_b16 a[106:107], v154 offset:9216
    buffer_load_dwordx4 v150, s[48:51], s14 offen offset:2048 lds
    v_mfma_f32_16x16x32_bf16 v[208:211], a[40:43], v[100:103], v[208:211]
    v_mfma_f32_16x16x32_bf16 v[212:215], a[44:47], v[100:103], v[212:215]
    ds_read_b64_tr_b16 a[108:109], v155 offset:8192
    buffer_load_dwordx4 v151, s[48:51], s14 offen offset:3072 lds
    v_mfma_f32_16x16x32_bf16 v[212:215], a[36:39], v[96:99], v[212:215]
    ds_read_b64_tr_b16 a[110:111], v155 offset:9216
    s_waitcnt lgkmcnt(4)
    v_mfma_f32_16x16x32_bf16 v[220:223], a[36:39], v[104:107], v[220:223]
    s_waitcnt vmcnt(20)
    s_barrier
    v_mfma_f32_16x16x32_bf16 v[220:223], a[44:47], v[108:111], v[220:223]
    ds_read_b128 v[80:83], v250 offset:0
    s_add_u32 m0, s74, 24576
    v_mfma_f32_16x16x32_bf16 v[216:219], a[40:43], v[108:111], v[216:219]
    ds_read_b128 v[84:87], v250 offset:6144
    v_mfma_f32_16x16x32_bf16 v[216:219], a[32:35], v[104:107], v[216:219]
    ds_read_b128 v[88:91], v250 offset:256
    buffer_load_dwordx4 v156, s[44:47], s26 offen offset:0 sc1 lds
    v_mfma_f32_16x16x32_bf16 v[224:227], a[32:35], v[112:115], v[224:227]
    ds_read_b128 v[92:95], v250 offset:6400
    v_mfma_f32_16x16x32_bf16 v[224:227], a[40:43], v[116:119], v[224:227]
    ds_read_b128 v[96:99], v250 offset:512
    v_mfma_f32_16x16x32_bf16 v[228:231], a[44:47], v[116:119], v[228:231]
    ds_read_b128 v[100:103], v250 offset:6656
    buffer_load_dwordx4 v157, s[44:47], s26 offen offset:1024 sc1 lds
    s_mov_b32 s5, 3
    s_lshr_b64 s[4:5], s[4:5], s7
    s_and_b32 s4, s4, 15
    s_lshl4_add_u32 s4, s8, s4
    v_lshl_add_u32 v244, s4, 8, v245
    s_mul_i32 s7, s70, 6
    s_add_u32 s7, s7, 5
    s_mul_i32 s8, s7, 7282
    s_lshr_b32 s8, s8, 16
    s_mul_i32 s5, s8, 9
    s_sub_u32 s7, s7, s5
    s_lshl_b32 s7, s7, 2
    s_mov_b32 s4, 0xeca86420
    s_mov_b32 s5, 3
    s_lshr_b64 s[4:5], s[4:5], s7
    s_and_b32 s4, s4, 15
    s_lshl4_add_u32 s4, s8, s4
    v_lshl_add_u32 v245, s4, 8, v245
    s_xor_b32 s7, s75, 1
    s_lshl2_add_u32 s7, s7, s3
    s_mul_i32 s9, s7, 6144
    s_add_u32 s9, s9, 7077888
    s_lshl_b32 s7, s7, 7
    s_add_u32 s6, s7, 22822912
    s_lshl2_add_u32 s7, s75, s3
    s_mul_i32 s10, s7, 6144
    s_add_u32 s10, s10, 7077888
    s_lshl_b32 s7, s7, 7
    v_mfma_f32_16x16x32_bf16 v[228:231], a[36:39], v[112:115], v[228:231]
    ds_read_b64_tr_b16 a[112:113], v152 offset:0
    v_mfma_f32_16x16x32_bf16 v[236:239], a[36:39], v[120:123], v[236:239]
    ds_read_b64_tr_b16 a[114:115], v152 offset:1024
    v_mfma_f32_16x16x32_bf16 v[236:239], a[44:47], v[124:127], v[236:239]
    buffer_load_dwordx4 v158, s[44:47], s26 offen offset:2048 sc1 lds
    v_mfma_f32_16x16x32_bf16 v[232:235], a[40:43], v[124:127], v[232:235]
    ds_read_b64_tr_b16 a[116:117], v153 offset:0
    v_mfma_f32_16x16x32_bf16 v[232:235], a[32:35], v[120:123], v[232:235]
    ds_read_b64_tr_b16 a[118:119], v153 offset:1024
    s_waitcnt lgkmcnt(4)
    v_mfma_f32_16x16x32_bf16 v[192:195], a[48:51], v[80:83], v[192:195]
    s_add_u32 m0, s73, 49152
    s_lshl_b32 s14, s76, 3
    v_mfma_f32_16x16x32_bf16 v[192:195], a[56:59], v[84:87], v[192:195]
    ds_read_b128 v[104:107], v250 offset:768
    v_mfma_f32_16x16x32_bf16 v[196:199], a[60:63], v[84:87], v[196:199]
    ds_read_b128 v[108:111], v250 offset:6912
    buffer_load_dwordx4 v148, s[48:51], s14 offen offset:0 lds
    v_mfma_f32_16x16x32_bf16 v[196:199], a[52:55], v[80:83], v[196:199]
    ds_read_b128 v[112:115], v250 offset:1024
    v_mfma_f32_16x16x32_bf16 v[204:207], a[52:55], v[88:91], v[204:207]
    ds_read_b128 v[116:119], v250 offset:7168
    buffer_load_dwordx4 v149, s[48:51], s14 offen offset:1024 lds
    v_mfma_f32_16x16x32_bf16 v[204:207], a[60:63], v[92:95], v[204:207]
    ds_read_b128 v[120:123], v250 offset:1280
    v_mfma_f32_16x16x32_bf16 v[200:203], a[56:59], v[92:95], v[200:203]
    ds_read_b128 v[124:127], v250 offset:7424
    s_add_u32 s7, s7, 22822912
    v_mov_b32 v28, s7
    v_add_u32 v247, 3072, v246
    v_cmp_eq_u32 vcc, 0, v2
    v_mov_b32 v248, 0x40000000
    s_nop 0
    v_cndmask_b32 v248, v248, 0, vcc
    v_mov_b32 v249, s68
    v_and_b32 v129, 0xffff0000, v144
    v_lshlrev_b32 v128, 16, v144
    v_and_b32 v131, 0xffff0000, v145
    v_lshlrev_b32 v130, 16, v145
    v_and_b32 v133, 0xffff0000, v146
    v_lshlrev_b32 v132, 16, v146
    v_and_b32 v135, 0xffff0000, v147
    v_lshlrev_b32 v134, 16, v147
    s_mul_i32 s4, s70, 43691
    s_lshr_b32 s4, s4, 16
    s_mul_i32 s5, s70, 21846
    s_lshr_b32 s5, s5, 16
    s_mul_i32 s5, s5, 3
    s_sub_u32 s5, s70, s5
    s_lshl2_add_u32 s4, s72, s4
    v_mfma_f32_16x16x32_bf16 v[200:203], a[48:51], v[88:91], v[200:203]
    ds_read_b64_tr_b16 a[120:121], v152 offset:8192
    buffer_load_dwordx4 v150, s[48:51], s14 offen offset:2048 lds
    v_mfma_f32_16x16x32_bf16 v[208:211], a[48:51], v[96:99], v[208:211]
    ds_read_b64_tr_b16 a[122:123], v152 offset:9216
    v_mfma_f32_16x16x32_bf16 v[208:211], a[56:59], v[100:103], v[208:211]
    buffer_load_dwordx4 v151, s[48:51], s14 offen offset:3072 lds
    v_mfma_f32_16x16x32_bf16 v[212:215], a[60:63], v[100:103], v[212:215]
    ds_read_b64_tr_b16 a[124:125], v153 offset:8192
    v_mfma_f32_16x16x32_bf16 v[212:215], a[52:55], v[96:99], v[212:215]
    ds_read_b64_tr_b16 a[126:127], v153 offset:9216
    s_waitcnt lgkmcnt(4)
    v_mfma_f32_16x16x32_bf16 v[220:223], a[52:55], v[104:107], v[220:223]
    s_waitcnt vmcnt(17)
    s_barrier
    v_mfma_f32_16x16x32_bf16 v[220:223], a[60:63], v[108:111], v[220:223]
    ds_read_b128 v[80:83], v250 offset:12288
    s_add_u32 m0, s74, 36864
    v_mfma_f32_16x16x32_bf16 v[216:219], a[56:59], v[108:111], v[216:219]
    ds_read_b128 v[84:87], v250 offset:18432
    v_mfma_f32_16x16x32_bf16 v[216:219], a[48:51], v[104:107], v[216:219]
    ds_read_b128 v[88:91], v250 offset:12544
    buffer_load_dwordx4 v156, s[44:47], s27 offen offset:0 sc1 lds
    v_mfma_f32_16x16x32_bf16 v[224:227], a[48:51], v[112:115], v[224:227]
    ds_read_b128 v[92:95], v250 offset:18688
    v_mfma_f32_16x16x32_bf16 v[224:227], a[56:59], v[116:119], v[224:227]
    ds_read_b128 v[96:99], v250 offset:12800
    v_mfma_f32_16x16x32_bf16 v[228:231], a[60:63], v[116:119], v[228:231]
    ds_read_b128 v[100:103], v250 offset:18944
    buffer_load_dwordx4 v157, s[44:47], s27 offen offset:1024 sc1 lds
    s_lshl_b32 s4, s4, 10
    s_mul_i32 s7, s72, 9
    s_sub_u32 s7, s69, s7
    s_lshl3_add_u32 s4, s7, s4
    s_add_u32 s4, s4, 12566528
    s_cmp_eq_u32 s5, 1
    s_cselect_b32 s7, 16, 8
    s_cmp_lg_u32 s5, 0
    s_cselect_b32 s5, 4, 0
    v_lshlrev_b32 v17, 7, v0
    v_add_u32 v17, s4, v17
    v_cmp_gt_u32 vcc, 8, v0
    v_mov_b32 v24, s5
    s_nop 0
    v_cndmask_b32 v24, 0, v24, vcc
    v_add_u32 v17, v17, v24
    v_cmp_gt_u32 vcc, s7, v0
    v_mov_b32 v24, 0x40000000
    s_nop 0
    v_cndmask_b32 v17, v24, v17, vcc
    s_bfe_u32 s4, s2, 0x20003
    s_lshl2_add_u32 s4, s72, s4
    s_lshl_b32 s4, s4, 3
    s_lshr_b32 s5, s2, 4
    v_mfma_f32_16x16x32_bf16 v[228:231], a[52:55], v[112:115], v[228:231]
    ds_read_b64_tr_b16 a[128:129], v152 offset:16384
    v_mfma_f32_16x16x32_bf16 v[236:239], a[52:55], v[120:123], v[236:239]
    ds_read_b64_tr_b16 a[130:131], v152 offset:17408
    v_mfma_f32_16x16x32_bf16 v[236:239], a[60:63], v[124:127], v[236:239]
    buffer_load_dwordx4 v158, s[44:47], s27 offen offset:2048 sc1 lds
    v_mfma_f32_16x16x32_bf16 v[232:235], a[56:59], v[124:127], v[232:235]
    ds_read_b64_tr_b16 a[132:133], v153 offset:16384
    v_mfma_f32_16x16x32_bf16 v[232:235], a[48:51], v[120:123], v[232:235]
    ds_read_b64_tr_b16 a[134:135], v153 offset:17408
    s_waitcnt lgkmcnt(4)
    v_mfma_f32_16x16x32_bf16 v[192:195], a[64:67], v[80:83], v[192:195]
    s_add_u32 m0, s73, 65536
    s_lshl_b32 s14, s77, 3
    v_mfma_f32_16x16x32_bf16 v[192:195], a[72:75], v[84:87], v[192:195]
    ds_read_b128 v[104:107], v250 offset:13056
    v_mfma_f32_16x16x32_bf16 v[196:199], a[76:79], v[84:87], v[196:199]
    ds_read_b128 v[108:111], v250 offset:19200
    buffer_load_dwordx4 v148, s[48:51], s14 offen offset:0 lds
    v_mfma_f32_16x16x32_bf16 v[196:199], a[68:71], v[80:83], v[196:199]
    ds_read_b128 v[112:115], v250 offset:13312
    v_mfma_f32_16x16x32_bf16 v[204:207], a[68:71], v[88:91], v[204:207]
    ds_read_b128 v[116:119], v250 offset:19456
    buffer_load_dwordx4 v149, s[48:51], s14 offen offset:1024 lds
    v_mfma_f32_16x16x32_bf16 v[204:207], a[76:79], v[92:95], v[204:207]
    ds_read_b128 v[120:123], v250 offset:13568
    v_mfma_f32_16x16x32_bf16 v[200:203], a[72:75], v[92:95], v[200:203]
    ds_read_b128 v[124:127], v250 offset:19712
    s_and_b32 s5, s5, 6
    s_add_u32 s4, s4, s5
    s_and_b32 s5, s2, 1
    s_add_u32 s4, s4, s5
    s_lshl_b32 s4, s4, 7
    s_add_u32 s4, s4, 12566528
    v_lshl_add_u32 v15, v2, 2, s4
    s_cmp_eq_u32 s3, 0
    s_cselect_b32 s4, 18, 0
    v_cmp_gt_u32 vcc, s4, v2
    v_mov_b32 v13, 0x40000000
    s_nop 0
    v_cndmask_b32 v15, v13, v15, vcc
    v_mov_b32 v13, s68
    v_cndmask_b32 v13, 0, v13, vcc
    v_and_b32 v24, 15, v2
    v_lshrrev_b32 v25, 4, v2
    v_mul_u32_u24 v25, 17408, v25
    v_lshl_add_u32 v24, v24, 4, v25
    s_mul_i32 s7, s72, 36
    s_and_b32 s8, s3, 1
    v_mfma_f32_16x16x32_bf16 v[200:203], a[64:67], v[88:91], v[200:203]
    ds_read_b64_tr_b16 a[136:137], v152 offset:24576
    buffer_load_dwordx4 v150, s[48:51], s14 offen offset:2048 lds
    v_mfma_f32_16x16x32_bf16 v[208:211], a[64:67], v[96:99], v[208:211]
    ds_read_b64_tr_b16 a[138:139], v152 offset:25600
    v_mfma_f32_16x16x32_bf16 v[208:211], a[72:75], v[100:103], v[208:211]
    buffer_load_dwordx4 v151, s[48:51], s14 offen offset:3072 lds
    v_mfma_f32_16x16x32_bf16 v[212:215], a[76:79], v[100:103], v[212:215]
    ds_read_b64_tr_b16 a[140:141], v153 offset:24576
    v_mfma_f32_16x16x32_bf16 v[212:215], a[68:71], v[96:99], v[212:215]
    ds_read_b64_tr_b16 a[142:143], v153 offset:25600
    s_waitcnt lgkmcnt(4)
    v_mfma_f32_16x16x32_bf16 v[220:223], a[68:71], v[104:107], v[220:223]
    s_waitcnt vmcnt(14)
    s_barrier
    v_mfma_f32_16x16x32_bf16 v[220:223], a[76:79], v[108:111], v[220:223]
    ds_read_b128 v[80:83], v250 offset:24576
    s_add_u32 m0, s74, 49152
    v_mfma_f32_16x16x32_bf16 v[216:219], a[72:75], v[108:111], v[216:219]
    ds_read_b128 v[84:87], v250 offset:30720
    v_mfma_f32_16x16x32_bf16 v[216:219], a[64:67], v[104:107], v[216:219]
    ds_read_b128 v[88:91], v250 offset:24832
    buffer_load_dwordx4 v156, s[44:47], s76 offen offset:0 sc1 lds
    v_mfma_f32_16x16x32_bf16 v[224:227], a[64:67], v[112:115], v[224:227]
    ds_read_b128 v[92:95], v250 offset:30976
    v_mfma_f32_16x16x32_bf16 v[224:227], a[72:75], v[116:119], v[224:227]
    ds_read_b128 v[96:99], v250 offset:25088
    v_mfma_f32_16x16x32_bf16 v[228:231], a[76:79], v[116:119], v[228:231]
    ds_read_b128 v[100:103], v250 offset:31232
    buffer_load_dwordx4 v157, s[44:47], s76 offen offset:1024 sc1 lds
    s_add_u32 s7, s7, s8
    s_mul_i32 s7, s7, 69632
    s_bfe_u32 s8, s2, 0x20003
    s_lshl_b32 s8, s8, 12
    s_add_u32 s7, s7, s8
    s_add_u32 s7, s7, 12795904
    v_add_u32 v23, s7, v24
    s_xor_b32 s7, s72, 0
    v_lshl_add_u32 v19, s7, 10, v23
    s_xor_b32 s7, s72, 1
    v_lshl_add_u32 v20, s7, 10, v23
    s_xor_b32 s7, s72, 2
    v_lshl_add_u32 v21, s7, 10, v23
    s_xor_b32 s7, s72, 3
    v_lshl_add_u32 v22, s7, 10, v23
    v_lshlrev_b32 v14, 4, v2
    v_add_u32 v14, 98304, v14
    v_add_u32 v1, 0x10000, v14
    v_mfma_f32_16x16x32_bf16 v[228:231], a[68:71], v[112:115], v[228:231]
    ds_read_b64_tr_b16 a[144:145], v152 offset:32768
    v_mfma_f32_16x16x32_bf16 v[236:239], a[68:71], v[120:123], v[236:239]
    ds_read_b64_tr_b16 a[146:147], v152 offset:33792
    v_mfma_f32_16x16x32_bf16 v[236:239], a[76:79], v[124:127], v[236:239]
    buffer_load_dwordx4 v158, s[44:47], s76 offen offset:2048 sc1 lds
    v_mfma_f32_16x16x32_bf16 v[232:235], a[72:75], v[124:127], v[232:235]
    ds_read_b64_tr_b16 a[148:149], v153 offset:32768
    v_mfma_f32_16x16x32_bf16 v[232:235], a[64:67], v[120:123], v[232:235]
    ds_read_b64_tr_b16 a[150:151], v153 offset:33792
    s_waitcnt lgkmcnt(4)
    v_mfma_f32_16x16x32_bf16 v[192:195], a[80:83], v[80:83], v[192:195]
    s_add_u32 m0, s73, 0
    s_lshl_b32 s14, s78, 3
    v_mfma_f32_16x16x32_bf16 v[192:195], a[88:91], v[84:87], v[192:195]
    ds_read_b128 v[104:107], v250 offset:25344
    v_mfma_f32_16x16x32_bf16 v[196:199], a[92:95], v[84:87], v[196:199]
    ds_read_b128 v[108:111], v250 offset:31488
    buffer_load_dwordx4 v148, s[48:51], s14 offen offset:0 lds
    v_mfma_f32_16x16x32_bf16 v[196:199], a[84:87], v[80:83], v[196:199]
    ds_read_b128 v[112:115], v250 offset:25600
    v_mfma_f32_16x16x32_bf16 v[204:207], a[84:87], v[88:91], v[204:207]
    ds_read_b128 v[116:119], v250 offset:31744
    buffer_load_dwordx4 v149, s[48:51], s14 offen offset:1024 lds
    v_mfma_f32_16x16x32_bf16 v[204:207], a[92:95], v[92:95], v[204:207]
    ds_read_b128 v[120:123], v250 offset:25856
    v_mfma_f32_16x16x32_bf16 v[200:203], a[88:91], v[92:95], v[200:203]
    ds_read_b128 v[124:127], v250 offset:32000
    s_mov_b32 s56, s16
    s_and_b32 s57, s17, 0xffff
    s_mov_b32 s58, 2359296
    s_mov_b32 s59, 0x20000
    s_mov_b32 s40, 18432
    s_mov_b32 s42, 12386304
    s_mov_b32 s64, s38
    s_and_b32 s65, s39, 0xffff
    s_mov_b32 s66, 2359296
    s_mov_b32 s67, 0x20000
    v_lshlrev_b32 v136, 4, v2
    s_mul_i32 s7, s72, 36
    s_bitcmp1_b32 s3, 0
    s_addc_u32 s7, s7, 0
    s_lshl_b32 s7, s7, 17
    v_subrev_u32 v184, s7, v4
    v_subrev_u32 v185, s7, v5
    v_mfma_f32_16x16x32_bf16 v[200:203], a[80:83], v[88:91], v[200:203]
    ds_read_b64_tr_b16 a[152:153], v152 offset:40960
    buffer_load_dwordx4 v150, s[48:51], s14 offen offset:2048 lds
    v_mfma_f32_16x16x32_bf16 v[208:211], a[80:83], v[96:99], v[208:211]
    ds_read_b64_tr_b16 a[154:155], v152 offset:41984
    v_mfma_f32_16x16x32_bf16 v[208:211], a[88:91], v[100:103], v[208:211]
    buffer_load_dwordx4 v151, s[48:51], s14 offen offset:3072 lds
    v_mfma_f32_16x16x32_bf16 v[212:215], a[92:95], v[100:103], v[212:215]
    ds_read_b64_tr_b16 a[156:157], v153 offset:40960
    v_mfma_f32_16x16x32_bf16 v[212:215], a[84:87], v[96:99], v[212:215]
    ds_read_b64_tr_b16 a[158:159], v153 offset:41984
    s_waitcnt lgkmcnt(4)
    v_mfma_f32_16x16x32_bf16 v[220:223], a[84:87], v[104:107], v[220:223]
    s_waitcnt vmcnt(14)
    s_barrier
    v_mfma_f32_16x16x32_bf16 v[220:223], a[92:95], v[108:111], v[220:223]
L_pl_G_2:
    s_cbranch_execz L_pl_G_6
    ds_read_b128 v[80:83], v159 offset:0
    s_add_u32 m0, s74, 61440
    v_mfma_f32_16x16x32_bf16 v[216:219], a[88:91], v[108:111], v[216:219]
    ds_read_b128 v[84:87], v159 offset:6144
    v_mfma_f32_16x16x32_bf16 v[216:219], a[80:83], v[104:107], v[216:219]
    ds_read_b128 v[88:91], v159 offset:256
    buffer_load_dwordx4 v156, s[44:47], s77 offen offset:0 sc1 lds
    v_mfma_f32_16x16x32_bf16 v[224:227], a[80:83], v[112:115], v[224:227]
    ds_read_b128 v[92:95], v159 offset:6400
    v_mfma_f32_16x16x32_bf16 v[224:227], a[88:91], v[116:119], v[224:227]
    ds_read_b128 v[96:99], v159 offset:512
    v_mfma_f32_16x16x32_bf16 v[228:231], a[92:95], v[116:119], v[228:231]
    ds_read_b128 v[100:103], v159 offset:6656
    buffer_load_dwordx4 v157, s[44:47], s77 offen offset:1024 sc1 lds
    s_bfe_u32 s4, s2, 0x20003
    s_mul_i32 s4, s4, 9
    s_lshl1_add_u32 s7, s72, s4
    s_and_b32 s8, s3, 1
    s_add_u32 s7, s7, s8
    s_lshl_b32 s37, s7, 16
    s_add_u32 s37, s37, 4718592
    s_add_u32 s4, s4, 8
    s_lshl_b32 s16, s4, 16
    s_add_u32 s16, s16, 4718592
    s_sub_u32 s4, s4, s7
    s_lshl_b32 s4, s4, 7
    s_lshl_b32 s7, s7, 7
    s_add_u32 s7, s7, 12582912
    v_bfe_u32 v24, v2, 2, 1
    v_mfma_f32_16x16x32_bf16 v[228:231], a[84:87], v[112:115], v[228:231]
    ds_read_b64_tr_b16 a[160:161], v152 offset:49152
    v_mfma_f32_16x16x32_bf16 v[236:239], a[84:87], v[120:123], v[236:239]
    ds_read_b64_tr_b16 a[162:163], v152 offset:50176
    v_mfma_f32_16x16x32_bf16 v[236:239], a[92:95], v[124:127], v[236:239]
    buffer_load_dwordx4 v158, s[44:47], s77 offen offset:2048 sc1 lds
    v_mfma_f32_16x16x32_bf16 v[232:235], a[88:91], v[124:127], v[232:235]
    ds_read_b64_tr_b16 a[164:165], v153 offset:49152
    v_mfma_f32_16x16x32_bf16 v[232:235], a[80:83], v[120:123], v[232:235]
    ds_read_b64_tr_b16 a[166:167], v153 offset:50176
    s_waitcnt lgkmcnt(4)
    v_mfma_f32_16x16x32_bf16 v[192:195], a[96:99], v[80:83], v[192:195]
    s_add_u32 m0, s73, 16384
    s_lshl_b32 s14, s79, 3
    v_mfma_f32_16x16x32_bf16 v[192:195], a[104:107], v[84:87], v[192:195]
    ds_read_b128 v[104:107], v159 offset:768
    v_mfma_f32_16x16x32_bf16 v[196:199], a[108:111], v[84:87], v[196:199]
    ds_read_b128 v[108:111], v159 offset:6912
    buffer_load_dwordx4 v148, s[48:51], s14 offen offset:0 lds
    v_mfma_f32_16x16x32_bf16 v[196:199], a[100:103], v[80:83], v[196:199]
    ds_read_b128 v[112:115], v159 offset:1024
    v_mfma_f32_16x16x32_bf16 v[204:207], a[100:103], v[88:91], v[204:207]
    ds_read_b128 v[116:119], v159 offset:7168
    buffer_load_dwordx4 v149, s[48:51], s14 offen offset:1024 lds
    v_mfma_f32_16x16x32_bf16 v[204:207], a[108:111], v[92:95], v[204:207]
    ds_read_b128 v[120:123], v159 offset:1280
    v_mfma_f32_16x16x32_bf16 v[200:203], a[104:107], v[92:95], v[200:203]
    ds_read_b128 v[124:127], v159 offset:7424
    v_mul_u32_u24 v24, s4, v24
    v_and_b32 v25, 3, v2
    v_lshl_add_u32 v24, v25, 2, v24
    v_add_u32 v188, s7, v24
    s_lshl2_add_u32 s7, s2, s3
    s_mul_i32 s8, s7, 3072
    s_add_u32 s34, s8, 22953984
    s_add_u32 s11, s8, 26099712
    s_add_u32 s12, s8, 29245440
    s_lshl_b32 s35, s7, 12
    s_add_u32 s35, s35, 32391168
    s_xor_b32 s8, s7, 8
    s_mul_i32 s8, s8, 3072
    s_add_u32 s30, s8, 22953984
    v_mfma_f32_16x16x32_bf16 v[200:203], a[96:99], v[88:91], v[200:203]
    ds_read_b64_tr_b16 a[168:169], v152 offset:57344
    buffer_load_dwordx4 v150, s[48:51], s14 offen offset:2048 lds
    v_mfma_f32_16x16x32_bf16 v[208:211], a[96:99], v[96:99], v[208:211]
    ds_read_b64_tr_b16 a[170:171], v152 offset:58368
    v_mfma_f32_16x16x32_bf16 v[208:211], a[104:107], v[100:103], v[208:211]
    buffer_load_dwordx4 v151, s[48:51], s14 offen offset:3072 lds
    v_mfma_f32_16x16x32_bf16 v[212:215], a[108:111], v[100:103], v[212:215]
    ds_read_b64_tr_b16 a[172:173], v153 offset:57344
    v_mfma_f32_16x16x32_bf16 v[212:215], a[100:103], v[96:99], v[212:215]
    ds_read_b64_tr_b16 a[174:175], v153 offset:58368
    s_waitcnt lgkmcnt(4)
    v_mfma_f32_16x16x32_bf16 v[220:223], a[100:103], v[104:107], v[220:223]
    s_waitcnt vmcnt(14)
    s_barrier
    v_mfma_f32_16x16x32_bf16 v[220:223], a[108:111], v[108:111], v[220:223]
    ds_read_b128 v[80:83], v159 offset:12288
    s_add_u32 m0, s74, 0
    v_mfma_f32_16x16x32_bf16 v[216:219], a[104:107], v[108:111], v[216:219]
    ds_read_b128 v[84:87], v159 offset:18432
    v_mfma_f32_16x16x32_bf16 v[216:219], a[96:99], v[104:107], v[216:219]
    ds_read_b128 v[88:91], v159 offset:12544
    buffer_load_dwordx4 v156, s[44:47], s78 offen offset:0 sc1 lds
    v_mfma_f32_16x16x32_bf16 v[224:227], a[96:99], v[112:115], v[224:227]
    ds_read_b128 v[92:95], v159 offset:18688
    v_mfma_f32_16x16x32_bf16 v[224:227], a[104:107], v[116:119], v[224:227]
    ds_read_b128 v[96:99], v159 offset:12800
    v_mfma_f32_16x16x32_bf16 v[228:231], a[108:111], v[116:119], v[228:231]
    ds_read_b128 v[100:103], v159 offset:18944
    buffer_load_dwordx4 v157, s[44:47], s78 offen offset:1024 sc1 lds
    s_xor_b32 s8, s7, 16
    s_mul_i32 s8, s8, 3072
    s_add_u32 s15, s8, 26099712
    s_xor_b32 s8, s7, 24
    s_mul_i32 s8, s8, 3072
    s_add_u32 s31, s8, 29245440
    s_andn2_b32 s7, s7, 24
    s_lshl3_add_u32 s7, s3, s7
    s_lshl2_add_u32 s8, s7, s72
    s_lshl_b32 s8, s8, 10
    s_add_u32 s32, s8, 32391168
    s_xor_b32 s8, s8, 4096
    v_mfma_f32_16x16x32_bf16 v[228:231], a[100:103], v[112:115], v[228:231]
    ds_read_b64_tr_b16 a[176:177], v154 offset:0
    v_mfma_f32_16x16x32_bf16 v[236:239], a[100:103], v[120:123], v[236:239]
    ds_read_b64_tr_b16 a[178:179], v154 offset:1024
    v_mfma_f32_16x16x32_bf16 v[236:239], a[108:111], v[124:127], v[236:239]
    buffer_load_dwordx4 v158, s[44:47], s78 offen offset:2048 sc1 lds
    v_mfma_f32_16x16x32_bf16 v[232:235], a[104:107], v[124:127], v[232:235]
    ds_read_b64_tr_b16 a[180:181], v155 offset:0
    v_mfma_f32_16x16x32_bf16 v[232:235], a[96:99], v[120:123], v[232:235]
    ds_read_b64_tr_b16 a[182:183], v155 offset:1024
    s_waitcnt lgkmcnt(4)
    v_mfma_f32_16x16x32_bf16 v[192:195], a[112:115], v[80:83], v[192:195]
    s_add_u32 m0, s73, 32768
    s_lshl_b32 s14, s80, 3
    v_mfma_f32_16x16x32_bf16 v[192:195], a[120:123], v[84:87], v[192:195]
    ds_read_b128 v[104:107], v159 offset:13056
    v_mfma_f32_16x16x32_bf16 v[196:199], a[124:127], v[84:87], v[196:199]
    ds_read_b128 v[108:111], v159 offset:19200
    buffer_load_dwordx4 v148, s[48:51], s14 offen offset:0 lds
    v_mfma_f32_16x16x32_bf16 v[196:199], a[116:119], v[80:83], v[196:199]
    ds_read_b128 v[112:115], v159 offset:13312
    v_mfma_f32_16x16x32_bf16 v[204:207], a[116:119], v[88:91], v[204:207]
    ds_read_b128 v[116:119], v159 offset:19456
    buffer_load_dwordx4 v149, s[48:51], s14 offen offset:1024 lds
    v_mfma_f32_16x16x32_bf16 v[204:207], a[124:127], v[92:95], v[204:207]
    ds_read_b128 v[120:123], v159 offset:13568
    v_mfma_f32_16x16x32_bf16 v[200:203], a[120:123], v[92:95], v[200:203]
    ds_read_b128 v[124:127], v159 offset:19712
    s_add_u32 s33, s8, 32391168
    s_xor_b32 s8, s3, s72
    s_cmp_lt_u32 s8, 2
    s_cselect_b32 s35, s35, 0x40000000
    s_cselect_b32 s16, s16, 0x40000000
    s_cselect_b32 s36, s68, 0
    s_mov_b32 s38, 0xbfb8aa3b
    s_and_b32 s8, s8, 1
    s_mul_i32 s41, s8, 96
    s_and_b32 s43, s73, 4096
    v_lshlrev_b32 v24, 10, v2
    v_add_u32 v24, s35, v24
    s_add_u32 s7, s34, 2048
    v_mov_b32 v25, s36
    v_mfma_f32_16x16x32_bf16 v[200:203], a[112:115], v[88:91], v[200:203]
    ds_read_b64_tr_b16 a[184:185], v154 offset:8192
    buffer_load_dwordx4 v150, s[48:51], s14 offen offset:2048 lds
    v_mfma_f32_16x16x32_bf16 v[208:211], a[112:115], v[96:99], v[208:211]
    ds_read_b64_tr_b16 a[186:187], v154 offset:9216
    v_mfma_f32_16x16x32_bf16 v[208:211], a[120:123], v[100:103], v[208:211]
    buffer_load_dwordx4 v151, s[48:51], s14 offen offset:3072 lds
    v_mfma_f32_16x16x32_bf16 v[212:215], a[124:127], v[100:103], v[212:215]
    ds_read_b64_tr_b16 a[188:189], v155 offset:8192
    v_mfma_f32_16x16x32_bf16 v[212:215], a[116:119], v[96:99], v[212:215]
    ds_read_b64_tr_b16 a[190:191], v155 offset:9216
    s_waitcnt lgkmcnt(4)
    v_mfma_f32_16x16x32_bf16 v[220:223], a[116:119], v[104:107], v[220:223]
    s_waitcnt vmcnt(14)
    s_barrier
    v_mfma_f32_16x16x32_bf16 v[220:223], a[124:127], v[108:111], v[220:223]
    ds_read_b128 v[80:83], v159 offset:24576
    s_add_u32 m0, s74, 12288
    v_mfma_f32_16x16x32_bf16 v[216:219], a[120:123], v[108:111], v[216:219]
    ds_read_b128 v[84:87], v159 offset:30720
    v_mfma_f32_16x16x32_bf16 v[216:219], a[112:115], v[104:107], v[216:219]
    ds_read_b128 v[88:91], v159 offset:24832
    buffer_load_dwordx4 v156, s[44:47], s79 offen offset:0 sc1 lds
    v_mfma_f32_16x16x32_bf16 v[224:227], a[112:115], v[112:115], v[224:227]
    ds_read_b128 v[92:95], v159 offset:30976
    v_mfma_f32_16x16x32_bf16 v[224:227], a[120:123], v[116:119], v[224:227]
    ds_read_b128 v[96:99], v159 offset:25088
    v_mfma_f32_16x16x32_bf16 v[228:231], a[124:127], v[116:119], v[228:231]
    ds_read_b128 v[100:103], v159 offset:31232
    buffer_load_dwordx4 v157, s[44:47], s79 offen offset:1024 sc1 lds
    v_cmp_gt_u32 vcc, 4, v2
    s_nop 1
    v_cndmask_b32 v138, 0, v25, vcc
    v_mov_b32 v25, 0x40000000
    v_cndmask_b32 v137, v25, v24, vcc
    v_writelane_b32 v137, s7, 4
    v_writelane_b32 v138, s68, 4
    v_min_u32 v139, 1, v2
    v_lshlrev_b32 v139, 30, v139
    v_mov_b32 v140, 0
    v_writelane_b32 v140, s68, 0
    v_mfma_f32_16x16x32_bf16 v[228:231], a[116:119], v[112:115], v[228:231]
    ds_read_b64_tr_b16 a[192:193], v152 offset:0
    v_mfma_f32_16x16x32_bf16 v[236:239], a[116:119], v[120:123], v[236:239]
    ds_read_b64_tr_b16 a[194:195], v152 offset:1024
    v_mfma_f32_16x16x32_bf16 v[236:239], a[124:127], v[124:127], v[236:239]
    buffer_load_dwordx4 v158, s[44:47], s79 offen offset:2048 sc1 lds
    v_mfma_f32_16x16x32_bf16 v[232:235], a[120:123], v[124:127], v[232:235]
    ds_read_b64_tr_b16 a[196:197], v153 offset:0
    v_mfma_f32_16x16x32_bf16 v[232:235], a[112:115], v[120:123], v[232:235]
    ds_read_b64_tr_b16 a[198:199], v153 offset:1024
    s_waitcnt lgkmcnt(4)
    v_mfma_f32_16x16x32_bf16 v[192:195], a[128:131], v[80:83], v[192:195]
    s_add_u32 m0, s73, 49152
    s_lshl_b32 s14, s81, 3
    v_mfma_f32_16x16x32_bf16 v[192:195], a[136:139], v[84:87], v[192:195]
    ds_read_b128 v[104:107], v159 offset:25344
    v_mfma_f32_16x16x32_bf16 v[196:199], a[140:143], v[84:87], v[196:199]
    ds_read_b128 v[108:111], v159 offset:31488
    buffer_load_dwordx4 v148, s[48:51], s14 offen offset:0 lds
    v_mfma_f32_16x16x32_bf16 v[196:199], a[132:135], v[80:83], v[196:199]
    ds_read_b128 v[112:115], v159 offset:25600
    v_mfma_f32_16x16x32_bf16 v[204:207], a[132:135], v[88:91], v[204:207]
    ds_read_b128 v[116:119], v159 offset:31744
    buffer_load_dwordx4 v149, s[48:51], s14 offen offset:1024 lds
    v_mfma_f32_16x16x32_bf16 v[204:207], a[140:143], v[92:95], v[204:207]
    ds_read_b128 v[120:123], v159 offset:25856
    v_mfma_f32_16x16x32_bf16 v[200:203], a[136:139], v[92:95], v[200:203]
    ds_read_b128 v[124:127], v159 offset:32000
    v_mfma_f32_16x16x32_bf16 v[200:203], a[128:131], v[88:91], v[200:203]
    ds_read_b64_tr_b16 a[200:201], v152 offset:8192
    buffer_load_dwordx4 v150, s[48:51], s14 offen offset:2048 lds
    v_mfma_f32_16x16x32_bf16 v[208:211], a[128:131], v[96:99], v[208:211]
    ds_read_b64_tr_b16 a[202:203], v152 offset:9216
    v_mfma_f32_16x16x32_bf16 v[208:211], a[136:139], v[100:103], v[208:211]
    buffer_load_dwordx4 v151, s[48:51], s14 offen offset:3072 lds
    v_mfma_f32_16x16x32_bf16 v[212:215], a[140:143], v[100:103], v[212:215]
    ds_read_b64_tr_b16 a[204:205], v153 offset:8192
    v_mfma_f32_16x16x32_bf16 v[212:215], a[132:135], v[96:99], v[212:215]
    ds_read_b64_tr_b16 a[206:207], v153 offset:9216
    s_waitcnt lgkmcnt(4)
    v_mfma_f32_16x16x32_bf16 v[220:223], a[132:135], v[104:107], v[220:223]
    s_waitcnt vmcnt(14)
    s_barrier
    v_mfma_f32_16x16x32_bf16 v[220:223], a[140:143], v[108:111], v[220:223]
    ds_read_b128 v[80:83], v250 offset:0
    s_add_u32 m0, s74, 24576
    v_mfma_f32_16x16x32_bf16 v[216:219], a[136:139], v[108:111], v[216:219]
    ds_read_b128 v[84:87], v250 offset:6144
    v_mfma_f32_16x16x32_bf16 v[216:219], a[128:131], v[104:107], v[216:219]
    ds_read_b128 v[88:91], v250 offset:256
    buffer_load_dwordx4 v156, s[44:47], s80 offen offset:0 sc1 lds
    v_mfma_f32_16x16x32_bf16 v[224:227], a[128:131], v[112:115], v[224:227]
    ds_read_b128 v[92:95], v250 offset:6400
    v_mfma_f32_16x16x32_bf16 v[224:227], a[136:139], v[116:119], v[224:227]
    ds_read_b128 v[96:99], v250 offset:512
    v_mfma_f32_16x16x32_bf16 v[228:231], a[140:143], v[116:119], v[228:231]
    ds_read_b128 v[100:103], v250 offset:6656
    buffer_load_dwordx4 v157, s[44:47], s80 offen offset:1024 sc1 lds
    v_mfma_f32_16x16x32_bf16 v[228:231], a[132:135], v[112:115], v[228:231]
    ds_read_b64_tr_b16 a[208:209], v152 offset:16384
    v_mfma_f32_16x16x32_bf16 v[236:239], a[132:135], v[120:123], v[236:239]
    ds_read_b64_tr_b16 a[210:211], v152 offset:17408
    v_mfma_f32_16x16x32_bf16 v[236:239], a[140:143], v[124:127], v[236:239]
    buffer_load_dwordx4 v158, s[44:47], s80 offen offset:2048 sc1 lds
    v_mfma_f32_16x16x32_bf16 v[232:235], a[136:139], v[124:127], v[232:235]
    ds_read_b64_tr_b16 a[212:213], v153 offset:16384
    v_mfma_f32_16x16x32_bf16 v[232:235], a[128:131], v[120:123], v[232:235]
    ds_read_b64_tr_b16 a[214:215], v153 offset:17408
    s_waitcnt lgkmcnt(4)
    v_mfma_f32_16x16x32_bf16 v[192:195], a[144:147], v[80:83], v[192:195]
    s_add_u32 m0, s73, 65536
    s_lshl_b32 s14, s84, 18
    v_mfma_f32_16x16x32_bf16 v[192:195], a[152:155], v[84:87], v[192:195]
    ds_read_b128 v[104:107], v250 offset:768
    v_mfma_f32_16x16x32_bf16 v[196:199], a[156:159], v[84:87], v[196:199]
    ds_read_b128 v[108:111], v250 offset:6912
    buffer_load_dwordx4 v4, s[52:55], s14 offen offset:0 lds
    v_mfma_f32_16x16x32_bf16 v[196:199], a[148:151], v[80:83], v[196:199]
    ds_read_b128 v[112:115], v250 offset:1024
    v_mfma_f32_16x16x32_bf16 v[204:207], a[148:151], v[88:91], v[204:207]
    ds_read_b128 v[116:119], v250 offset:7168
    buffer_load_dwordx4 v5, s[52:55], s14 offen offset:1024 lds
    v_mfma_f32_16x16x32_bf16 v[204:207], a[156:159], v[92:95], v[204:207]
    ds_read_b128 v[120:123], v250 offset:1280
    v_mfma_f32_16x16x32_bf16 v[200:203], a[152:155], v[92:95], v[200:203]
    ds_read_b128 v[124:127], v250 offset:7424
    v_mfma_f32_16x16x32_bf16 v[200:203], a[144:147], v[88:91], v[200:203]
    ds_read_b64_tr_b16 a[216:217], v152 offset:24576
    buffer_load_dwordx4 v6, s[52:55], s14 offen offset:2048 lds
    v_mfma_f32_16x16x32_bf16 v[208:211], a[144:147], v[96:99], v[208:211]
    ds_read_b64_tr_b16 a[218:219], v152 offset:25600
    v_mfma_f32_16x16x32_bf16 v[208:211], a[152:155], v[100:103], v[208:211]
    buffer_load_dwordx4 v7, s[52:55], s14 offen offset:3072 lds
    v_mfma_f32_16x16x32_bf16 v[212:215], a[156:159], v[100:103], v[212:215]
    ds_read_b64_tr_b16 a[220:221], v153 offset:24576
    v_mfma_f32_16x16x32_bf16 v[212:215], a[148:151], v[96:99], v[212:215]
    ds_read_b64_tr_b16 a[222:223], v153 offset:25600
    s_waitcnt lgkmcnt(4)
    v_mfma_f32_16x16x32_bf16 v[220:223], a[148:151], v[104:107], v[220:223]
    s_waitcnt vmcnt(14)
    s_barrier
    v_mfma_f32_16x16x32_bf16 v[220:223], a[156:159], v[108:111], v[220:223]
    ds_read_b128 v[80:83], v250 offset:12288
    v_mfma_f32_16x16x32_bf16 v[216:219], a[152:155], v[108:111], v[216:219]
    ds_read_b128 v[84:87], v250 offset:18432
    v_mfma_f32_16x16x32_bf16 v[216:219], a[144:147], v[104:107], v[216:219]
    ds_read_b128 v[88:91], v250 offset:12544
    v_mfma_f32_16x16x32_bf16 v[224:227], a[144:147], v[112:115], v[224:227]
    ds_read_b128 v[92:95], v250 offset:18688
    v_mfma_f32_16x16x32_bf16 v[224:227], a[152:155], v[116:119], v[224:227]
    ds_read_b128 v[96:99], v250 offset:12800
    v_mfma_f32_16x16x32_bf16 v[228:231], a[156:159], v[116:119], v[228:231]
    ds_read_b128 v[100:103], v250 offset:18944
    v_mfma_f32_16x16x32_bf16 v[228:231], a[148:151], v[112:115], v[228:231]
    ds_read_b64_tr_b16 a[224:225], v152 offset:32768
    v_mfma_f32_16x16x32_bf16 v[236:239], a[148:151], v[120:123], v[236:239]
    ds_read_b64_tr_b16 a[226:227], v152 offset:33792
    v_mfma_f32_16x16x32_bf16 v[236:239], a[156:159], v[124:127], v[236:239]
    v_mfma_f32_16x16x32_bf16 v[232:235], a[152:155], v[124:127], v[232:235]
    ds_read_b64_tr_b16 a[228:229], v153 offset:32768
    v_mfma_f32_16x16x32_bf16 v[232:235], a[144:147], v[120:123], v[232:235]
    ds_read_b64_tr_b16 a[230:231], v153 offset:33792
    s_waitcnt lgkmcnt(4)
    v_mfma_f32_16x16x32_bf16 v[192:195], a[160:163], v[80:83], v[192:195]
    v_mfma_f32_16x16x32_bf16 v[192:195], a[168:171], v[84:87], v[192:195]
    ds_read_b128 v[104:107], v250 offset:13056
    v_mfma_f32_16x16x32_bf16 v[196:199], a[172:175], v[84:87], v[196:199]
    ds_read_b128 v[108:111], v250 offset:19200
    v_mfma_f32_16x16x32_bf16 v[196:199], a[164:167], v[80:83], v[196:199]
    ds_read_b128 v[112:115], v250 offset:13312
    v_mfma_f32_16x16x32_bf16 v[204:207], a[164:167], v[88:91], v[204:207]
    ds_read_b128 v[116:119], v250 offset:19456
    v_mfma_f32_16x16x32_bf16 v[204:207], a[172:175], v[92:95], v[204:207]
    ds_read_b128 v[120:123], v250 offset:13568
    v_mfma_f32_16x16x32_bf16 v[200:203], a[168:171], v[92:95], v[200:203]
    ds_read_b128 v[124:127], v250 offset:19712
    v_mfma_f32_16x16x32_bf16 v[200:203], a[160:163], v[88:91], v[200:203]
    ds_read_b64_tr_b16 a[232:233], v152 offset:40960
    v_mfma_f32_16x16x32_bf16 v[208:211], a[160:163], v[96:99], v[208:211]
    ds_read_b64_tr_b16 a[234:235], v152 offset:41984
    v_mfma_f32_16x16x32_bf16 v[208:211], a[168:171], v[100:103], v[208:211]
    v_mfma_f32_16x16x32_bf16 v[212:215], a[172:175], v[100:103], v[212:215]
    ds_read_b64_tr_b16 a[236:237], v153 offset:40960
    v_mfma_f32_16x16x32_bf16 v[212:215], a[164:167], v[96:99], v[212:215]
    ds_read_b64_tr_b16 a[238:239], v153 offset:41984
    s_waitcnt lgkmcnt(4)
    v_mfma_f32_16x16x32_bf16 v[220:223], a[164:167], v[104:107], v[220:223]
    s_waitcnt vmcnt(7)
    s_barrier
    v_mfma_f32_16x16x32_bf16 v[220:223], a[172:175], v[108:111], v[220:223]
    ds_read_b128 v[80:83], v250 offset:24576
    v_mfma_f32_16x16x32_bf16 v[216:219], a[168:171], v[108:111], v[216:219]
    ds_read_b128 v[84:87], v250 offset:30720
    v_mfma_f32_16x16x32_bf16 v[216:219], a[160:163], v[104:107], v[216:219]
    ds_read_b128 v[88:91], v250 offset:24832
    v_mfma_f32_16x16x32_bf16 v[224:227], a[160:163], v[112:115], v[224:227]
    ds_read_b128 v[92:95], v250 offset:30976
    v_mfma_f32_16x16x32_bf16 v[224:227], a[168:171], v[116:119], v[224:227]
    ds_read_b128 v[96:99], v250 offset:25088
    v_mfma_f32_16x16x32_bf16 v[228:231], a[172:175], v[116:119], v[228:231]
    ds_read_b128 v[100:103], v250 offset:31232
    v_mfma_f32_16x16x32_bf16 v[228:231], a[164:167], v[112:115], v[228:231]
    ds_read_b64_tr_b16 a[240:241], v152 offset:49152
    v_mfma_f32_16x16x32_bf16 v[236:239], a[164:167], v[120:123], v[236:239]
    ds_read_b64_tr_b16 a[242:243], v152 offset:50176
    v_mfma_f32_16x16x32_bf16 v[236:239], a[172:175], v[124:127], v[236:239]
    v_mfma_f32_16x16x32_bf16 v[232:235], a[168:171], v[124:127], v[232:235]
    ds_read_b64_tr_b16 a[244:245], v153 offset:49152
    v_mfma_f32_16x16x32_bf16 v[232:235], a[160:163], v[120:123], v[232:235]
    ds_read_b64_tr_b16 a[246:247], v153 offset:50176
    s_waitcnt lgkmcnt(4)
    v_mfma_f32_16x16x32_bf16 v[192:195], a[176:179], v[80:83], v[192:195]
    v_mfma_f32_16x16x32_bf16 v[192:195], a[184:187], v[84:87], v[192:195]
    ds_read_b128 v[104:107], v250 offset:25344
    v_mfma_f32_16x16x32_bf16 v[196:199], a[188:191], v[84:87], v[196:199]
    ds_read_b128 v[108:111], v250 offset:31488
    v_mfma_f32_16x16x32_bf16 v[196:199], a[180:183], v[80:83], v[196:199]
    ds_read_b128 v[112:115], v250 offset:25600
    v_mfma_f32_16x16x32_bf16 v[204:207], a[180:183], v[88:91], v[204:207]
    ds_read_b128 v[116:119], v250 offset:31744
    v_mfma_f32_16x16x32_bf16 v[204:207], a[188:191], v[92:95], v[204:207]
    ds_read_b128 v[120:123], v250 offset:25856
    v_mfma_f32_16x16x32_bf16 v[200:203], a[184:187], v[92:95], v[200:203]
    ds_read_b128 v[124:127], v250 offset:32000
    v_mfma_f32_16x16x32_bf16 v[200:203], a[176:179], v[88:91], v[200:203]
    ds_read_b64_tr_b16 a[248:249], v152 offset:57344
    v_mfma_f32_16x16x32_bf16 v[208:211], a[176:179], v[96:99], v[208:211]
    ds_read_b64_tr_b16 a[250:251], v152 offset:58368
    v_mfma_f32_16x16x32_bf16 v[208:211], a[184:187], v[100:103], v[208:211]
    v_mfma_f32_16x16x32_bf16 v[212:215], a[188:191], v[100:103], v[212:215]
    ds_read_b64_tr_b16 a[252:253], v153 offset:57344
    v_mfma_f32_16x16x32_bf16 v[212:215], a[180:183], v[96:99], v[212:215]
    ds_read_b64_tr_b16 a[254:255], v153 offset:58368
    s_waitcnt lgkmcnt(4)
    v_mfma_f32_16x16x32_bf16 v[220:223], a[180:183], v[104:107], v[220:223]
    s_barrier
    v_mfma_f32_16x16x32_bf16 v[220:223], a[188:191], v[108:111], v[220:223]
    ds_read_b128 v[80:83], v159 offset:0
    s_add_u32 m0, s74, 36864
    v_mfma_f32_16x16x32_bf16 v[216:219], a[184:187], v[108:111], v[216:219]
    ds_read_b128 v[84:87], v159 offset:6144
    v_mfma_f32_16x16x32_bf16 v[216:219], a[176:179], v[104:107], v[216:219]
    ds_read_b128 v[88:91], v159 offset:256
    buffer_load_dwordx4 v156, s[44:47], s81 offen offset:0 sc1 lds
    v_mfma_f32_16x16x32_bf16 v[224:227], a[176:179], v[112:115], v[224:227]
    ds_read_b128 v[92:95], v159 offset:6400
    v_mfma_f32_16x16x32_bf16 v[224:227], a[184:187], v[116:119], v[224:227]
    ds_read_b128 v[96:99], v159 offset:512
    v_mfma_f32_16x16x32_bf16 v[228:231], a[188:191], v[116:119], v[228:231]
    ds_read_b128 v[100:103], v159 offset:6656
    buffer_load_dwordx4 v157, s[44:47], s81 offen offset:1024 sc1 lds
    v_mfma_f32_16x16x32_bf16 v[228:231], a[180:183], v[112:115], v[228:231]
    v_mfma_f32_16x16x32_bf16 v[236:239], a[180:183], v[120:123], v[236:239]
    v_mfma_f32_16x16x32_bf16 v[236:239], a[188:191], v[124:127], v[236:239]
    buffer_load_dwordx4 v158, s[44:47], s81 offen offset:2048 sc1 lds
    v_mfma_f32_16x16x32_bf16 v[232:235], a[184:187], v[124:127], v[232:235]
    v_mfma_f32_16x16x32_bf16 v[232:235], a[176:179], v[120:123], v[232:235]
    s_waitcnt lgkmcnt(0)
    v_mfma_f32_16x16x32_bf16 v[192:195], a[192:195], v[80:83], v[192:195]
    s_and_b32 s13, s70, 1
    s_mul_i32 s13, s13, 3072
    v_mfma_f32_16x16x32_bf16 v[192:195], a[200:203], v[84:87], v[192:195]
    ds_read_b128 v[104:107], v159 offset:768
    s_sub_u32 s13, s13, 1536
    v_mfma_f32_16x16x32_bf16 v[196:199], a[204:207], v[84:87], v[196:199]
    ds_read_b128 v[108:111], v159 offset:6912
    v_add_u32 v156, s13, v156
    v_mfma_f32_16x16x32_bf16 v[196:199], a[196:199], v[80:83], v[196:199]
    ds_read_b128 v[112:115], v159 offset:1024
    v_mfma_f32_16x16x32_bf16 v[204:207], a[196:199], v[88:91], v[204:207]
    ds_read_b128 v[116:119], v159 offset:7168
    v_add_u32 v157, s13, v157
    v_mfma_f32_16x16x32_bf16 v[204:207], a[204:207], v[92:95], v[204:207]
    ds_read_b128 v[120:123], v159 offset:1280
    v_add_u32 v158, s13, v158
    v_mfma_f32_16x16x32_bf16 v[200:203], a[200:203], v[92:95], v[200:203]
    ds_read_b128 v[124:127], v159 offset:7424
    s_add_u32 m0, s74, 49152
    v_mfma_f32_16x16x32_bf16 v[200:203], a[192:195], v[88:91], v[200:203]
    v_mfma_f32_16x16x32_bf16 v[208:211], a[192:195], v[96:99], v[208:211]
    buffer_load_dwordx4 v156, s[44:47], s18 offen offset:0 sc1 lds
    v_mfma_f32_16x16x32_bf16 v[208:211], a[200:203], v[100:103], v[208:211]
    buffer_load_dwordx4 v157, s[44:47], s18 offen offset:1024 sc1 lds
    v_mfma_f32_16x16x32_bf16 v[212:215], a[204:207], v[100:103], v[212:215]
    buffer_load_dwordx4 v158, s[44:47], s18 offen offset:2048 sc1 lds
    v_mfma_f32_16x16x32_bf16 v[212:215], a[196:199], v[96:99], v[212:215]
    s_waitcnt lgkmcnt(0)
    v_mfma_f32_16x16x32_bf16 v[220:223], a[196:199], v[104:107], v[220:223]
    s_barrier
    v_mfma_f32_16x16x32_bf16 v[220:223], a[204:207], v[108:111], v[220:223]
    ds_read_b128 v[80:83], v159 offset:12288
    s_add_u32 m0, s74, 61440
    v_mfma_f32_16x16x32_bf16 v[216:219], a[200:203], v[108:111], v[216:219]
    ds_read_b128 v[84:87], v159 offset:18432
    v_mfma_f32_16x16x32_bf16 v[216:219], a[192:195], v[104:107], v[216:219]
    ds_read_b128 v[88:91], v159 offset:12544
    buffer_load_dwordx4 v156, s[44:47], s19 offen offset:0 sc1 lds
    v_mfma_f32_16x16x32_bf16 v[224:227], a[192:195], v[112:115], v[224:227]
    ds_read_b128 v[92:95], v159 offset:18688
    v_mfma_f32_16x16x32_bf16 v[224:227], a[200:203], v[116:119], v[224:227]
    ds_read_b128 v[96:99], v159 offset:12800
    v_mfma_f32_16x16x32_bf16 v[228:231], a[204:207], v[116:119], v[228:231]
    ds_read_b128 v[100:103], v159 offset:18944
    buffer_load_dwordx4 v157, s[44:47], s19 offen offset:1024 sc1 lds
    v_mfma_f32_16x16x32_bf16 v[228:231], a[196:199], v[112:115], v[228:231]
    v_mfma_f32_16x16x32_bf16 v[236:239], a[196:199], v[120:123], v[236:239]
    v_mfma_f32_16x16x32_bf16 v[236:239], a[204:207], v[124:127], v[236:239]
    buffer_load_dwordx4 v158, s[44:47], s19 offen offset:2048 sc1 lds
    v_mfma_f32_16x16x32_bf16 v[232:235], a[200:203], v[124:127], v[232:235]
    v_mfma_f32_16x16x32_bf16 v[232:235], a[192:195], v[120:123], v[232:235]
    s_waitcnt lgkmcnt(0)
    v_mfma_f32_16x16x32_bf16 v[192:195], a[208:211], v[80:83], v[192:195]
    s_add_u32 m0, s74, 0
    v_mfma_f32_16x16x32_bf16 v[192:195], a[216:219], v[84:87], v[192:195]
    ds_read_b128 v[104:107], v159 offset:13056
    v_mfma_f32_16x16x32_bf16 v[196:199], a[220:223], v[84:87], v[196:199]
    ds_read_b128 v[108:111], v159 offset:19200
    v_mfma_f32_16x16x32_bf16 v[196:199], a[212:215], v[80:83], v[196:199]
    ds_read_b128 v[112:115], v159 offset:13312
    buffer_load_dwordx4 v156, s[44:47], s20 offen offset:0 sc1 lds
    v_mfma_f32_16x16x32_bf16 v[204:207], a[212:215], v[88:91], v[204:207]
    ds_read_b128 v[116:119], v159 offset:19456
    v_mfma_f32_16x16x32_bf16 v[204:207], a[220:223], v[92:95], v[204:207]
    ds_read_b128 v[120:123], v159 offset:13568
    v_mfma_f32_16x16x32_bf16 v[200:203], a[216:219], v[92:95], v[200:203]
    ds_read_b128 v[124:127], v159 offset:19712
    buffer_load_dwordx4 v157, s[44:47], s20 offen offset:1024 sc1 lds
    v_mfma_f32_16x16x32_bf16 v[200:203], a[208:211], v[88:91], v[200:203]
    v_mfma_f32_16x16x32_bf16 v[208:211], a[208:211], v[96:99], v[208:211]
    v_mfma_f32_16x16x32_bf16 v[208:211], a[216:219], v[100:103], v[208:211]
    buffer_load_dwordx4 v158, s[44:47], s20 offen offset:2048 sc1 lds
    v_mfma_f32_16x16x32_bf16 v[212:215], a[220:223], v[100:103], v[212:215]
    v_mfma_f32_16x16x32_bf16 v[212:215], a[212:215], v[96:99], v[212:215]
    s_waitcnt lgkmcnt(0)
    v_mfma_f32_16x16x32_bf16 v[220:223], a[212:215], v[104:107], v[220:223]
    s_waitcnt vmcnt(16)
    s_barrier
    v_mfma_f32_16x16x32_bf16 v[220:223], a[220:223], v[108:111], v[220:223]
    ds_read_b128 v[80:83], v159 offset:24576
    s_add_u32 m0, s74, 12288
    v_mfma_f32_16x16x32_bf16 v[216:219], a[216:219], v[108:111], v[216:219]
    ds_read_b128 v[84:87], v159 offset:30720
    v_mfma_f32_16x16x32_bf16 v[216:219], a[208:211], v[104:107], v[216:219]
    ds_read_b128 v[88:91], v159 offset:24832
    buffer_load_dwordx4 v156, s[44:47], s21 offen offset:0 sc1 lds
    v_mfma_f32_16x16x32_bf16 v[224:227], a[208:211], v[112:115], v[224:227]
    ds_read_b128 v[92:95], v159 offset:30976
    v_mfma_f32_16x16x32_bf16 v[224:227], a[216:219], v[116:119], v[224:227]
    ds_read_b128 v[96:99], v159 offset:25088
    v_mfma_f32_16x16x32_bf16 v[228:231], a[220:223], v[116:119], v[228:231]
    ds_read_b128 v[100:103], v159 offset:31232
    buffer_load_dwordx4 v157, s[44:47], s21 offen offset:1024 sc1 lds
    v_mfma_f32_16x16x32_bf16 v[228:231], a[212:215], v[112:115], v[228:231]
    v_mfma_f32_16x16x32_bf16 v[236:239], a[212:215], v[120:123], v[236:239]
    v_mfma_f32_16x16x32_bf16 v[236:239], a[220:223], v[124:127], v[236:239]
    buffer_load_dwordx4 v158, s[44:47], s21 offen offset:2048 sc1 lds
    v_mfma_f32_16x16x32_bf16 v[232:235], a[216:219], v[124:127], v[232:235]
    v_mfma_f32_16x16x32_bf16 v[232:235], a[208:211], v[120:123], v[232:235]
    s_waitcnt lgkmcnt(0)
    v_mfma_f32_16x16x32_bf16 v[192:195], a[224:227], v[80:83], v[192:195]
    s_add_u32 m0, s73, 0
    s_lshl_b32 s14, s85, 18
    v_mfma_f32_16x16x32_bf16 v[192:195], a[232:235], v[84:87], v[192:195]
    ds_read_b128 v[104:107], v159 offset:25344
    v_mfma_f32_16x16x32_bf16 v[196:199], a[236:239], v[84:87], v[196:199]
    ds_read_b128 v[108:111], v159 offset:31488
    buffer_load_dwordx4 v4, s[52:55], s14 offen offset:0 lds
    v_mfma_f32_16x16x32_bf16 v[196:199], a[228:231], v[80:83], v[196:199]
    ds_read_b128 v[112:115], v159 offset:25600
    v_mfma_f32_16x16x32_bf16 v[204:207], a[228:231], v[88:91], v[204:207]
    ds_read_b128 v[116:119], v159 offset:31744
    buffer_load_dwordx4 v5, s[52:55], s14 offen offset:1024 lds
    v_mfma_f32_16x16x32_bf16 v[204:207], a[236:239], v[92:95], v[204:207]
    ds_read_b128 v[120:123], v159 offset:25856
    v_mfma_f32_16x16x32_bf16 v[200:203], a[232:235], v[92:95], v[200:203]
    ds_read_b128 v[124:127], v159 offset:32000
    v_mfma_f32_16x16x32_bf16 v[200:203], a[224:227], v[88:91], v[200:203]
    buffer_load_dwordx4 v6, s[52:55], s14 offen offset:2048 lds
    v_mfma_f32_16x16x32_bf16 v[208:211], a[224:227], v[96:99], v[208:211]
    v_mfma_f32_16x16x32_bf16 v[208:211], a[232:235], v[100:103], v[208:211]
    buffer_load_dwordx4 v7, s[52:55], s14 offen offset:3072 lds
    v_mfma_f32_16x16x32_bf16 v[212:215], a[236:239], v[100:103], v[212:215]
    v_mfma_f32_16x16x32_bf16 v[212:215], a[228:231], v[96:99], v[212:215]
    s_waitcnt lgkmcnt(0)
    v_mfma_f32_16x16x32_bf16 v[220:223], a[228:231], v[104:107], v[220:223]
    s_waitcnt vmcnt(16)
    s_barrier
    v_mfma_f32_16x16x32_bf16 v[220:223], a[236:239], v[108:111], v[220:223]
    ds_read_b128 v[80:83], v250 offset:0
    v_mfma_f32_16x16x32_bf16 v[216:219], a[232:235], v[108:111], v[216:219]
    ds_read_b128 v[84:87], v250 offset:6144
    v_mfma_f32_16x16x32_bf16 v[216:219], a[224:227], v[104:107], v[216:219]
    ds_read_b128 v[88:91], v250 offset:256
    v_mfma_f32_16x16x32_bf16 v[224:227], a[224:227], v[112:115], v[224:227]
    ds_read_b128 v[92:95], v250 offset:6400
    v_mfma_f32_16x16x32_bf16 v[224:227], a[232:235], v[116:119], v[224:227]
    ds_read_b128 v[96:99], v250 offset:512
    v_mfma_f32_16x16x32_bf16 v[228:231], a[236:239], v[116:119], v[228:231]
L_pl_G_3:
    s_cbranch_execz L_wret
    ds_read_b128 v[100:103], v250 offset:6656
    v_mfma_f32_16x16x32_bf16 v[228:231], a[228:231], v[112:115], v[228:231]
    v_mfma_f32_16x16x32_bf16 v[236:239], a[228:231], v[120:123], v[236:239]
    v_mfma_f32_16x16x32_bf16 v[236:239], a[236:239], v[124:127], v[236:239]
    v_mfma_f32_16x16x32_bf16 v[232:235], a[232:235], v[124:127], v[232:235]
    v_mfma_f32_16x16x32_bf16 v[232:235], a[224:227], v[120:123], v[232:235]
    s_waitcnt lgkmcnt(0)
    v_mfma_f32_16x16x32_bf16 v[192:195], a[240:243], v[80:83], v[192:195]
    v_mfma_f32_16x16x32_bf16 v[192:195], a[248:251], v[84:87], v[192:195]
    ds_read_b128 v[104:107], v250 offset:768
    v_mfma_f32_16x16x32_bf16 v[196:199], a[252:255], v[84:87], v[196:199]
    ds_read_b128 v[108:111], v250 offset:6912
    v_mfma_f32_16x16x32_bf16 v[196:199], a[244:247], v[80:83], v[196:199]
    ds_read_b128 v[112:115], v250 offset:1024
    v_mfma_f32_16x16x32_bf16 v[204:207], a[244:247], v[88:91], v[204:207]
    ds_read_b128 v[116:119], v250 offset:7168
    v_mfma_f32_16x16x32_bf16 v[204:207], a[252:255], v[92:95], v[204:207]
    ds_read_b128 v[120:123], v250 offset:1280
    v_mfma_f32_16x16x32_bf16 v[200:203], a[248:251], v[92:95], v[200:203]
    ds_read_b128 v[124:127], v250 offset:7424
    v_mfma_f32_16x16x32_bf16 v[200:203], a[240:243], v[88:91], v[200:203]
    v_mfma_f32_16x16x32_bf16 v[208:211], a[240:243], v[96:99], v[208:211]
    v_mfma_f32_16x16x32_bf16 v[208:211], a[248:251], v[100:103], v[208:211]
    v_mfma_f32_16x16x32_bf16 v[212:215], a[252:255], v[100:103], v[212:215]
    v_mfma_f32_16x16x32_bf16 v[212:215], a[244:247], v[96:99], v[212:215]
    s_waitcnt lgkmcnt(0)
    v_mfma_f32_16x16x32_bf16 v[220:223], a[244:247], v[104:107], v[220:223]
    s_waitcnt vmcnt(13)
    s_barrier
    v_mfma_f32_16x16x32_bf16 v[220:223], a[252:255], v[108:111], v[220:223]
    ds_read_b128 v[80:83], v250 offset:12288
    v_mfma_f32_16x16x32_bf16 v[216:219], a[248:251], v[108:111], v[216:219]
    ds_read_b128 v[84:87], v250 offset:18432
    v_mfma_f32_16x16x32_bf16 v[216:219], a[240:243], v[104:107], v[216:219]
    ds_read_b128 v[88:91], v250 offset:12544
    v_mfma_f32_16x16x32_bf16 v[224:227], a[240:243], v[112:115], v[224:227]
    ds_read_b128 v[92:95], v250 offset:18688
    v_cvt_pk_bf16_f32 v192, v192, v193
    v_mfma_f32_16x16x32_bf16 v[224:227], a[248:251], v[116:119], v[224:227]
    ds_read_b128 v[96:99], v250 offset:12800
    v_mfma_f32_16x16x32_bf16 v[228:231], a[252:255], v[116:119], v[228:231]
    ds_read_b128 v[100:103], v250 offset:18944
    v_cvt_pk_bf16_f32 v193, v194, v195
    v_mfma_f32_16x16x32_bf16 v[228:231], a[244:247], v[112:115], v[228:231]
    v_mfma_f32_16x16x32_bf16 v[236:239], a[244:247], v[120:123], v[236:239]
    v_cvt_pk_bf16_f32 v194, v196, v197
    v_mfma_f32_16x16x32_bf16 v[236:239], a[252:255], v[124:127], v[236:239]
    v_cvt_pk_bf16_f32 v195, v198, v199
    v_mfma_f32_16x16x32_bf16 v[232:235], a[248:251], v[124:127], v[232:235]
    v_mfma_f32_16x16x32_bf16 v[232:235], a[240:243], v[120:123], v[232:235]
    buffer_store_dwordx4 v[192:195], v246, s[44:47], s9 offen offset:0 sc1
    s_waitcnt lgkmcnt(0)
    v_mfma_f32_16x16x32_bf16 v[32:35], a[0:3], v[80:83], v[128:131]
    v_mfma_f32_16x16x32_bf16 v[32:35], a[8:11], v[84:87], v[32:35]
    ds_read_b128 v[104:107], v250 offset:13056
    v_mfma_f32_16x16x32_bf16 v[36:39], a[12:15], v[84:87], v[132:135]
    ds_read_b128 v[108:111], v250 offset:19200
    v_mfma_f32_16x16x32_bf16 v[36:39], a[4:7], v[80:83], v[36:39]
    ds_read_b128 v[112:115], v250 offset:13312
    v_mfma_f32_16x16x32_bf16 v[44:47], a[4:7], v[88:91], v[132:135]
    ds_read_b128 v[116:119], v250 offset:19456
    v_cvt_pk_bf16_f32 v200, v200, v201
    v_mfma_f32_16x16x32_bf16 v[44:47], a[12:15], v[92:95], v[44:47]
    ds_read_b128 v[120:123], v250 offset:13568
    v_mfma_f32_16x16x32_bf16 v[40:43], a[8:11], v[92:95], v[128:131]
    ds_read_b128 v[124:127], v250 offset:19712
    v_cvt_pk_bf16_f32 v201, v202, v203
    v_mfma_f32_16x16x32_bf16 v[40:43], a[0:3], v[88:91], v[40:43]
    v_mfma_f32_16x16x32_bf16 v[48:51], a[0:3], v[96:99], v[128:131]
    v_cvt_pk_bf16_f32 v202, v204, v205
    v_mfma_f32_16x16x32_bf16 v[48:51], a[8:11], v[100:103], v[48:51]
    v_cvt_pk_bf16_f32 v203, v206, v207
    v_mfma_f32_16x16x32_bf16 v[52:55], a[12:15], v[100:103], v[132:135]
    v_mfma_f32_16x16x32_bf16 v[52:55], a[4:7], v[96:99], v[52:55]
    buffer_store_dwordx4 v[200:203], v246, s[44:47], s9 offen offset:1024 sc1
    s_waitcnt lgkmcnt(0)
    v_mfma_f32_16x16x32_bf16 v[60:63], a[4:7], v[104:107], v[132:135]
    s_waitcnt vmcnt(12)
    s_barrier
    v_mfma_f32_16x16x32_bf16 v[60:63], a[12:15], v[108:111], v[60:63]
    ds_read_b128 v[80:83], v250 offset:24576
    s_add_u32 m0, s74, 24576
    v_cvt_pk_bf16_f32 v208, v208, v209
    v_mfma_f32_16x16x32_bf16 v[56:59], a[8:11], v[108:111], v[128:131]
    ds_read_b128 v[84:87], v250 offset:30720
    v_mfma_f32_16x16x32_bf16 v[56:59], a[0:3], v[104:107], v[56:59]
    ds_read_b128 v[88:91], v250 offset:24832
    buffer_load_dwordx4 v156, s[44:47], s22 offen offset:0 sc1 lds
    v_mfma_f32_16x16x32_bf16 v[64:67], a[0:3], v[112:115], v[128:131]
    ds_read_b128 v[92:95], v250 offset:30976
    v_cvt_pk_bf16_f32 v209, v210, v211
    v_mfma_f32_16x16x32_bf16 v[64:67], a[8:11], v[116:119], v[64:67]
    ds_read_b128 v[96:99], v250 offset:25088
    v_cvt_pk_bf16_f32 v210, v212, v213
    v_mfma_f32_16x16x32_bf16 v[68:71], a[12:15], v[116:119], v[132:135]
    ds_read_b128 v[100:103], v250 offset:31232
    buffer_load_dwordx4 v157, s[44:47], s22 offen offset:1024 sc1 lds
    v_mfma_f32_16x16x32_bf16 v[68:71], a[4:7], v[112:115], v[68:71]
    v_mfma_f32_16x16x32_bf16 v[76:79], a[4:7], v[120:123], v[132:135]
    v_cvt_pk_bf16_f32 v211, v214, v215
    v_mfma_f32_16x16x32_bf16 v[76:79], a[12:15], v[124:127], v[76:79]
    buffer_load_dwordx4 v158, s[44:47], s22 offen offset:2048 sc1 lds
    v_mfma_f32_16x16x32_bf16 v[72:75], a[8:11], v[124:127], v[128:131]
    buffer_store_dwordx4 v[208:211], v246, s[44:47], s9 offen offset:2048 sc1
    v_mfma_f32_16x16x32_bf16 v[72:75], a[0:3], v[120:123], v[72:75]
    s_waitcnt lgkmcnt(0)
    v_mfma_f32_16x16x32_bf16 v[32:35], a[16:19], v[80:83], v[32:35]
    s_add_u32 m0, s74, 36864
    v_mfma_f32_16x16x32_bf16 v[32:35], a[24:27], v[84:87], v[32:35]
    ds_read_b128 v[104:107], v250 offset:25344
    v_cvt_pk_bf16_f32 v216, v216, v217
    v_mfma_f32_16x16x32_bf16 v[36:39], a[28:31], v[84:87], v[36:39]
    ds_read_b128 v[108:111], v250 offset:31488
    v_mfma_f32_16x16x32_bf16 v[36:39], a[20:23], v[80:83], v[36:39]
    ds_read_b128 v[112:115], v250 offset:25600
    buffer_load_dwordx4 v156, s[44:47], s23 offen offset:0 sc1 lds
    v_mfma_f32_16x16x32_bf16 v[44:47], a[20:23], v[88:91], v[44:47]
    ds_read_b128 v[116:119], v250 offset:31744
    v_cvt_pk_bf16_f32 v217, v218, v219
    v_mfma_f32_16x16x32_bf16 v[44:47], a[28:31], v[92:95], v[44:47]
    ds_read_b128 v[120:123], v250 offset:25856
    v_cvt_pk_bf16_f32 v218, v220, v221
    v_mfma_f32_16x16x32_bf16 v[40:43], a[24:27], v[92:95], v[40:43]
    ds_read_b128 v[124:127], v250 offset:32000
    buffer_load_dwordx4 v157, s[44:47], s23 offen offset:1024 sc1 lds
    v_mfma_f32_16x16x32_bf16 v[40:43], a[16:19], v[88:91], v[40:43]
    v_mfma_f32_16x16x32_bf16 v[48:51], a[16:19], v[96:99], v[48:51]
    v_cvt_pk_bf16_f32 v219, v222, v223
    v_mfma_f32_16x16x32_bf16 v[48:51], a[24:27], v[100:103], v[48:51]
    buffer_load_dwordx4 v158, s[44:47], s23 offen offset:2048 sc1 lds
    v_mfma_f32_16x16x32_bf16 v[52:55], a[28:31], v[100:103], v[52:55]
    buffer_store_dwordx4 v[216:219], v247, s[44:47], s9 offen offset:0 sc1
    v_mfma_f32_16x16x32_bf16 v[52:55], a[20:23], v[96:99], v[52:55]
    s_waitcnt lgkmcnt(0)
    v_mfma_f32_16x16x32_bf16 v[60:63], a[20:23], v[104:107], v[60:63]
    s_waitcnt vmcnt(17)
    s_barrier
    v_mfma_f32_16x16x32_bf16 v[60:63], a[28:31], v[108:111], v[60:63]
    ds_read_b128 v[80:83], v159 offset:0
    s_add_u32 m0, s74, 49152
    v_cvt_pk_bf16_f32 v224, v224, v225
    v_mfma_f32_16x16x32_bf16 v[56:59], a[24:27], v[108:111], v[56:59]
    ds_read_b128 v[84:87], v159 offset:6144
    v_mfma_f32_16x16x32_bf16 v[56:59], a[16:19], v[104:107], v[56:59]
    ds_read_b128 v[88:91], v159 offset:256
    buffer_load_dwordx4 v156, s[44:47], s24 offen offset:0 sc1 lds
    v_mfma_f32_16x16x32_bf16 v[64:67], a[16:19], v[112:115], v[64:67]
    ds_read_b128 v[92:95], v159 offset:6400
    v_cvt_pk_bf16_f32 v225, v226, v227
    v_mfma_f32_16x16x32_bf16 v[64:67], a[24:27], v[116:119], v[64:67]
    ds_read_b128 v[96:99], v159 offset:512
    v_cvt_pk_bf16_f32 v226, v228, v229
    v_mfma_f32_16x16x32_bf16 v[68:71], a[28:31], v[116:119], v[68:71]
    ds_read_b128 v[100:103], v159 offset:6656
    buffer_load_dwordx4 v157, s[44:47], s24 offen offset:1024 sc1 lds
    v_mfma_f32_16x16x32_bf16 v[68:71], a[20:23], v[112:115], v[68:71]
    v_add_u32 v10, 65536, v10
    v_mfma_f32_16x16x32_bf16 v[76:79], a[20:23], v[120:123], v[76:79]
    ds_read_b64_tr_b16 a[0:1], v10 offset:0
    v_cvt_pk_bf16_f32 v227, v230, v231
    v_mfma_f32_16x16x32_bf16 v[76:79], a[28:31], v[124:127], v[76:79]
    ds_read_b64_tr_b16 a[2:3], v10 offset:2048
    buffer_load_dwordx4 v158, s[44:47], s24 offen offset:2048 sc1 lds
    v_mfma_f32_16x16x32_bf16 v[72:75], a[24:27], v[124:127], v[72:75]
    buffer_store_dwordx4 v[224:227], v247, s[44:47], s9 offen offset:1024 sc1
    ds_read_b64_tr_b16 a[8:9], v10 offset:4096
    v_mfma_f32_16x16x32_bf16 v[72:75], a[16:19], v[120:123], v[72:75]
    ds_read_b64_tr_b16 a[10:11], v10 offset:6144
    s_waitcnt lgkmcnt(4)
    v_mfma_f32_16x16x32_bf16 v[32:35], a[32:35], v[80:83], v[32:35]
    s_add_u32 m0, s74, 61440
    v_mfma_f32_16x16x32_bf16 v[32:35], a[40:43], v[84:87], v[32:35]
    ds_read_b128 v[104:107], v159 offset:768
    v_cvt_pk_bf16_f32 v232, v232, v233
    v_mfma_f32_16x16x32_bf16 v[36:39], a[44:47], v[84:87], v[36:39]
    ds_read_b128 v[108:111], v159 offset:6912
    v_mfma_f32_16x16x32_bf16 v[36:39], a[36:39], v[80:83], v[36:39]
    ds_read_b128 v[112:115], v159 offset:1024
    buffer_load_dwordx4 v156, s[44:47], s25 offen offset:0 sc1 lds
    v_mfma_f32_16x16x32_bf16 v[44:47], a[36:39], v[88:91], v[44:47]
    ds_read_b128 v[116:119], v159 offset:7168
    v_cvt_pk_bf16_f32 v233, v234, v235
    v_mfma_f32_16x16x32_bf16 v[44:47], a[44:47], v[92:95], v[44:47]
    ds_read_b128 v[120:123], v159 offset:1280
    v_cvt_pk_bf16_f32 v234, v236, v237
    v_mfma_f32_16x16x32_bf16 v[40:43], a[40:43], v[92:95], v[40:43]
    ds_read_b128 v[124:127], v159 offset:7424
    buffer_load_dwordx4 v157, s[44:47], s25 offen offset:1024 sc1 lds
    v_mfma_f32_16x16x32_bf16 v[40:43], a[32:35], v[88:91], v[40:43]
    v_add_u32 v11, 65536, v11
    v_mfma_f32_16x16x32_bf16 v[48:51], a[32:35], v[96:99], v[48:51]
    ds_read_b64_tr_b16 a[4:5], v11 offset:0
    v_cvt_pk_bf16_f32 v235, v238, v239
    v_mfma_f32_16x16x32_bf16 v[48:51], a[40:43], v[100:103], v[48:51]
    ds_read_b64_tr_b16 a[6:7], v11 offset:2048
    buffer_load_dwordx4 v158, s[44:47], s25 offen offset:2048 sc1 lds
    v_mfma_f32_16x16x32_bf16 v[52:55], a[44:47], v[100:103], v[52:55]
    buffer_store_dwordx4 v[232:235], v247, s[44:47], s9 offen offset:2048 sc1
    ds_read_b64_tr_b16 a[12:13], v11 offset:4096
    v_mfma_f32_16x16x32_bf16 v[52:55], a[36:39], v[96:99], v[52:55]
    ds_read_b64_tr_b16 a[14:15], v11 offset:6144
    s_waitcnt lgkmcnt(4)
    v_mfma_f32_16x16x32_bf16 v[60:63], a[36:39], v[104:107], v[60:63]
    s_waitcnt vmcnt(18)
    s_barrier
    v_mfma_f32_16x16x32_bf16 v[60:63], a[44:47], v[108:111], v[60:63]
    ds_read_b128 v[80:83], v159 offset:12288
    s_add_u32 m0, s74, 0
    v_mfma_f32_16x16x32_bf16 v[56:59], a[40:43], v[108:111], v[56:59]
    ds_read_b128 v[84:87], v159 offset:18432
    v_mfma_f32_16x16x32_bf16 v[56:59], a[32:35], v[104:107], v[56:59]
    ds_read_b128 v[88:91], v159 offset:12544
    buffer_load_dwordx4 v156, s[44:47], s26 offen offset:0 sc1 lds
    v_mfma_f32_16x16x32_bf16 v[64:67], a[32:35], v[112:115], v[64:67]
    ds_read_b128 v[92:95], v159 offset:18688
    v_mfma_f32_16x16x32_bf16 v[64:67], a[40:43], v[116:119], v[64:67]
    ds_read_b128 v[96:99], v159 offset:12800
    v_mfma_f32_16x16x32_bf16 v[68:71], a[44:47], v[116:119], v[68:71]
    ds_read_b128 v[100:103], v159 offset:18944
    buffer_load_dwordx4 v157, s[44:47], s26 offen offset:1024 sc1 lds
    v_mfma_f32_16x16x32_bf16 v[68:71], a[36:39], v[112:115], v[68:71]
    v_add_u32 v10, -65536, v10
    v_mfma_f32_16x16x32_bf16 v[76:79], a[36:39], v[120:123], v[76:79]
    ds_read_b64_tr_b16 a[16:17], v10 offset:0
    v_mfma_f32_16x16x32_bf16 v[76:79], a[44:47], v[124:127], v[76:79]
    ds_read_b64_tr_b16 a[18:19], v10 offset:2048
    buffer_load_dwordx4 v158, s[44:47], s26 offen offset:2048 sc1 lds
    v_mfma_f32_16x16x32_bf16 v[72:75], a[40:43], v[124:127], v[72:75]
    ds_read_b64_tr_b16 a[24:25], v10 offset:4096
    v_mfma_f32_16x16x32_bf16 v[72:75], a[32:35], v[120:123], v[72:75]
    ds_read_b64_tr_b16 a[26:27], v10 offset:6144
    s_waitcnt lgkmcnt(4)
    v_mfma_f32_16x16x32_bf16 v[32:35], a[48:51], v[80:83], v[32:35]
    v_mfma_f32_16x16x32_bf16 v[32:35], a[56:59], v[84:87], v[32:35]
    ds_read_b128 v[104:107], v159 offset:13056
    v_mfma_f32_16x16x32_bf16 v[36:39], a[60:63], v[84:87], v[36:39]
    ds_read_b128 v[108:111], v159 offset:19200
    v_mfma_f32_16x16x32_bf16 v[36:39], a[52:55], v[80:83], v[36:39]
    ds_read_b128 v[112:115], v159 offset:13312
    v_mfma_f32_16x16x32_bf16 v[44:47], a[52:55], v[88:91], v[44:47]
    ds_read_b128 v[116:119], v159 offset:19456
    v_mfma_f32_16x16x32_bf16 v[44:47], a[60:63], v[92:95], v[44:47]
    ds_read_b128 v[120:123], v159 offset:13568
    v_mfma_f32_16x16x32_bf16 v[40:43], a[56:59], v[92:95], v[40:43]
    ds_read_b128 v[124:127], v159 offset:19712
    v_mfma_f32_16x16x32_bf16 v[40:43], a[48:51], v[88:91], v[40:43]
    v_add_u32 v11, -65536, v11
    v_mfma_f32_16x16x32_bf16 v[48:51], a[48:51], v[96:99], v[48:51]
    ds_read_b64_tr_b16 a[20:21], v11 offset:0
    v_mfma_f32_16x16x32_bf16 v[48:51], a[56:59], v[100:103], v[48:51]
    ds_read_b64_tr_b16 a[22:23], v11 offset:2048
    v_mfma_f32_16x16x32_bf16 v[52:55], a[60:63], v[100:103], v[52:55]
    ds_read_b64_tr_b16 a[28:29], v11 offset:4096
    v_mfma_f32_16x16x32_bf16 v[52:55], a[52:55], v[96:99], v[52:55]
    ds_read_b64_tr_b16 a[30:31], v11 offset:6144
    s_waitcnt lgkmcnt(4)
    v_mfma_f32_16x16x32_bf16 v[60:63], a[52:55], v[104:107], v[60:63]
    s_waitcnt vmcnt(16)
    s_barrier
    v_mfma_f32_16x16x32_bf16 v[60:63], a[60:63], v[108:111], v[60:63]
    ds_read_b128 v[80:83], v159 offset:24576
    s_add_u32 m0, s74, 12288
    v_mfma_f32_16x16x32_bf16 v[56:59], a[56:59], v[108:111], v[56:59]
    ds_read_b128 v[84:87], v159 offset:30720
    v_mfma_f32_16x16x32_bf16 v[56:59], a[48:51], v[104:107], v[56:59]
    ds_read_b128 v[88:91], v159 offset:24832
    buffer_load_dwordx4 v156, s[44:47], s27 offen offset:0 sc1 lds
    v_mfma_f32_16x16x32_bf16 v[64:67], a[48:51], v[112:115], v[64:67]
    ds_read_b128 v[92:95], v159 offset:30976
    v_mfma_f32_16x16x32_bf16 v[64:67], a[56:59], v[116:119], v[64:67]
    ds_read_b128 v[96:99], v159 offset:25088
    v_mfma_f32_16x16x32_bf16 v[68:71], a[60:63], v[116:119], v[68:71]
    ds_read_b128 v[100:103], v159 offset:31232
    buffer_load_dwordx4 v157, s[44:47], s27 offen offset:1024 sc1 lds
    v_mfma_f32_16x16x32_bf16 v[68:71], a[52:55], v[112:115], v[68:71]
    v_mfma_f32_16x16x32_bf16 v[76:79], a[52:55], v[120:123], v[76:79]
    v_mfma_f32_16x16x32_bf16 v[76:79], a[60:63], v[124:127], v[76:79]
    buffer_load_dwordx4 v158, s[44:47], s27 offen offset:2048 sc1 lds
    v_mfma_f32_16x16x32_bf16 v[72:75], a[56:59], v[124:127], v[72:75]
    v_mfma_f32_16x16x32_bf16 v[72:75], a[48:51], v[120:123], v[72:75]
    s_waitcnt lgkmcnt(0)
    v_mfma_f32_16x16x32_bf16 v[32:35], a[64:67], v[80:83], v[32:35]
    s_add_u32 m0, s73, 16384
    s_lshl_b32 s14, s86, 18
    v_mfma_f32_16x16x32_bf16 v[32:35], a[72:75], v[84:87], v[32:35]
    ds_read_b128 v[104:107], v159 offset:25344
    v_mfma_f32_16x16x32_bf16 v[36:39], a[76:79], v[84:87], v[36:39]
    ds_read_b128 v[108:111], v159 offset:31488
    buffer_load_dwordx4 v4, s[52:55], s14 offen offset:0 lds
    v_mfma_f32_16x16x32_bf16 v[36:39], a[68:71], v[80:83], v[36:39]
    ds_read_b128 v[112:115], v159 offset:25600
    v_mfma_f32_16x16x32_bf16 v[44:47], a[68:71], v[88:91], v[44:47]
    ds_read_b128 v[116:119], v159 offset:31744
    buffer_load_dwordx4 v5, s[52:55], s14 offen offset:1024 lds
    v_mfma_f32_16x16x32_bf16 v[44:47], a[76:79], v[92:95], v[44:47]
    ds_read_b128 v[120:123], v159 offset:25856
    v_mfma_f32_16x16x32_bf16 v[40:43], a[72:75], v[92:95], v[40:43]
    ds_read_b128 v[124:127], v159 offset:32000
    v_mfma_f32_16x16x32_bf16 v[40:43], a[64:67], v[88:91], v[40:43]
    buffer_load_dwordx4 v6, s[52:55], s14 offen offset:2048 lds
    v_mfma_f32_16x16x32_bf16 v[48:51], a[64:67], v[96:99], v[48:51]
    v_mfma_f32_16x16x32_bf16 v[48:51], a[72:75], v[100:103], v[48:51]
    buffer_load_dwordx4 v7, s[52:55], s14 offen offset:3072 lds
    v_mfma_f32_16x16x32_bf16 v[52:55], a[76:79], v[100:103], v[52:55]
    v_mfma_f32_16x16x32_bf16 v[52:55], a[68:71], v[96:99], v[52:55]
    s_waitcnt lgkmcnt(0)
    v_mfma_f32_16x16x32_bf16 v[60:63], a[68:71], v[104:107], v[60:63]
    s_waitcnt vmcnt(19)
    s_barrier
    v_mfma_f32_16x16x32_bf16 v[60:63], a[76:79], v[108:111], v[60:63]
    ds_read_b128 v[80:83], v250 offset:0
    v_mfma_f32_16x16x32_bf16 v[56:59], a[72:75], v[108:111], v[56:59]
    ds_read_b128 v[84:87], v250 offset:6144
    v_mfma_f32_16x16x32_bf16 v[56:59], a[64:67], v[104:107], v[56:59]
    ds_read_b128 v[88:91], v250 offset:256
    v_mfma_f32_16x16x32_bf16 v[64:67], a[64:67], v[112:115], v[64:67]
    ds_read_b128 v[92:95], v250 offset:6400
    v_mfma_f32_16x16x32_bf16 v[64:67], a[72:75], v[116:119], v[64:67]
    ds_read_b128 v[96:99], v250 offset:512
    v_mfma_f32_16x16x32_bf16 v[68:71], a[76:79], v[116:119], v[68:71]
    ds_read_b128 v[100:103], v250 offset:6656
    v_mfma_f32_16x16x32_bf16 v[68:71], a[68:71], v[112:115], v[68:71]
    v_mfma_f32_16x16x32_bf16 v[76:79], a[68:71], v[120:123], v[76:79]
    v_mfma_f32_16x16x32_bf16 v[76:79], a[76:79], v[124:127], v[76:79]
    v_mfma_f32_16x16x32_bf16 v[72:75], a[72:75], v[124:127], v[72:75]
    v_mfma_f32_16x16x32_bf16 v[72:75], a[64:67], v[120:123], v[72:75]
    s_waitcnt lgkmcnt(0)
    v_mfma_f32_16x16x32_bf16 v[32:35], a[80:83], v[80:83], v[32:35]
    v_mfma_f32_16x16x32_bf16 v[32:35], a[88:91], v[84:87], v[32:35]
    ds_read_b128 v[104:107], v250 offset:768
    v_mfma_f32_16x16x32_bf16 v[36:39], a[92:95], v[84:87], v[36:39]
    ds_read_b128 v[108:111], v250 offset:6912
    v_mfma_f32_16x16x32_bf16 v[36:39], a[84:87], v[80:83], v[36:39]
    ds_read_b128 v[112:115], v250 offset:1024
    v_mfma_f32_16x16x32_bf16 v[44:47], a[84:87], v[88:91], v[44:47]
    ds_read_b128 v[116:119], v250 offset:7168
    v_mfma_f32_16x16x32_bf16 v[44:47], a[92:95], v[92:95], v[44:47]
    ds_read_b128 v[120:123], v250 offset:1280
    v_mfma_f32_16x16x32_bf16 v[40:43], a[88:91], v[92:95], v[40:43]
    ds_read_b128 v[124:127], v250 offset:7424
    v_mfma_f32_16x16x32_bf16 v[40:43], a[80:83], v[88:91], v[40:43]
    s_waitcnt vmcnt(10)
    buffer_store_dword v249, v248, s[44:47], s6 offen sc1
    v_mfma_f32_16x16x32_bf16 v[48:51], a[80:83], v[96:99], v[48:51]
    v_mfma_f32_16x16x32_bf16 v[48:51], a[88:91], v[100:103], v[48:51]
    v_mfma_f32_16x16x32_bf16 v[52:55], a[92:95], v[100:103], v[52:55]
    v_mfma_f32_16x16x32_bf16 v[52:55], a[84:87], v[96:99], v[52:55]
    s_waitcnt lgkmcnt(0)
    v_mfma_f32_16x16x32_bf16 v[60:63], a[84:87], v[104:107], v[60:63]
    s_barrier
    v_mfma_f32_16x16x32_bf16 v[60:63], a[92:95], v[108:111], v[60:63]
    ds_read_b128 v[80:83], v250 offset:12288
    v_mfma_f32_16x16x32_bf16 v[56:59], a[88:91], v[108:111], v[56:59]
    ds_read_b128 v[84:87], v250 offset:18432
    v_mfma_f32_16x16x32_bf16 v[56:59], a[80:83], v[104:107], v[56:59]
    ds_read_b128 v[88:91], v250 offset:12544
    v_mfma_f32_16x16x32_bf16 v[64:67], a[80:83], v[112:115], v[64:67]
    ds_read_b128 v[92:95], v250 offset:18688
    v_mfma_f32_16x16x32_bf16 v[64:67], a[88:91], v[116:119], v[64:67]
    ds_read_b128 v[96:99], v250 offset:12800
    v_mfma_f32_16x16x32_bf16 v[68:71], a[92:95], v[116:119], v[68:71]
    ds_read_b128 v[100:103], v250 offset:18944
    v_mfma_f32_16x16x32_bf16 v[68:71], a[84:87], v[112:115], v[68:71]
    v_mfma_f32_16x16x32_bf16 v[76:79], a[84:87], v[120:123], v[76:79]
    v_mfma_f32_16x16x32_bf16 v[76:79], a[92:95], v[124:127], v[76:79]
    v_mfma_f32_16x16x32_bf16 v[72:75], a[88:91], v[124:127], v[72:75]
    v_mfma_f32_16x16x32_bf16 v[72:75], a[80:83], v[120:123], v[72:75]
    s_waitcnt lgkmcnt(0)
    v_mfma_f32_16x16x32_bf16 v[32:35], a[96:99], v[80:83], v[32:35]
    v_mfma_f32_16x16x32_bf16 v[32:35], a[104:107], v[84:87], v[32:35]
    ds_read_b128 v[104:107], v250 offset:13056
    v_mfma_f32_16x16x32_bf16 v[36:39], a[108:111], v[84:87], v[36:39]
    ds_read_b128 v[108:111], v250 offset:19200
    v_mfma_f32_16x16x32_bf16 v[36:39], a[100:103], v[80:83], v[36:39]
    ds_read_b128 v[112:115], v250 offset:13312
    v_mfma_f32_16x16x32_bf16 v[44:47], a[100:103], v[88:91], v[44:47]
    ds_read_b128 v[116:119], v250 offset:19456
    v_mfma_f32_16x16x32_bf16 v[44:47], a[108:111], v[92:95], v[44:47]
    ds_read_b128 v[120:123], v250 offset:13568
    v_mfma_f32_16x16x32_bf16 v[40:43], a[104:107], v[92:95], v[40:43]
    ds_read_b128 v[124:127], v250 offset:19712
    v_mfma_f32_16x16x32_bf16 v[40:43], a[96:99], v[88:91], v[40:43]
    v_mfma_f32_16x16x32_bf16 v[48:51], a[96:99], v[96:99], v[48:51]
    v_mfma_f32_16x16x32_bf16 v[48:51], a[104:107], v[100:103], v[48:51]
    v_mfma_f32_16x16x32_bf16 v[52:55], a[108:111], v[100:103], v[52:55]
    v_mfma_f32_16x16x32_bf16 v[52:55], a[100:103], v[96:99], v[52:55]
    s_waitcnt lgkmcnt(0)
    v_mfma_f32_16x16x32_bf16 v[60:63], a[100:103], v[104:107], v[60:63]
    s_barrier
    v_mfma_f32_16x16x32_bf16 v[60:63], a[108:111], v[108:111], v[60:63]
    ds_read_b128 v[80:83], v250 offset:24576
    s_add_u32 m0, s74, 24576
    v_mfma_f32_16x16x32_bf16 v[56:59], a[104:107], v[108:111], v[56:59]
    ds_read_b128 v[84:87], v250 offset:30720
    v_mfma_f32_16x16x32_bf16 v[56:59], a[96:99], v[104:107], v[56:59]
    ds_read_b128 v[88:91], v250 offset:24832
    buffer_load_dwordx4 v156, s[44:47], s76 offen offset:0 sc1 lds
    v_mfma_f32_16x16x32_bf16 v[64:67], a[96:99], v[112:115], v[64:67]
    ds_read_b128 v[92:95], v250 offset:30976
    v_mfma_f32_16x16x32_bf16 v[64:67], a[104:107], v[116:119], v[64:67]
    ds_read_b128 v[96:99], v250 offset:25088
    v_mfma_f32_16x16x32_bf16 v[68:71], a[108:111], v[116:119], v[68:71]
    ds_read_b128 v[100:103], v250 offset:31232
    buffer_load_dwordx4 v157, s[44:47], s76 offen offset:1024 sc1 lds
    v_mfma_f32_16x16x32_bf16 v[68:71], a[100:103], v[112:115], v[68:71]
    v_mfma_f32_16x16x32_bf16 v[76:79], a[100:103], v[120:123], v[76:79]
    v_mfma_f32_16x16x32_bf16 v[76:79], a[108:111], v[124:127], v[76:79]
    buffer_load_dwordx4 v158, s[44:47], s76 offen offset:2048 sc1 lds
    v_mfma_f32_16x16x32_bf16 v[72:75], a[104:107], v[124:127], v[72:75]
    v_mfma_f32_16x16x32_bf16 v[72:75], a[96:99], v[120:123], v[72:75]
    s_waitcnt lgkmcnt(0)
    v_mfma_f32_16x16x32_bf16 v[32:35], a[112:115], v[80:83], v[32:35]
    s_add_u32 m0, s74, 36864
    v_mfma_f32_16x16x32_bf16 v[32:35], a[120:123], v[84:87], v[32:35]
    ds_read_b128 v[104:107], v250 offset:25344
    v_mfma_f32_16x16x32_bf16 v[36:39], a[124:127], v[84:87], v[36:39]
    ds_read_b128 v[108:111], v250 offset:31488
    v_mfma_f32_16x16x32_bf16 v[36:39], a[116:119], v[80:83], v[36:39]
    ds_read_b128 v[112:115], v250 offset:25600
    buffer_load_dwordx4 v156, s[44:47], s77 offen offset:0 sc1 lds
    v_mfma_f32_16x16x32_bf16 v[44:47], a[116:119], v[88:91], v[44:47]
    ds_read_b128 v[116:119], v250 offset:31744
    v_mfma_f32_16x16x32_bf16 v[44:47], a[124:127], v[92:95], v[44:47]
    ds_read_b128 v[120:123], v250 offset:25856
    v_mfma_f32_16x16x32_bf16 v[40:43], a[120:123], v[92:95], v[40:43]
    ds_read_b128 v[124:127], v250 offset:32000
    buffer_load_dwordx4 v157, s[44:47], s77 offen offset:1024 sc1 lds
    v_mfma_f32_16x16x32_bf16 v[40:43], a[112:115], v[88:91], v[40:43]
    v_mfma_f32_16x16x32_bf16 v[48:51], a[112:115], v[96:99], v[48:51]
    v_mfma_f32_16x16x32_bf16 v[48:51], a[120:123], v[100:103], v[48:51]
    buffer_load_dwordx4 v158, s[44:47], s77 offen offset:2048 sc1 lds
    v_mfma_f32_16x16x32_bf16 v[52:55], a[124:127], v[100:103], v[52:55]
    v_mfma_f32_16x16x32_bf16 v[52:55], a[116:119], v[96:99], v[52:55]
    s_waitcnt lgkmcnt(0)
    v_mfma_f32_16x16x32_bf16 v[60:63], a[116:119], v[104:107], v[60:63]
    s_waitcnt vmcnt(14)
    s_barrier
    v_mfma_f32_16x16x32_bf16 v[60:63], a[124:127], v[108:111], v[60:63]
    ds_read_b128 v[80:83], v159 offset:0
    s_add_u32 m0, s74, 49152
    v_mfma_f32_16x16x32_bf16 v[56:59], a[120:123], v[108:111], v[56:59]
    ds_read_b128 v[84:87], v159 offset:6144
    v_mfma_f32_16x16x32_bf16 v[56:59], a[112:115], v[104:107], v[56:59]
    ds_read_b128 v[88:91], v159 offset:256
    buffer_load_dwordx4 v156, s[44:47], s78 offen offset:0 sc1 lds
    v_mfma_f32_16x16x32_bf16 v[64:67], a[112:115], v[112:115], v[64:67]
    ds_read_b128 v[92:95], v159 offset:6400
    v_mfma_f32_16x16x32_bf16 v[64:67], a[120:123], v[116:119], v[64:67]
    ds_read_b128 v[96:99], v159 offset:512
    v_mfma_f32_16x16x32_bf16 v[68:71], a[124:127], v[116:119], v[68:71]
    ds_read_b128 v[100:103], v159 offset:6656
    buffer_load_dwordx4 v157, s[44:47], s78 offen offset:1024 sc1 lds
    v_mfma_f32_16x16x32_bf16 v[68:71], a[116:119], v[112:115], v[68:71]
    v_mfma_f32_16x16x32_bf16 v[76:79], a[116:119], v[120:123], v[76:79]
    v_mfma_f32_16x16x32_bf16 v[76:79], a[124:127], v[124:127], v[76:79]
    buffer_load_dwordx4 v158, s[44:47], s78 offen offset:2048 sc1 lds
    v_mfma_f32_16x16x32_bf16 v[72:75], a[120:123], v[124:127], v[72:75]
    v_mfma_f32_16x16x32_bf16 v[72:75], a[112:115], v[120:123], v[72:75]
    s_waitcnt lgkmcnt(0)
    v_mfma_f32_16x16x32_bf16 v[32:35], a[128:131], v[80:83], v[32:35]
    s_add_u32 m0, s74, 61440
    v_mfma_f32_16x16x32_bf16 v[32:35], a[136:139], v[84:87], v[32:35]
    ds_read_b128 v[104:107], v159 offset:768
    v_mfma_f32_16x16x32_bf16 v[36:39], a[140:143], v[84:87], v[36:39]
    ds_read_b128 v[108:111], v159 offset:6912
    v_mfma_f32_16x16x32_bf16 v[36:39], a[132:135], v[80:83], v[36:39]
    ds_read_b128 v[112:115], v159 offset:1024
    buffer_load_dwordx4 v156, s[44:47], s79 offen offset:0 sc1 lds
    v_mfma_f32_16x16x32_bf16 v[44:47], a[132:135], v[88:91], v[44:47]
    ds_read_b128 v[116:119], v159 offset:7168
    v_mfma_f32_16x16x32_bf16 v[44:47], a[140:143], v[92:95], v[44:47]
    ds_read_b128 v[120:123], v159 offset:1280
    v_mfma_f32_16x16x32_bf16 v[40:43], a[136:139], v[92:95], v[40:43]
    ds_read_b128 v[124:127], v159 offset:7424
    buffer_load_dwordx4 v157, s[44:47], s79 offen offset:1024 sc1 lds
    v_mfma_f32_16x16x32_bf16 v[40:43], a[128:131], v[88:91], v[40:43]
    v_mfma_f32_16x16x32_bf16 v[48:51], a[128:131], v[96:99], v[48:51]
    v_mfma_f32_16x16x32_bf16 v[48:51], a[136:139], v[100:103], v[48:51]
    buffer_load_dwordx4 v158, s[44:47], s79 offen offset:2048 sc1 lds
    v_mfma_f32_16x16x32_bf16 v[52:55], a[140:143], v[100:103], v[52:55]
    v_mfma_f32_16x16x32_bf16 v[52:55], a[132:135], v[96:99], v[52:55]
    s_waitcnt lgkmcnt(0)
    v_mfma_f32_16x16x32_bf16 v[60:63], a[132:135], v[104:107], v[60:63]
    s_waitcnt vmcnt(13)
    s_barrier
    v_mfma_f32_16x16x32_bf16 v[60:63], a[140:143], v[108:111], v[60:63]
    ds_read_b128 v[80:83], v159 offset:12288
    s_add_u32 m0, s74, 0
    v_mfma_f32_16x16x32_bf16 v[56:59], a[136:139], v[108:111], v[56:59]
    ds_read_b128 v[84:87], v159 offset:18432
    v_mfma_f32_16x16x32_bf16 v[56:59], a[128:131], v[104:107], v[56:59]
    ds_read_b128 v[88:91], v159 offset:12544
    buffer_load_dwordx4 v156, s[44:47], s80 offen offset:0 sc1 lds
    v_mfma_f32_16x16x32_bf16 v[64:67], a[128:131], v[112:115], v[64:67]
    ds_read_b128 v[92:95], v159 offset:18688
    v_mfma_f32_16x16x32_bf16 v[64:67], a[136:139], v[116:119], v[64:67]
    ds_read_b128 v[96:99], v159 offset:12800
    buffer_load_dword v29, v28, s[44:47], 0 offen sc1
    v_mfma_f32_16x16x32_bf16 v[68:71], a[140:143], v[116:119], v[68:71]
    ds_read_b128 v[100:103], v159 offset:18944
    buffer_load_dwordx4 v157, s[44:47], s80 offen offset:1024 sc1 lds
    v_mfma_f32_16x16x32_bf16 v[68:71], a[132:135], v[112:115], v[68:71]
    ds_read_b64_tr_b16 a[32:33], v10 offset:16384
    v_mfma_f32_16x16x32_bf16 v[76:79], a[132:135], v[120:123], v[76:79]
    ds_read_b64_tr_b16 a[34:35], v10 offset:18432
    v_mfma_f32_16x16x32_bf16 v[76:79], a[140:143], v[124:127], v[76:79]
    buffer_load_dwordx4 v158, s[44:47], s80 offen offset:2048 sc1 lds
    v_mfma_f32_16x16x32_bf16 v[72:75], a[136:139], v[124:127], v[72:75]
    ds_read_b64_tr_b16 a[40:41], v10 offset:20480
    v_mfma_f32_16x16x32_bf16 v[72:75], a[128:131], v[120:123], v[72:75]
    ds_read_b64_tr_b16 a[42:43], v10 offset:22528
    s_waitcnt lgkmcnt(4)
    v_mfma_f32_16x16x32_bf16 v[32:35], a[144:147], v[80:83], v[32:35]
    s_add_u32 m0, s73, 32768
    s_lshl_b32 s14, s87, 18
    v_mfma_f32_16x16x32_bf16 v[32:35], a[152:155], v[84:87], v[32:35]
    ds_read_b128 v[104:107], v159 offset:13056
    v_mfma_f32_16x16x32_bf16 v[36:39], a[156:159], v[84:87], v[36:39]
    ds_read_b128 v[108:111], v159 offset:19200
    buffer_load_dwordx4 v4, s[52:55], s14 offen offset:0 lds
    v_mfma_f32_16x16x32_bf16 v[36:39], a[148:151], v[80:83], v[36:39]
    ds_read_b128 v[112:115], v159 offset:13312
    v_mfma_f32_16x16x32_bf16 v[44:47], a[148:151], v[88:91], v[44:47]
    ds_read_b128 v[116:119], v159 offset:19456
    buffer_load_dwordx4 v5, s[52:55], s14 offen offset:1024 lds
    v_mfma_f32_16x16x32_bf16 v[44:47], a[156:159], v[92:95], v[44:47]
    ds_read_b128 v[120:123], v159 offset:13568
    v_mfma_f32_16x16x32_bf16 v[40:43], a[152:155], v[92:95], v[40:43]
    ds_read_b128 v[124:127], v159 offset:19712
    v_mfma_f32_16x16x32_bf16 v[40:43], a[144:147], v[88:91], v[40:43]
    ds_read_b64_tr_b16 a[36:37], v11 offset:16384
    buffer_load_dwordx4 v6, s[52:55], s14 offen offset:2048 lds
    v_mfma_f32_16x16x32_bf16 v[48:51], a[144:147], v[96:99], v[48:51]
L_pl_G_4:
    s_cbranch_execz L_wret
    ds_read_b64_tr_b16 a[38:39], v11 offset:18432
    v_mfma_f32_16x16x32_bf16 v[48:51], a[152:155], v[100:103], v[48:51]
    buffer_load_dwordx4 v7, s[52:55], s14 offen offset:3072 lds
    v_mfma_f32_16x16x32_bf16 v[52:55], a[156:159], v[100:103], v[52:55]
    ds_read_b64_tr_b16 a[44:45], v11 offset:20480
    v_mfma_f32_16x16x32_bf16 v[52:55], a[148:151], v[96:99], v[52:55]
    ds_read_b64_tr_b16 a[46:47], v11 offset:22528
    s_waitcnt lgkmcnt(4)
    v_mfma_f32_16x16x32_bf16 v[60:63], a[148:151], v[104:107], v[60:63]
    s_waitcnt vmcnt(17)
    s_barrier
    v_mfma_f32_16x16x32_bf16 v[60:63], a[156:159], v[108:111], v[60:63]
    ds_read_b128 v[80:83], v159 offset:24576
    v_mfma_f32_16x16x32_bf16 v[56:59], a[152:155], v[108:111], v[56:59]
    ds_read_b128 v[84:87], v159 offset:30720
    v_mfma_f32_16x16x32_bf16 v[56:59], a[144:147], v[104:107], v[56:59]
    ds_read_b128 v[88:91], v159 offset:24832
    v_mfma_f32_16x16x32_bf16 v[64:67], a[144:147], v[112:115], v[64:67]
    ds_read_b128 v[92:95], v159 offset:30976
    v_mfma_f32_16x16x32_bf16 v[64:67], a[152:155], v[116:119], v[64:67]
    ds_read_b128 v[96:99], v159 offset:25088
    v_mfma_f32_16x16x32_bf16 v[68:71], a[156:159], v[116:119], v[68:71]
    ds_read_b128 v[100:103], v159 offset:31232
    v_mfma_f32_16x16x32_bf16 v[68:71], a[148:151], v[112:115], v[68:71]
    v_mfma_f32_16x16x32_bf16 v[76:79], a[148:151], v[120:123], v[76:79]
    v_mfma_f32_16x16x32_bf16 v[76:79], a[156:159], v[124:127], v[76:79]
    v_mfma_f32_16x16x32_bf16 v[72:75], a[152:155], v[124:127], v[72:75]
    v_mfma_f32_16x16x32_bf16 v[72:75], a[144:147], v[120:123], v[72:75]
    s_waitcnt lgkmcnt(0)
    v_mfma_f32_16x16x32_bf16 v[32:35], a[160:163], v[80:83], v[32:35]
    v_mfma_f32_16x16x32_bf16 v[32:35], a[168:171], v[84:87], v[32:35]
    ds_read_b128 v[104:107], v159 offset:25344
    v_mfma_f32_16x16x32_bf16 v[36:39], a[172:175], v[84:87], v[36:39]
    ds_read_b128 v[108:111], v159 offset:31488
    v_mfma_f32_16x16x32_bf16 v[36:39], a[164:167], v[80:83], v[36:39]
    ds_read_b128 v[112:115], v159 offset:25600
    v_mfma_f32_16x16x32_bf16 v[44:47], a[164:167], v[88:91], v[44:47]
    ds_read_b128 v[116:119], v159 offset:31744
    v_mfma_f32_16x16x32_bf16 v[44:47], a[172:175], v[92:95], v[44:47]
    ds_read_b128 v[120:123], v159 offset:25856
    v_mfma_f32_16x16x32_bf16 v[40:43], a[168:171], v[92:95], v[40:43]
    ds_read_b128 v[124:127], v159 offset:32000
    v_mfma_f32_16x16x32_bf16 v[40:43], a[160:163], v[88:91], v[40:43]
    v_mfma_f32_16x16x32_bf16 v[48:51], a[160:163], v[96:99], v[48:51]
    v_mfma_f32_16x16x32_bf16 v[48:51], a[168:171], v[100:103], v[48:51]
    v_mfma_f32_16x16x32_bf16 v[52:55], a[172:175], v[100:103], v[52:55]
    v_mfma_f32_16x16x32_bf16 v[52:55], a[164:167], v[96:99], v[52:55]
    s_waitcnt lgkmcnt(0)
    v_mfma_f32_16x16x32_bf16 v[60:63], a[164:167], v[104:107], v[60:63]
    s_waitcnt vmcnt(14)
    s_barrier
    v_mfma_f32_16x16x32_bf16 v[60:63], a[172:175], v[108:111], v[60:63]
    ds_read_b128 v[80:83], v250 offset:0
    s_waitcnt vmcnt(6)
    v_mfma_f32_16x16x32_bf16 v[56:59], a[168:171], v[108:111], v[56:59]
    ds_read_b128 v[84:87], v250 offset:6144
    v_cmp_ne_u32 vcc, s68, v29
    v_mfma_f32_16x16x32_bf16 v[56:59], a[160:163], v[104:107], v[56:59]
    ds_read_b128 v[88:91], v250 offset:256
    v_mfma_f32_16x16x32_bf16 v[64:67], a[160:163], v[112:115], v[64:67]
    ds_read_b128 v[92:95], v250 offset:6400
    v_mfma_f32_16x16x32_bf16 v[64:67], a[168:171], v[116:119], v[64:67]
    ds_read_b128 v[96:99], v250 offset:512
    s_cbranch_vccnz L_rs_p5
L_ok_p5:
    v_mfma_f32_16x16x32_bf16 v[68:71], a[172:175], v[116:119], v[68:71]
    ds_read_b128 v[100:103], v250 offset:6656
    buffer_load_dwordx4 v[160:163], v246, s[44:47], s10 offen offset:0 sc1
    v_mfma_f32_16x16x32_bf16 v[68:71], a[164:167], v[112:115], v[68:71]
    v_mfma_f32_16x16x32_bf16 v[76:79], a[164:167], v[120:123], v[76:79]
    v_mfma_f32_16x16x32_bf16 v[76:79], a[172:175], v[124:127], v[76:79]
    buffer_load_dwordx4 v[164:167], v246, s[44:47], s10 offen offset:1024 sc1
    v_mfma_f32_16x16x32_bf16 v[72:75], a[168:171], v[124:127], v[72:75]
    buffer_load_dwordx4 v[168:171], v246, s[44:47], s10 offen offset:2048 sc1
    v_mfma_f32_16x16x32_bf16 v[72:75], a[160:163], v[120:123], v[72:75]
    s_waitcnt lgkmcnt(0)
    v_mfma_f32_16x16x32_bf16 v[32:35], a[176:179], v[80:83], v[32:35]
    v_mfma_f32_16x16x32_bf16 v[32:35], a[184:187], v[84:87], v[32:35]
    ds_read_b128 v[104:107], v250 offset:768
    v_mfma_f32_16x16x32_bf16 v[36:39], a[188:191], v[84:87], v[36:39]
    ds_read_b128 v[108:111], v250 offset:6912
    buffer_load_dwordx4 v[172:175], v247, s[44:47], s10 offen offset:0 sc1
    v_mfma_f32_16x16x32_bf16 v[36:39], a[180:183], v[80:83], v[36:39]
    ds_read_b128 v[112:115], v250 offset:1024
    v_mfma_f32_16x16x32_bf16 v[44:47], a[180:183], v[88:91], v[44:47]
    ds_read_b128 v[116:119], v250 offset:7168
    v_mfma_f32_16x16x32_bf16 v[44:47], a[188:191], v[92:95], v[44:47]
    ds_read_b128 v[120:123], v250 offset:1280
    buffer_load_dwordx4 v[176:179], v247, s[44:47], s10 offen offset:1024 sc1
    v_mfma_f32_16x16x32_bf16 v[40:43], a[184:187], v[92:95], v[40:43]
    ds_read_b128 v[124:127], v250 offset:7424
    v_mfma_f32_16x16x32_bf16 v[40:43], a[176:179], v[88:91], v[40:43]
    v_mfma_f32_16x16x32_bf16 v[48:51], a[176:179], v[96:99], v[48:51]
    v_mfma_f32_16x16x32_bf16 v[48:51], a[184:187], v[100:103], v[48:51]
    v_mfma_f32_16x16x32_bf16 v[52:55], a[188:191], v[100:103], v[52:55]
    buffer_load_dwordx4 v[180:183], v247, s[44:47], s10 offen offset:2048 sc1
    v_mfma_f32_16x16x32_bf16 v[52:55], a[180:183], v[96:99], v[52:55]
    s_waitcnt lgkmcnt(0)
    v_mfma_f32_16x16x32_bf16 v[60:63], a[180:183], v[104:107], v[60:63]
    s_barrier
    v_mfma_f32_16x16x32_bf16 v[60:63], a[188:191], v[108:111], v[60:63]
    ds_read_b128 v[80:83], v250 offset:12288
    s_add_u32 m0, s74, 12288
    v_mfma_f32_16x16x32_bf16 v[56:59], a[184:187], v[108:111], v[56:59]
    ds_read_b128 v[84:87], v250 offset:18432
    v_mfma_f32_16x16x32_bf16 v[56:59], a[176:179], v[104:107], v[56:59]
    ds_read_b128 v[88:91], v250 offset:12544
    buffer_load_dwordx4 v156, s[44:47], s81 offen offset:0 sc1 lds
    v_mfma_f32_16x16x32_bf16 v[64:67], a[176:179], v[112:115], v[64:67]
    ds_read_b128 v[92:95], v250 offset:18688
    v_mfma_f32_16x16x32_bf16 v[64:67], a[184:187], v[116:119], v[64:67]
    ds_read_b128 v[96:99], v250 offset:12800
    v_mfma_f32_16x16x32_bf16 v[68:71], a[188:191], v[116:119], v[68:71]
    ds_read_b128 v[100:103], v250 offset:18944
    buffer_load_dwordx4 v157, s[44:47], s81 offen offset:1024 sc1 lds
    v_mfma_f32_16x16x32_bf16 v[68:71], a[180:183], v[112:115], v[68:71]
    v_mfma_f32_16x16x32_bf16 v[76:79], a[180:183], v[120:123], v[76:79]
    v_mfma_f32_16x16x32_bf16 v[76:79], a[188:191], v[124:127], v[76:79]
    buffer_load_dwordx4 v158, s[44:47], s81 offen offset:2048 sc1 lds
    v_mfma_f32_16x16x32_bf16 v[72:75], a[184:187], v[124:127], v[72:75]
    v_mfma_f32_16x16x32_bf16 v[72:75], a[176:179], v[120:123], v[72:75]
    s_waitcnt lgkmcnt(0)
    v_mfma_f32_16x16x32_bf16 v[32:35], a[192:195], v[80:83], v[32:35]
    s_add_u32 m0, s73, 49152
    s_lshl_b32 s14, s88, 18
    v_mfma_f32_16x16x32_bf16 v[32:35], a[200:203], v[84:87], v[32:35]
    ds_read_b128 v[104:107], v250 offset:13056
    v_mfma_f32_16x16x32_bf16 v[36:39], a[204:207], v[84:87], v[36:39]
    ds_read_b128 v[108:111], v250 offset:19200
    buffer_load_dwordx4 v4, s[52:55], s14 offen offset:0 lds
    v_mfma_f32_16x16x32_bf16 v[36:39], a[196:199], v[80:83], v[36:39]
    ds_read_b128 v[112:115], v250 offset:13312
    v_mfma_f32_16x16x32_bf16 v[44:47], a[196:199], v[88:91], v[44:47]
    ds_read_b128 v[116:119], v250 offset:19456
    buffer_load_dwordx4 v5, s[52:55], s14 offen offset:1024 lds
    v_mfma_f32_16x16x32_bf16 v[44:47], a[204:207], v[92:95], v[44:47]
    ds_read_b128 v[120:123], v250 offset:13568
    v_mfma_f32_16x16x32_bf16 v[40:43], a[200:203], v[92:95], v[40:43]
    ds_read_b128 v[124:127], v250 offset:19712
    v_mfma_f32_16x16x32_bf16 v[40:43], a[192:195], v[88:91], v[40:43]
    buffer_load_dwordx4 v6, s[52:55], s14 offen offset:2048 lds
    v_mfma_f32_16x16x32_bf16 v[48:51], a[192:195], v[96:99], v[48:51]
    v_mfma_f32_16x16x32_bf16 v[48:51], a[200:203], v[100:103], v[48:51]
    buffer_load_dwordx4 v7, s[52:55], s14 offen offset:3072 lds
    v_mfma_f32_16x16x32_bf16 v[52:55], a[204:207], v[100:103], v[52:55]
    v_mfma_f32_16x16x32_bf16 v[52:55], a[196:199], v[96:99], v[52:55]
    s_waitcnt lgkmcnt(0)
    v_mfma_f32_16x16x32_bf16 v[60:63], a[196:199], v[104:107], v[60:63]
    s_barrier
    v_mfma_f32_16x16x32_bf16 v[60:63], a[204:207], v[108:111], v[60:63]
    ds_read_b128 v[80:83], v250 offset:24576
    v_mfma_f32_16x16x32_bf16 v[56:59], a[200:203], v[108:111], v[56:59]
    ds_read_b128 v[84:87], v250 offset:30720
    v_mfma_f32_16x16x32_bf16 v[56:59], a[192:195], v[104:107], v[56:59]
    ds_read_b128 v[88:91], v250 offset:24832
    v_mfma_f32_16x16x32_bf16 v[64:67], a[192:195], v[112:115], v[64:67]
    ds_read_b128 v[92:95], v250 offset:30976
    v_mfma_f32_16x16x32_bf16 v[64:67], a[200:203], v[116:119], v[64:67]
    ds_read_b128 v[96:99], v250 offset:25088
    v_mfma_f32_16x16x32_bf16 v[68:71], a[204:207], v[116:119], v[68:71]
    ds_read_b128 v[100:103], v250 offset:31232
    s_waitcnt vmcnt(7)
    v_mfma_f32_16x16x32_bf16 v[68:71], a[196:199], v[112:115], v[68:71]
    v_mfma_f32_16x16x32_bf16 v[76:79], a[196:199], v[120:123], v[76:79]
    v_mfma_f32_16x16x32_bf16 v[76:79], a[204:207], v[124:127], v[76:79]
    v_mfma_f32_16x16x32_bf16 v[72:75], a[200:203], v[124:127], v[72:75]
    v_mfma_f32_16x16x32_bf16 v[72:75], a[192:195], v[120:123], v[72:75]
    s_waitcnt lgkmcnt(0)
    v_mfma_f32_16x16x32_bf16 v[32:35], a[208:211], v[80:83], v[32:35]
    s_add_u32 m0, s73, 65536
    s_lshl_b32 s14, s89, 18
    v_mfma_f32_16x16x32_bf16 v[32:35], a[216:219], v[84:87], v[32:35]
    ds_read_b128 v[104:107], v250 offset:25344
    v_mfma_f32_16x16x32_bf16 v[36:39], a[220:223], v[84:87], v[36:39]
    ds_read_b128 v[108:111], v250 offset:31488
    buffer_load_dwordx4 v4, s[52:55], s14 offen offset:0 lds
    v_and_b32 v193, 0xffff0000, v172
    v_lshlrev_b32 v192, 16, v172
    v_mfma_f32_16x16x32_bf16 v[36:39], a[212:215], v[80:83], v[36:39]
    ds_read_b128 v[112:115], v250 offset:25600
    v_and_b32 v195, 0xffff0000, v173
    v_lshlrev_b32 v194, 16, v173
    v_mfma_f32_16x16x32_bf16 v[44:47], a[212:215], v[88:91], v[44:47]
    ds_read_b128 v[116:119], v250 offset:31744
    buffer_load_dwordx4 v5, s[52:55], s14 offen offset:1024 lds
    v_add_f32 v56, v56, v192
    v_mfma_f32_16x16x32_bf16 v[44:47], a[220:223], v[92:95], v[44:47]
    ds_read_b128 v[120:123], v250 offset:25856
    v_add_f32 v57, v57, v193
    v_add_f32 v58, v58, v194
    v_mfma_f32_16x16x32_bf16 v[40:43], a[216:219], v[92:95], v[40:43]
    ds_read_b128 v[124:127], v250 offset:32000
    v_add_f32 v59, v59, v195
    v_and_b32 v197, 0xffff0000, v174
    v_mfma_f32_16x16x32_bf16 v[40:43], a[208:211], v[88:91], v[40:43]
    buffer_load_dwordx4 v6, s[52:55], s14 offen offset:2048 lds
    v_lshlrev_b32 v196, 16, v174
    v_and_b32 v199, 0xffff0000, v175
    v_mfma_f32_16x16x32_bf16 v[48:51], a[208:211], v[96:99], v[48:51]
    v_lshlrev_b32 v198, 16, v175
    v_add_f32 v60, v60, v196
    v_mfma_f32_16x16x32_bf16 v[48:51], a[216:219], v[100:103], v[48:51]
    buffer_load_dwordx4 v7, s[52:55], s14 offen offset:3072 lds
    v_add_f32 v61, v61, v197
    v_mfma_f32_16x16x32_bf16 v[52:55], a[220:223], v[100:103], v[52:55]
    v_add_f32 v62, v62, v198
    v_add_f32 v63, v63, v199
    v_mfma_f32_16x16x32_bf16 v[52:55], a[212:215], v[96:99], v[52:55]
    s_waitcnt lgkmcnt(0)
    v_mfma_f32_16x16x32_bf16 v[60:63], a[212:215], v[104:107], v[60:63]
    s_barrier
    v_mfma_f32_16x16x32_bf16 v[60:63], a[220:223], v[108:111], v[60:63]
    ds_read_b128 v[80:83], v159 offset:0
    v_mfma_f32_16x16x32_bf16 v[56:59], a[216:219], v[108:111], v[56:59]
    ds_read_b128 v[84:87], v159 offset:6144
    v_and_b32 v193, 0xffff0000, v160
    v_lshlrev_b32 v192, 16, v160
    v_mfma_f32_16x16x32_bf16 v[56:59], a[208:211], v[104:107], v[56:59]
    ds_read_b128 v[88:91], v159 offset:256
    v_and_b32 v195, 0xffff0000, v161
    v_lshlrev_b32 v194, 16, v161
    v_mfma_f32_16x16x32_bf16 v[64:67], a[208:211], v[112:115], v[64:67]
    ds_read_b128 v[92:95], v159 offset:6400
    v_add_f32 v32, v32, v192
    v_mfma_f32_16x16x32_bf16 v[64:67], a[216:219], v[116:119], v[64:67]
    ds_read_b128 v[96:99], v159 offset:512
    v_add_f32 v33, v33, v193
    v_add_f32 v34, v34, v194
    v_mfma_f32_16x16x32_bf16 v[68:71], a[220:223], v[116:119], v[68:71]
    ds_read_b128 v[100:103], v159 offset:6656
    v_add_f32 v35, v35, v195
    v_and_b32 v197, 0xffff0000, v162
    v_mfma_f32_16x16x32_bf16 v[68:71], a[212:215], v[112:115], v[68:71]
    ds_read_b64_tr_b16 a[48:49], v10 offset:32768
    v_lshlrev_b32 v196, 16, v162
    v_and_b32 v199, 0xffff0000, v163
    v_mfma_f32_16x16x32_bf16 v[76:79], a[212:215], v[120:123], v[76:79]
    ds_read_b64_tr_b16 a[50:51], v10 offset:34816
    v_lshlrev_b32 v198, 16, v163
    v_mfma_f32_16x16x32_bf16 v[76:79], a[220:223], v[124:127], v[76:79]
    v_add_f32 v36, v36, v196
    v_add_f32 v37, v37, v197
    v_mfma_f32_16x16x32_bf16 v[72:75], a[216:219], v[124:127], v[72:75]
    ds_read_b64_tr_b16 a[56:57], v10 offset:36864
    v_add_f32 v38, v38, v198
    v_add_f32 v39, v39, v199
    v_mfma_f32_16x16x32_bf16 v[72:75], a[208:211], v[120:123], v[72:75]
    ds_read_b64_tr_b16 a[58:59], v10 offset:38912
    s_waitcnt lgkmcnt(4)
    v_mfma_f32_16x16x32_bf16 v[32:35], a[224:227], v[80:83], v[32:35]
    s_add_u32 m0, s73, 0
    s_lshl_b32 s14, s90, 18
    v_mfma_f32_16x16x32_bf16 v[32:35], a[232:235], v[84:87], v[32:35]
    ds_read_b128 v[104:107], v159 offset:768
    v_mfma_f32_16x16x32_bf16 v[36:39], a[236:239], v[84:87], v[36:39]
    ds_read_b128 v[108:111], v159 offset:6912
    buffer_load_dwordx4 v4, s[52:55], s14 offen offset:0 lds
    v_and_b32 v193, 0xffff0000, v176
    v_lshlrev_b32 v192, 16, v176
    v_mfma_f32_16x16x32_bf16 v[36:39], a[228:231], v[80:83], v[36:39]
    ds_read_b128 v[112:115], v159 offset:1024
    v_and_b32 v195, 0xffff0000, v177
    v_lshlrev_b32 v194, 16, v177
    v_mfma_f32_16x16x32_bf16 v[44:47], a[228:231], v[88:91], v[44:47]
    ds_read_b128 v[116:119], v159 offset:7168
    buffer_load_dwordx4 v5, s[52:55], s14 offen offset:1024 lds
    v_add_f32 v64, v64, v192
    v_mfma_f32_16x16x32_bf16 v[44:47], a[236:239], v[92:95], v[44:47]
    ds_read_b128 v[120:123], v159 offset:1280
    v_add_f32 v65, v65, v193
    v_add_f32 v66, v66, v194
    v_mfma_f32_16x16x32_bf16 v[40:43], a[232:235], v[92:95], v[40:43]
    ds_read_b128 v[124:127], v159 offset:7424
    v_add_f32 v67, v67, v195
    v_and_b32 v197, 0xffff0000, v178
    v_mfma_f32_16x16x32_bf16 v[40:43], a[224:227], v[88:91], v[40:43]
    ds_read_b64_tr_b16 a[52:53], v11 offset:32768
    buffer_load_dwordx4 v6, s[52:55], s14 offen offset:2048 lds
    v_lshlrev_b32 v196, 16, v178
    v_and_b32 v199, 0xffff0000, v179
    v_mfma_f32_16x16x32_bf16 v[48:51], a[224:227], v[96:99], v[48:51]
    ds_read_b64_tr_b16 a[54:55], v11 offset:34816
    v_lshlrev_b32 v198, 16, v179
    v_mfma_f32_16x16x32_bf16 v[48:51], a[232:235], v[100:103], v[48:51]
    buffer_load_dwordx4 v7, s[52:55], s14 offen offset:3072 lds
    v_add_f32 v68, v68, v196
    v_add_f32 v69, v69, v197
    v_mfma_f32_16x16x32_bf16 v[52:55], a[236:239], v[100:103], v[52:55]
    ds_read_b64_tr_b16 a[60:61], v11 offset:36864
    v_add_f32 v70, v70, v198
    v_add_f32 v71, v71, v199
    v_mfma_f32_16x16x32_bf16 v[52:55], a[228:231], v[96:99], v[52:55]
    ds_read_b64_tr_b16 a[62:63], v11 offset:38912
    s_waitcnt lgkmcnt(4)
    v_mfma_f32_16x16x32_bf16 v[60:63], a[228:231], v[104:107], v[60:63]
    s_waitcnt vmcnt(12)
    s_barrier
    v_mfma_f32_16x16x32_bf16 v[60:63], a[236:239], v[108:111], v[60:63]
    ds_read_b128 v[80:83], v159 offset:12288
    v_mfma_f32_16x16x32_bf16 v[56:59], a[232:235], v[108:111], v[56:59]
    ds_read_b128 v[84:87], v159 offset:18432
    v_and_b32 v193, 0xffff0000, v164
    v_lshlrev_b32 v192, 16, v164
    v_mfma_f32_16x16x32_bf16 v[56:59], a[224:227], v[104:107], v[56:59]
    ds_read_b128 v[88:91], v159 offset:12544
    v_and_b32 v195, 0xffff0000, v165
    v_lshlrev_b32 v194, 16, v165
    v_mfma_f32_16x16x32_bf16 v[64:67], a[224:227], v[112:115], v[64:67]
    ds_read_b128 v[92:95], v159 offset:18688
    v_add_f32 v40, v40, v192
    v_mfma_f32_16x16x32_bf16 v[64:67], a[232:235], v[116:119], v[64:67]
    ds_read_b128 v[96:99], v159 offset:12800
    v_add_f32 v41, v41, v193
    v_add_f32 v42, v42, v194
    v_mfma_f32_16x16x32_bf16 v[68:71], a[236:239], v[116:119], v[68:71]
    ds_read_b128 v[100:103], v159 offset:18944
    v_add_f32 v43, v43, v195
    v_mfma_f32_16x16x32_bf16 v[68:71], a[228:231], v[112:115], v[68:71]
    v_and_b32 v197, 0xffff0000, v166
    v_lshlrev_b32 v196, 16, v166
    v_mfma_f32_16x16x32_bf16 v[76:79], a[228:231], v[120:123], v[76:79]
    v_and_b32 v199, 0xffff0000, v167
    v_lshlrev_b32 v198, 16, v167
    v_mfma_f32_16x16x32_bf16 v[76:79], a[236:239], v[124:127], v[76:79]
    v_add_f32 v44, v44, v196
    v_add_f32 v45, v45, v197
    v_mfma_f32_16x16x32_bf16 v[72:75], a[232:235], v[124:127], v[72:75]
    v_add_f32 v46, v46, v198
    v_add_f32 v47, v47, v199
    v_mfma_f32_16x16x32_bf16 v[72:75], a[224:227], v[120:123], v[72:75]
    s_waitcnt lgkmcnt(0)
    v_mfma_f32_16x16x32_bf16 v[32:35], a[240:243], v[80:83], v[32:35]
    s_add_u32 m0, s73, 16384
    s_lshl_b32 s14, s91, 18
    v_mfma_f32_16x16x32_bf16 v[32:35], a[248:251], v[84:87], v[32:35]
    ds_read_b128 v[104:107], v159 offset:13056
    v_mfma_f32_16x16x32_bf16 v[36:39], a[252:255], v[84:87], v[36:39]
    ds_read_b128 v[108:111], v159 offset:19200
    buffer_load_dwordx4 v4, s[52:55], s14 offen offset:0 lds
    v_and_b32 v193, 0xffff0000, v180
    v_lshlrev_b32 v192, 16, v180
    v_mfma_f32_16x16x32_bf16 v[36:39], a[244:247], v[80:83], v[36:39]
    ds_read_b128 v[112:115], v159 offset:13312
    v_and_b32 v195, 0xffff0000, v181
    v_lshlrev_b32 v194, 16, v181
    v_mfma_f32_16x16x32_bf16 v[44:47], a[244:247], v[88:91], v[44:47]
    ds_read_b128 v[116:119], v159 offset:19456
    buffer_load_dwordx4 v5, s[52:55], s14 offen offset:1024 lds
    v_add_f32 v72, v72, v192
    v_mfma_f32_16x16x32_bf16 v[44:47], a[252:255], v[92:95], v[44:47]
    ds_read_b128 v[120:123], v159 offset:13568
    v_add_f32 v73, v73, v193
    v_add_f32 v74, v74, v194
    v_mfma_f32_16x16x32_bf16 v[40:43], a[248:251], v[92:95], v[40:43]
    ds_read_b128 v[124:127], v159 offset:19712
    v_add_f32 v75, v75, v195
    v_and_b32 v197, 0xffff0000, v182
    v_mfma_f32_16x16x32_bf16 v[40:43], a[240:243], v[88:91], v[40:43]
    buffer_load_dwordx4 v6, s[52:55], s14 offen offset:2048 lds
    v_lshlrev_b32 v196, 16, v182
    v_and_b32 v199, 0xffff0000, v183
    v_mfma_f32_16x16x32_bf16 v[48:51], a[240:243], v[96:99], v[48:51]
    v_lshlrev_b32 v198, 16, v183
    v_add_f32 v76, v76, v196
    v_mfma_f32_16x16x32_bf16 v[48:51], a[248:251], v[100:103], v[48:51]
    buffer_load_dwordx4 v7, s[52:55], s14 offen offset:3072 lds
    v_add_f32 v77, v77, v197
    v_mfma_f32_16x16x32_bf16 v[52:55], a[252:255], v[100:103], v[52:55]
    v_add_f32 v78, v78, v198
    v_add_f32 v79, v79, v199
    v_mfma_f32_16x16x32_bf16 v[52:55], a[244:247], v[96:99], v[52:55]
    s_waitcnt lgkmcnt(0)
    v_mfma_f32_16x16x32_bf16 v[60:63], a[244:247], v[104:107], v[60:63]
    s_barrier
    v_mfma_f32_16x16x32_bf16 v[60:63], a[252:255], v[108:111], v[60:63]
    s_add_u32 m0, s73, 131072
    s_lshl_b32 s14, s92, 18
    v_mfma_f32_16x16x32_bf16 v[56:59], a[248:251], v[108:111], v[56:59]
    buffer_load_dwordx4 v4, s[52:55], s14 offen offset:0 lds
    v_and_b32 v193, 0xffff0000, v168
    v_lshlrev_b32 v192, 16, v168
    v_mfma_f32_16x16x32_bf16 v[56:59], a[240:243], v[104:107], v[56:59]
    buffer_load_dwordx4 v5, s[52:55], s14 offen offset:1024 lds
    v_and_b32 v195, 0xffff0000, v169
    v_lshlrev_b32 v194, 16, v169
    v_mfma_f32_16x16x32_bf16 v[64:67], a[240:243], v[112:115], v[64:67]
    buffer_load_dwordx4 v6, s[52:55], s14 offen offset:2048 lds
    v_add_f32 v48, v48, v192
    v_mfma_f32_16x16x32_bf16 v[64:67], a[248:251], v[116:119], v[64:67]
    buffer_load_dwordx4 v7, s[52:55], s14 offen offset:3072 lds
    v_add_f32 v49, v49, v193
    v_add_f32 v50, v50, v194
    v_mfma_f32_16x16x32_bf16 v[68:71], a[252:255], v[116:119], v[68:71]
    s_add_u32 m0, s73, 147456
    s_lshl_b32 s14, s93, 18
    v_add_f32 v51, v51, v195
    v_and_b32 v197, 0xffff0000, v170
    v_mfma_f32_16x16x32_bf16 v[68:71], a[244:247], v[112:115], v[68:71]
    buffer_load_dwordx4 v4, s[52:55], s14 offen offset:0 lds
    v_lshlrev_b32 v196, 16, v170
    v_and_b32 v199, 0xffff0000, v171
    v_mfma_f32_16x16x32_bf16 v[76:79], a[244:247], v[120:123], v[76:79]
    buffer_load_dwordx4 v5, s[52:55], s14 offen offset:1024 lds
    v_lshlrev_b32 v198, 16, v171
    v_mfma_f32_16x16x32_bf16 v[76:79], a[252:255], v[124:127], v[76:79]
    buffer_load_dwordx4 v6, s[52:55], s14 offen offset:2048 lds
    v_add_f32 v52, v52, v196
    v_add_f32 v53, v53, v197
    v_mfma_f32_16x16x32_bf16 v[72:75], a[248:251], v[124:127], v[72:75]
    buffer_load_dwordx4 v7, s[52:55], s14 offen offset:3072 lds
    v_add_f32 v54, v54, v198
    v_add_f32 v55, v55, v199
    v_mfma_f32_16x16x32_bf16 v[72:75], a[240:243], v[120:123], v[72:75]
    s_waitcnt lgkmcnt(0)
    v_mov_b32 v88, 0xc0135761
    s_mov_b32 s10, 0xbdd2d3e8
    s_lshl_b32 s9, s69, 2
    s_add_u32 s9, s9, s3
    s_mul_i32 s9, s9, 69632
    s_add_u32 s9, s9, 12795904
    v_pk_mul_f32 v[160:161], v[32:33], v[32:33]
    v_pk_mul_f32 v[162:163], v[34:35], v[34:35]
    v_pk_mul_f32 v[164:165], v[36:37], v[36:37]
    v_pk_mul_f32 v[166:167], v[38:39], v[38:39]
    v_pk_mul_f32 v[168:169], v[40:41], v[40:41]
    v_pk_mul_f32 v[170:171], v[42:43], v[42:43]
    v_pk_mul_f32 v[172:173], v[44:45], v[44:45]
    v_pk_mul_f32 v[174:175], v[46:47], v[46:47]
    v_pk_fma_f32 v[160:161], v[160:161], s[10:11], v[88:89] op_sel_hi:[1,0,0]
    v_pk_fma_f32 v[162:163], v[162:163], s[10:11], v[88:89] op_sel_hi:[1,0,0]
    v_pk_fma_f32 v[164:165], v[164:165], s[10:11], v[88:89] op_sel_hi:[1,0,0]
    v_pk_fma_f32 v[166:167], v[166:167], s[10:11], v[88:89] op_sel_hi:[1,0,0]
    v_pk_fma_f32 v[168:169], v[168:169], s[10:11], v[88:89] op_sel_hi:[1,0,0]
    v_pk_fma_f32 v[170:171], v[170:171], s[10:11], v[88:89] op_sel_hi:[1,0,0]
    v_pk_fma_f32 v[172:173], v[172:173], s[10:11], v[88:89] op_sel_hi:[1,0,0]
    v_pk_fma_f32 v[174:175], v[174:175], s[10:11], v[88:89] op_sel_hi:[1,0,0]
    v_pk_mul_f32 v[160:161], v[160:161], v[32:33]
    v_pk_mul_f32 v[162:163], v[162:163], v[34:35]
    v_pk_mul_f32 v[164:165], v[164:165], v[36:37]
    v_pk_mul_f32 v[166:167], v[166:167], v[38:39]
    v_pk_mul_f32 v[168:169], v[168:169], v[40:41]
    v_pk_mul_f32 v[170:171], v[170:171], v[42:43]
    v_pk_mul_f32 v[172:173], v[172:173], v[44:45]
    v_pk_mul_f32 v[174:175], v[174:175], v[46:47]
    v_exp_f32 v160, v160
    v_exp_f32 v161, v161
    v_exp_f32 v162, v162
    v_exp_f32 v163, v163
    v_exp_f32 v164, v164
    v_exp_f32 v165, v165
    v_exp_f32 v166, v166
    v_exp_f32 v167, v167
    v_exp_f32 v168, v168
    v_exp_f32 v169, v169
    v_exp_f32 v170, v170
    v_exp_f32 v171, v171
    v_exp_f32 v172, v172
    v_exp_f32 v173, v173
    v_exp_f32 v174, v174
    v_exp_f32 v175, v175
    v_pk_add_f32 v[160:161], v[160:161], 1.0 op_sel_hi:[1,0]
    v_pk_add_f32 v[162:163], v[162:163], 1.0 op_sel_hi:[1,0]
    v_pk_add_f32 v[164:165], v[164:165], 1.0 op_sel_hi:[1,0]
    v_pk_add_f32 v[166:167], v[166:167], 1.0 op_sel_hi:[1,0]
    v_pk_add_f32 v[168:169], v[168:169], 1.0 op_sel_hi:[1,0]
    v_pk_add_f32 v[170:171], v[170:171], 1.0 op_sel_hi:[1,0]
    v_pk_add_f32 v[172:173], v[172:173], 1.0 op_sel_hi:[1,0]
    v_pk_add_f32 v[174:175], v[174:175], 1.0 op_sel_hi:[1,0]
    v_rcp_f32 v160, v160
    v_rcp_f32 v161, v161
    v_rcp_f32 v162, v162
    v_rcp_f32 v163, v163
    v_rcp_f32 v164, v164
    v_rcp_f32 v165, v165
    v_rcp_f32 v166, v166
    v_rcp_f32 v167, v167
    v_rcp_f32 v168, v168
    v_rcp_f32 v169, v169
    v_rcp_f32 v170, v170
    v_rcp_f32 v171, v171
    v_rcp_f32 v172, v172
    v_rcp_f32 v173, v173
    v_rcp_f32 v174, v174
    v_rcp_f32 v175, v175
    v_pk_mul_f32 v[32:33], v[32:33], v[160:161]
    v_pk_mul_f32 v[34:35], v[34:35], v[162:163]
    v_pk_mul_f32 v[36:37], v[36:37], v[164:165]
    v_pk_mul_f32 v[38:39], v[38:39], v[166:167]
    v_pk_mul_f32 v[40:41], v[40:41], v[168:169]
    v_pk_mul_f32 v[42:43], v[42:43], v[170:171]
    v_pk_mul_f32 v[44:45], v[44:45], v[172:173]
    v_pk_mul_f32 v[46:47], v[46:47], v[174:175]
    v_cvt_pk_bf16_f32 v96, v32, v33
    v_cvt_pk_bf16_f32 v97, v34, v35
    v_cvt_pk_bf16_f32 v98, v36, v37
    v_cvt_pk_bf16_f32 v99, v38, v39
    v_cvt_pk_bf16_f32 v100, v40, v41
    v_cvt_pk_bf16_f32 v101, v42, v43
    v_cvt_pk_bf16_f32 v102, v44, v45
    v_cvt_pk_bf16_f32 v103, v46, v47
    buffer_store_dwordx4 v[96:99], v240, s[44:47], s9 offen sc1
    buffer_store_dwordx4 v[100:103], v241, s[44:47], s9 offen sc1
    v_pk_mul_f32 v[160:161], v[48:49], v[48:49]
    v_pk_mul_f32 v[162:163], v[50:51], v[50:51]
    v_pk_mul_f32 v[164:165], v[52:53], v[52:53]
    v_pk_mul_f32 v[166:167], v[54:55], v[54:55]
    v_pk_mul_f32 v[168:169], v[56:57], v[56:57]
    v_pk_mul_f32 v[170:171], v[58:59], v[58:59]
    v_pk_mul_f32 v[172:173], v[60:61], v[60:61]
    v_pk_mul_f32 v[174:175], v[62:63], v[62:63]
    v_pk_fma_f32 v[160:161], v[160:161], s[10:11], v[88:89] op_sel_hi:[1,0,0]
    v_pk_fma_f32 v[162:163], v[162:163], s[10:11], v[88:89] op_sel_hi:[1,0,0]
    v_pk_fma_f32 v[164:165], v[164:165], s[10:11], v[88:89] op_sel_hi:[1,0,0]
    v_pk_fma_f32 v[166:167], v[166:167], s[10:11], v[88:89] op_sel_hi:[1,0,0]
    v_pk_fma_f32 v[168:169], v[168:169], s[10:11], v[88:89] op_sel_hi:[1,0,0]
    v_pk_fma_f32 v[170:171], v[170:171], s[10:11], v[88:89] op_sel_hi:[1,0,0]
    v_pk_fma_f32 v[172:173], v[172:173], s[10:11], v[88:89] op_sel_hi:[1,0,0]
    v_pk_fma_f32 v[174:175], v[174:175], s[10:11], v[88:89] op_sel_hi:[1,0,0]
    v_pk_mul_f32 v[160:161], v[160:161], v[48:49]
    v_pk_mul_f32 v[162:163], v[162:163], v[50:51]
    v_pk_mul_f32 v[164:165], v[164:165], v[52:53]
    v_pk_mul_f32 v[166:167], v[166:167], v[54:55]
    v_pk_mul_f32 v[168:169], v[168:169], v[56:57]
    v_pk_mul_f32 v[170:171], v[170:171], v[58:59]
    v_pk_mul_f32 v[172:173], v[172:173], v[60:61]
    v_pk_mul_f32 v[174:175], v[174:175], v[62:63]
    v_exp_f32 v160, v160
    v_exp_f32 v161, v161
    v_exp_f32 v162, v162
    v_exp_f32 v163, v163
    v_exp_f32 v164, v164
    v_exp_f32 v165, v165
    v_exp_f32 v166, v166
    v_exp_f32 v167, v167
    v_exp_f32 v168, v168
    v_exp_f32 v169, v169
    v_exp_f32 v170, v170
    v_exp_f32 v171, v171
    v_exp_f32 v172, v172
    v_exp_f32 v173, v173
    v_exp_f32 v174, v174
    v_exp_f32 v175, v175
    v_pk_add_f32 v[160:161], v[160:161], 1.0 op_sel_hi:[1,0]
    v_pk_add_f32 v[162:163], v[162:163], 1.0 op_sel_hi:[1,0]
    v_pk_add_f32 v[164:165], v[164:165], 1.0 op_sel_hi:[1,0]
    v_pk_add_f32 v[166:167], v[166:167], 1.0 op_sel_hi:[1,0]
    v_pk_add_f32 v[168:169], v[168:169], 1.0 op_sel_hi:[1,0]
    v_pk_add_f32 v[170:171], v[170:171], 1.0 op_sel_hi:[1,0]
    v_pk_add_f32 v[172:173], v[172:173], 1.0 op_sel_hi:[1,0]
    v_pk_add_f32 v[174:175], v[174:175], 1.0 op_sel_hi:[1,0]
    v_rcp_f32 v160, v160
    v_rcp_f32 v161, v161
    v_rcp_f32 v162, v162
    v_rcp_f32 v163, v163
    v_rcp_f32 v164, v164
    v_rcp_f32 v165, v165
    v_rcp_f32 v166, v166
    v_rcp_f32 v167, v167
    v_rcp_f32 v168, v168
    v_rcp_f32 v169, v169
    v_rcp_f32 v170, v170
    v_rcp_f32 v171, v171
    v_rcp_f32 v172, v172
    v_rcp_f32 v173, v173
    v_rcp_f32 v174, v174
    v_rcp_f32 v175, v175
    v_pk_mul_f32 v[48:49], v[48:49], v[160:161]
    v_pk_mul_f32 v[50:51], v[50:51], v[162:163]
    v_pk_mul_f32 v[52:53], v[52:53], v[164:165]
    v_pk_mul_f32 v[54:55], v[54:55], v[166:167]
    v_pk_mul_f32 v[56:57], v[56:57], v[168:169]
    v_pk_mul_f32 v[58:59], v[58:59], v[170:171]
    v_pk_mul_f32 v[60:61], v[60:61], v[172:173]
    v_pk_mul_f32 v[62:63], v[62:63], v[174:175]
    v_cvt_pk_bf16_f32 v104, v48, v49
    v_cvt_pk_bf16_f32 v105, v50, v51
    v_cvt_pk_bf16_f32 v106, v52, v53
    v_cvt_pk_bf16_f32 v107, v54, v55
    v_cvt_pk_bf16_f32 v108, v56, v57
    v_cvt_pk_bf16_f32 v109, v58, v59
    v_cvt_pk_bf16_f32 v110, v60, v61
    v_cvt_pk_bf16_f32 v111, v62, v63
    buffer_store_dwordx4 v[104:107], v242, s[44:47], s9 offen sc1
    buffer_store_dwordx4 v[108:111], v243, s[44:47], s9 offen sc1
    v_pk_mul_f32 v[160:161], v[64:65], v[64:65]
    v_pk_mul_f32 v[162:163], v[66:67], v[66:67]
    v_pk_mul_f32 v[164:165], v[68:69], v[68:69]
    v_pk_mul_f32 v[166:167], v[70:71], v[70:71]
    v_pk_mul_f32 v[168:169], v[72:73], v[72:73]
    v_pk_mul_f32 v[170:171], v[74:75], v[74:75]
    v_pk_mul_f32 v[172:173], v[76:77], v[76:77]
    v_pk_mul_f32 v[174:175], v[78:79], v[78:79]
    v_pk_fma_f32 v[160:161], v[160:161], s[10:11], v[88:89] op_sel_hi:[1,0,0]
    v_pk_fma_f32 v[162:163], v[162:163], s[10:11], v[88:89] op_sel_hi:[1,0,0]
    v_pk_fma_f32 v[164:165], v[164:165], s[10:11], v[88:89] op_sel_hi:[1,0,0]
    v_pk_fma_f32 v[166:167], v[166:167], s[10:11], v[88:89] op_sel_hi:[1,0,0]
    v_pk_fma_f32 v[168:169], v[168:169], s[10:11], v[88:89] op_sel_hi:[1,0,0]
    v_pk_fma_f32 v[170:171], v[170:171], s[10:11], v[88:89] op_sel_hi:[1,0,0]
    v_pk_fma_f32 v[172:173], v[172:173], s[10:11], v[88:89] op_sel_hi:[1,0,0]
L_pl_G_5:
    s_cbranch_execz L_wret
    v_pk_fma_f32 v[174:175], v[174:175], s[10:11], v[88:89] op_sel_hi:[1,0,0]
    v_pk_mul_f32 v[160:161], v[160:161], v[64:65]
    v_pk_mul_f32 v[162:163], v[162:163], v[66:67]
    v_pk_mul_f32 v[164:165], v[164:165], v[68:69]
    v_pk_mul_f32 v[166:167], v[166:167], v[70:71]
    v_pk_mul_f32 v[168:169], v[168:169], v[72:73]
    v_pk_mul_f32 v[170:171], v[170:171], v[74:75]
    v_pk_mul_f32 v[172:173], v[172:173], v[76:77]
    v_pk_mul_f32 v[174:175], v[174:175], v[78:79]
    v_exp_f32 v160, v160
    v_exp_f32 v161, v161
    v_exp_f32 v162, v162
    v_exp_f32 v163, v163
    v_exp_f32 v164, v164
    v_exp_f32 v165, v165
    v_exp_f32 v166, v166
    v_exp_f32 v167, v167
    v_exp_f32 v168, v168
    v_exp_f32 v169, v169
    v_exp_f32 v170, v170
    v_exp_f32 v171, v171
    v_exp_f32 v172, v172
    v_exp_f32 v173, v173
    v_exp_f32 v174, v174
    v_exp_f32 v175, v175
    v_pk_add_f32 v[160:161], v[160:161], 1.0 op_sel_hi:[1,0]
    v_pk_add_f32 v[162:163], v[162:163], 1.0 op_sel_hi:[1,0]
    v_pk_add_f32 v[164:165], v[164:165], 1.0 op_sel_hi:[1,0]
    v_pk_add_f32 v[166:167], v[166:167], 1.0 op_sel_hi:[1,0]
    v_pk_add_f32 v[168:169], v[168:169], 1.0 op_sel_hi:[1,0]
    v_pk_add_f32 v[170:171], v[170:171], 1.0 op_sel_hi:[1,0]
    v_pk_add_f32 v[172:173], v[172:173], 1.0 op_sel_hi:[1,0]
    v_pk_add_f32 v[174:175], v[174:175], 1.0 op_sel_hi:[1,0]
    v_rcp_f32 v160, v160
    v_rcp_f32 v161, v161
    v_rcp_f32 v162, v162
    v_rcp_f32 v163, v163
    v_rcp_f32 v164, v164
    v_rcp_f32 v165, v165
    v_rcp_f32 v166, v166
    v_rcp_f32 v167, v167
    v_rcp_f32 v168, v168
    v_rcp_f32 v169, v169
    v_rcp_f32 v170, v170
    v_rcp_f32 v171, v171
    v_rcp_f32 v172, v172
    v_rcp_f32 v173, v173
    v_rcp_f32 v174, v174
    v_rcp_f32 v175, v175
    v_pk_mul_f32 v[64:65], v[64:65], v[160:161]
    v_pk_mul_f32 v[66:67], v[66:67], v[162:163]
    v_pk_mul_f32 v[68:69], v[68:69], v[164:165]
    v_pk_mul_f32 v[70:71], v[70:71], v[166:167]
    v_pk_mul_f32 v[72:73], v[72:73], v[168:169]
    v_pk_mul_f32 v[74:75], v[74:75], v[170:171]
    v_pk_mul_f32 v[76:77], v[76:77], v[172:173]
    v_pk_mul_f32 v[78:79], v[78:79], v[174:175]
    v_cvt_pk_bf16_f32 v112, v64, v65
    v_cvt_pk_bf16_f32 v113, v66, v67
    v_cvt_pk_bf16_f32 v114, v68, v69
    v_cvt_pk_bf16_f32 v115, v70, v71
    v_cvt_pk_bf16_f32 v116, v72, v73
    v_cvt_pk_bf16_f32 v117, v74, v75
    v_cvt_pk_bf16_f32 v118, v76, v77
    v_cvt_pk_bf16_f32 v119, v78, v79
    buffer_store_dwordx4 v[112:115], v244, s[44:47], s9 offen sc1
    buffer_store_dwordx4 v[116:119], v245, s[44:47], s9 offen sc1
    s_waitcnt vmcnt(6)
    s_barrier
    ds_read_b64_tr_b16 a[64:65], v10 offset:49152
    s_add_u32 m0, s73, 32768
    s_lshl_b32 s14, s94, 18
    ds_read_b64_tr_b16 a[66:67], v10 offset:51200
    ds_read_b64_tr_b16 a[72:73], v10 offset:53248
    ds_read_b64_tr_b16 a[74:75], v10 offset:55296
    ds_read_b64_tr_b16 a[68:69], v11 offset:49152
    buffer_load_dwordx4 v4, s[52:55], s14 offen offset:0 lds
    ds_read_b64_tr_b16 a[70:71], v11 offset:51200
    ds_read_b64_tr_b16 a[76:77], v11 offset:53248
    ds_read_b64_tr_b16 a[78:79], v11 offset:55296
    v_add_u32 v10, 65536, v10
    ds_read_b64_tr_b16 a[80:81], v10 offset:0
    ds_read_b64_tr_b16 a[82:83], v10 offset:2048
    buffer_load_dwordx4 v5, s[52:55], s14 offen offset:1024 lds
    ds_read_b64_tr_b16 a[88:89], v10 offset:4096
    ds_read_b64_tr_b16 a[90:91], v10 offset:6144
    v_add_u32 v11, 65536, v11
    ds_read_b64_tr_b16 a[84:85], v11 offset:0
    ds_read_b64_tr_b16 a[86:87], v11 offset:2048
    ds_read_b64_tr_b16 a[92:93], v11 offset:4096
    buffer_load_dwordx4 v6, s[52:55], s14 offen offset:2048 lds
    ds_read_b64_tr_b16 a[94:95], v11 offset:6144
    v_add_u32 v10, -65536, v10
    ds_read_b64_tr_b16 a[96:97], v10 offset:0
    ds_read_b64_tr_b16 a[98:99], v10 offset:2048
    ds_read_b64_tr_b16 a[104:105], v10 offset:4096
    ds_read_b64_tr_b16 a[106:107], v10 offset:6144
    buffer_load_dwordx4 v7, s[52:55], s14 offen offset:3072 lds
    v_add_u32 v11, -65536, v11
    ds_read_b64_tr_b16 a[100:101], v11 offset:0
    ds_read_b64_tr_b16 a[102:103], v11 offset:2048
    ds_read_b64_tr_b16 a[108:109], v11 offset:4096
    ds_read_b64_tr_b16 a[110:111], v11 offset:6144
    ds_read_b64_tr_b16 a[112:113], v10 offset:16384
    s_add_u32 m0, s73, 81920
    s_lshl_b32 s14, s95, 18
    ds_read_b64_tr_b16 a[114:115], v10 offset:18432
    ds_read_b64_tr_b16 a[120:121], v10 offset:20480
    ds_read_b64_tr_b16 a[122:123], v10 offset:22528
    ds_read_b64_tr_b16 a[116:117], v11 offset:16384
    buffer_load_dwordx4 v4, s[52:55], s14 offen offset:0 lds
    ds_read_b64_tr_b16 a[118:119], v11 offset:18432
    ds_read_b64_tr_b16 a[124:125], v11 offset:20480
    ds_read_b64_tr_b16 a[126:127], v11 offset:22528
    v_add_u32 v10, 131072, v10
    ds_read_b64_tr_b16 a[128:129], v10 offset:0
    ds_read_b64_tr_b16 a[130:131], v10 offset:2048
    buffer_load_dwordx4 v5, s[52:55], s14 offen offset:1024 lds
    ds_read_b64_tr_b16 a[136:137], v10 offset:4096
    ds_read_b64_tr_b16 a[138:139], v10 offset:6144
    v_add_u32 v11, 131072, v11
    ds_read_b64_tr_b16 a[132:133], v11 offset:0
    ds_read_b64_tr_b16 a[134:135], v11 offset:2048
    ds_read_b64_tr_b16 a[140:141], v11 offset:4096
    buffer_load_dwordx4 v6, s[52:55], s14 offen offset:2048 lds
    ds_read_b64_tr_b16 a[142:143], v11 offset:6144
    ds_read_b64_tr_b16 a[144:145], v10 offset:16384
    ds_read_b64_tr_b16 a[146:147], v10 offset:18432
    ds_read_b64_tr_b16 a[152:153], v10 offset:20480
    ds_read_b64_tr_b16 a[154:155], v10 offset:22528
    buffer_load_dwordx4 v7, s[52:55], s14 offen offset:3072 lds
    ds_read_b64_tr_b16 a[148:149], v11 offset:16384
    ds_read_b64_tr_b16 a[150:151], v11 offset:18432
    ds_read_b64_tr_b16 a[156:157], v11 offset:20480
    ds_read_b64_tr_b16 a[158:159], v11 offset:22528
    s_bitcmp1_b32 s3, 1
    s_cselect_b32 s18, s85, s84
    s_mul_i32 s18, s18, 139264
    s_cselect_b32 s19, s87, s86
    s_mul_i32 s19, s19, 139264
    s_cselect_b32 s20, s89, s88
    s_mul_i32 s20, s20, 139264
    s_cselect_b32 s21, s91, s90
    s_mul_i32 s21, s21, 139264
    s_cselect_b32 s22, s93, s92
    s_mul_i32 s22, s22, 139264
    s_cselect_b32 s23, s95, s94
    s_mul_i32 s23, s23, 139264
    s_cselect_b32 s24, s97, s96
    s_mul_i32 s24, s24, 139264
    s_cselect_b32 s25, s99, s98
    s_mul_i32 s25, s25, 139264
    s_cselect_b32 s26, s101, s100
    s_mul_i32 s26, s26, 139264
    s_waitcnt vmcnt(8) lgkmcnt(0)
    s_barrier
    buffer_store_dword v249, v17, s[44:47], 0 offen sc1
    s_add_u32 m0, s73, 0
    s_lshl_b32 s14, s96, 18
    buffer_load_dwordx4 v4, s[52:55], s14 offen offset:0 lds
    buffer_load_dwordx4 v5, s[52:55], s14 offen offset:1024 lds
    buffer_load_dwordx4 v6, s[52:55], s14 offen offset:2048 lds
    buffer_load_dwordx4 v7, s[52:55], s14 offen offset:3072 lds
    s_add_u32 m0, s73, 16384
    s_lshl_b32 s14, s97, 18
    buffer_load_dwordx4 v4, s[52:55], s14 offen offset:0 lds
    buffer_load_dwordx4 v5, s[52:55], s14 offen offset:1024 lds
    buffer_load_dwordx4 v6, s[52:55], s14 offen offset:2048 lds
    buffer_load_dwordx4 v7, s[52:55], s14 offen offset:3072 lds
    v_mov_b32 v16, 0
    buffer_atomic_add v16, v15, s[44:47], 0 offen sc0 sc1
    s_add_u32 m0, s73, 49152
    s_lshl_b32 s14, s98, 18
    buffer_load_dwordx4 v4, s[52:55], s14 offen offset:0 lds
    buffer_load_dwordx4 v5, s[52:55], s14 offen offset:1024 lds
    buffer_load_dwordx4 v6, s[52:55], s14 offen offset:2048 lds
    buffer_load_dwordx4 v7, s[52:55], s14 offen offset:3072 lds
    s_add_u32 m0, s73, 65536
    s_lshl_b32 s14, s99, 18
    buffer_load_dwordx4 v4, s[52:55], s14 offen offset:0 lds
    buffer_load_dwordx4 v5, s[52:55], s14 offen offset:1024 lds
    buffer_load_dwordx4 v6, s[52:55], s14 offen offset:2048 lds
    buffer_load_dwordx4 v7, s[52:55], s14 offen offset:3072 lds
L_DG:
    s_waitcnt vmcnt(8)
    v_cmp_ne_u32 vcc, v13, v16
    s_cbranch_vccnz L_rs_p2G
L_ok_p2G:
    s_barrier
    s_add_u32 m0, s73, 97536
    s_nop 0
    buffer_load_dwordx4 v23, s[44:47], s18 offen offset:768 sc1 lds
    s_add_u32 m0, s73, 99328
    s_nop 0
    buffer_load_dwordx4 v20, s[44:47], s18 offen offset:0 sc1 lds
    s_add_u32 m0, s73, 99840
    s_nop 0
    buffer_load_dwordx4 v20, s[44:47], s18 offen offset:512 sc1 lds
    s_add_u32 m0, s73, 100608
    s_nop 0
    buffer_load_dwordx4 v23, s[44:47], s19 offen offset:768 sc1 lds
    s_add_u32 m0, s73, 114688
    s_nop 0
    buffer_load_dwordx4 v20, s[44:47], s19 offen offset:0 sc1 lds
    s_add_u32 m0, s73, 115200
    s_nop 0
    buffer_load_dwordx4 v20, s[44:47], s19 offen offset:512 sc1 lds
    s_add_u32 m0, s73, 115968
    s_nop 0
    buffer_load_dwordx4 v23, s[44:47], s20 offen offset:768 sc1 lds
    s_add_u32 m0, s73, 117760
    s_nop 0
    buffer_load_dwordx4 v20, s[44:47], s20 offen offset:0 sc1 lds
    v_mov_b32 v195, s68
    v_mov_b32 v199, s68
    v_mov_b32 v202, s68
    v_mov_b32 v203, s68
    s_waitcnt vmcnt(4)
    s_barrier
    ds_read_b128 v[104:107], v14 offset:0
    ds_read_b128 v[108:111], v14 offset:4096
    ds_read_b128 v[112:115], v14 offset:8192
    ds_read_b128 v[116:119], v14 offset:12288
    s_waitcnt lgkmcnt(2)
    v_mfma_f32_16x16x32_bf16 v[32:35], v[104:107], a[0:3], 0
    s_add_u32 m0, s73, 130560
    v_mfma_f32_16x16x32_bf16 v[32:35], v[108:111], a[8:11], v[32:35]
    buffer_load_dwordx4 v20, s[44:47], s20 offen offset:512 sc1 lds
    s_waitcnt lgkmcnt(0)
    v_mfma_f32_16x16x32_bf16 v[32:35], v[112:115], a[16:19], v[32:35]
    ds_read_b128 v[120:123], v14 offset:1024
    v_mfma_f32_16x16x32_bf16 v[32:35], v[116:119], a[24:27], v[32:35]
    ds_read_b128 v[124:127], v14 offset:5120
    v_mfma_f32_16x16x32_bf16 v[36:39], v[116:119], a[28:31], 0
    ds_read_b128 v[128:131], v14 offset:9216
    v_mfma_f32_16x16x32_bf16 v[36:39], v[112:115], a[20:23], v[36:39]
    ds_read_b128 v[132:135], v14 offset:13312
    v_mfma_f32_16x16x32_bf16 v[36:39], v[108:111], a[12:15], v[36:39]
    s_add_u32 m0, s73, 131328
    v_mfma_f32_16x16x32_bf16 v[36:39], v[104:107], a[4:7], v[36:39]
    buffer_load_dwordx4 v23, s[44:47], s21 offen offset:768 sc1 lds
    s_waitcnt lgkmcnt(2)
    v_mfma_f32_16x16x32_bf16 v[44:47], v[120:123], a[4:7], 0
    s_add_u32 m0, s73, 133120
    v_mfma_f32_16x16x32_bf16 v[44:47], v[124:127], a[12:15], v[44:47]
    buffer_load_dwordx4 v20, s[44:47], s21 offen offset:0 sc1 lds
    s_waitcnt lgkmcnt(0)
    v_mfma_f32_16x16x32_bf16 v[44:47], v[128:131], a[20:23], v[44:47]
    ds_read_b128 v[104:107], v14 offset:2048
    v_mfma_f32_16x16x32_bf16 v[44:47], v[132:135], a[28:31], v[44:47]
    ds_read_b128 v[108:111], v14 offset:6144
    v_mfma_f32_16x16x32_bf16 v[40:43], v[132:135], a[24:27], 0
    ds_read_b128 v[112:115], v14 offset:10240
    v_mfma_f32_16x16x32_bf16 v[40:43], v[128:131], a[16:19], v[40:43]
    ds_read_b128 v[116:119], v14 offset:14336
    v_mfma_f32_16x16x32_bf16 v[40:43], v[124:127], a[8:11], v[40:43]
    s_add_u32 m0, s73, 133632
    v_mfma_f32_16x16x32_bf16 v[40:43], v[120:123], a[0:3], v[40:43]
    buffer_load_dwordx4 v20, s[44:47], s21 offen offset:512 sc1 lds
    s_waitcnt lgkmcnt(2)
    v_mfma_f32_16x16x32_bf16 v[48:51], v[104:107], a[0:3], 0
    s_add_u32 m0, s73, 146688
    v_mfma_f32_16x16x32_bf16 v[48:51], v[108:111], a[8:11], v[48:51]
    buffer_load_dwordx4 v23, s[44:47], s22 offen offset:768 sc1 lds
    s_waitcnt lgkmcnt(0)
    v_mfma_f32_16x16x32_bf16 v[48:51], v[112:115], a[16:19], v[48:51]
    ds_read_b128 v[120:123], v14 offset:3072
    v_mfma_f32_16x16x32_bf16 v[48:51], v[116:119], a[24:27], v[48:51]
    ds_read_b128 v[124:127], v14 offset:7168
    v_mfma_f32_16x16x32_bf16 v[52:55], v[116:119], a[28:31], 0
    ds_read_b128 v[128:131], v14 offset:11264
    v_mfma_f32_16x16x32_bf16 v[52:55], v[112:115], a[20:23], v[52:55]
    ds_read_b128 v[132:135], v14 offset:15360
    v_mfma_f32_16x16x32_bf16 v[52:55], v[108:111], a[12:15], v[52:55]
    s_add_u32 m0, s73, 148480
    v_mfma_f32_16x16x32_bf16 v[52:55], v[104:107], a[4:7], v[52:55]
    buffer_load_dwordx4 v20, s[44:47], s22 offen offset:0 sc1 lds
    s_waitcnt lgkmcnt(2)
    v_mfma_f32_16x16x32_bf16 v[36:39], v[120:123], a[36:39], v[36:39]
    s_add_u32 m0, s73, 148992
    v_mfma_f32_16x16x32_bf16 v[36:39], v[124:127], a[44:47], v[36:39]
    buffer_load_dwordx4 v20, s[44:47], s22 offen offset:512 sc1 lds
    s_waitcnt lgkmcnt(0)
    v_mfma_f32_16x16x32_bf16 v[36:39], v[128:131], a[52:55], v[36:39]
    s_waitcnt vmcnt(7)
    s_barrier
    v_mfma_f32_16x16x32_bf16 v[36:39], v[132:135], a[60:63], v[36:39]
    ds_read_b128 v[104:107], v14 offset:16384
    v_add_u32 v10, -131072, v10
    v_mfma_f32_16x16x32_bf16 v[32:35], v[132:135], a[56:59], v[32:35]
    ds_read_b128 v[108:111], v14 offset:20480
    v_mfma_f32_16x16x32_bf16 v[32:35], v[128:131], a[48:51], v[32:35]
    ds_read_b128 v[112:115], v14 offset:24576
    ds_read_b64_tr_b16 a[160:161], v10 offset:32768
    v_mfma_f32_16x16x32_bf16 v[32:35], v[124:127], a[40:43], v[32:35]
    ds_read_b128 v[116:119], v14 offset:28672
    s_add_u32 m0, s73, 149760
    v_mfma_f32_16x16x32_bf16 v[32:35], v[120:123], a[32:35], v[32:35]
    buffer_load_dwordx4 v23, s[44:47], s23 offen offset:768 sc1 lds
    ds_read_b64_tr_b16 a[162:163], v10 offset:34816
    s_waitcnt lgkmcnt(4)
    v_mfma_f32_16x16x32_bf16 v[40:43], v[104:107], a[32:35], v[40:43]
    s_add_u32 m0, s73, 98304
    ds_read_b64_tr_b16 a[168:169], v10 offset:36864
    v_mfma_f32_16x16x32_bf16 v[40:43], v[108:111], a[40:43], v[40:43]
    buffer_load_dwordx4 v20, s[44:47], s23 offen offset:0 sc1 lds
    ds_read_b64_tr_b16 a[170:171], v10 offset:38912
    s_waitcnt lgkmcnt(3)
    v_mfma_f32_16x16x32_bf16 v[40:43], v[112:115], a[48:51], v[40:43]
    ds_read_b128 v[120:123], v14 offset:17408
    v_mfma_f32_16x16x32_bf16 v[40:43], v[116:119], a[56:59], v[40:43]
    ds_read_b128 v[124:127], v14 offset:21504
    v_add_u32 v11, -131072, v11
    v_mfma_f32_16x16x32_bf16 v[44:47], v[116:119], a[60:63], v[44:47]
    ds_read_b128 v[128:131], v14 offset:25600
    v_mfma_f32_16x16x32_bf16 v[44:47], v[112:115], a[52:55], v[44:47]
    ds_read_b128 v[132:135], v14 offset:29696
    v_mfma_f32_16x16x32_bf16 v[44:47], v[108:111], a[44:47], v[44:47]
    s_add_u32 m0, s73, 98816
    ds_read_b64_tr_b16 a[164:165], v11 offset:32768
    v_mfma_f32_16x16x32_bf16 v[44:47], v[104:107], a[36:39], v[44:47]
    buffer_load_dwordx4 v20, s[44:47], s23 offen offset:512 sc1 lds
    ds_read_b64_tr_b16 a[166:167], v11 offset:34816
    s_waitcnt lgkmcnt(4)
    v_mfma_f32_16x16x32_bf16 v[52:55], v[120:123], a[36:39], v[52:55]
    s_add_u32 m0, s73, 99584
    ds_read_b64_tr_b16 a[172:173], v11 offset:36864
    v_mfma_f32_16x16x32_bf16 v[52:55], v[124:127], a[44:47], v[52:55]
    buffer_load_dwordx4 v23, s[44:47], s24 offen offset:768 sc1 lds
    ds_read_b64_tr_b16 a[174:175], v11 offset:38912
    s_waitcnt lgkmcnt(4)
    v_mfma_f32_16x16x32_bf16 v[52:55], v[128:131], a[52:55], v[52:55]
    ds_read_b128 v[104:107], v14 offset:18432
    v_mfma_f32_16x16x32_bf16 v[52:55], v[132:135], a[60:63], v[52:55]
    ds_read_b128 v[108:111], v14 offset:22528
    v_add_u32 v10, 65536, v10
    v_mfma_f32_16x16x32_bf16 v[48:51], v[132:135], a[56:59], v[48:51]
    ds_read_b128 v[112:115], v14 offset:26624
    v_mfma_f32_16x16x32_bf16 v[48:51], v[128:131], a[48:51], v[48:51]
    ds_read_b128 v[116:119], v14 offset:30720
    v_mfma_f32_16x16x32_bf16 v[48:51], v[124:127], a[40:43], v[48:51]
    s_add_u32 m0, s73, 101376
    ds_read_b64_tr_b16 a[176:177], v10 offset:16384
    v_mfma_f32_16x16x32_bf16 v[48:51], v[120:123], a[32:35], v[48:51]
    buffer_load_dwordx4 v20, s[44:47], s24 offen offset:0 sc1 lds
    ds_read_b64_tr_b16 a[178:179], v10 offset:18432
    s_waitcnt lgkmcnt(4)
    v_mfma_f32_16x16x32_bf16 v[32:35], v[104:107], a[64:67], v[32:35]
    ds_read_b64_tr_b16 a[184:185], v10 offset:20480
    v_mfma_f32_16x16x32_bf16 v[32:35], v[108:111], a[72:75], v[32:35]
    ds_read_b64_tr_b16 a[186:187], v10 offset:22528
    s_waitcnt lgkmcnt(4)
    v_mfma_f32_16x16x32_bf16 v[32:35], v[112:115], a[80:83], v[32:35]
    ds_read_b128 v[120:123], v14 offset:19456
    v_mfma_f32_16x16x32_bf16 v[32:35], v[116:119], a[88:91], v[32:35]
    ds_read_b128 v[124:127], v14 offset:23552
    v_add_u32 v11, 65536, v11
    v_mfma_f32_16x16x32_bf16 v[36:39], v[116:119], a[92:95], v[36:39]
    ds_read_b128 v[128:131], v14 offset:27648
    v_mfma_f32_16x16x32_bf16 v[36:39], v[112:115], a[84:87], v[36:39]
    ds_read_b128 v[132:135], v14 offset:31744
    v_mfma_f32_16x16x32_bf16 v[36:39], v[108:111], a[76:79], v[36:39]
    ds_read_b64_tr_b16 a[180:181], v11 offset:16384
    v_mfma_f32_16x16x32_bf16 v[36:39], v[104:107], a[68:71], v[36:39]
    ds_read_b64_tr_b16 a[182:183], v11 offset:18432
    s_waitcnt lgkmcnt(4)
    v_mfma_f32_16x16x32_bf16 v[44:47], v[120:123], a[68:71], v[44:47]
    ds_read_b64_tr_b16 a[188:189], v11 offset:20480
    v_mfma_f32_16x16x32_bf16 v[44:47], v[124:127], a[76:79], v[44:47]
    ds_read_b64_tr_b16 a[190:191], v11 offset:22528
    s_waitcnt lgkmcnt(4)
    v_mfma_f32_16x16x32_bf16 v[44:47], v[128:131], a[84:87], v[44:47]
    s_waitcnt vmcnt(8) lgkmcnt(0)
    s_barrier
    v_mfma_f32_16x16x32_bf16 v[44:47], v[132:135], a[92:95], v[44:47]
    ds_read_b128 v[104:107], v14 offset:32768
    s_lshl_b32 s14, s100, 18
    s_add_u32 m0, s73, 32768
    v_add_u32 v10, -65536, v10
    v_mfma_f32_16x16x32_bf16 v[40:43], v[132:135], a[88:91], v[40:43]
    ds_read_b128 v[108:111], v14 offset:36864
    buffer_load_dwordx4 v4, s[52:55], s14 offen offset:0 lds
    v_mfma_f32_16x16x32_bf16 v[40:43], v[128:131], a[80:83], v[40:43]
    ds_read_b128 v[112:115], v14 offset:40960
    ds_read_b64_tr_b16 a[192:193], v10 offset:0
    v_mfma_f32_16x16x32_bf16 v[40:43], v[124:127], a[72:75], v[40:43]
    ds_read_b128 v[116:119], v14 offset:45056
    v_mfma_f32_16x16x32_bf16 v[40:43], v[120:123], a[64:67], v[40:43]
    ds_read_b64_tr_b16 a[194:195], v10 offset:2048
    s_waitcnt lgkmcnt(4)
    v_mfma_f32_16x16x32_bf16 v[48:51], v[104:107], a[64:67], v[48:51]
    s_add_u32 m0, s73, 114176
    ds_read_b64_tr_b16 a[200:201], v10 offset:4096
    v_mfma_f32_16x16x32_bf16 v[48:51], v[108:111], a[72:75], v[48:51]
    buffer_load_dwordx4 v20, s[44:47], s24 offen offset:512 sc1 lds
    ds_read_b64_tr_b16 a[202:203], v10 offset:6144
    s_waitcnt lgkmcnt(3)
    v_mfma_f32_16x16x32_bf16 v[48:51], v[112:115], a[80:83], v[48:51]
    ds_read_b128 v[120:123], v14 offset:33792
    s_add_u32 m0, s73, 32768
    v_lshrrev_b32 v30, 2, v26
    v_mfma_f32_16x16x32_bf16 v[48:51], v[116:119], a[88:91], v[48:51]
    ds_read_b128 v[124:127], v14 offset:37888
    buffer_load_dwordx4 v5, s[52:55], s14 offen offset:1024 lds
    v_mfma_f32_16x16x32_bf16 v[52:55], v[116:119], a[92:95], v[52:55]
    ds_read_b128 v[128:131], v14 offset:41984
    v_add_u32 v11, -65536, v11
    v_mfma_f32_16x16x32_bf16 v[52:55], v[112:115], a[84:87], v[52:55]
    ds_read_b128 v[132:135], v14 offset:46080
    v_mfma_f32_16x16x32_bf16 v[52:55], v[108:111], a[76:79], v[52:55]
    s_add_u32 m0, s73, 114944
    ds_read_b64_tr_b16 a[196:197], v11 offset:0
    v_mfma_f32_16x16x32_bf16 v[52:55], v[104:107], a[68:71], v[52:55]
    buffer_load_dwordx4 v23, s[44:47], s25 offen offset:768 sc1 lds
    ds_read_b64_tr_b16 a[198:199], v11 offset:2048
    s_waitcnt lgkmcnt(4)
    v_mfma_f32_16x16x32_bf16 v[36:39], v[120:123], a[100:103], v[36:39]
    s_add_u32 m0, s73, 116736
    ds_read_b64_tr_b16 a[204:205], v11 offset:4096
    v_mfma_f32_16x16x32_bf16 v[36:39], v[124:127], a[108:111], v[36:39]
    buffer_load_dwordx4 v20, s[44:47], s25 offen offset:0 sc1 lds
    ds_read_b64_tr_b16 a[206:207], v11 offset:6144
    s_waitcnt lgkmcnt(4)
    v_mfma_f32_16x16x32_bf16 v[36:39], v[128:131], a[116:119], v[36:39]
    ds_read_b128 v[104:107], v14 offset:34816
    s_add_u32 m0, s73, 32768
    v_lshrrev_b32 v31, 2, v18
    v_mfma_f32_16x16x32_bf16 v[36:39], v[132:135], a[124:127], v[36:39]
    ds_read_b128 v[108:111], v14 offset:38912
    buffer_load_dwordx4 v6, s[52:55], s14 offen offset:2048 lds
    v_mfma_f32_16x16x32_bf16 v[32:35], v[132:135], a[120:123], v[32:35]
    ds_read_b128 v[112:115], v14 offset:43008
    v_mfma_f32_16x16x32_bf16 v[32:35], v[128:131], a[112:115], v[32:35]
    ds_read_b128 v[116:119], v14 offset:47104
    v_mfma_f32_16x16x32_bf16 v[32:35], v[124:127], a[104:107], v[32:35]
    s_add_u32 m0, s73, 117248
    ds_read_b64_tr_b16 a[208:209], v10 offset:16384
    v_mfma_f32_16x16x32_bf16 v[32:35], v[120:123], a[96:99], v[32:35]
    buffer_load_dwordx4 v20, s[44:47], s25 offen offset:512 sc1 lds
    ds_read_b64_tr_b16 a[210:211], v10 offset:18432
    s_waitcnt lgkmcnt(4)
    v_mfma_f32_16x16x32_bf16 v[40:43], v[104:107], a[96:99], v[40:43]
    ds_read_b64_tr_b16 a[216:217], v10 offset:20480
    buffer_load_ushort v102, v30, s[60:63], 0 offen offset:0
    s_add_u32 m0, s73, 32768
    v_mfma_f32_16x16x32_bf16 v[40:43], v[108:111], a[104:107], v[40:43]
    ds_read_b64_tr_b16 a[218:219], v10 offset:22528
    buffer_load_dwordx4 v7, s[52:55], s14 offen offset:3072 lds
    s_waitcnt lgkmcnt(4)
    v_mfma_f32_16x16x32_bf16 v[40:43], v[112:115], a[112:115], v[40:43]
    ds_read_b128 v[120:123], v14 offset:35840
    v_mfma_f32_16x16x32_bf16 v[40:43], v[116:119], a[120:123], v[40:43]
    ds_read_b128 v[124:127], v14 offset:39936
    v_mfma_f32_16x16x32_bf16 v[44:47], v[116:119], a[124:127], v[44:47]
    ds_read_b128 v[128:131], v14 offset:44032
    v_mfma_f32_16x16x32_bf16 v[44:47], v[112:115], a[116:119], v[44:47]
    ds_read_b128 v[132:135], v14 offset:48128
    v_mfma_f32_16x16x32_bf16 v[44:47], v[108:111], a[108:111], v[44:47]
    ds_read_b64_tr_b16 a[212:213], v11 offset:16384
    buffer_load_ushort v103, v30, s[60:63], 0 offen offset:32
    v_mfma_f32_16x16x32_bf16 v[44:47], v[104:107], a[100:103], v[44:47]
    ds_read_b64_tr_b16 a[214:215], v11 offset:18432
    s_waitcnt lgkmcnt(4)
    v_mfma_f32_16x16x32_bf16 v[52:55], v[120:123], a[100:103], v[52:55]
    ds_read_b64_tr_b16 a[220:221], v11 offset:20480
    v_mfma_f32_16x16x32_bf16 v[52:55], v[124:127], a[108:111], v[52:55]
    ds_read_b64_tr_b16 a[222:223], v11 offset:22528
    s_waitcnt lgkmcnt(4)
    v_mfma_f32_16x16x32_bf16 v[52:55], v[128:131], a[116:119], v[52:55]
    s_waitcnt vmcnt(14) lgkmcnt(0)
    s_barrier
    v_mfma_f32_16x16x32_bf16 v[52:55], v[132:135], a[124:127], v[52:55]
    ds_read_b128 v[104:107], v14 offset:49152
    s_lshl_b32 s14, s101, 18
    ds_read_b64_tr_b16 a[224:225], v10 offset:49152
    s_add_u32 m0, s73, 81920
    v_mfma_f32_16x16x32_bf16 v[48:51], v[132:135], a[120:123], v[48:51]
    ds_read_b128 v[108:111], v14 offset:53248
    buffer_load_dwordx4 v4, s[52:55], s14 offen offset:0 lds
    v_mfma_f32_16x16x32_bf16 v[48:51], v[128:131], a[112:115], v[48:51]
    ds_read_b128 v[112:115], v14 offset:57344
    buffer_load_ushort v27, v31, s[60:63], 0 offen offset:0
    v_mfma_f32_16x16x32_bf16 v[48:51], v[124:127], a[104:107], v[48:51]
    ds_read_b128 v[116:119], v14 offset:61440
    v_mfma_f32_16x16x32_bf16 v[48:51], v[120:123], a[96:99], v[48:51]
    ds_read_b64_tr_b16 a[226:227], v10 offset:51200
    s_waitcnt lgkmcnt(3)
    v_mfma_f32_16x16x32_bf16 v[32:35], v[104:107], a[128:131], v[32:35]
    s_add_u32 m0, s73, 130304
    ds_read_b64_tr_b16 a[232:233], v10 offset:53248
    v_mfma_f32_16x16x32_bf16 v[32:35], v[108:111], a[136:139], v[32:35]
    buffer_load_dwordx4 v23, s[44:47], s26 offen offset:768 sc1 lds
    ds_read_b64_tr_b16 a[234:235], v10 offset:55296
    s_waitcnt lgkmcnt(3)
    v_mfma_f32_16x16x32_bf16 v[32:35], v[112:115], a[144:147], v[32:35]
    ds_read_b128 v[120:123], v14 offset:50176
    s_add_u32 m0, s73, 81920
    v_mfma_f32_16x16x32_bf16 v[32:35], v[116:119], a[152:155], v[32:35]
    ds_read_b128 v[124:127], v14 offset:54272
    buffer_load_dwordx4 v5, s[52:55], s14 offen offset:1024 lds
    v_mfma_f32_16x16x32_bf16 v[36:39], v[116:119], a[156:159], v[36:39]
    ds_read_b128 v[128:131], v14 offset:58368
    v_mfma_f32_16x16x32_bf16 v[36:39], v[112:115], a[148:151], v[36:39]
    ds_read_b128 v[132:135], v14 offset:62464
    v_mfma_f32_16x16x32_bf16 v[36:39], v[108:111], a[140:143], v[36:39]
    s_add_u32 m0, s73, 132096
    ds_read_b64_tr_b16 a[228:229], v11 offset:49152
    v_mfma_f32_16x16x32_bf16 v[36:39], v[104:107], a[132:135], v[36:39]
    buffer_load_dwordx4 v20, s[44:47], s26 offen offset:0 sc1 lds
    ds_read_b64_tr_b16 a[230:231], v11 offset:51200
    s_waitcnt lgkmcnt(4)
    v_mfma_f32_16x16x32_bf16 v[44:47], v[120:123], a[132:135], v[44:47]
    ds_read_b64_tr_b16 a[236:237], v11 offset:53248
    buffer_load_dwordx4 v[88:91], v252, s[56:59], 0 offen
    s_add_u32 m0, s73, 132608
    v_mfma_f32_16x16x32_bf16 v[44:47], v[124:127], a[140:143], v[44:47]
    buffer_load_dwordx4 v20, s[44:47], s26 offen offset:512 sc1 lds
    ds_read_b64_tr_b16 a[238:239], v11 offset:55296
    s_waitcnt lgkmcnt(4)
    v_mfma_f32_16x16x32_bf16 v[44:47], v[128:131], a[148:151], v[44:47]
    ds_read_b128 v[104:107], v14 offset:51200
    s_add_u32 m0, s73, 81920
    v_add_u32 v10, 65536, v10
    v_mfma_f32_16x16x32_bf16 v[44:47], v[132:135], a[156:159], v[44:47]
    ds_read_b128 v[108:111], v14 offset:55296
    buffer_load_dwordx4 v6, s[52:55], s14 offen offset:2048 lds
    v_mfma_f32_16x16x32_bf16 v[40:43], v[132:135], a[152:155], v[40:43]
    ds_read_b128 v[112:115], v14 offset:59392
    v_mfma_f32_16x16x32_bf16 v[40:43], v[128:131], a[144:147], v[40:43]
    ds_read_b128 v[116:119], v14 offset:63488
    v_mfma_f32_16x16x32_bf16 v[40:43], v[124:127], a[136:139], v[40:43]
    s_add_u32 m0, s73, 134144
    ds_read_b64_tr_b16 a[240:241], v10 offset:0
    v_mfma_f32_16x16x32_bf16 v[40:43], v[120:123], a[128:131], v[40:43]
    buffer_load_dwordx4 v21, s[44:47], s18 offen offset:0 sc1 lds
    ds_read_b64_tr_b16 a[242:243], v10 offset:2048
    s_waitcnt lgkmcnt(4)
    v_mfma_f32_16x16x32_bf16 v[48:51], v[104:107], a[128:131], v[48:51]
    ds_read_b64_tr_b16 a[248:249], v10 offset:4096
    s_add_u32 m0, s73, 81920
    v_mfma_f32_16x16x32_bf16 v[48:51], v[108:111], a[136:139], v[48:51]
    ds_read_b64_tr_b16 a[250:251], v10 offset:6144
    buffer_load_dwordx4 v7, s[52:55], s14 offen offset:3072 lds
    s_waitcnt lgkmcnt(4)
    v_mfma_f32_16x16x32_bf16 v[48:51], v[112:115], a[144:147], v[48:51]
    ds_read_b128 v[120:123], v14 offset:52224
    v_add_u32 v11, 65536, v11
    v_mfma_f32_16x16x32_bf16 v[48:51], v[116:119], a[152:155], v[48:51]
    ds_read_b128 v[124:127], v14 offset:56320
    v_mfma_f32_16x16x32_bf16 v[52:55], v[116:119], a[156:159], v[52:55]
    ds_read_b128 v[128:131], v14 offset:60416
    v_mfma_f32_16x16x32_bf16 v[52:55], v[112:115], a[148:151], v[52:55]
    ds_read_b128 v[132:135], v14 offset:64512
    v_mfma_f32_16x16x32_bf16 v[52:55], v[108:111], a[140:143], v[52:55]
    ds_read_b64_tr_b16 a[244:245], v11 offset:0
    v_mfma_f32_16x16x32_bf16 v[52:55], v[104:107], a[132:135], v[52:55]
    ds_read_b64_tr_b16 a[246:247], v11 offset:2048
    s_waitcnt lgkmcnt(4)
    v_mfma_f32_16x16x32_bf16 v[36:39], v[120:123], a[164:167], v[36:39]
    ds_read_b64_tr_b16 a[252:253], v11 offset:4096
    buffer_load_dwordx4 v[92:95], v252, s[56:59], s40 offen
    v_mfma_f32_16x16x32_bf16 v[36:39], v[124:127], a[172:175], v[36:39]
    ds_read_b64_tr_b16 a[254:255], v11 offset:6144
    s_waitcnt lgkmcnt(4)
    v_mfma_f32_16x16x32_bf16 v[36:39], v[128:131], a[180:183], v[36:39]
    s_waitcnt vmcnt(12) lgkmcnt(0)
    s_barrier
    v_mfma_f32_16x16x32_bf16 v[36:39], v[132:135], a[188:191], v[36:39]
    ds_read_b128 v[104:107], v14 offset:0
    v_mfma_f32_16x16x32_bf16 v[32:35], v[132:135], a[184:187], v[32:35]
    ds_read_b128 v[108:111], v14 offset:4096
    v_add_u32 v10, -65536, v10
L_pl_G_6:
    s_cbranch_execz L_wret
    v_mfma_f32_16x16x32_bf16 v[32:35], v[128:131], a[176:179], v[32:35]
    ds_read_b128 v[112:115], v14 offset:8192
    v_mfma_f32_16x16x32_bf16 v[32:35], v[124:127], a[168:171], v[32:35]
    ds_read_b128 v[116:119], v14 offset:12288
    v_mfma_f32_16x16x32_bf16 v[32:35], v[120:123], a[160:163], v[32:35]
    ds_read_b64_tr_b16 v[220:221], v10 offset:32768
    s_waitcnt lgkmcnt(3)
    v_mfma_f32_16x16x32_bf16 v[40:43], v[104:107], a[160:163], v[40:43]
    s_add_u32 m0, s73, 146944
    v_mfma_f32_16x16x32_bf16 v[40:43], v[108:111], a[168:171], v[40:43]
    buffer_load_dwordx4 v21, s[44:47], s18 offen offset:512 sc1 lds
    ds_read_b64_tr_b16 v[222:223], v10 offset:34816
    s_waitcnt lgkmcnt(2)
    v_mfma_f32_16x16x32_bf16 v[40:43], v[112:115], a[176:179], v[40:43]
    ds_read_b128 v[120:123], v14 offset:1024
    v_mfma_f32_16x16x32_bf16 v[40:43], v[116:119], a[184:187], v[40:43]
    ds_read_b128 v[124:127], v14 offset:5120
    v_mfma_f32_16x16x32_bf16 v[44:47], v[116:119], a[188:191], v[44:47]
    ds_read_b128 v[128:131], v14 offset:9216
    v_mfma_f32_16x16x32_bf16 v[44:47], v[112:115], a[180:183], v[44:47]
    ds_read_b128 v[132:135], v14 offset:13312
    v_mfma_f32_16x16x32_bf16 v[44:47], v[108:111], a[172:175], v[44:47]
    s_add_u32 m0, s73, 148480
    ds_read_b64_tr_b16 v[228:229], v10 offset:36864
    v_mfma_f32_16x16x32_bf16 v[44:47], v[104:107], a[164:167], v[44:47]
    buffer_load_dwordx4 v21, s[44:47], s19 offen offset:0 sc1 lds
    s_waitcnt lgkmcnt(3)
    v_mfma_f32_16x16x32_bf16 v[52:55], v[120:123], a[164:167], v[52:55]
    ds_read_b64_tr_b16 v[230:231], v10 offset:38912
    buffer_load_dwordx2 v[142:143], v253, s[56:59], 0 offen
    s_add_u32 m0, s73, 148992
    v_mfma_f32_16x16x32_bf16 v[52:55], v[124:127], a[172:175], v[52:55]
    buffer_load_dwordx4 v21, s[44:47], s19 offen offset:512 sc1 lds
    s_waitcnt lgkmcnt(2)
    v_mfma_f32_16x16x32_bf16 v[52:55], v[128:131], a[180:183], v[52:55]
    ds_read_b128 v[104:107], v14 offset:2048
    v_mfma_f32_16x16x32_bf16 v[52:55], v[132:135], a[188:191], v[52:55]
    ds_read_b128 v[108:111], v14 offset:6144
    v_mfma_f32_16x16x32_bf16 v[48:51], v[132:135], a[184:187], v[48:51]
    ds_read_b128 v[112:115], v14 offset:10240
    v_add_u32 v11, -65536, v11
    v_mfma_f32_16x16x32_bf16 v[48:51], v[128:131], a[176:179], v[48:51]
    ds_read_b128 v[116:119], v14 offset:14336
    v_mfma_f32_16x16x32_bf16 v[48:51], v[124:127], a[168:171], v[48:51]
    s_add_u32 m0, s73, 150528
    v_mfma_f32_16x16x32_bf16 v[48:51], v[120:123], a[160:163], v[48:51]
    buffer_load_dwordx4 v21, s[44:47], s20 offen offset:0 sc1 lds
    ds_read_b64_tr_b16 v[224:225], v11 offset:32768
    s_waitcnt lgkmcnt(3)
    v_mfma_f32_16x16x32_bf16 v[32:35], v[104:107], a[192:195], v[32:35]
    v_mfma_f32_16x16x32_bf16 v[32:35], v[108:111], a[200:203], v[32:35]
    ds_read_b64_tr_b16 v[226:227], v11 offset:34816
    s_waitcnt vmcnt(14)
    s_waitcnt lgkmcnt(2)
    v_mfma_f32_16x16x32_bf16 v[32:35], v[112:115], a[208:211], v[32:35]
    ds_read_b128 v[120:123], v14 offset:3072
    v_mfma_f32_16x16x32_bf16 v[32:35], v[116:119], a[216:219], v[32:35]
    ds_read_b128 v[124:127], v14 offset:7168
    v_mfma_f32_16x16x32_bf16 v[36:39], v[116:119], a[220:223], v[36:39]
    ds_read_b128 v[128:131], v14 offset:11264
    v_lshlrev_b32 v72, 16, v102
    v_mfma_f32_16x16x32_bf16 v[36:39], v[112:115], a[212:215], v[36:39]
    ds_read_b128 v[132:135], v14 offset:15360
    v_mfma_f32_16x16x32_bf16 v[36:39], v[108:111], a[204:207], v[36:39]
    ds_read_b64_tr_b16 v[232:233], v11 offset:36864
    v_lshlrev_b32 v73, 16, v102
    v_mfma_f32_16x16x32_bf16 v[36:39], v[104:107], a[196:199], v[36:39]
    s_waitcnt lgkmcnt(3)
    v_mfma_f32_16x16x32_bf16 v[44:47], v[120:123], a[196:199], v[44:47]
    ds_read_b64_tr_b16 v[234:235], v11 offset:38912
    buffer_load_dwordx2 v[96:97], v26, s[44:47], s42 offen offset:0 sc1
    v_mfma_f32_16x16x32_bf16 v[44:47], v[124:127], a[204:207], v[44:47]
    v_lshlrev_b32 v74, 16, v102
    s_waitcnt lgkmcnt(2)
    v_mfma_f32_16x16x32_bf16 v[44:47], v[128:131], a[212:215], v[44:47]
    s_waitcnt vmcnt(7) lgkmcnt(0)
    s_barrier
    v_mfma_f32_16x16x32_bf16 v[44:47], v[132:135], a[220:223], v[44:47]
    ds_read_b128 v[104:107], v14 offset:16384
    v_lshlrev_b32 v75, 16, v102
    v_mfma_f32_16x16x32_bf16 v[40:43], v[132:135], a[216:219], v[40:43]
    ds_read_b128 v[108:111], v14 offset:20480
    v_add_u32 v10, 65536, v10
    v_mfma_f32_16x16x32_bf16 v[40:43], v[128:131], a[208:211], v[40:43]
    ds_read_b128 v[112:115], v14 offset:24576
    v_mfma_f32_16x16x32_bf16 v[40:43], v[124:127], a[200:203], v[40:43]
    ds_read_b128 v[116:119], v14 offset:28672
    v_lshlrev_b32 v76, 16, v103
    v_mfma_f32_16x16x32_bf16 v[40:43], v[120:123], a[192:195], v[40:43]
    ds_read_b64_tr_b16 v[236:237], v10 offset:16384
    s_waitcnt lgkmcnt(3)
    v_mfma_f32_16x16x32_bf16 v[48:51], v[104:107], a[192:195], v[48:51]
    s_add_u32 m0, s73, 97792
    v_lshlrev_b32 v77, 16, v103
    v_mfma_f32_16x16x32_bf16 v[48:51], v[108:111], a[200:203], v[48:51]
    buffer_load_dwordx4 v21, s[44:47], s20 offen offset:512 sc1 lds
    ds_read_b64_tr_b16 v[238:239], v10 offset:18432
    s_waitcnt lgkmcnt(2)
    v_mfma_f32_16x16x32_bf16 v[48:51], v[112:115], a[208:211], v[48:51]
    ds_read_b128 v[120:123], v14 offset:17408
    v_mfma_f32_16x16x32_bf16 v[48:51], v[116:119], a[216:219], v[48:51]
    ds_read_b128 v[124:127], v14 offset:21504
    v_mfma_f32_16x16x32_bf16 v[52:55], v[116:119], a[220:223], v[52:55]
    ds_read_b128 v[128:131], v14 offset:25600
    v_lshlrev_b32 v78, 16, v103
    v_mfma_f32_16x16x32_bf16 v[52:55], v[112:115], a[212:215], v[52:55]
    ds_read_b128 v[132:135], v14 offset:29696
    v_mfma_f32_16x16x32_bf16 v[52:55], v[108:111], a[204:207], v[52:55]
    ds_read_b64_tr_b16 v[244:245], v10 offset:20480
    s_add_u32 m0, s73, 99328
    v_lshlrev_b32 v79, 16, v103
    v_mfma_f32_16x16x32_bf16 v[52:55], v[104:107], a[196:199], v[52:55]
    buffer_load_dwordx4 v21, s[44:47], s21 offen offset:0 sc1 lds
    s_waitcnt lgkmcnt(3)
    v_mfma_f32_16x16x32_bf16 v[36:39], v[120:123], a[228:231], v[36:39]
    ds_read_b64_tr_b16 v[246:247], v10 offset:22528
    buffer_load_dwordx2 v[98:99], v26, s[44:47], s42 offen offset:128 sc1
    s_add_u32 m0, s73, 99840
    v_mfma_f32_16x16x32_bf16 v[36:39], v[124:127], a[236:239], v[36:39]
    buffer_load_dwordx4 v21, s[44:47], s21 offen offset:512 sc1 lds
    s_waitcnt lgkmcnt(2)
    v_mfma_f32_16x16x32_bf16 v[36:39], v[128:131], a[244:247], v[36:39]
    ds_read_b128 v[104:107], v14 offset:18432
    v_lshlrev_b32 v80, 16, v102
    v_mfma_f32_16x16x32_bf16 v[36:39], v[132:135], a[252:255], v[36:39]
    ds_read_b128 v[108:111], v14 offset:22528
    v_lshlrev_b32 v81, 16, v102
    v_mfma_f32_16x16x32_bf16 v[32:35], v[132:135], a[248:251], v[32:35]
    ds_read_b128 v[112:115], v14 offset:26624
    v_add_u32 v11, 65536, v11
    v_mfma_f32_16x16x32_bf16 v[32:35], v[128:131], a[240:243], v[32:35]
    ds_read_b128 v[116:119], v14 offset:30720
    v_mfma_f32_16x16x32_bf16 v[32:35], v[124:127], a[232:235], v[32:35]
    s_add_u32 m0, s73, 101376
    v_lshlrev_b32 v82, 16, v102
    v_mfma_f32_16x16x32_bf16 v[32:35], v[120:123], a[224:227], v[32:35]
    buffer_load_dwordx4 v21, s[44:47], s22 offen offset:0 sc1 lds
    ds_read_b64_tr_b16 v[240:241], v11 offset:16384
    s_waitcnt lgkmcnt(3)
    v_mfma_f32_16x16x32_bf16 v[40:43], v[104:107], a[224:227], v[40:43]
    v_lshlrev_b32 v83, 16, v102
    v_mfma_f32_16x16x32_bf16 v[40:43], v[108:111], a[232:235], v[40:43]
    ds_read_b64_tr_b16 v[242:243], v11 offset:18432
    s_waitcnt lgkmcnt(2)
    v_mfma_f32_16x16x32_bf16 v[40:43], v[112:115], a[240:243], v[40:43]
    ds_read_b128 v[120:123], v14 offset:19456
    v_mfma_f32_16x16x32_bf16 v[40:43], v[116:119], a[248:251], v[40:43]
    ds_read_b128 v[124:127], v14 offset:23552
    v_mfma_f32_16x16x32_bf16 v[44:47], v[116:119], a[252:255], v[44:47]
    ds_read_b128 v[128:131], v14 offset:27648
    v_lshlrev_b32 v84, 16, v103
    v_mfma_f32_16x16x32_bf16 v[44:47], v[112:115], a[244:247], v[44:47]
    ds_read_b128 v[132:135], v14 offset:31744
    v_mfma_f32_16x16x32_bf16 v[44:47], v[108:111], a[236:239], v[44:47]
    ds_read_b64_tr_b16 v[248:249], v11 offset:20480
    v_lshlrev_b32 v85, 16, v103
    v_mfma_f32_16x16x32_bf16 v[44:47], v[104:107], a[228:231], v[44:47]
    s_waitcnt lgkmcnt(3)
    v_mfma_f32_16x16x32_bf16 v[52:55], v[120:123], a[228:231], v[52:55]
    ds_read_b64_tr_b16 v[250:251], v11 offset:22528
    buffer_load_dwordx2 v[100:101], v18, s[44:47], s42 offen offset:0 sc1
    v_mfma_f32_16x16x32_bf16 v[52:55], v[124:127], a[236:239], v[52:55]
    v_lshlrev_b32 v86, 16, v103
    s_waitcnt lgkmcnt(2)
    v_mfma_f32_16x16x32_bf16 v[52:55], v[128:131], a[244:247], v[52:55]
    s_waitcnt lgkmcnt(0)
    s_barrier
    v_mfma_f32_16x16x32_bf16 v[52:55], v[132:135], a[252:255], v[52:55]
    ds_read_b128 v[104:107], v14 offset:32768
    v_mfma_f32_16x16x32_bf16 v[48:51], v[132:135], a[248:251], v[48:51]
    ds_read_b128 v[108:111], v14 offset:36864
    v_lshlrev_b32 v87, 16, v103
    v_mfma_f32_16x16x32_bf16 v[48:51], v[128:131], a[240:243], v[48:51]
    ds_read_b128 v[112:115], v14 offset:40960
    v_mfma_f32_16x16x32_bf16 v[48:51], v[124:127], a[232:235], v[48:51]
    ds_read_b128 v[116:119], v14 offset:45056
    v_lshlrev_b32 v27, 16, v27
    v_mfma_f32_16x16x32_bf16 v[48:51], v[120:123], a[224:227], v[48:51]
L_Dc:
L_pl_D_0:
    s_cbranch_execz L_wret
    s_waitcnt lgkmcnt(2)
    v_mfma_f32_16x16x32_bf16 v[32:35], v[104:107], v[220:223], v[32:35]
    s_add_u32 m0, s73, 114176
    v_mfma_f32_16x16x32_bf16 v[32:35], v[108:111], v[228:231], v[32:35]
    buffer_load_dwordx4 v21, s[44:47], s22 offen offset:512 sc1 lds
    s_waitcnt lgkmcnt(0)
    v_mfma_f32_16x16x32_bf16 v[32:35], v[112:115], v[236:239], v[32:35]
    ds_read_b128 v[120:123], v14 offset:33792
    v_mfma_f32_16x16x32_bf16 v[32:35], v[116:119], v[244:247], v[32:35]
    ds_read_b128 v[124:127], v14 offset:37888
    v_mfma_f32_16x16x32_bf16 v[36:39], v[116:119], v[248:251], v[36:39]
    ds_read_b128 v[128:131], v14 offset:41984
    buffer_load_dword v189, v188, s[44:47], 0 offen sc1
    v_mfma_f32_16x16x32_bf16 v[36:39], v[112:115], v[240:243], v[36:39]
    ds_read_b128 v[132:135], v14 offset:46080
    v_mfma_f32_16x16x32_bf16 v[36:39], v[108:111], v[232:235], v[36:39]
    s_add_u32 m0, s73, 115712
    v_mfma_f32_16x16x32_bf16 v[36:39], v[104:107], v[224:227], v[36:39]
    buffer_load_dwordx4 v21, s[44:47], s23 offen offset:0 sc1 lds
    s_waitcnt lgkmcnt(2)
    v_mfma_f32_16x16x32_bf16 v[44:47], v[120:123], v[224:227], v[44:47]
    s_add_u32 m0, s73, 116224
    v_mfma_f32_16x16x32_bf16 v[44:47], v[124:127], v[232:235], v[44:47]
    buffer_load_dwordx4 v21, s[44:47], s23 offen offset:512 sc1 lds
    s_waitcnt lgkmcnt(0)
    v_mfma_f32_16x16x32_bf16 v[44:47], v[128:131], v[240:243], v[44:47]
    ds_read_b128 v[104:107], v14 offset:34816
    v_mfma_f32_16x16x32_bf16 v[44:47], v[132:135], v[248:251], v[44:47]
    ds_read_b128 v[108:111], v14 offset:38912
    v_mfma_f32_16x16x32_bf16 v[40:43], v[132:135], v[244:247], v[40:43]
    ds_read_b128 v[112:115], v14 offset:43008
    v_mfma_f32_16x16x32_bf16 v[40:43], v[128:131], v[236:239], v[40:43]
    ds_read_b128 v[116:119], v14 offset:47104
    v_mfma_f32_16x16x32_bf16 v[40:43], v[124:127], v[228:231], v[40:43]
    s_add_u32 m0, s73, 117760
    v_mfma_f32_16x16x32_bf16 v[40:43], v[120:123], v[220:223], v[40:43]
    buffer_load_dwordx4 v21, s[44:47], s24 offen offset:0 sc1 lds
    s_waitcnt lgkmcnt(2)
    v_mfma_f32_16x16x32_bf16 v[48:51], v[104:107], v[220:223], v[48:51]
    v_mfma_f32_16x16x32_bf16 v[48:51], v[108:111], v[228:231], v[48:51]
    s_waitcnt lgkmcnt(0)
    v_mfma_f32_16x16x32_bf16 v[48:51], v[112:115], v[236:239], v[48:51]
    ds_read_b128 v[120:123], v14 offset:35840
    v_mfma_f32_16x16x32_bf16 v[48:51], v[116:119], v[244:247], v[48:51]
    ds_read_b128 v[124:127], v14 offset:39936
    v_mfma_f32_16x16x32_bf16 v[52:55], v[116:119], v[248:251], v[52:55]
    ds_read_b128 v[128:131], v14 offset:44032
    v_mfma_f32_16x16x32_bf16 v[52:55], v[112:115], v[240:243], v[52:55]
    ds_read_b128 v[132:135], v14 offset:48128
    v_mfma_f32_16x16x32_bf16 v[52:55], v[108:111], v[232:235], v[52:55]
    v_mfma_f32_16x16x32_bf16 v[52:55], v[104:107], v[224:227], v[52:55]
    s_waitcnt lgkmcnt(2)
    v_mfma_f32_16x16x32_bf16 v[60:63], v[120:123], a[4:7], 0
    v_mfma_f32_16x16x32_bf16 v[60:63], v[124:127], a[12:15], v[60:63]
    s_waitcnt lgkmcnt(0)
    v_mfma_f32_16x16x32_bf16 v[60:63], v[128:131], a[20:23], v[60:63]
    s_waitcnt vmcnt(12)
    s_barrier
    v_mfma_f32_16x16x32_bf16 v[60:63], v[132:135], a[28:31], v[60:63]
    ds_read_b128 v[104:107], v14 offset:49152
    v_mfma_f32_16x16x32_bf16 v[56:59], v[132:135], a[24:27], 0
    ds_read_b128 v[108:111], v14 offset:53248
    v_mfma_f32_16x16x32_bf16 v[56:59], v[128:131], a[16:19], v[56:59]
    ds_read_b128 v[112:115], v14 offset:57344
    v_cvt_pk_bf16_f32 v192, v32, v33
    v_mfma_f32_16x16x32_bf16 v[56:59], v[124:127], a[8:11], v[56:59]
    ds_read_b128 v[116:119], v14 offset:61440
    v_mfma_f32_16x16x32_bf16 v[56:59], v[120:123], a[0:3], v[56:59]
    s_waitcnt lgkmcnt(2)
    v_mfma_f32_16x16x32_bf16 v[64:67], v[104:107], a[0:3], 0
    s_add_u32 m0, s73, 130560
    v_mfma_f32_16x16x32_bf16 v[64:67], v[108:111], a[8:11], v[64:67]
    buffer_load_dwordx4 v21, s[44:47], s24 offen offset:512 sc1 lds
    s_waitcnt lgkmcnt(0)
    v_mfma_f32_16x16x32_bf16 v[64:67], v[112:115], a[16:19], v[64:67]
    ds_read_b128 v[120:123], v14 offset:50176
    v_cvt_pk_bf16_f32 v193, v34, v35
    v_mfma_f32_16x16x32_bf16 v[64:67], v[116:119], a[24:27], v[64:67]
    ds_read_b128 v[124:127], v14 offset:54272
    v_mfma_f32_16x16x32_bf16 v[68:71], v[116:119], a[28:31], 0
    ds_read_b128 v[128:131], v14 offset:58368
    v_mfma_f32_16x16x32_bf16 v[68:71], v[112:115], a[20:23], v[68:71]
    buffer_store_dwordx4 v[192:195], v136, s[44:47], s32 offen sc1
    ds_read_b128 v[132:135], v14 offset:62464
    v_mfma_f32_16x16x32_bf16 v[68:71], v[108:111], a[12:15], v[68:71]
    s_add_u32 m0, s73, 132096
    v_mfma_f32_16x16x32_bf16 v[68:71], v[104:107], a[4:7], v[68:71]
    buffer_load_dwordx4 v21, s[44:47], s25 offen offset:0 sc1 lds
    s_waitcnt lgkmcnt(2)
    v_mfma_f32_16x16x32_bf16 v[60:63], v[120:123], a[36:39], v[60:63]
    s_add_u32 m0, s73, 132608
    v_mfma_f32_16x16x32_bf16 v[60:63], v[124:127], a[44:47], v[60:63]
    buffer_load_dwordx4 v21, s[44:47], s25 offen offset:512 sc1 lds
    s_waitcnt lgkmcnt(0)
    v_mfma_f32_16x16x32_bf16 v[60:63], v[128:131], a[52:55], v[60:63]
    ds_read_b128 v[104:107], v14 offset:51200
    v_mfma_f32_16x16x32_bf16 v[60:63], v[132:135], a[60:63], v[60:63]
    ds_read_b128 v[108:111], v14 offset:55296
    v_mfma_f32_16x16x32_bf16 v[56:59], v[132:135], a[56:59], v[56:59]
    ds_read_b128 v[112:115], v14 offset:59392
    v_mfma_f32_16x16x32_bf16 v[56:59], v[128:131], a[48:51], v[56:59]
    ds_read_b128 v[116:119], v14 offset:63488
    v_mfma_f32_16x16x32_bf16 v[56:59], v[124:127], a[40:43], v[56:59]
    s_add_u32 m0, s73, 134144
    v_cvt_pk_bf16_f32 v196, v36, v37
    v_mfma_f32_16x16x32_bf16 v[56:59], v[120:123], a[32:35], v[56:59]
    buffer_load_dwordx4 v21, s[44:47], s26 offen offset:0 sc1 lds
    s_waitcnt lgkmcnt(2)
    v_mfma_f32_16x16x32_bf16 v[64:67], v[104:107], a[32:35], v[64:67]
    v_mfma_f32_16x16x32_bf16 v[64:67], v[108:111], a[40:43], v[64:67]
    s_waitcnt lgkmcnt(0)
    v_mfma_f32_16x16x32_bf16 v[64:67], v[112:115], a[48:51], v[64:67]
    ds_read_b128 v[120:123], v14 offset:52224
    v_cvt_pk_bf16_f32 v197, v38, v39
    v_mfma_f32_16x16x32_bf16 v[64:67], v[116:119], a[56:59], v[64:67]
    ds_read_b128 v[124:127], v14 offset:56320
    v_mfma_f32_16x16x32_bf16 v[68:71], v[116:119], a[60:63], v[68:71]
    ds_read_b128 v[128:131], v14 offset:60416
    v_mfma_f32_16x16x32_bf16 v[68:71], v[112:115], a[52:55], v[68:71]
    ds_read_b128 v[132:135], v14 offset:64512
    v_mfma_f32_16x16x32_bf16 v[68:71], v[108:111], a[44:47], v[68:71]
    buffer_store_dwordx4 v[196:199], v136, s[44:47], s33 offen sc1
    v_mfma_f32_16x16x32_bf16 v[68:71], v[104:107], a[36:39], v[68:71]
    s_waitcnt lgkmcnt(2)
    v_mfma_f32_16x16x32_bf16 v[60:63], v[120:123], a[68:71], v[60:63]
    v_mfma_f32_16x16x32_bf16 v[60:63], v[124:127], a[76:79], v[60:63]
    s_waitcnt lgkmcnt(0)
    v_mfma_f32_16x16x32_bf16 v[60:63], v[128:131], a[84:87], v[60:63]
    s_waitcnt vmcnt(12)
    s_barrier
    v_mfma_f32_16x16x32_bf16 v[60:63], v[132:135], a[92:95], v[60:63]
    ds_read_b128 v[104:107], v14 offset:0
    v_mfma_f32_16x16x32_bf16 v[56:59], v[132:135], a[88:91], v[56:59]
    ds_read_b128 v[108:111], v14 offset:4096
    v_mfma_f32_16x16x32_bf16 v[56:59], v[128:131], a[80:83], v[56:59]
    ds_read_b128 v[112:115], v14 offset:8192
    v_cvt_pk_bf16_f32 v192, v40, v41
    v_mfma_f32_16x16x32_bf16 v[56:59], v[124:127], a[72:75], v[56:59]
    ds_read_b128 v[116:119], v14 offset:12288
    v_mfma_f32_16x16x32_bf16 v[56:59], v[120:123], a[64:67], v[56:59]
    s_waitcnt lgkmcnt(2)
    v_mfma_f32_16x16x32_bf16 v[64:67], v[104:107], a[64:67], v[64:67]
    s_add_u32 m0, s73, 146944
    v_cvt_pk_bf16_f32 v193, v42, v43
    s_waitcnt vmcnt(11)
    v_mfma_f32_16x16x32_bf16 v[64:67], v[108:111], a[72:75], v[64:67]
    buffer_load_dwordx4 v21, s[44:47], s26 offen offset:512 sc1 lds
    s_waitcnt lgkmcnt(0)
    v_mfma_f32_16x16x32_bf16 v[64:67], v[112:115], a[80:83], v[64:67]
    ds_read_b128 v[120:123], v14 offset:1024
    v_mul_f32 v96, v96, v97
    v_mfma_f32_16x16x32_bf16 v[64:67], v[116:119], a[88:91], v[64:67]
    ds_read_b128 v[124:127], v14 offset:5120
    v_cvt_pk_bf16_f32 v194, v44, v45
    v_mfma_f32_16x16x32_bf16 v[68:71], v[116:119], a[92:95], v[68:71]
    ds_read_b128 v[128:131], v14 offset:9216
    v_mul_f32 v98, v98, v99
    v_mfma_f32_16x16x32_bf16 v[68:71], v[112:115], a[84:87], v[68:71]
    ds_read_b128 v[132:135], v14 offset:13312
    v_mul_f32 v100, v100, v101
    v_mfma_f32_16x16x32_bf16 v[68:71], v[108:111], a[76:79], v[68:71]
    buffer_store_dwordx4 v[192:195], v136, s[44:47], s30 offen offset:0 sc1
    s_add_u32 m0, s73, 148480
    v_permlane16_swap_b32 v88, v90
    v_mfma_f32_16x16x32_bf16 v[68:71], v[104:107], a[68:71], v[68:71]
    buffer_load_dwordx4 v22, s[44:47], s18 offen offset:0 sc1 lds
    s_waitcnt lgkmcnt(2)
    v_mfma_f32_16x16x32_bf16 v[60:63], v[120:123], a[100:103], v[60:63]
    s_add_u32 m0, s73, 148992
    v_permlane16_swap_b32 v89, v91
    v_permlane16_swap_b32 v92, v94
    v_mfma_f32_16x16x32_bf16 v[60:63], v[124:127], a[108:111], v[60:63]
    buffer_load_dwordx4 v22, s[44:47], s18 offen offset:512 sc1 lds
    s_waitcnt vmcnt(13)
    s_waitcnt lgkmcnt(0)
    v_mfma_f32_16x16x32_bf16 v[60:63], v[128:131], a[116:119], v[60:63]
    ds_read_b128 v[104:107], v14 offset:2048
    v_permlane16_swap_b32 v93, v95
    v_mfma_f32_16x16x32_bf16 v[60:63], v[132:135], a[124:127], v[60:63]
    ds_read_b128 v[108:111], v14 offset:6144
    v_cmp_ne_u32 vcc, s68, v189
    v_mfma_f32_16x16x32_bf16 v[56:59], v[132:135], a[120:123], v[56:59]
    ds_read_b128 v[112:115], v14 offset:10240
    v_and_b32 v145, 0xffff0000, v88
    v_mfma_f32_16x16x32_bf16 v[56:59], v[128:131], a[112:115], v[56:59]
    ds_read_b128 v[116:119], v14 offset:14336
    v_cvt_pk_bf16_f32 v196, v46, v47
    v_mfma_f32_16x16x32_bf16 v[56:59], v[124:127], a[104:107], v[56:59]
    s_add_u32 m0, s73, 150528
    s_cbranch_vccnz L_rs_p3
L_ok_p3:
    v_lshlrev_b32 v144, 16, v88
    v_mfma_f32_16x16x32_bf16 v[56:59], v[120:123], a[96:99], v[56:59]
    buffer_load_dwordx4 v22, s[44:47], s19 offen offset:0 sc1 lds
    s_waitcnt lgkmcnt(2)
    v_mfma_f32_16x16x32_bf16 v[64:67], v[104:107], a[96:99], v[64:67]
    s_add_u32 m0, s73, 81920
    v_cvt_pk_bf16_f32 v197, v48, v49
    v_and_b32 v147, 0xffff0000, v89
    v_mfma_f32_16x16x32_bf16 v[64:67], v[108:111], a[104:107], v[64:67]
    buffer_load_dwordx4 v184, s[44:47], s37 offen offset:0 sc1 lds
    s_waitcnt lgkmcnt(0)
    v_mfma_f32_16x16x32_bf16 v[64:67], v[112:115], a[112:115], v[64:67]
    ds_read_b128 v[120:123], v14 offset:3072
    buffer_load_dwordx4 v185, s[44:47], s37 offen offset:1024 sc1 lds
    v_mfma_f32_16x16x32_bf16 v[64:67], v[116:119], a[120:123], v[64:67]
    ds_read_b128 v[124:127], v14 offset:7168
    s_add_u32 m0, s73, 83968
    v_cvt_pk_bf16_f32 v198, v50, v51
    v_mfma_f32_16x16x32_bf16 v[68:71], v[116:119], a[124:127], v[68:71]
    ds_read_b128 v[128:131], v14 offset:11264
    buffer_load_dwordx4 v184, s[44:47], s16 offen offset:0 sc1 lds
    v_mfma_f32_16x16x32_bf16 v[68:71], v[112:115], a[116:119], v[68:71]
    ds_read_b128 v[132:135], v14 offset:15360
    buffer_load_dwordx4 v185, s[44:47], s16 offen offset:1024 sc1 lds
    v_mfma_f32_16x16x32_bf16 v[68:71], v[108:111], a[108:111], v[68:71]
    buffer_store_dwordx4 v[196:199], v136, s[44:47], s30 offen offset:1024 sc1
    v_lshlrev_b32 v146, 16, v89
    v_and_b32 v149, 0xffff0000, v92
    v_lshlrev_b32 v148, 16, v92
    v_mfma_f32_16x16x32_bf16 v[68:71], v[104:107], a[100:103], v[68:71]
    s_waitcnt lgkmcnt(2)
    v_mfma_f32_16x16x32_bf16 v[60:63], v[120:123], a[132:135], v[60:63]
    v_and_b32 v151, 0xffff0000, v93
    v_mfma_f32_16x16x32_bf16 v[60:63], v[124:127], a[140:143], v[60:63]
    v_lshlrev_b32 v150, 16, v93
    s_waitcnt lgkmcnt(0)
    v_mfma_f32_16x16x32_bf16 v[60:63], v[128:131], a[148:151], v[60:63]
    s_waitcnt vmcnt(16)
    s_barrier
    v_mfma_f32_16x16x32_bf16 v[60:63], v[132:135], a[156:159], v[60:63]
    ds_read_b128 v[104:107], v14 offset:16384
    v_and_b32 v153, 0xffff0000, v90
    v_mfma_f32_16x16x32_bf16 v[56:59], v[132:135], a[152:155], v[56:59]
    ds_read_b128 v[108:111], v14 offset:20480
    v_lshlrev_b32 v152, 16, v90
    v_mfma_f32_16x16x32_bf16 v[56:59], v[128:131], a[144:147], v[56:59]
    ds_read_b128 v[112:115], v14 offset:24576
    v_cvt_pk_bf16_f32 v200, v52, v53
    v_mfma_f32_16x16x32_bf16 v[56:59], v[124:127], a[136:139], v[56:59]
    ds_read_b128 v[116:119], v14 offset:28672
    v_and_b32 v155, 0xffff0000, v91
    v_mfma_f32_16x16x32_bf16 v[56:59], v[120:123], a[128:131], v[56:59]
    s_waitcnt lgkmcnt(2)
    v_mfma_f32_16x16x32_bf16 v[64:67], v[104:107], a[128:131], v[64:67]
    s_add_u32 m0, s73, 97792
    v_lshlrev_b32 v154, 16, v91
    v_mfma_f32_16x16x32_bf16 v[64:67], v[108:111], a[136:139], v[64:67]
    buffer_load_dwordx4 v22, s[44:47], s19 offen offset:512 sc1 lds
    s_waitcnt lgkmcnt(0)
    v_mfma_f32_16x16x32_bf16 v[64:67], v[112:115], a[144:147], v[64:67]
    ds_read_b128 v[120:123], v14 offset:17408
    v_cvt_pk_bf16_f32 v201, v54, v55
    v_mfma_f32_16x16x32_bf16 v[64:67], v[116:119], a[152:155], v[64:67]
    ds_read_b128 v[124:127], v14 offset:21504
    v_and_b32 v157, 0xffff0000, v94
    v_mfma_f32_16x16x32_bf16 v[68:71], v[116:119], a[156:159], v[68:71]
    ds_read_b128 v[128:131], v14 offset:25600
    v_lshlrev_b32 v156, 16, v94
    v_mfma_f32_16x16x32_bf16 v[68:71], v[112:115], a[148:151], v[68:71]
    buffer_store_dwordx4 v[200:203], v136, s[44:47], s30 offen offset:2048 sc1
    ds_read_b128 v[132:135], v14 offset:29696
    v_and_b32 v159, 0xffff0000, v95
    v_mfma_f32_16x16x32_bf16 v[68:71], v[108:111], a[140:143], v[68:71]
    s_add_u32 m0, s73, 99328
    v_lshlrev_b32 v158, 16, v95
    v_mfma_f32_16x16x32_bf16 v[68:71], v[104:107], a[132:135], v[68:71]
    buffer_load_dwordx4 v22, s[44:47], s20 offen offset:0 sc1 lds
    s_waitcnt lgkmcnt(2)
    v_mfma_f32_16x16x32_bf16 v[60:63], v[120:123], a[164:167], v[60:63]
    s_add_u32 m0, s73, 99840
    v_and_b32 v161, 0xffff0000, v142
    v_mfma_f32_16x16x32_bf16 v[60:63], v[124:127], a[172:175], v[60:63]
    buffer_load_dwordx4 v22, s[44:47], s20 offen offset:512 sc1 lds
    s_waitcnt lgkmcnt(0)
    v_mfma_f32_16x16x32_bf16 v[60:63], v[128:131], a[180:183], v[60:63]
    ds_read_b128 v[104:107], v14 offset:18432
    v_lshlrev_b32 v160, 16, v142
    v_mfma_f32_16x16x32_bf16 v[60:63], v[132:135], a[188:191], v[60:63]
    ds_read_b128 v[108:111], v14 offset:22528
    v_mfma_f32_16x16x32_bf16 v[56:59], v[132:135], a[184:187], v[56:59]
    ds_read_b128 v[112:115], v14 offset:26624
    v_and_b32 v163, 0xffff0000, v143
    v_mfma_f32_16x16x32_bf16 v[56:59], v[128:131], a[176:179], v[56:59]
    ds_read_b128 v[116:119], v14 offset:30720
    v_lshlrev_b32 v162, 16, v143
    v_mfma_f32_16x16x32_bf16 v[56:59], v[124:127], a[168:171], v[56:59]
    s_add_u32 m0, s73, 101376
    v_mfma_f32_16x16x32_bf16 v[56:59], v[120:123], a[160:163], v[56:59]
    buffer_load_dwordx4 v22, s[44:47], s21 offen offset:0 sc1 lds
    s_waitcnt lgkmcnt(2)
    v_mfma_f32_16x16x32_bf16 v[64:67], v[104:107], a[160:163], v[64:67]
    v_fma_f32 v164, v144, v97, -v96
    v_mfma_f32_16x16x32_bf16 v[64:67], v[108:111], a[168:171], v[64:67]
    v_fma_f32 v165, v145, v97, -v96
    s_waitcnt lgkmcnt(0)
    v_mfma_f32_16x16x32_bf16 v[64:67], v[112:115], a[176:179], v[64:67]
    ds_read_b128 v[120:123], v14 offset:19456
    v_fma_f32 v166, v146, v97, -v96
    v_mfma_f32_16x16x32_bf16 v[64:67], v[116:119], a[184:187], v[64:67]
    ds_read_b128 v[124:127], v14 offset:23552
    v_mfma_f32_16x16x32_bf16 v[68:71], v[116:119], a[188:191], v[68:71]
    ds_read_b128 v[128:131], v14 offset:27648
    v_fma_f32 v167, v147, v97, -v96
    v_mfma_f32_16x16x32_bf16 v[68:71], v[112:115], a[180:183], v[68:71]
    ds_read_b128 v[132:135], v14 offset:31744
    v_mfma_f32_16x16x32_bf16 v[68:71], v[108:111], a[172:175], v[68:71]
    v_fma_f32 v168, v148, v99, -v98
    v_mfma_f32_16x16x32_bf16 v[68:71], v[104:107], a[164:167], v[68:71]
    v_fma_f32 v169, v149, v99, -v98
    s_waitcnt lgkmcnt(2)
    v_mfma_f32_16x16x32_bf16 v[60:63], v[120:123], a[196:199], v[60:63]
    v_mfma_f32_16x16x32_bf16 v[60:63], v[124:127], a[204:207], v[60:63]
    v_fma_f32 v170, v150, v99, -v98
    s_waitcnt lgkmcnt(0)
    v_mfma_f32_16x16x32_bf16 v[60:63], v[128:131], a[212:215], v[60:63]
    s_waitcnt vmcnt(16)
    s_barrier
    v_mfma_f32_16x16x32_bf16 v[60:63], v[132:135], a[220:223], v[60:63]
    ds_read_b128 v[104:107], v14 offset:32768
    v_fma_f32 v171, v151, v99, -v98
    v_mfma_f32_16x16x32_bf16 v[56:59], v[132:135], a[216:219], v[56:59]
    ds_read_b128 v[108:111], v14 offset:36864
    v_fma_f32 v172, v152, v97, -v96
    v_mfma_f32_16x16x32_bf16 v[56:59], v[128:131], a[208:211], v[56:59]
    ds_read_b128 v[112:115], v14 offset:40960
    v_mfma_f32_16x16x32_bf16 v[56:59], v[124:127], a[200:203], v[56:59]
    ds_read_b128 v[116:119], v14 offset:45056
    v_fma_f32 v173, v153, v97, -v96
    v_mfma_f32_16x16x32_bf16 v[56:59], v[120:123], a[192:195], v[56:59]
    s_waitcnt lgkmcnt(2)
    v_mfma_f32_16x16x32_bf16 v[64:67], v[104:107], a[192:195], v[64:67]
    s_add_u32 m0, s73, 114176
    v_fma_f32 v174, v154, v97, -v96
    v_mfma_f32_16x16x32_bf16 v[64:67], v[108:111], a[200:203], v[64:67]
    buffer_load_dwordx4 v22, s[44:47], s21 offen offset:512 sc1 lds
    s_waitcnt lgkmcnt(0)
    v_mfma_f32_16x16x32_bf16 v[64:67], v[112:115], a[208:211], v[64:67]
    ds_read_b128 v[120:123], v14 offset:33792
    v_fma_f32 v175, v155, v97, -v96
    v_mfma_f32_16x16x32_bf16 v[64:67], v[116:119], a[216:219], v[64:67]
    ds_read_b128 v[124:127], v14 offset:37888
    v_fma_f32 v176, v156, v99, -v98
    v_mfma_f32_16x16x32_bf16 v[68:71], v[116:119], a[220:223], v[68:71]
    ds_read_b128 v[128:131], v14 offset:41984
    v_mfma_f32_16x16x32_bf16 v[68:71], v[112:115], a[212:215], v[68:71]
    ds_read_b128 v[132:135], v14 offset:46080
    v_fma_f32 v177, v157, v99, -v98
    v_mfma_f32_16x16x32_bf16 v[68:71], v[108:111], a[204:207], v[68:71]
    s_add_u32 m0, s73, 115712
    v_fma_f32 v178, v158, v99, -v98
    v_mfma_f32_16x16x32_bf16 v[68:71], v[104:107], a[196:199], v[68:71]
    buffer_load_dwordx4 v22, s[44:47], s22 offen offset:0 sc1 lds
    s_waitcnt lgkmcnt(2)
    v_mfma_f32_16x16x32_bf16 v[60:63], v[120:123], a[228:231], v[60:63]
    s_add_u32 m0, s73, 116224
    v_fma_f32 v179, v159, v99, -v98
    v_mfma_f32_16x16x32_bf16 v[60:63], v[124:127], a[236:239], v[60:63]
    buffer_load_dwordx4 v22, s[44:47], s22 offen offset:512 sc1 lds
    s_waitcnt lgkmcnt(0)
    v_mfma_f32_16x16x32_bf16 v[60:63], v[128:131], a[244:247], v[60:63]
    ds_read_b128 v[104:107], v14 offset:34816
    v_fma_f32 v180, v160, v101, -v100
    v_mfma_f32_16x16x32_bf16 v[60:63], v[132:135], a[252:255], v[60:63]
    ds_read_b128 v[108:111], v14 offset:38912
    v_fma_f32 v181, v161, v101, -v100
    v_mfma_f32_16x16x32_bf16 v[56:59], v[132:135], a[248:251], v[56:59]
    ds_read_b128 v[112:115], v14 offset:43008
    v_mfma_f32_16x16x32_bf16 v[56:59], v[128:131], a[240:243], v[56:59]
    ds_read_b128 v[116:119], v14 offset:47104
    v_fma_f32 v182, v162, v101, -v100
    v_mfma_f32_16x16x32_bf16 v[56:59], v[124:127], a[232:235], v[56:59]
    s_add_u32 m0, s73, 117760
    v_fma_f32 v183, v163, v101, -v100
    v_mfma_f32_16x16x32_bf16 v[56:59], v[120:123], a[224:227], v[56:59]
    buffer_load_dwordx4 v22, s[44:47], s23 offen offset:0 sc1 lds
    s_waitcnt lgkmcnt(2)
    v_mfma_f32_16x16x32_bf16 v[64:67], v[104:107], a[224:227], v[64:67]
    v_mfma_f32_16x16x32_bf16 v[64:67], v[108:111], a[232:235], v[64:67]
    s_waitcnt lgkmcnt(0)
    v_mfma_f32_16x16x32_bf16 v[64:67], v[112:115], a[240:243], v[64:67]
    ds_read_b128 v[120:123], v14 offset:35840
    v_mfma_f32_16x16x32_bf16 v[64:67], v[116:119], a[248:251], v[64:67]
    ds_read_b128 v[124:127], v14 offset:39936
    v_mfma_f32_16x16x32_bf16 v[68:71], v[116:119], a[252:255], v[68:71]
    ds_read_b128 v[128:131], v14 offset:44032
L_pl_D_1:
    s_cbranch_execz L_wret
    v_mfma_f32_16x16x32_bf16 v[68:71], v[112:115], a[244:247], v[68:71]
    ds_read_b128 v[132:135], v14 offset:48128
    v_mfma_f32_16x16x32_bf16 v[68:71], v[108:111], a[236:239], v[68:71]
    v_mfma_f32_16x16x32_bf16 v[68:71], v[104:107], a[228:231], v[68:71]
    s_waitcnt lgkmcnt(2)
    v_mfma_f32_16x16x32_bf16 v[60:63], v[120:123], v[224:227], v[60:63]
    v_mfma_f32_16x16x32_bf16 v[60:63], v[124:127], v[232:235], v[60:63]
    s_waitcnt lgkmcnt(0)
    v_mfma_f32_16x16x32_bf16 v[60:63], v[128:131], v[240:243], v[60:63]
    s_waitcnt vmcnt(10)
    s_barrier
    v_mfma_f32_16x16x32_bf16 v[60:63], v[132:135], v[248:251], v[60:63]
    ds_read_b128 v[104:107], v14 offset:49152
    v_mfma_f32_16x16x32_bf16 v[56:59], v[132:135], v[244:247], v[56:59]
    ds_read_b128 v[108:111], v14 offset:53248
    v_mfma_f32_16x16x32_bf16 v[56:59], v[128:131], v[236:239], v[56:59]
    ds_read_b128 v[112:115], v14 offset:57344
    v_mfma_f32_16x16x32_bf16 v[56:59], v[124:127], v[228:231], v[56:59]
    ds_read_b128 v[116:119], v14 offset:61440
    v_mfma_f32_16x16x32_bf16 v[56:59], v[120:123], v[220:223], v[56:59]
    s_waitcnt lgkmcnt(2)
    v_mfma_f32_16x16x32_bf16 v[64:67], v[104:107], v[220:223], v[64:67]
    s_add_u32 m0, s73, 130560
    v_xor_b32 v186, s41, v10
    v_add_u32 v186, s43, v186
    v_mfma_f32_16x16x32_bf16 v[64:67], v[108:111], v[228:231], v[64:67]
    buffer_load_dwordx4 v22, s[44:47], s23 offen offset:512 sc1 lds
    ds_read_b64_tr_b16 v[12:13], v10 offset:16384
    s_waitcnt lgkmcnt(1)
    v_mfma_f32_16x16x32_bf16 v[64:67], v[112:115], v[236:239], v[64:67]
    ds_read_b128 v[120:123], v14 offset:50176
    v_mfma_f32_16x16x32_bf16 v[64:67], v[116:119], v[244:247], v[64:67]
    ds_read_b128 v[124:127], v14 offset:54272
    v_mfma_f32_16x16x32_bf16 v[68:71], v[116:119], v[248:251], v[68:71]
    ds_read_b128 v[128:131], v14 offset:58368
    ds_read_b64_tr_b16 v[24:25], v11 offset:16384
    v_mfma_f32_16x16x32_bf16 v[68:71], v[112:115], v[240:243], v[68:71]
    ds_read_b128 v[132:135], v14 offset:62464
    ds_read_b64_tr_b16 v[28:29], v10 offset:20480
    v_mfma_f32_16x16x32_bf16 v[68:71], v[108:111], v[232:235], v[68:71]
    s_add_u32 m0, s73, 132096
    ds_read_b64_tr_b16 v[190:191], v11 offset:20480
    v_mfma_f32_16x16x32_bf16 v[68:71], v[104:107], v[224:227], v[68:71]
    buffer_load_dwordx4 v22, s[44:47], s24 offen offset:0 sc1 lds
    ds_read_b64_tr_b16 v[142:143], v186 offset:18432
    s_waitcnt lgkmcnt(6)
    v_mfma_f32_16x16x32_bf16 v[76:79], v[120:123], a[4:7], v[76:79]
    s_add_u32 m0, s73, 132608
    s_waitcnt lgkmcnt(0)
    v_mfma_f32_16x16x32_bf16 v[76:79], v[124:127], a[12:15], v[76:79]
    buffer_load_dwordx4 v22, s[44:47], s24 offen offset:512 sc1 lds
    v_mfma_f32_16x16x32_bf16 v[76:79], v[128:131], a[20:23], v[76:79]
    ds_read_b128 v[104:107], v14 offset:51200
    v_and_b32 v9, 0xffff0000, v12
    v_mfma_f32_16x16x32_bf16 v[76:79], v[132:135], a[28:31], v[76:79]
    ds_read_b128 v[108:111], v14 offset:55296
    v_mfma_f32_16x16x32_bf16 v[72:75], v[132:135], a[24:27], v[72:75]
    ds_read_b128 v[112:115], v14 offset:59392
    v_lshlrev_b32 v8, 16, v12
    v_mfma_f32_16x16x32_bf16 v[72:75], v[128:131], a[16:19], v[72:75]
    ds_read_b128 v[116:119], v14 offset:63488
    v_cvt_pk_bf16_f32 v192, v56, v57
    v_mfma_f32_16x16x32_bf16 v[72:75], v[124:127], a[8:11], v[72:75]
    s_add_u32 m0, s73, 134144
    v_mul_f32 v165, v165, v9
    v_mfma_f32_16x16x32_bf16 v[72:75], v[120:123], a[0:3], v[72:75]
    buffer_load_dwordx4 v22, s[44:47], s25 offen offset:0 sc1 lds
    s_waitcnt lgkmcnt(2)
    v_mfma_f32_16x16x32_bf16 v[80:83], v[104:107], a[0:3], v[80:83]
    v_cvt_pk_bf16_f32 v193, v58, v59
    v_mul_f32 v164, v164, v8
    v_mfma_f32_16x16x32_bf16 v[80:83], v[108:111], a[8:11], v[80:83]
    v_and_b32 v31, 0xffff0000, v13
    s_waitcnt lgkmcnt(0)
    v_mfma_f32_16x16x32_bf16 v[80:83], v[112:115], a[16:19], v[80:83]
    ds_read_b128 v[120:123], v14 offset:52224
    v_lshlrev_b32 v30, 16, v13
    v_mfma_f32_16x16x32_bf16 v[80:83], v[116:119], a[24:27], v[80:83]
    ds_read_b128 v[124:127], v14 offset:56320
    v_cvt_pk_bf16_f32 v194, v60, v61
    v_mfma_f32_16x16x32_bf16 v[84:87], v[116:119], a[28:31], v[84:87]
    ds_read_b128 v[128:131], v14 offset:60416
    v_mfma_f32_16x16x32_bf16 v[84:87], v[112:115], a[20:23], v[84:87]
    ds_read_b128 v[132:135], v14 offset:64512
    v_mul_f32 v167, v167, v31
    v_mfma_f32_16x16x32_bf16 v[84:87], v[108:111], a[12:15], v[84:87]
    buffer_store_dwordx4 v[192:195], v136, s[44:47], s15 offen offset:0 sc1
    v_mul_f32 v166, v166, v30
    v_mfma_f32_16x16x32_bf16 v[84:87], v[104:107], a[4:7], v[84:87]
    s_waitcnt lgkmcnt(2)
    v_mfma_f32_16x16x32_bf16 v[76:79], v[120:123], a[36:39], v[76:79]
    v_and_b32 v9, 0xffff0000, v24
    v_mfma_f32_16x16x32_bf16 v[76:79], v[124:127], a[44:47], v[76:79]
    v_cvt_pk_bf16_f32 v196, v62, v63
    s_waitcnt lgkmcnt(0)
    v_mfma_f32_16x16x32_bf16 v[76:79], v[128:131], a[52:55], v[76:79]
    s_waitcnt vmcnt(9)
    s_barrier
    v_lshlrev_b32 v8, 16, v24
    v_mfma_f32_16x16x32_bf16 v[76:79], v[132:135], a[60:63], v[76:79]
    ds_read_b128 v[104:107], v14 offset:0
    v_mul_f32 v169, v169, v9
    v_mfma_f32_16x16x32_bf16 v[72:75], v[132:135], a[56:59], v[72:75]
    ds_read_b128 v[108:111], v14 offset:4096
    v_cvt_pk_bf16_f32 v197, v64, v65
    v_mfma_f32_16x16x32_bf16 v[72:75], v[128:131], a[48:51], v[72:75]
    ds_read_b128 v[112:115], v14 offset:8192
    v_mul_f32 v168, v168, v8
    v_mfma_f32_16x16x32_bf16 v[72:75], v[124:127], a[40:43], v[72:75]
    ds_read_b128 v[116:119], v14 offset:12288
    v_mfma_f32_16x16x32_bf16 v[72:75], v[120:123], a[32:35], v[72:75]
    v_cvt_pk_bf16_f32 v198, v66, v67
    s_waitcnt lgkmcnt(2)
    v_mfma_f32_16x16x32_bf16 v[80:83], v[104:107], a[32:35], v[80:83]
    s_add_u32 m0, s73, 146944
    v_and_b32 v31, 0xffff0000, v25
    v_lshlrev_b32 v30, 16, v25
    v_mfma_f32_16x16x32_bf16 v[80:83], v[108:111], a[40:43], v[80:83]
    buffer_load_dwordx4 v22, s[44:47], s25 offen offset:512 sc1 lds
    s_waitcnt lgkmcnt(0)
    v_mfma_f32_16x16x32_bf16 v[80:83], v[112:115], a[48:51], v[80:83]
    buffer_store_dwordx4 v[196:199], v136, s[44:47], s15 offen offset:1024 sc1
    ds_read_b128 v[120:123], v14 offset:1024
    v_mfma_f32_16x16x32_bf16 v[80:83], v[116:119], a[56:59], v[80:83]
    ds_read_b128 v[124:127], v14 offset:5120
    v_mul_f32 v171, v171, v31
    v_mfma_f32_16x16x32_bf16 v[84:87], v[116:119], a[60:63], v[84:87]
    ds_read_b128 v[128:131], v14 offset:9216
    v_mul_f32 v170, v170, v30
    v_mfma_f32_16x16x32_bf16 v[84:87], v[112:115], a[52:55], v[84:87]
    ds_read_b128 v[132:135], v14 offset:13312
    v_mfma_f32_16x16x32_bf16 v[84:87], v[108:111], a[44:47], v[84:87]
    s_add_u32 m0, s73, 148480
    v_cvt_pk_bf16_f32 v200, v68, v69
    v_and_b32 v9, 0xffff0000, v28
    v_mfma_f32_16x16x32_bf16 v[84:87], v[104:107], a[36:39], v[84:87]
    buffer_load_dwordx4 v22, s[44:47], s26 offen offset:0 sc1 lds
    s_waitcnt lgkmcnt(2)
    v_mfma_f32_16x16x32_bf16 v[76:79], v[120:123], a[68:71], v[76:79]
    s_add_u32 m0, s73, 148992
    v_lshlrev_b32 v8, 16, v28
    v_mfma_f32_16x16x32_bf16 v[76:79], v[124:127], a[76:79], v[76:79]
    buffer_load_dwordx4 v22, s[44:47], s26 offen offset:512 sc1 lds
    s_waitcnt lgkmcnt(0)
    v_mfma_f32_16x16x32_bf16 v[76:79], v[128:131], a[84:87], v[76:79]
    ds_read_b128 v[104:107], v14 offset:2048
    v_cvt_pk_bf16_f32 v201, v70, v71
    v_mfma_f32_16x16x32_bf16 v[76:79], v[132:135], a[92:95], v[76:79]
    ds_read_b128 v[108:111], v14 offset:6144
    v_mul_f32 v173, v173, v9
    v_mfma_f32_16x16x32_bf16 v[72:75], v[132:135], a[88:91], v[72:75]
    ds_read_b128 v[112:115], v14 offset:10240
    v_mul_f32 v172, v172, v8
    v_mfma_f32_16x16x32_bf16 v[72:75], v[128:131], a[80:83], v[72:75]
    ds_read_b128 v[116:119], v14 offset:14336
    v_and_b32 v31, 0xffff0000, v29
    v_mfma_f32_16x16x32_bf16 v[72:75], v[124:127], a[72:75], v[72:75]
    buffer_store_dwordx4 v[200:203], v136, s[44:47], s15 offen offset:2048 sc1
    s_add_u32 m0, s73, 150528
    v_mfma_f32_16x16x32_bf16 v[72:75], v[120:123], a[64:67], v[72:75]
    buffer_load_dwordx4 v19, s[44:47], s18 offen offset:0 sc1 lds
    s_waitcnt lgkmcnt(2)
    v_mfma_f32_16x16x32_bf16 v[80:83], v[104:107], a[64:67], v[80:83]
    v_lshlrev_b32 v30, 16, v29
    v_mul_f32 v175, v175, v31
    v_mfma_f32_16x16x32_bf16 v[80:83], v[108:111], a[72:75], v[80:83]
    buffer_load_dwordx4 v[40:43], v136, s[44:47], s34 offen offset:0 sc1
    s_waitcnt lgkmcnt(0)
    v_mfma_f32_16x16x32_bf16 v[80:83], v[112:115], a[80:83], v[80:83]
    ds_read_b128 v[120:123], v14 offset:3072
    v_mfma_f32_16x16x32_bf16 v[80:83], v[116:119], a[88:91], v[80:83]
    ds_read_b128 v[124:127], v14 offset:7168
    v_mul_f32 v174, v174, v30
    v_mfma_f32_16x16x32_bf16 v[84:87], v[116:119], a[92:95], v[84:87]
    ds_read_b128 v[128:131], v14 offset:11264
    v_and_b32 v9, 0xffff0000, v190
    v_mfma_f32_16x16x32_bf16 v[84:87], v[112:115], a[84:87], v[84:87]
    ds_read_b128 v[132:135], v14 offset:15360
    buffer_load_dwordx4 v[44:47], v136, s[44:47], s34 offen offset:1024 sc1
    v_mfma_f32_16x16x32_bf16 v[84:87], v[108:111], a[76:79], v[84:87]
    v_lshlrev_b32 v8, 16, v190
    v_mfma_f32_16x16x32_bf16 v[84:87], v[104:107], a[68:71], v[84:87]
    s_waitcnt lgkmcnt(2)
    v_mfma_f32_16x16x32_bf16 v[76:79], v[120:123], a[100:103], v[76:79]
    buffer_load_dwordx4 v[48:51], v136, s[44:47], s34 offen offset:2048 sc1
    v_mul_f32 v177, v177, v9
    v_mfma_f32_16x16x32_bf16 v[76:79], v[124:127], a[108:111], v[76:79]
    s_waitcnt lgkmcnt(0)
    v_mfma_f32_16x16x32_bf16 v[76:79], v[128:131], a[116:119], v[76:79]
    s_waitcnt vmcnt(14)
    s_barrier
    v_mul_f32 v176, v176, v8
    v_mfma_f32_16x16x32_bf16 v[76:79], v[132:135], a[124:127], v[76:79]
    ds_read_b128 v[104:107], v14 offset:16384
    v_and_b32 v31, 0xffff0000, v191
    v_mfma_f32_16x16x32_bf16 v[72:75], v[132:135], a[120:123], v[72:75]
    ds_read_b128 v[108:111], v14 offset:20480
    buffer_load_dwordx4 v[204:207], v136, s[44:47], s35 offen offset:0 sc1
    v_mfma_f32_16x16x32_bf16 v[72:75], v[128:131], a[112:115], v[72:75]
    ds_read_b128 v[112:115], v14 offset:24576
    v_lshlrev_b32 v30, 16, v191
    v_mfma_f32_16x16x32_bf16 v[72:75], v[124:127], a[104:107], v[72:75]
    ds_read_b128 v[116:119], v14 offset:28672
    v_mul_f32 v179, v179, v31
    v_mfma_f32_16x16x32_bf16 v[72:75], v[120:123], a[96:99], v[72:75]
    buffer_load_dwordx4 v[208:211], v136, s[44:47], s35 offen offset:1024 sc1
    s_waitcnt lgkmcnt(2)
    v_mfma_f32_16x16x32_bf16 v[80:83], v[104:107], a[96:99], v[80:83]
    v_mfma_f32_16x16x32_bf16 v[80:83], v[108:111], a[104:107], v[80:83]
    v_mul_f32 v178, v178, v30
    s_waitcnt lgkmcnt(0)
    v_mfma_f32_16x16x32_bf16 v[80:83], v[112:115], a[112:115], v[80:83]
    ds_read_b128 v[120:123], v14 offset:17408
    buffer_load_dwordx4 v[212:215], v136, s[44:47], s35 offen offset:2048 sc1
    v_mfma_f32_16x16x32_bf16 v[80:83], v[116:119], a[120:123], v[80:83]
    ds_read_b128 v[124:127], v14 offset:21504
    v_and_b32 v9, 0xffff0000, v142
    v_mfma_f32_16x16x32_bf16 v[84:87], v[116:119], a[124:127], v[84:87]
    ds_read_b128 v[128:131], v14 offset:25600
    v_lshlrev_b32 v8, 16, v142
    v_mfma_f32_16x16x32_bf16 v[84:87], v[112:115], a[116:119], v[84:87]
    ds_read_b128 v[132:135], v14 offset:29696
    v_mfma_f32_16x16x32_bf16 v[84:87], v[108:111], a[108:111], v[84:87]
    buffer_load_dwordx4 v[216:219], v136, s[44:47], s35 offen offset:3072 sc1
    v_mul_f32 v181, v181, v9
    v_mfma_f32_16x16x32_bf16 v[84:87], v[104:107], a[100:103], v[84:87]
    s_waitcnt lgkmcnt(2)
    v_mfma_f32_16x16x32_bf16 v[76:79], v[120:123], a[132:135], v[76:79]
    v_mul_f32 v180, v180, v8
    v_mfma_f32_16x16x32_bf16 v[76:79], v[124:127], a[140:143], v[76:79]
    v_and_b32 v31, 0xffff0000, v143
    s_waitcnt lgkmcnt(0)
    v_mfma_f32_16x16x32_bf16 v[76:79], v[128:131], a[148:151], v[76:79]
    ds_read_b128 v[104:107], v14 offset:18432
    v_mfma_f32_16x16x32_bf16 v[76:79], v[132:135], a[156:159], v[76:79]
    ds_read_b128 v[108:111], v14 offset:22528
    v_lshlrev_b32 v30, 16, v143
    v_mfma_f32_16x16x32_bf16 v[72:75], v[132:135], a[152:155], v[72:75]
    ds_read_b128 v[112:115], v14 offset:26624
    v_mfma_f32_16x16x32_bf16 v[72:75], v[128:131], a[144:147], v[72:75]
    ds_read_b128 v[116:119], v14 offset:30720
    v_mul_f32 v183, v183, v31
    v_mfma_f32_16x16x32_bf16 v[72:75], v[124:127], a[136:139], v[72:75]
    v_mfma_f32_16x16x32_bf16 v[72:75], v[120:123], a[128:131], v[72:75]
    v_mul_f32 v182, v182, v30
    s_waitcnt lgkmcnt(2)
    v_mfma_f32_16x16x32_bf16 v[80:83], v[104:107], a[128:131], v[80:83]
    v_mfma_f32_16x16x32_bf16 v[80:83], v[108:111], a[136:139], v[80:83]
    s_waitcnt lgkmcnt(0)
    v_mfma_f32_16x16x32_bf16 v[80:83], v[112:115], a[144:147], v[80:83]
    ds_read_b128 v[120:123], v14 offset:19456
    v_mfma_f32_16x16x32_bf16 v[80:83], v[116:119], a[152:155], v[80:83]
    ds_read_b128 v[124:127], v14 offset:23552
    v_mfma_f32_16x16x32_bf16 v[84:87], v[116:119], a[156:159], v[84:87]
    ds_read_b128 v[128:131], v14 offset:27648
    v_mfma_f32_16x16x32_bf16 v[84:87], v[112:115], a[148:151], v[84:87]
    ds_read_b128 v[132:135], v14 offset:31744
    v_mfma_f32_16x16x32_bf16 v[84:87], v[108:111], a[140:143], v[84:87]
    v_mfma_f32_16x16x32_bf16 v[84:87], v[104:107], a[132:135], v[84:87]
    s_waitcnt lgkmcnt(2)
    v_mfma_f32_16x16x32_bf16 v[76:79], v[120:123], a[164:167], v[76:79]
    s_add_u32 m0, s73, 97792
    v_mfma_f32_16x16x32_bf16 v[76:79], v[124:127], a[172:175], v[76:79]
    buffer_load_dwordx4 v19, s[44:47], s18 offen offset:512 sc1 lds
    s_waitcnt lgkmcnt(0)
    v_mfma_f32_16x16x32_bf16 v[76:79], v[128:131], a[180:183], v[76:79]
    s_waitcnt vmcnt(15)
    s_barrier
    v_mfma_f32_16x16x32_bf16 v[76:79], v[132:135], a[188:191], v[76:79]
    ds_read_b128 v[104:107], v14 offset:32768
    v_mfma_f32_16x16x32_bf16 v[72:75], v[132:135], a[184:187], v[72:75]
    ds_read_b128 v[108:111], v14 offset:36864
    v_mfma_f32_16x16x32_bf16 v[72:75], v[128:131], a[176:179], v[72:75]
    ds_read_b128 v[112:115], v14 offset:40960
    v_mfma_f32_16x16x32_bf16 v[72:75], v[124:127], a[168:171], v[72:75]
    ds_read_b128 v[116:119], v14 offset:45056
    s_add_u32 m0, s73, 99328
    v_mfma_f32_16x16x32_bf16 v[72:75], v[120:123], a[160:163], v[72:75]
    buffer_load_dwordx4 v19, s[44:47], s19 offen offset:0 sc1 lds
    s_waitcnt lgkmcnt(2)
    v_mfma_f32_16x16x32_bf16 v[80:83], v[104:107], a[160:163], v[80:83]
    s_add_u32 m0, s73, 99840
    v_mfma_f32_16x16x32_bf16 v[80:83], v[108:111], a[168:171], v[80:83]
    buffer_load_dwordx4 v19, s[44:47], s19 offen offset:512 sc1 lds
    s_waitcnt lgkmcnt(0)
    v_mfma_f32_16x16x32_bf16 v[80:83], v[112:115], a[176:179], v[80:83]
    ds_read_b128 v[120:123], v14 offset:33792
    v_mfma_f32_16x16x32_bf16 v[80:83], v[116:119], a[184:187], v[80:83]
    ds_read_b128 v[124:127], v14 offset:37888
    v_mfma_f32_16x16x32_bf16 v[84:87], v[116:119], a[188:191], v[84:87]
    ds_read_b128 v[128:131], v14 offset:41984
    v_mfma_f32_16x16x32_bf16 v[84:87], v[112:115], a[180:183], v[84:87]
    ds_read_b128 v[132:135], v14 offset:46080
    v_mfma_f32_16x16x32_bf16 v[84:87], v[108:111], a[172:175], v[84:87]
    s_add_u32 m0, s73, 101376
    v_mfma_f32_16x16x32_bf16 v[84:87], v[104:107], a[164:167], v[84:87]
    buffer_load_dwordx4 v19, s[44:47], s20 offen offset:0 sc1 lds
    s_waitcnt lgkmcnt(2)
    v_mfma_f32_16x16x32_bf16 v[76:79], v[120:123], a[196:199], v[76:79]
    s_add_u32 m0, s73, 114176
    v_mov_b32 v141, 0
    v_mfma_f32_16x16x32_bf16 v[76:79], v[124:127], a[204:207], v[76:79]
    buffer_load_dwordx4 v19, s[44:47], s20 offen offset:512 sc1 lds
    s_waitcnt lgkmcnt(0)
    v_mfma_f32_16x16x32_bf16 v[76:79], v[128:131], a[212:215], v[76:79]
    ds_read_b128 v[104:107], v14 offset:34816
    v_mfma_f32_16x16x32_bf16 v[76:79], v[132:135], a[220:223], v[76:79]
    ds_read_b128 v[108:111], v14 offset:38912
    buffer_atomic_add v141, v139, s[44:47], s11 offen offset:2060 sc0 sc1
    v_mfma_f32_16x16x32_bf16 v[72:75], v[132:135], a[216:219], v[72:75]
    ds_read_b128 v[112:115], v14 offset:43008
    v_mfma_f32_16x16x32_bf16 v[72:75], v[128:131], a[208:211], v[72:75]
    ds_read_b128 v[116:119], v14 offset:47104
    v_mfma_f32_16x16x32_bf16 v[72:75], v[124:127], a[200:203], v[72:75]
    s_add_u32 m0, s73, 115712
    v_mfma_f32_16x16x32_bf16 v[72:75], v[120:123], a[192:195], v[72:75]
    buffer_load_dwordx4 v19, s[44:47], s21 offen offset:0 sc1 lds
    s_waitcnt lgkmcnt(2)
    v_mfma_f32_16x16x32_bf16 v[80:83], v[104:107], a[192:195], v[80:83]
    s_add_u32 m0, s73, 116224
    v_mfma_f32_16x16x32_bf16 v[80:83], v[108:111], a[200:203], v[80:83]
    buffer_load_dwordx4 v19, s[44:47], s21 offen offset:512 sc1 lds
    s_waitcnt lgkmcnt(0)
    v_mfma_f32_16x16x32_bf16 v[80:83], v[112:115], a[208:211], v[80:83]
    ds_read_b128 v[120:123], v14 offset:35840
    v_mfma_f32_16x16x32_bf16 v[80:83], v[116:119], a[216:219], v[80:83]
    ds_read_b128 v[124:127], v14 offset:39936
    v_mfma_f32_16x16x32_bf16 v[84:87], v[116:119], a[220:223], v[84:87]
    ds_read_b128 v[128:131], v14 offset:44032
    v_mfma_f32_16x16x32_bf16 v[84:87], v[112:115], a[212:215], v[84:87]
    ds_read_b128 v[132:135], v14 offset:48128
    v_mfma_f32_16x16x32_bf16 v[84:87], v[108:111], a[204:207], v[84:87]
    s_add_u32 m0, s73, 117760
    v_mfma_f32_16x16x32_bf16 v[84:87], v[104:107], a[196:199], v[84:87]
    buffer_load_dwordx4 v19, s[44:47], s22 offen offset:0 sc1 lds
    s_waitcnt lgkmcnt(2)
    v_mfma_f32_16x16x32_bf16 v[76:79], v[120:123], a[228:231], v[76:79]
    v_mfma_f32_16x16x32_bf16 v[76:79], v[124:127], a[236:239], v[76:79]
    s_waitcnt lgkmcnt(0)
    v_mfma_f32_16x16x32_bf16 v[76:79], v[128:131], a[244:247], v[76:79]
    s_waitcnt vmcnt(16)
    s_barrier
    v_mfma_f32_16x16x32_bf16 v[76:79], v[132:135], a[252:255], v[76:79]
    ds_read_b128 v[104:107], v14 offset:49152
    v_mfma_f32_16x16x32_bf16 v[72:75], v[132:135], a[248:251], v[72:75]
    ds_read_b128 v[108:111], v14 offset:53248
    v_mfma_f32_16x16x32_bf16 v[72:75], v[128:131], a[240:243], v[72:75]
    ds_read_b128 v[112:115], v14 offset:57344
    v_mfma_f32_16x16x32_bf16 v[72:75], v[124:127], a[232:235], v[72:75]
    ds_read_b128 v[116:119], v14 offset:61440
    v_mfma_f32_16x16x32_bf16 v[72:75], v[120:123], a[224:227], v[72:75]
    s_waitcnt lgkmcnt(2)
    v_mfma_f32_16x16x32_bf16 v[80:83], v[104:107], a[224:227], v[80:83]
    s_add_u32 m0, s73, 130560
    v_mfma_f32_16x16x32_bf16 v[80:83], v[108:111], a[232:235], v[80:83]
    buffer_load_dwordx4 v19, s[44:47], s22 offen offset:512 sc1 lds
    s_waitcnt lgkmcnt(0)
    v_mfma_f32_16x16x32_bf16 v[80:83], v[112:115], a[240:243], v[80:83]
    ds_read_b128 v[120:123], v14 offset:50176
    v_mfma_f32_16x16x32_bf16 v[80:83], v[116:119], a[248:251], v[80:83]
    ds_read_b128 v[124:127], v14 offset:54272
    v_mfma_f32_16x16x32_bf16 v[84:87], v[116:119], a[252:255], v[84:87]
    ds_read_b128 v[128:131], v14 offset:58368
    v_mfma_f32_16x16x32_bf16 v[84:87], v[112:115], a[244:247], v[84:87]
    ds_read_b128 v[132:135], v14 offset:62464
    v_mfma_f32_16x16x32_bf16 v[84:87], v[108:111], a[236:239], v[84:87]
    s_add_u32 m0, s73, 132096
    v_mfma_f32_16x16x32_bf16 v[84:87], v[104:107], a[228:231], v[84:87]
    buffer_load_dwordx4 v19, s[44:47], s23 offen offset:0 sc1 lds
    s_waitcnt lgkmcnt(2)
    v_mfma_f32_16x16x32_bf16 v[76:79], v[120:123], v[224:227], v[76:79]
    s_add_u32 m0, s73, 132608
    s_waitcnt vmcnt(15)
    v_bitop3_b32 v43, v43, v47, s68 bitop3:0x7e
    v_bitop3_b32 v43, v43, v51, s68 bitop3:0xf6
    v_cmp_ne_u32 vcc, 0, v43
    v_mfma_f32_16x16x32_bf16 v[76:79], v[124:127], v[232:235], v[76:79]
    buffer_load_dwordx4 v19, s[44:47], s23 offen offset:512 sc1 lds
    s_waitcnt lgkmcnt(0)
    v_mfma_f32_16x16x32_bf16 v[76:79], v[128:131], v[240:243], v[76:79]
    ds_read_b128 v[104:107], v14 offset:51200
    s_cbranch_vccnz L_xs_a
L_xo_a:
    v_and_b32 v89, 0xffff0000, v40
    v_mfma_f32_16x16x32_bf16 v[76:79], v[132:135], v[248:251], v[76:79]
    ds_read_b128 v[108:111], v14 offset:55296
    v_lshlrev_b32 v88, 16, v40
    v_mfma_f32_16x16x32_bf16 v[72:75], v[132:135], v[244:247], v[72:75]
    ds_read_b128 v[112:115], v14 offset:59392
    v_and_b32 v91, 0xffff0000, v41
    v_mfma_f32_16x16x32_bf16 v[72:75], v[128:131], v[236:239], v[72:75]
    ds_read_b128 v[116:119], v14 offset:63488
    v_lshlrev_b32 v90, 16, v41
    v_mfma_f32_16x16x32_bf16 v[72:75], v[124:127], v[228:231], v[72:75]
    s_add_u32 m0, s73, 134144
    v_and_b32 v93, 0xffff0000, v42
    v_lshlrev_b32 v92, 16, v42
    v_mfma_f32_16x16x32_bf16 v[72:75], v[120:123], v[220:223], v[72:75]
    buffer_load_dwordx4 v19, s[44:47], s24 offen offset:0 sc1 lds
    s_waitcnt lgkmcnt(2)
    v_mfma_f32_16x16x32_bf16 v[80:83], v[104:107], v[220:223], v[80:83]
    v_and_b32 v95, 0xffff0000, v44
    v_lshlrev_b32 v94, 16, v44
    v_mfma_f32_16x16x32_bf16 v[80:83], v[108:111], v[228:231], v[80:83]
    v_and_b32 v97, 0xffff0000, v45
    s_waitcnt lgkmcnt(0)
    v_mfma_f32_16x16x32_bf16 v[80:83], v[112:115], v[236:239], v[80:83]
    ds_read_b128 v[120:123], v14 offset:52224
    v_lshlrev_b32 v96, 16, v45
    v_mfma_f32_16x16x32_bf16 v[80:83], v[116:119], v[244:247], v[80:83]
    ds_read_b128 v[124:127], v14 offset:56320
    v_and_b32 v99, 0xffff0000, v46
    v_lshlrev_b32 v98, 16, v46
    v_mfma_f32_16x16x32_bf16 v[84:87], v[116:119], v[248:251], v[84:87]
    ds_read_b128 v[128:131], v14 offset:60416
    s_waitcnt vmcnt(7)
    v_and_b32 v101, 0xffff0000, v48
    v_mfma_f32_16x16x32_bf16 v[84:87], v[112:115], v[240:243], v[84:87]
    ds_read_b128 v[132:135], v14 offset:64512
    v_lshlrev_b32 v100, 16, v48
    v_cmp_ne_u32 vcc, v140, v141
    v_mfma_f32_16x16x32_bf16 v[84:87], v[108:111], v[232:235], v[84:87]
    v_and_b32 v103, 0xffff0000, v49
    v_lshlrev_b32 v102, 16, v49
    v_mfma_f32_16x16x32_bf16 v[84:87], v[104:107], v[224:227], v[84:87]
    s_cbranch_vccnz L_as_b
L_ao_b:
    s_waitcnt lgkmcnt(2)
    v_mfma_f32_16x16x32_bf16 v[92:95], v[120:123], a[4:7], v[92:95]
    buffer_load_dwordx4 v[56:59], v136, s[44:47], s11 offen offset:0 sc1
    v_mfma_f32_16x16x32_bf16 v[92:95], v[124:127], a[12:15], v[92:95]
    s_waitcnt lgkmcnt(0)
    v_mfma_f32_16x16x32_bf16 v[92:95], v[128:131], a[20:23], v[92:95]
    buffer_load_dwordx4 v[60:63], v136, s[44:47], s11 offen offset:1024 sc1
    s_barrier
    v_mfma_f32_16x16x32_bf16 v[92:95], v[132:135], a[28:31], v[92:95]
    ds_read_b128 v[104:107], v14 offset:0
    buffer_load_dwordx4 v[64:67], v136, s[44:47], s11 offen offset:2048 sc1
    v_mfma_f32_16x16x32_bf16 v[88:91], v[132:135], a[24:27], v[88:91]
    ds_read_b128 v[108:111], v14 offset:4096
    v_cvt_pk_bf16_f32 v192, v72, v73
    v_mfma_f32_16x16x32_bf16 v[88:91], v[128:131], a[16:19], v[88:91]
    ds_read_b128 v[112:115], v14 offset:8192
    v_cvt_pk_bf16_f32 v193, v74, v75
    v_mfma_f32_16x16x32_bf16 v[88:91], v[124:127], a[8:11], v[88:91]
    ds_read_b128 v[116:119], v14 offset:12288
    v_cvt_pk_bf16_f32 v194, v76, v77
    v_mfma_f32_16x16x32_bf16 v[88:91], v[120:123], a[0:3], v[88:91]
    buffer_store_dwordx4 v[192:195], v136, s[44:47], s31 offen offset:0 sc1
    s_waitcnt lgkmcnt(2)
    v_mfma_f32_16x16x32_bf16 v[96:99], v[104:107], a[0:3], v[96:99]
    s_add_u32 m0, s73, 146944
    v_cvt_pk_bf16_f32 v196, v78, v79
    v_cvt_pk_bf16_f32 v197, v80, v81
    v_mfma_f32_16x16x32_bf16 v[96:99], v[108:111], a[8:11], v[96:99]
    buffer_load_dwordx4 v19, s[44:47], s24 offen offset:512 sc1 lds
    s_waitcnt lgkmcnt(0)
    v_mfma_f32_16x16x32_bf16 v[96:99], v[112:115], a[16:19], v[96:99]
    ds_read_b128 v[120:123], v14 offset:1024
    v_cvt_pk_bf16_f32 v198, v82, v83
    v_mfma_f32_16x16x32_bf16 v[96:99], v[116:119], a[24:27], v[96:99]
    buffer_store_dwordx4 v[196:199], v136, s[44:47], s31 offen offset:1024 sc1
    ds_read_b128 v[124:127], v14 offset:5120
    v_bitop3_b32 v207, v207, v211, s36 bitop3:0x7e
    v_bitop3_b32 v207, v207, v215, s36 bitop3:0xf6
    v_mfma_f32_16x16x32_bf16 v[100:103], v[116:119], a[28:31], v[100:103]
    ds_read_b128 v[128:131], v14 offset:9216
    v_cvt_pk_bf16_f32 v200, v84, v85
    v_mfma_f32_16x16x32_bf16 v[100:103], v[112:115], a[20:23], v[100:103]
    ds_read_b128 v[132:135], v14 offset:13312
    v_cvt_pk_bf16_f32 v201, v86, v87
    v_mfma_f32_16x16x32_bf16 v[100:103], v[108:111], a[12:15], v[100:103]
    buffer_store_dwordx4 v[200:203], v136, s[44:47], s31 offen offset:2048 sc1
    s_add_u32 m0, s73, 148480
    v_bitop3_b32 v207, v207, v219, s36 bitop3:0xf6
    v_cmp_ne_u32 vcc, 0, v207
    v_mfma_f32_16x16x32_bf16 v[100:103], v[104:107], a[4:7], v[100:103]
    buffer_load_dwordx4 v19, s[44:47], s25 offen offset:0 sc1 lds
    s_waitcnt lgkmcnt(2)
    v_mfma_f32_16x16x32_bf16 v[92:95], v[120:123], a[36:39], v[92:95]
    s_add_u32 m0, s73, 148992
    s_cbranch_vccnz L_xs_8
L_xo_8:
    v_mfma_f32_16x16x32_bf16 v[92:95], v[124:127], a[44:47], v[92:95]
    buffer_load_dwordx4 v19, s[44:47], s25 offen offset:512 sc1 lds
    s_waitcnt lgkmcnt(0)
    v_mfma_f32_16x16x32_bf16 v[92:95], v[128:131], a[52:55], v[92:95]
    ds_read_b128 v[104:107], v14 offset:2048
    v_and_b32 v33, 0xffff0000, v204
    v_mfma_f32_16x16x32_bf16 v[92:95], v[132:135], a[60:63], v[92:95]
    ds_read_b128 v[108:111], v14 offset:6144
    v_lshlrev_b32 v32, 16, v204
    v_mfma_f32_16x16x32_bf16 v[88:91], v[132:135], a[56:59], v[88:91]
    ds_read_b128 v[112:115], v14 offset:10240
    v_and_b32 v35, 0xffff0000, v205
    v_mfma_f32_16x16x32_bf16 v[88:91], v[128:131], a[48:51], v[88:91]
    ds_read_b128 v[116:119], v14 offset:14336
    v_mfma_f32_16x16x32_bf16 v[88:91], v[124:127], a[40:43], v[88:91]
    s_add_u32 m0, s73, 150528
    v_lshlrev_b32 v34, 16, v205
    v_mfma_f32_16x16x32_bf16 v[88:91], v[120:123], a[32:35], v[88:91]
    buffer_load_dwordx4 v19, s[44:47], s26 offen offset:0 sc1 lds
    s_waitcnt lgkmcnt(2)
    v_mfma_f32_16x16x32_bf16 v[96:99], v[104:107], a[32:35], v[96:99]
    v_add_f32 v32, v32, v27
    v_mfma_f32_16x16x32_bf16 v[96:99], v[108:111], a[40:43], v[96:99]
    v_add_f32 v33, v33, v27
    s_waitcnt lgkmcnt(0)
    v_mfma_f32_16x16x32_bf16 v[96:99], v[112:115], a[48:51], v[96:99]
    ds_read_b128 v[120:123], v14 offset:3072
    v_add_f32 v34, v34, v27
    v_mfma_f32_16x16x32_bf16 v[96:99], v[116:119], a[56:59], v[96:99]
    ds_read_b128 v[124:127], v14 offset:7168
    v_mfma_f32_16x16x32_bf16 v[100:103], v[116:119], a[60:63], v[100:103]
    ds_read_b128 v[128:131], v14 offset:11264
    v_add_f32 v35, v35, v27
    v_mfma_f32_16x16x32_bf16 v[100:103], v[112:115], a[52:55], v[100:103]
    ds_read_b128 v[132:135], v14 offset:15360
    v_and_b32 v37, 0xffff0000, v208
    v_mfma_f32_16x16x32_bf16 v[100:103], v[108:111], a[44:47], v[100:103]
    v_mfma_f32_16x16x32_bf16 v[100:103], v[104:107], a[36:39], v[100:103]
    v_lshlrev_b32 v36, 16, v208
    s_waitcnt lgkmcnt(2)
    v_mfma_f32_16x16x32_bf16 v[92:95], v[120:123], a[68:71], v[92:95]
    v_and_b32 v39, 0xffff0000, v209
    v_mfma_f32_16x16x32_bf16 v[92:95], v[124:127], a[76:79], v[92:95]
    s_waitcnt lgkmcnt(0)
    v_mfma_f32_16x16x32_bf16 v[92:95], v[128:131], a[84:87], v[92:95]
    s_waitcnt vmcnt(14)
    s_barrier
    v_lshlrev_b32 v38, 16, v209
    v_mfma_f32_16x16x32_bf16 v[92:95], v[132:135], a[92:95], v[92:95]
    ds_read_b128 v[104:107], v14 offset:16384
    v_add_f32 v32, v32, v36
    v_mfma_f32_16x16x32_bf16 v[88:91], v[132:135], a[88:91], v[88:91]
    ds_read_b128 v[108:111], v14 offset:20480
    v_mfma_f32_16x16x32_bf16 v[88:91], v[128:131], a[80:83], v[88:91]
    ds_read_b128 v[112:115], v14 offset:24576
    v_add_f32 v33, v33, v37
    v_mfma_f32_16x16x32_bf16 v[88:91], v[124:127], a[72:75], v[88:91]
    ds_read_b128 v[116:119], v14 offset:28672
    v_add_f32 v34, v34, v38
    v_mfma_f32_16x16x32_bf16 v[88:91], v[120:123], a[64:67], v[88:91]
    s_waitcnt lgkmcnt(2)
    v_mfma_f32_16x16x32_bf16 v[96:99], v[104:107], a[64:67], v[96:99]
    s_add_u32 m0, s73, 97792
    v_add_f32 v35, v35, v39
    v_mfma_f32_16x16x32_bf16 v[96:99], v[108:111], a[72:75], v[96:99]
    buffer_load_dwordx4 v19, s[44:47], s26 offen offset:512 sc1 lds
    s_waitcnt lgkmcnt(0)
    v_mfma_f32_16x16x32_bf16 v[96:99], v[112:115], a[80:83], v[96:99]
    ds_read_b128 v[120:123], v14 offset:17408
    v_and_b32 v37, 0xffff0000, v212
    v_mfma_f32_16x16x32_bf16 v[96:99], v[116:119], a[88:91], v[96:99]
    ds_read_b128 v[124:127], v14 offset:21504
    v_lshlrev_b32 v36, 16, v212
    v_mfma_f32_16x16x32_bf16 v[100:103], v[116:119], a[92:95], v[100:103]
    ds_read_b128 v[128:131], v14 offset:25600
    v_and_b32 v39, 0xffff0000, v213
    v_mfma_f32_16x16x32_bf16 v[100:103], v[112:115], a[84:87], v[100:103]
    ds_read_b128 v[132:135], v14 offset:29696
    v_mfma_f32_16x16x32_bf16 v[100:103], v[108:111], a[76:79], v[100:103]
    v_lshlrev_b32 v38, 16, v213
    v_mfma_f32_16x16x32_bf16 v[100:103], v[104:107], a[68:71], v[100:103]
    v_add_f32 v32, v32, v36
    s_waitcnt lgkmcnt(2)
    v_mfma_f32_16x16x32_bf16 v[92:95], v[120:123], a[100:103], v[92:95]
    v_mfma_f32_16x16x32_bf16 v[92:95], v[124:127], a[108:111], v[92:95]
    v_add_f32 v33, v33, v37
    s_waitcnt lgkmcnt(0)
    v_mfma_f32_16x16x32_bf16 v[92:95], v[128:131], a[116:119], v[92:95]
    ds_read_b128 v[104:107], v14 offset:18432
    v_add_f32 v34, v34, v38
    v_mfma_f32_16x16x32_bf16 v[92:95], v[132:135], a[124:127], v[92:95]
    ds_read_b128 v[108:111], v14 offset:22528
    v_add_f32 v35, v35, v39
    v_mfma_f32_16x16x32_bf16 v[88:91], v[132:135], a[120:123], v[88:91]
    ds_read_b128 v[112:115], v14 offset:26624
    v_and_b32 v37, 0xffff0000, v216
    v_mfma_f32_16x16x32_bf16 v[88:91], v[128:131], a[112:115], v[88:91]
    ds_read_b128 v[116:119], v14 offset:30720
    v_lshlrev_b32 v36, 16, v216
L_pl_D_2:
    s_cbranch_execz L_wret
    v_mfma_f32_16x16x32_bf16 v[88:91], v[124:127], a[104:107], v[88:91]
    v_and_b32 v39, 0xffff0000, v217
    v_lshlrev_b32 v38, 16, v217
    v_mfma_f32_16x16x32_bf16 v[88:91], v[120:123], a[96:99], v[88:91]
    v_add_f32 v32, v32, v36
    s_waitcnt lgkmcnt(2)
    v_mfma_f32_16x16x32_bf16 v[96:99], v[104:107], a[96:99], v[96:99]
    v_add_f32 v33, v33, v37
    v_add_f32 v34, v34, v38
    v_mfma_f32_16x16x32_bf16 v[96:99], v[108:111], a[104:107], v[96:99]
    v_add_f32 v35, v35, v39
    s_waitcnt lgkmcnt(0)
    v_mfma_f32_16x16x32_bf16 v[96:99], v[112:115], a[112:115], v[96:99]
    ds_read_b128 v[120:123], v14 offset:19456
    v_mul_f32 v36, s38, v32
    v_mfma_f32_16x16x32_bf16 v[96:99], v[116:119], a[120:123], v[96:99]
    ds_read_b128 v[124:127], v14 offset:23552
    v_mul_f32 v37, s38, v33
    v_mfma_f32_16x16x32_bf16 v[100:103], v[116:119], a[124:127], v[100:103]
    ds_read_b128 v[128:131], v14 offset:27648
    v_mul_f32 v38, s38, v34
    v_mfma_f32_16x16x32_bf16 v[100:103], v[112:115], a[116:119], v[100:103]
    ds_read_b128 v[132:135], v14 offset:31744
    v_mul_f32 v39, s38, v35
    v_mfma_f32_16x16x32_bf16 v[100:103], v[108:111], a[108:111], v[100:103]
    v_exp_f32 v36, v36
    v_mfma_f32_16x16x32_bf16 v[100:103], v[104:107], a[100:103], v[100:103]
    s_waitcnt lgkmcnt(2)
    v_mfma_f32_16x16x32_bf16 v[92:95], v[120:123], a[132:135], v[92:95]
    v_exp_f32 v37, v37
    v_mfma_f32_16x16x32_bf16 v[92:95], v[124:127], a[140:143], v[92:95]
    s_waitcnt lgkmcnt(0)
    v_mfma_f32_16x16x32_bf16 v[92:95], v[128:131], a[148:151], v[92:95]
    s_waitcnt vmcnt(11)
    s_barrier
    v_mfma_f32_16x16x32_bf16 v[92:95], v[132:135], a[156:159], v[92:95]
    ds_read_b128 v[104:107], v14 offset:32768
    v_mfma_f32_16x16x32_bf16 v[88:91], v[132:135], a[152:155], v[88:91]
    ds_read_b128 v[108:111], v14 offset:36864
    v_exp_f32 v38, v38
    v_mfma_f32_16x16x32_bf16 v[88:91], v[128:131], a[144:147], v[88:91]
    ds_read_b128 v[112:115], v14 offset:40960
    v_exp_f32 v39, v39
    v_mfma_f32_16x16x32_bf16 v[88:91], v[124:127], a[136:139], v[88:91]
    ds_read_b128 v[116:119], v14 offset:45056
    v_mul_f32 v180, v180, v32
    v_mfma_f32_16x16x32_bf16 v[88:91], v[120:123], a[128:131], v[88:91]
    v_mul_f32 v181, v181, v33
    s_waitcnt lgkmcnt(2)
    v_mfma_f32_16x16x32_bf16 v[96:99], v[104:107], a[128:131], v[96:99]
    v_mul_f32 v182, v182, v34
    v_mul_f32 v183, v183, v35
    v_mfma_f32_16x16x32_bf16 v[96:99], v[108:111], a[136:139], v[96:99]
    v_add_f32 v36, 1.0, v36
    s_waitcnt lgkmcnt(0)
    v_mfma_f32_16x16x32_bf16 v[96:99], v[112:115], a[144:147], v[96:99]
    ds_read_b128 v[120:123], v14 offset:33792
    v_add_f32 v37, 1.0, v37
    v_mfma_f32_16x16x32_bf16 v[96:99], v[116:119], a[152:155], v[96:99]
    ds_read_b128 v[124:127], v14 offset:37888
    v_add_f32 v38, 1.0, v38
    v_mfma_f32_16x16x32_bf16 v[100:103], v[116:119], a[156:159], v[100:103]
    ds_read_b128 v[128:131], v14 offset:41984
    v_add_f32 v39, 1.0, v39
    v_mfma_f32_16x16x32_bf16 v[100:103], v[112:115], a[148:151], v[100:103]
    ds_read_b128 v[132:135], v14 offset:46080
    v_rcp_f32 v36, v36
    v_mfma_f32_16x16x32_bf16 v[100:103], v[108:111], a[140:143], v[100:103]
    v_rcp_f32 v37, v37
    v_mfma_f32_16x16x32_bf16 v[100:103], v[104:107], a[132:135], v[100:103]
    v_rcp_f32 v38, v38
    s_waitcnt lgkmcnt(2)
    v_mfma_f32_16x16x32_bf16 v[92:95], v[120:123], a[164:167], v[92:95]
    s_waitcnt vmcnt(8)
    v_bitop3_b32 v59, v59, v63, s68 bitop3:0x7e
    v_rcp_f32 v39, v39
    v_mfma_f32_16x16x32_bf16 v[92:95], v[124:127], a[172:175], v[92:95]
    buffer_load_dwordx4 v[72:75], v136, s[44:47], s12 offen offset:0 sc1
    s_waitcnt lgkmcnt(0)
    v_mfma_f32_16x16x32_bf16 v[92:95], v[128:131], a[180:183], v[92:95]
    ds_read_b128 v[104:107], v14 offset:34816
    v_bitop3_b32 v59, v59, v67, s68 bitop3:0xf6
    v_mfma_f32_16x16x32_bf16 v[92:95], v[132:135], a[188:191], v[92:95]
    ds_read_b128 v[108:111], v14 offset:38912
    v_cmp_ne_u32 vcc, 0, v59
    v_mfma_f32_16x16x32_bf16 v[88:91], v[132:135], a[184:187], v[88:91]
    ds_read_b128 v[112:115], v14 offset:43008
    buffer_load_dwordx4 v[76:79], v136, s[44:47], s12 offen offset:1024 sc1
    v_mfma_f32_16x16x32_bf16 v[88:91], v[128:131], a[176:179], v[88:91]
    ds_read_b128 v[116:119], v14 offset:47104
    s_cbranch_vccnz L_xs_b
L_xo_b:
    v_fma_f32 v180, v180, v36, v160
    v_mfma_f32_16x16x32_bf16 v[88:91], v[124:127], a[168:171], v[88:91]
    buffer_load_dwordx4 v[80:83], v136, s[44:47], s12 offen offset:2048 sc1
    v_and_b32 v41, 0xffff0000, v56
    v_mfma_f32_16x16x32_bf16 v[88:91], v[120:123], a[160:163], v[88:91]
    v_lshlrev_b32 v40, 16, v56
    s_waitcnt lgkmcnt(2)
    v_mfma_f32_16x16x32_bf16 v[96:99], v[104:107], a[160:163], v[96:99]
    v_and_b32 v43, 0xffff0000, v57
    v_fma_f32 v181, v181, v37, v161
    v_mfma_f32_16x16x32_bf16 v[96:99], v[108:111], a[168:171], v[96:99]
    v_lshlrev_b32 v42, 16, v57
    s_waitcnt lgkmcnt(0)
    v_mfma_f32_16x16x32_bf16 v[96:99], v[112:115], a[176:179], v[96:99]
    ds_read_b128 v[120:123], v14 offset:35840
    v_and_b32 v45, 0xffff0000, v58
    v_mfma_f32_16x16x32_bf16 v[96:99], v[116:119], a[184:187], v[96:99]
    ds_read_b128 v[124:127], v14 offset:39936
    v_fma_f32 v182, v182, v38, v162
    v_mfma_f32_16x16x32_bf16 v[100:103], v[116:119], a[188:191], v[100:103]
    ds_read_b128 v[128:131], v14 offset:44032
    v_lshlrev_b32 v44, 16, v58
    v_mfma_f32_16x16x32_bf16 v[100:103], v[112:115], a[180:183], v[100:103]
    ds_read_b128 v[132:135], v14 offset:48128
    v_and_b32 v47, 0xffff0000, v60
    v_mfma_f32_16x16x32_bf16 v[100:103], v[108:111], a[172:175], v[100:103]
    v_lshlrev_b32 v46, 16, v60
    v_fma_f32 v183, v183, v39, v163
    v_mfma_f32_16x16x32_bf16 v[100:103], v[104:107], a[164:167], v[100:103]
    v_and_b32 v49, 0xffff0000, v61
    s_waitcnt lgkmcnt(2)
    v_mfma_f32_16x16x32_bf16 v[92:95], v[120:123], a[196:199], v[92:95]
    v_lshlrev_b32 v48, 16, v61
    v_cvt_pk_bf16_f32 v142, v180, v181
    v_mfma_f32_16x16x32_bf16 v[92:95], v[124:127], a[204:207], v[92:95]
    v_and_b32 v51, 0xffff0000, v62
    s_waitcnt lgkmcnt(0)
    v_mfma_f32_16x16x32_bf16 v[92:95], v[128:131], a[212:215], v[92:95]
    s_waitcnt vmcnt(4)
    s_barrier
    v_lshlrev_b32 v50, 16, v62
    v_mfma_f32_16x16x32_bf16 v[92:95], v[132:135], a[220:223], v[92:95]
    ds_read_b128 v[104:107], v14 offset:49152
    v_cvt_pk_bf16_f32 v143, v182, v183
    v_mfma_f32_16x16x32_bf16 v[88:91], v[132:135], a[216:219], v[88:91]
    ds_read_b128 v[108:111], v14 offset:53248
    v_and_b32 v53, 0xffff0000, v64
    v_mfma_f32_16x16x32_bf16 v[88:91], v[128:131], a[208:211], v[88:91]
    ds_read_b128 v[112:115], v14 offset:57344
    v_lshlrev_b32 v52, 16, v64
    v_mfma_f32_16x16x32_bf16 v[88:91], v[124:127], a[200:203], v[88:91]
    ds_read_b128 v[116:119], v14 offset:61440
    v_and_b32 v55, 0xffff0000, v65
    v_mfma_f32_16x16x32_bf16 v[88:91], v[120:123], a[192:195], v[88:91]
    v_lshlrev_b32 v54, 16, v65
    s_waitcnt lgkmcnt(2)
    v_mfma_f32_16x16x32_bf16 v[96:99], v[104:107], a[192:195], v[96:99]
    v_mfma_f32_16x16x32_bf16 v[96:99], v[108:111], a[200:203], v[96:99]
    s_waitcnt lgkmcnt(0)
    v_mfma_f32_16x16x32_bf16 v[96:99], v[112:115], a[208:211], v[96:99]
    ds_read_b128 v[120:123], v14 offset:50176
    v_add_f32 v92, v92, v44
    v_add_f32 v93, v93, v45
    v_mfma_f32_16x16x32_bf16 v[96:99], v[116:119], a[216:219], v[96:99]
    ds_read_b128 v[124:127], v14 offset:54272
    v_add_f32 v94, v94, v46
    v_mfma_f32_16x16x32_bf16 v[100:103], v[116:119], a[220:223], v[100:103]
    ds_read_b128 v[128:131], v14 offset:58368
    v_add_f32 v95, v95, v47
    v_add_f32 v88, v88, v40
    v_mfma_f32_16x16x32_bf16 v[100:103], v[112:115], a[212:215], v[100:103]
    ds_read_b128 v[132:135], v14 offset:62464
    v_add_f32 v89, v89, v41
    v_mfma_f32_16x16x32_bf16 v[100:103], v[108:111], a[204:207], v[100:103]
    v_add_f32 v90, v90, v42
    v_add_f32 v91, v91, v43
    v_mfma_f32_16x16x32_bf16 v[100:103], v[104:107], a[196:199], v[100:103]
    s_waitcnt lgkmcnt(2)
    v_mfma_f32_16x16x32_bf16 v[92:95], v[120:123], a[228:231], v[92:95]
    v_mfma_f32_16x16x32_bf16 v[92:95], v[124:127], a[236:239], v[92:95]
    s_waitcnt lgkmcnt(0)
    v_mfma_f32_16x16x32_bf16 v[92:95], v[128:131], a[244:247], v[92:95]
    ds_read_b128 v[104:107], v14 offset:51200
    v_add_f32 v96, v96, v48
    v_add_f32 v97, v97, v49
    v_mfma_f32_16x16x32_bf16 v[92:95], v[132:135], a[252:255], v[92:95]
    ds_read_b128 v[108:111], v14 offset:55296
    v_add_f32 v98, v98, v50
    v_mfma_f32_16x16x32_bf16 v[88:91], v[132:135], a[248:251], v[88:91]
    ds_read_b128 v[112:115], v14 offset:59392
    v_add_f32 v99, v99, v51
    v_add_f32 v100, v100, v52
    v_mfma_f32_16x16x32_bf16 v[88:91], v[128:131], a[240:243], v[88:91]
    ds_read_b128 v[116:119], v14 offset:63488
    v_add_f32 v101, v101, v53
    v_mfma_f32_16x16x32_bf16 v[88:91], v[124:127], a[232:235], v[88:91]
    v_add_f32 v102, v102, v54
    v_add_f32 v103, v103, v55
    v_mfma_f32_16x16x32_bf16 v[88:91], v[120:123], a[224:227], v[88:91]
    s_waitcnt lgkmcnt(2)
    v_mfma_f32_16x16x32_bf16 v[96:99], v[104:107], a[224:227], v[96:99]
    v_mfma_f32_16x16x32_bf16 v[96:99], v[108:111], a[232:235], v[96:99]
    s_waitcnt lgkmcnt(0)
    v_mfma_f32_16x16x32_bf16 v[96:99], v[112:115], a[240:243], v[96:99]
    ds_read_b128 v[120:123], v14 offset:52224
    v_mfma_f32_16x16x32_bf16 v[96:99], v[116:119], a[248:251], v[96:99]
    ds_read_b128 v[124:127], v14 offset:56320
    v_mfma_f32_16x16x32_bf16 v[100:103], v[116:119], a[252:255], v[100:103]
    buffer_store_dwordx2 v[142:143], v253, s[64:67], 0 offen sc1
    ds_read_b128 v[128:131], v14 offset:60416
    v_mfma_f32_16x16x32_bf16 v[100:103], v[112:115], a[244:247], v[100:103]
    ds_read_b128 v[132:135], v14 offset:64512
    v_mfma_f32_16x16x32_bf16 v[100:103], v[108:111], a[236:239], v[100:103]
    v_mfma_f32_16x16x32_bf16 v[100:103], v[104:107], a[228:231], v[100:103]
    s_waitcnt lgkmcnt(2)
    v_mfma_f32_16x16x32_bf16 v[92:95], v[120:123], v[224:227], v[92:95]
    v_mfma_f32_16x16x32_bf16 v[92:95], v[124:127], v[232:235], v[92:95]
    s_waitcnt lgkmcnt(0)
    v_mfma_f32_16x16x32_bf16 v[92:95], v[128:131], v[240:243], v[92:95]
    s_waitcnt vmcnt(4)
    s_barrier
    v_mfma_f32_16x16x32_bf16 v[92:95], v[132:135], v[248:251], v[92:95]
    ds_read_b128 v[104:107], v14 offset:0
    v_mfma_f32_16x16x32_bf16 v[88:91], v[132:135], v[244:247], v[88:91]
    ds_read_b128 v[108:111], v14 offset:4096
    v_mfma_f32_16x16x32_bf16 v[88:91], v[128:131], v[236:239], v[88:91]
    ds_read_b128 v[112:115], v14 offset:8192
    v_mfma_f32_16x16x32_bf16 v[88:91], v[124:127], v[228:231], v[88:91]
    ds_read_b128 v[116:119], v14 offset:12288
    v_mfma_f32_16x16x32_bf16 v[88:91], v[120:123], v[220:223], v[88:91]
    s_waitcnt lgkmcnt(2)
    v_mfma_f32_16x16x32_bf16 v[96:99], v[104:107], v[220:223], v[96:99]
    v_mfma_f32_16x16x32_bf16 v[96:99], v[108:111], v[228:231], v[96:99]
    s_waitcnt lgkmcnt(0)
    v_mfma_f32_16x16x32_bf16 v[96:99], v[112:115], v[236:239], v[96:99]
    v_mfma_f32_16x16x32_bf16 v[96:99], v[116:119], v[244:247], v[96:99]
    v_mfma_f32_16x16x32_bf16 v[100:103], v[116:119], v[248:251], v[100:103]
    v_mfma_f32_16x16x32_bf16 v[100:103], v[112:115], v[240:243], v[100:103]
    v_mfma_f32_16x16x32_bf16 v[100:103], v[108:111], v[232:235], v[100:103]
    v_mfma_f32_16x16x32_bf16 v[100:103], v[104:107], v[224:227], v[100:103]
    s_waitcnt vmcnt(1)
    v_bitop3_b32 v75, v75, v79, s68 bitop3:0x7e
    v_bitop3_b32 v75, v75, v83, s68 bitop3:0xf6
    v_cmp_ne_u32 vcc, 0, v75
    s_cbranch_vccnz L_xs_z
L_xo_z:
    v_and_b32 v41, 0xffff0000, v72
    v_lshlrev_b32 v40, 16, v72
    v_and_b32 v43, 0xffff0000, v73
    v_lshlrev_b32 v42, 16, v73
    v_and_b32 v45, 0xffff0000, v74
    v_lshlrev_b32 v44, 16, v74
    v_and_b32 v47, 0xffff0000, v76
    v_lshlrev_b32 v46, 16, v76
    v_and_b32 v49, 0xffff0000, v77
    v_lshlrev_b32 v48, 16, v77
    v_and_b32 v51, 0xffff0000, v78
    v_lshlrev_b32 v50, 16, v78
    v_and_b32 v53, 0xffff0000, v80
    v_lshlrev_b32 v52, 16, v80
    v_and_b32 v55, 0xffff0000, v81
    v_lshlrev_b32 v54, 16, v81
    v_pk_add_f32 v[88:89], v[88:89], v[40:41]
    v_pk_add_f32 v[90:91], v[90:91], v[42:43]
    v_pk_add_f32 v[96:97], v[96:97], v[48:49]
    v_pk_add_f32 v[98:99], v[98:99], v[50:51]
    v_pk_mul_f32 v[56:57], v[88:89], s[38:39] op_sel_hi:[1,0]
    v_pk_mul_f32 v[58:59], v[90:91], s[38:39] op_sel_hi:[1,0]
    v_pk_mul_f32 v[64:65], v[96:97], s[38:39] op_sel_hi:[1,0]
    v_pk_mul_f32 v[66:67], v[98:99], s[38:39] op_sel_hi:[1,0]
    v_exp_f32 v56, v56
    v_exp_f32 v57, v57
    v_exp_f32 v58, v58
    v_exp_f32 v59, v59
    v_exp_f32 v64, v64
    v_exp_f32 v65, v65
    v_exp_f32 v66, v66
    v_exp_f32 v67, v67
    v_pk_mul_f32 v[164:165], v[164:165], v[88:89]
    v_pk_mul_f32 v[166:167], v[166:167], v[90:91]
    v_pk_mul_f32 v[172:173], v[172:173], v[96:97]
    v_pk_mul_f32 v[174:175], v[174:175], v[98:99]
    v_pk_add_f32 v[56:57], v[56:57], 1.0 op_sel_hi:[1,0]
    v_pk_add_f32 v[58:59], v[58:59], 1.0 op_sel_hi:[1,0]
    v_pk_add_f32 v[64:65], v[64:65], 1.0 op_sel_hi:[1,0]
    v_pk_add_f32 v[66:67], v[66:67], 1.0 op_sel_hi:[1,0]
    v_rcp_f32 v56, v56
    v_rcp_f32 v57, v57
    v_rcp_f32 v58, v58
    v_rcp_f32 v59, v59
    v_rcp_f32 v64, v64
    v_rcp_f32 v65, v65
    v_rcp_f32 v66, v66
    v_rcp_f32 v67, v67
    v_pk_fma_f32 v[164:165], v[164:165], v[56:57], v[144:145]
    v_pk_fma_f32 v[166:167], v[166:167], v[58:59], v[146:147]
    v_pk_fma_f32 v[172:173], v[172:173], v[64:65], v[152:153]
    v_pk_fma_f32 v[174:175], v[174:175], v[66:67], v[154:155]
    v_cvt_pk_bf16_f32 v88, v164, v165
    v_cvt_pk_bf16_f32 v90, v172, v173
    v_cvt_pk_bf16_f32 v89, v166, v167
    v_cvt_pk_bf16_f32 v91, v174, v175
    v_permlane16_swap_b32 v88, v90
    s_nop 0
    v_permlane16_swap_b32 v89, v91
    buffer_store_dwordx4 v[88:91], v252, s[64:67], 0 offen sc1
    v_pk_add_f32 v[92:93], v[92:93], v[44:45]
    v_pk_add_f32 v[94:95], v[94:95], v[46:47]
    v_pk_add_f32 v[100:101], v[100:101], v[52:53]
    v_pk_add_f32 v[102:103], v[102:103], v[54:55]
    v_pk_mul_f32 v[60:61], v[92:93], s[38:39] op_sel_hi:[1,0]
    v_pk_mul_f32 v[62:63], v[94:95], s[38:39] op_sel_hi:[1,0]
    v_pk_mul_f32 v[68:69], v[100:101], s[38:39] op_sel_hi:[1,0]
    v_pk_mul_f32 v[70:71], v[102:103], s[38:39] op_sel_hi:[1,0]
    v_exp_f32 v60, v60
    v_exp_f32 v61, v61
    v_exp_f32 v62, v62
    v_exp_f32 v63, v63
    v_exp_f32 v68, v68
    v_exp_f32 v69, v69
    v_exp_f32 v70, v70
    v_exp_f32 v71, v71
    v_pk_mul_f32 v[168:169], v[168:169], v[92:93]
    v_pk_mul_f32 v[170:171], v[170:171], v[94:95]
    v_pk_mul_f32 v[176:177], v[176:177], v[100:101]
    v_pk_mul_f32 v[178:179], v[178:179], v[102:103]
    v_pk_add_f32 v[60:61], v[60:61], 1.0 op_sel_hi:[1,0]
    v_pk_add_f32 v[62:63], v[62:63], 1.0 op_sel_hi:[1,0]
    v_pk_add_f32 v[68:69], v[68:69], 1.0 op_sel_hi:[1,0]
    v_pk_add_f32 v[70:71], v[70:71], 1.0 op_sel_hi:[1,0]
    v_rcp_f32 v60, v60
    v_rcp_f32 v61, v61
    v_rcp_f32 v62, v62
    v_rcp_f32 v63, v63
    v_rcp_f32 v68, v68
    v_rcp_f32 v69, v69
    v_rcp_f32 v70, v70
    v_rcp_f32 v71, v71
    v_pk_fma_f32 v[168:169], v[168:169], v[60:61], v[148:149]
    v_pk_fma_f32 v[170:171], v[170:171], v[62:63], v[150:151]
    v_pk_fma_f32 v[176:177], v[176:177], v[68:69], v[156:157]
    v_pk_fma_f32 v[178:179], v[178:179], v[70:71], v[158:159]
    v_cvt_pk_bf16_f32 v92, v168, v169
    v_cvt_pk_bf16_f32 v94, v176, v177
    v_cvt_pk_bf16_f32 v93, v170, v171
    v_cvt_pk_bf16_f32 v95, v178, v179
    v_permlane16_swap_b32 v92, v94
    s_nop 0
    v_permlane16_swap_b32 v93, v95
    buffer_store_dwordx4 v[92:95], v252, s[64:67], s40 offen sc1
    s_endpgm
L_segE:
.p2align 12
L_aux:
    s_mul_i32 s84, s101, 14
    s_lshr_b32 s84, s84, 2
    s_add_u32 s84, s84, 0
    s_add_u32 s85, s84, 1
    s_cmp_eq_u32 s85, 14
    s_cselect_b32 s85, 0, s85
    s_add_u32 s86, s85, 1
    s_cmp_eq_u32 s86, 14
    s_cselect_b32 s86, 0, s86
    s_add_u32 s87, s86, 1
    s_cmp_eq_u32 s87, 14
    s_cselect_b32 s87, 0, s87
    s_add_u32 s88, s87, 1
    s_cmp_eq_u32 s88, 14
    s_cselect_b32 s88, 0, s88
    s_add_u32 s89, s88, 1
    s_cmp_eq_u32 s89, 14
    s_cselect_b32 s89, 0, s89
    s_add_u32 s90, s89, 1
    s_cmp_eq_u32 s90, 14
    s_cselect_b32 s90, 0, s90
    s_add_u32 s91, s90, 1
    s_cmp_eq_u32 s91, 14
    s_cselect_b32 s91, 0, s91
    s_add_u32 s92, s91, 1
    s_cmp_eq_u32 s92, 14
    s_cselect_b32 s92, 0, s92
    s_add_u32 s93, s92, 1
    s_cmp_eq_u32 s93, 14
    s_cselect_b32 s93, 0, s93
    s_add_u32 s94, s93, 1
    s_cmp_eq_u32 s94, 14
    s_cselect_b32 s94, 0, s94
    s_add_u32 s95, s94, 1
    s_cmp_eq_u32 s95, 14
    s_cselect_b32 s95, 0, s95
    s_add_u32 s96, s95, 1
    s_cmp_eq_u32 s96, 14
    s_cselect_b32 s96, 0, s96
    s_add_u32 s97, s96, 1
    s_cmp_eq_u32 s97, 14
    s_cselect_b32 s97, 0, s97
    s_mul_i32 s98, s101, 4
    s_lshr_b32 s98, s98, 2
    s_add_u32 s98, s98, 14
    s_add_u32 s99, s98, 1
    s_cmp_eq_u32 s99, 18
    s_cselect_b32 s99, 14, s99
    s_add_u32 s100, s99, 1
    s_cmp_eq_u32 s100, 18
    s_cselect_b32 s100, 14, s100
    s_add_u32 s101, s100, 1
    s_cmp_eq_u32 s101, 18
    s_cselect_b32 s101, 14, s101
    s_lshl2_add_u32 s7, s5, s6
    s_add_u32 s7, s7, 188
    s_add_u32 s8, s5, 248
    s_cmp_eq_u32 s6, 27
    s_cselect_b32 s75, s8, s7
    s_mov_b32 s48, s24
    s_and_b32 s49, s25, 0xffff
    s_mov_b32 s50, 2359296
    s_mov_b32 s51, 0x20000
    v_lshlrev_b32 v240, 4, v2
    s_mul_i32 s74, s3, 16640
    s_add_u32 s74, s74, 73728
    s_sub_u32 s69, s75, 216
    s_lshl_b32 s70, s69, 4
    s_add_u32 s70, s70, s3
    s_lshl_b32 s12, s70, 12
    s_lshl_b32 s70, s70, 1
    s_mov_b32 s9, 144896
    s_mov_b32 s11, 8192
    v_mul_u32_u24 v48, 1216, v3
    v_mad_u32_u24 v48, v4, 12, v48
    v_add_u32 v48, s9, v48
    v_mov_b32 v47, 0x40000000
    v_lshlrev_b32 v3, 3, v3
    s_lshl_b32 s5, s68, 6
    s_add_u32 s5, s5, 12386304
    v_cmp_eq_u32 vcc, 0, v4
    s_nop 1
    v_cndmask_b32 v49, v47, v3, vcc
    v_lshrrev_b32 v5, 4, v0
    v_and_b32 v4, 3, v2
    v_lshlrev_b32 v4, 3, v4
    v_lshl_add_u32 v5, v5, 5, v4
    v_bfe_u32 v6, v2, 2, 2
    v_mul_u32_u24 v4, 1216, v6
    v_mul_u32_u24 v6, 1152, v6
    v_add3_u32 v50, v4, v5, s9
    v_add3_u32 v51, v6, v5, s11
    s_mul_i32 s4, s3, 2176
    v_add_u32 v55, s4, v51
    v_lshlrev_b32 v52, 4, v0
    s_add_u32 s7, s15, 4096
    s_add_u32 s8, s15, 8192
    s_cmp_eq_u32 s3, 0
    s_cselect_b32 s8, s8, 0x40000000
    v_add_u32 v53, 2359296, v52
    v_mov_b32 v54, 0
    s_mul_i32 s4, s3, 1028
    s_sub_u32 s4, 8204, s4
    v_add_u32 v90, s4, v53
    s_bfe_u32 s6, s68, 0x20001
    s_lshl_b32 s6, s6, 6
    s_lshr_b32 s9, s68, 3
    s_lshl1_add_u32 s6, s9, s6
    s_and_b32 s9, s68, 1
    s_add_u32 s6, s6, s9
    s_lshl_b32 s4, s6, 2
    s_add_u32 s4, s4, 12533760
    v_lshl_add_u32 v1, v0, 10, s4
    s_lshl_b32 s4, s68, 2
    s_add_u32 s4, s4, 12599296
    v_lshl_add_u32 v46, v0, 10, s4
    v_cmp_gt_u32 vcc, 8, v0
    s_nop 1
    v_cndmask_b32 v1, v47, v1, vcc
    v_cmp_gt_u32 vcc, 4, v0
    s_nop 1
    v_cndmask_b32 v46, v47, v46, vcc
    s_waitcnt vmcnt(9)
    v_and_b32 v21, 0xffff0000, v8
    v_lshlrev_b32 v20, 16, v8
    v_and_b32 v23, 0xffff0000, v9
    v_lshlrev_b32 v22, 16, v9
    v_and_b32 v25, 0xffff0000, v10
    v_lshlrev_b32 v24, 16, v10
    v_and_b32 v27, 0xffff0000, v12
    v_lshlrev_b32 v26, 16, v12
    v_and_b32 v29, 0xffff0000, v13
    v_lshlrev_b32 v28, 16, v13
    v_and_b32 v31, 0xffff0000, v14
    v_lshlrev_b32 v30, 16, v14
    v_and_b32 v33, 0xffff0000, v16
    v_lshlrev_b32 v32, 16, v16
    v_and_b32 v35, 0xffff0000, v17
    v_lshlrev_b32 v34, 16, v17
    v_and_b32 v37, 0xffff0000, v18
    v_lshlrev_b32 v36, 16, v18
    v_pk_add_f32 v[38:39], v[20:21], v[22:23]
    v_pk_add_f32 v[40:41], v[24:25], v[26:27]
    v_pk_add_f32 v[42:43], v[28:29], v[30:31]
    v_pk_add_f32 v[44:45], v[32:33], v[34:35]
    v_pk_add_f32 v[38:39], v[38:39], v[40:41]
    v_pk_add_f32 v[42:43], v[42:43], v[44:45]
    v_pk_add_f32 v[38:39], v[38:39], v[36:37]
    v_pk_add_f32 v[38:39], v[38:39], v[42:43]
    v_add_f32 v56, v38, v39
    s_nop 1
    v_add_f32_dpp v56, v56, v56 row_ror:8 row_mask:0xf bank_mask:0xf
    s_nop 1
    v_add_f32_dpp v56, v56, v56 row_ror:4 row_mask:0xf bank_mask:0xf
    s_nop 1
    v_add_f32_dpp v56, v56, v56 row_ror:2 row_mask:0xf bank_mask:0xf
    s_nop 1
    v_add_f32_dpp v56, v56, v56 row_ror:1 row_mask:0xf bank_mask:0xf
    v_mov_b32 v57, v56
    s_nop 1
    v_permlane16_swap_b32 v56, v57
    v_add_f32 v56, v56, v57
    v_mul_f32 v56, 0x3ae38e39, v56
    v_pk_add_f32 v[20:21], v[20:21], v[56:57] op_sel_hi:[1,0] neg_lo:[0,1] neg_hi:[0,1]
    v_pk_add_f32 v[22:23], v[22:23], v[56:57] op_sel_hi:[1,0] neg_lo:[0,1] neg_hi:[0,1]
    v_pk_add_f32 v[24:25], v[24:25], v[56:57] op_sel_hi:[1,0] neg_lo:[0,1] neg_hi:[0,1]
    v_pk_add_f32 v[26:27], v[26:27], v[56:57] op_sel_hi:[1,0] neg_lo:[0,1] neg_hi:[0,1]
    v_pk_add_f32 v[28:29], v[28:29], v[56:57] op_sel_hi:[1,0] neg_lo:[0,1] neg_hi:[0,1]
    v_pk_add_f32 v[30:31], v[30:31], v[56:57] op_sel_hi:[1,0] neg_lo:[0,1] neg_hi:[0,1]
    v_pk_add_f32 v[32:33], v[32:33], v[56:57] op_sel_hi:[1,0] neg_lo:[0,1] neg_hi:[0,1]
    v_pk_add_f32 v[34:35], v[34:35], v[56:57] op_sel_hi:[1,0] neg_lo:[0,1] neg_hi:[0,1]
    v_pk_add_f32 v[36:37], v[36:37], v[56:57] op_sel_hi:[1,0] neg_lo:[0,1] neg_hi:[0,1]
    v_pk_mul_f32 v[38:39], v[20:21], v[20:21]
    v_pk_mul_f32 v[40:41], v[22:23], v[22:23]
    v_pk_fma_f32 v[38:39], v[24:25], v[24:25], v[38:39]
    v_pk_fma_f32 v[40:41], v[26:27], v[26:27], v[40:41]
    v_pk_fma_f32 v[38:39], v[28:29], v[28:29], v[38:39]
    v_pk_fma_f32 v[40:41], v[30:31], v[30:31], v[40:41]
    v_pk_fma_f32 v[38:39], v[32:33], v[32:33], v[38:39]
    v_pk_fma_f32 v[40:41], v[34:35], v[34:35], v[40:41]
    v_pk_fma_f32 v[38:39], v[36:37], v[36:37], v[38:39]
    v_pk_add_f32 v[38:39], v[38:39], v[40:41]
    v_add_f32 v18, v38, v39
    s_nop 1
    v_add_f32_dpp v18, v18, v18 row_ror:8 row_mask:0xf bank_mask:0xf
    s_nop 1
    v_add_f32_dpp v18, v18, v18 row_ror:4 row_mask:0xf bank_mask:0xf
    s_nop 1
    v_add_f32_dpp v18, v18, v18 row_ror:2 row_mask:0xf bank_mask:0xf
    s_nop 1
    v_add_f32_dpp v18, v18, v18 row_ror:1 row_mask:0xf bank_mask:0xf
    v_mov_b32 v19, v18
    s_nop 1
    v_permlane16_swap_b32 v18, v19
    v_add_f32 v18, v18, v19
    v_mul_f32 v18, 0x3ae38e39, v18
    v_cvt_pk_bf16_f32 v38, v56, v18
    v_lshlrev_b32 v106, 16, v38
    v_and_b32 v38, 0xffff0000, v38
    v_add_f32 v38, 0x3727c5ac, v38
    v_sub_f32 v56, v56, v106
    v_cvt_pk_bf16_f32 v38, v38, v38
    v_lshlrev_b32 v38, 16, v38
    v_sqrt_f32 v38, v38
    s_nop 0
    v_cvt_pk_bf16_f32 v38, v38, v38
    v_lshlrev_b32 v38, 16, v38
    v_rcp_f32 v107, v38
    s_nop 0
    v_mul_f32 v56, v56, v107
    v_mul_f32 v18, v18, v107
    v_mul_f32 v18, v18, v107
    v_cvt_pk_bf16_f32 v38, v56, v18
    v_lshlrev_b32 v39, 16, v38
    v_and_b32 v38, 0xffff0000, v38
    v_add_f32 v38, 0x3727c5ac, v38
    v_sub_f32 v56, v56, v39
    v_cvt_pk_bf16_f32 v38, v38, v38
    v_lshlrev_b32 v38, 16, v38
    v_sqrt_f32 v38, v38
    s_nop 0
    v_cvt_pk_bf16_f32 v38, v38, v38
    v_lshlrev_b32 v38, 16, v38
    v_rcp_f32 v38, v38
    s_nop 0
    v_mul_f32 v18, v107, v38
    v_mul_f32 v56, v56, v38
    v_pk_fma_f32 v[20:21], v[20:21], v[18:19], v[56:57] op_sel_hi:[1,0,0]
    v_pk_fma_f32 v[22:23], v[22:23], v[18:19], v[56:57] op_sel_hi:[1,0,0]
    v_pk_fma_f32 v[24:25], v[24:25], v[18:19], v[56:57] op_sel_hi:[1,0,0]
    v_pk_fma_f32 v[26:27], v[26:27], v[18:19], v[56:57] op_sel_hi:[1,0,0]
    v_pk_fma_f32 v[28:29], v[28:29], v[18:19], v[56:57] op_sel_hi:[1,0,0]
    v_pk_fma_f32 v[30:31], v[30:31], v[18:19], v[56:57] op_sel_hi:[1,0,0]
    v_pk_fma_f32 v[32:33], v[32:33], v[18:19], v[56:57] op_sel_hi:[1,0,0]
    v_pk_fma_f32 v[34:35], v[34:35], v[18:19], v[56:57] op_sel_hi:[1,0,0]
    v_pk_fma_f32 v[36:37], v[36:37], v[18:19], v[56:57] op_sel_hi:[1,0,0]
    v_cvt_pk_bf16_f32 v8, v20, v21
    v_cvt_pk_bf16_f32 v9, v22, v23
    v_cvt_pk_bf16_f32 v10, v24, v25
    v_cvt_pk_bf16_f32 v11, v26, v27
    v_cvt_pk_bf16_f32 v12, v28, v29
    v_cvt_pk_bf16_f32 v13, v30, v31
    v_cvt_pk_bf16_f32 v14, v32, v33
    v_cvt_pk_bf16_f32 v15, v34, v35
    v_cvt_pk_bf16_f32 v16, v36, v37
    ds_write_b32 v48, v8 offset:0
    ds_write_b32 v48, v9 offset:4
    ds_write_b32 v48, v10 offset:8
    ds_write_b32 v48, v11 offset:384
    ds_write_b32 v48, v12 offset:388
    ds_write_b32 v48, v13 offset:392
    ds_write_b32 v48, v14 offset:768
    ds_write_b32 v48, v15 offset:772
    ds_write_b32 v48, v16 offset:776
    buffer_store_dwordx2 v[106:107], v49, s[44:47], s5 offen sc1
    s_waitcnt lgkmcnt(0)
    s_barrier
    ds_read_b64_tr_b16 v[20:21], v50 offset:0
    ds_read_b64_tr_b16 v[22:23], v50 offset:4864
    ds_read_b64_tr_b16 v[24:25], v50 offset:512
    ds_read_b64_tr_b16 v[26:27], v50 offset:5376
    ds_read_b64_tr_b16 v[28:29], v50 offset:1024
    ds_read_b64_tr_b16 v[30:31], v50 offset:5888
    s_waitcnt lgkmcnt(4)
    buffer_store_dwordx4 v[20:23], v52, s[44:47], s15 offen sc1
    s_waitcnt lgkmcnt(2)
    buffer_store_dwordx4 v[24:27], v52, s[44:47], s7 offen sc1
    s_waitcnt lgkmcnt(0)
    buffer_store_dwordx4 v[28:31], v52, s[44:47], s8 offen sc1
    buffer_load_dword v45, v54, s[64:67], 0 offen sc1
    s_waitcnt vmcnt(5)
    s_barrier
    ds_read_b64_tr_b16 v[60:61], v51 offset:0
    ds_read_b64_tr_b16 v[62:63], v51 offset:4608
    ds_read_b64_tr_b16 v[64:65], v51 offset:9216
    ds_read_b64_tr_b16 v[66:67], v51 offset:12672
    ds_read_b64_tr_b16 v[68:69], v51 offset:17280
    ds_read_b64_tr_b16 v[70:71], v51 offset:512
    ds_read_b64_tr_b16 v[72:73], v51 offset:5120
    ds_read_b64_tr_b16 v[74:75], v51 offset:9728
    ds_read_b64_tr_b16 v[76:77], v51 offset:13184
    ds_read_b64_tr_b16 v[78:79], v51 offset:17792
    v_alignbit_b32 v114, v99, v99, 16
    v_alignbit_b32 v115, v98, v98, 16
    s_waitcnt lgkmcnt(5)
    v_alignbit_b32 v108, v61, v60, 16
    v_alignbit_b32 v109, v62, v61, 16
    v_alignbit_b32 v110, v63, v62, 16
    v_alignbit_b32 v111, v64, v63, 16
    v_alignbit_b32 v112, v65, v64, 16
    v_dot2_f32_bf16 v116, v60, v114, 0
    ds_read_b64_tr_b16 v[80:81], v51 offset:1024
    v_dot2_f32_bf16 v117, v108, v114, 0
    v_dot2_f32_bf16 v118, v61, v114, 0
    v_dot2_f32_bf16 v119, v109, v114, 0
    v_dot2_f32_bf16 v120, v62, v114, 0
    ds_read_b64_tr_b16 v[82:83], v51 offset:5632
    v_dot2_f32_bf16 v121, v110, v114, 0
    v_dot2_f32_bf16 v122, v63, v114, 0
    v_dot2_f32_bf16 v123, v111, v114, 0
    v_dot2_f32_bf16 v116, v61, v115, v116
    v_dot2_f32_bf16 v117, v109, v115, v117
    ds_read_b64_tr_b16 v[84:85], v51 offset:10240
    v_dot2_f32_bf16 v118, v62, v115, v118
    v_dot2_f32_bf16 v119, v110, v115, v119
    v_dot2_f32_bf16 v120, v63, v115, v120
    v_dot2_f32_bf16 v121, v111, v115, v121
    v_dot2_f32_bf16 v122, v64, v115, v122
    ds_read_b64_tr_b16 v[86:87], v51 offset:13696
    v_dot2_f32_bf16 v123, v112, v115, v123
    v_and_b32 v133, 0xffff0000, v66
    v_lshlrev_b32 v132, 16, v66
    v_and_b32 v135, 0xffff0000, v67
    v_lshlrev_b32 v134, 16, v67
    ds_read_b64_tr_b16 v[88:89], v51 offset:18304
    v_and_b32 v137, 0xffff0000, v68
    v_lshlrev_b32 v136, 16, v68
    v_and_b32 v139, 0xffff0000, v69
    v_lshlrev_b32 v138, 16, v69
    v_pk_mul_f32 v[116:117], v[116:117], v[132:133]
    v_pk_mul_f32 v[118:119], v[118:119], v[134:135]
    v_pk_mul_f32 v[120:121], v[120:121], v[136:137]
    v_pk_mul_f32 v[122:123], v[122:123], v[138:139]
    v_cvt_pk_bf16_f32 v160, v123, v122
    v_cvt_pk_bf16_f32 v161, v121, v120
    v_cvt_pk_bf16_f32 v162, v119, v118
    v_cvt_pk_bf16_f32 v163, v117, v116
    buffer_store_dwordx4 v[160:163], v53, s[44:47], s15 offen sc1
    v_alignbit_b32 v114, v101, v101, 16
    v_alignbit_b32 v115, v100, v100, 16
    s_waitcnt lgkmcnt(5)
    v_alignbit_b32 v108, v71, v70, 16
    v_alignbit_b32 v109, v72, v71, 16
    v_alignbit_b32 v110, v73, v72, 16
    v_alignbit_b32 v111, v74, v73, 16
    v_alignbit_b32 v112, v75, v74, 16
    v_dot2_f32_bf16 v124, v70, v114, 0
    v_dot2_f32_bf16 v125, v108, v114, 0
    v_dot2_f32_bf16 v126, v71, v114, 0
    v_dot2_f32_bf16 v127, v109, v114, 0
    v_dot2_f32_bf16 v128, v72, v114, 0
    v_dot2_f32_bf16 v129, v110, v114, 0
    v_dot2_f32_bf16 v130, v73, v114, 0
    v_dot2_f32_bf16 v131, v111, v114, 0
    v_dot2_f32_bf16 v124, v71, v115, v124
    v_dot2_f32_bf16 v125, v109, v115, v125
    v_dot2_f32_bf16 v126, v72, v115, v126
    v_dot2_f32_bf16 v127, v110, v115, v127
    v_dot2_f32_bf16 v128, v73, v115, v128
    v_dot2_f32_bf16 v129, v111, v115, v129
    v_dot2_f32_bf16 v130, v74, v115, v130
    v_dot2_f32_bf16 v131, v112, v115, v131
    v_and_b32 v133, 0xffff0000, v76
    v_lshlrev_b32 v132, 16, v76
    v_and_b32 v135, 0xffff0000, v77
    v_lshlrev_b32 v134, 16, v77
    v_and_b32 v137, 0xffff0000, v78
    v_lshlrev_b32 v136, 16, v78
    v_and_b32 v139, 0xffff0000, v79
    v_lshlrev_b32 v138, 16, v79
    v_pk_mul_f32 v[124:125], v[124:125], v[132:133]
    v_pk_mul_f32 v[126:127], v[126:127], v[134:135]
    v_pk_mul_f32 v[128:129], v[128:129], v[136:137]
    v_pk_mul_f32 v[130:131], v[130:131], v[138:139]
    v_cvt_pk_bf16_f32 v164, v131, v130
    v_cvt_pk_bf16_f32 v165, v129, v128
    v_cvt_pk_bf16_f32 v166, v127, v126
    v_cvt_pk_bf16_f32 v167, v125, v124
    buffer_store_dwordx4 v[164:167], v53, s[44:47], s7 offen sc1
    v_alignbit_b32 v114, v103, v103, 16
    v_alignbit_b32 v115, v102, v102, 16
    s_waitcnt lgkmcnt(0)
    v_alignbit_b32 v108, v81, v80, 16
    v_alignbit_b32 v109, v82, v81, 16
    v_alignbit_b32 v110, v83, v82, 16
    v_alignbit_b32 v111, v84, v83, 16
    v_alignbit_b32 v112, v85, v84, 16
    v_dot2_f32_bf16 v116, v80, v114, 0
    v_dot2_f32_bf16 v117, v108, v114, 0
    v_dot2_f32_bf16 v118, v81, v114, 0
    v_dot2_f32_bf16 v119, v109, v114, 0
    v_dot2_f32_bf16 v120, v82, v114, 0
    v_dot2_f32_bf16 v121, v110, v114, 0
    v_dot2_f32_bf16 v122, v83, v114, 0
    v_dot2_f32_bf16 v123, v111, v114, 0
    v_dot2_f32_bf16 v116, v81, v115, v116
    v_dot2_f32_bf16 v117, v109, v115, v117
    v_dot2_f32_bf16 v118, v82, v115, v118
    v_dot2_f32_bf16 v119, v110, v115, v119
    v_dot2_f32_bf16 v120, v83, v115, v120
    v_dot2_f32_bf16 v121, v111, v115, v121
    v_dot2_f32_bf16 v122, v84, v115, v122
    v_dot2_f32_bf16 v123, v112, v115, v123
    v_and_b32 v133, 0xffff0000, v86
    v_lshlrev_b32 v132, 16, v86
    v_and_b32 v135, 0xffff0000, v87
    v_lshlrev_b32 v134, 16, v87
    v_and_b32 v137, 0xffff0000, v88
    v_lshlrev_b32 v136, 16, v88
    v_and_b32 v139, 0xffff0000, v89
    v_lshlrev_b32 v138, 16, v89
    v_pk_mul_f32 v[116:117], v[116:117], v[132:133]
    v_pk_mul_f32 v[118:119], v[118:119], v[134:135]
    v_pk_mul_f32 v[120:121], v[120:121], v[136:137]
    v_pk_mul_f32 v[122:123], v[122:123], v[138:139]
    v_cvt_pk_bf16_f32 v168, v123, v122
    v_cvt_pk_bf16_f32 v169, v121, v120
    v_cvt_pk_bf16_f32 v170, v119, v118
    v_cvt_pk_bf16_f32 v171, v117, v116
    buffer_store_dwordx4 v[168:171], v53, s[44:47], s8 offen sc1
    s_add_u32 m0, s74, 32
    s_add_u32 s13, s12, 0
    buffer_load_dwordx4 v240, s[48:51], s13 offen offset:0 lds
    buffer_load_dwordx4 v240, s[48:51], s13 offen offset:1024 lds
    buffer_load_dwordx4 v240, s[48:51], s13 offen offset:2048 lds
    buffer_load_dwordx4 v240, s[48:51], s13 offen offset:3072 lds
    s_mov_b64 exec, 0
    s_call_b64 s[82:83], L_wc_X
    s_mov_b64 exec, -1
    s_waitcnt vmcnt(7)
    v_readfirstlane_b32 s68, v45
    s_nop 1
    s_cmp_eq_u32 s68, 0
    s_cbranch_scc1 L_nw_X
L_ng_X:
    s_barrier
    v_mov_b32 v3, s68
    buffer_store_dword v3, v1, s[44:47], 0 offen sc1
    s_waitcnt vmcnt(5)
    s_barrier
    buffer_store_dword v3, v46, s[44:47], 0 offen sc1
L_segX:
L_pl_X_0:
    s_cbranch_execz L_pl_X_4
    s_cmp_lt_u32 s75, 252
    s_cbranch_scc0 L_idle
    s_mov_b32 s56, s26
    s_and_b32 s57, s27, 0xffff
    s_mov_b32 s58, 1152
    s_mov_b32 s59, 0x20000
    v_mov_b32 v9, 0
    buffer_load_ushort v9, v9, s[56:59], s70 offen
    s_lshr_b32 s4, s2, 1
    s_and_b32 s4, s4, 3
    s_lshl2_add_u32 s4, s4, s3
    s_lshl_b32 s4, s4, 8
    s_add_u32 s4, s4, 12599296
    v_lshl_add_u32 v28, v2, 2, s4
    v_add_u32 v241, s74, v240
    v_cmp_eq_u32 vcc, 0, v2
    v_mov_b32 v196, 4136
    s_nop 0
    v_cndmask_b32 v196, v196, 30, vcc
    v_add_u32 v242, s74, v196
    v_bfe_u32 v196, v2, 3, 2
    v_mul_u32_u24 v196, 4160, v196
    v_and_b32 v197, 7, v2
    v_lshl_add_u32 v196, v197, 2, v196
    v_add_u32 v200, s74, v196
    v_mov_b32 v196, 0
    v_mov_b32 v197, 0
    v_mov_b32 v198, 0
    v_mov_b32 v199, 0
    ds_write_b32 v200, v196
    v_lshlrev_b32 v201, 4, v0
    ds_write_b128 v201, v[196:199]
    ds_write_b128 v201, v[196:199] offset:36864
    s_waitcnt vmcnt(3)
    ds_read_b128 v[212:215], v241 offset:32
    ds_read_b32 v216, v241 offset:48
    ds_read_b128 v[218:221], v241 offset:1056
    ds_read_b32 v222, v241 offset:1072
    ds_read_b128 v[224:227], v241 offset:2080
    ds_read_b32 v228, v241 offset:2096
    ds_read_b128 v[230:233], v241 offset:3104
    ds_read_b32 v234, v241 offset:3120
    v_lshrrev_b32 v202, 3, v2
    v_and_b32 v203, 7, v2
    v_lshrrev_b32 v204, 1, v202
    v_xor_b32 v203, v203, v204
    v_mul_u32_u24 v202, 9216, v202
    v_lshl_add_u32 v15, v203, 4, v202
    v_xor_b32 v16, 64, v15
    v_and_b32 v202, 15, v2
    v_add_u32 v202, 1, v202
    v_and_b32 v203, 1, v202
    v_mul_u32_u24 v203, 4160, v203
    v_lshrrev_b32 v202, 1, v202
    v_lshl_add_u32 v203, v202, 2, v203
    v_lshrrev_b32 v204, 4, v2
    v_lshl_add_u32 v203, v204, 4, v203
    v_add_u32 v236, s74, v203
    v_add_u32 v237, 1024, v236
    v_add_u32 v238, 1024, v237
    v_add_u32 v239, 1024, v238
    s_waitcnt lgkmcnt(0)
    s_waitcnt vmcnt(0)
    v_lshlrev_b32 v9, 16, v9
    v_lshlrev_b32 v208, 16, v212
    v_add_f32 v9, v9, v208
    v_cvt_pk_bf16_f32 v9, v9, v9
    ds_write_b16 v242, v9 offset:4160
    ds_write_b16 v242, v9 offset:2
    v_alignbit_b32 v212, v213, v212, 16
    v_alignbit_b32 v213, v214, v213, 16
    v_alignbit_b32 v214, v215, v214, 16
    v_alignbit_b32 v215, v216, v215, 16
    ds_write_b128 v241, v[212:215] offset:4192
    v_alignbit_b32 v218, v219, v218, 16
    v_alignbit_b32 v219, v220, v219, 16
    v_alignbit_b32 v220, v221, v220, 16
    v_alignbit_b32 v221, v222, v221, 16
    ds_write_b128 v241, v[218:221] offset:5216
    v_alignbit_b32 v224, v225, v224, 16
    v_alignbit_b32 v225, v226, v225, 16
    v_alignbit_b32 v226, v227, v226, 16
    v_alignbit_b32 v227, v228, v227, 16
    ds_write_b128 v241, v[224:227] offset:6240
    v_alignbit_b32 v230, v231, v230, 16
    v_alignbit_b32 v231, v232, v231, 16
    v_alignbit_b32 v232, v233, v232, 16
    v_alignbit_b32 v233, v234, v233, 16
    ds_write_b128 v241, v[230:233] offset:7264
    v_and_b32 v202, 15, v2
    v_lshlrev_b32 v202, 1, v202
    v_sub_u32 v202, v202, v204
    v_add_u32 v202, 17, v202
    v_bfe_u32 v203, v202, 1, 3
    v_xor_b32 v203, s3, v203
    v_lshlrev_b32 v203, 4, v203
    v_lshl_add_u32 v244, v202, 7, v203
    v_and_b32 v202, 15, v2
    v_lshlrev_b32 v202, 1, v202
    v_sub_u32 v202, v202, v204
    v_add_u32 v202, 13, v202
    v_bfe_u32 v203, v202, 1, 3
    v_xor_b32 v203, s3, v203
    v_lshlrev_b32 v203, 4, v203
    v_lshl_add_u32 v245, v202, 7, v203
    v_and_b32 v202, 15, v2
    v_lshlrev_b32 v202, 1, v202
    v_sub_u32 v202, v202, v204
    v_add_u32 v202, 9, v202
    v_bfe_u32 v203, v202, 1, 3
    v_xor_b32 v203, s3, v203
    v_lshlrev_b32 v203, 4, v203
    v_lshl_add_u32 v246, v202, 7, v203
    v_and_b32 v202, 15, v2
    v_lshlrev_b32 v202, 1, v202
    v_sub_u32 v202, v202, v204
    v_add_u32 v202, 5, v202
    v_bfe_u32 v203, v202, 1, 3
    v_xor_b32 v203, s3, v203
    v_lshlrev_b32 v203, 4, v203
    v_lshl_add_u32 v247, v202, 7, v203
    v_and_b32 v202, 15, v2
    v_lshlrev_b32 v202, 5, v202
    v_lshl_add_u32 v8, v204, 3, v202
    s_mul_i32 s7, s3, 589824
    s_lshl_b32 s8, s69, 8
    s_add_u32 s7, s7, s8
    s_add_u32 s10, s7, 2359296
    s_lshl_b32 s9, s3, 13
    s_add_u32 s9, s9, 4096
    ds_read2_b32 v[64:65], v236 offset0:0 offset1:1
    ds_read2_b32 v[66:67], v236 offset0:2 offset1:3
    ds_read2_b32 v[68:69], v236 offset0:128 offset1:129
    ds_read2_b32 v[70:71], v236 offset0:130 offset1:131
    ds_read2_b32 v[72:73], v237 offset0:0 offset1:1
    ds_read2_b32 v[74:75], v237 offset0:2 offset1:3
    ds_read2_b32 v[76:77], v237 offset0:128 offset1:129
    ds_read2_b32 v[78:79], v237 offset0:130 offset1:131
    ds_read2_b32 v[80:81], v238 offset0:0 offset1:1
    ds_read2_b32 v[82:83], v238 offset0:2 offset1:3
    ds_read2_b32 v[84:85], v238 offset0:128 offset1:129
    ds_read2_b32 v[86:87], v238 offset0:130 offset1:131
    ds_read2_b32 v[88:89], v239 offset0:0 offset1:1
    ds_read2_b32 v[90:91], v239 offset0:2 offset1:3
    ds_read2_b32 v[92:93], v239 offset0:128 offset1:129
    ds_read2_b32 v[94:95], v239 offset0:130 offset1:131
    v_mov_b32 v29, 0
    buffer_atomic_add v29, v28, s[44:47], 0 offen sc0 sc1
    s_waitcnt vmcnt(0)
    v_cmp_ne_u32 vcc, s68, v29
    s_cbranch_vccnz L_rs_p1X
L_ok_p1X:
    s_add_u32 m0, s9, 0
    s_add_u32 s13, s10, 0
    buffer_load_dwordx4 v15, s[44:47], s13 offen sc1 lds
    s_add_u32 m0, s9, 1024
    s_add_u32 s13, s10, 73728
    buffer_load_dwordx4 v16, s[44:47], s13 offen sc1 lds
    s_add_u32 m0, s9, 2048
    s_add_u32 s13, s10, 147456
    buffer_load_dwordx4 v15, s[44:47], s13 offen sc1 lds
    s_add_u32 m0, s9, 3072
    s_add_u32 s13, s10, 221184
    buffer_load_dwordx4 v16, s[44:47], s13 offen sc1 lds
    s_add_u32 m0, s9, 4096
    s_add_u32 s13, s10, 294912
    buffer_load_dwordx4 v15, s[44:47], s13 offen sc1 lds
    s_add_u32 m0, s9, 5120
    s_add_u32 s13, s10, 368640
    buffer_load_dwordx4 v16, s[44:47], s13 offen sc1 lds
    s_add_u32 m0, s9, 6144
    s_add_u32 s13, s10, 442368
    buffer_load_dwordx4 v15, s[44:47], s13 offen sc1 lds
    s_add_u32 m0, s9, 7168
    s_add_u32 s13, s10, 516096
    buffer_load_dwordx4 v16, s[44:47], s13 offen sc1 lds
    s_mov_b64 exec, 0
    s_call_b64 s[82:83], L_wc_D
    s_mov_b64 exec, -1
    s_mov_b32 s60, s36
    s_and_b32 s61, s37, 0xffff
    s_mov_b32 s62, 4096
    s_mov_b32 s63, 0x20000
    v_and_b32 v24, 15, v2
    s_lshl_b32 s7, s71, 6
    v_add_u32 v24, s7, v24
    s_and_b32 s8, s3, 1
    s_lshl_b32 s4, s8, 5
    v_add_u32 v25, s4, v24
    v_lshlrev_b32 v26, 3, v25
    v_mul_u32_u24 v25, 1152, v25
    v_bfe_u32 v31, v2, 4, 1
    v_lshl_add_u32 v25, v31, 5, v25
    v_lshrrev_b32 v31, 5, v2
    v_lshl_add_u32 v25, v31, 4, v25
    s_bfe_u32 s7, s2, 0x20003
    s_mul_i32 s7, s7, 288
    s_lshl_b32 s4, s72, 6
    s_add_u32 s4, s4, s7
    v_add_u32 v252, s4, v25
    s_xor_b32 s8, s3, s72
    s_and_b32 s4, s72, 1
    s_lshl1_add_u32 s4, s4, s8
    v_lshl_add_u32 v24, s4, 4, v24
    s_add_u32 s7, s7, 256
    s_cmp_lt_u32 s8, 2
    s_cselect_b32 s7, s7, 0x40000000
    v_lshlrev_b32 v18, 3, v24
    v_mul_u32_u24 v24, 1152, v24
    v_lshrrev_b32 v31, 4, v2
    v_lshl_add_u32 v24, v31, 3, v24
    v_add_u32 v253, s7, v24
    v_lshrrev_b32 v24, 3, v2
    v_and_b32 v25, 7, v2
    v_bfe_u32 v31, v2, 4, 2
    v_lshlrev_b32 v31, 1, v31
    v_xor_b32 v25, v25, v31
    v_lshlrev_b32 v24, 12, v24
    v_lshl_add_u32 v24, v25, 4, v24
    s_mul_i32 s7, s72, 36
    s_bitcmp1_b32 s3, 0
L_pl_X_1:
    s_cbranch_execz L_pl_X_5
    s_addc_u32 s7, s7, 0
    s_lshl_b32 s7, s7, 17
    s_lshl_b32 s8, s71, 7
    s_add_u32 s7, s7, s8
    v_add_u32 v4, s7, v24
    v_add_u32 v5, 31744, v4
    v_add_u32 v6, 31744, v5
    v_add_u32 v7, 31744, v6
    v_lshrrev_b32 v24, 2, v2
    v_lshlrev_b32 v24, 7, v24
    v_and_b32 v25, 3, v2
    v_lshl_add_u32 v24, v25, 3, v24
    s_and_b32 s7, s73, 8192
    v_add_u32 v24, s7, v24
    v_bfe_u32 v31, v2, 3, 2
    s_and_b32 s7, s3, 1
    s_lshl_b32 s7, s7, 1
    v_xor_b32 v31, s7, v31
    v_lshl_add_u32 v10, v31, 5, v24
    v_xor_b32 v11, 32, v10
    v_and_b32 v24, 15, v2
    v_lshrrev_b32 v25, 4, v2
    v_mul_u32_u24 v25, 17408, v25
    v_lshl_add_u32 v24, v24, 4, v25
    s_mul_i32 s7, s72, 36
    s_and_b32 s8, s3, 1
    s_add_u32 s7, s7, s8
    s_mul_i32 s7, s7, 69632
    s_bfe_u32 s8, s2, 0x20003
    s_lshl_b32 s8, s8, 12
    s_add_u32 s7, s7, s8
    s_add_u32 s7, s7, 12795904
    v_add_u32 v23, s7, v24
    s_xor_b32 s7, s72, 0
    v_lshl_add_u32 v19, s7, 10, v23
    s_xor_b32 s7, s72, 1
    v_lshl_add_u32 v20, s7, 10, v23
    s_xor_b32 s7, s72, 2
    v_lshl_add_u32 v21, s7, 10, v23
    s_xor_b32 s7, s72, 3
    v_lshl_add_u32 v22, s7, 10, v23
    v_lshlrev_b32 v14, 4, v2
    v_add_u32 v14, 98304, v14
    v_add_u32 v1, 0x10000, v14
    s_bitcmp1_b32 s3, 1
    s_cselect_b32 s18, s85, s84
    s_mul_i32 s18, s18, 139264
    s_cselect_b32 s19, s87, s86
    s_mul_i32 s19, s19, 139264
    s_cselect_b32 s20, s89, s88
    s_mul_i32 s20, s20, 139264
    s_cselect_b32 s21, s91, s90
    s_mul_i32 s21, s21, 139264
    s_cselect_b32 s22, s93, s92
    s_mul_i32 s22, s22, 139264
    s_cselect_b32 s23, s95, s94
    s_mul_i32 s23, s23, 139264
    s_cselect_b32 s24, s97, s96
    s_mul_i32 s24, s24, 139264
    s_cselect_b32 s25, s99, s98
    s_mul_i32 s25, s25, 139264
    s_cselect_b32 s26, s101, s100
    s_mul_i32 s26, s26, 139264
    v_add_u32 v10, 131072, v10
    v_add_u32 v11, 131072, v11
    s_waitcnt vmcnt(0) lgkmcnt(0)
    s_barrier
    ds_read_b128 v[96:99], v244 offset:2048
    ds_read_b128 v[100:103], v244 offset:6144
    ds_read_b128 v[104:107], v244 offset:10240
    ds_read_b128 v[108:111], v244 offset:14336
    ds_read_b128 v[112:115], v244 offset:18432
    ds_read_b128 v[116:119], v244 offset:22528
    ds_read_b128 v[120:123], v244 offset:26624
    ds_read_b128 v[124:127], v244 offset:30720
    s_waitcnt lgkmcnt(0)
    v_mfma_f32_16x16x32_bf16 v[32:35], v[64:67], v[96:99], 0
    s_lshl_b32 s14, s84, 18
    ds_read_b128 v[160:163], v245 offset:2048
    v_mfma_f32_16x16x32_bf16 v[36:39], v[68:71], v[96:99], 0
    s_add_u32 m0, s73, 147456
    v_mfma_f32_16x16x32_bf16 v[36:39], v[64:67], v[100:103], v[36:39]
    buffer_load_dwordx4 v4, s[52:55], s14 offen offset:0 lds
    ds_read2_b32 v[128:129], v236 offset0:16 offset1:17
    v_mfma_f32_16x16x32_bf16 v[40:43], v[64:67], v[104:107], 0
    ds_read2_b32 v[130:131], v236 offset0:18 offset1:19
    v_mfma_f32_16x16x32_bf16 v[40:43], v[68:71], v[100:103], v[40:43]
    v_mfma_f32_16x16x32_bf16 v[40:43], v[72:75], v[96:99], v[40:43]
    ds_read_b128 v[164:167], v245 offset:6144
    v_mfma_f32_16x16x32_bf16 v[44:47], v[76:79], v[96:99], 0
    ds_read2_b32 v[132:133], v236 offset0:144 offset1:145
    v_mfma_f32_16x16x32_bf16 v[44:47], v[72:75], v[100:103], v[44:47]
    s_add_u32 s13, s12, 16384
    v_mfma_f32_16x16x32_bf16 v[44:47], v[68:71], v[104:107], v[44:47]
    ds_read2_b32 v[134:135], v236 offset0:146 offset1:147
    v_mfma_f32_16x16x32_bf16 v[44:47], v[64:67], v[108:111], v[44:47]
    s_add_u32 m0, s74, 8352
    ds_read_b128 v[168:171], v245 offset:10240
    v_mfma_f32_16x16x32_bf16 v[48:51], v[64:67], v[112:115], 0
    buffer_load_dwordx4 v240, s[48:51], s13 offen offset:0 lds
    ds_read2_b32 v[136:137], v237 offset0:16 offset1:17
    v_mfma_f32_16x16x32_bf16 v[48:51], v[68:71], v[108:111], v[48:51]
    v_mfma_f32_16x16x32_bf16 v[48:51], v[72:75], v[104:107], v[48:51]
    s_add_u32 m0, s73, 147456
    ds_read2_b32 v[138:139], v237 offset0:18 offset1:19
    v_mfma_f32_16x16x32_bf16 v[48:51], v[76:79], v[100:103], v[48:51]
    buffer_load_dwordx4 v5, s[52:55], s14 offen offset:1024 lds
    ds_read_b128 v[172:175], v245 offset:14336
    v_mfma_f32_16x16x32_bf16 v[48:51], v[80:83], v[96:99], v[48:51]
    v_mfma_f32_16x16x32_bf16 v[52:55], v[84:87], v[96:99], 0
    ds_read2_b32 v[140:141], v237 offset0:144 offset1:145
    v_mfma_f32_16x16x32_bf16 v[52:55], v[80:83], v[100:103], v[52:55]
    s_add_u32 m0, s74, 8352
    ds_read2_b32 v[142:143], v237 offset0:146 offset1:147
    v_mfma_f32_16x16x32_bf16 v[52:55], v[76:79], v[104:107], v[52:55]
    buffer_load_dwordx4 v240, s[48:51], s13 offen offset:1024 lds
    v_mfma_f32_16x16x32_bf16 v[52:55], v[72:75], v[108:111], v[52:55]
    ds_read_b128 v[176:179], v245 offset:18432
    v_mfma_f32_16x16x32_bf16 v[52:55], v[68:71], v[112:115], v[52:55]
    ds_read2_b32 v[144:145], v238 offset0:16 offset1:17
    v_mfma_f32_16x16x32_bf16 v[52:55], v[64:67], v[116:119], v[52:55]
    v_mfma_f32_16x16x32_bf16 v[56:59], v[64:67], v[120:123], 0
    ds_read2_b32 v[146:147], v238 offset0:18 offset1:19
    v_mfma_f32_16x16x32_bf16 v[56:59], v[68:71], v[116:119], v[56:59]
    ds_read_b128 v[180:183], v245 offset:22528
    v_mfma_f32_16x16x32_bf16 v[56:59], v[72:75], v[112:115], v[56:59]
    v_mfma_f32_16x16x32_bf16 v[56:59], v[76:79], v[108:111], v[56:59]
    s_add_u32 m0, s73, 147456
    ds_read2_b32 v[148:149], v238 offset0:144 offset1:145
    v_mfma_f32_16x16x32_bf16 v[56:59], v[80:83], v[104:107], v[56:59]
    buffer_load_dwordx4 v6, s[52:55], s14 offen offset:2048 lds
    ds_read2_b32 v[150:151], v238 offset0:146 offset1:147
    v_mfma_f32_16x16x32_bf16 v[56:59], v[84:87], v[100:103], v[56:59]
    s_add_u32 m0, s74, 8352
    ds_read_b128 v[184:187], v245 offset:26624
    v_mfma_f32_16x16x32_bf16 v[56:59], v[88:91], v[96:99], v[56:59]
    buffer_load_dwordx4 v240, s[48:51], s13 offen offset:2048 lds
    v_mfma_f32_16x16x32_bf16 v[60:63], v[92:95], v[96:99], 0
    ds_read2_b32 v[152:153], v239 offset0:16 offset1:17
    v_mfma_f32_16x16x32_bf16 v[60:63], v[88:91], v[100:103], v[60:63]
    ds_read2_b32 v[154:155], v239 offset0:18 offset1:19
    v_mfma_f32_16x16x32_bf16 v[60:63], v[84:87], v[104:107], v[60:63]
    v_mfma_f32_16x16x32_bf16 v[60:63], v[80:83], v[108:111], v[60:63]
    ds_read_b128 v[188:191], v245 offset:30720
    v_mfma_f32_16x16x32_bf16 v[60:63], v[76:79], v[112:115], v[60:63]
    s_add_u32 m0, s74, 8352
    ds_read2_b32 v[156:157], v239 offset0:144 offset1:145
    v_mfma_f32_16x16x32_bf16 v[60:63], v[72:75], v[116:119], v[60:63]
    buffer_load_dwordx4 v240, s[48:51], s13 offen offset:3072 lds
    v_mfma_f32_16x16x32_bf16 v[60:63], v[68:71], v[120:123], v[60:63]
    ds_read2_b32 v[158:159], v239 offset0:146 offset1:147
    v_mfma_f32_16x16x32_bf16 v[60:63], v[64:67], v[124:127], v[60:63]
    s_waitcnt lgkmcnt(12)
    v_mfma_f32_16x16x32_bf16 v[32:35], v[128:131], v[160:163], v[32:35]
    s_add_u32 m0, s73, 147456
    ds_read_b128 v[96:99], v246 offset:2048
    v_mfma_f32_16x16x32_bf16 v[36:39], v[132:135], v[160:163], v[36:39]
    buffer_load_dwordx4 v7, s[52:55], s14 offen offset:3072 lds
    v_mfma_f32_16x16x32_bf16 v[36:39], v[128:131], v[164:167], v[36:39]
    ds_read2_b32 v[64:65], v236 offset0:32 offset1:33
    v_mfma_f32_16x16x32_bf16 v[40:43], v[128:131], v[168:171], v[40:43]
    ds_read2_b32 v[66:67], v236 offset0:34 offset1:35
    v_mfma_f32_16x16x32_bf16 v[40:43], v[132:135], v[164:167], v[40:43]
    v_mfma_f32_16x16x32_bf16 v[40:43], v[136:139], v[160:163], v[40:43]
    ds_read_b128 v[100:103], v246 offset:6144
    v_mfma_f32_16x16x32_bf16 v[44:47], v[140:143], v[160:163], v[44:47]
    ds_read2_b32 v[68:69], v236 offset0:160 offset1:161
    v_mfma_f32_16x16x32_bf16 v[44:47], v[136:139], v[164:167], v[44:47]
    v_mfma_f32_16x16x32_bf16 v[44:47], v[132:135], v[168:171], v[44:47]
    ds_read2_b32 v[70:71], v236 offset0:162 offset1:163
    v_mfma_f32_16x16x32_bf16 v[44:47], v[128:131], v[172:175], v[44:47]
    ds_read_b128 v[104:107], v246 offset:10240
    s_waitcnt lgkmcnt(7)
    v_mfma_f32_16x16x32_bf16 v[48:51], v[128:131], v[176:179], v[48:51]
    ds_read2_b32 v[72:73], v237 offset0:32 offset1:33
    v_mfma_f32_16x16x32_bf16 v[48:51], v[132:135], v[172:175], v[48:51]
    ds_read2_b32 v[74:75], v237 offset0:34 offset1:35
    v_mfma_f32_16x16x32_bf16 v[48:51], v[136:139], v[168:171], v[48:51]
    v_mov_b32 v9, 8
    buffer_load_ushort v9, v9, s[56:59], s70 offen
    v_mfma_f32_16x16x32_bf16 v[48:51], v[140:143], v[164:167], v[48:51]
    ds_read_b128 v[108:111], v246 offset:14336
    v_mfma_f32_16x16x32_bf16 v[48:51], v[144:147], v[160:163], v[48:51]
    v_mfma_f32_16x16x32_bf16 v[52:55], v[148:151], v[160:163], v[52:55]
    ds_read2_b32 v[76:77], v237 offset0:160 offset1:161
    v_mfma_f32_16x16x32_bf16 v[52:55], v[144:147], v[164:167], v[52:55]
    ds_read2_b32 v[78:79], v237 offset0:162 offset1:163
    v_mfma_f32_16x16x32_bf16 v[52:55], v[140:143], v[168:171], v[52:55]
    v_mfma_f32_16x16x32_bf16 v[52:55], v[136:139], v[172:175], v[52:55]
    ds_read_b128 v[112:115], v246 offset:18432
    v_mfma_f32_16x16x32_bf16 v[52:55], v[132:135], v[176:179], v[52:55]
    ds_read2_b32 v[80:81], v238 offset0:32 offset1:33
    v_mfma_f32_16x16x32_bf16 v[52:55], v[128:131], v[180:183], v[52:55]
    v_mfma_f32_16x16x32_bf16 v[56:59], v[128:131], v[184:187], v[56:59]
    ds_read2_b32 v[82:83], v238 offset0:34 offset1:35
    v_mfma_f32_16x16x32_bf16 v[56:59], v[132:135], v[180:183], v[56:59]
    ds_read_b128 v[116:119], v246 offset:22528
    v_mfma_f32_16x16x32_bf16 v[56:59], v[136:139], v[176:179], v[56:59]
    v_mfma_f32_16x16x32_bf16 v[56:59], v[140:143], v[172:175], v[56:59]
    ds_read2_b32 v[84:85], v238 offset0:160 offset1:161
    v_mfma_f32_16x16x32_bf16 v[56:59], v[144:147], v[168:171], v[56:59]
    ds_read2_b32 v[86:87], v238 offset0:162 offset1:163
    v_mfma_f32_16x16x32_bf16 v[56:59], v[148:151], v[164:167], v[56:59]
    ds_read_b128 v[120:123], v246 offset:26624
    v_mfma_f32_16x16x32_bf16 v[56:59], v[152:155], v[160:163], v[56:59]
    v_mfma_f32_16x16x32_bf16 v[60:63], v[156:159], v[160:163], v[60:63]
    ds_read2_b32 v[88:89], v239 offset0:32 offset1:33
    v_mfma_f32_16x16x32_bf16 v[60:63], v[152:155], v[164:167], v[60:63]
    ds_read2_b32 v[90:91], v239 offset0:34 offset1:35
    v_mfma_f32_16x16x32_bf16 v[60:63], v[148:151], v[168:171], v[60:63]
    v_mfma_f32_16x16x32_bf16 v[60:63], v[144:147], v[172:175], v[60:63]
    ds_read_b128 v[124:127], v246 offset:30720
    v_mfma_f32_16x16x32_bf16 v[60:63], v[140:143], v[176:179], v[60:63]
    ds_read2_b32 v[92:93], v239 offset0:160 offset1:161
    v_mfma_f32_16x16x32_bf16 v[60:63], v[136:139], v[180:183], v[60:63]
    v_mfma_f32_16x16x32_bf16 v[60:63], v[132:135], v[184:187], v[60:63]
    ds_read2_b32 v[94:95], v239 offset0:162 offset1:163
    v_mfma_f32_16x16x32_bf16 v[60:63], v[128:131], v[188:191], v[60:63]
    s_waitcnt lgkmcnt(12)
    v_mfma_f32_16x16x32_bf16 v[32:35], v[64:67], v[96:99], v[32:35]
    s_lshl_b32 s14, s85, 18
    ds_read_b128 v[160:163], v247 offset:2048
    v_mfma_f32_16x16x32_bf16 v[36:39], v[68:71], v[96:99], v[36:39]
    s_add_u32 m0, s73, 49152
    v_mfma_f32_16x16x32_bf16 v[36:39], v[64:67], v[100:103], v[36:39]
    buffer_load_dwordx4 v4, s[52:55], s14 offen offset:0 lds
    ds_read2_b32 v[128:129], v236 offset0:48 offset1:49
    v_mfma_f32_16x16x32_bf16 v[40:43], v[64:67], v[104:107], v[40:43]
    ds_read2_b32 v[130:131], v236 offset0:50 offset1:51
    v_mfma_f32_16x16x32_bf16 v[40:43], v[68:71], v[100:103], v[40:43]
    v_mfma_f32_16x16x32_bf16 v[40:43], v[72:75], v[96:99], v[40:43]
    ds_read_b128 v[164:167], v247 offset:6144
    v_mfma_f32_16x16x32_bf16 v[44:47], v[76:79], v[96:99], v[44:47]
    ds_read2_b32 v[132:133], v236 offset0:176 offset1:177
    v_mfma_f32_16x16x32_bf16 v[44:47], v[72:75], v[100:103], v[44:47]
    v_mfma_f32_16x16x32_bf16 v[44:47], v[68:71], v[104:107], v[44:47]
    ds_read2_b32 v[134:135], v236 offset0:178 offset1:179
    v_mfma_f32_16x16x32_bf16 v[44:47], v[64:67], v[108:111], v[44:47]
    ds_read_b128 v[168:171], v247 offset:10240
    s_waitcnt lgkmcnt(7)
    v_mfma_f32_16x16x32_bf16 v[48:51], v[64:67], v[112:115], v[48:51]
    ds_read2_b32 v[136:137], v237 offset0:48 offset1:49
    v_mfma_f32_16x16x32_bf16 v[48:51], v[68:71], v[108:111], v[48:51]
    v_mfma_f32_16x16x32_bf16 v[48:51], v[72:75], v[104:107], v[48:51]
    s_add_u32 m0, s73, 49152
    ds_read2_b32 v[138:139], v237 offset0:50 offset1:51
    v_mfma_f32_16x16x32_bf16 v[48:51], v[76:79], v[100:103], v[48:51]
    buffer_load_dwordx4 v5, s[52:55], s14 offen offset:1024 lds
    ds_read_b128 v[172:175], v247 offset:14336
    v_mfma_f32_16x16x32_bf16 v[48:51], v[80:83], v[96:99], v[48:51]
    v_mfma_f32_16x16x32_bf16 v[52:55], v[84:87], v[96:99], v[52:55]
    ds_read2_b32 v[140:141], v237 offset0:176 offset1:177
    v_mfma_f32_16x16x32_bf16 v[52:55], v[80:83], v[100:103], v[52:55]
    ds_read2_b32 v[142:143], v237 offset0:178 offset1:179
    v_mfma_f32_16x16x32_bf16 v[52:55], v[76:79], v[104:107], v[52:55]
    v_mfma_f32_16x16x32_bf16 v[52:55], v[72:75], v[108:111], v[52:55]
    ds_read_b128 v[176:179], v247 offset:18432
    v_mfma_f32_16x16x32_bf16 v[52:55], v[68:71], v[112:115], v[52:55]
    ds_read2_b32 v[144:145], v238 offset0:48 offset1:49
    v_mfma_f32_16x16x32_bf16 v[52:55], v[64:67], v[116:119], v[52:55]
    v_mfma_f32_16x16x32_bf16 v[56:59], v[64:67], v[120:123], v[56:59]
    ds_read2_b32 v[146:147], v238 offset0:50 offset1:51
    v_mfma_f32_16x16x32_bf16 v[56:59], v[68:71], v[116:119], v[56:59]
    ds_read_b128 v[180:183], v247 offset:22528
    v_mfma_f32_16x16x32_bf16 v[56:59], v[72:75], v[112:115], v[56:59]
    v_mfma_f32_16x16x32_bf16 v[56:59], v[76:79], v[108:111], v[56:59]
    s_add_u32 m0, s73, 49152
    ds_read2_b32 v[148:149], v238 offset0:176 offset1:177
    v_mfma_f32_16x16x32_bf16 v[56:59], v[80:83], v[104:107], v[56:59]
    buffer_load_dwordx4 v6, s[52:55], s14 offen offset:2048 lds
    ds_read2_b32 v[150:151], v238 offset0:178 offset1:179
    v_mfma_f32_16x16x32_bf16 v[56:59], v[84:87], v[100:103], v[56:59]
    ds_read_b128 v[184:187], v247 offset:26624
    v_mfma_f32_16x16x32_bf16 v[56:59], v[88:91], v[96:99], v[56:59]
    v_mfma_f32_16x16x32_bf16 v[60:63], v[92:95], v[96:99], v[60:63]
    ds_read2_b32 v[152:153], v239 offset0:48 offset1:49
    v_mfma_f32_16x16x32_bf16 v[60:63], v[88:91], v[100:103], v[60:63]
    ds_read2_b32 v[154:155], v239 offset0:50 offset1:51
    v_mfma_f32_16x16x32_bf16 v[60:63], v[84:87], v[104:107], v[60:63]
    v_mfma_f32_16x16x32_bf16 v[60:63], v[80:83], v[108:111], v[60:63]
    ds_read_b128 v[188:191], v247 offset:30720
    v_mfma_f32_16x16x32_bf16 v[60:63], v[76:79], v[112:115], v[60:63]
    ds_read2_b32 v[156:157], v239 offset0:176 offset1:177
    v_mfma_f32_16x16x32_bf16 v[60:63], v[72:75], v[116:119], v[60:63]
    v_mfma_f32_16x16x32_bf16 v[60:63], v[68:71], v[120:123], v[60:63]
    ds_read2_b32 v[158:159], v239 offset0:178 offset1:179
    v_mfma_f32_16x16x32_bf16 v[60:63], v[64:67], v[124:127], v[60:63]
    s_waitcnt lgkmcnt(12)
    v_mfma_f32_16x16x32_bf16 v[32:35], v[128:131], v[160:163], v[32:35]
    s_add_u32 m0, s73, 49152
    ds_read_b128 v[96:99], v244 offset:0
    v_mfma_f32_16x16x32_bf16 v[36:39], v[132:135], v[160:163], v[36:39]
    buffer_load_dwordx4 v7, s[52:55], s14 offen offset:3072 lds
    v_mfma_f32_16x16x32_bf16 v[36:39], v[128:131], v[164:167], v[36:39]
    ds_read2_b32 v[64:65], v236 offset0:64 offset1:65
    v_mfma_f32_16x16x32_bf16 v[40:43], v[128:131], v[168:171], v[40:43]
    ds_read2_b32 v[66:67], v236 offset0:66 offset1:67
    v_mfma_f32_16x16x32_bf16 v[40:43], v[132:135], v[164:167], v[40:43]
    v_mfma_f32_16x16x32_bf16 v[40:43], v[136:139], v[160:163], v[40:43]
    ds_read_b128 v[100:103], v244 offset:4096
    v_mfma_f32_16x16x32_bf16 v[44:47], v[140:143], v[160:163], v[44:47]
    ds_read2_b32 v[68:69], v236 offset0:192 offset1:193
    v_mfma_f32_16x16x32_bf16 v[44:47], v[136:139], v[164:167], v[44:47]
    v_mfma_f32_16x16x32_bf16 v[44:47], v[132:135], v[168:171], v[44:47]
    ds_read2_b32 v[70:71], v236 offset0:194 offset1:195
    v_mfma_f32_16x16x32_bf16 v[44:47], v[128:131], v[172:175], v[44:47]
    ds_read_b128 v[104:107], v244 offset:8192
    s_waitcnt lgkmcnt(7)
    v_mfma_f32_16x16x32_bf16 v[48:51], v[128:131], v[176:179], v[48:51]
    ds_read2_b32 v[72:73], v237 offset0:64 offset1:65
    v_mfma_f32_16x16x32_bf16 v[48:51], v[132:135], v[172:175], v[48:51]
    ds_read2_b32 v[74:75], v237 offset0:66 offset1:67
    v_mfma_f32_16x16x32_bf16 v[48:51], v[136:139], v[168:171], v[48:51]
    ds_read_b128 v[108:111], v244 offset:12288
    v_mfma_f32_16x16x32_bf16 v[48:51], v[140:143], v[164:167], v[48:51]
    ds_read2_b32 v[76:77], v237 offset0:192 offset1:193
    v_mfma_f32_16x16x32_bf16 v[48:51], v[144:147], v[160:163], v[48:51]
    ds_read2_b32 v[78:79], v237 offset0:194 offset1:195
    v_mfma_f32_16x16x32_bf16 v[52:55], v[148:151], v[160:163], v[52:55]
    ds_read_b128 v[112:115], v244 offset:16384
    v_mfma_f32_16x16x32_bf16 v[52:55], v[144:147], v[164:167], v[52:55]
    ds_read2_b32 v[80:81], v238 offset0:64 offset1:65
    v_mfma_f32_16x16x32_bf16 v[52:55], v[140:143], v[168:171], v[52:55]
    ds_read2_b32 v[82:83], v238 offset0:66 offset1:67
    v_mfma_f32_16x16x32_bf16 v[52:55], v[136:139], v[172:175], v[52:55]
    ds_read_b128 v[116:119], v244 offset:20480
    v_mfma_f32_16x16x32_bf16 v[52:55], v[132:135], v[176:179], v[52:55]
    ds_read2_b32 v[84:85], v238 offset0:192 offset1:193
    v_mfma_f32_16x16x32_bf16 v[52:55], v[128:131], v[180:183], v[52:55]
    ds_read2_b32 v[86:87], v238 offset0:194 offset1:195
    v_mfma_f32_16x16x32_bf16 v[56:59], v[128:131], v[184:187], v[56:59]
    ds_read_b128 v[120:123], v244 offset:24576
    s_waitcnt vmcnt(5)
    s_barrier
    v_mfma_f32_16x16x32_bf16 v[56:59], v[132:135], v[180:183], v[56:59]
    ds_read2_b32 v[88:89], v239 offset0:64 offset1:65
    v_mfma_f32_16x16x32_bf16 v[56:59], v[136:139], v[176:179], v[56:59]
    ds_read_b64_tr_b16 a[0:1], v10 offset:16384
    v_mfma_f32_16x16x32_bf16 v[56:59], v[140:143], v[172:175], v[56:59]
    ds_read_b64_tr_b16 a[2:3], v10 offset:18432
    v_mfma_f32_16x16x32_bf16 v[56:59], v[144:147], v[168:171], v[56:59]
    ds_read_b64_tr_b16 a[8:9], v10 offset:20480
    v_mfma_f32_16x16x32_bf16 v[56:59], v[148:151], v[164:167], v[56:59]
    ds_read2_b32 v[90:91], v239 offset0:66 offset1:67
    v_mfma_f32_16x16x32_bf16 v[56:59], v[152:155], v[160:163], v[56:59]
    ds_read_b64_tr_b16 a[10:11], v10 offset:22528
    v_mfma_f32_16x16x32_bf16 v[60:63], v[156:159], v[160:163], v[60:63]
    ds_read_b64_tr_b16 a[4:5], v11 offset:16384
    v_mfma_f32_16x16x32_bf16 v[60:63], v[152:155], v[164:167], v[60:63]
    ds_read_b128 v[124:127], v244 offset:28672
    v_mfma_f32_16x16x32_bf16 v[60:63], v[148:151], v[168:171], v[60:63]
    ds_read_b64_tr_b16 a[6:7], v11 offset:18432
    v_mfma_f32_16x16x32_bf16 v[60:63], v[144:147], v[172:175], v[60:63]
    ds_read_b64_tr_b16 a[12:13], v11 offset:20480
    v_mfma_f32_16x16x32_bf16 v[60:63], v[140:143], v[176:179], v[60:63]
    ds_read2_b32 v[92:93], v239 offset0:192 offset1:193
    v_mfma_f32_16x16x32_bf16 v[60:63], v[136:139], v[180:183], v[60:63]
    ds_read_b64_tr_b16 a[14:15], v11 offset:22528
    v_mfma_f32_16x16x32_bf16 v[60:63], v[132:135], v[184:187], v[60:63]
    ds_read2_b32 v[94:95], v239 offset0:194 offset1:195
    v_mfma_f32_16x16x32_bf16 v[60:63], v[128:131], v[188:191], v[60:63]
    s_waitcnt lgkmcnt(15)
    v_mfma_f32_16x16x32_bf16 v[32:35], v[64:67], v[96:99], v[32:35]
    ds_read_b128 v[160:163], v245 offset:0
    s_waitcnt lgkmcnt(2)
    s_barrier
    v_mfma_f32_16x16x32_bf16 v[36:39], v[68:71], v[96:99], v[36:39]
    v_mfma_f32_16x16x32_bf16 v[36:39], v[64:67], v[100:103], v[36:39]
    ds_read2_b32 v[128:129], v236 offset0:80 offset1:81
    v_mfma_f32_16x16x32_bf16 v[40:43], v[64:67], v[104:107], v[40:43]
    s_lshl_b32 s14, s86, 18
    ds_read2_b32 v[130:131], v236 offset0:82 offset1:83
    v_mfma_f32_16x16x32_bf16 v[40:43], v[68:71], v[100:103], v[40:43]
    s_add_u32 m0, s73, 147456
    v_mfma_f32_16x16x32_bf16 v[40:43], v[72:75], v[96:99], v[40:43]
    buffer_load_dwordx4 v4, s[52:55], s14 offen offset:0 lds
    ds_read_b128 v[164:167], v245 offset:4096
    v_mfma_f32_16x16x32_bf16 v[44:47], v[76:79], v[96:99], v[44:47]
    ds_read2_b32 v[132:133], v236 offset0:208 offset1:209
    v_mfma_f32_16x16x32_bf16 v[44:47], v[72:75], v[100:103], v[44:47]
    v_mfma_f32_16x16x32_bf16 v[44:47], v[68:71], v[104:107], v[44:47]
    ds_read2_b32 v[134:135], v236 offset0:210 offset1:211
    v_mfma_f32_16x16x32_bf16 v[44:47], v[64:67], v[108:111], v[44:47]
    ds_read_b128 v[168:171], v245 offset:8192
    s_waitcnt lgkmcnt(7)
    v_mfma_f32_16x16x32_bf16 v[48:51], v[64:67], v[112:115], v[48:51]
    ds_read2_b32 v[136:137], v237 offset0:80 offset1:81
    v_mfma_f32_16x16x32_bf16 v[48:51], v[68:71], v[108:111], v[48:51]
    ds_read2_b32 v[138:139], v237 offset0:82 offset1:83
    v_mfma_f32_16x16x32_bf16 v[48:51], v[72:75], v[104:107], v[48:51]
    ds_read_b128 v[172:175], v245 offset:12288
    v_mfma_f32_16x16x32_bf16 v[48:51], v[76:79], v[100:103], v[48:51]
    ds_read2_b32 v[140:141], v237 offset0:208 offset1:209
    v_mfma_f32_16x16x32_bf16 v[48:51], v[80:83], v[96:99], v[48:51]
    ds_read2_b32 v[142:143], v237 offset0:210 offset1:211
    v_mfma_f32_16x16x32_bf16 v[52:55], v[84:87], v[96:99], v[52:55]
    ds_read_b128 v[176:179], v245 offset:16384
    v_mfma_f32_16x16x32_bf16 v[52:55], v[80:83], v[100:103], v[52:55]
    s_add_u32 m0, s73, 147456
    ds_read2_b32 v[144:145], v238 offset0:80 offset1:81
    v_mfma_f32_16x16x32_bf16 v[52:55], v[76:79], v[104:107], v[52:55]
    buffer_load_dwordx4 v5, s[52:55], s14 offen offset:1024 lds
    ds_read2_b32 v[146:147], v238 offset0:82 offset1:83
    v_mfma_f32_16x16x32_bf16 v[52:55], v[72:75], v[108:111], v[52:55]
    ds_read_b128 v[180:183], v245 offset:20480
    v_mfma_f32_16x16x32_bf16 v[52:55], v[68:71], v[112:115], v[52:55]
    ds_read_b128 v[212:215], v241 offset:8352
    v_mfma_f32_16x16x32_bf16 v[52:55], v[64:67], v[116:119], v[52:55]
    ds_read2_b32 v[148:149], v238 offset0:208 offset1:209
    v_mfma_f32_16x16x32_bf16 v[56:59], v[64:67], v[120:123], v[56:59]
    ds_read_b32 v216, v241 offset:8368
    v_mfma_f32_16x16x32_bf16 v[56:59], v[68:71], v[116:119], v[56:59]
    ds_read2_b32 v[150:151], v238 offset0:210 offset1:211
    v_mfma_f32_16x16x32_bf16 v[56:59], v[72:75], v[112:115], v[56:59]
    ds_read_b128 v[218:221], v241 offset:9376
    v_mfma_f32_16x16x32_bf16 v[56:59], v[76:79], v[108:111], v[56:59]
    ds_read_b128 v[184:187], v245 offset:24576
    v_mfma_f32_16x16x32_bf16 v[56:59], v[80:83], v[104:107], v[56:59]
    ds_read2_b32 v[152:153], v239 offset0:80 offset1:81
    v_mfma_f32_16x16x32_bf16 v[56:59], v[84:87], v[100:103], v[56:59]
    ds_read_b32 v222, v241 offset:9392
    v_mfma_f32_16x16x32_bf16 v[56:59], v[88:91], v[96:99], v[56:59]
    ds_read2_b32 v[154:155], v239 offset0:82 offset1:83
    v_mfma_f32_16x16x32_bf16 v[60:63], v[92:95], v[96:99], v[60:63]
    s_add_u32 m0, s73, 147456
    ds_read_b128 v[224:227], v241 offset:10400
    v_mfma_f32_16x16x32_bf16 v[60:63], v[88:91], v[100:103], v[60:63]
    buffer_load_dwordx4 v6, s[52:55], s14 offen offset:2048 lds
    ds_read_b128 v[188:191], v245 offset:28672
    v_mfma_f32_16x16x32_bf16 v[60:63], v[84:87], v[104:107], v[60:63]
    ds_read_b32 v228, v241 offset:10416
    v_mfma_f32_16x16x32_bf16 v[60:63], v[80:83], v[108:111], v[60:63]
    ds_read2_b32 v[156:157], v239 offset0:208 offset1:209
    v_mfma_f32_16x16x32_bf16 v[60:63], v[76:79], v[112:115], v[60:63]
    ds_read_b128 v[230:233], v241 offset:11424
    v_mfma_f32_16x16x32_bf16 v[60:63], v[72:75], v[116:119], v[60:63]
    ds_read2_b32 v[158:159], v239 offset0:210 offset1:211
    v_mfma_f32_16x16x32_bf16 v[60:63], v[68:71], v[120:123], v[60:63]
    ds_read_b32 v234, v241 offset:11440
    v_mfma_f32_16x16x32_bf16 v[60:63], v[64:67], v[124:127], v[60:63]
    s_waitcnt lgkmcnt(15)
    v_mfma_f32_16x16x32_bf16 v[32:35], v[128:131], v[160:163], v[32:35]
    ds_read_b128 v[96:99], v246 offset:0
    v_mfma_f32_16x16x32_bf16 v[36:39], v[132:135], v[160:163], v[36:39]
    ds_read2_b32 v[64:65], v236 offset0:96 offset1:97
    v_mfma_f32_16x16x32_bf16 v[36:39], v[128:131], v[164:167], v[36:39]
    ds_read2_b32 v[66:67], v236 offset0:98 offset1:99
    v_mfma_f32_16x16x32_bf16 v[40:43], v[128:131], v[168:171], v[40:43]
    s_add_u32 m0, s73, 147456
    ds_read_b128 v[100:103], v246 offset:4096
    v_mfma_f32_16x16x32_bf16 v[40:43], v[132:135], v[164:167], v[40:43]
    buffer_load_dwordx4 v7, s[52:55], s14 offen offset:3072 lds
    ds_read2_b32 v[68:69], v236 offset0:224 offset1:225
    s_waitcnt lgkmcnt(5)
    v_mfma_f32_16x16x32_bf16 v[40:43], v[136:139], v[160:163], v[40:43]
    ds_read2_b32 v[70:71], v236 offset0:226 offset1:227
    v_mfma_f32_16x16x32_bf16 v[44:47], v[140:143], v[160:163], v[44:47]
    s_waitcnt vmcnt(8)
    ds_read_b128 v[104:107], v246 offset:8192
    v_mfma_f32_16x16x32_bf16 v[44:47], v[136:139], v[164:167], v[44:47]
    ds_read2_b32 v[72:73], v237 offset0:96 offset1:97
    v_mfma_f32_16x16x32_bf16 v[44:47], v[132:135], v[168:171], v[44:47]
    ds_read2_b32 v[74:75], v237 offset0:98 offset1:99
    v_lshlrev_b32 v9, 16, v9
    v_mfma_f32_16x16x32_bf16 v[44:47], v[128:131], v[172:175], v[44:47]
    ds_read_b128 v[108:111], v246 offset:12288
    v_mfma_f32_16x16x32_bf16 v[48:51], v[128:131], v[176:179], v[48:51]
    ds_read2_b32 v[76:77], v237 offset0:224 offset1:225
    v_lshlrev_b32 v208, 16, v212
    v_mfma_f32_16x16x32_bf16 v[48:51], v[132:135], v[172:175], v[48:51]
    ds_read2_b32 v[78:79], v237 offset0:226 offset1:227
    v_mfma_f32_16x16x32_bf16 v[48:51], v[136:139], v[168:171], v[48:51]
    ds_read_b128 v[112:115], v246 offset:16384
    v_add_f32 v9, v9, v208
    v_mfma_f32_16x16x32_bf16 v[48:51], v[140:143], v[164:167], v[48:51]
    ds_read2_b32 v[80:81], v238 offset0:96 offset1:97
    v_cvt_pk_bf16_f32 v9, v9, v9
    v_mfma_f32_16x16x32_bf16 v[48:51], v[144:147], v[160:163], v[48:51]
    ds_read2_b32 v[82:83], v238 offset0:98 offset1:99
    v_mfma_f32_16x16x32_bf16 v[52:55], v[148:151], v[160:163], v[52:55]
    ds_write_b16 v242, v9 offset:12480
    v_mfma_f32_16x16x32_bf16 v[52:55], v[144:147], v[164:167], v[52:55]
    ds_read_b128 v[116:119], v246 offset:20480
    v_mfma_f32_16x16x32_bf16 v[52:55], v[140:143], v[168:171], v[52:55]
    ds_write_b16 v242, v9 offset:8322
    v_mfma_f32_16x16x32_bf16 v[52:55], v[136:139], v[172:175], v[52:55]
    ds_read2_b32 v[84:85], v238 offset0:224 offset1:225
    v_mfma_f32_16x16x32_bf16 v[52:55], v[132:135], v[176:179], v[52:55]
    ds_read2_b32 v[86:87], v238 offset0:226 offset1:227
    v_alignbit_b32 v212, v213, v212, 16
    v_mfma_f32_16x16x32_bf16 v[52:55], v[128:131], v[180:183], v[52:55]
    ds_read_b128 v[120:123], v246 offset:24576
    v_alignbit_b32 v213, v214, v213, 16
    v_mfma_f32_16x16x32_bf16 v[56:59], v[128:131], v[184:187], v[56:59]
    ds_read2_b32 v[88:89], v239 offset0:96 offset1:97
    s_waitcnt vmcnt(4)
    s_barrier
    v_mfma_f32_16x16x32_bf16 v[56:59], v[132:135], v[180:183], v[56:59]
    v_add_u32 v10, -131072, v10
    v_alignbit_b32 v214, v215, v214, 16
    v_mfma_f32_16x16x32_bf16 v[56:59], v[136:139], v[176:179], v[56:59]
    ds_read_b64_tr_b16 a[16:17], v10 offset:49152
    v_alignbit_b32 v215, v216, v215, 16
    v_mfma_f32_16x16x32_bf16 v[56:59], v[140:143], v[172:175], v[56:59]
    ds_write_b128 v241, v[212:215] offset:12512
    v_mfma_f32_16x16x32_bf16 v[56:59], v[144:147], v[168:171], v[56:59]
    ds_read_b64_tr_b16 a[18:19], v10 offset:51200
    v_mfma_f32_16x16x32_bf16 v[56:59], v[148:151], v[164:167], v[56:59]
    ds_read_b64_tr_b16 a[24:25], v10 offset:53248
    v_mfma_f32_16x16x32_bf16 v[56:59], v[152:155], v[160:163], v[56:59]
    ds_read_b64_tr_b16 a[26:27], v10 offset:55296
    v_mfma_f32_16x16x32_bf16 v[60:63], v[156:159], v[160:163], v[60:63]
    ds_read2_b32 v[90:91], v239 offset0:98 offset1:99
    v_add_u32 v11, -131072, v11
    v_alignbit_b32 v218, v219, v218, 16
    v_mfma_f32_16x16x32_bf16 v[60:63], v[152:155], v[164:167], v[60:63]
    ds_read_b64_tr_b16 a[20:21], v11 offset:49152
    v_alignbit_b32 v219, v220, v219, 16
    v_mfma_f32_16x16x32_bf16 v[60:63], v[148:151], v[168:171], v[60:63]
    ds_read_b128 v[124:127], v246 offset:28672
    ds_read2_b32 v[92:93], v239 offset0:224 offset1:225
    v_mfma_f32_16x16x32_bf16 v[60:63], v[144:147], v[172:175], v[60:63]
    ds_read_b64_tr_b16 a[22:23], v11 offset:51200
    v_alignbit_b32 v220, v221, v220, 16
    v_mfma_f32_16x16x32_bf16 v[60:63], v[140:143], v[176:179], v[60:63]
    ds_read_b64_tr_b16 a[28:29], v11 offset:53248
    ds_read2_b32 v[94:95], v239 offset0:226 offset1:227
    v_mfma_f32_16x16x32_bf16 v[60:63], v[136:139], v[180:183], v[60:63]
    ds_read_b64_tr_b16 a[30:31], v11 offset:55296
    v_alignbit_b32 v221, v222, v221, 16
    v_mfma_f32_16x16x32_bf16 v[60:63], v[132:135], v[184:187], v[60:63]
    ds_write_b128 v241, v[218:221] offset:13536
    v_mfma_f32_16x16x32_bf16 v[60:63], v[128:131], v[188:191], v[60:63]
    s_waitcnt lgkmcnt(15)
    v_mfma_f32_16x16x32_bf16 v[32:35], v[64:67], v[96:99], v[32:35]
    ds_read_b128 v[160:163], v247 offset:0
    s_waitcnt lgkmcnt(2)
    s_barrier
    v_mfma_f32_16x16x32_bf16 v[36:39], v[68:71], v[96:99], v[36:39]
    v_alignbit_b32 v224, v225, v224, 16
    v_mfma_f32_16x16x32_bf16 v[36:39], v[64:67], v[100:103], v[36:39]
    ds_read_b128 v[164:167], v247 offset:4096
    v_mfma_f32_16x16x32_bf16 v[40:43], v[64:67], v[104:107], v[40:43]
    s_lshl_b32 s14, s87, 18
    ds_read_b128 v[168:171], v247 offset:8192
L_pl_X_2:
    s_cbranch_execz L_pl_X_6
    v_mfma_f32_16x16x32_bf16 v[40:43], v[68:71], v[100:103], v[40:43]
    s_add_u32 m0, s73, 49152
    ds_read_b128 v[172:175], v247 offset:12288
    v_mfma_f32_16x16x32_bf16 v[40:43], v[72:75], v[96:99], v[40:43]
    buffer_load_dwordx4 v4, s[52:55], s14 offen offset:0 lds
    v_alignbit_b32 v225, v226, v225, 16
    v_mfma_f32_16x16x32_bf16 v[44:47], v[76:79], v[96:99], v[44:47]
    ds_read_b128 v[176:179], v247 offset:16384
    v_mfma_f32_16x16x32_bf16 v[44:47], v[72:75], v[100:103], v[44:47]
    ds_read_b128 v[180:183], v247 offset:20480
    v_mfma_f32_16x16x32_bf16 v[44:47], v[68:71], v[104:107], v[44:47]
    ds_read_b128 v[184:187], v247 offset:24576
    v_mfma_f32_16x16x32_bf16 v[44:47], v[64:67], v[108:111], v[44:47]
    v_alignbit_b32 v226, v227, v226, 16
    v_mfma_f32_16x16x32_bf16 v[48:51], v[64:67], v[112:115], v[48:51]
    ds_read_b128 v[188:191], v247 offset:28672
    v_mfma_f32_16x16x32_bf16 v[48:51], v[68:71], v[108:111], v[48:51]
    ds_read2_b32 v[128:129], v236 offset0:112 offset1:113
    v_mfma_f32_16x16x32_bf16 v[48:51], v[72:75], v[104:107], v[48:51]
    v_alignbit_b32 v227, v228, v227, 16
    v_mfma_f32_16x16x32_bf16 v[48:51], v[76:79], v[100:103], v[48:51]
    ds_read2_b32 v[130:131], v236 offset0:114 offset1:115
    v_mfma_f32_16x16x32_bf16 v[48:51], v[80:83], v[96:99], v[48:51]
    ds_read2_b32 v[132:133], v236 offset0:240 offset1:241
    v_mfma_f32_16x16x32_bf16 v[52:55], v[84:87], v[96:99], v[52:55]
    ds_write_b128 v241, v[224:227] offset:14560
    v_mfma_f32_16x16x32_bf16 v[52:55], v[80:83], v[100:103], v[52:55]
    s_add_u32 m0, s73, 49152
    ds_read2_b32 v[134:135], v236 offset0:242 offset1:243
    v_mfma_f32_16x16x32_bf16 v[52:55], v[76:79], v[104:107], v[52:55]
    buffer_load_dwordx4 v5, s[52:55], s14 offen offset:1024 lds
    ds_read2_b32 v[136:137], v237 offset0:112 offset1:113
    v_mfma_f32_16x16x32_bf16 v[52:55], v[72:75], v[108:111], v[52:55]
    s_add_u32 s6, s12, 4718592
    ds_read2_b32 v[138:139], v237 offset0:114 offset1:115
    v_mfma_f32_16x16x32_bf16 v[52:55], v[68:71], v[112:115], v[52:55]
    ds_read2_b32 v[140:141], v237 offset0:240 offset1:241
    v_alignbit_b32 v230, v231, v230, 16
    v_mfma_f32_16x16x32_bf16 v[52:55], v[64:67], v[116:119], v[52:55]
    ds_read2_b32 v[142:143], v237 offset0:242 offset1:243
    v_xor_b32 v244, 64, v244
    v_mfma_f32_16x16x32_bf16 v[56:59], v[64:67], v[120:123], v[56:59]
    ds_read2_b32 v[144:145], v238 offset0:112 offset1:113
    v_mfma_f32_16x16x32_bf16 v[56:59], v[68:71], v[116:119], v[56:59]
    ds_read2_b32 v[146:147], v238 offset0:114 offset1:115
    v_mfma_f32_16x16x32_bf16 v[56:59], v[72:75], v[112:115], v[56:59]
    ds_read2_b32 v[148:149], v238 offset0:240 offset1:241
    v_alignbit_b32 v231, v232, v231, 16
    v_mfma_f32_16x16x32_bf16 v[56:59], v[76:79], v[108:111], v[56:59]
    ds_read2_b32 v[150:151], v238 offset0:242 offset1:243
    v_xor_b32 v245, 64, v245
    v_mfma_f32_16x16x32_bf16 v[56:59], v[80:83], v[104:107], v[56:59]
    ds_read2_b32 v[152:153], v239 offset0:112 offset1:113
    v_mfma_f32_16x16x32_bf16 v[56:59], v[84:87], v[100:103], v[56:59]
    ds_read2_b32 v[154:155], v239 offset0:114 offset1:115
    v_mfma_f32_16x16x32_bf16 v[56:59], v[88:91], v[96:99], v[56:59]
    ds_read2_b32 v[156:157], v239 offset0:240 offset1:241
    v_alignbit_b32 v232, v233, v232, 16
    v_mfma_f32_16x16x32_bf16 v[60:63], v[92:95], v[96:99], v[60:63]
    s_add_u32 m0, s73, 49152
    ds_read2_b32 v[158:159], v239 offset0:242 offset1:243
    v_mfma_f32_16x16x32_bf16 v[60:63], v[88:91], v[100:103], v[60:63]
    buffer_load_dwordx4 v6, s[52:55], s14 offen offset:2048 lds
    v_xor_b32 v246, 64, v246
    v_mfma_f32_16x16x32_bf16 v[60:63], v[84:87], v[104:107], v[60:63]
    v_alignbit_b32 v233, v234, v233, 16
    v_add_u32 v236, 8320, v236
    v_mfma_f32_16x16x32_bf16 v[60:63], v[80:83], v[108:111], v[60:63]
    v_add_u32 v237, 8320, v237
    v_mfma_f32_16x16x32_bf16 v[60:63], v[76:79], v[112:115], v[60:63]
    v_mfma_f32_16x16x32_bf16 v[60:63], v[72:75], v[116:119], v[60:63]
    v_xor_b32 v247, 64, v247
    v_add_u32 v238, 8320, v238
    v_mfma_f32_16x16x32_bf16 v[60:63], v[68:71], v[120:123], v[60:63]
    ds_write_b128 v241, v[230:233] offset:15584
    v_mfma_f32_16x16x32_bf16 v[60:63], v[64:67], v[124:127], v[60:63]
    v_add_u32 v239, 8320, v239
    s_waitcnt lgkmcnt(1)
    v_mfma_f32_16x16x32_bf16 v[60:63], v[128:131], v[188:191], v[60:63]
    ds_read_b128 v[96:99], v244 offset:2048
    v_mfma_f32_16x16x32_bf16 v[60:63], v[132:135], v[184:187], v[60:63]
    ds_read2_b32 v[64:65], v236 offset0:0 offset1:1
    v_mfma_f32_16x16x32_bf16 v[60:63], v[136:139], v[180:183], v[60:63]
    ds_read2_b32 v[66:67], v236 offset0:2 offset1:3
    v_mfma_f32_16x16x32_bf16 v[60:63], v[140:143], v[176:179], v[60:63]
    s_add_u32 m0, s73, 49152
    ds_read_b128 v[100:103], v244 offset:6144
    v_mfma_f32_16x16x32_bf16 v[60:63], v[144:147], v[172:175], v[60:63]
    buffer_load_dwordx4 v7, s[52:55], s14 offen offset:3072 lds
    ds_read2_b32 v[68:69], v236 offset0:128 offset1:129
    v_mfma_f32_16x16x32_bf16 v[60:63], v[148:151], v[168:171], v[60:63]
    ds_read2_b32 v[70:71], v236 offset0:130 offset1:131
    v_mfma_f32_16x16x32_bf16 v[60:63], v[152:155], v[164:167], v[60:63]
    ds_read_b128 v[104:107], v244 offset:10240
    v_mfma_f32_16x16x32_bf16 v[60:63], v[156:159], v[160:163], v[60:63]
    ds_read2_b32 v[72:73], v237 offset0:0 offset1:1
    v_mfma_f32_16x16x32_bf16 v[56:59], v[128:131], v[184:187], v[56:59]
    ds_read2_b32 v[74:75], v237 offset0:2 offset1:3
    v_mfma_f32_16x16x32_bf16 v[56:59], v[132:135], v[180:183], v[56:59]
    ds_read_b128 v[108:111], v244 offset:14336
    v_mfma_f32_16x16x32_bf16 v[56:59], v[136:139], v[176:179], v[56:59]
    ds_read2_b32 v[76:77], v237 offset0:128 offset1:129
    v_mfma_f32_16x16x32_bf16 v[56:59], v[140:143], v[172:175], v[56:59]
    ds_read2_b32 v[78:79], v237 offset0:130 offset1:131
    v_mfma_f32_16x16x32_bf16 v[56:59], v[144:147], v[168:171], v[56:59]
    ds_read_b128 v[112:115], v244 offset:18432
    v_mfma_f32_16x16x32_bf16 v[56:59], v[148:151], v[164:167], v[56:59]
    ds_read2_b32 v[80:81], v238 offset0:0 offset1:1
    v_cvt_pk_bf16_f32 v206, v60, v61
    v_mfma_f32_16x16x32_bf16 v[56:59], v[152:155], v[160:163], v[56:59]
    ds_read2_b32 v[82:83], v238 offset0:2 offset1:3
    v_mfma_f32_16x16x32_bf16 v[52:55], v[128:131], v[180:183], v[52:55]
    ds_read_b128 v[116:119], v244 offset:22528
    v_mfma_f32_16x16x32_bf16 v[52:55], v[132:135], v[176:179], v[52:55]
    ds_read2_b32 v[84:85], v238 offset0:128 offset1:129
    v_cvt_pk_bf16_f32 v207, v62, v63
    v_mfma_f32_16x16x32_bf16 v[52:55], v[136:139], v[172:175], v[52:55]
    ds_read2_b32 v[86:87], v238 offset0:130 offset1:131
    v_mfma_f32_16x16x32_bf16 v[52:55], v[140:143], v[168:171], v[52:55]
    buffer_store_dwordx2 v[206:207], v8, s[44:47], s6 offen offset:3584 sc1
    ds_read_b128 v[120:123], v244 offset:26624
    v_mfma_f32_16x16x32_bf16 v[52:55], v[144:147], v[164:167], v[52:55]
    ds_read2_b32 v[88:89], v239 offset0:0 offset1:1
    v_mfma_f32_16x16x32_bf16 v[52:55], v[148:151], v[160:163], v[52:55]
    ds_read2_b32 v[90:91], v239 offset0:2 offset1:3
    v_mfma_f32_16x16x32_bf16 v[48:51], v[128:131], v[176:179], v[48:51]
    s_waitcnt vmcnt(5)
    s_barrier
    v_cvt_pk_bf16_f32 v204, v56, v57
    v_mfma_f32_16x16x32_bf16 v[48:51], v[132:135], v[172:175], v[48:51]
    ds_read_b128 v[124:127], v244 offset:30720
    v_add_u32 v10, 131072, v10
    v_mfma_f32_16x16x32_bf16 v[48:51], v[136:139], v[168:171], v[48:51]
    ds_read_b64_tr_b16 a[32:33], v10 offset:16384
    v_mfma_f32_16x16x32_bf16 v[48:51], v[140:143], v[164:167], v[48:51]
    ds_read2_b32 v[92:93], v239 offset0:128 offset1:129
    v_cvt_pk_bf16_f32 v205, v58, v59
    v_mfma_f32_16x16x32_bf16 v[48:51], v[144:147], v[160:163], v[48:51]
    ds_read_b64_tr_b16 a[34:35], v10 offset:18432
    v_mfma_f32_16x16x32_bf16 v[44:47], v[128:131], v[172:175], v[44:47]
    buffer_store_dwordx2 v[204:205], v8, s[44:47], s6 offen offset:3072 sc1
    ds_read_b64_tr_b16 a[40:41], v10 offset:20480
    v_mfma_f32_16x16x32_bf16 v[44:47], v[132:135], v[168:171], v[44:47]
    ds_read_b64_tr_b16 a[42:43], v10 offset:22528
    v_mfma_f32_16x16x32_bf16 v[44:47], v[136:139], v[164:167], v[44:47]
    ds_read2_b32 v[94:95], v239 offset0:130 offset1:131
    v_add_u32 v11, 131072, v11
    v_mfma_f32_16x16x32_bf16 v[44:47], v[140:143], v[160:163], v[44:47]
    ds_read_b64_tr_b16 a[36:37], v11 offset:16384
    v_cvt_pk_bf16_f32 v202, v52, v53
    v_mfma_f32_16x16x32_bf16 v[40:43], v[128:131], v[168:171], v[40:43]
    v_mfma_f32_16x16x32_bf16 v[40:43], v[132:135], v[164:167], v[40:43]
    ds_read_b64_tr_b16 a[38:39], v11 offset:18432
    v_mfma_f32_16x16x32_bf16 v[40:43], v[136:139], v[160:163], v[40:43]
    ds_read_b64_tr_b16 a[44:45], v11 offset:20480
    v_cvt_pk_bf16_f32 v203, v54, v55
    v_mfma_f32_16x16x32_bf16 v[36:39], v[128:131], v[164:167], v[36:39]
    ds_read_b64_tr_b16 a[46:47], v11 offset:22528
    v_mfma_f32_16x16x32_bf16 v[36:39], v[132:135], v[160:163], v[36:39]
    buffer_store_dwordx2 v[202:203], v8, s[44:47], s6 offen offset:2560 sc1
    v_mfma_f32_16x16x32_bf16 v[32:35], v[128:131], v[160:163], v[32:35]
    s_waitcnt lgkmcnt(4)
    v_mfma_f32_16x16x32_bf16 v[60:63], v[64:67], v[124:127], 0
    ds_read_b128 v[160:163], v245 offset:2048
    s_waitcnt lgkmcnt(1)
    s_barrier
    v_mfma_f32_16x16x32_bf16 v[60:63], v[68:71], v[120:123], v[60:63]
    v_cvt_pk_bf16_f32 v200, v48, v49
    v_mfma_f32_16x16x32_bf16 v[60:63], v[72:75], v[116:119], v[60:63]
    ds_read2_b32 v[128:129], v236 offset0:16 offset1:17
    v_mfma_f32_16x16x32_bf16 v[60:63], v[76:79], v[112:115], v[60:63]
    ds_read2_b32 v[130:131], v236 offset0:18 offset1:19
    s_lshl_b32 s14, s88, 18
    v_cvt_pk_bf16_f32 v201, v50, v51
    v_mfma_f32_16x16x32_bf16 v[60:63], v[80:83], v[108:111], v[60:63]
    s_add_u32 m0, s73, 147456
    v_mfma_f32_16x16x32_bf16 v[60:63], v[84:87], v[104:107], v[60:63]
    buffer_load_dwordx4 v4, s[52:55], s14 offen offset:0 lds
    ds_read_b128 v[164:167], v245 offset:6144
    v_mfma_f32_16x16x32_bf16 v[60:63], v[88:91], v[100:103], v[60:63]
    buffer_store_dwordx2 v[200:201], v8, s[44:47], s6 offen offset:2048 sc1
    ds_read2_b32 v[132:133], v236 offset0:144 offset1:145
    v_mfma_f32_16x16x32_bf16 v[60:63], v[92:95], v[96:99], v[60:63]
    s_add_u32 s13, s12, 32768
    v_cvt_pk_bf16_f32 v198, v44, v45
    v_mfma_f32_16x16x32_bf16 v[56:59], v[64:67], v[120:123], 0
    ds_read2_b32 v[134:135], v236 offset0:146 offset1:147
    v_mfma_f32_16x16x32_bf16 v[56:59], v[68:71], v[116:119], v[56:59]
    s_add_u32 m0, s74, 32
    ds_read_b128 v[168:171], v245 offset:10240
    v_mfma_f32_16x16x32_bf16 v[56:59], v[72:75], v[112:115], v[56:59]
    buffer_load_dwordx4 v240, s[48:51], s13 offen offset:0 lds
    v_cvt_pk_bf16_f32 v199, v46, v47
    v_mfma_f32_16x16x32_bf16 v[56:59], v[76:79], v[108:111], v[56:59]
    ds_read2_b32 v[136:137], v237 offset0:16 offset1:17
    v_mfma_f32_16x16x32_bf16 v[56:59], v[80:83], v[104:107], v[56:59]
    buffer_store_dwordx2 v[198:199], v8, s[44:47], s6 offen offset:1536 sc1
    ds_read2_b32 v[138:139], v237 offset0:18 offset1:19
    v_mfma_f32_16x16x32_bf16 v[56:59], v[84:87], v[100:103], v[56:59]
    ds_read_b128 v[172:175], v245 offset:14336
    v_mfma_f32_16x16x32_bf16 v[56:59], v[88:91], v[96:99], v[56:59]
    v_cvt_pk_bf16_f32 v196, v40, v41
    v_mfma_f32_16x16x32_bf16 v[52:55], v[64:67], v[116:119], 0
    ds_read2_b32 v[140:141], v237 offset0:144 offset1:145
    v_mfma_f32_16x16x32_bf16 v[52:55], v[68:71], v[112:115], v[52:55]
    ds_read2_b32 v[142:143], v237 offset0:146 offset1:147
    s_add_u32 m0, s73, 147456
    v_cvt_pk_bf16_f32 v197, v42, v43
    v_mfma_f32_16x16x32_bf16 v[52:55], v[72:75], v[108:111], v[52:55]
    buffer_load_dwordx4 v5, s[52:55], s14 offen offset:1024 lds
    v_mfma_f32_16x16x32_bf16 v[52:55], v[76:79], v[104:107], v[52:55]
    buffer_store_dwordx2 v[196:197], v8, s[44:47], s6 offen offset:1024 sc1
    ds_read_b128 v[176:179], v245 offset:18432
    s_add_u32 m0, s74, 32
    v_mfma_f32_16x16x32_bf16 v[52:55], v[80:83], v[100:103], v[52:55]
    buffer_load_dwordx4 v240, s[48:51], s13 offen offset:1024 lds
    ds_read2_b32 v[144:145], v238 offset0:16 offset1:17
    v_mfma_f32_16x16x32_bf16 v[52:55], v[84:87], v[96:99], v[52:55]
    v_mfma_f32_16x16x32_bf16 v[48:51], v[64:67], v[112:115], 0
    ds_read2_b32 v[146:147], v238 offset0:18 offset1:19
    v_cvt_pk_bf16_f32 v194, v36, v37
    v_mfma_f32_16x16x32_bf16 v[48:51], v[68:71], v[108:111], v[48:51]
    ds_read_b128 v[180:183], v245 offset:22528
    v_mfma_f32_16x16x32_bf16 v[48:51], v[72:75], v[104:107], v[48:51]
    v_cvt_pk_bf16_f32 v195, v38, v39
    v_mfma_f32_16x16x32_bf16 v[48:51], v[76:79], v[100:103], v[48:51]
    buffer_store_dwordx2 v[194:195], v8, s[44:47], s6 offen offset:512 sc1
    ds_read2_b32 v[148:149], v238 offset0:144 offset1:145
    s_add_u32 m0, s74, 32
    v_mfma_f32_16x16x32_bf16 v[48:51], v[80:83], v[96:99], v[48:51]
    buffer_load_dwordx4 v240, s[48:51], s13 offen offset:2048 lds
    ds_read2_b32 v[150:151], v238 offset0:146 offset1:147
    v_mfma_f32_16x16x32_bf16 v[44:47], v[64:67], v[108:111], 0
    ds_read_b128 v[184:187], v245 offset:26624
    v_mfma_f32_16x16x32_bf16 v[44:47], v[68:71], v[104:107], v[44:47]
    v_cvt_pk_bf16_f32 v192, v32, v33
    v_mfma_f32_16x16x32_bf16 v[44:47], v[72:75], v[100:103], v[44:47]
    s_add_u32 m0, s73, 147456
    ds_read2_b32 v[152:153], v239 offset0:16 offset1:17
    v_mfma_f32_16x16x32_bf16 v[44:47], v[76:79], v[96:99], v[44:47]
    buffer_load_dwordx4 v6, s[52:55], s14 offen offset:2048 lds
    v_cvt_pk_bf16_f32 v193, v34, v35
    v_mfma_f32_16x16x32_bf16 v[40:43], v[64:67], v[104:107], 0
    ds_read2_b32 v[154:155], v239 offset0:18 offset1:19
    v_mfma_f32_16x16x32_bf16 v[40:43], v[68:71], v[100:103], v[40:43]
    buffer_store_dwordx2 v[192:193], v8, s[44:47], s6 offen offset:0 sc1
    ds_read_b128 v[188:191], v245 offset:30720
    v_mfma_f32_16x16x32_bf16 v[40:43], v[72:75], v[96:99], v[40:43]
    s_add_u32 m0, s74, 32
    ds_read2_b32 v[156:157], v239 offset0:144 offset1:145
    v_mfma_f32_16x16x32_bf16 v[36:39], v[64:67], v[100:103], 0
    buffer_load_dwordx4 v240, s[48:51], s13 offen offset:3072 lds
    v_mfma_f32_16x16x32_bf16 v[36:39], v[68:71], v[96:99], v[36:39]
    ds_read2_b32 v[158:159], v239 offset0:146 offset1:147
    v_mfma_f32_16x16x32_bf16 v[32:35], v[64:67], v[96:99], 0
    s_waitcnt lgkmcnt(12)
    v_mfma_f32_16x16x32_bf16 v[32:35], v[128:131], v[160:163], v[32:35]
    ds_read_b128 v[96:99], v246 offset:2048
    v_mfma_f32_16x16x32_bf16 v[36:39], v[132:135], v[160:163], v[36:39]
    v_mfma_f32_16x16x32_bf16 v[36:39], v[128:131], v[164:167], v[36:39]
    ds_read2_b32 v[64:65], v236 offset0:32 offset1:33
    v_mfma_f32_16x16x32_bf16 v[40:43], v[128:131], v[168:171], v[40:43]
    s_add_u32 m0, s73, 147456
    ds_read2_b32 v[66:67], v236 offset0:34 offset1:35
    v_mfma_f32_16x16x32_bf16 v[40:43], v[132:135], v[164:167], v[40:43]
    buffer_load_dwordx4 v7, s[52:55], s14 offen offset:3072 lds
    v_mfma_f32_16x16x32_bf16 v[40:43], v[136:139], v[160:163], v[40:43]
    ds_read_b128 v[100:103], v246 offset:6144
    v_mfma_f32_16x16x32_bf16 v[44:47], v[140:143], v[160:163], v[44:47]
    ds_read2_b32 v[68:69], v236 offset0:160 offset1:161
    v_mfma_f32_16x16x32_bf16 v[44:47], v[136:139], v[164:167], v[44:47]
    ds_read2_b32 v[70:71], v236 offset0:162 offset1:163
    v_mfma_f32_16x16x32_bf16 v[44:47], v[132:135], v[168:171], v[44:47]
    ds_read_b128 v[104:107], v246 offset:10240
    v_mfma_f32_16x16x32_bf16 v[44:47], v[128:131], v[172:175], v[44:47]
    ds_read2_b32 v[72:73], v237 offset0:32 offset1:33
    s_waitcnt lgkmcnt(8)
    v_mfma_f32_16x16x32_bf16 v[48:51], v[128:131], v[176:179], v[48:51]
    ds_read2_b32 v[74:75], v237 offset0:34 offset1:35
    v_mfma_f32_16x16x32_bf16 v[48:51], v[132:135], v[172:175], v[48:51]
    ds_read_b128 v[108:111], v246 offset:14336
    v_mfma_f32_16x16x32_bf16 v[48:51], v[136:139], v[168:171], v[48:51]
    v_mov_b32 v9, 16
    buffer_load_ushort v9, v9, s[56:59], s70 offen
    v_mfma_f32_16x16x32_bf16 v[48:51], v[140:143], v[164:167], v[48:51]
    ds_read2_b32 v[76:77], v237 offset0:160 offset1:161
    v_mfma_f32_16x16x32_bf16 v[48:51], v[144:147], v[160:163], v[48:51]
    ds_read2_b32 v[78:79], v237 offset0:162 offset1:163
    s_waitcnt vmcnt(17)
    s_barrier
    v_mfma_f32_16x16x32_bf16 v[52:55], v[148:151], v[160:163], v[52:55]
    ds_read_b128 v[112:115], v246 offset:18432
    v_add_u32 v10, -131072, v10
    v_mfma_f32_16x16x32_bf16 v[52:55], v[144:147], v[164:167], v[52:55]
    ds_read_b64_tr_b16 a[48:49], v10 offset:49152
    v_mfma_f32_16x16x32_bf16 v[52:55], v[140:143], v[168:171], v[52:55]
    ds_read_b64_tr_b16 a[50:51], v10 offset:51200
    v_mfma_f32_16x16x32_bf16 v[52:55], v[136:139], v[172:175], v[52:55]
    ds_read2_b32 v[80:81], v238 offset0:32 offset1:33
    v_mfma_f32_16x16x32_bf16 v[52:55], v[132:135], v[176:179], v[52:55]
    ds_read_b64_tr_b16 a[56:57], v10 offset:53248
    v_mfma_f32_16x16x32_bf16 v[52:55], v[128:131], v[180:183], v[52:55]
    ds_read_b64_tr_b16 a[58:59], v10 offset:55296
    v_mfma_f32_16x16x32_bf16 v[56:59], v[128:131], v[184:187], v[56:59]
    ds_read2_b32 v[82:83], v238 offset0:34 offset1:35
    v_add_u32 v11, -131072, v11
    v_mfma_f32_16x16x32_bf16 v[56:59], v[132:135], v[180:183], v[56:59]
    ds_read_b64_tr_b16 a[52:53], v11 offset:49152
    v_mfma_f32_16x16x32_bf16 v[56:59], v[136:139], v[176:179], v[56:59]
    ds_read_b64_tr_b16 a[54:55], v11 offset:51200
    v_mfma_f32_16x16x32_bf16 v[56:59], v[140:143], v[172:175], v[56:59]
    ds_read_b128 v[116:119], v246 offset:22528
    v_mfma_f32_16x16x32_bf16 v[56:59], v[144:147], v[168:171], v[56:59]
    ds_read_b64_tr_b16 a[60:61], v11 offset:53248
    v_mfma_f32_16x16x32_bf16 v[56:59], v[148:151], v[164:167], v[56:59]
    ds_read_b64_tr_b16 a[62:63], v11 offset:55296
    v_mfma_f32_16x16x32_bf16 v[56:59], v[152:155], v[160:163], v[56:59]
    ds_read2_b32 v[84:85], v238 offset0:160 offset1:161
    v_mfma_f32_16x16x32_bf16 v[60:63], v[156:159], v[160:163], v[60:63]
    ds_read2_b32 v[86:87], v238 offset0:162 offset1:163
    v_mfma_f32_16x16x32_bf16 v[60:63], v[152:155], v[164:167], v[60:63]
    ds_read_b128 v[120:123], v246 offset:26624
    v_mfma_f32_16x16x32_bf16 v[60:63], v[148:151], v[168:171], v[60:63]
    ds_read2_b32 v[88:89], v239 offset0:32 offset1:33
    v_mfma_f32_16x16x32_bf16 v[60:63], v[144:147], v[172:175], v[60:63]
    ds_read2_b32 v[90:91], v239 offset0:34 offset1:35
    v_mfma_f32_16x16x32_bf16 v[60:63], v[140:143], v[176:179], v[60:63]
    ds_read_b128 v[124:127], v246 offset:30720
    v_mfma_f32_16x16x32_bf16 v[60:63], v[136:139], v[180:183], v[60:63]
    ds_read2_b32 v[92:93], v239 offset0:160 offset1:161
    v_mfma_f32_16x16x32_bf16 v[60:63], v[132:135], v[184:187], v[60:63]
    ds_read2_b32 v[94:95], v239 offset0:162 offset1:163
    v_mfma_f32_16x16x32_bf16 v[60:63], v[128:131], v[188:191], v[60:63]
    s_waitcnt lgkmcnt(15)
    v_mfma_f32_16x16x32_bf16 v[32:35], v[64:67], v[96:99], v[32:35]
    ds_read_b128 v[160:163], v247 offset:2048
    v_mfma_f32_16x16x32_bf16 v[36:39], v[68:71], v[96:99], v[36:39]
    v_mfma_f32_16x16x32_bf16 v[36:39], v[64:67], v[100:103], v[36:39]
    ds_read2_b32 v[128:129], v236 offset0:48 offset1:49
    v_mfma_f32_16x16x32_bf16 v[40:43], v[64:67], v[104:107], v[40:43]
    ds_read2_b32 v[130:131], v236 offset0:50 offset1:51
    v_mfma_f32_16x16x32_bf16 v[40:43], v[68:71], v[100:103], v[40:43]
    v_mfma_f32_16x16x32_bf16 v[40:43], v[72:75], v[96:99], v[40:43]
    ds_read_b128 v[164:167], v247 offset:6144
    v_mfma_f32_16x16x32_bf16 v[44:47], v[76:79], v[96:99], v[44:47]
    ds_read2_b32 v[132:133], v236 offset0:176 offset1:177
    v_mfma_f32_16x16x32_bf16 v[44:47], v[72:75], v[100:103], v[44:47]
    s_waitcnt lgkmcnt(13)
    s_barrier
    v_mfma_f32_16x16x32_bf16 v[44:47], v[68:71], v[104:107], v[44:47]
    ds_read2_b32 v[134:135], v236 offset0:178 offset1:179
    v_mfma_f32_16x16x32_bf16 v[44:47], v[64:67], v[108:111], v[44:47]
    ds_read_b128 v[168:171], v247 offset:10240
    s_waitcnt lgkmcnt(7)
    v_mfma_f32_16x16x32_bf16 v[48:51], v[64:67], v[112:115], v[48:51]
    ds_read2_b32 v[136:137], v237 offset0:48 offset1:49
    v_mfma_f32_16x16x32_bf16 v[48:51], v[68:71], v[108:111], v[48:51]
    v_mfma_f32_16x16x32_bf16 v[48:51], v[72:75], v[104:107], v[48:51]
    ds_read2_b32 v[138:139], v237 offset0:50 offset1:51
    v_mfma_f32_16x16x32_bf16 v[48:51], v[76:79], v[100:103], v[48:51]
    ds_read_b128 v[172:175], v247 offset:14336
    v_mfma_f32_16x16x32_bf16 v[48:51], v[80:83], v[96:99], v[48:51]
    v_mfma_f32_16x16x32_bf16 v[52:55], v[84:87], v[96:99], v[52:55]
    ds_read2_b32 v[140:141], v237 offset0:176 offset1:177
    v_mfma_f32_16x16x32_bf16 v[52:55], v[80:83], v[100:103], v[52:55]
    ds_read2_b32 v[142:143], v237 offset0:178 offset1:179
    v_mfma_f32_16x16x32_bf16 v[52:55], v[76:79], v[104:107], v[52:55]
    v_mfma_f32_16x16x32_bf16 v[52:55], v[72:75], v[108:111], v[52:55]
    ds_read_b128 v[176:179], v247 offset:18432
    v_mfma_f32_16x16x32_bf16 v[52:55], v[68:71], v[112:115], v[52:55]
    ds_read2_b32 v[144:145], v238 offset0:48 offset1:49
    v_mfma_f32_16x16x32_bf16 v[52:55], v[64:67], v[116:119], v[52:55]
    v_mfma_f32_16x16x32_bf16 v[56:59], v[64:67], v[120:123], v[56:59]
    ds_read2_b32 v[146:147], v238 offset0:50 offset1:51
    v_mfma_f32_16x16x32_bf16 v[56:59], v[68:71], v[116:119], v[56:59]
    ds_read_b128 v[180:183], v247 offset:22528
    v_mfma_f32_16x16x32_bf16 v[56:59], v[72:75], v[112:115], v[56:59]
    v_mfma_f32_16x16x32_bf16 v[56:59], v[76:79], v[108:111], v[56:59]
    ds_read2_b32 v[148:149], v238 offset0:176 offset1:177
    v_mfma_f32_16x16x32_bf16 v[56:59], v[80:83], v[104:107], v[56:59]
    ds_read2_b32 v[150:151], v238 offset0:178 offset1:179
    v_mfma_f32_16x16x32_bf16 v[56:59], v[84:87], v[100:103], v[56:59]
    ds_read_b128 v[184:187], v247 offset:26624
    v_mfma_f32_16x16x32_bf16 v[56:59], v[88:91], v[96:99], v[56:59]
    v_mfma_f32_16x16x32_bf16 v[60:63], v[92:95], v[96:99], v[60:63]
    ds_read2_b32 v[152:153], v239 offset0:48 offset1:49
    v_mfma_f32_16x16x32_bf16 v[60:63], v[88:91], v[100:103], v[60:63]
    ds_read2_b32 v[154:155], v239 offset0:50 offset1:51
    v_mfma_f32_16x16x32_bf16 v[60:63], v[84:87], v[104:107], v[60:63]
    v_mfma_f32_16x16x32_bf16 v[60:63], v[80:83], v[108:111], v[60:63]
    ds_read_b128 v[188:191], v247 offset:30720
    v_mfma_f32_16x16x32_bf16 v[60:63], v[76:79], v[112:115], v[60:63]
    ds_read2_b32 v[156:157], v239 offset0:176 offset1:177
    v_mfma_f32_16x16x32_bf16 v[60:63], v[72:75], v[116:119], v[60:63]
    v_mfma_f32_16x16x32_bf16 v[60:63], v[68:71], v[120:123], v[60:63]
    ds_read2_b32 v[158:159], v239 offset0:178 offset1:179
    v_mfma_f32_16x16x32_bf16 v[60:63], v[64:67], v[124:127], v[60:63]
    s_waitcnt lgkmcnt(12)
    v_mfma_f32_16x16x32_bf16 v[32:35], v[128:131], v[160:163], v[32:35]
    ds_read_b128 v[96:99], v244 offset:0
    v_mfma_f32_16x16x32_bf16 v[36:39], v[132:135], v[160:163], v[36:39]
    v_mfma_f32_16x16x32_bf16 v[36:39], v[128:131], v[164:167], v[36:39]
    ds_read2_b32 v[64:65], v236 offset0:64 offset1:65
    v_mfma_f32_16x16x32_bf16 v[40:43], v[128:131], v[168:171], v[40:43]
    ds_read2_b32 v[66:67], v236 offset0:66 offset1:67
    v_mfma_f32_16x16x32_bf16 v[40:43], v[132:135], v[164:167], v[40:43]
    v_mfma_f32_16x16x32_bf16 v[40:43], v[136:139], v[160:163], v[40:43]
    ds_read_b128 v[100:103], v244 offset:4096
    v_mfma_f32_16x16x32_bf16 v[44:47], v[140:143], v[160:163], v[44:47]
    ds_read2_b32 v[68:69], v236 offset0:192 offset1:193
    v_mfma_f32_16x16x32_bf16 v[44:47], v[136:139], v[164:167], v[44:47]
    s_add_u32 m0, s9, 36864
    s_add_u32 s13, s10, 128
    v_mfma_f32_16x16x32_bf16 v[44:47], v[132:135], v[168:171], v[44:47]
    buffer_load_dwordx4 v15, s[44:47], s13 offen sc1 lds
    ds_read2_b32 v[70:71], v236 offset0:194 offset1:195
    v_mfma_f32_16x16x32_bf16 v[44:47], v[128:131], v[172:175], v[44:47]
    ds_read_b128 v[104:107], v244 offset:8192
    s_waitcnt lgkmcnt(7)
    v_mfma_f32_16x16x32_bf16 v[48:51], v[128:131], v[176:179], v[48:51]
    ds_read2_b32 v[72:73], v237 offset0:64 offset1:65
    v_mfma_f32_16x16x32_bf16 v[48:51], v[132:135], v[172:175], v[48:51]
    ds_read2_b32 v[74:75], v237 offset0:66 offset1:67
    v_mfma_f32_16x16x32_bf16 v[48:51], v[136:139], v[168:171], v[48:51]
    ds_read_b128 v[108:111], v244 offset:12288
    v_mfma_f32_16x16x32_bf16 v[48:51], v[140:143], v[164:167], v[48:51]
    ds_read2_b32 v[76:77], v237 offset0:192 offset1:193
    v_mfma_f32_16x16x32_bf16 v[48:51], v[144:147], v[160:163], v[48:51]
    ds_read2_b32 v[78:79], v237 offset0:194 offset1:195
    v_mfma_f32_16x16x32_bf16 v[52:55], v[148:151], v[160:163], v[52:55]
    ds_read_b128 v[112:115], v244 offset:16384
    v_mfma_f32_16x16x32_bf16 v[52:55], v[144:147], v[164:167], v[52:55]
    ds_read2_b32 v[80:81], v238 offset0:64 offset1:65
    s_add_u32 m0, s9, 37888
    s_add_u32 s13, s10, 73856
    v_mfma_f32_16x16x32_bf16 v[52:55], v[140:143], v[168:171], v[52:55]
    buffer_load_dwordx4 v16, s[44:47], s13 offen sc1 lds
    ds_read2_b32 v[82:83], v238 offset0:66 offset1:67
    v_mfma_f32_16x16x32_bf16 v[52:55], v[136:139], v[172:175], v[52:55]
    ds_read_b128 v[116:119], v244 offset:20480
    v_mfma_f32_16x16x32_bf16 v[52:55], v[132:135], v[176:179], v[52:55]
    ds_read2_b32 v[84:85], v238 offset0:192 offset1:193
    v_mfma_f32_16x16x32_bf16 v[52:55], v[128:131], v[180:183], v[52:55]
    ds_read2_b32 v[86:87], v238 offset0:194 offset1:195
    v_mfma_f32_16x16x32_bf16 v[56:59], v[128:131], v[184:187], v[56:59]
    ds_read_b128 v[120:123], v244 offset:24576
    s_waitcnt vmcnt(3)
    s_barrier
    v_mfma_f32_16x16x32_bf16 v[56:59], v[132:135], v[180:183], v[56:59]
    ds_read2_b32 v[88:89], v239 offset0:64 offset1:65
    v_add_u32 v10, 131072, v10
    v_mfma_f32_16x16x32_bf16 v[56:59], v[136:139], v[176:179], v[56:59]
    ds_read_b64_tr_b16 a[64:65], v10 offset:16384
    v_mfma_f32_16x16x32_bf16 v[56:59], v[140:143], v[172:175], v[56:59]
    ds_read2_b32 v[90:91], v239 offset0:66 offset1:67
    v_mfma_f32_16x16x32_bf16 v[56:59], v[144:147], v[168:171], v[56:59]
    ds_read_b64_tr_b16 a[66:67], v10 offset:18432
    s_add_u32 m0, s9, 38912
    s_add_u32 s13, s10, 147584
    v_mfma_f32_16x16x32_bf16 v[56:59], v[148:151], v[164:167], v[56:59]
    ds_read_b64_tr_b16 a[72:73], v10 offset:20480
    buffer_load_dwordx4 v15, s[44:47], s13 offen sc1 lds
    v_mfma_f32_16x16x32_bf16 v[56:59], v[152:155], v[160:163], v[56:59]
    ds_read_b64_tr_b16 a[74:75], v10 offset:22528
    v_mfma_f32_16x16x32_bf16 v[60:63], v[156:159], v[160:163], v[60:63]
    ds_read_b128 v[124:127], v244 offset:28672
    v_add_u32 v11, 131072, v11
    v_mfma_f32_16x16x32_bf16 v[60:63], v[152:155], v[164:167], v[60:63]
    ds_read_b64_tr_b16 a[68:69], v11 offset:16384
    v_mfma_f32_16x16x32_bf16 v[60:63], v[148:151], v[168:171], v[60:63]
    ds_read2_b32 v[92:93], v239 offset0:192 offset1:193
    v_mfma_f32_16x16x32_bf16 v[60:63], v[144:147], v[172:175], v[60:63]
    ds_read_b64_tr_b16 a[70:71], v11 offset:18432
    v_mfma_f32_16x16x32_bf16 v[60:63], v[140:143], v[176:179], v[60:63]
    ds_read_b64_tr_b16 a[76:77], v11 offset:20480
    v_mfma_f32_16x16x32_bf16 v[60:63], v[136:139], v[180:183], v[60:63]
    ds_read_b64_tr_b16 a[78:79], v11 offset:22528
    v_mfma_f32_16x16x32_bf16 v[60:63], v[132:135], v[184:187], v[60:63]
    ds_read2_b32 v[94:95], v239 offset0:194 offset1:195
    s_add_u32 m0, s9, 39936
    s_add_u32 s13, s10, 221312
    v_mfma_f32_16x16x32_bf16 v[60:63], v[128:131], v[188:191], v[60:63]
    buffer_load_dwordx4 v16, s[44:47], s13 offen sc1 lds
    s_waitcnt lgkmcnt(15)
    v_mfma_f32_16x16x32_bf16 v[32:35], v[64:67], v[96:99], v[32:35]
    ds_read_b128 v[160:163], v245 offset:0
    s_waitcnt lgkmcnt(2)
    s_barrier
    v_mfma_f32_16x16x32_bf16 v[36:39], v[68:71], v[96:99], v[36:39]
    v_mfma_f32_16x16x32_bf16 v[36:39], v[64:67], v[100:103], v[36:39]
    ds_read2_b32 v[128:129], v236 offset0:80 offset1:81
    v_mfma_f32_16x16x32_bf16 v[40:43], v[64:67], v[104:107], v[40:43]
    s_lshl_b32 s14, s89, 18
    ds_read2_b32 v[130:131], v236 offset0:82 offset1:83
    v_mfma_f32_16x16x32_bf16 v[40:43], v[68:71], v[100:103], v[40:43]
    s_add_u32 m0, s73, 147456
    v_mfma_f32_16x16x32_bf16 v[40:43], v[72:75], v[96:99], v[40:43]
    buffer_load_dwordx4 v4, s[52:55], s14 offen offset:0 lds
    ds_read_b128 v[164:167], v245 offset:4096
    v_mfma_f32_16x16x32_bf16 v[44:47], v[76:79], v[96:99], v[44:47]
    ds_read2_b32 v[132:133], v236 offset0:208 offset1:209
    v_mfma_f32_16x16x32_bf16 v[44:47], v[72:75], v[100:103], v[44:47]
    s_add_u32 m0, s9, 40960
    s_add_u32 s13, s10, 295040
    v_mfma_f32_16x16x32_bf16 v[44:47], v[68:71], v[104:107], v[44:47]
    buffer_load_dwordx4 v15, s[44:47], s13 offen sc1 lds
    ds_read2_b32 v[134:135], v236 offset0:210 offset1:211
    v_mfma_f32_16x16x32_bf16 v[44:47], v[64:67], v[108:111], v[44:47]
    ds_read_b128 v[168:171], v245 offset:8192
    s_waitcnt lgkmcnt(7)
    v_mfma_f32_16x16x32_bf16 v[48:51], v[64:67], v[112:115], v[48:51]
    ds_read2_b32 v[136:137], v237 offset0:80 offset1:81
    v_mfma_f32_16x16x32_bf16 v[48:51], v[68:71], v[108:111], v[48:51]
    ds_read2_b32 v[138:139], v237 offset0:82 offset1:83
    v_mfma_f32_16x16x32_bf16 v[48:51], v[72:75], v[104:107], v[48:51]
    ds_read_b128 v[172:175], v245 offset:12288
    v_mfma_f32_16x16x32_bf16 v[48:51], v[76:79], v[100:103], v[48:51]
    ds_read2_b32 v[140:141], v237 offset0:208 offset1:209
    v_mfma_f32_16x16x32_bf16 v[48:51], v[80:83], v[96:99], v[48:51]
    ds_read2_b32 v[142:143], v237 offset0:210 offset1:211
    v_mfma_f32_16x16x32_bf16 v[52:55], v[84:87], v[96:99], v[52:55]
    ds_read_b128 v[176:179], v245 offset:16384
    v_mfma_f32_16x16x32_bf16 v[52:55], v[80:83], v[100:103], v[52:55]
    s_add_u32 m0, s73, 147456
    ds_read2_b32 v[144:145], v238 offset0:80 offset1:81
    v_mfma_f32_16x16x32_bf16 v[52:55], v[76:79], v[104:107], v[52:55]
    buffer_load_dwordx4 v5, s[52:55], s14 offen offset:1024 lds
    ds_read2_b32 v[146:147], v238 offset0:82 offset1:83
L_pl_X_3:
    s_cbranch_execz L_pl_X_7
    v_mfma_f32_16x16x32_bf16 v[52:55], v[72:75], v[108:111], v[52:55]
    ds_read_b128 v[180:183], v245 offset:20480
    s_add_u32 m0, s9, 41984
    s_add_u32 s13, s10, 368768
    v_mfma_f32_16x16x32_bf16 v[52:55], v[68:71], v[112:115], v[52:55]
    buffer_load_dwordx4 v16, s[44:47], s13 offen sc1 lds
    ds_read_b128 v[212:215], v241 offset:32
    v_mfma_f32_16x16x32_bf16 v[52:55], v[64:67], v[116:119], v[52:55]
    ds_read2_b32 v[148:149], v238 offset0:208 offset1:209
    v_mfma_f32_16x16x32_bf16 v[56:59], v[64:67], v[120:123], v[56:59]
    ds_read_b32 v216, v241 offset:48
    v_mfma_f32_16x16x32_bf16 v[56:59], v[68:71], v[116:119], v[56:59]
    ds_read2_b32 v[150:151], v238 offset0:210 offset1:211
    v_mfma_f32_16x16x32_bf16 v[56:59], v[72:75], v[112:115], v[56:59]
    ds_read_b128 v[218:221], v241 offset:1056
    v_mfma_f32_16x16x32_bf16 v[56:59], v[76:79], v[108:111], v[56:59]
    ds_read_b128 v[184:187], v245 offset:24576
    v_mfma_f32_16x16x32_bf16 v[56:59], v[80:83], v[104:107], v[56:59]
    ds_read2_b32 v[152:153], v239 offset0:80 offset1:81
    s_add_u32 m0, s9, 43008
    s_add_u32 s13, s10, 442496
    v_mfma_f32_16x16x32_bf16 v[56:59], v[84:87], v[100:103], v[56:59]
    buffer_load_dwordx4 v15, s[44:47], s13 offen sc1 lds
    ds_read_b32 v222, v241 offset:1072
    v_mfma_f32_16x16x32_bf16 v[56:59], v[88:91], v[96:99], v[56:59]
    ds_read2_b32 v[154:155], v239 offset0:82 offset1:83
    v_mfma_f32_16x16x32_bf16 v[60:63], v[92:95], v[96:99], v[60:63]
    s_add_u32 m0, s73, 147456
    ds_read_b128 v[224:227], v241 offset:2080
    v_mfma_f32_16x16x32_bf16 v[60:63], v[88:91], v[100:103], v[60:63]
    buffer_load_dwordx4 v6, s[52:55], s14 offen offset:2048 lds
    ds_read_b128 v[188:191], v245 offset:28672
    v_mfma_f32_16x16x32_bf16 v[60:63], v[84:87], v[104:107], v[60:63]
    ds_read_b32 v228, v241 offset:2096
    v_mfma_f32_16x16x32_bf16 v[60:63], v[80:83], v[108:111], v[60:63]
    ds_read2_b32 v[156:157], v239 offset0:208 offset1:209
    v_mfma_f32_16x16x32_bf16 v[60:63], v[76:79], v[112:115], v[60:63]
    ds_read_b128 v[230:233], v241 offset:3104
    v_mfma_f32_16x16x32_bf16 v[60:63], v[72:75], v[116:119], v[60:63]
    ds_read2_b32 v[158:159], v239 offset0:210 offset1:211
    v_mfma_f32_16x16x32_bf16 v[60:63], v[68:71], v[120:123], v[60:63]
    ds_read_b32 v234, v241 offset:3120
    s_add_u32 m0, s9, 44032
    s_add_u32 s13, s10, 516224
    v_mfma_f32_16x16x32_bf16 v[60:63], v[64:67], v[124:127], v[60:63]
    buffer_load_dwordx4 v16, s[44:47], s13 offen sc1 lds
    s_waitcnt lgkmcnt(15)
    v_mfma_f32_16x16x32_bf16 v[32:35], v[128:131], v[160:163], v[32:35]
    ds_read_b128 v[96:99], v246 offset:0
    v_mfma_f32_16x16x32_bf16 v[36:39], v[132:135], v[160:163], v[36:39]
    v_mfma_f32_16x16x32_bf16 v[36:39], v[128:131], v[164:167], v[36:39]
    ds_read2_b32 v[64:65], v236 offset0:96 offset1:97
    v_mfma_f32_16x16x32_bf16 v[40:43], v[128:131], v[168:171], v[40:43]
    s_add_u32 m0, s73, 147456
    ds_read2_b32 v[66:67], v236 offset0:98 offset1:99
    v_mfma_f32_16x16x32_bf16 v[40:43], v[132:135], v[164:167], v[40:43]
    buffer_load_dwordx4 v7, s[52:55], s14 offen offset:3072 lds
    s_waitcnt lgkmcnt(3)
    v_mfma_f32_16x16x32_bf16 v[40:43], v[136:139], v[160:163], v[40:43]
    ds_read_b128 v[100:103], v246 offset:4096
    v_mfma_f32_16x16x32_bf16 v[44:47], v[140:143], v[160:163], v[44:47]
    s_waitcnt vmcnt(12)
    ds_read2_b32 v[68:69], v236 offset0:224 offset1:225
    v_mfma_f32_16x16x32_bf16 v[44:47], v[136:139], v[164:167], v[44:47]
    v_mfma_f32_16x16x32_bf16 v[44:47], v[132:135], v[168:171], v[44:47]
    ds_read2_b32 v[70:71], v236 offset0:226 offset1:227
    v_lshlrev_b32 v9, 16, v9
    v_mfma_f32_16x16x32_bf16 v[44:47], v[128:131], v[172:175], v[44:47]
    ds_read_b128 v[104:107], v246 offset:8192
    v_mfma_f32_16x16x32_bf16 v[48:51], v[128:131], v[176:179], v[48:51]
    ds_read2_b32 v[72:73], v237 offset0:96 offset1:97
    v_lshlrev_b32 v208, 16, v212
    v_mfma_f32_16x16x32_bf16 v[48:51], v[132:135], v[172:175], v[48:51]
    v_mfma_f32_16x16x32_bf16 v[48:51], v[136:139], v[168:171], v[48:51]
    ds_read2_b32 v[74:75], v237 offset0:98 offset1:99
    v_add_f32 v9, v9, v208
    v_mfma_f32_16x16x32_bf16 v[48:51], v[140:143], v[164:167], v[48:51]
    ds_read_b128 v[108:111], v246 offset:12288
    v_cvt_pk_bf16_f32 v9, v9, v9
    v_mfma_f32_16x16x32_bf16 v[48:51], v[144:147], v[160:163], v[48:51]
    ds_read2_b32 v[76:77], v237 offset0:224 offset1:225
    v_mfma_f32_16x16x32_bf16 v[52:55], v[148:151], v[160:163], v[52:55]
    ds_write_b16 v242, v9 offset:4160
    v_mfma_f32_16x16x32_bf16 v[52:55], v[144:147], v[164:167], v[52:55]
    ds_read2_b32 v[78:79], v237 offset0:226 offset1:227
    v_mfma_f32_16x16x32_bf16 v[52:55], v[140:143], v[168:171], v[52:55]
    ds_write_b16 v242, v9 offset:2
    v_mfma_f32_16x16x32_bf16 v[52:55], v[136:139], v[172:175], v[52:55]
    ds_read_b128 v[112:115], v246 offset:16384
    v_mfma_f32_16x16x32_bf16 v[52:55], v[132:135], v[176:179], v[52:55]
    ds_read2_b32 v[80:81], v238 offset0:96 offset1:97
    v_alignbit_b32 v212, v213, v212, 16
    v_mfma_f32_16x16x32_bf16 v[52:55], v[128:131], v[180:183], v[52:55]
    v_alignbit_b32 v213, v214, v213, 16
    v_mfma_f32_16x16x32_bf16 v[56:59], v[128:131], v[184:187], v[56:59]
    ds_read2_b32 v[82:83], v238 offset0:98 offset1:99
    v_mfma_f32_16x16x32_bf16 v[56:59], v[132:135], v[180:183], v[56:59]
    ds_read_b128 v[116:119], v246 offset:20480
    v_alignbit_b32 v214, v215, v214, 16
    v_mfma_f32_16x16x32_bf16 v[56:59], v[136:139], v[176:179], v[56:59]
    v_mfma_f32_16x16x32_bf16 v[56:59], v[140:143], v[172:175], v[56:59]
    ds_read2_b32 v[84:85], v238 offset0:224 offset1:225
    v_alignbit_b32 v215, v216, v215, 16
    v_mfma_f32_16x16x32_bf16 v[56:59], v[144:147], v[168:171], v[56:59]
    ds_read2_b32 v[86:87], v238 offset0:226 offset1:227
    v_mfma_f32_16x16x32_bf16 v[56:59], v[148:151], v[164:167], v[56:59]
    ds_write_b128 v241, v[212:215] offset:4192
    v_mfma_f32_16x16x32_bf16 v[56:59], v[152:155], v[160:163], v[56:59]
    ds_read_b128 v[120:123], v246 offset:24576
    v_mfma_f32_16x16x32_bf16 v[60:63], v[156:159], v[160:163], v[60:63]
    ds_read2_b32 v[88:89], v239 offset0:96 offset1:97
    v_alignbit_b32 v218, v219, v218, 16
    v_mfma_f32_16x16x32_bf16 v[60:63], v[152:155], v[164:167], v[60:63]
    ds_read2_b32 v[90:91], v239 offset0:98 offset1:99
    v_alignbit_b32 v219, v220, v219, 16
    v_mfma_f32_16x16x32_bf16 v[60:63], v[148:151], v[168:171], v[60:63]
    v_mfma_f32_16x16x32_bf16 v[60:63], v[144:147], v[172:175], v[60:63]
    ds_read_b128 v[124:127], v246 offset:28672
    v_alignbit_b32 v220, v221, v220, 16
    v_mfma_f32_16x16x32_bf16 v[60:63], v[140:143], v[176:179], v[60:63]
    ds_read2_b32 v[92:93], v239 offset0:224 offset1:225
    v_mfma_f32_16x16x32_bf16 v[60:63], v[136:139], v[180:183], v[60:63]
    ds_read2_b32 v[94:95], v239 offset0:226 offset1:227
    v_alignbit_b32 v221, v222, v221, 16
    v_mfma_f32_16x16x32_bf16 v[60:63], v[132:135], v[184:187], v[60:63]
    ds_write_b128 v241, v[218:221] offset:5216
    v_mfma_f32_16x16x32_bf16 v[60:63], v[128:131], v[188:191], v[60:63]
    s_waitcnt lgkmcnt(15)
    v_mfma_f32_16x16x32_bf16 v[32:35], v[64:67], v[96:99], v[32:35]
    ds_read_b128 v[160:163], v247 offset:0
    v_mfma_f32_16x16x32_bf16 v[36:39], v[68:71], v[96:99], v[36:39]
    v_alignbit_b32 v224, v225, v224, 16
    v_mfma_f32_16x16x32_bf16 v[36:39], v[64:67], v[100:103], v[36:39]
    ds_read_b128 v[164:167], v247 offset:4096
    v_mfma_f32_16x16x32_bf16 v[40:43], v[64:67], v[104:107], v[40:43]
    ds_read_b128 v[168:171], v247 offset:8192
    v_mfma_f32_16x16x32_bf16 v[40:43], v[68:71], v[100:103], v[40:43]
    ds_read_b128 v[172:175], v247 offset:12288
    v_mfma_f32_16x16x32_bf16 v[40:43], v[72:75], v[96:99], v[40:43]
    v_alignbit_b32 v225, v226, v225, 16
    v_mfma_f32_16x16x32_bf16 v[44:47], v[76:79], v[96:99], v[44:47]
    ds_read_b128 v[176:179], v247 offset:16384
    v_mfma_f32_16x16x32_bf16 v[44:47], v[72:75], v[100:103], v[44:47]
    ds_read_b128 v[180:183], v247 offset:20480
    v_mfma_f32_16x16x32_bf16 v[44:47], v[68:71], v[104:107], v[44:47]
    ds_read_b128 v[184:187], v247 offset:24576
    v_mfma_f32_16x16x32_bf16 v[44:47], v[64:67], v[108:111], v[44:47]
    v_alignbit_b32 v226, v227, v226, 16
    s_waitcnt lgkmcnt(8)
    v_mfma_f32_16x16x32_bf16 v[48:51], v[64:67], v[112:115], v[48:51]
    ds_read_b128 v[188:191], v247 offset:28672
    v_mfma_f32_16x16x32_bf16 v[48:51], v[68:71], v[108:111], v[48:51]
    ds_read2_b32 v[128:129], v236 offset0:112 offset1:113
    v_mfma_f32_16x16x32_bf16 v[48:51], v[72:75], v[104:107], v[48:51]
    v_alignbit_b32 v227, v228, v227, 16
    v_mfma_f32_16x16x32_bf16 v[48:51], v[76:79], v[100:103], v[48:51]
    ds_read2_b32 v[130:131], v236 offset0:114 offset1:115
    v_mfma_f32_16x16x32_bf16 v[48:51], v[80:83], v[96:99], v[48:51]
    ds_read2_b32 v[132:133], v236 offset0:240 offset1:241
    v_mfma_f32_16x16x32_bf16 v[52:55], v[84:87], v[96:99], v[52:55]
    ds_read2_b32 v[134:135], v236 offset0:242 offset1:243
    v_mfma_f32_16x16x32_bf16 v[52:55], v[80:83], v[100:103], v[52:55]
    ds_write_b128 v241, v[224:227] offset:6240
    v_mfma_f32_16x16x32_bf16 v[52:55], v[76:79], v[104:107], v[52:55]
    ds_read2_b32 v[136:137], v237 offset0:112 offset1:113
    ds_read2_b32 v[138:139], v237 offset0:114 offset1:115
    v_mfma_f32_16x16x32_bf16 v[52:55], v[72:75], v[108:111], v[52:55]
    s_add_u32 s6, s12, 4734976
    ds_read2_b32 v[140:141], v237 offset0:240 offset1:241
    v_mfma_f32_16x16x32_bf16 v[52:55], v[68:71], v[112:115], v[52:55]
    ds_read2_b32 v[142:143], v237 offset0:242 offset1:243
    v_alignbit_b32 v230, v231, v230, 16
    v_xor_b32 v244, 64, v244
    v_mfma_f32_16x16x32_bf16 v[52:55], v[64:67], v[116:119], v[52:55]
    ds_read2_b32 v[144:145], v238 offset0:112 offset1:113
    v_mfma_f32_16x16x32_bf16 v[56:59], v[64:67], v[120:123], v[56:59]
    ds_read2_b32 v[146:147], v238 offset0:114 offset1:115
    v_xor_b32 v245, 64, v245
    v_mfma_f32_16x16x32_bf16 v[56:59], v[68:71], v[116:119], v[56:59]
    ds_read2_b32 v[148:149], v238 offset0:240 offset1:241
    v_mfma_f32_16x16x32_bf16 v[56:59], v[72:75], v[112:115], v[56:59]
    v_alignbit_b32 v231, v232, v231, 16
    v_xor_b32 v246, 64, v246
    v_mfma_f32_16x16x32_bf16 v[56:59], v[76:79], v[108:111], v[56:59]
    ds_read2_b32 v[150:151], v238 offset0:242 offset1:243
    v_mfma_f32_16x16x32_bf16 v[56:59], v[80:83], v[104:107], v[56:59]
    ds_read2_b32 v[152:153], v239 offset0:112 offset1:113
    v_xor_b32 v247, 64, v247
    v_mfma_f32_16x16x32_bf16 v[56:59], v[84:87], v[100:103], v[56:59]
    ds_read2_b32 v[154:155], v239 offset0:114 offset1:115
    v_mfma_f32_16x16x32_bf16 v[56:59], v[88:91], v[96:99], v[56:59]
    ds_read2_b32 v[156:157], v239 offset0:240 offset1:241
    v_alignbit_b32 v232, v233, v232, 16
    v_mfma_f32_16x16x32_bf16 v[60:63], v[92:95], v[96:99], v[60:63]
    ds_read2_b32 v[158:159], v239 offset0:242 offset1:243
    v_add_u32 v244, 36864, v244
    v_mfma_f32_16x16x32_bf16 v[60:63], v[88:91], v[100:103], v[60:63]
    v_add_u32 v236, -8320, v236
    v_mfma_f32_16x16x32_bf16 v[60:63], v[84:87], v[104:107], v[60:63]
    v_alignbit_b32 v233, v234, v233, 16
    v_add_u32 v245, 36864, v245
    v_mfma_f32_16x16x32_bf16 v[60:63], v[80:83], v[108:111], v[60:63]
    v_add_u32 v237, -8320, v237
    v_mfma_f32_16x16x32_bf16 v[60:63], v[76:79], v[112:115], v[60:63]
    s_waitcnt vmcnt(1)
    s_barrier
    v_add_u32 v246, 36864, v246
    v_mfma_f32_16x16x32_bf16 v[60:63], v[72:75], v[116:119], v[60:63]
    v_add_u32 v238, -8320, v238
    v_add_u32 v239, -8320, v239
    v_mfma_f32_16x16x32_bf16 v[60:63], v[68:71], v[120:123], v[60:63]
    ds_write_b128 v241, v[230:233] offset:7264
    v_mfma_f32_16x16x32_bf16 v[60:63], v[64:67], v[124:127], v[60:63]
    v_add_u32 v247, 36864, v247
    s_waitcnt lgkmcnt(1)
    v_mfma_f32_16x16x32_bf16 v[60:63], v[128:131], v[188:191], v[60:63]
    ds_read_b128 v[96:99], v244 offset:2048
    v_mfma_f32_16x16x32_bf16 v[60:63], v[132:135], v[184:187], v[60:63]
    ds_read2_b32 v[64:65], v236 offset0:0 offset1:1
    v_mfma_f32_16x16x32_bf16 v[60:63], v[136:139], v[180:183], v[60:63]
    ds_read2_b32 v[66:67], v236 offset0:2 offset1:3
    v_mfma_f32_16x16x32_bf16 v[60:63], v[140:143], v[176:179], v[60:63]
    ds_read_b128 v[100:103], v244 offset:6144
    v_mfma_f32_16x16x32_bf16 v[60:63], v[144:147], v[172:175], v[60:63]
    ds_read2_b32 v[68:69], v236 offset0:128 offset1:129
    v_mfma_f32_16x16x32_bf16 v[60:63], v[148:151], v[168:171], v[60:63]
    ds_read2_b32 v[70:71], v236 offset0:130 offset1:131
    v_mfma_f32_16x16x32_bf16 v[60:63], v[152:155], v[164:167], v[60:63]
    ds_read_b128 v[104:107], v244 offset:10240
    v_mfma_f32_16x16x32_bf16 v[60:63], v[156:159], v[160:163], v[60:63]
    ds_read2_b32 v[72:73], v237 offset0:0 offset1:1
    v_mfma_f32_16x16x32_bf16 v[56:59], v[128:131], v[184:187], v[56:59]
    ds_read2_b32 v[74:75], v237 offset0:2 offset1:3
    v_mfma_f32_16x16x32_bf16 v[56:59], v[132:135], v[180:183], v[56:59]
    ds_read_b128 v[108:111], v244 offset:14336
    v_mfma_f32_16x16x32_bf16 v[56:59], v[136:139], v[176:179], v[56:59]
    ds_read2_b32 v[76:77], v237 offset0:128 offset1:129
    v_mfma_f32_16x16x32_bf16 v[56:59], v[140:143], v[172:175], v[56:59]
    ds_read2_b32 v[78:79], v237 offset0:130 offset1:131
    v_mfma_f32_16x16x32_bf16 v[56:59], v[144:147], v[168:171], v[56:59]
    ds_read_b128 v[112:115], v244 offset:18432
    v_mfma_f32_16x16x32_bf16 v[56:59], v[148:151], v[164:167], v[56:59]
    ds_read2_b32 v[80:81], v238 offset0:0 offset1:1
    v_cvt_pk_bf16_f32 v206, v60, v61
    v_mfma_f32_16x16x32_bf16 v[56:59], v[152:155], v[160:163], v[56:59]
    ds_read2_b32 v[82:83], v238 offset0:2 offset1:3
    v_mfma_f32_16x16x32_bf16 v[52:55], v[128:131], v[180:183], v[52:55]
    ds_read_b128 v[116:119], v244 offset:22528
    v_mfma_f32_16x16x32_bf16 v[52:55], v[132:135], v[176:179], v[52:55]
    ds_read2_b32 v[84:85], v238 offset0:128 offset1:129
    v_cvt_pk_bf16_f32 v207, v62, v63
    v_mfma_f32_16x16x32_bf16 v[52:55], v[136:139], v[172:175], v[52:55]
    ds_read2_b32 v[86:87], v238 offset0:130 offset1:131
    v_mfma_f32_16x16x32_bf16 v[52:55], v[140:143], v[168:171], v[52:55]
    buffer_store_dwordx2 v[206:207], v8, s[44:47], s6 offen offset:3584 sc1
    ds_read_b128 v[120:123], v244 offset:26624
    v_mfma_f32_16x16x32_bf16 v[52:55], v[144:147], v[164:167], v[52:55]
    ds_read2_b32 v[88:89], v239 offset0:0 offset1:1
    v_mfma_f32_16x16x32_bf16 v[52:55], v[148:151], v[160:163], v[52:55]
    ds_read2_b32 v[90:91], v239 offset0:2 offset1:3
    v_mfma_f32_16x16x32_bf16 v[48:51], v[128:131], v[176:179], v[48:51]
    s_waitcnt vmcnt(1)
    s_barrier
    v_cvt_pk_bf16_f32 v204, v56, v57
    v_mfma_f32_16x16x32_bf16 v[48:51], v[132:135], v[172:175], v[48:51]
    ds_read_b128 v[124:127], v244 offset:30720
    v_mfma_f32_16x16x32_bf16 v[48:51], v[136:139], v[168:171], v[48:51]
    ds_read_b64_tr_b16 a[80:81], v10 offset:16384
    v_mfma_f32_16x16x32_bf16 v[48:51], v[140:143], v[164:167], v[48:51]
    ds_read_b64_tr_b16 a[82:83], v10 offset:18432
    v_cvt_pk_bf16_f32 v205, v58, v59
    v_mfma_f32_16x16x32_bf16 v[48:51], v[144:147], v[160:163], v[48:51]
    ds_read_b64_tr_b16 a[88:89], v10 offset:20480
    v_mfma_f32_16x16x32_bf16 v[44:47], v[128:131], v[172:175], v[44:47]
    buffer_store_dwordx2 v[204:205], v8, s[44:47], s6 offen offset:3072 sc1
    ds_read2_b32 v[92:93], v239 offset0:128 offset1:129
    v_mfma_f32_16x16x32_bf16 v[44:47], v[132:135], v[168:171], v[44:47]
    ds_read_b64_tr_b16 a[90:91], v10 offset:22528
    v_mfma_f32_16x16x32_bf16 v[44:47], v[136:139], v[164:167], v[44:47]
    ds_read_b64_tr_b16 a[84:85], v11 offset:16384
    ds_read2_b32 v[94:95], v239 offset0:130 offset1:131
    v_mfma_f32_16x16x32_bf16 v[44:47], v[140:143], v[160:163], v[44:47]
    v_cvt_pk_bf16_f32 v202, v52, v53
    v_mfma_f32_16x16x32_bf16 v[40:43], v[128:131], v[168:171], v[40:43]
    ds_read_b64_tr_b16 a[86:87], v11 offset:18432
    v_mfma_f32_16x16x32_bf16 v[40:43], v[132:135], v[164:167], v[40:43]
    ds_read_b64_tr_b16 a[92:93], v11 offset:20480
    v_mfma_f32_16x16x32_bf16 v[40:43], v[136:139], v[160:163], v[40:43]
    v_cvt_pk_bf16_f32 v203, v54, v55
    v_mfma_f32_16x16x32_bf16 v[36:39], v[128:131], v[164:167], v[36:39]
    ds_read_b64_tr_b16 a[94:95], v11 offset:22528
    v_mfma_f32_16x16x32_bf16 v[36:39], v[132:135], v[160:163], v[36:39]
    buffer_store_dwordx2 v[202:203], v8, s[44:47], s6 offen offset:2560 sc1
    v_mfma_f32_16x16x32_bf16 v[32:35], v[128:131], v[160:163], v[32:35]
    s_waitcnt lgkmcnt(3)
    v_mfma_f32_16x16x32_bf16 v[60:63], v[64:67], v[124:127], 0
    ds_read_b128 v[160:163], v245 offset:2048
    s_waitcnt lgkmcnt(1)
    s_barrier
    v_mfma_f32_16x16x32_bf16 v[60:63], v[68:71], v[120:123], v[60:63]
    v_cvt_pk_bf16_f32 v200, v48, v49
    v_mfma_f32_16x16x32_bf16 v[60:63], v[72:75], v[116:119], v[60:63]
    ds_read2_b32 v[128:129], v236 offset0:16 offset1:17
    v_mfma_f32_16x16x32_bf16 v[60:63], v[76:79], v[112:115], v[60:63]
    ds_read2_b32 v[130:131], v236 offset0:18 offset1:19
    s_lshl_b32 s14, s90, 18
    v_cvt_pk_bf16_f32 v201, v50, v51
    v_mfma_f32_16x16x32_bf16 v[60:63], v[80:83], v[108:111], v[60:63]
    s_add_u32 m0, s73, 147456
    v_mfma_f32_16x16x32_bf16 v[60:63], v[84:87], v[104:107], v[60:63]
    buffer_load_dwordx4 v4, s[52:55], s14 offen offset:0 lds
    ds_read_b128 v[164:167], v245 offset:6144
    v_mfma_f32_16x16x32_bf16 v[60:63], v[88:91], v[100:103], v[60:63]
    buffer_store_dwordx2 v[200:201], v8, s[44:47], s6 offen offset:2048 sc1
    ds_read2_b32 v[132:133], v236 offset0:144 offset1:145
    v_mfma_f32_16x16x32_bf16 v[60:63], v[92:95], v[96:99], v[60:63]
    s_add_u32 s13, s12, 49152
    v_cvt_pk_bf16_f32 v198, v44, v45
    v_mfma_f32_16x16x32_bf16 v[56:59], v[64:67], v[120:123], 0
    ds_read2_b32 v[134:135], v236 offset0:146 offset1:147
    v_mfma_f32_16x16x32_bf16 v[56:59], v[68:71], v[116:119], v[56:59]
    s_add_u32 m0, s74, 8352
    ds_read_b128 v[168:171], v245 offset:10240
    v_mfma_f32_16x16x32_bf16 v[56:59], v[72:75], v[112:115], v[56:59]
    buffer_load_dwordx4 v240, s[48:51], s13 offen offset:0 lds
    v_cvt_pk_bf16_f32 v199, v46, v47
    v_mfma_f32_16x16x32_bf16 v[56:59], v[76:79], v[108:111], v[56:59]
    ds_read2_b32 v[136:137], v237 offset0:16 offset1:17
    v_mfma_f32_16x16x32_bf16 v[56:59], v[80:83], v[104:107], v[56:59]
    buffer_store_dwordx2 v[198:199], v8, s[44:47], s6 offen offset:1536 sc1
    ds_read2_b32 v[138:139], v237 offset0:18 offset1:19
    v_mfma_f32_16x16x32_bf16 v[56:59], v[84:87], v[100:103], v[56:59]
    ds_read_b128 v[172:175], v245 offset:14336
    v_mfma_f32_16x16x32_bf16 v[56:59], v[88:91], v[96:99], v[56:59]
    v_cvt_pk_bf16_f32 v196, v40, v41
    v_mfma_f32_16x16x32_bf16 v[52:55], v[64:67], v[116:119], 0
    ds_read2_b32 v[140:141], v237 offset0:144 offset1:145
    v_mfma_f32_16x16x32_bf16 v[52:55], v[68:71], v[112:115], v[52:55]
    ds_read2_b32 v[142:143], v237 offset0:146 offset1:147
    s_add_u32 m0, s73, 147456
    v_cvt_pk_bf16_f32 v197, v42, v43
    v_mfma_f32_16x16x32_bf16 v[52:55], v[72:75], v[108:111], v[52:55]
    buffer_load_dwordx4 v5, s[52:55], s14 offen offset:1024 lds
    v_mfma_f32_16x16x32_bf16 v[52:55], v[76:79], v[104:107], v[52:55]
    buffer_store_dwordx2 v[196:197], v8, s[44:47], s6 offen offset:1024 sc1
    ds_read_b128 v[176:179], v245 offset:18432
    s_add_u32 m0, s74, 8352
    v_mfma_f32_16x16x32_bf16 v[52:55], v[80:83], v[100:103], v[52:55]
    buffer_load_dwordx4 v240, s[48:51], s13 offen offset:1024 lds
    ds_read2_b32 v[144:145], v238 offset0:16 offset1:17
    v_mfma_f32_16x16x32_bf16 v[52:55], v[84:87], v[96:99], v[52:55]
    v_mfma_f32_16x16x32_bf16 v[48:51], v[64:67], v[112:115], 0
    ds_read2_b32 v[146:147], v238 offset0:18 offset1:19
    v_cvt_pk_bf16_f32 v194, v36, v37
    v_mfma_f32_16x16x32_bf16 v[48:51], v[68:71], v[108:111], v[48:51]
    ds_read_b128 v[180:183], v245 offset:22528
    v_mfma_f32_16x16x32_bf16 v[48:51], v[72:75], v[104:107], v[48:51]
    v_cvt_pk_bf16_f32 v195, v38, v39
    v_mfma_f32_16x16x32_bf16 v[48:51], v[76:79], v[100:103], v[48:51]
    buffer_store_dwordx2 v[194:195], v8, s[44:47], s6 offen offset:512 sc1
    ds_read2_b32 v[148:149], v238 offset0:144 offset1:145
    s_add_u32 m0, s74, 8352
    v_mfma_f32_16x16x32_bf16 v[48:51], v[80:83], v[96:99], v[48:51]
    buffer_load_dwordx4 v240, s[48:51], s13 offen offset:2048 lds
    ds_read2_b32 v[150:151], v238 offset0:146 offset1:147
    v_mfma_f32_16x16x32_bf16 v[44:47], v[64:67], v[108:111], 0
    ds_read_b128 v[184:187], v245 offset:26624
    v_mfma_f32_16x16x32_bf16 v[44:47], v[68:71], v[104:107], v[44:47]
    v_cvt_pk_bf16_f32 v192, v32, v33
    v_mfma_f32_16x16x32_bf16 v[44:47], v[72:75], v[100:103], v[44:47]
    s_add_u32 m0, s73, 147456
    ds_read2_b32 v[152:153], v239 offset0:16 offset1:17
    v_mfma_f32_16x16x32_bf16 v[44:47], v[76:79], v[96:99], v[44:47]
    buffer_load_dwordx4 v6, s[52:55], s14 offen offset:2048 lds
    v_cvt_pk_bf16_f32 v193, v34, v35
    v_mfma_f32_16x16x32_bf16 v[40:43], v[64:67], v[104:107], 0
    ds_read2_b32 v[154:155], v239 offset0:18 offset1:19
    v_mfma_f32_16x16x32_bf16 v[40:43], v[68:71], v[100:103], v[40:43]
    buffer_store_dwordx2 v[192:193], v8, s[44:47], s6 offen offset:0 sc1
    ds_read_b128 v[188:191], v245 offset:30720
    v_mfma_f32_16x16x32_bf16 v[40:43], v[72:75], v[96:99], v[40:43]
    s_add_u32 m0, s74, 8352
    ds_read2_b32 v[156:157], v239 offset0:144 offset1:145
    v_mfma_f32_16x16x32_bf16 v[36:39], v[64:67], v[100:103], 0
    buffer_load_dwordx4 v240, s[48:51], s13 offen offset:3072 lds
    v_mfma_f32_16x16x32_bf16 v[36:39], v[68:71], v[96:99], v[36:39]
    ds_read2_b32 v[158:159], v239 offset0:146 offset1:147
    v_mfma_f32_16x16x32_bf16 v[32:35], v[64:67], v[96:99], 0
    s_waitcnt lgkmcnt(12)
    v_mfma_f32_16x16x32_bf16 v[32:35], v[128:131], v[160:163], v[32:35]
    ds_read_b128 v[96:99], v246 offset:2048
    v_mfma_f32_16x16x32_bf16 v[36:39], v[132:135], v[160:163], v[36:39]
    v_mfma_f32_16x16x32_bf16 v[36:39], v[128:131], v[164:167], v[36:39]
    ds_read2_b32 v[64:65], v236 offset0:32 offset1:33
    v_mfma_f32_16x16x32_bf16 v[40:43], v[128:131], v[168:171], v[40:43]
    s_barrier
    ds_read2_b32 v[66:67], v236 offset0:34 offset1:35
    s_add_u32 m0, s73, 147456
    v_mfma_f32_16x16x32_bf16 v[40:43], v[132:135], v[164:167], v[40:43]
    buffer_load_dwordx4 v7, s[52:55], s14 offen offset:3072 lds
    v_mfma_f32_16x16x32_bf16 v[40:43], v[136:139], v[160:163], v[40:43]
    ds_read_b128 v[100:103], v246 offset:6144
    v_mfma_f32_16x16x32_bf16 v[44:47], v[140:143], v[160:163], v[44:47]
    ds_read2_b32 v[68:69], v236 offset0:160 offset1:161
    v_mfma_f32_16x16x32_bf16 v[44:47], v[136:139], v[164:167], v[44:47]
    v_mfma_f32_16x16x32_bf16 v[44:47], v[132:135], v[168:171], v[44:47]
    ds_read2_b32 v[70:71], v236 offset0:162 offset1:163
    v_mfma_f32_16x16x32_bf16 v[44:47], v[128:131], v[172:175], v[44:47]
    ds_read_b128 v[104:107], v246 offset:10240
    s_waitcnt lgkmcnt(7)
    v_mfma_f32_16x16x32_bf16 v[48:51], v[128:131], v[176:179], v[48:51]
    ds_read2_b32 v[72:73], v237 offset0:32 offset1:33
    v_mfma_f32_16x16x32_bf16 v[48:51], v[132:135], v[172:175], v[48:51]
    ds_read2_b32 v[74:75], v237 offset0:34 offset1:35
    v_mfma_f32_16x16x32_bf16 v[48:51], v[136:139], v[168:171], v[48:51]
    v_mov_b32 v9, 24
    buffer_load_ushort v9, v9, s[56:59], s70 offen
    v_mfma_f32_16x16x32_bf16 v[48:51], v[140:143], v[164:167], v[48:51]
    ds_read_b128 v[108:111], v246 offset:14336
    v_mfma_f32_16x16x32_bf16 v[48:51], v[144:147], v[160:163], v[48:51]
    v_mfma_f32_16x16x32_bf16 v[52:55], v[148:151], v[160:163], v[52:55]
    ds_read2_b32 v[76:77], v237 offset0:160 offset1:161
    v_mfma_f32_16x16x32_bf16 v[52:55], v[144:147], v[164:167], v[52:55]
    ds_read2_b32 v[78:79], v237 offset0:162 offset1:163
    v_mfma_f32_16x16x32_bf16 v[52:55], v[140:143], v[168:171], v[52:55]
    v_mfma_f32_16x16x32_bf16 v[52:55], v[136:139], v[172:175], v[52:55]
    s_lshl_b32 s14, s91, 18
    ds_read_b128 v[112:115], v246 offset:18432
    v_mfma_f32_16x16x32_bf16 v[52:55], v[132:135], v[176:179], v[52:55]
    s_add_u32 m0, s73, 0
    ds_read2_b32 v[80:81], v238 offset0:32 offset1:33
    v_mfma_f32_16x16x32_bf16 v[52:55], v[128:131], v[180:183], v[52:55]
    buffer_load_dwordx4 v4, s[52:55], s14 offen offset:0 lds
    v_mfma_f32_16x16x32_bf16 v[56:59], v[128:131], v[184:187], v[56:59]
    ds_read2_b32 v[82:83], v238 offset0:34 offset1:35
    v_mfma_f32_16x16x32_bf16 v[56:59], v[132:135], v[180:183], v[56:59]
    ds_read_b128 v[116:119], v246 offset:22528
    v_mfma_f32_16x16x32_bf16 v[56:59], v[136:139], v[176:179], v[56:59]
    v_mfma_f32_16x16x32_bf16 v[56:59], v[140:143], v[172:175], v[56:59]
    ds_read2_b32 v[84:85], v238 offset0:160 offset1:161
    v_mfma_f32_16x16x32_bf16 v[56:59], v[144:147], v[168:171], v[56:59]
    ds_read2_b32 v[86:87], v238 offset0:162 offset1:163
    v_mfma_f32_16x16x32_bf16 v[56:59], v[148:151], v[164:167], v[56:59]
    ds_read_b128 v[120:123], v246 offset:26624
    v_mfma_f32_16x16x32_bf16 v[56:59], v[152:155], v[160:163], v[56:59]
    v_mfma_f32_16x16x32_bf16 v[60:63], v[156:159], v[160:163], v[60:63]
    ds_read2_b32 v[88:89], v239 offset0:32 offset1:33
    v_mfma_f32_16x16x32_bf16 v[60:63], v[152:155], v[164:167], v[60:63]
    ds_read2_b32 v[90:91], v239 offset0:34 offset1:35
    v_mfma_f32_16x16x32_bf16 v[60:63], v[148:151], v[168:171], v[60:63]
    s_add_u32 m0, s73, 0
    v_mfma_f32_16x16x32_bf16 v[60:63], v[144:147], v[172:175], v[60:63]
    buffer_load_dwordx4 v5, s[52:55], s14 offen offset:1024 lds
    ds_read_b128 v[124:127], v246 offset:30720
    v_mfma_f32_16x16x32_bf16 v[60:63], v[140:143], v[176:179], v[60:63]
    ds_read2_b32 v[92:93], v239 offset0:160 offset1:161
    v_mfma_f32_16x16x32_bf16 v[60:63], v[136:139], v[180:183], v[60:63]
    v_mfma_f32_16x16x32_bf16 v[60:63], v[132:135], v[184:187], v[60:63]
    ds_read2_b32 v[94:95], v239 offset0:162 offset1:163
    v_mfma_f32_16x16x32_bf16 v[60:63], v[128:131], v[188:191], v[60:63]
    s_waitcnt lgkmcnt(12)
    v_mfma_f32_16x16x32_bf16 v[32:35], v[64:67], v[96:99], v[32:35]
    ds_read_b128 v[160:163], v247 offset:2048
    v_mfma_f32_16x16x32_bf16 v[36:39], v[68:71], v[96:99], v[36:39]
    v_mfma_f32_16x16x32_bf16 v[36:39], v[64:67], v[100:103], v[36:39]
    ds_read2_b32 v[128:129], v236 offset0:48 offset1:49
    v_mfma_f32_16x16x32_bf16 v[40:43], v[64:67], v[104:107], v[40:43]
    ds_read2_b32 v[130:131], v236 offset0:50 offset1:51
    v_mfma_f32_16x16x32_bf16 v[40:43], v[68:71], v[100:103], v[40:43]
    v_mfma_f32_16x16x32_bf16 v[40:43], v[72:75], v[96:99], v[40:43]
    ds_read_b128 v[164:167], v247 offset:6144
    v_mfma_f32_16x16x32_bf16 v[44:47], v[76:79], v[96:99], v[44:47]
    s_add_u32 m0, s73, 0
    ds_read2_b32 v[132:133], v236 offset0:176 offset1:177
    v_mfma_f32_16x16x32_bf16 v[44:47], v[72:75], v[100:103], v[44:47]
    buffer_load_dwordx4 v6, s[52:55], s14 offen offset:2048 lds
    v_mfma_f32_16x16x32_bf16 v[44:47], v[68:71], v[104:107], v[44:47]
    ds_read2_b32 v[134:135], v236 offset0:178 offset1:179
    v_mfma_f32_16x16x32_bf16 v[44:47], v[64:67], v[108:111], v[44:47]
    ds_read_b128 v[168:171], v247 offset:10240
    s_waitcnt lgkmcnt(7)
    v_mfma_f32_16x16x32_bf16 v[48:51], v[64:67], v[112:115], v[48:51]
    ds_read2_b32 v[136:137], v237 offset0:48 offset1:49
    v_mfma_f32_16x16x32_bf16 v[48:51], v[68:71], v[108:111], v[48:51]
    v_mfma_f32_16x16x32_bf16 v[48:51], v[72:75], v[104:107], v[48:51]
    ds_read2_b32 v[138:139], v237 offset0:50 offset1:51
    v_mfma_f32_16x16x32_bf16 v[48:51], v[76:79], v[100:103], v[48:51]
    ds_read_b128 v[172:175], v247 offset:14336
    v_mfma_f32_16x16x32_bf16 v[48:51], v[80:83], v[96:99], v[48:51]
    v_mfma_f32_16x16x32_bf16 v[52:55], v[84:87], v[96:99], v[52:55]
    ds_read2_b32 v[140:141], v237 offset0:176 offset1:177
    v_mfma_f32_16x16x32_bf16 v[52:55], v[80:83], v[100:103], v[52:55]
    ds_read2_b32 v[142:143], v237 offset0:178 offset1:179
    v_mfma_f32_16x16x32_bf16 v[52:55], v[76:79], v[104:107], v[52:55]
    v_mfma_f32_16x16x32_bf16 v[52:55], v[72:75], v[108:111], v[52:55]
    s_add_u32 m0, s73, 0
    ds_read_b128 v[176:179], v247 offset:18432
    v_mfma_f32_16x16x32_bf16 v[52:55], v[68:71], v[112:115], v[52:55]
    buffer_load_dwordx4 v7, s[52:55], s14 offen offset:3072 lds
    ds_read2_b32 v[144:145], v238 offset0:48 offset1:49
    v_mfma_f32_16x16x32_bf16 v[52:55], v[64:67], v[116:119], v[52:55]
    v_mfma_f32_16x16x32_bf16 v[56:59], v[64:67], v[120:123], v[56:59]
    ds_read2_b32 v[146:147], v238 offset0:50 offset1:51
    v_mfma_f32_16x16x32_bf16 v[56:59], v[68:71], v[116:119], v[56:59]
    ds_read_b128 v[180:183], v247 offset:22528
    v_mfma_f32_16x16x32_bf16 v[56:59], v[72:75], v[112:115], v[56:59]
    v_mfma_f32_16x16x32_bf16 v[56:59], v[76:79], v[108:111], v[56:59]
    ds_read2_b32 v[148:149], v238 offset0:176 offset1:177
    v_mfma_f32_16x16x32_bf16 v[56:59], v[80:83], v[104:107], v[56:59]
    ds_read2_b32 v[150:151], v238 offset0:178 offset1:179
    v_mfma_f32_16x16x32_bf16 v[56:59], v[84:87], v[100:103], v[56:59]
    ds_read_b128 v[184:187], v247 offset:26624
    v_mfma_f32_16x16x32_bf16 v[56:59], v[88:91], v[96:99], v[56:59]
    v_mfma_f32_16x16x32_bf16 v[60:63], v[92:95], v[96:99], v[60:63]
    s_lshl_b32 s14, s92, 18
    ds_read2_b32 v[152:153], v239 offset0:48 offset1:49
    v_mfma_f32_16x16x32_bf16 v[60:63], v[88:91], v[100:103], v[60:63]
    s_add_u32 m0, s73, 16384
    ds_read2_b32 v[154:155], v239 offset0:50 offset1:51
    v_mfma_f32_16x16x32_bf16 v[60:63], v[84:87], v[104:107], v[60:63]
    buffer_load_dwordx4 v4, s[52:55], s14 offen offset:0 lds
    v_mfma_f32_16x16x32_bf16 v[60:63], v[80:83], v[108:111], v[60:63]
    ds_read_b128 v[188:191], v247 offset:30720
    v_mfma_f32_16x16x32_bf16 v[60:63], v[76:79], v[112:115], v[60:63]
    ds_read2_b32 v[156:157], v239 offset0:176 offset1:177
    v_mfma_f32_16x16x32_bf16 v[60:63], v[72:75], v[116:119], v[60:63]
    v_mfma_f32_16x16x32_bf16 v[60:63], v[68:71], v[120:123], v[60:63]
    ds_read2_b32 v[158:159], v239 offset0:178 offset1:179
L_pl_X_4:
    s_cbranch_execz L_wret
    v_mfma_f32_16x16x32_bf16 v[60:63], v[64:67], v[124:127], v[60:63]
    s_waitcnt lgkmcnt(12)
    v_mfma_f32_16x16x32_bf16 v[32:35], v[128:131], v[160:163], v[32:35]
    ds_read_b128 v[96:99], v244 offset:0
    v_mfma_f32_16x16x32_bf16 v[36:39], v[132:135], v[160:163], v[36:39]
    ds_read2_b32 v[64:65], v236 offset0:64 offset1:65
    v_mfma_f32_16x16x32_bf16 v[36:39], v[128:131], v[164:167], v[36:39]
    ds_read2_b32 v[66:67], v236 offset0:66 offset1:67
    v_mfma_f32_16x16x32_bf16 v[40:43], v[128:131], v[168:171], v[40:43]
    ds_read_b128 v[100:103], v244 offset:4096
    v_mfma_f32_16x16x32_bf16 v[40:43], v[132:135], v[164:167], v[40:43]
    ds_read2_b32 v[68:69], v236 offset0:192 offset1:193
    v_mfma_f32_16x16x32_bf16 v[40:43], v[136:139], v[160:163], v[40:43]
    s_add_u32 m0, s73, 16384
    ds_read2_b32 v[70:71], v236 offset0:194 offset1:195
    v_mfma_f32_16x16x32_bf16 v[44:47], v[140:143], v[160:163], v[44:47]
    buffer_load_dwordx4 v5, s[52:55], s14 offen offset:1024 lds
    ds_read_b128 v[104:107], v244 offset:8192
    v_mfma_f32_16x16x32_bf16 v[44:47], v[136:139], v[164:167], v[44:47]
    ds_read2_b32 v[72:73], v237 offset0:64 offset1:65
    s_waitcnt vmcnt(7)
    s_barrier
    v_mfma_f32_16x16x32_bf16 v[44:47], v[132:135], v[168:171], v[44:47]
    ds_read_b64_tr_b16 a[96:97], v10 offset:16384
    v_mfma_f32_16x16x32_bf16 v[44:47], v[128:131], v[172:175], v[44:47]
    ds_read2_b32 v[74:75], v237 offset0:66 offset1:67
    s_waitcnt lgkmcnt(10)
    v_mfma_f32_16x16x32_bf16 v[48:51], v[128:131], v[176:179], v[48:51]
    ds_read_b64_tr_b16 a[98:99], v10 offset:18432
    v_mfma_f32_16x16x32_bf16 v[48:51], v[132:135], v[172:175], v[48:51]
    ds_read_b64_tr_b16 a[104:105], v10 offset:20480
    v_mfma_f32_16x16x32_bf16 v[48:51], v[136:139], v[168:171], v[48:51]
    ds_read_b64_tr_b16 a[106:107], v10 offset:22528
    v_mfma_f32_16x16x32_bf16 v[48:51], v[140:143], v[164:167], v[48:51]
    ds_read_b128 v[108:111], v244 offset:12288
    v_mfma_f32_16x16x32_bf16 v[48:51], v[144:147], v[160:163], v[48:51]
    ds_read_b64_tr_b16 a[100:101], v11 offset:16384
    v_mfma_f32_16x16x32_bf16 v[52:55], v[148:151], v[160:163], v[52:55]
    ds_read_b64_tr_b16 a[102:103], v11 offset:18432
    v_mfma_f32_16x16x32_bf16 v[52:55], v[144:147], v[164:167], v[52:55]
    ds_read2_b32 v[76:77], v237 offset0:192 offset1:193
    v_mfma_f32_16x16x32_bf16 v[52:55], v[140:143], v[168:171], v[52:55]
    ds_read_b64_tr_b16 a[108:109], v11 offset:20480
    s_add_u32 m0, s73, 16384
    v_mfma_f32_16x16x32_bf16 v[52:55], v[136:139], v[172:175], v[52:55]
    ds_read_b64_tr_b16 a[110:111], v11 offset:22528
    buffer_load_dwordx4 v6, s[52:55], s14 offen offset:2048 lds
    v_mfma_f32_16x16x32_bf16 v[52:55], v[132:135], v[176:179], v[52:55]
    ds_read2_b32 v[78:79], v237 offset0:194 offset1:195
    v_mfma_f32_16x16x32_bf16 v[52:55], v[128:131], v[180:183], v[52:55]
    ds_read_b128 v[112:115], v244 offset:16384
    v_mfma_f32_16x16x32_bf16 v[56:59], v[128:131], v[184:187], v[56:59]
    ds_read2_b32 v[80:81], v238 offset0:64 offset1:65
    v_mfma_f32_16x16x32_bf16 v[56:59], v[132:135], v[180:183], v[56:59]
    ds_read2_b32 v[82:83], v238 offset0:66 offset1:67
    v_mfma_f32_16x16x32_bf16 v[56:59], v[136:139], v[176:179], v[56:59]
    ds_read_b128 v[116:119], v244 offset:20480
    v_mfma_f32_16x16x32_bf16 v[56:59], v[140:143], v[172:175], v[56:59]
    ds_read2_b32 v[84:85], v238 offset0:192 offset1:193
    v_mfma_f32_16x16x32_bf16 v[56:59], v[144:147], v[168:171], v[56:59]
    ds_read2_b32 v[86:87], v238 offset0:194 offset1:195
    v_mfma_f32_16x16x32_bf16 v[56:59], v[148:151], v[164:167], v[56:59]
    ds_read_b128 v[120:123], v244 offset:24576
    v_mfma_f32_16x16x32_bf16 v[56:59], v[152:155], v[160:163], v[56:59]
    v_mfma_f32_16x16x32_bf16 v[60:63], v[156:159], v[160:163], v[60:63]
    s_add_u32 m0, s73, 16384
    ds_read2_b32 v[88:89], v239 offset0:64 offset1:65
    v_mfma_f32_16x16x32_bf16 v[60:63], v[152:155], v[164:167], v[60:63]
    buffer_load_dwordx4 v7, s[52:55], s14 offen offset:3072 lds
    ds_read2_b32 v[90:91], v239 offset0:66 offset1:67
    v_mfma_f32_16x16x32_bf16 v[60:63], v[148:151], v[168:171], v[60:63]
    v_mfma_f32_16x16x32_bf16 v[60:63], v[144:147], v[172:175], v[60:63]
    ds_read_b128 v[124:127], v244 offset:28672
    v_mfma_f32_16x16x32_bf16 v[60:63], v[140:143], v[176:179], v[60:63]
    ds_read2_b32 v[92:93], v239 offset0:192 offset1:193
    v_mfma_f32_16x16x32_bf16 v[60:63], v[136:139], v[180:183], v[60:63]
    v_mfma_f32_16x16x32_bf16 v[60:63], v[132:135], v[184:187], v[60:63]
    ds_read2_b32 v[94:95], v239 offset0:194 offset1:195
    v_mfma_f32_16x16x32_bf16 v[60:63], v[128:131], v[188:191], v[60:63]
    s_waitcnt lgkmcnt(12)
    v_mfma_f32_16x16x32_bf16 v[32:35], v[64:67], v[96:99], v[32:35]
    ds_read_b128 v[160:163], v245 offset:0
    v_mfma_f32_16x16x32_bf16 v[36:39], v[68:71], v[96:99], v[36:39]
    ds_read2_b32 v[128:129], v236 offset0:80 offset1:81
    v_mfma_f32_16x16x32_bf16 v[36:39], v[64:67], v[100:103], v[36:39]
    ds_read2_b32 v[130:131], v236 offset0:82 offset1:83
    v_mfma_f32_16x16x32_bf16 v[40:43], v[64:67], v[104:107], v[40:43]
    ds_read_b128 v[164:167], v245 offset:4096
    s_barrier
    v_mfma_f32_16x16x32_bf16 v[40:43], v[68:71], v[100:103], v[40:43]
    ds_read2_b32 v[132:133], v236 offset0:208 offset1:209
    v_mfma_f32_16x16x32_bf16 v[40:43], v[72:75], v[96:99], v[40:43]
    ds_read2_b32 v[134:135], v236 offset0:210 offset1:211
    v_mfma_f32_16x16x32_bf16 v[44:47], v[76:79], v[96:99], v[44:47]
    ds_read_b128 v[168:171], v245 offset:8192
    v_mfma_f32_16x16x32_bf16 v[44:47], v[72:75], v[100:103], v[44:47]
    s_lshl_b32 s14, s93, 18
    ds_read2_b32 v[136:137], v237 offset0:80 offset1:81
    v_mfma_f32_16x16x32_bf16 v[44:47], v[68:71], v[104:107], v[44:47]
    s_add_u32 m0, s73, 147456
    ds_read2_b32 v[138:139], v237 offset0:82 offset1:83
    v_mfma_f32_16x16x32_bf16 v[44:47], v[64:67], v[108:111], v[44:47]
    buffer_load_dwordx4 v4, s[52:55], s14 offen offset:0 lds
    ds_read_b128 v[172:175], v245 offset:12288
    s_waitcnt lgkmcnt(10)
    v_mfma_f32_16x16x32_bf16 v[48:51], v[64:67], v[112:115], v[48:51]
    ds_read2_b32 v[140:141], v237 offset0:208 offset1:209
    v_mfma_f32_16x16x32_bf16 v[48:51], v[68:71], v[108:111], v[48:51]
    ds_read2_b32 v[142:143], v237 offset0:210 offset1:211
    v_mfma_f32_16x16x32_bf16 v[48:51], v[72:75], v[104:107], v[48:51]
    ds_read_b128 v[176:179], v245 offset:16384
    v_mfma_f32_16x16x32_bf16 v[48:51], v[76:79], v[100:103], v[48:51]
    ds_read2_b32 v[144:145], v238 offset0:80 offset1:81
    v_mfma_f32_16x16x32_bf16 v[48:51], v[80:83], v[96:99], v[48:51]
    ds_read2_b32 v[146:147], v238 offset0:82 offset1:83
    v_mfma_f32_16x16x32_bf16 v[52:55], v[84:87], v[96:99], v[52:55]
    ds_read_b128 v[180:183], v245 offset:20480
    v_mfma_f32_16x16x32_bf16 v[52:55], v[80:83], v[100:103], v[52:55]
    ds_read2_b32 v[148:149], v238 offset0:208 offset1:209
    v_mfma_f32_16x16x32_bf16 v[52:55], v[76:79], v[104:107], v[52:55]
    ds_read2_b32 v[150:151], v238 offset0:210 offset1:211
    v_mfma_f32_16x16x32_bf16 v[52:55], v[72:75], v[108:111], v[52:55]
    ds_read_b128 v[184:187], v245 offset:24576
    v_mfma_f32_16x16x32_bf16 v[52:55], v[68:71], v[112:115], v[52:55]
    s_add_u32 m0, s73, 147456
    ds_read_b128 v[212:215], v241 offset:8352
    v_mfma_f32_16x16x32_bf16 v[52:55], v[64:67], v[116:119], v[52:55]
    buffer_load_dwordx4 v5, s[52:55], s14 offen offset:1024 lds
    ds_read2_b32 v[152:153], v239 offset0:80 offset1:81
    v_mfma_f32_16x16x32_bf16 v[56:59], v[64:67], v[120:123], v[56:59]
    ds_read_b32 v216, v241 offset:8368
    v_mfma_f32_16x16x32_bf16 v[56:59], v[68:71], v[116:119], v[56:59]
    ds_read_b128 v[218:221], v241 offset:9376
    v_mfma_f32_16x16x32_bf16 v[56:59], v[72:75], v[112:115], v[56:59]
    ds_read_b32 v222, v241 offset:9392
    v_mfma_f32_16x16x32_bf16 v[56:59], v[76:79], v[108:111], v[56:59]
    ds_read_b128 v[224:227], v241 offset:10400
    v_mfma_f32_16x16x32_bf16 v[56:59], v[80:83], v[104:107], v[56:59]
    ds_read_b32 v228, v241 offset:10416
    s_waitcnt vmcnt(6)
    s_barrier
    v_mfma_f32_16x16x32_bf16 v[56:59], v[84:87], v[100:103], v[56:59]
    ds_read_b128 v[230:233], v241 offset:11424
    v_add_u32 v10, -131072, v10
    v_mfma_f32_16x16x32_bf16 v[56:59], v[88:91], v[96:99], v[56:59]
    ds_read_b64_tr_b16 a[112:113], v10 offset:0
    v_mfma_f32_16x16x32_bf16 v[60:63], v[92:95], v[96:99], v[60:63]
    ds_read_b64_tr_b16 a[114:115], v10 offset:2048
    v_mfma_f32_16x16x32_bf16 v[60:63], v[88:91], v[100:103], v[60:63]
    ds_read_b64_tr_b16 a[120:121], v10 offset:4096
    ds_read2_b32 v[154:155], v239 offset0:82 offset1:83
    v_mfma_f32_16x16x32_bf16 v[60:63], v[84:87], v[104:107], v[60:63]
    ds_read_b32 v234, v241 offset:11440
    v_mfma_f32_16x16x32_bf16 v[60:63], v[80:83], v[108:111], v[60:63]
    ds_read_b64_tr_b16 a[122:123], v10 offset:6144
    s_add_u32 m0, s73, 147456
    ds_read_b128 v[188:191], v245 offset:28672
    v_mfma_f32_16x16x32_bf16 v[60:63], v[76:79], v[112:115], v[60:63]
    v_add_u32 v11, -131072, v11
    buffer_load_dwordx4 v6, s[52:55], s14 offen offset:2048 lds
    ds_read2_b32 v[156:157], v239 offset0:208 offset1:209
    v_mfma_f32_16x16x32_bf16 v[60:63], v[72:75], v[116:119], v[60:63]
    ds_read_b64_tr_b16 a[116:117], v11 offset:0
    v_mfma_f32_16x16x32_bf16 v[60:63], v[68:71], v[120:123], v[60:63]
    ds_read_b64_tr_b16 a[118:119], v11 offset:2048
    ds_read2_b32 v[158:159], v239 offset0:210 offset1:211
    v_mfma_f32_16x16x32_bf16 v[60:63], v[64:67], v[124:127], v[60:63]
    ds_read_b64_tr_b16 a[124:125], v11 offset:4096
    s_waitcnt lgkmcnt(15)
    v_mfma_f32_16x16x32_bf16 v[32:35], v[128:131], v[160:163], v[32:35]
    ds_read_b64_tr_b16 a[126:127], v11 offset:6144
    v_mfma_f32_16x16x32_bf16 v[36:39], v[132:135], v[160:163], v[36:39]
    ds_read_b128 v[96:99], v246 offset:0
    v_mfma_f32_16x16x32_bf16 v[36:39], v[128:131], v[164:167], v[36:39]
    ds_read2_b32 v[64:65], v236 offset0:96 offset1:97
    v_mfma_f32_16x16x32_bf16 v[40:43], v[128:131], v[168:171], v[40:43]
    ds_read2_b32 v[66:67], v236 offset0:98 offset1:99
    v_mfma_f32_16x16x32_bf16 v[40:43], v[132:135], v[164:167], v[40:43]
    s_waitcnt lgkmcnt(11)
    v_mfma_f32_16x16x32_bf16 v[40:43], v[136:139], v[160:163], v[40:43]
    ds_read_b128 v[100:103], v246 offset:4096
    v_mfma_f32_16x16x32_bf16 v[44:47], v[140:143], v[160:163], v[44:47]
    ds_read2_b32 v[68:69], v236 offset0:224 offset1:225
    v_mfma_f32_16x16x32_bf16 v[44:47], v[136:139], v[164:167], v[44:47]
    s_add_u32 m0, s73, 147456
    ds_read2_b32 v[70:71], v236 offset0:226 offset1:227
    v_mfma_f32_16x16x32_bf16 v[44:47], v[132:135], v[168:171], v[44:47]
    buffer_load_dwordx4 v7, s[52:55], s14 offen offset:3072 lds
    v_lshlrev_b32 v9, 16, v9
    v_mfma_f32_16x16x32_bf16 v[44:47], v[128:131], v[172:175], v[44:47]
    ds_read_b128 v[104:107], v246 offset:8192
    s_waitcnt lgkmcnt(9)
    v_mfma_f32_16x16x32_bf16 v[48:51], v[128:131], v[176:179], v[48:51]
    ds_read2_b32 v[72:73], v237 offset0:96 offset1:97
    v_lshlrev_b32 v208, 16, v212
    v_mfma_f32_16x16x32_bf16 v[48:51], v[132:135], v[172:175], v[48:51]
    v_mfma_f32_16x16x32_bf16 v[48:51], v[136:139], v[168:171], v[48:51]
    ds_read2_b32 v[74:75], v237 offset0:98 offset1:99
    v_add_f32 v9, v9, v208
    v_mfma_f32_16x16x32_bf16 v[48:51], v[140:143], v[164:167], v[48:51]
    ds_read_b128 v[108:111], v246 offset:12288
    v_cvt_pk_bf16_f32 v9, v9, v9
    v_mfma_f32_16x16x32_bf16 v[48:51], v[144:147], v[160:163], v[48:51]
    ds_read2_b32 v[76:77], v237 offset0:224 offset1:225
    s_waitcnt lgkmcnt(11)
    s_barrier
    v_mfma_f32_16x16x32_bf16 v[52:55], v[148:151], v[160:163], v[52:55]
    ds_write_b16 v242, v9 offset:12480
    v_mfma_f32_16x16x32_bf16 v[52:55], v[144:147], v[164:167], v[52:55]
    ds_read2_b32 v[78:79], v237 offset0:226 offset1:227
    v_mfma_f32_16x16x32_bf16 v[52:55], v[140:143], v[168:171], v[52:55]
    ds_write_b16 v242, v9 offset:8322
    v_mfma_f32_16x16x32_bf16 v[52:55], v[136:139], v[172:175], v[52:55]
    s_lshl_b32 s14, s94, 18
    ds_read_b128 v[112:115], v246 offset:16384
    v_mfma_f32_16x16x32_bf16 v[52:55], v[132:135], v[176:179], v[52:55]
    ds_read2_b32 v[80:81], v238 offset0:96 offset1:97
    s_add_u32 m0, s73, 0
    v_alignbit_b32 v212, v213, v212, 16
    v_mfma_f32_16x16x32_bf16 v[52:55], v[128:131], v[180:183], v[52:55]
    buffer_load_dwordx4 v4, s[52:55], s14 offen offset:0 lds
    v_alignbit_b32 v213, v214, v213, 16
    v_mfma_f32_16x16x32_bf16 v[56:59], v[128:131], v[184:187], v[56:59]
    ds_read2_b32 v[82:83], v238 offset0:98 offset1:99
    v_mfma_f32_16x16x32_bf16 v[56:59], v[132:135], v[180:183], v[56:59]
    ds_read_b128 v[116:119], v246 offset:20480
    v_alignbit_b32 v214, v215, v214, 16
    v_mfma_f32_16x16x32_bf16 v[56:59], v[136:139], v[176:179], v[56:59]
    v_mfma_f32_16x16x32_bf16 v[56:59], v[140:143], v[172:175], v[56:59]
    ds_read2_b32 v[84:85], v238 offset0:224 offset1:225
    v_alignbit_b32 v215, v216, v215, 16
    v_mfma_f32_16x16x32_bf16 v[56:59], v[144:147], v[168:171], v[56:59]
    ds_read2_b32 v[86:87], v238 offset0:226 offset1:227
    v_mfma_f32_16x16x32_bf16 v[56:59], v[148:151], v[164:167], v[56:59]
    ds_write_b128 v241, v[212:215] offset:12512
    v_mfma_f32_16x16x32_bf16 v[56:59], v[152:155], v[160:163], v[56:59]
    ds_read_b128 v[120:123], v246 offset:24576
    v_mfma_f32_16x16x32_bf16 v[60:63], v[156:159], v[160:163], v[60:63]
    ds_read2_b32 v[88:89], v239 offset0:96 offset1:97
    v_alignbit_b32 v218, v219, v218, 16
    v_mfma_f32_16x16x32_bf16 v[60:63], v[152:155], v[164:167], v[60:63]
    ds_read2_b32 v[90:91], v239 offset0:98 offset1:99
    v_alignbit_b32 v219, v220, v219, 16
    v_mfma_f32_16x16x32_bf16 v[60:63], v[148:151], v[168:171], v[60:63]
    s_add_u32 m0, s73, 0
    ds_read_b128 v[124:127], v246 offset:28672
    v_mfma_f32_16x16x32_bf16 v[60:63], v[144:147], v[172:175], v[60:63]
    buffer_load_dwordx4 v5, s[52:55], s14 offen offset:1024 lds
    v_alignbit_b32 v220, v221, v220, 16
    v_mfma_f32_16x16x32_bf16 v[60:63], v[140:143], v[176:179], v[60:63]
    ds_read2_b32 v[92:93], v239 offset0:224 offset1:225
    v_mfma_f32_16x16x32_bf16 v[60:63], v[136:139], v[180:183], v[60:63]
    ds_read2_b32 v[94:95], v239 offset0:226 offset1:227
    v_alignbit_b32 v221, v222, v221, 16
    v_mfma_f32_16x16x32_bf16 v[60:63], v[132:135], v[184:187], v[60:63]
    ds_write_b128 v241, v[218:221] offset:13536
    v_mfma_f32_16x16x32_bf16 v[60:63], v[128:131], v[188:191], v[60:63]
    s_waitcnt lgkmcnt(15)
    v_mfma_f32_16x16x32_bf16 v[32:35], v[64:67], v[96:99], v[32:35]
    ds_read_b128 v[160:163], v247 offset:0
    s_waitcnt vmcnt(6)
    s_barrier
    v_mfma_f32_16x16x32_bf16 v[36:39], v[68:71], v[96:99], v[36:39]
    ds_read_b64_tr_b16 a[128:129], v10 offset:16384
    v_alignbit_b32 v224, v225, v224, 16
    v_mfma_f32_16x16x32_bf16 v[36:39], v[64:67], v[100:103], v[36:39]
    ds_read_b64_tr_b16 a[130:131], v10 offset:18432
    ds_read_b128 v[164:167], v247 offset:4096
    v_mfma_f32_16x16x32_bf16 v[40:43], v[64:67], v[104:107], v[40:43]
    ds_read_b128 v[168:171], v247 offset:8192
    v_mfma_f32_16x16x32_bf16 v[40:43], v[68:71], v[100:103], v[40:43]
    ds_read_b64_tr_b16 a[136:137], v10 offset:20480
    ds_read_b128 v[172:175], v247 offset:12288
    v_mfma_f32_16x16x32_bf16 v[40:43], v[72:75], v[96:99], v[40:43]
    ds_read_b64_tr_b16 a[138:139], v10 offset:22528
    v_alignbit_b32 v225, v226, v225, 16
    v_mfma_f32_16x16x32_bf16 v[44:47], v[76:79], v[96:99], v[44:47]
    s_add_u32 m0, s73, 0
    ds_read_b128 v[176:179], v247 offset:16384
    v_mfma_f32_16x16x32_bf16 v[44:47], v[72:75], v[100:103], v[44:47]
    ds_read_b64_tr_b16 a[132:133], v11 offset:16384
    buffer_load_dwordx4 v6, s[52:55], s14 offen offset:2048 lds
    ds_read_b128 v[180:183], v247 offset:20480
    v_mfma_f32_16x16x32_bf16 v[44:47], v[68:71], v[104:107], v[44:47]
    ds_read_b64_tr_b16 a[134:135], v11 offset:18432
    v_mfma_f32_16x16x32_bf16 v[44:47], v[64:67], v[108:111], v[44:47]
    ds_read_b128 v[184:187], v247 offset:24576
    v_alignbit_b32 v226, v227, v226, 16
    s_waitcnt lgkmcnt(14)
    v_mfma_f32_16x16x32_bf16 v[48:51], v[64:67], v[112:115], v[48:51]
    ds_read_b64_tr_b16 a[140:141], v11 offset:20480
    ds_read_b128 v[188:191], v247 offset:28672
    v_mfma_f32_16x16x32_bf16 v[48:51], v[68:71], v[108:111], v[48:51]
    ds_read_b64_tr_b16 a[142:143], v11 offset:22528
    v_mfma_f32_16x16x32_bf16 v[48:51], v[72:75], v[104:107], v[48:51]
    ds_read2_b32 v[128:129], v236 offset0:112 offset1:113
    v_alignbit_b32 v227, v228, v227, 16
    v_mfma_f32_16x16x32_bf16 v[48:51], v[76:79], v[100:103], v[48:51]
    ds_read2_b32 v[130:131], v236 offset0:114 offset1:115
    v_mfma_f32_16x16x32_bf16 v[48:51], v[80:83], v[96:99], v[48:51]
    ds_read2_b32 v[132:133], v236 offset0:240 offset1:241
    v_mfma_f32_16x16x32_bf16 v[52:55], v[84:87], v[96:99], v[52:55]
    ds_read2_b32 v[134:135], v236 offset0:242 offset1:243
    v_mfma_f32_16x16x32_bf16 v[52:55], v[80:83], v[100:103], v[52:55]
    ds_write_b128 v241, v[224:227] offset:14560
    v_mfma_f32_16x16x32_bf16 v[52:55], v[76:79], v[104:107], v[52:55]
    ds_read2_b32 v[136:137], v237 offset0:112 offset1:113
    ds_read2_b32 v[138:139], v237 offset0:114 offset1:115
    v_mfma_f32_16x16x32_bf16 v[52:55], v[72:75], v[108:111], v[52:55]
    s_add_u32 m0, s73, 0
    ds_read2_b32 v[140:141], v237 offset0:240 offset1:241
    s_add_u32 s6, s12, 4751360
    v_mfma_f32_16x16x32_bf16 v[52:55], v[68:71], v[112:115], v[52:55]
    buffer_load_dwordx4 v7, s[52:55], s14 offen offset:3072 lds
    v_alignbit_b32 v230, v231, v230, 16
    v_mfma_f32_16x16x32_bf16 v[52:55], v[64:67], v[116:119], v[52:55]
    ds_read2_b32 v[142:143], v237 offset0:242 offset1:243
    v_xor_b32 v244, 64, v244
    v_mfma_f32_16x16x32_bf16 v[56:59], v[64:67], v[120:123], v[56:59]
    ds_read2_b32 v[144:145], v238 offset0:112 offset1:113
    v_mfma_f32_16x16x32_bf16 v[56:59], v[68:71], v[116:119], v[56:59]
    ds_read2_b32 v[146:147], v238 offset0:114 offset1:115
    v_mfma_f32_16x16x32_bf16 v[56:59], v[72:75], v[112:115], v[56:59]
    ds_read2_b32 v[148:149], v238 offset0:240 offset1:241
    v_alignbit_b32 v231, v232, v231, 16
    v_mfma_f32_16x16x32_bf16 v[56:59], v[76:79], v[108:111], v[56:59]
    ds_read2_b32 v[150:151], v238 offset0:242 offset1:243
    v_xor_b32 v245, 64, v245
    v_mfma_f32_16x16x32_bf16 v[56:59], v[80:83], v[104:107], v[56:59]
    ds_read2_b32 v[152:153], v239 offset0:112 offset1:113
    s_waitcnt lgkmcnt(14)
    s_barrier
    v_mfma_f32_16x16x32_bf16 v[56:59], v[84:87], v[100:103], v[56:59]
    ds_read2_b32 v[154:155], v239 offset0:114 offset1:115
    v_mfma_f32_16x16x32_bf16 v[56:59], v[88:91], v[96:99], v[56:59]
    ds_read2_b32 v[156:157], v239 offset0:240 offset1:241
    v_alignbit_b32 v232, v233, v232, 16
    v_mfma_f32_16x16x32_bf16 v[60:63], v[92:95], v[96:99], v[60:63]
    s_lshl_b32 s14, s95, 18
    ds_read2_b32 v[158:159], v239 offset0:242 offset1:243
    v_mfma_f32_16x16x32_bf16 v[60:63], v[88:91], v[100:103], v[60:63]
    s_add_u32 m0, s73, 16384
    v_xor_b32 v246, 64, v246
    v_add_u32 v236, 8320, v236
    v_mfma_f32_16x16x32_bf16 v[60:63], v[84:87], v[104:107], v[60:63]
    buffer_load_dwordx4 v4, s[52:55], s14 offen offset:0 lds
    v_alignbit_b32 v233, v234, v233, 16
    v_mfma_f32_16x16x32_bf16 v[60:63], v[80:83], v[108:111], v[60:63]
    v_add_u32 v237, 8320, v237
    v_mfma_f32_16x16x32_bf16 v[60:63], v[76:79], v[112:115], v[60:63]
    v_mfma_f32_16x16x32_bf16 v[60:63], v[72:75], v[116:119], v[60:63]
    v_xor_b32 v247, 64, v247
    v_add_u32 v238, 8320, v238
    v_mfma_f32_16x16x32_bf16 v[60:63], v[68:71], v[120:123], v[60:63]
    ds_write_b128 v241, v[230:233] offset:15584
    v_mfma_f32_16x16x32_bf16 v[60:63], v[64:67], v[124:127], v[60:63]
    v_add_u32 v239, 8320, v239
    s_waitcnt lgkmcnt(1)
    v_mfma_f32_16x16x32_bf16 v[60:63], v[128:131], v[188:191], v[60:63]
    ds_read_b128 v[96:99], v244 offset:2048
    v_mfma_f32_16x16x32_bf16 v[60:63], v[132:135], v[184:187], v[60:63]
    ds_read2_b32 v[64:65], v236 offset0:0 offset1:1
    v_mfma_f32_16x16x32_bf16 v[60:63], v[136:139], v[180:183], v[60:63]
    ds_read2_b32 v[66:67], v236 offset0:2 offset1:3
    v_mfma_f32_16x16x32_bf16 v[60:63], v[140:143], v[176:179], v[60:63]
    ds_read_b128 v[100:103], v244 offset:6144
    v_mfma_f32_16x16x32_bf16 v[60:63], v[144:147], v[172:175], v[60:63]
    ds_read2_b32 v[68:69], v236 offset0:128 offset1:129
    v_mfma_f32_16x16x32_bf16 v[60:63], v[148:151], v[168:171], v[60:63]
    s_add_u32 m0, s73, 16384
    ds_read2_b32 v[70:71], v236 offset0:130 offset1:131
    v_mfma_f32_16x16x32_bf16 v[60:63], v[152:155], v[164:167], v[60:63]
    buffer_load_dwordx4 v5, s[52:55], s14 offen offset:1024 lds
    ds_read_b128 v[104:107], v244 offset:10240
    v_mfma_f32_16x16x32_bf16 v[60:63], v[156:159], v[160:163], v[60:63]
    ds_read2_b32 v[72:73], v237 offset0:0 offset1:1
    v_mfma_f32_16x16x32_bf16 v[56:59], v[128:131], v[184:187], v[56:59]
    ds_read2_b32 v[74:75], v237 offset0:2 offset1:3
    v_mfma_f32_16x16x32_bf16 v[56:59], v[132:135], v[180:183], v[56:59]
    ds_read_b128 v[108:111], v244 offset:14336
    v_mfma_f32_16x16x32_bf16 v[56:59], v[136:139], v[176:179], v[56:59]
    ds_read2_b32 v[76:77], v237 offset0:128 offset1:129
    v_mfma_f32_16x16x32_bf16 v[56:59], v[140:143], v[172:175], v[56:59]
    ds_read2_b32 v[78:79], v237 offset0:130 offset1:131
    v_mfma_f32_16x16x32_bf16 v[56:59], v[144:147], v[168:171], v[56:59]
    ds_read_b128 v[112:115], v244 offset:18432
    v_mfma_f32_16x16x32_bf16 v[56:59], v[148:151], v[164:167], v[56:59]
    ds_read2_b32 v[80:81], v238 offset0:0 offset1:1
    v_cvt_pk_bf16_f32 v206, v60, v61
    v_mfma_f32_16x16x32_bf16 v[56:59], v[152:155], v[160:163], v[56:59]
    ds_read2_b32 v[82:83], v238 offset0:2 offset1:3
    s_waitcnt vmcnt(6)
    s_barrier
    v_mfma_f32_16x16x32_bf16 v[52:55], v[128:131], v[180:183], v[52:55]
    ds_read_b128 v[116:119], v244 offset:22528
    v_add_u32 v10, 131072, v10
    v_mfma_f32_16x16x32_bf16 v[52:55], v[132:135], v[176:179], v[52:55]
    ds_read_b64_tr_b16 a[144:145], v10 offset:16384
    v_cvt_pk_bf16_f32 v207, v62, v63
    v_mfma_f32_16x16x32_bf16 v[52:55], v[136:139], v[172:175], v[52:55]
    ds_read_b64_tr_b16 a[146:147], v10 offset:18432
    s_add_u32 m0, s73, 16384
    v_mfma_f32_16x16x32_bf16 v[52:55], v[140:143], v[168:171], v[52:55]
    buffer_load_dwordx4 v6, s[52:55], s14 offen offset:2048 lds
    ds_read2_b32 v[84:85], v238 offset0:128 offset1:129
    v_mfma_f32_16x16x32_bf16 v[52:55], v[144:147], v[164:167], v[52:55]
    buffer_store_dwordx2 v[206:207], v8, s[44:47], s6 offen offset:3584 sc1
    ds_read_b64_tr_b16 a[152:153], v10 offset:20480
    v_mfma_f32_16x16x32_bf16 v[52:55], v[148:151], v[160:163], v[52:55]
    ds_read_b64_tr_b16 a[154:155], v10 offset:22528
    v_mfma_f32_16x16x32_bf16 v[48:51], v[128:131], v[176:179], v[48:51]
    ds_read2_b32 v[86:87], v238 offset0:130 offset1:131
    v_add_u32 v11, 131072, v11
    v_cvt_pk_bf16_f32 v204, v56, v57
    v_mfma_f32_16x16x32_bf16 v[48:51], v[132:135], v[172:175], v[48:51]
    ds_read_b64_tr_b16 a[148:149], v11 offset:16384
    ds_read_b128 v[120:123], v244 offset:26624
    v_mfma_f32_16x16x32_bf16 v[48:51], v[136:139], v[168:171], v[48:51]
    ds_read_b64_tr_b16 a[150:151], v11 offset:18432
    ds_read2_b32 v[88:89], v239 offset0:0 offset1:1
    v_mfma_f32_16x16x32_bf16 v[48:51], v[140:143], v[164:167], v[48:51]
    ds_read2_b32 v[90:91], v239 offset0:2 offset1:3
    v_cvt_pk_bf16_f32 v205, v58, v59
    v_mfma_f32_16x16x32_bf16 v[48:51], v[144:147], v[160:163], v[48:51]
    ds_read_b64_tr_b16 a[156:157], v11 offset:20480
    ds_read_b128 v[124:127], v244 offset:30720
    v_mfma_f32_16x16x32_bf16 v[44:47], v[128:131], v[172:175], v[44:47]
    buffer_store_dwordx2 v[204:205], v8, s[44:47], s6 offen offset:3072 sc1
    ds_read_b64_tr_b16 a[158:159], v11 offset:22528
    v_mfma_f32_16x16x32_bf16 v[44:47], v[132:135], v[168:171], v[44:47]
    ds_read2_b32 v[92:93], v239 offset0:128 offset1:129
    v_mfma_f32_16x16x32_bf16 v[44:47], v[136:139], v[164:167], v[44:47]
    s_add_u32 m0, s73, 16384
    ds_read2_b32 v[94:95], v239 offset0:130 offset1:131
    v_mfma_f32_16x16x32_bf16 v[44:47], v[140:143], v[160:163], v[44:47]
    buffer_load_dwordx4 v7, s[52:55], s14 offen offset:3072 lds
    v_cvt_pk_bf16_f32 v202, v52, v53
    v_mfma_f32_16x16x32_bf16 v[40:43], v[128:131], v[168:171], v[40:43]
    v_mfma_f32_16x16x32_bf16 v[40:43], v[132:135], v[164:167], v[40:43]
    v_mfma_f32_16x16x32_bf16 v[40:43], v[136:139], v[160:163], v[40:43]
    v_cvt_pk_bf16_f32 v203, v54, v55
    v_mfma_f32_16x16x32_bf16 v[36:39], v[128:131], v[164:167], v[36:39]
    v_mfma_f32_16x16x32_bf16 v[36:39], v[132:135], v[160:163], v[36:39]
    buffer_store_dwordx2 v[202:203], v8, s[44:47], s6 offen offset:2560 sc1
    v_mfma_f32_16x16x32_bf16 v[32:35], v[128:131], v[160:163], v[32:35]
    s_waitcnt lgkmcnt(0)
    v_mfma_f32_16x16x32_bf16 v[60:63], v[64:67], v[124:127], 0
    ds_read_b128 v[160:163], v245 offset:2048
    v_mfma_f32_16x16x32_bf16 v[60:63], v[68:71], v[120:123], v[60:63]
    v_cvt_pk_bf16_f32 v200, v48, v49
    v_mfma_f32_16x16x32_bf16 v[60:63], v[72:75], v[116:119], v[60:63]
    ds_read2_b32 v[128:129], v236 offset0:16 offset1:17
    v_mfma_f32_16x16x32_bf16 v[60:63], v[76:79], v[112:115], v[60:63]
    s_barrier
    v_cvt_pk_bf16_f32 v201, v50, v51
    v_mfma_f32_16x16x32_bf16 v[60:63], v[80:83], v[108:111], v[60:63]
    ds_read2_b32 v[130:131], v236 offset0:18 offset1:19
    v_mfma_f32_16x16x32_bf16 v[60:63], v[84:87], v[104:107], v[60:63]
    buffer_store_dwordx2 v[200:201], v8, s[44:47], s6 offen offset:2048 sc1
    ds_read_b128 v[164:167], v245 offset:6144
    v_mfma_f32_16x16x32_bf16 v[60:63], v[88:91], v[100:103], v[60:63]
    ds_read2_b32 v[132:133], v236 offset0:144 offset1:145
    v_mfma_f32_16x16x32_bf16 v[60:63], v[92:95], v[96:99], v[60:63]
    ds_read2_b32 v[134:135], v236 offset0:146 offset1:147
    s_lshl_b32 s14, s96, 18
    v_cvt_pk_bf16_f32 v198, v44, v45
    v_mfma_f32_16x16x32_bf16 v[56:59], v[64:67], v[120:123], 0
    s_add_u32 m0, s73, 147456
    ds_read_b128 v[168:171], v245 offset:10240
    v_mfma_f32_16x16x32_bf16 v[56:59], v[68:71], v[116:119], v[56:59]
    buffer_load_dwordx4 v4, s[52:55], s14 offen offset:0 lds
    ds_read2_b32 v[136:137], v237 offset0:16 offset1:17
    v_mfma_f32_16x16x32_bf16 v[56:59], v[72:75], v[112:115], v[56:59]
    ds_read2_b32 v[138:139], v237 offset0:18 offset1:19
    v_cvt_pk_bf16_f32 v199, v46, v47
    v_mfma_f32_16x16x32_bf16 v[56:59], v[76:79], v[108:111], v[56:59]
    ds_read_b128 v[172:175], v245 offset:14336
    v_mfma_f32_16x16x32_bf16 v[56:59], v[80:83], v[104:107], v[56:59]
    buffer_store_dwordx2 v[198:199], v8, s[44:47], s6 offen offset:1536 sc1
    ds_read2_b32 v[140:141], v237 offset0:144 offset1:145
    v_mfma_f32_16x16x32_bf16 v[56:59], v[84:87], v[100:103], v[56:59]
    ds_read2_b32 v[142:143], v237 offset0:146 offset1:147
    v_mfma_f32_16x16x32_bf16 v[56:59], v[88:91], v[96:99], v[56:59]
    ds_read_b128 v[176:179], v245 offset:18432
    v_cvt_pk_bf16_f32 v196, v40, v41
    v_mfma_f32_16x16x32_bf16 v[52:55], v[64:67], v[116:119], 0
    ds_read2_b32 v[144:145], v238 offset0:16 offset1:17
    v_mfma_f32_16x16x32_bf16 v[52:55], v[68:71], v[112:115], v[52:55]
    ds_read2_b32 v[146:147], v238 offset0:18 offset1:19
    v_cvt_pk_bf16_f32 v197, v42, v43
    v_mfma_f32_16x16x32_bf16 v[52:55], v[72:75], v[108:111], v[52:55]
    ds_read_b128 v[180:183], v245 offset:22528
    v_mfma_f32_16x16x32_bf16 v[52:55], v[76:79], v[104:107], v[52:55]
    buffer_store_dwordx2 v[196:197], v8, s[44:47], s6 offen offset:1024 sc1
    ds_read2_b32 v[148:149], v238 offset0:144 offset1:145
    v_mfma_f32_16x16x32_bf16 v[52:55], v[80:83], v[100:103], v[52:55]
    s_add_u32 m0, s73, 147456
    ds_read2_b32 v[150:151], v238 offset0:146 offset1:147
    v_mfma_f32_16x16x32_bf16 v[52:55], v[84:87], v[96:99], v[52:55]
    buffer_load_dwordx4 v5, s[52:55], s14 offen offset:1024 lds
    ds_read_b128 v[184:187], v245 offset:26624
    v_mfma_f32_16x16x32_bf16 v[48:51], v[64:67], v[112:115], 0
    ds_read2_b32 v[152:153], v239 offset0:16 offset1:17
    v_cvt_pk_bf16_f32 v194, v36, v37
    v_mfma_f32_16x16x32_bf16 v[48:51], v[68:71], v[108:111], v[48:51]
    ds_read2_b32 v[154:155], v239 offset0:18 offset1:19
    v_mfma_f32_16x16x32_bf16 v[48:51], v[72:75], v[104:107], v[48:51]
    ds_read_b128 v[188:191], v245 offset:30720
    v_cvt_pk_bf16_f32 v195, v38, v39
    v_mfma_f32_16x16x32_bf16 v[48:51], v[76:79], v[100:103], v[48:51]
    ds_read2_b32 v[156:157], v239 offset0:144 offset1:145
    v_mfma_f32_16x16x32_bf16 v[48:51], v[80:83], v[96:99], v[48:51]
    buffer_store_dwordx2 v[194:195], v8, s[44:47], s6 offen offset:512 sc1
    s_waitcnt vmcnt(13)
    s_barrier
    v_mfma_f32_16x16x32_bf16 v[44:47], v[64:67], v[108:111], 0
    v_add_u32 v10, -131072, v10
    v_cvt_pk_bf16_f32 v192, v32, v33
    v_mfma_f32_16x16x32_bf16 v[44:47], v[68:71], v[104:107], v[44:47]
    ds_read_b64_tr_b16 a[160:161], v10 offset:0
    v_mfma_f32_16x16x32_bf16 v[44:47], v[72:75], v[100:103], v[44:47]
    ds_read_b64_tr_b16 a[162:163], v10 offset:2048
    v_mfma_f32_16x16x32_bf16 v[44:47], v[76:79], v[96:99], v[44:47]
    ds_read_b64_tr_b16 a[168:169], v10 offset:4096
    v_cvt_pk_bf16_f32 v193, v34, v35
    v_mfma_f32_16x16x32_bf16 v[40:43], v[64:67], v[104:107], 0
    ds_read2_b32 v[158:159], v239 offset0:146 offset1:147
    v_mfma_f32_16x16x32_bf16 v[40:43], v[68:71], v[100:103], v[40:43]
    buffer_store_dwordx2 v[192:193], v8, s[44:47], s6 offen offset:0 sc1
    ds_read_b64_tr_b16 a[170:171], v10 offset:6144
    s_add_u32 m0, s73, 147456
    v_mfma_f32_16x16x32_bf16 v[40:43], v[72:75], v[96:99], v[40:43]
    v_add_u32 v11, -131072, v11
L_pl_X_5:
    s_cbranch_execz L_wret
    buffer_load_dwordx4 v6, s[52:55], s14 offen offset:2048 lds
    v_mfma_f32_16x16x32_bf16 v[36:39], v[64:67], v[100:103], 0
    ds_read_b64_tr_b16 a[164:165], v11 offset:0
    v_mfma_f32_16x16x32_bf16 v[36:39], v[68:71], v[96:99], v[36:39]
    ds_read_b64_tr_b16 a[166:167], v11 offset:2048
    v_mfma_f32_16x16x32_bf16 v[32:35], v[64:67], v[96:99], 0
    ds_read_b64_tr_b16 a[172:173], v11 offset:4096
    s_waitcnt lgkmcnt(15)
    v_mfma_f32_16x16x32_bf16 v[32:35], v[128:131], v[160:163], v[32:35]
    ds_read_b64_tr_b16 a[174:175], v11 offset:6144
    v_mfma_f32_16x16x32_bf16 v[36:39], v[132:135], v[160:163], v[36:39]
    ds_read_b128 v[96:99], v246 offset:2048
    v_mfma_f32_16x16x32_bf16 v[36:39], v[128:131], v[164:167], v[36:39]
    ds_read2_b32 v[64:65], v236 offset0:32 offset1:33
    v_mfma_f32_16x16x32_bf16 v[40:43], v[128:131], v[168:171], v[40:43]
    ds_read2_b32 v[66:67], v236 offset0:34 offset1:35
    v_mfma_f32_16x16x32_bf16 v[40:43], v[132:135], v[164:167], v[40:43]
    v_mfma_f32_16x16x32_bf16 v[40:43], v[136:139], v[160:163], v[40:43]
    ds_read_b128 v[100:103], v246 offset:6144
    v_mfma_f32_16x16x32_bf16 v[44:47], v[140:143], v[160:163], v[44:47]
    ds_read2_b32 v[68:69], v236 offset0:160 offset1:161
    v_mfma_f32_16x16x32_bf16 v[44:47], v[136:139], v[164:167], v[44:47]
    s_add_u32 m0, s73, 147456
    v_mfma_f32_16x16x32_bf16 v[44:47], v[132:135], v[168:171], v[44:47]
    buffer_load_dwordx4 v7, s[52:55], s14 offen offset:3072 lds
    ds_read2_b32 v[70:71], v236 offset0:162 offset1:163
    v_mfma_f32_16x16x32_bf16 v[44:47], v[128:131], v[172:175], v[44:47]
    ds_read_b128 v[104:107], v246 offset:10240
    s_waitcnt lgkmcnt(12)
    v_mfma_f32_16x16x32_bf16 v[48:51], v[128:131], v[176:179], v[48:51]
    ds_read2_b32 v[72:73], v237 offset0:32 offset1:33
    v_mfma_f32_16x16x32_bf16 v[48:51], v[132:135], v[172:175], v[48:51]
    v_mfma_f32_16x16x32_bf16 v[48:51], v[136:139], v[168:171], v[48:51]
    ds_read2_b32 v[74:75], v237 offset0:34 offset1:35
    v_mfma_f32_16x16x32_bf16 v[48:51], v[140:143], v[164:167], v[48:51]
    ds_read_b128 v[108:111], v246 offset:14336
    v_mfma_f32_16x16x32_bf16 v[48:51], v[144:147], v[160:163], v[48:51]
    s_waitcnt lgkmcnt(10)
    s_barrier
    v_mfma_f32_16x16x32_bf16 v[52:55], v[148:151], v[160:163], v[52:55]
    ds_read2_b32 v[76:77], v237 offset0:160 offset1:161
    v_mfma_f32_16x16x32_bf16 v[52:55], v[144:147], v[164:167], v[52:55]
    ds_read2_b32 v[78:79], v237 offset0:162 offset1:163
    v_mfma_f32_16x16x32_bf16 v[52:55], v[140:143], v[168:171], v[52:55]
    v_mfma_f32_16x16x32_bf16 v[52:55], v[136:139], v[172:175], v[52:55]
    s_lshl_b32 s14, s97, 18
    ds_read_b128 v[112:115], v246 offset:18432
    v_mfma_f32_16x16x32_bf16 v[52:55], v[132:135], v[176:179], v[52:55]
    s_add_u32 m0, s73, 0
    ds_read2_b32 v[80:81], v238 offset0:32 offset1:33
    v_mfma_f32_16x16x32_bf16 v[52:55], v[128:131], v[180:183], v[52:55]
    buffer_load_dwordx4 v4, s[52:55], s14 offen offset:0 lds
    v_mfma_f32_16x16x32_bf16 v[56:59], v[128:131], v[184:187], v[56:59]
    ds_read2_b32 v[82:83], v238 offset0:34 offset1:35
    v_mfma_f32_16x16x32_bf16 v[56:59], v[132:135], v[180:183], v[56:59]
    ds_read_b128 v[116:119], v246 offset:22528
    v_mfma_f32_16x16x32_bf16 v[56:59], v[136:139], v[176:179], v[56:59]
    v_mfma_f32_16x16x32_bf16 v[56:59], v[140:143], v[172:175], v[56:59]
    ds_read2_b32 v[84:85], v238 offset0:160 offset1:161
    v_mfma_f32_16x16x32_bf16 v[56:59], v[144:147], v[168:171], v[56:59]
    ds_read2_b32 v[86:87], v238 offset0:162 offset1:163
    v_mfma_f32_16x16x32_bf16 v[56:59], v[148:151], v[164:167], v[56:59]
    ds_read_b128 v[120:123], v246 offset:26624
    v_mfma_f32_16x16x32_bf16 v[56:59], v[152:155], v[160:163], v[56:59]
    v_mfma_f32_16x16x32_bf16 v[60:63], v[156:159], v[160:163], v[60:63]
    ds_read2_b32 v[88:89], v239 offset0:32 offset1:33
    v_mfma_f32_16x16x32_bf16 v[60:63], v[152:155], v[164:167], v[60:63]
    ds_read2_b32 v[90:91], v239 offset0:34 offset1:35
    v_mfma_f32_16x16x32_bf16 v[60:63], v[148:151], v[168:171], v[60:63]
    s_add_u32 m0, s73, 0
    v_mfma_f32_16x16x32_bf16 v[60:63], v[144:147], v[172:175], v[60:63]
    buffer_load_dwordx4 v5, s[52:55], s14 offen offset:1024 lds
    ds_read_b128 v[124:127], v246 offset:30720
    v_mfma_f32_16x16x32_bf16 v[60:63], v[140:143], v[176:179], v[60:63]
    ds_read2_b32 v[92:93], v239 offset0:160 offset1:161
    v_mfma_f32_16x16x32_bf16 v[60:63], v[136:139], v[180:183], v[60:63]
    v_mfma_f32_16x16x32_bf16 v[60:63], v[132:135], v[184:187], v[60:63]
    ds_read2_b32 v[94:95], v239 offset0:162 offset1:163
    v_mfma_f32_16x16x32_bf16 v[60:63], v[128:131], v[188:191], v[60:63]
    s_waitcnt lgkmcnt(12)
    v_mfma_f32_16x16x32_bf16 v[32:35], v[64:67], v[96:99], v[32:35]
    ds_read_b128 v[160:163], v247 offset:2048
    s_waitcnt vmcnt(12)
    s_barrier
    v_mfma_f32_16x16x32_bf16 v[36:39], v[68:71], v[96:99], v[36:39]
    ds_read_b64_tr_b16 a[176:177], v10 offset:16384
    v_mfma_f32_16x16x32_bf16 v[36:39], v[64:67], v[100:103], v[36:39]
    ds_read_b64_tr_b16 a[178:179], v10 offset:18432
    v_mfma_f32_16x16x32_bf16 v[40:43], v[64:67], v[104:107], v[40:43]
    ds_read2_b32 v[128:129], v236 offset0:48 offset1:49
    v_mfma_f32_16x16x32_bf16 v[40:43], v[68:71], v[100:103], v[40:43]
    ds_read_b64_tr_b16 a[184:185], v10 offset:20480
    v_mfma_f32_16x16x32_bf16 v[40:43], v[72:75], v[96:99], v[40:43]
    ds_read_b64_tr_b16 a[186:187], v10 offset:22528
    v_mfma_f32_16x16x32_bf16 v[44:47], v[76:79], v[96:99], v[44:47]
    s_add_u32 m0, s73, 0
    ds_read2_b32 v[130:131], v236 offset0:50 offset1:51
    v_mfma_f32_16x16x32_bf16 v[44:47], v[72:75], v[100:103], v[44:47]
    ds_read_b64_tr_b16 a[180:181], v11 offset:16384
    buffer_load_dwordx4 v6, s[52:55], s14 offen offset:2048 lds
    v_mfma_f32_16x16x32_bf16 v[44:47], v[68:71], v[104:107], v[44:47]
    ds_read_b64_tr_b16 a[182:183], v11 offset:18432
    v_mfma_f32_16x16x32_bf16 v[44:47], v[64:67], v[108:111], v[44:47]
    ds_read_b128 v[164:167], v247 offset:6144
    s_waitcnt lgkmcnt(10)
    v_mfma_f32_16x16x32_bf16 v[48:51], v[64:67], v[112:115], v[48:51]
    ds_read_b64_tr_b16 a[188:189], v11 offset:20480
    v_mfma_f32_16x16x32_bf16 v[48:51], v[68:71], v[108:111], v[48:51]
    ds_read_b64_tr_b16 a[190:191], v11 offset:22528
    v_mfma_f32_16x16x32_bf16 v[48:51], v[72:75], v[104:107], v[48:51]
    ds_read2_b32 v[132:133], v236 offset0:176 offset1:177
    v_mfma_f32_16x16x32_bf16 v[48:51], v[76:79], v[100:103], v[48:51]
    ds_read2_b32 v[134:135], v236 offset0:178 offset1:179
    v_mfma_f32_16x16x32_bf16 v[48:51], v[80:83], v[96:99], v[48:51]
    ds_read_b128 v[168:171], v247 offset:10240
    v_mfma_f32_16x16x32_bf16 v[52:55], v[84:87], v[96:99], v[52:55]
    ds_read2_b32 v[136:137], v237 offset0:48 offset1:49
    v_mfma_f32_16x16x32_bf16 v[52:55], v[80:83], v[100:103], v[52:55]
    ds_read2_b32 v[138:139], v237 offset0:50 offset1:51
    v_mfma_f32_16x16x32_bf16 v[52:55], v[76:79], v[104:107], v[52:55]
    ds_read_b128 v[172:175], v247 offset:14336
    v_mfma_f32_16x16x32_bf16 v[52:55], v[72:75], v[108:111], v[52:55]
    s_add_u32 m0, s73, 0
    ds_read2_b32 v[140:141], v237 offset0:176 offset1:177
    v_mfma_f32_16x16x32_bf16 v[52:55], v[68:71], v[112:115], v[52:55]
    buffer_load_dwordx4 v7, s[52:55], s14 offen offset:3072 lds
    ds_read2_b32 v[142:143], v237 offset0:178 offset1:179
    v_mfma_f32_16x16x32_bf16 v[52:55], v[64:67], v[116:119], v[52:55]
    ds_read_b128 v[176:179], v247 offset:18432
    v_mfma_f32_16x16x32_bf16 v[56:59], v[64:67], v[120:123], v[56:59]
    ds_read2_b32 v[144:145], v238 offset0:48 offset1:49
    v_mfma_f32_16x16x32_bf16 v[56:59], v[68:71], v[116:119], v[56:59]
    ds_read2_b32 v[146:147], v238 offset0:50 offset1:51
    v_mfma_f32_16x16x32_bf16 v[56:59], v[72:75], v[112:115], v[56:59]
    ds_read_b128 v[180:183], v247 offset:22528
    v_mfma_f32_16x16x32_bf16 v[56:59], v[76:79], v[108:111], v[56:59]
    ds_read2_b32 v[148:149], v238 offset0:176 offset1:177
    v_mfma_f32_16x16x32_bf16 v[56:59], v[80:83], v[104:107], v[56:59]
    ds_read2_b32 v[150:151], v238 offset0:178 offset1:179
    s_waitcnt lgkmcnt(14)
    s_barrier
    v_mfma_f32_16x16x32_bf16 v[56:59], v[84:87], v[100:103], v[56:59]
    ds_read_b128 v[184:187], v247 offset:26624
    v_mfma_f32_16x16x32_bf16 v[56:59], v[88:91], v[96:99], v[56:59]
    v_mfma_f32_16x16x32_bf16 v[60:63], v[92:95], v[96:99], v[60:63]
    s_lshl_b32 s14, s98, 18
    ds_read2_b32 v[152:153], v239 offset0:48 offset1:49
    v_mfma_f32_16x16x32_bf16 v[60:63], v[88:91], v[100:103], v[60:63]
    s_add_u32 m0, s73, 16384
    ds_read2_b32 v[154:155], v239 offset0:50 offset1:51
    v_mfma_f32_16x16x32_bf16 v[60:63], v[84:87], v[104:107], v[60:63]
    buffer_load_dwordx4 v4, s[52:55], s14 offen offset:0 lds
    v_mfma_f32_16x16x32_bf16 v[60:63], v[80:83], v[108:111], v[60:63]
    ds_read_b128 v[188:191], v247 offset:30720
    v_mfma_f32_16x16x32_bf16 v[60:63], v[76:79], v[112:115], v[60:63]
    ds_read2_b32 v[156:157], v239 offset0:176 offset1:177
    v_mfma_f32_16x16x32_bf16 v[60:63], v[72:75], v[116:119], v[60:63]
    v_mfma_f32_16x16x32_bf16 v[60:63], v[68:71], v[120:123], v[60:63]
    ds_read2_b32 v[158:159], v239 offset0:178 offset1:179
    v_mfma_f32_16x16x32_bf16 v[60:63], v[64:67], v[124:127], v[60:63]
    s_waitcnt lgkmcnt(12)
    v_mfma_f32_16x16x32_bf16 v[32:35], v[128:131], v[160:163], v[32:35]
    ds_read_b128 v[96:99], v244 offset:0
    v_mfma_f32_16x16x32_bf16 v[36:39], v[132:135], v[160:163], v[36:39]
    v_mfma_f32_16x16x32_bf16 v[36:39], v[128:131], v[164:167], v[36:39]
    ds_read2_b32 v[64:65], v236 offset0:64 offset1:65
    v_mfma_f32_16x16x32_bf16 v[40:43], v[128:131], v[168:171], v[40:43]
    ds_read2_b32 v[66:67], v236 offset0:66 offset1:67
    v_mfma_f32_16x16x32_bf16 v[40:43], v[132:135], v[164:167], v[40:43]
    v_mfma_f32_16x16x32_bf16 v[40:43], v[136:139], v[160:163], v[40:43]
    s_add_u32 m0, s73, 16384
    ds_read_b128 v[100:103], v244 offset:4096
    v_mfma_f32_16x16x32_bf16 v[44:47], v[140:143], v[160:163], v[44:47]
    buffer_load_dwordx4 v5, s[52:55], s14 offen offset:1024 lds
    ds_read2_b32 v[68:69], v236 offset0:192 offset1:193
    v_mfma_f32_16x16x32_bf16 v[44:47], v[136:139], v[164:167], v[44:47]
    v_mfma_f32_16x16x32_bf16 v[44:47], v[132:135], v[168:171], v[44:47]
    ds_read2_b32 v[70:71], v236 offset0:194 offset1:195
    v_mfma_f32_16x16x32_bf16 v[44:47], v[128:131], v[172:175], v[44:47]
    ds_read_b128 v[104:107], v244 offset:8192
    s_waitcnt lgkmcnt(7)
    v_mfma_f32_16x16x32_bf16 v[48:51], v[128:131], v[176:179], v[48:51]
    ds_read2_b32 v[72:73], v237 offset0:64 offset1:65
    v_mfma_f32_16x16x32_bf16 v[48:51], v[132:135], v[172:175], v[48:51]
    ds_read2_b32 v[74:75], v237 offset0:66 offset1:67
    v_mfma_f32_16x16x32_bf16 v[48:51], v[136:139], v[168:171], v[48:51]
    ds_read_b128 v[108:111], v244 offset:12288
    v_mfma_f32_16x16x32_bf16 v[48:51], v[140:143], v[164:167], v[48:51]
    ds_read2_b32 v[76:77], v237 offset0:192 offset1:193
    v_mfma_f32_16x16x32_bf16 v[48:51], v[144:147], v[160:163], v[48:51]
    ds_read2_b32 v[78:79], v237 offset0:194 offset1:195
    s_waitcnt vmcnt(6)
    s_barrier
    v_mfma_f32_16x16x32_bf16 v[52:55], v[148:151], v[160:163], v[52:55]
    ds_read_b128 v[112:115], v244 offset:16384
    v_add_u32 v10, 131072, v10
    v_mfma_f32_16x16x32_bf16 v[52:55], v[144:147], v[164:167], v[52:55]
    ds_read_b64_tr_b16 a[192:193], v10 offset:16384
    v_mfma_f32_16x16x32_bf16 v[52:55], v[140:143], v[168:171], v[52:55]
    ds_read_b64_tr_b16 a[194:195], v10 offset:18432
    s_add_u32 m0, s73, 16384
    v_mfma_f32_16x16x32_bf16 v[52:55], v[136:139], v[172:175], v[52:55]
    buffer_load_dwordx4 v6, s[52:55], s14 offen offset:2048 lds
    ds_read2_b32 v[80:81], v238 offset0:64 offset1:65
    v_mfma_f32_16x16x32_bf16 v[52:55], v[132:135], v[176:179], v[52:55]
    ds_read_b64_tr_b16 a[200:201], v10 offset:20480
    v_mfma_f32_16x16x32_bf16 v[52:55], v[128:131], v[180:183], v[52:55]
    ds_read_b64_tr_b16 a[202:203], v10 offset:22528
    v_mfma_f32_16x16x32_bf16 v[56:59], v[128:131], v[184:187], v[56:59]
    ds_read2_b32 v[82:83], v238 offset0:66 offset1:67
    v_add_u32 v11, 131072, v11
    v_mfma_f32_16x16x32_bf16 v[56:59], v[132:135], v[180:183], v[56:59]
    ds_read_b64_tr_b16 a[196:197], v11 offset:16384
    v_mfma_f32_16x16x32_bf16 v[56:59], v[136:139], v[176:179], v[56:59]
    ds_read_b64_tr_b16 a[198:199], v11 offset:18432
    v_mfma_f32_16x16x32_bf16 v[56:59], v[140:143], v[172:175], v[56:59]
    ds_read_b128 v[116:119], v244 offset:20480
    v_mfma_f32_16x16x32_bf16 v[56:59], v[144:147], v[168:171], v[56:59]
    ds_read_b64_tr_b16 a[204:205], v11 offset:20480
    v_mfma_f32_16x16x32_bf16 v[56:59], v[148:151], v[164:167], v[56:59]
    ds_read_b64_tr_b16 a[206:207], v11 offset:22528
    v_mfma_f32_16x16x32_bf16 v[56:59], v[152:155], v[160:163], v[56:59]
    ds_read2_b32 v[84:85], v238 offset0:192 offset1:193
    v_mfma_f32_16x16x32_bf16 v[60:63], v[156:159], v[160:163], v[60:63]
    s_add_u32 m0, s73, 16384
    ds_read2_b32 v[86:87], v238 offset0:194 offset1:195
    v_mfma_f32_16x16x32_bf16 v[60:63], v[152:155], v[164:167], v[60:63]
    buffer_load_dwordx4 v7, s[52:55], s14 offen offset:3072 lds
    ds_read_b128 v[120:123], v244 offset:24576
    v_mfma_f32_16x16x32_bf16 v[60:63], v[148:151], v[168:171], v[60:63]
    ds_read2_b32 v[88:89], v239 offset0:64 offset1:65
    v_mfma_f32_16x16x32_bf16 v[60:63], v[144:147], v[172:175], v[60:63]
    ds_read2_b32 v[90:91], v239 offset0:66 offset1:67
    v_mfma_f32_16x16x32_bf16 v[60:63], v[140:143], v[176:179], v[60:63]
    ds_read_b128 v[124:127], v244 offset:28672
    v_mfma_f32_16x16x32_bf16 v[60:63], v[136:139], v[180:183], v[60:63]
    ds_read2_b32 v[92:93], v239 offset0:192 offset1:193
    v_mfma_f32_16x16x32_bf16 v[60:63], v[132:135], v[184:187], v[60:63]
    ds_read2_b32 v[94:95], v239 offset0:194 offset1:195
    v_mfma_f32_16x16x32_bf16 v[60:63], v[128:131], v[188:191], v[60:63]
    s_waitcnt lgkmcnt(15)
    v_mfma_f32_16x16x32_bf16 v[32:35], v[64:67], v[96:99], v[32:35]
    ds_read_b128 v[160:163], v245 offset:0
    v_mfma_f32_16x16x32_bf16 v[36:39], v[68:71], v[96:99], v[36:39]
    v_mfma_f32_16x16x32_bf16 v[36:39], v[64:67], v[100:103], v[36:39]
    ds_read2_b32 v[128:129], v236 offset0:80 offset1:81
    v_mfma_f32_16x16x32_bf16 v[40:43], v[64:67], v[104:107], v[40:43]
    ds_read2_b32 v[130:131], v236 offset0:82 offset1:83
    s_waitcnt lgkmcnt(11)
    s_barrier
    v_mfma_f32_16x16x32_bf16 v[40:43], v[68:71], v[100:103], v[40:43]
    v_mfma_f32_16x16x32_bf16 v[40:43], v[72:75], v[96:99], v[40:43]
    ds_read_b128 v[164:167], v245 offset:4096
    v_mfma_f32_16x16x32_bf16 v[44:47], v[76:79], v[96:99], v[44:47]
    ds_read2_b32 v[132:133], v236 offset0:208 offset1:209
    v_mfma_f32_16x16x32_bf16 v[44:47], v[72:75], v[100:103], v[44:47]
    s_lshl_b32 s14, s99, 18
    v_mfma_f32_16x16x32_bf16 v[44:47], v[68:71], v[104:107], v[44:47]
    s_add_u32 m0, s73, 147456
    ds_read2_b32 v[134:135], v236 offset0:210 offset1:211
    v_mfma_f32_16x16x32_bf16 v[44:47], v[64:67], v[108:111], v[44:47]
    buffer_load_dwordx4 v4, s[52:55], s14 offen offset:0 lds
    ds_read_b128 v[168:171], v245 offset:8192
    s_waitcnt lgkmcnt(7)
    v_mfma_f32_16x16x32_bf16 v[48:51], v[64:67], v[112:115], v[48:51]
    ds_read2_b32 v[136:137], v237 offset0:80 offset1:81
    v_mfma_f32_16x16x32_bf16 v[48:51], v[68:71], v[108:111], v[48:51]
    v_mfma_f32_16x16x32_bf16 v[48:51], v[72:75], v[104:107], v[48:51]
    ds_read2_b32 v[138:139], v237 offset0:82 offset1:83
    v_mfma_f32_16x16x32_bf16 v[48:51], v[76:79], v[100:103], v[48:51]
    ds_read_b128 v[172:175], v245 offset:12288
    v_mfma_f32_16x16x32_bf16 v[48:51], v[80:83], v[96:99], v[48:51]
    ds_read2_b32 v[140:141], v237 offset0:208 offset1:209
    v_mfma_f32_16x16x32_bf16 v[52:55], v[84:87], v[96:99], v[52:55]
    ds_read2_b32 v[142:143], v237 offset0:210 offset1:211
    v_mfma_f32_16x16x32_bf16 v[52:55], v[80:83], v[100:103], v[52:55]
    ds_read_b128 v[176:179], v245 offset:16384
    v_mfma_f32_16x16x32_bf16 v[52:55], v[76:79], v[104:107], v[52:55]
    ds_read2_b32 v[144:145], v238 offset0:80 offset1:81
    v_mfma_f32_16x16x32_bf16 v[52:55], v[72:75], v[108:111], v[52:55]
    ds_read2_b32 v[146:147], v238 offset0:82 offset1:83
    v_mfma_f32_16x16x32_bf16 v[52:55], v[68:71], v[112:115], v[52:55]
    s_add_u32 m0, s73, 147456
    ds_read_b128 v[180:183], v245 offset:20480
    v_mfma_f32_16x16x32_bf16 v[52:55], v[64:67], v[116:119], v[52:55]
    buffer_load_dwordx4 v5, s[52:55], s14 offen offset:1024 lds
    ds_read2_b32 v[148:149], v238 offset0:208 offset1:209
    v_mfma_f32_16x16x32_bf16 v[56:59], v[64:67], v[120:123], v[56:59]
    ds_read2_b32 v[150:151], v238 offset0:210 offset1:211
    v_mfma_f32_16x16x32_bf16 v[56:59], v[68:71], v[116:119], v[56:59]
    ds_read_b128 v[184:187], v245 offset:24576
    v_mfma_f32_16x16x32_bf16 v[56:59], v[72:75], v[112:115], v[56:59]
    ds_read2_b32 v[152:153], v239 offset0:80 offset1:81
    v_mfma_f32_16x16x32_bf16 v[56:59], v[76:79], v[108:111], v[56:59]
    ds_read2_b32 v[154:155], v239 offset0:82 offset1:83
    v_mfma_f32_16x16x32_bf16 v[56:59], v[80:83], v[104:107], v[56:59]
    ds_read_b128 v[188:191], v245 offset:28672
    s_waitcnt vmcnt(6)
    s_barrier
    v_mfma_f32_16x16x32_bf16 v[56:59], v[84:87], v[100:103], v[56:59]
    ds_read2_b32 v[156:157], v239 offset0:208 offset1:209
    v_add_u32 v10, -131072, v10
    v_mfma_f32_16x16x32_bf16 v[56:59], v[88:91], v[96:99], v[56:59]
    ds_read_b64_tr_b16 a[208:209], v10 offset:0
    v_mfma_f32_16x16x32_bf16 v[60:63], v[92:95], v[96:99], v[60:63]
    ds_read_b64_tr_b16 a[210:211], v10 offset:2048
    v_mfma_f32_16x16x32_bf16 v[60:63], v[88:91], v[100:103], v[60:63]
    ds_read_b64_tr_b16 a[216:217], v10 offset:4096
    v_mfma_f32_16x16x32_bf16 v[60:63], v[84:87], v[104:107], v[60:63]
    ds_read2_b32 v[158:159], v239 offset0:210 offset1:211
    v_mfma_f32_16x16x32_bf16 v[60:63], v[80:83], v[108:111], v[60:63]
    ds_read_b64_tr_b16 a[218:219], v10 offset:6144
    s_add_u32 m0, s73, 147456
    v_mfma_f32_16x16x32_bf16 v[60:63], v[76:79], v[112:115], v[60:63]
    v_add_u32 v11, -131072, v11
    buffer_load_dwordx4 v6, s[52:55], s14 offen offset:2048 lds
    v_mfma_f32_16x16x32_bf16 v[60:63], v[72:75], v[116:119], v[60:63]
    ds_read_b64_tr_b16 a[212:213], v11 offset:0
    v_mfma_f32_16x16x32_bf16 v[60:63], v[68:71], v[120:123], v[60:63]
    ds_read_b64_tr_b16 a[214:215], v11 offset:2048
    v_mfma_f32_16x16x32_bf16 v[60:63], v[64:67], v[124:127], v[60:63]
    ds_read_b64_tr_b16 a[220:221], v11 offset:4096
    s_waitcnt lgkmcnt(15)
    v_mfma_f32_16x16x32_bf16 v[32:35], v[128:131], v[160:163], v[32:35]
    ds_read_b64_tr_b16 a[222:223], v11 offset:6144
    v_mfma_f32_16x16x32_bf16 v[36:39], v[132:135], v[160:163], v[36:39]
    ds_read_b128 v[96:99], v246 offset:0
    v_mfma_f32_16x16x32_bf16 v[36:39], v[128:131], v[164:167], v[36:39]
    ds_read2_b32 v[64:65], v236 offset0:96 offset1:97
    v_mfma_f32_16x16x32_bf16 v[40:43], v[128:131], v[168:171], v[40:43]
    ds_read2_b32 v[66:67], v236 offset0:98 offset1:99
    v_mfma_f32_16x16x32_bf16 v[40:43], v[132:135], v[164:167], v[40:43]
    v_mfma_f32_16x16x32_bf16 v[40:43], v[136:139], v[160:163], v[40:43]
    ds_read_b128 v[100:103], v246 offset:4096
    v_mfma_f32_16x16x32_bf16 v[44:47], v[140:143], v[160:163], v[44:47]
    ds_read2_b32 v[68:69], v236 offset0:224 offset1:225
    v_mfma_f32_16x16x32_bf16 v[44:47], v[136:139], v[164:167], v[44:47]
    s_add_u32 m0, s73, 147456
    v_mfma_f32_16x16x32_bf16 v[44:47], v[132:135], v[168:171], v[44:47]
    buffer_load_dwordx4 v7, s[52:55], s14 offen offset:3072 lds
    ds_read2_b32 v[70:71], v236 offset0:226 offset1:227
    v_mfma_f32_16x16x32_bf16 v[44:47], v[128:131], v[172:175], v[44:47]
    ds_read_b128 v[104:107], v246 offset:8192
    s_waitcnt lgkmcnt(12)
    v_mfma_f32_16x16x32_bf16 v[48:51], v[128:131], v[176:179], v[48:51]
    ds_read2_b32 v[72:73], v237 offset0:96 offset1:97
    v_mfma_f32_16x16x32_bf16 v[48:51], v[132:135], v[172:175], v[48:51]
    v_mfma_f32_16x16x32_bf16 v[48:51], v[136:139], v[168:171], v[48:51]
    ds_read2_b32 v[74:75], v237 offset0:98 offset1:99
    v_mfma_f32_16x16x32_bf16 v[48:51], v[140:143], v[164:167], v[48:51]
    ds_read_b128 v[108:111], v246 offset:12288
    v_mfma_f32_16x16x32_bf16 v[48:51], v[144:147], v[160:163], v[48:51]
    s_waitcnt lgkmcnt(10)
    s_barrier
    v_mfma_f32_16x16x32_bf16 v[52:55], v[148:151], v[160:163], v[52:55]
    ds_read2_b32 v[76:77], v237 offset0:224 offset1:225
    v_mfma_f32_16x16x32_bf16 v[52:55], v[144:147], v[164:167], v[52:55]
    ds_read2_b32 v[78:79], v237 offset0:226 offset1:227
    v_mfma_f32_16x16x32_bf16 v[52:55], v[140:143], v[168:171], v[52:55]
    v_mfma_f32_16x16x32_bf16 v[52:55], v[136:139], v[172:175], v[52:55]
    s_lshl_b32 s14, s100, 18
    ds_read_b128 v[112:115], v246 offset:16384
    v_mfma_f32_16x16x32_bf16 v[52:55], v[132:135], v[176:179], v[52:55]
    s_add_u32 m0, s73, 0
    ds_read2_b32 v[80:81], v238 offset0:96 offset1:97
    v_mfma_f32_16x16x32_bf16 v[52:55], v[128:131], v[180:183], v[52:55]
    buffer_load_dwordx4 v4, s[52:55], s14 offen offset:0 lds
    v_mfma_f32_16x16x32_bf16 v[56:59], v[128:131], v[184:187], v[56:59]
    ds_read2_b32 v[82:83], v238 offset0:98 offset1:99
    v_mfma_f32_16x16x32_bf16 v[56:59], v[132:135], v[180:183], v[56:59]
    ds_read_b128 v[116:119], v246 offset:20480
    v_mfma_f32_16x16x32_bf16 v[56:59], v[136:139], v[176:179], v[56:59]
    v_mfma_f32_16x16x32_bf16 v[56:59], v[140:143], v[172:175], v[56:59]
    ds_read2_b32 v[84:85], v238 offset0:224 offset1:225
    v_mfma_f32_16x16x32_bf16 v[56:59], v[144:147], v[168:171], v[56:59]
    ds_read2_b32 v[86:87], v238 offset0:226 offset1:227
    v_mfma_f32_16x16x32_bf16 v[56:59], v[148:151], v[164:167], v[56:59]
    ds_read_b128 v[120:123], v246 offset:24576
    v_mfma_f32_16x16x32_bf16 v[56:59], v[152:155], v[160:163], v[56:59]
    v_mfma_f32_16x16x32_bf16 v[60:63], v[156:159], v[160:163], v[60:63]
    ds_read2_b32 v[88:89], v239 offset0:96 offset1:97
    v_mfma_f32_16x16x32_bf16 v[60:63], v[152:155], v[164:167], v[60:63]
    s_add_u32 m0, s73, 0
    ds_read2_b32 v[90:91], v239 offset0:98 offset1:99
    v_mfma_f32_16x16x32_bf16 v[60:63], v[148:151], v[168:171], v[60:63]
    buffer_load_dwordx4 v5, s[52:55], s14 offen offset:1024 lds
    v_mfma_f32_16x16x32_bf16 v[60:63], v[144:147], v[172:175], v[60:63]
    ds_read_b128 v[124:127], v246 offset:28672
    v_mfma_f32_16x16x32_bf16 v[60:63], v[140:143], v[176:179], v[60:63]
    ds_read2_b32 v[92:93], v239 offset0:224 offset1:225
    v_mfma_f32_16x16x32_bf16 v[60:63], v[136:139], v[180:183], v[60:63]
    v_mfma_f32_16x16x32_bf16 v[60:63], v[132:135], v[184:187], v[60:63]
    ds_read2_b32 v[94:95], v239 offset0:226 offset1:227
    v_mfma_f32_16x16x32_bf16 v[60:63], v[128:131], v[188:191], v[60:63]
    s_waitcnt lgkmcnt(12)
    v_mfma_f32_16x16x32_bf16 v[32:35], v[64:67], v[96:99], v[32:35]
    ds_read_b128 v[160:163], v247 offset:0
    s_waitcnt vmcnt(6)
    s_barrier
    v_mfma_f32_16x16x32_bf16 v[36:39], v[68:71], v[96:99], v[36:39]
    ds_read_b64_tr_b16 a[224:225], v10 offset:16384
    s_bfe_u32 s4, s2, 0x20003
    v_mfma_f32_16x16x32_bf16 v[36:39], v[64:67], v[100:103], v[36:39]
    ds_read_b64_tr_b16 a[226:227], v10 offset:18432
    ds_read_b128 v[164:167], v247 offset:4096
    v_mfma_f32_16x16x32_bf16 v[40:43], v[64:67], v[104:107], v[40:43]
    s_lshl2_add_u32 s4, s72, s4
    ds_read_b128 v[168:171], v247 offset:8192
    v_mfma_f32_16x16x32_bf16 v[40:43], v[68:71], v[100:103], v[40:43]
    ds_read_b64_tr_b16 a[232:233], v10 offset:20480
    s_add_u32 m0, s73, 0
    ds_read_b128 v[172:175], v247 offset:12288
    v_mfma_f32_16x16x32_bf16 v[40:43], v[72:75], v[96:99], v[40:43]
    ds_read_b64_tr_b16 a[234:235], v10 offset:22528
    buffer_load_dwordx4 v6, s[52:55], s14 offen offset:2048 lds
    s_lshl_b32 s4, s4, 3
    v_mfma_f32_16x16x32_bf16 v[44:47], v[76:79], v[96:99], v[44:47]
    ds_read_b128 v[176:179], v247 offset:16384
    v_mfma_f32_16x16x32_bf16 v[44:47], v[72:75], v[100:103], v[44:47]
    ds_read_b64_tr_b16 a[228:229], v11 offset:16384
    s_lshr_b32 s5, s2, 4
    ds_read_b128 v[180:183], v247 offset:20480
    v_mfma_f32_16x16x32_bf16 v[44:47], v[68:71], v[104:107], v[44:47]
    ds_read_b64_tr_b16 a[230:231], v11 offset:18432
    v_mfma_f32_16x16x32_bf16 v[44:47], v[64:67], v[108:111], v[44:47]
    s_and_b32 s5, s5, 6
    ds_read_b128 v[184:187], v247 offset:24576
    s_waitcnt lgkmcnt(13)
    v_mfma_f32_16x16x32_bf16 v[48:51], v[64:67], v[112:115], v[48:51]
    ds_read_b64_tr_b16 a[236:237], v11 offset:20480
    ds_read_b128 v[188:191], v247 offset:28672
    v_mfma_f32_16x16x32_bf16 v[48:51], v[68:71], v[108:111], v[48:51]
    ds_read_b64_tr_b16 a[238:239], v11 offset:22528
    s_add_u32 s4, s4, s5
    v_mfma_f32_16x16x32_bf16 v[48:51], v[72:75], v[104:107], v[48:51]
    ds_read2_b32 v[128:129], v236 offset0:112 offset1:113
    v_mfma_f32_16x16x32_bf16 v[48:51], v[76:79], v[100:103], v[48:51]
    s_and_b32 s5, s2, 1
    ds_read2_b32 v[130:131], v236 offset0:114 offset1:115
    v_mfma_f32_16x16x32_bf16 v[48:51], v[80:83], v[96:99], v[48:51]
    ds_read2_b32 v[132:133], v236 offset0:240 offset1:241
    v_mfma_f32_16x16x32_bf16 v[52:55], v[84:87], v[96:99], v[52:55]
    s_add_u32 m0, s73, 0
    ds_read2_b32 v[134:135], v236 offset0:242 offset1:243
    s_add_u32 s4, s4, s5
    v_mfma_f32_16x16x32_bf16 v[52:55], v[80:83], v[100:103], v[52:55]
    buffer_load_dwordx4 v7, s[52:55], s14 offen offset:3072 lds
    ds_read2_b32 v[136:137], v237 offset0:112 offset1:113
    v_mfma_f32_16x16x32_bf16 v[52:55], v[76:79], v[104:107], v[52:55]
    s_lshl_b32 s4, s4, 7
    ds_read2_b32 v[138:139], v237 offset0:114 offset1:115
    v_mfma_f32_16x16x32_bf16 v[52:55], v[72:75], v[108:111], v[52:55]
    s_add_u32 s4, s4, 12566528
    ds_read2_b32 v[140:141], v237 offset0:240 offset1:241
    s_add_u32 s6, s12, 4767744
    v_mfma_f32_16x16x32_bf16 v[52:55], v[68:71], v[112:115], v[52:55]
    ds_read2_b32 v[142:143], v237 offset0:242 offset1:243
    v_mfma_f32_16x16x32_bf16 v[52:55], v[64:67], v[116:119], v[52:55]
    ds_read2_b32 v[144:145], v238 offset0:112 offset1:113
    v_lshl_add_u32 v28, v2, 2, s4
    v_mfma_f32_16x16x32_bf16 v[56:59], v[64:67], v[120:123], v[56:59]
    s_waitcnt lgkmcnt(9)
    s_barrier
    v_mfma_f32_16x16x32_bf16 v[56:59], v[68:71], v[116:119], v[56:59]
    ds_read2_b32 v[146:147], v238 offset0:114 offset1:115
    s_cmp_eq_u32 s3, 0
    s_cselect_b32 s4, 18, 0
    v_mfma_f32_16x16x32_bf16 v[56:59], v[72:75], v[112:115], v[56:59]
    ds_read2_b32 v[148:149], v238 offset0:240 offset1:241
    v_mfma_f32_16x16x32_bf16 v[56:59], v[76:79], v[108:111], v[56:59]
    ds_read2_b32 v[150:151], v238 offset0:242 offset1:243
    v_cmp_gt_u32 vcc, s4, v2
    v_mfma_f32_16x16x32_bf16 v[56:59], v[80:83], v[104:107], v[56:59]
    s_lshl_b32 s14, s101, 18
    ds_read2_b32 v[152:153], v239 offset0:112 offset1:113
    v_mfma_f32_16x16x32_bf16 v[56:59], v[84:87], v[100:103], v[56:59]
    ds_read2_b32 v[154:155], v239 offset0:114 offset1:115
    s_add_u32 m0, s73, 16384
    v_mov_b32 v13, 0x40000000
    v_mfma_f32_16x16x32_bf16 v[56:59], v[88:91], v[96:99], v[56:59]
    buffer_load_dwordx4 v4, s[52:55], s14 offen offset:0 lds
    ds_read2_b32 v[156:157], v239 offset0:240 offset1:241
    v_mfma_f32_16x16x32_bf16 v[60:63], v[92:95], v[96:99], v[60:63]
    ds_read2_b32 v[158:159], v239 offset0:242 offset1:243
    v_cndmask_b32 v28, v13, v28, vcc
    v_mfma_f32_16x16x32_bf16 v[60:63], v[88:91], v[100:103], v[60:63]
    v_mfma_f32_16x16x32_bf16 v[60:63], v[84:87], v[104:107], v[60:63]
    v_mov_b32 v13, s68
    v_mfma_f32_16x16x32_bf16 v[60:63], v[80:83], v[108:111], v[60:63]
    v_mfma_f32_16x16x32_bf16 v[60:63], v[76:79], v[112:115], v[60:63]
    v_cndmask_b32 v13, 0, v13, vcc
    v_mfma_f32_16x16x32_bf16 v[60:63], v[72:75], v[116:119], v[60:63]
    v_mfma_f32_16x16x32_bf16 v[60:63], v[68:71], v[120:123], v[60:63]
    v_mfma_f32_16x16x32_bf16 v[60:63], v[64:67], v[124:127], v[60:63]
    s_waitcnt lgkmcnt(0)
    v_mfma_f32_16x16x32_bf16 v[60:63], v[128:131], v[188:191], v[60:63]
    v_mfma_f32_16x16x32_bf16 v[60:63], v[132:135], v[184:187], v[60:63]
    s_add_u32 m0, s73, 16384
    v_mfma_f32_16x16x32_bf16 v[60:63], v[136:139], v[180:183], v[60:63]
    buffer_load_dwordx4 v5, s[52:55], s14 offen offset:1024 lds
    v_mfma_f32_16x16x32_bf16 v[60:63], v[140:143], v[176:179], v[60:63]
    v_mfma_f32_16x16x32_bf16 v[60:63], v[144:147], v[172:175], v[60:63]
    v_mfma_f32_16x16x32_bf16 v[60:63], v[148:151], v[168:171], v[60:63]
    v_mfma_f32_16x16x32_bf16 v[60:63], v[152:155], v[164:167], v[60:63]
    v_mfma_f32_16x16x32_bf16 v[60:63], v[156:159], v[160:163], v[60:63]
    v_mfma_f32_16x16x32_bf16 v[56:59], v[128:131], v[184:187], v[56:59]
    v_mfma_f32_16x16x32_bf16 v[56:59], v[132:135], v[180:183], v[56:59]
    v_mfma_f32_16x16x32_bf16 v[56:59], v[136:139], v[176:179], v[56:59]
    v_mfma_f32_16x16x32_bf16 v[56:59], v[140:143], v[172:175], v[56:59]
    s_add_u32 m0, s73, 16384
    v_mfma_f32_16x16x32_bf16 v[56:59], v[144:147], v[168:171], v[56:59]
    buffer_load_dwordx4 v6, s[52:55], s14 offen offset:2048 lds
    v_mfma_f32_16x16x32_bf16 v[56:59], v[148:151], v[164:167], v[56:59]
    v_cvt_pk_bf16_f32 v206, v60, v61
    v_mfma_f32_16x16x32_bf16 v[56:59], v[152:155], v[160:163], v[56:59]
    s_waitcnt vmcnt(7)
    s_barrier
    v_mfma_f32_16x16x32_bf16 v[52:55], v[128:131], v[180:183], v[52:55]
    v_add_u32 v10, 131072, v10
    v_mfma_f32_16x16x32_bf16 v[52:55], v[132:135], v[176:179], v[52:55]
    ds_read_b64_tr_b16 a[240:241], v10 offset:16384
    v_cvt_pk_bf16_f32 v207, v62, v63
    v_mfma_f32_16x16x32_bf16 v[52:55], v[136:139], v[172:175], v[52:55]
    ds_read_b64_tr_b16 a[242:243], v10 offset:18432
    v_mfma_f32_16x16x32_bf16 v[52:55], v[140:143], v[168:171], v[52:55]
    buffer_store_dwordx2 v[206:207], v8, s[44:47], s6 offen offset:3584 sc1
    v_mfma_f32_16x16x32_bf16 v[52:55], v[144:147], v[164:167], v[52:55]
    ds_read_b64_tr_b16 a[248:249], v10 offset:20480
    v_mfma_f32_16x16x32_bf16 v[52:55], v[148:151], v[160:163], v[52:55]
    ds_read_b64_tr_b16 a[250:251], v10 offset:22528
    v_mfma_f32_16x16x32_bf16 v[48:51], v[128:131], v[176:179], v[48:51]
    v_add_u32 v11, 131072, v11
    v_cvt_pk_bf16_f32 v204, v56, v57
    v_mfma_f32_16x16x32_bf16 v[48:51], v[132:135], v[172:175], v[48:51]
    ds_read_b64_tr_b16 a[244:245], v11 offset:16384
    s_add_u32 m0, s73, 16384
    v_mfma_f32_16x16x32_bf16 v[48:51], v[136:139], v[168:171], v[48:51]
    ds_read_b64_tr_b16 a[246:247], v11 offset:18432
    buffer_load_dwordx4 v7, s[52:55], s14 offen offset:3072 lds
    v_mfma_f32_16x16x32_bf16 v[48:51], v[140:143], v[164:167], v[48:51]
    v_cvt_pk_bf16_f32 v205, v58, v59
    v_mfma_f32_16x16x32_bf16 v[48:51], v[144:147], v[160:163], v[48:51]
L_pl_X_6:
    s_cbranch_execz L_wret
    ds_read_b64_tr_b16 a[252:253], v11 offset:20480
    v_mfma_f32_16x16x32_bf16 v[44:47], v[128:131], v[172:175], v[44:47]
    buffer_store_dwordx2 v[204:205], v8, s[44:47], s6 offen offset:3072 sc1
    ds_read_b64_tr_b16 a[254:255], v11 offset:22528
    v_mfma_f32_16x16x32_bf16 v[44:47], v[132:135], v[168:171], v[44:47]
    v_mfma_f32_16x16x32_bf16 v[44:47], v[136:139], v[164:167], v[44:47]
    v_mfma_f32_16x16x32_bf16 v[44:47], v[140:143], v[160:163], v[44:47]
    v_cvt_pk_bf16_f32 v202, v52, v53
    v_mfma_f32_16x16x32_bf16 v[40:43], v[128:131], v[168:171], v[40:43]
    v_mfma_f32_16x16x32_bf16 v[40:43], v[132:135], v[164:167], v[40:43]
    v_mfma_f32_16x16x32_bf16 v[40:43], v[136:139], v[160:163], v[40:43]
    v_cvt_pk_bf16_f32 v203, v54, v55
    v_mfma_f32_16x16x32_bf16 v[36:39], v[128:131], v[164:167], v[36:39]
    v_mfma_f32_16x16x32_bf16 v[36:39], v[132:135], v[160:163], v[36:39]
    buffer_store_dwordx2 v[202:203], v8, s[44:47], s6 offen offset:2560 sc1
    v_mfma_f32_16x16x32_bf16 v[32:35], v[128:131], v[160:163], v[32:35]
    v_mov_b32 v29, 0
    buffer_atomic_add v29, v28, s[44:47], 0 offen sc0 sc1
    v_cvt_pk_bf16_f32 v200, v48, v49
    v_cvt_pk_bf16_f32 v201, v50, v51
    buffer_store_dwordx2 v[200:201], v8, s[44:47], s6 offen offset:2048 sc1
    v_cvt_pk_bf16_f32 v198, v44, v45
    v_cvt_pk_bf16_f32 v199, v46, v47
    buffer_store_dwordx2 v[198:199], v8, s[44:47], s6 offen offset:1536 sc1
    v_cvt_pk_bf16_f32 v196, v40, v41
    v_cvt_pk_bf16_f32 v197, v42, v43
    buffer_store_dwordx2 v[196:197], v8, s[44:47], s6 offen offset:1024 sc1
    v_cvt_pk_bf16_f32 v194, v36, v37
    v_cvt_pk_bf16_f32 v195, v38, v39
    buffer_store_dwordx2 v[194:195], v8, s[44:47], s6 offen offset:512 sc1
    v_cvt_pk_bf16_f32 v192, v32, v33
    v_cvt_pk_bf16_f32 v193, v34, v35
    buffer_store_dwordx2 v[192:193], v8, s[44:47], s6 offen offset:0 sc1
    v_add_u32 v10, -131072, v10
    v_add_u32 v11, -131072, v11
    s_waitcnt lgkmcnt(0)
    s_barrier
L_DX:
    s_waitcnt vmcnt(0)
    v_cmp_ne_u32 vcc, v13, v29
    s_cbranch_vccnz L_rs_p2X
L_ok_p2X:
    s_barrier
    s_add_u32 m0, s73, 97536
    s_nop 0
    buffer_load_dwordx4 v23, s[44:47], s18 offen offset:768 sc1 lds
    s_add_u32 m0, s73, 99328
    s_nop 0
    buffer_load_dwordx4 v20, s[44:47], s18 offen offset:0 sc1 lds
    s_add_u32 m0, s73, 99840
    s_nop 0
    buffer_load_dwordx4 v20, s[44:47], s18 offen offset:512 sc1 lds
    s_add_u32 m0, s73, 100608
    s_nop 0
    buffer_load_dwordx4 v23, s[44:47], s19 offen offset:768 sc1 lds
    s_add_u32 m0, s73, 114688
    s_nop 0
    buffer_load_dwordx4 v20, s[44:47], s19 offen offset:0 sc1 lds
    s_add_u32 m0, s73, 115200
    s_nop 0
    buffer_load_dwordx4 v20, s[44:47], s19 offen offset:512 sc1 lds
    s_add_u32 m0, s73, 115968
    s_nop 0
    buffer_load_dwordx4 v23, s[44:47], s20 offen offset:768 sc1 lds
    s_add_u32 m0, s73, 117760
    s_nop 0
    buffer_load_dwordx4 v20, s[44:47], s20 offen offset:0 sc1 lds
    s_mov_b32 s56, s16
    s_and_b32 s57, s17, 0xffff
    s_mov_b32 s58, 2359296
    s_mov_b32 s59, 0x20000
    s_mov_b32 s40, 18432
    s_mov_b32 s42, 12386304
    s_mov_b32 s64, s38
    s_and_b32 s65, s39, 0xffff
    s_mov_b32 s66, 2359296
    s_mov_b32 s67, 0x20000
    v_lshlrev_b32 v136, 4, v2
    s_mul_i32 s7, s72, 36
    s_bitcmp1_b32 s3, 0
    s_addc_u32 s7, s7, 0
    s_lshl_b32 s7, s7, 17
    v_subrev_u32 v184, s7, v4
    v_subrev_u32 v185, s7, v5
    s_bfe_u32 s4, s2, 0x20003
    s_mul_i32 s4, s4, 9
    s_lshl1_add_u32 s7, s72, s4
    s_and_b32 s8, s3, 1
    s_add_u32 s7, s7, s8
    s_lshl_b32 s37, s7, 16
    s_add_u32 s37, s37, 4718592
    s_add_u32 s4, s4, 8
    s_lshl_b32 s16, s4, 16
    s_add_u32 s16, s16, 4718592
    s_sub_u32 s4, s4, s7
    s_lshl_b32 s4, s4, 7
    s_lshl_b32 s7, s7, 7
    s_add_u32 s7, s7, 12582912
    v_bfe_u32 v24, v2, 2, 1
    v_mul_u32_u24 v24, s4, v24
    v_and_b32 v25, 3, v2
    v_lshl_add_u32 v24, v25, 2, v24
    v_add_u32 v188, s7, v24
    s_lshl2_add_u32 s7, s2, s3
    s_mul_i32 s8, s7, 3072
    s_add_u32 s34, s8, 22953984
    s_add_u32 s11, s8, 26099712
    s_add_u32 s12, s8, 29245440
    s_lshl_b32 s35, s7, 12
    s_add_u32 s35, s35, 32391168
    s_xor_b32 s8, s7, 8
    s_mul_i32 s8, s8, 3072
    s_add_u32 s30, s8, 22953984
    s_xor_b32 s8, s7, 16
    s_mul_i32 s8, s8, 3072
    s_add_u32 s15, s8, 26099712
    s_xor_b32 s8, s7, 24
    s_mul_i32 s8, s8, 3072
    s_add_u32 s31, s8, 29245440
    s_andn2_b32 s7, s7, 24
    s_lshl3_add_u32 s7, s3, s7
    s_lshl2_add_u32 s8, s7, s72
    s_lshl_b32 s8, s8, 10
    s_add_u32 s32, s8, 32391168
    s_xor_b32 s8, s8, 4096
    s_add_u32 s33, s8, 32391168
    s_xor_b32 s8, s3, s72
    s_cmp_lt_u32 s8, 2
    s_cselect_b32 s35, s35, 0x40000000
    s_cselect_b32 s16, s16, 0x40000000
    s_cselect_b32 s36, s68, 0
    s_mov_b32 s38, 0xbfb8aa3b
    s_and_b32 s8, s8, 1
    s_mul_i32 s41, s8, 96
    s_and_b32 s43, s73, 4096
    v_lshlrev_b32 v24, 10, v2
    v_add_u32 v24, s35, v24
    s_add_u32 s7, s34, 2048
    v_mov_b32 v25, s36
    v_cmp_gt_u32 vcc, 4, v2
    s_nop 1
    v_cndmask_b32 v138, 0, v25, vcc
    v_mov_b32 v25, 0x40000000
    v_cndmask_b32 v137, v25, v24, vcc
    v_writelane_b32 v137, s7, 4
    v_writelane_b32 v138, s68, 4
    v_min_u32 v139, 1, v2
    v_lshlrev_b32 v139, 30, v139
    v_mov_b32 v140, 0
    v_writelane_b32 v140, s68, 0
    v_mov_b32 v195, s68
    v_mov_b32 v199, s68
    v_mov_b32 v202, s68
    v_mov_b32 v203, s68
    s_waitcnt vmcnt(4)
    s_barrier
    ds_read_b128 v[104:107], v14 offset:0
    ds_read_b128 v[108:111], v14 offset:4096
    ds_read_b128 v[112:115], v14 offset:8192
    ds_read_b128 v[116:119], v14 offset:12288
    s_waitcnt lgkmcnt(2)
    v_mfma_f32_16x16x32_bf16 v[32:35], v[104:107], a[0:3], 0
    s_add_u32 m0, s73, 130560
    s_sub_u32 s4, s75, 216
    s_lshl_b32 s7, s4, 7
    v_mfma_f32_16x16x32_bf16 v[32:35], v[108:111], a[8:11], v[32:35]
    buffer_load_dwordx4 v20, s[44:47], s20 offen offset:512 sc1 lds
    s_waitcnt lgkmcnt(0)
    v_mfma_f32_16x16x32_bf16 v[32:35], v[112:115], a[16:19], v[32:35]
    ds_read_b128 v[120:123], v14 offset:1024
    s_lshl2_add_u32 s7, s3, s7
    s_add_u32 s7, s7, 12582912
    v_mfma_f32_16x16x32_bf16 v[32:35], v[116:119], a[24:27], v[32:35]
    ds_read_b128 v[124:127], v14 offset:5120
    v_mfma_f32_16x16x32_bf16 v[36:39], v[116:119], a[28:31], 0
    ds_read_b128 v[128:131], v14 offset:9216
    s_cmp_lt_u32 s4, 36
    s_cselect_b32 s7, s7, 0x40000000
    v_mfma_f32_16x16x32_bf16 v[36:39], v[112:115], a[20:23], v[36:39]
    ds_read_b128 v[132:135], v14 offset:13312
    v_min_u32 v28, 1, v2
    v_mfma_f32_16x16x32_bf16 v[36:39], v[108:111], a[12:15], v[36:39]
    s_add_u32 m0, s73, 131328
    v_lshlrev_b32 v28, 30, v28
    v_mov_b32 v29, s68
    v_mfma_f32_16x16x32_bf16 v[36:39], v[104:107], a[4:7], v[36:39]
    buffer_load_dwordx4 v23, s[44:47], s21 offen offset:768 sc1 lds
    s_waitcnt lgkmcnt(2)
    v_mfma_f32_16x16x32_bf16 v[44:47], v[120:123], a[4:7], 0
    buffer_store_dword v29, v28, s[44:47], s7 offen sc1
    s_add_u32 m0, s73, 133120
    v_mfma_f32_16x16x32_bf16 v[44:47], v[124:127], a[12:15], v[44:47]
    buffer_load_dwordx4 v20, s[44:47], s21 offen offset:0 sc1 lds
    s_waitcnt lgkmcnt(0)
    v_mfma_f32_16x16x32_bf16 v[44:47], v[128:131], a[20:23], v[44:47]
    ds_read_b128 v[104:107], v14 offset:2048
    v_mfma_f32_16x16x32_bf16 v[44:47], v[132:135], a[28:31], v[44:47]
    ds_read_b128 v[108:111], v14 offset:6144
    v_mfma_f32_16x16x32_bf16 v[40:43], v[132:135], a[24:27], 0
    ds_read_b128 v[112:115], v14 offset:10240
    v_mfma_f32_16x16x32_bf16 v[40:43], v[128:131], a[16:19], v[40:43]
    ds_read_b128 v[116:119], v14 offset:14336
    v_mfma_f32_16x16x32_bf16 v[40:43], v[124:127], a[8:11], v[40:43]
    s_add_u32 m0, s73, 133632
    v_mfma_f32_16x16x32_bf16 v[40:43], v[120:123], a[0:3], v[40:43]
    buffer_load_dwordx4 v20, s[44:47], s21 offen offset:512 sc1 lds
    s_waitcnt lgkmcnt(2)
    v_mfma_f32_16x16x32_bf16 v[48:51], v[104:107], a[0:3], 0
    s_add_u32 m0, s73, 146688
    v_mfma_f32_16x16x32_bf16 v[48:51], v[108:111], a[8:11], v[48:51]
    buffer_load_dwordx4 v23, s[44:47], s22 offen offset:768 sc1 lds
    s_waitcnt lgkmcnt(0)
    v_mfma_f32_16x16x32_bf16 v[48:51], v[112:115], a[16:19], v[48:51]
    ds_read_b128 v[120:123], v14 offset:3072
    v_mfma_f32_16x16x32_bf16 v[48:51], v[116:119], a[24:27], v[48:51]
    ds_read_b128 v[124:127], v14 offset:7168
    v_mfma_f32_16x16x32_bf16 v[52:55], v[116:119], a[28:31], 0
    ds_read_b128 v[128:131], v14 offset:11264
    v_mfma_f32_16x16x32_bf16 v[52:55], v[112:115], a[20:23], v[52:55]
    ds_read_b128 v[132:135], v14 offset:15360
    v_mfma_f32_16x16x32_bf16 v[52:55], v[108:111], a[12:15], v[52:55]
    s_add_u32 m0, s73, 148480
    v_mfma_f32_16x16x32_bf16 v[52:55], v[104:107], a[4:7], v[52:55]
    buffer_load_dwordx4 v20, s[44:47], s22 offen offset:0 sc1 lds
    s_waitcnt lgkmcnt(2)
    v_mfma_f32_16x16x32_bf16 v[36:39], v[120:123], a[36:39], v[36:39]
    s_add_u32 m0, s73, 148992
    v_mfma_f32_16x16x32_bf16 v[36:39], v[124:127], a[44:47], v[36:39]
    buffer_load_dwordx4 v20, s[44:47], s22 offen offset:512 sc1 lds
    s_waitcnt lgkmcnt(0)
    v_mfma_f32_16x16x32_bf16 v[36:39], v[128:131], a[52:55], v[36:39]
    s_waitcnt vmcnt(8)
    s_barrier
    v_mfma_f32_16x16x32_bf16 v[36:39], v[132:135], a[60:63], v[36:39]
    ds_read_b128 v[104:107], v14 offset:16384
    v_mfma_f32_16x16x32_bf16 v[32:35], v[132:135], a[56:59], v[32:35]
    ds_read_b128 v[108:111], v14 offset:20480
    v_mfma_f32_16x16x32_bf16 v[32:35], v[128:131], a[48:51], v[32:35]
    ds_read_b128 v[112:115], v14 offset:24576
    v_mfma_f32_16x16x32_bf16 v[32:35], v[124:127], a[40:43], v[32:35]
    ds_read_b128 v[116:119], v14 offset:28672
    s_add_u32 m0, s73, 149760
    v_mfma_f32_16x16x32_bf16 v[32:35], v[120:123], a[32:35], v[32:35]
    buffer_load_dwordx4 v23, s[44:47], s23 offen offset:768 sc1 lds
    ds_read_b64_tr_b16 v[220:221], v10 offset:0
    s_waitcnt lgkmcnt(3)
    v_mfma_f32_16x16x32_bf16 v[40:43], v[104:107], a[32:35], v[40:43]
    s_add_u32 m0, s73, 98304
    ds_read_b64_tr_b16 v[222:223], v10 offset:2048
    v_mfma_f32_16x16x32_bf16 v[40:43], v[108:111], a[40:43], v[40:43]
    buffer_load_dwordx4 v20, s[44:47], s23 offen offset:0 sc1 lds
    s_waitcnt lgkmcnt(2)
    v_mfma_f32_16x16x32_bf16 v[40:43], v[112:115], a[48:51], v[40:43]
    ds_read_b128 v[120:123], v14 offset:17408
    v_mfma_f32_16x16x32_bf16 v[40:43], v[116:119], a[56:59], v[40:43]
    ds_read_b128 v[124:127], v14 offset:21504
    v_mfma_f32_16x16x32_bf16 v[44:47], v[116:119], a[60:63], v[44:47]
    ds_read_b128 v[128:131], v14 offset:25600
    v_mfma_f32_16x16x32_bf16 v[44:47], v[112:115], a[52:55], v[44:47]
    ds_read_b128 v[132:135], v14 offset:29696
    v_mfma_f32_16x16x32_bf16 v[44:47], v[108:111], a[44:47], v[44:47]
    s_add_u32 m0, s73, 98816
    ds_read_b64_tr_b16 v[228:229], v10 offset:4096
    v_mfma_f32_16x16x32_bf16 v[44:47], v[104:107], a[36:39], v[44:47]
    buffer_load_dwordx4 v20, s[44:47], s23 offen offset:512 sc1 lds
    s_waitcnt lgkmcnt(3)
    v_mfma_f32_16x16x32_bf16 v[52:55], v[120:123], a[36:39], v[52:55]
    s_add_u32 m0, s73, 99584
    ds_read_b64_tr_b16 v[230:231], v10 offset:6144
    v_mfma_f32_16x16x32_bf16 v[52:55], v[124:127], a[44:47], v[52:55]
    buffer_load_dwordx4 v23, s[44:47], s24 offen offset:768 sc1 lds
    s_waitcnt lgkmcnt(2)
    v_mfma_f32_16x16x32_bf16 v[52:55], v[128:131], a[52:55], v[52:55]
    ds_read_b128 v[104:107], v14 offset:18432
    v_mfma_f32_16x16x32_bf16 v[52:55], v[132:135], a[60:63], v[52:55]
    ds_read_b128 v[108:111], v14 offset:22528
    v_mfma_f32_16x16x32_bf16 v[48:51], v[132:135], a[56:59], v[48:51]
    ds_read_b128 v[112:115], v14 offset:26624
    v_mfma_f32_16x16x32_bf16 v[48:51], v[128:131], a[48:51], v[48:51]
    ds_read_b128 v[116:119], v14 offset:30720
    v_mfma_f32_16x16x32_bf16 v[48:51], v[124:127], a[40:43], v[48:51]
    s_add_u32 m0, s73, 101376
    ds_read_b64_tr_b16 v[224:225], v11 offset:0
    v_mfma_f32_16x16x32_bf16 v[48:51], v[120:123], a[32:35], v[48:51]
    buffer_load_dwordx4 v20, s[44:47], s24 offen offset:0 sc1 lds
    s_waitcnt lgkmcnt(3)
    v_mfma_f32_16x16x32_bf16 v[32:35], v[104:107], a[64:67], v[32:35]
    ds_read_b64_tr_b16 v[226:227], v11 offset:2048
    v_mfma_f32_16x16x32_bf16 v[32:35], v[108:111], a[72:75], v[32:35]
    s_waitcnt lgkmcnt(2)
    v_mfma_f32_16x16x32_bf16 v[32:35], v[112:115], a[80:83], v[32:35]
    ds_read_b128 v[120:123], v14 offset:19456
    v_mfma_f32_16x16x32_bf16 v[32:35], v[116:119], a[88:91], v[32:35]
    ds_read_b128 v[124:127], v14 offset:23552
    v_mfma_f32_16x16x32_bf16 v[36:39], v[116:119], a[92:95], v[36:39]
    ds_read_b128 v[128:131], v14 offset:27648
    v_mfma_f32_16x16x32_bf16 v[36:39], v[112:115], a[84:87], v[36:39]
    ds_read_b128 v[132:135], v14 offset:31744
    v_mfma_f32_16x16x32_bf16 v[36:39], v[108:111], a[76:79], v[36:39]
    ds_read_b64_tr_b16 v[232:233], v11 offset:4096
    v_mfma_f32_16x16x32_bf16 v[36:39], v[104:107], a[68:71], v[36:39]
    s_waitcnt lgkmcnt(3)
    v_mfma_f32_16x16x32_bf16 v[44:47], v[120:123], a[68:71], v[44:47]
    ds_read_b64_tr_b16 v[234:235], v11 offset:6144
    v_mfma_f32_16x16x32_bf16 v[44:47], v[124:127], a[76:79], v[44:47]
    s_waitcnt lgkmcnt(2)
    v_mfma_f32_16x16x32_bf16 v[44:47], v[128:131], a[84:87], v[44:47]
    s_waitcnt vmcnt(8) lgkmcnt(0)
    s_barrier
    v_mfma_f32_16x16x32_bf16 v[44:47], v[132:135], a[92:95], v[44:47]
    ds_read_b128 v[104:107], v14 offset:32768
    v_mfma_f32_16x16x32_bf16 v[40:43], v[132:135], a[88:91], v[40:43]
    ds_read_b128 v[108:111], v14 offset:36864
    v_mfma_f32_16x16x32_bf16 v[40:43], v[128:131], a[80:83], v[40:43]
    ds_read_b128 v[112:115], v14 offset:40960
    v_mfma_f32_16x16x32_bf16 v[40:43], v[124:127], a[72:75], v[40:43]
    ds_read_b128 v[116:119], v14 offset:45056
    v_mfma_f32_16x16x32_bf16 v[40:43], v[120:123], a[64:67], v[40:43]
    ds_read_b64_tr_b16 v[236:237], v10 offset:16384
    s_waitcnt lgkmcnt(3)
    v_mfma_f32_16x16x32_bf16 v[48:51], v[104:107], a[64:67], v[48:51]
    s_add_u32 m0, s73, 114176
    ds_read_b64_tr_b16 v[238:239], v10 offset:18432
    v_mfma_f32_16x16x32_bf16 v[48:51], v[108:111], a[72:75], v[48:51]
    buffer_load_dwordx4 v20, s[44:47], s24 offen offset:512 sc1 lds
    s_waitcnt lgkmcnt(2)
    v_mfma_f32_16x16x32_bf16 v[48:51], v[112:115], a[80:83], v[48:51]
    ds_read_b128 v[120:123], v14 offset:33792
    v_mfma_f32_16x16x32_bf16 v[48:51], v[116:119], a[88:91], v[48:51]
    ds_read_b128 v[124:127], v14 offset:37888
    v_lshrrev_b32 v30, 2, v26
    v_mfma_f32_16x16x32_bf16 v[52:55], v[116:119], a[92:95], v[52:55]
    ds_read_b128 v[128:131], v14 offset:41984
    v_mfma_f32_16x16x32_bf16 v[52:55], v[112:115], a[84:87], v[52:55]
    ds_read_b128 v[132:135], v14 offset:46080
    v_mfma_f32_16x16x32_bf16 v[52:55], v[108:111], a[76:79], v[52:55]
    s_add_u32 m0, s73, 114944
    ds_read_b64_tr_b16 v[244:245], v10 offset:20480
    v_mfma_f32_16x16x32_bf16 v[52:55], v[104:107], a[68:71], v[52:55]
    buffer_load_dwordx4 v23, s[44:47], s25 offen offset:768 sc1 lds
    s_waitcnt lgkmcnt(3)
    v_mfma_f32_16x16x32_bf16 v[36:39], v[120:123], a[100:103], v[36:39]
    s_add_u32 m0, s73, 116736
    ds_read_b64_tr_b16 v[246:247], v10 offset:22528
    v_mfma_f32_16x16x32_bf16 v[36:39], v[124:127], a[108:111], v[36:39]
    buffer_load_dwordx4 v20, s[44:47], s25 offen offset:0 sc1 lds
    s_waitcnt lgkmcnt(2)
    v_mfma_f32_16x16x32_bf16 v[36:39], v[128:131], a[116:119], v[36:39]
    ds_read_b128 v[104:107], v14 offset:34816
    v_lshrrev_b32 v31, 2, v18
    v_mfma_f32_16x16x32_bf16 v[36:39], v[132:135], a[124:127], v[36:39]
    ds_read_b128 v[108:111], v14 offset:38912
    v_mfma_f32_16x16x32_bf16 v[32:35], v[132:135], a[120:123], v[32:35]
    ds_read_b128 v[112:115], v14 offset:43008
    v_mfma_f32_16x16x32_bf16 v[32:35], v[128:131], a[112:115], v[32:35]
    ds_read_b128 v[116:119], v14 offset:47104
    v_mfma_f32_16x16x32_bf16 v[32:35], v[124:127], a[104:107], v[32:35]
    s_add_u32 m0, s73, 117248
    ds_read_b64_tr_b16 v[240:241], v11 offset:16384
    v_mfma_f32_16x16x32_bf16 v[32:35], v[120:123], a[96:99], v[32:35]
    buffer_load_dwordx4 v20, s[44:47], s25 offen offset:512 sc1 lds
    s_waitcnt lgkmcnt(3)
    v_mfma_f32_16x16x32_bf16 v[40:43], v[104:107], a[96:99], v[40:43]
    ds_read_b64_tr_b16 v[242:243], v11 offset:18432
    buffer_load_ushort v102, v30, s[60:63], 0 offen offset:0
    v_mfma_f32_16x16x32_bf16 v[40:43], v[108:111], a[104:107], v[40:43]
    s_waitcnt lgkmcnt(2)
    v_mfma_f32_16x16x32_bf16 v[40:43], v[112:115], a[112:115], v[40:43]
    ds_read_b128 v[120:123], v14 offset:35840
    v_mfma_f32_16x16x32_bf16 v[40:43], v[116:119], a[120:123], v[40:43]
    ds_read_b128 v[124:127], v14 offset:39936
    v_mfma_f32_16x16x32_bf16 v[44:47], v[116:119], a[124:127], v[44:47]
    ds_read_b128 v[128:131], v14 offset:44032
    v_mfma_f32_16x16x32_bf16 v[44:47], v[112:115], a[116:119], v[44:47]
    ds_read_b128 v[132:135], v14 offset:48128
    v_mfma_f32_16x16x32_bf16 v[44:47], v[108:111], a[108:111], v[44:47]
    ds_read_b64_tr_b16 v[248:249], v11 offset:20480
    buffer_load_ushort v103, v30, s[60:63], 0 offen offset:32
    v_mfma_f32_16x16x32_bf16 v[44:47], v[104:107], a[100:103], v[44:47]
    s_waitcnt lgkmcnt(3)
    v_mfma_f32_16x16x32_bf16 v[52:55], v[120:123], a[100:103], v[52:55]
    ds_read_b64_tr_b16 v[250:251], v11 offset:22528
    v_mfma_f32_16x16x32_bf16 v[52:55], v[124:127], a[108:111], v[52:55]
    s_waitcnt lgkmcnt(2)
    v_mfma_f32_16x16x32_bf16 v[52:55], v[128:131], a[116:119], v[52:55]
    s_waitcnt vmcnt(10) lgkmcnt(0)
    s_barrier
    v_mfma_f32_16x16x32_bf16 v[52:55], v[132:135], a[124:127], v[52:55]
    ds_read_b128 v[104:107], v14 offset:49152
    v_mfma_f32_16x16x32_bf16 v[48:51], v[132:135], a[120:123], v[48:51]
    ds_read_b128 v[108:111], v14 offset:53248
    buffer_load_ushort v27, v31, s[60:63], 0 offen offset:0
    v_mfma_f32_16x16x32_bf16 v[48:51], v[128:131], a[112:115], v[48:51]
    ds_read_b128 v[112:115], v14 offset:57344
    v_mfma_f32_16x16x32_bf16 v[48:51], v[124:127], a[104:107], v[48:51]
    ds_read_b128 v[116:119], v14 offset:61440
    v_mfma_f32_16x16x32_bf16 v[48:51], v[120:123], a[96:99], v[48:51]
    s_waitcnt lgkmcnt(2)
    v_mfma_f32_16x16x32_bf16 v[32:35], v[104:107], a[128:131], v[32:35]
    s_add_u32 m0, s73, 130304
    v_mfma_f32_16x16x32_bf16 v[32:35], v[108:111], a[136:139], v[32:35]
    buffer_load_dwordx4 v23, s[44:47], s26 offen offset:768 sc1 lds
    s_waitcnt lgkmcnt(0)
    v_mfma_f32_16x16x32_bf16 v[32:35], v[112:115], a[144:147], v[32:35]
    ds_read_b128 v[120:123], v14 offset:50176
    v_mfma_f32_16x16x32_bf16 v[32:35], v[116:119], a[152:155], v[32:35]
    ds_read_b128 v[124:127], v14 offset:54272
    v_mfma_f32_16x16x32_bf16 v[36:39], v[116:119], a[156:159], v[36:39]
    ds_read_b128 v[128:131], v14 offset:58368
    v_mfma_f32_16x16x32_bf16 v[36:39], v[112:115], a[148:151], v[36:39]
    ds_read_b128 v[132:135], v14 offset:62464
    v_mfma_f32_16x16x32_bf16 v[36:39], v[108:111], a[140:143], v[36:39]
    s_add_u32 m0, s73, 132096
    v_mfma_f32_16x16x32_bf16 v[36:39], v[104:107], a[132:135], v[36:39]
    buffer_load_dwordx4 v20, s[44:47], s26 offen offset:0 sc1 lds
    s_waitcnt lgkmcnt(2)
    v_mfma_f32_16x16x32_bf16 v[44:47], v[120:123], a[132:135], v[44:47]
    s_add_u32 m0, s73, 132608
    buffer_load_dwordx4 v[88:91], v252, s[56:59], 0 offen
    v_mfma_f32_16x16x32_bf16 v[44:47], v[124:127], a[140:143], v[44:47]
    buffer_load_dwordx4 v20, s[44:47], s26 offen offset:512 sc1 lds
    s_waitcnt lgkmcnt(0)
    v_mfma_f32_16x16x32_bf16 v[44:47], v[128:131], a[148:151], v[44:47]
    ds_read_b128 v[104:107], v14 offset:51200
    v_mfma_f32_16x16x32_bf16 v[44:47], v[132:135], a[156:159], v[44:47]
    ds_read_b128 v[108:111], v14 offset:55296
    v_mfma_f32_16x16x32_bf16 v[40:43], v[132:135], a[152:155], v[40:43]
    ds_read_b128 v[112:115], v14 offset:59392
    v_mfma_f32_16x16x32_bf16 v[40:43], v[128:131], a[144:147], v[40:43]
    ds_read_b128 v[116:119], v14 offset:63488
    v_mfma_f32_16x16x32_bf16 v[40:43], v[124:127], a[136:139], v[40:43]
    s_add_u32 m0, s73, 134144
    v_mfma_f32_16x16x32_bf16 v[40:43], v[120:123], a[128:131], v[40:43]
    buffer_load_dwordx4 v21, s[44:47], s18 offen offset:0 sc1 lds
    s_waitcnt lgkmcnt(2)
    v_mfma_f32_16x16x32_bf16 v[48:51], v[104:107], a[128:131], v[48:51]
    v_mfma_f32_16x16x32_bf16 v[48:51], v[108:111], a[136:139], v[48:51]
    s_waitcnt lgkmcnt(0)
    v_mfma_f32_16x16x32_bf16 v[48:51], v[112:115], a[144:147], v[48:51]
    ds_read_b128 v[120:123], v14 offset:52224
    v_mfma_f32_16x16x32_bf16 v[48:51], v[116:119], a[152:155], v[48:51]
    ds_read_b128 v[124:127], v14 offset:56320
    v_mfma_f32_16x16x32_bf16 v[52:55], v[116:119], a[156:159], v[52:55]
    ds_read_b128 v[128:131], v14 offset:60416
    v_mfma_f32_16x16x32_bf16 v[52:55], v[112:115], a[148:151], v[52:55]
    ds_read_b128 v[132:135], v14 offset:64512
    v_mfma_f32_16x16x32_bf16 v[52:55], v[108:111], a[140:143], v[52:55]
    v_mfma_f32_16x16x32_bf16 v[52:55], v[104:107], a[132:135], v[52:55]
    s_waitcnt lgkmcnt(2)
    v_mfma_f32_16x16x32_bf16 v[36:39], v[120:123], a[164:167], v[36:39]
    buffer_load_dwordx4 v[92:95], v252, s[56:59], s40 offen
    v_mfma_f32_16x16x32_bf16 v[36:39], v[124:127], a[172:175], v[36:39]
    s_waitcnt lgkmcnt(0)
    v_mfma_f32_16x16x32_bf16 v[36:39], v[128:131], a[180:183], v[36:39]
    s_waitcnt vmcnt(13)
    s_barrier
    v_mfma_f32_16x16x32_bf16 v[36:39], v[132:135], a[188:191], v[36:39]
    ds_read_b128 v[104:107], v14 offset:0
    v_mfma_f32_16x16x32_bf16 v[32:35], v[132:135], a[184:187], v[32:35]
    ds_read_b128 v[108:111], v14 offset:4096
    v_mfma_f32_16x16x32_bf16 v[32:35], v[128:131], a[176:179], v[32:35]
    ds_read_b128 v[112:115], v14 offset:8192
    v_mfma_f32_16x16x32_bf16 v[32:35], v[124:127], a[168:171], v[32:35]
    ds_read_b128 v[116:119], v14 offset:12288
    v_mfma_f32_16x16x32_bf16 v[32:35], v[120:123], a[160:163], v[32:35]
    s_waitcnt lgkmcnt(2)
    v_mfma_f32_16x16x32_bf16 v[40:43], v[104:107], a[160:163], v[40:43]
    s_add_u32 m0, s73, 146944
    v_mfma_f32_16x16x32_bf16 v[40:43], v[108:111], a[168:171], v[40:43]
    buffer_load_dwordx4 v21, s[44:47], s18 offen offset:512 sc1 lds
    s_waitcnt lgkmcnt(0)
    v_mfma_f32_16x16x32_bf16 v[40:43], v[112:115], a[176:179], v[40:43]
    ds_read_b128 v[120:123], v14 offset:1024
    v_mfma_f32_16x16x32_bf16 v[40:43], v[116:119], a[184:187], v[40:43]
    ds_read_b128 v[124:127], v14 offset:5120
    v_mfma_f32_16x16x32_bf16 v[44:47], v[116:119], a[188:191], v[44:47]
    ds_read_b128 v[128:131], v14 offset:9216
    v_mfma_f32_16x16x32_bf16 v[44:47], v[112:115], a[180:183], v[44:47]
    ds_read_b128 v[132:135], v14 offset:13312
    v_mfma_f32_16x16x32_bf16 v[44:47], v[108:111], a[172:175], v[44:47]
    s_add_u32 m0, s73, 148480
    v_mfma_f32_16x16x32_bf16 v[44:47], v[104:107], a[164:167], v[44:47]
    buffer_load_dwordx4 v21, s[44:47], s19 offen offset:0 sc1 lds
    s_waitcnt lgkmcnt(2)
    v_mfma_f32_16x16x32_bf16 v[52:55], v[120:123], a[164:167], v[52:55]
    s_add_u32 m0, s73, 148992
    buffer_load_dwordx2 v[142:143], v253, s[56:59], 0 offen
    v_mfma_f32_16x16x32_bf16 v[52:55], v[124:127], a[172:175], v[52:55]
    buffer_load_dwordx4 v21, s[44:47], s19 offen offset:512 sc1 lds
    s_waitcnt lgkmcnt(0)
    v_mfma_f32_16x16x32_bf16 v[52:55], v[128:131], a[180:183], v[52:55]
    ds_read_b128 v[104:107], v14 offset:2048
    v_mfma_f32_16x16x32_bf16 v[52:55], v[132:135], a[188:191], v[52:55]
    ds_read_b128 v[108:111], v14 offset:6144
    v_mfma_f32_16x16x32_bf16 v[48:51], v[132:135], a[184:187], v[48:51]
    ds_read_b128 v[112:115], v14 offset:10240
    v_mfma_f32_16x16x32_bf16 v[48:51], v[128:131], a[176:179], v[48:51]
    ds_read_b128 v[116:119], v14 offset:14336
    v_mfma_f32_16x16x32_bf16 v[48:51], v[124:127], a[168:171], v[48:51]
    s_add_u32 m0, s73, 150528
    v_mfma_f32_16x16x32_bf16 v[48:51], v[120:123], a[160:163], v[48:51]
    buffer_load_dwordx4 v21, s[44:47], s20 offen offset:0 sc1 lds
    s_waitcnt lgkmcnt(2)
    v_mfma_f32_16x16x32_bf16 v[32:35], v[104:107], a[192:195], v[32:35]
    v_mfma_f32_16x16x32_bf16 v[32:35], v[108:111], a[200:203], v[32:35]
    s_waitcnt vmcnt(11)
    s_waitcnt lgkmcnt(0)
    v_mfma_f32_16x16x32_bf16 v[32:35], v[112:115], a[208:211], v[32:35]
    ds_read_b128 v[120:123], v14 offset:3072
    v_mfma_f32_16x16x32_bf16 v[32:35], v[116:119], a[216:219], v[32:35]
    ds_read_b128 v[124:127], v14 offset:7168
    v_mfma_f32_16x16x32_bf16 v[36:39], v[116:119], a[220:223], v[36:39]
    ds_read_b128 v[128:131], v14 offset:11264
    v_lshlrev_b32 v72, 16, v102
    v_mfma_f32_16x16x32_bf16 v[36:39], v[112:115], a[212:215], v[36:39]
    ds_read_b128 v[132:135], v14 offset:15360
    v_mfma_f32_16x16x32_bf16 v[36:39], v[108:111], a[204:207], v[36:39]
    v_lshlrev_b32 v73, 16, v102
    v_mfma_f32_16x16x32_bf16 v[36:39], v[104:107], a[196:199], v[36:39]
    buffer_load_dwordx2 v[96:97], v26, s[44:47], s42 offen offset:0 sc1
    s_waitcnt lgkmcnt(2)
    v_mfma_f32_16x16x32_bf16 v[44:47], v[120:123], a[196:199], v[44:47]
    v_mfma_f32_16x16x32_bf16 v[44:47], v[124:127], a[204:207], v[44:47]
    v_lshlrev_b32 v74, 16, v102
    s_waitcnt lgkmcnt(0)
    v_mfma_f32_16x16x32_bf16 v[44:47], v[128:131], a[212:215], v[44:47]
    s_barrier
    v_mfma_f32_16x16x32_bf16 v[44:47], v[132:135], a[220:223], v[44:47]
    ds_read_b128 v[104:107], v14 offset:16384
    v_mfma_f32_16x16x32_bf16 v[40:43], v[132:135], a[216:219], v[40:43]
    ds_read_b128 v[108:111], v14 offset:20480
    v_lshlrev_b32 v75, 16, v102
    v_mfma_f32_16x16x32_bf16 v[40:43], v[128:131], a[208:211], v[40:43]
    ds_read_b128 v[112:115], v14 offset:24576
    v_mfma_f32_16x16x32_bf16 v[40:43], v[124:127], a[200:203], v[40:43]
    ds_read_b128 v[116:119], v14 offset:28672
    v_lshlrev_b32 v76, 16, v103
    v_mfma_f32_16x16x32_bf16 v[40:43], v[120:123], a[192:195], v[40:43]
    s_waitcnt lgkmcnt(2)
    v_mfma_f32_16x16x32_bf16 v[48:51], v[104:107], a[192:195], v[48:51]
    s_add_u32 m0, s73, 97792
    v_lshlrev_b32 v77, 16, v103
    v_mfma_f32_16x16x32_bf16 v[48:51], v[108:111], a[200:203], v[48:51]
    buffer_load_dwordx4 v21, s[44:47], s20 offen offset:512 sc1 lds
    s_waitcnt lgkmcnt(0)
    v_mfma_f32_16x16x32_bf16 v[48:51], v[112:115], a[208:211], v[48:51]
    ds_read_b128 v[120:123], v14 offset:17408
    v_mfma_f32_16x16x32_bf16 v[48:51], v[116:119], a[216:219], v[48:51]
    ds_read_b128 v[124:127], v14 offset:21504
    v_mfma_f32_16x16x32_bf16 v[52:55], v[116:119], a[220:223], v[52:55]
    ds_read_b128 v[128:131], v14 offset:25600
    v_lshlrev_b32 v78, 16, v103
    v_mfma_f32_16x16x32_bf16 v[52:55], v[112:115], a[212:215], v[52:55]
    ds_read_b128 v[132:135], v14 offset:29696
    v_mfma_f32_16x16x32_bf16 v[52:55], v[108:111], a[204:207], v[52:55]
    s_add_u32 m0, s73, 99328
    v_lshlrev_b32 v79, 16, v103
    v_mfma_f32_16x16x32_bf16 v[52:55], v[104:107], a[196:199], v[52:55]
    buffer_load_dwordx4 v21, s[44:47], s21 offen offset:0 sc1 lds
    s_waitcnt lgkmcnt(2)
    v_mfma_f32_16x16x32_bf16 v[36:39], v[120:123], a[228:231], v[36:39]
    buffer_load_dwordx2 v[98:99], v26, s[44:47], s42 offen offset:128 sc1
    s_add_u32 m0, s73, 99840
    v_lshlrev_b32 v80, 16, v102
    v_mfma_f32_16x16x32_bf16 v[36:39], v[124:127], a[236:239], v[36:39]
    buffer_load_dwordx4 v21, s[44:47], s21 offen offset:512 sc1 lds
    s_waitcnt lgkmcnt(0)
    v_mfma_f32_16x16x32_bf16 v[36:39], v[128:131], a[244:247], v[36:39]
    ds_read_b128 v[104:107], v14 offset:18432
    v_mfma_f32_16x16x32_bf16 v[36:39], v[132:135], a[252:255], v[36:39]
    ds_read_b128 v[108:111], v14 offset:22528
    v_mfma_f32_16x16x32_bf16 v[32:35], v[132:135], a[248:251], v[32:35]
    ds_read_b128 v[112:115], v14 offset:26624
    v_lshlrev_b32 v81, 16, v102
    v_mfma_f32_16x16x32_bf16 v[32:35], v[128:131], a[240:243], v[32:35]
    ds_read_b128 v[116:119], v14 offset:30720
    v_mfma_f32_16x16x32_bf16 v[32:35], v[124:127], a[232:235], v[32:35]
    s_add_u32 m0, s73, 101376
    v_lshlrev_b32 v82, 16, v102
    v_mfma_f32_16x16x32_bf16 v[32:35], v[120:123], a[224:227], v[32:35]
    buffer_load_dwordx4 v21, s[44:47], s22 offen offset:0 sc1 lds
    s_waitcnt lgkmcnt(2)
    v_mfma_f32_16x16x32_bf16 v[40:43], v[104:107], a[224:227], v[40:43]
    v_mfma_f32_16x16x32_bf16 v[40:43], v[108:111], a[232:235], v[40:43]
    v_lshlrev_b32 v83, 16, v102
    s_waitcnt lgkmcnt(0)
L_pl_X_7:
    s_cbranch_execz L_wret
    v_mfma_f32_16x16x32_bf16 v[40:43], v[112:115], a[240:243], v[40:43]
    ds_read_b128 v[120:123], v14 offset:19456
    v_mfma_f32_16x16x32_bf16 v[40:43], v[116:119], a[248:251], v[40:43]
    ds_read_b128 v[124:127], v14 offset:23552
    v_mfma_f32_16x16x32_bf16 v[44:47], v[116:119], a[252:255], v[44:47]
    ds_read_b128 v[128:131], v14 offset:27648
    v_lshlrev_b32 v84, 16, v103
    v_mfma_f32_16x16x32_bf16 v[44:47], v[112:115], a[244:247], v[44:47]
    ds_read_b128 v[132:135], v14 offset:31744
    v_mfma_f32_16x16x32_bf16 v[44:47], v[108:111], a[236:239], v[44:47]
    v_lshlrev_b32 v85, 16, v103
    v_mfma_f32_16x16x32_bf16 v[44:47], v[104:107], a[228:231], v[44:47]
    buffer_load_dwordx2 v[100:101], v18, s[44:47], s42 offen offset:0 sc1
    s_waitcnt lgkmcnt(2)
    v_mfma_f32_16x16x32_bf16 v[52:55], v[120:123], a[228:231], v[52:55]
    v_mfma_f32_16x16x32_bf16 v[52:55], v[124:127], a[236:239], v[52:55]
    v_lshlrev_b32 v86, 16, v103
    s_waitcnt lgkmcnt(0)
    v_mfma_f32_16x16x32_bf16 v[52:55], v[128:131], a[244:247], v[52:55]
    s_waitcnt vmcnt(13)
    s_barrier
    v_mfma_f32_16x16x32_bf16 v[52:55], v[132:135], a[252:255], v[52:55]
    ds_read_b128 v[104:107], v14 offset:32768
    v_lshlrev_b32 v87, 16, v103
    v_mfma_f32_16x16x32_bf16 v[48:51], v[132:135], a[248:251], v[48:51]
    ds_read_b128 v[108:111], v14 offset:36864
    v_add_u32 v10, 65536, v10
    v_mfma_f32_16x16x32_bf16 v[48:51], v[128:131], a[240:243], v[48:51]
    ds_read_b128 v[112:115], v14 offset:40960
    v_mfma_f32_16x16x32_bf16 v[48:51], v[124:127], a[232:235], v[48:51]
    ds_read_b128 v[116:119], v14 offset:45056
    v_add_u32 v11, 65536, v11
    v_mfma_f32_16x16x32_bf16 v[48:51], v[120:123], a[224:227], v[48:51]
    v_lshlrev_b32 v27, 16, v27
    s_branch L_Dc
L_idle:
    s_waitcnt vmcnt(0)
    s_barrier
    s_mov_b64 exec, 0
    s_call_b64 s[82:83], L_wc_D
    s_mov_b64 exec, -1
    s_mov_b32 s60, s36
    s_and_b32 s61, s37, 0xffff
    s_mov_b32 s62, 4096
    s_mov_b32 s63, 0x20000
    v_and_b32 v24, 15, v2
    s_lshl_b32 s7, s71, 6
    v_add_u32 v24, s7, v24
    s_and_b32 s8, s3, 1
    s_lshl_b32 s4, s8, 5
    v_add_u32 v25, s4, v24
    v_lshlrev_b32 v26, 3, v25
    v_mul_u32_u24 v25, 1152, v25
    v_bfe_u32 v31, v2, 4, 1
    v_lshl_add_u32 v25, v31, 5, v25
    v_lshrrev_b32 v31, 5, v2
    v_lshl_add_u32 v25, v31, 4, v25
    s_bfe_u32 s7, s2, 0x20003
    s_mul_i32 s7, s7, 288
    s_lshl_b32 s4, s72, 6
    s_add_u32 s4, s4, s7
    v_add_u32 v252, s4, v25
    s_xor_b32 s8, s3, s72
    s_and_b32 s4, s72, 1
    s_lshl1_add_u32 s4, s4, s8
    v_lshl_add_u32 v24, s4, 4, v24
    s_add_u32 s7, s7, 256
    s_cmp_lt_u32 s8, 2
    s_cselect_b32 s7, s7, 0x40000000
    v_lshlrev_b32 v18, 3, v24
    v_mul_u32_u24 v24, 1152, v24
    v_lshrrev_b32 v31, 4, v2
    v_lshl_add_u32 v24, v31, 3, v24
    v_add_u32 v253, s7, v24
    v_lshrrev_b32 v24, 3, v2
    v_and_b32 v25, 7, v2
    v_bfe_u32 v31, v2, 4, 2
    v_lshlrev_b32 v31, 1, v31
    v_xor_b32 v25, v25, v31
    v_lshlrev_b32 v24, 12, v24
    v_lshl_add_u32 v24, v25, 4, v24
    s_mul_i32 s7, s72, 36
    s_bitcmp1_b32 s3, 0
    s_addc_u32 s7, s7, 0
    s_lshl_b32 s7, s7, 17
    s_lshl_b32 s8, s71, 7
    s_add_u32 s7, s7, s8
    v_add_u32 v4, s7, v24
    v_add_u32 v5, 31744, v4
    v_add_u32 v6, 31744, v5
    v_add_u32 v7, 31744, v6
    v_lshrrev_b32 v24, 2, v2
    v_lshlrev_b32 v24, 7, v24
    v_and_b32 v25, 3, v2
    v_lshl_add_u32 v24, v25, 3, v24
    s_and_b32 s7, s73, 8192
    v_add_u32 v24, s7, v24
    v_bfe_u32 v31, v2, 3, 2
    s_and_b32 s7, s3, 1
    s_lshl_b32 s7, s7, 1
    v_xor_b32 v31, s7, v31
    v_lshl_add_u32 v10, v31, 5, v24
    v_xor_b32 v11, 32, v10
    v_and_b32 v24, 15, v2
    v_lshrrev_b32 v25, 4, v2
    v_mul_u32_u24 v25, 17408, v25
    v_lshl_add_u32 v24, v24, 4, v25
    s_mul_i32 s7, s72, 36
    s_and_b32 s8, s3, 1
    s_add_u32 s7, s7, s8
    s_mul_i32 s7, s7, 69632
    s_bfe_u32 s8, s2, 0x20003
    s_lshl_b32 s8, s8, 12
    s_add_u32 s7, s7, s8
    s_add_u32 s7, s7, 12795904
    v_add_u32 v23, s7, v24
    s_xor_b32 s7, s72, 0
    v_lshl_add_u32 v19, s7, 10, v23
    s_xor_b32 s7, s72, 1
    v_lshl_add_u32 v20, s7, 10, v23
    s_xor_b32 s7, s72, 2
    v_lshl_add_u32 v21, s7, 10, v23
    s_xor_b32 s7, s72, 3
    v_lshl_add_u32 v22, s7, 10, v23
    v_lshlrev_b32 v14, 4, v2
    v_add_u32 v14, 98304, v14
    v_add_u32 v1, 0x10000, v14
    s_bitcmp1_b32 s3, 1
    s_cselect_b32 s18, s85, s84
    s_mul_i32 s18, s18, 139264
    s_cselect_b32 s19, s87, s86
    s_mul_i32 s19, s19, 139264
    s_cselect_b32 s20, s89, s88
    s_mul_i32 s20, s20, 139264
    s_cselect_b32 s21, s91, s90
    s_mul_i32 s21, s21, 139264
    s_cselect_b32 s22, s93, s92
    s_mul_i32 s22, s22, 139264
    s_cselect_b32 s23, s95, s94
    s_mul_i32 s23, s23, 139264
    s_cselect_b32 s24, s97, s96
    s_mul_i32 s24, s24, 139264
    s_cselect_b32 s25, s99, s98
    s_mul_i32 s25, s25, 139264
    s_cselect_b32 s26, s101, s100
    s_mul_i32 s26, s26, 139264
    s_sub_u32 s4, s75, 252
    s_mul_i32 s4, s4, 1152
    s_mul_i32 s5, s3, 64
    s_add_u32 s4, s4, s5
    s_add_u32 s4, s4, 896
    s_lshl_b32 s4, s4, 12
    s_add_u32 s4, s4, 384
    v_lshlrev_b32 v24, 10, v2
    buffer_load_dword v255, v24, s[52:55], s4 offen
    s_add_u32 s4, s4, 65536
    buffer_load_dword v255, v24, s[52:55], s4 offen
    s_add_u32 s4, s4, 65536
    buffer_load_dword v255, v24, s[52:55], s4 offen
    s_add_u32 s4, s4, 65536
    buffer_load_dword v255, v24, s[52:55], s4 offen
    s_add_u32 s4, s4, 65536
    s_add_u32 m0, s73, 32768
    s_lshl_b32 s14, s84, 18
    buffer_load_dwordx4 v4, s[52:55], s14 offen offset:0 lds
    buffer_load_dwordx4 v5, s[52:55], s14 offen offset:1024 lds
    buffer_load_dwordx4 v6, s[52:55], s14 offen offset:2048 lds
    buffer_load_dwordx4 v7, s[52:55], s14 offen offset:3072 lds
    s_add_u32 m0, s73, 49152
    s_lshl_b32 s14, s85, 18
    buffer_load_dwordx4 v4, s[52:55], s14 offen offset:0 lds
    buffer_load_dwordx4 v5, s[52:55], s14 offen offset:1024 lds
    buffer_load_dwordx4 v6, s[52:55], s14 offen offset:2048 lds
    buffer_load_dwordx4 v7, s[52:55], s14 offen offset:3072 lds
    s_add_u32 m0, s73, 65536
    s_lshl_b32 s14, s86, 18
    buffer_load_dwordx4 v4, s[52:55], s14 offen offset:0 lds
    buffer_load_dwordx4 v5, s[52:55], s14 offen offset:1024 lds
    buffer_load_dwordx4 v6, s[52:55], s14 offen offset:2048 lds
    buffer_load_dwordx4 v7, s[52:55], s14 offen offset:3072 lds
    s_add_u32 m0, s73, 81920
    s_lshl_b32 s14, s87, 18
    buffer_load_dwordx4 v4, s[52:55], s14 offen offset:0 lds
    buffer_load_dwordx4 v5, s[52:55], s14 offen offset:1024 lds
    buffer_load_dwordx4 v6, s[52:55], s14 offen offset:2048 lds
    buffer_load_dwordx4 v7, s[52:55], s14 offen offset:3072 lds
    s_add_u32 m0, s73, 98304
    s_lshl_b32 s14, s88, 18
    buffer_load_dwordx4 v4, s[52:55], s14 offen offset:0 lds
    buffer_load_dwordx4 v5, s[52:55], s14 offen offset:1024 lds
    buffer_load_dwordx4 v6, s[52:55], s14 offen offset:2048 lds
    buffer_load_dwordx4 v7, s[52:55], s14 offen offset:3072 lds
    s_add_u32 m0, s73, 114688
    s_lshl_b32 s14, s89, 18
    buffer_load_dwordx4 v4, s[52:55], s14 offen offset:0 lds
    buffer_load_dwordx4 v5, s[52:55], s14 offen offset:1024 lds
    buffer_load_dwordx4 v6, s[52:55], s14 offen offset:2048 lds
    buffer_load_dwordx4 v7, s[52:55], s14 offen offset:3072 lds
    s_add_u32 m0, s73, 131072
    s_lshl_b32 s14, s90, 18
    buffer_load_dwordx4 v4, s[52:55], s14 offen offset:0 lds
    buffer_load_dwordx4 v5, s[52:55], s14 offen offset:1024 lds
    buffer_load_dwordx4 v6, s[52:55], s14 offen offset:2048 lds
    buffer_load_dwordx4 v7, s[52:55], s14 offen offset:3072 lds
    s_add_u32 m0, s73, 147456
    s_lshl_b32 s14, s91, 18
    buffer_load_dwordx4 v4, s[52:55], s14 offen offset:0 lds
    buffer_load_dwordx4 v5, s[52:55], s14 offen offset:1024 lds
    buffer_load_dwordx4 v6, s[52:55], s14 offen offset:2048 lds
    buffer_load_dwordx4 v7, s[52:55], s14 offen offset:3072 lds
    s_waitcnt vmcnt(28)
    s_barrier
    ds_read_b64_tr_b16 a[0:1], v10 offset:32768
    ds_read_b64_tr_b16 a[2:3], v10 offset:34816
    ds_read_b64_tr_b16 a[8:9], v10 offset:36864
    ds_read_b64_tr_b16 a[10:11], v10 offset:38912
    ds_read_b64_tr_b16 a[4:5], v11 offset:32768
    ds_read_b64_tr_b16 a[6:7], v11 offset:34816
    ds_read_b64_tr_b16 a[12:13], v11 offset:36864
    ds_read_b64_tr_b16 a[14:15], v11 offset:38912
    s_waitcnt vmcnt(24) lgkmcnt(0)
    s_barrier
    ds_read_b64_tr_b16 a[16:17], v10 offset:49152
    s_add_u32 m0, s73, 32768
    s_lshl_b32 s14, s92, 18
    ds_read_b64_tr_b16 a[18:19], v10 offset:51200
    buffer_load_dwordx4 v4, s[52:55], s14 offen offset:0 lds
    ds_read_b64_tr_b16 a[24:25], v10 offset:53248
    ds_read_b64_tr_b16 a[26:27], v10 offset:55296
    buffer_load_dwordx4 v5, s[52:55], s14 offen offset:1024 lds
    ds_read_b64_tr_b16 a[20:21], v11 offset:49152
    buffer_load_dwordx4 v6, s[52:55], s14 offen offset:2048 lds
    ds_read_b64_tr_b16 a[22:23], v11 offset:51200
    ds_read_b64_tr_b16 a[28:29], v11 offset:53248
    buffer_load_dwordx4 v7, s[52:55], s14 offen offset:3072 lds
    ds_read_b64_tr_b16 a[30:31], v11 offset:55296
    s_waitcnt vmcnt(24) lgkmcnt(0)
    s_barrier
    v_add_u32 v10, 65536, v10
    ds_read_b64_tr_b16 a[32:33], v10 offset:0
    s_add_u32 m0, s73, 49152
    s_lshl_b32 s14, s93, 18
    ds_read_b64_tr_b16 a[34:35], v10 offset:2048
    buffer_load_dwordx4 v4, s[52:55], s14 offen offset:0 lds
    ds_read_b64_tr_b16 a[40:41], v10 offset:4096
    ds_read_b64_tr_b16 a[42:43], v10 offset:6144
    buffer_load_dwordx4 v5, s[52:55], s14 offen offset:1024 lds
    v_add_u32 v11, 65536, v11
    ds_read_b64_tr_b16 a[36:37], v11 offset:0
    buffer_load_dwordx4 v6, s[52:55], s14 offen offset:2048 lds
    ds_read_b64_tr_b16 a[38:39], v11 offset:2048
    ds_read_b64_tr_b16 a[44:45], v11 offset:4096
    buffer_load_dwordx4 v7, s[52:55], s14 offen offset:3072 lds
    ds_read_b64_tr_b16 a[46:47], v11 offset:6144
    s_waitcnt vmcnt(24) lgkmcnt(0)
    s_barrier
    ds_read_b64_tr_b16 a[48:49], v10 offset:16384
    s_add_u32 m0, s73, 65536
    s_lshl_b32 s14, s94, 18
    ds_read_b64_tr_b16 a[50:51], v10 offset:18432
    buffer_load_dwordx4 v4, s[52:55], s14 offen offset:0 lds
    ds_read_b64_tr_b16 a[56:57], v10 offset:20480
    ds_read_b64_tr_b16 a[58:59], v10 offset:22528
    buffer_load_dwordx4 v5, s[52:55], s14 offen offset:1024 lds
    ds_read_b64_tr_b16 a[52:53], v11 offset:16384
    buffer_load_dwordx4 v6, s[52:55], s14 offen offset:2048 lds
    ds_read_b64_tr_b16 a[54:55], v11 offset:18432
    ds_read_b64_tr_b16 a[60:61], v11 offset:20480
    buffer_load_dwordx4 v7, s[52:55], s14 offen offset:3072 lds
    ds_read_b64_tr_b16 a[62:63], v11 offset:22528
    s_waitcnt vmcnt(24) lgkmcnt(0)
    s_barrier
    ds_read_b64_tr_b16 a[64:65], v10 offset:32768
    s_add_u32 m0, s73, 81920
    s_lshl_b32 s14, s95, 18
    ds_read_b64_tr_b16 a[66:67], v10 offset:34816
    buffer_load_dwordx4 v4, s[52:55], s14 offen offset:0 lds
    ds_read_b64_tr_b16 a[72:73], v10 offset:36864
    ds_read_b64_tr_b16 a[74:75], v10 offset:38912
    buffer_load_dwordx4 v5, s[52:55], s14 offen offset:1024 lds
    ds_read_b64_tr_b16 a[68:69], v11 offset:32768
    buffer_load_dwordx4 v6, s[52:55], s14 offen offset:2048 lds
    ds_read_b64_tr_b16 a[70:71], v11 offset:34816
    ds_read_b64_tr_b16 a[76:77], v11 offset:36864
    buffer_load_dwordx4 v7, s[52:55], s14 offen offset:3072 lds
    ds_read_b64_tr_b16 a[78:79], v11 offset:38912
    s_waitcnt vmcnt(24) lgkmcnt(0)
    s_barrier
    ds_read_b64_tr_b16 a[80:81], v10 offset:49152
    s_add_u32 m0, s73, 98304
    s_lshl_b32 s14, s96, 18
    ds_read_b64_tr_b16 a[82:83], v10 offset:51200
    buffer_load_dwordx4 v4, s[52:55], s14 offen offset:0 lds
    ds_read_b64_tr_b16 a[88:89], v10 offset:53248
    ds_read_b64_tr_b16 a[90:91], v10 offset:55296
    buffer_load_dwordx4 v5, s[52:55], s14 offen offset:1024 lds
    ds_read_b64_tr_b16 a[84:85], v11 offset:49152
    buffer_load_dwordx4 v6, s[52:55], s14 offen offset:2048 lds
    ds_read_b64_tr_b16 a[86:87], v11 offset:51200
    ds_read_b64_tr_b16 a[92:93], v11 offset:53248
    buffer_load_dwordx4 v7, s[52:55], s14 offen offset:3072 lds
    ds_read_b64_tr_b16 a[94:95], v11 offset:55296
    s_waitcnt vmcnt(24) lgkmcnt(0)
    s_barrier
    v_add_u32 v10, 65536, v10
    ds_read_b64_tr_b16 a[96:97], v10 offset:0
    s_add_u32 m0, s73, 114688
    s_lshl_b32 s14, s97, 18
    ds_read_b64_tr_b16 a[98:99], v10 offset:2048
    buffer_load_dwordx4 v4, s[52:55], s14 offen offset:0 lds
    ds_read_b64_tr_b16 a[104:105], v10 offset:4096
    ds_read_b64_tr_b16 a[106:107], v10 offset:6144
    buffer_load_dwordx4 v5, s[52:55], s14 offen offset:1024 lds
    v_add_u32 v11, 65536, v11
    ds_read_b64_tr_b16 a[100:101], v11 offset:0
    buffer_load_dwordx4 v6, s[52:55], s14 offen offset:2048 lds
    ds_read_b64_tr_b16 a[102:103], v11 offset:2048
    ds_read_b64_tr_b16 a[108:109], v11 offset:4096
    buffer_load_dwordx4 v7, s[52:55], s14 offen offset:3072 lds
    ds_read_b64_tr_b16 a[110:111], v11 offset:6144
    s_waitcnt vmcnt(24) lgkmcnt(0)
    s_barrier
    ds_read_b64_tr_b16 a[112:113], v10 offset:16384
    s_add_u32 m0, s73, 131072
    s_lshl_b32 s14, s98, 18
    ds_read_b64_tr_b16 a[114:115], v10 offset:18432
    buffer_load_dwordx4 v4, s[52:55], s14 offen offset:0 lds
    ds_read_b64_tr_b16 a[120:121], v10 offset:20480
    ds_read_b64_tr_b16 a[122:123], v10 offset:22528
    buffer_load_dwordx4 v5, s[52:55], s14 offen offset:1024 lds
    ds_read_b64_tr_b16 a[116:117], v11 offset:16384
    buffer_load_dwordx4 v6, s[52:55], s14 offen offset:2048 lds
    ds_read_b64_tr_b16 a[118:119], v11 offset:18432
    ds_read_b64_tr_b16 a[124:125], v11 offset:20480
    buffer_load_dwordx4 v7, s[52:55], s14 offen offset:3072 lds
    ds_read_b64_tr_b16 a[126:127], v11 offset:22528
    s_waitcnt vmcnt(24) lgkmcnt(0)
    s_barrier
    v_add_u32 v10, -131072, v10
    ds_read_b64_tr_b16 a[128:129], v10 offset:32768
    s_add_u32 m0, s73, 147456
    s_lshl_b32 s14, s99, 18
    ds_read_b64_tr_b16 a[130:131], v10 offset:34816
    buffer_load_dwordx4 v4, s[52:55], s14 offen offset:0 lds
    ds_read_b64_tr_b16 a[136:137], v10 offset:36864
    ds_read_b64_tr_b16 a[138:139], v10 offset:38912
    buffer_load_dwordx4 v5, s[52:55], s14 offen offset:1024 lds
    v_add_u32 v11, -131072, v11
    ds_read_b64_tr_b16 a[132:133], v11 offset:32768
    buffer_load_dwordx4 v6, s[52:55], s14 offen offset:2048 lds
    ds_read_b64_tr_b16 a[134:135], v11 offset:34816
    ds_read_b64_tr_b16 a[140:141], v11 offset:36864
    buffer_load_dwordx4 v7, s[52:55], s14 offen offset:3072 lds
    ds_read_b64_tr_b16 a[142:143], v11 offset:38912
    s_waitcnt vmcnt(24) lgkmcnt(0)
    s_barrier
    ds_read_b64_tr_b16 a[144:145], v10 offset:49152
    s_add_u32 m0, s73, 0
    s_lshl_b32 s14, s100, 18
    ds_read_b64_tr_b16 a[146:147], v10 offset:51200
    buffer_load_dwordx4 v4, s[52:55], s14 offen offset:0 lds
    ds_read_b64_tr_b16 a[152:153], v10 offset:53248
    ds_read_b64_tr_b16 a[154:155], v10 offset:55296
    buffer_load_dwordx4 v5, s[52:55], s14 offen offset:1024 lds
    ds_read_b64_tr_b16 a[148:149], v11 offset:49152
    buffer_load_dwordx4 v6, s[52:55], s14 offen offset:2048 lds
    ds_read_b64_tr_b16 a[150:151], v11 offset:51200
    ds_read_b64_tr_b16 a[156:157], v11 offset:53248
    buffer_load_dwordx4 v7, s[52:55], s14 offen offset:3072 lds
    ds_read_b64_tr_b16 a[158:159], v11 offset:55296
    s_waitcnt vmcnt(24) lgkmcnt(0)
    s_barrier
    v_add_u32 v10, 65536, v10
    ds_read_b64_tr_b16 a[160:161], v10 offset:0
    s_add_u32 m0, s73, 16384
    s_lshl_b32 s14, s101, 18
    ds_read_b64_tr_b16 a[162:163], v10 offset:2048
    buffer_load_dwordx4 v4, s[52:55], s14 offen offset:0 lds
    ds_read_b64_tr_b16 a[168:169], v10 offset:4096
    ds_read_b64_tr_b16 a[170:171], v10 offset:6144
    buffer_load_dwordx4 v5, s[52:55], s14 offen offset:1024 lds
    v_add_u32 v11, 65536, v11
    ds_read_b64_tr_b16 a[164:165], v11 offset:0
    buffer_load_dwordx4 v6, s[52:55], s14 offen offset:2048 lds
    ds_read_b64_tr_b16 a[166:167], v11 offset:2048
    ds_read_b64_tr_b16 a[172:173], v11 offset:4096
    buffer_load_dwordx4 v7, s[52:55], s14 offen offset:3072 lds
    ds_read_b64_tr_b16 a[174:175], v11 offset:6144
    s_waitcnt vmcnt(24) lgkmcnt(0)
    s_barrier
    ds_read_b64_tr_b16 a[176:177], v10 offset:16384
    ds_read_b64_tr_b16 a[178:179], v10 offset:18432
    ds_read_b64_tr_b16 a[184:185], v10 offset:20480
    ds_read_b64_tr_b16 a[186:187], v10 offset:22528
    ds_read_b64_tr_b16 a[180:181], v11 offset:16384
    ds_read_b64_tr_b16 a[182:183], v11 offset:18432
    ds_read_b64_tr_b16 a[188:189], v11 offset:20480
    ds_read_b64_tr_b16 a[190:191], v11 offset:22528
    s_waitcnt vmcnt(20) lgkmcnt(0)
    s_barrier
    ds_read_b64_tr_b16 a[192:193], v10 offset:32768
    ds_read_b64_tr_b16 a[194:195], v10 offset:34816
    ds_read_b64_tr_b16 a[200:201], v10 offset:36864
    ds_read_b64_tr_b16 a[202:203], v10 offset:38912
    ds_read_b64_tr_b16 a[196:197], v11 offset:32768
    ds_read_b64_tr_b16 a[198:199], v11 offset:34816
    ds_read_b64_tr_b16 a[204:205], v11 offset:36864
    ds_read_b64_tr_b16 a[206:207], v11 offset:38912
    s_waitcnt vmcnt(16) lgkmcnt(0)
    s_barrier
    ds_read_b64_tr_b16 a[208:209], v10 offset:49152
    ds_read_b64_tr_b16 a[210:211], v10 offset:51200
    ds_read_b64_tr_b16 a[216:217], v10 offset:53248
    ds_read_b64_tr_b16 a[218:219], v10 offset:55296
    ds_read_b64_tr_b16 a[212:213], v11 offset:49152
    ds_read_b64_tr_b16 a[214:215], v11 offset:51200
    ds_read_b64_tr_b16 a[220:221], v11 offset:53248
    ds_read_b64_tr_b16 a[222:223], v11 offset:55296
    s_waitcnt vmcnt(12) lgkmcnt(0)
    s_barrier
    v_add_u32 v10, 65536, v10
    ds_read_b64_tr_b16 a[224:225], v10 offset:0
    ds_read_b64_tr_b16 a[226:227], v10 offset:2048
    ds_read_b64_tr_b16 a[232:233], v10 offset:4096
    ds_read_b64_tr_b16 a[234:235], v10 offset:6144
    v_add_u32 v11, 65536, v11
    ds_read_b64_tr_b16 a[228:229], v11 offset:0
    ds_read_b64_tr_b16 a[230:231], v11 offset:2048
    ds_read_b64_tr_b16 a[236:237], v11 offset:4096
    ds_read_b64_tr_b16 a[238:239], v11 offset:6144
    s_waitcnt vmcnt(8) lgkmcnt(0)
    s_barrier
    ds_read_b64_tr_b16 a[240:241], v10 offset:16384
    ds_read_b64_tr_b16 a[242:243], v10 offset:18432
    ds_read_b64_tr_b16 a[248:249], v10 offset:20480
    ds_read_b64_tr_b16 a[250:251], v10 offset:22528
    ds_read_b64_tr_b16 a[244:245], v11 offset:16384
    ds_read_b64_tr_b16 a[246:247], v11 offset:18432
    ds_read_b64_tr_b16 a[252:253], v11 offset:20480
    ds_read_b64_tr_b16 a[254:255], v11 offset:22528
    s_waitcnt lgkmcnt(0)
    s_barrier
    v_add_u32 v10, -131072, v10
    v_add_u32 v11, -131072, v11
    s_mov_b64 exec, 0
    s_call_b64 s[82:83], L_wc_D
    s_mov_b64 exec, -1
    s_bfe_u32 s4, s2, 0x20003
    s_lshl2_add_u32 s4, s72, s4
    s_lshl_b32 s4, s4, 3
    s_lshr_b32 s5, s2, 4
    s_and_b32 s5, s5, 6
    s_add_u32 s4, s4, s5
    s_and_b32 s5, s2, 1
    s_add_u32 s4, s4, s5
    s_lshl_b32 s4, s4, 7
    s_add_u32 s4, s4, 12566528
    v_lshl_add_u32 v28, v2, 2, s4
    s_cmp_eq_u32 s3, 0
    s_cselect_b32 s4, 18, 0
    v_cmp_gt_u32 vcc, s4, v2
    v_mov_b32 v13, 0x40000000
    s_nop 0
    v_cndmask_b32 v28, v13, v28, vcc
    v_mov_b32 v13, s68
    v_cndmask_b32 v13, 0, v13, vcc
    s_mov_b32 s5, 0
L_iw:
    s_sleep 16
    v_mov_b32 v29, 0
    buffer_atomic_add v29, v28, s[44:47], 0 offen sc0 sc1
    s_waitcnt vmcnt(0)
    v_cmp_eq_u32 vcc, 0, v13
    s_nop 1
    s_mov_b64 s[6:7], vcc
    v_cmp_ne_u32 vcc, v13, v29
    s_nop 1
    s_andn2_b64 s[8:9], exec, vcc
    s_andn2_b64 s[8:9], s[8:9], s[6:7]
    s_cbranch_scc1 L_ix
    s_cmp_eq_u64 s[6:7], exec
    s_cbranch_scc1 L_ix
    s_add_u32 s5, s5, 1
    s_cmp_lt_u32 s5, 100000
    s_cbranch_scc1 L_iw
L_ix:
    v_mov_b32 v29, 0
    buffer_atomic_add v29, v28, s[44:47], 0 offen sc0 sc1
    s_branch L_DX
L_end:
.section .rodata,"a"
.p2align 6
.amdhsa_kernel recurrent_scan__ssm_conv_h3__mixer_token_mlp__prompt_kernel
  .amdhsa_next_free_vgpr 512
  .amdhsa_next_free_sgpr 102
  .amdhsa_accum_offset 256
  .amdhsa_group_segment_fixed_size 0
  .amdhsa_kernarg_size 112
  .amdhsa_user_sgpr_count 2
  .amdhsa_user_sgpr_kernarg_segment_ptr 1
  .amdhsa_system_sgpr_workgroup_id_x 1
  .amdhsa_float_denorm_mode_32 3
.end_amdhsa_kernel
```

```asm
; @launch grid=(256,1,1) block=(256,1,1) lds=163840
.amdgcn_target "amdgcn-amd-amdhsa--gfx950"
.text
.globl recurrent_scan__ssm_conv_h3__mixer_token_mlp__prompt_kernel
.p2align 8
.type recurrent_scan__ssm_conv_h3__mixer_token_mlp__prompt_kernel,@function
recurrent_scan__ssm_conv_h3__mixer_token_mlp__prompt_kernel:
    s_cmp_lt_u32 s2, 256
    s_cbranch_scc0 L_exit
    s_load_dwordx2 s[56:57], s[0:1], 0
    s_load_dwordx2 s[48:49], s[0:1], 8
    s_load_dwordx2 s[52:53], s[0:1], 16
    s_load_dwordx2 s[60:61], s[0:1], 24
    s_load_dwordx16 s[16:31], s[0:1], 0
    s_load_dwordx8 s[32:39], s[0:1], 64
    s_load_dwordx4 s[40:43], s[0:1], 96
    s_memrealtime s[12:13]
    v_lshrrev_b32 v1, 6, v0
    v_and_b32 v2, 63, v0
    s_getpc_b64 s[6:7]
L_pc:
    s_lshr_b32 s4, s2, 1
    s_and_b32 s4, s4, 124
    v_add_u32 v22, s4, v1
    v_lshl_add_u32 v22, v2, 7, v22
    v_lshlrev_b32 v22, 7, v22
    v_min_u32 v22, L_end-L_pc-4, v22
    s_mov_b64 exec, 31
    global_load_dword v255, v22, s[6:7]
    s_mov_b64 exec, -1
    v_readfirstlane_b32 s3, v1
    s_and_b32 s4, s2, 7
    s_lshr_b32 s5, s2, 3
    s_lshl_b32 s4, s4, 5
    s_add_u32 s68, s4, s5
    v_lshrrev_b32 v3, 5, v0
    v_and_b32 v4, 31, v0
    v_mul_u32_u24 v5, 1152, v3
    v_mad_u32_u24 v5, v4, 12, v5
    s_mul_i32 s15, s68, 9216
    s_mul_i32 s4, s3, 3072
    s_add_u32 s5, s4, s15
    s_sub_u32 s5, s5, 3456
    v_lshlrev_b32 v6, 4, v2
    v_add_u32 v7, s5, v6
    v_add_u32 v58, 1024, v7
    s_add_u32 s4, s4, 114688
    s_lshl_b32 s5, s3, 11
    s_add_u32 s11, s5, s15
    s_add_u32 s5, s5, 127360
    s_cmp_lt_u32 s2, 216
    s_cselect_b32 s9, 0, 106496
    s_sub_u32 s4, s4, s9
    s_sub_u32 s5, s5, s9
    s_mov_b32 m0, s4
    s_mov_b32 s58, 2359296
    s_mov_b32 s59, 0x20000
    s_mov_b32 s50, 2359296
    s_mov_b32 s51, 0x20000
    s_mov_b32 s54, 2359296
    s_mov_b32 s55, 0x20000
    s_mov_b32 s62, 4608
    s_mov_b32 s63, 0x20000
    v_lshlrev_b32 v59, 3, v0
    s_movk_i32 s10, 4096
    v_lshlrev_b32 v91, 3, v2
    v_or_b32 v22, s2, v0
    v_lshlrev_b32 v22, 8, v22
    s_mov_b32 s66, 256
    s_mov_b32 s67, 0x20000
    s_waitcnt lgkmcnt(0)
    buffer_load_dwordx3 v[8:10], v5, s[56:59], s15 offen offset:0
    buffer_load_dwordx3 v[12:14], v5, s[56:59], s15 offen offset:384
    buffer_load_dwordx3 v[16:18], v5, s[56:59], s15 offen offset:768
    s_mov_b32 s64, s40
    s_and_b32 s65, s41, 0xffff
    s_or_b32 s12, s12, 1
    v_mov_b32 v23, s12
    buffer_store_dword v23, v22, s[64:67], 0 offen sc1
    buffer_load_dwordx4 v7, s[48:51], 0 offen lds
    s_add_u32 m0, s4, 1024
    s_cmp_eq_u32 s3, 3
    buffer_load_dwordx4 v58, s[48:51], 0 offen lds
    buffer_load_dwordx4 v58, s[48:51], 0 offen offset:1024 lds
    s_cbranch_scc1 L_xld
L_nox:
    s_mov_b32 m0, s5
    buffer_load_dwordx2 v[98:99], v59, s[60:63], 0 offen
    buffer_load_dwordx4 v6, s[52:55], s11 offen lds
    buffer_load_dwordx4 v6, s[52:55], s11 offen offset:1024 lds
    buffer_load_dwordx2 v[100:101], v59, s[60:63], 0 offen offset:2048
    buffer_load_dwordx2 v[102:103], v59, s[60:63], s10 offen
    s_mov_b32 s44, s42
    s_and_b32 s45, s43, 0xffff
    s_mov_b32 s46, 42352640
    s_mov_b32 s47, 0x20000
    s_and_b32 s5, s2, 7
    s_lshr_b32 s6, s2, 3
    s_lshr_b32 s7, s6, 2
    s_lshr_b32 s8, s3, 1
    s_lshl1_add_u32 s9, s7, s8
    s_cmp_ge_u32 s9, 10
    s_addc_u32 s14, s9, 0
    s_cmp_ge_u32 s9, 3
    s_addc_u32 s14, s14, 0
    s_lshl3_add_u32 s8, s8, 3
    s_cmp_eq_u32 s7, 7
    s_cselect_b32 s14, s8, s14
    s_and_b32 s4, s5, 1
    s_lshl4_add_u32 s71, s4, s14
    s_lshr_b32 s13, s5, 1
    s_mov_b32 s72, s13
    s_lshl_b32 s73, s3, 12
    s_mov_b32 s52, s34
    s_and_b32 s53, s35, 0xffff
    s_mov_b32 s54, 18874368
    s_mov_b32 s55, 0x20000
    s_cmp_lt_u32 s6, 27
    s_cbranch_scc0 L_aux
    s_branch L_org
L_exit:
    s_endpgm
L_xld:
    s_mov_b64 exec, 0xffffff
    buffer_load_dwordx4 v58, s[48:51], 0 offen offset:2048 lds
    s_mov_b64 exec, -1
    s_mov_b32 m0, s5
    s_nop 0
    buffer_load_dwordx4 v6, s[52:55], s11 offen offset:2048 lds
    s_branch L_nox
L_nw_G:
    s_mov_b32 s5, 0
L_nl_G:
    buffer_load_dword v45, v54, s[64:67], 0 offen sc1
    s_waitcnt vmcnt(0)
    v_readfirstlane_b32 s68, v45
    s_nop 1
    s_cmp_lg_u32 s68, 0
    s_cbranch_scc1 L_ng_G
    s_add_u32 s5, s5, 1
    s_cmp_lt_u32 s5, 100000
    s_cbranch_scc1 L_nl_G
    s_branch L_ng_G
L_rs_p1G:
    s_mov_b32 s5, 0
L_rt_p1G:
    s_mov_b64 exec, vcc
    v_mov_b32 v29, 0
    buffer_atomic_add v29, v28, s[44:47], 0 offen sc0 sc1
    s_waitcnt vmcnt(0)
    v_cmp_ne_u32 vcc, v12, v29
    s_cbranch_vccz L_rx_p1G
    s_add_u32 s5, s5, 1
    s_cmp_lt_u32 s5, 100000
    s_cbranch_scc1 L_rt_p1G
L_rx_p1G:
    s_mov_b64 exec, -1
    s_branch L_ok_p1G
L_rs_p5:
    s_mov_b32 s5, 0
L_rt_p5:
    s_mov_b64 exec, vcc
    buffer_load_dword v29, v28, s[44:47], 0 offen sc1
    s_waitcnt vmcnt(0)
    v_cmp_ne_u32 vcc, s68, v29
    s_cbranch_vccz L_rx_p5
    s_add_u32 s5, s5, 1
    s_cmp_lt_u32 s5, 100000
    s_cbranch_scc1 L_rt_p5
L_rx_p5:
    s_mov_b64 exec, -1
    s_branch L_ok_p5
L_nw_X:
    s_mov_b32 s5, 0
L_nl_X:
    buffer_load_dword v45, v54, s[64:67], 0 offen sc1
    s_waitcnt vmcnt(0)
    v_readfirstlane_b32 s68, v45
    s_nop 1
    s_cmp_lg_u32 s68, 0
    s_cbranch_scc1 L_ng_X
    s_add_u32 s5, s5, 1
    s_cmp_lt_u32 s5, 100000
    s_cbranch_scc1 L_nl_X
    s_branch L_ng_X
L_rs_p1X:
    s_mov_b32 s5, 0
L_rt_p1X:
    s_mov_b64 exec, vcc
    v_mov_b32 v29, 0
    buffer_atomic_add v29, v28, s[44:47], 0 offen sc0 sc1
    s_waitcnt vmcnt(0)
    v_cmp_ne_u32 vcc, s68, v29
    s_cbranch_vccz L_rx_p1X
    s_add_u32 s5, s5, 1
    s_cmp_lt_u32 s5, 100000
    s_cbranch_scc1 L_rt_p1X
L_rx_p1X:
    s_mov_b64 exec, -1
    s_branch L_ok_p1X
L_rs_p2G:
    s_mov_b32 s5, 0
L_rt_p2G:
    s_mov_b64 exec, vcc
    v_mov_b32 v16, 0
    buffer_atomic_add v16, v15, s[44:47], 0 offen sc0 sc1
    s_waitcnt vmcnt(0)
    v_cmp_ne_u32 vcc, v13, v16
    s_cbranch_vccz L_rx_p2G
    s_add_u32 s5, s5, 1
    s_cmp_lt_u32 s5, 100000
    s_cbranch_scc1 L_rt_p2G
L_rx_p2G:
    s_mov_b64 exec, -1
    s_branch L_ok_p2G
L_xs_a:
    s_mov_b32 s5, 0
L_xt_a:
    v_mov_b32 v187, 0
    buffer_atomic_add v187, v137, s[44:47], 0 offen offset:12 sc0 sc1
    s_waitcnt vmcnt(0)
    v_cmp_ne_u32 vcc, v138, v187
    s_cbranch_vccz L_xr_a
    s_add_u32 s5, s5, 1
    s_cmp_lt_u32 s5, 100000
    s_cbranch_scc1 L_xt_a
L_xr_a:
    buffer_load_dwordx4 v[40:43], v136, s[44:47], s34 offen offset:0 sc1
    buffer_load_dwordx4 v[44:47], v136, s[44:47], s34 offen offset:1024 sc1
    buffer_load_dwordx4 v[48:51], v136, s[44:47], s34 offen offset:2048 sc1
    s_waitcnt vmcnt(0)
    v_bitop3_b32 v43, v43, v47, s68 bitop3:0x7e
    v_bitop3_b32 v43, v43, v51, s68 bitop3:0xf6
    v_cmp_ne_u32 vcc, 0, v43
    s_cbranch_vccz L_xo_a
    s_add_u32 s5, s5, 1
    s_cmp_lt_u32 s5, 100000
    s_cbranch_scc1 L_xt_a
    s_branch L_xo_a
L_as_b:
    s_mov_b32 s5, 0
L_at_b:
    v_mov_b32 v141, 0
    buffer_atomic_add v141, v139, s[44:47], s11 offen offset:2060 sc0 sc1
    s_waitcnt vmcnt(0)
    v_cmp_ne_u32 vcc, v140, v141
    s_cbranch_vccz L_ao_b
    s_add_u32 s5, s5, 1
    s_cmp_lt_u32 s5, 100000
    s_cbranch_scc1 L_at_b
    s_branch L_ao_b
L_xs_b:
    s_mov_b32 s5, 0
L_xt_b:
    buffer_load_dwordx4 v[56:59], v136, s[44:47], s11 offen offset:0 sc1
    buffer_load_dwordx4 v[60:63], v136, s[44:47], s11 offen offset:1024 sc1
    buffer_load_dwordx4 v[64:67], v136, s[44:47], s11 offen offset:2048 sc1
    s_waitcnt vmcnt(0)
    v_bitop3_b32 v59, v59, v63, s68 bitop3:0x7e
    v_bitop3_b32 v59, v59, v67, s68 bitop3:0xf6
    v_cmp_ne_u32 vcc, 0, v59
    s_cbranch_vccz L_xo_b
    s_add_u32 s5, s5, 1
    s_cmp_lt_u32 s5, 100000
    s_cbranch_scc1 L_xt_b
    s_branch L_xo_b
L_xs_z:
    s_mov_b32 s5, 0
L_xt_z:
    buffer_load_dwordx4 v[72:75], v136, s[44:47], s12 offen offset:0 sc1
    buffer_load_dwordx4 v[76:79], v136, s[44:47], s12 offen offset:1024 sc1
    buffer_load_dwordx4 v[80:83], v136, s[44:47], s12 offen offset:2048 sc1
    s_waitcnt vmcnt(0)
    v_bitop3_b32 v75, v75, v79, s68 bitop3:0x7e
    v_bitop3_b32 v75, v75, v83, s68 bitop3:0xf6
    v_cmp_ne_u32 vcc, 0, v75
    s_cbranch_vccz L_xo_z
    s_add_u32 s5, s5, 1
    s_cmp_lt_u32 s5, 100000
    s_cbranch_scc1 L_xt_z
    s_branch L_xo_z
L_rs_p3:
    s_mov_b32 s5, 0
L_rt_p3:
    s_mov_b64 exec, vcc
    buffer_load_dword v189, v188, s[44:47], 0 offen sc1
    s_waitcnt vmcnt(0)
    v_cmp_ne_u32 vcc, s68, v189
    s_cbranch_vccz L_rx_p3
    s_add_u32 s5, s5, 1
    s_cmp_lt_u32 s5, 100000
    s_cbranch_scc1 L_rt_p3
L_rx_p3:
    s_mov_b64 exec, -1
    s_branch L_ok_p3
L_xs_8:
    s_mov_b32 s5, 0
L_xt_8:
    v_mov_b32 v187, 0
    buffer_atomic_add v187, v137, s[44:47], 0 offen offset:12 sc0 sc1
    s_waitcnt vmcnt(0)
    v_cmp_ne_u32 vcc, v138, v187
    s_cbranch_vccz L_xr_8
    s_add_u32 s5, s5, 1
    s_cmp_lt_u32 s5, 100000
    s_cbranch_scc1 L_xt_8
L_xr_8:
    buffer_load_dwordx4 v[204:207], v136, s[44:47], s35 offen offset:0 sc1
    buffer_load_dwordx4 v[208:211], v136, s[44:47], s35 offen offset:1024 sc1
    buffer_load_dwordx4 v[212:215], v136, s[44:47], s35 offen offset:2048 sc1
    buffer_load_dwordx4 v[216:219], v136, s[44:47], s35 offen offset:3072 sc1
    s_waitcnt vmcnt(0)
    v_bitop3_b32 v207, v207, v211, s36 bitop3:0x7e
    v_bitop3_b32 v207, v207, v215, s36 bitop3:0xf6
    v_bitop3_b32 v207, v207, v219, s36 bitop3:0xf6
    v_cmp_ne_u32 vcc, 0, v207
    s_cbranch_vccz L_xo_8
    s_add_u32 s5, s5, 1
    s_cmp_lt_u32 s5, 100000
    s_cbranch_scc1 L_xt_8
    s_branch L_xo_8
L_rs_p2X:
    s_mov_b32 s5, 0
L_rt_p2X:
    s_mov_b64 exec, vcc
    v_mov_b32 v29, 0
    buffer_atomic_add v29, v28, s[44:47], 0 offen sc0 sc1
    s_waitcnt vmcnt(0)
    v_cmp_ne_u32 vcc, v13, v29
    s_cbranch_vccz L_rx_p2X
    s_add_u32 s5, s5, 1
    s_cmp_lt_u32 s5, 100000
    s_cbranch_scc1 L_rt_p2X
L_rx_p2X:
    s_mov_b64 exec, -1
    s_branch L_ok_p2X
L_wc_G:
    s_cmp_eq_u32 s3, 0
    s_cbranch_scc1 L_pl_G_0
    s_cmp_eq_u32 s3, 1
    s_cbranch_scc1 L_pl_G_1
    s_cmp_eq_u32 s3, 2
    s_cbranch_scc1 L_pl_G_2
    s_branch L_pl_G_3
L_wc_X:
    s_cmp_eq_u32 s3, 0
    s_cbranch_scc1 L_pl_X_0
    s_cmp_eq_u32 s3, 1
    s_cbranch_scc1 L_pl_X_1
    s_cmp_eq_u32 s3, 2
    s_cbranch_scc1 L_pl_X_2
    s_branch L_pl_X_3
L_wc_D:
    s_cmp_eq_u32 s3, 0
    s_cbranch_scc1 L_pl_D_0
    s_cmp_eq_u32 s3, 1
    s_cbranch_scc1 L_pl_D_1
    s_cmp_eq_u32 s3, 2
    s_cbranch_scc1 L_pl_D_2
    s_branch L_wret
L_wret:
    s_setpc_b64 s[82:83]
.p2align 12
L_org:
    s_mul_i32 s7, s6, 21846
    s_lshr_b32 s7, s7, 16
    s_mul_i32 s8, s7, 3
    s_sub_u32 s12, s6, s8
    s_mul_i32 s8, s13, 9
    s_add_u32 s69, s8, s7
    s_lshl1_add_u32 s70, s12, s4
    s_mul_i32 s8, s69, 6
    s_add_u32 s75, s8, s70
    s_mov_b32 s48, s30
    s_and_b32 s49, s31, 0xffff
    s_mov_b32 s50, 18874368
    s_mov_b32 s51, 0x20000
    s_add_u32 s12, s12, s7
    s_mul_i32 s8, s12, 21846
    s_lshr_b32 s8, s8, 16
    s_mul_i32 s8, s8, 3
    s_sub_u32 s12, s12, s8
    s_mul_i32 s4, s4, 16
    s_mul_i32 s7, s12, 65538
    s_lshr_b32 s7, s7, 16
    s_mul_i32 s7, s7, 1
    s_add_u32 s5, s4, 0
    s_add_u32 s18, s7, s5
    s_add_u32 s8, s5, 3
    s_add_u32 s19, s18, 1
    s_cmp_eq_u32 s19, s8
    s_cselect_b32 s19, s5, s19
    s_add_u32 s20, s19, 1
    s_cmp_eq_u32 s20, s8
    s_cselect_b32 s20, s5, s20
    s_mul_i32 s7, s12, 65538
    s_lshr_b32 s7, s7, 16
    s_mul_i32 s7, s7, 1
    s_add_u32 s5, s4, 3
    s_add_u32 s21, s7, s5
    s_add_u32 s8, s5, 3
    s_add_u32 s22, s21, 1
    s_cmp_eq_u32 s22, s8
    s_cselect_b32 s22, s5, s22
    s_add_u32 s23, s22, 1
    s_cmp_eq_u32 s23, s8
    s_cselect_b32 s23, s5, s23
    s_mul_i32 s7, s12, 87384
    s_lshr_b32 s7, s7, 16
    s_mul_i32 s7, s7, 1
    s_add_u32 s5, s4, 6
    s_add_u32 s24, s7, s5
    s_add_u32 s8, s5, 4
    s_add_u32 s25, s24, 1
    s_cmp_eq_u32 s25, s8
    s_cselect_b32 s25, s5, s25
    s_add_u32 s26, s25, 1
    s_cmp_eq_u32 s26, s8
    s_cselect_b32 s26, s5, s26
    s_add_u32 s27, s26, 1
    s_cmp_eq_u32 s27, s8
    s_cselect_b32 s27, s5, s27
    s_mul_i32 s7, s12, 131076
    s_lshr_b32 s7, s7, 16
    s_mul_i32 s7, s7, 1
    s_add_u32 s5, s4, 10
    s_add_u32 s76, s7, s5
    s_add_u32 s8, s5, 6
    s_add_u32 s77, s76, 1
    s_cmp_eq_u32 s77, s8
    s_cselect_b32 s77, s5, s77
    s_add_u32 s78, s77, 1
    s_cmp_eq_u32 s78, s8
    s_cselect_b32 s78, s5, s78
    s_add_u32 s79, s78, 1
    s_cmp_eq_u32 s79, s8
    s_cselect_b32 s79, s5, s79
    s_add_u32 s80, s79, 1
    s_cmp_eq_u32 s80, s8
    s_cselect_b32 s80, s5, s80
    s_add_u32 s81, s80, 1
    s_cmp_eq_u32 s81, s8
    s_cselect_b32 s81, s5, s81
    v_lshrrev_b32 v24, 4, v2
    v_and_b32 v25, 15, v2
    v_lshlrev_b32 v26, 1, v24
    v_xor_b32 v25, v25, v26
    v_mul_u32_u24 v24, 9216, v24
    v_lshl_add_u32 v24, v25, 4, v24
    s_mul_i32 s7, s3, 147456
    s_lshl_b32 s8, s69, 8
    s_add_u32 s7, s7, s8
    v_add_u32 v148, s7, v24
    v_add_u32 v149, 35840, v148
    v_xor_b32 v24, 128, v148
    v_add_u32 v150, 71680, v24
    v_add_u32 v151, 35840, v150
    s_mov_b32 s9, 144896
    s_mov_b32 s11, 114688
    v_mul_u32_u24 v48, 1216, v3
    v_mad_u32_u24 v48, v4, 12, v48
    v_add_u32 v48, s9, v48
    v_mov_b32 v47, 0x40000000
    v_lshlrev_b32 v3, 3, v3
    s_lshl_b32 s5, s68, 6
    s_add_u32 s5, s5, 12386304
    v_cmp_eq_u32 vcc, 0, v4
    s_nop 1
    v_cndmask_b32 v49, v47, v3, vcc
    v_lshrrev_b32 v5, 4, v0
    v_and_b32 v4, 3, v2
    v_lshlrev_b32 v4, 3, v4
    v_lshl_add_u32 v5, v5, 5, v4
    v_bfe_u32 v6, v2, 2, 2
    v_mul_u32_u24 v4, 1216, v6
    v_mul_u32_u24 v6, 1152, v6
    v_add3_u32 v50, v4, v5, s9
    v_add3_u32 v51, v6, v5, s11
    s_mul_i32 s4, s3, 2176
    v_add_u32 v55, s4, v51
    v_lshlrev_b32 v52, 4, v0
    s_add_u32 s7, s15, 4096
    s_add_u32 s8, s15, 8192
    s_cmp_eq_u32 s3, 0
    s_cselect_b32 s8, s8, 0x40000000
    v_add_u32 v53, 2359296, v52
    v_mov_b32 v54, 0
    v_add_u32 v4, 0, v52
    v_lshrrev_b32 v5, 7, v4
    v_mul_u32_u24 v6, 9363, v5
    v_lshrrev_b32 v6, 16, v6
    v_mad_i32_i24 v5, v6, -7, v5
    v_cmp_lt_u32 vcc, 2, v5
    s_nop 1
    v_addc_co_u32 v6, vcc, 0, v6, vcc
    v_lshl_add_u32 v93, v6, 7, v4
    v_add_u32 v4, 4096, v52
    v_lshrrev_b32 v5, 7, v4
    v_mul_u32_u24 v6, 9363, v5
    v_lshrrev_b32 v6, 16, v6
    v_mad_i32_i24 v5, v6, -7, v5
    v_cmp_lt_u32 vcc, 2, v5
    s_nop 1
    v_addc_co_u32 v6, vcc, 0, v6, vcc
    v_lshl_add_u32 v94, v6, 7, v4
    v_add_u32 v4, 8192, v52
    v_lshrrev_b32 v5, 7, v4
    v_mul_u32_u24 v6, 9363, v5
    v_lshrrev_b32 v6, 16, v6
    v_mad_i32_i24 v5, v6, -7, v5
    v_cmp_lt_u32 vcc, 2, v5
    s_nop 1
    v_addc_co_u32 v6, vcc, 0, v6, vcc
    v_lshl_add_u32 v95, v6, 7, v4
    s_mul_i32 s10, s68, 11264
    s_add_u32 s10, s10, 36585472
    s_cmp_eq_u32 s3, 0
    s_cselect_b32 s83, s10, 0x40000000
    s_add_u32 s7, s10, 2883584
    s_add_u32 s8, s83, 2883584
    s_mul_i32 s4, s3, 1028
    s_sub_u32 s4, 8204, s4
    v_add_u32 v90, s4, v53
    s_bfe_u32 s6, s68, 0x20001
    s_lshl_b32 s6, s6, 6
    s_lshr_b32 s9, s68, 3
    s_lshl1_add_u32 s6, s9, s6
    s_and_b32 s9, s68, 1
    s_add_u32 s6, s6, s9
    s_lshl_b32 s4, s6, 2
    s_add_u32 s4, s4, 12533760
    v_lshl_add_u32 v1, v0, 10, s4
    s_lshl_b32 s4, s68, 2
    s_add_u32 s4, s4, 12599296
    v_lshl_add_u32 v46, v0, 10, s4
    v_cmp_gt_u32 vcc, 8, v0
    s_nop 1
    v_cndmask_b32 v1, v47, v1, vcc
    v_cmp_gt_u32 vcc, 4, v0
    s_nop 1
    v_cndmask_b32 v46, v47, v46, vcc
    s_waitcnt vmcnt(9)
    v_and_b32 v21, 0xffff0000, v8
    s_add_u32 m0, s73, 81920
    s_mul_i32 s14, s18, 589824
    buffer_load_dwordx4 v148, s[48:51], s14 offen offset:0 lds
    v_lshlrev_b32 v20, 16, v8
    v_and_b32 v23, 0xffff0000, v9
    v_lshlrev_b32 v22, 16, v9
    v_and_b32 v25, 0xffff0000, v10
    v_lshlrev_b32 v24, 16, v10
    v_and_b32 v27, 0xffff0000, v12
    v_lshlrev_b32 v26, 16, v12
    v_and_b32 v29, 0xffff0000, v13
    v_lshlrev_b32 v28, 16, v13
    v_and_b32 v31, 0xffff0000, v14
    v_lshlrev_b32 v30, 16, v14
    v_and_b32 v33, 0xffff0000, v16
    v_lshlrev_b32 v32, 16, v16
    v_and_b32 v35, 0xffff0000, v17
    v_lshlrev_b32 v34, 16, v17
    v_and_b32 v37, 0xffff0000, v18
    v_lshlrev_b32 v36, 16, v18
    v_pk_add_f32 v[38:39], v[20:21], v[22:23]
    v_pk_add_f32 v[40:41], v[24:25], v[26:27]
    v_pk_add_f32 v[42:43], v[28:29], v[30:31]
    v_pk_add_f32 v[44:45], v[32:33], v[34:35]
    v_pk_add_f32 v[38:39], v[38:39], v[40:41]
    v_pk_add_f32 v[42:43], v[42:43], v[44:45]
    v_pk_add_f32 v[38:39], v[38:39], v[36:37]
    v_pk_add_f32 v[38:39], v[38:39], v[42:43]
    v_add_f32 v56, v38, v39
    buffer_load_dwordx4 v149, s[48:51], s14 offen offset:1024 lds
    s_nop 0
    v_add_f32_dpp v56, v56, v56 row_ror:8 row_mask:0xf bank_mask:0xf
    s_nop 1
    v_add_f32_dpp v56, v56, v56 row_ror:4 row_mask:0xf bank_mask:0xf
    s_nop 1
    v_add_f32_dpp v56, v56, v56 row_ror:2 row_mask:0xf bank_mask:0xf
    s_nop 1
    v_add_f32_dpp v56, v56, v56 row_ror:1 row_mask:0xf bank_mask:0xf
    v_mov_b32 v57, v56
    s_nop 1
    v_permlane16_swap_b32 v56, v57
    v_add_f32 v56, v56, v57
    v_mul_f32 v56, 0x3ae38e39, v56
    v_pk_add_f32 v[20:21], v[20:21], v[56:57] op_sel_hi:[1,0] neg_lo:[0,1] neg_hi:[0,1]
    v_pk_add_f32 v[22:23], v[22:23], v[56:57] op_sel_hi:[1,0] neg_lo:[0,1] neg_hi:[0,1]
    v_pk_add_f32 v[24:25], v[24:25], v[56:57] op_sel_hi:[1,0] neg_lo:[0,1] neg_hi:[0,1]
    v_pk_add_f32 v[26:27], v[26:27], v[56:57] op_sel_hi:[1,0] neg_lo:[0,1] neg_hi:[0,1]
    v_pk_add_f32 v[28:29], v[28:29], v[56:57] op_sel_hi:[1,0] neg_lo:[0,1] neg_hi:[0,1]
    v_pk_add_f32 v[30:31], v[30:31], v[56:57] op_sel_hi:[1,0] neg_lo:[0,1] neg_hi:[0,1]
    v_pk_add_f32 v[32:33], v[32:33], v[56:57] op_sel_hi:[1,0] neg_lo:[0,1] neg_hi:[0,1]
    v_pk_add_f32 v[34:35], v[34:35], v[56:57] op_sel_hi:[1,0] neg_lo:[0,1] neg_hi:[0,1]
    v_pk_add_f32 v[36:37], v[36:37], v[56:57] op_sel_hi:[1,0] neg_lo:[0,1] neg_hi:[0,1]
    v_pk_mul_f32 v[38:39], v[20:21], v[20:21]
    v_pk_mul_f32 v[40:41], v[22:23], v[22:23]
    v_pk_fma_f32 v[38:39], v[24:25], v[24:25], v[38:39]
    v_pk_fma_f32 v[40:41], v[26:27], v[26:27], v[40:41]
    v_pk_fma_f32 v[38:39], v[28:29], v[28:29], v[38:39]
    v_pk_fma_f32 v[40:41], v[30:31], v[30:31], v[40:41]
    v_pk_fma_f32 v[38:39], v[32:33], v[32:33], v[38:39]
    v_pk_fma_f32 v[40:41], v[34:35], v[34:35], v[40:41]
    v_pk_fma_f32 v[38:39], v[36:37], v[36:37], v[38:39]
    buffer_load_dwordx4 v150, s[48:51], s14 offen offset:2048 lds
    v_pk_add_f32 v[38:39], v[38:39], v[40:41]
    v_add_f32 v18, v38, v39
    s_nop 1
    v_add_f32_dpp v18, v18, v18 row_ror:8 row_mask:0xf bank_mask:0xf
    s_nop 1
    v_add_f32_dpp v18, v18, v18 row_ror:4 row_mask:0xf bank_mask:0xf
    s_nop 1
    v_add_f32_dpp v18, v18, v18 row_ror:2 row_mask:0xf bank_mask:0xf
    s_nop 1
    v_add_f32_dpp v18, v18, v18 row_ror:1 row_mask:0xf bank_mask:0xf
    v_mov_b32 v19, v18
    s_nop 1
    v_permlane16_swap_b32 v18, v19
    v_add_f32 v18, v18, v19
    v_mul_f32 v18, 0x3ae38e39, v18
    v_cvt_pk_bf16_f32 v38, v56, v18
    v_lshlrev_b32 v106, 16, v38
    v_and_b32 v38, 0xffff0000, v38
    v_add_f32 v38, 0x3727c5ac, v38
    v_sub_f32 v56, v56, v106
    v_cvt_pk_bf16_f32 v38, v38, v38
    v_lshlrev_b32 v38, 16, v38
    v_sqrt_f32 v38, v38
    s_nop 0
    v_cvt_pk_bf16_f32 v38, v38, v38
    v_lshlrev_b32 v38, 16, v38
    v_rcp_f32 v107, v38
    s_nop 0
    v_mul_f32 v56, v56, v107
    v_mul_f32 v18, v18, v107
    v_mul_f32 v18, v18, v107
    v_cvt_pk_bf16_f32 v38, v56, v18
    v_lshlrev_b32 v39, 16, v38
    buffer_load_dwordx4 v151, s[48:51], s14 offen offset:3072 lds
    v_and_b32 v38, 0xffff0000, v38
    v_add_f32 v38, 0x3727c5ac, v38
    v_sub_f32 v56, v56, v39
    v_cvt_pk_bf16_f32 v38, v38, v38
    v_lshlrev_b32 v38, 16, v38
    v_sqrt_f32 v38, v38
    s_nop 0
    v_cvt_pk_bf16_f32 v38, v38, v38
    v_lshlrev_b32 v38, 16, v38
    v_rcp_f32 v38, v38
    s_nop 0
    v_mul_f32 v18, v107, v38
    v_mul_f32 v56, v56, v38
    v_pk_fma_f32 v[20:21], v[20:21], v[18:19], v[56:57] op_sel_hi:[1,0,0]
    v_pk_fma_f32 v[22:23], v[22:23], v[18:19], v[56:57] op_sel_hi:[1,0,0]
    v_pk_fma_f32 v[24:25], v[24:25], v[18:19], v[56:57] op_sel_hi:[1,0,0]
    v_pk_fma_f32 v[26:27], v[26:27], v[18:19], v[56:57] op_sel_hi:[1,0,0]
    v_pk_fma_f32 v[28:29], v[28:29], v[18:19], v[56:57] op_sel_hi:[1,0,0]
    v_pk_fma_f32 v[30:31], v[30:31], v[18:19], v[56:57] op_sel_hi:[1,0,0]
    v_pk_fma_f32 v[32:33], v[32:33], v[18:19], v[56:57] op_sel_hi:[1,0,0]
    v_pk_fma_f32 v[34:35], v[34:35], v[18:19], v[56:57] op_sel_hi:[1,0,0]
    v_pk_fma_f32 v[36:37], v[36:37], v[18:19], v[56:57] op_sel_hi:[1,0,0]
    v_cvt_pk_bf16_f32 v8, v20, v21
    v_cvt_pk_bf16_f32 v9, v22, v23
    v_cvt_pk_bf16_f32 v10, v24, v25
    v_cvt_pk_bf16_f32 v11, v26, v27
    v_cvt_pk_bf16_f32 v12, v28, v29
    v_cvt_pk_bf16_f32 v13, v30, v31
    v_cvt_pk_bf16_f32 v14, v32, v33
    v_cvt_pk_bf16_f32 v15, v34, v35
    v_cvt_pk_bf16_f32 v16, v36, v37
    ds_write_b32 v48, v8 offset:0
    ds_write_b32 v48, v9 offset:4
    ds_write_b32 v48, v10 offset:8
    ds_write_b32 v48, v11 offset:384
    ds_write_b32 v48, v12 offset:388
    ds_write_b32 v48, v13 offset:392
    ds_write_b32 v48, v14 offset:768
    ds_write_b32 v48, v15 offset:772
    ds_write_b32 v48, v16 offset:776
    buffer_store_dwordx2 v[106:107], v49, s[44:47], s5 offen sc1
    s_waitcnt lgkmcnt(0)
    s_barrier
    ds_read_b64_tr_b16 v[20:21], v50 offset:0
    ds_read_b64_tr_b16 v[22:23], v50 offset:4864
    ds_read_b64_tr_b16 v[24:25], v50 offset:512
    ds_read_b64_tr_b16 v[26:27], v50 offset:5376
    ds_read_b64_tr_b16 v[28:29], v50 offset:1024
    ds_read_b64_tr_b16 v[30:31], v50 offset:5888
    s_waitcnt lgkmcnt(4)
    buffer_store_dwordx4 v[20:23], v93, s[44:47], s10 offen sc1
    s_waitcnt lgkmcnt(2)
    buffer_store_dwordx4 v[24:27], v94, s[44:47], s10 offen sc1
    s_waitcnt lgkmcnt(0)
    buffer_store_dwordx4 v[28:31], v95, s[44:47], s83 offen sc1
    buffer_load_dword v45, v54, s[64:67], 0 offen sc1
    s_waitcnt vmcnt(9)
    s_barrier
    ds_read_b64_tr_b16 v[60:61], v51 offset:0
    ds_read_b64_tr_b16 v[62:63], v51 offset:4608
    ds_read_b64_tr_b16 v[64:65], v51 offset:9216
    ds_read_b64_tr_b16 v[66:67], v51 offset:12672
    ds_read_b64_tr_b16 v[68:69], v51 offset:17280
    ds_read_b64_tr_b16 v[70:71], v51 offset:512
    ds_read_b64_tr_b16 v[72:73], v51 offset:5120
    ds_read_b64_tr_b16 v[74:75], v51 offset:9728
    ds_read_b64_tr_b16 v[76:77], v51 offset:13184
    ds_read_b64_tr_b16 v[78:79], v51 offset:17792
    v_alignbit_b32 v114, v99, v99, 16
    v_alignbit_b32 v115, v98, v98, 16
    s_waitcnt lgkmcnt(5)
    v_alignbit_b32 v108, v61, v60, 16
    v_alignbit_b32 v109, v62, v61, 16
    v_alignbit_b32 v110, v63, v62, 16
    v_alignbit_b32 v111, v64, v63, 16
    v_alignbit_b32 v112, v65, v64, 16
    v_dot2_f32_bf16 v116, v60, v114, 0
    ds_read_b64_tr_b16 v[80:81], v51 offset:1024
    v_dot2_f32_bf16 v117, v108, v114, 0
    v_dot2_f32_bf16 v118, v61, v114, 0
    v_dot2_f32_bf16 v119, v109, v114, 0
    v_dot2_f32_bf16 v120, v62, v114, 0
    ds_read_b64_tr_b16 v[82:83], v51 offset:5632
    v_dot2_f32_bf16 v121, v110, v114, 0
    v_dot2_f32_bf16 v122, v63, v114, 0
    v_dot2_f32_bf16 v123, v111, v114, 0
    v_dot2_f32_bf16 v116, v61, v115, v116
    v_dot2_f32_bf16 v117, v109, v115, v117
    ds_read_b64_tr_b16 v[84:85], v51 offset:10240
    v_dot2_f32_bf16 v118, v62, v115, v118
    v_dot2_f32_bf16 v119, v110, v115, v119
    v_dot2_f32_bf16 v120, v63, v115, v120
    v_dot2_f32_bf16 v121, v111, v115, v121
    v_dot2_f32_bf16 v122, v64, v115, v122
    ds_read_b64_tr_b16 v[86:87], v51 offset:13696
    v_dot2_f32_bf16 v123, v112, v115, v123
    v_and_b32 v133, 0xffff0000, v66
    v_lshlrev_b32 v132, 16, v66
    v_and_b32 v135, 0xffff0000, v67
    v_lshlrev_b32 v134, 16, v67
    ds_read_b64_tr_b16 v[88:89], v51 offset:18304
    v_and_b32 v137, 0xffff0000, v68
    v_lshlrev_b32 v136, 16, v68
    v_and_b32 v139, 0xffff0000, v69
    v_lshlrev_b32 v138, 16, v69
    v_pk_mul_f32 v[116:117], v[116:117], v[132:133]
    v_pk_mul_f32 v[118:119], v[118:119], v[134:135]
    v_pk_mul_f32 v[120:121], v[120:121], v[136:137]
    v_pk_mul_f32 v[122:123], v[122:123], v[138:139]
    v_cvt_pk_bf16_f32 v160, v123, v122
    v_cvt_pk_bf16_f32 v161, v121, v120
    v_cvt_pk_bf16_f32 v162, v119, v118
    v_cvt_pk_bf16_f32 v163, v117, v116
    buffer_store_dwordx4 v[160:163], v93, s[44:47], s7 offen sc1
    v_alignbit_b32 v114, v101, v101, 16
    v_alignbit_b32 v115, v100, v100, 16
    s_waitcnt lgkmcnt(5)
    v_alignbit_b32 v108, v71, v70, 16
    v_alignbit_b32 v109, v72, v71, 16
    v_alignbit_b32 v110, v73, v72, 16
    v_alignbit_b32 v111, v74, v73, 16
    v_alignbit_b32 v112, v75, v74, 16
    v_dot2_f32_bf16 v124, v70, v114, 0
    v_dot2_f32_bf16 v125, v108, v114, 0
    v_dot2_f32_bf16 v126, v71, v114, 0
    v_dot2_f32_bf16 v127, v109, v114, 0
    v_dot2_f32_bf16 v128, v72, v114, 0
    v_dot2_f32_bf16 v129, v110, v114, 0
    v_dot2_f32_bf16 v130, v73, v114, 0
    v_dot2_f32_bf16 v131, v111, v114, 0
    v_dot2_f32_bf16 v124, v71, v115, v124
    v_dot2_f32_bf16 v125, v109, v115, v125
    v_dot2_f32_bf16 v126, v72, v115, v126
    v_dot2_f32_bf16 v127, v110, v115, v127
    v_dot2_f32_bf16 v128, v73, v115, v128
    v_dot2_f32_bf16 v129, v111, v115, v129
    v_dot2_f32_bf16 v130, v74, v115, v130
    v_dot2_f32_bf16 v131, v112, v115, v131
    v_and_b32 v133, 0xffff0000, v76
    v_lshlrev_b32 v132, 16, v76
    v_and_b32 v135, 0xffff0000, v77
    v_lshlrev_b32 v134, 16, v77
    v_and_b32 v137, 0xffff0000, v78
    v_lshlrev_b32 v136, 16, v78
    v_and_b32 v139, 0xffff0000, v79
    v_lshlrev_b32 v138, 16, v79
    v_pk_mul_f32 v[124:125], v[124:125], v[132:133]
    v_pk_mul_f32 v[126:127], v[126:127], v[134:135]
    v_pk_mul_f32 v[128:129], v[128:129], v[136:137]
    v_pk_mul_f32 v[130:131], v[130:131], v[138:139]
    v_cvt_pk_bf16_f32 v164, v131, v130
    v_cvt_pk_bf16_f32 v165, v129, v128
    v_cvt_pk_bf16_f32 v166, v127, v126
    v_cvt_pk_bf16_f32 v167, v125, v124
    buffer_store_dwordx4 v[164:167], v94, s[44:47], s7 offen sc1
    v_alignbit_b32 v114, v103, v103, 16
    v_alignbit_b32 v115, v102, v102, 16
    s_waitcnt lgkmcnt(0)
    v_alignbit_b32 v108, v81, v80, 16
    v_alignbit_b32 v109, v82, v81, 16
    v_alignbit_b32 v110, v83, v82, 16
    v_alignbit_b32 v111, v84, v83, 16
    v_alignbit_b32 v112, v85, v84, 16
    v_dot2_f32_bf16 v116, v80, v114, 0
    v_dot2_f32_bf16 v117, v108, v114, 0
    v_dot2_f32_bf16 v118, v81, v114, 0
    v_dot2_f32_bf16 v119, v109, v114, 0
    v_dot2_f32_bf16 v120, v82, v114, 0
    v_dot2_f32_bf16 v121, v110, v114, 0
    v_dot2_f32_bf16 v122, v83, v114, 0
    v_dot2_f32_bf16 v123, v111, v114, 0
    v_dot2_f32_bf16 v116, v81, v115, v116
    v_dot2_f32_bf16 v117, v109, v115, v117
    v_dot2_f32_bf16 v118, v82, v115, v118
    v_dot2_f32_bf16 v119, v110, v115, v119
    v_dot2_f32_bf16 v120, v83, v115, v120
    v_dot2_f32_bf16 v121, v111, v115, v121
    v_dot2_f32_bf16 v122, v84, v115, v122
    v_dot2_f32_bf16 v123, v112, v115, v123
    v_and_b32 v133, 0xffff0000, v86
    v_lshlrev_b32 v132, 16, v86
    v_and_b32 v135, 0xffff0000, v87
    v_lshlrev_b32 v134, 16, v87
    v_and_b32 v137, 0xffff0000, v88
    v_lshlrev_b32 v136, 16, v88
    v_and_b32 v139, 0xffff0000, v89
    v_lshlrev_b32 v138, 16, v89
    v_pk_mul_f32 v[116:117], v[116:117], v[132:133]
    v_pk_mul_f32 v[118:119], v[118:119], v[134:135]
    v_pk_mul_f32 v[120:121], v[120:121], v[136:137]
    v_pk_mul_f32 v[122:123], v[122:123], v[138:139]
    v_cvt_pk_bf16_f32 v168, v123, v122
    v_cvt_pk_bf16_f32 v169, v121, v120
    v_cvt_pk_bf16_f32 v170, v119, v118
    v_cvt_pk_bf16_f32 v171, v117, v116
    buffer_store_dwordx4 v[168:171], v95, s[44:47], s8 offen sc1
    s_add_u32 m0, s73, 98304
    s_mul_i32 s14, s19, 589824
    buffer_load_dwordx4 v148, s[48:51], s14 offen offset:0 lds
    buffer_load_dwordx4 v149, s[48:51], s14 offen offset:1024 lds
    buffer_load_dwordx4 v150, s[48:51], s14 offen offset:2048 lds
    buffer_load_dwordx4 v151, s[48:51], s14 offen offset:3072 lds
    s_add_u32 m0, s73, 0
    s_mul_i32 s14, s20, 589824
    buffer_load_dwordx4 v148, s[48:51], s14 offen offset:0 lds
    buffer_load_dwordx4 v149, s[48:51], s14 offen offset:1024 lds
    buffer_load_dwordx4 v150, s[48:51], s14 offen offset:2048 lds
    buffer_load_dwordx4 v151, s[48:51], s14 offen offset:3072 lds
    s_add_u32 m0, s73, 16384
    s_mul_i32 s14, s21, 589824
    buffer_load_dwordx4 v148, s[48:51], s14 offen offset:0 lds
    buffer_load_dwordx4 v149, s[48:51], s14 offen offset:1024 lds
    s_waitcnt vmcnt(13)
    v_readfirstlane_b32 s68, v45
    s_nop 1
    s_cmp_eq_u32 s68, 0
    s_cbranch_scc1 L_nw_G
L_ng_G:
    s_barrier
    v_mov_b32 v3, s68
    buffer_store_dword v3, v1, s[44:47], 0 offen sc1
    s_mov_b64 exec, 0
    s_call_b64 s[82:83], L_wc_G
    s_mov_b64 exec, -1
    s_waitcnt vmcnt(11)
    s_barrier
    buffer_store_dword v3, v46, s[44:47], 0 offen sc1
L_segG:
L_pl_G_0:
    s_cbranch_execz L_pl_G_4
    buffer_load_dwordx4 v150, s[48:51], s14 offen offset:2048 lds
    buffer_load_dwordx4 v151, s[48:51], s14 offen offset:3072 lds
    s_add_u32 m0, s73, 32768
    s_mul_i32 s14, s22, 589824
    buffer_load_dwordx4 v148, s[48:51], s14 offen offset:0 lds
    buffer_load_dwordx4 v149, s[48:51], s14 offen offset:1024 lds
    buffer_load_dwordx4 v150, s[48:51], s14 offen offset:2048 lds
    buffer_load_dwordx4 v151, s[48:51], s14 offen offset:3072 lds
    s_add_u32 m0, s73, 49152
    s_mul_i32 s14, s23, 589824
    buffer_load_dwordx4 v148, s[48:51], s14 offen offset:0 lds
    buffer_load_dwordx4 v149, s[48:51], s14 offen offset:1024 lds
    buffer_load_dwordx4 v150, s[48:51], s14 offen offset:2048 lds
    buffer_load_dwordx4 v151, s[48:51], s14 offen offset:3072 lds
    s_add_u32 m0, s73, 65536
    s_mul_i32 s14, s24, 589824
    buffer_load_dwordx4 v148, s[48:51], s14 offen offset:0 lds
    buffer_load_dwordx4 v149, s[48:51], s14 offen offset:1024 lds
    buffer_load_dwordx4 v150, s[48:51], s14 offen offset:2048 lds
    buffer_load_dwordx4 v151, s[48:51], s14 offen offset:3072 lds
    v_bfe_u32 v140, v2, 2, 2
    v_lshrrev_b32 v141, 4, v2
    v_lshl_add_u32 v142, v141, 3, v140
    v_lshlrev_b32 v142, 8, v142
    v_and_b32 v143, 3, v2
    v_lshl_add_u32 v142, v143, 3, v142
    v_and_b32 v141, 1, v141
    v_lshl_add_u32 v140, v141, 2, v140
    s_lshl_b32 s7, s3, 1
    v_xor_b32 v140, s7, v140
    v_lshl_add_u32 v152, v140, 5, v142
    v_xor_b32 v153, 32, v152
    v_add_u32 v154, 0x10000, v152
    v_add_u32 v155, 0x10000, v153
    v_and_b32 v24, 15, v2
    v_lshrrev_b32 v25, 4, v2
    v_mul_u32_u24 v26, 17408, v25
    v_lshl_add_u32 v26, v24, 4, v26
    v_mul_u32_u24 v25, 1536, v25
    v_lshl_add_u32 v25, v24, 4, v25
    v_add_u32 v159, 81920, v25
    v_add_u32 v250, 36864, v159
    s_mul_i32 s7, s3, 18432
    s_xor_b32 s8, s70, 1
    s_mul_i32 s8, s8, 1536
    s_add_u32 s7, s7, s8
    v_lshlrev_b32 v246, 4, v2
    v_add_u32 v156, s7, v246
    v_lshrrev_b32 v25, 5, v2
    v_mul_u32_u24 v25, 7680, v25
    v_add_u32 v157, v156, v25
    v_add_u32 v158, 7680, v156
    s_mul_i32 s74, s3, 3072
    s_add_u32 s74, s74, 81920
    v_mov_b32 v245, v26
    s_mov_b64 exec, 0
    s_call_b64 s[82:83], L_wc_D
    s_mov_b64 exec, -1
    s_mov_b32 s56, s32
    s_and_b32 s57, s33, 0xffff
    s_mov_b32 s58, 9216
    s_mov_b32 s59, 0x20000
    s_mov_b32 s60, s36
    s_and_b32 s61, s37, 0xffff
    s_mov_b32 s62, 4096
    s_mov_b32 s63, 0x20000
    s_and_b32 s4, s70, 1
    s_lshl1_add_u32 s4, s3, s4
    s_lshl_b32 s4, s4, 7
    s_bfe_u32 s5, s2, 0x10003
    s_lshl1_add_u32 s5, s72, s5
    s_lshr_b32 s5, s5, 0
    s_lshl_b32 s5, s5, 10
    s_add_u32 s4, s4, s5
    s_add_u32 s4, s4, 12533760
    v_lshl_add_u32 v28, v2, 2, s4
    v_cmp_gt_u32 vcc, 32, v2
    v_mov_b32 v12, 0x40000000
    s_nop 0
    v_cndmask_b32 v28, v12, v28, vcc
    v_mov_b32 v12, s68
    v_cndmask_b32 v12, 0, v12, vcc
    v_lshrrev_b32 v24, 4, v2
    v_lshlrev_b32 v25, 3, v24
    s_lshl_b32 s7, s69, 8
    s_lshl_b32 s8, s3, 6
    s_add_u32 s7, s7, s8
    buffer_load_dwordx2 v[144:145], v25, s[56:59], s7 offen
    buffer_load_dwordx2 v[146:147], v25, s[56:59], s7 offen offset:32
    s_waitcnt vmcnt(24)
    s_barrier
    ds_read_b64_tr_b16 a[0:1], v154 offset:16384
    ds_read_b64_tr_b16 a[2:3], v154 offset:17408
    ds_read_b64_tr_b16 a[4:5], v155 offset:16384
    ds_read_b64_tr_b16 a[6:7], v155 offset:17408
    ds_read_b64_tr_b16 a[8:9], v154 offset:24576
    ds_read_b64_tr_b16 a[10:11], v154 offset:25600
    ds_read_b64_tr_b16 a[12:13], v155 offset:24576
    ds_read_b64_tr_b16 a[14:15], v155 offset:25600
    ds_read_b64_tr_b16 a[16:17], v154 offset:32768
    ds_read_b64_tr_b16 a[18:19], v154 offset:33792
    ds_read_b64_tr_b16 a[20:21], v155 offset:32768
    ds_read_b64_tr_b16 a[22:23], v155 offset:33792
    ds_read_b64_tr_b16 a[24:25], v154 offset:40960
    ds_read_b64_tr_b16 a[26:27], v154 offset:41984
    ds_read_b64_tr_b16 a[28:29], v155 offset:40960
    ds_read_b64_tr_b16 a[30:31], v155 offset:41984
    s_waitcnt vmcnt(20)
    s_barrier
    ds_read_b64_tr_b16 a[32:33], v152 offset:0
    ds_read_b64_tr_b16 a[34:35], v152 offset:1024
    ds_read_b64_tr_b16 a[36:37], v153 offset:0
    ds_read_b64_tr_b16 a[38:39], v153 offset:1024
    ds_read_b64_tr_b16 a[40:41], v152 offset:8192
    ds_read_b64_tr_b16 a[42:43], v152 offset:9216
    ds_read_b64_tr_b16 a[44:45], v153 offset:8192
    ds_read_b64_tr_b16 a[46:47], v153 offset:9216
    s_waitcnt vmcnt(14)
    s_barrier
    ds_read_b64_tr_b16 a[48:49], v152 offset:16384
    ds_read_b64_tr_b16 a[50:51], v152 offset:17408
    ds_read_b64_tr_b16 a[52:53], v153 offset:16384
    ds_read_b64_tr_b16 a[54:55], v153 offset:17408
    ds_read_b64_tr_b16 a[56:57], v152 offset:24576
    ds_read_b64_tr_b16 a[58:59], v152 offset:25600
    ds_read_b64_tr_b16 a[60:61], v153 offset:24576
    ds_read_b64_tr_b16 a[62:63], v153 offset:25600
    v_mov_b32 v29, 0
    buffer_atomic_add v29, v28, s[44:47], 0 offen sc0 sc1
    s_waitcnt vmcnt(11)
    s_barrier
    ds_read_b64_tr_b16 a[64:65], v152 offset:32768
    ds_read_b64_tr_b16 a[66:67], v152 offset:33792
    ds_read_b64_tr_b16 a[68:69], v153 offset:32768
    ds_read_b64_tr_b16 a[70:71], v153 offset:33792
    ds_read_b64_tr_b16 a[72:73], v152 offset:40960
    ds_read_b64_tr_b16 a[74:75], v152 offset:41984
    ds_read_b64_tr_b16 a[76:77], v153 offset:40960
    ds_read_b64_tr_b16 a[78:79], v153 offset:41984
L_pl_G_1:
    s_cbranch_execz L_pl_G_5
    s_waitcnt lgkmcnt(0)
    s_barrier
    s_xor_b32 s8, s70, 1
    s_mul_i32 s8, s8, 1536
    s_mul_i32 s7, s3, 22528
    s_add_u32 s7, s7, 36585472
    v_add_u32 v24, 0, v246
    v_cmp_lt_u32 vcc, 1535, v24
    s_nop 1
    v_cndmask_b32 v25, 0, 1, vcc
    v_mul_u32_u24 v30, 1536, v25
    v_sub_u32 v24, v24, v30
    v_add_u32 v24, s8, v24
    v_lshrrev_b32 v30, 7, v24
    v_mul_u32_u24 v31, 9363, v30
    v_lshrrev_b32 v31, 16, v31
    v_mad_i32_i24 v30, v31, -7, v30
    v_cmp_lt_u32 vcc, 2, v30
    s_nop 1
    v_addc_co_u32 v31, vcc, 0, v31, vcc
    v_lshl_add_u32 v24, v31, 7, v24
    v_mul_u32_u24 v25, 11264, v25
    v_add3_u32 v24, v24, v25, s7
    v_subrev_u32 v156, 0, v24
    v_add_u32 v24, 1024, v246
    v_cmp_lt_u32 vcc, 1535, v24
    s_nop 1
    v_cndmask_b32 v25, 0, 1, vcc
    v_mul_u32_u24 v30, 1536, v25
    v_sub_u32 v24, v24, v30
    v_add_u32 v24, s8, v24
    v_lshrrev_b32 v30, 7, v24
    v_mul_u32_u24 v31, 9363, v30
    v_lshrrev_b32 v31, 16, v31
    v_mad_i32_i24 v30, v31, -7, v30
    v_cmp_lt_u32 vcc, 2, v30
    s_nop 1
    v_addc_co_u32 v31, vcc, 0, v31, vcc
    v_lshl_add_u32 v24, v31, 7, v24
    v_mul_u32_u24 v25, 11264, v25
    v_add3_u32 v24, v24, v25, s7
    v_subrev_u32 v157, 1024, v24
    v_add_u32 v24, 2048, v246
    v_cmp_lt_u32 vcc, 1535, v24
    s_nop 1
    v_cndmask_b32 v25, 0, 1, vcc
    v_mul_u32_u24 v30, 1536, v25
    v_sub_u32 v24, v24, v30
    v_add_u32 v24, s8, v24
    v_lshrrev_b32 v30, 7, v24
    v_mul_u32_u24 v31, 9363, v30
    v_lshrrev_b32 v31, 16, v31
    v_mad_i32_i24 v30, v31, -7, v30
    v_cmp_lt_u32 vcc, 2, v30
    s_nop 1
    v_addc_co_u32 v31, vcc, 0, v31, vcc
    v_lshl_add_u32 v24, v31, 7, v24
    v_mul_u32_u24 v25, 11264, v25
    v_add3_u32 v24, v24, v25, s7
    v_subrev_u32 v158, 2048, v24
    s_xor_b32 s8, s70, 0
    s_mul_i32 s8, s8, 1536
    s_mul_i32 s7, s3, 22528
    s_add_u32 s7, s7, 36585472
    v_add_u32 v24, 0, v246
    v_cmp_lt_u32 vcc, 1535, v24
    s_nop 1
    v_cndmask_b32 v25, 0, 1, vcc
    v_mul_u32_u24 v30, 1536, v25
    v_sub_u32 v24, v24, v30
    v_add_u32 v24, s8, v24
    v_lshrrev_b32 v30, 7, v24
    v_mul_u32_u24 v31, 9363, v30
    v_lshrrev_b32 v31, 16, v31
    v_mad_i32_i24 v30, v31, -7, v30
    v_cmp_lt_u32 vcc, 2, v30
    s_nop 1
    v_addc_co_u32 v31, vcc, 0, v31, vcc
    v_lshl_add_u32 v24, v31, 7, v24
    v_mul_u32_u24 v25, 11264, v25
    v_add3_u32 v24, v24, v25, s7
    v_subrev_u32 v8, 0, v24
    v_add_u32 v24, 1024, v246
    v_cmp_lt_u32 vcc, 1535, v24
    s_nop 1
    v_cndmask_b32 v25, 0, 1, vcc
    v_mul_u32_u24 v30, 1536, v25
    v_sub_u32 v24, v24, v30
    v_add_u32 v24, s8, v24
    v_lshrrev_b32 v30, 7, v24
    v_mul_u32_u24 v31, 9363, v30
    v_lshrrev_b32 v31, 16, v31
    v_mad_i32_i24 v30, v31, -7, v30
    v_cmp_lt_u32 vcc, 2, v30
    s_nop 1
    v_addc_co_u32 v31, vcc, 0, v31, vcc
    v_lshl_add_u32 v24, v31, 7, v24
    v_mul_u32_u24 v25, 11264, v25
    v_add3_u32 v24, v24, v25, s7
    v_subrev_u32 v9, 1024, v24
    v_add_u32 v24, 2048, v246
    v_cmp_lt_u32 vcc, 1535, v24
    s_nop 1
    v_cndmask_b32 v25, 0, 1, vcc
    v_mul_u32_u24 v30, 1536, v25
    v_sub_u32 v24, v24, v30
    v_add_u32 v24, s8, v24
    v_lshrrev_b32 v30, 7, v24
    v_mul_u32_u24 v31, 9363, v30
    v_lshrrev_b32 v31, 16, v31
    v_mad_i32_i24 v30, v31, -7, v30
    v_cmp_lt_u32 vcc, 2, v30
    s_nop 1
    v_addc_co_u32 v31, vcc, 0, v31, vcc
    v_lshl_add_u32 v24, v31, 7, v24
    v_mul_u32_u24 v25, 11264, v25
    v_add3_u32 v24, v24, v25, s7
    v_subrev_u32 v3, 2048, v24
    s_waitcnt vmcnt(0)
    v_cmp_ne_u32 vcc, v12, v29
    s_cbranch_vccnz L_rs_p1G
L_ok_p1G:
    s_add_u32 m0, s74, 0
    s_mul_i32 s13, s18, 90112
    buffer_load_dwordx4 v156, s[44:47], s13 offen offset:0 sc1 lds
    buffer_load_dwordx4 v157, s[44:47], s13 offen offset:1024 sc1 lds
    buffer_load_dwordx4 v158, s[44:47], s13 offen offset:2048 sc1 lds
    s_add_u32 m0, s74, 12288
    s_mul_i32 s13, s19, 90112
    buffer_load_dwordx4 v156, s[44:47], s13 offen offset:0 sc1 lds
    buffer_load_dwordx4 v157, s[44:47], s13 offen offset:1024 sc1 lds
    buffer_load_dwordx4 v158, s[44:47], s13 offen offset:2048 sc1 lds
    s_add_u32 m0, s74, 24576
    s_mul_i32 s13, s20, 90112
    buffer_load_dwordx4 v156, s[44:47], s13 offen offset:0 sc1 lds
    buffer_load_dwordx4 v157, s[44:47], s13 offen offset:1024 sc1 lds
    buffer_load_dwordx4 v158, s[44:47], s13 offen offset:2048 sc1 lds
    s_add_u32 m0, s74, 36864
    s_mul_i32 s13, s21, 90112
    buffer_load_dwordx4 v156, s[44:47], s13 offen offset:0 sc1 lds
    buffer_load_dwordx4 v157, s[44:47], s13 offen offset:1024 sc1 lds
    buffer_load_dwordx4 v158, s[44:47], s13 offen offset:2048 sc1 lds
    s_waitcnt vmcnt(9) lgkmcnt(0)
    s_barrier
    ds_read_b128 v[80:83], v159 offset:0
    ds_read_b128 v[84:87], v159 offset:6144
    ds_read_b128 v[88:91], v159 offset:256
    ds_read_b128 v[92:95], v159 offset:6400
    ds_read_b128 v[96:99], v159 offset:512
    ds_read_b128 v[100:103], v159 offset:6656
    s_waitcnt lgkmcnt(0)
    v_mfma_f32_16x16x32_bf16 v[192:195], a[0:3], v[80:83], 0
    v_mfma_f32_16x16x32_bf16 v[192:195], a[8:11], v[84:87], v[192:195]
    ds_read_b128 v[104:107], v159 offset:768
    v_mfma_f32_16x16x32_bf16 v[196:199], a[12:15], v[84:87], 0
    ds_read_b128 v[108:111], v159 offset:6912
    v_mfma_f32_16x16x32_bf16 v[196:199], a[4:7], v[80:83], v[196:199]
    ds_read_b128 v[112:115], v159 offset:1024
    v_mfma_f32_16x16x32_bf16 v[204:207], a[4:7], v[88:91], 0
    ds_read_b128 v[116:119], v159 offset:7168
    v_mfma_f32_16x16x32_bf16 v[204:207], a[12:15], v[92:95], v[204:207]
    ds_read_b128 v[120:123], v159 offset:1280
    v_mfma_f32_16x16x32_bf16 v[200:203], a[8:11], v[92:95], 0
    ds_read_b128 v[124:127], v159 offset:7424
    v_and_b32 v24, 15, v2
    s_lshl_b32 s7, s71, 6
    v_add_u32 v24, s7, v24
    s_and_b32 s8, s3, 1
    s_lshl_b32 s4, s8, 5
    v_add_u32 v25, s4, v24
    v_lshlrev_b32 v26, 3, v25
    v_mul_u32_u24 v25, 1152, v25
    v_bfe_u32 v31, v2, 4, 1
    v_lshl_add_u32 v25, v31, 5, v25
    v_lshrrev_b32 v31, 5, v2
    v_lshl_add_u32 v25, v31, 4, v25
    s_bfe_u32 s7, s2, 0x20003
    s_mul_i32 s7, s7, 288
    s_lshl_b32 s4, s72, 6
    s_add_u32 s4, s4, s7
    v_add_u32 v252, s4, v25
    s_xor_b32 s8, s3, s72
    s_and_b32 s4, s72, 1
    s_lshl1_add_u32 s4, s4, s8
    v_lshl_add_u32 v24, s4, 4, v24
    s_add_u32 s7, s7, 256
    s_cmp_lt_u32 s8, 2
    s_cselect_b32 s7, s7, 0x40000000
    v_lshlrev_b32 v18, 3, v24
    v_mul_u32_u24 v24, 1152, v24
    v_lshrrev_b32 v31, 4, v2
    v_lshl_add_u32 v24, v31, 3, v24
    v_add_u32 v253, s7, v24
    v_lshrrev_b32 v24, 3, v2
    v_and_b32 v25, 7, v2
    v_mfma_f32_16x16x32_bf16 v[200:203], a[0:3], v[88:91], v[200:203]
    v_mfma_f32_16x16x32_bf16 v[208:211], a[0:3], v[96:99], 0
    v_mfma_f32_16x16x32_bf16 v[208:211], a[8:11], v[100:103], v[208:211]
    v_mfma_f32_16x16x32_bf16 v[212:215], a[12:15], v[100:103], 0
    v_mfma_f32_16x16x32_bf16 v[212:215], a[4:7], v[96:99], v[212:215]
    s_waitcnt lgkmcnt(0)
    v_mfma_f32_16x16x32_bf16 v[220:223], a[4:7], v[104:107], 0
    s_waitcnt vmcnt(6)
    s_barrier
    v_mfma_f32_16x16x32_bf16 v[220:223], a[12:15], v[108:111], v[220:223]
    ds_read_b128 v[80:83], v159 offset:12288
    s_add_u32 m0, s74, 49152
    s_mul_i32 s13, s22, 90112
    v_mfma_f32_16x16x32_bf16 v[216:219], a[8:11], v[108:111], 0
    ds_read_b128 v[84:87], v159 offset:18432
    buffer_load_dwordx4 v156, s[44:47], s13 offen offset:0 sc1 lds
    v_mfma_f32_16x16x32_bf16 v[216:219], a[0:3], v[104:107], v[216:219]
    ds_read_b128 v[88:91], v159 offset:12544
    v_mfma_f32_16x16x32_bf16 v[224:227], a[0:3], v[112:115], 0
    ds_read_b128 v[92:95], v159 offset:18688
    buffer_load_dwordx4 v157, s[44:47], s13 offen offset:1024 sc1 lds
    v_mfma_f32_16x16x32_bf16 v[224:227], a[8:11], v[116:119], v[224:227]
    ds_read_b128 v[96:99], v159 offset:12800
    v_mfma_f32_16x16x32_bf16 v[228:231], a[12:15], v[116:119], 0
    ds_read_b128 v[100:103], v159 offset:18944
    buffer_load_dwordx4 v158, s[44:47], s13 offen offset:2048 sc1 lds
    v_bfe_u32 v31, v2, 4, 2
    v_lshlrev_b32 v31, 1, v31
    v_xor_b32 v25, v25, v31
    v_lshlrev_b32 v24, 12, v24
    v_lshl_add_u32 v24, v25, 4, v24
    s_mul_i32 s7, s72, 36
    s_bitcmp1_b32 s3, 0
    s_addc_u32 s7, s7, 0
    s_lshl_b32 s7, s7, 17
    s_lshl_b32 s8, s71, 7
    s_add_u32 s7, s7, s8
    v_add_u32 v4, s7, v24
    v_add_u32 v5, 31744, v4
    v_add_u32 v6, 31744, v5
    v_add_u32 v7, 31744, v6
    v_lshrrev_b32 v24, 2, v2
    v_lshlrev_b32 v24, 7, v24
    v_and_b32 v25, 3, v2
    v_lshl_add_u32 v24, v25, 3, v24
    s_and_b32 s7, s73, 8192
    v_add_u32 v24, s7, v24
    v_bfe_u32 v31, v2, 3, 2
    s_and_b32 s7, s3, 1
    s_lshl_b32 s7, s7, 1
    v_xor_b32 v31, s7, v31
    v_lshl_add_u32 v10, v31, 5, v24
    v_xor_b32 v11, 32, v10
    s_bfe_u32 s101, s2, 0x20003
    s_mul_i32 s101, s101, 3
    s_mul_i32 s84, s101, 305844
    s_lshr_b32 s84, s84, 18
    s_add_u32 s84, s84, 0
    v_mfma_f32_16x16x32_bf16 v[228:231], a[4:7], v[112:115], v[228:231]
    ds_read_b64_tr_b16 a[80:81], v152 offset:49152
    v_mfma_f32_16x16x32_bf16 v[236:239], a[4:7], v[120:123], 0
    ds_read_b64_tr_b16 a[82:83], v152 offset:50176
    s_add_u32 m0, s74, 61440
    s_mul_i32 s13, s23, 90112
    v_mfma_f32_16x16x32_bf16 v[236:239], a[12:15], v[124:127], v[236:239]
    v_mfma_f32_16x16x32_bf16 v[232:235], a[8:11], v[124:127], 0
    ds_read_b64_tr_b16 a[84:85], v153 offset:49152
    buffer_load_dwordx4 v156, s[44:47], s13 offen offset:0 sc1 lds
    v_mfma_f32_16x16x32_bf16 v[232:235], a[0:3], v[120:123], v[232:235]
    ds_read_b64_tr_b16 a[86:87], v153 offset:50176
    s_waitcnt lgkmcnt(4)
    v_mfma_f32_16x16x32_bf16 v[192:195], a[16:19], v[80:83], v[192:195]
    buffer_load_dwordx4 v157, s[44:47], s13 offen offset:1024 sc1 lds
    v_mfma_f32_16x16x32_bf16 v[192:195], a[24:27], v[84:87], v[192:195]
    ds_read_b128 v[104:107], v159 offset:13056
    buffer_load_dwordx4 v158, s[44:47], s13 offen offset:2048 sc1 lds
    v_mfma_f32_16x16x32_bf16 v[196:199], a[28:31], v[84:87], v[196:199]
    ds_read_b128 v[108:111], v159 offset:19200
    v_mfma_f32_16x16x32_bf16 v[196:199], a[20:23], v[80:83], v[196:199]
    ds_read_b128 v[112:115], v159 offset:13312
    s_add_u32 m0, s73, 0
    s_mul_i32 s14, s25, 589824
    v_mfma_f32_16x16x32_bf16 v[204:207], a[20:23], v[88:91], v[204:207]
    ds_read_b128 v[116:119], v159 offset:19456
    v_mfma_f32_16x16x32_bf16 v[204:207], a[28:31], v[92:95], v[204:207]
    ds_read_b128 v[120:123], v159 offset:13568
    buffer_load_dwordx4 v148, s[48:51], s14 offen offset:0 lds
    v_mfma_f32_16x16x32_bf16 v[200:203], a[24:27], v[92:95], v[200:203]
    ds_read_b128 v[124:127], v159 offset:19712
    buffer_load_dwordx4 v149, s[48:51], s14 offen offset:1024 lds
    s_add_u32 s85, s84, 1
    s_cmp_eq_u32 s85, 14
    s_cselect_b32 s85, 0, s85
    s_add_u32 s86, s85, 1
    s_cmp_eq_u32 s86, 14
    s_cselect_b32 s86, 0, s86
    s_add_u32 s87, s86, 1
    s_cmp_eq_u32 s87, 14
    s_cselect_b32 s87, 0, s87
    s_add_u32 s88, s87, 1
    s_cmp_eq_u32 s88, 14
    s_cselect_b32 s88, 0, s88
    s_add_u32 s89, s88, 1
    s_cmp_eq_u32 s89, 14
    s_cselect_b32 s89, 0, s89
    s_add_u32 s90, s89, 1
    s_cmp_eq_u32 s90, 14
    s_cselect_b32 s90, 0, s90
    s_add_u32 s91, s90, 1
    s_cmp_eq_u32 s91, 14
    s_cselect_b32 s91, 0, s91
    s_add_u32 s92, s91, 1
    s_cmp_eq_u32 s92, 14
    s_cselect_b32 s92, 0, s92
    s_add_u32 s93, s92, 1
    s_cmp_eq_u32 s93, 14
    s_cselect_b32 s93, 0, s93
    s_add_u32 s94, s93, 1
    s_cmp_eq_u32 s94, 14
    s_cselect_b32 s94, 0, s94
    s_add_u32 s95, s94, 1
    s_cmp_eq_u32 s95, 14
    s_cselect_b32 s95, 0, s95
    s_add_u32 s96, s95, 1
    s_cmp_eq_u32 s96, 14
    s_cselect_b32 s96, 0, s96
    s_add_u32 s97, s96, 1
    s_cmp_eq_u32 s97, 14
    s_cselect_b32 s97, 0, s97
    s_mul_i32 s98, s101, 87384
    s_lshr_b32 s98, s98, 18
    s_add_u32 s98, s98, 14
    s_add_u32 s99, s98, 1
    s_cmp_eq_u32 s99, 18
    s_cselect_b32 s99, 14, s99
    s_add_u32 s100, s99, 1
    s_cmp_eq_u32 s100, 18
    s_cselect_b32 s100, 14, s100
    s_add_u32 s101, s100, 1
    s_cmp_eq_u32 s101, 18
    s_cselect_b32 s101, 14, s101
    s_mul_i32 s7, s70, 6
    s_add_u32 s7, s7, 0
    s_mul_i32 s8, s7, 7282
    s_lshr_b32 s8, s8, 16
    s_mul_i32 s5, s8, 9
    s_sub_u32 s7, s7, s5
    s_lshl_b32 s7, s7, 2
    s_mov_b32 s4, 0xeca86420
    s_mov_b32 s5, 3
    s_lshr_b64 s[4:5], s[4:5], s7
    v_mfma_f32_16x16x32_bf16 v[200:203], a[16:19], v[88:91], v[200:203]
    ds_read_b64_tr_b16 a[88:89], v152 offset:57344
    v_mfma_f32_16x16x32_bf16 v[208:211], a[16:19], v[96:99], v[208:211]
    ds_read_b64_tr_b16 a[90:91], v152 offset:58368
    buffer_load_dwordx4 v150, s[48:51], s14 offen offset:2048 lds
    v_mfma_f32_16x16x32_bf16 v[208:211], a[24:27], v[100:103], v[208:211]
    v_mfma_f32_16x16x32_bf16 v[212:215], a[28:31], v[100:103], v[212:215]
    ds_read_b64_tr_b16 a[92:93], v153 offset:57344
    buffer_load_dwordx4 v151, s[48:51], s14 offen offset:3072 lds
    v_mfma_f32_16x16x32_bf16 v[212:215], a[20:23], v[96:99], v[212:215]
    ds_read_b64_tr_b16 a[94:95], v153 offset:58368
    s_waitcnt lgkmcnt(4)
    v_mfma_f32_16x16x32_bf16 v[220:223], a[20:23], v[104:107], v[220:223]
    s_waitcnt vmcnt(13)
    s_barrier
    v_mfma_f32_16x16x32_bf16 v[220:223], a[28:31], v[108:111], v[220:223]
    ds_read_b128 v[80:83], v159 offset:24576
    s_add_u32 m0, s74, 0
    s_mul_i32 s13, s24, 90112
    v_mfma_f32_16x16x32_bf16 v[216:219], a[24:27], v[108:111], v[216:219]
    ds_read_b128 v[84:87], v159 offset:30720
    buffer_load_dwordx4 v156, s[44:47], s13 offen offset:0 sc1 lds
    v_mfma_f32_16x16x32_bf16 v[216:219], a[16:19], v[104:107], v[216:219]
    ds_read_b128 v[88:91], v159 offset:24832
    v_mfma_f32_16x16x32_bf16 v[224:227], a[16:19], v[112:115], v[224:227]
    ds_read_b128 v[92:95], v159 offset:30976
    buffer_load_dwordx4 v157, s[44:47], s13 offen offset:1024 sc1 lds
    v_mfma_f32_16x16x32_bf16 v[224:227], a[24:27], v[116:119], v[224:227]
    ds_read_b128 v[96:99], v159 offset:25088
    v_mfma_f32_16x16x32_bf16 v[228:231], a[28:31], v[116:119], v[228:231]
    ds_read_b128 v[100:103], v159 offset:31232
    buffer_load_dwordx4 v158, s[44:47], s13 offen offset:2048 sc1 lds
    s_and_b32 s4, s4, 15
    s_lshl4_add_u32 s4, s8, s4
    v_lshl_add_u32 v240, s4, 8, v245
    s_mul_i32 s7, s70, 6
    s_add_u32 s7, s7, 1
    s_mul_i32 s8, s7, 7282
    s_lshr_b32 s8, s8, 16
    s_mul_i32 s5, s8, 9
    s_sub_u32 s7, s7, s5
    s_lshl_b32 s7, s7, 2
    s_mov_b32 s4, 0xeca86420
    s_mov_b32 s5, 3
    s_lshr_b64 s[4:5], s[4:5], s7
    s_and_b32 s4, s4, 15
    s_lshl4_add_u32 s4, s8, s4
    v_lshl_add_u32 v241, s4, 8, v245
    s_mul_i32 s7, s70, 6
    s_add_u32 s7, s7, 2
    s_mul_i32 s8, s7, 7282
    s_lshr_b32 s8, s8, 16
    s_mul_i32 s5, s8, 9
    s_sub_u32 s7, s7, s5
    s_lshl_b32 s7, s7, 2
    s_mov_b32 s4, 0xeca86420
    s_mov_b32 s5, 3
    v_mfma_f32_16x16x32_bf16 v[228:231], a[20:23], v[112:115], v[228:231]
    ds_read_b64_tr_b16 a[96:97], v154 offset:0
    v_mfma_f32_16x16x32_bf16 v[236:239], a[20:23], v[120:123], v[236:239]
    ds_read_b64_tr_b16 a[98:99], v154 offset:1024
    s_add_u32 m0, s74, 12288
    s_mul_i32 s13, s25, 90112
    v_mfma_f32_16x16x32_bf16 v[236:239], a[28:31], v[124:127], v[236:239]
    v_mfma_f32_16x16x32_bf16 v[232:235], a[24:27], v[124:127], v[232:235]
    ds_read_b64_tr_b16 a[100:101], v155 offset:0
    buffer_load_dwordx4 v156, s[44:47], s13 offen offset:0 sc1 lds
    v_mfma_f32_16x16x32_bf16 v[232:235], a[16:19], v[120:123], v[232:235]
    ds_read_b64_tr_b16 a[102:103], v155 offset:1024
    s_waitcnt lgkmcnt(4)
    v_mfma_f32_16x16x32_bf16 v[192:195], a[32:35], v[80:83], v[192:195]
    buffer_load_dwordx4 v157, s[44:47], s13 offen offset:1024 sc1 lds
    v_mfma_f32_16x16x32_bf16 v[192:195], a[40:43], v[84:87], v[192:195]
    ds_read_b128 v[104:107], v159 offset:25344
    buffer_load_dwordx4 v158, s[44:47], s13 offen offset:2048 sc1 lds
    v_mfma_f32_16x16x32_bf16 v[196:199], a[44:47], v[84:87], v[196:199]
    ds_read_b128 v[108:111], v159 offset:31488
    v_mfma_f32_16x16x32_bf16 v[196:199], a[36:39], v[80:83], v[196:199]
    ds_read_b128 v[112:115], v159 offset:25600
    s_add_u32 m0, s73, 16384
    s_mul_i32 s14, s26, 589824
    v_mfma_f32_16x16x32_bf16 v[204:207], a[36:39], v[88:91], v[204:207]
    ds_read_b128 v[116:119], v159 offset:31744
    v_mfma_f32_16x16x32_bf16 v[204:207], a[44:47], v[92:95], v[204:207]
    ds_read_b128 v[120:123], v159 offset:25856
    buffer_load_dwordx4 v148, s[48:51], s14 offen offset:0 lds
    v_mfma_f32_16x16x32_bf16 v[200:203], a[40:43], v[92:95], v[200:203]
    ds_read_b128 v[124:127], v159 offset:32000
    buffer_load_dwordx4 v149, s[48:51], s14 offen offset:1024 lds
    s_lshr_b64 s[4:5], s[4:5], s7
    s_and_b32 s4, s4, 15
    s_lshl4_add_u32 s4, s8, s4
    v_lshl_add_u32 v242, s4, 8, v245
    s_mul_i32 s7, s70, 6
    s_add_u32 s7, s7, 3
    s_mul_i32 s8, s7, 7282
    s_lshr_b32 s8, s8, 16
    s_mul_i32 s5, s8, 9
    s_sub_u32 s7, s7, s5
    s_lshl_b32 s7, s7, 2
    s_mov_b32 s4, 0xeca86420
    s_mov_b32 s5, 3
    s_lshr_b64 s[4:5], s[4:5], s7
    s_and_b32 s4, s4, 15
    s_lshl4_add_u32 s4, s8, s4
    v_lshl_add_u32 v243, s4, 8, v245
    s_mul_i32 s7, s70, 6
    s_add_u32 s7, s7, 4
    s_mul_i32 s8, s7, 7282
    s_lshr_b32 s8, s8, 16
    s_mul_i32 s5, s8, 9
    s_sub_u32 s7, s7, s5
    s_lshl_b32 s7, s7, 2
    s_mov_b32 s4, 0xeca86420
    v_mfma_f32_16x16x32_bf16 v[200:203], a[32:35], v[88:91], v[200:203]
    ds_read_b64_tr_b16 a[104:105], v154 offset:8192
    v_mfma_f32_16x16x32_bf16 v[208:211], a[32:35], v[96:99], v[208:211]
    ds_read_b64_tr_b16 a[106:107], v154 offset:9216
    buffer_load_dwordx4 v150, s[48:51], s14 offen offset:2048 lds
    v_mfma_f32_16x16x32_bf16 v[208:211], a[40:43], v[100:103], v[208:211]
    v_mfma_f32_16x16x32_bf16 v[212:215], a[44:47], v[100:103], v[212:215]
    ds_read_b64_tr_b16 a[108:109], v155 offset:8192
    buffer_load_dwordx4 v151, s[48:51], s14 offen offset:3072 lds
    v_mfma_f32_16x16x32_bf16 v[212:215], a[36:39], v[96:99], v[212:215]
    ds_read_b64_tr_b16 a[110:111], v155 offset:9216
    s_waitcnt lgkmcnt(4)
    v_mfma_f32_16x16x32_bf16 v[220:223], a[36:39], v[104:107], v[220:223]
    s_waitcnt vmcnt(20)
    s_barrier
    v_mfma_f32_16x16x32_bf16 v[220:223], a[44:47], v[108:111], v[220:223]
    ds_read_b128 v[80:83], v250 offset:0
    s_add_u32 m0, s74, 24576
    s_mul_i32 s13, s26, 90112
    v_mfma_f32_16x16x32_bf16 v[216:219], a[40:43], v[108:111], v[216:219]
    ds_read_b128 v[84:87], v250 offset:6144
    v_mfma_f32_16x16x32_bf16 v[216:219], a[32:35], v[104:107], v[216:219]
    ds_read_b128 v[88:91], v250 offset:256
    buffer_load_dwordx4 v156, s[44:47], s13 offen offset:0 sc1 lds
    v_mfma_f32_16x16x32_bf16 v[224:227], a[32:35], v[112:115], v[224:227]
    ds_read_b128 v[92:95], v250 offset:6400
    v_mfma_f32_16x16x32_bf16 v[224:227], a[40:43], v[116:119], v[224:227]
    ds_read_b128 v[96:99], v250 offset:512
    v_mfma_f32_16x16x32_bf16 v[228:231], a[44:47], v[116:119], v[228:231]
    ds_read_b128 v[100:103], v250 offset:6656
    buffer_load_dwordx4 v157, s[44:47], s13 offen offset:1024 sc1 lds
    s_mov_b32 s5, 3
    s_lshr_b64 s[4:5], s[4:5], s7
    s_and_b32 s4, s4, 15
    s_lshl4_add_u32 s4, s8, s4
    v_lshl_add_u32 v244, s4, 8, v245
    s_mul_i32 s7, s70, 6
    s_add_u32 s7, s7, 5
    s_mul_i32 s8, s7, 7282
    s_lshr_b32 s8, s8, 16
    s_mul_i32 s5, s8, 9
    s_sub_u32 s7, s7, s5
    s_lshl_b32 s7, s7, 2
    s_mov_b32 s4, 0xeca86420
    s_mov_b32 s5, 3
    s_lshr_b64 s[4:5], s[4:5], s7
    s_and_b32 s4, s4, 15
    s_lshl4_add_u32 s4, s8, s4
    v_lshl_add_u32 v245, s4, 8, v245
    s_xor_b32 s7, s75, 1
    s_lshl2_add_u32 s7, s7, s3
    s_mul_i32 s9, s7, 6144
    s_add_u32 s9, s9, 7077888
    s_lshl_b32 s7, s7, 7
    s_add_u32 s6, s7, 22822912
    s_lshl2_add_u32 s7, s75, s3
    s_mul_i32 s10, s7, 6144
    s_add_u32 s10, s10, 7077888
    s_lshl_b32 s7, s7, 7
    v_mfma_f32_16x16x32_bf16 v[228:231], a[36:39], v[112:115], v[228:231]
    v_mfma_f32_16x16x32_bf16 v[236:239], a[36:39], v[120:123], v[236:239]
    v_mfma_f32_16x16x32_bf16 v[236:239], a[44:47], v[124:127], v[236:239]
    buffer_load_dwordx4 v158, s[44:47], s13 offen offset:2048 sc1 lds
    v_mfma_f32_16x16x32_bf16 v[232:235], a[40:43], v[124:127], v[232:235]
    v_mfma_f32_16x16x32_bf16 v[232:235], a[32:35], v[120:123], v[232:235]
    s_waitcnt lgkmcnt(0)
    v_mfma_f32_16x16x32_bf16 v[192:195], a[48:51], v[80:83], v[192:195]
    s_add_u32 m0, s73, 32768
    s_mul_i32 s14, s27, 589824
    v_mfma_f32_16x16x32_bf16 v[192:195], a[56:59], v[84:87], v[192:195]
    ds_read_b128 v[104:107], v250 offset:768
    v_mfma_f32_16x16x32_bf16 v[196:199], a[60:63], v[84:87], v[196:199]
    ds_read_b128 v[108:111], v250 offset:6912
    buffer_load_dwordx4 v148, s[48:51], s14 offen offset:0 lds
    v_mfma_f32_16x16x32_bf16 v[196:199], a[52:55], v[80:83], v[196:199]
    ds_read_b128 v[112:115], v250 offset:1024
    v_mfma_f32_16x16x32_bf16 v[204:207], a[52:55], v[88:91], v[204:207]
    ds_read_b128 v[116:119], v250 offset:7168
    buffer_load_dwordx4 v149, s[48:51], s14 offen offset:1024 lds
    v_mfma_f32_16x16x32_bf16 v[204:207], a[60:63], v[92:95], v[204:207]
    ds_read_b128 v[120:123], v250 offset:1280
    v_mfma_f32_16x16x32_bf16 v[200:203], a[56:59], v[92:95], v[200:203]
    ds_read_b128 v[124:127], v250 offset:7424
    s_add_u32 s7, s7, 22822912
    v_mov_b32 v28, s7
    v_add_u32 v247, 3072, v246
    v_cmp_eq_u32 vcc, 0, v2
    v_mov_b32 v248, 0x40000000
    s_nop 0
    v_cndmask_b32 v248, v248, 0, vcc
    v_mov_b32 v249, s68
    v_and_b32 v129, 0xffff0000, v144
    v_lshlrev_b32 v128, 16, v144
    v_and_b32 v131, 0xffff0000, v145
    v_lshlrev_b32 v130, 16, v145
    v_and_b32 v133, 0xffff0000, v146
    v_lshlrev_b32 v132, 16, v146
    v_and_b32 v135, 0xffff0000, v147
    v_lshlrev_b32 v134, 16, v147
    s_mul_i32 s4, s70, 43691
    s_lshr_b32 s4, s4, 16
    s_mul_i32 s5, s70, 21846
    s_lshr_b32 s5, s5, 16
    s_mul_i32 s5, s5, 3
    s_sub_u32 s5, s70, s5
    v_mfma_f32_16x16x32_bf16 v[200:203], a[48:51], v[88:91], v[200:203]
    buffer_load_dwordx4 v150, s[48:51], s14 offen offset:2048 lds
    v_mfma_f32_16x16x32_bf16 v[208:211], a[48:51], v[96:99], v[208:211]
    v_mfma_f32_16x16x32_bf16 v[208:211], a[56:59], v[100:103], v[208:211]
    buffer_load_dwordx4 v151, s[48:51], s14 offen offset:3072 lds
    v_mfma_f32_16x16x32_bf16 v[212:215], a[60:63], v[100:103], v[212:215]
    v_mfma_f32_16x16x32_bf16 v[212:215], a[52:55], v[96:99], v[212:215]
    s_waitcnt lgkmcnt(0)
    v_mfma_f32_16x16x32_bf16 v[220:223], a[52:55], v[104:107], v[220:223]
    s_waitcnt vmcnt(17)
    s_barrier
    v_mfma_f32_16x16x32_bf16 v[220:223], a[60:63], v[108:111], v[220:223]
    ds_read_b128 v[80:83], v250 offset:12288
    s_add_u32 m0, s74, 36864
    s_mul_i32 s13, s27, 90112
    v_mfma_f32_16x16x32_bf16 v[216:219], a[56:59], v[108:111], v[216:219]
    ds_read_b128 v[84:87], v250 offset:18432
    v_mfma_f32_16x16x32_bf16 v[216:219], a[48:51], v[104:107], v[216:219]
    ds_read_b128 v[88:91], v250 offset:12544
    buffer_load_dwordx4 v156, s[44:47], s13 offen offset:0 sc1 lds
    v_mfma_f32_16x16x32_bf16 v[224:227], a[48:51], v[112:115], v[224:227]
    ds_read_b128 v[92:95], v250 offset:18688
    v_mfma_f32_16x16x32_bf16 v[224:227], a[56:59], v[116:119], v[224:227]
    ds_read_b128 v[96:99], v250 offset:12800
    v_mfma_f32_16x16x32_bf16 v[228:231], a[60:63], v[116:119], v[228:231]
    ds_read_b128 v[100:103], v250 offset:18944
    buffer_load_dwordx4 v157, s[44:47], s13 offen offset:1024 sc1 lds
    s_lshl2_add_u32 s4, s72, s4
    s_lshl_b32 s4, s4, 10
    s_mul_i32 s7, s72, 9
    s_sub_u32 s7, s69, s7
    s_lshl3_add_u32 s4, s7, s4
    s_add_u32 s4, s4, 12566528
    s_cmp_eq_u32 s5, 1
    s_cselect_b32 s7, 16, 8
    s_cmp_lg_u32 s5, 0
    s_cselect_b32 s5, 4, 0
    v_lshlrev_b32 v17, 7, v0
    v_add_u32 v17, s4, v17
    v_cmp_gt_u32 vcc, 8, v0
    v_mov_b32 v24, s5
    s_nop 0
    v_cndmask_b32 v24, 0, v24, vcc
    v_add_u32 v17, v17, v24
    v_cmp_gt_u32 vcc, s7, v0
    v_mov_b32 v24, 0x40000000
    s_nop 0
    v_cndmask_b32 v17, v24, v17, vcc
    s_bfe_u32 s4, s2, 0x20003
    s_lshl2_add_u32 s4, s72, s4
    s_lshl_b32 s4, s4, 3
    s_lshr_b32 s5, s2, 4
    v_mfma_f32_16x16x32_bf16 v[228:231], a[52:55], v[112:115], v[228:231]
    ds_read_b64_tr_b16 a[112:113], v152 offset:0
    v_mfma_f32_16x16x32_bf16 v[236:239], a[52:55], v[120:123], v[236:239]
    ds_read_b64_tr_b16 a[114:115], v152 offset:1024
    v_mfma_f32_16x16x32_bf16 v[236:239], a[60:63], v[124:127], v[236:239]
    buffer_load_dwordx4 v158, s[44:47], s13 offen offset:2048 sc1 lds
    v_mfma_f32_16x16x32_bf16 v[232:235], a[56:59], v[124:127], v[232:235]
    ds_read_b64_tr_b16 a[116:117], v153 offset:0
    v_mfma_f32_16x16x32_bf16 v[232:235], a[48:51], v[120:123], v[232:235]
    ds_read_b64_tr_b16 a[118:119], v153 offset:1024
    s_waitcnt lgkmcnt(4)
    v_mfma_f32_16x16x32_bf16 v[192:195], a[64:67], v[80:83], v[192:195]
    s_add_u32 m0, s73, 49152
    s_mul_i32 s14, s76, 589824
    v_mfma_f32_16x16x32_bf16 v[192:195], a[72:75], v[84:87], v[192:195]
    ds_read_b128 v[104:107], v250 offset:13056
    v_mfma_f32_16x16x32_bf16 v[196:199], a[76:79], v[84:87], v[196:199]
    ds_read_b128 v[108:111], v250 offset:19200
    buffer_load_dwordx4 v148, s[48:51], s14 offen offset:0 lds
    v_mfma_f32_16x16x32_bf16 v[196:199], a[68:71], v[80:83], v[196:199]
    ds_read_b128 v[112:115], v250 offset:13312
    v_mfma_f32_16x16x32_bf16 v[204:207], a[68:71], v[88:91], v[204:207]
    ds_read_b128 v[116:119], v250 offset:19456
    buffer_load_dwordx4 v149, s[48:51], s14 offen offset:1024 lds
    v_mfma_f32_16x16x32_bf16 v[204:207], a[76:79], v[92:95], v[204:207]
    ds_read_b128 v[120:123], v250 offset:13568
    v_mfma_f32_16x16x32_bf16 v[200:203], a[72:75], v[92:95], v[200:203]
    ds_read_b128 v[124:127], v250 offset:19712
    s_and_b32 s5, s5, 6
    s_add_u32 s4, s4, s5
    s_and_b32 s5, s2, 1
    s_add_u32 s4, s4, s5
    s_lshl_b32 s4, s4, 7
    s_add_u32 s4, s4, 12566528
    v_lshl_add_u32 v15, v2, 2, s4
L_pl_G_2:
    s_cbranch_execz L_pl_G_6
    s_cmp_eq_u32 s3, 0
    s_cselect_b32 s4, 18, 0
    v_cmp_gt_u32 vcc, s4, v2
    v_mov_b32 v13, 0x40000000
    s_nop 0
    v_cndmask_b32 v15, v13, v15, vcc
    v_mov_b32 v13, s68
    v_cndmask_b32 v13, 0, v13, vcc
    v_and_b32 v24, 15, v2
    v_lshrrev_b32 v25, 4, v2
    v_mul_u32_u24 v25, 17408, v25
    v_lshl_add_u32 v24, v24, 4, v25
    s_mul_i32 s7, s72, 36
    s_and_b32 s8, s3, 1
    v_mfma_f32_16x16x32_bf16 v[200:203], a[64:67], v[88:91], v[200:203]
    ds_read_b64_tr_b16 a[120:121], v152 offset:8192
    buffer_load_dwordx4 v150, s[48:51], s14 offen offset:2048 lds
    v_mfma_f32_16x16x32_bf16 v[208:211], a[64:67], v[96:99], v[208:211]
    ds_read_b64_tr_b16 a[122:123], v152 offset:9216
    v_mfma_f32_16x16x32_bf16 v[208:211], a[72:75], v[100:103], v[208:211]
    buffer_load_dwordx4 v151, s[48:51], s14 offen offset:3072 lds
    v_mfma_f32_16x16x32_bf16 v[212:215], a[76:79], v[100:103], v[212:215]
    ds_read_b64_tr_b16 a[124:125], v153 offset:8192
    v_mfma_f32_16x16x32_bf16 v[212:215], a[68:71], v[96:99], v[212:215]
    ds_read_b64_tr_b16 a[126:127], v153 offset:9216
    s_waitcnt lgkmcnt(4)
    v_mfma_f32_16x16x32_bf16 v[220:223], a[68:71], v[104:107], v[220:223]
    s_waitcnt vmcnt(14)
    s_barrier
    v_mfma_f32_16x16x32_bf16 v[220:223], a[76:79], v[108:111], v[220:223]
    ds_read_b128 v[80:83], v250 offset:24576
    s_add_u32 m0, s74, 49152
    s_mul_i32 s13, s76, 90112
    v_mfma_f32_16x16x32_bf16 v[216:219], a[72:75], v[108:111], v[216:219]
    ds_read_b128 v[84:87], v250 offset:30720
    v_mfma_f32_16x16x32_bf16 v[216:219], a[64:67], v[104:107], v[216:219]
    ds_read_b128 v[88:91], v250 offset:24832
    buffer_load_dwordx4 v156, s[44:47], s13 offen offset:0 sc1 lds
    v_mfma_f32_16x16x32_bf16 v[224:227], a[64:67], v[112:115], v[224:227]
    ds_read_b128 v[92:95], v250 offset:30976
    v_mfma_f32_16x16x32_bf16 v[224:227], a[72:75], v[116:119], v[224:227]
    ds_read_b128 v[96:99], v250 offset:25088
    v_mfma_f32_16x16x32_bf16 v[228:231], a[76:79], v[116:119], v[228:231]
    ds_read_b128 v[100:103], v250 offset:31232
    buffer_load_dwordx4 v157, s[44:47], s13 offen offset:1024 sc1 lds
    s_add_u32 s7, s7, s8
    s_mul_i32 s7, s7, 69632
    s_bfe_u32 s8, s2, 0x20003
    s_lshl_b32 s8, s8, 12
    s_add_u32 s7, s7, s8
    s_add_u32 s7, s7, 12795904
    v_add_u32 v23, s7, v24
    s_xor_b32 s7, s72, 0
    v_lshl_add_u32 v19, s7, 10, v23
    s_xor_b32 s7, s72, 1
    v_lshl_add_u32 v20, s7, 10, v23
    s_xor_b32 s7, s72, 2
    v_lshl_add_u32 v21, s7, 10, v23
    s_xor_b32 s7, s72, 3
    v_lshl_add_u32 v22, s7, 10, v23
    v_lshlrev_b32 v14, 4, v2
    v_add_u32 v14, 98304, v14
    v_mfma_f32_16x16x32_bf16 v[228:231], a[68:71], v[112:115], v[228:231]
    ds_read_b64_tr_b16 a[128:129], v152 offset:16384
    v_mfma_f32_16x16x32_bf16 v[236:239], a[68:71], v[120:123], v[236:239]
    ds_read_b64_tr_b16 a[130:131], v152 offset:17408
    v_mfma_f32_16x16x32_bf16 v[236:239], a[76:79], v[124:127], v[236:239]
    buffer_load_dwordx4 v158, s[44:47], s13 offen offset:2048 sc1 lds
    v_mfma_f32_16x16x32_bf16 v[232:235], a[72:75], v[124:127], v[232:235]
    ds_read_b64_tr_b16 a[132:133], v153 offset:16384
    v_mfma_f32_16x16x32_bf16 v[232:235], a[64:67], v[120:123], v[232:235]
    ds_read_b64_tr_b16 a[134:135], v153 offset:17408
    s_waitcnt lgkmcnt(4)
    v_mfma_f32_16x16x32_bf16 v[192:195], a[80:83], v[80:83], v[192:195]
    s_add_u32 m0, s73, 65536
    s_mul_i32 s14, s77, 589824
    v_mfma_f32_16x16x32_bf16 v[192:195], a[88:91], v[84:87], v[192:195]
    ds_read_b128 v[104:107], v250 offset:25344
    v_mfma_f32_16x16x32_bf16 v[196:199], a[92:95], v[84:87], v[196:199]
    ds_read_b128 v[108:111], v250 offset:31488
    buffer_load_dwordx4 v148, s[48:51], s14 offen offset:0 lds
    v_mfma_f32_16x16x32_bf16 v[196:199], a[84:87], v[80:83], v[196:199]
    ds_read_b128 v[112:115], v250 offset:25600
    v_mfma_f32_16x16x32_bf16 v[204:207], a[84:87], v[88:91], v[204:207]
    ds_read_b128 v[116:119], v250 offset:31744
    buffer_load_dwordx4 v149, s[48:51], s14 offen offset:1024 lds
    v_mfma_f32_16x16x32_bf16 v[204:207], a[92:95], v[92:95], v[204:207]
    ds_read_b128 v[120:123], v250 offset:25856
    v_mfma_f32_16x16x32_bf16 v[200:203], a[88:91], v[92:95], v[200:203]
    ds_read_b128 v[124:127], v250 offset:32000
    v_add_u32 v1, 0x10000, v14
    s_mov_b32 s56, s16
    s_and_b32 s57, s17, 0xffff
    s_mov_b32 s58, 2359296
    s_mov_b32 s59, 0x20000
    s_mov_b32 s40, 18432
    s_mov_b32 s42, 12386304
    s_mov_b32 s64, s38
    s_and_b32 s65, s39, 0xffff
    s_mov_b32 s66, 2359296
    s_mov_b32 s67, 0x20000
    v_lshlrev_b32 v136, 4, v2
    s_mul_i32 s7, s72, 36
    s_bitcmp1_b32 s3, 0
    s_addc_u32 s7, s7, 0
    s_lshl_b32 s7, s7, 17
    v_subrev_u32 v184, s7, v4
    v_subrev_u32 v185, s7, v5
    v_mfma_f32_16x16x32_bf16 v[200:203], a[80:83], v[88:91], v[200:203]
    ds_read_b64_tr_b16 a[136:137], v152 offset:24576
    buffer_load_dwordx4 v150, s[48:51], s14 offen offset:2048 lds
    v_mfma_f32_16x16x32_bf16 v[208:211], a[80:83], v[96:99], v[208:211]
    ds_read_b64_tr_b16 a[138:139], v152 offset:25600
    v_mfma_f32_16x16x32_bf16 v[208:211], a[88:91], v[100:103], v[208:211]
    buffer_load_dwordx4 v151, s[48:51], s14 offen offset:3072 lds
    v_mfma_f32_16x16x32_bf16 v[212:215], a[92:95], v[100:103], v[212:215]
    ds_read_b64_tr_b16 a[140:141], v153 offset:24576
    v_mfma_f32_16x16x32_bf16 v[212:215], a[84:87], v[96:99], v[212:215]
    ds_read_b64_tr_b16 a[142:143], v153 offset:25600
    s_waitcnt lgkmcnt(4)
    v_mfma_f32_16x16x32_bf16 v[220:223], a[84:87], v[104:107], v[220:223]
    s_waitcnt vmcnt(14)
    s_barrier
    v_mfma_f32_16x16x32_bf16 v[220:223], a[92:95], v[108:111], v[220:223]
    ds_read_b128 v[80:83], v159 offset:0
    s_add_u32 m0, s74, 61440
    s_mul_i32 s13, s77, 90112
    v_mfma_f32_16x16x32_bf16 v[216:219], a[88:91], v[108:111], v[216:219]
    ds_read_b128 v[84:87], v159 offset:6144
    v_mfma_f32_16x16x32_bf16 v[216:219], a[80:83], v[104:107], v[216:219]
    ds_read_b128 v[88:91], v159 offset:256
    buffer_load_dwordx4 v156, s[44:47], s13 offen offset:0 sc1 lds
    v_mfma_f32_16x16x32_bf16 v[224:227], a[80:83], v[112:115], v[224:227]
    ds_read_b128 v[92:95], v159 offset:6400
    v_mfma_f32_16x16x32_bf16 v[224:227], a[88:91], v[116:119], v[224:227]
    ds_read_b128 v[96:99], v159 offset:512
    v_mfma_f32_16x16x32_bf16 v[228:231], a[92:95], v[116:119], v[228:231]
    ds_read_b128 v[100:103], v159 offset:6656
    buffer_load_dwordx4 v157, s[44:47], s13 offen offset:1024 sc1 lds
    s_bfe_u32 s4, s2, 0x20003
    s_mul_i32 s4, s4, 9
    s_lshl1_add_u32 s7, s72, s4
    s_and_b32 s8, s3, 1
    s_add_u32 s7, s7, s8
    s_lshl_b32 s37, s7, 16
    s_add_u32 s37, s37, 4718592
    s_add_u32 s4, s4, 8
    s_lshl_b32 s16, s4, 16
    s_add_u32 s16, s16, 4718592
    s_sub_u32 s4, s4, s7
    s_lshl_b32 s4, s4, 7
    s_lshl_b32 s7, s7, 7
    s_add_u32 s7, s7, 12582912
    v_bfe_u32 v24, v2, 2, 1
    v_mfma_f32_16x16x32_bf16 v[228:231], a[84:87], v[112:115], v[228:231]
    ds_read_b64_tr_b16 a[144:145], v152 offset:32768
    v_mfma_f32_16x16x32_bf16 v[236:239], a[84:87], v[120:123], v[236:239]
    ds_read_b64_tr_b16 a[146:147], v152 offset:33792
    v_mfma_f32_16x16x32_bf16 v[236:239], a[92:95], v[124:127], v[236:239]
    buffer_load_dwordx4 v158, s[44:47], s13 offen offset:2048 sc1 lds
    v_mfma_f32_16x16x32_bf16 v[232:235], a[88:91], v[124:127], v[232:235]
    ds_read_b64_tr_b16 a[148:149], v153 offset:32768
    v_mfma_f32_16x16x32_bf16 v[232:235], a[80:83], v[120:123], v[232:235]
    ds_read_b64_tr_b16 a[150:151], v153 offset:33792
    s_waitcnt lgkmcnt(4)
    v_mfma_f32_16x16x32_bf16 v[192:195], a[96:99], v[80:83], v[192:195]
    s_add_u32 m0, s73, 0
    s_mul_i32 s14, s78, 589824
    v_mfma_f32_16x16x32_bf16 v[192:195], a[104:107], v[84:87], v[192:195]
    ds_read_b128 v[104:107], v159 offset:768
    v_mfma_f32_16x16x32_bf16 v[196:199], a[108:111], v[84:87], v[196:199]
    ds_read_b128 v[108:111], v159 offset:6912
    buffer_load_dwordx4 v148, s[48:51], s14 offen offset:0 lds
    v_mfma_f32_16x16x32_bf16 v[196:199], a[100:103], v[80:83], v[196:199]
    ds_read_b128 v[112:115], v159 offset:1024
    v_mfma_f32_16x16x32_bf16 v[204:207], a[100:103], v[88:91], v[204:207]
    ds_read_b128 v[116:119], v159 offset:7168
    buffer_load_dwordx4 v149, s[48:51], s14 offen offset:1024 lds
    v_mfma_f32_16x16x32_bf16 v[204:207], a[108:111], v[92:95], v[204:207]
    ds_read_b128 v[120:123], v159 offset:1280
    v_mfma_f32_16x16x32_bf16 v[200:203], a[104:107], v[92:95], v[200:203]
    ds_read_b128 v[124:127], v159 offset:7424
    v_mul_u32_u24 v24, s4, v24
    v_and_b32 v25, 3, v2
    v_lshl_add_u32 v24, v25, 2, v24
    v_add_u32 v188, s7, v24
    s_lshl2_add_u32 s7, s2, s3
    s_mul_i32 s8, s7, 3072
    s_add_u32 s34, s8, 22953984
    s_add_u32 s11, s8, 26099712
    s_add_u32 s12, s8, 29245440
    s_lshl_b32 s35, s7, 12
    s_add_u32 s35, s35, 32391168
    s_xor_b32 s8, s7, 8
    s_mul_i32 s8, s8, 3072
    s_add_u32 s30, s8, 22953984
    v_mfma_f32_16x16x32_bf16 v[200:203], a[96:99], v[88:91], v[200:203]
    ds_read_b64_tr_b16 a[152:153], v152 offset:40960
    buffer_load_dwordx4 v150, s[48:51], s14 offen offset:2048 lds
    v_mfma_f32_16x16x32_bf16 v[208:211], a[96:99], v[96:99], v[208:211]
    ds_read_b64_tr_b16 a[154:155], v152 offset:41984
    v_mfma_f32_16x16x32_bf16 v[208:211], a[104:107], v[100:103], v[208:211]
    buffer_load_dwordx4 v151, s[48:51], s14 offen offset:3072 lds
    v_mfma_f32_16x16x32_bf16 v[212:215], a[108:111], v[100:103], v[212:215]
    ds_read_b64_tr_b16 a[156:157], v153 offset:40960
    v_mfma_f32_16x16x32_bf16 v[212:215], a[100:103], v[96:99], v[212:215]
    ds_read_b64_tr_b16 a[158:159], v153 offset:41984
    s_waitcnt lgkmcnt(4)
    v_mfma_f32_16x16x32_bf16 v[220:223], a[100:103], v[104:107], v[220:223]
    s_waitcnt vmcnt(14)
    s_barrier
    v_mfma_f32_16x16x32_bf16 v[220:223], a[108:111], v[108:111], v[220:223]
    ds_read_b128 v[80:83], v159 offset:12288
    s_add_u32 m0, s74, 0
    s_mul_i32 s13, s78, 90112
    v_mfma_f32_16x16x32_bf16 v[216:219], a[104:107], v[108:111], v[216:219]
    ds_read_b128 v[84:87], v159 offset:18432
    v_mfma_f32_16x16x32_bf16 v[216:219], a[96:99], v[104:107], v[216:219]
    ds_read_b128 v[88:91], v159 offset:12544
    buffer_load_dwordx4 v156, s[44:47], s13 offen offset:0 sc1 lds
    v_mfma_f32_16x16x32_bf16 v[224:227], a[96:99], v[112:115], v[224:227]
    ds_read_b128 v[92:95], v159 offset:18688
    v_mfma_f32_16x16x32_bf16 v[224:227], a[104:107], v[116:119], v[224:227]
    ds_read_b128 v[96:99], v159 offset:12800
    v_mfma_f32_16x16x32_bf16 v[228:231], a[108:111], v[116:119], v[228:231]
    ds_read_b128 v[100:103], v159 offset:18944
    buffer_load_dwordx4 v157, s[44:47], s13 offen offset:1024 sc1 lds
    s_xor_b32 s8, s7, 16
    s_mul_i32 s8, s8, 3072
    s_add_u32 s15, s8, 26099712
    s_xor_b32 s8, s7, 24
    s_mul_i32 s8, s8, 3072
    s_add_u32 s31, s8, 29245440
    s_andn2_b32 s7, s7, 24
    s_lshl3_add_u32 s7, s3, s7
    s_lshl2_add_u32 s8, s7, s72
    s_lshl_b32 s8, s8, 10
    s_add_u32 s32, s8, 32391168
    s_xor_b32 s8, s8, 4096
    v_mfma_f32_16x16x32_bf16 v[228:231], a[100:103], v[112:115], v[228:231]
    ds_read_b64_tr_b16 a[160:161], v152 offset:49152
    v_mfma_f32_16x16x32_bf16 v[236:239], a[100:103], v[120:123], v[236:239]
    ds_read_b64_tr_b16 a[162:163], v152 offset:50176
    v_mfma_f32_16x16x32_bf16 v[236:239], a[108:111], v[124:127], v[236:239]
    buffer_load_dwordx4 v158, s[44:47], s13 offen offset:2048 sc1 lds
    v_mfma_f32_16x16x32_bf16 v[232:235], a[104:107], v[124:127], v[232:235]
    ds_read_b64_tr_b16 a[164:165], v153 offset:49152
    v_mfma_f32_16x16x32_bf16 v[232:235], a[96:99], v[120:123], v[232:235]
    ds_read_b64_tr_b16 a[166:167], v153 offset:50176
    s_waitcnt lgkmcnt(4)
    v_mfma_f32_16x16x32_bf16 v[192:195], a[112:115], v[80:83], v[192:195]
    s_add_u32 m0, s73, 16384
    s_mul_i32 s14, s79, 589824
    v_mfma_f32_16x16x32_bf16 v[192:195], a[120:123], v[84:87], v[192:195]
    ds_read_b128 v[104:107], v159 offset:13056
    v_mfma_f32_16x16x32_bf16 v[196:199], a[124:127], v[84:87], v[196:199]
    ds_read_b128 v[108:111], v159 offset:19200
    buffer_load_dwordx4 v148, s[48:51], s14 offen offset:0 lds
    v_mfma_f32_16x16x32_bf16 v[196:199], a[116:119], v[80:83], v[196:199]
    ds_read_b128 v[112:115], v159 offset:13312
    v_mfma_f32_16x16x32_bf16 v[204:207], a[116:119], v[88:91], v[204:207]
    ds_read_b128 v[116:119], v159 offset:19456
    buffer_load_dwordx4 v149, s[48:51], s14 offen offset:1024 lds
    v_mfma_f32_16x16x32_bf16 v[204:207], a[124:127], v[92:95], v[204:207]
    ds_read_b128 v[120:123], v159 offset:13568
    v_mfma_f32_16x16x32_bf16 v[200:203], a[120:123], v[92:95], v[200:203]
    ds_read_b128 v[124:127], v159 offset:19712
    s_add_u32 s33, s8, 32391168
    s_xor_b32 s8, s3, s72
    s_cmp_lt_u32 s8, 2
    s_cselect_b32 s35, s35, 0x40000000
    s_cselect_b32 s16, s16, 0x40000000
    s_cselect_b32 s36, s68, 0
    s_mov_b32 s38, 0xbfb8aa3b
    s_and_b32 s8, s8, 1
    s_mul_i32 s41, s8, 96
    s_and_b32 s43, s73, 4096
    v_lshlrev_b32 v24, 10, v2
    v_add_u32 v24, s35, v24
    s_add_u32 s7, s34, 2048
    v_mov_b32 v25, s36
    v_mfma_f32_16x16x32_bf16 v[200:203], a[112:115], v[88:91], v[200:203]
    ds_read_b64_tr_b16 a[168:169], v152 offset:57344
    buffer_load_dwordx4 v150, s[48:51], s14 offen offset:2048 lds
    v_mfma_f32_16x16x32_bf16 v[208:211], a[112:115], v[96:99], v[208:211]
    ds_read_b64_tr_b16 a[170:171], v152 offset:58368
    v_mfma_f32_16x16x32_bf16 v[208:211], a[120:123], v[100:103], v[208:211]
    buffer_load_dwordx4 v151, s[48:51], s14 offen offset:3072 lds
    v_mfma_f32_16x16x32_bf16 v[212:215], a[124:127], v[100:103], v[212:215]
    ds_read_b64_tr_b16 a[172:173], v153 offset:57344
    v_mfma_f32_16x16x32_bf16 v[212:215], a[116:119], v[96:99], v[212:215]
    ds_read_b64_tr_b16 a[174:175], v153 offset:58368
    s_waitcnt lgkmcnt(4)
    v_mfma_f32_16x16x32_bf16 v[220:223], a[116:119], v[104:107], v[220:223]
    s_waitcnt vmcnt(14)
    s_barrier
    v_mfma_f32_16x16x32_bf16 v[220:223], a[124:127], v[108:111], v[220:223]
    ds_read_b128 v[80:83], v159 offset:24576
    s_add_u32 m0, s74, 12288
    s_mul_i32 s13, s79, 90112
    v_mfma_f32_16x16x32_bf16 v[216:219], a[120:123], v[108:111], v[216:219]
    ds_read_b128 v[84:87], v159 offset:30720
    v_mfma_f32_16x16x32_bf16 v[216:219], a[112:115], v[104:107], v[216:219]
    ds_read_b128 v[88:91], v159 offset:24832
    buffer_load_dwordx4 v156, s[44:47], s13 offen offset:0 sc1 lds
    v_mfma_f32_16x16x32_bf16 v[224:227], a[112:115], v[112:115], v[224:227]
    ds_read_b128 v[92:95], v159 offset:30976
    v_mfma_f32_16x16x32_bf16 v[224:227], a[120:123], v[116:119], v[224:227]
    ds_read_b128 v[96:99], v159 offset:25088
    v_mfma_f32_16x16x32_bf16 v[228:231], a[124:127], v[116:119], v[228:231]
    ds_read_b128 v[100:103], v159 offset:31232
    buffer_load_dwordx4 v157, s[44:47], s13 offen offset:1024 sc1 lds
    v_cmp_gt_u32 vcc, 4, v2
    s_nop 1
    v_cndmask_b32 v138, 0, v25, vcc
    v_mov_b32 v25, 0x40000000
    v_cndmask_b32 v137, v25, v24, vcc
    v_writelane_b32 v137, s7, 4
    v_writelane_b32 v138, s68, 4
    v_min_u32 v139, 1, v2
    v_lshlrev_b32 v139, 30, v139
    v_mov_b32 v140, 0
    v_writelane_b32 v140, s68, 0
    v_mfma_f32_16x16x32_bf16 v[228:231], a[116:119], v[112:115], v[228:231]
    ds_read_b64_tr_b16 a[176:177], v154 offset:0
    v_mfma_f32_16x16x32_bf16 v[236:239], a[116:119], v[120:123], v[236:239]
    ds_read_b64_tr_b16 a[178:179], v154 offset:1024
    v_mfma_f32_16x16x32_bf16 v[236:239], a[124:127], v[124:127], v[236:239]
    buffer_load_dwordx4 v158, s[44:47], s13 offen offset:2048 sc1 lds
    v_mfma_f32_16x16x32_bf16 v[232:235], a[120:123], v[124:127], v[232:235]
    ds_read_b64_tr_b16 a[180:181], v155 offset:0
    v_mfma_f32_16x16x32_bf16 v[232:235], a[112:115], v[120:123], v[232:235]
    ds_read_b64_tr_b16 a[182:183], v155 offset:1024
    s_waitcnt lgkmcnt(4)
    v_mfma_f32_16x16x32_bf16 v[192:195], a[128:131], v[80:83], v[192:195]
    s_add_u32 m0, s73, 32768
    s_mul_i32 s14, s80, 589824
    v_mfma_f32_16x16x32_bf16 v[192:195], a[136:139], v[84:87], v[192:195]
    ds_read_b128 v[104:107], v159 offset:25344
    v_mfma_f32_16x16x32_bf16 v[196:199], a[140:143], v[84:87], v[196:199]
    ds_read_b128 v[108:111], v159 offset:31488
    buffer_load_dwordx4 v148, s[48:51], s14 offen offset:0 lds
    v_mfma_f32_16x16x32_bf16 v[196:199], a[132:135], v[80:83], v[196:199]
    ds_read_b128 v[112:115], v159 offset:25600
    v_mfma_f32_16x16x32_bf16 v[204:207], a[132:135], v[88:91], v[204:207]
    ds_read_b128 v[116:119], v159 offset:31744
    buffer_load_dwordx4 v149, s[48:51], s14 offen offset:1024 lds
    v_mfma_f32_16x16x32_bf16 v[204:207], a[140:143], v[92:95], v[204:207]
    ds_read_b128 v[120:123], v159 offset:25856
    v_mfma_f32_16x16x32_bf16 v[200:203], a[136:139], v[92:95], v[200:203]
    ds_read_b128 v[124:127], v159 offset:32000
    v_mfma_f32_16x16x32_bf16 v[200:203], a[128:131], v[88:91], v[200:203]
    ds_read_b64_tr_b16 a[184:185], v154 offset:8192
    buffer_load_dwordx4 v150, s[48:51], s14 offen offset:2048 lds
    v_mfma_f32_16x16x32_bf16 v[208:211], a[128:131], v[96:99], v[208:211]
    ds_read_b64_tr_b16 a[186:187], v154 offset:9216
    v_mfma_f32_16x16x32_bf16 v[208:211], a[136:139], v[100:103], v[208:211]
    buffer_load_dwordx4 v151, s[48:51], s14 offen offset:3072 lds
    v_mfma_f32_16x16x32_bf16 v[212:215], a[140:143], v[100:103], v[212:215]
    ds_read_b64_tr_b16 a[188:189], v155 offset:8192
    v_mfma_f32_16x16x32_bf16 v[212:215], a[132:135], v[96:99], v[212:215]
    ds_read_b64_tr_b16 a[190:191], v155 offset:9216
    s_waitcnt lgkmcnt(4)
    v_mfma_f32_16x16x32_bf16 v[220:223], a[132:135], v[104:107], v[220:223]
    s_waitcnt vmcnt(14)
    s_barrier
    v_mfma_f32_16x16x32_bf16 v[220:223], a[140:143], v[108:111], v[220:223]
    ds_read_b128 v[80:83], v250 offset:0
    s_add_u32 m0, s74, 24576
    s_mul_i32 s13, s80, 90112
    v_mfma_f32_16x16x32_bf16 v[216:219], a[136:139], v[108:111], v[216:219]
    ds_read_b128 v[84:87], v250 offset:6144
    v_mfma_f32_16x16x32_bf16 v[216:219], a[128:131], v[104:107], v[216:219]
    ds_read_b128 v[88:91], v250 offset:256
    buffer_load_dwordx4 v156, s[44:47], s13 offen offset:0 sc1 lds
    v_mfma_f32_16x16x32_bf16 v[224:227], a[128:131], v[112:115], v[224:227]
    ds_read_b128 v[92:95], v250 offset:6400
    v_mfma_f32_16x16x32_bf16 v[224:227], a[136:139], v[116:119], v[224:227]
    ds_read_b128 v[96:99], v250 offset:512
    v_mfma_f32_16x16x32_bf16 v[228:231], a[140:143], v[116:119], v[228:231]
    ds_read_b128 v[100:103], v250 offset:6656
    buffer_load_dwordx4 v157, s[44:47], s13 offen offset:1024 sc1 lds
    v_mfma_f32_16x16x32_bf16 v[228:231], a[132:135], v[112:115], v[228:231]
    ds_read_b64_tr_b16 a[192:193], v152 offset:0
    v_mfma_f32_16x16x32_bf16 v[236:239], a[132:135], v[120:123], v[236:239]
    ds_read_b64_tr_b16 a[194:195], v152 offset:1024
    v_mfma_f32_16x16x32_bf16 v[236:239], a[140:143], v[124:127], v[236:239]
    buffer_load_dwordx4 v158, s[44:47], s13 offen offset:2048 sc1 lds
    v_mfma_f32_16x16x32_bf16 v[232:235], a[136:139], v[124:127], v[232:235]
    ds_read_b64_tr_b16 a[196:197], v153 offset:0
    v_mfma_f32_16x16x32_bf16 v[232:235], a[128:131], v[120:123], v[232:235]
    ds_read_b64_tr_b16 a[198:199], v153 offset:1024
    s_waitcnt lgkmcnt(4)
    v_mfma_f32_16x16x32_bf16 v[192:195], a[144:147], v[80:83], v[192:195]
    s_add_u32 m0, s73, 49152
    s_mul_i32 s14, s81, 589824
    v_mfma_f32_16x16x32_bf16 v[192:195], a[152:155], v[84:87], v[192:195]
    ds_read_b128 v[104:107], v250 offset:768
    v_mfma_f32_16x16x32_bf16 v[196:199], a[156:159], v[84:87], v[196:199]
    ds_read_b128 v[108:111], v250 offset:6912
    buffer_load_dwordx4 v148, s[48:51], s14 offen offset:0 lds
    v_mfma_f32_16x16x32_bf16 v[196:199], a[148:151], v[80:83], v[196:199]
    ds_read_b128 v[112:115], v250 offset:1024
    v_mfma_f32_16x16x32_bf16 v[204:207], a[148:151], v[88:91], v[204:207]
    ds_read_b128 v[116:119], v250 offset:7168
    buffer_load_dwordx4 v149, s[48:51], s14 offen offset:1024 lds
    v_mfma_f32_16x16x32_bf16 v[204:207], a[156:159], v[92:95], v[204:207]
    ds_read_b128 v[120:123], v250 offset:1280
    v_mfma_f32_16x16x32_bf16 v[200:203], a[152:155], v[92:95], v[200:203]
    ds_read_b128 v[124:127], v250 offset:7424
    v_mfma_f32_16x16x32_bf16 v[200:203], a[144:147], v[88:91], v[200:203]
    ds_read_b64_tr_b16 a[200:201], v152 offset:8192
    buffer_load_dwordx4 v150, s[48:51], s14 offen offset:2048 lds
    v_mfma_f32_16x16x32_bf16 v[208:211], a[144:147], v[96:99], v[208:211]
    ds_read_b64_tr_b16 a[202:203], v152 offset:9216
    v_mfma_f32_16x16x32_bf16 v[208:211], a[152:155], v[100:103], v[208:211]
    buffer_load_dwordx4 v151, s[48:51], s14 offen offset:3072 lds
    v_mfma_f32_16x16x32_bf16 v[212:215], a[156:159], v[100:103], v[212:215]
    ds_read_b64_tr_b16 a[204:205], v153 offset:8192
    v_mfma_f32_16x16x32_bf16 v[212:215], a[148:151], v[96:99], v[212:215]
    ds_read_b64_tr_b16 a[206:207], v153 offset:9216
    s_waitcnt lgkmcnt(4)
    v_mfma_f32_16x16x32_bf16 v[220:223], a[148:151], v[104:107], v[220:223]
    s_waitcnt vmcnt(14)
    s_barrier
    v_mfma_f32_16x16x32_bf16 v[220:223], a[156:159], v[108:111], v[220:223]
    ds_read_b128 v[80:83], v250 offset:12288
    s_add_u32 m0, s74, 36864
    s_mul_i32 s13, s81, 90112
    v_mfma_f32_16x16x32_bf16 v[216:219], a[152:155], v[108:111], v[216:219]
    ds_read_b128 v[84:87], v250 offset:18432
    v_mfma_f32_16x16x32_bf16 v[216:219], a[144:147], v[104:107], v[216:219]
    ds_read_b128 v[88:91], v250 offset:12544
    buffer_load_dwordx4 v156, s[44:47], s13 offen offset:0 sc1 lds
    v_mfma_f32_16x16x32_bf16 v[224:227], a[144:147], v[112:115], v[224:227]
    ds_read_b128 v[92:95], v250 offset:18688
    v_mfma_f32_16x16x32_bf16 v[224:227], a[152:155], v[116:119], v[224:227]
    ds_read_b128 v[96:99], v250 offset:12800
    v_mfma_f32_16x16x32_bf16 v[228:231], a[156:159], v[116:119], v[228:231]
    ds_read_b128 v[100:103], v250 offset:18944
    buffer_load_dwordx4 v157, s[44:47], s13 offen offset:1024 sc1 lds
    v_mfma_f32_16x16x32_bf16 v[228:231], a[148:151], v[112:115], v[228:231]
    ds_read_b64_tr_b16 a[208:209], v152 offset:16384
    v_mfma_f32_16x16x32_bf16 v[236:239], a[148:151], v[120:123], v[236:239]
    ds_read_b64_tr_b16 a[210:211], v152 offset:17408
    v_mfma_f32_16x16x32_bf16 v[236:239], a[156:159], v[124:127], v[236:239]
    buffer_load_dwordx4 v158, s[44:47], s13 offen offset:2048 sc1 lds
    v_mfma_f32_16x16x32_bf16 v[232:235], a[152:155], v[124:127], v[232:235]
    ds_read_b64_tr_b16 a[212:213], v153 offset:16384
    v_mfma_f32_16x16x32_bf16 v[232:235], a[144:147], v[120:123], v[232:235]
    ds_read_b64_tr_b16 a[214:215], v153 offset:17408
    s_waitcnt lgkmcnt(4)
    v_mfma_f32_16x16x32_bf16 v[192:195], a[160:163], v[80:83], v[192:195]
    s_add_u32 m0, s73, 65536
    s_lshl_b32 s14, s84, 18
    v_mfma_f32_16x16x32_bf16 v[192:195], a[168:171], v[84:87], v[192:195]
    ds_read_b128 v[104:107], v250 offset:13056
    v_mfma_f32_16x16x32_bf16 v[196:199], a[172:175], v[84:87], v[196:199]
    ds_read_b128 v[108:111], v250 offset:19200
    buffer_load_dwordx4 v4, s[52:55], s14 offen offset:0 lds
    v_mfma_f32_16x16x32_bf16 v[196:199], a[164:167], v[80:83], v[196:199]
    ds_read_b128 v[112:115], v250 offset:13312
    v_mfma_f32_16x16x32_bf16 v[204:207], a[164:167], v[88:91], v[204:207]
    ds_read_b128 v[116:119], v250 offset:19456
    buffer_load_dwordx4 v5, s[52:55], s14 offen offset:1024 lds
    v_mfma_f32_16x16x32_bf16 v[204:207], a[172:175], v[92:95], v[204:207]
    ds_read_b128 v[120:123], v250 offset:13568
    v_mfma_f32_16x16x32_bf16 v[200:203], a[168:171], v[92:95], v[200:203]
    ds_read_b128 v[124:127], v250 offset:19712
    v_mfma_f32_16x16x32_bf16 v[200:203], a[160:163], v[88:91], v[200:203]
    ds_read_b64_tr_b16 a[216:217], v152 offset:24576
    buffer_load_dwordx4 v6, s[52:55], s14 offen offset:2048 lds
    v_mfma_f32_16x16x32_bf16 v[208:211], a[160:163], v[96:99], v[208:211]
    ds_read_b64_tr_b16 a[218:219], v152 offset:25600
    v_mfma_f32_16x16x32_bf16 v[208:211], a[168:171], v[100:103], v[208:211]
    buffer_load_dwordx4 v7, s[52:55], s14 offen offset:3072 lds
    v_mfma_f32_16x16x32_bf16 v[212:215], a[172:175], v[100:103], v[212:215]
    ds_read_b64_tr_b16 a[220:221], v153 offset:24576
    v_mfma_f32_16x16x32_bf16 v[212:215], a[164:167], v[96:99], v[212:215]
    ds_read_b64_tr_b16 a[222:223], v153 offset:25600
    s_waitcnt lgkmcnt(4)
    v_mfma_f32_16x16x32_bf16 v[220:223], a[164:167], v[104:107], v[220:223]
    s_waitcnt vmcnt(14)
    s_barrier
    v_mfma_f32_16x16x32_bf16 v[220:223], a[172:175], v[108:111], v[220:223]
    ds_read_b128 v[80:83], v250 offset:24576
    v_mfma_f32_16x16x32_bf16 v[216:219], a[168:171], v[108:111], v[216:219]
    ds_read_b128 v[84:87], v250 offset:30720
    v_mfma_f32_16x16x32_bf16 v[216:219], a[160:163], v[104:107], v[216:219]
    ds_read_b128 v[88:91], v250 offset:24832
    v_mfma_f32_16x16x32_bf16 v[224:227], a[160:163], v[112:115], v[224:227]
    ds_read_b128 v[92:95], v250 offset:30976
    v_mfma_f32_16x16x32_bf16 v[224:227], a[168:171], v[116:119], v[224:227]
    ds_read_b128 v[96:99], v250 offset:25088
    v_mfma_f32_16x16x32_bf16 v[228:231], a[172:175], v[116:119], v[228:231]
    ds_read_b128 v[100:103], v250 offset:31232
    v_mfma_f32_16x16x32_bf16 v[228:231], a[164:167], v[112:115], v[228:231]
    ds_read_b64_tr_b16 a[224:225], v152 offset:32768
    v_mfma_f32_16x16x32_bf16 v[236:239], a[164:167], v[120:123], v[236:239]
    ds_read_b64_tr_b16 a[226:227], v152 offset:33792
    v_mfma_f32_16x16x32_bf16 v[236:239], a[172:175], v[124:127], v[236:239]
    v_mfma_f32_16x16x32_bf16 v[232:235], a[168:171], v[124:127], v[232:235]
    ds_read_b64_tr_b16 a[228:229], v153 offset:32768
    v_mfma_f32_16x16x32_bf16 v[232:235], a[160:163], v[120:123], v[232:235]
    ds_read_b64_tr_b16 a[230:231], v153 offset:33792
    s_waitcnt lgkmcnt(4)
    v_mfma_f32_16x16x32_bf16 v[192:195], a[176:179], v[80:83], v[192:195]
    v_mfma_f32_16x16x32_bf16 v[192:195], a[184:187], v[84:87], v[192:195]
    ds_read_b128 v[104:107], v250 offset:25344
    v_mfma_f32_16x16x32_bf16 v[196:199], a[188:191], v[84:87], v[196:199]
    ds_read_b128 v[108:111], v250 offset:31488
    v_mfma_f32_16x16x32_bf16 v[196:199], a[180:183], v[80:83], v[196:199]
    ds_read_b128 v[112:115], v250 offset:25600
    v_mfma_f32_16x16x32_bf16 v[204:207], a[180:183], v[88:91], v[204:207]
    ds_read_b128 v[116:119], v250 offset:31744
    v_mfma_f32_16x16x32_bf16 v[204:207], a[188:191], v[92:95], v[204:207]
    ds_read_b128 v[120:123], v250 offset:25856
    v_mfma_f32_16x16x32_bf16 v[200:203], a[184:187], v[92:95], v[200:203]
    ds_read_b128 v[124:127], v250 offset:32000
    v_mfma_f32_16x16x32_bf16 v[200:203], a[176:179], v[88:91], v[200:203]
    ds_read_b64_tr_b16 a[232:233], v152 offset:40960
    v_mfma_f32_16x16x32_bf16 v[208:211], a[176:179], v[96:99], v[208:211]
    ds_read_b64_tr_b16 a[234:235], v152 offset:41984
    v_mfma_f32_16x16x32_bf16 v[208:211], a[184:187], v[100:103], v[208:211]
    v_mfma_f32_16x16x32_bf16 v[212:215], a[188:191], v[100:103], v[212:215]
    ds_read_b64_tr_b16 a[236:237], v153 offset:40960
    v_mfma_f32_16x16x32_bf16 v[212:215], a[180:183], v[96:99], v[212:215]
    ds_read_b64_tr_b16 a[238:239], v153 offset:41984
    s_waitcnt lgkmcnt(4)
    v_mfma_f32_16x16x32_bf16 v[220:223], a[180:183], v[104:107], v[220:223]
    s_waitcnt vmcnt(7)
    s_barrier
    v_mfma_f32_16x16x32_bf16 v[220:223], a[188:191], v[108:111], v[220:223]
    ds_read_b128 v[80:83], v159 offset:0
    v_mfma_f32_16x16x32_bf16 v[216:219], a[184:187], v[108:111], v[216:219]
    ds_read_b128 v[84:87], v159 offset:6144
    v_mfma_f32_16x16x32_bf16 v[216:219], a[176:179], v[104:107], v[216:219]
    ds_read_b128 v[88:91], v159 offset:256
    v_mfma_f32_16x16x32_bf16 v[224:227], a[176:179], v[112:115], v[224:227]
    ds_read_b128 v[92:95], v159 offset:6400
    v_mfma_f32_16x16x32_bf16 v[224:227], a[184:187], v[116:119], v[224:227]
    ds_read_b128 v[96:99], v159 offset:512
    v_mfma_f32_16x16x32_bf16 v[228:231], a[188:191], v[116:119], v[228:231]
    ds_read_b128 v[100:103], v159 offset:6656
    v_mfma_f32_16x16x32_bf16 v[228:231], a[180:183], v[112:115], v[228:231]
    ds_read_b64_tr_b16 a[240:241], v152 offset:49152
    v_mfma_f32_16x16x32_bf16 v[236:239], a[180:183], v[120:123], v[236:239]
    ds_read_b64_tr_b16 a[242:243], v152 offset:50176
    v_mfma_f32_16x16x32_bf16 v[236:239], a[188:191], v[124:127], v[236:239]
    v_mfma_f32_16x16x32_bf16 v[232:235], a[184:187], v[124:127], v[232:235]
    ds_read_b64_tr_b16 a[244:245], v153 offset:49152
    v_mfma_f32_16x16x32_bf16 v[232:235], a[176:179], v[120:123], v[232:235]
    ds_read_b64_tr_b16 a[246:247], v153 offset:50176
    s_waitcnt lgkmcnt(4)
    v_mfma_f32_16x16x32_bf16 v[192:195], a[192:195], v[80:83], v[192:195]
    v_mfma_f32_16x16x32_bf16 v[192:195], a[200:203], v[84:87], v[192:195]
    ds_read_b128 v[104:107], v159 offset:768
    v_mfma_f32_16x16x32_bf16 v[196:199], a[204:207], v[84:87], v[196:199]
    ds_read_b128 v[108:111], v159 offset:6912
    v_mfma_f32_16x16x32_bf16 v[196:199], a[196:199], v[80:83], v[196:199]
    ds_read_b128 v[112:115], v159 offset:1024
    v_mfma_f32_16x16x32_bf16 v[204:207], a[196:199], v[88:91], v[204:207]
    ds_read_b128 v[116:119], v159 offset:7168
L_pl_G_3:
    s_cbranch_execz L_wret
    v_mfma_f32_16x16x32_bf16 v[204:207], a[204:207], v[92:95], v[204:207]
    ds_read_b128 v[120:123], v159 offset:1280
    v_mfma_f32_16x16x32_bf16 v[200:203], a[200:203], v[92:95], v[200:203]
    ds_read_b128 v[124:127], v159 offset:7424
    v_mfma_f32_16x16x32_bf16 v[200:203], a[192:195], v[88:91], v[200:203]
    ds_read_b64_tr_b16 a[248:249], v152 offset:57344
    v_mfma_f32_16x16x32_bf16 v[208:211], a[192:195], v[96:99], v[208:211]
    ds_read_b64_tr_b16 a[250:251], v152 offset:58368
    v_mfma_f32_16x16x32_bf16 v[208:211], a[200:203], v[100:103], v[208:211]
    v_mfma_f32_16x16x32_bf16 v[212:215], a[204:207], v[100:103], v[212:215]
    ds_read_b64_tr_b16 a[252:253], v153 offset:57344
    v_mfma_f32_16x16x32_bf16 v[212:215], a[196:199], v[96:99], v[212:215]
    ds_read_b64_tr_b16 a[254:255], v153 offset:58368
    s_waitcnt lgkmcnt(4)
    v_mfma_f32_16x16x32_bf16 v[220:223], a[196:199], v[104:107], v[220:223]
    s_barrier
    v_mfma_f32_16x16x32_bf16 v[220:223], a[204:207], v[108:111], v[220:223]
    ds_read_b128 v[80:83], v159 offset:12288
    s_add_u32 m0, s74, 49152
    s_mul_i32 s13, s18, 90112
    v_mfma_f32_16x16x32_bf16 v[216:219], a[200:203], v[108:111], v[216:219]
    ds_read_b128 v[84:87], v159 offset:18432
    v_mfma_f32_16x16x32_bf16 v[216:219], a[192:195], v[104:107], v[216:219]
    ds_read_b128 v[88:91], v159 offset:12544
    buffer_load_dwordx4 v8, s[44:47], s13 offen offset:0 sc1 lds
    v_mfma_f32_16x16x32_bf16 v[224:227], a[192:195], v[112:115], v[224:227]
    ds_read_b128 v[92:95], v159 offset:18688
    v_mfma_f32_16x16x32_bf16 v[224:227], a[200:203], v[116:119], v[224:227]
    ds_read_b128 v[96:99], v159 offset:12800
    v_mfma_f32_16x16x32_bf16 v[228:231], a[204:207], v[116:119], v[228:231]
    ds_read_b128 v[100:103], v159 offset:18944
    buffer_load_dwordx4 v9, s[44:47], s13 offen offset:1024 sc1 lds
    v_mfma_f32_16x16x32_bf16 v[228:231], a[196:199], v[112:115], v[228:231]
    v_mfma_f32_16x16x32_bf16 v[236:239], a[196:199], v[120:123], v[236:239]
    v_mfma_f32_16x16x32_bf16 v[236:239], a[204:207], v[124:127], v[236:239]
    buffer_load_dwordx4 v3, s[44:47], s13 offen offset:2048 sc1 lds
    v_mfma_f32_16x16x32_bf16 v[232:235], a[200:203], v[124:127], v[232:235]
    v_mfma_f32_16x16x32_bf16 v[232:235], a[192:195], v[120:123], v[232:235]
    s_waitcnt lgkmcnt(0)
    v_mfma_f32_16x16x32_bf16 v[192:195], a[208:211], v[80:83], v[192:195]
    s_add_u32 m0, s74, 61440
    s_mul_i32 s13, s19, 90112
    v_mfma_f32_16x16x32_bf16 v[192:195], a[216:219], v[84:87], v[192:195]
    ds_read_b128 v[104:107], v159 offset:13056
    v_mfma_f32_16x16x32_bf16 v[196:199], a[220:223], v[84:87], v[196:199]
    ds_read_b128 v[108:111], v159 offset:19200
    v_mfma_f32_16x16x32_bf16 v[196:199], a[212:215], v[80:83], v[196:199]
    ds_read_b128 v[112:115], v159 offset:13312
    buffer_load_dwordx4 v8, s[44:47], s13 offen offset:0 sc1 lds
    v_mfma_f32_16x16x32_bf16 v[204:207], a[212:215], v[88:91], v[204:207]
    ds_read_b128 v[116:119], v159 offset:19456
    v_mfma_f32_16x16x32_bf16 v[204:207], a[220:223], v[92:95], v[204:207]
    ds_read_b128 v[120:123], v159 offset:13568
    v_mfma_f32_16x16x32_bf16 v[200:203], a[216:219], v[92:95], v[200:203]
    ds_read_b128 v[124:127], v159 offset:19712
    buffer_load_dwordx4 v9, s[44:47], s13 offen offset:1024 sc1 lds
    v_mfma_f32_16x16x32_bf16 v[200:203], a[208:211], v[88:91], v[200:203]
    v_mfma_f32_16x16x32_bf16 v[208:211], a[208:211], v[96:99], v[208:211]
    v_mfma_f32_16x16x32_bf16 v[208:211], a[216:219], v[100:103], v[208:211]
    buffer_load_dwordx4 v3, s[44:47], s13 offen offset:2048 sc1 lds
    v_mfma_f32_16x16x32_bf16 v[212:215], a[220:223], v[100:103], v[212:215]
    v_mfma_f32_16x16x32_bf16 v[212:215], a[212:215], v[96:99], v[212:215]
    s_waitcnt lgkmcnt(0)
    v_mfma_f32_16x16x32_bf16 v[220:223], a[212:215], v[104:107], v[220:223]
    s_barrier
    v_mfma_f32_16x16x32_bf16 v[220:223], a[220:223], v[108:111], v[220:223]
    ds_read_b128 v[80:83], v159 offset:24576
    s_add_u32 m0, s74, 0
    s_mul_i32 s13, s20, 90112
    v_mfma_f32_16x16x32_bf16 v[216:219], a[216:219], v[108:111], v[216:219]
    ds_read_b128 v[84:87], v159 offset:30720
    v_mfma_f32_16x16x32_bf16 v[216:219], a[208:211], v[104:107], v[216:219]
    ds_read_b128 v[88:91], v159 offset:24832
    buffer_load_dwordx4 v8, s[44:47], s13 offen offset:0 sc1 lds
    v_mfma_f32_16x16x32_bf16 v[224:227], a[208:211], v[112:115], v[224:227]
    ds_read_b128 v[92:95], v159 offset:30976
    v_mfma_f32_16x16x32_bf16 v[224:227], a[216:219], v[116:119], v[224:227]
    ds_read_b128 v[96:99], v159 offset:25088
    v_mfma_f32_16x16x32_bf16 v[228:231], a[220:223], v[116:119], v[228:231]
    ds_read_b128 v[100:103], v159 offset:31232
    buffer_load_dwordx4 v9, s[44:47], s13 offen offset:1024 sc1 lds
    v_mfma_f32_16x16x32_bf16 v[228:231], a[212:215], v[112:115], v[228:231]
    v_mfma_f32_16x16x32_bf16 v[236:239], a[212:215], v[120:123], v[236:239]
    v_mfma_f32_16x16x32_bf16 v[236:239], a[220:223], v[124:127], v[236:239]
    buffer_load_dwordx4 v3, s[44:47], s13 offen offset:2048 sc1 lds
    v_mfma_f32_16x16x32_bf16 v[232:235], a[216:219], v[124:127], v[232:235]
    v_mfma_f32_16x16x32_bf16 v[232:235], a[208:211], v[120:123], v[232:235]
    s_waitcnt lgkmcnt(0)
    v_mfma_f32_16x16x32_bf16 v[192:195], a[224:227], v[80:83], v[192:195]
    s_add_u32 m0, s74, 12288
    s_mul_i32 s13, s21, 90112
    v_mfma_f32_16x16x32_bf16 v[192:195], a[232:235], v[84:87], v[192:195]
    ds_read_b128 v[104:107], v159 offset:25344
    v_mfma_f32_16x16x32_bf16 v[196:199], a[236:239], v[84:87], v[196:199]
    ds_read_b128 v[108:111], v159 offset:31488
    v_mfma_f32_16x16x32_bf16 v[196:199], a[228:231], v[80:83], v[196:199]
    ds_read_b128 v[112:115], v159 offset:25600
    buffer_load_dwordx4 v8, s[44:47], s13 offen offset:0 sc1 lds
    v_mfma_f32_16x16x32_bf16 v[204:207], a[228:231], v[88:91], v[204:207]
    ds_read_b128 v[116:119], v159 offset:31744
    v_mfma_f32_16x16x32_bf16 v[204:207], a[236:239], v[92:95], v[204:207]
    ds_read_b128 v[120:123], v159 offset:25856
    v_mfma_f32_16x16x32_bf16 v[200:203], a[232:235], v[92:95], v[200:203]
    ds_read_b128 v[124:127], v159 offset:32000
    buffer_load_dwordx4 v9, s[44:47], s13 offen offset:1024 sc1 lds
    v_mfma_f32_16x16x32_bf16 v[200:203], a[224:227], v[88:91], v[200:203]
    v_mfma_f32_16x16x32_bf16 v[208:211], a[224:227], v[96:99], v[208:211]
    v_mfma_f32_16x16x32_bf16 v[208:211], a[232:235], v[100:103], v[208:211]
    buffer_load_dwordx4 v3, s[44:47], s13 offen offset:2048 sc1 lds
    v_mfma_f32_16x16x32_bf16 v[212:215], a[236:239], v[100:103], v[212:215]
    v_mfma_f32_16x16x32_bf16 v[212:215], a[228:231], v[96:99], v[212:215]
    s_waitcnt lgkmcnt(0)
    v_mfma_f32_16x16x32_bf16 v[220:223], a[228:231], v[104:107], v[220:223]
    s_waitcnt vmcnt(16)
    s_barrier
    v_mfma_f32_16x16x32_bf16 v[220:223], a[236:239], v[108:111], v[220:223]
    ds_read_b128 v[80:83], v250 offset:0
    s_add_u32 m0, s74, 24576
    s_mul_i32 s13, s22, 90112
    v_mfma_f32_16x16x32_bf16 v[216:219], a[232:235], v[108:111], v[216:219]
    ds_read_b128 v[84:87], v250 offset:6144
    v_mfma_f32_16x16x32_bf16 v[216:219], a[224:227], v[104:107], v[216:219]
    ds_read_b128 v[88:91], v250 offset:256
    buffer_load_dwordx4 v8, s[44:47], s13 offen offset:0 sc1 lds
    v_mfma_f32_16x16x32_bf16 v[224:227], a[224:227], v[112:115], v[224:227]
    ds_read_b128 v[92:95], v250 offset:6400
    v_mfma_f32_16x16x32_bf16 v[224:227], a[232:235], v[116:119], v[224:227]
    ds_read_b128 v[96:99], v250 offset:512
    v_mfma_f32_16x16x32_bf16 v[228:231], a[236:239], v[116:119], v[228:231]
    ds_read_b128 v[100:103], v250 offset:6656
    buffer_load_dwordx4 v9, s[44:47], s13 offen offset:1024 sc1 lds
    v_mfma_f32_16x16x32_bf16 v[228:231], a[228:231], v[112:115], v[228:231]
    v_mfma_f32_16x16x32_bf16 v[236:239], a[228:231], v[120:123], v[236:239]
    v_mfma_f32_16x16x32_bf16 v[236:239], a[236:239], v[124:127], v[236:239]
    buffer_load_dwordx4 v3, s[44:47], s13 offen offset:2048 sc1 lds
    v_mfma_f32_16x16x32_bf16 v[232:235], a[232:235], v[124:127], v[232:235]
    v_mfma_f32_16x16x32_bf16 v[232:235], a[224:227], v[120:123], v[232:235]
    s_waitcnt lgkmcnt(0)
    v_mfma_f32_16x16x32_bf16 v[192:195], a[240:243], v[80:83], v[192:195]
    s_add_u32 m0, s73, 0
    s_lshl_b32 s14, s85, 18
    v_mfma_f32_16x16x32_bf16 v[192:195], a[248:251], v[84:87], v[192:195]
    ds_read_b128 v[104:107], v250 offset:768
    v_mfma_f32_16x16x32_bf16 v[196:199], a[252:255], v[84:87], v[196:199]
    ds_read_b128 v[108:111], v250 offset:6912
    buffer_load_dwordx4 v4, s[52:55], s14 offen offset:0 lds
    v_mfma_f32_16x16x32_bf16 v[196:199], a[244:247], v[80:83], v[196:199]
    ds_read_b128 v[112:115], v250 offset:1024
    v_mfma_f32_16x16x32_bf16 v[204:207], a[244:247], v[88:91], v[204:207]
    ds_read_b128 v[116:119], v250 offset:7168
    buffer_load_dwordx4 v5, s[52:55], s14 offen offset:1024 lds
    v_mfma_f32_16x16x32_bf16 v[204:207], a[252:255], v[92:95], v[204:207]
    ds_read_b128 v[120:123], v250 offset:1280
    v_mfma_f32_16x16x32_bf16 v[200:203], a[248:251], v[92:95], v[200:203]
    ds_read_b128 v[124:127], v250 offset:7424
    v_mfma_f32_16x16x32_bf16 v[200:203], a[240:243], v[88:91], v[200:203]
    buffer_load_dwordx4 v6, s[52:55], s14 offen offset:2048 lds
    v_mfma_f32_16x16x32_bf16 v[208:211], a[240:243], v[96:99], v[208:211]
    v_mfma_f32_16x16x32_bf16 v[208:211], a[248:251], v[100:103], v[208:211]
    buffer_load_dwordx4 v7, s[52:55], s14 offen offset:3072 lds
    v_mfma_f32_16x16x32_bf16 v[212:215], a[252:255], v[100:103], v[212:215]
    v_mfma_f32_16x16x32_bf16 v[212:215], a[244:247], v[96:99], v[212:215]
    s_waitcnt lgkmcnt(0)
    v_mfma_f32_16x16x32_bf16 v[220:223], a[244:247], v[104:107], v[220:223]
    s_waitcnt vmcnt(16)
    s_barrier
    v_mfma_f32_16x16x32_bf16 v[220:223], a[252:255], v[108:111], v[220:223]
    ds_read_b128 v[80:83], v250 offset:12288
    v_mfma_f32_16x16x32_bf16 v[216:219], a[248:251], v[108:111], v[216:219]
    ds_read_b128 v[84:87], v250 offset:18432
    v_mfma_f32_16x16x32_bf16 v[216:219], a[240:243], v[104:107], v[216:219]
    ds_read_b128 v[88:91], v250 offset:12544
    v_mfma_f32_16x16x32_bf16 v[224:227], a[240:243], v[112:115], v[224:227]
    ds_read_b128 v[92:95], v250 offset:18688
    v_cvt_pk_bf16_f32 v192, v192, v193
    v_mfma_f32_16x16x32_bf16 v[224:227], a[248:251], v[116:119], v[224:227]
    ds_read_b128 v[96:99], v250 offset:12800
    v_mfma_f32_16x16x32_bf16 v[228:231], a[252:255], v[116:119], v[228:231]
    ds_read_b128 v[100:103], v250 offset:18944
    v_cvt_pk_bf16_f32 v193, v194, v195
    v_mfma_f32_16x16x32_bf16 v[228:231], a[244:247], v[112:115], v[228:231]
    v_mfma_f32_16x16x32_bf16 v[236:239], a[244:247], v[120:123], v[236:239]
    v_cvt_pk_bf16_f32 v194, v196, v197
    v_mfma_f32_16x16x32_bf16 v[236:239], a[252:255], v[124:127], v[236:239]
    v_cvt_pk_bf16_f32 v195, v198, v199
    v_mfma_f32_16x16x32_bf16 v[232:235], a[248:251], v[124:127], v[232:235]
    v_mfma_f32_16x16x32_bf16 v[232:235], a[240:243], v[120:123], v[232:235]
    buffer_store_dwordx4 v[192:195], v246, s[44:47], s9 offen offset:0 sc1
    s_waitcnt lgkmcnt(0)
    v_mfma_f32_16x16x32_bf16 v[32:35], a[0:3], v[80:83], v[128:131]
    v_mfma_f32_16x16x32_bf16 v[32:35], a[8:11], v[84:87], v[32:35]
    ds_read_b128 v[104:107], v250 offset:13056
    v_mfma_f32_16x16x32_bf16 v[36:39], a[12:15], v[84:87], v[132:135]
    ds_read_b128 v[108:111], v250 offset:19200
    v_mfma_f32_16x16x32_bf16 v[36:39], a[4:7], v[80:83], v[36:39]
    ds_read_b128 v[112:115], v250 offset:13312
    v_mfma_f32_16x16x32_bf16 v[44:47], a[4:7], v[88:91], v[132:135]
    ds_read_b128 v[116:119], v250 offset:19456
    v_cvt_pk_bf16_f32 v200, v200, v201
    v_mfma_f32_16x16x32_bf16 v[44:47], a[12:15], v[92:95], v[44:47]
    ds_read_b128 v[120:123], v250 offset:13568
    v_mfma_f32_16x16x32_bf16 v[40:43], a[8:11], v[92:95], v[128:131]
    ds_read_b128 v[124:127], v250 offset:19712
    v_cvt_pk_bf16_f32 v201, v202, v203
    v_mfma_f32_16x16x32_bf16 v[40:43], a[0:3], v[88:91], v[40:43]
    v_mfma_f32_16x16x32_bf16 v[48:51], a[0:3], v[96:99], v[128:131]
    v_cvt_pk_bf16_f32 v202, v204, v205
    v_mfma_f32_16x16x32_bf16 v[48:51], a[8:11], v[100:103], v[48:51]
    v_cvt_pk_bf16_f32 v203, v206, v207
    v_mfma_f32_16x16x32_bf16 v[52:55], a[12:15], v[100:103], v[132:135]
    v_mfma_f32_16x16x32_bf16 v[52:55], a[4:7], v[96:99], v[52:55]
    buffer_store_dwordx4 v[200:203], v246, s[44:47], s9 offen offset:1024 sc1
    s_waitcnt lgkmcnt(0)
    v_mfma_f32_16x16x32_bf16 v[60:63], a[4:7], v[104:107], v[132:135]
    s_waitcnt vmcnt(15)
    s_barrier
    v_mfma_f32_16x16x32_bf16 v[60:63], a[12:15], v[108:111], v[60:63]
    ds_read_b128 v[80:83], v250 offset:24576
    v_cvt_pk_bf16_f32 v208, v208, v209
    v_mfma_f32_16x16x32_bf16 v[56:59], a[8:11], v[108:111], v[128:131]
    ds_read_b128 v[84:87], v250 offset:30720
    v_mfma_f32_16x16x32_bf16 v[56:59], a[0:3], v[104:107], v[56:59]
    ds_read_b128 v[88:91], v250 offset:24832
    v_cvt_pk_bf16_f32 v209, v210, v211
    v_mfma_f32_16x16x32_bf16 v[64:67], a[0:3], v[112:115], v[128:131]
    ds_read_b128 v[92:95], v250 offset:30976
    v_mfma_f32_16x16x32_bf16 v[64:67], a[8:11], v[116:119], v[64:67]
    ds_read_b128 v[96:99], v250 offset:25088
    v_mfma_f32_16x16x32_bf16 v[68:71], a[12:15], v[116:119], v[132:135]
    ds_read_b128 v[100:103], v250 offset:31232
    v_cvt_pk_bf16_f32 v210, v212, v213
    v_mfma_f32_16x16x32_bf16 v[68:71], a[4:7], v[112:115], v[68:71]
    v_mfma_f32_16x16x32_bf16 v[76:79], a[4:7], v[120:123], v[132:135]
    v_cvt_pk_bf16_f32 v211, v214, v215
    v_mfma_f32_16x16x32_bf16 v[76:79], a[12:15], v[124:127], v[76:79]
    v_mfma_f32_16x16x32_bf16 v[72:75], a[8:11], v[124:127], v[128:131]
    buffer_store_dwordx4 v[208:211], v246, s[44:47], s9 offen offset:2048 sc1
    v_mfma_f32_16x16x32_bf16 v[72:75], a[0:3], v[120:123], v[72:75]
    s_waitcnt lgkmcnt(0)
    v_mfma_f32_16x16x32_bf16 v[32:35], a[16:19], v[80:83], v[32:35]
    v_mfma_f32_16x16x32_bf16 v[32:35], a[24:27], v[84:87], v[32:35]
    ds_read_b128 v[104:107], v250 offset:25344
    v_cvt_pk_bf16_f32 v216, v216, v217
    v_mfma_f32_16x16x32_bf16 v[36:39], a[28:31], v[84:87], v[36:39]
    ds_read_b128 v[108:111], v250 offset:31488
    v_mfma_f32_16x16x32_bf16 v[36:39], a[20:23], v[80:83], v[36:39]
    ds_read_b128 v[112:115], v250 offset:25600
    v_cvt_pk_bf16_f32 v217, v218, v219
    v_mfma_f32_16x16x32_bf16 v[44:47], a[20:23], v[88:91], v[44:47]
    ds_read_b128 v[116:119], v250 offset:31744
    v_mfma_f32_16x16x32_bf16 v[44:47], a[28:31], v[92:95], v[44:47]
    ds_read_b128 v[120:123], v250 offset:25856
    v_mfma_f32_16x16x32_bf16 v[40:43], a[24:27], v[92:95], v[40:43]
    ds_read_b128 v[124:127], v250 offset:32000
    v_cvt_pk_bf16_f32 v218, v220, v221
    v_mfma_f32_16x16x32_bf16 v[40:43], a[16:19], v[88:91], v[40:43]
    v_mfma_f32_16x16x32_bf16 v[48:51], a[16:19], v[96:99], v[48:51]
    v_cvt_pk_bf16_f32 v219, v222, v223
    v_mfma_f32_16x16x32_bf16 v[48:51], a[24:27], v[100:103], v[48:51]
    v_mfma_f32_16x16x32_bf16 v[52:55], a[28:31], v[100:103], v[52:55]
    buffer_store_dwordx4 v[216:219], v247, s[44:47], s9 offen offset:0 sc1
    v_mfma_f32_16x16x32_bf16 v[52:55], a[20:23], v[96:99], v[52:55]
    s_waitcnt lgkmcnt(0)
    v_mfma_f32_16x16x32_bf16 v[60:63], a[20:23], v[104:107], v[60:63]
    s_waitcnt vmcnt(14)
    s_barrier
    v_cvt_pk_bf16_f32 v224, v224, v225
    v_mfma_f32_16x16x32_bf16 v[60:63], a[28:31], v[108:111], v[60:63]
    ds_read_b128 v[80:83], v159 offset:0
    s_add_u32 m0, s74, 36864
    s_mul_i32 s13, s23, 90112
    v_mfma_f32_16x16x32_bf16 v[56:59], a[24:27], v[108:111], v[56:59]
    ds_read_b128 v[84:87], v159 offset:6144
    v_mfma_f32_16x16x32_bf16 v[56:59], a[16:19], v[104:107], v[56:59]
    ds_read_b128 v[88:91], v159 offset:256
    buffer_load_dwordx4 v8, s[44:47], s13 offen offset:0 sc1 lds
    v_mfma_f32_16x16x32_bf16 v[64:67], a[16:19], v[112:115], v[64:67]
    ds_read_b128 v[92:95], v159 offset:6400
    v_cvt_pk_bf16_f32 v225, v226, v227
    v_mfma_f32_16x16x32_bf16 v[64:67], a[24:27], v[116:119], v[64:67]
    ds_read_b128 v[96:99], v159 offset:512
    v_cvt_pk_bf16_f32 v226, v228, v229
    v_mfma_f32_16x16x32_bf16 v[68:71], a[28:31], v[116:119], v[68:71]
    ds_read_b128 v[100:103], v159 offset:6656
    buffer_load_dwordx4 v9, s[44:47], s13 offen offset:1024 sc1 lds
    v_mfma_f32_16x16x32_bf16 v[68:71], a[20:23], v[112:115], v[68:71]
    v_add_u32 v10, 65536, v10
    v_mfma_f32_16x16x32_bf16 v[76:79], a[20:23], v[120:123], v[76:79]
    ds_read_b64_tr_b16 a[0:1], v10 offset:0
    v_cvt_pk_bf16_f32 v227, v230, v231
    v_mfma_f32_16x16x32_bf16 v[76:79], a[28:31], v[124:127], v[76:79]
    ds_read_b64_tr_b16 a[2:3], v10 offset:2048
    buffer_load_dwordx4 v3, s[44:47], s13 offen offset:2048 sc1 lds
    v_mfma_f32_16x16x32_bf16 v[72:75], a[24:27], v[124:127], v[72:75]
    buffer_store_dwordx4 v[224:227], v247, s[44:47], s9 offen offset:1024 sc1
    ds_read_b64_tr_b16 a[8:9], v10 offset:4096
    v_mfma_f32_16x16x32_bf16 v[72:75], a[16:19], v[120:123], v[72:75]
    ds_read_b64_tr_b16 a[10:11], v10 offset:6144
    s_waitcnt lgkmcnt(4)
    v_mfma_f32_16x16x32_bf16 v[32:35], a[32:35], v[80:83], v[32:35]
    s_add_u32 m0, s74, 49152
    s_mul_i32 s13, s24, 90112
    v_mfma_f32_16x16x32_bf16 v[32:35], a[40:43], v[84:87], v[32:35]
    ds_read_b128 v[104:107], v159 offset:768
    v_cvt_pk_bf16_f32 v232, v232, v233
    v_mfma_f32_16x16x32_bf16 v[36:39], a[44:47], v[84:87], v[36:39]
    ds_read_b128 v[108:111], v159 offset:6912
    v_mfma_f32_16x16x32_bf16 v[36:39], a[36:39], v[80:83], v[36:39]
    ds_read_b128 v[112:115], v159 offset:1024
    buffer_load_dwordx4 v8, s[44:47], s13 offen offset:0 sc1 lds
    v_mfma_f32_16x16x32_bf16 v[44:47], a[36:39], v[88:91], v[44:47]
    ds_read_b128 v[116:119], v159 offset:7168
    v_cvt_pk_bf16_f32 v233, v234, v235
    v_mfma_f32_16x16x32_bf16 v[44:47], a[44:47], v[92:95], v[44:47]
    ds_read_b128 v[120:123], v159 offset:1280
    v_cvt_pk_bf16_f32 v234, v236, v237
    v_mfma_f32_16x16x32_bf16 v[40:43], a[40:43], v[92:95], v[40:43]
    ds_read_b128 v[124:127], v159 offset:7424
    buffer_load_dwordx4 v9, s[44:47], s13 offen offset:1024 sc1 lds
    v_mfma_f32_16x16x32_bf16 v[40:43], a[32:35], v[88:91], v[40:43]
    v_add_u32 v11, 65536, v11
    v_mfma_f32_16x16x32_bf16 v[48:51], a[32:35], v[96:99], v[48:51]
    ds_read_b64_tr_b16 a[4:5], v11 offset:0
    v_cvt_pk_bf16_f32 v235, v238, v239
    v_mfma_f32_16x16x32_bf16 v[48:51], a[40:43], v[100:103], v[48:51]
    ds_read_b64_tr_b16 a[6:7], v11 offset:2048
    buffer_load_dwordx4 v3, s[44:47], s13 offen offset:2048 sc1 lds
    v_mfma_f32_16x16x32_bf16 v[52:55], a[44:47], v[100:103], v[52:55]
    buffer_store_dwordx4 v[232:235], v247, s[44:47], s9 offen offset:2048 sc1
    ds_read_b64_tr_b16 a[12:13], v11 offset:4096
    v_mfma_f32_16x16x32_bf16 v[52:55], a[36:39], v[96:99], v[52:55]
    ds_read_b64_tr_b16 a[14:15], v11 offset:6144
    s_waitcnt lgkmcnt(4)
    v_mfma_f32_16x16x32_bf16 v[60:63], a[36:39], v[104:107], v[60:63]
    s_waitcnt vmcnt(19)
    s_barrier
    v_mfma_f32_16x16x32_bf16 v[60:63], a[44:47], v[108:111], v[60:63]
    ds_read_b128 v[80:83], v159 offset:12288
    s_add_u32 m0, s74, 61440
    s_mul_i32 s13, s25, 90112
    v_mfma_f32_16x16x32_bf16 v[56:59], a[40:43], v[108:111], v[56:59]
    ds_read_b128 v[84:87], v159 offset:18432
    v_mfma_f32_16x16x32_bf16 v[56:59], a[32:35], v[104:107], v[56:59]
    ds_read_b128 v[88:91], v159 offset:12544
    buffer_load_dwordx4 v8, s[44:47], s13 offen offset:0 sc1 lds
    v_mfma_f32_16x16x32_bf16 v[64:67], a[32:35], v[112:115], v[64:67]
    ds_read_b128 v[92:95], v159 offset:18688
    v_mfma_f32_16x16x32_bf16 v[64:67], a[40:43], v[116:119], v[64:67]
    ds_read_b128 v[96:99], v159 offset:12800
    v_mfma_f32_16x16x32_bf16 v[68:71], a[44:47], v[116:119], v[68:71]
    ds_read_b128 v[100:103], v159 offset:18944
    buffer_load_dwordx4 v9, s[44:47], s13 offen offset:1024 sc1 lds
    v_mfma_f32_16x16x32_bf16 v[68:71], a[36:39], v[112:115], v[68:71]
    v_mfma_f32_16x16x32_bf16 v[76:79], a[36:39], v[120:123], v[76:79]
    v_mfma_f32_16x16x32_bf16 v[76:79], a[44:47], v[124:127], v[76:79]
    buffer_load_dwordx4 v3, s[44:47], s13 offen offset:2048 sc1 lds
    v_mfma_f32_16x16x32_bf16 v[72:75], a[40:43], v[124:127], v[72:75]
    v_mfma_f32_16x16x32_bf16 v[72:75], a[32:35], v[120:123], v[72:75]
    s_waitcnt lgkmcnt(0)
    v_mfma_f32_16x16x32_bf16 v[32:35], a[48:51], v[80:83], v[32:35]
    s_add_u32 m0, s74, 0
    s_mul_i32 s13, s26, 90112
    v_mfma_f32_16x16x32_bf16 v[32:35], a[56:59], v[84:87], v[32:35]
    ds_read_b128 v[104:107], v159 offset:13056
    v_mfma_f32_16x16x32_bf16 v[36:39], a[60:63], v[84:87], v[36:39]
    ds_read_b128 v[108:111], v159 offset:19200
    v_mfma_f32_16x16x32_bf16 v[36:39], a[52:55], v[80:83], v[36:39]
    ds_read_b128 v[112:115], v159 offset:13312
    buffer_load_dwordx4 v8, s[44:47], s13 offen offset:0 sc1 lds
    v_mfma_f32_16x16x32_bf16 v[44:47], a[52:55], v[88:91], v[44:47]
    ds_read_b128 v[116:119], v159 offset:19456
    v_mfma_f32_16x16x32_bf16 v[44:47], a[60:63], v[92:95], v[44:47]
    ds_read_b128 v[120:123], v159 offset:13568
    v_mfma_f32_16x16x32_bf16 v[40:43], a[56:59], v[92:95], v[40:43]
    ds_read_b128 v[124:127], v159 offset:19712
    buffer_load_dwordx4 v9, s[44:47], s13 offen offset:1024 sc1 lds
    v_mfma_f32_16x16x32_bf16 v[40:43], a[48:51], v[88:91], v[40:43]
    v_mfma_f32_16x16x32_bf16 v[48:51], a[48:51], v[96:99], v[48:51]
    v_mfma_f32_16x16x32_bf16 v[48:51], a[56:59], v[100:103], v[48:51]
    buffer_load_dwordx4 v3, s[44:47], s13 offen offset:2048 sc1 lds
    v_mfma_f32_16x16x32_bf16 v[52:55], a[60:63], v[100:103], v[52:55]
    v_mfma_f32_16x16x32_bf16 v[52:55], a[52:55], v[96:99], v[52:55]
    s_waitcnt lgkmcnt(0)
    v_mfma_f32_16x16x32_bf16 v[60:63], a[52:55], v[104:107], v[60:63]
    s_waitcnt vmcnt(18)
    s_barrier
    v_mfma_f32_16x16x32_bf16 v[60:63], a[60:63], v[108:111], v[60:63]
    ds_read_b128 v[80:83], v159 offset:24576
    s_add_u32 m0, s74, 12288
    s_mul_i32 s13, s27, 90112
    v_mfma_f32_16x16x32_bf16 v[56:59], a[56:59], v[108:111], v[56:59]
    ds_read_b128 v[84:87], v159 offset:30720
    v_mfma_f32_16x16x32_bf16 v[56:59], a[48:51], v[104:107], v[56:59]
    ds_read_b128 v[88:91], v159 offset:24832
    buffer_load_dwordx4 v8, s[44:47], s13 offen offset:0 sc1 lds
    v_mfma_f32_16x16x32_bf16 v[64:67], a[48:51], v[112:115], v[64:67]
    ds_read_b128 v[92:95], v159 offset:30976
    v_mfma_f32_16x16x32_bf16 v[64:67], a[56:59], v[116:119], v[64:67]
    ds_read_b128 v[96:99], v159 offset:25088
    v_mfma_f32_16x16x32_bf16 v[68:71], a[60:63], v[116:119], v[68:71]
    ds_read_b128 v[100:103], v159 offset:31232
    buffer_load_dwordx4 v9, s[44:47], s13 offen offset:1024 sc1 lds
    v_mfma_f32_16x16x32_bf16 v[68:71], a[52:55], v[112:115], v[68:71]
    v_add_u32 v10, -65536, v10
    v_mfma_f32_16x16x32_bf16 v[76:79], a[52:55], v[120:123], v[76:79]
    ds_read_b64_tr_b16 a[16:17], v10 offset:0
    v_mfma_f32_16x16x32_bf16 v[76:79], a[60:63], v[124:127], v[76:79]
    ds_read_b64_tr_b16 a[18:19], v10 offset:2048
    buffer_load_dwordx4 v3, s[44:47], s13 offen offset:2048 sc1 lds
    v_mfma_f32_16x16x32_bf16 v[72:75], a[56:59], v[124:127], v[72:75]
    ds_read_b64_tr_b16 a[24:25], v10 offset:4096
    v_mfma_f32_16x16x32_bf16 v[72:75], a[48:51], v[120:123], v[72:75]
    ds_read_b64_tr_b16 a[26:27], v10 offset:6144
    s_waitcnt lgkmcnt(4)
    v_mfma_f32_16x16x32_bf16 v[32:35], a[64:67], v[80:83], v[32:35]
    s_add_u32 m0, s73, 16384
    s_lshl_b32 s14, s86, 18
    v_mfma_f32_16x16x32_bf16 v[32:35], a[72:75], v[84:87], v[32:35]
    ds_read_b128 v[104:107], v159 offset:25344
    v_mfma_f32_16x16x32_bf16 v[36:39], a[76:79], v[84:87], v[36:39]
    ds_read_b128 v[108:111], v159 offset:31488
    buffer_load_dwordx4 v4, s[52:55], s14 offen offset:0 lds
    v_mfma_f32_16x16x32_bf16 v[36:39], a[68:71], v[80:83], v[36:39]
    ds_read_b128 v[112:115], v159 offset:25600
    v_mfma_f32_16x16x32_bf16 v[44:47], a[68:71], v[88:91], v[44:47]
    ds_read_b128 v[116:119], v159 offset:31744
    buffer_load_dwordx4 v5, s[52:55], s14 offen offset:1024 lds
    v_mfma_f32_16x16x32_bf16 v[44:47], a[76:79], v[92:95], v[44:47]
    ds_read_b128 v[120:123], v159 offset:25856
    v_mfma_f32_16x16x32_bf16 v[40:43], a[72:75], v[92:95], v[40:43]
    ds_read_b128 v[124:127], v159 offset:32000
    v_mfma_f32_16x16x32_bf16 v[40:43], a[64:67], v[88:91], v[40:43]
    buffer_load_dwordx4 v6, s[52:55], s14 offen offset:2048 lds
    v_add_u32 v11, -65536, v11
    v_mfma_f32_16x16x32_bf16 v[48:51], a[64:67], v[96:99], v[48:51]
    ds_read_b64_tr_b16 a[20:21], v11 offset:0
    v_mfma_f32_16x16x32_bf16 v[48:51], a[72:75], v[100:103], v[48:51]
    ds_read_b64_tr_b16 a[22:23], v11 offset:2048
    buffer_load_dwordx4 v7, s[52:55], s14 offen offset:3072 lds
    v_mfma_f32_16x16x32_bf16 v[52:55], a[76:79], v[100:103], v[52:55]
    ds_read_b64_tr_b16 a[28:29], v11 offset:4096
    v_mfma_f32_16x16x32_bf16 v[52:55], a[68:71], v[96:99], v[52:55]
    ds_read_b64_tr_b16 a[30:31], v11 offset:6144
    s_waitcnt lgkmcnt(4)
    v_mfma_f32_16x16x32_bf16 v[60:63], a[68:71], v[104:107], v[60:63]
    s_waitcnt vmcnt(18)
    s_barrier
    v_mfma_f32_16x16x32_bf16 v[60:63], a[76:79], v[108:111], v[60:63]
    ds_read_b128 v[80:83], v250 offset:0
    v_mfma_f32_16x16x32_bf16 v[56:59], a[72:75], v[108:111], v[56:59]
    ds_read_b128 v[84:87], v250 offset:6144
    v_mfma_f32_16x16x32_bf16 v[56:59], a[64:67], v[104:107], v[56:59]
    ds_read_b128 v[88:91], v250 offset:256
    v_mfma_f32_16x16x32_bf16 v[64:67], a[64:67], v[112:115], v[64:67]
    ds_read_b128 v[92:95], v250 offset:6400
    v_mfma_f32_16x16x32_bf16 v[64:67], a[72:75], v[116:119], v[64:67]
    ds_read_b128 v[96:99], v250 offset:512
    v_mfma_f32_16x16x32_bf16 v[68:71], a[76:79], v[116:119], v[68:71]
    ds_read_b128 v[100:103], v250 offset:6656
    v_mfma_f32_16x16x32_bf16 v[68:71], a[68:71], v[112:115], v[68:71]
    v_mfma_f32_16x16x32_bf16 v[76:79], a[68:71], v[120:123], v[76:79]
    v_mfma_f32_16x16x32_bf16 v[76:79], a[76:79], v[124:127], v[76:79]
    v_mfma_f32_16x16x32_bf16 v[72:75], a[72:75], v[124:127], v[72:75]
    v_mfma_f32_16x16x32_bf16 v[72:75], a[64:67], v[120:123], v[72:75]
    s_waitcnt lgkmcnt(0)
    v_mfma_f32_16x16x32_bf16 v[32:35], a[80:83], v[80:83], v[32:35]
    v_mfma_f32_16x16x32_bf16 v[32:35], a[88:91], v[84:87], v[32:35]
    ds_read_b128 v[104:107], v250 offset:768
    v_mfma_f32_16x16x32_bf16 v[36:39], a[92:95], v[84:87], v[36:39]
    ds_read_b128 v[108:111], v250 offset:6912
    v_mfma_f32_16x16x32_bf16 v[36:39], a[84:87], v[80:83], v[36:39]
    ds_read_b128 v[112:115], v250 offset:1024
    v_mfma_f32_16x16x32_bf16 v[44:47], a[84:87], v[88:91], v[44:47]
    ds_read_b128 v[116:119], v250 offset:7168
    v_mfma_f32_16x16x32_bf16 v[44:47], a[92:95], v[92:95], v[44:47]
    ds_read_b128 v[120:123], v250 offset:1280
    v_mfma_f32_16x16x32_bf16 v[40:43], a[88:91], v[92:95], v[40:43]
    ds_read_b128 v[124:127], v250 offset:7424
    v_mfma_f32_16x16x32_bf16 v[40:43], a[80:83], v[88:91], v[40:43]
    s_waitcnt vmcnt(13)
    buffer_store_dword v249, v248, s[44:47], s6 offen sc1
    v_mfma_f32_16x16x32_bf16 v[48:51], a[80:83], v[96:99], v[48:51]
    v_mfma_f32_16x16x32_bf16 v[48:51], a[88:91], v[100:103], v[48:51]
    v_mfma_f32_16x16x32_bf16 v[52:55], a[92:95], v[100:103], v[52:55]
    v_mfma_f32_16x16x32_bf16 v[52:55], a[84:87], v[96:99], v[52:55]
    s_waitcnt lgkmcnt(0)
    v_mfma_f32_16x16x32_bf16 v[60:63], a[84:87], v[104:107], v[60:63]
    s_barrier
    v_mfma_f32_16x16x32_bf16 v[60:63], a[92:95], v[108:111], v[60:63]
    ds_read_b128 v[80:83], v250 offset:12288
    v_mfma_f32_16x16x32_bf16 v[56:59], a[88:91], v[108:111], v[56:59]
    ds_read_b128 v[84:87], v250 offset:18432
    v_mfma_f32_16x16x32_bf16 v[56:59], a[80:83], v[104:107], v[56:59]
    ds_read_b128 v[88:91], v250 offset:12544
    v_mfma_f32_16x16x32_bf16 v[64:67], a[80:83], v[112:115], v[64:67]
    ds_read_b128 v[92:95], v250 offset:18688
    v_mfma_f32_16x16x32_bf16 v[64:67], a[88:91], v[116:119], v[64:67]
    ds_read_b128 v[96:99], v250 offset:12800
    v_mfma_f32_16x16x32_bf16 v[68:71], a[92:95], v[116:119], v[68:71]
    ds_read_b128 v[100:103], v250 offset:18944
    v_mfma_f32_16x16x32_bf16 v[68:71], a[84:87], v[112:115], v[68:71]
    v_mfma_f32_16x16x32_bf16 v[76:79], a[84:87], v[120:123], v[76:79]
    v_mfma_f32_16x16x32_bf16 v[76:79], a[92:95], v[124:127], v[76:79]
    v_mfma_f32_16x16x32_bf16 v[72:75], a[88:91], v[124:127], v[72:75]
    v_mfma_f32_16x16x32_bf16 v[72:75], a[80:83], v[120:123], v[72:75]
    s_waitcnt lgkmcnt(0)
    v_mfma_f32_16x16x32_bf16 v[32:35], a[96:99], v[80:83], v[32:35]
    v_mfma_f32_16x16x32_bf16 v[32:35], a[104:107], v[84:87], v[32:35]
    ds_read_b128 v[104:107], v250 offset:13056
    v_mfma_f32_16x16x32_bf16 v[36:39], a[108:111], v[84:87], v[36:39]
    ds_read_b128 v[108:111], v250 offset:19200
    v_mfma_f32_16x16x32_bf16 v[36:39], a[100:103], v[80:83], v[36:39]
    ds_read_b128 v[112:115], v250 offset:13312
    v_mfma_f32_16x16x32_bf16 v[44:47], a[100:103], v[88:91], v[44:47]
    ds_read_b128 v[116:119], v250 offset:19456
    v_mfma_f32_16x16x32_bf16 v[44:47], a[108:111], v[92:95], v[44:47]
    ds_read_b128 v[120:123], v250 offset:13568
    v_mfma_f32_16x16x32_bf16 v[40:43], a[104:107], v[92:95], v[40:43]
    ds_read_b128 v[124:127], v250 offset:19712
    v_mfma_f32_16x16x32_bf16 v[40:43], a[96:99], v[88:91], v[40:43]
    v_mfma_f32_16x16x32_bf16 v[48:51], a[96:99], v[96:99], v[48:51]
    v_mfma_f32_16x16x32_bf16 v[48:51], a[104:107], v[100:103], v[48:51]
    v_mfma_f32_16x16x32_bf16 v[52:55], a[108:111], v[100:103], v[52:55]
    v_mfma_f32_16x16x32_bf16 v[52:55], a[100:103], v[96:99], v[52:55]
    s_waitcnt lgkmcnt(0)
    v_mfma_f32_16x16x32_bf16 v[60:63], a[100:103], v[104:107], v[60:63]
    s_waitcnt vmcnt(11)
    s_barrier
    v_mfma_f32_16x16x32_bf16 v[60:63], a[108:111], v[108:111], v[60:63]
    ds_read_b128 v[80:83], v250 offset:24576
    s_add_u32 m0, s74, 24576
    s_mul_i32 s13, s76, 90112
    v_mfma_f32_16x16x32_bf16 v[56:59], a[104:107], v[108:111], v[56:59]
    ds_read_b128 v[84:87], v250 offset:30720
    v_mfma_f32_16x16x32_bf16 v[56:59], a[96:99], v[104:107], v[56:59]
L_pl_G_4:
    s_cbranch_execz L_wret
    ds_read_b128 v[88:91], v250 offset:24832
    buffer_load_dwordx4 v8, s[44:47], s13 offen offset:0 sc1 lds
    v_mfma_f32_16x16x32_bf16 v[64:67], a[96:99], v[112:115], v[64:67]
    ds_read_b128 v[92:95], v250 offset:30976
    v_mfma_f32_16x16x32_bf16 v[64:67], a[104:107], v[116:119], v[64:67]
    ds_read_b128 v[96:99], v250 offset:25088
    v_mfma_f32_16x16x32_bf16 v[68:71], a[108:111], v[116:119], v[68:71]
    ds_read_b128 v[100:103], v250 offset:31232
    buffer_load_dwordx4 v9, s[44:47], s13 offen offset:1024 sc1 lds
    v_mfma_f32_16x16x32_bf16 v[68:71], a[100:103], v[112:115], v[68:71]
    v_mfma_f32_16x16x32_bf16 v[76:79], a[100:103], v[120:123], v[76:79]
    v_mfma_f32_16x16x32_bf16 v[76:79], a[108:111], v[124:127], v[76:79]
    buffer_load_dwordx4 v3, s[44:47], s13 offen offset:2048 sc1 lds
    v_mfma_f32_16x16x32_bf16 v[72:75], a[104:107], v[124:127], v[72:75]
    v_mfma_f32_16x16x32_bf16 v[72:75], a[96:99], v[120:123], v[72:75]
    s_waitcnt lgkmcnt(0)
    v_mfma_f32_16x16x32_bf16 v[32:35], a[112:115], v[80:83], v[32:35]
    s_add_u32 m0, s74, 36864
    s_mul_i32 s13, s77, 90112
    v_mfma_f32_16x16x32_bf16 v[32:35], a[120:123], v[84:87], v[32:35]
    ds_read_b128 v[104:107], v250 offset:25344
    v_mfma_f32_16x16x32_bf16 v[36:39], a[124:127], v[84:87], v[36:39]
    ds_read_b128 v[108:111], v250 offset:31488
    v_mfma_f32_16x16x32_bf16 v[36:39], a[116:119], v[80:83], v[36:39]
    ds_read_b128 v[112:115], v250 offset:25600
    buffer_load_dwordx4 v8, s[44:47], s13 offen offset:0 sc1 lds
    v_mfma_f32_16x16x32_bf16 v[44:47], a[116:119], v[88:91], v[44:47]
    ds_read_b128 v[116:119], v250 offset:31744
    v_mfma_f32_16x16x32_bf16 v[44:47], a[124:127], v[92:95], v[44:47]
    ds_read_b128 v[120:123], v250 offset:25856
    v_mfma_f32_16x16x32_bf16 v[40:43], a[120:123], v[92:95], v[40:43]
    ds_read_b128 v[124:127], v250 offset:32000
    buffer_load_dwordx4 v9, s[44:47], s13 offen offset:1024 sc1 lds
    v_mfma_f32_16x16x32_bf16 v[40:43], a[112:115], v[88:91], v[40:43]
    v_mfma_f32_16x16x32_bf16 v[48:51], a[112:115], v[96:99], v[48:51]
    v_mfma_f32_16x16x32_bf16 v[48:51], a[120:123], v[100:103], v[48:51]
    buffer_load_dwordx4 v3, s[44:47], s13 offen offset:2048 sc1 lds
    v_mfma_f32_16x16x32_bf16 v[52:55], a[124:127], v[100:103], v[52:55]
    v_mfma_f32_16x16x32_bf16 v[52:55], a[116:119], v[96:99], v[52:55]
    s_waitcnt lgkmcnt(0)
    v_mfma_f32_16x16x32_bf16 v[60:63], a[116:119], v[104:107], v[60:63]
    s_waitcnt vmcnt(14)
    s_barrier
    v_mfma_f32_16x16x32_bf16 v[60:63], a[124:127], v[108:111], v[60:63]
    ds_read_b128 v[80:83], v159 offset:0
    s_add_u32 m0, s74, 49152
    s_mul_i32 s13, s78, 90112
    v_mfma_f32_16x16x32_bf16 v[56:59], a[120:123], v[108:111], v[56:59]
    ds_read_b128 v[84:87], v159 offset:6144
    v_mfma_f32_16x16x32_bf16 v[56:59], a[112:115], v[104:107], v[56:59]
    ds_read_b128 v[88:91], v159 offset:256
    buffer_load_dwordx4 v8, s[44:47], s13 offen offset:0 sc1 lds
    v_mfma_f32_16x16x32_bf16 v[64:67], a[112:115], v[112:115], v[64:67]
    ds_read_b128 v[92:95], v159 offset:6400
    v_mfma_f32_16x16x32_bf16 v[64:67], a[120:123], v[116:119], v[64:67]
    ds_read_b128 v[96:99], v159 offset:512
    v_mfma_f32_16x16x32_bf16 v[68:71], a[124:127], v[116:119], v[68:71]
    ds_read_b128 v[100:103], v159 offset:6656
    buffer_load_dwordx4 v9, s[44:47], s13 offen offset:1024 sc1 lds
    v_mfma_f32_16x16x32_bf16 v[68:71], a[116:119], v[112:115], v[68:71]
    v_mfma_f32_16x16x32_bf16 v[76:79], a[116:119], v[120:123], v[76:79]
    v_mfma_f32_16x16x32_bf16 v[76:79], a[124:127], v[124:127], v[76:79]
    buffer_load_dwordx4 v3, s[44:47], s13 offen offset:2048 sc1 lds
    v_mfma_f32_16x16x32_bf16 v[72:75], a[120:123], v[124:127], v[72:75]
    v_mfma_f32_16x16x32_bf16 v[72:75], a[112:115], v[120:123], v[72:75]
    s_waitcnt lgkmcnt(0)
    v_mfma_f32_16x16x32_bf16 v[32:35], a[128:131], v[80:83], v[32:35]
    s_add_u32 m0, s74, 61440
    s_mul_i32 s13, s79, 90112
    v_mfma_f32_16x16x32_bf16 v[32:35], a[136:139], v[84:87], v[32:35]
    ds_read_b128 v[104:107], v159 offset:768
    v_mfma_f32_16x16x32_bf16 v[36:39], a[140:143], v[84:87], v[36:39]
    ds_read_b128 v[108:111], v159 offset:6912
    v_mfma_f32_16x16x32_bf16 v[36:39], a[132:135], v[80:83], v[36:39]
    ds_read_b128 v[112:115], v159 offset:1024
    buffer_load_dwordx4 v8, s[44:47], s13 offen offset:0 sc1 lds
    v_mfma_f32_16x16x32_bf16 v[44:47], a[132:135], v[88:91], v[44:47]
    ds_read_b128 v[116:119], v159 offset:7168
    v_mfma_f32_16x16x32_bf16 v[44:47], a[140:143], v[92:95], v[44:47]
    ds_read_b128 v[120:123], v159 offset:1280
    v_mfma_f32_16x16x32_bf16 v[40:43], a[136:139], v[92:95], v[40:43]
    ds_read_b128 v[124:127], v159 offset:7424
    buffer_load_dwordx4 v9, s[44:47], s13 offen offset:1024 sc1 lds
    v_mfma_f32_16x16x32_bf16 v[40:43], a[128:131], v[88:91], v[40:43]
    v_mfma_f32_16x16x32_bf16 v[48:51], a[128:131], v[96:99], v[48:51]
    v_mfma_f32_16x16x32_bf16 v[48:51], a[136:139], v[100:103], v[48:51]
    buffer_load_dwordx4 v3, s[44:47], s13 offen offset:2048 sc1 lds
    v_mfma_f32_16x16x32_bf16 v[52:55], a[140:143], v[100:103], v[52:55]
    v_mfma_f32_16x16x32_bf16 v[52:55], a[132:135], v[96:99], v[52:55]
    s_waitcnt lgkmcnt(0)
    v_mfma_f32_16x16x32_bf16 v[60:63], a[132:135], v[104:107], v[60:63]
    s_waitcnt vmcnt(13)
    s_barrier
    v_mfma_f32_16x16x32_bf16 v[60:63], a[140:143], v[108:111], v[60:63]
    ds_read_b128 v[80:83], v159 offset:12288
    s_add_u32 m0, s74, 0
    s_mul_i32 s13, s80, 90112
    v_mfma_f32_16x16x32_bf16 v[56:59], a[136:139], v[108:111], v[56:59]
    ds_read_b128 v[84:87], v159 offset:18432
    v_mfma_f32_16x16x32_bf16 v[56:59], a[128:131], v[104:107], v[56:59]
    ds_read_b128 v[88:91], v159 offset:12544
    buffer_load_dwordx4 v8, s[44:47], s13 offen offset:0 sc1 lds
    v_mfma_f32_16x16x32_bf16 v[64:67], a[128:131], v[112:115], v[64:67]
    ds_read_b128 v[92:95], v159 offset:18688
    v_mfma_f32_16x16x32_bf16 v[64:67], a[136:139], v[116:119], v[64:67]
    ds_read_b128 v[96:99], v159 offset:12800
    buffer_load_dword v29, v28, s[44:47], 0 offen sc1
    v_mfma_f32_16x16x32_bf16 v[68:71], a[140:143], v[116:119], v[68:71]
    ds_read_b128 v[100:103], v159 offset:18944
    buffer_load_dwordx4 v9, s[44:47], s13 offen offset:1024 sc1 lds
    v_mfma_f32_16x16x32_bf16 v[68:71], a[132:135], v[112:115], v[68:71]
    ds_read_b64_tr_b16 a[32:33], v10 offset:16384
    v_mfma_f32_16x16x32_bf16 v[76:79], a[132:135], v[120:123], v[76:79]
    ds_read_b64_tr_b16 a[34:35], v10 offset:18432
    v_mfma_f32_16x16x32_bf16 v[76:79], a[140:143], v[124:127], v[76:79]
    buffer_load_dwordx4 v3, s[44:47], s13 offen offset:2048 sc1 lds
    v_mfma_f32_16x16x32_bf16 v[72:75], a[136:139], v[124:127], v[72:75]
    ds_read_b64_tr_b16 a[40:41], v10 offset:20480
    v_mfma_f32_16x16x32_bf16 v[72:75], a[128:131], v[120:123], v[72:75]
    ds_read_b64_tr_b16 a[42:43], v10 offset:22528
    s_waitcnt lgkmcnt(4)
    v_mfma_f32_16x16x32_bf16 v[32:35], a[144:147], v[80:83], v[32:35]
    s_add_u32 m0, s73, 32768
    s_lshl_b32 s14, s87, 18
    v_mfma_f32_16x16x32_bf16 v[32:35], a[152:155], v[84:87], v[32:35]
    ds_read_b128 v[104:107], v159 offset:13056
    v_mfma_f32_16x16x32_bf16 v[36:39], a[156:159], v[84:87], v[36:39]
    ds_read_b128 v[108:111], v159 offset:19200
    buffer_load_dwordx4 v4, s[52:55], s14 offen offset:0 lds
    v_mfma_f32_16x16x32_bf16 v[36:39], a[148:151], v[80:83], v[36:39]
    ds_read_b128 v[112:115], v159 offset:13312
    v_mfma_f32_16x16x32_bf16 v[44:47], a[148:151], v[88:91], v[44:47]
    ds_read_b128 v[116:119], v159 offset:19456
    buffer_load_dwordx4 v5, s[52:55], s14 offen offset:1024 lds
    v_mfma_f32_16x16x32_bf16 v[44:47], a[156:159], v[92:95], v[44:47]
    ds_read_b128 v[120:123], v159 offset:13568
    v_mfma_f32_16x16x32_bf16 v[40:43], a[152:155], v[92:95], v[40:43]
    ds_read_b128 v[124:127], v159 offset:19712
    v_mfma_f32_16x16x32_bf16 v[40:43], a[144:147], v[88:91], v[40:43]
    ds_read_b64_tr_b16 a[36:37], v11 offset:16384
    buffer_load_dwordx4 v6, s[52:55], s14 offen offset:2048 lds
    v_mfma_f32_16x16x32_bf16 v[48:51], a[144:147], v[96:99], v[48:51]
    ds_read_b64_tr_b16 a[38:39], v11 offset:18432
    v_mfma_f32_16x16x32_bf16 v[48:51], a[152:155], v[100:103], v[48:51]
    buffer_load_dwordx4 v7, s[52:55], s14 offen offset:3072 lds
    v_mfma_f32_16x16x32_bf16 v[52:55], a[156:159], v[100:103], v[52:55]
    ds_read_b64_tr_b16 a[44:45], v11 offset:20480
    v_mfma_f32_16x16x32_bf16 v[52:55], a[148:151], v[96:99], v[52:55]
    ds_read_b64_tr_b16 a[46:47], v11 offset:22528
    s_waitcnt lgkmcnt(4)
    v_mfma_f32_16x16x32_bf16 v[60:63], a[148:151], v[104:107], v[60:63]
    s_waitcnt vmcnt(17)
    s_barrier
    v_mfma_f32_16x16x32_bf16 v[60:63], a[156:159], v[108:111], v[60:63]
    ds_read_b128 v[80:83], v159 offset:24576
    v_mfma_f32_16x16x32_bf16 v[56:59], a[152:155], v[108:111], v[56:59]
    ds_read_b128 v[84:87], v159 offset:30720
    v_mfma_f32_16x16x32_bf16 v[56:59], a[144:147], v[104:107], v[56:59]
    ds_read_b128 v[88:91], v159 offset:24832
    v_mfma_f32_16x16x32_bf16 v[64:67], a[144:147], v[112:115], v[64:67]
    ds_read_b128 v[92:95], v159 offset:30976
    v_mfma_f32_16x16x32_bf16 v[64:67], a[152:155], v[116:119], v[64:67]
    ds_read_b128 v[96:99], v159 offset:25088
    v_mfma_f32_16x16x32_bf16 v[68:71], a[156:159], v[116:119], v[68:71]
    ds_read_b128 v[100:103], v159 offset:31232
    v_mfma_f32_16x16x32_bf16 v[68:71], a[148:151], v[112:115], v[68:71]
    v_mfma_f32_16x16x32_bf16 v[76:79], a[148:151], v[120:123], v[76:79]
    v_mfma_f32_16x16x32_bf16 v[76:79], a[156:159], v[124:127], v[76:79]
    v_mfma_f32_16x16x32_bf16 v[72:75], a[152:155], v[124:127], v[72:75]
    v_mfma_f32_16x16x32_bf16 v[72:75], a[144:147], v[120:123], v[72:75]
    s_waitcnt lgkmcnt(0)
    v_mfma_f32_16x16x32_bf16 v[32:35], a[160:163], v[80:83], v[32:35]
    v_mfma_f32_16x16x32_bf16 v[32:35], a[168:171], v[84:87], v[32:35]
    ds_read_b128 v[104:107], v159 offset:25344
    v_mfma_f32_16x16x32_bf16 v[36:39], a[172:175], v[84:87], v[36:39]
    ds_read_b128 v[108:111], v159 offset:31488
    v_mfma_f32_16x16x32_bf16 v[36:39], a[164:167], v[80:83], v[36:39]
    ds_read_b128 v[112:115], v159 offset:25600
    v_mfma_f32_16x16x32_bf16 v[44:47], a[164:167], v[88:91], v[44:47]
    ds_read_b128 v[116:119], v159 offset:31744
    v_mfma_f32_16x16x32_bf16 v[44:47], a[172:175], v[92:95], v[44:47]
    ds_read_b128 v[120:123], v159 offset:25856
    v_mfma_f32_16x16x32_bf16 v[40:43], a[168:171], v[92:95], v[40:43]
    ds_read_b128 v[124:127], v159 offset:32000
    v_mfma_f32_16x16x32_bf16 v[40:43], a[160:163], v[88:91], v[40:43]
    v_mfma_f32_16x16x32_bf16 v[48:51], a[160:163], v[96:99], v[48:51]
    v_mfma_f32_16x16x32_bf16 v[48:51], a[168:171], v[100:103], v[48:51]
    v_mfma_f32_16x16x32_bf16 v[52:55], a[172:175], v[100:103], v[52:55]
    v_mfma_f32_16x16x32_bf16 v[52:55], a[164:167], v[96:99], v[52:55]
    s_waitcnt lgkmcnt(0)
    v_mfma_f32_16x16x32_bf16 v[60:63], a[164:167], v[104:107], v[60:63]
    s_waitcnt vmcnt(14)
    s_barrier
    v_mfma_f32_16x16x32_bf16 v[60:63], a[172:175], v[108:111], v[60:63]
    ds_read_b128 v[80:83], v250 offset:0
    s_waitcnt vmcnt(6)
    v_mfma_f32_16x16x32_bf16 v[56:59], a[168:171], v[108:111], v[56:59]
    ds_read_b128 v[84:87], v250 offset:6144
    v_cmp_ne_u32 vcc, s68, v29
    v_mfma_f32_16x16x32_bf16 v[56:59], a[160:163], v[104:107], v[56:59]
    ds_read_b128 v[88:91], v250 offset:256
    v_mfma_f32_16x16x32_bf16 v[64:67], a[160:163], v[112:115], v[64:67]
    ds_read_b128 v[92:95], v250 offset:6400
    v_mfma_f32_16x16x32_bf16 v[64:67], a[168:171], v[116:119], v[64:67]
    ds_read_b128 v[96:99], v250 offset:512
    s_cbranch_vccnz L_rs_p5
L_ok_p5:
    v_mfma_f32_16x16x32_bf16 v[68:71], a[172:175], v[116:119], v[68:71]
    ds_read_b128 v[100:103], v250 offset:6656
    buffer_load_dwordx4 v[160:163], v246, s[44:47], s10 offen offset:0 sc1
    v_mfma_f32_16x16x32_bf16 v[68:71], a[164:167], v[112:115], v[68:71]
    v_mfma_f32_16x16x32_bf16 v[76:79], a[164:167], v[120:123], v[76:79]
    v_mfma_f32_16x16x32_bf16 v[76:79], a[172:175], v[124:127], v[76:79]
    buffer_load_dwordx4 v[164:167], v246, s[44:47], s10 offen offset:1024 sc1
    v_mfma_f32_16x16x32_bf16 v[72:75], a[168:171], v[124:127], v[72:75]
    buffer_load_dwordx4 v[168:171], v246, s[44:47], s10 offen offset:2048 sc1
    v_mfma_f32_16x16x32_bf16 v[72:75], a[160:163], v[120:123], v[72:75]
    s_waitcnt lgkmcnt(0)
    v_mfma_f32_16x16x32_bf16 v[32:35], a[176:179], v[80:83], v[32:35]
    v_mfma_f32_16x16x32_bf16 v[32:35], a[184:187], v[84:87], v[32:35]
    ds_read_b128 v[104:107], v250 offset:768
    v_mfma_f32_16x16x32_bf16 v[36:39], a[188:191], v[84:87], v[36:39]
    ds_read_b128 v[108:111], v250 offset:6912
    buffer_load_dwordx4 v[172:175], v247, s[44:47], s10 offen offset:0 sc1
    v_mfma_f32_16x16x32_bf16 v[36:39], a[180:183], v[80:83], v[36:39]
    ds_read_b128 v[112:115], v250 offset:1024
    v_mfma_f32_16x16x32_bf16 v[44:47], a[180:183], v[88:91], v[44:47]
    ds_read_b128 v[116:119], v250 offset:7168
    v_mfma_f32_16x16x32_bf16 v[44:47], a[188:191], v[92:95], v[44:47]
    ds_read_b128 v[120:123], v250 offset:1280
    buffer_load_dwordx4 v[176:179], v247, s[44:47], s10 offen offset:1024 sc1
    v_mfma_f32_16x16x32_bf16 v[40:43], a[184:187], v[92:95], v[40:43]
    ds_read_b128 v[124:127], v250 offset:7424
    v_mfma_f32_16x16x32_bf16 v[40:43], a[176:179], v[88:91], v[40:43]
    v_mfma_f32_16x16x32_bf16 v[48:51], a[176:179], v[96:99], v[48:51]
    v_mfma_f32_16x16x32_bf16 v[48:51], a[184:187], v[100:103], v[48:51]
    v_mfma_f32_16x16x32_bf16 v[52:55], a[188:191], v[100:103], v[52:55]
    buffer_load_dwordx4 v[180:183], v247, s[44:47], s10 offen offset:2048 sc1
    v_mfma_f32_16x16x32_bf16 v[52:55], a[180:183], v[96:99], v[52:55]
    s_waitcnt lgkmcnt(0)
    v_mfma_f32_16x16x32_bf16 v[60:63], a[180:183], v[104:107], v[60:63]
    s_barrier
    v_mfma_f32_16x16x32_bf16 v[60:63], a[188:191], v[108:111], v[60:63]
    ds_read_b128 v[80:83], v250 offset:12288
    s_add_u32 m0, s74, 12288
    s_mul_i32 s13, s81, 90112
    v_mfma_f32_16x16x32_bf16 v[56:59], a[184:187], v[108:111], v[56:59]
    ds_read_b128 v[84:87], v250 offset:18432
    v_mfma_f32_16x16x32_bf16 v[56:59], a[176:179], v[104:107], v[56:59]
    ds_read_b128 v[88:91], v250 offset:12544
    buffer_load_dwordx4 v8, s[44:47], s13 offen offset:0 sc1 lds
    v_mfma_f32_16x16x32_bf16 v[64:67], a[176:179], v[112:115], v[64:67]
    ds_read_b128 v[92:95], v250 offset:18688
    v_mfma_f32_16x16x32_bf16 v[64:67], a[184:187], v[116:119], v[64:67]
    ds_read_b128 v[96:99], v250 offset:12800
    v_mfma_f32_16x16x32_bf16 v[68:71], a[188:191], v[116:119], v[68:71]
    ds_read_b128 v[100:103], v250 offset:18944
    buffer_load_dwordx4 v9, s[44:47], s13 offen offset:1024 sc1 lds
    v_mfma_f32_16x16x32_bf16 v[68:71], a[180:183], v[112:115], v[68:71]
    v_mfma_f32_16x16x32_bf16 v[76:79], a[180:183], v[120:123], v[76:79]
    v_mfma_f32_16x16x32_bf16 v[76:79], a[188:191], v[124:127], v[76:79]
    buffer_load_dwordx4 v3, s[44:47], s13 offen offset:2048 sc1 lds
    v_mfma_f32_16x16x32_bf16 v[72:75], a[184:187], v[124:127], v[72:75]
    v_mfma_f32_16x16x32_bf16 v[72:75], a[176:179], v[120:123], v[72:75]
    s_waitcnt lgkmcnt(0)
    v_mfma_f32_16x16x32_bf16 v[32:35], a[192:195], v[80:83], v[32:35]
    s_add_u32 m0, s73, 49152
    s_lshl_b32 s14, s88, 18
    v_mfma_f32_16x16x32_bf16 v[32:35], a[200:203], v[84:87], v[32:35]
    ds_read_b128 v[104:107], v250 offset:13056
    v_mfma_f32_16x16x32_bf16 v[36:39], a[204:207], v[84:87], v[36:39]
    ds_read_b128 v[108:111], v250 offset:19200
    buffer_load_dwordx4 v4, s[52:55], s14 offen offset:0 lds
    v_mfma_f32_16x16x32_bf16 v[36:39], a[196:199], v[80:83], v[36:39]
    ds_read_b128 v[112:115], v250 offset:13312
    v_mfma_f32_16x16x32_bf16 v[44:47], a[196:199], v[88:91], v[44:47]
    ds_read_b128 v[116:119], v250 offset:19456
    buffer_load_dwordx4 v5, s[52:55], s14 offen offset:1024 lds
    v_mfma_f32_16x16x32_bf16 v[44:47], a[204:207], v[92:95], v[44:47]
    ds_read_b128 v[120:123], v250 offset:13568
    v_mfma_f32_16x16x32_bf16 v[40:43], a[200:203], v[92:95], v[40:43]
    ds_read_b128 v[124:127], v250 offset:19712
    v_mfma_f32_16x16x32_bf16 v[40:43], a[192:195], v[88:91], v[40:43]
    buffer_load_dwordx4 v6, s[52:55], s14 offen offset:2048 lds
    v_mfma_f32_16x16x32_bf16 v[48:51], a[192:195], v[96:99], v[48:51]
    v_mfma_f32_16x16x32_bf16 v[48:51], a[200:203], v[100:103], v[48:51]
    buffer_load_dwordx4 v7, s[52:55], s14 offen offset:3072 lds
    v_mfma_f32_16x16x32_bf16 v[52:55], a[204:207], v[100:103], v[52:55]
    v_mfma_f32_16x16x32_bf16 v[52:55], a[196:199], v[96:99], v[52:55]
    s_waitcnt lgkmcnt(0)
    v_mfma_f32_16x16x32_bf16 v[60:63], a[196:199], v[104:107], v[60:63]
    s_barrier
    v_mfma_f32_16x16x32_bf16 v[60:63], a[204:207], v[108:111], v[60:63]
    ds_read_b128 v[80:83], v250 offset:24576
    v_mfma_f32_16x16x32_bf16 v[56:59], a[200:203], v[108:111], v[56:59]
    ds_read_b128 v[84:87], v250 offset:30720
    v_mfma_f32_16x16x32_bf16 v[56:59], a[192:195], v[104:107], v[56:59]
    ds_read_b128 v[88:91], v250 offset:24832
    v_mfma_f32_16x16x32_bf16 v[64:67], a[192:195], v[112:115], v[64:67]
    ds_read_b128 v[92:95], v250 offset:30976
    v_mfma_f32_16x16x32_bf16 v[64:67], a[200:203], v[116:119], v[64:67]
    ds_read_b128 v[96:99], v250 offset:25088
    v_mfma_f32_16x16x32_bf16 v[68:71], a[204:207], v[116:119], v[68:71]
    ds_read_b128 v[100:103], v250 offset:31232
    s_waitcnt vmcnt(7)
    v_mfma_f32_16x16x32_bf16 v[68:71], a[196:199], v[112:115], v[68:71]
    v_mfma_f32_16x16x32_bf16 v[76:79], a[196:199], v[120:123], v[76:79]
    v_mfma_f32_16x16x32_bf16 v[76:79], a[204:207], v[124:127], v[76:79]
    v_mfma_f32_16x16x32_bf16 v[72:75], a[200:203], v[124:127], v[72:75]
    v_mfma_f32_16x16x32_bf16 v[72:75], a[192:195], v[120:123], v[72:75]
    s_waitcnt lgkmcnt(0)
    v_mfma_f32_16x16x32_bf16 v[32:35], a[208:211], v[80:83], v[32:35]
    s_add_u32 m0, s73, 65536
    s_lshl_b32 s14, s89, 18
    v_mfma_f32_16x16x32_bf16 v[32:35], a[216:219], v[84:87], v[32:35]
    ds_read_b128 v[104:107], v250 offset:25344
    v_mfma_f32_16x16x32_bf16 v[36:39], a[220:223], v[84:87], v[36:39]
    ds_read_b128 v[108:111], v250 offset:31488
    buffer_load_dwordx4 v4, s[52:55], s14 offen offset:0 lds
    v_and_b32 v193, 0xffff0000, v172
    v_lshlrev_b32 v192, 16, v172
    v_mfma_f32_16x16x32_bf16 v[36:39], a[212:215], v[80:83], v[36:39]
    ds_read_b128 v[112:115], v250 offset:25600
    v_and_b32 v195, 0xffff0000, v173
    v_lshlrev_b32 v194, 16, v173
    v_mfma_f32_16x16x32_bf16 v[44:47], a[212:215], v[88:91], v[44:47]
    ds_read_b128 v[116:119], v250 offset:31744
    buffer_load_dwordx4 v5, s[52:55], s14 offen offset:1024 lds
    v_add_f32 v56, v56, v192
    v_mfma_f32_16x16x32_bf16 v[44:47], a[220:223], v[92:95], v[44:47]
    ds_read_b128 v[120:123], v250 offset:25856
    v_add_f32 v57, v57, v193
    v_add_f32 v58, v58, v194
    v_mfma_f32_16x16x32_bf16 v[40:43], a[216:219], v[92:95], v[40:43]
    ds_read_b128 v[124:127], v250 offset:32000
    v_add_f32 v59, v59, v195
    v_and_b32 v197, 0xffff0000, v174
    v_mfma_f32_16x16x32_bf16 v[40:43], a[208:211], v[88:91], v[40:43]
    buffer_load_dwordx4 v6, s[52:55], s14 offen offset:2048 lds
    v_lshlrev_b32 v196, 16, v174
    v_and_b32 v199, 0xffff0000, v175
    v_mfma_f32_16x16x32_bf16 v[48:51], a[208:211], v[96:99], v[48:51]
    v_lshlrev_b32 v198, 16, v175
    v_add_f32 v60, v60, v196
    v_mfma_f32_16x16x32_bf16 v[48:51], a[216:219], v[100:103], v[48:51]
    buffer_load_dwordx4 v7, s[52:55], s14 offen offset:3072 lds
    v_add_f32 v61, v61, v197
    v_mfma_f32_16x16x32_bf16 v[52:55], a[220:223], v[100:103], v[52:55]
    v_add_f32 v62, v62, v198
    v_add_f32 v63, v63, v199
    v_mfma_f32_16x16x32_bf16 v[52:55], a[212:215], v[96:99], v[52:55]
    s_waitcnt lgkmcnt(0)
    v_mfma_f32_16x16x32_bf16 v[60:63], a[212:215], v[104:107], v[60:63]
    s_barrier
    v_mfma_f32_16x16x32_bf16 v[60:63], a[220:223], v[108:111], v[60:63]
    ds_read_b128 v[80:83], v159 offset:0
    v_mfma_f32_16x16x32_bf16 v[56:59], a[216:219], v[108:111], v[56:59]
    ds_read_b128 v[84:87], v159 offset:6144
    v_and_b32 v193, 0xffff0000, v160
    v_lshlrev_b32 v192, 16, v160
    v_mfma_f32_16x16x32_bf16 v[56:59], a[208:211], v[104:107], v[56:59]
    ds_read_b128 v[88:91], v159 offset:256
    v_and_b32 v195, 0xffff0000, v161
    v_lshlrev_b32 v194, 16, v161
    v_mfma_f32_16x16x32_bf16 v[64:67], a[208:211], v[112:115], v[64:67]
    ds_read_b128 v[92:95], v159 offset:6400
    v_add_f32 v32, v32, v192
    v_mfma_f32_16x16x32_bf16 v[64:67], a[216:219], v[116:119], v[64:67]
    ds_read_b128 v[96:99], v159 offset:512
    v_add_f32 v33, v33, v193
    v_add_f32 v34, v34, v194
    v_mfma_f32_16x16x32_bf16 v[68:71], a[220:223], v[116:119], v[68:71]
    ds_read_b128 v[100:103], v159 offset:6656
    v_add_f32 v35, v35, v195
    v_and_b32 v197, 0xffff0000, v162
    v_mfma_f32_16x16x32_bf16 v[68:71], a[212:215], v[112:115], v[68:71]
    ds_read_b64_tr_b16 a[48:49], v10 offset:32768
    v_lshlrev_b32 v196, 16, v162
    v_and_b32 v199, 0xffff0000, v163
    v_mfma_f32_16x16x32_bf16 v[76:79], a[212:215], v[120:123], v[76:79]
    ds_read_b64_tr_b16 a[50:51], v10 offset:34816
    v_lshlrev_b32 v198, 16, v163
    v_mfma_f32_16x16x32_bf16 v[76:79], a[220:223], v[124:127], v[76:79]
    v_add_f32 v36, v36, v196
    v_add_f32 v37, v37, v197
    v_mfma_f32_16x16x32_bf16 v[72:75], a[216:219], v[124:127], v[72:75]
    ds_read_b64_tr_b16 a[56:57], v10 offset:36864
    v_add_f32 v38, v38, v198
    v_add_f32 v39, v39, v199
    v_mfma_f32_16x16x32_bf16 v[72:75], a[208:211], v[120:123], v[72:75]
    ds_read_b64_tr_b16 a[58:59], v10 offset:38912
    s_waitcnt lgkmcnt(4)
    v_mfma_f32_16x16x32_bf16 v[32:35], a[224:227], v[80:83], v[32:35]
    s_add_u32 m0, s73, 0
    s_lshl_b32 s14, s90, 18
    v_mfma_f32_16x16x32_bf16 v[32:35], a[232:235], v[84:87], v[32:35]
    ds_read_b128 v[104:107], v159 offset:768
    v_mfma_f32_16x16x32_bf16 v[36:39], a[236:239], v[84:87], v[36:39]
    ds_read_b128 v[108:111], v159 offset:6912
    buffer_load_dwordx4 v4, s[52:55], s14 offen offset:0 lds
    v_and_b32 v193, 0xffff0000, v176
    v_lshlrev_b32 v192, 16, v176
    v_mfma_f32_16x16x32_bf16 v[36:39], a[228:231], v[80:83], v[36:39]
    ds_read_b128 v[112:115], v159 offset:1024
    v_and_b32 v195, 0xffff0000, v177
    v_lshlrev_b32 v194, 16, v177
    v_mfma_f32_16x16x32_bf16 v[44:47], a[228:231], v[88:91], v[44:47]
    ds_read_b128 v[116:119], v159 offset:7168
    buffer_load_dwordx4 v5, s[52:55], s14 offen offset:1024 lds
    v_add_f32 v64, v64, v192
    v_mfma_f32_16x16x32_bf16 v[44:47], a[236:239], v[92:95], v[44:47]
    ds_read_b128 v[120:123], v159 offset:1280
    v_add_f32 v65, v65, v193
    v_add_f32 v66, v66, v194
    v_mfma_f32_16x16x32_bf16 v[40:43], a[232:235], v[92:95], v[40:43]
    ds_read_b128 v[124:127], v159 offset:7424
    v_add_f32 v67, v67, v195
    v_and_b32 v197, 0xffff0000, v178
    v_mfma_f32_16x16x32_bf16 v[40:43], a[224:227], v[88:91], v[40:43]
    ds_read_b64_tr_b16 a[52:53], v11 offset:32768
    buffer_load_dwordx4 v6, s[52:55], s14 offen offset:2048 lds
    v_lshlrev_b32 v196, 16, v178
    v_and_b32 v199, 0xffff0000, v179
    v_mfma_f32_16x16x32_bf16 v[48:51], a[224:227], v[96:99], v[48:51]
    ds_read_b64_tr_b16 a[54:55], v11 offset:34816
    v_lshlrev_b32 v198, 16, v179
    v_mfma_f32_16x16x32_bf16 v[48:51], a[232:235], v[100:103], v[48:51]
    buffer_load_dwordx4 v7, s[52:55], s14 offen offset:3072 lds
    v_add_f32 v68, v68, v196
    v_add_f32 v69, v69, v197
    v_mfma_f32_16x16x32_bf16 v[52:55], a[236:239], v[100:103], v[52:55]
    ds_read_b64_tr_b16 a[60:61], v11 offset:36864
    v_add_f32 v70, v70, v198
    v_add_f32 v71, v71, v199
    v_mfma_f32_16x16x32_bf16 v[52:55], a[228:231], v[96:99], v[52:55]
    ds_read_b64_tr_b16 a[62:63], v11 offset:38912
    s_waitcnt lgkmcnt(4)
    v_mfma_f32_16x16x32_bf16 v[60:63], a[228:231], v[104:107], v[60:63]
    s_waitcnt vmcnt(12)
    s_barrier
    v_mfma_f32_16x16x32_bf16 v[60:63], a[236:239], v[108:111], v[60:63]
    ds_read_b128 v[80:83], v159 offset:12288
    v_mfma_f32_16x16x32_bf16 v[56:59], a[232:235], v[108:111], v[56:59]
    ds_read_b128 v[84:87], v159 offset:18432
    v_and_b32 v193, 0xffff0000, v164
    v_lshlrev_b32 v192, 16, v164
    v_mfma_f32_16x16x32_bf16 v[56:59], a[224:227], v[104:107], v[56:59]
    ds_read_b128 v[88:91], v159 offset:12544
    v_and_b32 v195, 0xffff0000, v165
    v_lshlrev_b32 v194, 16, v165
    v_mfma_f32_16x16x32_bf16 v[64:67], a[224:227], v[112:115], v[64:67]
    ds_read_b128 v[92:95], v159 offset:18688
    v_add_f32 v40, v40, v192
    v_mfma_f32_16x16x32_bf16 v[64:67], a[232:235], v[116:119], v[64:67]
    ds_read_b128 v[96:99], v159 offset:12800
    v_add_f32 v41, v41, v193
    v_add_f32 v42, v42, v194
    v_mfma_f32_16x16x32_bf16 v[68:71], a[236:239], v[116:119], v[68:71]
    ds_read_b128 v[100:103], v159 offset:18944
    v_add_f32 v43, v43, v195
    v_mfma_f32_16x16x32_bf16 v[68:71], a[228:231], v[112:115], v[68:71]
    v_and_b32 v197, 0xffff0000, v166
    v_lshlrev_b32 v196, 16, v166
    v_mfma_f32_16x16x32_bf16 v[76:79], a[228:231], v[120:123], v[76:79]
    v_and_b32 v199, 0xffff0000, v167
    v_lshlrev_b32 v198, 16, v167
    v_mfma_f32_16x16x32_bf16 v[76:79], a[236:239], v[124:127], v[76:79]
    v_add_f32 v44, v44, v196
    v_add_f32 v45, v45, v197
    v_mfma_f32_16x16x32_bf16 v[72:75], a[232:235], v[124:127], v[72:75]
    v_add_f32 v46, v46, v198
    v_add_f32 v47, v47, v199
    v_mfma_f32_16x16x32_bf16 v[72:75], a[224:227], v[120:123], v[72:75]
    s_waitcnt lgkmcnt(0)
    v_mfma_f32_16x16x32_bf16 v[32:35], a[240:243], v[80:83], v[32:35]
    s_add_u32 m0, s73, 16384
    s_lshl_b32 s14, s91, 18
    v_mfma_f32_16x16x32_bf16 v[32:35], a[248:251], v[84:87], v[32:35]
    ds_read_b128 v[104:107], v159 offset:13056
    v_mfma_f32_16x16x32_bf16 v[36:39], a[252:255], v[84:87], v[36:39]
    ds_read_b128 v[108:111], v159 offset:19200
    buffer_load_dwordx4 v4, s[52:55], s14 offen offset:0 lds
    v_and_b32 v193, 0xffff0000, v180
    v_lshlrev_b32 v192, 16, v180
    v_mfma_f32_16x16x32_bf16 v[36:39], a[244:247], v[80:83], v[36:39]
    ds_read_b128 v[112:115], v159 offset:13312
    v_and_b32 v195, 0xffff0000, v181
    v_lshlrev_b32 v194, 16, v181
    v_mfma_f32_16x16x32_bf16 v[44:47], a[244:247], v[88:91], v[44:47]
    ds_read_b128 v[116:119], v159 offset:19456
    buffer_load_dwordx4 v5, s[52:55], s14 offen offset:1024 lds
    v_add_f32 v72, v72, v192
    v_mfma_f32_16x16x32_bf16 v[44:47], a[252:255], v[92:95], v[44:47]
    ds_read_b128 v[120:123], v159 offset:13568
    v_add_f32 v73, v73, v193
    v_add_f32 v74, v74, v194
    v_mfma_f32_16x16x32_bf16 v[40:43], a[248:251], v[92:95], v[40:43]
    ds_read_b128 v[124:127], v159 offset:19712
    v_add_f32 v75, v75, v195
    v_and_b32 v197, 0xffff0000, v182
    v_mfma_f32_16x16x32_bf16 v[40:43], a[240:243], v[88:91], v[40:43]
    buffer_load_dwordx4 v6, s[52:55], s14 offen offset:2048 lds
    v_lshlrev_b32 v196, 16, v182
    v_and_b32 v199, 0xffff0000, v183
    v_mfma_f32_16x16x32_bf16 v[48:51], a[240:243], v[96:99], v[48:51]
    v_lshlrev_b32 v198, 16, v183
    v_add_f32 v76, v76, v196
    v_mfma_f32_16x16x32_bf16 v[48:51], a[248:251], v[100:103], v[48:51]
    buffer_load_dwordx4 v7, s[52:55], s14 offen offset:3072 lds
    v_add_f32 v77, v77, v197
    v_mfma_f32_16x16x32_bf16 v[52:55], a[252:255], v[100:103], v[52:55]
    v_add_f32 v78, v78, v198
    v_add_f32 v79, v79, v199
    v_mfma_f32_16x16x32_bf16 v[52:55], a[244:247], v[96:99], v[52:55]
    s_waitcnt lgkmcnt(0)
    v_mfma_f32_16x16x32_bf16 v[60:63], a[244:247], v[104:107], v[60:63]
    s_barrier
    v_mfma_f32_16x16x32_bf16 v[60:63], a[252:255], v[108:111], v[60:63]
    s_add_u32 m0, s73, 131072
    s_lshl_b32 s14, s92, 18
    v_mfma_f32_16x16x32_bf16 v[56:59], a[248:251], v[108:111], v[56:59]
    buffer_load_dwordx4 v4, s[52:55], s14 offen offset:0 lds
    v_and_b32 v193, 0xffff0000, v168
    v_lshlrev_b32 v192, 16, v168
    v_mfma_f32_16x16x32_bf16 v[56:59], a[240:243], v[104:107], v[56:59]
    buffer_load_dwordx4 v5, s[52:55], s14 offen offset:1024 lds
    v_and_b32 v195, 0xffff0000, v169
    v_lshlrev_b32 v194, 16, v169
    v_mfma_f32_16x16x32_bf16 v[64:67], a[240:243], v[112:115], v[64:67]
    buffer_load_dwordx4 v6, s[52:55], s14 offen offset:2048 lds
    v_add_f32 v48, v48, v192
    v_mfma_f32_16x16x32_bf16 v[64:67], a[248:251], v[116:119], v[64:67]
    buffer_load_dwordx4 v7, s[52:55], s14 offen offset:3072 lds
    v_add_f32 v49, v49, v193
    v_add_f32 v50, v50, v194
    v_mfma_f32_16x16x32_bf16 v[68:71], a[252:255], v[116:119], v[68:71]
    s_add_u32 m0, s73, 147456
    s_lshl_b32 s14, s93, 18
    v_add_f32 v51, v51, v195
    v_and_b32 v197, 0xffff0000, v170
    v_mfma_f32_16x16x32_bf16 v[68:71], a[244:247], v[112:115], v[68:71]
    buffer_load_dwordx4 v4, s[52:55], s14 offen offset:0 lds
    v_lshlrev_b32 v196, 16, v170
    v_and_b32 v199, 0xffff0000, v171
    v_mfma_f32_16x16x32_bf16 v[76:79], a[244:247], v[120:123], v[76:79]
    buffer_load_dwordx4 v5, s[52:55], s14 offen offset:1024 lds
    v_lshlrev_b32 v198, 16, v171
    v_mfma_f32_16x16x32_bf16 v[76:79], a[252:255], v[124:127], v[76:79]
    buffer_load_dwordx4 v6, s[52:55], s14 offen offset:2048 lds
    v_add_f32 v52, v52, v196
    v_add_f32 v53, v53, v197
    v_mfma_f32_16x16x32_bf16 v[72:75], a[248:251], v[124:127], v[72:75]
    buffer_load_dwordx4 v7, s[52:55], s14 offen offset:3072 lds
    v_add_f32 v54, v54, v198
    v_add_f32 v55, v55, v199
    v_mfma_f32_16x16x32_bf16 v[72:75], a[240:243], v[120:123], v[72:75]
    s_waitcnt lgkmcnt(0)
    v_mov_b32 v88, 0xc0135761
    s_mov_b32 s10, 0xbdd2d3e8
    s_lshl_b32 s9, s69, 2
    s_add_u32 s9, s9, s3
    s_mul_i32 s9, s9, 69632
    s_add_u32 s9, s9, 12795904
    v_pk_mul_f32 v[160:161], v[32:33], v[32:33]
    v_pk_mul_f32 v[162:163], v[34:35], v[34:35]
    v_pk_mul_f32 v[164:165], v[36:37], v[36:37]
    v_pk_mul_f32 v[166:167], v[38:39], v[38:39]
    v_pk_mul_f32 v[168:169], v[40:41], v[40:41]
    v_pk_mul_f32 v[170:171], v[42:43], v[42:43]
    v_pk_mul_f32 v[172:173], v[44:45], v[44:45]
    v_pk_mul_f32 v[174:175], v[46:47], v[46:47]
    v_pk_fma_f32 v[160:161], v[160:161], s[10:11], v[88:89] op_sel_hi:[1,0,0]
L_pl_G_5:
    s_cbranch_execz L_wret
    v_pk_fma_f32 v[162:163], v[162:163], s[10:11], v[88:89] op_sel_hi:[1,0,0]
    v_pk_fma_f32 v[164:165], v[164:165], s[10:11], v[88:89] op_sel_hi:[1,0,0]
    v_pk_fma_f32 v[166:167], v[166:167], s[10:11], v[88:89] op_sel_hi:[1,0,0]
    v_pk_fma_f32 v[168:169], v[168:169], s[10:11], v[88:89] op_sel_hi:[1,0,0]
    v_pk_fma_f32 v[170:171], v[170:171], s[10:11], v[88:89] op_sel_hi:[1,0,0]
    v_pk_fma_f32 v[172:173], v[172:173], s[10:11], v[88:89] op_sel_hi:[1,0,0]
    v_pk_fma_f32 v[174:175], v[174:175], s[10:11], v[88:89] op_sel_hi:[1,0,0]
    v_pk_mul_f32 v[160:161], v[160:161], v[32:33]
    v_pk_mul_f32 v[162:163], v[162:163], v[34:35]
    v_pk_mul_f32 v[164:165], v[164:165], v[36:37]
    v_pk_mul_f32 v[166:167], v[166:167], v[38:39]
    v_pk_mul_f32 v[168:169], v[168:169], v[40:41]
    v_pk_mul_f32 v[170:171], v[170:171], v[42:43]
    v_pk_mul_f32 v[172:173], v[172:173], v[44:45]
    v_pk_mul_f32 v[174:175], v[174:175], v[46:47]
    v_exp_f32 v160, v160
    v_exp_f32 v161, v161
    v_exp_f32 v162, v162
    v_exp_f32 v163, v163
    v_exp_f32 v164, v164
    v_exp_f32 v165, v165
    v_exp_f32 v166, v166
    v_exp_f32 v167, v167
    v_exp_f32 v168, v168
    v_exp_f32 v169, v169
    v_exp_f32 v170, v170
    v_exp_f32 v171, v171
    v_exp_f32 v172, v172
    v_exp_f32 v173, v173
    v_exp_f32 v174, v174
    v_exp_f32 v175, v175
    v_pk_add_f32 v[160:161], v[160:161], 1.0 op_sel_hi:[1,0]
    v_pk_add_f32 v[162:163], v[162:163], 1.0 op_sel_hi:[1,0]
    v_pk_add_f32 v[164:165], v[164:165], 1.0 op_sel_hi:[1,0]
    v_pk_add_f32 v[166:167], v[166:167], 1.0 op_sel_hi:[1,0]
    v_pk_add_f32 v[168:169], v[168:169], 1.0 op_sel_hi:[1,0]
    v_pk_add_f32 v[170:171], v[170:171], 1.0 op_sel_hi:[1,0]
    v_pk_add_f32 v[172:173], v[172:173], 1.0 op_sel_hi:[1,0]
    v_pk_add_f32 v[174:175], v[174:175], 1.0 op_sel_hi:[1,0]
    v_rcp_f32 v160, v160
    v_rcp_f32 v161, v161
    v_rcp_f32 v162, v162
    v_rcp_f32 v163, v163
    v_rcp_f32 v164, v164
    v_rcp_f32 v165, v165
    v_rcp_f32 v166, v166
    v_rcp_f32 v167, v167
    v_rcp_f32 v168, v168
    v_rcp_f32 v169, v169
    v_rcp_f32 v170, v170
    v_rcp_f32 v171, v171
    v_rcp_f32 v172, v172
    v_rcp_f32 v173, v173
    v_rcp_f32 v174, v174
    v_rcp_f32 v175, v175
    v_pk_mul_f32 v[32:33], v[32:33], v[160:161]
    v_pk_mul_f32 v[34:35], v[34:35], v[162:163]
    v_pk_mul_f32 v[36:37], v[36:37], v[164:165]
    v_pk_mul_f32 v[38:39], v[38:39], v[166:167]
    v_pk_mul_f32 v[40:41], v[40:41], v[168:169]
    v_pk_mul_f32 v[42:43], v[42:43], v[170:171]
    v_pk_mul_f32 v[44:45], v[44:45], v[172:173]
    v_pk_mul_f32 v[46:47], v[46:47], v[174:175]
    v_cvt_pk_bf16_f32 v96, v32, v33
    v_cvt_pk_bf16_f32 v97, v34, v35
    v_cvt_pk_bf16_f32 v98, v36, v37
    v_cvt_pk_bf16_f32 v99, v38, v39
    v_cvt_pk_bf16_f32 v100, v40, v41
    v_cvt_pk_bf16_f32 v101, v42, v43
    v_cvt_pk_bf16_f32 v102, v44, v45
    v_cvt_pk_bf16_f32 v103, v46, v47
    buffer_store_dwordx4 v[96:99], v240, s[44:47], s9 offen sc1
    buffer_store_dwordx4 v[100:103], v241, s[44:47], s9 offen sc1
    v_pk_mul_f32 v[160:161], v[48:49], v[48:49]
    v_pk_mul_f32 v[162:163], v[50:51], v[50:51]
    v_pk_mul_f32 v[164:165], v[52:53], v[52:53]
    v_pk_mul_f32 v[166:167], v[54:55], v[54:55]
    v_pk_mul_f32 v[168:169], v[56:57], v[56:57]
    v_pk_mul_f32 v[170:171], v[58:59], v[58:59]
    v_pk_mul_f32 v[172:173], v[60:61], v[60:61]
    v_pk_mul_f32 v[174:175], v[62:63], v[62:63]
    v_pk_fma_f32 v[160:161], v[160:161], s[10:11], v[88:89] op_sel_hi:[1,0,0]
    v_pk_fma_f32 v[162:163], v[162:163], s[10:11], v[88:89] op_sel_hi:[1,0,0]
    v_pk_fma_f32 v[164:165], v[164:165], s[10:11], v[88:89] op_sel_hi:[1,0,0]
    v_pk_fma_f32 v[166:167], v[166:167], s[10:11], v[88:89] op_sel_hi:[1,0,0]
    v_pk_fma_f32 v[168:169], v[168:169], s[10:11], v[88:89] op_sel_hi:[1,0,0]
    v_pk_fma_f32 v[170:171], v[170:171], s[10:11], v[88:89] op_sel_hi:[1,0,0]
    v_pk_fma_f32 v[172:173], v[172:173], s[10:11], v[88:89] op_sel_hi:[1,0,0]
    v_pk_fma_f32 v[174:175], v[174:175], s[10:11], v[88:89] op_sel_hi:[1,0,0]
    v_pk_mul_f32 v[160:161], v[160:161], v[48:49]
    v_pk_mul_f32 v[162:163], v[162:163], v[50:51]
    v_pk_mul_f32 v[164:165], v[164:165], v[52:53]
    v_pk_mul_f32 v[166:167], v[166:167], v[54:55]
    v_pk_mul_f32 v[168:169], v[168:169], v[56:57]
    v_pk_mul_f32 v[170:171], v[170:171], v[58:59]
    v_pk_mul_f32 v[172:173], v[172:173], v[60:61]
    v_pk_mul_f32 v[174:175], v[174:175], v[62:63]
    v_exp_f32 v160, v160
    v_exp_f32 v161, v161
    v_exp_f32 v162, v162
    v_exp_f32 v163, v163
    v_exp_f32 v164, v164
    v_exp_f32 v165, v165
    v_exp_f32 v166, v166
    v_exp_f32 v167, v167
    v_exp_f32 v168, v168
    v_exp_f32 v169, v169
    v_exp_f32 v170, v170
    v_exp_f32 v171, v171
    v_exp_f32 v172, v172
    v_exp_f32 v173, v173
    v_exp_f32 v174, v174
    v_exp_f32 v175, v175
    v_pk_add_f32 v[160:161], v[160:161], 1.0 op_sel_hi:[1,0]
    v_pk_add_f32 v[162:163], v[162:163], 1.0 op_sel_hi:[1,0]
    v_pk_add_f32 v[164:165], v[164:165], 1.0 op_sel_hi:[1,0]
    v_pk_add_f32 v[166:167], v[166:167], 1.0 op_sel_hi:[1,0]
    v_pk_add_f32 v[168:169], v[168:169], 1.0 op_sel_hi:[1,0]
    v_pk_add_f32 v[170:171], v[170:171], 1.0 op_sel_hi:[1,0]
    v_pk_add_f32 v[172:173], v[172:173], 1.0 op_sel_hi:[1,0]
    v_pk_add_f32 v[174:175], v[174:175], 1.0 op_sel_hi:[1,0]
    v_rcp_f32 v160, v160
    v_rcp_f32 v161, v161
    v_rcp_f32 v162, v162
    v_rcp_f32 v163, v163
    v_rcp_f32 v164, v164
    v_rcp_f32 v165, v165
    v_rcp_f32 v166, v166
    v_rcp_f32 v167, v167
    v_rcp_f32 v168, v168
    v_rcp_f32 v169, v169
    v_rcp_f32 v170, v170
    v_rcp_f32 v171, v171
    v_rcp_f32 v172, v172
    v_rcp_f32 v173, v173
    v_rcp_f32 v174, v174
    v_rcp_f32 v175, v175
    v_pk_mul_f32 v[48:49], v[48:49], v[160:161]
    v_pk_mul_f32 v[50:51], v[50:51], v[162:163]
    v_pk_mul_f32 v[52:53], v[52:53], v[164:165]
    v_pk_mul_f32 v[54:55], v[54:55], v[166:167]
    v_pk_mul_f32 v[56:57], v[56:57], v[168:169]
    v_pk_mul_f32 v[58:59], v[58:59], v[170:171]
    v_pk_mul_f32 v[60:61], v[60:61], v[172:173]
    v_pk_mul_f32 v[62:63], v[62:63], v[174:175]
    v_cvt_pk_bf16_f32 v104, v48, v49
    v_cvt_pk_bf16_f32 v105, v50, v51
    v_cvt_pk_bf16_f32 v106, v52, v53
    v_cvt_pk_bf16_f32 v107, v54, v55
    v_cvt_pk_bf16_f32 v108, v56, v57
    v_cvt_pk_bf16_f32 v109, v58, v59
    v_cvt_pk_bf16_f32 v110, v60, v61
    v_cvt_pk_bf16_f32 v111, v62, v63
    buffer_store_dwordx4 v[104:107], v242, s[44:47], s9 offen sc1
    buffer_store_dwordx4 v[108:111], v243, s[44:47], s9 offen sc1
    v_pk_mul_f32 v[160:161], v[64:65], v[64:65]
    v_pk_mul_f32 v[162:163], v[66:67], v[66:67]
    v_pk_mul_f32 v[164:165], v[68:69], v[68:69]
    v_pk_mul_f32 v[166:167], v[70:71], v[70:71]
    v_pk_mul_f32 v[168:169], v[72:73], v[72:73]
    v_pk_mul_f32 v[170:171], v[74:75], v[74:75]
    v_pk_mul_f32 v[172:173], v[76:77], v[76:77]
    v_pk_mul_f32 v[174:175], v[78:79], v[78:79]
    v_pk_fma_f32 v[160:161], v[160:161], s[10:11], v[88:89] op_sel_hi:[1,0,0]
    v_pk_fma_f32 v[162:163], v[162:163], s[10:11], v[88:89] op_sel_hi:[1,0,0]
    v_pk_fma_f32 v[164:165], v[164:165], s[10:11], v[88:89] op_sel_hi:[1,0,0]
    v_pk_fma_f32 v[166:167], v[166:167], s[10:11], v[88:89] op_sel_hi:[1,0,0]
    v_pk_fma_f32 v[168:169], v[168:169], s[10:11], v[88:89] op_sel_hi:[1,0,0]
    v_pk_fma_f32 v[170:171], v[170:171], s[10:11], v[88:89] op_sel_hi:[1,0,0]
    v_pk_fma_f32 v[172:173], v[172:173], s[10:11], v[88:89] op_sel_hi:[1,0,0]
    v_pk_fma_f32 v[174:175], v[174:175], s[10:11], v[88:89] op_sel_hi:[1,0,0]
    v_pk_mul_f32 v[160:161], v[160:161], v[64:65]
    v_pk_mul_f32 v[162:163], v[162:163], v[66:67]
    v_pk_mul_f32 v[164:165], v[164:165], v[68:69]
    v_pk_mul_f32 v[166:167], v[166:167], v[70:71]
    v_pk_mul_f32 v[168:169], v[168:169], v[72:73]
    v_pk_mul_f32 v[170:171], v[170:171], v[74:75]
    v_pk_mul_f32 v[172:173], v[172:173], v[76:77]
    v_pk_mul_f32 v[174:175], v[174:175], v[78:79]
    v_exp_f32 v160, v160
    v_exp_f32 v161, v161
    v_exp_f32 v162, v162
    v_exp_f32 v163, v163
    v_exp_f32 v164, v164
    v_exp_f32 v165, v165
    v_exp_f32 v166, v166
    v_exp_f32 v167, v167
    v_exp_f32 v168, v168
    v_exp_f32 v169, v169
    v_exp_f32 v170, v170
    v_exp_f32 v171, v171
    v_exp_f32 v172, v172
    v_exp_f32 v173, v173
    v_exp_f32 v174, v174
    v_exp_f32 v175, v175
    v_pk_add_f32 v[160:161], v[160:161], 1.0 op_sel_hi:[1,0]
    v_pk_add_f32 v[162:163], v[162:163], 1.0 op_sel_hi:[1,0]
    v_pk_add_f32 v[164:165], v[164:165], 1.0 op_sel_hi:[1,0]
    v_pk_add_f32 v[166:167], v[166:167], 1.0 op_sel_hi:[1,0]
    v_pk_add_f32 v[168:169], v[168:169], 1.0 op_sel_hi:[1,0]
    v_pk_add_f32 v[170:171], v[170:171], 1.0 op_sel_hi:[1,0]
    v_pk_add_f32 v[172:173], v[172:173], 1.0 op_sel_hi:[1,0]
    v_pk_add_f32 v[174:175], v[174:175], 1.0 op_sel_hi:[1,0]
    v_rcp_f32 v160, v160
    v_rcp_f32 v161, v161
    v_rcp_f32 v162, v162
    v_rcp_f32 v163, v163
    v_rcp_f32 v164, v164
    v_rcp_f32 v165, v165
    v_rcp_f32 v166, v166
    v_rcp_f32 v167, v167
    v_rcp_f32 v168, v168
    v_rcp_f32 v169, v169
    v_rcp_f32 v170, v170
    v_rcp_f32 v171, v171
    v_rcp_f32 v172, v172
    v_rcp_f32 v173, v173
    v_rcp_f32 v174, v174
    v_rcp_f32 v175, v175
    v_pk_mul_f32 v[64:65], v[64:65], v[160:161]
    v_pk_mul_f32 v[66:67], v[66:67], v[162:163]
    v_pk_mul_f32 v[68:69], v[68:69], v[164:165]
    v_pk_mul_f32 v[70:71], v[70:71], v[166:167]
    v_pk_mul_f32 v[72:73], v[72:73], v[168:169]
    v_pk_mul_f32 v[74:75], v[74:75], v[170:171]
    v_pk_mul_f32 v[76:77], v[76:77], v[172:173]
    v_pk_mul_f32 v[78:79], v[78:79], v[174:175]
    v_cvt_pk_bf16_f32 v112, v64, v65
    v_cvt_pk_bf16_f32 v113, v66, v67
    v_cvt_pk_bf16_f32 v114, v68, v69
    v_cvt_pk_bf16_f32 v115, v70, v71
    v_cvt_pk_bf16_f32 v116, v72, v73
    v_cvt_pk_bf16_f32 v117, v74, v75
    v_cvt_pk_bf16_f32 v118, v76, v77
    v_cvt_pk_bf16_f32 v119, v78, v79
    buffer_store_dwordx4 v[112:115], v244, s[44:47], s9 offen sc1
    buffer_store_dwordx4 v[116:119], v245, s[44:47], s9 offen sc1
    s_waitcnt vmcnt(6)
    s_barrier
    ds_read_b64_tr_b16 a[64:65], v10 offset:49152
    s_add_u32 m0, s73, 32768
    s_lshl_b32 s14, s94, 18
    ds_read_b64_tr_b16 a[66:67], v10 offset:51200
    ds_read_b64_tr_b16 a[72:73], v10 offset:53248
    ds_read_b64_tr_b16 a[74:75], v10 offset:55296
    ds_read_b64_tr_b16 a[68:69], v11 offset:49152
    buffer_load_dwordx4 v4, s[52:55], s14 offen offset:0 lds
    ds_read_b64_tr_b16 a[70:71], v11 offset:51200
    ds_read_b64_tr_b16 a[76:77], v11 offset:53248
    ds_read_b64_tr_b16 a[78:79], v11 offset:55296
    v_add_u32 v10, 65536, v10
    ds_read_b64_tr_b16 a[80:81], v10 offset:0
    ds_read_b64_tr_b16 a[82:83], v10 offset:2048
    buffer_load_dwordx4 v5, s[52:55], s14 offen offset:1024 lds
    ds_read_b64_tr_b16 a[88:89], v10 offset:4096
    ds_read_b64_tr_b16 a[90:91], v10 offset:6144
    v_add_u32 v11, 65536, v11
    ds_read_b64_tr_b16 a[84:85], v11 offset:0
    ds_read_b64_tr_b16 a[86:87], v11 offset:2048
    ds_read_b64_tr_b16 a[92:93], v11 offset:4096
    buffer_load_dwordx4 v6, s[52:55], s14 offen offset:2048 lds
    ds_read_b64_tr_b16 a[94:95], v11 offset:6144
    v_add_u32 v10, -65536, v10
    ds_read_b64_tr_b16 a[96:97], v10 offset:0
    ds_read_b64_tr_b16 a[98:99], v10 offset:2048
    ds_read_b64_tr_b16 a[104:105], v10 offset:4096
    ds_read_b64_tr_b16 a[106:107], v10 offset:6144
    buffer_load_dwordx4 v7, s[52:55], s14 offen offset:3072 lds
    v_add_u32 v11, -65536, v11
    ds_read_b64_tr_b16 a[100:101], v11 offset:0
    ds_read_b64_tr_b16 a[102:103], v11 offset:2048
    ds_read_b64_tr_b16 a[108:109], v11 offset:4096
    ds_read_b64_tr_b16 a[110:111], v11 offset:6144
    ds_read_b64_tr_b16 a[112:113], v10 offset:16384
    s_add_u32 m0, s73, 81920
    s_lshl_b32 s14, s95, 18
    ds_read_b64_tr_b16 a[114:115], v10 offset:18432
    ds_read_b64_tr_b16 a[120:121], v10 offset:20480
    ds_read_b64_tr_b16 a[122:123], v10 offset:22528
    ds_read_b64_tr_b16 a[116:117], v11 offset:16384
    buffer_load_dwordx4 v4, s[52:55], s14 offen offset:0 lds
    ds_read_b64_tr_b16 a[118:119], v11 offset:18432
    ds_read_b64_tr_b16 a[124:125], v11 offset:20480
    ds_read_b64_tr_b16 a[126:127], v11 offset:22528
    v_add_u32 v10, 131072, v10
    ds_read_b64_tr_b16 a[128:129], v10 offset:0
    ds_read_b64_tr_b16 a[130:131], v10 offset:2048
    buffer_load_dwordx4 v5, s[52:55], s14 offen offset:1024 lds
    ds_read_b64_tr_b16 a[136:137], v10 offset:4096
    ds_read_b64_tr_b16 a[138:139], v10 offset:6144
    v_add_u32 v11, 131072, v11
    ds_read_b64_tr_b16 a[132:133], v11 offset:0
    ds_read_b64_tr_b16 a[134:135], v11 offset:2048
    ds_read_b64_tr_b16 a[140:141], v11 offset:4096
    buffer_load_dwordx4 v6, s[52:55], s14 offen offset:2048 lds
    ds_read_b64_tr_b16 a[142:143], v11 offset:6144
    ds_read_b64_tr_b16 a[144:145], v10 offset:16384
    ds_read_b64_tr_b16 a[146:147], v10 offset:18432
    ds_read_b64_tr_b16 a[152:153], v10 offset:20480
    ds_read_b64_tr_b16 a[154:155], v10 offset:22528
    buffer_load_dwordx4 v7, s[52:55], s14 offen offset:3072 lds
    ds_read_b64_tr_b16 a[148:149], v11 offset:16384
    ds_read_b64_tr_b16 a[150:151], v11 offset:18432
    ds_read_b64_tr_b16 a[156:157], v11 offset:20480
    ds_read_b64_tr_b16 a[158:159], v11 offset:22528
    s_bitcmp1_b32 s3, 1
    s_cselect_b32 s18, s85, s84
    s_mul_i32 s18, s18, 139264
    s_cselect_b32 s19, s87, s86
    s_mul_i32 s19, s19, 139264
    s_cselect_b32 s20, s89, s88
    s_mul_i32 s20, s20, 139264
    s_cselect_b32 s21, s91, s90
    s_mul_i32 s21, s21, 139264
    s_cselect_b32 s22, s93, s92
    s_mul_i32 s22, s22, 139264
    s_cselect_b32 s23, s95, s94
    s_mul_i32 s23, s23, 139264
    s_cselect_b32 s24, s97, s96
    s_mul_i32 s24, s24, 139264
    s_cselect_b32 s25, s99, s98
    s_mul_i32 s25, s25, 139264
    s_cselect_b32 s26, s101, s100
    s_mul_i32 s26, s26, 139264
    s_waitcnt vmcnt(8) lgkmcnt(0)
    s_barrier
    buffer_store_dword v249, v17, s[44:47], 0 offen sc1
    s_add_u32 m0, s73, 0
    s_lshl_b32 s14, s96, 18
    buffer_load_dwordx4 v4, s[52:55], s14 offen offset:0 lds
    buffer_load_dwordx4 v5, s[52:55], s14 offen offset:1024 lds
    buffer_load_dwordx4 v6, s[52:55], s14 offen offset:2048 lds
    buffer_load_dwordx4 v7, s[52:55], s14 offen offset:3072 lds
    s_add_u32 m0, s73, 16384
    s_lshl_b32 s14, s97, 18
    buffer_load_dwordx4 v4, s[52:55], s14 offen offset:0 lds
    buffer_load_dwordx4 v5, s[52:55], s14 offen offset:1024 lds
    buffer_load_dwordx4 v6, s[52:55], s14 offen offset:2048 lds
    buffer_load_dwordx4 v7, s[52:55], s14 offen offset:3072 lds
    v_mov_b32 v16, 0
    buffer_atomic_add v16, v15, s[44:47], 0 offen sc0 sc1
    s_add_u32 m0, s73, 49152
    s_lshl_b32 s14, s98, 18
    buffer_load_dwordx4 v4, s[52:55], s14 offen offset:0 lds
    buffer_load_dwordx4 v5, s[52:55], s14 offen offset:1024 lds
    buffer_load_dwordx4 v6, s[52:55], s14 offen offset:2048 lds
    buffer_load_dwordx4 v7, s[52:55], s14 offen offset:3072 lds
    s_add_u32 m0, s73, 65536
    s_lshl_b32 s14, s99, 18
    buffer_load_dwordx4 v4, s[52:55], s14 offen offset:0 lds
    buffer_load_dwordx4 v5, s[52:55], s14 offen offset:1024 lds
    buffer_load_dwordx4 v6, s[52:55], s14 offen offset:2048 lds
    buffer_load_dwordx4 v7, s[52:55], s14 offen offset:3072 lds
L_DG:
    s_waitcnt vmcnt(8)
    v_cmp_ne_u32 vcc, v13, v16
    s_cbranch_vccnz L_rs_p2G
L_ok_p2G:
    s_barrier
    s_add_u32 m0, s73, 97536
    s_nop 0
    buffer_load_dwordx4 v23, s[44:47], s18 offen offset:768 sc1 lds
    s_add_u32 m0, s73, 99328
    s_nop 0
    buffer_load_dwordx4 v20, s[44:47], s18 offen offset:0 sc1 lds
    s_add_u32 m0, s73, 99840
    s_nop 0
    buffer_load_dwordx4 v20, s[44:47], s18 offen offset:512 sc1 lds
    s_add_u32 m0, s73, 100608
    s_nop 0
    buffer_load_dwordx4 v23, s[44:47], s19 offen offset:768 sc1 lds
    s_add_u32 m0, s73, 114688
    s_nop 0
    buffer_load_dwordx4 v20, s[44:47], s19 offen offset:0 sc1 lds
    s_add_u32 m0, s73, 115200
    s_nop 0
    buffer_load_dwordx4 v20, s[44:47], s19 offen offset:512 sc1 lds
    s_add_u32 m0, s73, 115968
    s_nop 0
    buffer_load_dwordx4 v23, s[44:47], s20 offen offset:768 sc1 lds
    s_add_u32 m0, s73, 117760
    s_nop 0
    buffer_load_dwordx4 v20, s[44:47], s20 offen offset:0 sc1 lds
    v_mov_b32 v195, s68
    v_mov_b32 v199, s68
    v_mov_b32 v202, s68
    v_mov_b32 v203, s68
    s_waitcnt vmcnt(4)
    s_barrier
    ds_read_b128 v[104:107], v14 offset:0
    ds_read_b128 v[108:111], v14 offset:4096
    ds_read_b128 v[112:115], v14 offset:8192
    ds_read_b128 v[116:119], v14 offset:12288
    s_waitcnt lgkmcnt(2)
    v_mfma_f32_16x16x32_bf16 v[32:35], v[104:107], a[0:3], 0
    s_add_u32 m0, s73, 130560
    v_mfma_f32_16x16x32_bf16 v[32:35], v[108:111], a[8:11], v[32:35]
    buffer_load_dwordx4 v20, s[44:47], s20 offen offset:512 sc1 lds
    s_waitcnt lgkmcnt(0)
    v_mfma_f32_16x16x32_bf16 v[32:35], v[112:115], a[16:19], v[32:35]
    ds_read_b128 v[120:123], v14 offset:1024
    v_mfma_f32_16x16x32_bf16 v[32:35], v[116:119], a[24:27], v[32:35]
    ds_read_b128 v[124:127], v14 offset:5120
    v_mfma_f32_16x16x32_bf16 v[36:39], v[116:119], a[28:31], 0
    ds_read_b128 v[128:131], v14 offset:9216
    v_mfma_f32_16x16x32_bf16 v[36:39], v[112:115], a[20:23], v[36:39]
    ds_read_b128 v[132:135], v14 offset:13312
    v_mfma_f32_16x16x32_bf16 v[36:39], v[108:111], a[12:15], v[36:39]
    s_add_u32 m0, s73, 131328
    v_mfma_f32_16x16x32_bf16 v[36:39], v[104:107], a[4:7], v[36:39]
    buffer_load_dwordx4 v23, s[44:47], s21 offen offset:768 sc1 lds
    s_waitcnt lgkmcnt(2)
    v_mfma_f32_16x16x32_bf16 v[44:47], v[120:123], a[4:7], 0
    s_add_u32 m0, s73, 133120
    v_mfma_f32_16x16x32_bf16 v[44:47], v[124:127], a[12:15], v[44:47]
    buffer_load_dwordx4 v20, s[44:47], s21 offen offset:0 sc1 lds
    s_waitcnt lgkmcnt(0)
    v_mfma_f32_16x16x32_bf16 v[44:47], v[128:131], a[20:23], v[44:47]
    ds_read_b128 v[104:107], v14 offset:2048
    v_mfma_f32_16x16x32_bf16 v[44:47], v[132:135], a[28:31], v[44:47]
    ds_read_b128 v[108:111], v14 offset:6144
    v_mfma_f32_16x16x32_bf16 v[40:43], v[132:135], a[24:27], 0
    ds_read_b128 v[112:115], v14 offset:10240
    v_mfma_f32_16x16x32_bf16 v[40:43], v[128:131], a[16:19], v[40:43]
    ds_read_b128 v[116:119], v14 offset:14336
    v_mfma_f32_16x16x32_bf16 v[40:43], v[124:127], a[8:11], v[40:43]
    s_add_u32 m0, s73, 133632
    v_mfma_f32_16x16x32_bf16 v[40:43], v[120:123], a[0:3], v[40:43]
    buffer_load_dwordx4 v20, s[44:47], s21 offen offset:512 sc1 lds
    s_waitcnt lgkmcnt(2)
    v_mfma_f32_16x16x32_bf16 v[48:51], v[104:107], a[0:3], 0
    s_add_u32 m0, s73, 146688
    v_mfma_f32_16x16x32_bf16 v[48:51], v[108:111], a[8:11], v[48:51]
    buffer_load_dwordx4 v23, s[44:47], s22 offen offset:768 sc1 lds
    s_waitcnt lgkmcnt(0)
    v_mfma_f32_16x16x32_bf16 v[48:51], v[112:115], a[16:19], v[48:51]
    ds_read_b128 v[120:123], v14 offset:3072
    v_mfma_f32_16x16x32_bf16 v[48:51], v[116:119], a[24:27], v[48:51]
    ds_read_b128 v[124:127], v14 offset:7168
    v_mfma_f32_16x16x32_bf16 v[52:55], v[116:119], a[28:31], 0
    ds_read_b128 v[128:131], v14 offset:11264
    v_mfma_f32_16x16x32_bf16 v[52:55], v[112:115], a[20:23], v[52:55]
    ds_read_b128 v[132:135], v14 offset:15360
    v_mfma_f32_16x16x32_bf16 v[52:55], v[108:111], a[12:15], v[52:55]
    s_add_u32 m0, s73, 148480
    v_mfma_f32_16x16x32_bf16 v[52:55], v[104:107], a[4:7], v[52:55]
    buffer_load_dwordx4 v20, s[44:47], s22 offen offset:0 sc1 lds
    s_waitcnt lgkmcnt(2)
    v_mfma_f32_16x16x32_bf16 v[36:39], v[120:123], a[36:39], v[36:39]
    s_add_u32 m0, s73, 148992
    v_mfma_f32_16x16x32_bf16 v[36:39], v[124:127], a[44:47], v[36:39]
    buffer_load_dwordx4 v20, s[44:47], s22 offen offset:512 sc1 lds
    s_waitcnt lgkmcnt(0)
    v_mfma_f32_16x16x32_bf16 v[36:39], v[128:131], a[52:55], v[36:39]
    s_waitcnt vmcnt(7)
    s_barrier
    v_mfma_f32_16x16x32_bf16 v[36:39], v[132:135], a[60:63], v[36:39]
    ds_read_b128 v[104:107], v14 offset:16384
    v_add_u32 v10, -131072, v10
    v_mfma_f32_16x16x32_bf16 v[32:35], v[132:135], a[56:59], v[32:35]
    ds_read_b128 v[108:111], v14 offset:20480
    v_mfma_f32_16x16x32_bf16 v[32:35], v[128:131], a[48:51], v[32:35]
    ds_read_b128 v[112:115], v14 offset:24576
    ds_read_b64_tr_b16 a[160:161], v10 offset:32768
    v_mfma_f32_16x16x32_bf16 v[32:35], v[124:127], a[40:43], v[32:35]
    ds_read_b128 v[116:119], v14 offset:28672
    s_add_u32 m0, s73, 149760
    v_mfma_f32_16x16x32_bf16 v[32:35], v[120:123], a[32:35], v[32:35]
    buffer_load_dwordx4 v23, s[44:47], s23 offen offset:768 sc1 lds
    ds_read_b64_tr_b16 a[162:163], v10 offset:34816
    s_waitcnt lgkmcnt(4)
    v_mfma_f32_16x16x32_bf16 v[40:43], v[104:107], a[32:35], v[40:43]
    s_add_u32 m0, s73, 98304
    ds_read_b64_tr_b16 a[168:169], v10 offset:36864
    v_mfma_f32_16x16x32_bf16 v[40:43], v[108:111], a[40:43], v[40:43]
    buffer_load_dwordx4 v20, s[44:47], s23 offen offset:0 sc1 lds
    ds_read_b64_tr_b16 a[170:171], v10 offset:38912
    s_waitcnt lgkmcnt(3)
    v_mfma_f32_16x16x32_bf16 v[40:43], v[112:115], a[48:51], v[40:43]
    ds_read_b128 v[120:123], v14 offset:17408
    v_mfma_f32_16x16x32_bf16 v[40:43], v[116:119], a[56:59], v[40:43]
    ds_read_b128 v[124:127], v14 offset:21504
    v_add_u32 v11, -131072, v11
    v_mfma_f32_16x16x32_bf16 v[44:47], v[116:119], a[60:63], v[44:47]
    ds_read_b128 v[128:131], v14 offset:25600
    v_mfma_f32_16x16x32_bf16 v[44:47], v[112:115], a[52:55], v[44:47]
    ds_read_b128 v[132:135], v14 offset:29696
    v_mfma_f32_16x16x32_bf16 v[44:47], v[108:111], a[44:47], v[44:47]
    s_add_u32 m0, s73, 98816
    ds_read_b64_tr_b16 a[164:165], v11 offset:32768
    v_mfma_f32_16x16x32_bf16 v[44:47], v[104:107], a[36:39], v[44:47]
    buffer_load_dwordx4 v20, s[44:47], s23 offen offset:512 sc1 lds
    ds_read_b64_tr_b16 a[166:167], v11 offset:34816
    s_waitcnt lgkmcnt(4)
    v_mfma_f32_16x16x32_bf16 v[52:55], v[120:123], a[36:39], v[52:55]
    s_add_u32 m0, s73, 99584
    ds_read_b64_tr_b16 a[172:173], v11 offset:36864
    v_mfma_f32_16x16x32_bf16 v[52:55], v[124:127], a[44:47], v[52:55]
    buffer_load_dwordx4 v23, s[44:47], s24 offen offset:768 sc1 lds
    ds_read_b64_tr_b16 a[174:175], v11 offset:38912
    s_waitcnt lgkmcnt(4)
    v_mfma_f32_16x16x32_bf16 v[52:55], v[128:131], a[52:55], v[52:55]
    ds_read_b128 v[104:107], v14 offset:18432
    v_mfma_f32_16x16x32_bf16 v[52:55], v[132:135], a[60:63], v[52:55]
    ds_read_b128 v[108:111], v14 offset:22528
    v_add_u32 v10, 65536, v10
    v_mfma_f32_16x16x32_bf16 v[48:51], v[132:135], a[56:59], v[48:51]
    ds_read_b128 v[112:115], v14 offset:26624
    v_mfma_f32_16x16x32_bf16 v[48:51], v[128:131], a[48:51], v[48:51]
    ds_read_b128 v[116:119], v14 offset:30720
    v_mfma_f32_16x16x32_bf16 v[48:51], v[124:127], a[40:43], v[48:51]
    s_add_u32 m0, s73, 101376
    ds_read_b64_tr_b16 a[176:177], v10 offset:16384
    v_mfma_f32_16x16x32_bf16 v[48:51], v[120:123], a[32:35], v[48:51]
    buffer_load_dwordx4 v20, s[44:47], s24 offen offset:0 sc1 lds
    ds_read_b64_tr_b16 a[178:179], v10 offset:18432
    s_waitcnt lgkmcnt(4)
    v_mfma_f32_16x16x32_bf16 v[32:35], v[104:107], a[64:67], v[32:35]
    ds_read_b64_tr_b16 a[184:185], v10 offset:20480
    v_mfma_f32_16x16x32_bf16 v[32:35], v[108:111], a[72:75], v[32:35]
    ds_read_b64_tr_b16 a[186:187], v10 offset:22528
    s_waitcnt lgkmcnt(4)
    v_mfma_f32_16x16x32_bf16 v[32:35], v[112:115], a[80:83], v[32:35]
    ds_read_b128 v[120:123], v14 offset:19456
    v_mfma_f32_16x16x32_bf16 v[32:35], v[116:119], a[88:91], v[32:35]
    ds_read_b128 v[124:127], v14 offset:23552
    v_add_u32 v11, 65536, v11
    v_mfma_f32_16x16x32_bf16 v[36:39], v[116:119], a[92:95], v[36:39]
    ds_read_b128 v[128:131], v14 offset:27648
    v_mfma_f32_16x16x32_bf16 v[36:39], v[112:115], a[84:87], v[36:39]
    ds_read_b128 v[132:135], v14 offset:31744
    v_mfma_f32_16x16x32_bf16 v[36:39], v[108:111], a[76:79], v[36:39]
    ds_read_b64_tr_b16 a[180:181], v11 offset:16384
    v_mfma_f32_16x16x32_bf16 v[36:39], v[104:107], a[68:71], v[36:39]
    ds_read_b64_tr_b16 a[182:183], v11 offset:18432
    s_waitcnt lgkmcnt(4)
    v_mfma_f32_16x16x32_bf16 v[44:47], v[120:123], a[68:71], v[44:47]
    ds_read_b64_tr_b16 a[188:189], v11 offset:20480
    v_mfma_f32_16x16x32_bf16 v[44:47], v[124:127], a[76:79], v[44:47]
    ds_read_b64_tr_b16 a[190:191], v11 offset:22528
    s_waitcnt lgkmcnt(4)
    v_mfma_f32_16x16x32_bf16 v[44:47], v[128:131], a[84:87], v[44:47]
    s_waitcnt vmcnt(8) lgkmcnt(0)
    s_barrier
    v_mfma_f32_16x16x32_bf16 v[44:47], v[132:135], a[92:95], v[44:47]
    ds_read_b128 v[104:107], v14 offset:32768
    s_lshl_b32 s14, s100, 18
    s_add_u32 m0, s73, 32768
    v_add_u32 v10, -65536, v10
    v_mfma_f32_16x16x32_bf16 v[40:43], v[132:135], a[88:91], v[40:43]
    ds_read_b128 v[108:111], v14 offset:36864
    buffer_load_dwordx4 v4, s[52:55], s14 offen offset:0 lds
    v_mfma_f32_16x16x32_bf16 v[40:43], v[128:131], a[80:83], v[40:43]
    ds_read_b128 v[112:115], v14 offset:40960
    ds_read_b64_tr_b16 a[192:193], v10 offset:0
    v_mfma_f32_16x16x32_bf16 v[40:43], v[124:127], a[72:75], v[40:43]
    ds_read_b128 v[116:119], v14 offset:45056
    v_mfma_f32_16x16x32_bf16 v[40:43], v[120:123], a[64:67], v[40:43]
    ds_read_b64_tr_b16 a[194:195], v10 offset:2048
    s_waitcnt lgkmcnt(4)
    v_mfma_f32_16x16x32_bf16 v[48:51], v[104:107], a[64:67], v[48:51]
    s_add_u32 m0, s73, 114176
    ds_read_b64_tr_b16 a[200:201], v10 offset:4096
    v_mfma_f32_16x16x32_bf16 v[48:51], v[108:111], a[72:75], v[48:51]
    buffer_load_dwordx4 v20, s[44:47], s24 offen offset:512 sc1 lds
    ds_read_b64_tr_b16 a[202:203], v10 offset:6144
    s_waitcnt lgkmcnt(3)
    v_mfma_f32_16x16x32_bf16 v[48:51], v[112:115], a[80:83], v[48:51]
    ds_read_b128 v[120:123], v14 offset:33792
    s_add_u32 m0, s73, 32768
    v_lshrrev_b32 v30, 2, v26
    v_mfma_f32_16x16x32_bf16 v[48:51], v[116:119], a[88:91], v[48:51]
    ds_read_b128 v[124:127], v14 offset:37888
    buffer_load_dwordx4 v5, s[52:55], s14 offen offset:1024 lds
    v_mfma_f32_16x16x32_bf16 v[52:55], v[116:119], a[92:95], v[52:55]
    ds_read_b128 v[128:131], v14 offset:41984
    v_add_u32 v11, -65536, v11
    v_mfma_f32_16x16x32_bf16 v[52:55], v[112:115], a[84:87], v[52:55]
    ds_read_b128 v[132:135], v14 offset:46080
    v_mfma_f32_16x16x32_bf16 v[52:55], v[108:111], a[76:79], v[52:55]
    s_add_u32 m0, s73, 114944
    ds_read_b64_tr_b16 a[196:197], v11 offset:0
    v_mfma_f32_16x16x32_bf16 v[52:55], v[104:107], a[68:71], v[52:55]
    buffer_load_dwordx4 v23, s[44:47], s25 offen offset:768 sc1 lds
    ds_read_b64_tr_b16 a[198:199], v11 offset:2048
    s_waitcnt lgkmcnt(4)
    v_mfma_f32_16x16x32_bf16 v[36:39], v[120:123], a[100:103], v[36:39]
    s_add_u32 m0, s73, 116736
    ds_read_b64_tr_b16 a[204:205], v11 offset:4096
    v_mfma_f32_16x16x32_bf16 v[36:39], v[124:127], a[108:111], v[36:39]
    buffer_load_dwordx4 v20, s[44:47], s25 offen offset:0 sc1 lds
    ds_read_b64_tr_b16 a[206:207], v11 offset:6144
    s_waitcnt lgkmcnt(4)
    v_mfma_f32_16x16x32_bf16 v[36:39], v[128:131], a[116:119], v[36:39]
    ds_read_b128 v[104:107], v14 offset:34816
L_pl_G_6:
    s_cbranch_execz L_wret
    s_add_u32 m0, s73, 32768
    v_lshrrev_b32 v31, 2, v18
    v_mfma_f32_16x16x32_bf16 v[36:39], v[132:135], a[124:127], v[36:39]
    ds_read_b128 v[108:111], v14 offset:38912
    buffer_load_dwordx4 v6, s[52:55], s14 offen offset:2048 lds
    v_mfma_f32_16x16x32_bf16 v[32:35], v[132:135], a[120:123], v[32:35]
    ds_read_b128 v[112:115], v14 offset:43008
    v_mfma_f32_16x16x32_bf16 v[32:35], v[128:131], a[112:115], v[32:35]
    ds_read_b128 v[116:119], v14 offset:47104
    v_mfma_f32_16x16x32_bf16 v[32:35], v[124:127], a[104:107], v[32:35]
    s_add_u32 m0, s73, 117248
    ds_read_b64_tr_b16 a[208:209], v10 offset:16384
    v_mfma_f32_16x16x32_bf16 v[32:35], v[120:123], a[96:99], v[32:35]
    buffer_load_dwordx4 v20, s[44:47], s25 offen offset:512 sc1 lds
    ds_read_b64_tr_b16 a[210:211], v10 offset:18432
    s_waitcnt lgkmcnt(4)
    v_mfma_f32_16x16x32_bf16 v[40:43], v[104:107], a[96:99], v[40:43]
    ds_read_b64_tr_b16 a[216:217], v10 offset:20480
    buffer_load_ushort v102, v30, s[60:63], 0 offen offset:0
    s_add_u32 m0, s73, 32768
    v_mfma_f32_16x16x32_bf16 v[40:43], v[108:111], a[104:107], v[40:43]
    ds_read_b64_tr_b16 a[218:219], v10 offset:22528
    buffer_load_dwordx4 v7, s[52:55], s14 offen offset:3072 lds
    s_waitcnt lgkmcnt(4)
    v_mfma_f32_16x16x32_bf16 v[40:43], v[112:115], a[112:115], v[40:43]
    ds_read_b128 v[120:123], v14 offset:35840
    v_mfma_f32_16x16x32_bf16 v[40:43], v[116:119], a[120:123], v[40:43]
    ds_read_b128 v[124:127], v14 offset:39936
    v_mfma_f32_16x16x32_bf16 v[44:47], v[116:119], a[124:127], v[44:47]
    ds_read_b128 v[128:131], v14 offset:44032
    v_mfma_f32_16x16x32_bf16 v[44:47], v[112:115], a[116:119], v[44:47]
    ds_read_b128 v[132:135], v14 offset:48128
    v_mfma_f32_16x16x32_bf16 v[44:47], v[108:111], a[108:111], v[44:47]
    ds_read_b64_tr_b16 a[212:213], v11 offset:16384
    buffer_load_ushort v103, v30, s[60:63], 0 offen offset:32
    v_mfma_f32_16x16x32_bf16 v[44:47], v[104:107], a[100:103], v[44:47]
    ds_read_b64_tr_b16 a[214:215], v11 offset:18432
    s_waitcnt lgkmcnt(4)
    v_mfma_f32_16x16x32_bf16 v[52:55], v[120:123], a[100:103], v[52:55]
    ds_read_b64_tr_b16 a[220:221], v11 offset:20480
    v_mfma_f32_16x16x32_bf16 v[52:55], v[124:127], a[108:111], v[52:55]
    ds_read_b64_tr_b16 a[222:223], v11 offset:22528
    s_waitcnt lgkmcnt(4)
    v_mfma_f32_16x16x32_bf16 v[52:55], v[128:131], a[116:119], v[52:55]
    s_waitcnt vmcnt(14) lgkmcnt(0)
    s_barrier
    v_mfma_f32_16x16x32_bf16 v[52:55], v[132:135], a[124:127], v[52:55]
    ds_read_b128 v[104:107], v14 offset:49152
    s_lshl_b32 s14, s101, 18
    ds_read_b64_tr_b16 a[224:225], v10 offset:49152
    s_add_u32 m0, s73, 81920
    v_mfma_f32_16x16x32_bf16 v[48:51], v[132:135], a[120:123], v[48:51]
    ds_read_b128 v[108:111], v14 offset:53248
    buffer_load_dwordx4 v4, s[52:55], s14 offen offset:0 lds
    v_mfma_f32_16x16x32_bf16 v[48:51], v[128:131], a[112:115], v[48:51]
    ds_read_b128 v[112:115], v14 offset:57344
    buffer_load_ushort v27, v31, s[60:63], 0 offen offset:0
    v_mfma_f32_16x16x32_bf16 v[48:51], v[124:127], a[104:107], v[48:51]
    ds_read_b128 v[116:119], v14 offset:61440
    v_mfma_f32_16x16x32_bf16 v[48:51], v[120:123], a[96:99], v[48:51]
    ds_read_b64_tr_b16 a[226:227], v10 offset:51200
    s_waitcnt lgkmcnt(3)
    v_mfma_f32_16x16x32_bf16 v[32:35], v[104:107], a[128:131], v[32:35]
    s_add_u32 m0, s73, 130304
    ds_read_b64_tr_b16 a[232:233], v10 offset:53248
    v_mfma_f32_16x16x32_bf16 v[32:35], v[108:111], a[136:139], v[32:35]
    buffer_load_dwordx4 v23, s[44:47], s26 offen offset:768 sc1 lds
    ds_read_b64_tr_b16 a[234:235], v10 offset:55296
    s_waitcnt lgkmcnt(3)
    v_mfma_f32_16x16x32_bf16 v[32:35], v[112:115], a[144:147], v[32:35]
    ds_read_b128 v[120:123], v14 offset:50176
    s_add_u32 m0, s73, 81920
    v_mfma_f32_16x16x32_bf16 v[32:35], v[116:119], a[152:155], v[32:35]
    ds_read_b128 v[124:127], v14 offset:54272
    buffer_load_dwordx4 v5, s[52:55], s14 offen offset:1024 lds
    v_mfma_f32_16x16x32_bf16 v[36:39], v[116:119], a[156:159], v[36:39]
    ds_read_b128 v[128:131], v14 offset:58368
    v_mfma_f32_16x16x32_bf16 v[36:39], v[112:115], a[148:151], v[36:39]
    ds_read_b128 v[132:135], v14 offset:62464
    v_mfma_f32_16x16x32_bf16 v[36:39], v[108:111], a[140:143], v[36:39]
    s_add_u32 m0, s73, 132096
    ds_read_b64_tr_b16 a[228:229], v11 offset:49152
    v_mfma_f32_16x16x32_bf16 v[36:39], v[104:107], a[132:135], v[36:39]
    buffer_load_dwordx4 v20, s[44:47], s26 offen offset:0 sc1 lds
    ds_read_b64_tr_b16 a[230:231], v11 offset:51200
    s_waitcnt lgkmcnt(4)
    v_mfma_f32_16x16x32_bf16 v[44:47], v[120:123], a[132:135], v[44:47]
    ds_read_b64_tr_b16 a[236:237], v11 offset:53248
    buffer_load_dwordx4 v[88:91], v252, s[56:59], 0 offen
    s_add_u32 m0, s73, 132608
    v_mfma_f32_16x16x32_bf16 v[44:47], v[124:127], a[140:143], v[44:47]
    buffer_load_dwordx4 v20, s[44:47], s26 offen offset:512 sc1 lds
    ds_read_b64_tr_b16 a[238:239], v11 offset:55296
    s_waitcnt lgkmcnt(4)
    v_mfma_f32_16x16x32_bf16 v[44:47], v[128:131], a[148:151], v[44:47]
    ds_read_b128 v[104:107], v14 offset:51200
    s_add_u32 m0, s73, 81920
    v_add_u32 v10, 65536, v10
    v_mfma_f32_16x16x32_bf16 v[44:47], v[132:135], a[156:159], v[44:47]
    ds_read_b128 v[108:111], v14 offset:55296
    buffer_load_dwordx4 v6, s[52:55], s14 offen offset:2048 lds
    v_mfma_f32_16x16x32_bf16 v[40:43], v[132:135], a[152:155], v[40:43]
    ds_read_b128 v[112:115], v14 offset:59392
    v_mfma_f32_16x16x32_bf16 v[40:43], v[128:131], a[144:147], v[40:43]
    ds_read_b128 v[116:119], v14 offset:63488
    v_mfma_f32_16x16x32_bf16 v[40:43], v[124:127], a[136:139], v[40:43]
    s_add_u32 m0, s73, 134144
    ds_read_b64_tr_b16 a[240:241], v10 offset:0
    v_mfma_f32_16x16x32_bf16 v[40:43], v[120:123], a[128:131], v[40:43]
    buffer_load_dwordx4 v21, s[44:47], s18 offen offset:0 sc1 lds
    ds_read_b64_tr_b16 a[242:243], v10 offset:2048
    s_waitcnt lgkmcnt(4)
    v_mfma_f32_16x16x32_bf16 v[48:51], v[104:107], a[128:131], v[48:51]
    ds_read_b64_tr_b16 a[248:249], v10 offset:4096
    s_add_u32 m0, s73, 81920
    v_mfma_f32_16x16x32_bf16 v[48:51], v[108:111], a[136:139], v[48:51]
    ds_read_b64_tr_b16 a[250:251], v10 offset:6144
    buffer_load_dwordx4 v7, s[52:55], s14 offen offset:3072 lds
    s_waitcnt lgkmcnt(4)
    v_mfma_f32_16x16x32_bf16 v[48:51], v[112:115], a[144:147], v[48:51]
    ds_read_b128 v[120:123], v14 offset:52224
    v_add_u32 v11, 65536, v11
    v_mfma_f32_16x16x32_bf16 v[48:51], v[116:119], a[152:155], v[48:51]
    ds_read_b128 v[124:127], v14 offset:56320
    v_mfma_f32_16x16x32_bf16 v[52:55], v[116:119], a[156:159], v[52:55]
    ds_read_b128 v[128:131], v14 offset:60416
    v_mfma_f32_16x16x32_bf16 v[52:55], v[112:115], a[148:151], v[52:55]
    ds_read_b128 v[132:135], v14 offset:64512
    v_mfma_f32_16x16x32_bf16 v[52:55], v[108:111], a[140:143], v[52:55]
    ds_read_b64_tr_b16 a[244:245], v11 offset:0
    v_mfma_f32_16x16x32_bf16 v[52:55], v[104:107], a[132:135], v[52:55]
    ds_read_b64_tr_b16 a[246:247], v11 offset:2048
    s_waitcnt lgkmcnt(4)
    v_mfma_f32_16x16x32_bf16 v[36:39], v[120:123], a[164:167], v[36:39]
    ds_read_b64_tr_b16 a[252:253], v11 offset:4096
    buffer_load_dwordx4 v[92:95], v252, s[56:59], s40 offen
    v_mfma_f32_16x16x32_bf16 v[36:39], v[124:127], a[172:175], v[36:39]
    ds_read_b64_tr_b16 a[254:255], v11 offset:6144
    s_waitcnt lgkmcnt(4)
    v_mfma_f32_16x16x32_bf16 v[36:39], v[128:131], a[180:183], v[36:39]
    s_waitcnt vmcnt(12) lgkmcnt(0)
    s_barrier
    v_mfma_f32_16x16x32_bf16 v[36:39], v[132:135], a[188:191], v[36:39]
    ds_read_b128 v[104:107], v14 offset:0
    v_mfma_f32_16x16x32_bf16 v[32:35], v[132:135], a[184:187], v[32:35]
    ds_read_b128 v[108:111], v14 offset:4096
    v_add_u32 v10, -65536, v10
    v_mfma_f32_16x16x32_bf16 v[32:35], v[128:131], a[176:179], v[32:35]
    ds_read_b128 v[112:115], v14 offset:8192
    v_mfma_f32_16x16x32_bf16 v[32:35], v[124:127], a[168:171], v[32:35]
    ds_read_b128 v[116:119], v14 offset:12288
    v_mfma_f32_16x16x32_bf16 v[32:35], v[120:123], a[160:163], v[32:35]
    ds_read_b64_tr_b16 v[220:221], v10 offset:32768
    s_waitcnt lgkmcnt(3)
    v_mfma_f32_16x16x32_bf16 v[40:43], v[104:107], a[160:163], v[40:43]
    s_add_u32 m0, s73, 146944
    v_mfma_f32_16x16x32_bf16 v[40:43], v[108:111], a[168:171], v[40:43]
    buffer_load_dwordx4 v21, s[44:47], s18 offen offset:512 sc1 lds
    ds_read_b64_tr_b16 v[222:223], v10 offset:34816
    s_waitcnt lgkmcnt(2)
    v_mfma_f32_16x16x32_bf16 v[40:43], v[112:115], a[176:179], v[40:43]
    ds_read_b128 v[120:123], v14 offset:1024
    v_mfma_f32_16x16x32_bf16 v[40:43], v[116:119], a[184:187], v[40:43]
    ds_read_b128 v[124:127], v14 offset:5120
    v_mfma_f32_16x16x32_bf16 v[44:47], v[116:119], a[188:191], v[44:47]
    ds_read_b128 v[128:131], v14 offset:9216
    v_mfma_f32_16x16x32_bf16 v[44:47], v[112:115], a[180:183], v[44:47]
    ds_read_b128 v[132:135], v14 offset:13312
    v_mfma_f32_16x16x32_bf16 v[44:47], v[108:111], a[172:175], v[44:47]
    s_add_u32 m0, s73, 148480
    ds_read_b64_tr_b16 v[228:229], v10 offset:36864
    v_mfma_f32_16x16x32_bf16 v[44:47], v[104:107], a[164:167], v[44:47]
    buffer_load_dwordx4 v21, s[44:47], s19 offen offset:0 sc1 lds
    s_waitcnt lgkmcnt(3)
    v_mfma_f32_16x16x32_bf16 v[52:55], v[120:123], a[164:167], v[52:55]
    ds_read_b64_tr_b16 v[230:231], v10 offset:38912
    buffer_load_dwordx2 v[142:143], v253, s[56:59], 0 offen
    s_add_u32 m0, s73, 148992
    v_mfma_f32_16x16x32_bf16 v[52:55], v[124:127], a[172:175], v[52:55]
    buffer_load_dwordx4 v21, s[44:47], s19 offen offset:512 sc1 lds
    s_waitcnt lgkmcnt(2)
    v_mfma_f32_16x16x32_bf16 v[52:55], v[128:131], a[180:183], v[52:55]
    ds_read_b128 v[104:107], v14 offset:2048
    v_mfma_f32_16x16x32_bf16 v[52:55], v[132:135], a[188:191], v[52:55]
    ds_read_b128 v[108:111], v14 offset:6144
    v_mfma_f32_16x16x32_bf16 v[48:51], v[132:135], a[184:187], v[48:51]
    ds_read_b128 v[112:115], v14 offset:10240
    v_add_u32 v11, -65536, v11
    v_mfma_f32_16x16x32_bf16 v[48:51], v[128:131], a[176:179], v[48:51]
    ds_read_b128 v[116:119], v14 offset:14336
    v_mfma_f32_16x16x32_bf16 v[48:51], v[124:127], a[168:171], v[48:51]
    s_add_u32 m0, s73, 150528
    v_mfma_f32_16x16x32_bf16 v[48:51], v[120:123], a[160:163], v[48:51]
    buffer_load_dwordx4 v21, s[44:47], s20 offen offset:0 sc1 lds
    ds_read_b64_tr_b16 v[224:225], v11 offset:32768
    s_waitcnt lgkmcnt(3)
    v_mfma_f32_16x16x32_bf16 v[32:35], v[104:107], a[192:195], v[32:35]
    v_mfma_f32_16x16x32_bf16 v[32:35], v[108:111], a[200:203], v[32:35]
    ds_read_b64_tr_b16 v[226:227], v11 offset:34816
    s_waitcnt vmcnt(14)
    s_waitcnt lgkmcnt(2)
    v_mfma_f32_16x16x32_bf16 v[32:35], v[112:115], a[208:211], v[32:35]
    ds_read_b128 v[120:123], v14 offset:3072
    v_mfma_f32_16x16x32_bf16 v[32:35], v[116:119], a[216:219], v[32:35]
    ds_read_b128 v[124:127], v14 offset:7168
    v_mfma_f32_16x16x32_bf16 v[36:39], v[116:119], a[220:223], v[36:39]
    ds_read_b128 v[128:131], v14 offset:11264
    v_lshlrev_b32 v72, 16, v102
    v_mfma_f32_16x16x32_bf16 v[36:39], v[112:115], a[212:215], v[36:39]
    ds_read_b128 v[132:135], v14 offset:15360
    v_mfma_f32_16x16x32_bf16 v[36:39], v[108:111], a[204:207], v[36:39]
    ds_read_b64_tr_b16 v[232:233], v11 offset:36864
    v_lshlrev_b32 v73, 16, v102
    v_mfma_f32_16x16x32_bf16 v[36:39], v[104:107], a[196:199], v[36:39]
    s_waitcnt lgkmcnt(3)
    v_mfma_f32_16x16x32_bf16 v[44:47], v[120:123], a[196:199], v[44:47]
    ds_read_b64_tr_b16 v[234:235], v11 offset:38912
    buffer_load_dwordx2 v[96:97], v26, s[44:47], s42 offen offset:0 sc1
    v_mfma_f32_16x16x32_bf16 v[44:47], v[124:127], a[204:207], v[44:47]
    v_lshlrev_b32 v74, 16, v102
    s_waitcnt lgkmcnt(2)
    v_mfma_f32_16x16x32_bf16 v[44:47], v[128:131], a[212:215], v[44:47]
    s_waitcnt vmcnt(7) lgkmcnt(0)
    s_barrier
    v_mfma_f32_16x16x32_bf16 v[44:47], v[132:135], a[220:223], v[44:47]
    ds_read_b128 v[104:107], v14 offset:16384
    v_lshlrev_b32 v75, 16, v102
    v_mfma_f32_16x16x32_bf16 v[40:43], v[132:135], a[216:219], v[40:43]
    ds_read_b128 v[108:111], v14 offset:20480
    v_add_u32 v10, 65536, v10
    v_mfma_f32_16x16x32_bf16 v[40:43], v[128:131], a[208:211], v[40:43]
    ds_read_b128 v[112:115], v14 offset:24576
    v_mfma_f32_16x16x32_bf16 v[40:43], v[124:127], a[200:203], v[40:43]
    ds_read_b128 v[116:119], v14 offset:28672
    v_lshlrev_b32 v76, 16, v103
    v_mfma_f32_16x16x32_bf16 v[40:43], v[120:123], a[192:195], v[40:43]
    ds_read_b64_tr_b16 v[236:237], v10 offset:16384
    s_waitcnt lgkmcnt(3)
    v_mfma_f32_16x16x32_bf16 v[48:51], v[104:107], a[192:195], v[48:51]
    s_add_u32 m0, s73, 97792
    v_lshlrev_b32 v77, 16, v103
    v_mfma_f32_16x16x32_bf16 v[48:51], v[108:111], a[200:203], v[48:51]
    buffer_load_dwordx4 v21, s[44:47], s20 offen offset:512 sc1 lds
    ds_read_b64_tr_b16 v[238:239], v10 offset:18432
    s_waitcnt lgkmcnt(2)
    v_mfma_f32_16x16x32_bf16 v[48:51], v[112:115], a[208:211], v[48:51]
    ds_read_b128 v[120:123], v14 offset:17408
    v_mfma_f32_16x16x32_bf16 v[48:51], v[116:119], a[216:219], v[48:51]
    ds_read_b128 v[124:127], v14 offset:21504
    v_mfma_f32_16x16x32_bf16 v[52:55], v[116:119], a[220:223], v[52:55]
    ds_read_b128 v[128:131], v14 offset:25600
    v_lshlrev_b32 v78, 16, v103
    v_mfma_f32_16x16x32_bf16 v[52:55], v[112:115], a[212:215], v[52:55]
    ds_read_b128 v[132:135], v14 offset:29696
    v_mfma_f32_16x16x32_bf16 v[52:55], v[108:111], a[204:207], v[52:55]
    ds_read_b64_tr_b16 v[244:245], v10 offset:20480
    s_add_u32 m0, s73, 99328
    v_lshlrev_b32 v79, 16, v103
    v_mfma_f32_16x16x32_bf16 v[52:55], v[104:107], a[196:199], v[52:55]
    buffer_load_dwordx4 v21, s[44:47], s21 offen offset:0 sc1 lds
    s_waitcnt lgkmcnt(3)
    v_mfma_f32_16x16x32_bf16 v[36:39], v[120:123], a[228:231], v[36:39]
    ds_read_b64_tr_b16 v[246:247], v10 offset:22528
    buffer_load_dwordx2 v[98:99], v26, s[44:47], s42 offen offset:128 sc1
    s_add_u32 m0, s73, 99840
    v_mfma_f32_16x16x32_bf16 v[36:39], v[124:127], a[236:239], v[36:39]
    buffer_load_dwordx4 v21, s[44:47], s21 offen offset:512 sc1 lds
    s_waitcnt lgkmcnt(2)
    v_mfma_f32_16x16x32_bf16 v[36:39], v[128:131], a[244:247], v[36:39]
    ds_read_b128 v[104:107], v14 offset:18432
    v_lshlrev_b32 v80, 16, v102
    v_mfma_f32_16x16x32_bf16 v[36:39], v[132:135], a[252:255], v[36:39]
    ds_read_b128 v[108:111], v14 offset:22528
    v_lshlrev_b32 v81, 16, v102
    v_mfma_f32_16x16x32_bf16 v[32:35], v[132:135], a[248:251], v[32:35]
    ds_read_b128 v[112:115], v14 offset:26624
    v_add_u32 v11, 65536, v11
    v_mfma_f32_16x16x32_bf16 v[32:35], v[128:131], a[240:243], v[32:35]
    ds_read_b128 v[116:119], v14 offset:30720
    v_mfma_f32_16x16x32_bf16 v[32:35], v[124:127], a[232:235], v[32:35]
    s_add_u32 m0, s73, 101376
    v_lshlrev_b32 v82, 16, v102
    v_mfma_f32_16x16x32_bf16 v[32:35], v[120:123], a[224:227], v[32:35]
    buffer_load_dwordx4 v21, s[44:47], s22 offen offset:0 sc1 lds
    ds_read_b64_tr_b16 v[240:241], v11 offset:16384
    s_waitcnt lgkmcnt(3)
    v_mfma_f32_16x16x32_bf16 v[40:43], v[104:107], a[224:227], v[40:43]
    v_lshlrev_b32 v83, 16, v102
    v_mfma_f32_16x16x32_bf16 v[40:43], v[108:111], a[232:235], v[40:43]
    ds_read_b64_tr_b16 v[242:243], v11 offset:18432
    s_waitcnt lgkmcnt(2)
    v_mfma_f32_16x16x32_bf16 v[40:43], v[112:115], a[240:243], v[40:43]
    ds_read_b128 v[120:123], v14 offset:19456
    v_mfma_f32_16x16x32_bf16 v[40:43], v[116:119], a[248:251], v[40:43]
    ds_read_b128 v[124:127], v14 offset:23552
    v_mfma_f32_16x16x32_bf16 v[44:47], v[116:119], a[252:255], v[44:47]
    ds_read_b128 v[128:131], v14 offset:27648
    v_lshlrev_b32 v84, 16, v103
    v_mfma_f32_16x16x32_bf16 v[44:47], v[112:115], a[244:247], v[44:47]
    ds_read_b128 v[132:135], v14 offset:31744
    v_mfma_f32_16x16x32_bf16 v[44:47], v[108:111], a[236:239], v[44:47]
    ds_read_b64_tr_b16 v[248:249], v11 offset:20480
    v_lshlrev_b32 v85, 16, v103
    v_mfma_f32_16x16x32_bf16 v[44:47], v[104:107], a[228:231], v[44:47]
    s_waitcnt lgkmcnt(3)
    v_mfma_f32_16x16x32_bf16 v[52:55], v[120:123], a[228:231], v[52:55]
    ds_read_b64_tr_b16 v[250:251], v11 offset:22528
    buffer_load_dwordx2 v[100:101], v18, s[44:47], s42 offen offset:0 sc1
    v_mfma_f32_16x16x32_bf16 v[52:55], v[124:127], a[236:239], v[52:55]
    v_lshlrev_b32 v86, 16, v103
    s_waitcnt lgkmcnt(2)
    v_mfma_f32_16x16x32_bf16 v[52:55], v[128:131], a[244:247], v[52:55]
    s_waitcnt lgkmcnt(0)
    s_barrier
    v_mfma_f32_16x16x32_bf16 v[52:55], v[132:135], a[252:255], v[52:55]
    ds_read_b128 v[104:107], v14 offset:32768
    v_mfma_f32_16x16x32_bf16 v[48:51], v[132:135], a[248:251], v[48:51]
    ds_read_b128 v[108:111], v14 offset:36864
    v_lshlrev_b32 v87, 16, v103
    v_mfma_f32_16x16x32_bf16 v[48:51], v[128:131], a[240:243], v[48:51]
    ds_read_b128 v[112:115], v14 offset:40960
    v_mfma_f32_16x16x32_bf16 v[48:51], v[124:127], a[232:235], v[48:51]
    ds_read_b128 v[116:119], v14 offset:45056
    v_lshlrev_b32 v27, 16, v27
    v_mfma_f32_16x16x32_bf16 v[48:51], v[120:123], a[224:227], v[48:51]
L_Dc:
L_pl_D_0:
    s_cbranch_execz L_wret
    s_waitcnt lgkmcnt(2)
    v_mfma_f32_16x16x32_bf16 v[32:35], v[104:107], v[220:223], v[32:35]
    s_add_u32 m0, s73, 114176
    v_mfma_f32_16x16x32_bf16 v[32:35], v[108:111], v[228:231], v[32:35]
    buffer_load_dwordx4 v21, s[44:47], s22 offen offset:512 sc1 lds
    s_waitcnt lgkmcnt(0)
    v_mfma_f32_16x16x32_bf16 v[32:35], v[112:115], v[236:239], v[32:35]
    ds_read_b128 v[120:123], v14 offset:33792
    v_mfma_f32_16x16x32_bf16 v[32:35], v[116:119], v[244:247], v[32:35]
    ds_read_b128 v[124:127], v14 offset:37888
    v_mfma_f32_16x16x32_bf16 v[36:39], v[116:119], v[248:251], v[36:39]
    ds_read_b128 v[128:131], v14 offset:41984
    buffer_load_dword v189, v188, s[44:47], 0 offen sc1
    v_mfma_f32_16x16x32_bf16 v[36:39], v[112:115], v[240:243], v[36:39]
    ds_read_b128 v[132:135], v14 offset:46080
    v_mfma_f32_16x16x32_bf16 v[36:39], v[108:111], v[232:235], v[36:39]
    s_add_u32 m0, s73, 115712
    v_mfma_f32_16x16x32_bf16 v[36:39], v[104:107], v[224:227], v[36:39]
    buffer_load_dwordx4 v21, s[44:47], s23 offen offset:0 sc1 lds
    s_waitcnt lgkmcnt(2)
    v_mfma_f32_16x16x32_bf16 v[44:47], v[120:123], v[224:227], v[44:47]
    s_add_u32 m0, s73, 116224
    v_mfma_f32_16x16x32_bf16 v[44:47], v[124:127], v[232:235], v[44:47]
    buffer_load_dwordx4 v21, s[44:47], s23 offen offset:512 sc1 lds
    s_waitcnt lgkmcnt(0)
    v_mfma_f32_16x16x32_bf16 v[44:47], v[128:131], v[240:243], v[44:47]
    ds_read_b128 v[104:107], v14 offset:34816
    v_mfma_f32_16x16x32_bf16 v[44:47], v[132:135], v[248:251], v[44:47]
    ds_read_b128 v[108:111], v14 offset:38912
    v_mfma_f32_16x16x32_bf16 v[40:43], v[132:135], v[244:247], v[40:43]
    ds_read_b128 v[112:115], v14 offset:43008
    v_mfma_f32_16x16x32_bf16 v[40:43], v[128:131], v[236:239], v[40:43]
    ds_read_b128 v[116:119], v14 offset:47104
    v_mfma_f32_16x16x32_bf16 v[40:43], v[124:127], v[228:231], v[40:43]
    s_add_u32 m0, s73, 117760
    v_mfma_f32_16x16x32_bf16 v[40:43], v[120:123], v[220:223], v[40:43]
    buffer_load_dwordx4 v21, s[44:47], s24 offen offset:0 sc1 lds
    s_waitcnt lgkmcnt(2)
    v_mfma_f32_16x16x32_bf16 v[48:51], v[104:107], v[220:223], v[48:51]
    v_mfma_f32_16x16x32_bf16 v[48:51], v[108:111], v[228:231], v[48:51]
    s_waitcnt lgkmcnt(0)
    v_mfma_f32_16x16x32_bf16 v[48:51], v[112:115], v[236:239], v[48:51]
    ds_read_b128 v[120:123], v14 offset:35840
    v_mfma_f32_16x16x32_bf16 v[48:51], v[116:119], v[244:247], v[48:51]
    ds_read_b128 v[124:127], v14 offset:39936
    v_mfma_f32_16x16x32_bf16 v[52:55], v[116:119], v[248:251], v[52:55]
    ds_read_b128 v[128:131], v14 offset:44032
    v_mfma_f32_16x16x32_bf16 v[52:55], v[112:115], v[240:243], v[52:55]
    ds_read_b128 v[132:135], v14 offset:48128
    v_mfma_f32_16x16x32_bf16 v[52:55], v[108:111], v[232:235], v[52:55]
    v_mfma_f32_16x16x32_bf16 v[52:55], v[104:107], v[224:227], v[52:55]
    s_waitcnt lgkmcnt(2)
    v_mfma_f32_16x16x32_bf16 v[60:63], v[120:123], a[4:7], 0
    v_mfma_f32_16x16x32_bf16 v[60:63], v[124:127], a[12:15], v[60:63]
    s_waitcnt lgkmcnt(0)
    v_mfma_f32_16x16x32_bf16 v[60:63], v[128:131], a[20:23], v[60:63]
    s_waitcnt vmcnt(12)
    s_barrier
    v_mfma_f32_16x16x32_bf16 v[60:63], v[132:135], a[28:31], v[60:63]
    ds_read_b128 v[104:107], v14 offset:49152
    v_mfma_f32_16x16x32_bf16 v[56:59], v[132:135], a[24:27], 0
    ds_read_b128 v[108:111], v14 offset:53248
    v_mfma_f32_16x16x32_bf16 v[56:59], v[128:131], a[16:19], v[56:59]
    ds_read_b128 v[112:115], v14 offset:57344
    v_cvt_pk_bf16_f32 v192, v32, v33
    v_mfma_f32_16x16x32_bf16 v[56:59], v[124:127], a[8:11], v[56:59]
    ds_read_b128 v[116:119], v14 offset:61440
    v_mfma_f32_16x16x32_bf16 v[56:59], v[120:123], a[0:3], v[56:59]
    s_waitcnt lgkmcnt(2)
    v_mfma_f32_16x16x32_bf16 v[64:67], v[104:107], a[0:3], 0
    s_add_u32 m0, s73, 130560
    v_mfma_f32_16x16x32_bf16 v[64:67], v[108:111], a[8:11], v[64:67]
    buffer_load_dwordx4 v21, s[44:47], s24 offen offset:512 sc1 lds
    s_waitcnt lgkmcnt(0)
    v_mfma_f32_16x16x32_bf16 v[64:67], v[112:115], a[16:19], v[64:67]
    ds_read_b128 v[120:123], v14 offset:50176
    v_cvt_pk_bf16_f32 v193, v34, v35
    v_mfma_f32_16x16x32_bf16 v[64:67], v[116:119], a[24:27], v[64:67]
    ds_read_b128 v[124:127], v14 offset:54272
    v_mfma_f32_16x16x32_bf16 v[68:71], v[116:119], a[28:31], 0
    ds_read_b128 v[128:131], v14 offset:58368
    v_mfma_f32_16x16x32_bf16 v[68:71], v[112:115], a[20:23], v[68:71]
    buffer_store_dwordx4 v[192:195], v136, s[44:47], s32 offen sc1
    ds_read_b128 v[132:135], v14 offset:62464
    v_mfma_f32_16x16x32_bf16 v[68:71], v[108:111], a[12:15], v[68:71]
    s_add_u32 m0, s73, 132096
    v_mfma_f32_16x16x32_bf16 v[68:71], v[104:107], a[4:7], v[68:71]
    buffer_load_dwordx4 v21, s[44:47], s25 offen offset:0 sc1 lds
    s_waitcnt lgkmcnt(2)
    v_mfma_f32_16x16x32_bf16 v[60:63], v[120:123], a[36:39], v[60:63]
    s_add_u32 m0, s73, 132608
    v_mfma_f32_16x16x32_bf16 v[60:63], v[124:127], a[44:47], v[60:63]
    buffer_load_dwordx4 v21, s[44:47], s25 offen offset:512 sc1 lds
    s_waitcnt lgkmcnt(0)
    v_mfma_f32_16x16x32_bf16 v[60:63], v[128:131], a[52:55], v[60:63]
    ds_read_b128 v[104:107], v14 offset:51200
    v_mfma_f32_16x16x32_bf16 v[60:63], v[132:135], a[60:63], v[60:63]
    ds_read_b128 v[108:111], v14 offset:55296
    v_mfma_f32_16x16x32_bf16 v[56:59], v[132:135], a[56:59], v[56:59]
    ds_read_b128 v[112:115], v14 offset:59392
    v_mfma_f32_16x16x32_bf16 v[56:59], v[128:131], a[48:51], v[56:59]
    ds_read_b128 v[116:119], v14 offset:63488
    v_mfma_f32_16x16x32_bf16 v[56:59], v[124:127], a[40:43], v[56:59]
    s_add_u32 m0, s73, 134144
    v_cvt_pk_bf16_f32 v196, v36, v37
    v_mfma_f32_16x16x32_bf16 v[56:59], v[120:123], a[32:35], v[56:59]
    buffer_load_dwordx4 v21, s[44:47], s26 offen offset:0 sc1 lds
    s_waitcnt lgkmcnt(2)
    v_mfma_f32_16x16x32_bf16 v[64:67], v[104:107], a[32:35], v[64:67]
    v_mfma_f32_16x16x32_bf16 v[64:67], v[108:111], a[40:43], v[64:67]
    s_waitcnt lgkmcnt(0)
    v_mfma_f32_16x16x32_bf16 v[64:67], v[112:115], a[48:51], v[64:67]
    ds_read_b128 v[120:123], v14 offset:52224
    v_cvt_pk_bf16_f32 v197, v38, v39
    v_mfma_f32_16x16x32_bf16 v[64:67], v[116:119], a[56:59], v[64:67]
    ds_read_b128 v[124:127], v14 offset:56320
    v_mfma_f32_16x16x32_bf16 v[68:71], v[116:119], a[60:63], v[68:71]
    ds_read_b128 v[128:131], v14 offset:60416
    v_mfma_f32_16x16x32_bf16 v[68:71], v[112:115], a[52:55], v[68:71]
    ds_read_b128 v[132:135], v14 offset:64512
    v_mfma_f32_16x16x32_bf16 v[68:71], v[108:111], a[44:47], v[68:71]
    buffer_store_dwordx4 v[196:199], v136, s[44:47], s33 offen sc1
    v_mfma_f32_16x16x32_bf16 v[68:71], v[104:107], a[36:39], v[68:71]
    s_waitcnt lgkmcnt(2)
    v_mfma_f32_16x16x32_bf16 v[60:63], v[120:123], a[68:71], v[60:63]
    v_mfma_f32_16x16x32_bf16 v[60:63], v[124:127], a[76:79], v[60:63]
    s_waitcnt lgkmcnt(0)
    v_mfma_f32_16x16x32_bf16 v[60:63], v[128:131], a[84:87], v[60:63]
    s_waitcnt vmcnt(12)
    s_barrier
    v_mfma_f32_16x16x32_bf16 v[60:63], v[132:135], a[92:95], v[60:63]
    ds_read_b128 v[104:107], v14 offset:0
    v_mfma_f32_16x16x32_bf16 v[56:59], v[132:135], a[88:91], v[56:59]
    ds_read_b128 v[108:111], v14 offset:4096
    v_mfma_f32_16x16x32_bf16 v[56:59], v[128:131], a[80:83], v[56:59]
    ds_read_b128 v[112:115], v14 offset:8192
    v_cvt_pk_bf16_f32 v192, v40, v41
    v_mfma_f32_16x16x32_bf16 v[56:59], v[124:127], a[72:75], v[56:59]
    ds_read_b128 v[116:119], v14 offset:12288
    v_mfma_f32_16x16x32_bf16 v[56:59], v[120:123], a[64:67], v[56:59]
    s_waitcnt lgkmcnt(2)
    v_mfma_f32_16x16x32_bf16 v[64:67], v[104:107], a[64:67], v[64:67]
    s_add_u32 m0, s73, 146944
    v_cvt_pk_bf16_f32 v193, v42, v43
    s_waitcnt vmcnt(11)
    v_mfma_f32_16x16x32_bf16 v[64:67], v[108:111], a[72:75], v[64:67]
    buffer_load_dwordx4 v21, s[44:47], s26 offen offset:512 sc1 lds
    s_waitcnt lgkmcnt(0)
    v_mfma_f32_16x16x32_bf16 v[64:67], v[112:115], a[80:83], v[64:67]
    ds_read_b128 v[120:123], v14 offset:1024
    v_mul_f32 v96, v96, v97
    v_mfma_f32_16x16x32_bf16 v[64:67], v[116:119], a[88:91], v[64:67]
    ds_read_b128 v[124:127], v14 offset:5120
    v_cvt_pk_bf16_f32 v194, v44, v45
    v_mfma_f32_16x16x32_bf16 v[68:71], v[116:119], a[92:95], v[68:71]
    ds_read_b128 v[128:131], v14 offset:9216
    v_mul_f32 v98, v98, v99
    v_mfma_f32_16x16x32_bf16 v[68:71], v[112:115], a[84:87], v[68:71]
    ds_read_b128 v[132:135], v14 offset:13312
    v_mul_f32 v100, v100, v101
    v_mfma_f32_16x16x32_bf16 v[68:71], v[108:111], a[76:79], v[68:71]
    buffer_store_dwordx4 v[192:195], v136, s[44:47], s30 offen offset:0 sc1
    s_add_u32 m0, s73, 148480
    v_permlane16_swap_b32 v88, v90
    v_mfma_f32_16x16x32_bf16 v[68:71], v[104:107], a[68:71], v[68:71]
    buffer_load_dwordx4 v22, s[44:47], s18 offen offset:0 sc1 lds
    s_waitcnt lgkmcnt(2)
    v_mfma_f32_16x16x32_bf16 v[60:63], v[120:123], a[100:103], v[60:63]
    s_add_u32 m0, s73, 148992
    v_permlane16_swap_b32 v89, v91
    v_permlane16_swap_b32 v92, v94
    v_mfma_f32_16x16x32_bf16 v[60:63], v[124:127], a[108:111], v[60:63]
    buffer_load_dwordx4 v22, s[44:47], s18 offen offset:512 sc1 lds
    s_waitcnt vmcnt(13)
    s_waitcnt lgkmcnt(0)
    v_mfma_f32_16x16x32_bf16 v[60:63], v[128:131], a[116:119], v[60:63]
    ds_read_b128 v[104:107], v14 offset:2048
    v_permlane16_swap_b32 v93, v95
    v_mfma_f32_16x16x32_bf16 v[60:63], v[132:135], a[124:127], v[60:63]
    ds_read_b128 v[108:111], v14 offset:6144
    v_cmp_ne_u32 vcc, s68, v189
    v_mfma_f32_16x16x32_bf16 v[56:59], v[132:135], a[120:123], v[56:59]
    ds_read_b128 v[112:115], v14 offset:10240
    v_and_b32 v145, 0xffff0000, v88
    v_mfma_f32_16x16x32_bf16 v[56:59], v[128:131], a[112:115], v[56:59]
    ds_read_b128 v[116:119], v14 offset:14336
    v_cvt_pk_bf16_f32 v196, v46, v47
    v_mfma_f32_16x16x32_bf16 v[56:59], v[124:127], a[104:107], v[56:59]
    s_add_u32 m0, s73, 150528
    s_cbranch_vccnz L_rs_p3
L_ok_p3:
    v_lshlrev_b32 v144, 16, v88
    v_mfma_f32_16x16x32_bf16 v[56:59], v[120:123], a[96:99], v[56:59]
    buffer_load_dwordx4 v22, s[44:47], s19 offen offset:0 sc1 lds
    s_waitcnt lgkmcnt(2)
    v_mfma_f32_16x16x32_bf16 v[64:67], v[104:107], a[96:99], v[64:67]
    s_add_u32 m0, s73, 81920
    v_cvt_pk_bf16_f32 v197, v48, v49
    v_and_b32 v147, 0xffff0000, v89
    v_mfma_f32_16x16x32_bf16 v[64:67], v[108:111], a[104:107], v[64:67]
    buffer_load_dwordx4 v184, s[44:47], s37 offen offset:0 sc1 lds
    s_waitcnt lgkmcnt(0)
    v_mfma_f32_16x16x32_bf16 v[64:67], v[112:115], a[112:115], v[64:67]
    ds_read_b128 v[120:123], v14 offset:3072
    buffer_load_dwordx4 v185, s[44:47], s37 offen offset:1024 sc1 lds
    v_mfma_f32_16x16x32_bf16 v[64:67], v[116:119], a[120:123], v[64:67]
    ds_read_b128 v[124:127], v14 offset:7168
    s_add_u32 m0, s73, 83968
    v_cvt_pk_bf16_f32 v198, v50, v51
    v_mfma_f32_16x16x32_bf16 v[68:71], v[116:119], a[124:127], v[68:71]
    ds_read_b128 v[128:131], v14 offset:11264
    buffer_load_dwordx4 v184, s[44:47], s16 offen offset:0 sc1 lds
    v_mfma_f32_16x16x32_bf16 v[68:71], v[112:115], a[116:119], v[68:71]
    ds_read_b128 v[132:135], v14 offset:15360
    buffer_load_dwordx4 v185, s[44:47], s16 offen offset:1024 sc1 lds
    v_mfma_f32_16x16x32_bf16 v[68:71], v[108:111], a[108:111], v[68:71]
    buffer_store_dwordx4 v[196:199], v136, s[44:47], s30 offen offset:1024 sc1
    v_lshlrev_b32 v146, 16, v89
    v_and_b32 v149, 0xffff0000, v92
    v_lshlrev_b32 v148, 16, v92
    v_mfma_f32_16x16x32_bf16 v[68:71], v[104:107], a[100:103], v[68:71]
    s_waitcnt lgkmcnt(2)
    v_mfma_f32_16x16x32_bf16 v[60:63], v[120:123], a[132:135], v[60:63]
    v_and_b32 v151, 0xffff0000, v93
    v_mfma_f32_16x16x32_bf16 v[60:63], v[124:127], a[140:143], v[60:63]
    v_lshlrev_b32 v150, 16, v93
    s_waitcnt lgkmcnt(0)
    v_mfma_f32_16x16x32_bf16 v[60:63], v[128:131], a[148:151], v[60:63]
    s_waitcnt vmcnt(16)
    s_barrier
    v_mfma_f32_16x16x32_bf16 v[60:63], v[132:135], a[156:159], v[60:63]
    ds_read_b128 v[104:107], v14 offset:16384
    v_and_b32 v153, 0xffff0000, v90
    v_mfma_f32_16x16x32_bf16 v[56:59], v[132:135], a[152:155], v[56:59]
    ds_read_b128 v[108:111], v14 offset:20480
    v_lshlrev_b32 v152, 16, v90
    v_mfma_f32_16x16x32_bf16 v[56:59], v[128:131], a[144:147], v[56:59]
    ds_read_b128 v[112:115], v14 offset:24576
L_pl_D_1:
    s_cbranch_execz L_wret
    v_cvt_pk_bf16_f32 v200, v52, v53
    v_mfma_f32_16x16x32_bf16 v[56:59], v[124:127], a[136:139], v[56:59]
    ds_read_b128 v[116:119], v14 offset:28672
    v_and_b32 v155, 0xffff0000, v91
    v_mfma_f32_16x16x32_bf16 v[56:59], v[120:123], a[128:131], v[56:59]
    s_waitcnt lgkmcnt(2)
    v_mfma_f32_16x16x32_bf16 v[64:67], v[104:107], a[128:131], v[64:67]
    s_add_u32 m0, s73, 97792
    v_lshlrev_b32 v154, 16, v91
    v_mfma_f32_16x16x32_bf16 v[64:67], v[108:111], a[136:139], v[64:67]
    buffer_load_dwordx4 v22, s[44:47], s19 offen offset:512 sc1 lds
    s_waitcnt lgkmcnt(0)
    v_mfma_f32_16x16x32_bf16 v[64:67], v[112:115], a[144:147], v[64:67]
    ds_read_b128 v[120:123], v14 offset:17408
    v_cvt_pk_bf16_f32 v201, v54, v55
    v_mfma_f32_16x16x32_bf16 v[64:67], v[116:119], a[152:155], v[64:67]
    ds_read_b128 v[124:127], v14 offset:21504
    v_and_b32 v157, 0xffff0000, v94
    v_mfma_f32_16x16x32_bf16 v[68:71], v[116:119], a[156:159], v[68:71]
    ds_read_b128 v[128:131], v14 offset:25600
    v_lshlrev_b32 v156, 16, v94
    v_mfma_f32_16x16x32_bf16 v[68:71], v[112:115], a[148:151], v[68:71]
    buffer_store_dwordx4 v[200:203], v136, s[44:47], s30 offen offset:2048 sc1
    ds_read_b128 v[132:135], v14 offset:29696
    v_and_b32 v159, 0xffff0000, v95
    v_mfma_f32_16x16x32_bf16 v[68:71], v[108:111], a[140:143], v[68:71]
    s_add_u32 m0, s73, 99328
    v_lshlrev_b32 v158, 16, v95
    v_mfma_f32_16x16x32_bf16 v[68:71], v[104:107], a[132:135], v[68:71]
    buffer_load_dwordx4 v22, s[44:47], s20 offen offset:0 sc1 lds
    s_waitcnt lgkmcnt(2)
    v_mfma_f32_16x16x32_bf16 v[60:63], v[120:123], a[164:167], v[60:63]
    s_add_u32 m0, s73, 99840
    v_and_b32 v161, 0xffff0000, v142
    v_mfma_f32_16x16x32_bf16 v[60:63], v[124:127], a[172:175], v[60:63]
    buffer_load_dwordx4 v22, s[44:47], s20 offen offset:512 sc1 lds
    s_waitcnt lgkmcnt(0)
    v_mfma_f32_16x16x32_bf16 v[60:63], v[128:131], a[180:183], v[60:63]
    ds_read_b128 v[104:107], v14 offset:18432
    v_lshlrev_b32 v160, 16, v142
    v_mfma_f32_16x16x32_bf16 v[60:63], v[132:135], a[188:191], v[60:63]
    ds_read_b128 v[108:111], v14 offset:22528
    v_mfma_f32_16x16x32_bf16 v[56:59], v[132:135], a[184:187], v[56:59]
    ds_read_b128 v[112:115], v14 offset:26624
    v_and_b32 v163, 0xffff0000, v143
    v_mfma_f32_16x16x32_bf16 v[56:59], v[128:131], a[176:179], v[56:59]
    ds_read_b128 v[116:119], v14 offset:30720
    v_lshlrev_b32 v162, 16, v143
    v_mfma_f32_16x16x32_bf16 v[56:59], v[124:127], a[168:171], v[56:59]
    s_add_u32 m0, s73, 101376
    v_mfma_f32_16x16x32_bf16 v[56:59], v[120:123], a[160:163], v[56:59]
    buffer_load_dwordx4 v22, s[44:47], s21 offen offset:0 sc1 lds
    s_waitcnt lgkmcnt(2)
    v_mfma_f32_16x16x32_bf16 v[64:67], v[104:107], a[160:163], v[64:67]
    v_fma_f32 v164, v144, v97, -v96
    v_mfma_f32_16x16x32_bf16 v[64:67], v[108:111], a[168:171], v[64:67]
    v_fma_f32 v165, v145, v97, -v96
    s_waitcnt lgkmcnt(0)
    v_mfma_f32_16x16x32_bf16 v[64:67], v[112:115], a[176:179], v[64:67]
    ds_read_b128 v[120:123], v14 offset:19456
    v_fma_f32 v166, v146, v97, -v96
    v_mfma_f32_16x16x32_bf16 v[64:67], v[116:119], a[184:187], v[64:67]
    ds_read_b128 v[124:127], v14 offset:23552
    v_mfma_f32_16x16x32_bf16 v[68:71], v[116:119], a[188:191], v[68:71]
    ds_read_b128 v[128:131], v14 offset:27648
    v_fma_f32 v167, v147, v97, -v96
    v_mfma_f32_16x16x32_bf16 v[68:71], v[112:115], a[180:183], v[68:71]
    ds_read_b128 v[132:135], v14 offset:31744
    v_mfma_f32_16x16x32_bf16 v[68:71], v[108:111], a[172:175], v[68:71]
    v_fma_f32 v168, v148, v99, -v98
    v_mfma_f32_16x16x32_bf16 v[68:71], v[104:107], a[164:167], v[68:71]
    v_fma_f32 v169, v149, v99, -v98
    s_waitcnt lgkmcnt(2)
    v_mfma_f32_16x16x32_bf16 v[60:63], v[120:123], a[196:199], v[60:63]
    v_mfma_f32_16x16x32_bf16 v[60:63], v[124:127], a[204:207], v[60:63]
    v_fma_f32 v170, v150, v99, -v98
    s_waitcnt lgkmcnt(0)
    v_mfma_f32_16x16x32_bf16 v[60:63], v[128:131], a[212:215], v[60:63]
    s_waitcnt vmcnt(16)
    s_barrier
    v_mfma_f32_16x16x32_bf16 v[60:63], v[132:135], a[220:223], v[60:63]
    ds_read_b128 v[104:107], v14 offset:32768
    v_fma_f32 v171, v151, v99, -v98
    v_mfma_f32_16x16x32_bf16 v[56:59], v[132:135], a[216:219], v[56:59]
    ds_read_b128 v[108:111], v14 offset:36864
    v_fma_f32 v172, v152, v97, -v96
    v_mfma_f32_16x16x32_bf16 v[56:59], v[128:131], a[208:211], v[56:59]
    ds_read_b128 v[112:115], v14 offset:40960
    v_mfma_f32_16x16x32_bf16 v[56:59], v[124:127], a[200:203], v[56:59]
    ds_read_b128 v[116:119], v14 offset:45056
    v_fma_f32 v173, v153, v97, -v96
    v_mfma_f32_16x16x32_bf16 v[56:59], v[120:123], a[192:195], v[56:59]
    s_waitcnt lgkmcnt(2)
    v_mfma_f32_16x16x32_bf16 v[64:67], v[104:107], a[192:195], v[64:67]
    s_add_u32 m0, s73, 114176
    v_fma_f32 v174, v154, v97, -v96
    v_mfma_f32_16x16x32_bf16 v[64:67], v[108:111], a[200:203], v[64:67]
    buffer_load_dwordx4 v22, s[44:47], s21 offen offset:512 sc1 lds
    s_waitcnt lgkmcnt(0)
    v_mfma_f32_16x16x32_bf16 v[64:67], v[112:115], a[208:211], v[64:67]
    ds_read_b128 v[120:123], v14 offset:33792
    v_fma_f32 v175, v155, v97, -v96
    v_mfma_f32_16x16x32_bf16 v[64:67], v[116:119], a[216:219], v[64:67]
    ds_read_b128 v[124:127], v14 offset:37888
    v_fma_f32 v176, v156, v99, -v98
    v_mfma_f32_16x16x32_bf16 v[68:71], v[116:119], a[220:223], v[68:71]
    ds_read_b128 v[128:131], v14 offset:41984
    v_mfma_f32_16x16x32_bf16 v[68:71], v[112:115], a[212:215], v[68:71]
    ds_read_b128 v[132:135], v14 offset:46080
    v_fma_f32 v177, v157, v99, -v98
    v_mfma_f32_16x16x32_bf16 v[68:71], v[108:111], a[204:207], v[68:71]
    s_add_u32 m0, s73, 115712
    v_fma_f32 v178, v158, v99, -v98
    v_mfma_f32_16x16x32_bf16 v[68:71], v[104:107], a[196:199], v[68:71]
    buffer_load_dwordx4 v22, s[44:47], s22 offen offset:0 sc1 lds
    s_waitcnt lgkmcnt(2)
    v_mfma_f32_16x16x32_bf16 v[60:63], v[120:123], a[228:231], v[60:63]
    s_add_u32 m0, s73, 116224
    v_fma_f32 v179, v159, v99, -v98
    v_mfma_f32_16x16x32_bf16 v[60:63], v[124:127], a[236:239], v[60:63]
    buffer_load_dwordx4 v22, s[44:47], s22 offen offset:512 sc1 lds
    s_waitcnt lgkmcnt(0)
    v_mfma_f32_16x16x32_bf16 v[60:63], v[128:131], a[244:247], v[60:63]
    ds_read_b128 v[104:107], v14 offset:34816
    v_fma_f32 v180, v160, v101, -v100
    v_mfma_f32_16x16x32_bf16 v[60:63], v[132:135], a[252:255], v[60:63]
    ds_read_b128 v[108:111], v14 offset:38912
    v_fma_f32 v181, v161, v101, -v100
    v_mfma_f32_16x16x32_bf16 v[56:59], v[132:135], a[248:251], v[56:59]
    ds_read_b128 v[112:115], v14 offset:43008
    v_mfma_f32_16x16x32_bf16 v[56:59], v[128:131], a[240:243], v[56:59]
    ds_read_b128 v[116:119], v14 offset:47104
    v_fma_f32 v182, v162, v101, -v100
    v_mfma_f32_16x16x32_bf16 v[56:59], v[124:127], a[232:235], v[56:59]
    s_add_u32 m0, s73, 117760
    v_fma_f32 v183, v163, v101, -v100
    v_mfma_f32_16x16x32_bf16 v[56:59], v[120:123], a[224:227], v[56:59]
    buffer_load_dwordx4 v22, s[44:47], s23 offen offset:0 sc1 lds
    s_waitcnt lgkmcnt(2)
    v_mfma_f32_16x16x32_bf16 v[64:67], v[104:107], a[224:227], v[64:67]
    v_mfma_f32_16x16x32_bf16 v[64:67], v[108:111], a[232:235], v[64:67]
    s_waitcnt lgkmcnt(0)
    v_mfma_f32_16x16x32_bf16 v[64:67], v[112:115], a[240:243], v[64:67]
    ds_read_b128 v[120:123], v14 offset:35840
    v_mfma_f32_16x16x32_bf16 v[64:67], v[116:119], a[248:251], v[64:67]
    ds_read_b128 v[124:127], v14 offset:39936
    v_mfma_f32_16x16x32_bf16 v[68:71], v[116:119], a[252:255], v[68:71]
    ds_read_b128 v[128:131], v14 offset:44032
    v_mfma_f32_16x16x32_bf16 v[68:71], v[112:115], a[244:247], v[68:71]
    ds_read_b128 v[132:135], v14 offset:48128
    v_mfma_f32_16x16x32_bf16 v[68:71], v[108:111], a[236:239], v[68:71]
    v_mfma_f32_16x16x32_bf16 v[68:71], v[104:107], a[228:231], v[68:71]
    s_waitcnt lgkmcnt(2)
    v_mfma_f32_16x16x32_bf16 v[60:63], v[120:123], v[224:227], v[60:63]
    v_mfma_f32_16x16x32_bf16 v[60:63], v[124:127], v[232:235], v[60:63]
    s_waitcnt lgkmcnt(0)
    v_mfma_f32_16x16x32_bf16 v[60:63], v[128:131], v[240:243], v[60:63]
    s_waitcnt vmcnt(10)
    s_barrier
    v_mfma_f32_16x16x32_bf16 v[60:63], v[132:135], v[248:251], v[60:63]
    ds_read_b128 v[104:107], v14 offset:49152
    v_mfma_f32_16x16x32_bf16 v[56:59], v[132:135], v[244:247], v[56:59]
    ds_read_b128 v[108:111], v14 offset:53248
    v_mfma_f32_16x16x32_bf16 v[56:59], v[128:131], v[236:239], v[56:59]
    ds_read_b128 v[112:115], v14 offset:57344
    v_mfma_f32_16x16x32_bf16 v[56:59], v[124:127], v[228:231], v[56:59]
    ds_read_b128 v[116:119], v14 offset:61440
    v_mfma_f32_16x16x32_bf16 v[56:59], v[120:123], v[220:223], v[56:59]
    s_waitcnt lgkmcnt(2)
    v_mfma_f32_16x16x32_bf16 v[64:67], v[104:107], v[220:223], v[64:67]
    s_add_u32 m0, s73, 130560
    v_xor_b32 v186, s41, v10
    v_add_u32 v186, s43, v186
    v_mfma_f32_16x16x32_bf16 v[64:67], v[108:111], v[228:231], v[64:67]
    buffer_load_dwordx4 v22, s[44:47], s23 offen offset:512 sc1 lds
    ds_read_b64_tr_b16 v[12:13], v10 offset:16384
    s_waitcnt lgkmcnt(1)
    v_mfma_f32_16x16x32_bf16 v[64:67], v[112:115], v[236:239], v[64:67]
    ds_read_b128 v[120:123], v14 offset:50176
    v_mfma_f32_16x16x32_bf16 v[64:67], v[116:119], v[244:247], v[64:67]
    ds_read_b128 v[124:127], v14 offset:54272
    v_mfma_f32_16x16x32_bf16 v[68:71], v[116:119], v[248:251], v[68:71]
    ds_read_b128 v[128:131], v14 offset:58368
    ds_read_b64_tr_b16 v[24:25], v11 offset:16384
    v_mfma_f32_16x16x32_bf16 v[68:71], v[112:115], v[240:243], v[68:71]
    ds_read_b128 v[132:135], v14 offset:62464
    ds_read_b64_tr_b16 v[28:29], v10 offset:20480
    v_mfma_f32_16x16x32_bf16 v[68:71], v[108:111], v[232:235], v[68:71]
    s_add_u32 m0, s73, 132096
    ds_read_b64_tr_b16 v[190:191], v11 offset:20480
    v_mfma_f32_16x16x32_bf16 v[68:71], v[104:107], v[224:227], v[68:71]
    buffer_load_dwordx4 v22, s[44:47], s24 offen offset:0 sc1 lds
    ds_read_b64_tr_b16 v[142:143], v186 offset:18432
    s_waitcnt lgkmcnt(6)
    v_mfma_f32_16x16x32_bf16 v[76:79], v[120:123], a[4:7], v[76:79]
    s_add_u32 m0, s73, 132608
    s_waitcnt lgkmcnt(0)
    v_mfma_f32_16x16x32_bf16 v[76:79], v[124:127], a[12:15], v[76:79]
    buffer_load_dwordx4 v22, s[44:47], s24 offen offset:512 sc1 lds
    v_mfma_f32_16x16x32_bf16 v[76:79], v[128:131], a[20:23], v[76:79]
    ds_read_b128 v[104:107], v14 offset:51200
    v_and_b32 v9, 0xffff0000, v12
    v_mfma_f32_16x16x32_bf16 v[76:79], v[132:135], a[28:31], v[76:79]
    ds_read_b128 v[108:111], v14 offset:55296
    v_mfma_f32_16x16x32_bf16 v[72:75], v[132:135], a[24:27], v[72:75]
    ds_read_b128 v[112:115], v14 offset:59392
    v_lshlrev_b32 v8, 16, v12
    v_mfma_f32_16x16x32_bf16 v[72:75], v[128:131], a[16:19], v[72:75]
    ds_read_b128 v[116:119], v14 offset:63488
    v_cvt_pk_bf16_f32 v192, v56, v57
    v_mfma_f32_16x16x32_bf16 v[72:75], v[124:127], a[8:11], v[72:75]
    s_add_u32 m0, s73, 134144
    v_mul_f32 v165, v165, v9
    v_mfma_f32_16x16x32_bf16 v[72:75], v[120:123], a[0:3], v[72:75]
    buffer_load_dwordx4 v22, s[44:47], s25 offen offset:0 sc1 lds
    s_waitcnt lgkmcnt(2)
    v_mfma_f32_16x16x32_bf16 v[80:83], v[104:107], a[0:3], v[80:83]
    v_cvt_pk_bf16_f32 v193, v58, v59
    v_mul_f32 v164, v164, v8
    v_mfma_f32_16x16x32_bf16 v[80:83], v[108:111], a[8:11], v[80:83]
    v_and_b32 v31, 0xffff0000, v13
    s_waitcnt lgkmcnt(0)
    v_mfma_f32_16x16x32_bf16 v[80:83], v[112:115], a[16:19], v[80:83]
    ds_read_b128 v[120:123], v14 offset:52224
    v_lshlrev_b32 v30, 16, v13
    v_mfma_f32_16x16x32_bf16 v[80:83], v[116:119], a[24:27], v[80:83]
    ds_read_b128 v[124:127], v14 offset:56320
    v_cvt_pk_bf16_f32 v194, v60, v61
    v_mfma_f32_16x16x32_bf16 v[84:87], v[116:119], a[28:31], v[84:87]
    ds_read_b128 v[128:131], v14 offset:60416
    v_mfma_f32_16x16x32_bf16 v[84:87], v[112:115], a[20:23], v[84:87]
    ds_read_b128 v[132:135], v14 offset:64512
    v_mul_f32 v167, v167, v31
    v_mfma_f32_16x16x32_bf16 v[84:87], v[108:111], a[12:15], v[84:87]
    buffer_store_dwordx4 v[192:195], v136, s[44:47], s15 offen offset:0 sc1
    v_mul_f32 v166, v166, v30
    v_mfma_f32_16x16x32_bf16 v[84:87], v[104:107], a[4:7], v[84:87]
    s_waitcnt lgkmcnt(2)
    v_mfma_f32_16x16x32_bf16 v[76:79], v[120:123], a[36:39], v[76:79]
    v_and_b32 v9, 0xffff0000, v24
    v_mfma_f32_16x16x32_bf16 v[76:79], v[124:127], a[44:47], v[76:79]
    v_cvt_pk_bf16_f32 v196, v62, v63
    s_waitcnt lgkmcnt(0)
    v_mfma_f32_16x16x32_bf16 v[76:79], v[128:131], a[52:55], v[76:79]
    s_waitcnt vmcnt(9)
    s_barrier
    v_lshlrev_b32 v8, 16, v24
    v_mfma_f32_16x16x32_bf16 v[76:79], v[132:135], a[60:63], v[76:79]
    ds_read_b128 v[104:107], v14 offset:0
    v_mul_f32 v169, v169, v9
    v_mfma_f32_16x16x32_bf16 v[72:75], v[132:135], a[56:59], v[72:75]
    ds_read_b128 v[108:111], v14 offset:4096
    v_cvt_pk_bf16_f32 v197, v64, v65
    v_mfma_f32_16x16x32_bf16 v[72:75], v[128:131], a[48:51], v[72:75]
    ds_read_b128 v[112:115], v14 offset:8192
    v_mul_f32 v168, v168, v8
    v_mfma_f32_16x16x32_bf16 v[72:75], v[124:127], a[40:43], v[72:75]
    ds_read_b128 v[116:119], v14 offset:12288
    v_mfma_f32_16x16x32_bf16 v[72:75], v[120:123], a[32:35], v[72:75]
    v_cvt_pk_bf16_f32 v198, v66, v67
    s_waitcnt lgkmcnt(2)
    v_mfma_f32_16x16x32_bf16 v[80:83], v[104:107], a[32:35], v[80:83]
    s_add_u32 m0, s73, 146944
    v_and_b32 v31, 0xffff0000, v25
    v_lshlrev_b32 v30, 16, v25
    v_mfma_f32_16x16x32_bf16 v[80:83], v[108:111], a[40:43], v[80:83]
    buffer_load_dwordx4 v22, s[44:47], s25 offen offset:512 sc1 lds
    s_waitcnt lgkmcnt(0)
    v_mfma_f32_16x16x32_bf16 v[80:83], v[112:115], a[48:51], v[80:83]
    buffer_store_dwordx4 v[196:199], v136, s[44:47], s15 offen offset:1024 sc1
    ds_read_b128 v[120:123], v14 offset:1024
    v_mfma_f32_16x16x32_bf16 v[80:83], v[116:119], a[56:59], v[80:83]
    ds_read_b128 v[124:127], v14 offset:5120
    v_mul_f32 v171, v171, v31
    v_mfma_f32_16x16x32_bf16 v[84:87], v[116:119], a[60:63], v[84:87]
    ds_read_b128 v[128:131], v14 offset:9216
    v_mul_f32 v170, v170, v30
    v_mfma_f32_16x16x32_bf16 v[84:87], v[112:115], a[52:55], v[84:87]
    ds_read_b128 v[132:135], v14 offset:13312
    v_mfma_f32_16x16x32_bf16 v[84:87], v[108:111], a[44:47], v[84:87]
    s_add_u32 m0, s73, 148480
    v_cvt_pk_bf16_f32 v200, v68, v69
    v_and_b32 v9, 0xffff0000, v28
    v_mfma_f32_16x16x32_bf16 v[84:87], v[104:107], a[36:39], v[84:87]
    buffer_load_dwordx4 v22, s[44:47], s26 offen offset:0 sc1 lds
    s_waitcnt lgkmcnt(2)
    v_mfma_f32_16x16x32_bf16 v[76:79], v[120:123], a[68:71], v[76:79]
    s_add_u32 m0, s73, 148992
    v_lshlrev_b32 v8, 16, v28
    v_mfma_f32_16x16x32_bf16 v[76:79], v[124:127], a[76:79], v[76:79]
    buffer_load_dwordx4 v22, s[44:47], s26 offen offset:512 sc1 lds
    s_waitcnt lgkmcnt(0)
    v_mfma_f32_16x16x32_bf16 v[76:79], v[128:131], a[84:87], v[76:79]
    ds_read_b128 v[104:107], v14 offset:2048
    v_cvt_pk_bf16_f32 v201, v70, v71
    v_mfma_f32_16x16x32_bf16 v[76:79], v[132:135], a[92:95], v[76:79]
    ds_read_b128 v[108:111], v14 offset:6144
    v_mul_f32 v173, v173, v9
    v_mfma_f32_16x16x32_bf16 v[72:75], v[132:135], a[88:91], v[72:75]
    ds_read_b128 v[112:115], v14 offset:10240
    v_mul_f32 v172, v172, v8
    v_mfma_f32_16x16x32_bf16 v[72:75], v[128:131], a[80:83], v[72:75]
    ds_read_b128 v[116:119], v14 offset:14336
    v_and_b32 v31, 0xffff0000, v29
    v_mfma_f32_16x16x32_bf16 v[72:75], v[124:127], a[72:75], v[72:75]
    buffer_store_dwordx4 v[200:203], v136, s[44:47], s15 offen offset:2048 sc1
    s_add_u32 m0, s73, 150528
    v_mfma_f32_16x16x32_bf16 v[72:75], v[120:123], a[64:67], v[72:75]
    buffer_load_dwordx4 v19, s[44:47], s18 offen offset:0 sc1 lds
    s_waitcnt lgkmcnt(2)
    v_mfma_f32_16x16x32_bf16 v[80:83], v[104:107], a[64:67], v[80:83]
    v_lshlrev_b32 v30, 16, v29
    v_mul_f32 v175, v175, v31
    v_mfma_f32_16x16x32_bf16 v[80:83], v[108:111], a[72:75], v[80:83]
    buffer_load_dwordx4 v[40:43], v136, s[44:47], s34 offen offset:0 sc1
    s_waitcnt lgkmcnt(0)
    v_mfma_f32_16x16x32_bf16 v[80:83], v[112:115], a[80:83], v[80:83]
    ds_read_b128 v[120:123], v14 offset:3072
    v_mfma_f32_16x16x32_bf16 v[80:83], v[116:119], a[88:91], v[80:83]
    ds_read_b128 v[124:127], v14 offset:7168
    v_mul_f32 v174, v174, v30
    v_mfma_f32_16x16x32_bf16 v[84:87], v[116:119], a[92:95], v[84:87]
    ds_read_b128 v[128:131], v14 offset:11264
    v_and_b32 v9, 0xffff0000, v190
    v_mfma_f32_16x16x32_bf16 v[84:87], v[112:115], a[84:87], v[84:87]
    ds_read_b128 v[132:135], v14 offset:15360
    buffer_load_dwordx4 v[44:47], v136, s[44:47], s34 offen offset:1024 sc1
    v_mfma_f32_16x16x32_bf16 v[84:87], v[108:111], a[76:79], v[84:87]
    v_lshlrev_b32 v8, 16, v190
    v_mfma_f32_16x16x32_bf16 v[84:87], v[104:107], a[68:71], v[84:87]
    s_waitcnt lgkmcnt(2)
    v_mfma_f32_16x16x32_bf16 v[76:79], v[120:123], a[100:103], v[76:79]
    buffer_load_dwordx4 v[48:51], v136, s[44:47], s34 offen offset:2048 sc1
    v_mul_f32 v177, v177, v9
    v_mfma_f32_16x16x32_bf16 v[76:79], v[124:127], a[108:111], v[76:79]
    s_waitcnt lgkmcnt(0)
    v_mfma_f32_16x16x32_bf16 v[76:79], v[128:131], a[116:119], v[76:79]
    s_waitcnt vmcnt(14)
    s_barrier
    v_mul_f32 v176, v176, v8
    v_mfma_f32_16x16x32_bf16 v[76:79], v[132:135], a[124:127], v[76:79]
    ds_read_b128 v[104:107], v14 offset:16384
    v_and_b32 v31, 0xffff0000, v191
    v_mfma_f32_16x16x32_bf16 v[72:75], v[132:135], a[120:123], v[72:75]
    ds_read_b128 v[108:111], v14 offset:20480
    buffer_load_dwordx4 v[204:207], v136, s[44:47], s35 offen offset:0 sc1
    v_mfma_f32_16x16x32_bf16 v[72:75], v[128:131], a[112:115], v[72:75]
    ds_read_b128 v[112:115], v14 offset:24576
    v_lshlrev_b32 v30, 16, v191
    v_mfma_f32_16x16x32_bf16 v[72:75], v[124:127], a[104:107], v[72:75]
    ds_read_b128 v[116:119], v14 offset:28672
    v_mul_f32 v179, v179, v31
    v_mfma_f32_16x16x32_bf16 v[72:75], v[120:123], a[96:99], v[72:75]
    buffer_load_dwordx4 v[208:211], v136, s[44:47], s35 offen offset:1024 sc1
    s_waitcnt lgkmcnt(2)
    v_mfma_f32_16x16x32_bf16 v[80:83], v[104:107], a[96:99], v[80:83]
    v_mfma_f32_16x16x32_bf16 v[80:83], v[108:111], a[104:107], v[80:83]
    v_mul_f32 v178, v178, v30
    s_waitcnt lgkmcnt(0)
    v_mfma_f32_16x16x32_bf16 v[80:83], v[112:115], a[112:115], v[80:83]
    ds_read_b128 v[120:123], v14 offset:17408
    buffer_load_dwordx4 v[212:215], v136, s[44:47], s35 offen offset:2048 sc1
    v_mfma_f32_16x16x32_bf16 v[80:83], v[116:119], a[120:123], v[80:83]
    ds_read_b128 v[124:127], v14 offset:21504
    v_and_b32 v9, 0xffff0000, v142
    v_mfma_f32_16x16x32_bf16 v[84:87], v[116:119], a[124:127], v[84:87]
    ds_read_b128 v[128:131], v14 offset:25600
    v_lshlrev_b32 v8, 16, v142
    v_mfma_f32_16x16x32_bf16 v[84:87], v[112:115], a[116:119], v[84:87]
    ds_read_b128 v[132:135], v14 offset:29696
    v_mfma_f32_16x16x32_bf16 v[84:87], v[108:111], a[108:111], v[84:87]
    buffer_load_dwordx4 v[216:219], v136, s[44:47], s35 offen offset:3072 sc1
    v_mul_f32 v181, v181, v9
    v_mfma_f32_16x16x32_bf16 v[84:87], v[104:107], a[100:103], v[84:87]
    s_waitcnt lgkmcnt(2)
    v_mfma_f32_16x16x32_bf16 v[76:79], v[120:123], a[132:135], v[76:79]
    v_mul_f32 v180, v180, v8
    v_mfma_f32_16x16x32_bf16 v[76:79], v[124:127], a[140:143], v[76:79]
    v_and_b32 v31, 0xffff0000, v143
    s_waitcnt lgkmcnt(0)
    v_mfma_f32_16x16x32_bf16 v[76:79], v[128:131], a[148:151], v[76:79]
    ds_read_b128 v[104:107], v14 offset:18432
    v_mfma_f32_16x16x32_bf16 v[76:79], v[132:135], a[156:159], v[76:79]
    ds_read_b128 v[108:111], v14 offset:22528
    v_lshlrev_b32 v30, 16, v143
    v_mfma_f32_16x16x32_bf16 v[72:75], v[132:135], a[152:155], v[72:75]
    ds_read_b128 v[112:115], v14 offset:26624
    v_mfma_f32_16x16x32_bf16 v[72:75], v[128:131], a[144:147], v[72:75]
    ds_read_b128 v[116:119], v14 offset:30720
    v_mul_f32 v183, v183, v31
    v_mfma_f32_16x16x32_bf16 v[72:75], v[124:127], a[136:139], v[72:75]
    v_mfma_f32_16x16x32_bf16 v[72:75], v[120:123], a[128:131], v[72:75]
    v_mul_f32 v182, v182, v30
    s_waitcnt lgkmcnt(2)
    v_mfma_f32_16x16x32_bf16 v[80:83], v[104:107], a[128:131], v[80:83]
    v_mfma_f32_16x16x32_bf16 v[80:83], v[108:111], a[136:139], v[80:83]
    s_waitcnt lgkmcnt(0)
    v_mfma_f32_16x16x32_bf16 v[80:83], v[112:115], a[144:147], v[80:83]
    ds_read_b128 v[120:123], v14 offset:19456
    v_mfma_f32_16x16x32_bf16 v[80:83], v[116:119], a[152:155], v[80:83]
    ds_read_b128 v[124:127], v14 offset:23552
    v_mfma_f32_16x16x32_bf16 v[84:87], v[116:119], a[156:159], v[84:87]
    ds_read_b128 v[128:131], v14 offset:27648
    v_mfma_f32_16x16x32_bf16 v[84:87], v[112:115], a[148:151], v[84:87]
    ds_read_b128 v[132:135], v14 offset:31744
    v_mfma_f32_16x16x32_bf16 v[84:87], v[108:111], a[140:143], v[84:87]
    v_mfma_f32_16x16x32_bf16 v[84:87], v[104:107], a[132:135], v[84:87]
    s_waitcnt lgkmcnt(2)
    v_mfma_f32_16x16x32_bf16 v[76:79], v[120:123], a[164:167], v[76:79]
    s_add_u32 m0, s73, 97792
    v_mfma_f32_16x16x32_bf16 v[76:79], v[124:127], a[172:175], v[76:79]
    buffer_load_dwordx4 v19, s[44:47], s18 offen offset:512 sc1 lds
    s_waitcnt lgkmcnt(0)
    v_mfma_f32_16x16x32_bf16 v[76:79], v[128:131], a[180:183], v[76:79]
    s_waitcnt vmcnt(15)
    s_barrier
    v_mfma_f32_16x16x32_bf16 v[76:79], v[132:135], a[188:191], v[76:79]
    ds_read_b128 v[104:107], v14 offset:32768
    v_mfma_f32_16x16x32_bf16 v[72:75], v[132:135], a[184:187], v[72:75]
    ds_read_b128 v[108:111], v14 offset:36864
    v_mfma_f32_16x16x32_bf16 v[72:75], v[128:131], a[176:179], v[72:75]
    ds_read_b128 v[112:115], v14 offset:40960
    v_mfma_f32_16x16x32_bf16 v[72:75], v[124:127], a[168:171], v[72:75]
    ds_read_b128 v[116:119], v14 offset:45056
    s_add_u32 m0, s73, 99328
    v_mfma_f32_16x16x32_bf16 v[72:75], v[120:123], a[160:163], v[72:75]
    buffer_load_dwordx4 v19, s[44:47], s19 offen offset:0 sc1 lds
    s_waitcnt lgkmcnt(2)
    v_mfma_f32_16x16x32_bf16 v[80:83], v[104:107], a[160:163], v[80:83]
    s_add_u32 m0, s73, 99840
    v_mfma_f32_16x16x32_bf16 v[80:83], v[108:111], a[168:171], v[80:83]
    buffer_load_dwordx4 v19, s[44:47], s19 offen offset:512 sc1 lds
    s_waitcnt lgkmcnt(0)
    v_mfma_f32_16x16x32_bf16 v[80:83], v[112:115], a[176:179], v[80:83]
    ds_read_b128 v[120:123], v14 offset:33792
    v_mfma_f32_16x16x32_bf16 v[80:83], v[116:119], a[184:187], v[80:83]
    ds_read_b128 v[124:127], v14 offset:37888
    v_mfma_f32_16x16x32_bf16 v[84:87], v[116:119], a[188:191], v[84:87]
    ds_read_b128 v[128:131], v14 offset:41984
    v_mfma_f32_16x16x32_bf16 v[84:87], v[112:115], a[180:183], v[84:87]
    ds_read_b128 v[132:135], v14 offset:46080
    v_mfma_f32_16x16x32_bf16 v[84:87], v[108:111], a[172:175], v[84:87]
    s_add_u32 m0, s73, 101376
    v_mfma_f32_16x16x32_bf16 v[84:87], v[104:107], a[164:167], v[84:87]
    buffer_load_dwordx4 v19, s[44:47], s20 offen offset:0 sc1 lds
    s_waitcnt lgkmcnt(2)
    v_mfma_f32_16x16x32_bf16 v[76:79], v[120:123], a[196:199], v[76:79]
    s_add_u32 m0, s73, 114176
    v_mov_b32 v141, 0
    v_mfma_f32_16x16x32_bf16 v[76:79], v[124:127], a[204:207], v[76:79]
    buffer_load_dwordx4 v19, s[44:47], s20 offen offset:512 sc1 lds
    s_waitcnt lgkmcnt(0)
    v_mfma_f32_16x16x32_bf16 v[76:79], v[128:131], a[212:215], v[76:79]
    ds_read_b128 v[104:107], v14 offset:34816
    v_mfma_f32_16x16x32_bf16 v[76:79], v[132:135], a[220:223], v[76:79]
    ds_read_b128 v[108:111], v14 offset:38912
    buffer_atomic_add v141, v139, s[44:47], s11 offen offset:2060 sc0 sc1
    v_mfma_f32_16x16x32_bf16 v[72:75], v[132:135], a[216:219], v[72:75]
    ds_read_b128 v[112:115], v14 offset:43008
    v_mfma_f32_16x16x32_bf16 v[72:75], v[128:131], a[208:211], v[72:75]
    ds_read_b128 v[116:119], v14 offset:47104
    v_mfma_f32_16x16x32_bf16 v[72:75], v[124:127], a[200:203], v[72:75]
    s_add_u32 m0, s73, 115712
    v_mfma_f32_16x16x32_bf16 v[72:75], v[120:123], a[192:195], v[72:75]
    buffer_load_dwordx4 v19, s[44:47], s21 offen offset:0 sc1 lds
    s_waitcnt lgkmcnt(2)
    v_mfma_f32_16x16x32_bf16 v[80:83], v[104:107], a[192:195], v[80:83]
    s_add_u32 m0, s73, 116224
    v_mfma_f32_16x16x32_bf16 v[80:83], v[108:111], a[200:203], v[80:83]
    buffer_load_dwordx4 v19, s[44:47], s21 offen offset:512 sc1 lds
    s_waitcnt lgkmcnt(0)
    v_mfma_f32_16x16x32_bf16 v[80:83], v[112:115], a[208:211], v[80:83]
    ds_read_b128 v[120:123], v14 offset:35840
    v_mfma_f32_16x16x32_bf16 v[80:83], v[116:119], a[216:219], v[80:83]
    ds_read_b128 v[124:127], v14 offset:39936
    v_mfma_f32_16x16x32_bf16 v[84:87], v[116:119], a[220:223], v[84:87]
    ds_read_b128 v[128:131], v14 offset:44032
    v_mfma_f32_16x16x32_bf16 v[84:87], v[112:115], a[212:215], v[84:87]
    ds_read_b128 v[132:135], v14 offset:48128
    v_mfma_f32_16x16x32_bf16 v[84:87], v[108:111], a[204:207], v[84:87]
    s_add_u32 m0, s73, 117760
    v_mfma_f32_16x16x32_bf16 v[84:87], v[104:107], a[196:199], v[84:87]
    buffer_load_dwordx4 v19, s[44:47], s22 offen offset:0 sc1 lds
    s_waitcnt lgkmcnt(2)
    v_mfma_f32_16x16x32_bf16 v[76:79], v[120:123], a[228:231], v[76:79]
    v_mfma_f32_16x16x32_bf16 v[76:79], v[124:127], a[236:239], v[76:79]
    s_waitcnt lgkmcnt(0)
    v_mfma_f32_16x16x32_bf16 v[76:79], v[128:131], a[244:247], v[76:79]
    s_waitcnt vmcnt(16)
    s_barrier
    v_mfma_f32_16x16x32_bf16 v[76:79], v[132:135], a[252:255], v[76:79]
    ds_read_b128 v[104:107], v14 offset:49152
    v_mfma_f32_16x16x32_bf16 v[72:75], v[132:135], a[248:251], v[72:75]
    ds_read_b128 v[108:111], v14 offset:53248
    v_mfma_f32_16x16x32_bf16 v[72:75], v[128:131], a[240:243], v[72:75]
    ds_read_b128 v[112:115], v14 offset:57344
    v_mfma_f32_16x16x32_bf16 v[72:75], v[124:127], a[232:235], v[72:75]
    ds_read_b128 v[116:119], v14 offset:61440
    v_mfma_f32_16x16x32_bf16 v[72:75], v[120:123], a[224:227], v[72:75]
    s_waitcnt lgkmcnt(2)
    v_mfma_f32_16x16x32_bf16 v[80:83], v[104:107], a[224:227], v[80:83]
    s_add_u32 m0, s73, 130560
    v_mfma_f32_16x16x32_bf16 v[80:83], v[108:111], a[232:235], v[80:83]
    buffer_load_dwordx4 v19, s[44:47], s22 offen offset:512 sc1 lds
    s_waitcnt lgkmcnt(0)
    v_mfma_f32_16x16x32_bf16 v[80:83], v[112:115], a[240:243], v[80:83]
    ds_read_b128 v[120:123], v14 offset:50176
    v_mfma_f32_16x16x32_bf16 v[80:83], v[116:119], a[248:251], v[80:83]
    ds_read_b128 v[124:127], v14 offset:54272
    v_mfma_f32_16x16x32_bf16 v[84:87], v[116:119], a[252:255], v[84:87]
    ds_read_b128 v[128:131], v14 offset:58368
    v_mfma_f32_16x16x32_bf16 v[84:87], v[112:115], a[244:247], v[84:87]
    ds_read_b128 v[132:135], v14 offset:62464
    v_mfma_f32_16x16x32_bf16 v[84:87], v[108:111], a[236:239], v[84:87]
    s_add_u32 m0, s73, 132096
    v_mfma_f32_16x16x32_bf16 v[84:87], v[104:107], a[228:231], v[84:87]
    buffer_load_dwordx4 v19, s[44:47], s23 offen offset:0 sc1 lds
    s_waitcnt lgkmcnt(2)
    v_mfma_f32_16x16x32_bf16 v[76:79], v[120:123], v[224:227], v[76:79]
    s_add_u32 m0, s73, 132608
    s_waitcnt vmcnt(15)
    v_bitop3_b32 v43, v43, v47, s68 bitop3:0x7e
    v_bitop3_b32 v43, v43, v51, s68 bitop3:0xf6
    v_cmp_ne_u32 vcc, 0, v43
    v_mfma_f32_16x16x32_bf16 v[76:79], v[124:127], v[232:235], v[76:79]
    buffer_load_dwordx4 v19, s[44:47], s23 offen offset:512 sc1 lds
    s_waitcnt lgkmcnt(0)
    v_mfma_f32_16x16x32_bf16 v[76:79], v[128:131], v[240:243], v[76:79]
    ds_read_b128 v[104:107], v14 offset:51200
    s_cbranch_vccnz L_xs_a
L_xo_a:
    v_and_b32 v89, 0xffff0000, v40
    v_mfma_f32_16x16x32_bf16 v[76:79], v[132:135], v[248:251], v[76:79]
    ds_read_b128 v[108:111], v14 offset:55296
    v_lshlrev_b32 v88, 16, v40
    v_mfma_f32_16x16x32_bf16 v[72:75], v[132:135], v[244:247], v[72:75]
    ds_read_b128 v[112:115], v14 offset:59392
    v_and_b32 v91, 0xffff0000, v41
    v_mfma_f32_16x16x32_bf16 v[72:75], v[128:131], v[236:239], v[72:75]
    ds_read_b128 v[116:119], v14 offset:63488
    v_lshlrev_b32 v90, 16, v41
    v_mfma_f32_16x16x32_bf16 v[72:75], v[124:127], v[228:231], v[72:75]
    s_add_u32 m0, s73, 134144
    v_and_b32 v93, 0xffff0000, v42
    v_lshlrev_b32 v92, 16, v42
    v_mfma_f32_16x16x32_bf16 v[72:75], v[120:123], v[220:223], v[72:75]
    buffer_load_dwordx4 v19, s[44:47], s24 offen offset:0 sc1 lds
    s_waitcnt lgkmcnt(2)
    v_mfma_f32_16x16x32_bf16 v[80:83], v[104:107], v[220:223], v[80:83]
    v_and_b32 v95, 0xffff0000, v44
    v_lshlrev_b32 v94, 16, v44
    v_mfma_f32_16x16x32_bf16 v[80:83], v[108:111], v[228:231], v[80:83]
    v_and_b32 v97, 0xffff0000, v45
    s_waitcnt lgkmcnt(0)
    v_mfma_f32_16x16x32_bf16 v[80:83], v[112:115], v[236:239], v[80:83]
    ds_read_b128 v[120:123], v14 offset:52224
    v_lshlrev_b32 v96, 16, v45
    v_mfma_f32_16x16x32_bf16 v[80:83], v[116:119], v[244:247], v[80:83]
    ds_read_b128 v[124:127], v14 offset:56320
    v_and_b32 v99, 0xffff0000, v46
    v_lshlrev_b32 v98, 16, v46
    v_mfma_f32_16x16x32_bf16 v[84:87], v[116:119], v[248:251], v[84:87]
    ds_read_b128 v[128:131], v14 offset:60416
    s_waitcnt vmcnt(7)
    v_and_b32 v101, 0xffff0000, v48
    v_mfma_f32_16x16x32_bf16 v[84:87], v[112:115], v[240:243], v[84:87]
    ds_read_b128 v[132:135], v14 offset:64512
    v_lshlrev_b32 v100, 16, v48
    v_cmp_ne_u32 vcc, v140, v141
    v_mfma_f32_16x16x32_bf16 v[84:87], v[108:111], v[232:235], v[84:87]
L_pl_D_2:
    s_cbranch_execz L_wret
    v_and_b32 v103, 0xffff0000, v49
    v_lshlrev_b32 v102, 16, v49
    v_mfma_f32_16x16x32_bf16 v[84:87], v[104:107], v[224:227], v[84:87]
    s_cbranch_vccnz L_as_b
L_ao_b:
    s_waitcnt lgkmcnt(2)
    v_mfma_f32_16x16x32_bf16 v[92:95], v[120:123], a[4:7], v[92:95]
    buffer_load_dwordx4 v[56:59], v136, s[44:47], s11 offen offset:0 sc1
    v_mfma_f32_16x16x32_bf16 v[92:95], v[124:127], a[12:15], v[92:95]
    s_waitcnt lgkmcnt(0)
    v_mfma_f32_16x16x32_bf16 v[92:95], v[128:131], a[20:23], v[92:95]
    buffer_load_dwordx4 v[60:63], v136, s[44:47], s11 offen offset:1024 sc1
    s_barrier
    v_mfma_f32_16x16x32_bf16 v[92:95], v[132:135], a[28:31], v[92:95]
    ds_read_b128 v[104:107], v14 offset:0
    buffer_load_dwordx4 v[64:67], v136, s[44:47], s11 offen offset:2048 sc1
    v_mfma_f32_16x16x32_bf16 v[88:91], v[132:135], a[24:27], v[88:91]
    ds_read_b128 v[108:111], v14 offset:4096
    v_cvt_pk_bf16_f32 v192, v72, v73
    v_mfma_f32_16x16x32_bf16 v[88:91], v[128:131], a[16:19], v[88:91]
    ds_read_b128 v[112:115], v14 offset:8192
    v_cvt_pk_bf16_f32 v193, v74, v75
    v_mfma_f32_16x16x32_bf16 v[88:91], v[124:127], a[8:11], v[88:91]
    ds_read_b128 v[116:119], v14 offset:12288
    v_cvt_pk_bf16_f32 v194, v76, v77
    v_mfma_f32_16x16x32_bf16 v[88:91], v[120:123], a[0:3], v[88:91]
    buffer_store_dwordx4 v[192:195], v136, s[44:47], s31 offen offset:0 sc1
    s_waitcnt lgkmcnt(2)
    v_mfma_f32_16x16x32_bf16 v[96:99], v[104:107], a[0:3], v[96:99]
    s_add_u32 m0, s73, 146944
    v_cvt_pk_bf16_f32 v196, v78, v79
    v_cvt_pk_bf16_f32 v197, v80, v81
    v_mfma_f32_16x16x32_bf16 v[96:99], v[108:111], a[8:11], v[96:99]
    buffer_load_dwordx4 v19, s[44:47], s24 offen offset:512 sc1 lds
    s_waitcnt lgkmcnt(0)
    v_mfma_f32_16x16x32_bf16 v[96:99], v[112:115], a[16:19], v[96:99]
    ds_read_b128 v[120:123], v14 offset:1024
    v_cvt_pk_bf16_f32 v198, v82, v83
    v_mfma_f32_16x16x32_bf16 v[96:99], v[116:119], a[24:27], v[96:99]
    buffer_store_dwordx4 v[196:199], v136, s[44:47], s31 offen offset:1024 sc1
    ds_read_b128 v[124:127], v14 offset:5120
    v_bitop3_b32 v207, v207, v211, s36 bitop3:0x7e
    v_bitop3_b32 v207, v207, v215, s36 bitop3:0xf6
    v_mfma_f32_16x16x32_bf16 v[100:103], v[116:119], a[28:31], v[100:103]
    ds_read_b128 v[128:131], v14 offset:9216
    v_cvt_pk_bf16_f32 v200, v84, v85
    v_mfma_f32_16x16x32_bf16 v[100:103], v[112:115], a[20:23], v[100:103]
    ds_read_b128 v[132:135], v14 offset:13312
    v_cvt_pk_bf16_f32 v201, v86, v87
    v_mfma_f32_16x16x32_bf16 v[100:103], v[108:111], a[12:15], v[100:103]
    buffer_store_dwordx4 v[200:203], v136, s[44:47], s31 offen offset:2048 sc1
    s_add_u32 m0, s73, 148480
    v_bitop3_b32 v207, v207, v219, s36 bitop3:0xf6
    v_cmp_ne_u32 vcc, 0, v207
    v_mfma_f32_16x16x32_bf16 v[100:103], v[104:107], a[4:7], v[100:103]
    buffer_load_dwordx4 v19, s[44:47], s25 offen offset:0 sc1 lds
    s_waitcnt lgkmcnt(2)
    v_mfma_f32_16x16x32_bf16 v[92:95], v[120:123], a[36:39], v[92:95]
    s_add_u32 m0, s73, 148992
    s_cbranch_vccnz L_xs_8
L_xo_8:
    v_mfma_f32_16x16x32_bf16 v[92:95], v[124:127], a[44:47], v[92:95]
    buffer_load_dwordx4 v19, s[44:47], s25 offen offset:512 sc1 lds
    s_waitcnt lgkmcnt(0)
    v_mfma_f32_16x16x32_bf16 v[92:95], v[128:131], a[52:55], v[92:95]
    ds_read_b128 v[104:107], v14 offset:2048
    v_and_b32 v33, 0xffff0000, v204
    v_mfma_f32_16x16x32_bf16 v[92:95], v[132:135], a[60:63], v[92:95]
    ds_read_b128 v[108:111], v14 offset:6144
    v_lshlrev_b32 v32, 16, v204
    v_mfma_f32_16x16x32_bf16 v[88:91], v[132:135], a[56:59], v[88:91]
    ds_read_b128 v[112:115], v14 offset:10240
    v_and_b32 v35, 0xffff0000, v205
    v_mfma_f32_16x16x32_bf16 v[88:91], v[128:131], a[48:51], v[88:91]
    ds_read_b128 v[116:119], v14 offset:14336
    v_mfma_f32_16x16x32_bf16 v[88:91], v[124:127], a[40:43], v[88:91]
    s_add_u32 m0, s73, 150528
    v_lshlrev_b32 v34, 16, v205
    v_mfma_f32_16x16x32_bf16 v[88:91], v[120:123], a[32:35], v[88:91]
    buffer_load_dwordx4 v19, s[44:47], s26 offen offset:0 sc1 lds
    s_waitcnt lgkmcnt(2)
    v_mfma_f32_16x16x32_bf16 v[96:99], v[104:107], a[32:35], v[96:99]
    v_add_f32 v32, v32, v27
    v_mfma_f32_16x16x32_bf16 v[96:99], v[108:111], a[40:43], v[96:99]
    v_add_f32 v33, v33, v27
    s_waitcnt lgkmcnt(0)
    v_mfma_f32_16x16x32_bf16 v[96:99], v[112:115], a[48:51], v[96:99]
    ds_read_b128 v[120:123], v14 offset:3072
    v_add_f32 v34, v34, v27
    v_mfma_f32_16x16x32_bf16 v[96:99], v[116:119], a[56:59], v[96:99]
    ds_read_b128 v[124:127], v14 offset:7168
    v_mfma_f32_16x16x32_bf16 v[100:103], v[116:119], a[60:63], v[100:103]
    ds_read_b128 v[128:131], v14 offset:11264
    v_add_f32 v35, v35, v27
    v_mfma_f32_16x16x32_bf16 v[100:103], v[112:115], a[52:55], v[100:103]
    ds_read_b128 v[132:135], v14 offset:15360
    v_and_b32 v37, 0xffff0000, v208
    v_mfma_f32_16x16x32_bf16 v[100:103], v[108:111], a[44:47], v[100:103]
    v_mfma_f32_16x16x32_bf16 v[100:103], v[104:107], a[36:39], v[100:103]
    v_lshlrev_b32 v36, 16, v208
    s_waitcnt lgkmcnt(2)
    v_mfma_f32_16x16x32_bf16 v[92:95], v[120:123], a[68:71], v[92:95]
    v_and_b32 v39, 0xffff0000, v209
    v_mfma_f32_16x16x32_bf16 v[92:95], v[124:127], a[76:79], v[92:95]
    s_waitcnt lgkmcnt(0)
    v_mfma_f32_16x16x32_bf16 v[92:95], v[128:131], a[84:87], v[92:95]
    s_waitcnt vmcnt(14)
    s_barrier
    v_lshlrev_b32 v38, 16, v209
    v_mfma_f32_16x16x32_bf16 v[92:95], v[132:135], a[92:95], v[92:95]
    ds_read_b128 v[104:107], v14 offset:16384
    v_add_f32 v32, v32, v36
    v_mfma_f32_16x16x32_bf16 v[88:91], v[132:135], a[88:91], v[88:91]
    ds_read_b128 v[108:111], v14 offset:20480
    v_mfma_f32_16x16x32_bf16 v[88:91], v[128:131], a[80:83], v[88:91]
    ds_read_b128 v[112:115], v14 offset:24576
    v_add_f32 v33, v33, v37
    v_mfma_f32_16x16x32_bf16 v[88:91], v[124:127], a[72:75], v[88:91]
    ds_read_b128 v[116:119], v14 offset:28672
    v_add_f32 v34, v34, v38
    v_mfma_f32_16x16x32_bf16 v[88:91], v[120:123], a[64:67], v[88:91]
    s_waitcnt lgkmcnt(2)
    v_mfma_f32_16x16x32_bf16 v[96:99], v[104:107], a[64:67], v[96:99]
    s_add_u32 m0, s73, 97792
    v_add_f32 v35, v35, v39
    v_mfma_f32_16x16x32_bf16 v[96:99], v[108:111], a[72:75], v[96:99]
    buffer_load_dwordx4 v19, s[44:47], s26 offen offset:512 sc1 lds
    s_waitcnt lgkmcnt(0)
    v_mfma_f32_16x16x32_bf16 v[96:99], v[112:115], a[80:83], v[96:99]
    ds_read_b128 v[120:123], v14 offset:17408
    v_and_b32 v37, 0xffff0000, v212
    v_mfma_f32_16x16x32_bf16 v[96:99], v[116:119], a[88:91], v[96:99]
    ds_read_b128 v[124:127], v14 offset:21504
    v_lshlrev_b32 v36, 16, v212
    v_mfma_f32_16x16x32_bf16 v[100:103], v[116:119], a[92:95], v[100:103]
    ds_read_b128 v[128:131], v14 offset:25600
    v_and_b32 v39, 0xffff0000, v213
    v_mfma_f32_16x16x32_bf16 v[100:103], v[112:115], a[84:87], v[100:103]
    ds_read_b128 v[132:135], v14 offset:29696
    v_mfma_f32_16x16x32_bf16 v[100:103], v[108:111], a[76:79], v[100:103]
    v_lshlrev_b32 v38, 16, v213
    v_mfma_f32_16x16x32_bf16 v[100:103], v[104:107], a[68:71], v[100:103]
    v_add_f32 v32, v32, v36
    s_waitcnt lgkmcnt(2)
    v_mfma_f32_16x16x32_bf16 v[92:95], v[120:123], a[100:103], v[92:95]
    v_mfma_f32_16x16x32_bf16 v[92:95], v[124:127], a[108:111], v[92:95]
    v_add_f32 v33, v33, v37
    s_waitcnt lgkmcnt(0)
    v_mfma_f32_16x16x32_bf16 v[92:95], v[128:131], a[116:119], v[92:95]
    ds_read_b128 v[104:107], v14 offset:18432
    v_add_f32 v34, v34, v38
    v_mfma_f32_16x16x32_bf16 v[92:95], v[132:135], a[124:127], v[92:95]
    ds_read_b128 v[108:111], v14 offset:22528
    v_add_f32 v35, v35, v39
    v_mfma_f32_16x16x32_bf16 v[88:91], v[132:135], a[120:123], v[88:91]
    ds_read_b128 v[112:115], v14 offset:26624
    v_and_b32 v37, 0xffff0000, v216
    v_mfma_f32_16x16x32_bf16 v[88:91], v[128:131], a[112:115], v[88:91]
    ds_read_b128 v[116:119], v14 offset:30720
    v_lshlrev_b32 v36, 16, v216
    v_mfma_f32_16x16x32_bf16 v[88:91], v[124:127], a[104:107], v[88:91]
    v_and_b32 v39, 0xffff0000, v217
    v_lshlrev_b32 v38, 16, v217
    v_mfma_f32_16x16x32_bf16 v[88:91], v[120:123], a[96:99], v[88:91]
    v_add_f32 v32, v32, v36
    s_waitcnt lgkmcnt(2)
    v_mfma_f32_16x16x32_bf16 v[96:99], v[104:107], a[96:99], v[96:99]
    v_add_f32 v33, v33, v37
    v_add_f32 v34, v34, v38
    v_mfma_f32_16x16x32_bf16 v[96:99], v[108:111], a[104:107], v[96:99]
    v_add_f32 v35, v35, v39
    s_waitcnt lgkmcnt(0)
    v_mfma_f32_16x16x32_bf16 v[96:99], v[112:115], a[112:115], v[96:99]
    ds_read_b128 v[120:123], v14 offset:19456
    v_mul_f32 v36, s38, v32
    v_mfma_f32_16x16x32_bf16 v[96:99], v[116:119], a[120:123], v[96:99]
    ds_read_b128 v[124:127], v14 offset:23552
    v_mul_f32 v37, s38, v33
    v_mfma_f32_16x16x32_bf16 v[100:103], v[116:119], a[124:127], v[100:103]
    ds_read_b128 v[128:131], v14 offset:27648
    v_mul_f32 v38, s38, v34
    v_mfma_f32_16x16x32_bf16 v[100:103], v[112:115], a[116:119], v[100:103]
    ds_read_b128 v[132:135], v14 offset:31744
    v_mul_f32 v39, s38, v35
    v_mfma_f32_16x16x32_bf16 v[100:103], v[108:111], a[108:111], v[100:103]
    v_exp_f32 v36, v36
    v_mfma_f32_16x16x32_bf16 v[100:103], v[104:107], a[100:103], v[100:103]
    s_waitcnt lgkmcnt(2)
    v_mfma_f32_16x16x32_bf16 v[92:95], v[120:123], a[132:135], v[92:95]
    v_exp_f32 v37, v37
    v_mfma_f32_16x16x32_bf16 v[92:95], v[124:127], a[140:143], v[92:95]
    s_waitcnt lgkmcnt(0)
    v_mfma_f32_16x16x32_bf16 v[92:95], v[128:131], a[148:151], v[92:95]
    s_waitcnt vmcnt(11)
    s_barrier
    v_mfma_f32_16x16x32_bf16 v[92:95], v[132:135], a[156:159], v[92:95]
    ds_read_b128 v[104:107], v14 offset:32768
    v_mfma_f32_16x16x32_bf16 v[88:91], v[132:135], a[152:155], v[88:91]
    ds_read_b128 v[108:111], v14 offset:36864
    v_exp_f32 v38, v38
    v_mfma_f32_16x16x32_bf16 v[88:91], v[128:131], a[144:147], v[88:91]
    ds_read_b128 v[112:115], v14 offset:40960
    v_exp_f32 v39, v39
    v_mfma_f32_16x16x32_bf16 v[88:91], v[124:127], a[136:139], v[88:91]
    ds_read_b128 v[116:119], v14 offset:45056
    v_mul_f32 v180, v180, v32
    v_mfma_f32_16x16x32_bf16 v[88:91], v[120:123], a[128:131], v[88:91]
    v_mul_f32 v181, v181, v33
    s_waitcnt lgkmcnt(2)
    v_mfma_f32_16x16x32_bf16 v[96:99], v[104:107], a[128:131], v[96:99]
    v_mul_f32 v182, v182, v34
    v_mul_f32 v183, v183, v35
    v_mfma_f32_16x16x32_bf16 v[96:99], v[108:111], a[136:139], v[96:99]
    v_add_f32 v36, 1.0, v36
    s_waitcnt lgkmcnt(0)
    v_mfma_f32_16x16x32_bf16 v[96:99], v[112:115], a[144:147], v[96:99]
    ds_read_b128 v[120:123], v14 offset:33792
    v_add_f32 v37, 1.0, v37
    v_mfma_f32_16x16x32_bf16 v[96:99], v[116:119], a[152:155], v[96:99]
    ds_read_b128 v[124:127], v14 offset:37888
    v_add_f32 v38, 1.0, v38
    v_mfma_f32_16x16x32_bf16 v[100:103], v[116:119], a[156:159], v[100:103]
    ds_read_b128 v[128:131], v14 offset:41984
    v_add_f32 v39, 1.0, v39
    v_mfma_f32_16x16x32_bf16 v[100:103], v[112:115], a[148:151], v[100:103]
    ds_read_b128 v[132:135], v14 offset:46080
    v_rcp_f32 v36, v36
    v_mfma_f32_16x16x32_bf16 v[100:103], v[108:111], a[140:143], v[100:103]
    v_rcp_f32 v37, v37
    v_mfma_f32_16x16x32_bf16 v[100:103], v[104:107], a[132:135], v[100:103]
    v_rcp_f32 v38, v38
    s_waitcnt lgkmcnt(2)
    v_mfma_f32_16x16x32_bf16 v[92:95], v[120:123], a[164:167], v[92:95]
    s_waitcnt vmcnt(8)
    v_bitop3_b32 v59, v59, v63, s68 bitop3:0x7e
    v_rcp_f32 v39, v39
    v_mfma_f32_16x16x32_bf16 v[92:95], v[124:127], a[172:175], v[92:95]
    buffer_load_dwordx4 v[72:75], v136, s[44:47], s12 offen offset:0 sc1
    s_waitcnt lgkmcnt(0)
    v_mfma_f32_16x16x32_bf16 v[92:95], v[128:131], a[180:183], v[92:95]
    ds_read_b128 v[104:107], v14 offset:34816
    v_bitop3_b32 v59, v59, v67, s68 bitop3:0xf6
    v_mfma_f32_16x16x32_bf16 v[92:95], v[132:135], a[188:191], v[92:95]
    ds_read_b128 v[108:111], v14 offset:38912
    v_cmp_ne_u32 vcc, 0, v59
    v_mfma_f32_16x16x32_bf16 v[88:91], v[132:135], a[184:187], v[88:91]
    ds_read_b128 v[112:115], v14 offset:43008
    buffer_load_dwordx4 v[76:79], v136, s[44:47], s12 offen offset:1024 sc1
    v_mfma_f32_16x16x32_bf16 v[88:91], v[128:131], a[176:179], v[88:91]
    ds_read_b128 v[116:119], v14 offset:47104
    s_cbranch_vccnz L_xs_b
L_xo_b:
    v_fma_f32 v180, v180, v36, v160
    v_mfma_f32_16x16x32_bf16 v[88:91], v[124:127], a[168:171], v[88:91]
    buffer_load_dwordx4 v[80:83], v136, s[44:47], s12 offen offset:2048 sc1
    v_and_b32 v41, 0xffff0000, v56
    v_mfma_f32_16x16x32_bf16 v[88:91], v[120:123], a[160:163], v[88:91]
    v_lshlrev_b32 v40, 16, v56
    s_waitcnt lgkmcnt(2)
    v_mfma_f32_16x16x32_bf16 v[96:99], v[104:107], a[160:163], v[96:99]
    v_and_b32 v43, 0xffff0000, v57
    v_fma_f32 v181, v181, v37, v161
    v_mfma_f32_16x16x32_bf16 v[96:99], v[108:111], a[168:171], v[96:99]
    v_lshlrev_b32 v42, 16, v57
    s_waitcnt lgkmcnt(0)
    v_mfma_f32_16x16x32_bf16 v[96:99], v[112:115], a[176:179], v[96:99]
    ds_read_b128 v[120:123], v14 offset:35840
    v_and_b32 v45, 0xffff0000, v58
    v_mfma_f32_16x16x32_bf16 v[96:99], v[116:119], a[184:187], v[96:99]
    ds_read_b128 v[124:127], v14 offset:39936
    v_fma_f32 v182, v182, v38, v162
    v_mfma_f32_16x16x32_bf16 v[100:103], v[116:119], a[188:191], v[100:103]
    ds_read_b128 v[128:131], v14 offset:44032
    v_lshlrev_b32 v44, 16, v58
    v_mfma_f32_16x16x32_bf16 v[100:103], v[112:115], a[180:183], v[100:103]
    ds_read_b128 v[132:135], v14 offset:48128
    v_and_b32 v47, 0xffff0000, v60
    v_mfma_f32_16x16x32_bf16 v[100:103], v[108:111], a[172:175], v[100:103]
    v_lshlrev_b32 v46, 16, v60
    v_fma_f32 v183, v183, v39, v163
    v_mfma_f32_16x16x32_bf16 v[100:103], v[104:107], a[164:167], v[100:103]
    v_and_b32 v49, 0xffff0000, v61
    s_waitcnt lgkmcnt(2)
    v_mfma_f32_16x16x32_bf16 v[92:95], v[120:123], a[196:199], v[92:95]
    v_lshlrev_b32 v48, 16, v61
    v_cvt_pk_bf16_f32 v142, v180, v181
    v_mfma_f32_16x16x32_bf16 v[92:95], v[124:127], a[204:207], v[92:95]
    v_and_b32 v51, 0xffff0000, v62
    s_waitcnt lgkmcnt(0)
    v_mfma_f32_16x16x32_bf16 v[92:95], v[128:131], a[212:215], v[92:95]
    s_waitcnt vmcnt(4)
    s_barrier
    v_lshlrev_b32 v50, 16, v62
    v_mfma_f32_16x16x32_bf16 v[92:95], v[132:135], a[220:223], v[92:95]
    ds_read_b128 v[104:107], v14 offset:49152
    v_cvt_pk_bf16_f32 v143, v182, v183
    v_mfma_f32_16x16x32_bf16 v[88:91], v[132:135], a[216:219], v[88:91]
    ds_read_b128 v[108:111], v14 offset:53248
    v_and_b32 v53, 0xffff0000, v64
    v_mfma_f32_16x16x32_bf16 v[88:91], v[128:131], a[208:211], v[88:91]
    ds_read_b128 v[112:115], v14 offset:57344
    v_lshlrev_b32 v52, 16, v64
    v_mfma_f32_16x16x32_bf16 v[88:91], v[124:127], a[200:203], v[88:91]
    ds_read_b128 v[116:119], v14 offset:61440
    v_and_b32 v55, 0xffff0000, v65
    v_mfma_f32_16x16x32_bf16 v[88:91], v[120:123], a[192:195], v[88:91]
    v_lshlrev_b32 v54, 16, v65
    s_waitcnt lgkmcnt(2)
    v_mfma_f32_16x16x32_bf16 v[96:99], v[104:107], a[192:195], v[96:99]
    v_mfma_f32_16x16x32_bf16 v[96:99], v[108:111], a[200:203], v[96:99]
    s_waitcnt lgkmcnt(0)
    v_mfma_f32_16x16x32_bf16 v[96:99], v[112:115], a[208:211], v[96:99]
    ds_read_b128 v[120:123], v14 offset:50176
    v_add_f32 v92, v92, v44
    v_add_f32 v93, v93, v45
    v_mfma_f32_16x16x32_bf16 v[96:99], v[116:119], a[216:219], v[96:99]
    ds_read_b128 v[124:127], v14 offset:54272
    v_add_f32 v94, v94, v46
    v_mfma_f32_16x16x32_bf16 v[100:103], v[116:119], a[220:223], v[100:103]
    ds_read_b128 v[128:131], v14 offset:58368
    v_add_f32 v95, v95, v47
    v_add_f32 v88, v88, v40
    v_mfma_f32_16x16x32_bf16 v[100:103], v[112:115], a[212:215], v[100:103]
    ds_read_b128 v[132:135], v14 offset:62464
    v_add_f32 v89, v89, v41
    v_mfma_f32_16x16x32_bf16 v[100:103], v[108:111], a[204:207], v[100:103]
    v_add_f32 v90, v90, v42
    v_add_f32 v91, v91, v43
    v_mfma_f32_16x16x32_bf16 v[100:103], v[104:107], a[196:199], v[100:103]
    s_waitcnt lgkmcnt(2)
    v_mfma_f32_16x16x32_bf16 v[92:95], v[120:123], a[228:231], v[92:95]
    v_mfma_f32_16x16x32_bf16 v[92:95], v[124:127], a[236:239], v[92:95]
    s_waitcnt lgkmcnt(0)
    v_mfma_f32_16x16x32_bf16 v[92:95], v[128:131], a[244:247], v[92:95]
    ds_read_b128 v[104:107], v14 offset:51200
    v_add_f32 v96, v96, v48
    v_add_f32 v97, v97, v49
    v_mfma_f32_16x16x32_bf16 v[92:95], v[132:135], a[252:255], v[92:95]
    ds_read_b128 v[108:111], v14 offset:55296
    v_add_f32 v98, v98, v50
    v_mfma_f32_16x16x32_bf16 v[88:91], v[132:135], a[248:251], v[88:91]
    ds_read_b128 v[112:115], v14 offset:59392
    v_add_f32 v99, v99, v51
    v_add_f32 v100, v100, v52
    v_mfma_f32_16x16x32_bf16 v[88:91], v[128:131], a[240:243], v[88:91]
    ds_read_b128 v[116:119], v14 offset:63488
    v_add_f32 v101, v101, v53
    v_mfma_f32_16x16x32_bf16 v[88:91], v[124:127], a[232:235], v[88:91]
    v_add_f32 v102, v102, v54
    v_add_f32 v103, v103, v55
    v_mfma_f32_16x16x32_bf16 v[88:91], v[120:123], a[224:227], v[88:91]
    s_waitcnt lgkmcnt(2)
    v_mfma_f32_16x16x32_bf16 v[96:99], v[104:107], a[224:227], v[96:99]
    v_mfma_f32_16x16x32_bf16 v[96:99], v[108:111], a[232:235], v[96:99]
    s_waitcnt lgkmcnt(0)
    v_mfma_f32_16x16x32_bf16 v[96:99], v[112:115], a[240:243], v[96:99]
    ds_read_b128 v[120:123], v14 offset:52224
    v_mfma_f32_16x16x32_bf16 v[96:99], v[116:119], a[248:251], v[96:99]
    ds_read_b128 v[124:127], v14 offset:56320
    v_mfma_f32_16x16x32_bf16 v[100:103], v[116:119], a[252:255], v[100:103]
    buffer_store_dwordx2 v[142:143], v253, s[64:67], 0 offen sc1
    ds_read_b128 v[128:131], v14 offset:60416
    v_mfma_f32_16x16x32_bf16 v[100:103], v[112:115], a[244:247], v[100:103]
    ds_read_b128 v[132:135], v14 offset:64512
    v_mfma_f32_16x16x32_bf16 v[100:103], v[108:111], a[236:239], v[100:103]
    v_mfma_f32_16x16x32_bf16 v[100:103], v[104:107], a[228:231], v[100:103]
    s_waitcnt lgkmcnt(2)
    v_mfma_f32_16x16x32_bf16 v[92:95], v[120:123], v[224:227], v[92:95]
    v_mfma_f32_16x16x32_bf16 v[92:95], v[124:127], v[232:235], v[92:95]
    s_waitcnt lgkmcnt(0)
    v_mfma_f32_16x16x32_bf16 v[92:95], v[128:131], v[240:243], v[92:95]
    s_waitcnt vmcnt(4)
    s_barrier
    v_mfma_f32_16x16x32_bf16 v[92:95], v[132:135], v[248:251], v[92:95]
    ds_read_b128 v[104:107], v14 offset:0
    v_mfma_f32_16x16x32_bf16 v[88:91], v[132:135], v[244:247], v[88:91]
    ds_read_b128 v[108:111], v14 offset:4096
    v_mfma_f32_16x16x32_bf16 v[88:91], v[128:131], v[236:239], v[88:91]
    ds_read_b128 v[112:115], v14 offset:8192
    v_mfma_f32_16x16x32_bf16 v[88:91], v[124:127], v[228:231], v[88:91]
    ds_read_b128 v[116:119], v14 offset:12288
    v_mfma_f32_16x16x32_bf16 v[88:91], v[120:123], v[220:223], v[88:91]
    s_waitcnt lgkmcnt(2)
    v_mfma_f32_16x16x32_bf16 v[96:99], v[104:107], v[220:223], v[96:99]
    v_mfma_f32_16x16x32_bf16 v[96:99], v[108:111], v[228:231], v[96:99]
    s_waitcnt lgkmcnt(0)
    v_mfma_f32_16x16x32_bf16 v[96:99], v[112:115], v[236:239], v[96:99]
    v_mfma_f32_16x16x32_bf16 v[96:99], v[116:119], v[244:247], v[96:99]
    v_mfma_f32_16x16x32_bf16 v[100:103], v[116:119], v[248:251], v[100:103]
    v_mfma_f32_16x16x32_bf16 v[100:103], v[112:115], v[240:243], v[100:103]
    v_mfma_f32_16x16x32_bf16 v[100:103], v[108:111], v[232:235], v[100:103]
    v_mfma_f32_16x16x32_bf16 v[100:103], v[104:107], v[224:227], v[100:103]
    s_waitcnt vmcnt(1)
    v_bitop3_b32 v75, v75, v79, s68 bitop3:0x7e
    v_bitop3_b32 v75, v75, v83, s68 bitop3:0xf6
    v_cmp_ne_u32 vcc, 0, v75
    s_cbranch_vccnz L_xs_z
L_xo_z:
    v_and_b32 v41, 0xffff0000, v72
    v_lshlrev_b32 v40, 16, v72
    v_and_b32 v43, 0xffff0000, v73
    v_lshlrev_b32 v42, 16, v73
    v_and_b32 v45, 0xffff0000, v74
    v_lshlrev_b32 v44, 16, v74
    v_and_b32 v47, 0xffff0000, v76
    v_lshlrev_b32 v46, 16, v76
    v_and_b32 v49, 0xffff0000, v77
    v_lshlrev_b32 v48, 16, v77
    v_and_b32 v51, 0xffff0000, v78
    v_lshlrev_b32 v50, 16, v78
    v_and_b32 v53, 0xffff0000, v80
    v_lshlrev_b32 v52, 16, v80
    v_and_b32 v55, 0xffff0000, v81
    v_lshlrev_b32 v54, 16, v81
    v_pk_add_f32 v[88:89], v[88:89], v[40:41]
    v_pk_add_f32 v[90:91], v[90:91], v[42:43]
    v_pk_add_f32 v[96:97], v[96:97], v[48:49]
    v_pk_add_f32 v[98:99], v[98:99], v[50:51]
    v_pk_mul_f32 v[56:57], v[88:89], s[38:39] op_sel_hi:[1,0]
    v_pk_mul_f32 v[58:59], v[90:91], s[38:39] op_sel_hi:[1,0]
    v_pk_mul_f32 v[64:65], v[96:97], s[38:39] op_sel_hi:[1,0]
    v_pk_mul_f32 v[66:67], v[98:99], s[38:39] op_sel_hi:[1,0]
    v_exp_f32 v56, v56
    v_exp_f32 v57, v57
    v_exp_f32 v58, v58
    v_exp_f32 v59, v59
    v_exp_f32 v64, v64
    v_exp_f32 v65, v65
    v_exp_f32 v66, v66
    v_exp_f32 v67, v67
    v_pk_mul_f32 v[164:165], v[164:165], v[88:89]
    v_pk_mul_f32 v[166:167], v[166:167], v[90:91]
    v_pk_mul_f32 v[172:173], v[172:173], v[96:97]
    v_pk_mul_f32 v[174:175], v[174:175], v[98:99]
    v_pk_add_f32 v[56:57], v[56:57], 1.0 op_sel_hi:[1,0]
    v_pk_add_f32 v[58:59], v[58:59], 1.0 op_sel_hi:[1,0]
    v_pk_add_f32 v[64:65], v[64:65], 1.0 op_sel_hi:[1,0]
    v_pk_add_f32 v[66:67], v[66:67], 1.0 op_sel_hi:[1,0]
    v_rcp_f32 v56, v56
    v_rcp_f32 v57, v57
    v_rcp_f32 v58, v58
    v_rcp_f32 v59, v59
    v_rcp_f32 v64, v64
    v_rcp_f32 v65, v65
    v_rcp_f32 v66, v66
    v_rcp_f32 v67, v67
    v_pk_fma_f32 v[164:165], v[164:165], v[56:57], v[144:145]
    v_pk_fma_f32 v[166:167], v[166:167], v[58:59], v[146:147]
    v_pk_fma_f32 v[172:173], v[172:173], v[64:65], v[152:153]
    v_pk_fma_f32 v[174:175], v[174:175], v[66:67], v[154:155]
    v_cvt_pk_bf16_f32 v88, v164, v165
    v_cvt_pk_bf16_f32 v90, v172, v173
    v_cvt_pk_bf16_f32 v89, v166, v167
    v_cvt_pk_bf16_f32 v91, v174, v175
    v_permlane16_swap_b32 v88, v90
    s_nop 0
    v_permlane16_swap_b32 v89, v91
    buffer_store_dwordx4 v[88:91], v252, s[64:67], 0 offen sc1
    v_pk_add_f32 v[92:93], v[92:93], v[44:45]
    v_pk_add_f32 v[94:95], v[94:95], v[46:47]
    v_pk_add_f32 v[100:101], v[100:101], v[52:53]
    v_pk_add_f32 v[102:103], v[102:103], v[54:55]
    v_pk_mul_f32 v[60:61], v[92:93], s[38:39] op_sel_hi:[1,0]
    v_pk_mul_f32 v[62:63], v[94:95], s[38:39] op_sel_hi:[1,0]
    v_pk_mul_f32 v[68:69], v[100:101], s[38:39] op_sel_hi:[1,0]
    v_pk_mul_f32 v[70:71], v[102:103], s[38:39] op_sel_hi:[1,0]
    v_exp_f32 v60, v60
    v_exp_f32 v61, v61
    v_exp_f32 v62, v62
    v_exp_f32 v63, v63
    v_exp_f32 v68, v68
    v_exp_f32 v69, v69
    v_exp_f32 v70, v70
    v_exp_f32 v71, v71
    v_pk_mul_f32 v[168:169], v[168:169], v[92:93]
    v_pk_mul_f32 v[170:171], v[170:171], v[94:95]
    v_pk_mul_f32 v[176:177], v[176:177], v[100:101]
    v_pk_mul_f32 v[178:179], v[178:179], v[102:103]
    v_pk_add_f32 v[60:61], v[60:61], 1.0 op_sel_hi:[1,0]
    v_pk_add_f32 v[62:63], v[62:63], 1.0 op_sel_hi:[1,0]
    v_pk_add_f32 v[68:69], v[68:69], 1.0 op_sel_hi:[1,0]
    v_pk_add_f32 v[70:71], v[70:71], 1.0 op_sel_hi:[1,0]
    v_rcp_f32 v60, v60
    v_rcp_f32 v61, v61
    v_rcp_f32 v62, v62
    v_rcp_f32 v63, v63
    v_rcp_f32 v68, v68
    v_rcp_f32 v69, v69
    v_rcp_f32 v70, v70
    v_rcp_f32 v71, v71
    v_pk_fma_f32 v[168:169], v[168:169], v[60:61], v[148:149]
    v_pk_fma_f32 v[170:171], v[170:171], v[62:63], v[150:151]
    v_pk_fma_f32 v[176:177], v[176:177], v[68:69], v[156:157]
    v_pk_fma_f32 v[178:179], v[178:179], v[70:71], v[158:159]
    v_cvt_pk_bf16_f32 v92, v168, v169
    v_cvt_pk_bf16_f32 v94, v176, v177
    v_cvt_pk_bf16_f32 v93, v170, v171
    v_cvt_pk_bf16_f32 v95, v178, v179
    v_permlane16_swap_b32 v92, v94
    s_nop 0
    v_permlane16_swap_b32 v93, v95
    buffer_store_dwordx4 v[92:95], v252, s[64:67], s40 offen sc1
    s_endpgm
L_segE:
.p2align 12
L_aux:
    s_bfe_u32 s101, s2, 0x20003
    s_mul_i32 s101, s101, 3
    s_mul_i32 s84, s101, 305844
    s_lshr_b32 s84, s84, 18
    s_add_u32 s84, s84, 0
    s_add_u32 s85, s84, 1
    s_cmp_eq_u32 s85, 14
    s_cselect_b32 s85, 0, s85
    s_add_u32 s86, s85, 1
    s_cmp_eq_u32 s86, 14
    s_cselect_b32 s86, 0, s86
    s_add_u32 s87, s86, 1
    s_cmp_eq_u32 s87, 14
    s_cselect_b32 s87, 0, s87
    s_add_u32 s88, s87, 1
    s_cmp_eq_u32 s88, 14
    s_cselect_b32 s88, 0, s88
    s_add_u32 s89, s88, 1
    s_cmp_eq_u32 s89, 14
    s_cselect_b32 s89, 0, s89
    s_add_u32 s90, s89, 1
    s_cmp_eq_u32 s90, 14
    s_cselect_b32 s90, 0, s90
    s_add_u32 s91, s90, 1
    s_cmp_eq_u32 s91, 14
    s_cselect_b32 s91, 0, s91
    s_add_u32 s92, s91, 1
    s_cmp_eq_u32 s92, 14
    s_cselect_b32 s92, 0, s92
    s_add_u32 s93, s92, 1
    s_cmp_eq_u32 s93, 14
    s_cselect_b32 s93, 0, s93
    s_add_u32 s94, s93, 1
    s_cmp_eq_u32 s94, 14
    s_cselect_b32 s94, 0, s94
    s_add_u32 s95, s94, 1
    s_cmp_eq_u32 s95, 14
    s_cselect_b32 s95, 0, s95
    s_add_u32 s96, s95, 1
    s_cmp_eq_u32 s96, 14
    s_cselect_b32 s96, 0, s96
    s_add_u32 s97, s96, 1
    s_cmp_eq_u32 s97, 14
    s_cselect_b32 s97, 0, s97
    s_mul_i32 s98, s101, 87384
    s_lshr_b32 s98, s98, 18
    s_add_u32 s98, s98, 14
    s_add_u32 s99, s98, 1
    s_cmp_eq_u32 s99, 18
    s_cselect_b32 s99, 14, s99
    s_add_u32 s100, s99, 1
    s_cmp_eq_u32 s100, 18
    s_cselect_b32 s100, 14, s100
    s_add_u32 s101, s100, 1
    s_cmp_eq_u32 s101, 18
    s_cselect_b32 s101, 14, s101
    s_lshl2_add_u32 s7, s5, s6
    s_add_u32 s7, s7, 188
    s_add_u32 s8, s5, 248
    s_cmp_eq_u32 s6, 27
    s_cselect_b32 s75, s8, s7
    s_mov_b32 s48, s24
    s_and_b32 s49, s25, 0xffff
    s_mov_b32 s50, 2359296
    s_mov_b32 s51, 0x20000
    v_lshlrev_b32 v240, 4, v2
    s_mul_i32 s74, s3, 16640
    s_add_u32 s74, s74, 73728
    s_sub_u32 s69, s75, 216
    s_lshl_b32 s70, s69, 4
    s_add_u32 s70, s70, s3
    s_lshl_b32 s12, s70, 12
    s_lshl_b32 s70, s70, 1
    s_mov_b32 s9, 144896
    s_mov_b32 s11, 8192
    v_mul_u32_u24 v48, 1216, v3
    v_mad_u32_u24 v48, v4, 12, v48
    v_add_u32 v48, s9, v48
    v_mov_b32 v47, 0x40000000
    v_lshlrev_b32 v3, 3, v3
    s_lshl_b32 s5, s68, 6
    s_add_u32 s5, s5, 12386304
    v_cmp_eq_u32 vcc, 0, v4
    s_nop 1
    v_cndmask_b32 v49, v47, v3, vcc
    v_lshrrev_b32 v5, 4, v0
    v_and_b32 v4, 3, v2
    v_lshlrev_b32 v4, 3, v4
    v_lshl_add_u32 v5, v5, 5, v4
    v_bfe_u32 v6, v2, 2, 2
    v_mul_u32_u24 v4, 1216, v6
    v_mul_u32_u24 v6, 1152, v6
    v_add3_u32 v50, v4, v5, s9
    v_add3_u32 v51, v6, v5, s11
    s_mul_i32 s4, s3, 2176
    v_add_u32 v55, s4, v51
    v_lshlrev_b32 v52, 4, v0
    s_add_u32 s7, s15, 4096
    s_add_u32 s8, s15, 8192
    s_cmp_eq_u32 s3, 0
    s_cselect_b32 s8, s8, 0x40000000
    v_add_u32 v53, 2359296, v52
    v_mov_b32 v54, 0
    v_add_u32 v4, 0, v52
    v_lshrrev_b32 v5, 7, v4
    v_mul_u32_u24 v6, 9363, v5
    v_lshrrev_b32 v6, 16, v6
    v_mad_i32_i24 v5, v6, -7, v5
    v_cmp_lt_u32 vcc, 2, v5
    s_nop 1
    v_addc_co_u32 v6, vcc, 0, v6, vcc
    v_lshl_add_u32 v93, v6, 7, v4
    v_add_u32 v4, 4096, v52
    v_lshrrev_b32 v5, 7, v4
    v_mul_u32_u24 v6, 9363, v5
    v_lshrrev_b32 v6, 16, v6
    v_mad_i32_i24 v5, v6, -7, v5
    v_cmp_lt_u32 vcc, 2, v5
    s_nop 1
    v_addc_co_u32 v6, vcc, 0, v6, vcc
    v_lshl_add_u32 v94, v6, 7, v4
    v_add_u32 v4, 8192, v52
    v_lshrrev_b32 v5, 7, v4
    v_mul_u32_u24 v6, 9363, v5
    v_lshrrev_b32 v6, 16, v6
    v_mad_i32_i24 v5, v6, -7, v5
    v_cmp_lt_u32 vcc, 2, v5
    s_nop 1
    v_addc_co_u32 v6, vcc, 0, v6, vcc
    v_lshl_add_u32 v95, v6, 7, v4
    s_mul_i32 s10, s68, 11264
    s_add_u32 s10, s10, 36585472
    s_cmp_eq_u32 s3, 0
    s_cselect_b32 s83, s10, 0x40000000
    s_add_u32 s7, s10, 2883584
    s_add_u32 s8, s83, 2883584
    s_mul_i32 s4, s3, 1028
    s_sub_u32 s4, 8204, s4
    v_add_u32 v90, s4, v53
    s_bfe_u32 s6, s68, 0x20001
    s_lshl_b32 s6, s6, 6
    s_lshr_b32 s9, s68, 3
    s_lshl1_add_u32 s6, s9, s6
    s_and_b32 s9, s68, 1
    s_add_u32 s6, s6, s9
    s_lshl_b32 s4, s6, 2
    s_add_u32 s4, s4, 12533760
    v_lshl_add_u32 v1, v0, 10, s4
    s_lshl_b32 s4, s68, 2
    s_add_u32 s4, s4, 12599296
    v_lshl_add_u32 v46, v0, 10, s4
    v_cmp_gt_u32 vcc, 8, v0
    s_nop 1
    v_cndmask_b32 v1, v47, v1, vcc
    v_cmp_gt_u32 vcc, 4, v0
    s_nop 1
    v_cndmask_b32 v46, v47, v46, vcc
    s_waitcnt vmcnt(9)
    v_and_b32 v21, 0xffff0000, v8
    v_lshlrev_b32 v20, 16, v8
    v_and_b32 v23, 0xffff0000, v9
    v_lshlrev_b32 v22, 16, v9
    v_and_b32 v25, 0xffff0000, v10
    v_lshlrev_b32 v24, 16, v10
    v_and_b32 v27, 0xffff0000, v12
    v_lshlrev_b32 v26, 16, v12
    v_and_b32 v29, 0xffff0000, v13
    v_lshlrev_b32 v28, 16, v13
    v_and_b32 v31, 0xffff0000, v14
    v_lshlrev_b32 v30, 16, v14
    v_and_b32 v33, 0xffff0000, v16
    v_lshlrev_b32 v32, 16, v16
    v_and_b32 v35, 0xffff0000, v17
    v_lshlrev_b32 v34, 16, v17
    v_and_b32 v37, 0xffff0000, v18
    v_lshlrev_b32 v36, 16, v18
    v_pk_add_f32 v[38:39], v[20:21], v[22:23]
    v_pk_add_f32 v[40:41], v[24:25], v[26:27]
    v_pk_add_f32 v[42:43], v[28:29], v[30:31]
    v_pk_add_f32 v[44:45], v[32:33], v[34:35]
    v_pk_add_f32 v[38:39], v[38:39], v[40:41]
    v_pk_add_f32 v[42:43], v[42:43], v[44:45]
    v_pk_add_f32 v[38:39], v[38:39], v[36:37]
    v_pk_add_f32 v[38:39], v[38:39], v[42:43]
    v_add_f32 v56, v38, v39
    s_nop 1
    v_add_f32_dpp v56, v56, v56 row_ror:8 row_mask:0xf bank_mask:0xf
    s_nop 1
    v_add_f32_dpp v56, v56, v56 row_ror:4 row_mask:0xf bank_mask:0xf
    s_nop 1
    v_add_f32_dpp v56, v56, v56 row_ror:2 row_mask:0xf bank_mask:0xf
    s_nop 1
    v_add_f32_dpp v56, v56, v56 row_ror:1 row_mask:0xf bank_mask:0xf
    v_mov_b32 v57, v56
    s_nop 1
    v_permlane16_swap_b32 v56, v57
    v_add_f32 v56, v56, v57
    v_mul_f32 v56, 0x3ae38e39, v56
    v_pk_add_f32 v[20:21], v[20:21], v[56:57] op_sel_hi:[1,0] neg_lo:[0,1] neg_hi:[0,1]
    v_pk_add_f32 v[22:23], v[22:23], v[56:57] op_sel_hi:[1,0] neg_lo:[0,1] neg_hi:[0,1]
    v_pk_add_f32 v[24:25], v[24:25], v[56:57] op_sel_hi:[1,0] neg_lo:[0,1] neg_hi:[0,1]
    v_pk_add_f32 v[26:27], v[26:27], v[56:57] op_sel_hi:[1,0] neg_lo:[0,1] neg_hi:[0,1]
    v_pk_add_f32 v[28:29], v[28:29], v[56:57] op_sel_hi:[1,0] neg_lo:[0,1] neg_hi:[0,1]
    v_pk_add_f32 v[30:31], v[30:31], v[56:57] op_sel_hi:[1,0] neg_lo:[0,1] neg_hi:[0,1]
    v_pk_add_f32 v[32:33], v[32:33], v[56:57] op_sel_hi:[1,0] neg_lo:[0,1] neg_hi:[0,1]
    v_pk_add_f32 v[34:35], v[34:35], v[56:57] op_sel_hi:[1,0] neg_lo:[0,1] neg_hi:[0,1]
    v_pk_add_f32 v[36:37], v[36:37], v[56:57] op_sel_hi:[1,0] neg_lo:[0,1] neg_hi:[0,1]
    v_pk_mul_f32 v[38:39], v[20:21], v[20:21]
    v_pk_mul_f32 v[40:41], v[22:23], v[22:23]
    v_pk_fma_f32 v[38:39], v[24:25], v[24:25], v[38:39]
    v_pk_fma_f32 v[40:41], v[26:27], v[26:27], v[40:41]
    v_pk_fma_f32 v[38:39], v[28:29], v[28:29], v[38:39]
    v_pk_fma_f32 v[40:41], v[30:31], v[30:31], v[40:41]
    v_pk_fma_f32 v[38:39], v[32:33], v[32:33], v[38:39]
    v_pk_fma_f32 v[40:41], v[34:35], v[34:35], v[40:41]
    v_pk_fma_f32 v[38:39], v[36:37], v[36:37], v[38:39]
    v_pk_add_f32 v[38:39], v[38:39], v[40:41]
    v_add_f32 v18, v38, v39
    s_nop 1
    v_add_f32_dpp v18, v18, v18 row_ror:8 row_mask:0xf bank_mask:0xf
    s_nop 1
    v_add_f32_dpp v18, v18, v18 row_ror:4 row_mask:0xf bank_mask:0xf
    s_nop 1
    v_add_f32_dpp v18, v18, v18 row_ror:2 row_mask:0xf bank_mask:0xf
    s_nop 1
    v_add_f32_dpp v18, v18, v18 row_ror:1 row_mask:0xf bank_mask:0xf
    v_mov_b32 v19, v18
    s_nop 1
    v_permlane16_swap_b32 v18, v19
    v_add_f32 v18, v18, v19
    v_mul_f32 v18, 0x3ae38e39, v18
    v_cvt_pk_bf16_f32 v38, v56, v18
    v_lshlrev_b32 v106, 16, v38
    v_and_b32 v38, 0xffff0000, v38
    v_add_f32 v38, 0x3727c5ac, v38
    v_sub_f32 v56, v56, v106
    v_cvt_pk_bf16_f32 v38, v38, v38
    v_lshlrev_b32 v38, 16, v38
    v_sqrt_f32 v38, v38
    s_nop 0
    v_cvt_pk_bf16_f32 v38, v38, v38
    v_lshlrev_b32 v38, 16, v38
    v_rcp_f32 v107, v38
    s_nop 0
    v_mul_f32 v56, v56, v107
    v_mul_f32 v18, v18, v107
    v_mul_f32 v18, v18, v107
    v_cvt_pk_bf16_f32 v38, v56, v18
    v_lshlrev_b32 v39, 16, v38
    v_and_b32 v38, 0xffff0000, v38
    v_add_f32 v38, 0x3727c5ac, v38
    v_sub_f32 v56, v56, v39
    v_cvt_pk_bf16_f32 v38, v38, v38
    v_lshlrev_b32 v38, 16, v38
    v_sqrt_f32 v38, v38
    s_nop 0
    v_cvt_pk_bf16_f32 v38, v38, v38
    v_lshlrev_b32 v38, 16, v38
    v_rcp_f32 v38, v38
    s_nop 0
    v_mul_f32 v18, v107, v38
    v_mul_f32 v56, v56, v38
    v_pk_fma_f32 v[20:21], v[20:21], v[18:19], v[56:57] op_sel_hi:[1,0,0]
    v_pk_fma_f32 v[22:23], v[22:23], v[18:19], v[56:57] op_sel_hi:[1,0,0]
    v_pk_fma_f32 v[24:25], v[24:25], v[18:19], v[56:57] op_sel_hi:[1,0,0]
    v_pk_fma_f32 v[26:27], v[26:27], v[18:19], v[56:57] op_sel_hi:[1,0,0]
    v_pk_fma_f32 v[28:29], v[28:29], v[18:19], v[56:57] op_sel_hi:[1,0,0]
    v_pk_fma_f32 v[30:31], v[30:31], v[18:19], v[56:57] op_sel_hi:[1,0,0]
    v_pk_fma_f32 v[32:33], v[32:33], v[18:19], v[56:57] op_sel_hi:[1,0,0]
    v_pk_fma_f32 v[34:35], v[34:35], v[18:19], v[56:57] op_sel_hi:[1,0,0]
    v_pk_fma_f32 v[36:37], v[36:37], v[18:19], v[56:57] op_sel_hi:[1,0,0]
    v_cvt_pk_bf16_f32 v8, v20, v21
    v_cvt_pk_bf16_f32 v9, v22, v23
    v_cvt_pk_bf16_f32 v10, v24, v25
    v_cvt_pk_bf16_f32 v11, v26, v27
    v_cvt_pk_bf16_f32 v12, v28, v29
    v_cvt_pk_bf16_f32 v13, v30, v31
    v_cvt_pk_bf16_f32 v14, v32, v33
    v_cvt_pk_bf16_f32 v15, v34, v35
    v_cvt_pk_bf16_f32 v16, v36, v37
    ds_write_b32 v48, v8 offset:0
    ds_write_b32 v48, v9 offset:4
    ds_write_b32 v48, v10 offset:8
    ds_write_b32 v48, v11 offset:384
    ds_write_b32 v48, v12 offset:388
    ds_write_b32 v48, v13 offset:392
    ds_write_b32 v48, v14 offset:768
    ds_write_b32 v48, v15 offset:772
    ds_write_b32 v48, v16 offset:776
    buffer_store_dwordx2 v[106:107], v49, s[44:47], s5 offen sc1
    s_waitcnt lgkmcnt(0)
    s_barrier
    ds_read_b64_tr_b16 v[20:21], v50 offset:0
    ds_read_b64_tr_b16 v[22:23], v50 offset:4864
    ds_read_b64_tr_b16 v[24:25], v50 offset:512
    ds_read_b64_tr_b16 v[26:27], v50 offset:5376
    ds_read_b64_tr_b16 v[28:29], v50 offset:1024
    ds_read_b64_tr_b16 v[30:31], v50 offset:5888
    s_waitcnt lgkmcnt(4)
    buffer_store_dwordx4 v[20:23], v93, s[44:47], s10 offen sc1
    s_waitcnt lgkmcnt(2)
    buffer_store_dwordx4 v[24:27], v94, s[44:47], s10 offen sc1
    s_waitcnt lgkmcnt(0)
    buffer_store_dwordx4 v[28:31], v95, s[44:47], s83 offen sc1
    buffer_load_dword v45, v54, s[64:67], 0 offen sc1
    s_waitcnt vmcnt(5)
    s_barrier
    ds_read_b64_tr_b16 v[60:61], v51 offset:0
    ds_read_b64_tr_b16 v[62:63], v51 offset:4608
    ds_read_b64_tr_b16 v[64:65], v51 offset:9216
    ds_read_b64_tr_b16 v[66:67], v51 offset:12672
    ds_read_b64_tr_b16 v[68:69], v51 offset:17280
    ds_read_b64_tr_b16 v[70:71], v51 offset:512
    ds_read_b64_tr_b16 v[72:73], v51 offset:5120
    ds_read_b64_tr_b16 v[74:75], v51 offset:9728
    ds_read_b64_tr_b16 v[76:77], v51 offset:13184
    ds_read_b64_tr_b16 v[78:79], v51 offset:17792
    v_alignbit_b32 v114, v99, v99, 16
    v_alignbit_b32 v115, v98, v98, 16
    s_waitcnt lgkmcnt(5)
    v_alignbit_b32 v108, v61, v60, 16
    v_alignbit_b32 v109, v62, v61, 16
    v_alignbit_b32 v110, v63, v62, 16
    v_alignbit_b32 v111, v64, v63, 16
    v_alignbit_b32 v112, v65, v64, 16
    v_dot2_f32_bf16 v116, v60, v114, 0
    ds_read_b64_tr_b16 v[80:81], v51 offset:1024
    v_dot2_f32_bf16 v117, v108, v114, 0
    v_dot2_f32_bf16 v118, v61, v114, 0
    v_dot2_f32_bf16 v119, v109, v114, 0
    v_dot2_f32_bf16 v120, v62, v114, 0
    ds_read_b64_tr_b16 v[82:83], v51 offset:5632
    v_dot2_f32_bf16 v121, v110, v114, 0
    v_dot2_f32_bf16 v122, v63, v114, 0
    v_dot2_f32_bf16 v123, v111, v114, 0
    v_dot2_f32_bf16 v116, v61, v115, v116
    v_dot2_f32_bf16 v117, v109, v115, v117
    ds_read_b64_tr_b16 v[84:85], v51 offset:10240
    v_dot2_f32_bf16 v118, v62, v115, v118
    v_dot2_f32_bf16 v119, v110, v115, v119
    v_dot2_f32_bf16 v120, v63, v115, v120
    v_dot2_f32_bf16 v121, v111, v115, v121
    v_dot2_f32_bf16 v122, v64, v115, v122
    ds_read_b64_tr_b16 v[86:87], v51 offset:13696
    v_dot2_f32_bf16 v123, v112, v115, v123
    v_and_b32 v133, 0xffff0000, v66
    v_lshlrev_b32 v132, 16, v66
    v_and_b32 v135, 0xffff0000, v67
    v_lshlrev_b32 v134, 16, v67
    ds_read_b64_tr_b16 v[88:89], v51 offset:18304
    v_and_b32 v137, 0xffff0000, v68
    v_lshlrev_b32 v136, 16, v68
    v_and_b32 v139, 0xffff0000, v69
    v_lshlrev_b32 v138, 16, v69
    v_pk_mul_f32 v[116:117], v[116:117], v[132:133]
    v_pk_mul_f32 v[118:119], v[118:119], v[134:135]
    v_pk_mul_f32 v[120:121], v[120:121], v[136:137]
    v_pk_mul_f32 v[122:123], v[122:123], v[138:139]
    v_cvt_pk_bf16_f32 v160, v123, v122
    v_cvt_pk_bf16_f32 v161, v121, v120
    v_cvt_pk_bf16_f32 v162, v119, v118
    v_cvt_pk_bf16_f32 v163, v117, v116
    buffer_store_dwordx4 v[160:163], v93, s[44:47], s7 offen sc1
    v_alignbit_b32 v114, v101, v101, 16
    v_alignbit_b32 v115, v100, v100, 16
    s_waitcnt lgkmcnt(5)
    v_alignbit_b32 v108, v71, v70, 16
    v_alignbit_b32 v109, v72, v71, 16
    v_alignbit_b32 v110, v73, v72, 16
    v_alignbit_b32 v111, v74, v73, 16
    v_alignbit_b32 v112, v75, v74, 16
    v_dot2_f32_bf16 v124, v70, v114, 0
    v_dot2_f32_bf16 v125, v108, v114, 0
    v_dot2_f32_bf16 v126, v71, v114, 0
    v_dot2_f32_bf16 v127, v109, v114, 0
    v_dot2_f32_bf16 v128, v72, v114, 0
    v_dot2_f32_bf16 v129, v110, v114, 0
    v_dot2_f32_bf16 v130, v73, v114, 0
    v_dot2_f32_bf16 v131, v111, v114, 0
    v_dot2_f32_bf16 v124, v71, v115, v124
    v_dot2_f32_bf16 v125, v109, v115, v125
    v_dot2_f32_bf16 v126, v72, v115, v126
    v_dot2_f32_bf16 v127, v110, v115, v127
    v_dot2_f32_bf16 v128, v73, v115, v128
    v_dot2_f32_bf16 v129, v111, v115, v129
    v_dot2_f32_bf16 v130, v74, v115, v130
    v_dot2_f32_bf16 v131, v112, v115, v131
    v_and_b32 v133, 0xffff0000, v76
    v_lshlrev_b32 v132, 16, v76
    v_and_b32 v135, 0xffff0000, v77
    v_lshlrev_b32 v134, 16, v77
    v_and_b32 v137, 0xffff0000, v78
    v_lshlrev_b32 v136, 16, v78
    v_and_b32 v139, 0xffff0000, v79
    v_lshlrev_b32 v138, 16, v79
    v_pk_mul_f32 v[124:125], v[124:125], v[132:133]
    v_pk_mul_f32 v[126:127], v[126:127], v[134:135]
    v_pk_mul_f32 v[128:129], v[128:129], v[136:137]
    v_pk_mul_f32 v[130:131], v[130:131], v[138:139]
    v_cvt_pk_bf16_f32 v164, v131, v130
    v_cvt_pk_bf16_f32 v165, v129, v128
    v_cvt_pk_bf16_f32 v166, v127, v126
    v_cvt_pk_bf16_f32 v167, v125, v124
    buffer_store_dwordx4 v[164:167], v94, s[44:47], s7 offen sc1
    v_alignbit_b32 v114, v103, v103, 16
    v_alignbit_b32 v115, v102, v102, 16
    s_waitcnt lgkmcnt(0)
    v_alignbit_b32 v108, v81, v80, 16
    v_alignbit_b32 v109, v82, v81, 16
    v_alignbit_b32 v110, v83, v82, 16
    v_alignbit_b32 v111, v84, v83, 16
    v_alignbit_b32 v112, v85, v84, 16
    v_dot2_f32_bf16 v116, v80, v114, 0
    v_dot2_f32_bf16 v117, v108, v114, 0
    v_dot2_f32_bf16 v118, v81, v114, 0
    v_dot2_f32_bf16 v119, v109, v114, 0
    v_dot2_f32_bf16 v120, v82, v114, 0
    v_dot2_f32_bf16 v121, v110, v114, 0
    v_dot2_f32_bf16 v122, v83, v114, 0
    v_dot2_f32_bf16 v123, v111, v114, 0
    v_dot2_f32_bf16 v116, v81, v115, v116
    v_dot2_f32_bf16 v117, v109, v115, v117
    v_dot2_f32_bf16 v118, v82, v115, v118
    v_dot2_f32_bf16 v119, v110, v115, v119
    v_dot2_f32_bf16 v120, v83, v115, v120
    v_dot2_f32_bf16 v121, v111, v115, v121
    v_dot2_f32_bf16 v122, v84, v115, v122
    v_dot2_f32_bf16 v123, v112, v115, v123
    v_and_b32 v133, 0xffff0000, v86
    v_lshlrev_b32 v132, 16, v86
    v_and_b32 v135, 0xffff0000, v87
    v_lshlrev_b32 v134, 16, v87
    v_and_b32 v137, 0xffff0000, v88
    v_lshlrev_b32 v136, 16, v88
    v_and_b32 v139, 0xffff0000, v89
    v_lshlrev_b32 v138, 16, v89
    v_pk_mul_f32 v[116:117], v[116:117], v[132:133]
    v_pk_mul_f32 v[118:119], v[118:119], v[134:135]
    v_pk_mul_f32 v[120:121], v[120:121], v[136:137]
    v_pk_mul_f32 v[122:123], v[122:123], v[138:139]
    v_cvt_pk_bf16_f32 v168, v123, v122
    v_cvt_pk_bf16_f32 v169, v121, v120
    v_cvt_pk_bf16_f32 v170, v119, v118
    v_cvt_pk_bf16_f32 v171, v117, v116
    buffer_store_dwordx4 v[168:171], v95, s[44:47], s8 offen sc1
    s_add_u32 m0, s74, 32
    s_add_u32 s13, s12, 0
    buffer_load_dwordx4 v240, s[48:51], s13 offen offset:0 lds
    buffer_load_dwordx4 v240, s[48:51], s13 offen offset:1024 lds
    buffer_load_dwordx4 v240, s[48:51], s13 offen offset:2048 lds
    buffer_load_dwordx4 v240, s[48:51], s13 offen offset:3072 lds
    s_mov_b64 exec, 0
    s_call_b64 s[82:83], L_wc_X
    s_mov_b64 exec, -1
    s_waitcnt vmcnt(7)
    v_readfirstlane_b32 s68, v45
    s_nop 1
    s_cmp_eq_u32 s68, 0
    s_cbranch_scc1 L_nw_X
L_ng_X:
    s_barrier
    v_mov_b32 v3, s68
    buffer_store_dword v3, v1, s[44:47], 0 offen sc1
    s_waitcnt vmcnt(5)
    s_barrier
    buffer_store_dword v3, v46, s[44:47], 0 offen sc1
L_segX:
L_pl_X_0:
    s_cbranch_execz L_pl_X_4
    s_cmp_lt_u32 s75, 252
    s_cbranch_scc0 L_idle
    s_mov_b32 s56, s26
    s_and_b32 s57, s27, 0xffff
    s_mov_b32 s58, 1152
    s_mov_b32 s59, 0x20000
    v_mov_b32 v9, 0
    buffer_load_ushort v9, v9, s[56:59], s70 offen
    s_lshr_b32 s4, s2, 1
    s_and_b32 s4, s4, 3
    s_lshl2_add_u32 s4, s4, s3
    s_lshl_b32 s4, s4, 8
    s_add_u32 s4, s4, 12599296
    v_lshl_add_u32 v28, v2, 2, s4
    v_add_u32 v241, s74, v240
    v_cmp_eq_u32 vcc, 0, v2
    v_mov_b32 v196, 4136
    s_nop 0
    v_cndmask_b32 v196, v196, 30, vcc
    v_add_u32 v242, s74, v196
    v_bfe_u32 v196, v2, 3, 2
    v_mul_u32_u24 v196, 4160, v196
    v_and_b32 v197, 7, v2
    v_lshl_add_u32 v196, v197, 2, v196
    v_add_u32 v200, s74, v196
    v_mov_b32 v196, 0
    v_mov_b32 v197, 0
    v_mov_b32 v198, 0
    v_mov_b32 v199, 0
    ds_write_b32 v200, v196
    v_lshlrev_b32 v201, 4, v0
    ds_write_b128 v201, v[196:199]
    ds_write_b128 v201, v[196:199] offset:36864
    s_waitcnt vmcnt(3)
    ds_read_b128 v[212:215], v241 offset:32
    ds_read_b32 v216, v241 offset:48
    ds_read_b128 v[218:221], v241 offset:1056
    ds_read_b32 v222, v241 offset:1072
    ds_read_b128 v[224:227], v241 offset:2080
    ds_read_b32 v228, v241 offset:2096
    ds_read_b128 v[230:233], v241 offset:3104
    ds_read_b32 v234, v241 offset:3120
    v_lshrrev_b32 v202, 3, v2
    v_and_b32 v203, 7, v2
    v_lshrrev_b32 v204, 1, v202
    v_xor_b32 v203, v203, v204
    v_mul_u32_u24 v202, 11264, v202
    v_lshl_add_u32 v15, v203, 4, v202
    v_xor_b32 v16, 64, v15
    v_and_b32 v202, 15, v2
    v_add_u32 v202, 1, v202
    v_and_b32 v203, 1, v202
    v_mul_u32_u24 v203, 4160, v203
    v_lshrrev_b32 v202, 1, v202
    v_lshl_add_u32 v203, v202, 2, v203
    v_lshrrev_b32 v204, 4, v2
    v_lshl_add_u32 v203, v204, 4, v203
    v_add_u32 v236, s74, v203
    v_add_u32 v237, 1024, v236
    v_add_u32 v238, 1024, v237
    v_add_u32 v239, 1024, v238
    s_waitcnt lgkmcnt(0)
    s_waitcnt vmcnt(0)
    v_lshlrev_b32 v9, 16, v9
    v_lshlrev_b32 v208, 16, v212
    v_add_f32 v9, v9, v208
    v_cvt_pk_bf16_f32 v9, v9, v9
    ds_write_b16 v242, v9 offset:4160
    ds_write_b16 v242, v9 offset:2
    v_alignbit_b32 v212, v213, v212, 16
    v_alignbit_b32 v213, v214, v213, 16
    v_alignbit_b32 v214, v215, v214, 16
    v_alignbit_b32 v215, v216, v215, 16
    ds_write_b128 v241, v[212:215] offset:4192
    v_alignbit_b32 v218, v219, v218, 16
    v_alignbit_b32 v219, v220, v219, 16
    v_alignbit_b32 v220, v221, v220, 16
    v_alignbit_b32 v221, v222, v221, 16
    ds_write_b128 v241, v[218:221] offset:5216
    v_alignbit_b32 v224, v225, v224, 16
    v_alignbit_b32 v225, v226, v225, 16
    v_alignbit_b32 v226, v227, v226, 16
    v_alignbit_b32 v227, v228, v227, 16
    ds_write_b128 v241, v[224:227] offset:6240
    v_alignbit_b32 v230, v231, v230, 16
    v_alignbit_b32 v231, v232, v231, 16
    v_alignbit_b32 v232, v233, v232, 16
    v_alignbit_b32 v233, v234, v233, 16
    ds_write_b128 v241, v[230:233] offset:7264
    v_and_b32 v202, 15, v2
    v_lshlrev_b32 v202, 1, v202
    v_sub_u32 v202, v202, v204
    v_add_u32 v202, 17, v202
    v_bfe_u32 v203, v202, 1, 3
    v_xor_b32 v203, s3, v203
    v_lshlrev_b32 v203, 4, v203
    v_lshl_add_u32 v244, v202, 7, v203
    v_and_b32 v202, 15, v2
    v_lshlrev_b32 v202, 1, v202
    v_sub_u32 v202, v202, v204
    v_add_u32 v202, 13, v202
    v_bfe_u32 v203, v202, 1, 3
    v_xor_b32 v203, s3, v203
    v_lshlrev_b32 v203, 4, v203
    v_lshl_add_u32 v245, v202, 7, v203
    v_and_b32 v202, 15, v2
    v_lshlrev_b32 v202, 1, v202
    v_sub_u32 v202, v202, v204
    v_add_u32 v202, 9, v202
    v_bfe_u32 v203, v202, 1, 3
    v_xor_b32 v203, s3, v203
    v_lshlrev_b32 v203, 4, v203
    v_lshl_add_u32 v246, v202, 7, v203
    v_and_b32 v202, 15, v2
    v_lshlrev_b32 v202, 1, v202
    v_sub_u32 v202, v202, v204
    v_add_u32 v202, 5, v202
    v_bfe_u32 v203, v202, 1, 3
    v_xor_b32 v203, s3, v203
    v_lshlrev_b32 v203, 4, v203
    v_lshl_add_u32 v247, v202, 7, v203
    v_and_b32 v202, 15, v2
    v_lshlrev_b32 v202, 5, v202
    v_lshl_add_u32 v8, v204, 3, v202
    s_mul_i32 s7, s3, 589824
    s_lshl_b32 s8, s69, 8
    s_add_u32 s7, s7, s8
    s_add_u32 s10, s7, 2359296
    s_lshl_b32 s9, s3, 13
    s_add_u32 s9, s9, 4096
    s_lshl1_add_u32 s4, s69, 0
    s_mul_i32 s5, s4, 9363
    s_lshr_b32 s5, s5, 16
    s_mul_i32 s7, s5, 7
    s_sub_u32 s7, s4, s7
    s_cmp_gt_u32 s7, 2
    s_addc_u32 s4, s4, s5
    s_lshl_b32 s4, s4, 7
    s_mul_i32 s7, s3, 720896
    s_add_u32 s4, s4, s7
    s_add_u32 s10, s4, 39469056
    s_lshl1_add_u32 s4, s69, 1
    s_mul_i32 s5, s4, 9363
    s_lshr_b32 s5, s5, 16
    s_mul_i32 s7, s5, 7
    s_sub_u32 s7, s4, s7
    s_cmp_gt_u32 s7, 2
    s_addc_u32 s4, s4, s5
    s_lshl_b32 s4, s4, 7
    s_mul_i32 s7, s3, 720896
    s_add_u32 s4, s4, s7
    s_add_u32 s11, s4, 39469056
    ds_read2_b32 v[64:65], v236 offset0:0 offset1:1
    ds_read2_b32 v[66:67], v236 offset0:2 offset1:3
    ds_read2_b32 v[68:69], v236 offset0:128 offset1:129
    ds_read2_b32 v[70:71], v236 offset0:130 offset1:131
    ds_read2_b32 v[72:73], v237 offset0:0 offset1:1
    ds_read2_b32 v[74:75], v237 offset0:2 offset1:3
    ds_read2_b32 v[76:77], v237 offset0:128 offset1:129
    ds_read2_b32 v[78:79], v237 offset0:130 offset1:131
    ds_read2_b32 v[80:81], v238 offset0:0 offset1:1
    ds_read2_b32 v[82:83], v238 offset0:2 offset1:3
    ds_read2_b32 v[84:85], v238 offset0:128 offset1:129
    ds_read2_b32 v[86:87], v238 offset0:130 offset1:131
    ds_read2_b32 v[88:89], v239 offset0:0 offset1:1
    ds_read2_b32 v[90:91], v239 offset0:2 offset1:3
    ds_read2_b32 v[92:93], v239 offset0:128 offset1:129
    ds_read2_b32 v[94:95], v239 offset0:130 offset1:131
    v_mov_b32 v29, 0
    buffer_atomic_add v29, v28, s[44:47], 0 offen sc0 sc1
    s_waitcnt vmcnt(0)
    v_cmp_ne_u32 vcc, s68, v29
    s_cbranch_vccnz L_rs_p1X
L_ok_p1X:
    s_add_u32 m0, s9, 0
    s_add_u32 s13, s10, 0
    buffer_load_dwordx4 v15, s[44:47], s13 offen sc1 lds
    s_add_u32 m0, s9, 1024
    s_add_u32 s13, s10, 90112
    buffer_load_dwordx4 v16, s[44:47], s13 offen sc1 lds
    s_add_u32 m0, s9, 2048
    s_add_u32 s13, s10, 180224
    buffer_load_dwordx4 v15, s[44:47], s13 offen sc1 lds
    s_add_u32 m0, s9, 3072
    s_add_u32 s13, s10, 270336
    buffer_load_dwordx4 v16, s[44:47], s13 offen sc1 lds
    s_add_u32 m0, s9, 4096
    s_add_u32 s13, s10, 360448
L_pl_X_1:
    s_cbranch_execz L_pl_X_5
    buffer_load_dwordx4 v15, s[44:47], s13 offen sc1 lds
    s_add_u32 m0, s9, 5120
    s_add_u32 s13, s10, 450560
    buffer_load_dwordx4 v16, s[44:47], s13 offen sc1 lds
    s_add_u32 m0, s9, 6144
    s_add_u32 s13, s10, 540672
    buffer_load_dwordx4 v15, s[44:47], s13 offen sc1 lds
    s_add_u32 m0, s9, 7168
    s_add_u32 s13, s10, 630784
    buffer_load_dwordx4 v16, s[44:47], s13 offen sc1 lds
    s_mov_b64 exec, 0
    s_call_b64 s[82:83], L_wc_D
    s_mov_b64 exec, -1
    s_mov_b32 s60, s36
    s_and_b32 s61, s37, 0xffff
    s_mov_b32 s62, 4096
    s_mov_b32 s63, 0x20000
    v_and_b32 v24, 15, v2
    s_lshl_b32 s7, s71, 6
    v_add_u32 v24, s7, v24
    s_and_b32 s8, s3, 1
    s_lshl_b32 s4, s8, 5
    v_add_u32 v25, s4, v24
    v_lshlrev_b32 v26, 3, v25
    v_mul_u32_u24 v25, 1152, v25
    v_bfe_u32 v31, v2, 4, 1
    v_lshl_add_u32 v25, v31, 5, v25
    v_lshrrev_b32 v31, 5, v2
    v_lshl_add_u32 v25, v31, 4, v25
    s_bfe_u32 s7, s2, 0x20003
    s_mul_i32 s7, s7, 288
    s_lshl_b32 s4, s72, 6
    s_add_u32 s4, s4, s7
    v_add_u32 v252, s4, v25
    s_xor_b32 s8, s3, s72
    s_and_b32 s4, s72, 1
    s_lshl1_add_u32 s4, s4, s8
    v_lshl_add_u32 v24, s4, 4, v24
    s_add_u32 s7, s7, 256
    s_cmp_lt_u32 s8, 2
    s_cselect_b32 s7, s7, 0x40000000
    v_lshlrev_b32 v18, 3, v24
    v_mul_u32_u24 v24, 1152, v24
    v_lshrrev_b32 v31, 4, v2
    v_lshl_add_u32 v24, v31, 3, v24
    v_add_u32 v253, s7, v24
    v_lshrrev_b32 v24, 3, v2
    v_and_b32 v25, 7, v2
    v_bfe_u32 v31, v2, 4, 2
    v_lshlrev_b32 v31, 1, v31
    v_xor_b32 v25, v25, v31
    v_lshlrev_b32 v24, 12, v24
    v_lshl_add_u32 v24, v25, 4, v24
    s_mul_i32 s7, s72, 36
    s_bitcmp1_b32 s3, 0
    s_addc_u32 s7, s7, 0
    s_lshl_b32 s7, s7, 17
    s_lshl_b32 s8, s71, 7
    s_add_u32 s7, s7, s8
    v_add_u32 v4, s7, v24
    v_add_u32 v5, 31744, v4
    v_add_u32 v6, 31744, v5
    v_add_u32 v7, 31744, v6
    v_lshrrev_b32 v24, 2, v2
    v_lshlrev_b32 v24, 7, v24
    v_and_b32 v25, 3, v2
    v_lshl_add_u32 v24, v25, 3, v24
    s_and_b32 s7, s73, 8192
    v_add_u32 v24, s7, v24
    v_bfe_u32 v31, v2, 3, 2
    s_and_b32 s7, s3, 1
    s_lshl_b32 s7, s7, 1
    v_xor_b32 v31, s7, v31
    v_lshl_add_u32 v10, v31, 5, v24
    v_xor_b32 v11, 32, v10
    v_and_b32 v24, 15, v2
    v_lshrrev_b32 v25, 4, v2
    v_mul_u32_u24 v25, 17408, v25
    v_lshl_add_u32 v24, v24, 4, v25
    s_mul_i32 s7, s72, 36
    s_and_b32 s8, s3, 1
    s_add_u32 s7, s7, s8
    s_mul_i32 s7, s7, 69632
    s_bfe_u32 s8, s2, 0x20003
    s_lshl_b32 s8, s8, 12
    s_add_u32 s7, s7, s8
    s_add_u32 s7, s7, 12795904
    v_add_u32 v23, s7, v24
    s_xor_b32 s7, s72, 0
    v_lshl_add_u32 v19, s7, 10, v23
    s_xor_b32 s7, s72, 1
    v_lshl_add_u32 v20, s7, 10, v23
    s_xor_b32 s7, s72, 2
    v_lshl_add_u32 v21, s7, 10, v23
    s_xor_b32 s7, s72, 3
    v_lshl_add_u32 v22, s7, 10, v23
    v_lshlrev_b32 v14, 4, v2
    v_add_u32 v14, 98304, v14
    v_add_u32 v1, 0x10000, v14
    s_bitcmp1_b32 s3, 1
    s_cselect_b32 s18, s85, s84
    s_mul_i32 s18, s18, 139264
    s_cselect_b32 s19, s87, s86
    s_mul_i32 s19, s19, 139264
    s_cselect_b32 s20, s89, s88
    s_mul_i32 s20, s20, 139264
    s_cselect_b32 s21, s91, s90
    s_mul_i32 s21, s21, 139264
    s_cselect_b32 s22, s93, s92
    s_mul_i32 s22, s22, 139264
    s_cselect_b32 s23, s95, s94
    s_mul_i32 s23, s23, 139264
    s_cselect_b32 s24, s97, s96
    s_mul_i32 s24, s24, 139264
    s_cselect_b32 s25, s99, s98
    s_mul_i32 s25, s25, 139264
    s_cselect_b32 s26, s101, s100
    s_mul_i32 s26, s26, 139264
    v_add_u32 v10, 131072, v10
    v_add_u32 v11, 131072, v11
    s_waitcnt vmcnt(0) lgkmcnt(0)
    s_barrier
    ds_read_b128 v[96:99], v244 offset:2048
    ds_read_b128 v[100:103], v244 offset:6144
    ds_read_b128 v[104:107], v244 offset:10240
    ds_read_b128 v[108:111], v244 offset:14336
    ds_read_b128 v[112:115], v244 offset:18432
    ds_read_b128 v[116:119], v244 offset:22528
    ds_read_b128 v[120:123], v244 offset:26624
    ds_read_b128 v[124:127], v244 offset:30720
    s_waitcnt lgkmcnt(0)
    v_mfma_f32_16x16x32_bf16 v[32:35], v[64:67], v[96:99], 0
    s_lshl_b32 s14, s84, 18
    ds_read_b128 v[160:163], v245 offset:2048
    v_mfma_f32_16x16x32_bf16 v[36:39], v[68:71], v[96:99], 0
    s_add_u32 m0, s73, 147456
    v_mfma_f32_16x16x32_bf16 v[36:39], v[64:67], v[100:103], v[36:39]
    buffer_load_dwordx4 v4, s[52:55], s14 offen offset:0 lds
    ds_read2_b32 v[128:129], v236 offset0:16 offset1:17
    v_mfma_f32_16x16x32_bf16 v[40:43], v[64:67], v[104:107], 0
    ds_read2_b32 v[130:131], v236 offset0:18 offset1:19
    v_mfma_f32_16x16x32_bf16 v[40:43], v[68:71], v[100:103], v[40:43]
    v_mfma_f32_16x16x32_bf16 v[40:43], v[72:75], v[96:99], v[40:43]
    ds_read_b128 v[164:167], v245 offset:6144
    v_mfma_f32_16x16x32_bf16 v[44:47], v[76:79], v[96:99], 0
    ds_read2_b32 v[132:133], v236 offset0:144 offset1:145
    v_mfma_f32_16x16x32_bf16 v[44:47], v[72:75], v[100:103], v[44:47]
    s_add_u32 s13, s12, 16384
    v_mfma_f32_16x16x32_bf16 v[44:47], v[68:71], v[104:107], v[44:47]
    ds_read2_b32 v[134:135], v236 offset0:146 offset1:147
    v_mfma_f32_16x16x32_bf16 v[44:47], v[64:67], v[108:111], v[44:47]
    s_add_u32 m0, s74, 8352
    ds_read_b128 v[168:171], v245 offset:10240
    v_mfma_f32_16x16x32_bf16 v[48:51], v[64:67], v[112:115], 0
    buffer_load_dwordx4 v240, s[48:51], s13 offen offset:0 lds
    ds_read2_b32 v[136:137], v237 offset0:16 offset1:17
    v_mfma_f32_16x16x32_bf16 v[48:51], v[68:71], v[108:111], v[48:51]
    v_mfma_f32_16x16x32_bf16 v[48:51], v[72:75], v[104:107], v[48:51]
    s_add_u32 m0, s73, 147456
    ds_read2_b32 v[138:139], v237 offset0:18 offset1:19
    v_mfma_f32_16x16x32_bf16 v[48:51], v[76:79], v[100:103], v[48:51]
    buffer_load_dwordx4 v5, s[52:55], s14 offen offset:1024 lds
    ds_read_b128 v[172:175], v245 offset:14336
    v_mfma_f32_16x16x32_bf16 v[48:51], v[80:83], v[96:99], v[48:51]
    v_mfma_f32_16x16x32_bf16 v[52:55], v[84:87], v[96:99], 0
    ds_read2_b32 v[140:141], v237 offset0:144 offset1:145
    v_mfma_f32_16x16x32_bf16 v[52:55], v[80:83], v[100:103], v[52:55]
    s_add_u32 m0, s74, 8352
    ds_read2_b32 v[142:143], v237 offset0:146 offset1:147
    v_mfma_f32_16x16x32_bf16 v[52:55], v[76:79], v[104:107], v[52:55]
    buffer_load_dwordx4 v240, s[48:51], s13 offen offset:1024 lds
    v_mfma_f32_16x16x32_bf16 v[52:55], v[72:75], v[108:111], v[52:55]
    ds_read_b128 v[176:179], v245 offset:18432
    v_mfma_f32_16x16x32_bf16 v[52:55], v[68:71], v[112:115], v[52:55]
    ds_read2_b32 v[144:145], v238 offset0:16 offset1:17
    v_mfma_f32_16x16x32_bf16 v[52:55], v[64:67], v[116:119], v[52:55]
    v_mfma_f32_16x16x32_bf16 v[56:59], v[64:67], v[120:123], 0
    ds_read2_b32 v[146:147], v238 offset0:18 offset1:19
    v_mfma_f32_16x16x32_bf16 v[56:59], v[68:71], v[116:119], v[56:59]
    ds_read_b128 v[180:183], v245 offset:22528
    v_mfma_f32_16x16x32_bf16 v[56:59], v[72:75], v[112:115], v[56:59]
    v_mfma_f32_16x16x32_bf16 v[56:59], v[76:79], v[108:111], v[56:59]
    s_add_u32 m0, s73, 147456
    ds_read2_b32 v[148:149], v238 offset0:144 offset1:145
    v_mfma_f32_16x16x32_bf16 v[56:59], v[80:83], v[104:107], v[56:59]
    buffer_load_dwordx4 v6, s[52:55], s14 offen offset:2048 lds
    ds_read2_b32 v[150:151], v238 offset0:146 offset1:147
    v_mfma_f32_16x16x32_bf16 v[56:59], v[84:87], v[100:103], v[56:59]
    s_add_u32 m0, s74, 8352
    ds_read_b128 v[184:187], v245 offset:26624
    v_mfma_f32_16x16x32_bf16 v[56:59], v[88:91], v[96:99], v[56:59]
    buffer_load_dwordx4 v240, s[48:51], s13 offen offset:2048 lds
    v_mfma_f32_16x16x32_bf16 v[60:63], v[92:95], v[96:99], 0
    ds_read2_b32 v[152:153], v239 offset0:16 offset1:17
    v_mfma_f32_16x16x32_bf16 v[60:63], v[88:91], v[100:103], v[60:63]
    ds_read2_b32 v[154:155], v239 offset0:18 offset1:19
    v_mfma_f32_16x16x32_bf16 v[60:63], v[84:87], v[104:107], v[60:63]
    v_mfma_f32_16x16x32_bf16 v[60:63], v[80:83], v[108:111], v[60:63]
    ds_read_b128 v[188:191], v245 offset:30720
    v_mfma_f32_16x16x32_bf16 v[60:63], v[76:79], v[112:115], v[60:63]
    s_add_u32 m0, s74, 8352
    ds_read2_b32 v[156:157], v239 offset0:144 offset1:145
    v_mfma_f32_16x16x32_bf16 v[60:63], v[72:75], v[116:119], v[60:63]
    buffer_load_dwordx4 v240, s[48:51], s13 offen offset:3072 lds
    v_mfma_f32_16x16x32_bf16 v[60:63], v[68:71], v[120:123], v[60:63]
    ds_read2_b32 v[158:159], v239 offset0:146 offset1:147
    v_mfma_f32_16x16x32_bf16 v[60:63], v[64:67], v[124:127], v[60:63]
    s_waitcnt lgkmcnt(12)
    v_mfma_f32_16x16x32_bf16 v[32:35], v[128:131], v[160:163], v[32:35]
    s_add_u32 m0, s73, 147456
    ds_read_b128 v[96:99], v246 offset:2048
    v_mfma_f32_16x16x32_bf16 v[36:39], v[132:135], v[160:163], v[36:39]
    buffer_load_dwordx4 v7, s[52:55], s14 offen offset:3072 lds
    v_mfma_f32_16x16x32_bf16 v[36:39], v[128:131], v[164:167], v[36:39]
    ds_read2_b32 v[64:65], v236 offset0:32 offset1:33
    v_mfma_f32_16x16x32_bf16 v[40:43], v[128:131], v[168:171], v[40:43]
    ds_read2_b32 v[66:67], v236 offset0:34 offset1:35
    v_mfma_f32_16x16x32_bf16 v[40:43], v[132:135], v[164:167], v[40:43]
    v_mfma_f32_16x16x32_bf16 v[40:43], v[136:139], v[160:163], v[40:43]
    ds_read_b128 v[100:103], v246 offset:6144
    v_mfma_f32_16x16x32_bf16 v[44:47], v[140:143], v[160:163], v[44:47]
    ds_read2_b32 v[68:69], v236 offset0:160 offset1:161
    v_mfma_f32_16x16x32_bf16 v[44:47], v[136:139], v[164:167], v[44:47]
    v_mfma_f32_16x16x32_bf16 v[44:47], v[132:135], v[168:171], v[44:47]
    ds_read2_b32 v[70:71], v236 offset0:162 offset1:163
    v_mfma_f32_16x16x32_bf16 v[44:47], v[128:131], v[172:175], v[44:47]
    ds_read_b128 v[104:107], v246 offset:10240
    s_waitcnt lgkmcnt(7)
    v_mfma_f32_16x16x32_bf16 v[48:51], v[128:131], v[176:179], v[48:51]
    ds_read2_b32 v[72:73], v237 offset0:32 offset1:33
    v_mfma_f32_16x16x32_bf16 v[48:51], v[132:135], v[172:175], v[48:51]
    ds_read2_b32 v[74:75], v237 offset0:34 offset1:35
    v_mfma_f32_16x16x32_bf16 v[48:51], v[136:139], v[168:171], v[48:51]
    v_mov_b32 v9, 8
    buffer_load_ushort v9, v9, s[56:59], s70 offen
    v_mfma_f32_16x16x32_bf16 v[48:51], v[140:143], v[164:167], v[48:51]
    ds_read_b128 v[108:111], v246 offset:14336
    v_mfma_f32_16x16x32_bf16 v[48:51], v[144:147], v[160:163], v[48:51]
    v_mfma_f32_16x16x32_bf16 v[52:55], v[148:151], v[160:163], v[52:55]
    ds_read2_b32 v[76:77], v237 offset0:160 offset1:161
    v_mfma_f32_16x16x32_bf16 v[52:55], v[144:147], v[164:167], v[52:55]
    ds_read2_b32 v[78:79], v237 offset0:162 offset1:163
    v_mfma_f32_16x16x32_bf16 v[52:55], v[140:143], v[168:171], v[52:55]
    v_mfma_f32_16x16x32_bf16 v[52:55], v[136:139], v[172:175], v[52:55]
    ds_read_b128 v[112:115], v246 offset:18432
    v_mfma_f32_16x16x32_bf16 v[52:55], v[132:135], v[176:179], v[52:55]
    ds_read2_b32 v[80:81], v238 offset0:32 offset1:33
    v_mfma_f32_16x16x32_bf16 v[52:55], v[128:131], v[180:183], v[52:55]
    v_mfma_f32_16x16x32_bf16 v[56:59], v[128:131], v[184:187], v[56:59]
    ds_read2_b32 v[82:83], v238 offset0:34 offset1:35
    v_mfma_f32_16x16x32_bf16 v[56:59], v[132:135], v[180:183], v[56:59]
    ds_read_b128 v[116:119], v246 offset:22528
    v_mfma_f32_16x16x32_bf16 v[56:59], v[136:139], v[176:179], v[56:59]
    v_mfma_f32_16x16x32_bf16 v[56:59], v[140:143], v[172:175], v[56:59]
    ds_read2_b32 v[84:85], v238 offset0:160 offset1:161
    v_mfma_f32_16x16x32_bf16 v[56:59], v[144:147], v[168:171], v[56:59]
    ds_read2_b32 v[86:87], v238 offset0:162 offset1:163
    v_mfma_f32_16x16x32_bf16 v[56:59], v[148:151], v[164:167], v[56:59]
    ds_read_b128 v[120:123], v246 offset:26624
    v_mfma_f32_16x16x32_bf16 v[56:59], v[152:155], v[160:163], v[56:59]
    v_mfma_f32_16x16x32_bf16 v[60:63], v[156:159], v[160:163], v[60:63]
    ds_read2_b32 v[88:89], v239 offset0:32 offset1:33
    v_mfma_f32_16x16x32_bf16 v[60:63], v[152:155], v[164:167], v[60:63]
    ds_read2_b32 v[90:91], v239 offset0:34 offset1:35
    v_mfma_f32_16x16x32_bf16 v[60:63], v[148:151], v[168:171], v[60:63]
    v_mfma_f32_16x16x32_bf16 v[60:63], v[144:147], v[172:175], v[60:63]
    ds_read_b128 v[124:127], v246 offset:30720
    v_mfma_f32_16x16x32_bf16 v[60:63], v[140:143], v[176:179], v[60:63]
    ds_read2_b32 v[92:93], v239 offset0:160 offset1:161
    v_mfma_f32_16x16x32_bf16 v[60:63], v[136:139], v[180:183], v[60:63]
    v_mfma_f32_16x16x32_bf16 v[60:63], v[132:135], v[184:187], v[60:63]
    ds_read2_b32 v[94:95], v239 offset0:162 offset1:163
    v_mfma_f32_16x16x32_bf16 v[60:63], v[128:131], v[188:191], v[60:63]
    s_waitcnt lgkmcnt(12)
    v_mfma_f32_16x16x32_bf16 v[32:35], v[64:67], v[96:99], v[32:35]
    s_lshl_b32 s14, s85, 18
    ds_read_b128 v[160:163], v247 offset:2048
    v_mfma_f32_16x16x32_bf16 v[36:39], v[68:71], v[96:99], v[36:39]
    s_add_u32 m0, s73, 49152
    v_mfma_f32_16x16x32_bf16 v[36:39], v[64:67], v[100:103], v[36:39]
    buffer_load_dwordx4 v4, s[52:55], s14 offen offset:0 lds
    ds_read2_b32 v[128:129], v236 offset0:48 offset1:49
    v_mfma_f32_16x16x32_bf16 v[40:43], v[64:67], v[104:107], v[40:43]
    ds_read2_b32 v[130:131], v236 offset0:50 offset1:51
    v_mfma_f32_16x16x32_bf16 v[40:43], v[68:71], v[100:103], v[40:43]
    v_mfma_f32_16x16x32_bf16 v[40:43], v[72:75], v[96:99], v[40:43]
    ds_read_b128 v[164:167], v247 offset:6144
    v_mfma_f32_16x16x32_bf16 v[44:47], v[76:79], v[96:99], v[44:47]
    ds_read2_b32 v[132:133], v236 offset0:176 offset1:177
    v_mfma_f32_16x16x32_bf16 v[44:47], v[72:75], v[100:103], v[44:47]
    v_mfma_f32_16x16x32_bf16 v[44:47], v[68:71], v[104:107], v[44:47]
    ds_read2_b32 v[134:135], v236 offset0:178 offset1:179
    v_mfma_f32_16x16x32_bf16 v[44:47], v[64:67], v[108:111], v[44:47]
    ds_read_b128 v[168:171], v247 offset:10240
    s_waitcnt lgkmcnt(7)
    v_mfma_f32_16x16x32_bf16 v[48:51], v[64:67], v[112:115], v[48:51]
    ds_read2_b32 v[136:137], v237 offset0:48 offset1:49
    v_mfma_f32_16x16x32_bf16 v[48:51], v[68:71], v[108:111], v[48:51]
    v_mfma_f32_16x16x32_bf16 v[48:51], v[72:75], v[104:107], v[48:51]
    s_add_u32 m0, s73, 49152
    ds_read2_b32 v[138:139], v237 offset0:50 offset1:51
    v_mfma_f32_16x16x32_bf16 v[48:51], v[76:79], v[100:103], v[48:51]
    buffer_load_dwordx4 v5, s[52:55], s14 offen offset:1024 lds
    ds_read_b128 v[172:175], v247 offset:14336
    v_mfma_f32_16x16x32_bf16 v[48:51], v[80:83], v[96:99], v[48:51]
    v_mfma_f32_16x16x32_bf16 v[52:55], v[84:87], v[96:99], v[52:55]
    ds_read2_b32 v[140:141], v237 offset0:176 offset1:177
    v_mfma_f32_16x16x32_bf16 v[52:55], v[80:83], v[100:103], v[52:55]
    ds_read2_b32 v[142:143], v237 offset0:178 offset1:179
    v_mfma_f32_16x16x32_bf16 v[52:55], v[76:79], v[104:107], v[52:55]
    v_mfma_f32_16x16x32_bf16 v[52:55], v[72:75], v[108:111], v[52:55]
    ds_read_b128 v[176:179], v247 offset:18432
    v_mfma_f32_16x16x32_bf16 v[52:55], v[68:71], v[112:115], v[52:55]
    ds_read2_b32 v[144:145], v238 offset0:48 offset1:49
    v_mfma_f32_16x16x32_bf16 v[52:55], v[64:67], v[116:119], v[52:55]
    v_mfma_f32_16x16x32_bf16 v[56:59], v[64:67], v[120:123], v[56:59]
    ds_read2_b32 v[146:147], v238 offset0:50 offset1:51
    v_mfma_f32_16x16x32_bf16 v[56:59], v[68:71], v[116:119], v[56:59]
    ds_read_b128 v[180:183], v247 offset:22528
    v_mfma_f32_16x16x32_bf16 v[56:59], v[72:75], v[112:115], v[56:59]
    v_mfma_f32_16x16x32_bf16 v[56:59], v[76:79], v[108:111], v[56:59]
    s_add_u32 m0, s73, 49152
    ds_read2_b32 v[148:149], v238 offset0:176 offset1:177
    v_mfma_f32_16x16x32_bf16 v[56:59], v[80:83], v[104:107], v[56:59]
    buffer_load_dwordx4 v6, s[52:55], s14 offen offset:2048 lds
    ds_read2_b32 v[150:151], v238 offset0:178 offset1:179
    v_mfma_f32_16x16x32_bf16 v[56:59], v[84:87], v[100:103], v[56:59]
    ds_read_b128 v[184:187], v247 offset:26624
    v_mfma_f32_16x16x32_bf16 v[56:59], v[88:91], v[96:99], v[56:59]
    v_mfma_f32_16x16x32_bf16 v[60:63], v[92:95], v[96:99], v[60:63]
    ds_read2_b32 v[152:153], v239 offset0:48 offset1:49
    v_mfma_f32_16x16x32_bf16 v[60:63], v[88:91], v[100:103], v[60:63]
    ds_read2_b32 v[154:155], v239 offset0:50 offset1:51
    v_mfma_f32_16x16x32_bf16 v[60:63], v[84:87], v[104:107], v[60:63]
    v_mfma_f32_16x16x32_bf16 v[60:63], v[80:83], v[108:111], v[60:63]
    ds_read_b128 v[188:191], v247 offset:30720
    v_mfma_f32_16x16x32_bf16 v[60:63], v[76:79], v[112:115], v[60:63]
    ds_read2_b32 v[156:157], v239 offset0:176 offset1:177
    v_mfma_f32_16x16x32_bf16 v[60:63], v[72:75], v[116:119], v[60:63]
    v_mfma_f32_16x16x32_bf16 v[60:63], v[68:71], v[120:123], v[60:63]
    ds_read2_b32 v[158:159], v239 offset0:178 offset1:179
    v_mfma_f32_16x16x32_bf16 v[60:63], v[64:67], v[124:127], v[60:63]
    s_waitcnt lgkmcnt(12)
    v_mfma_f32_16x16x32_bf16 v[32:35], v[128:131], v[160:163], v[32:35]
    s_add_u32 m0, s73, 49152
    ds_read_b128 v[96:99], v244 offset:0
    v_mfma_f32_16x16x32_bf16 v[36:39], v[132:135], v[160:163], v[36:39]
    buffer_load_dwordx4 v7, s[52:55], s14 offen offset:3072 lds
    v_mfma_f32_16x16x32_bf16 v[36:39], v[128:131], v[164:167], v[36:39]
    ds_read2_b32 v[64:65], v236 offset0:64 offset1:65
    v_mfma_f32_16x16x32_bf16 v[40:43], v[128:131], v[168:171], v[40:43]
    ds_read2_b32 v[66:67], v236 offset0:66 offset1:67
    v_mfma_f32_16x16x32_bf16 v[40:43], v[132:135], v[164:167], v[40:43]
    v_mfma_f32_16x16x32_bf16 v[40:43], v[136:139], v[160:163], v[40:43]
    ds_read_b128 v[100:103], v244 offset:4096
    v_mfma_f32_16x16x32_bf16 v[44:47], v[140:143], v[160:163], v[44:47]
    ds_read2_b32 v[68:69], v236 offset0:192 offset1:193
    v_mfma_f32_16x16x32_bf16 v[44:47], v[136:139], v[164:167], v[44:47]
    v_mfma_f32_16x16x32_bf16 v[44:47], v[132:135], v[168:171], v[44:47]
    ds_read2_b32 v[70:71], v236 offset0:194 offset1:195
    v_mfma_f32_16x16x32_bf16 v[44:47], v[128:131], v[172:175], v[44:47]
    ds_read_b128 v[104:107], v244 offset:8192
    s_waitcnt lgkmcnt(7)
    v_mfma_f32_16x16x32_bf16 v[48:51], v[128:131], v[176:179], v[48:51]
    ds_read2_b32 v[72:73], v237 offset0:64 offset1:65
    v_mfma_f32_16x16x32_bf16 v[48:51], v[132:135], v[172:175], v[48:51]
    ds_read2_b32 v[74:75], v237 offset0:66 offset1:67
    v_mfma_f32_16x16x32_bf16 v[48:51], v[136:139], v[168:171], v[48:51]
    ds_read_b128 v[108:111], v244 offset:12288
    v_mfma_f32_16x16x32_bf16 v[48:51], v[140:143], v[164:167], v[48:51]
    ds_read2_b32 v[76:77], v237 offset0:192 offset1:193
    v_mfma_f32_16x16x32_bf16 v[48:51], v[144:147], v[160:163], v[48:51]
    ds_read2_b32 v[78:79], v237 offset0:194 offset1:195
    v_mfma_f32_16x16x32_bf16 v[52:55], v[148:151], v[160:163], v[52:55]
    ds_read_b128 v[112:115], v244 offset:16384
    v_mfma_f32_16x16x32_bf16 v[52:55], v[144:147], v[164:167], v[52:55]
    ds_read2_b32 v[80:81], v238 offset0:64 offset1:65
    v_mfma_f32_16x16x32_bf16 v[52:55], v[140:143], v[168:171], v[52:55]
    ds_read2_b32 v[82:83], v238 offset0:66 offset1:67
    v_mfma_f32_16x16x32_bf16 v[52:55], v[136:139], v[172:175], v[52:55]
    ds_read_b128 v[116:119], v244 offset:20480
    v_mfma_f32_16x16x32_bf16 v[52:55], v[132:135], v[176:179], v[52:55]
    ds_read2_b32 v[84:85], v238 offset0:192 offset1:193
    v_mfma_f32_16x16x32_bf16 v[52:55], v[128:131], v[180:183], v[52:55]
    ds_read2_b32 v[86:87], v238 offset0:194 offset1:195
    v_mfma_f32_16x16x32_bf16 v[56:59], v[128:131], v[184:187], v[56:59]
    ds_read_b128 v[120:123], v244 offset:24576
    s_waitcnt vmcnt(5)
    s_barrier
    v_mfma_f32_16x16x32_bf16 v[56:59], v[132:135], v[180:183], v[56:59]
    ds_read2_b32 v[88:89], v239 offset0:64 offset1:65
    v_mfma_f32_16x16x32_bf16 v[56:59], v[136:139], v[176:179], v[56:59]
    ds_read_b64_tr_b16 a[0:1], v10 offset:16384
    v_mfma_f32_16x16x32_bf16 v[56:59], v[140:143], v[172:175], v[56:59]
    ds_read_b64_tr_b16 a[2:3], v10 offset:18432
    v_mfma_f32_16x16x32_bf16 v[56:59], v[144:147], v[168:171], v[56:59]
    ds_read_b64_tr_b16 a[8:9], v10 offset:20480
    v_mfma_f32_16x16x32_bf16 v[56:59], v[148:151], v[164:167], v[56:59]
    ds_read2_b32 v[90:91], v239 offset0:66 offset1:67
    v_mfma_f32_16x16x32_bf16 v[56:59], v[152:155], v[160:163], v[56:59]
    ds_read_b64_tr_b16 a[10:11], v10 offset:22528
    v_mfma_f32_16x16x32_bf16 v[60:63], v[156:159], v[160:163], v[60:63]
    ds_read_b64_tr_b16 a[4:5], v11 offset:16384
    v_mfma_f32_16x16x32_bf16 v[60:63], v[152:155], v[164:167], v[60:63]
    ds_read_b128 v[124:127], v244 offset:28672
    v_mfma_f32_16x16x32_bf16 v[60:63], v[148:151], v[168:171], v[60:63]
    ds_read_b64_tr_b16 a[6:7], v11 offset:18432
    v_mfma_f32_16x16x32_bf16 v[60:63], v[144:147], v[172:175], v[60:63]
    ds_read_b64_tr_b16 a[12:13], v11 offset:20480
    v_mfma_f32_16x16x32_bf16 v[60:63], v[140:143], v[176:179], v[60:63]
    ds_read2_b32 v[92:93], v239 offset0:192 offset1:193
    v_mfma_f32_16x16x32_bf16 v[60:63], v[136:139], v[180:183], v[60:63]
    ds_read_b64_tr_b16 a[14:15], v11 offset:22528
    v_mfma_f32_16x16x32_bf16 v[60:63], v[132:135], v[184:187], v[60:63]
    ds_read2_b32 v[94:95], v239 offset0:194 offset1:195
    v_mfma_f32_16x16x32_bf16 v[60:63], v[128:131], v[188:191], v[60:63]
    s_waitcnt lgkmcnt(15)
    v_mfma_f32_16x16x32_bf16 v[32:35], v[64:67], v[96:99], v[32:35]
    ds_read_b128 v[160:163], v245 offset:0
    s_waitcnt lgkmcnt(2)
    s_barrier
    v_mfma_f32_16x16x32_bf16 v[36:39], v[68:71], v[96:99], v[36:39]
    v_mfma_f32_16x16x32_bf16 v[36:39], v[64:67], v[100:103], v[36:39]
    ds_read2_b32 v[128:129], v236 offset0:80 offset1:81
    v_mfma_f32_16x16x32_bf16 v[40:43], v[64:67], v[104:107], v[40:43]
    s_lshl_b32 s14, s86, 18
    ds_read2_b32 v[130:131], v236 offset0:82 offset1:83
    v_mfma_f32_16x16x32_bf16 v[40:43], v[68:71], v[100:103], v[40:43]
    s_add_u32 m0, s73, 147456
    v_mfma_f32_16x16x32_bf16 v[40:43], v[72:75], v[96:99], v[40:43]
    buffer_load_dwordx4 v4, s[52:55], s14 offen offset:0 lds
    ds_read_b128 v[164:167], v245 offset:4096
    v_mfma_f32_16x16x32_bf16 v[44:47], v[76:79], v[96:99], v[44:47]
    ds_read2_b32 v[132:133], v236 offset0:208 offset1:209
    v_mfma_f32_16x16x32_bf16 v[44:47], v[72:75], v[100:103], v[44:47]
    v_mfma_f32_16x16x32_bf16 v[44:47], v[68:71], v[104:107], v[44:47]
    ds_read2_b32 v[134:135], v236 offset0:210 offset1:211
    v_mfma_f32_16x16x32_bf16 v[44:47], v[64:67], v[108:111], v[44:47]
    ds_read_b128 v[168:171], v245 offset:8192
    s_waitcnt lgkmcnt(7)
    v_mfma_f32_16x16x32_bf16 v[48:51], v[64:67], v[112:115], v[48:51]
    ds_read2_b32 v[136:137], v237 offset0:80 offset1:81
    v_mfma_f32_16x16x32_bf16 v[48:51], v[68:71], v[108:111], v[48:51]
    ds_read2_b32 v[138:139], v237 offset0:82 offset1:83
    v_mfma_f32_16x16x32_bf16 v[48:51], v[72:75], v[104:107], v[48:51]
    ds_read_b128 v[172:175], v245 offset:12288
    v_mfma_f32_16x16x32_bf16 v[48:51], v[76:79], v[100:103], v[48:51]
    ds_read2_b32 v[140:141], v237 offset0:208 offset1:209
    v_mfma_f32_16x16x32_bf16 v[48:51], v[80:83], v[96:99], v[48:51]
    ds_read2_b32 v[142:143], v237 offset0:210 offset1:211
    v_mfma_f32_16x16x32_bf16 v[52:55], v[84:87], v[96:99], v[52:55]
    ds_read_b128 v[176:179], v245 offset:16384
    v_mfma_f32_16x16x32_bf16 v[52:55], v[80:83], v[100:103], v[52:55]
    s_add_u32 m0, s73, 147456
    ds_read2_b32 v[144:145], v238 offset0:80 offset1:81
    v_mfma_f32_16x16x32_bf16 v[52:55], v[76:79], v[104:107], v[52:55]
    buffer_load_dwordx4 v5, s[52:55], s14 offen offset:1024 lds
    ds_read2_b32 v[146:147], v238 offset0:82 offset1:83
    v_mfma_f32_16x16x32_bf16 v[52:55], v[72:75], v[108:111], v[52:55]
    ds_read_b128 v[180:183], v245 offset:20480
    v_mfma_f32_16x16x32_bf16 v[52:55], v[68:71], v[112:115], v[52:55]
    ds_read_b128 v[212:215], v241 offset:8352
    v_mfma_f32_16x16x32_bf16 v[52:55], v[64:67], v[116:119], v[52:55]
    ds_read2_b32 v[148:149], v238 offset0:208 offset1:209
    v_mfma_f32_16x16x32_bf16 v[56:59], v[64:67], v[120:123], v[56:59]
    ds_read_b32 v216, v241 offset:8368
    v_mfma_f32_16x16x32_bf16 v[56:59], v[68:71], v[116:119], v[56:59]
    ds_read2_b32 v[150:151], v238 offset0:210 offset1:211
    v_mfma_f32_16x16x32_bf16 v[56:59], v[72:75], v[112:115], v[56:59]
    ds_read_b128 v[218:221], v241 offset:9376
    v_mfma_f32_16x16x32_bf16 v[56:59], v[76:79], v[108:111], v[56:59]
    ds_read_b128 v[184:187], v245 offset:24576
    v_mfma_f32_16x16x32_bf16 v[56:59], v[80:83], v[104:107], v[56:59]
    ds_read2_b32 v[152:153], v239 offset0:80 offset1:81
    v_mfma_f32_16x16x32_bf16 v[56:59], v[84:87], v[100:103], v[56:59]
    ds_read_b32 v222, v241 offset:9392
    v_mfma_f32_16x16x32_bf16 v[56:59], v[88:91], v[96:99], v[56:59]
    ds_read2_b32 v[154:155], v239 offset0:82 offset1:83
    v_mfma_f32_16x16x32_bf16 v[60:63], v[92:95], v[96:99], v[60:63]
    s_add_u32 m0, s73, 147456
    ds_read_b128 v[224:227], v241 offset:10400
    v_mfma_f32_16x16x32_bf16 v[60:63], v[88:91], v[100:103], v[60:63]
    buffer_load_dwordx4 v6, s[52:55], s14 offen offset:2048 lds
    ds_read_b128 v[188:191], v245 offset:28672
    v_mfma_f32_16x16x32_bf16 v[60:63], v[84:87], v[104:107], v[60:63]
    ds_read_b32 v228, v241 offset:10416
    v_mfma_f32_16x16x32_bf16 v[60:63], v[80:83], v[108:111], v[60:63]
    ds_read2_b32 v[156:157], v239 offset0:208 offset1:209
    v_mfma_f32_16x16x32_bf16 v[60:63], v[76:79], v[112:115], v[60:63]
    ds_read_b128 v[230:233], v241 offset:11424
    v_mfma_f32_16x16x32_bf16 v[60:63], v[72:75], v[116:119], v[60:63]
    ds_read2_b32 v[158:159], v239 offset0:210 offset1:211
    v_mfma_f32_16x16x32_bf16 v[60:63], v[68:71], v[120:123], v[60:63]
    ds_read_b32 v234, v241 offset:11440
    v_mfma_f32_16x16x32_bf16 v[60:63], v[64:67], v[124:127], v[60:63]
    s_waitcnt lgkmcnt(15)
    v_mfma_f32_16x16x32_bf16 v[32:35], v[128:131], v[160:163], v[32:35]
    ds_read_b128 v[96:99], v246 offset:0
    v_mfma_f32_16x16x32_bf16 v[36:39], v[132:135], v[160:163], v[36:39]
    ds_read2_b32 v[64:65], v236 offset0:96 offset1:97
    v_mfma_f32_16x16x32_bf16 v[36:39], v[128:131], v[164:167], v[36:39]
    ds_read2_b32 v[66:67], v236 offset0:98 offset1:99
    v_mfma_f32_16x16x32_bf16 v[40:43], v[128:131], v[168:171], v[40:43]
    s_add_u32 m0, s73, 147456
    ds_read_b128 v[100:103], v246 offset:4096
    v_mfma_f32_16x16x32_bf16 v[40:43], v[132:135], v[164:167], v[40:43]
    buffer_load_dwordx4 v7, s[52:55], s14 offen offset:3072 lds
    ds_read2_b32 v[68:69], v236 offset0:224 offset1:225
    s_waitcnt lgkmcnt(5)
    v_mfma_f32_16x16x32_bf16 v[40:43], v[136:139], v[160:163], v[40:43]
    ds_read2_b32 v[70:71], v236 offset0:226 offset1:227
    v_mfma_f32_16x16x32_bf16 v[44:47], v[140:143], v[160:163], v[44:47]
    s_waitcnt vmcnt(8)
    ds_read_b128 v[104:107], v246 offset:8192
    v_mfma_f32_16x16x32_bf16 v[44:47], v[136:139], v[164:167], v[44:47]
    ds_read2_b32 v[72:73], v237 offset0:96 offset1:97
    v_mfma_f32_16x16x32_bf16 v[44:47], v[132:135], v[168:171], v[44:47]
    ds_read2_b32 v[74:75], v237 offset0:98 offset1:99
    v_lshlrev_b32 v9, 16, v9
    v_mfma_f32_16x16x32_bf16 v[44:47], v[128:131], v[172:175], v[44:47]
    ds_read_b128 v[108:111], v246 offset:12288
    v_mfma_f32_16x16x32_bf16 v[48:51], v[128:131], v[176:179], v[48:51]
    ds_read2_b32 v[76:77], v237 offset0:224 offset1:225
    v_lshlrev_b32 v208, 16, v212
    v_mfma_f32_16x16x32_bf16 v[48:51], v[132:135], v[172:175], v[48:51]
    ds_read2_b32 v[78:79], v237 offset0:226 offset1:227
    v_mfma_f32_16x16x32_bf16 v[48:51], v[136:139], v[168:171], v[48:51]
    ds_read_b128 v[112:115], v246 offset:16384
    v_add_f32 v9, v9, v208
    v_mfma_f32_16x16x32_bf16 v[48:51], v[140:143], v[164:167], v[48:51]
    ds_read2_b32 v[80:81], v238 offset0:96 offset1:97
    v_cvt_pk_bf16_f32 v9, v9, v9
    v_mfma_f32_16x16x32_bf16 v[48:51], v[144:147], v[160:163], v[48:51]
    ds_read2_b32 v[82:83], v238 offset0:98 offset1:99
    v_mfma_f32_16x16x32_bf16 v[52:55], v[148:151], v[160:163], v[52:55]
    ds_write_b16 v242, v9 offset:12480
    v_mfma_f32_16x16x32_bf16 v[52:55], v[144:147], v[164:167], v[52:55]
    ds_read_b128 v[116:119], v246 offset:20480
    v_mfma_f32_16x16x32_bf16 v[52:55], v[140:143], v[168:171], v[52:55]
    ds_write_b16 v242, v9 offset:8322
    v_mfma_f32_16x16x32_bf16 v[52:55], v[136:139], v[172:175], v[52:55]
    ds_read2_b32 v[84:85], v238 offset0:224 offset1:225
    v_mfma_f32_16x16x32_bf16 v[52:55], v[132:135], v[176:179], v[52:55]
    ds_read2_b32 v[86:87], v238 offset0:226 offset1:227
    v_alignbit_b32 v212, v213, v212, 16
    v_mfma_f32_16x16x32_bf16 v[52:55], v[128:131], v[180:183], v[52:55]
    ds_read_b128 v[120:123], v246 offset:24576
    v_alignbit_b32 v213, v214, v213, 16
    v_mfma_f32_16x16x32_bf16 v[56:59], v[128:131], v[184:187], v[56:59]
    ds_read2_b32 v[88:89], v239 offset0:96 offset1:97
    s_waitcnt vmcnt(4)
    s_barrier
    v_mfma_f32_16x16x32_bf16 v[56:59], v[132:135], v[180:183], v[56:59]
    v_add_u32 v10, -131072, v10
    v_alignbit_b32 v214, v215, v214, 16
    v_mfma_f32_16x16x32_bf16 v[56:59], v[136:139], v[176:179], v[56:59]
    ds_read_b64_tr_b16 a[16:17], v10 offset:49152
    v_alignbit_b32 v215, v216, v215, 16
L_pl_X_2:
    s_cbranch_execz L_pl_X_6
    v_mfma_f32_16x16x32_bf16 v[56:59], v[140:143], v[172:175], v[56:59]
    ds_write_b128 v241, v[212:215] offset:12512
    v_mfma_f32_16x16x32_bf16 v[56:59], v[144:147], v[168:171], v[56:59]
    ds_read_b64_tr_b16 a[18:19], v10 offset:51200
    v_mfma_f32_16x16x32_bf16 v[56:59], v[148:151], v[164:167], v[56:59]
    ds_read_b64_tr_b16 a[24:25], v10 offset:53248
    v_mfma_f32_16x16x32_bf16 v[56:59], v[152:155], v[160:163], v[56:59]
    ds_read_b64_tr_b16 a[26:27], v10 offset:55296
    v_mfma_f32_16x16x32_bf16 v[60:63], v[156:159], v[160:163], v[60:63]
    ds_read2_b32 v[90:91], v239 offset0:98 offset1:99
    v_add_u32 v11, -131072, v11
    v_alignbit_b32 v218, v219, v218, 16
    v_mfma_f32_16x16x32_bf16 v[60:63], v[152:155], v[164:167], v[60:63]
    ds_read_b64_tr_b16 a[20:21], v11 offset:49152
    v_alignbit_b32 v219, v220, v219, 16
    v_mfma_f32_16x16x32_bf16 v[60:63], v[148:151], v[168:171], v[60:63]
    ds_read_b128 v[124:127], v246 offset:28672
    ds_read2_b32 v[92:93], v239 offset0:224 offset1:225
    v_mfma_f32_16x16x32_bf16 v[60:63], v[144:147], v[172:175], v[60:63]
    ds_read_b64_tr_b16 a[22:23], v11 offset:51200
    v_alignbit_b32 v220, v221, v220, 16
    v_mfma_f32_16x16x32_bf16 v[60:63], v[140:143], v[176:179], v[60:63]
    ds_read_b64_tr_b16 a[28:29], v11 offset:53248
    ds_read2_b32 v[94:95], v239 offset0:226 offset1:227
    v_mfma_f32_16x16x32_bf16 v[60:63], v[136:139], v[180:183], v[60:63]
    ds_read_b64_tr_b16 a[30:31], v11 offset:55296
    v_alignbit_b32 v221, v222, v221, 16
    v_mfma_f32_16x16x32_bf16 v[60:63], v[132:135], v[184:187], v[60:63]
    ds_write_b128 v241, v[218:221] offset:13536
    v_mfma_f32_16x16x32_bf16 v[60:63], v[128:131], v[188:191], v[60:63]
    s_waitcnt lgkmcnt(15)
    v_mfma_f32_16x16x32_bf16 v[32:35], v[64:67], v[96:99], v[32:35]
    ds_read_b128 v[160:163], v247 offset:0
    s_waitcnt lgkmcnt(2)
    s_barrier
    v_mfma_f32_16x16x32_bf16 v[36:39], v[68:71], v[96:99], v[36:39]
    v_alignbit_b32 v224, v225, v224, 16
    v_mfma_f32_16x16x32_bf16 v[36:39], v[64:67], v[100:103], v[36:39]
    ds_read_b128 v[164:167], v247 offset:4096
    v_mfma_f32_16x16x32_bf16 v[40:43], v[64:67], v[104:107], v[40:43]
    s_lshl_b32 s14, s87, 18
    ds_read_b128 v[168:171], v247 offset:8192
    v_mfma_f32_16x16x32_bf16 v[40:43], v[68:71], v[100:103], v[40:43]
    s_add_u32 m0, s73, 49152
    ds_read_b128 v[172:175], v247 offset:12288
    v_mfma_f32_16x16x32_bf16 v[40:43], v[72:75], v[96:99], v[40:43]
    buffer_load_dwordx4 v4, s[52:55], s14 offen offset:0 lds
    v_alignbit_b32 v225, v226, v225, 16
    v_mfma_f32_16x16x32_bf16 v[44:47], v[76:79], v[96:99], v[44:47]
    ds_read_b128 v[176:179], v247 offset:16384
    v_mfma_f32_16x16x32_bf16 v[44:47], v[72:75], v[100:103], v[44:47]
    ds_read_b128 v[180:183], v247 offset:20480
    v_mfma_f32_16x16x32_bf16 v[44:47], v[68:71], v[104:107], v[44:47]
    ds_read_b128 v[184:187], v247 offset:24576
    v_mfma_f32_16x16x32_bf16 v[44:47], v[64:67], v[108:111], v[44:47]
    v_alignbit_b32 v226, v227, v226, 16
    v_mfma_f32_16x16x32_bf16 v[48:51], v[64:67], v[112:115], v[48:51]
    ds_read_b128 v[188:191], v247 offset:28672
    v_mfma_f32_16x16x32_bf16 v[48:51], v[68:71], v[108:111], v[48:51]
    ds_read2_b32 v[128:129], v236 offset0:112 offset1:113
    v_mfma_f32_16x16x32_bf16 v[48:51], v[72:75], v[104:107], v[48:51]
    v_alignbit_b32 v227, v228, v227, 16
    v_mfma_f32_16x16x32_bf16 v[48:51], v[76:79], v[100:103], v[48:51]
    ds_read2_b32 v[130:131], v236 offset0:114 offset1:115
    v_mfma_f32_16x16x32_bf16 v[48:51], v[80:83], v[96:99], v[48:51]
    ds_read2_b32 v[132:133], v236 offset0:240 offset1:241
    v_mfma_f32_16x16x32_bf16 v[52:55], v[84:87], v[96:99], v[52:55]
    ds_write_b128 v241, v[224:227] offset:14560
    v_mfma_f32_16x16x32_bf16 v[52:55], v[80:83], v[100:103], v[52:55]
    s_add_u32 m0, s73, 49152
    ds_read2_b32 v[134:135], v236 offset0:242 offset1:243
    v_mfma_f32_16x16x32_bf16 v[52:55], v[76:79], v[104:107], v[52:55]
    buffer_load_dwordx4 v5, s[52:55], s14 offen offset:1024 lds
    ds_read2_b32 v[136:137], v237 offset0:112 offset1:113
    v_mfma_f32_16x16x32_bf16 v[52:55], v[72:75], v[108:111], v[52:55]
    s_add_u32 s6, s12, 4718592
    ds_read2_b32 v[138:139], v237 offset0:114 offset1:115
    v_mfma_f32_16x16x32_bf16 v[52:55], v[68:71], v[112:115], v[52:55]
    ds_read2_b32 v[140:141], v237 offset0:240 offset1:241
    v_alignbit_b32 v230, v231, v230, 16
    v_mfma_f32_16x16x32_bf16 v[52:55], v[64:67], v[116:119], v[52:55]
    ds_read2_b32 v[142:143], v237 offset0:242 offset1:243
    v_xor_b32 v244, 64, v244
    v_mfma_f32_16x16x32_bf16 v[56:59], v[64:67], v[120:123], v[56:59]
    ds_read2_b32 v[144:145], v238 offset0:112 offset1:113
    v_mfma_f32_16x16x32_bf16 v[56:59], v[68:71], v[116:119], v[56:59]
    ds_read2_b32 v[146:147], v238 offset0:114 offset1:115
    v_mfma_f32_16x16x32_bf16 v[56:59], v[72:75], v[112:115], v[56:59]
    ds_read2_b32 v[148:149], v238 offset0:240 offset1:241
    v_alignbit_b32 v231, v232, v231, 16
    v_mfma_f32_16x16x32_bf16 v[56:59], v[76:79], v[108:111], v[56:59]
    ds_read2_b32 v[150:151], v238 offset0:242 offset1:243
    v_xor_b32 v245, 64, v245
    v_mfma_f32_16x16x32_bf16 v[56:59], v[80:83], v[104:107], v[56:59]
    ds_read2_b32 v[152:153], v239 offset0:112 offset1:113
    v_mfma_f32_16x16x32_bf16 v[56:59], v[84:87], v[100:103], v[56:59]
    ds_read2_b32 v[154:155], v239 offset0:114 offset1:115
    v_mfma_f32_16x16x32_bf16 v[56:59], v[88:91], v[96:99], v[56:59]
    ds_read2_b32 v[156:157], v239 offset0:240 offset1:241
    v_alignbit_b32 v232, v233, v232, 16
    v_mfma_f32_16x16x32_bf16 v[60:63], v[92:95], v[96:99], v[60:63]
    s_add_u32 m0, s73, 49152
    ds_read2_b32 v[158:159], v239 offset0:242 offset1:243
    v_mfma_f32_16x16x32_bf16 v[60:63], v[88:91], v[100:103], v[60:63]
    buffer_load_dwordx4 v6, s[52:55], s14 offen offset:2048 lds
    v_xor_b32 v246, 64, v246
    v_mfma_f32_16x16x32_bf16 v[60:63], v[84:87], v[104:107], v[60:63]
    v_alignbit_b32 v233, v234, v233, 16
    v_add_u32 v236, 8320, v236
    v_mfma_f32_16x16x32_bf16 v[60:63], v[80:83], v[108:111], v[60:63]
    v_add_u32 v237, 8320, v237
    v_mfma_f32_16x16x32_bf16 v[60:63], v[76:79], v[112:115], v[60:63]
    v_mfma_f32_16x16x32_bf16 v[60:63], v[72:75], v[116:119], v[60:63]
    v_xor_b32 v247, 64, v247
    v_add_u32 v238, 8320, v238
    v_mfma_f32_16x16x32_bf16 v[60:63], v[68:71], v[120:123], v[60:63]
    ds_write_b128 v241, v[230:233] offset:15584
    v_mfma_f32_16x16x32_bf16 v[60:63], v[64:67], v[124:127], v[60:63]
    v_add_u32 v239, 8320, v239
    s_waitcnt lgkmcnt(1)
    v_mfma_f32_16x16x32_bf16 v[60:63], v[128:131], v[188:191], v[60:63]
    ds_read_b128 v[96:99], v244 offset:2048
    v_mfma_f32_16x16x32_bf16 v[60:63], v[132:135], v[184:187], v[60:63]
    ds_read2_b32 v[64:65], v236 offset0:0 offset1:1
    v_mfma_f32_16x16x32_bf16 v[60:63], v[136:139], v[180:183], v[60:63]
    ds_read2_b32 v[66:67], v236 offset0:2 offset1:3
    v_mfma_f32_16x16x32_bf16 v[60:63], v[140:143], v[176:179], v[60:63]
    s_add_u32 m0, s73, 49152
    ds_read_b128 v[100:103], v244 offset:6144
    v_mfma_f32_16x16x32_bf16 v[60:63], v[144:147], v[172:175], v[60:63]
    buffer_load_dwordx4 v7, s[52:55], s14 offen offset:3072 lds
    ds_read2_b32 v[68:69], v236 offset0:128 offset1:129
    v_mfma_f32_16x16x32_bf16 v[60:63], v[148:151], v[168:171], v[60:63]
    ds_read2_b32 v[70:71], v236 offset0:130 offset1:131
    v_mfma_f32_16x16x32_bf16 v[60:63], v[152:155], v[164:167], v[60:63]
    ds_read_b128 v[104:107], v244 offset:10240
    v_mfma_f32_16x16x32_bf16 v[60:63], v[156:159], v[160:163], v[60:63]
    ds_read2_b32 v[72:73], v237 offset0:0 offset1:1
    v_mfma_f32_16x16x32_bf16 v[56:59], v[128:131], v[184:187], v[56:59]
    ds_read2_b32 v[74:75], v237 offset0:2 offset1:3
    v_mfma_f32_16x16x32_bf16 v[56:59], v[132:135], v[180:183], v[56:59]
    ds_read_b128 v[108:111], v244 offset:14336
    v_mfma_f32_16x16x32_bf16 v[56:59], v[136:139], v[176:179], v[56:59]
    ds_read2_b32 v[76:77], v237 offset0:128 offset1:129
    v_mfma_f32_16x16x32_bf16 v[56:59], v[140:143], v[172:175], v[56:59]
    ds_read2_b32 v[78:79], v237 offset0:130 offset1:131
    v_mfma_f32_16x16x32_bf16 v[56:59], v[144:147], v[168:171], v[56:59]
    ds_read_b128 v[112:115], v244 offset:18432
    v_mfma_f32_16x16x32_bf16 v[56:59], v[148:151], v[164:167], v[56:59]
    ds_read2_b32 v[80:81], v238 offset0:0 offset1:1
    v_cvt_pk_bf16_f32 v206, v60, v61
    v_mfma_f32_16x16x32_bf16 v[56:59], v[152:155], v[160:163], v[56:59]
    ds_read2_b32 v[82:83], v238 offset0:2 offset1:3
    v_mfma_f32_16x16x32_bf16 v[52:55], v[128:131], v[180:183], v[52:55]
    ds_read_b128 v[116:119], v244 offset:22528
    v_mfma_f32_16x16x32_bf16 v[52:55], v[132:135], v[176:179], v[52:55]
    ds_read2_b32 v[84:85], v238 offset0:128 offset1:129
    v_cvt_pk_bf16_f32 v207, v62, v63
    v_mfma_f32_16x16x32_bf16 v[52:55], v[136:139], v[172:175], v[52:55]
    ds_read2_b32 v[86:87], v238 offset0:130 offset1:131
    v_mfma_f32_16x16x32_bf16 v[52:55], v[140:143], v[168:171], v[52:55]
    buffer_store_dwordx2 v[206:207], v8, s[44:47], s6 offen offset:3584 sc1
    ds_read_b128 v[120:123], v244 offset:26624
    v_mfma_f32_16x16x32_bf16 v[52:55], v[144:147], v[164:167], v[52:55]
    ds_read2_b32 v[88:89], v239 offset0:0 offset1:1
    v_mfma_f32_16x16x32_bf16 v[52:55], v[148:151], v[160:163], v[52:55]
    ds_read2_b32 v[90:91], v239 offset0:2 offset1:3
    v_mfma_f32_16x16x32_bf16 v[48:51], v[128:131], v[176:179], v[48:51]
    s_waitcnt vmcnt(5)
    s_barrier
    v_cvt_pk_bf16_f32 v204, v56, v57
    v_mfma_f32_16x16x32_bf16 v[48:51], v[132:135], v[172:175], v[48:51]
    ds_read_b128 v[124:127], v244 offset:30720
    v_add_u32 v10, 131072, v10
    v_mfma_f32_16x16x32_bf16 v[48:51], v[136:139], v[168:171], v[48:51]
    ds_read_b64_tr_b16 a[32:33], v10 offset:16384
    v_mfma_f32_16x16x32_bf16 v[48:51], v[140:143], v[164:167], v[48:51]
    ds_read2_b32 v[92:93], v239 offset0:128 offset1:129
    v_cvt_pk_bf16_f32 v205, v58, v59
    v_mfma_f32_16x16x32_bf16 v[48:51], v[144:147], v[160:163], v[48:51]
    ds_read_b64_tr_b16 a[34:35], v10 offset:18432
    v_mfma_f32_16x16x32_bf16 v[44:47], v[128:131], v[172:175], v[44:47]
    buffer_store_dwordx2 v[204:205], v8, s[44:47], s6 offen offset:3072 sc1
    ds_read_b64_tr_b16 a[40:41], v10 offset:20480
    v_mfma_f32_16x16x32_bf16 v[44:47], v[132:135], v[168:171], v[44:47]
    ds_read_b64_tr_b16 a[42:43], v10 offset:22528
    v_mfma_f32_16x16x32_bf16 v[44:47], v[136:139], v[164:167], v[44:47]
    ds_read2_b32 v[94:95], v239 offset0:130 offset1:131
    v_add_u32 v11, 131072, v11
    v_mfma_f32_16x16x32_bf16 v[44:47], v[140:143], v[160:163], v[44:47]
    ds_read_b64_tr_b16 a[36:37], v11 offset:16384
    v_cvt_pk_bf16_f32 v202, v52, v53
    v_mfma_f32_16x16x32_bf16 v[40:43], v[128:131], v[168:171], v[40:43]
    v_mfma_f32_16x16x32_bf16 v[40:43], v[132:135], v[164:167], v[40:43]
    ds_read_b64_tr_b16 a[38:39], v11 offset:18432
    v_mfma_f32_16x16x32_bf16 v[40:43], v[136:139], v[160:163], v[40:43]
    ds_read_b64_tr_b16 a[44:45], v11 offset:20480
    v_cvt_pk_bf16_f32 v203, v54, v55
    v_mfma_f32_16x16x32_bf16 v[36:39], v[128:131], v[164:167], v[36:39]
    ds_read_b64_tr_b16 a[46:47], v11 offset:22528
    v_mfma_f32_16x16x32_bf16 v[36:39], v[132:135], v[160:163], v[36:39]
    buffer_store_dwordx2 v[202:203], v8, s[44:47], s6 offen offset:2560 sc1
    v_mfma_f32_16x16x32_bf16 v[32:35], v[128:131], v[160:163], v[32:35]
    s_waitcnt lgkmcnt(4)
    v_mfma_f32_16x16x32_bf16 v[60:63], v[64:67], v[124:127], 0
    ds_read_b128 v[160:163], v245 offset:2048
    s_waitcnt lgkmcnt(1)
    s_barrier
    v_mfma_f32_16x16x32_bf16 v[60:63], v[68:71], v[120:123], v[60:63]
    v_cvt_pk_bf16_f32 v200, v48, v49
    v_mfma_f32_16x16x32_bf16 v[60:63], v[72:75], v[116:119], v[60:63]
    ds_read2_b32 v[128:129], v236 offset0:16 offset1:17
    v_mfma_f32_16x16x32_bf16 v[60:63], v[76:79], v[112:115], v[60:63]
    ds_read2_b32 v[130:131], v236 offset0:18 offset1:19
    s_lshl_b32 s14, s88, 18
    v_cvt_pk_bf16_f32 v201, v50, v51
    v_mfma_f32_16x16x32_bf16 v[60:63], v[80:83], v[108:111], v[60:63]
    s_add_u32 m0, s73, 147456
    v_mfma_f32_16x16x32_bf16 v[60:63], v[84:87], v[104:107], v[60:63]
    buffer_load_dwordx4 v4, s[52:55], s14 offen offset:0 lds
    ds_read_b128 v[164:167], v245 offset:6144
    v_mfma_f32_16x16x32_bf16 v[60:63], v[88:91], v[100:103], v[60:63]
    buffer_store_dwordx2 v[200:201], v8, s[44:47], s6 offen offset:2048 sc1
    ds_read2_b32 v[132:133], v236 offset0:144 offset1:145
    v_mfma_f32_16x16x32_bf16 v[60:63], v[92:95], v[96:99], v[60:63]
    s_add_u32 s13, s12, 32768
    v_cvt_pk_bf16_f32 v198, v44, v45
    v_mfma_f32_16x16x32_bf16 v[56:59], v[64:67], v[120:123], 0
    ds_read2_b32 v[134:135], v236 offset0:146 offset1:147
    v_mfma_f32_16x16x32_bf16 v[56:59], v[68:71], v[116:119], v[56:59]
    s_add_u32 m0, s74, 32
    ds_read_b128 v[168:171], v245 offset:10240
    v_mfma_f32_16x16x32_bf16 v[56:59], v[72:75], v[112:115], v[56:59]
    buffer_load_dwordx4 v240, s[48:51], s13 offen offset:0 lds
    v_cvt_pk_bf16_f32 v199, v46, v47
    v_mfma_f32_16x16x32_bf16 v[56:59], v[76:79], v[108:111], v[56:59]
    ds_read2_b32 v[136:137], v237 offset0:16 offset1:17
    v_mfma_f32_16x16x32_bf16 v[56:59], v[80:83], v[104:107], v[56:59]
    buffer_store_dwordx2 v[198:199], v8, s[44:47], s6 offen offset:1536 sc1
    ds_read2_b32 v[138:139], v237 offset0:18 offset1:19
    v_mfma_f32_16x16x32_bf16 v[56:59], v[84:87], v[100:103], v[56:59]
    ds_read_b128 v[172:175], v245 offset:14336
    v_mfma_f32_16x16x32_bf16 v[56:59], v[88:91], v[96:99], v[56:59]
    v_cvt_pk_bf16_f32 v196, v40, v41
    v_mfma_f32_16x16x32_bf16 v[52:55], v[64:67], v[116:119], 0
    ds_read2_b32 v[140:141], v237 offset0:144 offset1:145
    v_mfma_f32_16x16x32_bf16 v[52:55], v[68:71], v[112:115], v[52:55]
    ds_read2_b32 v[142:143], v237 offset0:146 offset1:147
    s_add_u32 m0, s73, 147456
    v_cvt_pk_bf16_f32 v197, v42, v43
    v_mfma_f32_16x16x32_bf16 v[52:55], v[72:75], v[108:111], v[52:55]
    buffer_load_dwordx4 v5, s[52:55], s14 offen offset:1024 lds
    v_mfma_f32_16x16x32_bf16 v[52:55], v[76:79], v[104:107], v[52:55]
    buffer_store_dwordx2 v[196:197], v8, s[44:47], s6 offen offset:1024 sc1
    ds_read_b128 v[176:179], v245 offset:18432
    s_add_u32 m0, s74, 32
    v_mfma_f32_16x16x32_bf16 v[52:55], v[80:83], v[100:103], v[52:55]
    buffer_load_dwordx4 v240, s[48:51], s13 offen offset:1024 lds
    ds_read2_b32 v[144:145], v238 offset0:16 offset1:17
    v_mfma_f32_16x16x32_bf16 v[52:55], v[84:87], v[96:99], v[52:55]
    v_mfma_f32_16x16x32_bf16 v[48:51], v[64:67], v[112:115], 0
    ds_read2_b32 v[146:147], v238 offset0:18 offset1:19
    v_cvt_pk_bf16_f32 v194, v36, v37
    v_mfma_f32_16x16x32_bf16 v[48:51], v[68:71], v[108:111], v[48:51]
    ds_read_b128 v[180:183], v245 offset:22528
    v_mfma_f32_16x16x32_bf16 v[48:51], v[72:75], v[104:107], v[48:51]
    v_cvt_pk_bf16_f32 v195, v38, v39
    v_mfma_f32_16x16x32_bf16 v[48:51], v[76:79], v[100:103], v[48:51]
    buffer_store_dwordx2 v[194:195], v8, s[44:47], s6 offen offset:512 sc1
    ds_read2_b32 v[148:149], v238 offset0:144 offset1:145
    s_add_u32 m0, s74, 32
    v_mfma_f32_16x16x32_bf16 v[48:51], v[80:83], v[96:99], v[48:51]
    buffer_load_dwordx4 v240, s[48:51], s13 offen offset:2048 lds
    ds_read2_b32 v[150:151], v238 offset0:146 offset1:147
    v_mfma_f32_16x16x32_bf16 v[44:47], v[64:67], v[108:111], 0
    ds_read_b128 v[184:187], v245 offset:26624
    v_mfma_f32_16x16x32_bf16 v[44:47], v[68:71], v[104:107], v[44:47]
    v_cvt_pk_bf16_f32 v192, v32, v33
    v_mfma_f32_16x16x32_bf16 v[44:47], v[72:75], v[100:103], v[44:47]
    s_add_u32 m0, s73, 147456
    ds_read2_b32 v[152:153], v239 offset0:16 offset1:17
    v_mfma_f32_16x16x32_bf16 v[44:47], v[76:79], v[96:99], v[44:47]
    buffer_load_dwordx4 v6, s[52:55], s14 offen offset:2048 lds
    v_cvt_pk_bf16_f32 v193, v34, v35
    v_mfma_f32_16x16x32_bf16 v[40:43], v[64:67], v[104:107], 0
    ds_read2_b32 v[154:155], v239 offset0:18 offset1:19
    v_mfma_f32_16x16x32_bf16 v[40:43], v[68:71], v[100:103], v[40:43]
    buffer_store_dwordx2 v[192:193], v8, s[44:47], s6 offen offset:0 sc1
    ds_read_b128 v[188:191], v245 offset:30720
    v_mfma_f32_16x16x32_bf16 v[40:43], v[72:75], v[96:99], v[40:43]
    s_add_u32 m0, s74, 32
    ds_read2_b32 v[156:157], v239 offset0:144 offset1:145
    v_mfma_f32_16x16x32_bf16 v[36:39], v[64:67], v[100:103], 0
    buffer_load_dwordx4 v240, s[48:51], s13 offen offset:3072 lds
    v_mfma_f32_16x16x32_bf16 v[36:39], v[68:71], v[96:99], v[36:39]
    ds_read2_b32 v[158:159], v239 offset0:146 offset1:147
    v_mfma_f32_16x16x32_bf16 v[32:35], v[64:67], v[96:99], 0
    s_waitcnt lgkmcnt(12)
    v_mfma_f32_16x16x32_bf16 v[32:35], v[128:131], v[160:163], v[32:35]
    ds_read_b128 v[96:99], v246 offset:2048
    v_mfma_f32_16x16x32_bf16 v[36:39], v[132:135], v[160:163], v[36:39]
    v_mfma_f32_16x16x32_bf16 v[36:39], v[128:131], v[164:167], v[36:39]
    ds_read2_b32 v[64:65], v236 offset0:32 offset1:33
    v_mfma_f32_16x16x32_bf16 v[40:43], v[128:131], v[168:171], v[40:43]
    s_add_u32 m0, s73, 147456
    ds_read2_b32 v[66:67], v236 offset0:34 offset1:35
    v_mfma_f32_16x16x32_bf16 v[40:43], v[132:135], v[164:167], v[40:43]
    buffer_load_dwordx4 v7, s[52:55], s14 offen offset:3072 lds
    v_mfma_f32_16x16x32_bf16 v[40:43], v[136:139], v[160:163], v[40:43]
    ds_read_b128 v[100:103], v246 offset:6144
    v_mfma_f32_16x16x32_bf16 v[44:47], v[140:143], v[160:163], v[44:47]
    ds_read2_b32 v[68:69], v236 offset0:160 offset1:161
    v_mfma_f32_16x16x32_bf16 v[44:47], v[136:139], v[164:167], v[44:47]
    ds_read2_b32 v[70:71], v236 offset0:162 offset1:163
    v_mfma_f32_16x16x32_bf16 v[44:47], v[132:135], v[168:171], v[44:47]
    ds_read_b128 v[104:107], v246 offset:10240
    v_mfma_f32_16x16x32_bf16 v[44:47], v[128:131], v[172:175], v[44:47]
    ds_read2_b32 v[72:73], v237 offset0:32 offset1:33
    s_waitcnt lgkmcnt(8)
    v_mfma_f32_16x16x32_bf16 v[48:51], v[128:131], v[176:179], v[48:51]
    ds_read2_b32 v[74:75], v237 offset0:34 offset1:35
    v_mfma_f32_16x16x32_bf16 v[48:51], v[132:135], v[172:175], v[48:51]
    ds_read_b128 v[108:111], v246 offset:14336
    v_mfma_f32_16x16x32_bf16 v[48:51], v[136:139], v[168:171], v[48:51]
    v_mov_b32 v9, 16
    buffer_load_ushort v9, v9, s[56:59], s70 offen
    v_mfma_f32_16x16x32_bf16 v[48:51], v[140:143], v[164:167], v[48:51]
    ds_read2_b32 v[76:77], v237 offset0:160 offset1:161
    v_mfma_f32_16x16x32_bf16 v[48:51], v[144:147], v[160:163], v[48:51]
    ds_read2_b32 v[78:79], v237 offset0:162 offset1:163
    s_waitcnt vmcnt(17)
    s_barrier
    v_mfma_f32_16x16x32_bf16 v[52:55], v[148:151], v[160:163], v[52:55]
    ds_read_b128 v[112:115], v246 offset:18432
    v_add_u32 v10, -131072, v10
    v_mfma_f32_16x16x32_bf16 v[52:55], v[144:147], v[164:167], v[52:55]
    ds_read_b64_tr_b16 a[48:49], v10 offset:49152
    v_mfma_f32_16x16x32_bf16 v[52:55], v[140:143], v[168:171], v[52:55]
    ds_read_b64_tr_b16 a[50:51], v10 offset:51200
    v_mfma_f32_16x16x32_bf16 v[52:55], v[136:139], v[172:175], v[52:55]
    ds_read2_b32 v[80:81], v238 offset0:32 offset1:33
    v_mfma_f32_16x16x32_bf16 v[52:55], v[132:135], v[176:179], v[52:55]
    ds_read_b64_tr_b16 a[56:57], v10 offset:53248
    v_mfma_f32_16x16x32_bf16 v[52:55], v[128:131], v[180:183], v[52:55]
    ds_read_b64_tr_b16 a[58:59], v10 offset:55296
    v_mfma_f32_16x16x32_bf16 v[56:59], v[128:131], v[184:187], v[56:59]
    ds_read2_b32 v[82:83], v238 offset0:34 offset1:35
    v_add_u32 v11, -131072, v11
    v_mfma_f32_16x16x32_bf16 v[56:59], v[132:135], v[180:183], v[56:59]
    ds_read_b64_tr_b16 a[52:53], v11 offset:49152
    v_mfma_f32_16x16x32_bf16 v[56:59], v[136:139], v[176:179], v[56:59]
    ds_read_b64_tr_b16 a[54:55], v11 offset:51200
    v_mfma_f32_16x16x32_bf16 v[56:59], v[140:143], v[172:175], v[56:59]
    ds_read_b128 v[116:119], v246 offset:22528
    v_mfma_f32_16x16x32_bf16 v[56:59], v[144:147], v[168:171], v[56:59]
    ds_read_b64_tr_b16 a[60:61], v11 offset:53248
    v_mfma_f32_16x16x32_bf16 v[56:59], v[148:151], v[164:167], v[56:59]
    ds_read_b64_tr_b16 a[62:63], v11 offset:55296
    v_mfma_f32_16x16x32_bf16 v[56:59], v[152:155], v[160:163], v[56:59]
    ds_read2_b32 v[84:85], v238 offset0:160 offset1:161
    v_mfma_f32_16x16x32_bf16 v[60:63], v[156:159], v[160:163], v[60:63]
    ds_read2_b32 v[86:87], v238 offset0:162 offset1:163
    v_mfma_f32_16x16x32_bf16 v[60:63], v[152:155], v[164:167], v[60:63]
    ds_read_b128 v[120:123], v246 offset:26624
    v_mfma_f32_16x16x32_bf16 v[60:63], v[148:151], v[168:171], v[60:63]
    ds_read2_b32 v[88:89], v239 offset0:32 offset1:33
    v_mfma_f32_16x16x32_bf16 v[60:63], v[144:147], v[172:175], v[60:63]
    ds_read2_b32 v[90:91], v239 offset0:34 offset1:35
    v_mfma_f32_16x16x32_bf16 v[60:63], v[140:143], v[176:179], v[60:63]
    ds_read_b128 v[124:127], v246 offset:30720
    v_mfma_f32_16x16x32_bf16 v[60:63], v[136:139], v[180:183], v[60:63]
    ds_read2_b32 v[92:93], v239 offset0:160 offset1:161
    v_mfma_f32_16x16x32_bf16 v[60:63], v[132:135], v[184:187], v[60:63]
    ds_read2_b32 v[94:95], v239 offset0:162 offset1:163
    v_mfma_f32_16x16x32_bf16 v[60:63], v[128:131], v[188:191], v[60:63]
    s_waitcnt lgkmcnt(15)
    v_mfma_f32_16x16x32_bf16 v[32:35], v[64:67], v[96:99], v[32:35]
    ds_read_b128 v[160:163], v247 offset:2048
    v_mfma_f32_16x16x32_bf16 v[36:39], v[68:71], v[96:99], v[36:39]
    v_mfma_f32_16x16x32_bf16 v[36:39], v[64:67], v[100:103], v[36:39]
    ds_read2_b32 v[128:129], v236 offset0:48 offset1:49
    v_mfma_f32_16x16x32_bf16 v[40:43], v[64:67], v[104:107], v[40:43]
    ds_read2_b32 v[130:131], v236 offset0:50 offset1:51
    v_mfma_f32_16x16x32_bf16 v[40:43], v[68:71], v[100:103], v[40:43]
    v_mfma_f32_16x16x32_bf16 v[40:43], v[72:75], v[96:99], v[40:43]
    ds_read_b128 v[164:167], v247 offset:6144
    v_mfma_f32_16x16x32_bf16 v[44:47], v[76:79], v[96:99], v[44:47]
    ds_read2_b32 v[132:133], v236 offset0:176 offset1:177
    v_mfma_f32_16x16x32_bf16 v[44:47], v[72:75], v[100:103], v[44:47]
    s_waitcnt lgkmcnt(13)
    s_barrier
    v_mfma_f32_16x16x32_bf16 v[44:47], v[68:71], v[104:107], v[44:47]
    ds_read2_b32 v[134:135], v236 offset0:178 offset1:179
    v_mfma_f32_16x16x32_bf16 v[44:47], v[64:67], v[108:111], v[44:47]
    ds_read_b128 v[168:171], v247 offset:10240
    s_waitcnt lgkmcnt(7)
    v_mfma_f32_16x16x32_bf16 v[48:51], v[64:67], v[112:115], v[48:51]
    ds_read2_b32 v[136:137], v237 offset0:48 offset1:49
    v_mfma_f32_16x16x32_bf16 v[48:51], v[68:71], v[108:111], v[48:51]
    v_mfma_f32_16x16x32_bf16 v[48:51], v[72:75], v[104:107], v[48:51]
    ds_read2_b32 v[138:139], v237 offset0:50 offset1:51
    v_mfma_f32_16x16x32_bf16 v[48:51], v[76:79], v[100:103], v[48:51]
    ds_read_b128 v[172:175], v247 offset:14336
    v_mfma_f32_16x16x32_bf16 v[48:51], v[80:83], v[96:99], v[48:51]
    v_mfma_f32_16x16x32_bf16 v[52:55], v[84:87], v[96:99], v[52:55]
    ds_read2_b32 v[140:141], v237 offset0:176 offset1:177
    v_mfma_f32_16x16x32_bf16 v[52:55], v[80:83], v[100:103], v[52:55]
    ds_read2_b32 v[142:143], v237 offset0:178 offset1:179
    v_mfma_f32_16x16x32_bf16 v[52:55], v[76:79], v[104:107], v[52:55]
    v_mfma_f32_16x16x32_bf16 v[52:55], v[72:75], v[108:111], v[52:55]
    ds_read_b128 v[176:179], v247 offset:18432
    v_mfma_f32_16x16x32_bf16 v[52:55], v[68:71], v[112:115], v[52:55]
    ds_read2_b32 v[144:145], v238 offset0:48 offset1:49
    v_mfma_f32_16x16x32_bf16 v[52:55], v[64:67], v[116:119], v[52:55]
    v_mfma_f32_16x16x32_bf16 v[56:59], v[64:67], v[120:123], v[56:59]
    ds_read2_b32 v[146:147], v238 offset0:50 offset1:51
    v_mfma_f32_16x16x32_bf16 v[56:59], v[68:71], v[116:119], v[56:59]
    ds_read_b128 v[180:183], v247 offset:22528
    v_mfma_f32_16x16x32_bf16 v[56:59], v[72:75], v[112:115], v[56:59]
    v_mfma_f32_16x16x32_bf16 v[56:59], v[76:79], v[108:111], v[56:59]
    ds_read2_b32 v[148:149], v238 offset0:176 offset1:177
    v_mfma_f32_16x16x32_bf16 v[56:59], v[80:83], v[104:107], v[56:59]
    ds_read2_b32 v[150:151], v238 offset0:178 offset1:179
    v_mfma_f32_16x16x32_bf16 v[56:59], v[84:87], v[100:103], v[56:59]
    ds_read_b128 v[184:187], v247 offset:26624
    v_mfma_f32_16x16x32_bf16 v[56:59], v[88:91], v[96:99], v[56:59]
    v_mfma_f32_16x16x32_bf16 v[60:63], v[92:95], v[96:99], v[60:63]
    ds_read2_b32 v[152:153], v239 offset0:48 offset1:49
    v_mfma_f32_16x16x32_bf16 v[60:63], v[88:91], v[100:103], v[60:63]
    ds_read2_b32 v[154:155], v239 offset0:50 offset1:51
    v_mfma_f32_16x16x32_bf16 v[60:63], v[84:87], v[104:107], v[60:63]
    v_mfma_f32_16x16x32_bf16 v[60:63], v[80:83], v[108:111], v[60:63]
    ds_read_b128 v[188:191], v247 offset:30720
    v_mfma_f32_16x16x32_bf16 v[60:63], v[76:79], v[112:115], v[60:63]
    ds_read2_b32 v[156:157], v239 offset0:176 offset1:177
    v_mfma_f32_16x16x32_bf16 v[60:63], v[72:75], v[116:119], v[60:63]
    v_mfma_f32_16x16x32_bf16 v[60:63], v[68:71], v[120:123], v[60:63]
    ds_read2_b32 v[158:159], v239 offset0:178 offset1:179
    v_mfma_f32_16x16x32_bf16 v[60:63], v[64:67], v[124:127], v[60:63]
    s_waitcnt lgkmcnt(12)
    v_mfma_f32_16x16x32_bf16 v[32:35], v[128:131], v[160:163], v[32:35]
    ds_read_b128 v[96:99], v244 offset:0
    v_mfma_f32_16x16x32_bf16 v[36:39], v[132:135], v[160:163], v[36:39]
    v_mfma_f32_16x16x32_bf16 v[36:39], v[128:131], v[164:167], v[36:39]
    ds_read2_b32 v[64:65], v236 offset0:64 offset1:65
    v_mfma_f32_16x16x32_bf16 v[40:43], v[128:131], v[168:171], v[40:43]
    ds_read2_b32 v[66:67], v236 offset0:66 offset1:67
    v_mfma_f32_16x16x32_bf16 v[40:43], v[132:135], v[164:167], v[40:43]
    v_mfma_f32_16x16x32_bf16 v[40:43], v[136:139], v[160:163], v[40:43]
    ds_read_b128 v[100:103], v244 offset:4096
    v_mfma_f32_16x16x32_bf16 v[44:47], v[140:143], v[160:163], v[44:47]
    ds_read2_b32 v[68:69], v236 offset0:192 offset1:193
    v_mfma_f32_16x16x32_bf16 v[44:47], v[136:139], v[164:167], v[44:47]
    s_add_u32 m0, s9, 36864
    s_add_u32 s13, s11, 0
    v_mfma_f32_16x16x32_bf16 v[44:47], v[132:135], v[168:171], v[44:47]
    buffer_load_dwordx4 v15, s[44:47], s13 offen sc1 lds
    ds_read2_b32 v[70:71], v236 offset0:194 offset1:195
    v_mfma_f32_16x16x32_bf16 v[44:47], v[128:131], v[172:175], v[44:47]
    ds_read_b128 v[104:107], v244 offset:8192
    s_waitcnt lgkmcnt(7)
    v_mfma_f32_16x16x32_bf16 v[48:51], v[128:131], v[176:179], v[48:51]
    ds_read2_b32 v[72:73], v237 offset0:64 offset1:65
    v_mfma_f32_16x16x32_bf16 v[48:51], v[132:135], v[172:175], v[48:51]
    ds_read2_b32 v[74:75], v237 offset0:66 offset1:67
    v_mfma_f32_16x16x32_bf16 v[48:51], v[136:139], v[168:171], v[48:51]
    ds_read_b128 v[108:111], v244 offset:12288
    v_mfma_f32_16x16x32_bf16 v[48:51], v[140:143], v[164:167], v[48:51]
    ds_read2_b32 v[76:77], v237 offset0:192 offset1:193
    v_mfma_f32_16x16x32_bf16 v[48:51], v[144:147], v[160:163], v[48:51]
    ds_read2_b32 v[78:79], v237 offset0:194 offset1:195
    v_mfma_f32_16x16x32_bf16 v[52:55], v[148:151], v[160:163], v[52:55]
    ds_read_b128 v[112:115], v244 offset:16384
    v_mfma_f32_16x16x32_bf16 v[52:55], v[144:147], v[164:167], v[52:55]
    ds_read2_b32 v[80:81], v238 offset0:64 offset1:65
    s_add_u32 m0, s9, 37888
    s_add_u32 s13, s11, 90112
    v_mfma_f32_16x16x32_bf16 v[52:55], v[140:143], v[168:171], v[52:55]
    buffer_load_dwordx4 v16, s[44:47], s13 offen sc1 lds
    ds_read2_b32 v[82:83], v238 offset0:66 offset1:67
    v_mfma_f32_16x16x32_bf16 v[52:55], v[136:139], v[172:175], v[52:55]
    ds_read_b128 v[116:119], v244 offset:20480
    v_mfma_f32_16x16x32_bf16 v[52:55], v[132:135], v[176:179], v[52:55]
    ds_read2_b32 v[84:85], v238 offset0:192 offset1:193
    v_mfma_f32_16x16x32_bf16 v[52:55], v[128:131], v[180:183], v[52:55]
    ds_read2_b32 v[86:87], v238 offset0:194 offset1:195
    v_mfma_f32_16x16x32_bf16 v[56:59], v[128:131], v[184:187], v[56:59]
    ds_read_b128 v[120:123], v244 offset:24576
    s_waitcnt vmcnt(3)
    s_barrier
    v_mfma_f32_16x16x32_bf16 v[56:59], v[132:135], v[180:183], v[56:59]
    ds_read2_b32 v[88:89], v239 offset0:64 offset1:65
    v_add_u32 v10, 131072, v10
    v_mfma_f32_16x16x32_bf16 v[56:59], v[136:139], v[176:179], v[56:59]
    ds_read_b64_tr_b16 a[64:65], v10 offset:16384
    v_mfma_f32_16x16x32_bf16 v[56:59], v[140:143], v[172:175], v[56:59]
    ds_read2_b32 v[90:91], v239 offset0:66 offset1:67
    v_mfma_f32_16x16x32_bf16 v[56:59], v[144:147], v[168:171], v[56:59]
    ds_read_b64_tr_b16 a[66:67], v10 offset:18432
    s_add_u32 m0, s9, 38912
    s_add_u32 s13, s11, 180224
    v_mfma_f32_16x16x32_bf16 v[56:59], v[148:151], v[164:167], v[56:59]
    ds_read_b64_tr_b16 a[72:73], v10 offset:20480
    buffer_load_dwordx4 v15, s[44:47], s13 offen sc1 lds
    v_mfma_f32_16x16x32_bf16 v[56:59], v[152:155], v[160:163], v[56:59]
    ds_read_b64_tr_b16 a[74:75], v10 offset:22528
    v_mfma_f32_16x16x32_bf16 v[60:63], v[156:159], v[160:163], v[60:63]
    ds_read_b128 v[124:127], v244 offset:28672
    v_add_u32 v11, 131072, v11
    v_mfma_f32_16x16x32_bf16 v[60:63], v[152:155], v[164:167], v[60:63]
    ds_read_b64_tr_b16 a[68:69], v11 offset:16384
    v_mfma_f32_16x16x32_bf16 v[60:63], v[148:151], v[168:171], v[60:63]
    ds_read2_b32 v[92:93], v239 offset0:192 offset1:193
    v_mfma_f32_16x16x32_bf16 v[60:63], v[144:147], v[172:175], v[60:63]
    ds_read_b64_tr_b16 a[70:71], v11 offset:18432
    v_mfma_f32_16x16x32_bf16 v[60:63], v[140:143], v[176:179], v[60:63]
    ds_read_b64_tr_b16 a[76:77], v11 offset:20480
    v_mfma_f32_16x16x32_bf16 v[60:63], v[136:139], v[180:183], v[60:63]
    ds_read_b64_tr_b16 a[78:79], v11 offset:22528
    v_mfma_f32_16x16x32_bf16 v[60:63], v[132:135], v[184:187], v[60:63]
    ds_read2_b32 v[94:95], v239 offset0:194 offset1:195
    s_add_u32 m0, s9, 39936
    s_add_u32 s13, s11, 270336
    v_mfma_f32_16x16x32_bf16 v[60:63], v[128:131], v[188:191], v[60:63]
    buffer_load_dwordx4 v16, s[44:47], s13 offen sc1 lds
    s_waitcnt lgkmcnt(15)
    v_mfma_f32_16x16x32_bf16 v[32:35], v[64:67], v[96:99], v[32:35]
    ds_read_b128 v[160:163], v245 offset:0
L_pl_X_3:
    s_cbranch_execz L_pl_X_7
    s_waitcnt lgkmcnt(2)
    s_barrier
    v_mfma_f32_16x16x32_bf16 v[36:39], v[68:71], v[96:99], v[36:39]
    v_mfma_f32_16x16x32_bf16 v[36:39], v[64:67], v[100:103], v[36:39]
    ds_read2_b32 v[128:129], v236 offset0:80 offset1:81
    v_mfma_f32_16x16x32_bf16 v[40:43], v[64:67], v[104:107], v[40:43]
    s_lshl_b32 s14, s89, 18
    ds_read2_b32 v[130:131], v236 offset0:82 offset1:83
    v_mfma_f32_16x16x32_bf16 v[40:43], v[68:71], v[100:103], v[40:43]
    s_add_u32 m0, s73, 147456
    v_mfma_f32_16x16x32_bf16 v[40:43], v[72:75], v[96:99], v[40:43]
    buffer_load_dwordx4 v4, s[52:55], s14 offen offset:0 lds
    ds_read_b128 v[164:167], v245 offset:4096
    v_mfma_f32_16x16x32_bf16 v[44:47], v[76:79], v[96:99], v[44:47]
    ds_read2_b32 v[132:133], v236 offset0:208 offset1:209
    v_mfma_f32_16x16x32_bf16 v[44:47], v[72:75], v[100:103], v[44:47]
    s_add_u32 m0, s9, 40960
    s_add_u32 s13, s11, 360448
    v_mfma_f32_16x16x32_bf16 v[44:47], v[68:71], v[104:107], v[44:47]
    buffer_load_dwordx4 v15, s[44:47], s13 offen sc1 lds
    ds_read2_b32 v[134:135], v236 offset0:210 offset1:211
    v_mfma_f32_16x16x32_bf16 v[44:47], v[64:67], v[108:111], v[44:47]
    ds_read_b128 v[168:171], v245 offset:8192
    s_waitcnt lgkmcnt(7)
    v_mfma_f32_16x16x32_bf16 v[48:51], v[64:67], v[112:115], v[48:51]
    ds_read2_b32 v[136:137], v237 offset0:80 offset1:81
    v_mfma_f32_16x16x32_bf16 v[48:51], v[68:71], v[108:111], v[48:51]
    ds_read2_b32 v[138:139], v237 offset0:82 offset1:83
    v_mfma_f32_16x16x32_bf16 v[48:51], v[72:75], v[104:107], v[48:51]
    ds_read_b128 v[172:175], v245 offset:12288
    v_mfma_f32_16x16x32_bf16 v[48:51], v[76:79], v[100:103], v[48:51]
    ds_read2_b32 v[140:141], v237 offset0:208 offset1:209
    v_mfma_f32_16x16x32_bf16 v[48:51], v[80:83], v[96:99], v[48:51]
    ds_read2_b32 v[142:143], v237 offset0:210 offset1:211
    v_mfma_f32_16x16x32_bf16 v[52:55], v[84:87], v[96:99], v[52:55]
    ds_read_b128 v[176:179], v245 offset:16384
    v_mfma_f32_16x16x32_bf16 v[52:55], v[80:83], v[100:103], v[52:55]
    s_add_u32 m0, s73, 147456
    ds_read2_b32 v[144:145], v238 offset0:80 offset1:81
    v_mfma_f32_16x16x32_bf16 v[52:55], v[76:79], v[104:107], v[52:55]
    buffer_load_dwordx4 v5, s[52:55], s14 offen offset:1024 lds
    ds_read2_b32 v[146:147], v238 offset0:82 offset1:83
    v_mfma_f32_16x16x32_bf16 v[52:55], v[72:75], v[108:111], v[52:55]
    ds_read_b128 v[180:183], v245 offset:20480
    s_add_u32 m0, s9, 41984
    s_add_u32 s13, s11, 450560
    v_mfma_f32_16x16x32_bf16 v[52:55], v[68:71], v[112:115], v[52:55]
    buffer_load_dwordx4 v16, s[44:47], s13 offen sc1 lds
    ds_read_b128 v[212:215], v241 offset:32
    v_mfma_f32_16x16x32_bf16 v[52:55], v[64:67], v[116:119], v[52:55]
    ds_read2_b32 v[148:149], v238 offset0:208 offset1:209
    v_mfma_f32_16x16x32_bf16 v[56:59], v[64:67], v[120:123], v[56:59]
    ds_read_b32 v216, v241 offset:48
    v_mfma_f32_16x16x32_bf16 v[56:59], v[68:71], v[116:119], v[56:59]
    ds_read2_b32 v[150:151], v238 offset0:210 offset1:211
    v_mfma_f32_16x16x32_bf16 v[56:59], v[72:75], v[112:115], v[56:59]
    ds_read_b128 v[218:221], v241 offset:1056
    v_mfma_f32_16x16x32_bf16 v[56:59], v[76:79], v[108:111], v[56:59]
    ds_read_b128 v[184:187], v245 offset:24576
    v_mfma_f32_16x16x32_bf16 v[56:59], v[80:83], v[104:107], v[56:59]
    ds_read2_b32 v[152:153], v239 offset0:80 offset1:81
    s_add_u32 m0, s9, 43008
    s_add_u32 s13, s11, 540672
    v_mfma_f32_16x16x32_bf16 v[56:59], v[84:87], v[100:103], v[56:59]
    buffer_load_dwordx4 v15, s[44:47], s13 offen sc1 lds
    ds_read_b32 v222, v241 offset:1072
    v_mfma_f32_16x16x32_bf16 v[56:59], v[88:91], v[96:99], v[56:59]
    ds_read2_b32 v[154:155], v239 offset0:82 offset1:83
    v_mfma_f32_16x16x32_bf16 v[60:63], v[92:95], v[96:99], v[60:63]
    s_add_u32 m0, s73, 147456
    ds_read_b128 v[224:227], v241 offset:2080
    v_mfma_f32_16x16x32_bf16 v[60:63], v[88:91], v[100:103], v[60:63]
    buffer_load_dwordx4 v6, s[52:55], s14 offen offset:2048 lds
    ds_read_b128 v[188:191], v245 offset:28672
    v_mfma_f32_16x16x32_bf16 v[60:63], v[84:87], v[104:107], v[60:63]
    ds_read_b32 v228, v241 offset:2096
    v_mfma_f32_16x16x32_bf16 v[60:63], v[80:83], v[108:111], v[60:63]
    ds_read2_b32 v[156:157], v239 offset0:208 offset1:209
    v_mfma_f32_16x16x32_bf16 v[60:63], v[76:79], v[112:115], v[60:63]
    ds_read_b128 v[230:233], v241 offset:3104
    v_mfma_f32_16x16x32_bf16 v[60:63], v[72:75], v[116:119], v[60:63]
    ds_read2_b32 v[158:159], v239 offset0:210 offset1:211
    v_mfma_f32_16x16x32_bf16 v[60:63], v[68:71], v[120:123], v[60:63]
    ds_read_b32 v234, v241 offset:3120
    s_add_u32 m0, s9, 44032
    s_add_u32 s13, s11, 630784
    v_mfma_f32_16x16x32_bf16 v[60:63], v[64:67], v[124:127], v[60:63]
    buffer_load_dwordx4 v16, s[44:47], s13 offen sc1 lds
    s_waitcnt lgkmcnt(15)
    v_mfma_f32_16x16x32_bf16 v[32:35], v[128:131], v[160:163], v[32:35]
    ds_read_b128 v[96:99], v246 offset:0
    v_mfma_f32_16x16x32_bf16 v[36:39], v[132:135], v[160:163], v[36:39]
    v_mfma_f32_16x16x32_bf16 v[36:39], v[128:131], v[164:167], v[36:39]
    ds_read2_b32 v[64:65], v236 offset0:96 offset1:97
    v_mfma_f32_16x16x32_bf16 v[40:43], v[128:131], v[168:171], v[40:43]
    s_add_u32 m0, s73, 147456
    ds_read2_b32 v[66:67], v236 offset0:98 offset1:99
    v_mfma_f32_16x16x32_bf16 v[40:43], v[132:135], v[164:167], v[40:43]
    buffer_load_dwordx4 v7, s[52:55], s14 offen offset:3072 lds
    s_waitcnt lgkmcnt(3)
    v_mfma_f32_16x16x32_bf16 v[40:43], v[136:139], v[160:163], v[40:43]
    ds_read_b128 v[100:103], v246 offset:4096
    v_mfma_f32_16x16x32_bf16 v[44:47], v[140:143], v[160:163], v[44:47]
    s_waitcnt vmcnt(12)
    ds_read2_b32 v[68:69], v236 offset0:224 offset1:225
    v_mfma_f32_16x16x32_bf16 v[44:47], v[136:139], v[164:167], v[44:47]
    v_mfma_f32_16x16x32_bf16 v[44:47], v[132:135], v[168:171], v[44:47]
    ds_read2_b32 v[70:71], v236 offset0:226 offset1:227
    v_lshlrev_b32 v9, 16, v9
    v_mfma_f32_16x16x32_bf16 v[44:47], v[128:131], v[172:175], v[44:47]
    ds_read_b128 v[104:107], v246 offset:8192
    v_mfma_f32_16x16x32_bf16 v[48:51], v[128:131], v[176:179], v[48:51]
    ds_read2_b32 v[72:73], v237 offset0:96 offset1:97
    v_lshlrev_b32 v208, 16, v212
    v_mfma_f32_16x16x32_bf16 v[48:51], v[132:135], v[172:175], v[48:51]
    v_mfma_f32_16x16x32_bf16 v[48:51], v[136:139], v[168:171], v[48:51]
    ds_read2_b32 v[74:75], v237 offset0:98 offset1:99
    v_add_f32 v9, v9, v208
    v_mfma_f32_16x16x32_bf16 v[48:51], v[140:143], v[164:167], v[48:51]
    ds_read_b128 v[108:111], v246 offset:12288
    v_cvt_pk_bf16_f32 v9, v9, v9
    v_mfma_f32_16x16x32_bf16 v[48:51], v[144:147], v[160:163], v[48:51]
    ds_read2_b32 v[76:77], v237 offset0:224 offset1:225
    v_mfma_f32_16x16x32_bf16 v[52:55], v[148:151], v[160:163], v[52:55]
    ds_write_b16 v242, v9 offset:4160
    v_mfma_f32_16x16x32_bf16 v[52:55], v[144:147], v[164:167], v[52:55]
    ds_read2_b32 v[78:79], v237 offset0:226 offset1:227
    v_mfma_f32_16x16x32_bf16 v[52:55], v[140:143], v[168:171], v[52:55]
    ds_write_b16 v242, v9 offset:2
    v_mfma_f32_16x16x32_bf16 v[52:55], v[136:139], v[172:175], v[52:55]
    ds_read_b128 v[112:115], v246 offset:16384
    v_mfma_f32_16x16x32_bf16 v[52:55], v[132:135], v[176:179], v[52:55]
    ds_read2_b32 v[80:81], v238 offset0:96 offset1:97
    v_alignbit_b32 v212, v213, v212, 16
    v_mfma_f32_16x16x32_bf16 v[52:55], v[128:131], v[180:183], v[52:55]
    v_alignbit_b32 v213, v214, v213, 16
    v_mfma_f32_16x16x32_bf16 v[56:59], v[128:131], v[184:187], v[56:59]
    ds_read2_b32 v[82:83], v238 offset0:98 offset1:99
    v_mfma_f32_16x16x32_bf16 v[56:59], v[132:135], v[180:183], v[56:59]
    ds_read_b128 v[116:119], v246 offset:20480
    v_alignbit_b32 v214, v215, v214, 16
    v_mfma_f32_16x16x32_bf16 v[56:59], v[136:139], v[176:179], v[56:59]
    v_mfma_f32_16x16x32_bf16 v[56:59], v[140:143], v[172:175], v[56:59]
    ds_read2_b32 v[84:85], v238 offset0:224 offset1:225
    v_alignbit_b32 v215, v216, v215, 16
    v_mfma_f32_16x16x32_bf16 v[56:59], v[144:147], v[168:171], v[56:59]
    ds_read2_b32 v[86:87], v238 offset0:226 offset1:227
    v_mfma_f32_16x16x32_bf16 v[56:59], v[148:151], v[164:167], v[56:59]
    ds_write_b128 v241, v[212:215] offset:4192
    v_mfma_f32_16x16x32_bf16 v[56:59], v[152:155], v[160:163], v[56:59]
    ds_read_b128 v[120:123], v246 offset:24576
    v_mfma_f32_16x16x32_bf16 v[60:63], v[156:159], v[160:163], v[60:63]
    ds_read2_b32 v[88:89], v239 offset0:96 offset1:97
    v_alignbit_b32 v218, v219, v218, 16
    v_mfma_f32_16x16x32_bf16 v[60:63], v[152:155], v[164:167], v[60:63]
    ds_read2_b32 v[90:91], v239 offset0:98 offset1:99
    v_alignbit_b32 v219, v220, v219, 16
    v_mfma_f32_16x16x32_bf16 v[60:63], v[148:151], v[168:171], v[60:63]
    v_mfma_f32_16x16x32_bf16 v[60:63], v[144:147], v[172:175], v[60:63]
    ds_read_b128 v[124:127], v246 offset:28672
    v_alignbit_b32 v220, v221, v220, 16
    v_mfma_f32_16x16x32_bf16 v[60:63], v[140:143], v[176:179], v[60:63]
    ds_read2_b32 v[92:93], v239 offset0:224 offset1:225
    v_mfma_f32_16x16x32_bf16 v[60:63], v[136:139], v[180:183], v[60:63]
    ds_read2_b32 v[94:95], v239 offset0:226 offset1:227
    v_alignbit_b32 v221, v222, v221, 16
    v_mfma_f32_16x16x32_bf16 v[60:63], v[132:135], v[184:187], v[60:63]
    ds_write_b128 v241, v[218:221] offset:5216
    v_mfma_f32_16x16x32_bf16 v[60:63], v[128:131], v[188:191], v[60:63]
    s_waitcnt lgkmcnt(15)
    v_mfma_f32_16x16x32_bf16 v[32:35], v[64:67], v[96:99], v[32:35]
    ds_read_b128 v[160:163], v247 offset:0
    v_mfma_f32_16x16x32_bf16 v[36:39], v[68:71], v[96:99], v[36:39]
    v_alignbit_b32 v224, v225, v224, 16
    v_mfma_f32_16x16x32_bf16 v[36:39], v[64:67], v[100:103], v[36:39]
    ds_read_b128 v[164:167], v247 offset:4096
    v_mfma_f32_16x16x32_bf16 v[40:43], v[64:67], v[104:107], v[40:43]
    ds_read_b128 v[168:171], v247 offset:8192
    v_mfma_f32_16x16x32_bf16 v[40:43], v[68:71], v[100:103], v[40:43]
    ds_read_b128 v[172:175], v247 offset:12288
    v_mfma_f32_16x16x32_bf16 v[40:43], v[72:75], v[96:99], v[40:43]
    v_alignbit_b32 v225, v226, v225, 16
    v_mfma_f32_16x16x32_bf16 v[44:47], v[76:79], v[96:99], v[44:47]
    ds_read_b128 v[176:179], v247 offset:16384
    v_mfma_f32_16x16x32_bf16 v[44:47], v[72:75], v[100:103], v[44:47]
    ds_read_b128 v[180:183], v247 offset:20480
    v_mfma_f32_16x16x32_bf16 v[44:47], v[68:71], v[104:107], v[44:47]
    ds_read_b128 v[184:187], v247 offset:24576
    v_mfma_f32_16x16x32_bf16 v[44:47], v[64:67], v[108:111], v[44:47]
    v_alignbit_b32 v226, v227, v226, 16
    s_waitcnt lgkmcnt(8)
    v_mfma_f32_16x16x32_bf16 v[48:51], v[64:67], v[112:115], v[48:51]
    ds_read_b128 v[188:191], v247 offset:28672
    v_mfma_f32_16x16x32_bf16 v[48:51], v[68:71], v[108:111], v[48:51]
    ds_read2_b32 v[128:129], v236 offset0:112 offset1:113
    v_mfma_f32_16x16x32_bf16 v[48:51], v[72:75], v[104:107], v[48:51]
    v_alignbit_b32 v227, v228, v227, 16
    v_mfma_f32_16x16x32_bf16 v[48:51], v[76:79], v[100:103], v[48:51]
    ds_read2_b32 v[130:131], v236 offset0:114 offset1:115
    v_mfma_f32_16x16x32_bf16 v[48:51], v[80:83], v[96:99], v[48:51]
    ds_read2_b32 v[132:133], v236 offset0:240 offset1:241
    v_mfma_f32_16x16x32_bf16 v[52:55], v[84:87], v[96:99], v[52:55]
    ds_read2_b32 v[134:135], v236 offset0:242 offset1:243
    v_mfma_f32_16x16x32_bf16 v[52:55], v[80:83], v[100:103], v[52:55]
    ds_write_b128 v241, v[224:227] offset:6240
    v_mfma_f32_16x16x32_bf16 v[52:55], v[76:79], v[104:107], v[52:55]
    ds_read2_b32 v[136:137], v237 offset0:112 offset1:113
    ds_read2_b32 v[138:139], v237 offset0:114 offset1:115
    v_mfma_f32_16x16x32_bf16 v[52:55], v[72:75], v[108:111], v[52:55]
    s_add_u32 s6, s12, 4734976
    ds_read2_b32 v[140:141], v237 offset0:240 offset1:241
    v_mfma_f32_16x16x32_bf16 v[52:55], v[68:71], v[112:115], v[52:55]
    ds_read2_b32 v[142:143], v237 offset0:242 offset1:243
    v_alignbit_b32 v230, v231, v230, 16
    v_xor_b32 v244, 64, v244
    v_mfma_f32_16x16x32_bf16 v[52:55], v[64:67], v[116:119], v[52:55]
    ds_read2_b32 v[144:145], v238 offset0:112 offset1:113
    v_mfma_f32_16x16x32_bf16 v[56:59], v[64:67], v[120:123], v[56:59]
    ds_read2_b32 v[146:147], v238 offset0:114 offset1:115
    v_xor_b32 v245, 64, v245
    v_mfma_f32_16x16x32_bf16 v[56:59], v[68:71], v[116:119], v[56:59]
    ds_read2_b32 v[148:149], v238 offset0:240 offset1:241
    v_mfma_f32_16x16x32_bf16 v[56:59], v[72:75], v[112:115], v[56:59]
    v_alignbit_b32 v231, v232, v231, 16
    v_xor_b32 v246, 64, v246
    v_mfma_f32_16x16x32_bf16 v[56:59], v[76:79], v[108:111], v[56:59]
    ds_read2_b32 v[150:151], v238 offset0:242 offset1:243
    v_mfma_f32_16x16x32_bf16 v[56:59], v[80:83], v[104:107], v[56:59]
    ds_read2_b32 v[152:153], v239 offset0:112 offset1:113
    v_xor_b32 v247, 64, v247
    v_mfma_f32_16x16x32_bf16 v[56:59], v[84:87], v[100:103], v[56:59]
    ds_read2_b32 v[154:155], v239 offset0:114 offset1:115
    v_mfma_f32_16x16x32_bf16 v[56:59], v[88:91], v[96:99], v[56:59]
    ds_read2_b32 v[156:157], v239 offset0:240 offset1:241
    v_alignbit_b32 v232, v233, v232, 16
    v_mfma_f32_16x16x32_bf16 v[60:63], v[92:95], v[96:99], v[60:63]
    ds_read2_b32 v[158:159], v239 offset0:242 offset1:243
    v_add_u32 v244, 36864, v244
    v_mfma_f32_16x16x32_bf16 v[60:63], v[88:91], v[100:103], v[60:63]
    v_add_u32 v236, -8320, v236
    v_mfma_f32_16x16x32_bf16 v[60:63], v[84:87], v[104:107], v[60:63]
    v_alignbit_b32 v233, v234, v233, 16
    v_add_u32 v245, 36864, v245
    v_mfma_f32_16x16x32_bf16 v[60:63], v[80:83], v[108:111], v[60:63]
    v_add_u32 v237, -8320, v237
    v_mfma_f32_16x16x32_bf16 v[60:63], v[76:79], v[112:115], v[60:63]
    s_waitcnt vmcnt(1)
    s_barrier
    v_add_u32 v246, 36864, v246
    v_mfma_f32_16x16x32_bf16 v[60:63], v[72:75], v[116:119], v[60:63]
    v_add_u32 v238, -8320, v238
    v_add_u32 v239, -8320, v239
    v_mfma_f32_16x16x32_bf16 v[60:63], v[68:71], v[120:123], v[60:63]
    ds_write_b128 v241, v[230:233] offset:7264
    v_mfma_f32_16x16x32_bf16 v[60:63], v[64:67], v[124:127], v[60:63]
    v_add_u32 v247, 36864, v247
    s_waitcnt lgkmcnt(1)
    v_mfma_f32_16x16x32_bf16 v[60:63], v[128:131], v[188:191], v[60:63]
    ds_read_b128 v[96:99], v244 offset:2048
    v_mfma_f32_16x16x32_bf16 v[60:63], v[132:135], v[184:187], v[60:63]
    ds_read2_b32 v[64:65], v236 offset0:0 offset1:1
    v_mfma_f32_16x16x32_bf16 v[60:63], v[136:139], v[180:183], v[60:63]
    ds_read2_b32 v[66:67], v236 offset0:2 offset1:3
    v_mfma_f32_16x16x32_bf16 v[60:63], v[140:143], v[176:179], v[60:63]
    ds_read_b128 v[100:103], v244 offset:6144
    v_mfma_f32_16x16x32_bf16 v[60:63], v[144:147], v[172:175], v[60:63]
    ds_read2_b32 v[68:69], v236 offset0:128 offset1:129
    v_mfma_f32_16x16x32_bf16 v[60:63], v[148:151], v[168:171], v[60:63]
    ds_read2_b32 v[70:71], v236 offset0:130 offset1:131
    v_mfma_f32_16x16x32_bf16 v[60:63], v[152:155], v[164:167], v[60:63]
    ds_read_b128 v[104:107], v244 offset:10240
    v_mfma_f32_16x16x32_bf16 v[60:63], v[156:159], v[160:163], v[60:63]
    ds_read2_b32 v[72:73], v237 offset0:0 offset1:1
    v_mfma_f32_16x16x32_bf16 v[56:59], v[128:131], v[184:187], v[56:59]
    ds_read2_b32 v[74:75], v237 offset0:2 offset1:3
    v_mfma_f32_16x16x32_bf16 v[56:59], v[132:135], v[180:183], v[56:59]
    ds_read_b128 v[108:111], v244 offset:14336
    v_mfma_f32_16x16x32_bf16 v[56:59], v[136:139], v[176:179], v[56:59]
    ds_read2_b32 v[76:77], v237 offset0:128 offset1:129
    v_mfma_f32_16x16x32_bf16 v[56:59], v[140:143], v[172:175], v[56:59]
    ds_read2_b32 v[78:79], v237 offset0:130 offset1:131
    v_mfma_f32_16x16x32_bf16 v[56:59], v[144:147], v[168:171], v[56:59]
    ds_read_b128 v[112:115], v244 offset:18432
    v_mfma_f32_16x16x32_bf16 v[56:59], v[148:151], v[164:167], v[56:59]
    ds_read2_b32 v[80:81], v238 offset0:0 offset1:1
    v_cvt_pk_bf16_f32 v206, v60, v61
    v_mfma_f32_16x16x32_bf16 v[56:59], v[152:155], v[160:163], v[56:59]
    ds_read2_b32 v[82:83], v238 offset0:2 offset1:3
    v_mfma_f32_16x16x32_bf16 v[52:55], v[128:131], v[180:183], v[52:55]
    ds_read_b128 v[116:119], v244 offset:22528
    v_mfma_f32_16x16x32_bf16 v[52:55], v[132:135], v[176:179], v[52:55]
    ds_read2_b32 v[84:85], v238 offset0:128 offset1:129
    v_cvt_pk_bf16_f32 v207, v62, v63
    v_mfma_f32_16x16x32_bf16 v[52:55], v[136:139], v[172:175], v[52:55]
    ds_read2_b32 v[86:87], v238 offset0:130 offset1:131
    v_mfma_f32_16x16x32_bf16 v[52:55], v[140:143], v[168:171], v[52:55]
    buffer_store_dwordx2 v[206:207], v8, s[44:47], s6 offen offset:3584 sc1
    ds_read_b128 v[120:123], v244 offset:26624
    v_mfma_f32_16x16x32_bf16 v[52:55], v[144:147], v[164:167], v[52:55]
    ds_read2_b32 v[88:89], v239 offset0:0 offset1:1
    v_mfma_f32_16x16x32_bf16 v[52:55], v[148:151], v[160:163], v[52:55]
    ds_read2_b32 v[90:91], v239 offset0:2 offset1:3
    v_mfma_f32_16x16x32_bf16 v[48:51], v[128:131], v[176:179], v[48:51]
    s_waitcnt vmcnt(1)
    s_barrier
    v_cvt_pk_bf16_f32 v204, v56, v57
    v_mfma_f32_16x16x32_bf16 v[48:51], v[132:135], v[172:175], v[48:51]
    ds_read_b128 v[124:127], v244 offset:30720
    v_mfma_f32_16x16x32_bf16 v[48:51], v[136:139], v[168:171], v[48:51]
    ds_read_b64_tr_b16 a[80:81], v10 offset:16384
    v_mfma_f32_16x16x32_bf16 v[48:51], v[140:143], v[164:167], v[48:51]
    ds_read_b64_tr_b16 a[82:83], v10 offset:18432
    v_cvt_pk_bf16_f32 v205, v58, v59
    v_mfma_f32_16x16x32_bf16 v[48:51], v[144:147], v[160:163], v[48:51]
    ds_read_b64_tr_b16 a[88:89], v10 offset:20480
    v_mfma_f32_16x16x32_bf16 v[44:47], v[128:131], v[172:175], v[44:47]
    buffer_store_dwordx2 v[204:205], v8, s[44:47], s6 offen offset:3072 sc1
    ds_read2_b32 v[92:93], v239 offset0:128 offset1:129
    v_mfma_f32_16x16x32_bf16 v[44:47], v[132:135], v[168:171], v[44:47]
    ds_read_b64_tr_b16 a[90:91], v10 offset:22528
    v_mfma_f32_16x16x32_bf16 v[44:47], v[136:139], v[164:167], v[44:47]
    ds_read_b64_tr_b16 a[84:85], v11 offset:16384
    ds_read2_b32 v[94:95], v239 offset0:130 offset1:131
    v_mfma_f32_16x16x32_bf16 v[44:47], v[140:143], v[160:163], v[44:47]
    v_cvt_pk_bf16_f32 v202, v52, v53
    v_mfma_f32_16x16x32_bf16 v[40:43], v[128:131], v[168:171], v[40:43]
    ds_read_b64_tr_b16 a[86:87], v11 offset:18432
    v_mfma_f32_16x16x32_bf16 v[40:43], v[132:135], v[164:167], v[40:43]
    ds_read_b64_tr_b16 a[92:93], v11 offset:20480
    v_mfma_f32_16x16x32_bf16 v[40:43], v[136:139], v[160:163], v[40:43]
    v_cvt_pk_bf16_f32 v203, v54, v55
    v_mfma_f32_16x16x32_bf16 v[36:39], v[128:131], v[164:167], v[36:39]
    ds_read_b64_tr_b16 a[94:95], v11 offset:22528
    v_mfma_f32_16x16x32_bf16 v[36:39], v[132:135], v[160:163], v[36:39]
    buffer_store_dwordx2 v[202:203], v8, s[44:47], s6 offen offset:2560 sc1
    v_mfma_f32_16x16x32_bf16 v[32:35], v[128:131], v[160:163], v[32:35]
    s_waitcnt lgkmcnt(3)
    v_mfma_f32_16x16x32_bf16 v[60:63], v[64:67], v[124:127], 0
    ds_read_b128 v[160:163], v245 offset:2048
    s_waitcnt lgkmcnt(1)
    s_barrier
    v_mfma_f32_16x16x32_bf16 v[60:63], v[68:71], v[120:123], v[60:63]
    v_cvt_pk_bf16_f32 v200, v48, v49
    v_mfma_f32_16x16x32_bf16 v[60:63], v[72:75], v[116:119], v[60:63]
    ds_read2_b32 v[128:129], v236 offset0:16 offset1:17
    v_mfma_f32_16x16x32_bf16 v[60:63], v[76:79], v[112:115], v[60:63]
    ds_read2_b32 v[130:131], v236 offset0:18 offset1:19
    s_lshl_b32 s14, s90, 18
    v_cvt_pk_bf16_f32 v201, v50, v51
    v_mfma_f32_16x16x32_bf16 v[60:63], v[80:83], v[108:111], v[60:63]
    s_add_u32 m0, s73, 147456
    v_mfma_f32_16x16x32_bf16 v[60:63], v[84:87], v[104:107], v[60:63]
    buffer_load_dwordx4 v4, s[52:55], s14 offen offset:0 lds
    ds_read_b128 v[164:167], v245 offset:6144
    v_mfma_f32_16x16x32_bf16 v[60:63], v[88:91], v[100:103], v[60:63]
    buffer_store_dwordx2 v[200:201], v8, s[44:47], s6 offen offset:2048 sc1
    ds_read2_b32 v[132:133], v236 offset0:144 offset1:145
    v_mfma_f32_16x16x32_bf16 v[60:63], v[92:95], v[96:99], v[60:63]
    s_add_u32 s13, s12, 49152
    v_cvt_pk_bf16_f32 v198, v44, v45
    v_mfma_f32_16x16x32_bf16 v[56:59], v[64:67], v[120:123], 0
    ds_read2_b32 v[134:135], v236 offset0:146 offset1:147
    v_mfma_f32_16x16x32_bf16 v[56:59], v[68:71], v[116:119], v[56:59]
    s_add_u32 m0, s74, 8352
    ds_read_b128 v[168:171], v245 offset:10240
    v_mfma_f32_16x16x32_bf16 v[56:59], v[72:75], v[112:115], v[56:59]
    buffer_load_dwordx4 v240, s[48:51], s13 offen offset:0 lds
    v_cvt_pk_bf16_f32 v199, v46, v47
    v_mfma_f32_16x16x32_bf16 v[56:59], v[76:79], v[108:111], v[56:59]
    ds_read2_b32 v[136:137], v237 offset0:16 offset1:17
    v_mfma_f32_16x16x32_bf16 v[56:59], v[80:83], v[104:107], v[56:59]
    buffer_store_dwordx2 v[198:199], v8, s[44:47], s6 offen offset:1536 sc1
    ds_read2_b32 v[138:139], v237 offset0:18 offset1:19
    v_mfma_f32_16x16x32_bf16 v[56:59], v[84:87], v[100:103], v[56:59]
    ds_read_b128 v[172:175], v245 offset:14336
    v_mfma_f32_16x16x32_bf16 v[56:59], v[88:91], v[96:99], v[56:59]
    v_cvt_pk_bf16_f32 v196, v40, v41
    v_mfma_f32_16x16x32_bf16 v[52:55], v[64:67], v[116:119], 0
    ds_read2_b32 v[140:141], v237 offset0:144 offset1:145
    v_mfma_f32_16x16x32_bf16 v[52:55], v[68:71], v[112:115], v[52:55]
    ds_read2_b32 v[142:143], v237 offset0:146 offset1:147
    s_add_u32 m0, s73, 147456
    v_cvt_pk_bf16_f32 v197, v42, v43
    v_mfma_f32_16x16x32_bf16 v[52:55], v[72:75], v[108:111], v[52:55]
    buffer_load_dwordx4 v5, s[52:55], s14 offen offset:1024 lds
    v_mfma_f32_16x16x32_bf16 v[52:55], v[76:79], v[104:107], v[52:55]
    buffer_store_dwordx2 v[196:197], v8, s[44:47], s6 offen offset:1024 sc1
    ds_read_b128 v[176:179], v245 offset:18432
    s_add_u32 m0, s74, 8352
    v_mfma_f32_16x16x32_bf16 v[52:55], v[80:83], v[100:103], v[52:55]
    buffer_load_dwordx4 v240, s[48:51], s13 offen offset:1024 lds
    ds_read2_b32 v[144:145], v238 offset0:16 offset1:17
    v_mfma_f32_16x16x32_bf16 v[52:55], v[84:87], v[96:99], v[52:55]
    v_mfma_f32_16x16x32_bf16 v[48:51], v[64:67], v[112:115], 0
    ds_read2_b32 v[146:147], v238 offset0:18 offset1:19
    v_cvt_pk_bf16_f32 v194, v36, v37
    v_mfma_f32_16x16x32_bf16 v[48:51], v[68:71], v[108:111], v[48:51]
    ds_read_b128 v[180:183], v245 offset:22528
    v_mfma_f32_16x16x32_bf16 v[48:51], v[72:75], v[104:107], v[48:51]
    v_cvt_pk_bf16_f32 v195, v38, v39
    v_mfma_f32_16x16x32_bf16 v[48:51], v[76:79], v[100:103], v[48:51]
    buffer_store_dwordx2 v[194:195], v8, s[44:47], s6 offen offset:512 sc1
    ds_read2_b32 v[148:149], v238 offset0:144 offset1:145
    s_add_u32 m0, s74, 8352
    v_mfma_f32_16x16x32_bf16 v[48:51], v[80:83], v[96:99], v[48:51]
    buffer_load_dwordx4 v240, s[48:51], s13 offen offset:2048 lds
    ds_read2_b32 v[150:151], v238 offset0:146 offset1:147
    v_mfma_f32_16x16x32_bf16 v[44:47], v[64:67], v[108:111], 0
    ds_read_b128 v[184:187], v245 offset:26624
    v_mfma_f32_16x16x32_bf16 v[44:47], v[68:71], v[104:107], v[44:47]
    v_cvt_pk_bf16_f32 v192, v32, v33
    v_mfma_f32_16x16x32_bf16 v[44:47], v[72:75], v[100:103], v[44:47]
    s_add_u32 m0, s73, 147456
    ds_read2_b32 v[152:153], v239 offset0:16 offset1:17
    v_mfma_f32_16x16x32_bf16 v[44:47], v[76:79], v[96:99], v[44:47]
    buffer_load_dwordx4 v6, s[52:55], s14 offen offset:2048 lds
    v_cvt_pk_bf16_f32 v193, v34, v35
    v_mfma_f32_16x16x32_bf16 v[40:43], v[64:67], v[104:107], 0
    ds_read2_b32 v[154:155], v239 offset0:18 offset1:19
    v_mfma_f32_16x16x32_bf16 v[40:43], v[68:71], v[100:103], v[40:43]
    buffer_store_dwordx2 v[192:193], v8, s[44:47], s6 offen offset:0 sc1
    ds_read_b128 v[188:191], v245 offset:30720
    v_mfma_f32_16x16x32_bf16 v[40:43], v[72:75], v[96:99], v[40:43]
    s_add_u32 m0, s74, 8352
    ds_read2_b32 v[156:157], v239 offset0:144 offset1:145
    v_mfma_f32_16x16x32_bf16 v[36:39], v[64:67], v[100:103], 0
    buffer_load_dwordx4 v240, s[48:51], s13 offen offset:3072 lds
    v_mfma_f32_16x16x32_bf16 v[36:39], v[68:71], v[96:99], v[36:39]
    ds_read2_b32 v[158:159], v239 offset0:146 offset1:147
    v_mfma_f32_16x16x32_bf16 v[32:35], v[64:67], v[96:99], 0
    s_waitcnt lgkmcnt(12)
    v_mfma_f32_16x16x32_bf16 v[32:35], v[128:131], v[160:163], v[32:35]
    ds_read_b128 v[96:99], v246 offset:2048
    v_mfma_f32_16x16x32_bf16 v[36:39], v[132:135], v[160:163], v[36:39]
    v_mfma_f32_16x16x32_bf16 v[36:39], v[128:131], v[164:167], v[36:39]
    ds_read2_b32 v[64:65], v236 offset0:32 offset1:33
    v_mfma_f32_16x16x32_bf16 v[40:43], v[128:131], v[168:171], v[40:43]
    s_barrier
    ds_read2_b32 v[66:67], v236 offset0:34 offset1:35
    s_add_u32 m0, s73, 147456
    v_mfma_f32_16x16x32_bf16 v[40:43], v[132:135], v[164:167], v[40:43]
    buffer_load_dwordx4 v7, s[52:55], s14 offen offset:3072 lds
    v_mfma_f32_16x16x32_bf16 v[40:43], v[136:139], v[160:163], v[40:43]
    ds_read_b128 v[100:103], v246 offset:6144
    v_mfma_f32_16x16x32_bf16 v[44:47], v[140:143], v[160:163], v[44:47]
    ds_read2_b32 v[68:69], v236 offset0:160 offset1:161
    v_mfma_f32_16x16x32_bf16 v[44:47], v[136:139], v[164:167], v[44:47]
    v_mfma_f32_16x16x32_bf16 v[44:47], v[132:135], v[168:171], v[44:47]
    ds_read2_b32 v[70:71], v236 offset0:162 offset1:163
    v_mfma_f32_16x16x32_bf16 v[44:47], v[128:131], v[172:175], v[44:47]
    ds_read_b128 v[104:107], v246 offset:10240
    s_waitcnt lgkmcnt(7)
    v_mfma_f32_16x16x32_bf16 v[48:51], v[128:131], v[176:179], v[48:51]
    ds_read2_b32 v[72:73], v237 offset0:32 offset1:33
    v_mfma_f32_16x16x32_bf16 v[48:51], v[132:135], v[172:175], v[48:51]
    ds_read2_b32 v[74:75], v237 offset0:34 offset1:35
    v_mfma_f32_16x16x32_bf16 v[48:51], v[136:139], v[168:171], v[48:51]
    v_mov_b32 v9, 24
    buffer_load_ushort v9, v9, s[56:59], s70 offen
    v_mfma_f32_16x16x32_bf16 v[48:51], v[140:143], v[164:167], v[48:51]
    ds_read_b128 v[108:111], v246 offset:14336
    v_mfma_f32_16x16x32_bf16 v[48:51], v[144:147], v[160:163], v[48:51]
    v_mfma_f32_16x16x32_bf16 v[52:55], v[148:151], v[160:163], v[52:55]
    ds_read2_b32 v[76:77], v237 offset0:160 offset1:161
    v_mfma_f32_16x16x32_bf16 v[52:55], v[144:147], v[164:167], v[52:55]
    ds_read2_b32 v[78:79], v237 offset0:162 offset1:163
    v_mfma_f32_16x16x32_bf16 v[52:55], v[140:143], v[168:171], v[52:55]
    v_mfma_f32_16x16x32_bf16 v[52:55], v[136:139], v[172:175], v[52:55]
    s_lshl_b32 s14, s91, 18
    ds_read_b128 v[112:115], v246 offset:18432
    v_mfma_f32_16x16x32_bf16 v[52:55], v[132:135], v[176:179], v[52:55]
    s_add_u32 m0, s73, 0
    ds_read2_b32 v[80:81], v238 offset0:32 offset1:33
    v_mfma_f32_16x16x32_bf16 v[52:55], v[128:131], v[180:183], v[52:55]
    buffer_load_dwordx4 v4, s[52:55], s14 offen offset:0 lds
    v_mfma_f32_16x16x32_bf16 v[56:59], v[128:131], v[184:187], v[56:59]
    ds_read2_b32 v[82:83], v238 offset0:34 offset1:35
    v_mfma_f32_16x16x32_bf16 v[56:59], v[132:135], v[180:183], v[56:59]
    ds_read_b128 v[116:119], v246 offset:22528
    v_mfma_f32_16x16x32_bf16 v[56:59], v[136:139], v[176:179], v[56:59]
    v_mfma_f32_16x16x32_bf16 v[56:59], v[140:143], v[172:175], v[56:59]
    ds_read2_b32 v[84:85], v238 offset0:160 offset1:161
    v_mfma_f32_16x16x32_bf16 v[56:59], v[144:147], v[168:171], v[56:59]
    ds_read2_b32 v[86:87], v238 offset0:162 offset1:163
    v_mfma_f32_16x16x32_bf16 v[56:59], v[148:151], v[164:167], v[56:59]
    ds_read_b128 v[120:123], v246 offset:26624
    v_mfma_f32_16x16x32_bf16 v[56:59], v[152:155], v[160:163], v[56:59]
    v_mfma_f32_16x16x32_bf16 v[60:63], v[156:159], v[160:163], v[60:63]
    ds_read2_b32 v[88:89], v239 offset0:32 offset1:33
    v_mfma_f32_16x16x32_bf16 v[60:63], v[152:155], v[164:167], v[60:63]
    ds_read2_b32 v[90:91], v239 offset0:34 offset1:35
    v_mfma_f32_16x16x32_bf16 v[60:63], v[148:151], v[168:171], v[60:63]
    s_add_u32 m0, s73, 0
    v_mfma_f32_16x16x32_bf16 v[60:63], v[144:147], v[172:175], v[60:63]
    buffer_load_dwordx4 v5, s[52:55], s14 offen offset:1024 lds
    ds_read_b128 v[124:127], v246 offset:30720
    v_mfma_f32_16x16x32_bf16 v[60:63], v[140:143], v[176:179], v[60:63]
    ds_read2_b32 v[92:93], v239 offset0:160 offset1:161
    v_mfma_f32_16x16x32_bf16 v[60:63], v[136:139], v[180:183], v[60:63]
    v_mfma_f32_16x16x32_bf16 v[60:63], v[132:135], v[184:187], v[60:63]
    ds_read2_b32 v[94:95], v239 offset0:162 offset1:163
    v_mfma_f32_16x16x32_bf16 v[60:63], v[128:131], v[188:191], v[60:63]
    s_waitcnt lgkmcnt(12)
    v_mfma_f32_16x16x32_bf16 v[32:35], v[64:67], v[96:99], v[32:35]
    ds_read_b128 v[160:163], v247 offset:2048
    v_mfma_f32_16x16x32_bf16 v[36:39], v[68:71], v[96:99], v[36:39]
    v_mfma_f32_16x16x32_bf16 v[36:39], v[64:67], v[100:103], v[36:39]
    ds_read2_b32 v[128:129], v236 offset0:48 offset1:49
    v_mfma_f32_16x16x32_bf16 v[40:43], v[64:67], v[104:107], v[40:43]
    ds_read2_b32 v[130:131], v236 offset0:50 offset1:51
    v_mfma_f32_16x16x32_bf16 v[40:43], v[68:71], v[100:103], v[40:43]
    v_mfma_f32_16x16x32_bf16 v[40:43], v[72:75], v[96:99], v[40:43]
    ds_read_b128 v[164:167], v247 offset:6144
    v_mfma_f32_16x16x32_bf16 v[44:47], v[76:79], v[96:99], v[44:47]
    s_add_u32 m0, s73, 0
    ds_read2_b32 v[132:133], v236 offset0:176 offset1:177
    v_mfma_f32_16x16x32_bf16 v[44:47], v[72:75], v[100:103], v[44:47]
    buffer_load_dwordx4 v6, s[52:55], s14 offen offset:2048 lds
    v_mfma_f32_16x16x32_bf16 v[44:47], v[68:71], v[104:107], v[44:47]
    ds_read2_b32 v[134:135], v236 offset0:178 offset1:179
    v_mfma_f32_16x16x32_bf16 v[44:47], v[64:67], v[108:111], v[44:47]
    ds_read_b128 v[168:171], v247 offset:10240
    s_waitcnt lgkmcnt(7)
    v_mfma_f32_16x16x32_bf16 v[48:51], v[64:67], v[112:115], v[48:51]
    ds_read2_b32 v[136:137], v237 offset0:48 offset1:49
    v_mfma_f32_16x16x32_bf16 v[48:51], v[68:71], v[108:111], v[48:51]
    v_mfma_f32_16x16x32_bf16 v[48:51], v[72:75], v[104:107], v[48:51]
    ds_read2_b32 v[138:139], v237 offset0:50 offset1:51
    v_mfma_f32_16x16x32_bf16 v[48:51], v[76:79], v[100:103], v[48:51]
L_pl_X_4:
    s_cbranch_execz L_wret
    ds_read_b128 v[172:175], v247 offset:14336
    v_mfma_f32_16x16x32_bf16 v[48:51], v[80:83], v[96:99], v[48:51]
    v_mfma_f32_16x16x32_bf16 v[52:55], v[84:87], v[96:99], v[52:55]
    ds_read2_b32 v[140:141], v237 offset0:176 offset1:177
    v_mfma_f32_16x16x32_bf16 v[52:55], v[80:83], v[100:103], v[52:55]
    ds_read2_b32 v[142:143], v237 offset0:178 offset1:179
    v_mfma_f32_16x16x32_bf16 v[52:55], v[76:79], v[104:107], v[52:55]
    v_mfma_f32_16x16x32_bf16 v[52:55], v[72:75], v[108:111], v[52:55]
    s_add_u32 m0, s73, 0
    ds_read_b128 v[176:179], v247 offset:18432
    v_mfma_f32_16x16x32_bf16 v[52:55], v[68:71], v[112:115], v[52:55]
    buffer_load_dwordx4 v7, s[52:55], s14 offen offset:3072 lds
    ds_read2_b32 v[144:145], v238 offset0:48 offset1:49
    v_mfma_f32_16x16x32_bf16 v[52:55], v[64:67], v[116:119], v[52:55]
    v_mfma_f32_16x16x32_bf16 v[56:59], v[64:67], v[120:123], v[56:59]
    ds_read2_b32 v[146:147], v238 offset0:50 offset1:51
    v_mfma_f32_16x16x32_bf16 v[56:59], v[68:71], v[116:119], v[56:59]
    ds_read_b128 v[180:183], v247 offset:22528
    v_mfma_f32_16x16x32_bf16 v[56:59], v[72:75], v[112:115], v[56:59]
    v_mfma_f32_16x16x32_bf16 v[56:59], v[76:79], v[108:111], v[56:59]
    ds_read2_b32 v[148:149], v238 offset0:176 offset1:177
    v_mfma_f32_16x16x32_bf16 v[56:59], v[80:83], v[104:107], v[56:59]
    ds_read2_b32 v[150:151], v238 offset0:178 offset1:179
    v_mfma_f32_16x16x32_bf16 v[56:59], v[84:87], v[100:103], v[56:59]
    ds_read_b128 v[184:187], v247 offset:26624
    v_mfma_f32_16x16x32_bf16 v[56:59], v[88:91], v[96:99], v[56:59]
    v_mfma_f32_16x16x32_bf16 v[60:63], v[92:95], v[96:99], v[60:63]
    s_lshl_b32 s14, s92, 18
    ds_read2_b32 v[152:153], v239 offset0:48 offset1:49
    v_mfma_f32_16x16x32_bf16 v[60:63], v[88:91], v[100:103], v[60:63]
    s_add_u32 m0, s73, 16384
    ds_read2_b32 v[154:155], v239 offset0:50 offset1:51
    v_mfma_f32_16x16x32_bf16 v[60:63], v[84:87], v[104:107], v[60:63]
    buffer_load_dwordx4 v4, s[52:55], s14 offen offset:0 lds
    v_mfma_f32_16x16x32_bf16 v[60:63], v[80:83], v[108:111], v[60:63]
    ds_read_b128 v[188:191], v247 offset:30720
    v_mfma_f32_16x16x32_bf16 v[60:63], v[76:79], v[112:115], v[60:63]
    ds_read2_b32 v[156:157], v239 offset0:176 offset1:177
    v_mfma_f32_16x16x32_bf16 v[60:63], v[72:75], v[116:119], v[60:63]
    v_mfma_f32_16x16x32_bf16 v[60:63], v[68:71], v[120:123], v[60:63]
    ds_read2_b32 v[158:159], v239 offset0:178 offset1:179
    v_mfma_f32_16x16x32_bf16 v[60:63], v[64:67], v[124:127], v[60:63]
    s_waitcnt lgkmcnt(12)
    v_mfma_f32_16x16x32_bf16 v[32:35], v[128:131], v[160:163], v[32:35]
    ds_read_b128 v[96:99], v244 offset:0
    v_mfma_f32_16x16x32_bf16 v[36:39], v[132:135], v[160:163], v[36:39]
    ds_read2_b32 v[64:65], v236 offset0:64 offset1:65
    v_mfma_f32_16x16x32_bf16 v[36:39], v[128:131], v[164:167], v[36:39]
    ds_read2_b32 v[66:67], v236 offset0:66 offset1:67
    v_mfma_f32_16x16x32_bf16 v[40:43], v[128:131], v[168:171], v[40:43]
    ds_read_b128 v[100:103], v244 offset:4096
    v_mfma_f32_16x16x32_bf16 v[40:43], v[132:135], v[164:167], v[40:43]
    ds_read2_b32 v[68:69], v236 offset0:192 offset1:193
    v_mfma_f32_16x16x32_bf16 v[40:43], v[136:139], v[160:163], v[40:43]
    s_add_u32 m0, s73, 16384
    ds_read2_b32 v[70:71], v236 offset0:194 offset1:195
    v_mfma_f32_16x16x32_bf16 v[44:47], v[140:143], v[160:163], v[44:47]
    buffer_load_dwordx4 v5, s[52:55], s14 offen offset:1024 lds
    ds_read_b128 v[104:107], v244 offset:8192
    v_mfma_f32_16x16x32_bf16 v[44:47], v[136:139], v[164:167], v[44:47]
    ds_read2_b32 v[72:73], v237 offset0:64 offset1:65
    s_waitcnt vmcnt(7)
    s_barrier
    v_mfma_f32_16x16x32_bf16 v[44:47], v[132:135], v[168:171], v[44:47]
    ds_read_b64_tr_b16 a[96:97], v10 offset:16384
    v_mfma_f32_16x16x32_bf16 v[44:47], v[128:131], v[172:175], v[44:47]
    ds_read2_b32 v[74:75], v237 offset0:66 offset1:67
    s_waitcnt lgkmcnt(10)
    v_mfma_f32_16x16x32_bf16 v[48:51], v[128:131], v[176:179], v[48:51]
    ds_read_b64_tr_b16 a[98:99], v10 offset:18432
    v_mfma_f32_16x16x32_bf16 v[48:51], v[132:135], v[172:175], v[48:51]
    ds_read_b64_tr_b16 a[104:105], v10 offset:20480
    v_mfma_f32_16x16x32_bf16 v[48:51], v[136:139], v[168:171], v[48:51]
    ds_read_b64_tr_b16 a[106:107], v10 offset:22528
    v_mfma_f32_16x16x32_bf16 v[48:51], v[140:143], v[164:167], v[48:51]
    ds_read_b128 v[108:111], v244 offset:12288
    v_mfma_f32_16x16x32_bf16 v[48:51], v[144:147], v[160:163], v[48:51]
    ds_read_b64_tr_b16 a[100:101], v11 offset:16384
    v_mfma_f32_16x16x32_bf16 v[52:55], v[148:151], v[160:163], v[52:55]
    ds_read_b64_tr_b16 a[102:103], v11 offset:18432
    v_mfma_f32_16x16x32_bf16 v[52:55], v[144:147], v[164:167], v[52:55]
    ds_read2_b32 v[76:77], v237 offset0:192 offset1:193
    v_mfma_f32_16x16x32_bf16 v[52:55], v[140:143], v[168:171], v[52:55]
    ds_read_b64_tr_b16 a[108:109], v11 offset:20480
    s_add_u32 m0, s73, 16384
    v_mfma_f32_16x16x32_bf16 v[52:55], v[136:139], v[172:175], v[52:55]
    ds_read_b64_tr_b16 a[110:111], v11 offset:22528
    buffer_load_dwordx4 v6, s[52:55], s14 offen offset:2048 lds
    v_mfma_f32_16x16x32_bf16 v[52:55], v[132:135], v[176:179], v[52:55]
    ds_read2_b32 v[78:79], v237 offset0:194 offset1:195
    v_mfma_f32_16x16x32_bf16 v[52:55], v[128:131], v[180:183], v[52:55]
    ds_read_b128 v[112:115], v244 offset:16384
    v_mfma_f32_16x16x32_bf16 v[56:59], v[128:131], v[184:187], v[56:59]
    ds_read2_b32 v[80:81], v238 offset0:64 offset1:65
    v_mfma_f32_16x16x32_bf16 v[56:59], v[132:135], v[180:183], v[56:59]
    ds_read2_b32 v[82:83], v238 offset0:66 offset1:67
    v_mfma_f32_16x16x32_bf16 v[56:59], v[136:139], v[176:179], v[56:59]
    ds_read_b128 v[116:119], v244 offset:20480
    v_mfma_f32_16x16x32_bf16 v[56:59], v[140:143], v[172:175], v[56:59]
    ds_read2_b32 v[84:85], v238 offset0:192 offset1:193
    v_mfma_f32_16x16x32_bf16 v[56:59], v[144:147], v[168:171], v[56:59]
    ds_read2_b32 v[86:87], v238 offset0:194 offset1:195
    v_mfma_f32_16x16x32_bf16 v[56:59], v[148:151], v[164:167], v[56:59]
    ds_read_b128 v[120:123], v244 offset:24576
    v_mfma_f32_16x16x32_bf16 v[56:59], v[152:155], v[160:163], v[56:59]
    v_mfma_f32_16x16x32_bf16 v[60:63], v[156:159], v[160:163], v[60:63]
    s_add_u32 m0, s73, 16384
    ds_read2_b32 v[88:89], v239 offset0:64 offset1:65
    v_mfma_f32_16x16x32_bf16 v[60:63], v[152:155], v[164:167], v[60:63]
    buffer_load_dwordx4 v7, s[52:55], s14 offen offset:3072 lds
    ds_read2_b32 v[90:91], v239 offset0:66 offset1:67
    v_mfma_f32_16x16x32_bf16 v[60:63], v[148:151], v[168:171], v[60:63]
    v_mfma_f32_16x16x32_bf16 v[60:63], v[144:147], v[172:175], v[60:63]
    ds_read_b128 v[124:127], v244 offset:28672
    v_mfma_f32_16x16x32_bf16 v[60:63], v[140:143], v[176:179], v[60:63]
    ds_read2_b32 v[92:93], v239 offset0:192 offset1:193
    v_mfma_f32_16x16x32_bf16 v[60:63], v[136:139], v[180:183], v[60:63]
    v_mfma_f32_16x16x32_bf16 v[60:63], v[132:135], v[184:187], v[60:63]
    ds_read2_b32 v[94:95], v239 offset0:194 offset1:195
    v_mfma_f32_16x16x32_bf16 v[60:63], v[128:131], v[188:191], v[60:63]
    s_waitcnt lgkmcnt(12)
    v_mfma_f32_16x16x32_bf16 v[32:35], v[64:67], v[96:99], v[32:35]
    ds_read_b128 v[160:163], v245 offset:0
    v_mfma_f32_16x16x32_bf16 v[36:39], v[68:71], v[96:99], v[36:39]
    ds_read2_b32 v[128:129], v236 offset0:80 offset1:81
    v_mfma_f32_16x16x32_bf16 v[36:39], v[64:67], v[100:103], v[36:39]
    ds_read2_b32 v[130:131], v236 offset0:82 offset1:83
    v_mfma_f32_16x16x32_bf16 v[40:43], v[64:67], v[104:107], v[40:43]
    ds_read_b128 v[164:167], v245 offset:4096
    s_barrier
    v_mfma_f32_16x16x32_bf16 v[40:43], v[68:71], v[100:103], v[40:43]
    ds_read2_b32 v[132:133], v236 offset0:208 offset1:209
    v_mfma_f32_16x16x32_bf16 v[40:43], v[72:75], v[96:99], v[40:43]
    ds_read2_b32 v[134:135], v236 offset0:210 offset1:211
    v_mfma_f32_16x16x32_bf16 v[44:47], v[76:79], v[96:99], v[44:47]
    ds_read_b128 v[168:171], v245 offset:8192
    v_mfma_f32_16x16x32_bf16 v[44:47], v[72:75], v[100:103], v[44:47]
    s_lshl_b32 s14, s93, 18
    ds_read2_b32 v[136:137], v237 offset0:80 offset1:81
    v_mfma_f32_16x16x32_bf16 v[44:47], v[68:71], v[104:107], v[44:47]
    s_add_u32 m0, s73, 147456
    ds_read2_b32 v[138:139], v237 offset0:82 offset1:83
    v_mfma_f32_16x16x32_bf16 v[44:47], v[64:67], v[108:111], v[44:47]
    buffer_load_dwordx4 v4, s[52:55], s14 offen offset:0 lds
    ds_read_b128 v[172:175], v245 offset:12288
    s_waitcnt lgkmcnt(10)
    v_mfma_f32_16x16x32_bf16 v[48:51], v[64:67], v[112:115], v[48:51]
    ds_read2_b32 v[140:141], v237 offset0:208 offset1:209
    v_mfma_f32_16x16x32_bf16 v[48:51], v[68:71], v[108:111], v[48:51]
    ds_read2_b32 v[142:143], v237 offset0:210 offset1:211
    v_mfma_f32_16x16x32_bf16 v[48:51], v[72:75], v[104:107], v[48:51]
    ds_read_b128 v[176:179], v245 offset:16384
    v_mfma_f32_16x16x32_bf16 v[48:51], v[76:79], v[100:103], v[48:51]
    ds_read2_b32 v[144:145], v238 offset0:80 offset1:81
    v_mfma_f32_16x16x32_bf16 v[48:51], v[80:83], v[96:99], v[48:51]
    ds_read2_b32 v[146:147], v238 offset0:82 offset1:83
    v_mfma_f32_16x16x32_bf16 v[52:55], v[84:87], v[96:99], v[52:55]
    ds_read_b128 v[180:183], v245 offset:20480
    v_mfma_f32_16x16x32_bf16 v[52:55], v[80:83], v[100:103], v[52:55]
    ds_read2_b32 v[148:149], v238 offset0:208 offset1:209
    v_mfma_f32_16x16x32_bf16 v[52:55], v[76:79], v[104:107], v[52:55]
    ds_read2_b32 v[150:151], v238 offset0:210 offset1:211
    v_mfma_f32_16x16x32_bf16 v[52:55], v[72:75], v[108:111], v[52:55]
    ds_read_b128 v[184:187], v245 offset:24576
    v_mfma_f32_16x16x32_bf16 v[52:55], v[68:71], v[112:115], v[52:55]
    s_add_u32 m0, s73, 147456
    ds_read_b128 v[212:215], v241 offset:8352
    v_mfma_f32_16x16x32_bf16 v[52:55], v[64:67], v[116:119], v[52:55]
    buffer_load_dwordx4 v5, s[52:55], s14 offen offset:1024 lds
    ds_read2_b32 v[152:153], v239 offset0:80 offset1:81
    v_mfma_f32_16x16x32_bf16 v[56:59], v[64:67], v[120:123], v[56:59]
    ds_read_b32 v216, v241 offset:8368
    v_mfma_f32_16x16x32_bf16 v[56:59], v[68:71], v[116:119], v[56:59]
    ds_read_b128 v[218:221], v241 offset:9376
    v_mfma_f32_16x16x32_bf16 v[56:59], v[72:75], v[112:115], v[56:59]
    ds_read_b32 v222, v241 offset:9392
    v_mfma_f32_16x16x32_bf16 v[56:59], v[76:79], v[108:111], v[56:59]
    ds_read_b128 v[224:227], v241 offset:10400
    v_mfma_f32_16x16x32_bf16 v[56:59], v[80:83], v[104:107], v[56:59]
    ds_read_b32 v228, v241 offset:10416
    s_waitcnt vmcnt(6)
    s_barrier
    v_mfma_f32_16x16x32_bf16 v[56:59], v[84:87], v[100:103], v[56:59]
    ds_read_b128 v[230:233], v241 offset:11424
    v_add_u32 v10, -131072, v10
    v_mfma_f32_16x16x32_bf16 v[56:59], v[88:91], v[96:99], v[56:59]
    ds_read_b64_tr_b16 a[112:113], v10 offset:0
    v_mfma_f32_16x16x32_bf16 v[60:63], v[92:95], v[96:99], v[60:63]
    ds_read_b64_tr_b16 a[114:115], v10 offset:2048
    v_mfma_f32_16x16x32_bf16 v[60:63], v[88:91], v[100:103], v[60:63]
    ds_read_b64_tr_b16 a[120:121], v10 offset:4096
    ds_read2_b32 v[154:155], v239 offset0:82 offset1:83
    v_mfma_f32_16x16x32_bf16 v[60:63], v[84:87], v[104:107], v[60:63]
    ds_read_b32 v234, v241 offset:11440
    v_mfma_f32_16x16x32_bf16 v[60:63], v[80:83], v[108:111], v[60:63]
    ds_read_b64_tr_b16 a[122:123], v10 offset:6144
    s_add_u32 m0, s73, 147456
    ds_read_b128 v[188:191], v245 offset:28672
    v_mfma_f32_16x16x32_bf16 v[60:63], v[76:79], v[112:115], v[60:63]
    v_add_u32 v11, -131072, v11
    buffer_load_dwordx4 v6, s[52:55], s14 offen offset:2048 lds
    ds_read2_b32 v[156:157], v239 offset0:208 offset1:209
    v_mfma_f32_16x16x32_bf16 v[60:63], v[72:75], v[116:119], v[60:63]
    ds_read_b64_tr_b16 a[116:117], v11 offset:0
    v_mfma_f32_16x16x32_bf16 v[60:63], v[68:71], v[120:123], v[60:63]
    ds_read_b64_tr_b16 a[118:119], v11 offset:2048
    ds_read2_b32 v[158:159], v239 offset0:210 offset1:211
    v_mfma_f32_16x16x32_bf16 v[60:63], v[64:67], v[124:127], v[60:63]
    ds_read_b64_tr_b16 a[124:125], v11 offset:4096
    s_waitcnt lgkmcnt(15)
    v_mfma_f32_16x16x32_bf16 v[32:35], v[128:131], v[160:163], v[32:35]
    ds_read_b64_tr_b16 a[126:127], v11 offset:6144
    v_mfma_f32_16x16x32_bf16 v[36:39], v[132:135], v[160:163], v[36:39]
    ds_read_b128 v[96:99], v246 offset:0
    v_mfma_f32_16x16x32_bf16 v[36:39], v[128:131], v[164:167], v[36:39]
    ds_read2_b32 v[64:65], v236 offset0:96 offset1:97
    v_mfma_f32_16x16x32_bf16 v[40:43], v[128:131], v[168:171], v[40:43]
    ds_read2_b32 v[66:67], v236 offset0:98 offset1:99
    v_mfma_f32_16x16x32_bf16 v[40:43], v[132:135], v[164:167], v[40:43]
    s_waitcnt lgkmcnt(11)
    v_mfma_f32_16x16x32_bf16 v[40:43], v[136:139], v[160:163], v[40:43]
    ds_read_b128 v[100:103], v246 offset:4096
    v_mfma_f32_16x16x32_bf16 v[44:47], v[140:143], v[160:163], v[44:47]
    ds_read2_b32 v[68:69], v236 offset0:224 offset1:225
    v_mfma_f32_16x16x32_bf16 v[44:47], v[136:139], v[164:167], v[44:47]
    s_add_u32 m0, s73, 147456
    ds_read2_b32 v[70:71], v236 offset0:226 offset1:227
    v_mfma_f32_16x16x32_bf16 v[44:47], v[132:135], v[168:171], v[44:47]
    buffer_load_dwordx4 v7, s[52:55], s14 offen offset:3072 lds
    v_lshlrev_b32 v9, 16, v9
    v_mfma_f32_16x16x32_bf16 v[44:47], v[128:131], v[172:175], v[44:47]
    ds_read_b128 v[104:107], v246 offset:8192
    s_waitcnt lgkmcnt(9)
    v_mfma_f32_16x16x32_bf16 v[48:51], v[128:131], v[176:179], v[48:51]
    ds_read2_b32 v[72:73], v237 offset0:96 offset1:97
    v_lshlrev_b32 v208, 16, v212
    v_mfma_f32_16x16x32_bf16 v[48:51], v[132:135], v[172:175], v[48:51]
    v_mfma_f32_16x16x32_bf16 v[48:51], v[136:139], v[168:171], v[48:51]
    ds_read2_b32 v[74:75], v237 offset0:98 offset1:99
    v_add_f32 v9, v9, v208
    v_mfma_f32_16x16x32_bf16 v[48:51], v[140:143], v[164:167], v[48:51]
    ds_read_b128 v[108:111], v246 offset:12288
    v_cvt_pk_bf16_f32 v9, v9, v9
    v_mfma_f32_16x16x32_bf16 v[48:51], v[144:147], v[160:163], v[48:51]
    ds_read2_b32 v[76:77], v237 offset0:224 offset1:225
    s_waitcnt lgkmcnt(11)
    s_barrier
    v_mfma_f32_16x16x32_bf16 v[52:55], v[148:151], v[160:163], v[52:55]
    ds_write_b16 v242, v9 offset:12480
    v_mfma_f32_16x16x32_bf16 v[52:55], v[144:147], v[164:167], v[52:55]
    ds_read2_b32 v[78:79], v237 offset0:226 offset1:227
    v_mfma_f32_16x16x32_bf16 v[52:55], v[140:143], v[168:171], v[52:55]
    ds_write_b16 v242, v9 offset:8322
    v_mfma_f32_16x16x32_bf16 v[52:55], v[136:139], v[172:175], v[52:55]
    s_lshl_b32 s14, s94, 18
    ds_read_b128 v[112:115], v246 offset:16384
    v_mfma_f32_16x16x32_bf16 v[52:55], v[132:135], v[176:179], v[52:55]
    ds_read2_b32 v[80:81], v238 offset0:96 offset1:97
    s_add_u32 m0, s73, 0
    v_alignbit_b32 v212, v213, v212, 16
    v_mfma_f32_16x16x32_bf16 v[52:55], v[128:131], v[180:183], v[52:55]
    buffer_load_dwordx4 v4, s[52:55], s14 offen offset:0 lds
    v_alignbit_b32 v213, v214, v213, 16
    v_mfma_f32_16x16x32_bf16 v[56:59], v[128:131], v[184:187], v[56:59]
    ds_read2_b32 v[82:83], v238 offset0:98 offset1:99
    v_mfma_f32_16x16x32_bf16 v[56:59], v[132:135], v[180:183], v[56:59]
    ds_read_b128 v[116:119], v246 offset:20480
    v_alignbit_b32 v214, v215, v214, 16
    v_mfma_f32_16x16x32_bf16 v[56:59], v[136:139], v[176:179], v[56:59]
    v_mfma_f32_16x16x32_bf16 v[56:59], v[140:143], v[172:175], v[56:59]
    ds_read2_b32 v[84:85], v238 offset0:224 offset1:225
    v_alignbit_b32 v215, v216, v215, 16
    v_mfma_f32_16x16x32_bf16 v[56:59], v[144:147], v[168:171], v[56:59]
    ds_read2_b32 v[86:87], v238 offset0:226 offset1:227
    v_mfma_f32_16x16x32_bf16 v[56:59], v[148:151], v[164:167], v[56:59]
    ds_write_b128 v241, v[212:215] offset:12512
    v_mfma_f32_16x16x32_bf16 v[56:59], v[152:155], v[160:163], v[56:59]
    ds_read_b128 v[120:123], v246 offset:24576
    v_mfma_f32_16x16x32_bf16 v[60:63], v[156:159], v[160:163], v[60:63]
    ds_read2_b32 v[88:89], v239 offset0:96 offset1:97
    v_alignbit_b32 v218, v219, v218, 16
    v_mfma_f32_16x16x32_bf16 v[60:63], v[152:155], v[164:167], v[60:63]
    ds_read2_b32 v[90:91], v239 offset0:98 offset1:99
    v_alignbit_b32 v219, v220, v219, 16
    v_mfma_f32_16x16x32_bf16 v[60:63], v[148:151], v[168:171], v[60:63]
    s_add_u32 m0, s73, 0
    ds_read_b128 v[124:127], v246 offset:28672
    v_mfma_f32_16x16x32_bf16 v[60:63], v[144:147], v[172:175], v[60:63]
    buffer_load_dwordx4 v5, s[52:55], s14 offen offset:1024 lds
    v_alignbit_b32 v220, v221, v220, 16
    v_mfma_f32_16x16x32_bf16 v[60:63], v[140:143], v[176:179], v[60:63]
    ds_read2_b32 v[92:93], v239 offset0:224 offset1:225
    v_mfma_f32_16x16x32_bf16 v[60:63], v[136:139], v[180:183], v[60:63]
    ds_read2_b32 v[94:95], v239 offset0:226 offset1:227
    v_alignbit_b32 v221, v222, v221, 16
    v_mfma_f32_16x16x32_bf16 v[60:63], v[132:135], v[184:187], v[60:63]
    ds_write_b128 v241, v[218:221] offset:13536
    v_mfma_f32_16x16x32_bf16 v[60:63], v[128:131], v[188:191], v[60:63]
    s_waitcnt lgkmcnt(15)
    v_mfma_f32_16x16x32_bf16 v[32:35], v[64:67], v[96:99], v[32:35]
    ds_read_b128 v[160:163], v247 offset:0
    s_waitcnt vmcnt(6)
    s_barrier
    v_mfma_f32_16x16x32_bf16 v[36:39], v[68:71], v[96:99], v[36:39]
    ds_read_b64_tr_b16 a[128:129], v10 offset:16384
    v_alignbit_b32 v224, v225, v224, 16
    v_mfma_f32_16x16x32_bf16 v[36:39], v[64:67], v[100:103], v[36:39]
    ds_read_b64_tr_b16 a[130:131], v10 offset:18432
    ds_read_b128 v[164:167], v247 offset:4096
    v_mfma_f32_16x16x32_bf16 v[40:43], v[64:67], v[104:107], v[40:43]
    ds_read_b128 v[168:171], v247 offset:8192
    v_mfma_f32_16x16x32_bf16 v[40:43], v[68:71], v[100:103], v[40:43]
    ds_read_b64_tr_b16 a[136:137], v10 offset:20480
    ds_read_b128 v[172:175], v247 offset:12288
    v_mfma_f32_16x16x32_bf16 v[40:43], v[72:75], v[96:99], v[40:43]
    ds_read_b64_tr_b16 a[138:139], v10 offset:22528
    v_alignbit_b32 v225, v226, v225, 16
    v_mfma_f32_16x16x32_bf16 v[44:47], v[76:79], v[96:99], v[44:47]
    s_add_u32 m0, s73, 0
    ds_read_b128 v[176:179], v247 offset:16384
    v_mfma_f32_16x16x32_bf16 v[44:47], v[72:75], v[100:103], v[44:47]
    ds_read_b64_tr_b16 a[132:133], v11 offset:16384
    buffer_load_dwordx4 v6, s[52:55], s14 offen offset:2048 lds
    ds_read_b128 v[180:183], v247 offset:20480
    v_mfma_f32_16x16x32_bf16 v[44:47], v[68:71], v[104:107], v[44:47]
    ds_read_b64_tr_b16 a[134:135], v11 offset:18432
    v_mfma_f32_16x16x32_bf16 v[44:47], v[64:67], v[108:111], v[44:47]
    ds_read_b128 v[184:187], v247 offset:24576
    v_alignbit_b32 v226, v227, v226, 16
    s_waitcnt lgkmcnt(14)
    v_mfma_f32_16x16x32_bf16 v[48:51], v[64:67], v[112:115], v[48:51]
    ds_read_b64_tr_b16 a[140:141], v11 offset:20480
    ds_read_b128 v[188:191], v247 offset:28672
    v_mfma_f32_16x16x32_bf16 v[48:51], v[68:71], v[108:111], v[48:51]
    ds_read_b64_tr_b16 a[142:143], v11 offset:22528
    v_mfma_f32_16x16x32_bf16 v[48:51], v[72:75], v[104:107], v[48:51]
    ds_read2_b32 v[128:129], v236 offset0:112 offset1:113
    v_alignbit_b32 v227, v228, v227, 16
    v_mfma_f32_16x16x32_bf16 v[48:51], v[76:79], v[100:103], v[48:51]
    ds_read2_b32 v[130:131], v236 offset0:114 offset1:115
    v_mfma_f32_16x16x32_bf16 v[48:51], v[80:83], v[96:99], v[48:51]
    ds_read2_b32 v[132:133], v236 offset0:240 offset1:241
    v_mfma_f32_16x16x32_bf16 v[52:55], v[84:87], v[96:99], v[52:55]
    ds_read2_b32 v[134:135], v236 offset0:242 offset1:243
    v_mfma_f32_16x16x32_bf16 v[52:55], v[80:83], v[100:103], v[52:55]
    ds_write_b128 v241, v[224:227] offset:14560
    v_mfma_f32_16x16x32_bf16 v[52:55], v[76:79], v[104:107], v[52:55]
    ds_read2_b32 v[136:137], v237 offset0:112 offset1:113
    ds_read2_b32 v[138:139], v237 offset0:114 offset1:115
    v_mfma_f32_16x16x32_bf16 v[52:55], v[72:75], v[108:111], v[52:55]
    s_add_u32 m0, s73, 0
    ds_read2_b32 v[140:141], v237 offset0:240 offset1:241
    s_add_u32 s6, s12, 4751360
    v_mfma_f32_16x16x32_bf16 v[52:55], v[68:71], v[112:115], v[52:55]
    buffer_load_dwordx4 v7, s[52:55], s14 offen offset:3072 lds
    v_alignbit_b32 v230, v231, v230, 16
    v_mfma_f32_16x16x32_bf16 v[52:55], v[64:67], v[116:119], v[52:55]
    ds_read2_b32 v[142:143], v237 offset0:242 offset1:243
    v_xor_b32 v244, 64, v244
    v_mfma_f32_16x16x32_bf16 v[56:59], v[64:67], v[120:123], v[56:59]
    ds_read2_b32 v[144:145], v238 offset0:112 offset1:113
    v_mfma_f32_16x16x32_bf16 v[56:59], v[68:71], v[116:119], v[56:59]
    ds_read2_b32 v[146:147], v238 offset0:114 offset1:115
    v_mfma_f32_16x16x32_bf16 v[56:59], v[72:75], v[112:115], v[56:59]
    ds_read2_b32 v[148:149], v238 offset0:240 offset1:241
    v_alignbit_b32 v231, v232, v231, 16
    v_mfma_f32_16x16x32_bf16 v[56:59], v[76:79], v[108:111], v[56:59]
    ds_read2_b32 v[150:151], v238 offset0:242 offset1:243
    v_xor_b32 v245, 64, v245
    v_mfma_f32_16x16x32_bf16 v[56:59], v[80:83], v[104:107], v[56:59]
    ds_read2_b32 v[152:153], v239 offset0:112 offset1:113
    s_waitcnt lgkmcnt(14)
    s_barrier
    v_mfma_f32_16x16x32_bf16 v[56:59], v[84:87], v[100:103], v[56:59]
    ds_read2_b32 v[154:155], v239 offset0:114 offset1:115
    v_mfma_f32_16x16x32_bf16 v[56:59], v[88:91], v[96:99], v[56:59]
    ds_read2_b32 v[156:157], v239 offset0:240 offset1:241
    v_alignbit_b32 v232, v233, v232, 16
    v_mfma_f32_16x16x32_bf16 v[60:63], v[92:95], v[96:99], v[60:63]
    s_lshl_b32 s14, s95, 18
    ds_read2_b32 v[158:159], v239 offset0:242 offset1:243
    v_mfma_f32_16x16x32_bf16 v[60:63], v[88:91], v[100:103], v[60:63]
    s_add_u32 m0, s73, 16384
    v_xor_b32 v246, 64, v246
    v_add_u32 v236, 8320, v236
    v_mfma_f32_16x16x32_bf16 v[60:63], v[84:87], v[104:107], v[60:63]
    buffer_load_dwordx4 v4, s[52:55], s14 offen offset:0 lds
    v_alignbit_b32 v233, v234, v233, 16
    v_mfma_f32_16x16x32_bf16 v[60:63], v[80:83], v[108:111], v[60:63]
    v_add_u32 v237, 8320, v237
    v_mfma_f32_16x16x32_bf16 v[60:63], v[76:79], v[112:115], v[60:63]
    v_mfma_f32_16x16x32_bf16 v[60:63], v[72:75], v[116:119], v[60:63]
    v_xor_b32 v247, 64, v247
    v_add_u32 v238, 8320, v238
    v_mfma_f32_16x16x32_bf16 v[60:63], v[68:71], v[120:123], v[60:63]
    ds_write_b128 v241, v[230:233] offset:15584
    v_mfma_f32_16x16x32_bf16 v[60:63], v[64:67], v[124:127], v[60:63]
    v_add_u32 v239, 8320, v239
    s_waitcnt lgkmcnt(1)
    v_mfma_f32_16x16x32_bf16 v[60:63], v[128:131], v[188:191], v[60:63]
    ds_read_b128 v[96:99], v244 offset:2048
    v_mfma_f32_16x16x32_bf16 v[60:63], v[132:135], v[184:187], v[60:63]
    ds_read2_b32 v[64:65], v236 offset0:0 offset1:1
    v_mfma_f32_16x16x32_bf16 v[60:63], v[136:139], v[180:183], v[60:63]
    ds_read2_b32 v[66:67], v236 offset0:2 offset1:3
    v_mfma_f32_16x16x32_bf16 v[60:63], v[140:143], v[176:179], v[60:63]
    ds_read_b128 v[100:103], v244 offset:6144
    v_mfma_f32_16x16x32_bf16 v[60:63], v[144:147], v[172:175], v[60:63]
    ds_read2_b32 v[68:69], v236 offset0:128 offset1:129
    v_mfma_f32_16x16x32_bf16 v[60:63], v[148:151], v[168:171], v[60:63]
    s_add_u32 m0, s73, 16384
    ds_read2_b32 v[70:71], v236 offset0:130 offset1:131
    v_mfma_f32_16x16x32_bf16 v[60:63], v[152:155], v[164:167], v[60:63]
    buffer_load_dwordx4 v5, s[52:55], s14 offen offset:1024 lds
    ds_read_b128 v[104:107], v244 offset:10240
    v_mfma_f32_16x16x32_bf16 v[60:63], v[156:159], v[160:163], v[60:63]
    ds_read2_b32 v[72:73], v237 offset0:0 offset1:1
    v_mfma_f32_16x16x32_bf16 v[56:59], v[128:131], v[184:187], v[56:59]
    ds_read2_b32 v[74:75], v237 offset0:2 offset1:3
    v_mfma_f32_16x16x32_bf16 v[56:59], v[132:135], v[180:183], v[56:59]
    ds_read_b128 v[108:111], v244 offset:14336
    v_mfma_f32_16x16x32_bf16 v[56:59], v[136:139], v[176:179], v[56:59]
    ds_read2_b32 v[76:77], v237 offset0:128 offset1:129
    v_mfma_f32_16x16x32_bf16 v[56:59], v[140:143], v[172:175], v[56:59]
    ds_read2_b32 v[78:79], v237 offset0:130 offset1:131
    v_mfma_f32_16x16x32_bf16 v[56:59], v[144:147], v[168:171], v[56:59]
    ds_read_b128 v[112:115], v244 offset:18432
    v_mfma_f32_16x16x32_bf16 v[56:59], v[148:151], v[164:167], v[56:59]
    ds_read2_b32 v[80:81], v238 offset0:0 offset1:1
    v_cvt_pk_bf16_f32 v206, v60, v61
    v_mfma_f32_16x16x32_bf16 v[56:59], v[152:155], v[160:163], v[56:59]
    ds_read2_b32 v[82:83], v238 offset0:2 offset1:3
    s_waitcnt vmcnt(6)
    s_barrier
    v_mfma_f32_16x16x32_bf16 v[52:55], v[128:131], v[180:183], v[52:55]
    ds_read_b128 v[116:119], v244 offset:22528
    v_add_u32 v10, 131072, v10
    v_mfma_f32_16x16x32_bf16 v[52:55], v[132:135], v[176:179], v[52:55]
    ds_read_b64_tr_b16 a[144:145], v10 offset:16384
    v_cvt_pk_bf16_f32 v207, v62, v63
    v_mfma_f32_16x16x32_bf16 v[52:55], v[136:139], v[172:175], v[52:55]
    ds_read_b64_tr_b16 a[146:147], v10 offset:18432
    s_add_u32 m0, s73, 16384
    v_mfma_f32_16x16x32_bf16 v[52:55], v[140:143], v[168:171], v[52:55]
    buffer_load_dwordx4 v6, s[52:55], s14 offen offset:2048 lds
    ds_read2_b32 v[84:85], v238 offset0:128 offset1:129
    v_mfma_f32_16x16x32_bf16 v[52:55], v[144:147], v[164:167], v[52:55]
    buffer_store_dwordx2 v[206:207], v8, s[44:47], s6 offen offset:3584 sc1
    ds_read_b64_tr_b16 a[152:153], v10 offset:20480
    v_mfma_f32_16x16x32_bf16 v[52:55], v[148:151], v[160:163], v[52:55]
    ds_read_b64_tr_b16 a[154:155], v10 offset:22528
    v_mfma_f32_16x16x32_bf16 v[48:51], v[128:131], v[176:179], v[48:51]
    ds_read2_b32 v[86:87], v238 offset0:130 offset1:131
    v_add_u32 v11, 131072, v11
    v_cvt_pk_bf16_f32 v204, v56, v57
    v_mfma_f32_16x16x32_bf16 v[48:51], v[132:135], v[172:175], v[48:51]
    ds_read_b64_tr_b16 a[148:149], v11 offset:16384
    ds_read_b128 v[120:123], v244 offset:26624
    v_mfma_f32_16x16x32_bf16 v[48:51], v[136:139], v[168:171], v[48:51]
    ds_read_b64_tr_b16 a[150:151], v11 offset:18432
    ds_read2_b32 v[88:89], v239 offset0:0 offset1:1
    v_mfma_f32_16x16x32_bf16 v[48:51], v[140:143], v[164:167], v[48:51]
    ds_read2_b32 v[90:91], v239 offset0:2 offset1:3
    v_cvt_pk_bf16_f32 v205, v58, v59
    v_mfma_f32_16x16x32_bf16 v[48:51], v[144:147], v[160:163], v[48:51]
    ds_read_b64_tr_b16 a[156:157], v11 offset:20480
    ds_read_b128 v[124:127], v244 offset:30720
    v_mfma_f32_16x16x32_bf16 v[44:47], v[128:131], v[172:175], v[44:47]
    buffer_store_dwordx2 v[204:205], v8, s[44:47], s6 offen offset:3072 sc1
    ds_read_b64_tr_b16 a[158:159], v11 offset:22528
    v_mfma_f32_16x16x32_bf16 v[44:47], v[132:135], v[168:171], v[44:47]
    ds_read2_b32 v[92:93], v239 offset0:128 offset1:129
    v_mfma_f32_16x16x32_bf16 v[44:47], v[136:139], v[164:167], v[44:47]
    s_add_u32 m0, s73, 16384
    ds_read2_b32 v[94:95], v239 offset0:130 offset1:131
    v_mfma_f32_16x16x32_bf16 v[44:47], v[140:143], v[160:163], v[44:47]
    buffer_load_dwordx4 v7, s[52:55], s14 offen offset:3072 lds
    v_cvt_pk_bf16_f32 v202, v52, v53
    v_mfma_f32_16x16x32_bf16 v[40:43], v[128:131], v[168:171], v[40:43]
    v_mfma_f32_16x16x32_bf16 v[40:43], v[132:135], v[164:167], v[40:43]
    v_mfma_f32_16x16x32_bf16 v[40:43], v[136:139], v[160:163], v[40:43]
    v_cvt_pk_bf16_f32 v203, v54, v55
    v_mfma_f32_16x16x32_bf16 v[36:39], v[128:131], v[164:167], v[36:39]
    v_mfma_f32_16x16x32_bf16 v[36:39], v[132:135], v[160:163], v[36:39]
    buffer_store_dwordx2 v[202:203], v8, s[44:47], s6 offen offset:2560 sc1
    v_mfma_f32_16x16x32_bf16 v[32:35], v[128:131], v[160:163], v[32:35]
    s_waitcnt lgkmcnt(0)
    v_mfma_f32_16x16x32_bf16 v[60:63], v[64:67], v[124:127], 0
    ds_read_b128 v[160:163], v245 offset:2048
    v_mfma_f32_16x16x32_bf16 v[60:63], v[68:71], v[120:123], v[60:63]
    v_cvt_pk_bf16_f32 v200, v48, v49
    v_mfma_f32_16x16x32_bf16 v[60:63], v[72:75], v[116:119], v[60:63]
    ds_read2_b32 v[128:129], v236 offset0:16 offset1:17
    v_mfma_f32_16x16x32_bf16 v[60:63], v[76:79], v[112:115], v[60:63]
    s_barrier
    v_cvt_pk_bf16_f32 v201, v50, v51
    v_mfma_f32_16x16x32_bf16 v[60:63], v[80:83], v[108:111], v[60:63]
    ds_read2_b32 v[130:131], v236 offset0:18 offset1:19
    v_mfma_f32_16x16x32_bf16 v[60:63], v[84:87], v[104:107], v[60:63]
    buffer_store_dwordx2 v[200:201], v8, s[44:47], s6 offen offset:2048 sc1
    ds_read_b128 v[164:167], v245 offset:6144
    v_mfma_f32_16x16x32_bf16 v[60:63], v[88:91], v[100:103], v[60:63]
    ds_read2_b32 v[132:133], v236 offset0:144 offset1:145
    v_mfma_f32_16x16x32_bf16 v[60:63], v[92:95], v[96:99], v[60:63]
    ds_read2_b32 v[134:135], v236 offset0:146 offset1:147
    s_lshl_b32 s14, s96, 18
    v_cvt_pk_bf16_f32 v198, v44, v45
    v_mfma_f32_16x16x32_bf16 v[56:59], v[64:67], v[120:123], 0
    s_add_u32 m0, s73, 147456
    ds_read_b128 v[168:171], v245 offset:10240
    v_mfma_f32_16x16x32_bf16 v[56:59], v[68:71], v[116:119], v[56:59]
    buffer_load_dwordx4 v4, s[52:55], s14 offen offset:0 lds
    ds_read2_b32 v[136:137], v237 offset0:16 offset1:17
    v_mfma_f32_16x16x32_bf16 v[56:59], v[72:75], v[112:115], v[56:59]
    ds_read2_b32 v[138:139], v237 offset0:18 offset1:19
    v_cvt_pk_bf16_f32 v199, v46, v47
    v_mfma_f32_16x16x32_bf16 v[56:59], v[76:79], v[108:111], v[56:59]
    ds_read_b128 v[172:175], v245 offset:14336
    v_mfma_f32_16x16x32_bf16 v[56:59], v[80:83], v[104:107], v[56:59]
    buffer_store_dwordx2 v[198:199], v8, s[44:47], s6 offen offset:1536 sc1
    ds_read2_b32 v[140:141], v237 offset0:144 offset1:145
    v_mfma_f32_16x16x32_bf16 v[56:59], v[84:87], v[100:103], v[56:59]
    ds_read2_b32 v[142:143], v237 offset0:146 offset1:147
    v_mfma_f32_16x16x32_bf16 v[56:59], v[88:91], v[96:99], v[56:59]
    ds_read_b128 v[176:179], v245 offset:18432
    v_cvt_pk_bf16_f32 v196, v40, v41
    v_mfma_f32_16x16x32_bf16 v[52:55], v[64:67], v[116:119], 0
    ds_read2_b32 v[144:145], v238 offset0:16 offset1:17
    v_mfma_f32_16x16x32_bf16 v[52:55], v[68:71], v[112:115], v[52:55]
    ds_read2_b32 v[146:147], v238 offset0:18 offset1:19
    v_cvt_pk_bf16_f32 v197, v42, v43
    v_mfma_f32_16x16x32_bf16 v[52:55], v[72:75], v[108:111], v[52:55]
    ds_read_b128 v[180:183], v245 offset:22528
L_pl_X_5:
    s_cbranch_execz L_wret
    v_mfma_f32_16x16x32_bf16 v[52:55], v[76:79], v[104:107], v[52:55]
    buffer_store_dwordx2 v[196:197], v8, s[44:47], s6 offen offset:1024 sc1
    ds_read2_b32 v[148:149], v238 offset0:144 offset1:145
    v_mfma_f32_16x16x32_bf16 v[52:55], v[80:83], v[100:103], v[52:55]
    s_add_u32 m0, s73, 147456
    ds_read2_b32 v[150:151], v238 offset0:146 offset1:147
    v_mfma_f32_16x16x32_bf16 v[52:55], v[84:87], v[96:99], v[52:55]
    buffer_load_dwordx4 v5, s[52:55], s14 offen offset:1024 lds
    ds_read_b128 v[184:187], v245 offset:26624
    v_mfma_f32_16x16x32_bf16 v[48:51], v[64:67], v[112:115], 0
    ds_read2_b32 v[152:153], v239 offset0:16 offset1:17
    v_cvt_pk_bf16_f32 v194, v36, v37
    v_mfma_f32_16x16x32_bf16 v[48:51], v[68:71], v[108:111], v[48:51]
    ds_read2_b32 v[154:155], v239 offset0:18 offset1:19
    v_mfma_f32_16x16x32_bf16 v[48:51], v[72:75], v[104:107], v[48:51]
    ds_read_b128 v[188:191], v245 offset:30720
    v_cvt_pk_bf16_f32 v195, v38, v39
    v_mfma_f32_16x16x32_bf16 v[48:51], v[76:79], v[100:103], v[48:51]
    ds_read2_b32 v[156:157], v239 offset0:144 offset1:145
    v_mfma_f32_16x16x32_bf16 v[48:51], v[80:83], v[96:99], v[48:51]
    buffer_store_dwordx2 v[194:195], v8, s[44:47], s6 offen offset:512 sc1
    s_waitcnt vmcnt(13)
    s_barrier
    v_mfma_f32_16x16x32_bf16 v[44:47], v[64:67], v[108:111], 0
    v_add_u32 v10, -131072, v10
    v_cvt_pk_bf16_f32 v192, v32, v33
    v_mfma_f32_16x16x32_bf16 v[44:47], v[68:71], v[104:107], v[44:47]
    ds_read_b64_tr_b16 a[160:161], v10 offset:0
    v_mfma_f32_16x16x32_bf16 v[44:47], v[72:75], v[100:103], v[44:47]
    ds_read_b64_tr_b16 a[162:163], v10 offset:2048
    v_mfma_f32_16x16x32_bf16 v[44:47], v[76:79], v[96:99], v[44:47]
    ds_read_b64_tr_b16 a[168:169], v10 offset:4096
    v_cvt_pk_bf16_f32 v193, v34, v35
    v_mfma_f32_16x16x32_bf16 v[40:43], v[64:67], v[104:107], 0
    ds_read2_b32 v[158:159], v239 offset0:146 offset1:147
    v_mfma_f32_16x16x32_bf16 v[40:43], v[68:71], v[100:103], v[40:43]
    buffer_store_dwordx2 v[192:193], v8, s[44:47], s6 offen offset:0 sc1
    ds_read_b64_tr_b16 a[170:171], v10 offset:6144
    s_add_u32 m0, s73, 147456
    v_mfma_f32_16x16x32_bf16 v[40:43], v[72:75], v[96:99], v[40:43]
    v_add_u32 v11, -131072, v11
    buffer_load_dwordx4 v6, s[52:55], s14 offen offset:2048 lds
    v_mfma_f32_16x16x32_bf16 v[36:39], v[64:67], v[100:103], 0
    ds_read_b64_tr_b16 a[164:165], v11 offset:0
    v_mfma_f32_16x16x32_bf16 v[36:39], v[68:71], v[96:99], v[36:39]
    ds_read_b64_tr_b16 a[166:167], v11 offset:2048
    v_mfma_f32_16x16x32_bf16 v[32:35], v[64:67], v[96:99], 0
    ds_read_b64_tr_b16 a[172:173], v11 offset:4096
    s_waitcnt lgkmcnt(15)
    v_mfma_f32_16x16x32_bf16 v[32:35], v[128:131], v[160:163], v[32:35]
    ds_read_b64_tr_b16 a[174:175], v11 offset:6144
    v_mfma_f32_16x16x32_bf16 v[36:39], v[132:135], v[160:163], v[36:39]
    ds_read_b128 v[96:99], v246 offset:2048
    v_mfma_f32_16x16x32_bf16 v[36:39], v[128:131], v[164:167], v[36:39]
    ds_read2_b32 v[64:65], v236 offset0:32 offset1:33
    v_mfma_f32_16x16x32_bf16 v[40:43], v[128:131], v[168:171], v[40:43]
    ds_read2_b32 v[66:67], v236 offset0:34 offset1:35
    v_mfma_f32_16x16x32_bf16 v[40:43], v[132:135], v[164:167], v[40:43]
    v_mfma_f32_16x16x32_bf16 v[40:43], v[136:139], v[160:163], v[40:43]
    ds_read_b128 v[100:103], v246 offset:6144
    v_mfma_f32_16x16x32_bf16 v[44:47], v[140:143], v[160:163], v[44:47]
    ds_read2_b32 v[68:69], v236 offset0:160 offset1:161
    v_mfma_f32_16x16x32_bf16 v[44:47], v[136:139], v[164:167], v[44:47]
    s_add_u32 m0, s73, 147456
    v_mfma_f32_16x16x32_bf16 v[44:47], v[132:135], v[168:171], v[44:47]
    buffer_load_dwordx4 v7, s[52:55], s14 offen offset:3072 lds
    ds_read2_b32 v[70:71], v236 offset0:162 offset1:163
    v_mfma_f32_16x16x32_bf16 v[44:47], v[128:131], v[172:175], v[44:47]
    ds_read_b128 v[104:107], v246 offset:10240
    s_waitcnt lgkmcnt(12)
    v_mfma_f32_16x16x32_bf16 v[48:51], v[128:131], v[176:179], v[48:51]
    ds_read2_b32 v[72:73], v237 offset0:32 offset1:33
    v_mfma_f32_16x16x32_bf16 v[48:51], v[132:135], v[172:175], v[48:51]
    v_mfma_f32_16x16x32_bf16 v[48:51], v[136:139], v[168:171], v[48:51]
    ds_read2_b32 v[74:75], v237 offset0:34 offset1:35
    v_mfma_f32_16x16x32_bf16 v[48:51], v[140:143], v[164:167], v[48:51]
    ds_read_b128 v[108:111], v246 offset:14336
    v_mfma_f32_16x16x32_bf16 v[48:51], v[144:147], v[160:163], v[48:51]
    s_waitcnt lgkmcnt(10)
    s_barrier
    v_mfma_f32_16x16x32_bf16 v[52:55], v[148:151], v[160:163], v[52:55]
    ds_read2_b32 v[76:77], v237 offset0:160 offset1:161
    v_mfma_f32_16x16x32_bf16 v[52:55], v[144:147], v[164:167], v[52:55]
    ds_read2_b32 v[78:79], v237 offset0:162 offset1:163
    v_mfma_f32_16x16x32_bf16 v[52:55], v[140:143], v[168:171], v[52:55]
    v_mfma_f32_16x16x32_bf16 v[52:55], v[136:139], v[172:175], v[52:55]
    s_lshl_b32 s14, s97, 18
    ds_read_b128 v[112:115], v246 offset:18432
    v_mfma_f32_16x16x32_bf16 v[52:55], v[132:135], v[176:179], v[52:55]
    s_add_u32 m0, s73, 0
    ds_read2_b32 v[80:81], v238 offset0:32 offset1:33
    v_mfma_f32_16x16x32_bf16 v[52:55], v[128:131], v[180:183], v[52:55]
    buffer_load_dwordx4 v4, s[52:55], s14 offen offset:0 lds
    v_mfma_f32_16x16x32_bf16 v[56:59], v[128:131], v[184:187], v[56:59]
    ds_read2_b32 v[82:83], v238 offset0:34 offset1:35
    v_mfma_f32_16x16x32_bf16 v[56:59], v[132:135], v[180:183], v[56:59]
    ds_read_b128 v[116:119], v246 offset:22528
    v_mfma_f32_16x16x32_bf16 v[56:59], v[136:139], v[176:179], v[56:59]
    v_mfma_f32_16x16x32_bf16 v[56:59], v[140:143], v[172:175], v[56:59]
    ds_read2_b32 v[84:85], v238 offset0:160 offset1:161
    v_mfma_f32_16x16x32_bf16 v[56:59], v[144:147], v[168:171], v[56:59]
    ds_read2_b32 v[86:87], v238 offset0:162 offset1:163
    v_mfma_f32_16x16x32_bf16 v[56:59], v[148:151], v[164:167], v[56:59]
    ds_read_b128 v[120:123], v246 offset:26624
    v_mfma_f32_16x16x32_bf16 v[56:59], v[152:155], v[160:163], v[56:59]
    v_mfma_f32_16x16x32_bf16 v[60:63], v[156:159], v[160:163], v[60:63]
    ds_read2_b32 v[88:89], v239 offset0:32 offset1:33
    v_mfma_f32_16x16x32_bf16 v[60:63], v[152:155], v[164:167], v[60:63]
    ds_read2_b32 v[90:91], v239 offset0:34 offset1:35
    v_mfma_f32_16x16x32_bf16 v[60:63], v[148:151], v[168:171], v[60:63]
    s_add_u32 m0, s73, 0
    v_mfma_f32_16x16x32_bf16 v[60:63], v[144:147], v[172:175], v[60:63]
    buffer_load_dwordx4 v5, s[52:55], s14 offen offset:1024 lds
    ds_read_b128 v[124:127], v246 offset:30720
    v_mfma_f32_16x16x32_bf16 v[60:63], v[140:143], v[176:179], v[60:63]
    ds_read2_b32 v[92:93], v239 offset0:160 offset1:161
    v_mfma_f32_16x16x32_bf16 v[60:63], v[136:139], v[180:183], v[60:63]
    v_mfma_f32_16x16x32_bf16 v[60:63], v[132:135], v[184:187], v[60:63]
    ds_read2_b32 v[94:95], v239 offset0:162 offset1:163
    v_mfma_f32_16x16x32_bf16 v[60:63], v[128:131], v[188:191], v[60:63]
    s_waitcnt lgkmcnt(12)
    v_mfma_f32_16x16x32_bf16 v[32:35], v[64:67], v[96:99], v[32:35]
    ds_read_b128 v[160:163], v247 offset:2048
    s_waitcnt vmcnt(12)
    s_barrier
    v_mfma_f32_16x16x32_bf16 v[36:39], v[68:71], v[96:99], v[36:39]
    ds_read_b64_tr_b16 a[176:177], v10 offset:16384
    v_mfma_f32_16x16x32_bf16 v[36:39], v[64:67], v[100:103], v[36:39]
    ds_read_b64_tr_b16 a[178:179], v10 offset:18432
    v_mfma_f32_16x16x32_bf16 v[40:43], v[64:67], v[104:107], v[40:43]
    ds_read2_b32 v[128:129], v236 offset0:48 offset1:49
    v_mfma_f32_16x16x32_bf16 v[40:43], v[68:71], v[100:103], v[40:43]
    ds_read_b64_tr_b16 a[184:185], v10 offset:20480
    v_mfma_f32_16x16x32_bf16 v[40:43], v[72:75], v[96:99], v[40:43]
    ds_read_b64_tr_b16 a[186:187], v10 offset:22528
    v_mfma_f32_16x16x32_bf16 v[44:47], v[76:79], v[96:99], v[44:47]
    s_add_u32 m0, s73, 0
    ds_read2_b32 v[130:131], v236 offset0:50 offset1:51
    v_mfma_f32_16x16x32_bf16 v[44:47], v[72:75], v[100:103], v[44:47]
    ds_read_b64_tr_b16 a[180:181], v11 offset:16384
    buffer_load_dwordx4 v6, s[52:55], s14 offen offset:2048 lds
    v_mfma_f32_16x16x32_bf16 v[44:47], v[68:71], v[104:107], v[44:47]
    ds_read_b64_tr_b16 a[182:183], v11 offset:18432
    v_mfma_f32_16x16x32_bf16 v[44:47], v[64:67], v[108:111], v[44:47]
    ds_read_b128 v[164:167], v247 offset:6144
    s_waitcnt lgkmcnt(10)
    v_mfma_f32_16x16x32_bf16 v[48:51], v[64:67], v[112:115], v[48:51]
    ds_read_b64_tr_b16 a[188:189], v11 offset:20480
    v_mfma_f32_16x16x32_bf16 v[48:51], v[68:71], v[108:111], v[48:51]
    ds_read_b64_tr_b16 a[190:191], v11 offset:22528
    v_mfma_f32_16x16x32_bf16 v[48:51], v[72:75], v[104:107], v[48:51]
    ds_read2_b32 v[132:133], v236 offset0:176 offset1:177
    v_mfma_f32_16x16x32_bf16 v[48:51], v[76:79], v[100:103], v[48:51]
    ds_read2_b32 v[134:135], v236 offset0:178 offset1:179
    v_mfma_f32_16x16x32_bf16 v[48:51], v[80:83], v[96:99], v[48:51]
    ds_read_b128 v[168:171], v247 offset:10240
    v_mfma_f32_16x16x32_bf16 v[52:55], v[84:87], v[96:99], v[52:55]
    ds_read2_b32 v[136:137], v237 offset0:48 offset1:49
    v_mfma_f32_16x16x32_bf16 v[52:55], v[80:83], v[100:103], v[52:55]
    ds_read2_b32 v[138:139], v237 offset0:50 offset1:51
    v_mfma_f32_16x16x32_bf16 v[52:55], v[76:79], v[104:107], v[52:55]
    ds_read_b128 v[172:175], v247 offset:14336
    v_mfma_f32_16x16x32_bf16 v[52:55], v[72:75], v[108:111], v[52:55]
    s_add_u32 m0, s73, 0
    ds_read2_b32 v[140:141], v237 offset0:176 offset1:177
    v_mfma_f32_16x16x32_bf16 v[52:55], v[68:71], v[112:115], v[52:55]
    buffer_load_dwordx4 v7, s[52:55], s14 offen offset:3072 lds
    ds_read2_b32 v[142:143], v237 offset0:178 offset1:179
    v_mfma_f32_16x16x32_bf16 v[52:55], v[64:67], v[116:119], v[52:55]
    ds_read_b128 v[176:179], v247 offset:18432
    v_mfma_f32_16x16x32_bf16 v[56:59], v[64:67], v[120:123], v[56:59]
    ds_read2_b32 v[144:145], v238 offset0:48 offset1:49
    v_mfma_f32_16x16x32_bf16 v[56:59], v[68:71], v[116:119], v[56:59]
    ds_read2_b32 v[146:147], v238 offset0:50 offset1:51
    v_mfma_f32_16x16x32_bf16 v[56:59], v[72:75], v[112:115], v[56:59]
    ds_read_b128 v[180:183], v247 offset:22528
    v_mfma_f32_16x16x32_bf16 v[56:59], v[76:79], v[108:111], v[56:59]
    ds_read2_b32 v[148:149], v238 offset0:176 offset1:177
    v_mfma_f32_16x16x32_bf16 v[56:59], v[80:83], v[104:107], v[56:59]
    ds_read2_b32 v[150:151], v238 offset0:178 offset1:179
    s_waitcnt lgkmcnt(14)
    s_barrier
    v_mfma_f32_16x16x32_bf16 v[56:59], v[84:87], v[100:103], v[56:59]
    ds_read_b128 v[184:187], v247 offset:26624
    v_mfma_f32_16x16x32_bf16 v[56:59], v[88:91], v[96:99], v[56:59]
    v_mfma_f32_16x16x32_bf16 v[60:63], v[92:95], v[96:99], v[60:63]
    s_lshl_b32 s14, s98, 18
    ds_read2_b32 v[152:153], v239 offset0:48 offset1:49
    v_mfma_f32_16x16x32_bf16 v[60:63], v[88:91], v[100:103], v[60:63]
    s_add_u32 m0, s73, 16384
    ds_read2_b32 v[154:155], v239 offset0:50 offset1:51
    v_mfma_f32_16x16x32_bf16 v[60:63], v[84:87], v[104:107], v[60:63]
    buffer_load_dwordx4 v4, s[52:55], s14 offen offset:0 lds
    v_mfma_f32_16x16x32_bf16 v[60:63], v[80:83], v[108:111], v[60:63]
    ds_read_b128 v[188:191], v247 offset:30720
    v_mfma_f32_16x16x32_bf16 v[60:63], v[76:79], v[112:115], v[60:63]
    ds_read2_b32 v[156:157], v239 offset0:176 offset1:177
    v_mfma_f32_16x16x32_bf16 v[60:63], v[72:75], v[116:119], v[60:63]
    v_mfma_f32_16x16x32_bf16 v[60:63], v[68:71], v[120:123], v[60:63]
    ds_read2_b32 v[158:159], v239 offset0:178 offset1:179
    v_mfma_f32_16x16x32_bf16 v[60:63], v[64:67], v[124:127], v[60:63]
    s_waitcnt lgkmcnt(12)
    v_mfma_f32_16x16x32_bf16 v[32:35], v[128:131], v[160:163], v[32:35]
    ds_read_b128 v[96:99], v244 offset:0
    v_mfma_f32_16x16x32_bf16 v[36:39], v[132:135], v[160:163], v[36:39]
    v_mfma_f32_16x16x32_bf16 v[36:39], v[128:131], v[164:167], v[36:39]
    ds_read2_b32 v[64:65], v236 offset0:64 offset1:65
    v_mfma_f32_16x16x32_bf16 v[40:43], v[128:131], v[168:171], v[40:43]
    ds_read2_b32 v[66:67], v236 offset0:66 offset1:67
    v_mfma_f32_16x16x32_bf16 v[40:43], v[132:135], v[164:167], v[40:43]
    v_mfma_f32_16x16x32_bf16 v[40:43], v[136:139], v[160:163], v[40:43]
    s_add_u32 m0, s73, 16384
    ds_read_b128 v[100:103], v244 offset:4096
    v_mfma_f32_16x16x32_bf16 v[44:47], v[140:143], v[160:163], v[44:47]
    buffer_load_dwordx4 v5, s[52:55], s14 offen offset:1024 lds
    ds_read2_b32 v[68:69], v236 offset0:192 offset1:193
    v_mfma_f32_16x16x32_bf16 v[44:47], v[136:139], v[164:167], v[44:47]
    v_mfma_f32_16x16x32_bf16 v[44:47], v[132:135], v[168:171], v[44:47]
    ds_read2_b32 v[70:71], v236 offset0:194 offset1:195
    v_mfma_f32_16x16x32_bf16 v[44:47], v[128:131], v[172:175], v[44:47]
    ds_read_b128 v[104:107], v244 offset:8192
    s_waitcnt lgkmcnt(7)
    v_mfma_f32_16x16x32_bf16 v[48:51], v[128:131], v[176:179], v[48:51]
    ds_read2_b32 v[72:73], v237 offset0:64 offset1:65
    v_mfma_f32_16x16x32_bf16 v[48:51], v[132:135], v[172:175], v[48:51]
    ds_read2_b32 v[74:75], v237 offset0:66 offset1:67
    v_mfma_f32_16x16x32_bf16 v[48:51], v[136:139], v[168:171], v[48:51]
    ds_read_b128 v[108:111], v244 offset:12288
    v_mfma_f32_16x16x32_bf16 v[48:51], v[140:143], v[164:167], v[48:51]
    ds_read2_b32 v[76:77], v237 offset0:192 offset1:193
    v_mfma_f32_16x16x32_bf16 v[48:51], v[144:147], v[160:163], v[48:51]
    ds_read2_b32 v[78:79], v237 offset0:194 offset1:195
    s_waitcnt vmcnt(6)
    s_barrier
    v_mfma_f32_16x16x32_bf16 v[52:55], v[148:151], v[160:163], v[52:55]
    ds_read_b128 v[112:115], v244 offset:16384
    v_add_u32 v10, 131072, v10
    v_mfma_f32_16x16x32_bf16 v[52:55], v[144:147], v[164:167], v[52:55]
    ds_read_b64_tr_b16 a[192:193], v10 offset:16384
    v_mfma_f32_16x16x32_bf16 v[52:55], v[140:143], v[168:171], v[52:55]
    ds_read_b64_tr_b16 a[194:195], v10 offset:18432
    s_add_u32 m0, s73, 16384
    v_mfma_f32_16x16x32_bf16 v[52:55], v[136:139], v[172:175], v[52:55]
    buffer_load_dwordx4 v6, s[52:55], s14 offen offset:2048 lds
    ds_read2_b32 v[80:81], v238 offset0:64 offset1:65
    v_mfma_f32_16x16x32_bf16 v[52:55], v[132:135], v[176:179], v[52:55]
    ds_read_b64_tr_b16 a[200:201], v10 offset:20480
    v_mfma_f32_16x16x32_bf16 v[52:55], v[128:131], v[180:183], v[52:55]
    ds_read_b64_tr_b16 a[202:203], v10 offset:22528
    v_mfma_f32_16x16x32_bf16 v[56:59], v[128:131], v[184:187], v[56:59]
    ds_read2_b32 v[82:83], v238 offset0:66 offset1:67
    v_add_u32 v11, 131072, v11
    v_mfma_f32_16x16x32_bf16 v[56:59], v[132:135], v[180:183], v[56:59]
    ds_read_b64_tr_b16 a[196:197], v11 offset:16384
    v_mfma_f32_16x16x32_bf16 v[56:59], v[136:139], v[176:179], v[56:59]
    ds_read_b64_tr_b16 a[198:199], v11 offset:18432
    v_mfma_f32_16x16x32_bf16 v[56:59], v[140:143], v[172:175], v[56:59]
    ds_read_b128 v[116:119], v244 offset:20480
    v_mfma_f32_16x16x32_bf16 v[56:59], v[144:147], v[168:171], v[56:59]
    ds_read_b64_tr_b16 a[204:205], v11 offset:20480
    v_mfma_f32_16x16x32_bf16 v[56:59], v[148:151], v[164:167], v[56:59]
    ds_read_b64_tr_b16 a[206:207], v11 offset:22528
    v_mfma_f32_16x16x32_bf16 v[56:59], v[152:155], v[160:163], v[56:59]
    ds_read2_b32 v[84:85], v238 offset0:192 offset1:193
    v_mfma_f32_16x16x32_bf16 v[60:63], v[156:159], v[160:163], v[60:63]
    s_add_u32 m0, s73, 16384
    ds_read2_b32 v[86:87], v238 offset0:194 offset1:195
    v_mfma_f32_16x16x32_bf16 v[60:63], v[152:155], v[164:167], v[60:63]
    buffer_load_dwordx4 v7, s[52:55], s14 offen offset:3072 lds
    ds_read_b128 v[120:123], v244 offset:24576
    v_mfma_f32_16x16x32_bf16 v[60:63], v[148:151], v[168:171], v[60:63]
    ds_read2_b32 v[88:89], v239 offset0:64 offset1:65
    v_mfma_f32_16x16x32_bf16 v[60:63], v[144:147], v[172:175], v[60:63]
    ds_read2_b32 v[90:91], v239 offset0:66 offset1:67
    v_mfma_f32_16x16x32_bf16 v[60:63], v[140:143], v[176:179], v[60:63]
    ds_read_b128 v[124:127], v244 offset:28672
    v_mfma_f32_16x16x32_bf16 v[60:63], v[136:139], v[180:183], v[60:63]
    ds_read2_b32 v[92:93], v239 offset0:192 offset1:193
    v_mfma_f32_16x16x32_bf16 v[60:63], v[132:135], v[184:187], v[60:63]
    ds_read2_b32 v[94:95], v239 offset0:194 offset1:195
    v_mfma_f32_16x16x32_bf16 v[60:63], v[128:131], v[188:191], v[60:63]
    s_waitcnt lgkmcnt(15)
    v_mfma_f32_16x16x32_bf16 v[32:35], v[64:67], v[96:99], v[32:35]
    ds_read_b128 v[160:163], v245 offset:0
    v_mfma_f32_16x16x32_bf16 v[36:39], v[68:71], v[96:99], v[36:39]
    v_mfma_f32_16x16x32_bf16 v[36:39], v[64:67], v[100:103], v[36:39]
    ds_read2_b32 v[128:129], v236 offset0:80 offset1:81
    v_mfma_f32_16x16x32_bf16 v[40:43], v[64:67], v[104:107], v[40:43]
    ds_read2_b32 v[130:131], v236 offset0:82 offset1:83
    s_waitcnt lgkmcnt(11)
    s_barrier
    v_mfma_f32_16x16x32_bf16 v[40:43], v[68:71], v[100:103], v[40:43]
    v_mfma_f32_16x16x32_bf16 v[40:43], v[72:75], v[96:99], v[40:43]
    ds_read_b128 v[164:167], v245 offset:4096
    v_mfma_f32_16x16x32_bf16 v[44:47], v[76:79], v[96:99], v[44:47]
    ds_read2_b32 v[132:133], v236 offset0:208 offset1:209
    v_mfma_f32_16x16x32_bf16 v[44:47], v[72:75], v[100:103], v[44:47]
    s_lshl_b32 s14, s99, 18
    v_mfma_f32_16x16x32_bf16 v[44:47], v[68:71], v[104:107], v[44:47]
    s_add_u32 m0, s73, 147456
    ds_read2_b32 v[134:135], v236 offset0:210 offset1:211
    v_mfma_f32_16x16x32_bf16 v[44:47], v[64:67], v[108:111], v[44:47]
    buffer_load_dwordx4 v4, s[52:55], s14 offen offset:0 lds
    ds_read_b128 v[168:171], v245 offset:8192
    s_waitcnt lgkmcnt(7)
    v_mfma_f32_16x16x32_bf16 v[48:51], v[64:67], v[112:115], v[48:51]
    ds_read2_b32 v[136:137], v237 offset0:80 offset1:81
    v_mfma_f32_16x16x32_bf16 v[48:51], v[68:71], v[108:111], v[48:51]
    v_mfma_f32_16x16x32_bf16 v[48:51], v[72:75], v[104:107], v[48:51]
    ds_read2_b32 v[138:139], v237 offset0:82 offset1:83
    v_mfma_f32_16x16x32_bf16 v[48:51], v[76:79], v[100:103], v[48:51]
    ds_read_b128 v[172:175], v245 offset:12288
    v_mfma_f32_16x16x32_bf16 v[48:51], v[80:83], v[96:99], v[48:51]
    ds_read2_b32 v[140:141], v237 offset0:208 offset1:209
    v_mfma_f32_16x16x32_bf16 v[52:55], v[84:87], v[96:99], v[52:55]
    ds_read2_b32 v[142:143], v237 offset0:210 offset1:211
    v_mfma_f32_16x16x32_bf16 v[52:55], v[80:83], v[100:103], v[52:55]
    ds_read_b128 v[176:179], v245 offset:16384
    v_mfma_f32_16x16x32_bf16 v[52:55], v[76:79], v[104:107], v[52:55]
    ds_read2_b32 v[144:145], v238 offset0:80 offset1:81
    v_mfma_f32_16x16x32_bf16 v[52:55], v[72:75], v[108:111], v[52:55]
    ds_read2_b32 v[146:147], v238 offset0:82 offset1:83
    v_mfma_f32_16x16x32_bf16 v[52:55], v[68:71], v[112:115], v[52:55]
    s_add_u32 m0, s73, 147456
    ds_read_b128 v[180:183], v245 offset:20480
    v_mfma_f32_16x16x32_bf16 v[52:55], v[64:67], v[116:119], v[52:55]
    buffer_load_dwordx4 v5, s[52:55], s14 offen offset:1024 lds
    ds_read2_b32 v[148:149], v238 offset0:208 offset1:209
    v_mfma_f32_16x16x32_bf16 v[56:59], v[64:67], v[120:123], v[56:59]
    ds_read2_b32 v[150:151], v238 offset0:210 offset1:211
    v_mfma_f32_16x16x32_bf16 v[56:59], v[68:71], v[116:119], v[56:59]
    ds_read_b128 v[184:187], v245 offset:24576
    v_mfma_f32_16x16x32_bf16 v[56:59], v[72:75], v[112:115], v[56:59]
    ds_read2_b32 v[152:153], v239 offset0:80 offset1:81
    v_mfma_f32_16x16x32_bf16 v[56:59], v[76:79], v[108:111], v[56:59]
    ds_read2_b32 v[154:155], v239 offset0:82 offset1:83
    v_mfma_f32_16x16x32_bf16 v[56:59], v[80:83], v[104:107], v[56:59]
    ds_read_b128 v[188:191], v245 offset:28672
    s_waitcnt vmcnt(6)
    s_barrier
    v_mfma_f32_16x16x32_bf16 v[56:59], v[84:87], v[100:103], v[56:59]
    ds_read2_b32 v[156:157], v239 offset0:208 offset1:209
    v_add_u32 v10, -131072, v10
    v_mfma_f32_16x16x32_bf16 v[56:59], v[88:91], v[96:99], v[56:59]
    ds_read_b64_tr_b16 a[208:209], v10 offset:0
    v_mfma_f32_16x16x32_bf16 v[60:63], v[92:95], v[96:99], v[60:63]
    ds_read_b64_tr_b16 a[210:211], v10 offset:2048
    v_mfma_f32_16x16x32_bf16 v[60:63], v[88:91], v[100:103], v[60:63]
    ds_read_b64_tr_b16 a[216:217], v10 offset:4096
    v_mfma_f32_16x16x32_bf16 v[60:63], v[84:87], v[104:107], v[60:63]
    ds_read2_b32 v[158:159], v239 offset0:210 offset1:211
    v_mfma_f32_16x16x32_bf16 v[60:63], v[80:83], v[108:111], v[60:63]
    ds_read_b64_tr_b16 a[218:219], v10 offset:6144
    s_add_u32 m0, s73, 147456
    v_mfma_f32_16x16x32_bf16 v[60:63], v[76:79], v[112:115], v[60:63]
    v_add_u32 v11, -131072, v11
    buffer_load_dwordx4 v6, s[52:55], s14 offen offset:2048 lds
    v_mfma_f32_16x16x32_bf16 v[60:63], v[72:75], v[116:119], v[60:63]
    ds_read_b64_tr_b16 a[212:213], v11 offset:0
    v_mfma_f32_16x16x32_bf16 v[60:63], v[68:71], v[120:123], v[60:63]
    ds_read_b64_tr_b16 a[214:215], v11 offset:2048
    v_mfma_f32_16x16x32_bf16 v[60:63], v[64:67], v[124:127], v[60:63]
    ds_read_b64_tr_b16 a[220:221], v11 offset:4096
    s_waitcnt lgkmcnt(15)
    v_mfma_f32_16x16x32_bf16 v[32:35], v[128:131], v[160:163], v[32:35]
    ds_read_b64_tr_b16 a[222:223], v11 offset:6144
    v_mfma_f32_16x16x32_bf16 v[36:39], v[132:135], v[160:163], v[36:39]
    ds_read_b128 v[96:99], v246 offset:0
    v_mfma_f32_16x16x32_bf16 v[36:39], v[128:131], v[164:167], v[36:39]
    ds_read2_b32 v[64:65], v236 offset0:96 offset1:97
    v_mfma_f32_16x16x32_bf16 v[40:43], v[128:131], v[168:171], v[40:43]
    ds_read2_b32 v[66:67], v236 offset0:98 offset1:99
    v_mfma_f32_16x16x32_bf16 v[40:43], v[132:135], v[164:167], v[40:43]
    v_mfma_f32_16x16x32_bf16 v[40:43], v[136:139], v[160:163], v[40:43]
    ds_read_b128 v[100:103], v246 offset:4096
    v_mfma_f32_16x16x32_bf16 v[44:47], v[140:143], v[160:163], v[44:47]
    ds_read2_b32 v[68:69], v236 offset0:224 offset1:225
    v_mfma_f32_16x16x32_bf16 v[44:47], v[136:139], v[164:167], v[44:47]
    s_add_u32 m0, s73, 147456
    v_mfma_f32_16x16x32_bf16 v[44:47], v[132:135], v[168:171], v[44:47]
    buffer_load_dwordx4 v7, s[52:55], s14 offen offset:3072 lds
    ds_read2_b32 v[70:71], v236 offset0:226 offset1:227
    v_mfma_f32_16x16x32_bf16 v[44:47], v[128:131], v[172:175], v[44:47]
    ds_read_b128 v[104:107], v246 offset:8192
    s_waitcnt lgkmcnt(12)
    v_mfma_f32_16x16x32_bf16 v[48:51], v[128:131], v[176:179], v[48:51]
    ds_read2_b32 v[72:73], v237 offset0:96 offset1:97
    v_mfma_f32_16x16x32_bf16 v[48:51], v[132:135], v[172:175], v[48:51]
    v_mfma_f32_16x16x32_bf16 v[48:51], v[136:139], v[168:171], v[48:51]
    ds_read2_b32 v[74:75], v237 offset0:98 offset1:99
    v_mfma_f32_16x16x32_bf16 v[48:51], v[140:143], v[164:167], v[48:51]
    ds_read_b128 v[108:111], v246 offset:12288
    v_mfma_f32_16x16x32_bf16 v[48:51], v[144:147], v[160:163], v[48:51]
    s_waitcnt lgkmcnt(10)
    s_barrier
    v_mfma_f32_16x16x32_bf16 v[52:55], v[148:151], v[160:163], v[52:55]
    ds_read2_b32 v[76:77], v237 offset0:224 offset1:225
    v_mfma_f32_16x16x32_bf16 v[52:55], v[144:147], v[164:167], v[52:55]
    ds_read2_b32 v[78:79], v237 offset0:226 offset1:227
    v_mfma_f32_16x16x32_bf16 v[52:55], v[140:143], v[168:171], v[52:55]
    v_mfma_f32_16x16x32_bf16 v[52:55], v[136:139], v[172:175], v[52:55]
    s_lshl_b32 s14, s100, 18
    ds_read_b128 v[112:115], v246 offset:16384
    v_mfma_f32_16x16x32_bf16 v[52:55], v[132:135], v[176:179], v[52:55]
    s_add_u32 m0, s73, 0
    ds_read2_b32 v[80:81], v238 offset0:96 offset1:97
    v_mfma_f32_16x16x32_bf16 v[52:55], v[128:131], v[180:183], v[52:55]
    buffer_load_dwordx4 v4, s[52:55], s14 offen offset:0 lds
    v_mfma_f32_16x16x32_bf16 v[56:59], v[128:131], v[184:187], v[56:59]
    ds_read2_b32 v[82:83], v238 offset0:98 offset1:99
    v_mfma_f32_16x16x32_bf16 v[56:59], v[132:135], v[180:183], v[56:59]
    ds_read_b128 v[116:119], v246 offset:20480
    v_mfma_f32_16x16x32_bf16 v[56:59], v[136:139], v[176:179], v[56:59]
    v_mfma_f32_16x16x32_bf16 v[56:59], v[140:143], v[172:175], v[56:59]
    ds_read2_b32 v[84:85], v238 offset0:224 offset1:225
    v_mfma_f32_16x16x32_bf16 v[56:59], v[144:147], v[168:171], v[56:59]
    ds_read2_b32 v[86:87], v238 offset0:226 offset1:227
    v_mfma_f32_16x16x32_bf16 v[56:59], v[148:151], v[164:167], v[56:59]
    ds_read_b128 v[120:123], v246 offset:24576
    v_mfma_f32_16x16x32_bf16 v[56:59], v[152:155], v[160:163], v[56:59]
    v_mfma_f32_16x16x32_bf16 v[60:63], v[156:159], v[160:163], v[60:63]
    ds_read2_b32 v[88:89], v239 offset0:96 offset1:97
    v_mfma_f32_16x16x32_bf16 v[60:63], v[152:155], v[164:167], v[60:63]
    s_add_u32 m0, s73, 0
    ds_read2_b32 v[90:91], v239 offset0:98 offset1:99
    v_mfma_f32_16x16x32_bf16 v[60:63], v[148:151], v[168:171], v[60:63]
    buffer_load_dwordx4 v5, s[52:55], s14 offen offset:1024 lds
    v_mfma_f32_16x16x32_bf16 v[60:63], v[144:147], v[172:175], v[60:63]
    ds_read_b128 v[124:127], v246 offset:28672
    v_mfma_f32_16x16x32_bf16 v[60:63], v[140:143], v[176:179], v[60:63]
    ds_read2_b32 v[92:93], v239 offset0:224 offset1:225
    v_mfma_f32_16x16x32_bf16 v[60:63], v[136:139], v[180:183], v[60:63]
    v_mfma_f32_16x16x32_bf16 v[60:63], v[132:135], v[184:187], v[60:63]
    ds_read2_b32 v[94:95], v239 offset0:226 offset1:227
    v_mfma_f32_16x16x32_bf16 v[60:63], v[128:131], v[188:191], v[60:63]
    s_waitcnt lgkmcnt(12)
    v_mfma_f32_16x16x32_bf16 v[32:35], v[64:67], v[96:99], v[32:35]
    ds_read_b128 v[160:163], v247 offset:0
    s_waitcnt vmcnt(6)
    s_barrier
    v_mfma_f32_16x16x32_bf16 v[36:39], v[68:71], v[96:99], v[36:39]
    ds_read_b64_tr_b16 a[224:225], v10 offset:16384
    s_bfe_u32 s4, s2, 0x20003
    v_mfma_f32_16x16x32_bf16 v[36:39], v[64:67], v[100:103], v[36:39]
    ds_read_b64_tr_b16 a[226:227], v10 offset:18432
    ds_read_b128 v[164:167], v247 offset:4096
    v_mfma_f32_16x16x32_bf16 v[40:43], v[64:67], v[104:107], v[40:43]
    s_lshl2_add_u32 s4, s72, s4
    ds_read_b128 v[168:171], v247 offset:8192
    v_mfma_f32_16x16x32_bf16 v[40:43], v[68:71], v[100:103], v[40:43]
    ds_read_b64_tr_b16 a[232:233], v10 offset:20480
    s_add_u32 m0, s73, 0
    ds_read_b128 v[172:175], v247 offset:12288
    v_mfma_f32_16x16x32_bf16 v[40:43], v[72:75], v[96:99], v[40:43]
    ds_read_b64_tr_b16 a[234:235], v10 offset:22528
    buffer_load_dwordx4 v6, s[52:55], s14 offen offset:2048 lds
    s_lshl_b32 s4, s4, 3
    v_mfma_f32_16x16x32_bf16 v[44:47], v[76:79], v[96:99], v[44:47]
    ds_read_b128 v[176:179], v247 offset:16384
    v_mfma_f32_16x16x32_bf16 v[44:47], v[72:75], v[100:103], v[44:47]
    ds_read_b64_tr_b16 a[228:229], v11 offset:16384
    s_lshr_b32 s5, s2, 4
    ds_read_b128 v[180:183], v247 offset:20480
    v_mfma_f32_16x16x32_bf16 v[44:47], v[68:71], v[104:107], v[44:47]
    ds_read_b64_tr_b16 a[230:231], v11 offset:18432
    v_mfma_f32_16x16x32_bf16 v[44:47], v[64:67], v[108:111], v[44:47]
    s_and_b32 s5, s5, 6
    ds_read_b128 v[184:187], v247 offset:24576
    s_waitcnt lgkmcnt(13)
    v_mfma_f32_16x16x32_bf16 v[48:51], v[64:67], v[112:115], v[48:51]
    ds_read_b64_tr_b16 a[236:237], v11 offset:20480
    ds_read_b128 v[188:191], v247 offset:28672
    v_mfma_f32_16x16x32_bf16 v[48:51], v[68:71], v[108:111], v[48:51]
    ds_read_b64_tr_b16 a[238:239], v11 offset:22528
    s_add_u32 s4, s4, s5
    v_mfma_f32_16x16x32_bf16 v[48:51], v[72:75], v[104:107], v[48:51]
    ds_read2_b32 v[128:129], v236 offset0:112 offset1:113
    v_mfma_f32_16x16x32_bf16 v[48:51], v[76:79], v[100:103], v[48:51]
    s_and_b32 s5, s2, 1
    ds_read2_b32 v[130:131], v236 offset0:114 offset1:115
    v_mfma_f32_16x16x32_bf16 v[48:51], v[80:83], v[96:99], v[48:51]
    ds_read2_b32 v[132:133], v236 offset0:240 offset1:241
    v_mfma_f32_16x16x32_bf16 v[52:55], v[84:87], v[96:99], v[52:55]
    s_add_u32 m0, s73, 0
    ds_read2_b32 v[134:135], v236 offset0:242 offset1:243
    s_add_u32 s4, s4, s5
    v_mfma_f32_16x16x32_bf16 v[52:55], v[80:83], v[100:103], v[52:55]
    buffer_load_dwordx4 v7, s[52:55], s14 offen offset:3072 lds
    ds_read2_b32 v[136:137], v237 offset0:112 offset1:113
    v_mfma_f32_16x16x32_bf16 v[52:55], v[76:79], v[104:107], v[52:55]
    s_lshl_b32 s4, s4, 7
    ds_read2_b32 v[138:139], v237 offset0:114 offset1:115
    v_mfma_f32_16x16x32_bf16 v[52:55], v[72:75], v[108:111], v[52:55]
    s_add_u32 s4, s4, 12566528
    ds_read2_b32 v[140:141], v237 offset0:240 offset1:241
    s_add_u32 s6, s12, 4767744
    v_mfma_f32_16x16x32_bf16 v[52:55], v[68:71], v[112:115], v[52:55]
    ds_read2_b32 v[142:143], v237 offset0:242 offset1:243
    v_mfma_f32_16x16x32_bf16 v[52:55], v[64:67], v[116:119], v[52:55]
    ds_read2_b32 v[144:145], v238 offset0:112 offset1:113
    v_lshl_add_u32 v28, v2, 2, s4
    v_mfma_f32_16x16x32_bf16 v[56:59], v[64:67], v[120:123], v[56:59]
    s_waitcnt lgkmcnt(9)
    s_barrier
    v_mfma_f32_16x16x32_bf16 v[56:59], v[68:71], v[116:119], v[56:59]
    ds_read2_b32 v[146:147], v238 offset0:114 offset1:115
    s_cmp_eq_u32 s3, 0
    s_cselect_b32 s4, 18, 0
    v_mfma_f32_16x16x32_bf16 v[56:59], v[72:75], v[112:115], v[56:59]
    ds_read2_b32 v[148:149], v238 offset0:240 offset1:241
    v_mfma_f32_16x16x32_bf16 v[56:59], v[76:79], v[108:111], v[56:59]
    ds_read2_b32 v[150:151], v238 offset0:242 offset1:243
    v_cmp_gt_u32 vcc, s4, v2
    v_mfma_f32_16x16x32_bf16 v[56:59], v[80:83], v[104:107], v[56:59]
    s_lshl_b32 s14, s101, 18
    ds_read2_b32 v[152:153], v239 offset0:112 offset1:113
    v_mfma_f32_16x16x32_bf16 v[56:59], v[84:87], v[100:103], v[56:59]
    ds_read2_b32 v[154:155], v239 offset0:114 offset1:115
    s_add_u32 m0, s73, 16384
    v_mov_b32 v13, 0x40000000
    v_mfma_f32_16x16x32_bf16 v[56:59], v[88:91], v[96:99], v[56:59]
    buffer_load_dwordx4 v4, s[52:55], s14 offen offset:0 lds
    ds_read2_b32 v[156:157], v239 offset0:240 offset1:241
    v_mfma_f32_16x16x32_bf16 v[60:63], v[92:95], v[96:99], v[60:63]
    ds_read2_b32 v[158:159], v239 offset0:242 offset1:243
    v_cndmask_b32 v28, v13, v28, vcc
    v_mfma_f32_16x16x32_bf16 v[60:63], v[88:91], v[100:103], v[60:63]
    v_mfma_f32_16x16x32_bf16 v[60:63], v[84:87], v[104:107], v[60:63]
    v_mov_b32 v13, s68
    v_mfma_f32_16x16x32_bf16 v[60:63], v[80:83], v[108:111], v[60:63]
    v_mfma_f32_16x16x32_bf16 v[60:63], v[76:79], v[112:115], v[60:63]
    v_cndmask_b32 v13, 0, v13, vcc
    v_mfma_f32_16x16x32_bf16 v[60:63], v[72:75], v[116:119], v[60:63]
    v_mfma_f32_16x16x32_bf16 v[60:63], v[68:71], v[120:123], v[60:63]
    v_mfma_f32_16x16x32_bf16 v[60:63], v[64:67], v[124:127], v[60:63]
    s_waitcnt lgkmcnt(0)
    v_mfma_f32_16x16x32_bf16 v[60:63], v[128:131], v[188:191], v[60:63]
    v_mfma_f32_16x16x32_bf16 v[60:63], v[132:135], v[184:187], v[60:63]
    s_add_u32 m0, s73, 16384
    v_mfma_f32_16x16x32_bf16 v[60:63], v[136:139], v[180:183], v[60:63]
    buffer_load_dwordx4 v5, s[52:55], s14 offen offset:1024 lds
    v_mfma_f32_16x16x32_bf16 v[60:63], v[140:143], v[176:179], v[60:63]
L_pl_X_6:
    s_cbranch_execz L_wret
    v_mfma_f32_16x16x32_bf16 v[60:63], v[144:147], v[172:175], v[60:63]
    v_mfma_f32_16x16x32_bf16 v[60:63], v[148:151], v[168:171], v[60:63]
    v_mfma_f32_16x16x32_bf16 v[60:63], v[152:155], v[164:167], v[60:63]
    v_mfma_f32_16x16x32_bf16 v[60:63], v[156:159], v[160:163], v[60:63]
    v_mfma_f32_16x16x32_bf16 v[56:59], v[128:131], v[184:187], v[56:59]
    v_mfma_f32_16x16x32_bf16 v[56:59], v[132:135], v[180:183], v[56:59]
    v_mfma_f32_16x16x32_bf16 v[56:59], v[136:139], v[176:179], v[56:59]
    v_mfma_f32_16x16x32_bf16 v[56:59], v[140:143], v[172:175], v[56:59]
    s_add_u32 m0, s73, 16384
    v_mfma_f32_16x16x32_bf16 v[56:59], v[144:147], v[168:171], v[56:59]
    buffer_load_dwordx4 v6, s[52:55], s14 offen offset:2048 lds
    v_mfma_f32_16x16x32_bf16 v[56:59], v[148:151], v[164:167], v[56:59]
    v_cvt_pk_bf16_f32 v206, v60, v61
    v_mfma_f32_16x16x32_bf16 v[56:59], v[152:155], v[160:163], v[56:59]
    s_waitcnt vmcnt(7)
    s_barrier
    v_mfma_f32_16x16x32_bf16 v[52:55], v[128:131], v[180:183], v[52:55]
    v_add_u32 v10, 131072, v10
    v_mfma_f32_16x16x32_bf16 v[52:55], v[132:135], v[176:179], v[52:55]
    ds_read_b64_tr_b16 a[240:241], v10 offset:16384
    v_cvt_pk_bf16_f32 v207, v62, v63
    v_mfma_f32_16x16x32_bf16 v[52:55], v[136:139], v[172:175], v[52:55]
    ds_read_b64_tr_b16 a[242:243], v10 offset:18432
    v_mfma_f32_16x16x32_bf16 v[52:55], v[140:143], v[168:171], v[52:55]
    buffer_store_dwordx2 v[206:207], v8, s[44:47], s6 offen offset:3584 sc1
    v_mfma_f32_16x16x32_bf16 v[52:55], v[144:147], v[164:167], v[52:55]
    ds_read_b64_tr_b16 a[248:249], v10 offset:20480
    v_mfma_f32_16x16x32_bf16 v[52:55], v[148:151], v[160:163], v[52:55]
    ds_read_b64_tr_b16 a[250:251], v10 offset:22528
    v_mfma_f32_16x16x32_bf16 v[48:51], v[128:131], v[176:179], v[48:51]
    v_add_u32 v11, 131072, v11
    v_cvt_pk_bf16_f32 v204, v56, v57
    v_mfma_f32_16x16x32_bf16 v[48:51], v[132:135], v[172:175], v[48:51]
    ds_read_b64_tr_b16 a[244:245], v11 offset:16384
    s_add_u32 m0, s73, 16384
    v_mfma_f32_16x16x32_bf16 v[48:51], v[136:139], v[168:171], v[48:51]
    ds_read_b64_tr_b16 a[246:247], v11 offset:18432
    buffer_load_dwordx4 v7, s[52:55], s14 offen offset:3072 lds
    v_mfma_f32_16x16x32_bf16 v[48:51], v[140:143], v[164:167], v[48:51]
    v_cvt_pk_bf16_f32 v205, v58, v59
    v_mfma_f32_16x16x32_bf16 v[48:51], v[144:147], v[160:163], v[48:51]
    ds_read_b64_tr_b16 a[252:253], v11 offset:20480
    v_mfma_f32_16x16x32_bf16 v[44:47], v[128:131], v[172:175], v[44:47]
    buffer_store_dwordx2 v[204:205], v8, s[44:47], s6 offen offset:3072 sc1
    ds_read_b64_tr_b16 a[254:255], v11 offset:22528
    v_mfma_f32_16x16x32_bf16 v[44:47], v[132:135], v[168:171], v[44:47]
    v_mfma_f32_16x16x32_bf16 v[44:47], v[136:139], v[164:167], v[44:47]
    v_mfma_f32_16x16x32_bf16 v[44:47], v[140:143], v[160:163], v[44:47]
    v_cvt_pk_bf16_f32 v202, v52, v53
    v_mfma_f32_16x16x32_bf16 v[40:43], v[128:131], v[168:171], v[40:43]
    v_mfma_f32_16x16x32_bf16 v[40:43], v[132:135], v[164:167], v[40:43]
    v_mfma_f32_16x16x32_bf16 v[40:43], v[136:139], v[160:163], v[40:43]
    v_cvt_pk_bf16_f32 v203, v54, v55
    v_mfma_f32_16x16x32_bf16 v[36:39], v[128:131], v[164:167], v[36:39]
    v_mfma_f32_16x16x32_bf16 v[36:39], v[132:135], v[160:163], v[36:39]
    buffer_store_dwordx2 v[202:203], v8, s[44:47], s6 offen offset:2560 sc1
    v_mfma_f32_16x16x32_bf16 v[32:35], v[128:131], v[160:163], v[32:35]
    v_mov_b32 v29, 0
    buffer_atomic_add v29, v28, s[44:47], 0 offen sc0 sc1
    v_cvt_pk_bf16_f32 v200, v48, v49
    v_cvt_pk_bf16_f32 v201, v50, v51
    buffer_store_dwordx2 v[200:201], v8, s[44:47], s6 offen offset:2048 sc1
    v_cvt_pk_bf16_f32 v198, v44, v45
    v_cvt_pk_bf16_f32 v199, v46, v47
    buffer_store_dwordx2 v[198:199], v8, s[44:47], s6 offen offset:1536 sc1
    v_cvt_pk_bf16_f32 v196, v40, v41
    v_cvt_pk_bf16_f32 v197, v42, v43
    buffer_store_dwordx2 v[196:197], v8, s[44:47], s6 offen offset:1024 sc1
    v_cvt_pk_bf16_f32 v194, v36, v37
    v_cvt_pk_bf16_f32 v195, v38, v39
    buffer_store_dwordx2 v[194:195], v8, s[44:47], s6 offen offset:512 sc1
    v_cvt_pk_bf16_f32 v192, v32, v33
    v_cvt_pk_bf16_f32 v193, v34, v35
    buffer_store_dwordx2 v[192:193], v8, s[44:47], s6 offen offset:0 sc1
    v_add_u32 v10, -131072, v10
    v_add_u32 v11, -131072, v11
    s_waitcnt lgkmcnt(0)
    s_barrier
L_DX:
    s_waitcnt vmcnt(0)
    v_cmp_ne_u32 vcc, v13, v29
    s_cbranch_vccnz L_rs_p2X
L_ok_p2X:
    s_barrier
    s_add_u32 m0, s73, 97536
    s_nop 0
    buffer_load_dwordx4 v23, s[44:47], s18 offen offset:768 sc1 lds
    s_add_u32 m0, s73, 99328
    s_nop 0
    buffer_load_dwordx4 v20, s[44:47], s18 offen offset:0 sc1 lds
    s_add_u32 m0, s73, 99840
    s_nop 0
    buffer_load_dwordx4 v20, s[44:47], s18 offen offset:512 sc1 lds
    s_add_u32 m0, s73, 100608
    s_nop 0
    buffer_load_dwordx4 v23, s[44:47], s19 offen offset:768 sc1 lds
    s_add_u32 m0, s73, 114688
    s_nop 0
    buffer_load_dwordx4 v20, s[44:47], s19 offen offset:0 sc1 lds
    s_add_u32 m0, s73, 115200
    s_nop 0
    buffer_load_dwordx4 v20, s[44:47], s19 offen offset:512 sc1 lds
    s_add_u32 m0, s73, 115968
    s_nop 0
    buffer_load_dwordx4 v23, s[44:47], s20 offen offset:768 sc1 lds
    s_add_u32 m0, s73, 117760
    s_nop 0
    buffer_load_dwordx4 v20, s[44:47], s20 offen offset:0 sc1 lds
    s_mov_b32 s56, s16
    s_and_b32 s57, s17, 0xffff
    s_mov_b32 s58, 2359296
    s_mov_b32 s59, 0x20000
    s_mov_b32 s40, 18432
    s_mov_b32 s42, 12386304
    s_mov_b32 s64, s38
    s_and_b32 s65, s39, 0xffff
    s_mov_b32 s66, 2359296
    s_mov_b32 s67, 0x20000
    v_lshlrev_b32 v136, 4, v2
    s_mul_i32 s7, s72, 36
    s_bitcmp1_b32 s3, 0
    s_addc_u32 s7, s7, 0
    s_lshl_b32 s7, s7, 17
    v_subrev_u32 v184, s7, v4
    v_subrev_u32 v185, s7, v5
    s_bfe_u32 s4, s2, 0x20003
    s_mul_i32 s4, s4, 9
    s_lshl1_add_u32 s7, s72, s4
    s_and_b32 s8, s3, 1
    s_add_u32 s7, s7, s8
    s_lshl_b32 s37, s7, 16
    s_add_u32 s37, s37, 4718592
    s_add_u32 s4, s4, 8
    s_lshl_b32 s16, s4, 16
    s_add_u32 s16, s16, 4718592
    s_sub_u32 s4, s4, s7
    s_lshl_b32 s4, s4, 7
    s_lshl_b32 s7, s7, 7
    s_add_u32 s7, s7, 12582912
    v_bfe_u32 v24, v2, 2, 1
    v_mul_u32_u24 v24, s4, v24
    v_and_b32 v25, 3, v2
    v_lshl_add_u32 v24, v25, 2, v24
    v_add_u32 v188, s7, v24
    s_lshl2_add_u32 s7, s2, s3
    s_mul_i32 s8, s7, 3072
    s_add_u32 s34, s8, 22953984
    s_add_u32 s11, s8, 26099712
    s_add_u32 s12, s8, 29245440
    s_lshl_b32 s35, s7, 12
    s_add_u32 s35, s35, 32391168
    s_xor_b32 s8, s7, 8
    s_mul_i32 s8, s8, 3072
    s_add_u32 s30, s8, 22953984
    s_xor_b32 s8, s7, 16
    s_mul_i32 s8, s8, 3072
    s_add_u32 s15, s8, 26099712
    s_xor_b32 s8, s7, 24
    s_mul_i32 s8, s8, 3072
    s_add_u32 s31, s8, 29245440
    s_andn2_b32 s7, s7, 24
    s_lshl3_add_u32 s7, s3, s7
    s_lshl2_add_u32 s8, s7, s72
    s_lshl_b32 s8, s8, 10
    s_add_u32 s32, s8, 32391168
    s_xor_b32 s8, s8, 4096
    s_add_u32 s33, s8, 32391168
    s_xor_b32 s8, s3, s72
    s_cmp_lt_u32 s8, 2
    s_cselect_b32 s35, s35, 0x40000000
    s_cselect_b32 s16, s16, 0x40000000
    s_cselect_b32 s36, s68, 0
    s_mov_b32 s38, 0xbfb8aa3b
    s_and_b32 s8, s8, 1
    s_mul_i32 s41, s8, 96
    s_and_b32 s43, s73, 4096
    v_lshlrev_b32 v24, 10, v2
    v_add_u32 v24, s35, v24
    s_add_u32 s7, s34, 2048
    v_mov_b32 v25, s36
    v_cmp_gt_u32 vcc, 4, v2
    s_nop 1
    v_cndmask_b32 v138, 0, v25, vcc
    v_mov_b32 v25, 0x40000000
    v_cndmask_b32 v137, v25, v24, vcc
    v_writelane_b32 v137, s7, 4
    v_writelane_b32 v138, s68, 4
    v_min_u32 v139, 1, v2
    v_lshlrev_b32 v139, 30, v139
    v_mov_b32 v140, 0
    v_writelane_b32 v140, s68, 0
    v_mov_b32 v195, s68
    v_mov_b32 v199, s68
    v_mov_b32 v202, s68
    v_mov_b32 v203, s68
    s_waitcnt vmcnt(4)
    s_barrier
    ds_read_b128 v[104:107], v14 offset:0
    ds_read_b128 v[108:111], v14 offset:4096
    ds_read_b128 v[112:115], v14 offset:8192
    ds_read_b128 v[116:119], v14 offset:12288
    s_waitcnt lgkmcnt(2)
    v_mfma_f32_16x16x32_bf16 v[32:35], v[104:107], a[0:3], 0
    s_add_u32 m0, s73, 130560
    s_sub_u32 s4, s75, 216
    s_lshl_b32 s7, s4, 7
    v_mfma_f32_16x16x32_bf16 v[32:35], v[108:111], a[8:11], v[32:35]
    buffer_load_dwordx4 v20, s[44:47], s20 offen offset:512 sc1 lds
    s_waitcnt lgkmcnt(0)
    v_mfma_f32_16x16x32_bf16 v[32:35], v[112:115], a[16:19], v[32:35]
    ds_read_b128 v[120:123], v14 offset:1024
    s_lshl2_add_u32 s7, s3, s7
    s_add_u32 s7, s7, 12582912
    v_mfma_f32_16x16x32_bf16 v[32:35], v[116:119], a[24:27], v[32:35]
    ds_read_b128 v[124:127], v14 offset:5120
    v_mfma_f32_16x16x32_bf16 v[36:39], v[116:119], a[28:31], 0
    ds_read_b128 v[128:131], v14 offset:9216
    s_cmp_lt_u32 s4, 36
    s_cselect_b32 s7, s7, 0x40000000
    v_mfma_f32_16x16x32_bf16 v[36:39], v[112:115], a[20:23], v[36:39]
    ds_read_b128 v[132:135], v14 offset:13312
    v_min_u32 v28, 1, v2
    v_mfma_f32_16x16x32_bf16 v[36:39], v[108:111], a[12:15], v[36:39]
    s_add_u32 m0, s73, 131328
    v_lshlrev_b32 v28, 30, v28
    v_mov_b32 v29, s68
    v_mfma_f32_16x16x32_bf16 v[36:39], v[104:107], a[4:7], v[36:39]
    buffer_load_dwordx4 v23, s[44:47], s21 offen offset:768 sc1 lds
    s_waitcnt lgkmcnt(2)
    v_mfma_f32_16x16x32_bf16 v[44:47], v[120:123], a[4:7], 0
    buffer_store_dword v29, v28, s[44:47], s7 offen sc1
    s_add_u32 m0, s73, 133120
    v_mfma_f32_16x16x32_bf16 v[44:47], v[124:127], a[12:15], v[44:47]
    buffer_load_dwordx4 v20, s[44:47], s21 offen offset:0 sc1 lds
    s_waitcnt lgkmcnt(0)
    v_mfma_f32_16x16x32_bf16 v[44:47], v[128:131], a[20:23], v[44:47]
    ds_read_b128 v[104:107], v14 offset:2048
    v_mfma_f32_16x16x32_bf16 v[44:47], v[132:135], a[28:31], v[44:47]
    ds_read_b128 v[108:111], v14 offset:6144
    v_mfma_f32_16x16x32_bf16 v[40:43], v[132:135], a[24:27], 0
    ds_read_b128 v[112:115], v14 offset:10240
    v_mfma_f32_16x16x32_bf16 v[40:43], v[128:131], a[16:19], v[40:43]
    ds_read_b128 v[116:119], v14 offset:14336
    v_mfma_f32_16x16x32_bf16 v[40:43], v[124:127], a[8:11], v[40:43]
    s_add_u32 m0, s73, 133632
    v_mfma_f32_16x16x32_bf16 v[40:43], v[120:123], a[0:3], v[40:43]
    buffer_load_dwordx4 v20, s[44:47], s21 offen offset:512 sc1 lds
    s_waitcnt lgkmcnt(2)
    v_mfma_f32_16x16x32_bf16 v[48:51], v[104:107], a[0:3], 0
    s_add_u32 m0, s73, 146688
    v_mfma_f32_16x16x32_bf16 v[48:51], v[108:111], a[8:11], v[48:51]
    buffer_load_dwordx4 v23, s[44:47], s22 offen offset:768 sc1 lds
    s_waitcnt lgkmcnt(0)
    v_mfma_f32_16x16x32_bf16 v[48:51], v[112:115], a[16:19], v[48:51]
    ds_read_b128 v[120:123], v14 offset:3072
    v_mfma_f32_16x16x32_bf16 v[48:51], v[116:119], a[24:27], v[48:51]
    ds_read_b128 v[124:127], v14 offset:7168
    v_mfma_f32_16x16x32_bf16 v[52:55], v[116:119], a[28:31], 0
    ds_read_b128 v[128:131], v14 offset:11264
    v_mfma_f32_16x16x32_bf16 v[52:55], v[112:115], a[20:23], v[52:55]
    ds_read_b128 v[132:135], v14 offset:15360
    v_mfma_f32_16x16x32_bf16 v[52:55], v[108:111], a[12:15], v[52:55]
    s_add_u32 m0, s73, 148480
    v_mfma_f32_16x16x32_bf16 v[52:55], v[104:107], a[4:7], v[52:55]
    buffer_load_dwordx4 v20, s[44:47], s22 offen offset:0 sc1 lds
    s_waitcnt lgkmcnt(2)
    v_mfma_f32_16x16x32_bf16 v[36:39], v[120:123], a[36:39], v[36:39]
    s_add_u32 m0, s73, 148992
    v_mfma_f32_16x16x32_bf16 v[36:39], v[124:127], a[44:47], v[36:39]
    buffer_load_dwordx4 v20, s[44:47], s22 offen offset:512 sc1 lds
    s_waitcnt lgkmcnt(0)
    v_mfma_f32_16x16x32_bf16 v[36:39], v[128:131], a[52:55], v[36:39]
    s_waitcnt vmcnt(8)
    s_barrier
    v_mfma_f32_16x16x32_bf16 v[36:39], v[132:135], a[60:63], v[36:39]
    ds_read_b128 v[104:107], v14 offset:16384
    v_mfma_f32_16x16x32_bf16 v[32:35], v[132:135], a[56:59], v[32:35]
    ds_read_b128 v[108:111], v14 offset:20480
    v_mfma_f32_16x16x32_bf16 v[32:35], v[128:131], a[48:51], v[32:35]
    ds_read_b128 v[112:115], v14 offset:24576
    v_mfma_f32_16x16x32_bf16 v[32:35], v[124:127], a[40:43], v[32:35]
    ds_read_b128 v[116:119], v14 offset:28672
    s_add_u32 m0, s73, 149760
    v_mfma_f32_16x16x32_bf16 v[32:35], v[120:123], a[32:35], v[32:35]
    buffer_load_dwordx4 v23, s[44:47], s23 offen offset:768 sc1 lds
    ds_read_b64_tr_b16 v[220:221], v10 offset:0
    s_waitcnt lgkmcnt(3)
    v_mfma_f32_16x16x32_bf16 v[40:43], v[104:107], a[32:35], v[40:43]
    s_add_u32 m0, s73, 98304
    ds_read_b64_tr_b16 v[222:223], v10 offset:2048
    v_mfma_f32_16x16x32_bf16 v[40:43], v[108:111], a[40:43], v[40:43]
    buffer_load_dwordx4 v20, s[44:47], s23 offen offset:0 sc1 lds
    s_waitcnt lgkmcnt(2)
    v_mfma_f32_16x16x32_bf16 v[40:43], v[112:115], a[48:51], v[40:43]
    ds_read_b128 v[120:123], v14 offset:17408
    v_mfma_f32_16x16x32_bf16 v[40:43], v[116:119], a[56:59], v[40:43]
    ds_read_b128 v[124:127], v14 offset:21504
    v_mfma_f32_16x16x32_bf16 v[44:47], v[116:119], a[60:63], v[44:47]
    ds_read_b128 v[128:131], v14 offset:25600
    v_mfma_f32_16x16x32_bf16 v[44:47], v[112:115], a[52:55], v[44:47]
    ds_read_b128 v[132:135], v14 offset:29696
    v_mfma_f32_16x16x32_bf16 v[44:47], v[108:111], a[44:47], v[44:47]
    s_add_u32 m0, s73, 98816
    ds_read_b64_tr_b16 v[228:229], v10 offset:4096
    v_mfma_f32_16x16x32_bf16 v[44:47], v[104:107], a[36:39], v[44:47]
    buffer_load_dwordx4 v20, s[44:47], s23 offen offset:512 sc1 lds
    s_waitcnt lgkmcnt(3)
    v_mfma_f32_16x16x32_bf16 v[52:55], v[120:123], a[36:39], v[52:55]
    s_add_u32 m0, s73, 99584
    ds_read_b64_tr_b16 v[230:231], v10 offset:6144
    v_mfma_f32_16x16x32_bf16 v[52:55], v[124:127], a[44:47], v[52:55]
    buffer_load_dwordx4 v23, s[44:47], s24 offen offset:768 sc1 lds
    s_waitcnt lgkmcnt(2)
    v_mfma_f32_16x16x32_bf16 v[52:55], v[128:131], a[52:55], v[52:55]
    ds_read_b128 v[104:107], v14 offset:18432
    v_mfma_f32_16x16x32_bf16 v[52:55], v[132:135], a[60:63], v[52:55]
    ds_read_b128 v[108:111], v14 offset:22528
    v_mfma_f32_16x16x32_bf16 v[48:51], v[132:135], a[56:59], v[48:51]
    ds_read_b128 v[112:115], v14 offset:26624
    v_mfma_f32_16x16x32_bf16 v[48:51], v[128:131], a[48:51], v[48:51]
    ds_read_b128 v[116:119], v14 offset:30720
    v_mfma_f32_16x16x32_bf16 v[48:51], v[124:127], a[40:43], v[48:51]
    s_add_u32 m0, s73, 101376
    ds_read_b64_tr_b16 v[224:225], v11 offset:0
    v_mfma_f32_16x16x32_bf16 v[48:51], v[120:123], a[32:35], v[48:51]
    buffer_load_dwordx4 v20, s[44:47], s24 offen offset:0 sc1 lds
    s_waitcnt lgkmcnt(3)
    v_mfma_f32_16x16x32_bf16 v[32:35], v[104:107], a[64:67], v[32:35]
    ds_read_b64_tr_b16 v[226:227], v11 offset:2048
    v_mfma_f32_16x16x32_bf16 v[32:35], v[108:111], a[72:75], v[32:35]
    s_waitcnt lgkmcnt(2)
    v_mfma_f32_16x16x32_bf16 v[32:35], v[112:115], a[80:83], v[32:35]
    ds_read_b128 v[120:123], v14 offset:19456
    v_mfma_f32_16x16x32_bf16 v[32:35], v[116:119], a[88:91], v[32:35]
    ds_read_b128 v[124:127], v14 offset:23552
    v_mfma_f32_16x16x32_bf16 v[36:39], v[116:119], a[92:95], v[36:39]
    ds_read_b128 v[128:131], v14 offset:27648
    v_mfma_f32_16x16x32_bf16 v[36:39], v[112:115], a[84:87], v[36:39]
    ds_read_b128 v[132:135], v14 offset:31744
    v_mfma_f32_16x16x32_bf16 v[36:39], v[108:111], a[76:79], v[36:39]
    ds_read_b64_tr_b16 v[232:233], v11 offset:4096
    v_mfma_f32_16x16x32_bf16 v[36:39], v[104:107], a[68:71], v[36:39]
    s_waitcnt lgkmcnt(3)
    v_mfma_f32_16x16x32_bf16 v[44:47], v[120:123], a[68:71], v[44:47]
    ds_read_b64_tr_b16 v[234:235], v11 offset:6144
    v_mfma_f32_16x16x32_bf16 v[44:47], v[124:127], a[76:79], v[44:47]
    s_waitcnt lgkmcnt(2)
    v_mfma_f32_16x16x32_bf16 v[44:47], v[128:131], a[84:87], v[44:47]
    s_waitcnt vmcnt(8) lgkmcnt(0)
    s_barrier
    v_mfma_f32_16x16x32_bf16 v[44:47], v[132:135], a[92:95], v[44:47]
    ds_read_b128 v[104:107], v14 offset:32768
    v_mfma_f32_16x16x32_bf16 v[40:43], v[132:135], a[88:91], v[40:43]
    ds_read_b128 v[108:111], v14 offset:36864
    v_mfma_f32_16x16x32_bf16 v[40:43], v[128:131], a[80:83], v[40:43]
    ds_read_b128 v[112:115], v14 offset:40960
    v_mfma_f32_16x16x32_bf16 v[40:43], v[124:127], a[72:75], v[40:43]
    ds_read_b128 v[116:119], v14 offset:45056
    v_mfma_f32_16x16x32_bf16 v[40:43], v[120:123], a[64:67], v[40:43]
    ds_read_b64_tr_b16 v[236:237], v10 offset:16384
    s_waitcnt lgkmcnt(3)
    v_mfma_f32_16x16x32_bf16 v[48:51], v[104:107], a[64:67], v[48:51]
    s_add_u32 m0, s73, 114176
    ds_read_b64_tr_b16 v[238:239], v10 offset:18432
    v_mfma_f32_16x16x32_bf16 v[48:51], v[108:111], a[72:75], v[48:51]
    buffer_load_dwordx4 v20, s[44:47], s24 offen offset:512 sc1 lds
    s_waitcnt lgkmcnt(2)
    v_mfma_f32_16x16x32_bf16 v[48:51], v[112:115], a[80:83], v[48:51]
    ds_read_b128 v[120:123], v14 offset:33792
    v_mfma_f32_16x16x32_bf16 v[48:51], v[116:119], a[88:91], v[48:51]
    ds_read_b128 v[124:127], v14 offset:37888
    v_lshrrev_b32 v30, 2, v26
    v_mfma_f32_16x16x32_bf16 v[52:55], v[116:119], a[92:95], v[52:55]
    ds_read_b128 v[128:131], v14 offset:41984
    v_mfma_f32_16x16x32_bf16 v[52:55], v[112:115], a[84:87], v[52:55]
    ds_read_b128 v[132:135], v14 offset:46080
    v_mfma_f32_16x16x32_bf16 v[52:55], v[108:111], a[76:79], v[52:55]
    s_add_u32 m0, s73, 114944
    ds_read_b64_tr_b16 v[244:245], v10 offset:20480
    v_mfma_f32_16x16x32_bf16 v[52:55], v[104:107], a[68:71], v[52:55]
    buffer_load_dwordx4 v23, s[44:47], s25 offen offset:768 sc1 lds
    s_waitcnt lgkmcnt(3)
    v_mfma_f32_16x16x32_bf16 v[36:39], v[120:123], a[100:103], v[36:39]
    s_add_u32 m0, s73, 116736
    ds_read_b64_tr_b16 v[246:247], v10 offset:22528
    v_mfma_f32_16x16x32_bf16 v[36:39], v[124:127], a[108:111], v[36:39]
    buffer_load_dwordx4 v20, s[44:47], s25 offen offset:0 sc1 lds
    s_waitcnt lgkmcnt(2)
    v_mfma_f32_16x16x32_bf16 v[36:39], v[128:131], a[116:119], v[36:39]
    ds_read_b128 v[104:107], v14 offset:34816
    v_lshrrev_b32 v31, 2, v18
    v_mfma_f32_16x16x32_bf16 v[36:39], v[132:135], a[124:127], v[36:39]
    ds_read_b128 v[108:111], v14 offset:38912
    v_mfma_f32_16x16x32_bf16 v[32:35], v[132:135], a[120:123], v[32:35]
    ds_read_b128 v[112:115], v14 offset:43008
    v_mfma_f32_16x16x32_bf16 v[32:35], v[128:131], a[112:115], v[32:35]
    ds_read_b128 v[116:119], v14 offset:47104
    v_mfma_f32_16x16x32_bf16 v[32:35], v[124:127], a[104:107], v[32:35]
    s_add_u32 m0, s73, 117248
    ds_read_b64_tr_b16 v[240:241], v11 offset:16384
    v_mfma_f32_16x16x32_bf16 v[32:35], v[120:123], a[96:99], v[32:35]
    buffer_load_dwordx4 v20, s[44:47], s25 offen offset:512 sc1 lds
    s_waitcnt lgkmcnt(3)
    v_mfma_f32_16x16x32_bf16 v[40:43], v[104:107], a[96:99], v[40:43]
    ds_read_b64_tr_b16 v[242:243], v11 offset:18432
    buffer_load_ushort v102, v30, s[60:63], 0 offen offset:0
    v_mfma_f32_16x16x32_bf16 v[40:43], v[108:111], a[104:107], v[40:43]
    s_waitcnt lgkmcnt(2)
    v_mfma_f32_16x16x32_bf16 v[40:43], v[112:115], a[112:115], v[40:43]
    ds_read_b128 v[120:123], v14 offset:35840
    v_mfma_f32_16x16x32_bf16 v[40:43], v[116:119], a[120:123], v[40:43]
    ds_read_b128 v[124:127], v14 offset:39936
    v_mfma_f32_16x16x32_bf16 v[44:47], v[116:119], a[124:127], v[44:47]
    ds_read_b128 v[128:131], v14 offset:44032
    v_mfma_f32_16x16x32_bf16 v[44:47], v[112:115], a[116:119], v[44:47]
    ds_read_b128 v[132:135], v14 offset:48128
    v_mfma_f32_16x16x32_bf16 v[44:47], v[108:111], a[108:111], v[44:47]
    ds_read_b64_tr_b16 v[248:249], v11 offset:20480
    buffer_load_ushort v103, v30, s[60:63], 0 offen offset:32
    v_mfma_f32_16x16x32_bf16 v[44:47], v[104:107], a[100:103], v[44:47]
    s_waitcnt lgkmcnt(3)
    v_mfma_f32_16x16x32_bf16 v[52:55], v[120:123], a[100:103], v[52:55]
    ds_read_b64_tr_b16 v[250:251], v11 offset:22528
    v_mfma_f32_16x16x32_bf16 v[52:55], v[124:127], a[108:111], v[52:55]
    s_waitcnt lgkmcnt(2)
    v_mfma_f32_16x16x32_bf16 v[52:55], v[128:131], a[116:119], v[52:55]
    s_waitcnt vmcnt(10) lgkmcnt(0)
    s_barrier
    v_mfma_f32_16x16x32_bf16 v[52:55], v[132:135], a[124:127], v[52:55]
    ds_read_b128 v[104:107], v14 offset:49152
    v_mfma_f32_16x16x32_bf16 v[48:51], v[132:135], a[120:123], v[48:51]
    ds_read_b128 v[108:111], v14 offset:53248
    buffer_load_ushort v27, v31, s[60:63], 0 offen offset:0
    v_mfma_f32_16x16x32_bf16 v[48:51], v[128:131], a[112:115], v[48:51]
    ds_read_b128 v[112:115], v14 offset:57344
    v_mfma_f32_16x16x32_bf16 v[48:51], v[124:127], a[104:107], v[48:51]
    ds_read_b128 v[116:119], v14 offset:61440
    v_mfma_f32_16x16x32_bf16 v[48:51], v[120:123], a[96:99], v[48:51]
    s_waitcnt lgkmcnt(2)
    v_mfma_f32_16x16x32_bf16 v[32:35], v[104:107], a[128:131], v[32:35]
    s_add_u32 m0, s73, 130304
    v_mfma_f32_16x16x32_bf16 v[32:35], v[108:111], a[136:139], v[32:35]
    buffer_load_dwordx4 v23, s[44:47], s26 offen offset:768 sc1 lds
    s_waitcnt lgkmcnt(0)
    v_mfma_f32_16x16x32_bf16 v[32:35], v[112:115], a[144:147], v[32:35]
    ds_read_b128 v[120:123], v14 offset:50176
    v_mfma_f32_16x16x32_bf16 v[32:35], v[116:119], a[152:155], v[32:35]
    ds_read_b128 v[124:127], v14 offset:54272
    v_mfma_f32_16x16x32_bf16 v[36:39], v[116:119], a[156:159], v[36:39]
    ds_read_b128 v[128:131], v14 offset:58368
    v_mfma_f32_16x16x32_bf16 v[36:39], v[112:115], a[148:151], v[36:39]
    ds_read_b128 v[132:135], v14 offset:62464
    v_mfma_f32_16x16x32_bf16 v[36:39], v[108:111], a[140:143], v[36:39]
    s_add_u32 m0, s73, 132096
    v_mfma_f32_16x16x32_bf16 v[36:39], v[104:107], a[132:135], v[36:39]
    buffer_load_dwordx4 v20, s[44:47], s26 offen offset:0 sc1 lds
    s_waitcnt lgkmcnt(2)
    v_mfma_f32_16x16x32_bf16 v[44:47], v[120:123], a[132:135], v[44:47]
    s_add_u32 m0, s73, 132608
    buffer_load_dwordx4 v[88:91], v252, s[56:59], 0 offen
    v_mfma_f32_16x16x32_bf16 v[44:47], v[124:127], a[140:143], v[44:47]
    buffer_load_dwordx4 v20, s[44:47], s26 offen offset:512 sc1 lds
    s_waitcnt lgkmcnt(0)
    v_mfma_f32_16x16x32_bf16 v[44:47], v[128:131], a[148:151], v[44:47]
    ds_read_b128 v[104:107], v14 offset:51200
    v_mfma_f32_16x16x32_bf16 v[44:47], v[132:135], a[156:159], v[44:47]
    ds_read_b128 v[108:111], v14 offset:55296
    v_mfma_f32_16x16x32_bf16 v[40:43], v[132:135], a[152:155], v[40:43]
    ds_read_b128 v[112:115], v14 offset:59392
    v_mfma_f32_16x16x32_bf16 v[40:43], v[128:131], a[144:147], v[40:43]
    ds_read_b128 v[116:119], v14 offset:63488
    v_mfma_f32_16x16x32_bf16 v[40:43], v[124:127], a[136:139], v[40:43]
    s_add_u32 m0, s73, 134144
    v_mfma_f32_16x16x32_bf16 v[40:43], v[120:123], a[128:131], v[40:43]
    buffer_load_dwordx4 v21, s[44:47], s18 offen offset:0 sc1 lds
    s_waitcnt lgkmcnt(2)
    v_mfma_f32_16x16x32_bf16 v[48:51], v[104:107], a[128:131], v[48:51]
    v_mfma_f32_16x16x32_bf16 v[48:51], v[108:111], a[136:139], v[48:51]
    s_waitcnt lgkmcnt(0)
    v_mfma_f32_16x16x32_bf16 v[48:51], v[112:115], a[144:147], v[48:51]
    ds_read_b128 v[120:123], v14 offset:52224
    v_mfma_f32_16x16x32_bf16 v[48:51], v[116:119], a[152:155], v[48:51]
    ds_read_b128 v[124:127], v14 offset:56320
    v_mfma_f32_16x16x32_bf16 v[52:55], v[116:119], a[156:159], v[52:55]
    ds_read_b128 v[128:131], v14 offset:60416
    v_mfma_f32_16x16x32_bf16 v[52:55], v[112:115], a[148:151], v[52:55]
    ds_read_b128 v[132:135], v14 offset:64512
    v_mfma_f32_16x16x32_bf16 v[52:55], v[108:111], a[140:143], v[52:55]
    v_mfma_f32_16x16x32_bf16 v[52:55], v[104:107], a[132:135], v[52:55]
    s_waitcnt lgkmcnt(2)
    v_mfma_f32_16x16x32_bf16 v[36:39], v[120:123], a[164:167], v[36:39]
    buffer_load_dwordx4 v[92:95], v252, s[56:59], s40 offen
    v_mfma_f32_16x16x32_bf16 v[36:39], v[124:127], a[172:175], v[36:39]
    s_waitcnt lgkmcnt(0)
    v_mfma_f32_16x16x32_bf16 v[36:39], v[128:131], a[180:183], v[36:39]
    s_waitcnt vmcnt(13)
    s_barrier
    v_mfma_f32_16x16x32_bf16 v[36:39], v[132:135], a[188:191], v[36:39]
    ds_read_b128 v[104:107], v14 offset:0
    v_mfma_f32_16x16x32_bf16 v[32:35], v[132:135], a[184:187], v[32:35]
    ds_read_b128 v[108:111], v14 offset:4096
    v_mfma_f32_16x16x32_bf16 v[32:35], v[128:131], a[176:179], v[32:35]
    ds_read_b128 v[112:115], v14 offset:8192
    v_mfma_f32_16x16x32_bf16 v[32:35], v[124:127], a[168:171], v[32:35]
    ds_read_b128 v[116:119], v14 offset:12288
    v_mfma_f32_16x16x32_bf16 v[32:35], v[120:123], a[160:163], v[32:35]
    s_waitcnt lgkmcnt(2)
    v_mfma_f32_16x16x32_bf16 v[40:43], v[104:107], a[160:163], v[40:43]
    s_add_u32 m0, s73, 146944
    v_mfma_f32_16x16x32_bf16 v[40:43], v[108:111], a[168:171], v[40:43]
    buffer_load_dwordx4 v21, s[44:47], s18 offen offset:512 sc1 lds
    s_waitcnt lgkmcnt(0)
    v_mfma_f32_16x16x32_bf16 v[40:43], v[112:115], a[176:179], v[40:43]
    ds_read_b128 v[120:123], v14 offset:1024
    v_mfma_f32_16x16x32_bf16 v[40:43], v[116:119], a[184:187], v[40:43]
    ds_read_b128 v[124:127], v14 offset:5120
    v_mfma_f32_16x16x32_bf16 v[44:47], v[116:119], a[188:191], v[44:47]
    ds_read_b128 v[128:131], v14 offset:9216
    v_mfma_f32_16x16x32_bf16 v[44:47], v[112:115], a[180:183], v[44:47]
    ds_read_b128 v[132:135], v14 offset:13312
    v_mfma_f32_16x16x32_bf16 v[44:47], v[108:111], a[172:175], v[44:47]
    s_add_u32 m0, s73, 148480
    v_mfma_f32_16x16x32_bf16 v[44:47], v[104:107], a[164:167], v[44:47]
    buffer_load_dwordx4 v21, s[44:47], s19 offen offset:0 sc1 lds
    s_waitcnt lgkmcnt(2)
    v_mfma_f32_16x16x32_bf16 v[52:55], v[120:123], a[164:167], v[52:55]
    s_add_u32 m0, s73, 148992
    buffer_load_dwordx2 v[142:143], v253, s[56:59], 0 offen
    v_mfma_f32_16x16x32_bf16 v[52:55], v[124:127], a[172:175], v[52:55]
    buffer_load_dwordx4 v21, s[44:47], s19 offen offset:512 sc1 lds
    s_waitcnt lgkmcnt(0)
    v_mfma_f32_16x16x32_bf16 v[52:55], v[128:131], a[180:183], v[52:55]
    ds_read_b128 v[104:107], v14 offset:2048
    v_mfma_f32_16x16x32_bf16 v[52:55], v[132:135], a[188:191], v[52:55]
    ds_read_b128 v[108:111], v14 offset:6144
    v_mfma_f32_16x16x32_bf16 v[48:51], v[132:135], a[184:187], v[48:51]
    ds_read_b128 v[112:115], v14 offset:10240
    v_mfma_f32_16x16x32_bf16 v[48:51], v[128:131], a[176:179], v[48:51]
    ds_read_b128 v[116:119], v14 offset:14336
    v_mfma_f32_16x16x32_bf16 v[48:51], v[124:127], a[168:171], v[48:51]
    s_add_u32 m0, s73, 150528
    v_mfma_f32_16x16x32_bf16 v[48:51], v[120:123], a[160:163], v[48:51]
    buffer_load_dwordx4 v21, s[44:47], s20 offen offset:0 sc1 lds
    s_waitcnt lgkmcnt(2)
    v_mfma_f32_16x16x32_bf16 v[32:35], v[104:107], a[192:195], v[32:35]
    v_mfma_f32_16x16x32_bf16 v[32:35], v[108:111], a[200:203], v[32:35]
    s_waitcnt vmcnt(11)
    s_waitcnt lgkmcnt(0)
    v_mfma_f32_16x16x32_bf16 v[32:35], v[112:115], a[208:211], v[32:35]
    ds_read_b128 v[120:123], v14 offset:3072
    v_mfma_f32_16x16x32_bf16 v[32:35], v[116:119], a[216:219], v[32:35]
    ds_read_b128 v[124:127], v14 offset:7168
    v_mfma_f32_16x16x32_bf16 v[36:39], v[116:119], a[220:223], v[36:39]
    ds_read_b128 v[128:131], v14 offset:11264
    v_lshlrev_b32 v72, 16, v102
    v_mfma_f32_16x16x32_bf16 v[36:39], v[112:115], a[212:215], v[36:39]
    ds_read_b128 v[132:135], v14 offset:15360
    v_mfma_f32_16x16x32_bf16 v[36:39], v[108:111], a[204:207], v[36:39]
    v_lshlrev_b32 v73, 16, v102
    v_mfma_f32_16x16x32_bf16 v[36:39], v[104:107], a[196:199], v[36:39]
    buffer_load_dwordx2 v[96:97], v26, s[44:47], s42 offen offset:0 sc1
    s_waitcnt lgkmcnt(2)
    v_mfma_f32_16x16x32_bf16 v[44:47], v[120:123], a[196:199], v[44:47]
    v_mfma_f32_16x16x32_bf16 v[44:47], v[124:127], a[204:207], v[44:47]
    v_lshlrev_b32 v74, 16, v102
    s_waitcnt lgkmcnt(0)
    v_mfma_f32_16x16x32_bf16 v[44:47], v[128:131], a[212:215], v[44:47]
    s_barrier
    v_mfma_f32_16x16x32_bf16 v[44:47], v[132:135], a[220:223], v[44:47]
    ds_read_b128 v[104:107], v14 offset:16384
    v_mfma_f32_16x16x32_bf16 v[40:43], v[132:135], a[216:219], v[40:43]
    ds_read_b128 v[108:111], v14 offset:20480
    v_lshlrev_b32 v75, 16, v102
    v_mfma_f32_16x16x32_bf16 v[40:43], v[128:131], a[208:211], v[40:43]
    ds_read_b128 v[112:115], v14 offset:24576
    v_mfma_f32_16x16x32_bf16 v[40:43], v[124:127], a[200:203], v[40:43]
    ds_read_b128 v[116:119], v14 offset:28672
    v_lshlrev_b32 v76, 16, v103
    v_mfma_f32_16x16x32_bf16 v[40:43], v[120:123], a[192:195], v[40:43]
    s_waitcnt lgkmcnt(2)
    v_mfma_f32_16x16x32_bf16 v[48:51], v[104:107], a[192:195], v[48:51]
L_pl_X_7:
    s_cbranch_execz L_wret
    s_add_u32 m0, s73, 97792
    v_lshlrev_b32 v77, 16, v103
    v_mfma_f32_16x16x32_bf16 v[48:51], v[108:111], a[200:203], v[48:51]
    buffer_load_dwordx4 v21, s[44:47], s20 offen offset:512 sc1 lds
    s_waitcnt lgkmcnt(0)
    v_mfma_f32_16x16x32_bf16 v[48:51], v[112:115], a[208:211], v[48:51]
    ds_read_b128 v[120:123], v14 offset:17408
    v_mfma_f32_16x16x32_bf16 v[48:51], v[116:119], a[216:219], v[48:51]
    ds_read_b128 v[124:127], v14 offset:21504
    v_mfma_f32_16x16x32_bf16 v[52:55], v[116:119], a[220:223], v[52:55]
    ds_read_b128 v[128:131], v14 offset:25600
    v_lshlrev_b32 v78, 16, v103
    v_mfma_f32_16x16x32_bf16 v[52:55], v[112:115], a[212:215], v[52:55]
    ds_read_b128 v[132:135], v14 offset:29696
    v_mfma_f32_16x16x32_bf16 v[52:55], v[108:111], a[204:207], v[52:55]
    s_add_u32 m0, s73, 99328
    v_lshlrev_b32 v79, 16, v103
    v_mfma_f32_16x16x32_bf16 v[52:55], v[104:107], a[196:199], v[52:55]
    buffer_load_dwordx4 v21, s[44:47], s21 offen offset:0 sc1 lds
    s_waitcnt lgkmcnt(2)
    v_mfma_f32_16x16x32_bf16 v[36:39], v[120:123], a[228:231], v[36:39]
    buffer_load_dwordx2 v[98:99], v26, s[44:47], s42 offen offset:128 sc1
    s_add_u32 m0, s73, 99840
    v_lshlrev_b32 v80, 16, v102
    v_mfma_f32_16x16x32_bf16 v[36:39], v[124:127], a[236:239], v[36:39]
    buffer_load_dwordx4 v21, s[44:47], s21 offen offset:512 sc1 lds
    s_waitcnt lgkmcnt(0)
    v_mfma_f32_16x16x32_bf16 v[36:39], v[128:131], a[244:247], v[36:39]
    ds_read_b128 v[104:107], v14 offset:18432
    v_mfma_f32_16x16x32_bf16 v[36:39], v[132:135], a[252:255], v[36:39]
    ds_read_b128 v[108:111], v14 offset:22528
    v_mfma_f32_16x16x32_bf16 v[32:35], v[132:135], a[248:251], v[32:35]
    ds_read_b128 v[112:115], v14 offset:26624
    v_lshlrev_b32 v81, 16, v102
    v_mfma_f32_16x16x32_bf16 v[32:35], v[128:131], a[240:243], v[32:35]
    ds_read_b128 v[116:119], v14 offset:30720
    v_mfma_f32_16x16x32_bf16 v[32:35], v[124:127], a[232:235], v[32:35]
    s_add_u32 m0, s73, 101376
    v_lshlrev_b32 v82, 16, v102
    v_mfma_f32_16x16x32_bf16 v[32:35], v[120:123], a[224:227], v[32:35]
    buffer_load_dwordx4 v21, s[44:47], s22 offen offset:0 sc1 lds
    s_waitcnt lgkmcnt(2)
    v_mfma_f32_16x16x32_bf16 v[40:43], v[104:107], a[224:227], v[40:43]
    v_mfma_f32_16x16x32_bf16 v[40:43], v[108:111], a[232:235], v[40:43]
    v_lshlrev_b32 v83, 16, v102
    s_waitcnt lgkmcnt(0)
    v_mfma_f32_16x16x32_bf16 v[40:43], v[112:115], a[240:243], v[40:43]
    ds_read_b128 v[120:123], v14 offset:19456
    v_mfma_f32_16x16x32_bf16 v[40:43], v[116:119], a[248:251], v[40:43]
    ds_read_b128 v[124:127], v14 offset:23552
    v_mfma_f32_16x16x32_bf16 v[44:47], v[116:119], a[252:255], v[44:47]
    ds_read_b128 v[128:131], v14 offset:27648
    v_lshlrev_b32 v84, 16, v103
    v_mfma_f32_16x16x32_bf16 v[44:47], v[112:115], a[244:247], v[44:47]
    ds_read_b128 v[132:135], v14 offset:31744
    v_mfma_f32_16x16x32_bf16 v[44:47], v[108:111], a[236:239], v[44:47]
    v_lshlrev_b32 v85, 16, v103
    v_mfma_f32_16x16x32_bf16 v[44:47], v[104:107], a[228:231], v[44:47]
    buffer_load_dwordx2 v[100:101], v18, s[44:47], s42 offen offset:0 sc1
    s_waitcnt lgkmcnt(2)
    v_mfma_f32_16x16x32_bf16 v[52:55], v[120:123], a[228:231], v[52:55]
    v_mfma_f32_16x16x32_bf16 v[52:55], v[124:127], a[236:239], v[52:55]
    v_lshlrev_b32 v86, 16, v103
    s_waitcnt lgkmcnt(0)
    v_mfma_f32_16x16x32_bf16 v[52:55], v[128:131], a[244:247], v[52:55]
    s_waitcnt vmcnt(13)
    s_barrier
    v_mfma_f32_16x16x32_bf16 v[52:55], v[132:135], a[252:255], v[52:55]
    ds_read_b128 v[104:107], v14 offset:32768
    v_lshlrev_b32 v87, 16, v103
    v_mfma_f32_16x16x32_bf16 v[48:51], v[132:135], a[248:251], v[48:51]
    ds_read_b128 v[108:111], v14 offset:36864
    v_add_u32 v10, 65536, v10
    v_mfma_f32_16x16x32_bf16 v[48:51], v[128:131], a[240:243], v[48:51]
    ds_read_b128 v[112:115], v14 offset:40960
    v_mfma_f32_16x16x32_bf16 v[48:51], v[124:127], a[232:235], v[48:51]
    ds_read_b128 v[116:119], v14 offset:45056
    v_add_u32 v11, 65536, v11
    v_mfma_f32_16x16x32_bf16 v[48:51], v[120:123], a[224:227], v[48:51]
    v_lshlrev_b32 v27, 16, v27
    s_branch L_Dc
L_idle:
    s_waitcnt vmcnt(0)
    s_barrier
    s_mov_b64 exec, 0
    s_call_b64 s[82:83], L_wc_D
    s_mov_b64 exec, -1
    s_mov_b32 s60, s36
    s_and_b32 s61, s37, 0xffff
    s_mov_b32 s62, 4096
    s_mov_b32 s63, 0x20000
    v_and_b32 v24, 15, v2
    s_lshl_b32 s7, s71, 6
    v_add_u32 v24, s7, v24
    s_and_b32 s8, s3, 1
    s_lshl_b32 s4, s8, 5
    v_add_u32 v25, s4, v24
    v_lshlrev_b32 v26, 3, v25
    v_mul_u32_u24 v25, 1152, v25
    v_bfe_u32 v31, v2, 4, 1
    v_lshl_add_u32 v25, v31, 5, v25
    v_lshrrev_b32 v31, 5, v2
    v_lshl_add_u32 v25, v31, 4, v25
    s_bfe_u32 s7, s2, 0x20003
    s_mul_i32 s7, s7, 288
    s_lshl_b32 s4, s72, 6
    s_add_u32 s4, s4, s7
    v_add_u32 v252, s4, v25
    s_xor_b32 s8, s3, s72
    s_and_b32 s4, s72, 1
    s_lshl1_add_u32 s4, s4, s8
    v_lshl_add_u32 v24, s4, 4, v24
    s_add_u32 s7, s7, 256
    s_cmp_lt_u32 s8, 2
    s_cselect_b32 s7, s7, 0x40000000
    v_lshlrev_b32 v18, 3, v24
    v_mul_u32_u24 v24, 1152, v24
    v_lshrrev_b32 v31, 4, v2
    v_lshl_add_u32 v24, v31, 3, v24
    v_add_u32 v253, s7, v24
    v_lshrrev_b32 v24, 3, v2
    v_and_b32 v25, 7, v2
    v_bfe_u32 v31, v2, 4, 2
    v_lshlrev_b32 v31, 1, v31
    v_xor_b32 v25, v25, v31
    v_lshlrev_b32 v24, 12, v24
    v_lshl_add_u32 v24, v25, 4, v24
    s_mul_i32 s7, s72, 36
    s_bitcmp1_b32 s3, 0
    s_addc_u32 s7, s7, 0
    s_lshl_b32 s7, s7, 17
    s_lshl_b32 s8, s71, 7
    s_add_u32 s7, s7, s8
    v_add_u32 v4, s7, v24
    v_add_u32 v5, 31744, v4
    v_add_u32 v6, 31744, v5
    v_add_u32 v7, 31744, v6
    v_lshrrev_b32 v24, 2, v2
    v_lshlrev_b32 v24, 7, v24
    v_and_b32 v25, 3, v2
    v_lshl_add_u32 v24, v25, 3, v24
    s_and_b32 s7, s73, 8192
    v_add_u32 v24, s7, v24
    v_bfe_u32 v31, v2, 3, 2
    s_and_b32 s7, s3, 1
    s_lshl_b32 s7, s7, 1
    v_xor_b32 v31, s7, v31
    v_lshl_add_u32 v10, v31, 5, v24
    v_xor_b32 v11, 32, v10
    v_and_b32 v24, 15, v2
    v_lshrrev_b32 v25, 4, v2
    v_mul_u32_u24 v25, 17408, v25
    v_lshl_add_u32 v24, v24, 4, v25
    s_mul_i32 s7, s72, 36
    s_and_b32 s8, s3, 1
    s_add_u32 s7, s7, s8
    s_mul_i32 s7, s7, 69632
    s_bfe_u32 s8, s2, 0x20003
    s_lshl_b32 s8, s8, 12
    s_add_u32 s7, s7, s8
    s_add_u32 s7, s7, 12795904
    v_add_u32 v23, s7, v24
    s_xor_b32 s7, s72, 0
    v_lshl_add_u32 v19, s7, 10, v23
    s_xor_b32 s7, s72, 1
    v_lshl_add_u32 v20, s7, 10, v23
    s_xor_b32 s7, s72, 2
    v_lshl_add_u32 v21, s7, 10, v23
    s_xor_b32 s7, s72, 3
    v_lshl_add_u32 v22, s7, 10, v23
    v_lshlrev_b32 v14, 4, v2
    v_add_u32 v14, 98304, v14
    v_add_u32 v1, 0x10000, v14
    s_bitcmp1_b32 s3, 1
    s_cselect_b32 s18, s85, s84
    s_mul_i32 s18, s18, 139264
    s_cselect_b32 s19, s87, s86
    s_mul_i32 s19, s19, 139264
    s_cselect_b32 s20, s89, s88
    s_mul_i32 s20, s20, 139264
    s_cselect_b32 s21, s91, s90
    s_mul_i32 s21, s21, 139264
    s_cselect_b32 s22, s93, s92
    s_mul_i32 s22, s22, 139264
    s_cselect_b32 s23, s95, s94
    s_mul_i32 s23, s23, 139264
    s_cselect_b32 s24, s97, s96
    s_mul_i32 s24, s24, 139264
    s_cselect_b32 s25, s99, s98
    s_mul_i32 s25, s25, 139264
    s_cselect_b32 s26, s101, s100
    s_mul_i32 s26, s26, 139264
    s_sub_u32 s4, s75, 252
    s_mul_i32 s4, s4, 1152
    s_mul_i32 s5, s3, 64
    s_add_u32 s4, s4, s5
    s_add_u32 s4, s4, 896
    s_lshl_b32 s4, s4, 12
    s_add_u32 s4, s4, 384
    v_lshlrev_b32 v24, 10, v2
    buffer_load_dword v255, v24, s[52:55], s4 offen
    s_add_u32 s4, s4, 65536
    buffer_load_dword v255, v24, s[52:55], s4 offen
    s_add_u32 s4, s4, 65536
    buffer_load_dword v255, v24, s[52:55], s4 offen
    s_add_u32 s4, s4, 65536
    buffer_load_dword v255, v24, s[52:55], s4 offen
    s_add_u32 s4, s4, 65536
    s_add_u32 m0, s73, 32768
    s_lshl_b32 s14, s84, 18
    buffer_load_dwordx4 v4, s[52:55], s14 offen offset:0 lds
    buffer_load_dwordx4 v5, s[52:55], s14 offen offset:1024 lds
    buffer_load_dwordx4 v6, s[52:55], s14 offen offset:2048 lds
    buffer_load_dwordx4 v7, s[52:55], s14 offen offset:3072 lds
    s_add_u32 m0, s73, 49152
    s_lshl_b32 s14, s85, 18
    buffer_load_dwordx4 v4, s[52:55], s14 offen offset:0 lds
    buffer_load_dwordx4 v5, s[52:55], s14 offen offset:1024 lds
    buffer_load_dwordx4 v6, s[52:55], s14 offen offset:2048 lds
    buffer_load_dwordx4 v7, s[52:55], s14 offen offset:3072 lds
    s_add_u32 m0, s73, 65536
    s_lshl_b32 s14, s86, 18
    buffer_load_dwordx4 v4, s[52:55], s14 offen offset:0 lds
    buffer_load_dwordx4 v5, s[52:55], s14 offen offset:1024 lds
    buffer_load_dwordx4 v6, s[52:55], s14 offen offset:2048 lds
    buffer_load_dwordx4 v7, s[52:55], s14 offen offset:3072 lds
    s_add_u32 m0, s73, 81920
    s_lshl_b32 s14, s87, 18
    buffer_load_dwordx4 v4, s[52:55], s14 offen offset:0 lds
    buffer_load_dwordx4 v5, s[52:55], s14 offen offset:1024 lds
    buffer_load_dwordx4 v6, s[52:55], s14 offen offset:2048 lds
    buffer_load_dwordx4 v7, s[52:55], s14 offen offset:3072 lds
    s_add_u32 m0, s73, 98304
    s_lshl_b32 s14, s88, 18
    buffer_load_dwordx4 v4, s[52:55], s14 offen offset:0 lds
    buffer_load_dwordx4 v5, s[52:55], s14 offen offset:1024 lds
    buffer_load_dwordx4 v6, s[52:55], s14 offen offset:2048 lds
    buffer_load_dwordx4 v7, s[52:55], s14 offen offset:3072 lds
    s_add_u32 m0, s73, 114688
    s_lshl_b32 s14, s89, 18
    buffer_load_dwordx4 v4, s[52:55], s14 offen offset:0 lds
    buffer_load_dwordx4 v5, s[52:55], s14 offen offset:1024 lds
    buffer_load_dwordx4 v6, s[52:55], s14 offen offset:2048 lds
    buffer_load_dwordx4 v7, s[52:55], s14 offen offset:3072 lds
    s_add_u32 m0, s73, 131072
    s_lshl_b32 s14, s90, 18
    buffer_load_dwordx4 v4, s[52:55], s14 offen offset:0 lds
    buffer_load_dwordx4 v5, s[52:55], s14 offen offset:1024 lds
    buffer_load_dwordx4 v6, s[52:55], s14 offen offset:2048 lds
    buffer_load_dwordx4 v7, s[52:55], s14 offen offset:3072 lds
    s_add_u32 m0, s73, 147456
    s_lshl_b32 s14, s91, 18
    buffer_load_dwordx4 v4, s[52:55], s14 offen offset:0 lds
    buffer_load_dwordx4 v5, s[52:55], s14 offen offset:1024 lds
    buffer_load_dwordx4 v6, s[52:55], s14 offen offset:2048 lds
    buffer_load_dwordx4 v7, s[52:55], s14 offen offset:3072 lds
    s_waitcnt vmcnt(28)
    s_barrier
    ds_read_b64_tr_b16 a[0:1], v10 offset:32768
    ds_read_b64_tr_b16 a[2:3], v10 offset:34816
    ds_read_b64_tr_b16 a[8:9], v10 offset:36864
    ds_read_b64_tr_b16 a[10:11], v10 offset:38912
    ds_read_b64_tr_b16 a[4:5], v11 offset:32768
    ds_read_b64_tr_b16 a[6:7], v11 offset:34816
    ds_read_b64_tr_b16 a[12:13], v11 offset:36864
    ds_read_b64_tr_b16 a[14:15], v11 offset:38912
    s_waitcnt vmcnt(24) lgkmcnt(0)
    s_barrier
    ds_read_b64_tr_b16 a[16:17], v10 offset:49152
    s_add_u32 m0, s73, 32768
    s_lshl_b32 s14, s92, 18
    ds_read_b64_tr_b16 a[18:19], v10 offset:51200
    buffer_load_dwordx4 v4, s[52:55], s14 offen offset:0 lds
    ds_read_b64_tr_b16 a[24:25], v10 offset:53248
    ds_read_b64_tr_b16 a[26:27], v10 offset:55296
    buffer_load_dwordx4 v5, s[52:55], s14 offen offset:1024 lds
    ds_read_b64_tr_b16 a[20:21], v11 offset:49152
    buffer_load_dwordx4 v6, s[52:55], s14 offen offset:2048 lds
    ds_read_b64_tr_b16 a[22:23], v11 offset:51200
    ds_read_b64_tr_b16 a[28:29], v11 offset:53248
    buffer_load_dwordx4 v7, s[52:55], s14 offen offset:3072 lds
    ds_read_b64_tr_b16 a[30:31], v11 offset:55296
    s_waitcnt vmcnt(24) lgkmcnt(0)
    s_barrier
    v_add_u32 v10, 65536, v10
    ds_read_b64_tr_b16 a[32:33], v10 offset:0
    s_add_u32 m0, s73, 49152
    s_lshl_b32 s14, s93, 18
    ds_read_b64_tr_b16 a[34:35], v10 offset:2048
    buffer_load_dwordx4 v4, s[52:55], s14 offen offset:0 lds
    ds_read_b64_tr_b16 a[40:41], v10 offset:4096
    ds_read_b64_tr_b16 a[42:43], v10 offset:6144
    buffer_load_dwordx4 v5, s[52:55], s14 offen offset:1024 lds
    v_add_u32 v11, 65536, v11
    ds_read_b64_tr_b16 a[36:37], v11 offset:0
    buffer_load_dwordx4 v6, s[52:55], s14 offen offset:2048 lds
    ds_read_b64_tr_b16 a[38:39], v11 offset:2048
    ds_read_b64_tr_b16 a[44:45], v11 offset:4096
    buffer_load_dwordx4 v7, s[52:55], s14 offen offset:3072 lds
    ds_read_b64_tr_b16 a[46:47], v11 offset:6144
    s_waitcnt vmcnt(24) lgkmcnt(0)
    s_barrier
    ds_read_b64_tr_b16 a[48:49], v10 offset:16384
    s_add_u32 m0, s73, 65536
    s_lshl_b32 s14, s94, 18
    ds_read_b64_tr_b16 a[50:51], v10 offset:18432
    buffer_load_dwordx4 v4, s[52:55], s14 offen offset:0 lds
    ds_read_b64_tr_b16 a[56:57], v10 offset:20480
    ds_read_b64_tr_b16 a[58:59], v10 offset:22528
    buffer_load_dwordx4 v5, s[52:55], s14 offen offset:1024 lds
    ds_read_b64_tr_b16 a[52:53], v11 offset:16384
    buffer_load_dwordx4 v6, s[52:55], s14 offen offset:2048 lds
    ds_read_b64_tr_b16 a[54:55], v11 offset:18432
    ds_read_b64_tr_b16 a[60:61], v11 offset:20480
    buffer_load_dwordx4 v7, s[52:55], s14 offen offset:3072 lds
    ds_read_b64_tr_b16 a[62:63], v11 offset:22528
    s_waitcnt vmcnt(24) lgkmcnt(0)
    s_barrier
    ds_read_b64_tr_b16 a[64:65], v10 offset:32768
    s_add_u32 m0, s73, 81920
    s_lshl_b32 s14, s95, 18
    ds_read_b64_tr_b16 a[66:67], v10 offset:34816
    buffer_load_dwordx4 v4, s[52:55], s14 offen offset:0 lds
    ds_read_b64_tr_b16 a[72:73], v10 offset:36864
    ds_read_b64_tr_b16 a[74:75], v10 offset:38912
    buffer_load_dwordx4 v5, s[52:55], s14 offen offset:1024 lds
    ds_read_b64_tr_b16 a[68:69], v11 offset:32768
    buffer_load_dwordx4 v6, s[52:55], s14 offen offset:2048 lds
    ds_read_b64_tr_b16 a[70:71], v11 offset:34816
    ds_read_b64_tr_b16 a[76:77], v11 offset:36864
    buffer_load_dwordx4 v7, s[52:55], s14 offen offset:3072 lds
    ds_read_b64_tr_b16 a[78:79], v11 offset:38912
    s_waitcnt vmcnt(24) lgkmcnt(0)
    s_barrier
    ds_read_b64_tr_b16 a[80:81], v10 offset:49152
    s_add_u32 m0, s73, 98304
    s_lshl_b32 s14, s96, 18
    ds_read_b64_tr_b16 a[82:83], v10 offset:51200
    buffer_load_dwordx4 v4, s[52:55], s14 offen offset:0 lds
    ds_read_b64_tr_b16 a[88:89], v10 offset:53248
    ds_read_b64_tr_b16 a[90:91], v10 offset:55296
    buffer_load_dwordx4 v5, s[52:55], s14 offen offset:1024 lds
    ds_read_b64_tr_b16 a[84:85], v11 offset:49152
    buffer_load_dwordx4 v6, s[52:55], s14 offen offset:2048 lds
    ds_read_b64_tr_b16 a[86:87], v11 offset:51200
    ds_read_b64_tr_b16 a[92:93], v11 offset:53248
    buffer_load_dwordx4 v7, s[52:55], s14 offen offset:3072 lds
    ds_read_b64_tr_b16 a[94:95], v11 offset:55296
    s_waitcnt vmcnt(24) lgkmcnt(0)
    s_barrier
    v_add_u32 v10, 65536, v10
    ds_read_b64_tr_b16 a[96:97], v10 offset:0
    s_add_u32 m0, s73, 114688
    s_lshl_b32 s14, s97, 18
    ds_read_b64_tr_b16 a[98:99], v10 offset:2048
    buffer_load_dwordx4 v4, s[52:55], s14 offen offset:0 lds
    ds_read_b64_tr_b16 a[104:105], v10 offset:4096
    ds_read_b64_tr_b16 a[106:107], v10 offset:6144
    buffer_load_dwordx4 v5, s[52:55], s14 offen offset:1024 lds
    v_add_u32 v11, 65536, v11
    ds_read_b64_tr_b16 a[100:101], v11 offset:0
    buffer_load_dwordx4 v6, s[52:55], s14 offen offset:2048 lds
    ds_read_b64_tr_b16 a[102:103], v11 offset:2048
    ds_read_b64_tr_b16 a[108:109], v11 offset:4096
    buffer_load_dwordx4 v7, s[52:55], s14 offen offset:3072 lds
    ds_read_b64_tr_b16 a[110:111], v11 offset:6144
    s_waitcnt vmcnt(24) lgkmcnt(0)
    s_barrier
    ds_read_b64_tr_b16 a[112:113], v10 offset:16384
    s_add_u32 m0, s73, 131072
    s_lshl_b32 s14, s98, 18
    ds_read_b64_tr_b16 a[114:115], v10 offset:18432
    buffer_load_dwordx4 v4, s[52:55], s14 offen offset:0 lds
    ds_read_b64_tr_b16 a[120:121], v10 offset:20480
    ds_read_b64_tr_b16 a[122:123], v10 offset:22528
    buffer_load_dwordx4 v5, s[52:55], s14 offen offset:1024 lds
    ds_read_b64_tr_b16 a[116:117], v11 offset:16384
    buffer_load_dwordx4 v6, s[52:55], s14 offen offset:2048 lds
    ds_read_b64_tr_b16 a[118:119], v11 offset:18432
    ds_read_b64_tr_b16 a[124:125], v11 offset:20480
    buffer_load_dwordx4 v7, s[52:55], s14 offen offset:3072 lds
    ds_read_b64_tr_b16 a[126:127], v11 offset:22528
    s_waitcnt vmcnt(24) lgkmcnt(0)
    s_barrier
    v_add_u32 v10, -131072, v10
    ds_read_b64_tr_b16 a[128:129], v10 offset:32768
    s_add_u32 m0, s73, 147456
    s_lshl_b32 s14, s99, 18
    ds_read_b64_tr_b16 a[130:131], v10 offset:34816
    buffer_load_dwordx4 v4, s[52:55], s14 offen offset:0 lds
    ds_read_b64_tr_b16 a[136:137], v10 offset:36864
    ds_read_b64_tr_b16 a[138:139], v10 offset:38912
    buffer_load_dwordx4 v5, s[52:55], s14 offen offset:1024 lds
    v_add_u32 v11, -131072, v11
    ds_read_b64_tr_b16 a[132:133], v11 offset:32768
    buffer_load_dwordx4 v6, s[52:55], s14 offen offset:2048 lds
    ds_read_b64_tr_b16 a[134:135], v11 offset:34816
    ds_read_b64_tr_b16 a[140:141], v11 offset:36864
    buffer_load_dwordx4 v7, s[52:55], s14 offen offset:3072 lds
    ds_read_b64_tr_b16 a[142:143], v11 offset:38912
    s_waitcnt vmcnt(24) lgkmcnt(0)
    s_barrier
    ds_read_b64_tr_b16 a[144:145], v10 offset:49152
    s_add_u32 m0, s73, 0
    s_lshl_b32 s14, s100, 18
    ds_read_b64_tr_b16 a[146:147], v10 offset:51200
    buffer_load_dwordx4 v4, s[52:55], s14 offen offset:0 lds
    ds_read_b64_tr_b16 a[152:153], v10 offset:53248
    ds_read_b64_tr_b16 a[154:155], v10 offset:55296
    buffer_load_dwordx4 v5, s[52:55], s14 offen offset:1024 lds
    ds_read_b64_tr_b16 a[148:149], v11 offset:49152
    buffer_load_dwordx4 v6, s[52:55], s14 offen offset:2048 lds
    ds_read_b64_tr_b16 a[150:151], v11 offset:51200
    ds_read_b64_tr_b16 a[156:157], v11 offset:53248
    buffer_load_dwordx4 v7, s[52:55], s14 offen offset:3072 lds
    ds_read_b64_tr_b16 a[158:159], v11 offset:55296
    s_waitcnt vmcnt(24) lgkmcnt(0)
    s_barrier
    v_add_u32 v10, 65536, v10
    ds_read_b64_tr_b16 a[160:161], v10 offset:0
    s_add_u32 m0, s73, 16384
    s_lshl_b32 s14, s101, 18
    ds_read_b64_tr_b16 a[162:163], v10 offset:2048
    buffer_load_dwordx4 v4, s[52:55], s14 offen offset:0 lds
    ds_read_b64_tr_b16 a[168:169], v10 offset:4096
    ds_read_b64_tr_b16 a[170:171], v10 offset:6144
    buffer_load_dwordx4 v5, s[52:55], s14 offen offset:1024 lds
    v_add_u32 v11, 65536, v11
    ds_read_b64_tr_b16 a[164:165], v11 offset:0
    buffer_load_dwordx4 v6, s[52:55], s14 offen offset:2048 lds
    ds_read_b64_tr_b16 a[166:167], v11 offset:2048
    ds_read_b64_tr_b16 a[172:173], v11 offset:4096
    buffer_load_dwordx4 v7, s[52:55], s14 offen offset:3072 lds
    ds_read_b64_tr_b16 a[174:175], v11 offset:6144
    s_waitcnt vmcnt(24) lgkmcnt(0)
    s_barrier
    ds_read_b64_tr_b16 a[176:177], v10 offset:16384
    ds_read_b64_tr_b16 a[178:179], v10 offset:18432
    ds_read_b64_tr_b16 a[184:185], v10 offset:20480
    ds_read_b64_tr_b16 a[186:187], v10 offset:22528
    ds_read_b64_tr_b16 a[180:181], v11 offset:16384
    ds_read_b64_tr_b16 a[182:183], v11 offset:18432
    ds_read_b64_tr_b16 a[188:189], v11 offset:20480
    ds_read_b64_tr_b16 a[190:191], v11 offset:22528
    s_waitcnt vmcnt(20) lgkmcnt(0)
    s_barrier
    ds_read_b64_tr_b16 a[192:193], v10 offset:32768
    ds_read_b64_tr_b16 a[194:195], v10 offset:34816
    ds_read_b64_tr_b16 a[200:201], v10 offset:36864
    ds_read_b64_tr_b16 a[202:203], v10 offset:38912
    ds_read_b64_tr_b16 a[196:197], v11 offset:32768
    ds_read_b64_tr_b16 a[198:199], v11 offset:34816
    ds_read_b64_tr_b16 a[204:205], v11 offset:36864
    ds_read_b64_tr_b16 a[206:207], v11 offset:38912
    s_waitcnt vmcnt(16) lgkmcnt(0)
    s_barrier
    ds_read_b64_tr_b16 a[208:209], v10 offset:49152
    ds_read_b64_tr_b16 a[210:211], v10 offset:51200
    ds_read_b64_tr_b16 a[216:217], v10 offset:53248
    ds_read_b64_tr_b16 a[218:219], v10 offset:55296
    ds_read_b64_tr_b16 a[212:213], v11 offset:49152
    ds_read_b64_tr_b16 a[214:215], v11 offset:51200
    ds_read_b64_tr_b16 a[220:221], v11 offset:53248
    ds_read_b64_tr_b16 a[222:223], v11 offset:55296
    s_waitcnt vmcnt(12) lgkmcnt(0)
    s_barrier
    v_add_u32 v10, 65536, v10
    ds_read_b64_tr_b16 a[224:225], v10 offset:0
    ds_read_b64_tr_b16 a[226:227], v10 offset:2048
    ds_read_b64_tr_b16 a[232:233], v10 offset:4096
    ds_read_b64_tr_b16 a[234:235], v10 offset:6144
    v_add_u32 v11, 65536, v11
    ds_read_b64_tr_b16 a[228:229], v11 offset:0
    ds_read_b64_tr_b16 a[230:231], v11 offset:2048
    ds_read_b64_tr_b16 a[236:237], v11 offset:4096
    ds_read_b64_tr_b16 a[238:239], v11 offset:6144
    s_waitcnt vmcnt(8) lgkmcnt(0)
    s_barrier
    ds_read_b64_tr_b16 a[240:241], v10 offset:16384
    ds_read_b64_tr_b16 a[242:243], v10 offset:18432
    ds_read_b64_tr_b16 a[248:249], v10 offset:20480
    ds_read_b64_tr_b16 a[250:251], v10 offset:22528
    ds_read_b64_tr_b16 a[244:245], v11 offset:16384
    ds_read_b64_tr_b16 a[246:247], v11 offset:18432
    ds_read_b64_tr_b16 a[252:253], v11 offset:20480
    ds_read_b64_tr_b16 a[254:255], v11 offset:22528
    s_waitcnt lgkmcnt(0)
    s_barrier
    v_add_u32 v10, -131072, v10
    v_add_u32 v11, -131072, v11
    s_mov_b64 exec, 0
    s_call_b64 s[82:83], L_wc_D
    s_mov_b64 exec, -1
    s_bfe_u32 s4, s2, 0x20003
    s_lshl2_add_u32 s4, s72, s4
    s_lshl_b32 s4, s4, 3
    s_lshr_b32 s5, s2, 4
    s_and_b32 s5, s5, 6
    s_add_u32 s4, s4, s5
    s_and_b32 s5, s2, 1
    s_add_u32 s4, s4, s5
    s_lshl_b32 s4, s4, 7
    s_add_u32 s4, s4, 12566528
    v_lshl_add_u32 v28, v2, 2, s4
    s_cmp_eq_u32 s3, 0
    s_cselect_b32 s4, 18, 0
    v_cmp_gt_u32 vcc, s4, v2
    v_mov_b32 v13, 0x40000000
    s_nop 0
    v_cndmask_b32 v28, v13, v28, vcc
    v_mov_b32 v13, s68
    v_cndmask_b32 v13, 0, v13, vcc
    s_mov_b32 s5, 0
L_iw:
    s_sleep 16
    v_mov_b32 v29, 0
    buffer_atomic_add v29, v28, s[44:47], 0 offen sc0 sc1
    s_waitcnt vmcnt(0)
    v_cmp_eq_u32 vcc, 0, v13
    s_nop 1
    s_mov_b64 s[6:7], vcc
    v_cmp_ne_u32 vcc, v13, v29
    s_nop 1
    s_andn2_b64 s[8:9], exec, vcc
    s_andn2_b64 s[8:9], s[8:9], s[6:7]
    s_cbranch_scc1 L_ix
    s_cmp_eq_u64 s[6:7], exec
    s_cbranch_scc1 L_ix
    s_add_u32 s5, s5, 1
    s_cmp_lt_u32 s5, 100000
    s_cbranch_scc1 L_iw
L_ix:
    v_mov_b32 v29, 0
    buffer_atomic_add v29, v28, s[44:47], 0 offen sc0 sc1
    s_branch L_DX
L_end:
.section .rodata,"a"
.p2align 6
.amdhsa_kernel recurrent_scan__ssm_conv_h3__mixer_token_mlp__prompt_kernel
  .amdhsa_next_free_vgpr 512
  .amdhsa_next_free_sgpr 102
  .amdhsa_accum_offset 256
  .amdhsa_group_segment_fixed_size 0
  .amdhsa_kernarg_size 112
  .amdhsa_user_sgpr_count 2
  .amdhsa_user_sgpr_kernarg_segment_ptr 1
  .amdhsa_system_sgpr_workgroup_id_x 1
  .amdhsa_float_denorm_mode_32 3
.end_amdhsa_kernel
```

```asm
; @launch grid=(256,1,1) block=(256,1,1) lds=163840
.amdgcn_target "amdgcn-amd-amdhsa--gfx950"
.text
.globl recurrent_scan__ssm_conv_h3__mixer_token_mlp__prompt_kernel
.p2align 8
.type recurrent_scan__ssm_conv_h3__mixer_token_mlp__prompt_kernel,@function
recurrent_scan__ssm_conv_h3__mixer_token_mlp__prompt_kernel:
    s_cmp_lt_u32 s2, 256
    s_cbranch_scc0 L_exit
    s_load_dwordx2 s[56:57], s[0:1], 0
    s_load_dwordx2 s[48:49], s[0:1], 8
    s_load_dwordx2 s[52:53], s[0:1], 16
    s_load_dwordx2 s[60:61], s[0:1], 24
    s_load_dwordx16 s[16:31], s[0:1], 0
    s_load_dwordx8 s[32:39], s[0:1], 64
    s_load_dwordx4 s[40:43], s[0:1], 96
    s_memrealtime s[12:13]
    v_lshrrev_b32 v1, 6, v0
    v_and_b32 v2, 63, v0
    s_getpc_b64 s[6:7]
L_pc:
    s_lshr_b32 s4, s2, 1
    s_and_b32 s4, s4, 124
    v_add_u32 v22, s4, v1
    v_lshl_add_u32 v22, v2, 7, v22
    v_lshlrev_b32 v22, 7, v22
    v_min_u32 v22, L_end-L_pc-4, v22
    s_mov_b64 exec, 31
    global_load_dword v255, v22, s[6:7]
    s_mov_b64 exec, -1
    v_readfirstlane_b32 s3, v1
    s_and_b32 s4, s2, 7
    s_lshr_b32 s5, s2, 3
    s_lshl_b32 s4, s4, 5
    s_add_u32 s68, s4, s5
    v_lshrrev_b32 v3, 5, v0
    v_and_b32 v4, 31, v0
    v_mul_u32_u24 v5, 1152, v3
    v_mad_u32_u24 v5, v4, 12, v5
    s_mul_i32 s15, s68, 9216
    s_mul_i32 s4, s3, 3072
    s_add_u32 s5, s4, s15
    s_sub_u32 s5, s5, 3456
    v_lshlrev_b32 v6, 4, v2
    v_add_u32 v7, s5, v6
    v_add_u32 v58, 1024, v7
    s_add_u32 s4, s4, 114688
    s_lshl_b32 s5, s3, 11
    s_add_u32 s11, s5, s15
    s_add_u32 s5, s5, 127360
    s_cmp_lt_u32 s2, 216
    s_cselect_b32 s9, 0, 106496
    s_sub_u32 s4, s4, s9
    s_sub_u32 s5, s5, s9
    s_mov_b32 m0, s4
    s_mov_b32 s58, 2359296
    s_mov_b32 s59, 0x20000
    s_mov_b32 s50, 2359296
    s_mov_b32 s51, 0x20000
    s_mov_b32 s54, 2359296
    s_mov_b32 s55, 0x20000
    s_mov_b32 s62, 4608
    s_mov_b32 s63, 0x20000
    v_lshlrev_b32 v59, 3, v0
    s_movk_i32 s10, 4096
    v_lshlrev_b32 v91, 3, v2
    v_or_b32 v22, s2, v0
    v_lshlrev_b32 v22, 8, v22
    s_mov_b32 s66, 256
    s_mov_b32 s67, 0x20000
    s_waitcnt lgkmcnt(0)
    buffer_load_dwordx3 v[8:10], v5, s[56:59], s15 offen offset:0
    buffer_load_dwordx3 v[12:14], v5, s[56:59], s15 offen offset:384
    buffer_load_dwordx3 v[16:18], v5, s[56:59], s15 offen offset:768
    s_mov_b32 s64, s40
    s_and_b32 s65, s41, 0xffff
    s_or_b32 s12, s12, 1
    v_mov_b32 v23, s12
    buffer_store_dword v23, v22, s[64:67], 0 offen sc1
    buffer_load_dwordx4 v7, s[48:51], 0 offen lds
    s_add_u32 m0, s4, 1024
    s_cmp_eq_u32 s3, 3
    buffer_load_dwordx4 v58, s[48:51], 0 offen lds
    buffer_load_dwordx4 v58, s[48:51], 0 offen offset:1024 lds
    s_cbranch_scc1 L_xld
L_nox:
    s_mov_b32 m0, s5
    buffer_load_dwordx2 v[98:99], v59, s[60:63], 0 offen
    buffer_load_dwordx4 v6, s[52:55], s11 offen lds
    buffer_load_dwordx4 v6, s[52:55], s11 offen offset:1024 lds
    buffer_load_dwordx2 v[100:101], v59, s[60:63], 0 offen offset:2048
    buffer_load_dwordx2 v[102:103], v59, s[60:63], s10 offen
    s_mov_b32 s44, s42
    s_and_b32 s45, s43, 0xffff
    s_mov_b32 s46, 42352640
    s_mov_b32 s47, 0x20000
    s_and_b32 s5, s2, 7
    s_lshr_b32 s6, s2, 3
    s_lshr_b32 s7, s6, 2
    s_lshr_b32 s8, s3, 1
    s_lshl1_add_u32 s9, s7, s8
    s_cmp_ge_u32 s9, 10
    s_addc_u32 s14, s9, 0
    s_cmp_ge_u32 s9, 3
    s_addc_u32 s14, s14, 0
    s_lshl3_add_u32 s8, s8, 3
    s_cmp_eq_u32 s7, 7
    s_cselect_b32 s14, s8, s14
    s_and_b32 s4, s5, 1
    s_lshl4_add_u32 s71, s4, s14
    s_lshr_b32 s13, s5, 1
    s_mov_b32 s72, s13
    s_lshl_b32 s73, s3, 12
    s_mov_b32 s52, s34
    s_and_b32 s53, s35, 0xffff
    s_mov_b32 s54, 18874368
    s_mov_b32 s55, 0x20000
    s_cmp_lt_u32 s6, 27
    s_cbranch_scc0 L_aux
    s_branch L_org
L_exit:
    s_endpgm
L_xld:
    s_mov_b64 exec, 0xffffff
    buffer_load_dwordx4 v58, s[48:51], 0 offen offset:2048 lds
    s_mov_b64 exec, -1
    s_mov_b32 m0, s5
    s_nop 0
    buffer_load_dwordx4 v6, s[52:55], s11 offen offset:2048 lds
    s_branch L_nox
L_nw_G:
    s_mov_b32 s5, 0
L_nl_G:
    buffer_load_dword v45, v54, s[64:67], 0 offen sc1
    s_waitcnt vmcnt(0)
    v_readfirstlane_b32 s68, v45
    s_nop 1
    s_cmp_lg_u32 s68, 0
    s_cbranch_scc1 L_ng_G
    s_add_u32 s5, s5, 1
    s_cmp_lt_u32 s5, 100000
    s_cbranch_scc1 L_nl_G
    s_branch L_ng_G
L_rs_p1G:
    s_mov_b32 s5, 0
L_rt_p1G:
    s_mov_b64 exec, vcc
    v_mov_b32 v29, 0
    buffer_atomic_add v29, v28, s[44:47], 0 offen sc0 sc1
    s_waitcnt vmcnt(0)
    v_cmp_ne_u32 vcc, v12, v29
    s_cbranch_vccz L_rx_p1G
    s_add_u32 s5, s5, 1
    s_cmp_lt_u32 s5, 100000
    s_cbranch_scc1 L_rt_p1G
L_rx_p1G:
    s_mov_b64 exec, -1
    s_branch L_ok_p1G
L_rs_p5:
    s_mov_b32 s5, 0
L_rt_p5:
    s_mov_b64 exec, vcc
    buffer_load_dword v29, v28, s[44:47], 0 offen sc1
    s_waitcnt vmcnt(0)
    v_cmp_ne_u32 vcc, s68, v29
    s_cbranch_vccz L_rx_p5
    s_add_u32 s5, s5, 1
    s_cmp_lt_u32 s5, 100000
    s_cbranch_scc1 L_rt_p5
L_rx_p5:
    s_mov_b64 exec, -1
    s_branch L_ok_p5
L_nw_X:
    s_mov_b32 s5, 0
L_nl_X:
    buffer_load_dword v45, v54, s[64:67], 0 offen sc1
    s_waitcnt vmcnt(0)
    v_readfirstlane_b32 s68, v45
    s_nop 1
    s_cmp_lg_u32 s68, 0
    s_cbranch_scc1 L_ng_X
    s_add_u32 s5, s5, 1
    s_cmp_lt_u32 s5, 100000
    s_cbranch_scc1 L_nl_X
    s_branch L_ng_X
L_rs_p1X:
    s_mov_b32 s5, 0
L_rt_p1X:
    s_mov_b64 exec, vcc
    v_mov_b32 v29, 0
    buffer_atomic_add v29, v28, s[44:47], 0 offen sc0 sc1
    s_waitcnt vmcnt(0)
    v_cmp_ne_u32 vcc, s68, v29
    s_cbranch_vccz L_rx_p1X
    s_add_u32 s5, s5, 1
    s_cmp_lt_u32 s5, 100000
    s_cbranch_scc1 L_rt_p1X
L_rx_p1X:
    s_mov_b64 exec, -1
    s_branch L_ok_p1X
L_rs_p2G:
    s_mov_b32 s5, 0
L_rt_p2G:
    s_mov_b64 exec, vcc
    v_mov_b32 v16, 0
    buffer_atomic_add v16, v15, s[44:47], 0 offen sc0 sc1
    s_waitcnt vmcnt(0)
    v_cmp_ne_u32 vcc, v13, v16
    s_cbranch_vccz L_rx_p2G
    s_add_u32 s5, s5, 1
    s_cmp_lt_u32 s5, 100000
    s_cbranch_scc1 L_rt_p2G
L_rx_p2G:
    s_mov_b64 exec, -1
    s_branch L_ok_p2G
L_xs_a:
    s_mov_b32 s5, 0
L_xt_a:
    v_mov_b32 v187, 0
    buffer_atomic_add v187, v137, s[44:47], 0 offen offset:12 sc0 sc1
    s_waitcnt vmcnt(0)
    v_cmp_ne_u32 vcc, v138, v187
    s_cbranch_vccz L_xr_a
    s_add_u32 s5, s5, 1
    s_cmp_lt_u32 s5, 100000
    s_cbranch_scc1 L_xt_a
L_xr_a:
    buffer_load_dwordx4 v[40:43], v136, s[44:47], s34 offen offset:0 sc1
    buffer_load_dwordx4 v[44:47], v136, s[44:47], s34 offen offset:1024 sc1
    buffer_load_dwordx4 v[48:51], v136, s[44:47], s34 offen offset:2048 sc1
    s_waitcnt vmcnt(0)
    v_bitop3_b32 v43, v43, v47, s68 bitop3:0x7e
    v_bitop3_b32 v43, v43, v51, s68 bitop3:0xf6
    v_cmp_ne_u32 vcc, 0, v43
    s_cbranch_vccz L_xo_a
    s_add_u32 s5, s5, 1
    s_cmp_lt_u32 s5, 100000
    s_cbranch_scc1 L_xt_a
    s_branch L_xo_a
L_as_b:
    s_mov_b32 s5, 0
L_at_b:
    v_mov_b32 v141, 0
    buffer_atomic_add v141, v139, s[44:47], s11 offen offset:2060 sc0 sc1
    s_waitcnt vmcnt(0)
    v_cmp_ne_u32 vcc, v140, v141
    s_cbranch_vccz L_ao_b
    s_add_u32 s5, s5, 1
    s_cmp_lt_u32 s5, 100000
    s_cbranch_scc1 L_at_b
    s_branch L_ao_b
L_xs_b:
    s_mov_b32 s5, 0
L_xt_b:
    buffer_load_dwordx4 v[56:59], v136, s[44:47], s11 offen offset:0 sc1
    buffer_load_dwordx4 v[60:63], v136, s[44:47], s11 offen offset:1024 sc1
    buffer_load_dwordx4 v[64:67], v136, s[44:47], s11 offen offset:2048 sc1
    s_waitcnt vmcnt(0)
    v_bitop3_b32 v59, v59, v63, s68 bitop3:0x7e
    v_bitop3_b32 v59, v59, v67, s68 bitop3:0xf6
    v_cmp_ne_u32 vcc, 0, v59
    s_cbranch_vccz L_xo_b
    s_add_u32 s5, s5, 1
    s_cmp_lt_u32 s5, 100000
    s_cbranch_scc1 L_xt_b
    s_branch L_xo_b
L_xs_z:
    s_mov_b32 s5, 0
L_xt_z:
    buffer_load_dwordx4 v[72:75], v136, s[44:47], s12 offen offset:0 sc1
    buffer_load_dwordx4 v[76:79], v136, s[44:47], s12 offen offset:1024 sc1
    buffer_load_dwordx4 v[80:83], v136, s[44:47], s12 offen offset:2048 sc1
    s_waitcnt vmcnt(0)
    v_bitop3_b32 v75, v75, v79, s68 bitop3:0x7e
    v_bitop3_b32 v75, v75, v83, s68 bitop3:0xf6
    v_cmp_ne_u32 vcc, 0, v75
    s_cbranch_vccz L_xo_z
    s_add_u32 s5, s5, 1
    s_cmp_lt_u32 s5, 100000
    s_cbranch_scc1 L_xt_z
    s_branch L_xo_z
L_rs_p3:
    s_mov_b32 s5, 0
L_rt_p3:
    s_mov_b64 exec, vcc
    buffer_load_dword v189, v188, s[44:47], 0 offen sc1
    s_waitcnt vmcnt(0)
    v_cmp_ne_u32 vcc, s68, v189
    s_cbranch_vccz L_rx_p3
    s_add_u32 s5, s5, 1
    s_cmp_lt_u32 s5, 100000
    s_cbranch_scc1 L_rt_p3
L_rx_p3:
    s_mov_b64 exec, -1
    s_branch L_ok_p3
L_xs_8:
    s_mov_b32 s5, 0
L_xt_8:
    v_mov_b32 v187, 0
    buffer_atomic_add v187, v137, s[44:47], 0 offen offset:12 sc0 sc1
    s_waitcnt vmcnt(0)
    v_cmp_ne_u32 vcc, v138, v187
    s_cbranch_vccz L_xr_8
    s_add_u32 s5, s5, 1
    s_cmp_lt_u32 s5, 100000
    s_cbranch_scc1 L_xt_8
L_xr_8:
    buffer_load_dwordx4 v[204:207], v136, s[44:47], s35 offen offset:0 sc1
    buffer_load_dwordx4 v[208:211], v136, s[44:47], s35 offen offset:1024 sc1
    buffer_load_dwordx4 v[212:215], v136, s[44:47], s35 offen offset:2048 sc1
    buffer_load_dwordx4 v[216:219], v136, s[44:47], s35 offen offset:3072 sc1
    s_waitcnt vmcnt(0)
    v_bitop3_b32 v207, v207, v211, s36 bitop3:0x7e
    v_bitop3_b32 v207, v207, v215, s36 bitop3:0xf6
    v_bitop3_b32 v207, v207, v219, s36 bitop3:0xf6
    v_cmp_ne_u32 vcc, 0, v207
    s_cbranch_vccz L_xo_8
    s_add_u32 s5, s5, 1
    s_cmp_lt_u32 s5, 100000
    s_cbranch_scc1 L_xt_8
    s_branch L_xo_8
L_rs_p2X:
    s_mov_b32 s5, 0
L_rt_p2X:
    s_mov_b64 exec, vcc
    v_mov_b32 v29, 0
    buffer_atomic_add v29, v28, s[44:47], 0 offen sc0 sc1
    s_waitcnt vmcnt(0)
    v_cmp_ne_u32 vcc, v13, v29
    s_cbranch_vccz L_rx_p2X
    s_add_u32 s5, s5, 1
    s_cmp_lt_u32 s5, 100000
    s_cbranch_scc1 L_rt_p2X
L_rx_p2X:
    s_mov_b64 exec, -1
    s_branch L_ok_p2X
L_wc_G:
    s_cmp_eq_u32 s3, 0
    s_cbranch_scc1 L_pl_G_0
    s_cmp_eq_u32 s3, 1
    s_cbranch_scc1 L_pl_G_1
    s_cmp_eq_u32 s3, 2
    s_cbranch_scc1 L_pl_G_2
    s_branch L_pl_G_3
L_wc_X:
    s_cmp_eq_u32 s3, 0
    s_cbranch_scc1 L_pl_X_0
    s_cmp_eq_u32 s3, 1
    s_cbranch_scc1 L_pl_X_1
    s_cmp_eq_u32 s3, 2
    s_cbranch_scc1 L_pl_X_2
    s_branch L_pl_X_3
L_wc_D:
    s_cmp_eq_u32 s3, 0
    s_cbranch_scc1 L_pl_D_0
    s_cmp_eq_u32 s3, 1
    s_cbranch_scc1 L_pl_D_1
    s_cmp_eq_u32 s3, 2
    s_cbranch_scc1 L_pl_D_2
    s_branch L_wret
L_wret:
    s_setpc_b64 s[82:83]
.p2align 12
L_org:
    s_mul_i32 s7, s6, 21846
    s_lshr_b32 s7, s7, 16
    s_mul_i32 s8, s7, 3
    s_sub_u32 s12, s6, s8
    s_mul_i32 s8, s13, 9
    s_add_u32 s69, s8, s7
    s_lshl1_add_u32 s70, s12, s4
    s_mul_i32 s8, s69, 6
    s_add_u32 s75, s8, s70
    s_mov_b32 s48, s30
    s_and_b32 s49, s31, 0xffff
    s_mov_b32 s50, 18874368
    s_mov_b32 s51, 0x20000
    s_add_u32 s12, s12, s7
    s_mul_i32 s8, s12, 21846
    s_lshr_b32 s8, s8, 16
    s_mul_i32 s8, s8, 3
    s_sub_u32 s12, s12, s8
    s_mul_i32 s4, s4, 16
    s_mul_i32 s7, s12, 65538
    s_lshr_b32 s7, s7, 16
    s_mul_i32 s7, s7, 1
    s_add_u32 s5, s4, 0
    s_add_u32 s18, s7, s5
    s_add_u32 s8, s5, 3
    s_add_u32 s19, s18, 1
    s_cmp_eq_u32 s19, s8
    s_cselect_b32 s19, s5, s19
    s_add_u32 s20, s19, 1
    s_cmp_eq_u32 s20, s8
    s_cselect_b32 s20, s5, s20
    s_mul_i32 s7, s12, 65538
    s_lshr_b32 s7, s7, 16
    s_mul_i32 s7, s7, 1
    s_add_u32 s5, s4, 3
    s_add_u32 s21, s7, s5
    s_add_u32 s8, s5, 3
    s_add_u32 s22, s21, 1
    s_cmp_eq_u32 s22, s8
    s_cselect_b32 s22, s5, s22
    s_add_u32 s23, s22, 1
    s_cmp_eq_u32 s23, s8
    s_cselect_b32 s23, s5, s23
    s_mul_i32 s7, s12, 87384
    s_lshr_b32 s7, s7, 16
    s_mul_i32 s7, s7, 1
    s_add_u32 s5, s4, 6
    s_add_u32 s24, s7, s5
    s_add_u32 s8, s5, 4
    s_add_u32 s25, s24, 1
    s_cmp_eq_u32 s25, s8
    s_cselect_b32 s25, s5, s25
    s_add_u32 s26, s25, 1
    s_cmp_eq_u32 s26, s8
    s_cselect_b32 s26, s5, s26
    s_add_u32 s27, s26, 1
    s_cmp_eq_u32 s27, s8
    s_cselect_b32 s27, s5, s27
    s_mul_i32 s7, s12, 131076
    s_lshr_b32 s7, s7, 16
    s_mul_i32 s7, s7, 1
    s_add_u32 s5, s4, 10
    s_add_u32 s76, s7, s5
    s_add_u32 s8, s5, 6
    s_add_u32 s77, s76, 1
    s_cmp_eq_u32 s77, s8
    s_cselect_b32 s77, s5, s77
    s_add_u32 s78, s77, 1
    s_cmp_eq_u32 s78, s8
    s_cselect_b32 s78, s5, s78
    s_add_u32 s79, s78, 1
    s_cmp_eq_u32 s79, s8
    s_cselect_b32 s79, s5, s79
    s_add_u32 s80, s79, 1
    s_cmp_eq_u32 s80, s8
    s_cselect_b32 s80, s5, s80
    s_add_u32 s81, s80, 1
    s_cmp_eq_u32 s81, s8
    s_cselect_b32 s81, s5, s81
    v_lshrrev_b32 v24, 4, v2
    v_and_b32 v25, 15, v2
    v_lshlrev_b32 v26, 1, v24
    v_xor_b32 v25, v25, v26
    v_mul_u32_u24 v24, 9216, v24
    v_lshl_add_u32 v24, v25, 4, v24
    s_mul_i32 s7, s3, 147456
    s_lshl_b32 s8, s69, 8
    s_add_u32 s7, s7, s8
    v_add_u32 v148, s7, v24
    v_add_u32 v149, 35840, v148
    v_xor_b32 v24, 128, v148
    v_add_u32 v150, 71680, v24
    v_add_u32 v151, 35840, v150
    s_mov_b32 s9, 144896
    s_mov_b32 s11, 114688
    v_mul_u32_u24 v48, 1216, v3
    v_mad_u32_u24 v48, v4, 12, v48
    v_add_u32 v48, s9, v48
    v_mov_b32 v47, 0x40000000
    v_lshlrev_b32 v3, 3, v3
    s_lshl_b32 s5, s68, 6
    s_add_u32 s5, s5, 12386304
    v_cmp_eq_u32 vcc, 0, v4
    s_nop 1
    v_cndmask_b32 v49, v47, v3, vcc
    v_lshrrev_b32 v5, 4, v0
    v_and_b32 v4, 3, v2
    v_lshlrev_b32 v4, 3, v4
    v_lshl_add_u32 v5, v5, 5, v4
    v_bfe_u32 v6, v2, 2, 2
    v_mul_u32_u24 v4, 1216, v6
    v_mul_u32_u24 v6, 1152, v6
    v_add3_u32 v50, v4, v5, s9
    v_add3_u32 v51, v6, v5, s11
    s_mul_i32 s4, s3, 2176
    v_add_u32 v55, s4, v51
    v_lshlrev_b32 v52, 4, v0
    s_add_u32 s7, s15, 4096
    s_add_u32 s8, s15, 8192
    s_cmp_eq_u32 s3, 0
    s_cselect_b32 s8, s8, 0x40000000
    v_add_u32 v53, 2359296, v52
    v_mov_b32 v54, 0
    v_add_u32 v4, 0, v52
    v_lshrrev_b32 v5, 7, v4
    v_mul_u32_u24 v6, 9363, v5
    v_lshrrev_b32 v6, 16, v6
    v_mad_i32_i24 v5, v6, -7, v5
    v_cmp_lt_u32 vcc, 2, v5
    s_nop 1
    v_addc_co_u32 v6, vcc, 0, v6, vcc
    v_lshl_add_u32 v93, v6, 7, v4
    v_add_u32 v4, 4096, v52
    v_lshrrev_b32 v5, 7, v4
    v_mul_u32_u24 v6, 9363, v5
    v_lshrrev_b32 v6, 16, v6
    v_mad_i32_i24 v5, v6, -7, v5
    v_cmp_lt_u32 vcc, 2, v5
    s_nop 1
    v_addc_co_u32 v6, vcc, 0, v6, vcc
    v_lshl_add_u32 v94, v6, 7, v4
    v_add_u32 v4, 8192, v52
    v_lshrrev_b32 v5, 7, v4
    v_mul_u32_u24 v6, 9363, v5
    v_lshrrev_b32 v6, 16, v6
    v_mad_i32_i24 v5, v6, -7, v5
    v_cmp_lt_u32 vcc, 2, v5
    s_nop 1
    v_addc_co_u32 v6, vcc, 0, v6, vcc
    v_lshl_add_u32 v95, v6, 7, v4
    s_mul_i32 s10, s68, 11264
    s_add_u32 s10, s10, 36585472
    s_cmp_eq_u32 s3, 0
    s_cselect_b32 s83, s10, 0x40000000
    s_add_u32 s7, s10, 2883584
    s_add_u32 s8, s83, 2883584
    s_mul_i32 s4, s3, 1028
    s_sub_u32 s4, 8204, s4
    v_add_u32 v90, s4, v53
    s_bfe_u32 s6, s68, 0x20001
    s_lshl_b32 s6, s6, 6
    s_lshr_b32 s9, s68, 3
    s_lshl1_add_u32 s6, s9, s6
    s_and_b32 s9, s68, 1
    s_add_u32 s6, s6, s9
    s_lshl_b32 s4, s6, 2
    s_add_u32 s4, s4, 12533760
    v_lshl_add_u32 v1, v0, 10, s4
    s_lshl_b32 s4, s68, 2
    s_add_u32 s4, s4, 12599296
    v_lshl_add_u32 v46, v0, 10, s4
    v_cmp_gt_u32 vcc, 8, v0
    s_nop 1
    v_cndmask_b32 v1, v47, v1, vcc
    v_cmp_gt_u32 vcc, 4, v0
    s_nop 1
    v_cndmask_b32 v46, v47, v46, vcc
    s_waitcnt vmcnt(9)
    v_and_b32 v21, 0xffff0000, v8
    s_add_u32 m0, s73, 81920
    s_mul_i32 s14, s18, 589824
    buffer_load_dwordx4 v148, s[48:51], s14 offen offset:0 lds
    v_lshlrev_b32 v20, 16, v8
    v_and_b32 v23, 0xffff0000, v9
    v_lshlrev_b32 v22, 16, v9
    v_and_b32 v25, 0xffff0000, v10
    v_lshlrev_b32 v24, 16, v10
    v_and_b32 v27, 0xffff0000, v12
    v_lshlrev_b32 v26, 16, v12
    v_and_b32 v29, 0xffff0000, v13
    v_lshlrev_b32 v28, 16, v13
    v_and_b32 v31, 0xffff0000, v14
    v_lshlrev_b32 v30, 16, v14
    v_and_b32 v33, 0xffff0000, v16
    v_lshlrev_b32 v32, 16, v16
    v_and_b32 v35, 0xffff0000, v17
    v_lshlrev_b32 v34, 16, v17
    v_and_b32 v37, 0xffff0000, v18
    v_lshlrev_b32 v36, 16, v18
    v_pk_add_f32 v[38:39], v[20:21], v[22:23]
    v_pk_add_f32 v[40:41], v[24:25], v[26:27]
    v_pk_add_f32 v[42:43], v[28:29], v[30:31]
    v_pk_add_f32 v[44:45], v[32:33], v[34:35]
    v_pk_add_f32 v[38:39], v[38:39], v[40:41]
    v_pk_add_f32 v[42:43], v[42:43], v[44:45]
    v_pk_add_f32 v[38:39], v[38:39], v[36:37]
    v_pk_add_f32 v[38:39], v[38:39], v[42:43]
    v_add_f32 v56, v38, v39
    buffer_load_dwordx4 v149, s[48:51], s14 offen offset:1024 lds
    s_nop 0
    v_add_f32_dpp v56, v56, v56 row_ror:8 row_mask:0xf bank_mask:0xf
    s_nop 1
    v_add_f32_dpp v56, v56, v56 row_ror:4 row_mask:0xf bank_mask:0xf
    s_nop 1
    v_add_f32_dpp v56, v56, v56 row_ror:2 row_mask:0xf bank_mask:0xf
    s_nop 1
    v_add_f32_dpp v56, v56, v56 row_ror:1 row_mask:0xf bank_mask:0xf
    v_mov_b32 v57, v56
    s_nop 1
    v_permlane16_swap_b32 v56, v57
    v_add_f32 v56, v56, v57
    v_mul_f32 v56, 0x3ae38e39, v56
    v_pk_add_f32 v[20:21], v[20:21], v[56:57] op_sel_hi:[1,0] neg_lo:[0,1] neg_hi:[0,1]
    v_pk_add_f32 v[22:23], v[22:23], v[56:57] op_sel_hi:[1,0] neg_lo:[0,1] neg_hi:[0,1]
    v_pk_add_f32 v[24:25], v[24:25], v[56:57] op_sel_hi:[1,0] neg_lo:[0,1] neg_hi:[0,1]
    v_pk_add_f32 v[26:27], v[26:27], v[56:57] op_sel_hi:[1,0] neg_lo:[0,1] neg_hi:[0,1]
    v_pk_add_f32 v[28:29], v[28:29], v[56:57] op_sel_hi:[1,0] neg_lo:[0,1] neg_hi:[0,1]
    v_pk_add_f32 v[30:31], v[30:31], v[56:57] op_sel_hi:[1,0] neg_lo:[0,1] neg_hi:[0,1]
    v_pk_add_f32 v[32:33], v[32:33], v[56:57] op_sel_hi:[1,0] neg_lo:[0,1] neg_hi:[0,1]
    v_pk_add_f32 v[34:35], v[34:35], v[56:57] op_sel_hi:[1,0] neg_lo:[0,1] neg_hi:[0,1]
    v_pk_add_f32 v[36:37], v[36:37], v[56:57] op_sel_hi:[1,0] neg_lo:[0,1] neg_hi:[0,1]
    v_pk_mul_f32 v[38:39], v[20:21], v[20:21]
    v_pk_mul_f32 v[40:41], v[22:23], v[22:23]
    v_pk_fma_f32 v[38:39], v[24:25], v[24:25], v[38:39]
    v_pk_fma_f32 v[40:41], v[26:27], v[26:27], v[40:41]
    v_pk_fma_f32 v[38:39], v[28:29], v[28:29], v[38:39]
    v_pk_fma_f32 v[40:41], v[30:31], v[30:31], v[40:41]
    v_pk_fma_f32 v[38:39], v[32:33], v[32:33], v[38:39]
    v_pk_fma_f32 v[40:41], v[34:35], v[34:35], v[40:41]
    v_pk_fma_f32 v[38:39], v[36:37], v[36:37], v[38:39]
    buffer_load_dwordx4 v150, s[48:51], s14 offen offset:2048 lds
    v_pk_add_f32 v[38:39], v[38:39], v[40:41]
    v_add_f32 v18, v38, v39
    s_nop 1
    v_add_f32_dpp v18, v18, v18 row_ror:8 row_mask:0xf bank_mask:0xf
    s_nop 1
    v_add_f32_dpp v18, v18, v18 row_ror:4 row_mask:0xf bank_mask:0xf
    s_nop 1
    v_add_f32_dpp v18, v18, v18 row_ror:2 row_mask:0xf bank_mask:0xf
    s_nop 1
    v_add_f32_dpp v18, v18, v18 row_ror:1 row_mask:0xf bank_mask:0xf
    v_mov_b32 v19, v18
    s_nop 1
    v_permlane16_swap_b32 v18, v19
    v_add_f32 v18, v18, v19
    v_mul_f32 v18, 0x3ae38e39, v18
    v_cvt_pk_bf16_f32 v38, v56, v18
    v_lshlrev_b32 v106, 16, v38
    v_and_b32 v38, 0xffff0000, v38
    v_add_f32 v38, 0x3727c5ac, v38
    v_sub_f32 v56, v56, v106
    v_cvt_pk_bf16_f32 v38, v38, v38
    v_lshlrev_b32 v38, 16, v38
    v_sqrt_f32 v38, v38
    s_nop 0
    v_cvt_pk_bf16_f32 v38, v38, v38
    v_lshlrev_b32 v38, 16, v38
    v_rcp_f32 v107, v38
    s_nop 0
    v_mul_f32 v56, v56, v107
    v_mul_f32 v18, v18, v107
    v_mul_f32 v18, v18, v107
    v_cvt_pk_bf16_f32 v38, v56, v18
    v_lshlrev_b32 v39, 16, v38
    buffer_load_dwordx4 v151, s[48:51], s14 offen offset:3072 lds
    v_and_b32 v38, 0xffff0000, v38
    v_add_f32 v38, 0x3727c5ac, v38
    v_sub_f32 v56, v56, v39
    v_cvt_pk_bf16_f32 v38, v38, v38
    v_lshlrev_b32 v38, 16, v38
    v_sqrt_f32 v38, v38
    s_nop 0
    v_cvt_pk_bf16_f32 v38, v38, v38
    v_lshlrev_b32 v38, 16, v38
    v_rcp_f32 v38, v38
    s_nop 0
    v_mul_f32 v18, v107, v38
    v_mul_f32 v56, v56, v38
    v_pk_fma_f32 v[20:21], v[20:21], v[18:19], v[56:57] op_sel_hi:[1,0,0]
    v_pk_fma_f32 v[22:23], v[22:23], v[18:19], v[56:57] op_sel_hi:[1,0,0]
    v_pk_fma_f32 v[24:25], v[24:25], v[18:19], v[56:57] op_sel_hi:[1,0,0]
    v_pk_fma_f32 v[26:27], v[26:27], v[18:19], v[56:57] op_sel_hi:[1,0,0]
    v_pk_fma_f32 v[28:29], v[28:29], v[18:19], v[56:57] op_sel_hi:[1,0,0]
    v_pk_fma_f32 v[30:31], v[30:31], v[18:19], v[56:57] op_sel_hi:[1,0,0]
    v_pk_fma_f32 v[32:33], v[32:33], v[18:19], v[56:57] op_sel_hi:[1,0,0]
    v_pk_fma_f32 v[34:35], v[34:35], v[18:19], v[56:57] op_sel_hi:[1,0,0]
    v_pk_fma_f32 v[36:37], v[36:37], v[18:19], v[56:57] op_sel_hi:[1,0,0]
    v_cvt_pk_bf16_f32 v8, v20, v21
    v_cvt_pk_bf16_f32 v9, v22, v23
    v_cvt_pk_bf16_f32 v10, v24, v25
    v_cvt_pk_bf16_f32 v11, v26, v27
    v_cvt_pk_bf16_f32 v12, v28, v29
    v_cvt_pk_bf16_f32 v13, v30, v31
    v_cvt_pk_bf16_f32 v14, v32, v33
    v_cvt_pk_bf16_f32 v15, v34, v35
    v_cvt_pk_bf16_f32 v16, v36, v37
    ds_write_b32 v48, v8 offset:0
    ds_write_b32 v48, v9 offset:4
    ds_write_b32 v48, v10 offset:8
    ds_write_b32 v48, v11 offset:384
    ds_write_b32 v48, v12 offset:388
    ds_write_b32 v48, v13 offset:392
    ds_write_b32 v48, v14 offset:768
    ds_write_b32 v48, v15 offset:772
    ds_write_b32 v48, v16 offset:776
    buffer_store_dwordx2 v[106:107], v49, s[44:47], s5 offen sc1
    s_waitcnt lgkmcnt(0)
    s_barrier
    ds_read_b64_tr_b16 v[20:21], v50 offset:0
    ds_read_b64_tr_b16 v[22:23], v50 offset:4864
    ds_read_b64_tr_b16 v[24:25], v50 offset:512
    ds_read_b64_tr_b16 v[26:27], v50 offset:5376
    ds_read_b64_tr_b16 v[28:29], v50 offset:1024
    ds_read_b64_tr_b16 v[30:31], v50 offset:5888
    s_waitcnt lgkmcnt(4)
    buffer_store_dwordx4 v[20:23], v93, s[44:47], s10 offen sc1
    s_waitcnt lgkmcnt(2)
    buffer_store_dwordx4 v[24:27], v94, s[44:47], s10 offen sc1
    s_waitcnt lgkmcnt(0)
    buffer_store_dwordx4 v[28:31], v95, s[44:47], s83 offen sc1
    buffer_load_dword v45, v54, s[64:67], 0 offen sc1
    s_waitcnt vmcnt(9)
    s_barrier
    ds_read_b64_tr_b16 v[60:61], v51 offset:0
    ds_read_b64_tr_b16 v[62:63], v51 offset:4608
    ds_read_b64_tr_b16 v[64:65], v51 offset:9216
    ds_read_b64_tr_b16 v[66:67], v51 offset:12672
    ds_read_b64_tr_b16 v[68:69], v51 offset:17280
    ds_read_b64_tr_b16 v[70:71], v51 offset:512
    ds_read_b64_tr_b16 v[72:73], v51 offset:5120
    ds_read_b64_tr_b16 v[74:75], v51 offset:9728
    ds_read_b64_tr_b16 v[76:77], v51 offset:13184
    ds_read_b64_tr_b16 v[78:79], v51 offset:17792
    v_alignbit_b32 v114, v99, v99, 16
    v_alignbit_b32 v115, v98, v98, 16
    s_waitcnt lgkmcnt(5)
    v_alignbit_b32 v108, v61, v60, 16
    v_alignbit_b32 v109, v62, v61, 16
    v_alignbit_b32 v110, v63, v62, 16
    v_alignbit_b32 v111, v64, v63, 16
    v_alignbit_b32 v112, v65, v64, 16
    v_dot2_f32_bf16 v116, v60, v114, 0
    ds_read_b64_tr_b16 v[80:81], v51 offset:1024
    v_dot2_f32_bf16 v117, v108, v114, 0
    s_add_u32 m0, s73, 98304
    s_mul_i32 s14, s19, 589824
    buffer_load_dwordx4 v148, s[48:51], s14 offen offset:0 lds
    v_dot2_f32_bf16 v118, v61, v114, 0
    v_dot2_f32_bf16 v119, v109, v114, 0
    v_dot2_f32_bf16 v120, v62, v114, 0
    ds_read_b64_tr_b16 v[82:83], v51 offset:5632
    v_dot2_f32_bf16 v121, v110, v114, 0
    v_dot2_f32_bf16 v122, v63, v114, 0
    v_dot2_f32_bf16 v123, v111, v114, 0
    v_dot2_f32_bf16 v116, v61, v115, v116
    v_dot2_f32_bf16 v117, v109, v115, v117
    ds_read_b64_tr_b16 v[84:85], v51 offset:10240
    v_dot2_f32_bf16 v118, v62, v115, v118
    v_dot2_f32_bf16 v119, v110, v115, v119
    v_dot2_f32_bf16 v120, v63, v115, v120
    v_dot2_f32_bf16 v121, v111, v115, v121
    v_dot2_f32_bf16 v122, v64, v115, v122
    ds_read_b64_tr_b16 v[86:87], v51 offset:13696
    v_dot2_f32_bf16 v123, v112, v115, v123
    v_and_b32 v133, 0xffff0000, v66
    v_lshlrev_b32 v132, 16, v66
    v_and_b32 v135, 0xffff0000, v67
    v_lshlrev_b32 v134, 16, v67
    ds_read_b64_tr_b16 v[88:89], v51 offset:18304
    v_and_b32 v137, 0xffff0000, v68
    v_lshlrev_b32 v136, 16, v68
    v_and_b32 v139, 0xffff0000, v69
    v_lshlrev_b32 v138, 16, v69
    v_pk_mul_f32 v[116:117], v[116:117], v[132:133]
    v_pk_mul_f32 v[118:119], v[118:119], v[134:135]
    v_pk_mul_f32 v[120:121], v[120:121], v[136:137]
    v_pk_mul_f32 v[122:123], v[122:123], v[138:139]
    buffer_load_dwordx4 v149, s[48:51], s14 offen offset:1024 lds
    v_cvt_pk_bf16_f32 v160, v123, v122
    v_cvt_pk_bf16_f32 v161, v121, v120
    v_cvt_pk_bf16_f32 v162, v119, v118
    v_cvt_pk_bf16_f32 v163, v117, v116
    buffer_store_dwordx4 v[160:163], v93, s[44:47], s7 offen sc1
    v_alignbit_b32 v114, v101, v101, 16
    v_alignbit_b32 v115, v100, v100, 16
    s_waitcnt lgkmcnt(5)
    v_alignbit_b32 v108, v71, v70, 16
    v_alignbit_b32 v109, v72, v71, 16
    v_alignbit_b32 v110, v73, v72, 16
    v_alignbit_b32 v111, v74, v73, 16
    v_alignbit_b32 v112, v75, v74, 16
    v_dot2_f32_bf16 v124, v70, v114, 0
    v_dot2_f32_bf16 v125, v108, v114, 0
    v_dot2_f32_bf16 v126, v71, v114, 0
    v_dot2_f32_bf16 v127, v109, v114, 0
    v_dot2_f32_bf16 v128, v72, v114, 0
    v_dot2_f32_bf16 v129, v110, v114, 0
    v_dot2_f32_bf16 v130, v73, v114, 0
    v_dot2_f32_bf16 v131, v111, v114, 0
    v_dot2_f32_bf16 v124, v71, v115, v124
    v_dot2_f32_bf16 v125, v109, v115, v125
    v_dot2_f32_bf16 v126, v72, v115, v126
    v_dot2_f32_bf16 v127, v110, v115, v127
    v_dot2_f32_bf16 v128, v73, v115, v128
    v_dot2_f32_bf16 v129, v111, v115, v129
    v_dot2_f32_bf16 v130, v74, v115, v130
    v_dot2_f32_bf16 v131, v112, v115, v131
    v_and_b32 v133, 0xffff0000, v76
    buffer_load_dwordx4 v150, s[48:51], s14 offen offset:2048 lds
    v_lshlrev_b32 v132, 16, v76
    v_and_b32 v135, 0xffff0000, v77
    v_lshlrev_b32 v134, 16, v77
    v_and_b32 v137, 0xffff0000, v78
    v_lshlrev_b32 v136, 16, v78
    v_and_b32 v139, 0xffff0000, v79
    v_lshlrev_b32 v138, 16, v79
    v_pk_mul_f32 v[124:125], v[124:125], v[132:133]
    v_pk_mul_f32 v[126:127], v[126:127], v[134:135]
    v_pk_mul_f32 v[128:129], v[128:129], v[136:137]
    v_pk_mul_f32 v[130:131], v[130:131], v[138:139]
    v_cvt_pk_bf16_f32 v164, v131, v130
    v_cvt_pk_bf16_f32 v165, v129, v128
    v_cvt_pk_bf16_f32 v166, v127, v126
    v_cvt_pk_bf16_f32 v167, v125, v124
    buffer_store_dwordx4 v[164:167], v94, s[44:47], s7 offen sc1
    v_alignbit_b32 v114, v103, v103, 16
    v_alignbit_b32 v115, v102, v102, 16
    s_waitcnt lgkmcnt(0)
    v_alignbit_b32 v108, v81, v80, 16
    v_alignbit_b32 v109, v82, v81, 16
    v_alignbit_b32 v110, v83, v82, 16
    v_alignbit_b32 v111, v84, v83, 16
    v_alignbit_b32 v112, v85, v84, 16
    v_dot2_f32_bf16 v116, v80, v114, 0
    v_dot2_f32_bf16 v117, v108, v114, 0
    v_dot2_f32_bf16 v118, v81, v114, 0
    v_dot2_f32_bf16 v119, v109, v114, 0
    v_dot2_f32_bf16 v120, v82, v114, 0
    v_dot2_f32_bf16 v121, v110, v114, 0
    buffer_load_dwordx4 v151, s[48:51], s14 offen offset:3072 lds
    v_dot2_f32_bf16 v122, v83, v114, 0
    v_dot2_f32_bf16 v123, v111, v114, 0
    v_dot2_f32_bf16 v116, v81, v115, v116
    v_dot2_f32_bf16 v117, v109, v115, v117
    v_dot2_f32_bf16 v118, v82, v115, v118
    v_dot2_f32_bf16 v119, v110, v115, v119
    v_dot2_f32_bf16 v120, v83, v115, v120
    v_dot2_f32_bf16 v121, v111, v115, v121
    v_dot2_f32_bf16 v122, v84, v115, v122
    v_dot2_f32_bf16 v123, v112, v115, v123
    v_and_b32 v133, 0xffff0000, v86
    v_lshlrev_b32 v132, 16, v86
    v_and_b32 v135, 0xffff0000, v87
    v_lshlrev_b32 v134, 16, v87
    v_and_b32 v137, 0xffff0000, v88
    v_lshlrev_b32 v136, 16, v88
    v_and_b32 v139, 0xffff0000, v89
    v_lshlrev_b32 v138, 16, v89
    v_pk_mul_f32 v[116:117], v[116:117], v[132:133]
    v_pk_mul_f32 v[118:119], v[118:119], v[134:135]
    v_pk_mul_f32 v[120:121], v[120:121], v[136:137]
    v_pk_mul_f32 v[122:123], v[122:123], v[138:139]
    v_cvt_pk_bf16_f32 v168, v123, v122
    v_cvt_pk_bf16_f32 v169, v121, v120
    v_cvt_pk_bf16_f32 v170, v119, v118
    v_cvt_pk_bf16_f32 v171, v117, v116
    buffer_store_dwordx4 v[168:171], v95, s[44:47], s8 offen sc1
    s_add_u32 m0, s73, 0
    s_mul_i32 s14, s20, 589824
    buffer_load_dwordx4 v148, s[48:51], s14 offen offset:0 lds
    buffer_load_dwordx4 v149, s[48:51], s14 offen offset:1024 lds
    buffer_load_dwordx4 v150, s[48:51], s14 offen offset:2048 lds
    buffer_load_dwordx4 v151, s[48:51], s14 offen offset:3072 lds
    s_add_u32 m0, s73, 16384
    s_mul_i32 s14, s21, 589824
    buffer_load_dwordx4 v148, s[48:51], s14 offen offset:0 lds
    buffer_load_dwordx4 v149, s[48:51], s14 offen offset:1024 lds
    buffer_load_dwordx4 v150, s[48:51], s14 offen offset:2048 lds
    buffer_load_dwordx4 v151, s[48:51], s14 offen offset:3072 lds
    s_waitcnt vmcnt(15)
    v_readfirstlane_b32 s68, v45
    s_nop 1
    s_cmp_eq_u32 s68, 0
    s_cbranch_scc1 L_nw_G
L_ng_G:
    s_barrier
    v_mov_b32 v3, s68
    buffer_store_dword v3, v1, s[44:47], 0 offen sc1
    s_mov_b64 exec, 0
    s_call_b64 s[82:83], L_wc_G
    s_mov_b64 exec, -1
    s_waitcnt vmcnt(9)
    s_barrier
    buffer_store_dword v3, v46, s[44:47], 0 offen sc1
L_segG:
L_pl_G_0:
    s_cbranch_execz L_pl_G_4
    s_add_u32 m0, s73, 32768
    s_mul_i32 s14, s22, 589824
    buffer_load_dwordx4 v148, s[48:51], s14 offen offset:0 lds
    buffer_load_dwordx4 v149, s[48:51], s14 offen offset:1024 lds
    buffer_load_dwordx4 v150, s[48:51], s14 offen offset:2048 lds
    buffer_load_dwordx4 v151, s[48:51], s14 offen offset:3072 lds
    s_add_u32 m0, s73, 49152
    s_mul_i32 s14, s23, 589824
    buffer_load_dwordx4 v148, s[48:51], s14 offen offset:0 lds
    buffer_load_dwordx4 v149, s[48:51], s14 offen offset:1024 lds
    buffer_load_dwordx4 v150, s[48:51], s14 offen offset:2048 lds
    buffer_load_dwordx4 v151, s[48:51], s14 offen offset:3072 lds
    s_add_u32 m0, s73, 65536
    s_mul_i32 s14, s24, 589824
    buffer_load_dwordx4 v148, s[48:51], s14 offen offset:0 lds
    buffer_load_dwordx4 v149, s[48:51], s14 offen offset:1024 lds
    buffer_load_dwordx4 v150, s[48:51], s14 offen offset:2048 lds
    buffer_load_dwordx4 v151, s[48:51], s14 offen offset:3072 lds
    v_bfe_u32 v140, v2, 2, 2
    v_lshrrev_b32 v141, 4, v2
    v_lshl_add_u32 v142, v141, 3, v140
    v_lshlrev_b32 v142, 8, v142
    v_and_b32 v143, 3, v2
    v_lshl_add_u32 v142, v143, 3, v142
    v_and_b32 v141, 1, v141
    v_lshl_add_u32 v140, v141, 2, v140
    s_lshl_b32 s7, s3, 1
    v_xor_b32 v140, s7, v140
    v_lshl_add_u32 v152, v140, 5, v142
    v_xor_b32 v153, 32, v152
    v_add_u32 v154, 0x10000, v152
    v_add_u32 v155, 0x10000, v153
    v_and_b32 v24, 15, v2
    v_lshrrev_b32 v25, 4, v2
    v_mul_u32_u24 v26, 17408, v25
    v_lshl_add_u32 v26, v24, 4, v26
    v_mul_u32_u24 v25, 1536, v25
    v_lshl_add_u32 v25, v24, 4, v25
    v_add_u32 v159, 81920, v25
    v_add_u32 v250, 36864, v159
    s_mul_i32 s7, s3, 18432
    s_xor_b32 s8, s70, 1
    s_mul_i32 s8, s8, 1536
    s_add_u32 s7, s7, s8
    v_lshlrev_b32 v246, 4, v2
    v_add_u32 v156, s7, v246
    v_lshrrev_b32 v25, 5, v2
    v_mul_u32_u24 v25, 7680, v25
    v_add_u32 v157, v156, v25
    v_add_u32 v158, 7680, v156
    s_mul_i32 s74, s3, 3072
    s_add_u32 s74, s74, 81920
    v_mov_b32 v245, v26
    s_mov_b64 exec, 0
    s_call_b64 s[82:83], L_wc_D
    s_mov_b64 exec, -1
    s_mov_b32 s56, s32
    s_and_b32 s57, s33, 0xffff
    s_mov_b32 s58, 9216
    s_mov_b32 s59, 0x20000
    s_mov_b32 s60, s36
    s_and_b32 s61, s37, 0xffff
    s_mov_b32 s62, 4096
    s_mov_b32 s63, 0x20000
    s_and_b32 s4, s70, 1
    s_lshl1_add_u32 s4, s3, s4
    s_lshl_b32 s4, s4, 7
    s_bfe_u32 s5, s2, 0x10003
    s_lshl1_add_u32 s5, s72, s5
    s_lshr_b32 s5, s5, 0
    s_lshl_b32 s5, s5, 10
    s_add_u32 s4, s4, s5
    s_add_u32 s4, s4, 12533760
    v_lshl_add_u32 v28, v2, 2, s4
    v_cmp_gt_u32 vcc, 32, v2
    v_mov_b32 v12, 0x40000000
    s_nop 0
    v_cndmask_b32 v28, v12, v28, vcc
    v_mov_b32 v12, s68
    v_cndmask_b32 v12, 0, v12, vcc
    v_lshrrev_b32 v24, 4, v2
    v_lshlrev_b32 v25, 3, v24
    s_lshl_b32 s7, s69, 8
    s_lshl_b32 s8, s3, 6
    s_add_u32 s7, s7, s8
    buffer_load_dwordx2 v[144:145], v25, s[56:59], s7 offen
    buffer_load_dwordx2 v[146:147], v25, s[56:59], s7 offen offset:32
    s_barrier
    ds_read_b64_tr_b16 a[0:1], v154 offset:16384
    ds_read_b64_tr_b16 a[2:3], v154 offset:17408
    ds_read_b64_tr_b16 a[4:5], v155 offset:16384
    ds_read_b64_tr_b16 a[6:7], v155 offset:17408
    ds_read_b64_tr_b16 a[8:9], v154 offset:24576
    ds_read_b64_tr_b16 a[10:11], v154 offset:25600
    ds_read_b64_tr_b16 a[12:13], v155 offset:24576
    ds_read_b64_tr_b16 a[14:15], v155 offset:25600
    ds_read_b64_tr_b16 a[16:17], v154 offset:32768
    ds_read_b64_tr_b16 a[18:19], v154 offset:33792
    ds_read_b64_tr_b16 a[20:21], v155 offset:32768
    ds_read_b64_tr_b16 a[22:23], v155 offset:33792
    ds_read_b64_tr_b16 a[24:25], v154 offset:40960
    ds_read_b64_tr_b16 a[26:27], v154 offset:41984
    ds_read_b64_tr_b16 a[28:29], v155 offset:40960
    ds_read_b64_tr_b16 a[30:31], v155 offset:41984
    s_waitcnt vmcnt(20)
    s_barrier
    ds_read_b64_tr_b16 a[32:33], v152 offset:0
    ds_read_b64_tr_b16 a[34:35], v152 offset:1024
    ds_read_b64_tr_b16 a[36:37], v153 offset:0
    ds_read_b64_tr_b16 a[38:39], v153 offset:1024
    ds_read_b64_tr_b16 a[40:41], v152 offset:8192
    ds_read_b64_tr_b16 a[42:43], v152 offset:9216
    ds_read_b64_tr_b16 a[44:45], v153 offset:8192
    ds_read_b64_tr_b16 a[46:47], v153 offset:9216
    s_waitcnt vmcnt(16)
    s_barrier
    ds_read_b64_tr_b16 a[48:49], v152 offset:16384
    ds_read_b64_tr_b16 a[50:51], v152 offset:17408
    ds_read_b64_tr_b16 a[52:53], v153 offset:16384
    ds_read_b64_tr_b16 a[54:55], v153 offset:17408
    ds_read_b64_tr_b16 a[56:57], v152 offset:24576
    ds_read_b64_tr_b16 a[58:59], v152 offset:25600
    ds_read_b64_tr_b16 a[60:61], v153 offset:24576
    ds_read_b64_tr_b16 a[62:63], v153 offset:25600
    v_mov_b32 v29, 0
    buffer_atomic_add v29, v28, s[44:47], 0 offen sc0 sc1
    s_waitcnt vmcnt(11)
    s_barrier
    ds_read_b64_tr_b16 a[64:65], v152 offset:32768
    ds_read_b64_tr_b16 a[66:67], v152 offset:33792
    ds_read_b64_tr_b16 a[68:69], v153 offset:32768
    ds_read_b64_tr_b16 a[70:71], v153 offset:33792
    ds_read_b64_tr_b16 a[72:73], v152 offset:40960
    ds_read_b64_tr_b16 a[74:75], v152 offset:41984
    ds_read_b64_tr_b16 a[76:77], v153 offset:40960
    ds_read_b64_tr_b16 a[78:79], v153 offset:41984
L_pl_G_1:
    s_cbranch_execz L_pl_G_5
    s_waitcnt lgkmcnt(0)
    s_barrier
    s_xor_b32 s8, s70, 1
    s_mul_i32 s8, s8, 1536
    s_mul_i32 s7, s3, 22528
    s_add_u32 s7, s7, 36585472
    v_add_u32 v24, 0, v246
    v_cmp_lt_u32 vcc, 1535, v24
    s_nop 1
    v_cndmask_b32 v25, 0, 1, vcc
    v_mul_u32_u24 v30, 1536, v25
    v_sub_u32 v24, v24, v30
    v_add_u32 v24, s8, v24
    v_lshrrev_b32 v30, 7, v24
    v_mul_u32_u24 v31, 9363, v30
    v_lshrrev_b32 v31, 16, v31
    v_mad_i32_i24 v30, v31, -7, v30
    v_cmp_lt_u32 vcc, 2, v30
    s_nop 1
    v_addc_co_u32 v31, vcc, 0, v31, vcc
    v_lshl_add_u32 v24, v31, 7, v24
    v_mul_u32_u24 v25, 11264, v25
    v_add3_u32 v24, v24, v25, s7
    v_subrev_u32 v156, 0, v24
    v_add_u32 v24, 1024, v246
    v_cmp_lt_u32 vcc, 1535, v24
    s_nop 1
    v_cndmask_b32 v25, 0, 1, vcc
    v_mul_u32_u24 v30, 1536, v25
    v_sub_u32 v24, v24, v30
    v_add_u32 v24, s8, v24
    v_lshrrev_b32 v30, 7, v24
    v_mul_u32_u24 v31, 9363, v30
    v_lshrrev_b32 v31, 16, v31
    v_mad_i32_i24 v30, v31, -7, v30
    v_cmp_lt_u32 vcc, 2, v30
    s_nop 1
    v_addc_co_u32 v31, vcc, 0, v31, vcc
    v_lshl_add_u32 v24, v31, 7, v24
    v_mul_u32_u24 v25, 11264, v25
    v_add3_u32 v24, v24, v25, s7
    v_subrev_u32 v157, 1024, v24
    v_add_u32 v24, 2048, v246
    v_cmp_lt_u32 vcc, 1535, v24
    s_nop 1
    v_cndmask_b32 v25, 0, 1, vcc
    v_mul_u32_u24 v30, 1536, v25
    v_sub_u32 v24, v24, v30
    v_add_u32 v24, s8, v24
    v_lshrrev_b32 v30, 7, v24
    v_mul_u32_u24 v31, 9363, v30
    v_lshrrev_b32 v31, 16, v31
    v_mad_i32_i24 v30, v31, -7, v30
    v_cmp_lt_u32 vcc, 2, v30
    s_nop 1
    v_addc_co_u32 v31, vcc, 0, v31, vcc
    v_lshl_add_u32 v24, v31, 7, v24
    v_mul_u32_u24 v25, 11264, v25
    v_add3_u32 v24, v24, v25, s7
    v_subrev_u32 v158, 2048, v24
    s_xor_b32 s8, s70, 0
    s_mul_i32 s8, s8, 1536
    s_mul_i32 s7, s3, 22528
    s_add_u32 s7, s7, 36585472
    v_add_u32 v24, 0, v246
    v_cmp_lt_u32 vcc, 1535, v24
    s_nop 1
    v_cndmask_b32 v25, 0, 1, vcc
    v_mul_u32_u24 v30, 1536, v25
    v_sub_u32 v24, v24, v30
    v_add_u32 v24, s8, v24
    v_lshrrev_b32 v30, 7, v24
    v_mul_u32_u24 v31, 9363, v30
    v_lshrrev_b32 v31, 16, v31
    v_mad_i32_i24 v30, v31, -7, v30
    v_cmp_lt_u32 vcc, 2, v30
    s_nop 1
    v_addc_co_u32 v31, vcc, 0, v31, vcc
    v_lshl_add_u32 v24, v31, 7, v24
    v_mul_u32_u24 v25, 11264, v25
    v_add3_u32 v24, v24, v25, s7
    v_subrev_u32 v8, 0, v24
    v_add_u32 v24, 1024, v246
    v_cmp_lt_u32 vcc, 1535, v24
    s_nop 1
    v_cndmask_b32 v25, 0, 1, vcc
    v_mul_u32_u24 v30, 1536, v25
    v_sub_u32 v24, v24, v30
    v_add_u32 v24, s8, v24
    v_lshrrev_b32 v30, 7, v24
    v_mul_u32_u24 v31, 9363, v30
    v_lshrrev_b32 v31, 16, v31
    v_mad_i32_i24 v30, v31, -7, v30
    v_cmp_lt_u32 vcc, 2, v30
    s_nop 1
    v_addc_co_u32 v31, vcc, 0, v31, vcc
    v_lshl_add_u32 v24, v31, 7, v24
    v_mul_u32_u24 v25, 11264, v25
    v_add3_u32 v24, v24, v25, s7
    v_subrev_u32 v9, 1024, v24
    v_add_u32 v24, 2048, v246
    v_cmp_lt_u32 vcc, 1535, v24
    s_nop 1
    v_cndmask_b32 v25, 0, 1, vcc
    v_mul_u32_u24 v30, 1536, v25
    v_sub_u32 v24, v24, v30
    v_add_u32 v24, s8, v24
    v_lshrrev_b32 v30, 7, v24
    v_mul_u32_u24 v31, 9363, v30
    v_lshrrev_b32 v31, 16, v31
    v_mad_i32_i24 v30, v31, -7, v30
    v_cmp_lt_u32 vcc, 2, v30
    s_nop 1
    v_addc_co_u32 v31, vcc, 0, v31, vcc
    v_lshl_add_u32 v24, v31, 7, v24
    v_mul_u32_u24 v25, 11264, v25
    v_add3_u32 v24, v24, v25, s7
    v_subrev_u32 v3, 2048, v24
    s_waitcnt vmcnt(0)
    v_cmp_ne_u32 vcc, v12, v29
    s_cbranch_vccnz L_rs_p1G
L_ok_p1G:
    s_add_u32 m0, s74, 0
    s_mul_i32 s13, s18, 90112
    buffer_load_dwordx4 v156, s[44:47], s13 offen offset:0 sc1 lds
    buffer_load_dwordx4 v157, s[44:47], s13 offen offset:1024 sc1 lds
    buffer_load_dwordx4 v158, s[44:47], s13 offen offset:2048 sc1 lds
    s_add_u32 m0, s74, 12288
    s_mul_i32 s13, s19, 90112
    buffer_load_dwordx4 v156, s[44:47], s13 offen offset:0 sc1 lds
    buffer_load_dwordx4 v157, s[44:47], s13 offen offset:1024 sc1 lds
    buffer_load_dwordx4 v158, s[44:47], s13 offen offset:2048 sc1 lds
    s_add_u32 m0, s74, 24576
    s_mul_i32 s13, s20, 90112
    buffer_load_dwordx4 v156, s[44:47], s13 offen offset:0 sc1 lds
    buffer_load_dwordx4 v157, s[44:47], s13 offen offset:1024 sc1 lds
    buffer_load_dwordx4 v158, s[44:47], s13 offen offset:2048 sc1 lds
    s_add_u32 m0, s74, 36864
    s_mul_i32 s13, s21, 90112
    buffer_load_dwordx4 v156, s[44:47], s13 offen offset:0 sc1 lds
    buffer_load_dwordx4 v157, s[44:47], s13 offen offset:1024 sc1 lds
    buffer_load_dwordx4 v158, s[44:47], s13 offen offset:2048 sc1 lds
    s_waitcnt vmcnt(9) lgkmcnt(0)
    s_barrier
    ds_read_b128 v[80:83], v159 offset:0
    ds_read_b128 v[84:87], v159 offset:6144
    ds_read_b128 v[88:91], v159 offset:256
    ds_read_b128 v[92:95], v159 offset:6400
    ds_read_b128 v[96:99], v159 offset:512
    ds_read_b128 v[100:103], v159 offset:6656
    s_waitcnt lgkmcnt(0)
    v_mfma_f32_16x16x32_bf16 v[192:195], a[0:3], v[80:83], 0
    v_mfma_f32_16x16x32_bf16 v[192:195], a[8:11], v[84:87], v[192:195]
    ds_read_b128 v[104:107], v159 offset:768
    v_mfma_f32_16x16x32_bf16 v[196:199], a[12:15], v[84:87], 0
    ds_read_b128 v[108:111], v159 offset:6912
    v_mfma_f32_16x16x32_bf16 v[196:199], a[4:7], v[80:83], v[196:199]
    ds_read_b128 v[112:115], v159 offset:1024
    v_mfma_f32_16x16x32_bf16 v[204:207], a[4:7], v[88:91], 0
    ds_read_b128 v[116:119], v159 offset:7168
    v_mfma_f32_16x16x32_bf16 v[204:207], a[12:15], v[92:95], v[204:207]
    ds_read_b128 v[120:123], v159 offset:1280
    v_mfma_f32_16x16x32_bf16 v[200:203], a[8:11], v[92:95], 0
    ds_read_b128 v[124:127], v159 offset:7424
    v_and_b32 v24, 15, v2
    s_lshl_b32 s7, s71, 6
    v_add_u32 v24, s7, v24
    s_and_b32 s8, s3, 1
    s_lshl_b32 s4, s8, 5
    v_add_u32 v25, s4, v24
    v_lshlrev_b32 v26, 3, v25
    v_mul_u32_u24 v25, 1152, v25
    v_bfe_u32 v31, v2, 4, 1
    v_lshl_add_u32 v25, v31, 5, v25
    v_lshrrev_b32 v31, 5, v2
    v_lshl_add_u32 v25, v31, 4, v25
    s_bfe_u32 s7, s2, 0x20003
    s_mul_i32 s7, s7, 288
    s_lshl_b32 s4, s72, 6
    s_add_u32 s4, s4, s7
    v_add_u32 v252, s4, v25
    s_xor_b32 s8, s3, s72
    s_and_b32 s4, s72, 1
    s_lshl1_add_u32 s4, s4, s8
    v_lshl_add_u32 v24, s4, 4, v24
    s_add_u32 s7, s7, 256
    s_cmp_lt_u32 s8, 2
    s_cselect_b32 s7, s7, 0x40000000
    v_lshlrev_b32 v18, 3, v24
    v_mul_u32_u24 v24, 1152, v24
    v_lshrrev_b32 v31, 4, v2
    v_lshl_add_u32 v24, v31, 3, v24
    v_add_u32 v253, s7, v24
    v_lshrrev_b32 v24, 3, v2
    v_and_b32 v25, 7, v2
    v_mfma_f32_16x16x32_bf16 v[200:203], a[0:3], v[88:91], v[200:203]
    v_mfma_f32_16x16x32_bf16 v[208:211], a[0:3], v[96:99], 0
    v_mfma_f32_16x16x32_bf16 v[208:211], a[8:11], v[100:103], v[208:211]
    v_mfma_f32_16x16x32_bf16 v[212:215], a[12:15], v[100:103], 0
    v_mfma_f32_16x16x32_bf16 v[212:215], a[4:7], v[96:99], v[212:215]
    s_waitcnt lgkmcnt(0)
    v_mfma_f32_16x16x32_bf16 v[220:223], a[4:7], v[104:107], 0
    s_waitcnt vmcnt(6)
    s_barrier
    v_mfma_f32_16x16x32_bf16 v[220:223], a[12:15], v[108:111], v[220:223]
    ds_read_b128 v[80:83], v159 offset:12288
    s_add_u32 m0, s74, 49152
    s_mul_i32 s13, s22, 90112
    v_mfma_f32_16x16x32_bf16 v[216:219], a[8:11], v[108:111], 0
    ds_read_b128 v[84:87], v159 offset:18432
    buffer_load_dwordx4 v156, s[44:47], s13 offen offset:0 sc1 lds
    v_mfma_f32_16x16x32_bf16 v[216:219], a[0:3], v[104:107], v[216:219]
    ds_read_b128 v[88:91], v159 offset:12544
    v_mfma_f32_16x16x32_bf16 v[224:227], a[0:3], v[112:115], 0
    ds_read_b128 v[92:95], v159 offset:18688
    buffer_load_dwordx4 v157, s[44:47], s13 offen offset:1024 sc1 lds
    v_mfma_f32_16x16x32_bf16 v[224:227], a[8:11], v[116:119], v[224:227]
    ds_read_b128 v[96:99], v159 offset:12800
    v_mfma_f32_16x16x32_bf16 v[228:231], a[12:15], v[116:119], 0
    ds_read_b128 v[100:103], v159 offset:18944
    buffer_load_dwordx4 v158, s[44:47], s13 offen offset:2048 sc1 lds
    v_bfe_u32 v31, v2, 4, 2
    v_lshlrev_b32 v31, 1, v31
    v_xor_b32 v25, v25, v31
    v_lshlrev_b32 v24, 12, v24
    v_lshl_add_u32 v24, v25, 4, v24
    s_mul_i32 s7, s72, 36
    s_bitcmp1_b32 s3, 0
    s_addc_u32 s7, s7, 0
    s_lshl_b32 s7, s7, 17
    s_lshl_b32 s8, s71, 7
    s_add_u32 s7, s7, s8
    v_add_u32 v4, s7, v24
    v_add_u32 v5, 31744, v4
    v_add_u32 v6, 31744, v5
    v_add_u32 v7, 31744, v6
    v_lshrrev_b32 v24, 2, v2
    v_lshlrev_b32 v24, 7, v24
    v_and_b32 v25, 3, v2
    v_lshl_add_u32 v24, v25, 3, v24
    s_and_b32 s7, s73, 8192
    v_add_u32 v24, s7, v24
    v_bfe_u32 v31, v2, 3, 2
    s_and_b32 s7, s3, 1
    s_lshl_b32 s7, s7, 1
    v_xor_b32 v31, s7, v31
    v_lshl_add_u32 v10, v31, 5, v24
    v_xor_b32 v11, 32, v10
    s_bfe_u32 s101, s2, 0x20003
    s_mul_i32 s101, s101, 3
    s_mul_i32 s84, s101, 305844
    s_lshr_b32 s84, s84, 18
    s_add_u32 s84, s84, 0
    v_mfma_f32_16x16x32_bf16 v[228:231], a[4:7], v[112:115], v[228:231]
    ds_read_b64_tr_b16 a[80:81], v152 offset:49152
    v_mfma_f32_16x16x32_bf16 v[236:239], a[4:7], v[120:123], 0
    ds_read_b64_tr_b16 a[82:83], v152 offset:50176
    s_add_u32 m0, s74, 61440
    s_mul_i32 s13, s23, 90112
    v_mfma_f32_16x16x32_bf16 v[236:239], a[12:15], v[124:127], v[236:239]
    v_mfma_f32_16x16x32_bf16 v[232:235], a[8:11], v[124:127], 0
    ds_read_b64_tr_b16 a[84:85], v153 offset:49152
    buffer_load_dwordx4 v156, s[44:47], s13 offen offset:0 sc1 lds
    v_mfma_f32_16x16x32_bf16 v[232:235], a[0:3], v[120:123], v[232:235]
    ds_read_b64_tr_b16 a[86:87], v153 offset:50176
    s_waitcnt lgkmcnt(4)
    v_mfma_f32_16x16x32_bf16 v[192:195], a[16:19], v[80:83], v[192:195]
    buffer_load_dwordx4 v157, s[44:47], s13 offen offset:1024 sc1 lds
    v_mfma_f32_16x16x32_bf16 v[192:195], a[24:27], v[84:87], v[192:195]
    ds_read_b128 v[104:107], v159 offset:13056
    buffer_load_dwordx4 v158, s[44:47], s13 offen offset:2048 sc1 lds
    v_mfma_f32_16x16x32_bf16 v[196:199], a[28:31], v[84:87], v[196:199]
    ds_read_b128 v[108:111], v159 offset:19200
    v_mfma_f32_16x16x32_bf16 v[196:199], a[20:23], v[80:83], v[196:199]
    ds_read_b128 v[112:115], v159 offset:13312
    s_add_u32 m0, s73, 0
    s_mul_i32 s14, s25, 589824
    v_mfma_f32_16x16x32_bf16 v[204:207], a[20:23], v[88:91], v[204:207]
    ds_read_b128 v[116:119], v159 offset:19456
    v_mfma_f32_16x16x32_bf16 v[204:207], a[28:31], v[92:95], v[204:207]
    ds_read_b128 v[120:123], v159 offset:13568
    buffer_load_dwordx4 v148, s[48:51], s14 offen offset:0 lds
    v_mfma_f32_16x16x32_bf16 v[200:203], a[24:27], v[92:95], v[200:203]
    ds_read_b128 v[124:127], v159 offset:19712
    buffer_load_dwordx4 v149, s[48:51], s14 offen offset:1024 lds
    s_add_u32 s85, s84, 1
    s_cmp_eq_u32 s85, 14
    s_cselect_b32 s85, 0, s85
    s_add_u32 s86, s85, 1
    s_cmp_eq_u32 s86, 14
    s_cselect_b32 s86, 0, s86
    s_add_u32 s87, s86, 1
    s_cmp_eq_u32 s87, 14
    s_cselect_b32 s87, 0, s87
    s_add_u32 s88, s87, 1
    s_cmp_eq_u32 s88, 14
    s_cselect_b32 s88, 0, s88
    s_add_u32 s89, s88, 1
    s_cmp_eq_u32 s89, 14
    s_cselect_b32 s89, 0, s89
    s_add_u32 s90, s89, 1
    s_cmp_eq_u32 s90, 14
    s_cselect_b32 s90, 0, s90
    s_add_u32 s91, s90, 1
    s_cmp_eq_u32 s91, 14
    s_cselect_b32 s91, 0, s91
    s_add_u32 s92, s91, 1
    s_cmp_eq_u32 s92, 14
    s_cselect_b32 s92, 0, s92
    s_add_u32 s93, s92, 1
    s_cmp_eq_u32 s93, 14
    s_cselect_b32 s93, 0, s93
    s_add_u32 s94, s93, 1
    s_cmp_eq_u32 s94, 14
    s_cselect_b32 s94, 0, s94
    s_add_u32 s95, s94, 1
    s_cmp_eq_u32 s95, 14
    s_cselect_b32 s95, 0, s95
    s_add_u32 s96, s95, 1
    s_cmp_eq_u32 s96, 14
    s_cselect_b32 s96, 0, s96
    s_add_u32 s97, s96, 1
    s_cmp_eq_u32 s97, 14
    s_cselect_b32 s97, 0, s97
    s_mul_i32 s98, s101, 87384
    s_lshr_b32 s98, s98, 18
    s_add_u32 s98, s98, 14
    s_add_u32 s99, s98, 1
    s_cmp_eq_u32 s99, 18
    s_cselect_b32 s99, 14, s99
    s_add_u32 s100, s99, 1
    s_cmp_eq_u32 s100, 18
    s_cselect_b32 s100, 14, s100
    s_add_u32 s101, s100, 1
    s_cmp_eq_u32 s101, 18
    s_cselect_b32 s101, 14, s101
    s_mul_i32 s7, s70, 6
    s_add_u32 s7, s7, 0
    s_mul_i32 s8, s7, 7282
    s_lshr_b32 s8, s8, 16
    s_mul_i32 s5, s8, 9
    s_sub_u32 s7, s7, s5
    s_lshl_b32 s7, s7, 2
    s_mov_b32 s4, 0xeca86420
    s_mov_b32 s5, 3
    s_lshr_b64 s[4:5], s[4:5], s7
    v_mfma_f32_16x16x32_bf16 v[200:203], a[16:19], v[88:91], v[200:203]
    ds_read_b64_tr_b16 a[88:89], v152 offset:57344
    v_mfma_f32_16x16x32_bf16 v[208:211], a[16:19], v[96:99], v[208:211]
    ds_read_b64_tr_b16 a[90:91], v152 offset:58368
    buffer_load_dwordx4 v150, s[48:51], s14 offen offset:2048 lds
    v_mfma_f32_16x16x32_bf16 v[208:211], a[24:27], v[100:103], v[208:211]
    v_mfma_f32_16x16x32_bf16 v[212:215], a[28:31], v[100:103], v[212:215]
    ds_read_b64_tr_b16 a[92:93], v153 offset:57344
    buffer_load_dwordx4 v151, s[48:51], s14 offen offset:3072 lds
    v_mfma_f32_16x16x32_bf16 v[212:215], a[20:23], v[96:99], v[212:215]
    ds_read_b64_tr_b16 a[94:95], v153 offset:58368
    s_waitcnt lgkmcnt(4)
    v_mfma_f32_16x16x32_bf16 v[220:223], a[20:23], v[104:107], v[220:223]
    s_waitcnt vmcnt(13)
    s_barrier
    v_mfma_f32_16x16x32_bf16 v[220:223], a[28:31], v[108:111], v[220:223]
    ds_read_b128 v[80:83], v159 offset:24576
    s_add_u32 m0, s74, 0
    s_mul_i32 s13, s24, 90112
    v_mfma_f32_16x16x32_bf16 v[216:219], a[24:27], v[108:111], v[216:219]
    ds_read_b128 v[84:87], v159 offset:30720
    buffer_load_dwordx4 v156, s[44:47], s13 offen offset:0 sc1 lds
    v_mfma_f32_16x16x32_bf16 v[216:219], a[16:19], v[104:107], v[216:219]
    ds_read_b128 v[88:91], v159 offset:24832
    v_mfma_f32_16x16x32_bf16 v[224:227], a[16:19], v[112:115], v[224:227]
    ds_read_b128 v[92:95], v159 offset:30976
    buffer_load_dwordx4 v157, s[44:47], s13 offen offset:1024 sc1 lds
    v_mfma_f32_16x16x32_bf16 v[224:227], a[24:27], v[116:119], v[224:227]
    ds_read_b128 v[96:99], v159 offset:25088
    v_mfma_f32_16x16x32_bf16 v[228:231], a[28:31], v[116:119], v[228:231]
    ds_read_b128 v[100:103], v159 offset:31232
    buffer_load_dwordx4 v158, s[44:47], s13 offen offset:2048 sc1 lds
    s_and_b32 s4, s4, 15
    s_lshl4_add_u32 s4, s8, s4
    v_lshl_add_u32 v240, s4, 8, v245
    s_mul_i32 s7, s70, 6
    s_add_u32 s7, s7, 1
    s_mul_i32 s8, s7, 7282
    s_lshr_b32 s8, s8, 16
    s_mul_i32 s5, s8, 9
    s_sub_u32 s7, s7, s5
    s_lshl_b32 s7, s7, 2
    s_mov_b32 s4, 0xeca86420
    s_mov_b32 s5, 3
    s_lshr_b64 s[4:5], s[4:5], s7
    s_and_b32 s4, s4, 15
    s_lshl4_add_u32 s4, s8, s4
    v_lshl_add_u32 v241, s4, 8, v245
    s_mul_i32 s7, s70, 6
    s_add_u32 s7, s7, 2
    s_mul_i32 s8, s7, 7282
    s_lshr_b32 s8, s8, 16
    s_mul_i32 s5, s8, 9
    s_sub_u32 s7, s7, s5
    s_lshl_b32 s7, s7, 2
    s_mov_b32 s4, 0xeca86420
    s_mov_b32 s5, 3
    v_mfma_f32_16x16x32_bf16 v[228:231], a[20:23], v[112:115], v[228:231]
    ds_read_b64_tr_b16 a[96:97], v154 offset:0
    v_mfma_f32_16x16x32_bf16 v[236:239], a[20:23], v[120:123], v[236:239]
    ds_read_b64_tr_b16 a[98:99], v154 offset:1024
    s_add_u32 m0, s74, 12288
    s_mul_i32 s13, s25, 90112
    v_mfma_f32_16x16x32_bf16 v[236:239], a[28:31], v[124:127], v[236:239]
    v_mfma_f32_16x16x32_bf16 v[232:235], a[24:27], v[124:127], v[232:235]
    ds_read_b64_tr_b16 a[100:101], v155 offset:0
    buffer_load_dwordx4 v156, s[44:47], s13 offen offset:0 sc1 lds
    v_mfma_f32_16x16x32_bf16 v[232:235], a[16:19], v[120:123], v[232:235]
    ds_read_b64_tr_b16 a[102:103], v155 offset:1024
    s_waitcnt lgkmcnt(4)
    v_mfma_f32_16x16x32_bf16 v[192:195], a[32:35], v[80:83], v[192:195]
    buffer_load_dwordx4 v157, s[44:47], s13 offen offset:1024 sc1 lds
    v_mfma_f32_16x16x32_bf16 v[192:195], a[40:43], v[84:87], v[192:195]
    ds_read_b128 v[104:107], v159 offset:25344
    buffer_load_dwordx4 v158, s[44:47], s13 offen offset:2048 sc1 lds
    v_mfma_f32_16x16x32_bf16 v[196:199], a[44:47], v[84:87], v[196:199]
    ds_read_b128 v[108:111], v159 offset:31488
    v_mfma_f32_16x16x32_bf16 v[196:199], a[36:39], v[80:83], v[196:199]
    ds_read_b128 v[112:115], v159 offset:25600
    s_add_u32 m0, s73, 16384
    s_mul_i32 s14, s26, 589824
    v_mfma_f32_16x16x32_bf16 v[204:207], a[36:39], v[88:91], v[204:207]
    ds_read_b128 v[116:119], v159 offset:31744
    v_mfma_f32_16x16x32_bf16 v[204:207], a[44:47], v[92:95], v[204:207]
    ds_read_b128 v[120:123], v159 offset:25856
    buffer_load_dwordx4 v148, s[48:51], s14 offen offset:0 lds
    v_mfma_f32_16x16x32_bf16 v[200:203], a[40:43], v[92:95], v[200:203]
    ds_read_b128 v[124:127], v159 offset:32000
    buffer_load_dwordx4 v149, s[48:51], s14 offen offset:1024 lds
    s_lshr_b64 s[4:5], s[4:5], s7
    s_and_b32 s4, s4, 15
    s_lshl4_add_u32 s4, s8, s4
    v_lshl_add_u32 v242, s4, 8, v245
    s_mul_i32 s7, s70, 6
    s_add_u32 s7, s7, 3
    s_mul_i32 s8, s7, 7282
    s_lshr_b32 s8, s8, 16
    s_mul_i32 s5, s8, 9
    s_sub_u32 s7, s7, s5
    s_lshl_b32 s7, s7, 2
    s_mov_b32 s4, 0xeca86420
    s_mov_b32 s5, 3
    s_lshr_b64 s[4:5], s[4:5], s7
    s_and_b32 s4, s4, 15
    s_lshl4_add_u32 s4, s8, s4
    v_lshl_add_u32 v243, s4, 8, v245
    s_mul_i32 s7, s70, 6
    s_add_u32 s7, s7, 4
    s_mul_i32 s8, s7, 7282
    s_lshr_b32 s8, s8, 16
    s_mul_i32 s5, s8, 9
    s_sub_u32 s7, s7, s5
    s_lshl_b32 s7, s7, 2
    s_mov_b32 s4, 0xeca86420
    v_mfma_f32_16x16x32_bf16 v[200:203], a[32:35], v[88:91], v[200:203]
    ds_read_b64_tr_b16 a[104:105], v154 offset:8192
    v_mfma_f32_16x16x32_bf16 v[208:211], a[32:35], v[96:99], v[208:211]
    ds_read_b64_tr_b16 a[106:107], v154 offset:9216
    buffer_load_dwordx4 v150, s[48:51], s14 offen offset:2048 lds
    v_mfma_f32_16x16x32_bf16 v[208:211], a[40:43], v[100:103], v[208:211]
    v_mfma_f32_16x16x32_bf16 v[212:215], a[44:47], v[100:103], v[212:215]
    ds_read_b64_tr_b16 a[108:109], v155 offset:8192
    buffer_load_dwordx4 v151, s[48:51], s14 offen offset:3072 lds
    v_mfma_f32_16x16x32_bf16 v[212:215], a[36:39], v[96:99], v[212:215]
    ds_read_b64_tr_b16 a[110:111], v155 offset:9216
    s_waitcnt lgkmcnt(4)
    v_mfma_f32_16x16x32_bf16 v[220:223], a[36:39], v[104:107], v[220:223]
    s_waitcnt vmcnt(20)
    s_barrier
    v_mfma_f32_16x16x32_bf16 v[220:223], a[44:47], v[108:111], v[220:223]
    ds_read_b128 v[80:83], v250 offset:0
    s_add_u32 m0, s74, 24576
    s_mul_i32 s13, s26, 90112
    v_mfma_f32_16x16x32_bf16 v[216:219], a[40:43], v[108:111], v[216:219]
    ds_read_b128 v[84:87], v250 offset:6144
    v_mfma_f32_16x16x32_bf16 v[216:219], a[32:35], v[104:107], v[216:219]
    ds_read_b128 v[88:91], v250 offset:256
    buffer_load_dwordx4 v156, s[44:47], s13 offen offset:0 sc1 lds
    v_mfma_f32_16x16x32_bf16 v[224:227], a[32:35], v[112:115], v[224:227]
    ds_read_b128 v[92:95], v250 offset:6400
    v_mfma_f32_16x16x32_bf16 v[224:227], a[40:43], v[116:119], v[224:227]
    ds_read_b128 v[96:99], v250 offset:512
    v_mfma_f32_16x16x32_bf16 v[228:231], a[44:47], v[116:119], v[228:231]
    ds_read_b128 v[100:103], v250 offset:6656
    buffer_load_dwordx4 v157, s[44:47], s13 offen offset:1024 sc1 lds
    s_mov_b32 s5, 3
    s_lshr_b64 s[4:5], s[4:5], s7
    s_and_b32 s4, s4, 15
    s_lshl4_add_u32 s4, s8, s4
    v_lshl_add_u32 v244, s4, 8, v245
    s_mul_i32 s7, s70, 6
    s_add_u32 s7, s7, 5
    s_mul_i32 s8, s7, 7282
    s_lshr_b32 s8, s8, 16
    s_mul_i32 s5, s8, 9
    s_sub_u32 s7, s7, s5
    s_lshl_b32 s7, s7, 2
    s_mov_b32 s4, 0xeca86420
    s_mov_b32 s5, 3
    s_lshr_b64 s[4:5], s[4:5], s7
    s_and_b32 s4, s4, 15
    s_lshl4_add_u32 s4, s8, s4
    v_lshl_add_u32 v245, s4, 8, v245
    s_xor_b32 s7, s75, 1
    s_lshl2_add_u32 s7, s7, s3
    s_mul_i32 s9, s7, 6144
    s_add_u32 s9, s9, 7077888
    s_lshl_b32 s7, s7, 7
    s_add_u32 s6, s7, 22822912
    s_lshl2_add_u32 s7, s75, s3
    s_mul_i32 s10, s7, 6144
    s_add_u32 s10, s10, 7077888
    s_lshl_b32 s7, s7, 7
    v_mfma_f32_16x16x32_bf16 v[228:231], a[36:39], v[112:115], v[228:231]
    v_mfma_f32_16x16x32_bf16 v[236:239], a[36:39], v[120:123], v[236:239]
    v_mfma_f32_16x16x32_bf16 v[236:239], a[44:47], v[124:127], v[236:239]
    buffer_load_dwordx4 v158, s[44:47], s13 offen offset:2048 sc1 lds
    v_mfma_f32_16x16x32_bf16 v[232:235], a[40:43], v[124:127], v[232:235]
    v_mfma_f32_16x16x32_bf16 v[232:235], a[32:35], v[120:123], v[232:235]
    s_waitcnt lgkmcnt(0)
    v_mfma_f32_16x16x32_bf16 v[192:195], a[48:51], v[80:83], v[192:195]
    s_add_u32 m0, s73, 32768
    s_mul_i32 s14, s27, 589824
    v_mfma_f32_16x16x32_bf16 v[192:195], a[56:59], v[84:87], v[192:195]
    ds_read_b128 v[104:107], v250 offset:768
    v_mfma_f32_16x16x32_bf16 v[196:199], a[60:63], v[84:87], v[196:199]
    ds_read_b128 v[108:111], v250 offset:6912
    buffer_load_dwordx4 v148, s[48:51], s14 offen offset:0 lds
    v_mfma_f32_16x16x32_bf16 v[196:199], a[52:55], v[80:83], v[196:199]
    ds_read_b128 v[112:115], v250 offset:1024
    v_mfma_f32_16x16x32_bf16 v[204:207], a[52:55], v[88:91], v[204:207]
    ds_read_b128 v[116:119], v250 offset:7168
    buffer_load_dwordx4 v149, s[48:51], s14 offen offset:1024 lds
    v_mfma_f32_16x16x32_bf16 v[204:207], a[60:63], v[92:95], v[204:207]
    ds_read_b128 v[120:123], v250 offset:1280
    v_mfma_f32_16x16x32_bf16 v[200:203], a[56:59], v[92:95], v[200:203]
    ds_read_b128 v[124:127], v250 offset:7424
    s_add_u32 s7, s7, 22822912
    v_mov_b32 v28, s7
    v_add_u32 v247, 3072, v246
    v_cmp_eq_u32 vcc, 0, v2
    v_mov_b32 v248, 0x40000000
    s_nop 0
    v_cndmask_b32 v248, v248, 0, vcc
    v_mov_b32 v249, s68
    v_and_b32 v129, 0xffff0000, v144
    v_lshlrev_b32 v128, 16, v144
    v_and_b32 v131, 0xffff0000, v145
    v_lshlrev_b32 v130, 16, v145
    v_and_b32 v133, 0xffff0000, v146
    v_lshlrev_b32 v132, 16, v146
    v_and_b32 v135, 0xffff0000, v147
    v_lshlrev_b32 v134, 16, v147
    s_mul_i32 s4, s70, 43691
    s_lshr_b32 s4, s4, 16
    s_mul_i32 s5, s70, 21846
    s_lshr_b32 s5, s5, 16
    s_mul_i32 s5, s5, 3
    s_sub_u32 s5, s70, s5
    v_mfma_f32_16x16x32_bf16 v[200:203], a[48:51], v[88:91], v[200:203]
    buffer_load_dwordx4 v150, s[48:51], s14 offen offset:2048 lds
    v_mfma_f32_16x16x32_bf16 v[208:211], a[48:51], v[96:99], v[208:211]
    v_mfma_f32_16x16x32_bf16 v[208:211], a[56:59], v[100:103], v[208:211]
    buffer_load_dwordx4 v151, s[48:51], s14 offen offset:3072 lds
    v_mfma_f32_16x16x32_bf16 v[212:215], a[60:63], v[100:103], v[212:215]
    v_mfma_f32_16x16x32_bf16 v[212:215], a[52:55], v[96:99], v[212:215]
    s_waitcnt lgkmcnt(0)
    v_mfma_f32_16x16x32_bf16 v[220:223], a[52:55], v[104:107], v[220:223]
    s_waitcnt vmcnt(17)
    s_barrier
    v_mfma_f32_16x16x32_bf16 v[220:223], a[60:63], v[108:111], v[220:223]
    ds_read_b128 v[80:83], v250 offset:12288
    s_add_u32 m0, s74, 36864
    s_mul_i32 s13, s27, 90112
    v_mfma_f32_16x16x32_bf16 v[216:219], a[56:59], v[108:111], v[216:219]
    ds_read_b128 v[84:87], v250 offset:18432
    v_mfma_f32_16x16x32_bf16 v[216:219], a[48:51], v[104:107], v[216:219]
    ds_read_b128 v[88:91], v250 offset:12544
    buffer_load_dwordx4 v156, s[44:47], s13 offen offset:0 sc1 lds
    v_mfma_f32_16x16x32_bf16 v[224:227], a[48:51], v[112:115], v[224:227]
    ds_read_b128 v[92:95], v250 offset:18688
    v_mfma_f32_16x16x32_bf16 v[224:227], a[56:59], v[116:119], v[224:227]
    ds_read_b128 v[96:99], v250 offset:12800
    v_mfma_f32_16x16x32_bf16 v[228:231], a[60:63], v[116:119], v[228:231]
    ds_read_b128 v[100:103], v250 offset:18944
    buffer_load_dwordx4 v157, s[44:47], s13 offen offset:1024 sc1 lds
    s_lshl2_add_u32 s4, s72, s4
    s_lshl_b32 s4, s4, 10
    s_mul_i32 s7, s72, 9
    s_sub_u32 s7, s69, s7
    s_lshl3_add_u32 s4, s7, s4
    s_add_u32 s4, s4, 12566528
    s_cmp_eq_u32 s5, 1
    s_cselect_b32 s7, 16, 8
    s_cmp_lg_u32 s5, 0
    s_cselect_b32 s5, 4, 0
    v_lshlrev_b32 v17, 7, v0
    v_add_u32 v17, s4, v17
    v_cmp_gt_u32 vcc, 8, v0
    v_mov_b32 v24, s5
    s_nop 0
    v_cndmask_b32 v24, 0, v24, vcc
    v_add_u32 v17, v17, v24
    v_cmp_gt_u32 vcc, s7, v0
    v_mov_b32 v24, 0x40000000
    s_nop 0
    v_cndmask_b32 v17, v24, v17, vcc
    s_bfe_u32 s4, s2, 0x20003
    s_lshl2_add_u32 s4, s72, s4
    s_lshl_b32 s4, s4, 3
    s_lshr_b32 s5, s2, 4
    v_mfma_f32_16x16x32_bf16 v[228:231], a[52:55], v[112:115], v[228:231]
    ds_read_b64_tr_b16 a[112:113], v152 offset:0
    v_mfma_f32_16x16x32_bf16 v[236:239], a[52:55], v[120:123], v[236:239]
    ds_read_b64_tr_b16 a[114:115], v152 offset:1024
    v_mfma_f32_16x16x32_bf16 v[236:239], a[60:63], v[124:127], v[236:239]
    buffer_load_dwordx4 v158, s[44:47], s13 offen offset:2048 sc1 lds
    v_mfma_f32_16x16x32_bf16 v[232:235], a[56:59], v[124:127], v[232:235]
    ds_read_b64_tr_b16 a[116:117], v153 offset:0
    v_mfma_f32_16x16x32_bf16 v[232:235], a[48:51], v[120:123], v[232:235]
    ds_read_b64_tr_b16 a[118:119], v153 offset:1024
    s_waitcnt lgkmcnt(4)
    v_mfma_f32_16x16x32_bf16 v[192:195], a[64:67], v[80:83], v[192:195]
    s_add_u32 m0, s73, 49152
    s_mul_i32 s14, s76, 589824
    v_mfma_f32_16x16x32_bf16 v[192:195], a[72:75], v[84:87], v[192:195]
    ds_read_b128 v[104:107], v250 offset:13056
    v_mfma_f32_16x16x32_bf16 v[196:199], a[76:79], v[84:87], v[196:199]
    ds_read_b128 v[108:111], v250 offset:19200
    buffer_load_dwordx4 v148, s[48:51], s14 offen offset:0 lds
    v_mfma_f32_16x16x32_bf16 v[196:199], a[68:71], v[80:83], v[196:199]
    ds_read_b128 v[112:115], v250 offset:13312
    v_mfma_f32_16x16x32_bf16 v[204:207], a[68:71], v[88:91], v[204:207]
    ds_read_b128 v[116:119], v250 offset:19456
    buffer_load_dwordx4 v149, s[48:51], s14 offen offset:1024 lds
    v_mfma_f32_16x16x32_bf16 v[204:207], a[76:79], v[92:95], v[204:207]
    ds_read_b128 v[120:123], v250 offset:13568
    v_mfma_f32_16x16x32_bf16 v[200:203], a[72:75], v[92:95], v[200:203]
    ds_read_b128 v[124:127], v250 offset:19712
    s_and_b32 s5, s5, 6
    s_add_u32 s4, s4, s5
    s_and_b32 s5, s2, 1
    s_add_u32 s4, s4, s5
    s_lshl_b32 s4, s4, 7
    s_add_u32 s4, s4, 12566528
    v_lshl_add_u32 v15, v2, 2, s4
L_pl_G_2:
    s_cbranch_execz L_pl_G_6
    s_cmp_eq_u32 s3, 0
    s_cselect_b32 s4, 18, 0
    v_cmp_gt_u32 vcc, s4, v2
    v_mov_b32 v13, 0x40000000
    s_nop 0
    v_cndmask_b32 v15, v13, v15, vcc
    v_mov_b32 v13, s68
    v_cndmask_b32 v13, 0, v13, vcc
    v_and_b32 v24, 15, v2
    v_lshrrev_b32 v25, 4, v2
    v_mul_u32_u24 v25, 17408, v25
    v_lshl_add_u32 v24, v24, 4, v25
    s_mul_i32 s7, s72, 36
    s_and_b32 s8, s3, 1
    v_mfma_f32_16x16x32_bf16 v[200:203], a[64:67], v[88:91], v[200:203]
    ds_read_b64_tr_b16 a[120:121], v152 offset:8192
    buffer_load_dwordx4 v150, s[48:51], s14 offen offset:2048 lds
    v_mfma_f32_16x16x32_bf16 v[208:211], a[64:67], v[96:99], v[208:211]
    ds_read_b64_tr_b16 a[122:123], v152 offset:9216
    v_mfma_f32_16x16x32_bf16 v[208:211], a[72:75], v[100:103], v[208:211]
    buffer_load_dwordx4 v151, s[48:51], s14 offen offset:3072 lds
    v_mfma_f32_16x16x32_bf16 v[212:215], a[76:79], v[100:103], v[212:215]
    ds_read_b64_tr_b16 a[124:125], v153 offset:8192
    v_mfma_f32_16x16x32_bf16 v[212:215], a[68:71], v[96:99], v[212:215]
    ds_read_b64_tr_b16 a[126:127], v153 offset:9216
    s_waitcnt lgkmcnt(4)
    v_mfma_f32_16x16x32_bf16 v[220:223], a[68:71], v[104:107], v[220:223]
    s_waitcnt vmcnt(14)
    s_barrier
    v_mfma_f32_16x16x32_bf16 v[220:223], a[76:79], v[108:111], v[220:223]
    ds_read_b128 v[80:83], v250 offset:24576
    s_add_u32 m0, s74, 49152
    s_mul_i32 s13, s76, 90112
    v_mfma_f32_16x16x32_bf16 v[216:219], a[72:75], v[108:111], v[216:219]
    ds_read_b128 v[84:87], v250 offset:30720
    v_mfma_f32_16x16x32_bf16 v[216:219], a[64:67], v[104:107], v[216:219]
    ds_read_b128 v[88:91], v250 offset:24832
    buffer_load_dwordx4 v156, s[44:47], s13 offen offset:0 sc1 lds
    v_mfma_f32_16x16x32_bf16 v[224:227], a[64:67], v[112:115], v[224:227]
    ds_read_b128 v[92:95], v250 offset:30976
    v_mfma_f32_16x16x32_bf16 v[224:227], a[72:75], v[116:119], v[224:227]
    ds_read_b128 v[96:99], v250 offset:25088
    v_mfma_f32_16x16x32_bf16 v[228:231], a[76:79], v[116:119], v[228:231]
    ds_read_b128 v[100:103], v250 offset:31232
    buffer_load_dwordx4 v157, s[44:47], s13 offen offset:1024 sc1 lds
    s_add_u32 s7, s7, s8
    s_mul_i32 s7, s7, 69632
    s_bfe_u32 s8, s2, 0x20003
    s_lshl_b32 s8, s8, 12
    s_add_u32 s7, s7, s8
    s_add_u32 s7, s7, 12795904
    v_add_u32 v23, s7, v24
    s_xor_b32 s7, s72, 0
    v_lshl_add_u32 v19, s7, 10, v23
    s_xor_b32 s7, s72, 1
    v_lshl_add_u32 v20, s7, 10, v23
    s_xor_b32 s7, s72, 2
    v_lshl_add_u32 v21, s7, 10, v23
    s_xor_b32 s7, s72, 3
    v_lshl_add_u32 v22, s7, 10, v23
    v_lshlrev_b32 v14, 4, v2
    v_add_u32 v14, 98304, v14
    v_mfma_f32_16x16x32_bf16 v[228:231], a[68:71], v[112:115], v[228:231]
    ds_read_b64_tr_b16 a[128:129], v152 offset:16384
    v_mfma_f32_16x16x32_bf16 v[236:239], a[68:71], v[120:123], v[236:239]
    ds_read_b64_tr_b16 a[130:131], v152 offset:17408
    v_mfma_f32_16x16x32_bf16 v[236:239], a[76:79], v[124:127], v[236:239]
    buffer_load_dwordx4 v158, s[44:47], s13 offen offset:2048 sc1 lds
    v_mfma_f32_16x16x32_bf16 v[232:235], a[72:75], v[124:127], v[232:235]
    ds_read_b64_tr_b16 a[132:133], v153 offset:16384
    v_mfma_f32_16x16x32_bf16 v[232:235], a[64:67], v[120:123], v[232:235]
    ds_read_b64_tr_b16 a[134:135], v153 offset:17408
    s_waitcnt lgkmcnt(4)
    v_mfma_f32_16x16x32_bf16 v[192:195], a[80:83], v[80:83], v[192:195]
    s_add_u32 m0, s73, 65536
    s_mul_i32 s14, s77, 589824
    v_mfma_f32_16x16x32_bf16 v[192:195], a[88:91], v[84:87], v[192:195]
    ds_read_b128 v[104:107], v250 offset:25344
    v_mfma_f32_16x16x32_bf16 v[196:199], a[92:95], v[84:87], v[196:199]
    ds_read_b128 v[108:111], v250 offset:31488
    buffer_load_dwordx4 v148, s[48:51], s14 offen offset:0 lds
    v_mfma_f32_16x16x32_bf16 v[196:199], a[84:87], v[80:83], v[196:199]
    ds_read_b128 v[112:115], v250 offset:25600
    v_mfma_f32_16x16x32_bf16 v[204:207], a[84:87], v[88:91], v[204:207]
    ds_read_b128 v[116:119], v250 offset:31744
    buffer_load_dwordx4 v149, s[48:51], s14 offen offset:1024 lds
    v_mfma_f32_16x16x32_bf16 v[204:207], a[92:95], v[92:95], v[204:207]
    ds_read_b128 v[120:123], v250 offset:25856
    v_mfma_f32_16x16x32_bf16 v[200:203], a[88:91], v[92:95], v[200:203]
    ds_read_b128 v[124:127], v250 offset:32000
    v_add_u32 v1, 0x10000, v14
    s_mov_b32 s56, s16
    s_and_b32 s57, s17, 0xffff
    s_mov_b32 s58, 2359296
    s_mov_b32 s59, 0x20000
    s_mov_b32 s40, 18432
    s_mov_b32 s42, 12386304
    s_mov_b32 s64, s38
    s_and_b32 s65, s39, 0xffff
    s_mov_b32 s66, 2359296
    s_mov_b32 s67, 0x20000
    v_lshlrev_b32 v136, 4, v2
    s_mul_i32 s7, s72, 36
    s_bitcmp1_b32 s3, 0
    s_addc_u32 s7, s7, 0
    s_lshl_b32 s7, s7, 17
    v_subrev_u32 v184, s7, v4
    v_subrev_u32 v185, s7, v5
    v_mfma_f32_16x16x32_bf16 v[200:203], a[80:83], v[88:91], v[200:203]
    ds_read_b64_tr_b16 a[136:137], v152 offset:24576
    buffer_load_dwordx4 v150, s[48:51], s14 offen offset:2048 lds
    v_mfma_f32_16x16x32_bf16 v[208:211], a[80:83], v[96:99], v[208:211]
    ds_read_b64_tr_b16 a[138:139], v152 offset:25600
    v_mfma_f32_16x16x32_bf16 v[208:211], a[88:91], v[100:103], v[208:211]
    buffer_load_dwordx4 v151, s[48:51], s14 offen offset:3072 lds
    v_mfma_f32_16x16x32_bf16 v[212:215], a[92:95], v[100:103], v[212:215]
    ds_read_b64_tr_b16 a[140:141], v153 offset:24576
    v_mfma_f32_16x16x32_bf16 v[212:215], a[84:87], v[96:99], v[212:215]
    ds_read_b64_tr_b16 a[142:143], v153 offset:25600
    s_waitcnt lgkmcnt(4)
    v_mfma_f32_16x16x32_bf16 v[220:223], a[84:87], v[104:107], v[220:223]
    s_waitcnt vmcnt(14)
    s_barrier
    v_mfma_f32_16x16x32_bf16 v[220:223], a[92:95], v[108:111], v[220:223]
    ds_read_b128 v[80:83], v159 offset:0
    s_add_u32 m0, s74, 61440
    s_mul_i32 s13, s77, 90112
    v_mfma_f32_16x16x32_bf16 v[216:219], a[88:91], v[108:111], v[216:219]
    ds_read_b128 v[84:87], v159 offset:6144
    v_mfma_f32_16x16x32_bf16 v[216:219], a[80:83], v[104:107], v[216:219]
    ds_read_b128 v[88:91], v159 offset:256
    buffer_load_dwordx4 v156, s[44:47], s13 offen offset:0 sc1 lds
    v_mfma_f32_16x16x32_bf16 v[224:227], a[80:83], v[112:115], v[224:227]
    ds_read_b128 v[92:95], v159 offset:6400
    v_mfma_f32_16x16x32_bf16 v[224:227], a[88:91], v[116:119], v[224:227]
    ds_read_b128 v[96:99], v159 offset:512
    v_mfma_f32_16x16x32_bf16 v[228:231], a[92:95], v[116:119], v[228:231]
    ds_read_b128 v[100:103], v159 offset:6656
    buffer_load_dwordx4 v157, s[44:47], s13 offen offset:1024 sc1 lds
    s_bfe_u32 s4, s2, 0x20003
    s_mul_i32 s4, s4, 9
    s_lshl1_add_u32 s7, s72, s4
    s_and_b32 s8, s3, 1
    s_add_u32 s7, s7, s8
    s_lshl_b32 s37, s7, 16
    s_add_u32 s37, s37, 4718592
    s_add_u32 s4, s4, 8
    s_lshl_b32 s16, s4, 16
    s_add_u32 s16, s16, 4718592
    s_sub_u32 s4, s4, s7
    s_lshl_b32 s4, s4, 7
    s_lshl_b32 s7, s7, 7
    s_add_u32 s7, s7, 12582912
    v_bfe_u32 v24, v2, 2, 1
    v_mfma_f32_16x16x32_bf16 v[228:231], a[84:87], v[112:115], v[228:231]
    ds_read_b64_tr_b16 a[144:145], v152 offset:32768
    v_mfma_f32_16x16x32_bf16 v[236:239], a[84:87], v[120:123], v[236:239]
    ds_read_b64_tr_b16 a[146:147], v152 offset:33792
    v_mfma_f32_16x16x32_bf16 v[236:239], a[92:95], v[124:127], v[236:239]
    buffer_load_dwordx4 v158, s[44:47], s13 offen offset:2048 sc1 lds
    v_mfma_f32_16x16x32_bf16 v[232:235], a[88:91], v[124:127], v[232:235]
    ds_read_b64_tr_b16 a[148:149], v153 offset:32768
    v_mfma_f32_16x16x32_bf16 v[232:235], a[80:83], v[120:123], v[232:235]
    ds_read_b64_tr_b16 a[150:151], v153 offset:33792
    s_waitcnt lgkmcnt(4)
    v_mfma_f32_16x16x32_bf16 v[192:195], a[96:99], v[80:83], v[192:195]
    s_add_u32 m0, s73, 0
    s_mul_i32 s14, s78, 589824
    v_mfma_f32_16x16x32_bf16 v[192:195], a[104:107], v[84:87], v[192:195]
    ds_read_b128 v[104:107], v159 offset:768
    v_mfma_f32_16x16x32_bf16 v[196:199], a[108:111], v[84:87], v[196:199]
    ds_read_b128 v[108:111], v159 offset:6912
    buffer_load_dwordx4 v148, s[48:51], s14 offen offset:0 lds
    v_mfma_f32_16x16x32_bf16 v[196:199], a[100:103], v[80:83], v[196:199]
    ds_read_b128 v[112:115], v159 offset:1024
    v_mfma_f32_16x16x32_bf16 v[204:207], a[100:103], v[88:91], v[204:207]
    ds_read_b128 v[116:119], v159 offset:7168
    buffer_load_dwordx4 v149, s[48:51], s14 offen offset:1024 lds
    v_mfma_f32_16x16x32_bf16 v[204:207], a[108:111], v[92:95], v[204:207]
    ds_read_b128 v[120:123], v159 offset:1280
    v_mfma_f32_16x16x32_bf16 v[200:203], a[104:107], v[92:95], v[200:203]
    ds_read_b128 v[124:127], v159 offset:7424
    v_mul_u32_u24 v24, s4, v24
    v_and_b32 v25, 3, v2
    v_lshl_add_u32 v24, v25, 2, v24
    v_add_u32 v188, s7, v24
    s_lshl2_add_u32 s7, s2, s3
    s_mul_i32 s8, s7, 3072
    s_add_u32 s34, s8, 22953984
    s_add_u32 s11, s8, 26099712
    s_add_u32 s12, s8, 29245440
    s_lshl_b32 s35, s7, 12
    s_add_u32 s35, s35, 32391168
    s_xor_b32 s8, s7, 8
    s_mul_i32 s8, s8, 3072
    s_add_u32 s30, s8, 22953984
    v_mfma_f32_16x16x32_bf16 v[200:203], a[96:99], v[88:91], v[200:203]
    ds_read_b64_tr_b16 a[152:153], v152 offset:40960
    buffer_load_dwordx4 v150, s[48:51], s14 offen offset:2048 lds
    v_mfma_f32_16x16x32_bf16 v[208:211], a[96:99], v[96:99], v[208:211]
    ds_read_b64_tr_b16 a[154:155], v152 offset:41984
    v_mfma_f32_16x16x32_bf16 v[208:211], a[104:107], v[100:103], v[208:211]
    buffer_load_dwordx4 v151, s[48:51], s14 offen offset:3072 lds
    v_mfma_f32_16x16x32_bf16 v[212:215], a[108:111], v[100:103], v[212:215]
    ds_read_b64_tr_b16 a[156:157], v153 offset:40960
    v_mfma_f32_16x16x32_bf16 v[212:215], a[100:103], v[96:99], v[212:215]
    ds_read_b64_tr_b16 a[158:159], v153 offset:41984
    s_waitcnt lgkmcnt(4)
    v_mfma_f32_16x16x32_bf16 v[220:223], a[100:103], v[104:107], v[220:223]
    s_waitcnt vmcnt(14)
    s_barrier
    v_mfma_f32_16x16x32_bf16 v[220:223], a[108:111], v[108:111], v[220:223]
    ds_read_b128 v[80:83], v159 offset:12288
    s_add_u32 m0, s74, 0
    s_mul_i32 s13, s78, 90112
    v_mfma_f32_16x16x32_bf16 v[216:219], a[104:107], v[108:111], v[216:219]
    ds_read_b128 v[84:87], v159 offset:18432
    v_mfma_f32_16x16x32_bf16 v[216:219], a[96:99], v[104:107], v[216:219]
    ds_read_b128 v[88:91], v159 offset:12544
    buffer_load_dwordx4 v156, s[44:47], s13 offen offset:0 sc1 lds
    v_mfma_f32_16x16x32_bf16 v[224:227], a[96:99], v[112:115], v[224:227]
    ds_read_b128 v[92:95], v159 offset:18688
    v_mfma_f32_16x16x32_bf16 v[224:227], a[104:107], v[116:119], v[224:227]
    ds_read_b128 v[96:99], v159 offset:12800
    v_mfma_f32_16x16x32_bf16 v[228:231], a[108:111], v[116:119], v[228:231]
    ds_read_b128 v[100:103], v159 offset:18944
    buffer_load_dwordx4 v157, s[44:47], s13 offen offset:1024 sc1 lds
    s_xor_b32 s8, s7, 16
    s_mul_i32 s8, s8, 3072
    s_add_u32 s15, s8, 26099712
    s_xor_b32 s8, s7, 24
    s_mul_i32 s8, s8, 3072
    s_add_u32 s31, s8, 29245440
    s_andn2_b32 s7, s7, 24
    s_lshl3_add_u32 s7, s3, s7
    s_lshl2_add_u32 s8, s7, s72
    s_lshl_b32 s8, s8, 10
    s_add_u32 s32, s8, 32391168
    s_xor_b32 s8, s8, 4096
    v_mfma_f32_16x16x32_bf16 v[228:231], a[100:103], v[112:115], v[228:231]
    ds_read_b64_tr_b16 a[160:161], v152 offset:49152
    v_mfma_f32_16x16x32_bf16 v[236:239], a[100:103], v[120:123], v[236:239]
    ds_read_b64_tr_b16 a[162:163], v152 offset:50176
    v_mfma_f32_16x16x32_bf16 v[236:239], a[108:111], v[124:127], v[236:239]
    buffer_load_dwordx4 v158, s[44:47], s13 offen offset:2048 sc1 lds
    v_mfma_f32_16x16x32_bf16 v[232:235], a[104:107], v[124:127], v[232:235]
    ds_read_b64_tr_b16 a[164:165], v153 offset:49152
    v_mfma_f32_16x16x32_bf16 v[232:235], a[96:99], v[120:123], v[232:235]
    ds_read_b64_tr_b16 a[166:167], v153 offset:50176
    s_waitcnt lgkmcnt(4)
    v_mfma_f32_16x16x32_bf16 v[192:195], a[112:115], v[80:83], v[192:195]
    s_add_u32 m0, s73, 16384
    s_mul_i32 s14, s79, 589824
    v_mfma_f32_16x16x32_bf16 v[192:195], a[120:123], v[84:87], v[192:195]
    ds_read_b128 v[104:107], v159 offset:13056
    v_mfma_f32_16x16x32_bf16 v[196:199], a[124:127], v[84:87], v[196:199]
    ds_read_b128 v[108:111], v159 offset:19200
    buffer_load_dwordx4 v148, s[48:51], s14 offen offset:0 lds
    v_mfma_f32_16x16x32_bf16 v[196:199], a[116:119], v[80:83], v[196:199]
    ds_read_b128 v[112:115], v159 offset:13312
    v_mfma_f32_16x16x32_bf16 v[204:207], a[116:119], v[88:91], v[204:207]
    ds_read_b128 v[116:119], v159 offset:19456
    buffer_load_dwordx4 v149, s[48:51], s14 offen offset:1024 lds
    v_mfma_f32_16x16x32_bf16 v[204:207], a[124:127], v[92:95], v[204:207]
    ds_read_b128 v[120:123], v159 offset:13568
    v_mfma_f32_16x16x32_bf16 v[200:203], a[120:123], v[92:95], v[200:203]
    ds_read_b128 v[124:127], v159 offset:19712
    s_add_u32 s33, s8, 32391168
    s_xor_b32 s8, s3, s72
    s_cmp_lt_u32 s8, 2
    s_cselect_b32 s35, s35, 0x40000000
    s_cselect_b32 s16, s16, 0x40000000
    s_cselect_b32 s36, s68, 0
    s_mov_b32 s38, 0xbfb8aa3b
    s_and_b32 s8, s8, 1
    s_mul_i32 s41, s8, 96
    s_and_b32 s43, s73, 4096
    v_lshlrev_b32 v24, 10, v2
    v_add_u32 v24, s35, v24
    s_add_u32 s7, s34, 2048
    v_mov_b32 v25, s36
    v_mfma_f32_16x16x32_bf16 v[200:203], a[112:115], v[88:91], v[200:203]
    ds_read_b64_tr_b16 a[168:169], v152 offset:57344
    buffer_load_dwordx4 v150, s[48:51], s14 offen offset:2048 lds
    v_mfma_f32_16x16x32_bf16 v[208:211], a[112:115], v[96:99], v[208:211]
    ds_read_b64_tr_b16 a[170:171], v152 offset:58368
    v_mfma_f32_16x16x32_bf16 v[208:211], a[120:123], v[100:103], v[208:211]
    buffer_load_dwordx4 v151, s[48:51], s14 offen offset:3072 lds
    v_mfma_f32_16x16x32_bf16 v[212:215], a[124:127], v[100:103], v[212:215]
    ds_read_b64_tr_b16 a[172:173], v153 offset:57344
    v_mfma_f32_16x16x32_bf16 v[212:215], a[116:119], v[96:99], v[212:215]
    ds_read_b64_tr_b16 a[174:175], v153 offset:58368
    s_waitcnt lgkmcnt(4)
    v_mfma_f32_16x16x32_bf16 v[220:223], a[116:119], v[104:107], v[220:223]
    s_waitcnt vmcnt(14)
    s_barrier
    v_mfma_f32_16x16x32_bf16 v[220:223], a[124:127], v[108:111], v[220:223]
    ds_read_b128 v[80:83], v159 offset:24576
    s_add_u32 m0, s74, 12288
    s_mul_i32 s13, s79, 90112
    v_mfma_f32_16x16x32_bf16 v[216:219], a[120:123], v[108:111], v[216:219]
    ds_read_b128 v[84:87], v159 offset:30720
    v_mfma_f32_16x16x32_bf16 v[216:219], a[112:115], v[104:107], v[216:219]
    ds_read_b128 v[88:91], v159 offset:24832
    buffer_load_dwordx4 v156, s[44:47], s13 offen offset:0 sc1 lds
    v_mfma_f32_16x16x32_bf16 v[224:227], a[112:115], v[112:115], v[224:227]
    ds_read_b128 v[92:95], v159 offset:30976
    v_mfma_f32_16x16x32_bf16 v[224:227], a[120:123], v[116:119], v[224:227]
    ds_read_b128 v[96:99], v159 offset:25088
    v_mfma_f32_16x16x32_bf16 v[228:231], a[124:127], v[116:119], v[228:231]
    ds_read_b128 v[100:103], v159 offset:31232
    buffer_load_dwordx4 v157, s[44:47], s13 offen offset:1024 sc1 lds
    v_cmp_gt_u32 vcc, 4, v2
    s_nop 1
    v_cndmask_b32 v138, 0, v25, vcc
    v_mov_b32 v25, 0x40000000
    v_cndmask_b32 v137, v25, v24, vcc
    v_writelane_b32 v137, s7, 4
    v_writelane_b32 v138, s68, 4
    v_min_u32 v139, 1, v2
    v_lshlrev_b32 v139, 30, v139
    v_mov_b32 v140, 0
    v_writelane_b32 v140, s68, 0
    v_mfma_f32_16x16x32_bf16 v[228:231], a[116:119], v[112:115], v[228:231]
    ds_read_b64_tr_b16 a[176:177], v154 offset:0
    v_mfma_f32_16x16x32_bf16 v[236:239], a[116:119], v[120:123], v[236:239]
    ds_read_b64_tr_b16 a[178:179], v154 offset:1024
    v_mfma_f32_16x16x32_bf16 v[236:239], a[124:127], v[124:127], v[236:239]
    buffer_load_dwordx4 v158, s[44:47], s13 offen offset:2048 sc1 lds
    v_mfma_f32_16x16x32_bf16 v[232:235], a[120:123], v[124:127], v[232:235]
    ds_read_b64_tr_b16 a[180:181], v155 offset:0
    v_mfma_f32_16x16x32_bf16 v[232:235], a[112:115], v[120:123], v[232:235]
    ds_read_b64_tr_b16 a[182:183], v155 offset:1024
    s_waitcnt lgkmcnt(4)
    v_mfma_f32_16x16x32_bf16 v[192:195], a[128:131], v[80:83], v[192:195]
    s_add_u32 m0, s73, 32768
    s_mul_i32 s14, s80, 589824
    v_mfma_f32_16x16x32_bf16 v[192:195], a[136:139], v[84:87], v[192:195]
    ds_read_b128 v[104:107], v159 offset:25344
    v_mfma_f32_16x16x32_bf16 v[196:199], a[140:143], v[84:87], v[196:199]
    ds_read_b128 v[108:111], v159 offset:31488
    buffer_load_dwordx4 v148, s[48:51], s14 offen offset:0 lds
    v_mfma_f32_16x16x32_bf16 v[196:199], a[132:135], v[80:83], v[196:199]
    ds_read_b128 v[112:115], v159 offset:25600
    v_mfma_f32_16x16x32_bf16 v[204:207], a[132:135], v[88:91], v[204:207]
    ds_read_b128 v[116:119], v159 offset:31744
    buffer_load_dwordx4 v149, s[48:51], s14 offen offset:1024 lds
    v_mfma_f32_16x16x32_bf16 v[204:207], a[140:143], v[92:95], v[204:207]
    ds_read_b128 v[120:123], v159 offset:25856
    v_mfma_f32_16x16x32_bf16 v[200:203], a[136:139], v[92:95], v[200:203]
    ds_read_b128 v[124:127], v159 offset:32000
    v_mfma_f32_16x16x32_bf16 v[200:203], a[128:131], v[88:91], v[200:203]
    ds_read_b64_tr_b16 a[184:185], v154 offset:8192
    buffer_load_dwordx4 v150, s[48:51], s14 offen offset:2048 lds
    v_mfma_f32_16x16x32_bf16 v[208:211], a[128:131], v[96:99], v[208:211]
    ds_read_b64_tr_b16 a[186:187], v154 offset:9216
    v_mfma_f32_16x16x32_bf16 v[208:211], a[136:139], v[100:103], v[208:211]
    buffer_load_dwordx4 v151, s[48:51], s14 offen offset:3072 lds
    v_mfma_f32_16x16x32_bf16 v[212:215], a[140:143], v[100:103], v[212:215]
    ds_read_b64_tr_b16 a[188:189], v155 offset:8192
    v_mfma_f32_16x16x32_bf16 v[212:215], a[132:135], v[96:99], v[212:215]
    ds_read_b64_tr_b16 a[190:191], v155 offset:9216
    s_waitcnt lgkmcnt(4)
    v_mfma_f32_16x16x32_bf16 v[220:223], a[132:135], v[104:107], v[220:223]
    s_waitcnt vmcnt(14)
    s_barrier
    v_mfma_f32_16x16x32_bf16 v[220:223], a[140:143], v[108:111], v[220:223]
    ds_read_b128 v[80:83], v250 offset:0
    s_add_u32 m0, s74, 24576
    s_mul_i32 s13, s80, 90112
    v_mfma_f32_16x16x32_bf16 v[216:219], a[136:139], v[108:111], v[216:219]
    ds_read_b128 v[84:87], v250 offset:6144
    v_mfma_f32_16x16x32_bf16 v[216:219], a[128:131], v[104:107], v[216:219]
    ds_read_b128 v[88:91], v250 offset:256
    buffer_load_dwordx4 v156, s[44:47], s13 offen offset:0 sc1 lds
    v_mfma_f32_16x16x32_bf16 v[224:227], a[128:131], v[112:115], v[224:227]
    ds_read_b128 v[92:95], v250 offset:6400
    v_mfma_f32_16x16x32_bf16 v[224:227], a[136:139], v[116:119], v[224:227]
    ds_read_b128 v[96:99], v250 offset:512
    v_mfma_f32_16x16x32_bf16 v[228:231], a[140:143], v[116:119], v[228:231]
    ds_read_b128 v[100:103], v250 offset:6656
    buffer_load_dwordx4 v157, s[44:47], s13 offen offset:1024 sc1 lds
    v_mfma_f32_16x16x32_bf16 v[228:231], a[132:135], v[112:115], v[228:231]
    ds_read_b64_tr_b16 a[192:193], v152 offset:0
    v_mfma_f32_16x16x32_bf16 v[236:239], a[132:135], v[120:123], v[236:239]
    ds_read_b64_tr_b16 a[194:195], v152 offset:1024
    v_mfma_f32_16x16x32_bf16 v[236:239], a[140:143], v[124:127], v[236:239]
    buffer_load_dwordx4 v158, s[44:47], s13 offen offset:2048 sc1 lds
    v_mfma_f32_16x16x32_bf16 v[232:235], a[136:139], v[124:127], v[232:235]
    ds_read_b64_tr_b16 a[196:197], v153 offset:0
    v_mfma_f32_16x16x32_bf16 v[232:235], a[128:131], v[120:123], v[232:235]
    ds_read_b64_tr_b16 a[198:199], v153 offset:1024
    s_waitcnt lgkmcnt(4)
    v_mfma_f32_16x16x32_bf16 v[192:195], a[144:147], v[80:83], v[192:195]
    s_add_u32 m0, s73, 49152
    s_mul_i32 s14, s81, 589824
    v_mfma_f32_16x16x32_bf16 v[192:195], a[152:155], v[84:87], v[192:195]
    ds_read_b128 v[104:107], v250 offset:768
    v_mfma_f32_16x16x32_bf16 v[196:199], a[156:159], v[84:87], v[196:199]
    ds_read_b128 v[108:111], v250 offset:6912
    buffer_load_dwordx4 v148, s[48:51], s14 offen offset:0 lds
    v_mfma_f32_16x16x32_bf16 v[196:199], a[148:151], v[80:83], v[196:199]
    ds_read_b128 v[112:115], v250 offset:1024
    v_mfma_f32_16x16x32_bf16 v[204:207], a[148:151], v[88:91], v[204:207]
    ds_read_b128 v[116:119], v250 offset:7168
    buffer_load_dwordx4 v149, s[48:51], s14 offen offset:1024 lds
    v_mfma_f32_16x16x32_bf16 v[204:207], a[156:159], v[92:95], v[204:207]
    ds_read_b128 v[120:123], v250 offset:1280
    v_mfma_f32_16x16x32_bf16 v[200:203], a[152:155], v[92:95], v[200:203]
    ds_read_b128 v[124:127], v250 offset:7424
    v_mfma_f32_16x16x32_bf16 v[200:203], a[144:147], v[88:91], v[200:203]
    ds_read_b64_tr_b16 a[200:201], v152 offset:8192
    buffer_load_dwordx4 v150, s[48:51], s14 offen offset:2048 lds
    v_mfma_f32_16x16x32_bf16 v[208:211], a[144:147], v[96:99], v[208:211]
    ds_read_b64_tr_b16 a[202:203], v152 offset:9216
    v_mfma_f32_16x16x32_bf16 v[208:211], a[152:155], v[100:103], v[208:211]
    buffer_load_dwordx4 v151, s[48:51], s14 offen offset:3072 lds
    v_mfma_f32_16x16x32_bf16 v[212:215], a[156:159], v[100:103], v[212:215]
    ds_read_b64_tr_b16 a[204:205], v153 offset:8192
    v_mfma_f32_16x16x32_bf16 v[212:215], a[148:151], v[96:99], v[212:215]
    ds_read_b64_tr_b16 a[206:207], v153 offset:9216
    s_waitcnt lgkmcnt(4)
    v_mfma_f32_16x16x32_bf16 v[220:223], a[148:151], v[104:107], v[220:223]
    s_waitcnt vmcnt(14)
    s_barrier
    v_mfma_f32_16x16x32_bf16 v[220:223], a[156:159], v[108:111], v[220:223]
    ds_read_b128 v[80:83], v250 offset:12288
    s_add_u32 m0, s74, 36864
    s_mul_i32 s13, s81, 90112
    v_mfma_f32_16x16x32_bf16 v[216:219], a[152:155], v[108:111], v[216:219]
    ds_read_b128 v[84:87], v250 offset:18432
    v_mfma_f32_16x16x32_bf16 v[216:219], a[144:147], v[104:107], v[216:219]
    ds_read_b128 v[88:91], v250 offset:12544
    buffer_load_dwordx4 v156, s[44:47], s13 offen offset:0 sc1 lds
    v_mfma_f32_16x16x32_bf16 v[224:227], a[144:147], v[112:115], v[224:227]
    ds_read_b128 v[92:95], v250 offset:18688
    v_mfma_f32_16x16x32_bf16 v[224:227], a[152:155], v[116:119], v[224:227]
    ds_read_b128 v[96:99], v250 offset:12800
    v_mfma_f32_16x16x32_bf16 v[228:231], a[156:159], v[116:119], v[228:231]
    ds_read_b128 v[100:103], v250 offset:18944
    buffer_load_dwordx4 v157, s[44:47], s13 offen offset:1024 sc1 lds
    v_mfma_f32_16x16x32_bf16 v[228:231], a[148:151], v[112:115], v[228:231]
    ds_read_b64_tr_b16 a[208:209], v152 offset:16384
    v_mfma_f32_16x16x32_bf16 v[236:239], a[148:151], v[120:123], v[236:239]
    ds_read_b64_tr_b16 a[210:211], v152 offset:17408
    v_mfma_f32_16x16x32_bf16 v[236:239], a[156:159], v[124:127], v[236:239]
    buffer_load_dwordx4 v158, s[44:47], s13 offen offset:2048 sc1 lds
    v_mfma_f32_16x16x32_bf16 v[232:235], a[152:155], v[124:127], v[232:235]
    ds_read_b64_tr_b16 a[212:213], v153 offset:16384
    v_mfma_f32_16x16x32_bf16 v[232:235], a[144:147], v[120:123], v[232:235]
    ds_read_b64_tr_b16 a[214:215], v153 offset:17408
    s_waitcnt lgkmcnt(4)
    v_mfma_f32_16x16x32_bf16 v[192:195], a[160:163], v[80:83], v[192:195]
    s_add_u32 m0, s73, 65536
    s_lshl_b32 s14, s84, 18
    v_mfma_f32_16x16x32_bf16 v[192:195], a[168:171], v[84:87], v[192:195]
    ds_read_b128 v[104:107], v250 offset:13056
    v_mfma_f32_16x16x32_bf16 v[196:199], a[172:175], v[84:87], v[196:199]
    ds_read_b128 v[108:111], v250 offset:19200
    buffer_load_dwordx4 v4, s[52:55], s14 offen offset:0 lds
    v_mfma_f32_16x16x32_bf16 v[196:199], a[164:167], v[80:83], v[196:199]
    ds_read_b128 v[112:115], v250 offset:13312
    v_mfma_f32_16x16x32_bf16 v[204:207], a[164:167], v[88:91], v[204:207]
    ds_read_b128 v[116:119], v250 offset:19456
    buffer_load_dwordx4 v5, s[52:55], s14 offen offset:1024 lds
    v_mfma_f32_16x16x32_bf16 v[204:207], a[172:175], v[92:95], v[204:207]
    ds_read_b128 v[120:123], v250 offset:13568
    v_mfma_f32_16x16x32_bf16 v[200:203], a[168:171], v[92:95], v[200:203]
    ds_read_b128 v[124:127], v250 offset:19712
    v_mfma_f32_16x16x32_bf16 v[200:203], a[160:163], v[88:91], v[200:203]
    ds_read_b64_tr_b16 a[216:217], v152 offset:24576
    buffer_load_dwordx4 v6, s[52:55], s14 offen offset:2048 lds
    v_mfma_f32_16x16x32_bf16 v[208:211], a[160:163], v[96:99], v[208:211]
    ds_read_b64_tr_b16 a[218:219], v152 offset:25600
    v_mfma_f32_16x16x32_bf16 v[208:211], a[168:171], v[100:103], v[208:211]
    buffer_load_dwordx4 v7, s[52:55], s14 offen offset:3072 lds
    v_mfma_f32_16x16x32_bf16 v[212:215], a[172:175], v[100:103], v[212:215]
    ds_read_b64_tr_b16 a[220:221], v153 offset:24576
    v_mfma_f32_16x16x32_bf16 v[212:215], a[164:167], v[96:99], v[212:215]
    ds_read_b64_tr_b16 a[222:223], v153 offset:25600
    s_waitcnt lgkmcnt(4)
    v_mfma_f32_16x16x32_bf16 v[220:223], a[164:167], v[104:107], v[220:223]
    s_waitcnt vmcnt(14)
    s_barrier
    v_mfma_f32_16x16x32_bf16 v[220:223], a[172:175], v[108:111], v[220:223]
    ds_read_b128 v[80:83], v250 offset:24576
    v_mfma_f32_16x16x32_bf16 v[216:219], a[168:171], v[108:111], v[216:219]
    ds_read_b128 v[84:87], v250 offset:30720
    v_mfma_f32_16x16x32_bf16 v[216:219], a[160:163], v[104:107], v[216:219]
    ds_read_b128 v[88:91], v250 offset:24832
    v_mfma_f32_16x16x32_bf16 v[224:227], a[160:163], v[112:115], v[224:227]
    ds_read_b128 v[92:95], v250 offset:30976
    v_mfma_f32_16x16x32_bf16 v[224:227], a[168:171], v[116:119], v[224:227]
    ds_read_b128 v[96:99], v250 offset:25088
    v_mfma_f32_16x16x32_bf16 v[228:231], a[172:175], v[116:119], v[228:231]
    ds_read_b128 v[100:103], v250 offset:31232
    v_mfma_f32_16x16x32_bf16 v[228:231], a[164:167], v[112:115], v[228:231]
    ds_read_b64_tr_b16 a[224:225], v152 offset:32768
    v_mfma_f32_16x16x32_bf16 v[236:239], a[164:167], v[120:123], v[236:239]
    ds_read_b64_tr_b16 a[226:227], v152 offset:33792
    v_mfma_f32_16x16x32_bf16 v[236:239], a[172:175], v[124:127], v[236:239]
    v_mfma_f32_16x16x32_bf16 v[232:235], a[168:171], v[124:127], v[232:235]
    ds_read_b64_tr_b16 a[228:229], v153 offset:32768
    v_mfma_f32_16x16x32_bf16 v[232:235], a[160:163], v[120:123], v[232:235]
    ds_read_b64_tr_b16 a[230:231], v153 offset:33792
    s_waitcnt lgkmcnt(4)
    v_mfma_f32_16x16x32_bf16 v[192:195], a[176:179], v[80:83], v[192:195]
    v_mfma_f32_16x16x32_bf16 v[192:195], a[184:187], v[84:87], v[192:195]
    ds_read_b128 v[104:107], v250 offset:25344
    v_mfma_f32_16x16x32_bf16 v[196:199], a[188:191], v[84:87], v[196:199]
    ds_read_b128 v[108:111], v250 offset:31488
    v_mfma_f32_16x16x32_bf16 v[196:199], a[180:183], v[80:83], v[196:199]
    ds_read_b128 v[112:115], v250 offset:25600
    v_mfma_f32_16x16x32_bf16 v[204:207], a[180:183], v[88:91], v[204:207]
    ds_read_b128 v[116:119], v250 offset:31744
    v_mfma_f32_16x16x32_bf16 v[204:207], a[188:191], v[92:95], v[204:207]
    ds_read_b128 v[120:123], v250 offset:25856
    v_mfma_f32_16x16x32_bf16 v[200:203], a[184:187], v[92:95], v[200:203]
    ds_read_b128 v[124:127], v250 offset:32000
    v_mfma_f32_16x16x32_bf16 v[200:203], a[176:179], v[88:91], v[200:203]
    ds_read_b64_tr_b16 a[232:233], v152 offset:40960
    v_mfma_f32_16x16x32_bf16 v[208:211], a[176:179], v[96:99], v[208:211]
    ds_read_b64_tr_b16 a[234:235], v152 offset:41984
    v_mfma_f32_16x16x32_bf16 v[208:211], a[184:187], v[100:103], v[208:211]
    v_mfma_f32_16x16x32_bf16 v[212:215], a[188:191], v[100:103], v[212:215]
    ds_read_b64_tr_b16 a[236:237], v153 offset:40960
    v_mfma_f32_16x16x32_bf16 v[212:215], a[180:183], v[96:99], v[212:215]
    ds_read_b64_tr_b16 a[238:239], v153 offset:41984
    s_waitcnt lgkmcnt(4)
    v_mfma_f32_16x16x32_bf16 v[220:223], a[180:183], v[104:107], v[220:223]
    s_waitcnt vmcnt(7)
    s_barrier
    v_mfma_f32_16x16x32_bf16 v[220:223], a[188:191], v[108:111], v[220:223]
    ds_read_b128 v[80:83], v159 offset:0
    v_mfma_f32_16x16x32_bf16 v[216:219], a[184:187], v[108:111], v[216:219]
    ds_read_b128 v[84:87], v159 offset:6144
    v_mfma_f32_16x16x32_bf16 v[216:219], a[176:179], v[104:107], v[216:219]
    ds_read_b128 v[88:91], v159 offset:256
    v_mfma_f32_16x16x32_bf16 v[224:227], a[176:179], v[112:115], v[224:227]
    ds_read_b128 v[92:95], v159 offset:6400
    v_mfma_f32_16x16x32_bf16 v[224:227], a[184:187], v[116:119], v[224:227]
    ds_read_b128 v[96:99], v159 offset:512
    v_mfma_f32_16x16x32_bf16 v[228:231], a[188:191], v[116:119], v[228:231]
    ds_read_b128 v[100:103], v159 offset:6656
    v_mfma_f32_16x16x32_bf16 v[228:231], a[180:183], v[112:115], v[228:231]
    ds_read_b64_tr_b16 a[240:241], v152 offset:49152
    v_mfma_f32_16x16x32_bf16 v[236:239], a[180:183], v[120:123], v[236:239]
    ds_read_b64_tr_b16 a[242:243], v152 offset:50176
    v_mfma_f32_16x16x32_bf16 v[236:239], a[188:191], v[124:127], v[236:239]
    v_mfma_f32_16x16x32_bf16 v[232:235], a[184:187], v[124:127], v[232:235]
    ds_read_b64_tr_b16 a[244:245], v153 offset:49152
    v_mfma_f32_16x16x32_bf16 v[232:235], a[176:179], v[120:123], v[232:235]
    ds_read_b64_tr_b16 a[246:247], v153 offset:50176
    s_waitcnt lgkmcnt(4)
    v_mfma_f32_16x16x32_bf16 v[192:195], a[192:195], v[80:83], v[192:195]
    v_mfma_f32_16x16x32_bf16 v[192:195], a[200:203], v[84:87], v[192:195]
    ds_read_b128 v[104:107], v159 offset:768
    v_mfma_f32_16x16x32_bf16 v[196:199], a[204:207], v[84:87], v[196:199]
    ds_read_b128 v[108:111], v159 offset:6912
    v_mfma_f32_16x16x32_bf16 v[196:199], a[196:199], v[80:83], v[196:199]
    ds_read_b128 v[112:115], v159 offset:1024
    v_mfma_f32_16x16x32_bf16 v[204:207], a[196:199], v[88:91], v[204:207]
    ds_read_b128 v[116:119], v159 offset:7168
    v_mfma_f32_16x16x32_bf16 v[204:207], a[204:207], v[92:95], v[204:207]
L_pl_G_3:
    s_cbranch_execz L_wret
    ds_read_b128 v[120:123], v159 offset:1280
    v_mfma_f32_16x16x32_bf16 v[200:203], a[200:203], v[92:95], v[200:203]
    ds_read_b128 v[124:127], v159 offset:7424
    v_mfma_f32_16x16x32_bf16 v[200:203], a[192:195], v[88:91], v[200:203]
    ds_read_b64_tr_b16 a[248:249], v152 offset:57344
    v_mfma_f32_16x16x32_bf16 v[208:211], a[192:195], v[96:99], v[208:211]
    ds_read_b64_tr_b16 a[250:251], v152 offset:58368
    v_mfma_f32_16x16x32_bf16 v[208:211], a[200:203], v[100:103], v[208:211]
    v_mfma_f32_16x16x32_bf16 v[212:215], a[204:207], v[100:103], v[212:215]
    ds_read_b64_tr_b16 a[252:253], v153 offset:57344
    v_mfma_f32_16x16x32_bf16 v[212:215], a[196:199], v[96:99], v[212:215]
    ds_read_b64_tr_b16 a[254:255], v153 offset:58368
    s_waitcnt lgkmcnt(4)
    v_mfma_f32_16x16x32_bf16 v[220:223], a[196:199], v[104:107], v[220:223]
    s_barrier
    v_mfma_f32_16x16x32_bf16 v[220:223], a[204:207], v[108:111], v[220:223]
    ds_read_b128 v[80:83], v159 offset:12288
    s_add_u32 m0, s74, 49152
    s_mul_i32 s13, s18, 90112
    v_mfma_f32_16x16x32_bf16 v[216:219], a[200:203], v[108:111], v[216:219]
    ds_read_b128 v[84:87], v159 offset:18432
    v_mfma_f32_16x16x32_bf16 v[216:219], a[192:195], v[104:107], v[216:219]
    ds_read_b128 v[88:91], v159 offset:12544
    buffer_load_dwordx4 v8, s[44:47], s13 offen offset:0 sc1 lds
    v_mfma_f32_16x16x32_bf16 v[224:227], a[192:195], v[112:115], v[224:227]
    ds_read_b128 v[92:95], v159 offset:18688
    v_mfma_f32_16x16x32_bf16 v[224:227], a[200:203], v[116:119], v[224:227]
    ds_read_b128 v[96:99], v159 offset:12800
    v_mfma_f32_16x16x32_bf16 v[228:231], a[204:207], v[116:119], v[228:231]
    ds_read_b128 v[100:103], v159 offset:18944
    buffer_load_dwordx4 v9, s[44:47], s13 offen offset:1024 sc1 lds
    v_mfma_f32_16x16x32_bf16 v[228:231], a[196:199], v[112:115], v[228:231]
    v_mfma_f32_16x16x32_bf16 v[236:239], a[196:199], v[120:123], v[236:239]
    v_mfma_f32_16x16x32_bf16 v[236:239], a[204:207], v[124:127], v[236:239]
    buffer_load_dwordx4 v3, s[44:47], s13 offen offset:2048 sc1 lds
    v_mfma_f32_16x16x32_bf16 v[232:235], a[200:203], v[124:127], v[232:235]
    v_mfma_f32_16x16x32_bf16 v[232:235], a[192:195], v[120:123], v[232:235]
    s_waitcnt lgkmcnt(0)
    v_mfma_f32_16x16x32_bf16 v[192:195], a[208:211], v[80:83], v[192:195]
    s_add_u32 m0, s74, 61440
    s_mul_i32 s13, s19, 90112
    v_mfma_f32_16x16x32_bf16 v[192:195], a[216:219], v[84:87], v[192:195]
    ds_read_b128 v[104:107], v159 offset:13056
    v_mfma_f32_16x16x32_bf16 v[196:199], a[220:223], v[84:87], v[196:199]
    ds_read_b128 v[108:111], v159 offset:19200
    v_mfma_f32_16x16x32_bf16 v[196:199], a[212:215], v[80:83], v[196:199]
    ds_read_b128 v[112:115], v159 offset:13312
    buffer_load_dwordx4 v8, s[44:47], s13 offen offset:0 sc1 lds
    v_mfma_f32_16x16x32_bf16 v[204:207], a[212:215], v[88:91], v[204:207]
    ds_read_b128 v[116:119], v159 offset:19456
    v_mfma_f32_16x16x32_bf16 v[204:207], a[220:223], v[92:95], v[204:207]
    ds_read_b128 v[120:123], v159 offset:13568
    v_mfma_f32_16x16x32_bf16 v[200:203], a[216:219], v[92:95], v[200:203]
    ds_read_b128 v[124:127], v159 offset:19712
    buffer_load_dwordx4 v9, s[44:47], s13 offen offset:1024 sc1 lds
    v_mfma_f32_16x16x32_bf16 v[200:203], a[208:211], v[88:91], v[200:203]
    v_mfma_f32_16x16x32_bf16 v[208:211], a[208:211], v[96:99], v[208:211]
    v_mfma_f32_16x16x32_bf16 v[208:211], a[216:219], v[100:103], v[208:211]
    buffer_load_dwordx4 v3, s[44:47], s13 offen offset:2048 sc1 lds
    v_mfma_f32_16x16x32_bf16 v[212:215], a[220:223], v[100:103], v[212:215]
    v_mfma_f32_16x16x32_bf16 v[212:215], a[212:215], v[96:99], v[212:215]
    s_waitcnt lgkmcnt(0)
    v_mfma_f32_16x16x32_bf16 v[220:223], a[212:215], v[104:107], v[220:223]
    s_barrier
    v_mfma_f32_16x16x32_bf16 v[220:223], a[220:223], v[108:111], v[220:223]
    ds_read_b128 v[80:83], v159 offset:24576
    s_add_u32 m0, s74, 0
    s_mul_i32 s13, s20, 90112
    v_mfma_f32_16x16x32_bf16 v[216:219], a[216:219], v[108:111], v[216:219]
    ds_read_b128 v[84:87], v159 offset:30720
    v_mfma_f32_16x16x32_bf16 v[216:219], a[208:211], v[104:107], v[216:219]
    ds_read_b128 v[88:91], v159 offset:24832
    buffer_load_dwordx4 v8, s[44:47], s13 offen offset:0 sc1 lds
    v_mfma_f32_16x16x32_bf16 v[224:227], a[208:211], v[112:115], v[224:227]
    ds_read_b128 v[92:95], v159 offset:30976
    v_mfma_f32_16x16x32_bf16 v[224:227], a[216:219], v[116:119], v[224:227]
    ds_read_b128 v[96:99], v159 offset:25088
    v_mfma_f32_16x16x32_bf16 v[228:231], a[220:223], v[116:119], v[228:231]
    ds_read_b128 v[100:103], v159 offset:31232
    buffer_load_dwordx4 v9, s[44:47], s13 offen offset:1024 sc1 lds
    v_mfma_f32_16x16x32_bf16 v[228:231], a[212:215], v[112:115], v[228:231]
    v_mfma_f32_16x16x32_bf16 v[236:239], a[212:215], v[120:123], v[236:239]
    v_mfma_f32_16x16x32_bf16 v[236:239], a[220:223], v[124:127], v[236:239]
    buffer_load_dwordx4 v3, s[44:47], s13 offen offset:2048 sc1 lds
    v_mfma_f32_16x16x32_bf16 v[232:235], a[216:219], v[124:127], v[232:235]
    v_mfma_f32_16x16x32_bf16 v[232:235], a[208:211], v[120:123], v[232:235]
    s_waitcnt lgkmcnt(0)
    v_mfma_f32_16x16x32_bf16 v[192:195], a[224:227], v[80:83], v[192:195]
    s_add_u32 m0, s74, 12288
    s_mul_i32 s13, s21, 90112
    v_mfma_f32_16x16x32_bf16 v[192:195], a[232:235], v[84:87], v[192:195]
    ds_read_b128 v[104:107], v159 offset:25344
    v_mfma_f32_16x16x32_bf16 v[196:199], a[236:239], v[84:87], v[196:199]
    ds_read_b128 v[108:111], v159 offset:31488
    v_mfma_f32_16x16x32_bf16 v[196:199], a[228:231], v[80:83], v[196:199]
    ds_read_b128 v[112:115], v159 offset:25600
    buffer_load_dwordx4 v8, s[44:47], s13 offen offset:0 sc1 lds
    v_mfma_f32_16x16x32_bf16 v[204:207], a[228:231], v[88:91], v[204:207]
    ds_read_b128 v[116:119], v159 offset:31744
    v_mfma_f32_16x16x32_bf16 v[204:207], a[236:239], v[92:95], v[204:207]
    ds_read_b128 v[120:123], v159 offset:25856
    v_mfma_f32_16x16x32_bf16 v[200:203], a[232:235], v[92:95], v[200:203]
    ds_read_b128 v[124:127], v159 offset:32000
    buffer_load_dwordx4 v9, s[44:47], s13 offen offset:1024 sc1 lds
    v_mfma_f32_16x16x32_bf16 v[200:203], a[224:227], v[88:91], v[200:203]
    v_mfma_f32_16x16x32_bf16 v[208:211], a[224:227], v[96:99], v[208:211]
    v_mfma_f32_16x16x32_bf16 v[208:211], a[232:235], v[100:103], v[208:211]
    buffer_load_dwordx4 v3, s[44:47], s13 offen offset:2048 sc1 lds
    v_mfma_f32_16x16x32_bf16 v[212:215], a[236:239], v[100:103], v[212:215]
    v_mfma_f32_16x16x32_bf16 v[212:215], a[228:231], v[96:99], v[212:215]
    s_waitcnt lgkmcnt(0)
    v_mfma_f32_16x16x32_bf16 v[220:223], a[228:231], v[104:107], v[220:223]
    s_waitcnt vmcnt(16)
    s_barrier
    v_mfma_f32_16x16x32_bf16 v[220:223], a[236:239], v[108:111], v[220:223]
    ds_read_b128 v[80:83], v250 offset:0
    s_add_u32 m0, s74, 24576
    s_mul_i32 s13, s22, 90112
    v_mfma_f32_16x16x32_bf16 v[216:219], a[232:235], v[108:111], v[216:219]
    ds_read_b128 v[84:87], v250 offset:6144
    v_mfma_f32_16x16x32_bf16 v[216:219], a[224:227], v[104:107], v[216:219]
    ds_read_b128 v[88:91], v250 offset:256
    buffer_load_dwordx4 v8, s[44:47], s13 offen offset:0 sc1 lds
    v_mfma_f32_16x16x32_bf16 v[224:227], a[224:227], v[112:115], v[224:227]
    ds_read_b128 v[92:95], v250 offset:6400
    v_mfma_f32_16x16x32_bf16 v[224:227], a[232:235], v[116:119], v[224:227]
    ds_read_b128 v[96:99], v250 offset:512
    v_mfma_f32_16x16x32_bf16 v[228:231], a[236:239], v[116:119], v[228:231]
    ds_read_b128 v[100:103], v250 offset:6656
    buffer_load_dwordx4 v9, s[44:47], s13 offen offset:1024 sc1 lds
    v_mfma_f32_16x16x32_bf16 v[228:231], a[228:231], v[112:115], v[228:231]
    v_mfma_f32_16x16x32_bf16 v[236:239], a[228:231], v[120:123], v[236:239]
    v_mfma_f32_16x16x32_bf16 v[236:239], a[236:239], v[124:127], v[236:239]
    buffer_load_dwordx4 v3, s[44:47], s13 offen offset:2048 sc1 lds
    v_mfma_f32_16x16x32_bf16 v[232:235], a[232:235], v[124:127], v[232:235]
    v_mfma_f32_16x16x32_bf16 v[232:235], a[224:227], v[120:123], v[232:235]
    s_waitcnt lgkmcnt(0)
    v_mfma_f32_16x16x32_bf16 v[192:195], a[240:243], v[80:83], v[192:195]
    s_add_u32 m0, s73, 0
    s_lshl_b32 s14, s85, 18
    v_mfma_f32_16x16x32_bf16 v[192:195], a[248:251], v[84:87], v[192:195]
    ds_read_b128 v[104:107], v250 offset:768
    v_mfma_f32_16x16x32_bf16 v[196:199], a[252:255], v[84:87], v[196:199]
    ds_read_b128 v[108:111], v250 offset:6912
    buffer_load_dwordx4 v4, s[52:55], s14 offen offset:0 lds
    v_mfma_f32_16x16x32_bf16 v[196:199], a[244:247], v[80:83], v[196:199]
    ds_read_b128 v[112:115], v250 offset:1024
    v_mfma_f32_16x16x32_bf16 v[204:207], a[244:247], v[88:91], v[204:207]
    ds_read_b128 v[116:119], v250 offset:7168
    buffer_load_dwordx4 v5, s[52:55], s14 offen offset:1024 lds
    v_mfma_f32_16x16x32_bf16 v[204:207], a[252:255], v[92:95], v[204:207]
    ds_read_b128 v[120:123], v250 offset:1280
    v_mfma_f32_16x16x32_bf16 v[200:203], a[248:251], v[92:95], v[200:203]
    ds_read_b128 v[124:127], v250 offset:7424
    v_mfma_f32_16x16x32_bf16 v[200:203], a[240:243], v[88:91], v[200:203]
    buffer_load_dwordx4 v6, s[52:55], s14 offen offset:2048 lds
    v_mfma_f32_16x16x32_bf16 v[208:211], a[240:243], v[96:99], v[208:211]
    v_mfma_f32_16x16x32_bf16 v[208:211], a[248:251], v[100:103], v[208:211]
    buffer_load_dwordx4 v7, s[52:55], s14 offen offset:3072 lds
    v_mfma_f32_16x16x32_bf16 v[212:215], a[252:255], v[100:103], v[212:215]
    v_mfma_f32_16x16x32_bf16 v[212:215], a[244:247], v[96:99], v[212:215]
    s_waitcnt lgkmcnt(0)
    v_mfma_f32_16x16x32_bf16 v[220:223], a[244:247], v[104:107], v[220:223]
    s_waitcnt vmcnt(16)
    s_barrier
    v_mfma_f32_16x16x32_bf16 v[220:223], a[252:255], v[108:111], v[220:223]
    ds_read_b128 v[80:83], v250 offset:12288
    v_mfma_f32_16x16x32_bf16 v[216:219], a[248:251], v[108:111], v[216:219]
    ds_read_b128 v[84:87], v250 offset:18432
    v_mfma_f32_16x16x32_bf16 v[216:219], a[240:243], v[104:107], v[216:219]
    ds_read_b128 v[88:91], v250 offset:12544
    v_mfma_f32_16x16x32_bf16 v[224:227], a[240:243], v[112:115], v[224:227]
    ds_read_b128 v[92:95], v250 offset:18688
    v_cvt_pk_bf16_f32 v192, v192, v193
    v_mfma_f32_16x16x32_bf16 v[224:227], a[248:251], v[116:119], v[224:227]
    ds_read_b128 v[96:99], v250 offset:12800
    v_mfma_f32_16x16x32_bf16 v[228:231], a[252:255], v[116:119], v[228:231]
    ds_read_b128 v[100:103], v250 offset:18944
    v_cvt_pk_bf16_f32 v193, v194, v195
    v_mfma_f32_16x16x32_bf16 v[228:231], a[244:247], v[112:115], v[228:231]
    v_mfma_f32_16x16x32_bf16 v[236:239], a[244:247], v[120:123], v[236:239]
    v_cvt_pk_bf16_f32 v194, v196, v197
    v_mfma_f32_16x16x32_bf16 v[236:239], a[252:255], v[124:127], v[236:239]
    v_cvt_pk_bf16_f32 v195, v198, v199
    v_mfma_f32_16x16x32_bf16 v[232:235], a[248:251], v[124:127], v[232:235]
    v_mfma_f32_16x16x32_bf16 v[232:235], a[240:243], v[120:123], v[232:235]
    buffer_store_dwordx4 v[192:195], v246, s[44:47], s9 offen offset:0 sc1
    s_waitcnt lgkmcnt(0)
    v_mfma_f32_16x16x32_bf16 v[32:35], a[0:3], v[80:83], v[128:131]
    v_mfma_f32_16x16x32_bf16 v[32:35], a[8:11], v[84:87], v[32:35]
    ds_read_b128 v[104:107], v250 offset:13056
    v_mfma_f32_16x16x32_bf16 v[36:39], a[12:15], v[84:87], v[132:135]
    ds_read_b128 v[108:111], v250 offset:19200
    v_mfma_f32_16x16x32_bf16 v[36:39], a[4:7], v[80:83], v[36:39]
    ds_read_b128 v[112:115], v250 offset:13312
    v_mfma_f32_16x16x32_bf16 v[44:47], a[4:7], v[88:91], v[132:135]
    ds_read_b128 v[116:119], v250 offset:19456
    v_cvt_pk_bf16_f32 v200, v200, v201
    v_mfma_f32_16x16x32_bf16 v[44:47], a[12:15], v[92:95], v[44:47]
    ds_read_b128 v[120:123], v250 offset:13568
    v_mfma_f32_16x16x32_bf16 v[40:43], a[8:11], v[92:95], v[128:131]
    ds_read_b128 v[124:127], v250 offset:19712
    v_cvt_pk_bf16_f32 v201, v202, v203
    v_mfma_f32_16x16x32_bf16 v[40:43], a[0:3], v[88:91], v[40:43]
    v_mfma_f32_16x16x32_bf16 v[48:51], a[0:3], v[96:99], v[128:131]
    v_cvt_pk_bf16_f32 v202, v204, v205
    v_mfma_f32_16x16x32_bf16 v[48:51], a[8:11], v[100:103], v[48:51]
    v_cvt_pk_bf16_f32 v203, v206, v207
    v_mfma_f32_16x16x32_bf16 v[52:55], a[12:15], v[100:103], v[132:135]
    v_mfma_f32_16x16x32_bf16 v[52:55], a[4:7], v[96:99], v[52:55]
    buffer_store_dwordx4 v[200:203], v246, s[44:47], s9 offen offset:1024 sc1
    s_waitcnt lgkmcnt(0)
    v_mfma_f32_16x16x32_bf16 v[60:63], a[4:7], v[104:107], v[132:135]
    s_waitcnt vmcnt(15)
    s_barrier
    v_mfma_f32_16x16x32_bf16 v[60:63], a[12:15], v[108:111], v[60:63]
    ds_read_b128 v[80:83], v250 offset:24576
    v_cvt_pk_bf16_f32 v208, v208, v209
    v_mfma_f32_16x16x32_bf16 v[56:59], a[8:11], v[108:111], v[128:131]
    ds_read_b128 v[84:87], v250 offset:30720
    v_mfma_f32_16x16x32_bf16 v[56:59], a[0:3], v[104:107], v[56:59]
    ds_read_b128 v[88:91], v250 offset:24832
    v_cvt_pk_bf16_f32 v209, v210, v211
    v_mfma_f32_16x16x32_bf16 v[64:67], a[0:3], v[112:115], v[128:131]
    ds_read_b128 v[92:95], v250 offset:30976
    v_mfma_f32_16x16x32_bf16 v[64:67], a[8:11], v[116:119], v[64:67]
    ds_read_b128 v[96:99], v250 offset:25088
    v_mfma_f32_16x16x32_bf16 v[68:71], a[12:15], v[116:119], v[132:135]
    ds_read_b128 v[100:103], v250 offset:31232
    v_cvt_pk_bf16_f32 v210, v212, v213
    v_mfma_f32_16x16x32_bf16 v[68:71], a[4:7], v[112:115], v[68:71]
    v_mfma_f32_16x16x32_bf16 v[76:79], a[4:7], v[120:123], v[132:135]
    v_cvt_pk_bf16_f32 v211, v214, v215
    v_mfma_f32_16x16x32_bf16 v[76:79], a[12:15], v[124:127], v[76:79]
    v_mfma_f32_16x16x32_bf16 v[72:75], a[8:11], v[124:127], v[128:131]
    buffer_store_dwordx4 v[208:211], v246, s[44:47], s9 offen offset:2048 sc1
    v_mfma_f32_16x16x32_bf16 v[72:75], a[0:3], v[120:123], v[72:75]
    s_waitcnt lgkmcnt(0)
    v_mfma_f32_16x16x32_bf16 v[32:35], a[16:19], v[80:83], v[32:35]
    v_mfma_f32_16x16x32_bf16 v[32:35], a[24:27], v[84:87], v[32:35]
    ds_read_b128 v[104:107], v250 offset:25344
    v_cvt_pk_bf16_f32 v216, v216, v217
    v_mfma_f32_16x16x32_bf16 v[36:39], a[28:31], v[84:87], v[36:39]
    ds_read_b128 v[108:111], v250 offset:31488
    v_mfma_f32_16x16x32_bf16 v[36:39], a[20:23], v[80:83], v[36:39]
    ds_read_b128 v[112:115], v250 offset:25600
    v_cvt_pk_bf16_f32 v217, v218, v219
    v_mfma_f32_16x16x32_bf16 v[44:47], a[20:23], v[88:91], v[44:47]
    ds_read_b128 v[116:119], v250 offset:31744
    v_mfma_f32_16x16x32_bf16 v[44:47], a[28:31], v[92:95], v[44:47]
    ds_read_b128 v[120:123], v250 offset:25856
    v_mfma_f32_16x16x32_bf16 v[40:43], a[24:27], v[92:95], v[40:43]
    ds_read_b128 v[124:127], v250 offset:32000
    v_cvt_pk_bf16_f32 v218, v220, v221
    v_mfma_f32_16x16x32_bf16 v[40:43], a[16:19], v[88:91], v[40:43]
    v_mfma_f32_16x16x32_bf16 v[48:51], a[16:19], v[96:99], v[48:51]
    v_cvt_pk_bf16_f32 v219, v222, v223
    v_mfma_f32_16x16x32_bf16 v[48:51], a[24:27], v[100:103], v[48:51]
    v_mfma_f32_16x16x32_bf16 v[52:55], a[28:31], v[100:103], v[52:55]
    buffer_store_dwordx4 v[216:219], v247, s[44:47], s9 offen offset:0 sc1
    v_mfma_f32_16x16x32_bf16 v[52:55], a[20:23], v[96:99], v[52:55]
    s_waitcnt lgkmcnt(0)
    v_mfma_f32_16x16x32_bf16 v[60:63], a[20:23], v[104:107], v[60:63]
    s_waitcnt vmcnt(14)
    s_barrier
    v_cvt_pk_bf16_f32 v224, v224, v225
    v_mfma_f32_16x16x32_bf16 v[60:63], a[28:31], v[108:111], v[60:63]
    ds_read_b128 v[80:83], v159 offset:0
    s_add_u32 m0, s74, 36864
    s_mul_i32 s13, s23, 90112
    v_mfma_f32_16x16x32_bf16 v[56:59], a[24:27], v[108:111], v[56:59]
    ds_read_b128 v[84:87], v159 offset:6144
    v_mfma_f32_16x16x32_bf16 v[56:59], a[16:19], v[104:107], v[56:59]
    ds_read_b128 v[88:91], v159 offset:256
    buffer_load_dwordx4 v8, s[44:47], s13 offen offset:0 sc1 lds
    v_mfma_f32_16x16x32_bf16 v[64:67], a[16:19], v[112:115], v[64:67]
    ds_read_b128 v[92:95], v159 offset:6400
    v_cvt_pk_bf16_f32 v225, v226, v227
    v_mfma_f32_16x16x32_bf16 v[64:67], a[24:27], v[116:119], v[64:67]
    ds_read_b128 v[96:99], v159 offset:512
    v_cvt_pk_bf16_f32 v226, v228, v229
    v_mfma_f32_16x16x32_bf16 v[68:71], a[28:31], v[116:119], v[68:71]
    ds_read_b128 v[100:103], v159 offset:6656
    buffer_load_dwordx4 v9, s[44:47], s13 offen offset:1024 sc1 lds
    v_mfma_f32_16x16x32_bf16 v[68:71], a[20:23], v[112:115], v[68:71]
    v_add_u32 v10, 65536, v10
    v_mfma_f32_16x16x32_bf16 v[76:79], a[20:23], v[120:123], v[76:79]
    ds_read_b64_tr_b16 a[0:1], v10 offset:0
    v_cvt_pk_bf16_f32 v227, v230, v231
    v_mfma_f32_16x16x32_bf16 v[76:79], a[28:31], v[124:127], v[76:79]
    ds_read_b64_tr_b16 a[2:3], v10 offset:2048
    buffer_load_dwordx4 v3, s[44:47], s13 offen offset:2048 sc1 lds
    v_mfma_f32_16x16x32_bf16 v[72:75], a[24:27], v[124:127], v[72:75]
    buffer_store_dwordx4 v[224:227], v247, s[44:47], s9 offen offset:1024 sc1
    ds_read_b64_tr_b16 a[8:9], v10 offset:4096
    v_mfma_f32_16x16x32_bf16 v[72:75], a[16:19], v[120:123], v[72:75]
    ds_read_b64_tr_b16 a[10:11], v10 offset:6144
    s_waitcnt lgkmcnt(4)
    v_mfma_f32_16x16x32_bf16 v[32:35], a[32:35], v[80:83], v[32:35]
    s_add_u32 m0, s74, 49152
    s_mul_i32 s13, s24, 90112
    v_mfma_f32_16x16x32_bf16 v[32:35], a[40:43], v[84:87], v[32:35]
    ds_read_b128 v[104:107], v159 offset:768
    v_cvt_pk_bf16_f32 v232, v232, v233
    v_mfma_f32_16x16x32_bf16 v[36:39], a[44:47], v[84:87], v[36:39]
    ds_read_b128 v[108:111], v159 offset:6912
    v_mfma_f32_16x16x32_bf16 v[36:39], a[36:39], v[80:83], v[36:39]
    ds_read_b128 v[112:115], v159 offset:1024
    buffer_load_dwordx4 v8, s[44:47], s13 offen offset:0 sc1 lds
    v_mfma_f32_16x16x32_bf16 v[44:47], a[36:39], v[88:91], v[44:47]
    ds_read_b128 v[116:119], v159 offset:7168
    v_cvt_pk_bf16_f32 v233, v234, v235
    v_mfma_f32_16x16x32_bf16 v[44:47], a[44:47], v[92:95], v[44:47]
    ds_read_b128 v[120:123], v159 offset:1280
    v_cvt_pk_bf16_f32 v234, v236, v237
    v_mfma_f32_16x16x32_bf16 v[40:43], a[40:43], v[92:95], v[40:43]
    ds_read_b128 v[124:127], v159 offset:7424
    buffer_load_dwordx4 v9, s[44:47], s13 offen offset:1024 sc1 lds
    v_mfma_f32_16x16x32_bf16 v[40:43], a[32:35], v[88:91], v[40:43]
    v_add_u32 v11, 65536, v11
    v_mfma_f32_16x16x32_bf16 v[48:51], a[32:35], v[96:99], v[48:51]
    ds_read_b64_tr_b16 a[4:5], v11 offset:0
    v_cvt_pk_bf16_f32 v235, v238, v239
    v_mfma_f32_16x16x32_bf16 v[48:51], a[40:43], v[100:103], v[48:51]
    ds_read_b64_tr_b16 a[6:7], v11 offset:2048
    buffer_load_dwordx4 v3, s[44:47], s13 offen offset:2048 sc1 lds
    v_mfma_f32_16x16x32_bf16 v[52:55], a[44:47], v[100:103], v[52:55]
    buffer_store_dwordx4 v[232:235], v247, s[44:47], s9 offen offset:2048 sc1
    ds_read_b64_tr_b16 a[12:13], v11 offset:4096
    v_mfma_f32_16x16x32_bf16 v[52:55], a[36:39], v[96:99], v[52:55]
    ds_read_b64_tr_b16 a[14:15], v11 offset:6144
    s_waitcnt lgkmcnt(4)
    v_mfma_f32_16x16x32_bf16 v[60:63], a[36:39], v[104:107], v[60:63]
    s_waitcnt vmcnt(19)
    s_barrier
    v_mfma_f32_16x16x32_bf16 v[60:63], a[44:47], v[108:111], v[60:63]
    ds_read_b128 v[80:83], v159 offset:12288
    s_add_u32 m0, s74, 61440
    s_mul_i32 s13, s25, 90112
    v_mfma_f32_16x16x32_bf16 v[56:59], a[40:43], v[108:111], v[56:59]
    ds_read_b128 v[84:87], v159 offset:18432
    v_mfma_f32_16x16x32_bf16 v[56:59], a[32:35], v[104:107], v[56:59]
    ds_read_b128 v[88:91], v159 offset:12544
    buffer_load_dwordx4 v8, s[44:47], s13 offen offset:0 sc1 lds
    v_mfma_f32_16x16x32_bf16 v[64:67], a[32:35], v[112:115], v[64:67]
    ds_read_b128 v[92:95], v159 offset:18688
    v_mfma_f32_16x16x32_bf16 v[64:67], a[40:43], v[116:119], v[64:67]
    ds_read_b128 v[96:99], v159 offset:12800
    v_mfma_f32_16x16x32_bf16 v[68:71], a[44:47], v[116:119], v[68:71]
    ds_read_b128 v[100:103], v159 offset:18944
    buffer_load_dwordx4 v9, s[44:47], s13 offen offset:1024 sc1 lds
    v_mfma_f32_16x16x32_bf16 v[68:71], a[36:39], v[112:115], v[68:71]
    v_mfma_f32_16x16x32_bf16 v[76:79], a[36:39], v[120:123], v[76:79]
    v_mfma_f32_16x16x32_bf16 v[76:79], a[44:47], v[124:127], v[76:79]
    buffer_load_dwordx4 v3, s[44:47], s13 offen offset:2048 sc1 lds
    v_mfma_f32_16x16x32_bf16 v[72:75], a[40:43], v[124:127], v[72:75]
    v_mfma_f32_16x16x32_bf16 v[72:75], a[32:35], v[120:123], v[72:75]
    s_waitcnt lgkmcnt(0)
    v_mfma_f32_16x16x32_bf16 v[32:35], a[48:51], v[80:83], v[32:35]
    s_add_u32 m0, s74, 0
    s_mul_i32 s13, s26, 90112
    v_mfma_f32_16x16x32_bf16 v[32:35], a[56:59], v[84:87], v[32:35]
    ds_read_b128 v[104:107], v159 offset:13056
    v_mfma_f32_16x16x32_bf16 v[36:39], a[60:63], v[84:87], v[36:39]
    ds_read_b128 v[108:111], v159 offset:19200
    v_mfma_f32_16x16x32_bf16 v[36:39], a[52:55], v[80:83], v[36:39]
    ds_read_b128 v[112:115], v159 offset:13312
    buffer_load_dwordx4 v8, s[44:47], s13 offen offset:0 sc1 lds
    v_mfma_f32_16x16x32_bf16 v[44:47], a[52:55], v[88:91], v[44:47]
    ds_read_b128 v[116:119], v159 offset:19456
    v_mfma_f32_16x16x32_bf16 v[44:47], a[60:63], v[92:95], v[44:47]
    ds_read_b128 v[120:123], v159 offset:13568
    v_mfma_f32_16x16x32_bf16 v[40:43], a[56:59], v[92:95], v[40:43]
    ds_read_b128 v[124:127], v159 offset:19712
    buffer_load_dwordx4 v9, s[44:47], s13 offen offset:1024 sc1 lds
    v_mfma_f32_16x16x32_bf16 v[40:43], a[48:51], v[88:91], v[40:43]
    v_mfma_f32_16x16x32_bf16 v[48:51], a[48:51], v[96:99], v[48:51]
    v_mfma_f32_16x16x32_bf16 v[48:51], a[56:59], v[100:103], v[48:51]
    buffer_load_dwordx4 v3, s[44:47], s13 offen offset:2048 sc1 lds
    v_mfma_f32_16x16x32_bf16 v[52:55], a[60:63], v[100:103], v[52:55]
    v_mfma_f32_16x16x32_bf16 v[52:55], a[52:55], v[96:99], v[52:55]
    s_waitcnt lgkmcnt(0)
    v_mfma_f32_16x16x32_bf16 v[60:63], a[52:55], v[104:107], v[60:63]
    s_waitcnt vmcnt(18)
    s_barrier
    v_mfma_f32_16x16x32_bf16 v[60:63], a[60:63], v[108:111], v[60:63]
    ds_read_b128 v[80:83], v159 offset:24576
    s_add_u32 m0, s74, 12288
    s_mul_i32 s13, s27, 90112
    v_mfma_f32_16x16x32_bf16 v[56:59], a[56:59], v[108:111], v[56:59]
    ds_read_b128 v[84:87], v159 offset:30720
    v_mfma_f32_16x16x32_bf16 v[56:59], a[48:51], v[104:107], v[56:59]
    ds_read_b128 v[88:91], v159 offset:24832
    buffer_load_dwordx4 v8, s[44:47], s13 offen offset:0 sc1 lds
    v_mfma_f32_16x16x32_bf16 v[64:67], a[48:51], v[112:115], v[64:67]
    ds_read_b128 v[92:95], v159 offset:30976
    v_mfma_f32_16x16x32_bf16 v[64:67], a[56:59], v[116:119], v[64:67]
    ds_read_b128 v[96:99], v159 offset:25088
    v_mfma_f32_16x16x32_bf16 v[68:71], a[60:63], v[116:119], v[68:71]
    ds_read_b128 v[100:103], v159 offset:31232
    buffer_load_dwordx4 v9, s[44:47], s13 offen offset:1024 sc1 lds
    v_mfma_f32_16x16x32_bf16 v[68:71], a[52:55], v[112:115], v[68:71]
    v_add_u32 v10, -65536, v10
    v_mfma_f32_16x16x32_bf16 v[76:79], a[52:55], v[120:123], v[76:79]
    ds_read_b64_tr_b16 a[16:17], v10 offset:0
    v_mfma_f32_16x16x32_bf16 v[76:79], a[60:63], v[124:127], v[76:79]
    ds_read_b64_tr_b16 a[18:19], v10 offset:2048
    buffer_load_dwordx4 v3, s[44:47], s13 offen offset:2048 sc1 lds
    v_mfma_f32_16x16x32_bf16 v[72:75], a[56:59], v[124:127], v[72:75]
    ds_read_b64_tr_b16 a[24:25], v10 offset:4096
    v_mfma_f32_16x16x32_bf16 v[72:75], a[48:51], v[120:123], v[72:75]
    ds_read_b64_tr_b16 a[26:27], v10 offset:6144
    s_waitcnt lgkmcnt(4)
    v_mfma_f32_16x16x32_bf16 v[32:35], a[64:67], v[80:83], v[32:35]
    s_add_u32 m0, s73, 16384
    s_lshl_b32 s14, s86, 18
    v_mfma_f32_16x16x32_bf16 v[32:35], a[72:75], v[84:87], v[32:35]
    ds_read_b128 v[104:107], v159 offset:25344
    v_mfma_f32_16x16x32_bf16 v[36:39], a[76:79], v[84:87], v[36:39]
    ds_read_b128 v[108:111], v159 offset:31488
    buffer_load_dwordx4 v4, s[52:55], s14 offen offset:0 lds
    v_mfma_f32_16x16x32_bf16 v[36:39], a[68:71], v[80:83], v[36:39]
    ds_read_b128 v[112:115], v159 offset:25600
    v_mfma_f32_16x16x32_bf16 v[44:47], a[68:71], v[88:91], v[44:47]
    ds_read_b128 v[116:119], v159 offset:31744
    buffer_load_dwordx4 v5, s[52:55], s14 offen offset:1024 lds
    v_mfma_f32_16x16x32_bf16 v[44:47], a[76:79], v[92:95], v[44:47]
    ds_read_b128 v[120:123], v159 offset:25856
    v_mfma_f32_16x16x32_bf16 v[40:43], a[72:75], v[92:95], v[40:43]
    ds_read_b128 v[124:127], v159 offset:32000
    v_mfma_f32_16x16x32_bf16 v[40:43], a[64:67], v[88:91], v[40:43]
    buffer_load_dwordx4 v6, s[52:55], s14 offen offset:2048 lds
    v_add_u32 v11, -65536, v11
    v_mfma_f32_16x16x32_bf16 v[48:51], a[64:67], v[96:99], v[48:51]
    ds_read_b64_tr_b16 a[20:21], v11 offset:0
    v_mfma_f32_16x16x32_bf16 v[48:51], a[72:75], v[100:103], v[48:51]
    ds_read_b64_tr_b16 a[22:23], v11 offset:2048
    buffer_load_dwordx4 v7, s[52:55], s14 offen offset:3072 lds
    v_mfma_f32_16x16x32_bf16 v[52:55], a[76:79], v[100:103], v[52:55]
    ds_read_b64_tr_b16 a[28:29], v11 offset:4096
    v_mfma_f32_16x16x32_bf16 v[52:55], a[68:71], v[96:99], v[52:55]
    ds_read_b64_tr_b16 a[30:31], v11 offset:6144
    s_waitcnt lgkmcnt(4)
    v_mfma_f32_16x16x32_bf16 v[60:63], a[68:71], v[104:107], v[60:63]
    s_waitcnt vmcnt(18)
    s_barrier
    v_mfma_f32_16x16x32_bf16 v[60:63], a[76:79], v[108:111], v[60:63]
    ds_read_b128 v[80:83], v250 offset:0
    v_mfma_f32_16x16x32_bf16 v[56:59], a[72:75], v[108:111], v[56:59]
    ds_read_b128 v[84:87], v250 offset:6144
    v_mfma_f32_16x16x32_bf16 v[56:59], a[64:67], v[104:107], v[56:59]
    ds_read_b128 v[88:91], v250 offset:256
    v_mfma_f32_16x16x32_bf16 v[64:67], a[64:67], v[112:115], v[64:67]
    ds_read_b128 v[92:95], v250 offset:6400
    v_mfma_f32_16x16x32_bf16 v[64:67], a[72:75], v[116:119], v[64:67]
    ds_read_b128 v[96:99], v250 offset:512
    v_mfma_f32_16x16x32_bf16 v[68:71], a[76:79], v[116:119], v[68:71]
    ds_read_b128 v[100:103], v250 offset:6656
    v_mfma_f32_16x16x32_bf16 v[68:71], a[68:71], v[112:115], v[68:71]
    v_mfma_f32_16x16x32_bf16 v[76:79], a[68:71], v[120:123], v[76:79]
    v_mfma_f32_16x16x32_bf16 v[76:79], a[76:79], v[124:127], v[76:79]
    v_mfma_f32_16x16x32_bf16 v[72:75], a[72:75], v[124:127], v[72:75]
    v_mfma_f32_16x16x32_bf16 v[72:75], a[64:67], v[120:123], v[72:75]
    s_waitcnt lgkmcnt(0)
    v_mfma_f32_16x16x32_bf16 v[32:35], a[80:83], v[80:83], v[32:35]
    v_mfma_f32_16x16x32_bf16 v[32:35], a[88:91], v[84:87], v[32:35]
    ds_read_b128 v[104:107], v250 offset:768
    v_mfma_f32_16x16x32_bf16 v[36:39], a[92:95], v[84:87], v[36:39]
    ds_read_b128 v[108:111], v250 offset:6912
    v_mfma_f32_16x16x32_bf16 v[36:39], a[84:87], v[80:83], v[36:39]
    ds_read_b128 v[112:115], v250 offset:1024
    v_mfma_f32_16x16x32_bf16 v[44:47], a[84:87], v[88:91], v[44:47]
    ds_read_b128 v[116:119], v250 offset:7168
    v_mfma_f32_16x16x32_bf16 v[44:47], a[92:95], v[92:95], v[44:47]
    ds_read_b128 v[120:123], v250 offset:1280
    v_mfma_f32_16x16x32_bf16 v[40:43], a[88:91], v[92:95], v[40:43]
    ds_read_b128 v[124:127], v250 offset:7424
    v_mfma_f32_16x16x32_bf16 v[40:43], a[80:83], v[88:91], v[40:43]
    s_waitcnt vmcnt(13)
    buffer_store_dword v249, v248, s[44:47], s6 offen sc1
    v_mfma_f32_16x16x32_bf16 v[48:51], a[80:83], v[96:99], v[48:51]
    v_mfma_f32_16x16x32_bf16 v[48:51], a[88:91], v[100:103], v[48:51]
    v_mfma_f32_16x16x32_bf16 v[52:55], a[92:95], v[100:103], v[52:55]
    v_mfma_f32_16x16x32_bf16 v[52:55], a[84:87], v[96:99], v[52:55]
    s_waitcnt lgkmcnt(0)
    v_mfma_f32_16x16x32_bf16 v[60:63], a[84:87], v[104:107], v[60:63]
    s_barrier
    v_mfma_f32_16x16x32_bf16 v[60:63], a[92:95], v[108:111], v[60:63]
    ds_read_b128 v[80:83], v250 offset:12288
    v_mfma_f32_16x16x32_bf16 v[56:59], a[88:91], v[108:111], v[56:59]
    ds_read_b128 v[84:87], v250 offset:18432
    v_mfma_f32_16x16x32_bf16 v[56:59], a[80:83], v[104:107], v[56:59]
    ds_read_b128 v[88:91], v250 offset:12544
    v_mfma_f32_16x16x32_bf16 v[64:67], a[80:83], v[112:115], v[64:67]
    ds_read_b128 v[92:95], v250 offset:18688
    v_mfma_f32_16x16x32_bf16 v[64:67], a[88:91], v[116:119], v[64:67]
    ds_read_b128 v[96:99], v250 offset:12800
    v_mfma_f32_16x16x32_bf16 v[68:71], a[92:95], v[116:119], v[68:71]
    ds_read_b128 v[100:103], v250 offset:18944
    v_mfma_f32_16x16x32_bf16 v[68:71], a[84:87], v[112:115], v[68:71]
    v_mfma_f32_16x16x32_bf16 v[76:79], a[84:87], v[120:123], v[76:79]
    v_mfma_f32_16x16x32_bf16 v[76:79], a[92:95], v[124:127], v[76:79]
    v_mfma_f32_16x16x32_bf16 v[72:75], a[88:91], v[124:127], v[72:75]
    v_mfma_f32_16x16x32_bf16 v[72:75], a[80:83], v[120:123], v[72:75]
    s_waitcnt lgkmcnt(0)
    v_mfma_f32_16x16x32_bf16 v[32:35], a[96:99], v[80:83], v[32:35]
    v_mfma_f32_16x16x32_bf16 v[32:35], a[104:107], v[84:87], v[32:35]
    ds_read_b128 v[104:107], v250 offset:13056
    v_mfma_f32_16x16x32_bf16 v[36:39], a[108:111], v[84:87], v[36:39]
    ds_read_b128 v[108:111], v250 offset:19200
    v_mfma_f32_16x16x32_bf16 v[36:39], a[100:103], v[80:83], v[36:39]
    ds_read_b128 v[112:115], v250 offset:13312
    v_mfma_f32_16x16x32_bf16 v[44:47], a[100:103], v[88:91], v[44:47]
    ds_read_b128 v[116:119], v250 offset:19456
    v_mfma_f32_16x16x32_bf16 v[44:47], a[108:111], v[92:95], v[44:47]
    ds_read_b128 v[120:123], v250 offset:13568
    v_mfma_f32_16x16x32_bf16 v[40:43], a[104:107], v[92:95], v[40:43]
    ds_read_b128 v[124:127], v250 offset:19712
    v_mfma_f32_16x16x32_bf16 v[40:43], a[96:99], v[88:91], v[40:43]
    v_mfma_f32_16x16x32_bf16 v[48:51], a[96:99], v[96:99], v[48:51]
    v_mfma_f32_16x16x32_bf16 v[48:51], a[104:107], v[100:103], v[48:51]
    v_mfma_f32_16x16x32_bf16 v[52:55], a[108:111], v[100:103], v[52:55]
    v_mfma_f32_16x16x32_bf16 v[52:55], a[100:103], v[96:99], v[52:55]
    s_waitcnt lgkmcnt(0)
    v_mfma_f32_16x16x32_bf16 v[60:63], a[100:103], v[104:107], v[60:63]
    s_waitcnt vmcnt(11)
    s_barrier
    v_mfma_f32_16x16x32_bf16 v[60:63], a[108:111], v[108:111], v[60:63]
    ds_read_b128 v[80:83], v250 offset:24576
    s_add_u32 m0, s74, 24576
    s_mul_i32 s13, s76, 90112
    v_mfma_f32_16x16x32_bf16 v[56:59], a[104:107], v[108:111], v[56:59]
    ds_read_b128 v[84:87], v250 offset:30720
    v_mfma_f32_16x16x32_bf16 v[56:59], a[96:99], v[104:107], v[56:59]
L_pl_G_4:
    s_cbranch_execz L_wret
    ds_read_b128 v[88:91], v250 offset:24832
    buffer_load_dwordx4 v8, s[44:47], s13 offen offset:0 sc1 lds
    v_mfma_f32_16x16x32_bf16 v[64:67], a[96:99], v[112:115], v[64:67]
    ds_read_b128 v[92:95], v250 offset:30976
    v_mfma_f32_16x16x32_bf16 v[64:67], a[104:107], v[116:119], v[64:67]
    ds_read_b128 v[96:99], v250 offset:25088
    v_mfma_f32_16x16x32_bf16 v[68:71], a[108:111], v[116:119], v[68:71]
    ds_read_b128 v[100:103], v250 offset:31232
    buffer_load_dwordx4 v9, s[44:47], s13 offen offset:1024 sc1 lds
    v_mfma_f32_16x16x32_bf16 v[68:71], a[100:103], v[112:115], v[68:71]
    v_mfma_f32_16x16x32_bf16 v[76:79], a[100:103], v[120:123], v[76:79]
    v_mfma_f32_16x16x32_bf16 v[76:79], a[108:111], v[124:127], v[76:79]
    buffer_load_dwordx4 v3, s[44:47], s13 offen offset:2048 sc1 lds
    v_mfma_f32_16x16x32_bf16 v[72:75], a[104:107], v[124:127], v[72:75]
    v_mfma_f32_16x16x32_bf16 v[72:75], a[96:99], v[120:123], v[72:75]
    s_waitcnt lgkmcnt(0)
    v_mfma_f32_16x16x32_bf16 v[32:35], a[112:115], v[80:83], v[32:35]
    s_add_u32 m0, s74, 36864
    s_mul_i32 s13, s77, 90112
    v_mfma_f32_16x16x32_bf16 v[32:35], a[120:123], v[84:87], v[32:35]
    ds_read_b128 v[104:107], v250 offset:25344
    v_mfma_f32_16x16x32_bf16 v[36:39], a[124:127], v[84:87], v[36:39]
    ds_read_b128 v[108:111], v250 offset:31488
    v_mfma_f32_16x16x32_bf16 v[36:39], a[116:119], v[80:83], v[36:39]
    ds_read_b128 v[112:115], v250 offset:25600
    buffer_load_dwordx4 v8, s[44:47], s13 offen offset:0 sc1 lds
    v_mfma_f32_16x16x32_bf16 v[44:47], a[116:119], v[88:91], v[44:47]
    ds_read_b128 v[116:119], v250 offset:31744
    v_mfma_f32_16x16x32_bf16 v[44:47], a[124:127], v[92:95], v[44:47]
    ds_read_b128 v[120:123], v250 offset:25856
    v_mfma_f32_16x16x32_bf16 v[40:43], a[120:123], v[92:95], v[40:43]
    ds_read_b128 v[124:127], v250 offset:32000
    buffer_load_dwordx4 v9, s[44:47], s13 offen offset:1024 sc1 lds
    v_mfma_f32_16x16x32_bf16 v[40:43], a[112:115], v[88:91], v[40:43]
    v_mfma_f32_16x16x32_bf16 v[48:51], a[112:115], v[96:99], v[48:51]
    v_mfma_f32_16x16x32_bf16 v[48:51], a[120:123], v[100:103], v[48:51]
    buffer_load_dwordx4 v3, s[44:47], s13 offen offset:2048 sc1 lds
    v_mfma_f32_16x16x32_bf16 v[52:55], a[124:127], v[100:103], v[52:55]
    v_mfma_f32_16x16x32_bf16 v[52:55], a[116:119], v[96:99], v[52:55]
    s_waitcnt lgkmcnt(0)
    v_mfma_f32_16x16x32_bf16 v[60:63], a[116:119], v[104:107], v[60:63]
    s_waitcnt vmcnt(14)
    s_barrier
    v_mfma_f32_16x16x32_bf16 v[60:63], a[124:127], v[108:111], v[60:63]
    ds_read_b128 v[80:83], v159 offset:0
    s_add_u32 m0, s74, 49152
    s_mul_i32 s13, s78, 90112
    v_mfma_f32_16x16x32_bf16 v[56:59], a[120:123], v[108:111], v[56:59]
    ds_read_b128 v[84:87], v159 offset:6144
    v_mfma_f32_16x16x32_bf16 v[56:59], a[112:115], v[104:107], v[56:59]
    ds_read_b128 v[88:91], v159 offset:256
    buffer_load_dwordx4 v8, s[44:47], s13 offen offset:0 sc1 lds
    v_mfma_f32_16x16x32_bf16 v[64:67], a[112:115], v[112:115], v[64:67]
    ds_read_b128 v[92:95], v159 offset:6400
    v_mfma_f32_16x16x32_bf16 v[64:67], a[120:123], v[116:119], v[64:67]
    ds_read_b128 v[96:99], v159 offset:512
    v_mfma_f32_16x16x32_bf16 v[68:71], a[124:127], v[116:119], v[68:71]
    ds_read_b128 v[100:103], v159 offset:6656
    buffer_load_dwordx4 v9, s[44:47], s13 offen offset:1024 sc1 lds
    v_mfma_f32_16x16x32_bf16 v[68:71], a[116:119], v[112:115], v[68:71]
    v_mfma_f32_16x16x32_bf16 v[76:79], a[116:119], v[120:123], v[76:79]
    v_mfma_f32_16x16x32_bf16 v[76:79], a[124:127], v[124:127], v[76:79]
    buffer_load_dwordx4 v3, s[44:47], s13 offen offset:2048 sc1 lds
    v_mfma_f32_16x16x32_bf16 v[72:75], a[120:123], v[124:127], v[72:75]
    v_mfma_f32_16x16x32_bf16 v[72:75], a[112:115], v[120:123], v[72:75]
    s_waitcnt lgkmcnt(0)
    v_mfma_f32_16x16x32_bf16 v[32:35], a[128:131], v[80:83], v[32:35]
    s_add_u32 m0, s74, 61440
    s_mul_i32 s13, s79, 90112
    v_mfma_f32_16x16x32_bf16 v[32:35], a[136:139], v[84:87], v[32:35]
    ds_read_b128 v[104:107], v159 offset:768
    v_mfma_f32_16x16x32_bf16 v[36:39], a[140:143], v[84:87], v[36:39]
    ds_read_b128 v[108:111], v159 offset:6912
    v_mfma_f32_16x16x32_bf16 v[36:39], a[132:135], v[80:83], v[36:39]
    ds_read_b128 v[112:115], v159 offset:1024
    buffer_load_dwordx4 v8, s[44:47], s13 offen offset:0 sc1 lds
    v_mfma_f32_16x16x32_bf16 v[44:47], a[132:135], v[88:91], v[44:47]
    ds_read_b128 v[116:119], v159 offset:7168
    v_mfma_f32_16x16x32_bf16 v[44:47], a[140:143], v[92:95], v[44:47]
    ds_read_b128 v[120:123], v159 offset:1280
    v_mfma_f32_16x16x32_bf16 v[40:43], a[136:139], v[92:95], v[40:43]
    ds_read_b128 v[124:127], v159 offset:7424
    buffer_load_dwordx4 v9, s[44:47], s13 offen offset:1024 sc1 lds
    v_mfma_f32_16x16x32_bf16 v[40:43], a[128:131], v[88:91], v[40:43]
    v_mfma_f32_16x16x32_bf16 v[48:51], a[128:131], v[96:99], v[48:51]
    v_mfma_f32_16x16x32_bf16 v[48:51], a[136:139], v[100:103], v[48:51]
    buffer_load_dwordx4 v3, s[44:47], s13 offen offset:2048 sc1 lds
    v_mfma_f32_16x16x32_bf16 v[52:55], a[140:143], v[100:103], v[52:55]
    v_mfma_f32_16x16x32_bf16 v[52:55], a[132:135], v[96:99], v[52:55]
    s_waitcnt lgkmcnt(0)
    v_mfma_f32_16x16x32_bf16 v[60:63], a[132:135], v[104:107], v[60:63]
    s_waitcnt vmcnt(13)
    s_barrier
    v_mfma_f32_16x16x32_bf16 v[60:63], a[140:143], v[108:111], v[60:63]
    ds_read_b128 v[80:83], v159 offset:12288
    s_add_u32 m0, s74, 0
    s_mul_i32 s13, s80, 90112
    v_mfma_f32_16x16x32_bf16 v[56:59], a[136:139], v[108:111], v[56:59]
    ds_read_b128 v[84:87], v159 offset:18432
    v_mfma_f32_16x16x32_bf16 v[56:59], a[128:131], v[104:107], v[56:59]
    ds_read_b128 v[88:91], v159 offset:12544
    buffer_load_dwordx4 v8, s[44:47], s13 offen offset:0 sc1 lds
    v_mfma_f32_16x16x32_bf16 v[64:67], a[128:131], v[112:115], v[64:67]
    ds_read_b128 v[92:95], v159 offset:18688
    v_mfma_f32_16x16x32_bf16 v[64:67], a[136:139], v[116:119], v[64:67]
    ds_read_b128 v[96:99], v159 offset:12800
    buffer_load_dword v29, v28, s[44:47], 0 offen sc1
    v_mfma_f32_16x16x32_bf16 v[68:71], a[140:143], v[116:119], v[68:71]
    ds_read_b128 v[100:103], v159 offset:18944
    buffer_load_dwordx4 v9, s[44:47], s13 offen offset:1024 sc1 lds
    v_mfma_f32_16x16x32_bf16 v[68:71], a[132:135], v[112:115], v[68:71]
    ds_read_b64_tr_b16 a[32:33], v10 offset:16384
    v_mfma_f32_16x16x32_bf16 v[76:79], a[132:135], v[120:123], v[76:79]
    ds_read_b64_tr_b16 a[34:35], v10 offset:18432
    v_mfma_f32_16x16x32_bf16 v[76:79], a[140:143], v[124:127], v[76:79]
    buffer_load_dwordx4 v3, s[44:47], s13 offen offset:2048 sc1 lds
    v_mfma_f32_16x16x32_bf16 v[72:75], a[136:139], v[124:127], v[72:75]
    ds_read_b64_tr_b16 a[40:41], v10 offset:20480
    v_mfma_f32_16x16x32_bf16 v[72:75], a[128:131], v[120:123], v[72:75]
    ds_read_b64_tr_b16 a[42:43], v10 offset:22528
    s_waitcnt lgkmcnt(4)
    v_mfma_f32_16x16x32_bf16 v[32:35], a[144:147], v[80:83], v[32:35]
    s_add_u32 m0, s73, 32768
    s_lshl_b32 s14, s87, 18
    v_mfma_f32_16x16x32_bf16 v[32:35], a[152:155], v[84:87], v[32:35]
    ds_read_b128 v[104:107], v159 offset:13056
    v_mfma_f32_16x16x32_bf16 v[36:39], a[156:159], v[84:87], v[36:39]
    ds_read_b128 v[108:111], v159 offset:19200
    buffer_load_dwordx4 v4, s[52:55], s14 offen offset:0 lds
    v_mfma_f32_16x16x32_bf16 v[36:39], a[148:151], v[80:83], v[36:39]
    ds_read_b128 v[112:115], v159 offset:13312
    v_mfma_f32_16x16x32_bf16 v[44:47], a[148:151], v[88:91], v[44:47]
    ds_read_b128 v[116:119], v159 offset:19456
    buffer_load_dwordx4 v5, s[52:55], s14 offen offset:1024 lds
    v_mfma_f32_16x16x32_bf16 v[44:47], a[156:159], v[92:95], v[44:47]
    ds_read_b128 v[120:123], v159 offset:13568
    v_mfma_f32_16x16x32_bf16 v[40:43], a[152:155], v[92:95], v[40:43]
    ds_read_b128 v[124:127], v159 offset:19712
    v_mfma_f32_16x16x32_bf16 v[40:43], a[144:147], v[88:91], v[40:43]
    ds_read_b64_tr_b16 a[36:37], v11 offset:16384
    buffer_load_dwordx4 v6, s[52:55], s14 offen offset:2048 lds
    v_mfma_f32_16x16x32_bf16 v[48:51], a[144:147], v[96:99], v[48:51]
    ds_read_b64_tr_b16 a[38:39], v11 offset:18432
    v_mfma_f32_16x16x32_bf16 v[48:51], a[152:155], v[100:103], v[48:51]
    buffer_load_dwordx4 v7, s[52:55], s14 offen offset:3072 lds
    v_mfma_f32_16x16x32_bf16 v[52:55], a[156:159], v[100:103], v[52:55]
    ds_read_b64_tr_b16 a[44:45], v11 offset:20480
    v_mfma_f32_16x16x32_bf16 v[52:55], a[148:151], v[96:99], v[52:55]
    ds_read_b64_tr_b16 a[46:47], v11 offset:22528
    s_waitcnt lgkmcnt(4)
    v_mfma_f32_16x16x32_bf16 v[60:63], a[148:151], v[104:107], v[60:63]
    s_waitcnt vmcnt(17)
    s_barrier
    v_mfma_f32_16x16x32_bf16 v[60:63], a[156:159], v[108:111], v[60:63]
    ds_read_b128 v[80:83], v159 offset:24576
    v_mfma_f32_16x16x32_bf16 v[56:59], a[152:155], v[108:111], v[56:59]
    ds_read_b128 v[84:87], v159 offset:30720
    v_mfma_f32_16x16x32_bf16 v[56:59], a[144:147], v[104:107], v[56:59]
    ds_read_b128 v[88:91], v159 offset:24832
    v_mfma_f32_16x16x32_bf16 v[64:67], a[144:147], v[112:115], v[64:67]
    ds_read_b128 v[92:95], v159 offset:30976
    v_mfma_f32_16x16x32_bf16 v[64:67], a[152:155], v[116:119], v[64:67]
    ds_read_b128 v[96:99], v159 offset:25088
    v_mfma_f32_16x16x32_bf16 v[68:71], a[156:159], v[116:119], v[68:71]
    ds_read_b128 v[100:103], v159 offset:31232
    v_mfma_f32_16x16x32_bf16 v[68:71], a[148:151], v[112:115], v[68:71]
    v_mfma_f32_16x16x32_bf16 v[76:79], a[148:151], v[120:123], v[76:79]
    v_mfma_f32_16x16x32_bf16 v[76:79], a[156:159], v[124:127], v[76:79]
    v_mfma_f32_16x16x32_bf16 v[72:75], a[152:155], v[124:127], v[72:75]
    v_mfma_f32_16x16x32_bf16 v[72:75], a[144:147], v[120:123], v[72:75]
    s_waitcnt lgkmcnt(0)
    v_mfma_f32_16x16x32_bf16 v[32:35], a[160:163], v[80:83], v[32:35]
    v_mfma_f32_16x16x32_bf16 v[32:35], a[168:171], v[84:87], v[32:35]
    ds_read_b128 v[104:107], v159 offset:25344
    v_mfma_f32_16x16x32_bf16 v[36:39], a[172:175], v[84:87], v[36:39]
    ds_read_b128 v[108:111], v159 offset:31488
    v_mfma_f32_16x16x32_bf16 v[36:39], a[164:167], v[80:83], v[36:39]
    ds_read_b128 v[112:115], v159 offset:25600
    v_mfma_f32_16x16x32_bf16 v[44:47], a[164:167], v[88:91], v[44:47]
    ds_read_b128 v[116:119], v159 offset:31744
    v_mfma_f32_16x16x32_bf16 v[44:47], a[172:175], v[92:95], v[44:47]
    ds_read_b128 v[120:123], v159 offset:25856
    v_mfma_f32_16x16x32_bf16 v[40:43], a[168:171], v[92:95], v[40:43]
    ds_read_b128 v[124:127], v159 offset:32000
    v_mfma_f32_16x16x32_bf16 v[40:43], a[160:163], v[88:91], v[40:43]
    v_mfma_f32_16x16x32_bf16 v[48:51], a[160:163], v[96:99], v[48:51]
    v_mfma_f32_16x16x32_bf16 v[48:51], a[168:171], v[100:103], v[48:51]
    v_mfma_f32_16x16x32_bf16 v[52:55], a[172:175], v[100:103], v[52:55]
    v_mfma_f32_16x16x32_bf16 v[52:55], a[164:167], v[96:99], v[52:55]
    s_waitcnt lgkmcnt(0)
    v_mfma_f32_16x16x32_bf16 v[60:63], a[164:167], v[104:107], v[60:63]
    s_waitcnt vmcnt(14)
    s_barrier
    v_mfma_f32_16x16x32_bf16 v[60:63], a[172:175], v[108:111], v[60:63]
    ds_read_b128 v[80:83], v250 offset:0
    s_waitcnt vmcnt(6)
    v_mfma_f32_16x16x32_bf16 v[56:59], a[168:171], v[108:111], v[56:59]
    ds_read_b128 v[84:87], v250 offset:6144
    v_cmp_ne_u32 vcc, s68, v29
    v_mfma_f32_16x16x32_bf16 v[56:59], a[160:163], v[104:107], v[56:59]
    ds_read_b128 v[88:91], v250 offset:256
    v_mfma_f32_16x16x32_bf16 v[64:67], a[160:163], v[112:115], v[64:67]
    ds_read_b128 v[92:95], v250 offset:6400
    v_mfma_f32_16x16x32_bf16 v[64:67], a[168:171], v[116:119], v[64:67]
    ds_read_b128 v[96:99], v250 offset:512
    s_cbranch_vccnz L_rs_p5
L_ok_p5:
    v_mfma_f32_16x16x32_bf16 v[68:71], a[172:175], v[116:119], v[68:71]
    ds_read_b128 v[100:103], v250 offset:6656
    buffer_load_dwordx4 v[160:163], v246, s[44:47], s10 offen offset:0 sc1
    v_mfma_f32_16x16x32_bf16 v[68:71], a[164:167], v[112:115], v[68:71]
    v_mfma_f32_16x16x32_bf16 v[76:79], a[164:167], v[120:123], v[76:79]
    v_mfma_f32_16x16x32_bf16 v[76:79], a[172:175], v[124:127], v[76:79]
    buffer_load_dwordx4 v[164:167], v246, s[44:47], s10 offen offset:1024 sc1
    v_mfma_f32_16x16x32_bf16 v[72:75], a[168:171], v[124:127], v[72:75]
    buffer_load_dwordx4 v[168:171], v246, s[44:47], s10 offen offset:2048 sc1
    v_mfma_f32_16x16x32_bf16 v[72:75], a[160:163], v[120:123], v[72:75]
    s_waitcnt lgkmcnt(0)
    v_mfma_f32_16x16x32_bf16 v[32:35], a[176:179], v[80:83], v[32:35]
    v_mfma_f32_16x16x32_bf16 v[32:35], a[184:187], v[84:87], v[32:35]
    ds_read_b128 v[104:107], v250 offset:768
    v_mfma_f32_16x16x32_bf16 v[36:39], a[188:191], v[84:87], v[36:39]
    ds_read_b128 v[108:111], v250 offset:6912
    buffer_load_dwordx4 v[172:175], v247, s[44:47], s10 offen offset:0 sc1
    v_mfma_f32_16x16x32_bf16 v[36:39], a[180:183], v[80:83], v[36:39]
    ds_read_b128 v[112:115], v250 offset:1024
    v_mfma_f32_16x16x32_bf16 v[44:47], a[180:183], v[88:91], v[44:47]
    ds_read_b128 v[116:119], v250 offset:7168
    v_mfma_f32_16x16x32_bf16 v[44:47], a[188:191], v[92:95], v[44:47]
    ds_read_b128 v[120:123], v250 offset:1280
    buffer_load_dwordx4 v[176:179], v247, s[44:47], s10 offen offset:1024 sc1
    v_mfma_f32_16x16x32_bf16 v[40:43], a[184:187], v[92:95], v[40:43]
    ds_read_b128 v[124:127], v250 offset:7424
    v_mfma_f32_16x16x32_bf16 v[40:43], a[176:179], v[88:91], v[40:43]
    v_mfma_f32_16x16x32_bf16 v[48:51], a[176:179], v[96:99], v[48:51]
    v_mfma_f32_16x16x32_bf16 v[48:51], a[184:187], v[100:103], v[48:51]
    v_mfma_f32_16x16x32_bf16 v[52:55], a[188:191], v[100:103], v[52:55]
    buffer_load_dwordx4 v[180:183], v247, s[44:47], s10 offen offset:2048 sc1
    v_mfma_f32_16x16x32_bf16 v[52:55], a[180:183], v[96:99], v[52:55]
    s_waitcnt lgkmcnt(0)
    v_mfma_f32_16x16x32_bf16 v[60:63], a[180:183], v[104:107], v[60:63]
    s_barrier
    v_mfma_f32_16x16x32_bf16 v[60:63], a[188:191], v[108:111], v[60:63]
    ds_read_b128 v[80:83], v250 offset:12288
    s_add_u32 m0, s74, 12288
    s_mul_i32 s13, s81, 90112
    v_mfma_f32_16x16x32_bf16 v[56:59], a[184:187], v[108:111], v[56:59]
    ds_read_b128 v[84:87], v250 offset:18432
    v_mfma_f32_16x16x32_bf16 v[56:59], a[176:179], v[104:107], v[56:59]
    ds_read_b128 v[88:91], v250 offset:12544
    buffer_load_dwordx4 v8, s[44:47], s13 offen offset:0 sc1 lds
    v_mfma_f32_16x16x32_bf16 v[64:67], a[176:179], v[112:115], v[64:67]
    ds_read_b128 v[92:95], v250 offset:18688
    v_mfma_f32_16x16x32_bf16 v[64:67], a[184:187], v[116:119], v[64:67]
    ds_read_b128 v[96:99], v250 offset:12800
    v_mfma_f32_16x16x32_bf16 v[68:71], a[188:191], v[116:119], v[68:71]
    ds_read_b128 v[100:103], v250 offset:18944
    buffer_load_dwordx4 v9, s[44:47], s13 offen offset:1024 sc1 lds
    v_mfma_f32_16x16x32_bf16 v[68:71], a[180:183], v[112:115], v[68:71]
    v_mfma_f32_16x16x32_bf16 v[76:79], a[180:183], v[120:123], v[76:79]
    v_mfma_f32_16x16x32_bf16 v[76:79], a[188:191], v[124:127], v[76:79]
    buffer_load_dwordx4 v3, s[44:47], s13 offen offset:2048 sc1 lds
    v_mfma_f32_16x16x32_bf16 v[72:75], a[184:187], v[124:127], v[72:75]
    v_mfma_f32_16x16x32_bf16 v[72:75], a[176:179], v[120:123], v[72:75]
    s_waitcnt lgkmcnt(0)
    v_mfma_f32_16x16x32_bf16 v[32:35], a[192:195], v[80:83], v[32:35]
    s_add_u32 m0, s73, 49152
    s_lshl_b32 s14, s88, 18
    v_mfma_f32_16x16x32_bf16 v[32:35], a[200:203], v[84:87], v[32:35]
    ds_read_b128 v[104:107], v250 offset:13056
    v_mfma_f32_16x16x32_bf16 v[36:39], a[204:207], v[84:87], v[36:39]
    ds_read_b128 v[108:111], v250 offset:19200
    buffer_load_dwordx4 v4, s[52:55], s14 offen offset:0 lds
    v_mfma_f32_16x16x32_bf16 v[36:39], a[196:199], v[80:83], v[36:39]
    ds_read_b128 v[112:115], v250 offset:13312
    v_mfma_f32_16x16x32_bf16 v[44:47], a[196:199], v[88:91], v[44:47]
    ds_read_b128 v[116:119], v250 offset:19456
    buffer_load_dwordx4 v5, s[52:55], s14 offen offset:1024 lds
    v_mfma_f32_16x16x32_bf16 v[44:47], a[204:207], v[92:95], v[44:47]
    ds_read_b128 v[120:123], v250 offset:13568
    v_mfma_f32_16x16x32_bf16 v[40:43], a[200:203], v[92:95], v[40:43]
    ds_read_b128 v[124:127], v250 offset:19712
    v_mfma_f32_16x16x32_bf16 v[40:43], a[192:195], v[88:91], v[40:43]
    buffer_load_dwordx4 v6, s[52:55], s14 offen offset:2048 lds
    v_mfma_f32_16x16x32_bf16 v[48:51], a[192:195], v[96:99], v[48:51]
    v_mfma_f32_16x16x32_bf16 v[48:51], a[200:203], v[100:103], v[48:51]
    buffer_load_dwordx4 v7, s[52:55], s14 offen offset:3072 lds
    v_mfma_f32_16x16x32_bf16 v[52:55], a[204:207], v[100:103], v[52:55]
    v_mfma_f32_16x16x32_bf16 v[52:55], a[196:199], v[96:99], v[52:55]
    s_waitcnt lgkmcnt(0)
    v_mfma_f32_16x16x32_bf16 v[60:63], a[196:199], v[104:107], v[60:63]
    s_barrier
    v_mfma_f32_16x16x32_bf16 v[60:63], a[204:207], v[108:111], v[60:63]
    ds_read_b128 v[80:83], v250 offset:24576
    v_mfma_f32_16x16x32_bf16 v[56:59], a[200:203], v[108:111], v[56:59]
    ds_read_b128 v[84:87], v250 offset:30720
    v_mfma_f32_16x16x32_bf16 v[56:59], a[192:195], v[104:107], v[56:59]
    ds_read_b128 v[88:91], v250 offset:24832
    v_mfma_f32_16x16x32_bf16 v[64:67], a[192:195], v[112:115], v[64:67]
    ds_read_b128 v[92:95], v250 offset:30976
    v_mfma_f32_16x16x32_bf16 v[64:67], a[200:203], v[116:119], v[64:67]
    ds_read_b128 v[96:99], v250 offset:25088
    v_mfma_f32_16x16x32_bf16 v[68:71], a[204:207], v[116:119], v[68:71]
    ds_read_b128 v[100:103], v250 offset:31232
    s_waitcnt vmcnt(7)
    v_mfma_f32_16x16x32_bf16 v[68:71], a[196:199], v[112:115], v[68:71]
    v_mfma_f32_16x16x32_bf16 v[76:79], a[196:199], v[120:123], v[76:79]
    v_mfma_f32_16x16x32_bf16 v[76:79], a[204:207], v[124:127], v[76:79]
    v_mfma_f32_16x16x32_bf16 v[72:75], a[200:203], v[124:127], v[72:75]
    v_mfma_f32_16x16x32_bf16 v[72:75], a[192:195], v[120:123], v[72:75]
    s_waitcnt lgkmcnt(0)
    v_mfma_f32_16x16x32_bf16 v[32:35], a[208:211], v[80:83], v[32:35]
    s_add_u32 m0, s73, 65536
    s_lshl_b32 s14, s89, 18
    v_mfma_f32_16x16x32_bf16 v[32:35], a[216:219], v[84:87], v[32:35]
    ds_read_b128 v[104:107], v250 offset:25344
    v_mfma_f32_16x16x32_bf16 v[36:39], a[220:223], v[84:87], v[36:39]
    ds_read_b128 v[108:111], v250 offset:31488
    buffer_load_dwordx4 v4, s[52:55], s14 offen offset:0 lds
    v_and_b32 v193, 0xffff0000, v172
    v_lshlrev_b32 v192, 16, v172
    v_mfma_f32_16x16x32_bf16 v[36:39], a[212:215], v[80:83], v[36:39]
    ds_read_b128 v[112:115], v250 offset:25600
    v_and_b32 v195, 0xffff0000, v173
    v_lshlrev_b32 v194, 16, v173
    v_mfma_f32_16x16x32_bf16 v[44:47], a[212:215], v[88:91], v[44:47]
    ds_read_b128 v[116:119], v250 offset:31744
    buffer_load_dwordx4 v5, s[52:55], s14 offen offset:1024 lds
    v_add_f32 v56, v56, v192
    v_mfma_f32_16x16x32_bf16 v[44:47], a[220:223], v[92:95], v[44:47]
    ds_read_b128 v[120:123], v250 offset:25856
    v_add_f32 v57, v57, v193
    v_add_f32 v58, v58, v194
    v_mfma_f32_16x16x32_bf16 v[40:43], a[216:219], v[92:95], v[40:43]
    ds_read_b128 v[124:127], v250 offset:32000
    v_add_f32 v59, v59, v195
    v_and_b32 v197, 0xffff0000, v174
    v_mfma_f32_16x16x32_bf16 v[40:43], a[208:211], v[88:91], v[40:43]
    buffer_load_dwordx4 v6, s[52:55], s14 offen offset:2048 lds
    v_lshlrev_b32 v196, 16, v174
    v_and_b32 v199, 0xffff0000, v175
    v_mfma_f32_16x16x32_bf16 v[48:51], a[208:211], v[96:99], v[48:51]
    v_lshlrev_b32 v198, 16, v175
    v_add_f32 v60, v60, v196
    v_mfma_f32_16x16x32_bf16 v[48:51], a[216:219], v[100:103], v[48:51]
    buffer_load_dwordx4 v7, s[52:55], s14 offen offset:3072 lds
    v_add_f32 v61, v61, v197
    v_mfma_f32_16x16x32_bf16 v[52:55], a[220:223], v[100:103], v[52:55]
    v_add_f32 v62, v62, v198
    v_add_f32 v63, v63, v199
    v_mfma_f32_16x16x32_bf16 v[52:55], a[212:215], v[96:99], v[52:55]
    s_waitcnt lgkmcnt(0)
    v_mfma_f32_16x16x32_bf16 v[60:63], a[212:215], v[104:107], v[60:63]
    s_barrier
    v_mfma_f32_16x16x32_bf16 v[60:63], a[220:223], v[108:111], v[60:63]
    ds_read_b128 v[80:83], v159 offset:0
    v_mfma_f32_16x16x32_bf16 v[56:59], a[216:219], v[108:111], v[56:59]
    ds_read_b128 v[84:87], v159 offset:6144
    v_and_b32 v193, 0xffff0000, v160
    v_lshlrev_b32 v192, 16, v160
    v_mfma_f32_16x16x32_bf16 v[56:59], a[208:211], v[104:107], v[56:59]
    ds_read_b128 v[88:91], v159 offset:256
    v_and_b32 v195, 0xffff0000, v161
    v_lshlrev_b32 v194, 16, v161
    v_mfma_f32_16x16x32_bf16 v[64:67], a[208:211], v[112:115], v[64:67]
    ds_read_b128 v[92:95], v159 offset:6400
    v_add_f32 v32, v32, v192
    v_mfma_f32_16x16x32_bf16 v[64:67], a[216:219], v[116:119], v[64:67]
    ds_read_b128 v[96:99], v159 offset:512
    v_add_f32 v33, v33, v193
    v_add_f32 v34, v34, v194
    v_mfma_f32_16x16x32_bf16 v[68:71], a[220:223], v[116:119], v[68:71]
    ds_read_b128 v[100:103], v159 offset:6656
    v_add_f32 v35, v35, v195
    v_and_b32 v197, 0xffff0000, v162
    v_mfma_f32_16x16x32_bf16 v[68:71], a[212:215], v[112:115], v[68:71]
    ds_read_b64_tr_b16 a[48:49], v10 offset:32768
    v_lshlrev_b32 v196, 16, v162
    v_and_b32 v199, 0xffff0000, v163
    v_mfma_f32_16x16x32_bf16 v[76:79], a[212:215], v[120:123], v[76:79]
    ds_read_b64_tr_b16 a[50:51], v10 offset:34816
    v_lshlrev_b32 v198, 16, v163
    v_mfma_f32_16x16x32_bf16 v[76:79], a[220:223], v[124:127], v[76:79]
    v_add_f32 v36, v36, v196
    v_add_f32 v37, v37, v197
    v_mfma_f32_16x16x32_bf16 v[72:75], a[216:219], v[124:127], v[72:75]
    ds_read_b64_tr_b16 a[56:57], v10 offset:36864
    v_add_f32 v38, v38, v198
    v_add_f32 v39, v39, v199
    v_mfma_f32_16x16x32_bf16 v[72:75], a[208:211], v[120:123], v[72:75]
    ds_read_b64_tr_b16 a[58:59], v10 offset:38912
    s_waitcnt lgkmcnt(4)
    v_mfma_f32_16x16x32_bf16 v[32:35], a[224:227], v[80:83], v[32:35]
    s_add_u32 m0, s73, 0
    s_lshl_b32 s14, s90, 18
    v_mfma_f32_16x16x32_bf16 v[32:35], a[232:235], v[84:87], v[32:35]
    ds_read_b128 v[104:107], v159 offset:768
    v_mfma_f32_16x16x32_bf16 v[36:39], a[236:239], v[84:87], v[36:39]
    ds_read_b128 v[108:111], v159 offset:6912
    buffer_load_dwordx4 v4, s[52:55], s14 offen offset:0 lds
    v_and_b32 v193, 0xffff0000, v176
    v_lshlrev_b32 v192, 16, v176
    v_mfma_f32_16x16x32_bf16 v[36:39], a[228:231], v[80:83], v[36:39]
    ds_read_b128 v[112:115], v159 offset:1024
    v_and_b32 v195, 0xffff0000, v177
    v_lshlrev_b32 v194, 16, v177
    v_mfma_f32_16x16x32_bf16 v[44:47], a[228:231], v[88:91], v[44:47]
    ds_read_b128 v[116:119], v159 offset:7168
    buffer_load_dwordx4 v5, s[52:55], s14 offen offset:1024 lds
    v_add_f32 v64, v64, v192
    v_mfma_f32_16x16x32_bf16 v[44:47], a[236:239], v[92:95], v[44:47]
    ds_read_b128 v[120:123], v159 offset:1280
    v_add_f32 v65, v65, v193
    v_add_f32 v66, v66, v194
    v_mfma_f32_16x16x32_bf16 v[40:43], a[232:235], v[92:95], v[40:43]
    ds_read_b128 v[124:127], v159 offset:7424
    v_add_f32 v67, v67, v195
    v_and_b32 v197, 0xffff0000, v178
    v_mfma_f32_16x16x32_bf16 v[40:43], a[224:227], v[88:91], v[40:43]
    ds_read_b64_tr_b16 a[52:53], v11 offset:32768
    buffer_load_dwordx4 v6, s[52:55], s14 offen offset:2048 lds
    v_lshlrev_b32 v196, 16, v178
    v_and_b32 v199, 0xffff0000, v179
    v_mfma_f32_16x16x32_bf16 v[48:51], a[224:227], v[96:99], v[48:51]
    ds_read_b64_tr_b16 a[54:55], v11 offset:34816
    v_lshlrev_b32 v198, 16, v179
    v_mfma_f32_16x16x32_bf16 v[48:51], a[232:235], v[100:103], v[48:51]
    buffer_load_dwordx4 v7, s[52:55], s14 offen offset:3072 lds
    v_add_f32 v68, v68, v196
    v_add_f32 v69, v69, v197
    v_mfma_f32_16x16x32_bf16 v[52:55], a[236:239], v[100:103], v[52:55]
    ds_read_b64_tr_b16 a[60:61], v11 offset:36864
    v_add_f32 v70, v70, v198
    v_add_f32 v71, v71, v199
    v_mfma_f32_16x16x32_bf16 v[52:55], a[228:231], v[96:99], v[52:55]
    ds_read_b64_tr_b16 a[62:63], v11 offset:38912
    s_waitcnt lgkmcnt(4)
    v_mfma_f32_16x16x32_bf16 v[60:63], a[228:231], v[104:107], v[60:63]
    s_waitcnt vmcnt(12)
    s_barrier
    v_mfma_f32_16x16x32_bf16 v[60:63], a[236:239], v[108:111], v[60:63]
    ds_read_b128 v[80:83], v159 offset:12288
    v_mfma_f32_16x16x32_bf16 v[56:59], a[232:235], v[108:111], v[56:59]
    ds_read_b128 v[84:87], v159 offset:18432
    v_and_b32 v193, 0xffff0000, v164
    v_lshlrev_b32 v192, 16, v164
    v_mfma_f32_16x16x32_bf16 v[56:59], a[224:227], v[104:107], v[56:59]
    ds_read_b128 v[88:91], v159 offset:12544
    v_and_b32 v195, 0xffff0000, v165
    v_lshlrev_b32 v194, 16, v165
    v_mfma_f32_16x16x32_bf16 v[64:67], a[224:227], v[112:115], v[64:67]
    ds_read_b128 v[92:95], v159 offset:18688
    v_add_f32 v40, v40, v192
    v_mfma_f32_16x16x32_bf16 v[64:67], a[232:235], v[116:119], v[64:67]
    ds_read_b128 v[96:99], v159 offset:12800
    v_add_f32 v41, v41, v193
    v_add_f32 v42, v42, v194
    v_mfma_f32_16x16x32_bf16 v[68:71], a[236:239], v[116:119], v[68:71]
    ds_read_b128 v[100:103], v159 offset:18944
    v_add_f32 v43, v43, v195
    v_mfma_f32_16x16x32_bf16 v[68:71], a[228:231], v[112:115], v[68:71]
    v_and_b32 v197, 0xffff0000, v166
    v_lshlrev_b32 v196, 16, v166
    v_mfma_f32_16x16x32_bf16 v[76:79], a[228:231], v[120:123], v[76:79]
    v_and_b32 v199, 0xffff0000, v167
    v_lshlrev_b32 v198, 16, v167
    v_mfma_f32_16x16x32_bf16 v[76:79], a[236:239], v[124:127], v[76:79]
    v_add_f32 v44, v44, v196
    v_add_f32 v45, v45, v197
    v_mfma_f32_16x16x32_bf16 v[72:75], a[232:235], v[124:127], v[72:75]
    v_add_f32 v46, v46, v198
    v_add_f32 v47, v47, v199
    v_mfma_f32_16x16x32_bf16 v[72:75], a[224:227], v[120:123], v[72:75]
    s_waitcnt lgkmcnt(0)
    v_mfma_f32_16x16x32_bf16 v[32:35], a[240:243], v[80:83], v[32:35]
    s_add_u32 m0, s73, 16384
    s_lshl_b32 s14, s91, 18
    v_mfma_f32_16x16x32_bf16 v[32:35], a[248:251], v[84:87], v[32:35]
    ds_read_b128 v[104:107], v159 offset:13056
    v_mfma_f32_16x16x32_bf16 v[36:39], a[252:255], v[84:87], v[36:39]
    ds_read_b128 v[108:111], v159 offset:19200
    buffer_load_dwordx4 v4, s[52:55], s14 offen offset:0 lds
    v_and_b32 v193, 0xffff0000, v180
    v_lshlrev_b32 v192, 16, v180
    v_mfma_f32_16x16x32_bf16 v[36:39], a[244:247], v[80:83], v[36:39]
    ds_read_b128 v[112:115], v159 offset:13312
    v_and_b32 v195, 0xffff0000, v181
    v_lshlrev_b32 v194, 16, v181
    v_mfma_f32_16x16x32_bf16 v[44:47], a[244:247], v[88:91], v[44:47]
    ds_read_b128 v[116:119], v159 offset:19456
    buffer_load_dwordx4 v5, s[52:55], s14 offen offset:1024 lds
    v_add_f32 v72, v72, v192
    v_mfma_f32_16x16x32_bf16 v[44:47], a[252:255], v[92:95], v[44:47]
    ds_read_b128 v[120:123], v159 offset:13568
    v_add_f32 v73, v73, v193
    v_add_f32 v74, v74, v194
    v_mfma_f32_16x16x32_bf16 v[40:43], a[248:251], v[92:95], v[40:43]
    ds_read_b128 v[124:127], v159 offset:19712
    v_add_f32 v75, v75, v195
    v_and_b32 v197, 0xffff0000, v182
    v_mfma_f32_16x16x32_bf16 v[40:43], a[240:243], v[88:91], v[40:43]
    buffer_load_dwordx4 v6, s[52:55], s14 offen offset:2048 lds
    v_lshlrev_b32 v196, 16, v182
    v_and_b32 v199, 0xffff0000, v183
    v_mfma_f32_16x16x32_bf16 v[48:51], a[240:243], v[96:99], v[48:51]
    v_lshlrev_b32 v198, 16, v183
    v_add_f32 v76, v76, v196
    v_mfma_f32_16x16x32_bf16 v[48:51], a[248:251], v[100:103], v[48:51]
    buffer_load_dwordx4 v7, s[52:55], s14 offen offset:3072 lds
    v_add_f32 v77, v77, v197
    v_mfma_f32_16x16x32_bf16 v[52:55], a[252:255], v[100:103], v[52:55]
    v_add_f32 v78, v78, v198
    v_add_f32 v79, v79, v199
    v_mfma_f32_16x16x32_bf16 v[52:55], a[244:247], v[96:99], v[52:55]
    s_waitcnt lgkmcnt(0)
    v_mfma_f32_16x16x32_bf16 v[60:63], a[244:247], v[104:107], v[60:63]
    s_barrier
    v_mfma_f32_16x16x32_bf16 v[60:63], a[252:255], v[108:111], v[60:63]
    s_add_u32 m0, s73, 131072
    s_lshl_b32 s14, s92, 18
    v_mfma_f32_16x16x32_bf16 v[56:59], a[248:251], v[108:111], v[56:59]
    buffer_load_dwordx4 v4, s[52:55], s14 offen offset:0 lds
    v_and_b32 v193, 0xffff0000, v168
    v_lshlrev_b32 v192, 16, v168
    v_mfma_f32_16x16x32_bf16 v[56:59], a[240:243], v[104:107], v[56:59]
    buffer_load_dwordx4 v5, s[52:55], s14 offen offset:1024 lds
    v_and_b32 v195, 0xffff0000, v169
    v_lshlrev_b32 v194, 16, v169
    v_mfma_f32_16x16x32_bf16 v[64:67], a[240:243], v[112:115], v[64:67]
    buffer_load_dwordx4 v6, s[52:55], s14 offen offset:2048 lds
    v_add_f32 v48, v48, v192
    v_mfma_f32_16x16x32_bf16 v[64:67], a[248:251], v[116:119], v[64:67]
    buffer_load_dwordx4 v7, s[52:55], s14 offen offset:3072 lds
    v_add_f32 v49, v49, v193
    v_add_f32 v50, v50, v194
    v_mfma_f32_16x16x32_bf16 v[68:71], a[252:255], v[116:119], v[68:71]
    s_add_u32 m0, s73, 147456
    s_lshl_b32 s14, s93, 18
    v_add_f32 v51, v51, v195
    v_and_b32 v197, 0xffff0000, v170
    v_mfma_f32_16x16x32_bf16 v[68:71], a[244:247], v[112:115], v[68:71]
    buffer_load_dwordx4 v4, s[52:55], s14 offen offset:0 lds
    v_lshlrev_b32 v196, 16, v170
    v_and_b32 v199, 0xffff0000, v171
    v_mfma_f32_16x16x32_bf16 v[76:79], a[244:247], v[120:123], v[76:79]
    buffer_load_dwordx4 v5, s[52:55], s14 offen offset:1024 lds
    v_lshlrev_b32 v198, 16, v171
    v_mfma_f32_16x16x32_bf16 v[76:79], a[252:255], v[124:127], v[76:79]
    buffer_load_dwordx4 v6, s[52:55], s14 offen offset:2048 lds
    v_add_f32 v52, v52, v196
    v_add_f32 v53, v53, v197
    v_mfma_f32_16x16x32_bf16 v[72:75], a[248:251], v[124:127], v[72:75]
    buffer_load_dwordx4 v7, s[52:55], s14 offen offset:3072 lds
    v_add_f32 v54, v54, v198
    v_add_f32 v55, v55, v199
    v_mfma_f32_16x16x32_bf16 v[72:75], a[240:243], v[120:123], v[72:75]
    s_waitcnt lgkmcnt(0)
    v_mov_b32 v88, 0xc0135761
    s_mov_b32 s10, 0xbdd2d3e8
    s_lshl_b32 s9, s69, 2
    s_add_u32 s9, s9, s3
    s_mul_i32 s9, s9, 69632
    s_add_u32 s9, s9, 12795904
    v_pk_mul_f32 v[160:161], v[32:33], v[32:33]
    v_pk_mul_f32 v[162:163], v[34:35], v[34:35]
    v_pk_mul_f32 v[164:165], v[36:37], v[36:37]
    v_pk_mul_f32 v[166:167], v[38:39], v[38:39]
    v_pk_mul_f32 v[168:169], v[40:41], v[40:41]
    v_pk_mul_f32 v[170:171], v[42:43], v[42:43]
    v_pk_mul_f32 v[172:173], v[44:45], v[44:45]
    v_pk_mul_f32 v[174:175], v[46:47], v[46:47]
    v_pk_fma_f32 v[160:161], v[160:161], s[10:11], v[88:89] op_sel_hi:[1,0,0]
    v_pk_fma_f32 v[162:163], v[162:163], s[10:11], v[88:89] op_sel_hi:[1,0,0]
L_pl_G_5:
    s_cbranch_execz L_wret
    v_pk_fma_f32 v[164:165], v[164:165], s[10:11], v[88:89] op_sel_hi:[1,0,0]
    v_pk_fma_f32 v[166:167], v[166:167], s[10:11], v[88:89] op_sel_hi:[1,0,0]
    v_pk_fma_f32 v[168:169], v[168:169], s[10:11], v[88:89] op_sel_hi:[1,0,0]
    v_pk_fma_f32 v[170:171], v[170:171], s[10:11], v[88:89] op_sel_hi:[1,0,0]
    v_pk_fma_f32 v[172:173], v[172:173], s[10:11], v[88:89] op_sel_hi:[1,0,0]
    v_pk_fma_f32 v[174:175], v[174:175], s[10:11], v[88:89] op_sel_hi:[1,0,0]
    v_pk_mul_f32 v[160:161], v[160:161], v[32:33]
    v_pk_mul_f32 v[162:163], v[162:163], v[34:35]
    v_pk_mul_f32 v[164:165], v[164:165], v[36:37]
    v_pk_mul_f32 v[166:167], v[166:167], v[38:39]
    v_pk_mul_f32 v[168:169], v[168:169], v[40:41]
    v_pk_mul_f32 v[170:171], v[170:171], v[42:43]
    v_pk_mul_f32 v[172:173], v[172:173], v[44:45]
    v_pk_mul_f32 v[174:175], v[174:175], v[46:47]
    v_exp_f32 v160, v160
    v_exp_f32 v161, v161
    v_exp_f32 v162, v162
    v_exp_f32 v163, v163
    v_exp_f32 v164, v164
    v_exp_f32 v165, v165
    v_exp_f32 v166, v166
    v_exp_f32 v167, v167
    v_exp_f32 v168, v168
    v_exp_f32 v169, v169
    v_exp_f32 v170, v170
    v_exp_f32 v171, v171
    v_exp_f32 v172, v172
    v_exp_f32 v173, v173
    v_exp_f32 v174, v174
    v_exp_f32 v175, v175
    v_pk_add_f32 v[160:161], v[160:161], 1.0 op_sel_hi:[1,0]
    v_pk_add_f32 v[162:163], v[162:163], 1.0 op_sel_hi:[1,0]
    v_pk_add_f32 v[164:165], v[164:165], 1.0 op_sel_hi:[1,0]
    v_pk_add_f32 v[166:167], v[166:167], 1.0 op_sel_hi:[1,0]
    v_pk_add_f32 v[168:169], v[168:169], 1.0 op_sel_hi:[1,0]
    v_pk_add_f32 v[170:171], v[170:171], 1.0 op_sel_hi:[1,0]
    v_pk_add_f32 v[172:173], v[172:173], 1.0 op_sel_hi:[1,0]
    v_pk_add_f32 v[174:175], v[174:175], 1.0 op_sel_hi:[1,0]
    v_rcp_f32 v160, v160
    v_rcp_f32 v161, v161
    v_rcp_f32 v162, v162
    v_rcp_f32 v163, v163
    v_rcp_f32 v164, v164
    v_rcp_f32 v165, v165
    v_rcp_f32 v166, v166
    v_rcp_f32 v167, v167
    v_rcp_f32 v168, v168
    v_rcp_f32 v169, v169
    v_rcp_f32 v170, v170
    v_rcp_f32 v171, v171
    v_rcp_f32 v172, v172
    v_rcp_f32 v173, v173
    v_rcp_f32 v174, v174
    v_rcp_f32 v175, v175
    v_pk_mul_f32 v[32:33], v[32:33], v[160:161]
    v_pk_mul_f32 v[34:35], v[34:35], v[162:163]
    v_pk_mul_f32 v[36:37], v[36:37], v[164:165]
    v_pk_mul_f32 v[38:39], v[38:39], v[166:167]
    v_pk_mul_f32 v[40:41], v[40:41], v[168:169]
    v_pk_mul_f32 v[42:43], v[42:43], v[170:171]
    v_pk_mul_f32 v[44:45], v[44:45], v[172:173]
    v_pk_mul_f32 v[46:47], v[46:47], v[174:175]
    v_cvt_pk_bf16_f32 v96, v32, v33
    v_cvt_pk_bf16_f32 v97, v34, v35
    v_cvt_pk_bf16_f32 v98, v36, v37
    v_cvt_pk_bf16_f32 v99, v38, v39
    v_cvt_pk_bf16_f32 v100, v40, v41
    v_cvt_pk_bf16_f32 v101, v42, v43
    v_cvt_pk_bf16_f32 v102, v44, v45
    v_cvt_pk_bf16_f32 v103, v46, v47
    buffer_store_dwordx4 v[96:99], v240, s[44:47], s9 offen sc1
    buffer_store_dwordx4 v[100:103], v241, s[44:47], s9 offen sc1
    v_pk_mul_f32 v[160:161], v[48:49], v[48:49]
    v_pk_mul_f32 v[162:163], v[50:51], v[50:51]
    v_pk_mul_f32 v[164:165], v[52:53], v[52:53]
    v_pk_mul_f32 v[166:167], v[54:55], v[54:55]
    v_pk_mul_f32 v[168:169], v[56:57], v[56:57]
    v_pk_mul_f32 v[170:171], v[58:59], v[58:59]
    v_pk_mul_f32 v[172:173], v[60:61], v[60:61]
    v_pk_mul_f32 v[174:175], v[62:63], v[62:63]
    v_pk_fma_f32 v[160:161], v[160:161], s[10:11], v[88:89] op_sel_hi:[1,0,0]
    v_pk_fma_f32 v[162:163], v[162:163], s[10:11], v[88:89] op_sel_hi:[1,0,0]
    v_pk_fma_f32 v[164:165], v[164:165], s[10:11], v[88:89] op_sel_hi:[1,0,0]
    v_pk_fma_f32 v[166:167], v[166:167], s[10:11], v[88:89] op_sel_hi:[1,0,0]
    v_pk_fma_f32 v[168:169], v[168:169], s[10:11], v[88:89] op_sel_hi:[1,0,0]
    v_pk_fma_f32 v[170:171], v[170:171], s[10:11], v[88:89] op_sel_hi:[1,0,0]
    v_pk_fma_f32 v[172:173], v[172:173], s[10:11], v[88:89] op_sel_hi:[1,0,0]
    v_pk_fma_f32 v[174:175], v[174:175], s[10:11], v[88:89] op_sel_hi:[1,0,0]
    v_pk_mul_f32 v[160:161], v[160:161], v[48:49]
    v_pk_mul_f32 v[162:163], v[162:163], v[50:51]
    v_pk_mul_f32 v[164:165], v[164:165], v[52:53]
    v_pk_mul_f32 v[166:167], v[166:167], v[54:55]
    v_pk_mul_f32 v[168:169], v[168:169], v[56:57]
    v_pk_mul_f32 v[170:171], v[170:171], v[58:59]
    v_pk_mul_f32 v[172:173], v[172:173], v[60:61]
    v_pk_mul_f32 v[174:175], v[174:175], v[62:63]
    v_exp_f32 v160, v160
    v_exp_f32 v161, v161
    v_exp_f32 v162, v162
    v_exp_f32 v163, v163
    v_exp_f32 v164, v164
    v_exp_f32 v165, v165
    v_exp_f32 v166, v166
    v_exp_f32 v167, v167
    v_exp_f32 v168, v168
    v_exp_f32 v169, v169
    v_exp_f32 v170, v170
    v_exp_f32 v171, v171
    v_exp_f32 v172, v172
    v_exp_f32 v173, v173
    v_exp_f32 v174, v174
    v_exp_f32 v175, v175
    v_pk_add_f32 v[160:161], v[160:161], 1.0 op_sel_hi:[1,0]
    v_pk_add_f32 v[162:163], v[162:163], 1.0 op_sel_hi:[1,0]
    v_pk_add_f32 v[164:165], v[164:165], 1.0 op_sel_hi:[1,0]
    v_pk_add_f32 v[166:167], v[166:167], 1.0 op_sel_hi:[1,0]
    v_pk_add_f32 v[168:169], v[168:169], 1.0 op_sel_hi:[1,0]
    v_pk_add_f32 v[170:171], v[170:171], 1.0 op_sel_hi:[1,0]
    v_pk_add_f32 v[172:173], v[172:173], 1.0 op_sel_hi:[1,0]
    v_pk_add_f32 v[174:175], v[174:175], 1.0 op_sel_hi:[1,0]
    v_rcp_f32 v160, v160
    v_rcp_f32 v161, v161
    v_rcp_f32 v162, v162
    v_rcp_f32 v163, v163
    v_rcp_f32 v164, v164
    v_rcp_f32 v165, v165
    v_rcp_f32 v166, v166
    v_rcp_f32 v167, v167
    v_rcp_f32 v168, v168
    v_rcp_f32 v169, v169
    v_rcp_f32 v170, v170
    v_rcp_f32 v171, v171
    v_rcp_f32 v172, v172
    v_rcp_f32 v173, v173
    v_rcp_f32 v174, v174
    v_rcp_f32 v175, v175
    v_pk_mul_f32 v[48:49], v[48:49], v[160:161]
    v_pk_mul_f32 v[50:51], v[50:51], v[162:163]
    v_pk_mul_f32 v[52:53], v[52:53], v[164:165]
    v_pk_mul_f32 v[54:55], v[54:55], v[166:167]
    v_pk_mul_f32 v[56:57], v[56:57], v[168:169]
    v_pk_mul_f32 v[58:59], v[58:59], v[170:171]
    v_pk_mul_f32 v[60:61], v[60:61], v[172:173]
    v_pk_mul_f32 v[62:63], v[62:63], v[174:175]
    v_cvt_pk_bf16_f32 v104, v48, v49
    v_cvt_pk_bf16_f32 v105, v50, v51
    v_cvt_pk_bf16_f32 v106, v52, v53
    v_cvt_pk_bf16_f32 v107, v54, v55
    v_cvt_pk_bf16_f32 v108, v56, v57
    v_cvt_pk_bf16_f32 v109, v58, v59
    v_cvt_pk_bf16_f32 v110, v60, v61
    v_cvt_pk_bf16_f32 v111, v62, v63
    buffer_store_dwordx4 v[104:107], v242, s[44:47], s9 offen sc1
    buffer_store_dwordx4 v[108:111], v243, s[44:47], s9 offen sc1
    v_pk_mul_f32 v[160:161], v[64:65], v[64:65]
    v_pk_mul_f32 v[162:163], v[66:67], v[66:67]
    v_pk_mul_f32 v[164:165], v[68:69], v[68:69]
    v_pk_mul_f32 v[166:167], v[70:71], v[70:71]
    v_pk_mul_f32 v[168:169], v[72:73], v[72:73]
    v_pk_mul_f32 v[170:171], v[74:75], v[74:75]
    v_pk_mul_f32 v[172:173], v[76:77], v[76:77]
    v_pk_mul_f32 v[174:175], v[78:79], v[78:79]
    v_pk_fma_f32 v[160:161], v[160:161], s[10:11], v[88:89] op_sel_hi:[1,0,0]
    v_pk_fma_f32 v[162:163], v[162:163], s[10:11], v[88:89] op_sel_hi:[1,0,0]
    v_pk_fma_f32 v[164:165], v[164:165], s[10:11], v[88:89] op_sel_hi:[1,0,0]
    v_pk_fma_f32 v[166:167], v[166:167], s[10:11], v[88:89] op_sel_hi:[1,0,0]
    v_pk_fma_f32 v[168:169], v[168:169], s[10:11], v[88:89] op_sel_hi:[1,0,0]
    v_pk_fma_f32 v[170:171], v[170:171], s[10:11], v[88:89] op_sel_hi:[1,0,0]
    v_pk_fma_f32 v[172:173], v[172:173], s[10:11], v[88:89] op_sel_hi:[1,0,0]
    v_pk_fma_f32 v[174:175], v[174:175], s[10:11], v[88:89] op_sel_hi:[1,0,0]
    v_pk_mul_f32 v[160:161], v[160:161], v[64:65]
    v_pk_mul_f32 v[162:163], v[162:163], v[66:67]
    v_pk_mul_f32 v[164:165], v[164:165], v[68:69]
    v_pk_mul_f32 v[166:167], v[166:167], v[70:71]
    v_pk_mul_f32 v[168:169], v[168:169], v[72:73]
    v_pk_mul_f32 v[170:171], v[170:171], v[74:75]
    v_pk_mul_f32 v[172:173], v[172:173], v[76:77]
    v_pk_mul_f32 v[174:175], v[174:175], v[78:79]
    v_exp_f32 v160, v160
    v_exp_f32 v161, v161
    v_exp_f32 v162, v162
    v_exp_f32 v163, v163
    v_exp_f32 v164, v164
    v_exp_f32 v165, v165
    v_exp_f32 v166, v166
    v_exp_f32 v167, v167
    v_exp_f32 v168, v168
    v_exp_f32 v169, v169
    v_exp_f32 v170, v170
    v_exp_f32 v171, v171
    v_exp_f32 v172, v172
    v_exp_f32 v173, v173
    v_exp_f32 v174, v174
    v_exp_f32 v175, v175
    v_pk_add_f32 v[160:161], v[160:161], 1.0 op_sel_hi:[1,0]
    v_pk_add_f32 v[162:163], v[162:163], 1.0 op_sel_hi:[1,0]
    v_pk_add_f32 v[164:165], v[164:165], 1.0 op_sel_hi:[1,0]
    v_pk_add_f32 v[166:167], v[166:167], 1.0 op_sel_hi:[1,0]
    v_pk_add_f32 v[168:169], v[168:169], 1.0 op_sel_hi:[1,0]
    v_pk_add_f32 v[170:171], v[170:171], 1.0 op_sel_hi:[1,0]
    v_pk_add_f32 v[172:173], v[172:173], 1.0 op_sel_hi:[1,0]
    v_pk_add_f32 v[174:175], v[174:175], 1.0 op_sel_hi:[1,0]
    v_rcp_f32 v160, v160
    v_rcp_f32 v161, v161
    v_rcp_f32 v162, v162
    v_rcp_f32 v163, v163
    v_rcp_f32 v164, v164
    v_rcp_f32 v165, v165
    v_rcp_f32 v166, v166
    v_rcp_f32 v167, v167
    v_rcp_f32 v168, v168
    v_rcp_f32 v169, v169
    v_rcp_f32 v170, v170
    v_rcp_f32 v171, v171
    v_rcp_f32 v172, v172
    v_rcp_f32 v173, v173
    v_rcp_f32 v174, v174
    v_rcp_f32 v175, v175
    v_pk_mul_f32 v[64:65], v[64:65], v[160:161]
    v_pk_mul_f32 v[66:67], v[66:67], v[162:163]
    v_pk_mul_f32 v[68:69], v[68:69], v[164:165]
    v_pk_mul_f32 v[70:71], v[70:71], v[166:167]
    v_pk_mul_f32 v[72:73], v[72:73], v[168:169]
    v_pk_mul_f32 v[74:75], v[74:75], v[170:171]
    v_pk_mul_f32 v[76:77], v[76:77], v[172:173]
    v_pk_mul_f32 v[78:79], v[78:79], v[174:175]
    v_cvt_pk_bf16_f32 v112, v64, v65
    v_cvt_pk_bf16_f32 v113, v66, v67
    v_cvt_pk_bf16_f32 v114, v68, v69
    v_cvt_pk_bf16_f32 v115, v70, v71
    v_cvt_pk_bf16_f32 v116, v72, v73
    v_cvt_pk_bf16_f32 v117, v74, v75
    v_cvt_pk_bf16_f32 v118, v76, v77
    v_cvt_pk_bf16_f32 v119, v78, v79
    buffer_store_dwordx4 v[112:115], v244, s[44:47], s9 offen sc1
    buffer_store_dwordx4 v[116:119], v245, s[44:47], s9 offen sc1
    s_waitcnt vmcnt(6)
    s_barrier
    ds_read_b64_tr_b16 a[64:65], v10 offset:49152
    s_add_u32 m0, s73, 32768
    s_lshl_b32 s14, s94, 18
    ds_read_b64_tr_b16 a[66:67], v10 offset:51200
    ds_read_b64_tr_b16 a[72:73], v10 offset:53248
    ds_read_b64_tr_b16 a[74:75], v10 offset:55296
    ds_read_b64_tr_b16 a[68:69], v11 offset:49152
    buffer_load_dwordx4 v4, s[52:55], s14 offen offset:0 lds
    ds_read_b64_tr_b16 a[70:71], v11 offset:51200
    ds_read_b64_tr_b16 a[76:77], v11 offset:53248
    ds_read_b64_tr_b16 a[78:79], v11 offset:55296
    v_add_u32 v10, 65536, v10
    ds_read_b64_tr_b16 a[80:81], v10 offset:0
    ds_read_b64_tr_b16 a[82:83], v10 offset:2048
    buffer_load_dwordx4 v5, s[52:55], s14 offen offset:1024 lds
    ds_read_b64_tr_b16 a[88:89], v10 offset:4096
    ds_read_b64_tr_b16 a[90:91], v10 offset:6144
    v_add_u32 v11, 65536, v11
    ds_read_b64_tr_b16 a[84:85], v11 offset:0
    ds_read_b64_tr_b16 a[86:87], v11 offset:2048
    ds_read_b64_tr_b16 a[92:93], v11 offset:4096
    buffer_load_dwordx4 v6, s[52:55], s14 offen offset:2048 lds
    ds_read_b64_tr_b16 a[94:95], v11 offset:6144
    v_add_u32 v10, -65536, v10
    ds_read_b64_tr_b16 a[96:97], v10 offset:0
    ds_read_b64_tr_b16 a[98:99], v10 offset:2048
    ds_read_b64_tr_b16 a[104:105], v10 offset:4096
    ds_read_b64_tr_b16 a[106:107], v10 offset:6144
    buffer_load_dwordx4 v7, s[52:55], s14 offen offset:3072 lds
    v_add_u32 v11, -65536, v11
    ds_read_b64_tr_b16 a[100:101], v11 offset:0
    ds_read_b64_tr_b16 a[102:103], v11 offset:2048
    ds_read_b64_tr_b16 a[108:109], v11 offset:4096
    ds_read_b64_tr_b16 a[110:111], v11 offset:6144
    ds_read_b64_tr_b16 a[112:113], v10 offset:16384
    s_add_u32 m0, s73, 81920
    s_lshl_b32 s14, s95, 18
    ds_read_b64_tr_b16 a[114:115], v10 offset:18432
    ds_read_b64_tr_b16 a[120:121], v10 offset:20480
    ds_read_b64_tr_b16 a[122:123], v10 offset:22528
    ds_read_b64_tr_b16 a[116:117], v11 offset:16384
    buffer_load_dwordx4 v4, s[52:55], s14 offen offset:0 lds
    ds_read_b64_tr_b16 a[118:119], v11 offset:18432
    ds_read_b64_tr_b16 a[124:125], v11 offset:20480
    ds_read_b64_tr_b16 a[126:127], v11 offset:22528
    v_add_u32 v10, 131072, v10
    ds_read_b64_tr_b16 a[128:129], v10 offset:0
    ds_read_b64_tr_b16 a[130:131], v10 offset:2048
    buffer_load_dwordx4 v5, s[52:55], s14 offen offset:1024 lds
    ds_read_b64_tr_b16 a[136:137], v10 offset:4096
    ds_read_b64_tr_b16 a[138:139], v10 offset:6144
    v_add_u32 v11, 131072, v11
    ds_read_b64_tr_b16 a[132:133], v11 offset:0
    ds_read_b64_tr_b16 a[134:135], v11 offset:2048
    ds_read_b64_tr_b16 a[140:141], v11 offset:4096
    buffer_load_dwordx4 v6, s[52:55], s14 offen offset:2048 lds
    ds_read_b64_tr_b16 a[142:143], v11 offset:6144
    ds_read_b64_tr_b16 a[144:145], v10 offset:16384
    ds_read_b64_tr_b16 a[146:147], v10 offset:18432
    ds_read_b64_tr_b16 a[152:153], v10 offset:20480
    ds_read_b64_tr_b16 a[154:155], v10 offset:22528
    buffer_load_dwordx4 v7, s[52:55], s14 offen offset:3072 lds
    ds_read_b64_tr_b16 a[148:149], v11 offset:16384
    ds_read_b64_tr_b16 a[150:151], v11 offset:18432
    ds_read_b64_tr_b16 a[156:157], v11 offset:20480
    ds_read_b64_tr_b16 a[158:159], v11 offset:22528
    s_bitcmp1_b32 s3, 1
    s_cselect_b32 s18, s85, s84
    s_mul_i32 s18, s18, 139264
    s_cselect_b32 s19, s87, s86
    s_mul_i32 s19, s19, 139264
    s_cselect_b32 s20, s89, s88
    s_mul_i32 s20, s20, 139264
    s_cselect_b32 s21, s91, s90
    s_mul_i32 s21, s21, 139264
    s_cselect_b32 s22, s93, s92
    s_mul_i32 s22, s22, 139264
    s_cselect_b32 s23, s95, s94
    s_mul_i32 s23, s23, 139264
    s_cselect_b32 s24, s97, s96
    s_mul_i32 s24, s24, 139264
    s_cselect_b32 s25, s99, s98
    s_mul_i32 s25, s25, 139264
    s_cselect_b32 s26, s101, s100
    s_mul_i32 s26, s26, 139264
    s_waitcnt vmcnt(8) lgkmcnt(0)
    s_barrier
    buffer_store_dword v249, v17, s[44:47], 0 offen sc1
    s_add_u32 m0, s73, 0
    s_lshl_b32 s14, s96, 18
    buffer_load_dwordx4 v4, s[52:55], s14 offen offset:0 lds
    buffer_load_dwordx4 v5, s[52:55], s14 offen offset:1024 lds
    buffer_load_dwordx4 v6, s[52:55], s14 offen offset:2048 lds
    buffer_load_dwordx4 v7, s[52:55], s14 offen offset:3072 lds
    s_add_u32 m0, s73, 16384
    s_lshl_b32 s14, s97, 18
    buffer_load_dwordx4 v4, s[52:55], s14 offen offset:0 lds
    buffer_load_dwordx4 v5, s[52:55], s14 offen offset:1024 lds
    buffer_load_dwordx4 v6, s[52:55], s14 offen offset:2048 lds
    buffer_load_dwordx4 v7, s[52:55], s14 offen offset:3072 lds
    v_mov_b32 v16, 0
    buffer_atomic_add v16, v15, s[44:47], 0 offen sc0 sc1
    s_add_u32 m0, s73, 49152
    s_lshl_b32 s14, s98, 18
    buffer_load_dwordx4 v4, s[52:55], s14 offen offset:0 lds
    buffer_load_dwordx4 v5, s[52:55], s14 offen offset:1024 lds
    buffer_load_dwordx4 v6, s[52:55], s14 offen offset:2048 lds
    buffer_load_dwordx4 v7, s[52:55], s14 offen offset:3072 lds
    s_add_u32 m0, s73, 65536
    s_lshl_b32 s14, s99, 18
    buffer_load_dwordx4 v4, s[52:55], s14 offen offset:0 lds
    buffer_load_dwordx4 v5, s[52:55], s14 offen offset:1024 lds
    buffer_load_dwordx4 v6, s[52:55], s14 offen offset:2048 lds
    buffer_load_dwordx4 v7, s[52:55], s14 offen offset:3072 lds
L_DG:
    s_waitcnt vmcnt(8)
    v_cmp_ne_u32 vcc, v13, v16
    s_cbranch_vccnz L_rs_p2G
L_ok_p2G:
    s_barrier
    s_add_u32 m0, s73, 97536
    s_nop 0
    buffer_load_dwordx4 v23, s[44:47], s18 offen offset:768 sc1 lds
    s_add_u32 m0, s73, 99328
    s_nop 0
    buffer_load_dwordx4 v20, s[44:47], s18 offen offset:0 sc1 lds
    s_add_u32 m0, s73, 99840
    s_nop 0
    buffer_load_dwordx4 v20, s[44:47], s18 offen offset:512 sc1 lds
    s_add_u32 m0, s73, 100608
    s_nop 0
    buffer_load_dwordx4 v23, s[44:47], s19 offen offset:768 sc1 lds
    s_add_u32 m0, s73, 114688
    s_nop 0
    buffer_load_dwordx4 v20, s[44:47], s19 offen offset:0 sc1 lds
    s_add_u32 m0, s73, 115200
    s_nop 0
    buffer_load_dwordx4 v20, s[44:47], s19 offen offset:512 sc1 lds
    s_add_u32 m0, s73, 115968
    s_nop 0
    buffer_load_dwordx4 v23, s[44:47], s20 offen offset:768 sc1 lds
    s_add_u32 m0, s73, 117760
    s_nop 0
    buffer_load_dwordx4 v20, s[44:47], s20 offen offset:0 sc1 lds
    v_mov_b32 v195, s68
    v_mov_b32 v199, s68
    v_mov_b32 v202, s68
    v_mov_b32 v203, s68
    s_waitcnt vmcnt(4)
    s_barrier
    ds_read_b128 v[104:107], v14 offset:0
    ds_read_b128 v[108:111], v14 offset:4096
    ds_read_b128 v[112:115], v14 offset:8192
    ds_read_b128 v[116:119], v14 offset:12288
    s_waitcnt lgkmcnt(2)
    v_mfma_f32_16x16x32_bf16 v[32:35], v[104:107], a[0:3], 0
    s_add_u32 m0, s73, 130560
    v_mfma_f32_16x16x32_bf16 v[32:35], v[108:111], a[8:11], v[32:35]
    buffer_load_dwordx4 v20, s[44:47], s20 offen offset:512 sc1 lds
    s_waitcnt lgkmcnt(0)
    v_mfma_f32_16x16x32_bf16 v[32:35], v[112:115], a[16:19], v[32:35]
    ds_read_b128 v[120:123], v14 offset:1024
    v_mfma_f32_16x16x32_bf16 v[32:35], v[116:119], a[24:27], v[32:35]
    ds_read_b128 v[124:127], v14 offset:5120
    v_mfma_f32_16x16x32_bf16 v[36:39], v[116:119], a[28:31], 0
    ds_read_b128 v[128:131], v14 offset:9216
    v_mfma_f32_16x16x32_bf16 v[36:39], v[112:115], a[20:23], v[36:39]
    ds_read_b128 v[132:135], v14 offset:13312
    v_mfma_f32_16x16x32_bf16 v[36:39], v[108:111], a[12:15], v[36:39]
    s_add_u32 m0, s73, 131328
    v_mfma_f32_16x16x32_bf16 v[36:39], v[104:107], a[4:7], v[36:39]
    buffer_load_dwordx4 v23, s[44:47], s21 offen offset:768 sc1 lds
    s_waitcnt lgkmcnt(2)
    v_mfma_f32_16x16x32_bf16 v[44:47], v[120:123], a[4:7], 0
    s_add_u32 m0, s73, 133120
    v_mfma_f32_16x16x32_bf16 v[44:47], v[124:127], a[12:15], v[44:47]
    buffer_load_dwordx4 v20, s[44:47], s21 offen offset:0 sc1 lds
    s_waitcnt lgkmcnt(0)
    v_mfma_f32_16x16x32_bf16 v[44:47], v[128:131], a[20:23], v[44:47]
    ds_read_b128 v[104:107], v14 offset:2048
    v_mfma_f32_16x16x32_bf16 v[44:47], v[132:135], a[28:31], v[44:47]
    ds_read_b128 v[108:111], v14 offset:6144
    v_mfma_f32_16x16x32_bf16 v[40:43], v[132:135], a[24:27], 0
    ds_read_b128 v[112:115], v14 offset:10240
    v_mfma_f32_16x16x32_bf16 v[40:43], v[128:131], a[16:19], v[40:43]
    ds_read_b128 v[116:119], v14 offset:14336
    v_mfma_f32_16x16x32_bf16 v[40:43], v[124:127], a[8:11], v[40:43]
    s_add_u32 m0, s73, 133632
    v_mfma_f32_16x16x32_bf16 v[40:43], v[120:123], a[0:3], v[40:43]
    buffer_load_dwordx4 v20, s[44:47], s21 offen offset:512 sc1 lds
    s_waitcnt lgkmcnt(2)
    v_mfma_f32_16x16x32_bf16 v[48:51], v[104:107], a[0:3], 0
    s_add_u32 m0, s73, 146688
    v_mfma_f32_16x16x32_bf16 v[48:51], v[108:111], a[8:11], v[48:51]
    buffer_load_dwordx4 v23, s[44:47], s22 offen offset:768 sc1 lds
    s_waitcnt lgkmcnt(0)
    v_mfma_f32_16x16x32_bf16 v[48:51], v[112:115], a[16:19], v[48:51]
    ds_read_b128 v[120:123], v14 offset:3072
    v_mfma_f32_16x16x32_bf16 v[48:51], v[116:119], a[24:27], v[48:51]
    ds_read_b128 v[124:127], v14 offset:7168
    v_mfma_f32_16x16x32_bf16 v[52:55], v[116:119], a[28:31], 0
    ds_read_b128 v[128:131], v14 offset:11264
    v_mfma_f32_16x16x32_bf16 v[52:55], v[112:115], a[20:23], v[52:55]
    ds_read_b128 v[132:135], v14 offset:15360
    v_mfma_f32_16x16x32_bf16 v[52:55], v[108:111], a[12:15], v[52:55]
    s_add_u32 m0, s73, 148480
    v_mfma_f32_16x16x32_bf16 v[52:55], v[104:107], a[4:7], v[52:55]
    buffer_load_dwordx4 v20, s[44:47], s22 offen offset:0 sc1 lds
    s_waitcnt lgkmcnt(2)
    v_mfma_f32_16x16x32_bf16 v[36:39], v[120:123], a[36:39], v[36:39]
    s_add_u32 m0, s73, 148992
    v_mfma_f32_16x16x32_bf16 v[36:39], v[124:127], a[44:47], v[36:39]
    buffer_load_dwordx4 v20, s[44:47], s22 offen offset:512 sc1 lds
    s_waitcnt lgkmcnt(0)
    v_mfma_f32_16x16x32_bf16 v[36:39], v[128:131], a[52:55], v[36:39]
    s_waitcnt vmcnt(7)
    s_barrier
    v_mfma_f32_16x16x32_bf16 v[36:39], v[132:135], a[60:63], v[36:39]
    ds_read_b128 v[104:107], v14 offset:16384
    v_add_u32 v10, -131072, v10
    v_mfma_f32_16x16x32_bf16 v[32:35], v[132:135], a[56:59], v[32:35]
    ds_read_b128 v[108:111], v14 offset:20480
    v_mfma_f32_16x16x32_bf16 v[32:35], v[128:131], a[48:51], v[32:35]
    ds_read_b128 v[112:115], v14 offset:24576
    ds_read_b64_tr_b16 a[160:161], v10 offset:32768
    v_mfma_f32_16x16x32_bf16 v[32:35], v[124:127], a[40:43], v[32:35]
    ds_read_b128 v[116:119], v14 offset:28672
    s_add_u32 m0, s73, 149760
    v_mfma_f32_16x16x32_bf16 v[32:35], v[120:123], a[32:35], v[32:35]
    buffer_load_dwordx4 v23, s[44:47], s23 offen offset:768 sc1 lds
    ds_read_b64_tr_b16 a[162:163], v10 offset:34816
    s_waitcnt lgkmcnt(4)
    v_mfma_f32_16x16x32_bf16 v[40:43], v[104:107], a[32:35], v[40:43]
    s_add_u32 m0, s73, 98304
    ds_read_b64_tr_b16 a[168:169], v10 offset:36864
    v_mfma_f32_16x16x32_bf16 v[40:43], v[108:111], a[40:43], v[40:43]
    buffer_load_dwordx4 v20, s[44:47], s23 offen offset:0 sc1 lds
    ds_read_b64_tr_b16 a[170:171], v10 offset:38912
    s_waitcnt lgkmcnt(3)
    v_mfma_f32_16x16x32_bf16 v[40:43], v[112:115], a[48:51], v[40:43]
    ds_read_b128 v[120:123], v14 offset:17408
    v_mfma_f32_16x16x32_bf16 v[40:43], v[116:119], a[56:59], v[40:43]
    ds_read_b128 v[124:127], v14 offset:21504
    v_add_u32 v11, -131072, v11
    v_mfma_f32_16x16x32_bf16 v[44:47], v[116:119], a[60:63], v[44:47]
    ds_read_b128 v[128:131], v14 offset:25600
    v_mfma_f32_16x16x32_bf16 v[44:47], v[112:115], a[52:55], v[44:47]
    ds_read_b128 v[132:135], v14 offset:29696
    v_mfma_f32_16x16x32_bf16 v[44:47], v[108:111], a[44:47], v[44:47]
    s_add_u32 m0, s73, 98816
    ds_read_b64_tr_b16 a[164:165], v11 offset:32768
    v_mfma_f32_16x16x32_bf16 v[44:47], v[104:107], a[36:39], v[44:47]
    buffer_load_dwordx4 v20, s[44:47], s23 offen offset:512 sc1 lds
    ds_read_b64_tr_b16 a[166:167], v11 offset:34816
    s_waitcnt lgkmcnt(4)
    v_mfma_f32_16x16x32_bf16 v[52:55], v[120:123], a[36:39], v[52:55]
    s_add_u32 m0, s73, 99584
    ds_read_b64_tr_b16 a[172:173], v11 offset:36864
    v_mfma_f32_16x16x32_bf16 v[52:55], v[124:127], a[44:47], v[52:55]
    buffer_load_dwordx4 v23, s[44:47], s24 offen offset:768 sc1 lds
    ds_read_b64_tr_b16 a[174:175], v11 offset:38912
    s_waitcnt lgkmcnt(4)
    v_mfma_f32_16x16x32_bf16 v[52:55], v[128:131], a[52:55], v[52:55]
    ds_read_b128 v[104:107], v14 offset:18432
    v_mfma_f32_16x16x32_bf16 v[52:55], v[132:135], a[60:63], v[52:55]
    ds_read_b128 v[108:111], v14 offset:22528
    v_add_u32 v10, 65536, v10
    v_mfma_f32_16x16x32_bf16 v[48:51], v[132:135], a[56:59], v[48:51]
    ds_read_b128 v[112:115], v14 offset:26624
    v_mfma_f32_16x16x32_bf16 v[48:51], v[128:131], a[48:51], v[48:51]
    ds_read_b128 v[116:119], v14 offset:30720
    v_mfma_f32_16x16x32_bf16 v[48:51], v[124:127], a[40:43], v[48:51]
    s_add_u32 m0, s73, 101376
    ds_read_b64_tr_b16 a[176:177], v10 offset:16384
    v_mfma_f32_16x16x32_bf16 v[48:51], v[120:123], a[32:35], v[48:51]
    buffer_load_dwordx4 v20, s[44:47], s24 offen offset:0 sc1 lds
    ds_read_b64_tr_b16 a[178:179], v10 offset:18432
    s_waitcnt lgkmcnt(4)
    v_mfma_f32_16x16x32_bf16 v[32:35], v[104:107], a[64:67], v[32:35]
    ds_read_b64_tr_b16 a[184:185], v10 offset:20480
    v_mfma_f32_16x16x32_bf16 v[32:35], v[108:111], a[72:75], v[32:35]
    ds_read_b64_tr_b16 a[186:187], v10 offset:22528
    s_waitcnt lgkmcnt(4)
    v_mfma_f32_16x16x32_bf16 v[32:35], v[112:115], a[80:83], v[32:35]
    ds_read_b128 v[120:123], v14 offset:19456
    v_mfma_f32_16x16x32_bf16 v[32:35], v[116:119], a[88:91], v[32:35]
    ds_read_b128 v[124:127], v14 offset:23552
    v_add_u32 v11, 65536, v11
    v_mfma_f32_16x16x32_bf16 v[36:39], v[116:119], a[92:95], v[36:39]
    ds_read_b128 v[128:131], v14 offset:27648
    v_mfma_f32_16x16x32_bf16 v[36:39], v[112:115], a[84:87], v[36:39]
    ds_read_b128 v[132:135], v14 offset:31744
    v_mfma_f32_16x16x32_bf16 v[36:39], v[108:111], a[76:79], v[36:39]
    ds_read_b64_tr_b16 a[180:181], v11 offset:16384
    v_mfma_f32_16x16x32_bf16 v[36:39], v[104:107], a[68:71], v[36:39]
    ds_read_b64_tr_b16 a[182:183], v11 offset:18432
    s_waitcnt lgkmcnt(4)
    v_mfma_f32_16x16x32_bf16 v[44:47], v[120:123], a[68:71], v[44:47]
    ds_read_b64_tr_b16 a[188:189], v11 offset:20480
    v_mfma_f32_16x16x32_bf16 v[44:47], v[124:127], a[76:79], v[44:47]
    ds_read_b64_tr_b16 a[190:191], v11 offset:22528
    s_waitcnt lgkmcnt(4)
    v_mfma_f32_16x16x32_bf16 v[44:47], v[128:131], a[84:87], v[44:47]
    s_waitcnt vmcnt(8) lgkmcnt(0)
    s_barrier
    v_mfma_f32_16x16x32_bf16 v[44:47], v[132:135], a[92:95], v[44:47]
    ds_read_b128 v[104:107], v14 offset:32768
    s_lshl_b32 s14, s100, 18
    s_add_u32 m0, s73, 32768
    v_add_u32 v10, -65536, v10
    v_mfma_f32_16x16x32_bf16 v[40:43], v[132:135], a[88:91], v[40:43]
    ds_read_b128 v[108:111], v14 offset:36864
    buffer_load_dwordx4 v4, s[52:55], s14 offen offset:0 lds
    v_mfma_f32_16x16x32_bf16 v[40:43], v[128:131], a[80:83], v[40:43]
    ds_read_b128 v[112:115], v14 offset:40960
    ds_read_b64_tr_b16 a[192:193], v10 offset:0
    v_mfma_f32_16x16x32_bf16 v[40:43], v[124:127], a[72:75], v[40:43]
    ds_read_b128 v[116:119], v14 offset:45056
    v_mfma_f32_16x16x32_bf16 v[40:43], v[120:123], a[64:67], v[40:43]
    ds_read_b64_tr_b16 a[194:195], v10 offset:2048
    s_waitcnt lgkmcnt(4)
    v_mfma_f32_16x16x32_bf16 v[48:51], v[104:107], a[64:67], v[48:51]
    s_add_u32 m0, s73, 114176
    ds_read_b64_tr_b16 a[200:201], v10 offset:4096
    v_mfma_f32_16x16x32_bf16 v[48:51], v[108:111], a[72:75], v[48:51]
    buffer_load_dwordx4 v20, s[44:47], s24 offen offset:512 sc1 lds
    ds_read_b64_tr_b16 a[202:203], v10 offset:6144
    s_waitcnt lgkmcnt(3)
    v_mfma_f32_16x16x32_bf16 v[48:51], v[112:115], a[80:83], v[48:51]
    ds_read_b128 v[120:123], v14 offset:33792
    s_add_u32 m0, s73, 32768
    v_lshrrev_b32 v30, 2, v26
    v_mfma_f32_16x16x32_bf16 v[48:51], v[116:119], a[88:91], v[48:51]
    ds_read_b128 v[124:127], v14 offset:37888
    buffer_load_dwordx4 v5, s[52:55], s14 offen offset:1024 lds
    v_mfma_f32_16x16x32_bf16 v[52:55], v[116:119], a[92:95], v[52:55]
    ds_read_b128 v[128:131], v14 offset:41984
    v_add_u32 v11, -65536, v11
    v_mfma_f32_16x16x32_bf16 v[52:55], v[112:115], a[84:87], v[52:55]
    ds_read_b128 v[132:135], v14 offset:46080
    v_mfma_f32_16x16x32_bf16 v[52:55], v[108:111], a[76:79], v[52:55]
    s_add_u32 m0, s73, 114944
    ds_read_b64_tr_b16 a[196:197], v11 offset:0
    v_mfma_f32_16x16x32_bf16 v[52:55], v[104:107], a[68:71], v[52:55]
    buffer_load_dwordx4 v23, s[44:47], s25 offen offset:768 sc1 lds
    ds_read_b64_tr_b16 a[198:199], v11 offset:2048
    s_waitcnt lgkmcnt(4)
    v_mfma_f32_16x16x32_bf16 v[36:39], v[120:123], a[100:103], v[36:39]
    s_add_u32 m0, s73, 116736
    ds_read_b64_tr_b16 a[204:205], v11 offset:4096
    v_mfma_f32_16x16x32_bf16 v[36:39], v[124:127], a[108:111], v[36:39]
    buffer_load_dwordx4 v20, s[44:47], s25 offen offset:0 sc1 lds
    ds_read_b64_tr_b16 a[206:207], v11 offset:6144
    s_waitcnt lgkmcnt(4)
    v_mfma_f32_16x16x32_bf16 v[36:39], v[128:131], a[116:119], v[36:39]
    ds_read_b128 v[104:107], v14 offset:34816
L_pl_G_6:
    s_cbranch_execz L_wret
    s_add_u32 m0, s73, 32768
    v_lshrrev_b32 v31, 2, v18
    v_mfma_f32_16x16x32_bf16 v[36:39], v[132:135], a[124:127], v[36:39]
    ds_read_b128 v[108:111], v14 offset:38912
    buffer_load_dwordx4 v6, s[52:55], s14 offen offset:2048 lds
    v_mfma_f32_16x16x32_bf16 v[32:35], v[132:135], a[120:123], v[32:35]
    ds_read_b128 v[112:115], v14 offset:43008
    v_mfma_f32_16x16x32_bf16 v[32:35], v[128:131], a[112:115], v[32:35]
    ds_read_b128 v[116:119], v14 offset:47104
    v_mfma_f32_16x16x32_bf16 v[32:35], v[124:127], a[104:107], v[32:35]
    s_add_u32 m0, s73, 117248
    ds_read_b64_tr_b16 a[208:209], v10 offset:16384
    v_mfma_f32_16x16x32_bf16 v[32:35], v[120:123], a[96:99], v[32:35]
    buffer_load_dwordx4 v20, s[44:47], s25 offen offset:512 sc1 lds
    ds_read_b64_tr_b16 a[210:211], v10 offset:18432
    s_waitcnt lgkmcnt(4)
    v_mfma_f32_16x16x32_bf16 v[40:43], v[104:107], a[96:99], v[40:43]
    ds_read_b64_tr_b16 a[216:217], v10 offset:20480
    buffer_load_ushort v102, v30, s[60:63], 0 offen offset:0
    s_add_u32 m0, s73, 32768
    v_mfma_f32_16x16x32_bf16 v[40:43], v[108:111], a[104:107], v[40:43]
    ds_read_b64_tr_b16 a[218:219], v10 offset:22528
    buffer_load_dwordx4 v7, s[52:55], s14 offen offset:3072 lds
    s_waitcnt lgkmcnt(4)
    v_mfma_f32_16x16x32_bf16 v[40:43], v[112:115], a[112:115], v[40:43]
    ds_read_b128 v[120:123], v14 offset:35840
    v_mfma_f32_16x16x32_bf16 v[40:43], v[116:119], a[120:123], v[40:43]
    ds_read_b128 v[124:127], v14 offset:39936
    v_mfma_f32_16x16x32_bf16 v[44:47], v[116:119], a[124:127], v[44:47]
    ds_read_b128 v[128:131], v14 offset:44032
    v_mfma_f32_16x16x32_bf16 v[44:47], v[112:115], a[116:119], v[44:47]
    ds_read_b128 v[132:135], v14 offset:48128
    v_mfma_f32_16x16x32_bf16 v[44:47], v[108:111], a[108:111], v[44:47]
    ds_read_b64_tr_b16 a[212:213], v11 offset:16384
    buffer_load_ushort v103, v30, s[60:63], 0 offen offset:32
    v_mfma_f32_16x16x32_bf16 v[44:47], v[104:107], a[100:103], v[44:47]
    ds_read_b64_tr_b16 a[214:215], v11 offset:18432
    s_waitcnt lgkmcnt(4)
    v_mfma_f32_16x16x32_bf16 v[52:55], v[120:123], a[100:103], v[52:55]
    ds_read_b64_tr_b16 a[220:221], v11 offset:20480
    v_mfma_f32_16x16x32_bf16 v[52:55], v[124:127], a[108:111], v[52:55]
    ds_read_b64_tr_b16 a[222:223], v11 offset:22528
    s_waitcnt lgkmcnt(4)
    v_mfma_f32_16x16x32_bf16 v[52:55], v[128:131], a[116:119], v[52:55]
    s_waitcnt vmcnt(14) lgkmcnt(0)
    s_barrier
    v_mfma_f32_16x16x32_bf16 v[52:55], v[132:135], a[124:127], v[52:55]
    ds_read_b128 v[104:107], v14 offset:49152
    s_lshl_b32 s14, s101, 18
    ds_read_b64_tr_b16 a[224:225], v10 offset:49152
    s_add_u32 m0, s73, 81920
    v_mfma_f32_16x16x32_bf16 v[48:51], v[132:135], a[120:123], v[48:51]
    ds_read_b128 v[108:111], v14 offset:53248
    buffer_load_dwordx4 v4, s[52:55], s14 offen offset:0 lds
    v_mfma_f32_16x16x32_bf16 v[48:51], v[128:131], a[112:115], v[48:51]
    ds_read_b128 v[112:115], v14 offset:57344
    buffer_load_ushort v27, v31, s[60:63], 0 offen offset:0
    v_mfma_f32_16x16x32_bf16 v[48:51], v[124:127], a[104:107], v[48:51]
    ds_read_b128 v[116:119], v14 offset:61440
    v_mfma_f32_16x16x32_bf16 v[48:51], v[120:123], a[96:99], v[48:51]
    ds_read_b64_tr_b16 a[226:227], v10 offset:51200
    s_waitcnt lgkmcnt(3)
    v_mfma_f32_16x16x32_bf16 v[32:35], v[104:107], a[128:131], v[32:35]
    s_add_u32 m0, s73, 130304
    ds_read_b64_tr_b16 a[232:233], v10 offset:53248
    v_mfma_f32_16x16x32_bf16 v[32:35], v[108:111], a[136:139], v[32:35]
    buffer_load_dwordx4 v23, s[44:47], s26 offen offset:768 sc1 lds
    ds_read_b64_tr_b16 a[234:235], v10 offset:55296
    s_waitcnt lgkmcnt(3)
    v_mfma_f32_16x16x32_bf16 v[32:35], v[112:115], a[144:147], v[32:35]
    ds_read_b128 v[120:123], v14 offset:50176
    s_add_u32 m0, s73, 81920
    v_mfma_f32_16x16x32_bf16 v[32:35], v[116:119], a[152:155], v[32:35]
    ds_read_b128 v[124:127], v14 offset:54272
    buffer_load_dwordx4 v5, s[52:55], s14 offen offset:1024 lds
    v_mfma_f32_16x16x32_bf16 v[36:39], v[116:119], a[156:159], v[36:39]
    ds_read_b128 v[128:131], v14 offset:58368
    v_mfma_f32_16x16x32_bf16 v[36:39], v[112:115], a[148:151], v[36:39]
    ds_read_b128 v[132:135], v14 offset:62464
    v_mfma_f32_16x16x32_bf16 v[36:39], v[108:111], a[140:143], v[36:39]
    s_add_u32 m0, s73, 132096
    ds_read_b64_tr_b16 a[228:229], v11 offset:49152
    v_mfma_f32_16x16x32_bf16 v[36:39], v[104:107], a[132:135], v[36:39]
    buffer_load_dwordx4 v20, s[44:47], s26 offen offset:0 sc1 lds
    ds_read_b64_tr_b16 a[230:231], v11 offset:51200
    s_waitcnt lgkmcnt(4)
    v_mfma_f32_16x16x32_bf16 v[44:47], v[120:123], a[132:135], v[44:47]
    ds_read_b64_tr_b16 a[236:237], v11 offset:53248
    buffer_load_dwordx4 v[88:91], v252, s[56:59], 0 offen
    s_add_u32 m0, s73, 132608
    v_mfma_f32_16x16x32_bf16 v[44:47], v[124:127], a[140:143], v[44:47]
    buffer_load_dwordx4 v20, s[44:47], s26 offen offset:512 sc1 lds
    ds_read_b64_tr_b16 a[238:239], v11 offset:55296
    s_waitcnt lgkmcnt(4)
    v_mfma_f32_16x16x32_bf16 v[44:47], v[128:131], a[148:151], v[44:47]
    ds_read_b128 v[104:107], v14 offset:51200
    s_add_u32 m0, s73, 81920
    v_add_u32 v10, 65536, v10
    v_mfma_f32_16x16x32_bf16 v[44:47], v[132:135], a[156:159], v[44:47]
    ds_read_b128 v[108:111], v14 offset:55296
    buffer_load_dwordx4 v6, s[52:55], s14 offen offset:2048 lds
    v_mfma_f32_16x16x32_bf16 v[40:43], v[132:135], a[152:155], v[40:43]
    ds_read_b128 v[112:115], v14 offset:59392
    v_mfma_f32_16x16x32_bf16 v[40:43], v[128:131], a[144:147], v[40:43]
    ds_read_b128 v[116:119], v14 offset:63488
    v_mfma_f32_16x16x32_bf16 v[40:43], v[124:127], a[136:139], v[40:43]
    s_add_u32 m0, s73, 134144
    ds_read_b64_tr_b16 a[240:241], v10 offset:0
    v_mfma_f32_16x16x32_bf16 v[40:43], v[120:123], a[128:131], v[40:43]
    buffer_load_dwordx4 v21, s[44:47], s18 offen offset:0 sc1 lds
    ds_read_b64_tr_b16 a[242:243], v10 offset:2048
    s_waitcnt lgkmcnt(4)
    v_mfma_f32_16x16x32_bf16 v[48:51], v[104:107], a[128:131], v[48:51]
    ds_read_b64_tr_b16 a[248:249], v10 offset:4096
    s_add_u32 m0, s73, 81920
    v_mfma_f32_16x16x32_bf16 v[48:51], v[108:111], a[136:139], v[48:51]
    ds_read_b64_tr_b16 a[250:251], v10 offset:6144
    buffer_load_dwordx4 v7, s[52:55], s14 offen offset:3072 lds
    s_waitcnt lgkmcnt(4)
    v_mfma_f32_16x16x32_bf16 v[48:51], v[112:115], a[144:147], v[48:51]
    ds_read_b128 v[120:123], v14 offset:52224
    v_add_u32 v11, 65536, v11
    v_mfma_f32_16x16x32_bf16 v[48:51], v[116:119], a[152:155], v[48:51]
    ds_read_b128 v[124:127], v14 offset:56320
    v_mfma_f32_16x16x32_bf16 v[52:55], v[116:119], a[156:159], v[52:55]
    ds_read_b128 v[128:131], v14 offset:60416
    v_mfma_f32_16x16x32_bf16 v[52:55], v[112:115], a[148:151], v[52:55]
    ds_read_b128 v[132:135], v14 offset:64512
    v_mfma_f32_16x16x32_bf16 v[52:55], v[108:111], a[140:143], v[52:55]
    ds_read_b64_tr_b16 a[244:245], v11 offset:0
    v_mfma_f32_16x16x32_bf16 v[52:55], v[104:107], a[132:135], v[52:55]
    ds_read_b64_tr_b16 a[246:247], v11 offset:2048
    s_waitcnt lgkmcnt(4)
    v_mfma_f32_16x16x32_bf16 v[36:39], v[120:123], a[164:167], v[36:39]
    ds_read_b64_tr_b16 a[252:253], v11 offset:4096
    buffer_load_dwordx4 v[92:95], v252, s[56:59], s40 offen
    v_mfma_f32_16x16x32_bf16 v[36:39], v[124:127], a[172:175], v[36:39]
    ds_read_b64_tr_b16 a[254:255], v11 offset:6144
    s_waitcnt lgkmcnt(4)
    v_mfma_f32_16x16x32_bf16 v[36:39], v[128:131], a[180:183], v[36:39]
    s_waitcnt vmcnt(12) lgkmcnt(0)
    s_barrier
    v_mfma_f32_16x16x32_bf16 v[36:39], v[132:135], a[188:191], v[36:39]
    ds_read_b128 v[104:107], v14 offset:0
    v_mfma_f32_16x16x32_bf16 v[32:35], v[132:135], a[184:187], v[32:35]
    ds_read_b128 v[108:111], v14 offset:4096
    v_add_u32 v10, -65536, v10
    v_mfma_f32_16x16x32_bf16 v[32:35], v[128:131], a[176:179], v[32:35]
    ds_read_b128 v[112:115], v14 offset:8192
    v_mfma_f32_16x16x32_bf16 v[32:35], v[124:127], a[168:171], v[32:35]
    ds_read_b128 v[116:119], v14 offset:12288
    v_mfma_f32_16x16x32_bf16 v[32:35], v[120:123], a[160:163], v[32:35]
    ds_read_b64_tr_b16 v[220:221], v10 offset:32768
    s_waitcnt lgkmcnt(3)
    v_mfma_f32_16x16x32_bf16 v[40:43], v[104:107], a[160:163], v[40:43]
    s_add_u32 m0, s73, 146944
    v_mfma_f32_16x16x32_bf16 v[40:43], v[108:111], a[168:171], v[40:43]
    buffer_load_dwordx4 v21, s[44:47], s18 offen offset:512 sc1 lds
    ds_read_b64_tr_b16 v[222:223], v10 offset:34816
    s_waitcnt lgkmcnt(2)
    v_mfma_f32_16x16x32_bf16 v[40:43], v[112:115], a[176:179], v[40:43]
    ds_read_b128 v[120:123], v14 offset:1024
    v_mfma_f32_16x16x32_bf16 v[40:43], v[116:119], a[184:187], v[40:43]
    ds_read_b128 v[124:127], v14 offset:5120
    v_mfma_f32_16x16x32_bf16 v[44:47], v[116:119], a[188:191], v[44:47]
    ds_read_b128 v[128:131], v14 offset:9216
    v_mfma_f32_16x16x32_bf16 v[44:47], v[112:115], a[180:183], v[44:47]
    ds_read_b128 v[132:135], v14 offset:13312
    v_mfma_f32_16x16x32_bf16 v[44:47], v[108:111], a[172:175], v[44:47]
    s_add_u32 m0, s73, 148480
    ds_read_b64_tr_b16 v[228:229], v10 offset:36864
    v_mfma_f32_16x16x32_bf16 v[44:47], v[104:107], a[164:167], v[44:47]
    buffer_load_dwordx4 v21, s[44:47], s19 offen offset:0 sc1 lds
    s_waitcnt lgkmcnt(3)
    v_mfma_f32_16x16x32_bf16 v[52:55], v[120:123], a[164:167], v[52:55]
    ds_read_b64_tr_b16 v[230:231], v10 offset:38912
    buffer_load_dwordx2 v[142:143], v253, s[56:59], 0 offen
    s_add_u32 m0, s73, 148992
    v_mfma_f32_16x16x32_bf16 v[52:55], v[124:127], a[172:175], v[52:55]
    buffer_load_dwordx4 v21, s[44:47], s19 offen offset:512 sc1 lds
    s_waitcnt lgkmcnt(2)
    v_mfma_f32_16x16x32_bf16 v[52:55], v[128:131], a[180:183], v[52:55]
    ds_read_b128 v[104:107], v14 offset:2048
    v_mfma_f32_16x16x32_bf16 v[52:55], v[132:135], a[188:191], v[52:55]
    ds_read_b128 v[108:111], v14 offset:6144
    v_mfma_f32_16x16x32_bf16 v[48:51], v[132:135], a[184:187], v[48:51]
    ds_read_b128 v[112:115], v14 offset:10240
    v_add_u32 v11, -65536, v11
    v_mfma_f32_16x16x32_bf16 v[48:51], v[128:131], a[176:179], v[48:51]
    ds_read_b128 v[116:119], v14 offset:14336
    v_mfma_f32_16x16x32_bf16 v[48:51], v[124:127], a[168:171], v[48:51]
    s_add_u32 m0, s73, 150528
    v_mfma_f32_16x16x32_bf16 v[48:51], v[120:123], a[160:163], v[48:51]
    buffer_load_dwordx4 v21, s[44:47], s20 offen offset:0 sc1 lds
    ds_read_b64_tr_b16 v[224:225], v11 offset:32768
    s_waitcnt lgkmcnt(3)
    v_mfma_f32_16x16x32_bf16 v[32:35], v[104:107], a[192:195], v[32:35]
    v_mfma_f32_16x16x32_bf16 v[32:35], v[108:111], a[200:203], v[32:35]
    ds_read_b64_tr_b16 v[226:227], v11 offset:34816
    s_waitcnt vmcnt(14)
    s_waitcnt lgkmcnt(2)
    v_mfma_f32_16x16x32_bf16 v[32:35], v[112:115], a[208:211], v[32:35]
    ds_read_b128 v[120:123], v14 offset:3072
    v_mfma_f32_16x16x32_bf16 v[32:35], v[116:119], a[216:219], v[32:35]
    ds_read_b128 v[124:127], v14 offset:7168
    v_mfma_f32_16x16x32_bf16 v[36:39], v[116:119], a[220:223], v[36:39]
    ds_read_b128 v[128:131], v14 offset:11264
    v_lshlrev_b32 v72, 16, v102
    v_mfma_f32_16x16x32_bf16 v[36:39], v[112:115], a[212:215], v[36:39]
    ds_read_b128 v[132:135], v14 offset:15360
    v_mfma_f32_16x16x32_bf16 v[36:39], v[108:111], a[204:207], v[36:39]
    ds_read_b64_tr_b16 v[232:233], v11 offset:36864
    v_lshlrev_b32 v73, 16, v102
    v_mfma_f32_16x16x32_bf16 v[36:39], v[104:107], a[196:199], v[36:39]
    s_waitcnt lgkmcnt(3)
    v_mfma_f32_16x16x32_bf16 v[44:47], v[120:123], a[196:199], v[44:47]
    ds_read_b64_tr_b16 v[234:235], v11 offset:38912
    buffer_load_dwordx2 v[96:97], v26, s[44:47], s42 offen offset:0 sc1
    v_mfma_f32_16x16x32_bf16 v[44:47], v[124:127], a[204:207], v[44:47]
    v_lshlrev_b32 v74, 16, v102
    s_waitcnt lgkmcnt(2)
    v_mfma_f32_16x16x32_bf16 v[44:47], v[128:131], a[212:215], v[44:47]
    s_waitcnt vmcnt(7) lgkmcnt(0)
    s_barrier
    v_mfma_f32_16x16x32_bf16 v[44:47], v[132:135], a[220:223], v[44:47]
    ds_read_b128 v[104:107], v14 offset:16384
    v_lshlrev_b32 v75, 16, v102
    v_mfma_f32_16x16x32_bf16 v[40:43], v[132:135], a[216:219], v[40:43]
    ds_read_b128 v[108:111], v14 offset:20480
    v_add_u32 v10, 65536, v10
    v_mfma_f32_16x16x32_bf16 v[40:43], v[128:131], a[208:211], v[40:43]
    ds_read_b128 v[112:115], v14 offset:24576
    v_mfma_f32_16x16x32_bf16 v[40:43], v[124:127], a[200:203], v[40:43]
    ds_read_b128 v[116:119], v14 offset:28672
    v_lshlrev_b32 v76, 16, v103
    v_mfma_f32_16x16x32_bf16 v[40:43], v[120:123], a[192:195], v[40:43]
    ds_read_b64_tr_b16 v[236:237], v10 offset:16384
    s_waitcnt lgkmcnt(3)
    v_mfma_f32_16x16x32_bf16 v[48:51], v[104:107], a[192:195], v[48:51]
    s_add_u32 m0, s73, 97792
    v_lshlrev_b32 v77, 16, v103
    v_mfma_f32_16x16x32_bf16 v[48:51], v[108:111], a[200:203], v[48:51]
    buffer_load_dwordx4 v21, s[44:47], s20 offen offset:512 sc1 lds
    ds_read_b64_tr_b16 v[238:239], v10 offset:18432
    s_waitcnt lgkmcnt(2)
    v_mfma_f32_16x16x32_bf16 v[48:51], v[112:115], a[208:211], v[48:51]
    ds_read_b128 v[120:123], v14 offset:17408
    v_mfma_f32_16x16x32_bf16 v[48:51], v[116:119], a[216:219], v[48:51]
    ds_read_b128 v[124:127], v14 offset:21504
    v_mfma_f32_16x16x32_bf16 v[52:55], v[116:119], a[220:223], v[52:55]
    ds_read_b128 v[128:131], v14 offset:25600
    v_lshlrev_b32 v78, 16, v103
    v_mfma_f32_16x16x32_bf16 v[52:55], v[112:115], a[212:215], v[52:55]
    ds_read_b128 v[132:135], v14 offset:29696
    v_mfma_f32_16x16x32_bf16 v[52:55], v[108:111], a[204:207], v[52:55]
    ds_read_b64_tr_b16 v[244:245], v10 offset:20480
    s_add_u32 m0, s73, 99328
    v_lshlrev_b32 v79, 16, v103
    v_mfma_f32_16x16x32_bf16 v[52:55], v[104:107], a[196:199], v[52:55]
    buffer_load_dwordx4 v21, s[44:47], s21 offen offset:0 sc1 lds
    s_waitcnt lgkmcnt(3)
    v_mfma_f32_16x16x32_bf16 v[36:39], v[120:123], a[228:231], v[36:39]
    ds_read_b64_tr_b16 v[246:247], v10 offset:22528
    buffer_load_dwordx2 v[98:99], v26, s[44:47], s42 offen offset:128 sc1
    s_add_u32 m0, s73, 99840
    v_mfma_f32_16x16x32_bf16 v[36:39], v[124:127], a[236:239], v[36:39]
    buffer_load_dwordx4 v21, s[44:47], s21 offen offset:512 sc1 lds
    s_waitcnt lgkmcnt(2)
    v_mfma_f32_16x16x32_bf16 v[36:39], v[128:131], a[244:247], v[36:39]
    ds_read_b128 v[104:107], v14 offset:18432
    v_lshlrev_b32 v80, 16, v102
    v_mfma_f32_16x16x32_bf16 v[36:39], v[132:135], a[252:255], v[36:39]
    ds_read_b128 v[108:111], v14 offset:22528
    v_lshlrev_b32 v81, 16, v102
    v_mfma_f32_16x16x32_bf16 v[32:35], v[132:135], a[248:251], v[32:35]
    ds_read_b128 v[112:115], v14 offset:26624
    v_add_u32 v11, 65536, v11
    v_mfma_f32_16x16x32_bf16 v[32:35], v[128:131], a[240:243], v[32:35]
    ds_read_b128 v[116:119], v14 offset:30720
    v_mfma_f32_16x16x32_bf16 v[32:35], v[124:127], a[232:235], v[32:35]
    s_add_u32 m0, s73, 101376
    v_lshlrev_b32 v82, 16, v102
    v_mfma_f32_16x16x32_bf16 v[32:35], v[120:123], a[224:227], v[32:35]
    buffer_load_dwordx4 v21, s[44:47], s22 offen offset:0 sc1 lds
    ds_read_b64_tr_b16 v[240:241], v11 offset:16384
    s_waitcnt lgkmcnt(3)
    v_mfma_f32_16x16x32_bf16 v[40:43], v[104:107], a[224:227], v[40:43]
    v_lshlrev_b32 v83, 16, v102
    v_mfma_f32_16x16x32_bf16 v[40:43], v[108:111], a[232:235], v[40:43]
    ds_read_b64_tr_b16 v[242:243], v11 offset:18432
    s_waitcnt lgkmcnt(2)
    v_mfma_f32_16x16x32_bf16 v[40:43], v[112:115], a[240:243], v[40:43]
    ds_read_b128 v[120:123], v14 offset:19456
    v_mfma_f32_16x16x32_bf16 v[40:43], v[116:119], a[248:251], v[40:43]
    ds_read_b128 v[124:127], v14 offset:23552
    v_mfma_f32_16x16x32_bf16 v[44:47], v[116:119], a[252:255], v[44:47]
    ds_read_b128 v[128:131], v14 offset:27648
    v_lshlrev_b32 v84, 16, v103
    v_mfma_f32_16x16x32_bf16 v[44:47], v[112:115], a[244:247], v[44:47]
    ds_read_b128 v[132:135], v14 offset:31744
    v_mfma_f32_16x16x32_bf16 v[44:47], v[108:111], a[236:239], v[44:47]
    ds_read_b64_tr_b16 v[248:249], v11 offset:20480
    v_lshlrev_b32 v85, 16, v103
    v_mfma_f32_16x16x32_bf16 v[44:47], v[104:107], a[228:231], v[44:47]
    s_waitcnt lgkmcnt(3)
    v_mfma_f32_16x16x32_bf16 v[52:55], v[120:123], a[228:231], v[52:55]
    ds_read_b64_tr_b16 v[250:251], v11 offset:22528
    buffer_load_dwordx2 v[100:101], v18, s[44:47], s42 offen offset:0 sc1
    v_mfma_f32_16x16x32_bf16 v[52:55], v[124:127], a[236:239], v[52:55]
    v_lshlrev_b32 v86, 16, v103
    s_waitcnt lgkmcnt(2)
    v_mfma_f32_16x16x32_bf16 v[52:55], v[128:131], a[244:247], v[52:55]
    s_waitcnt lgkmcnt(0)
    s_barrier
    v_mfma_f32_16x16x32_bf16 v[52:55], v[132:135], a[252:255], v[52:55]
    ds_read_b128 v[104:107], v14 offset:32768
    v_mfma_f32_16x16x32_bf16 v[48:51], v[132:135], a[248:251], v[48:51]
    ds_read_b128 v[108:111], v14 offset:36864
    v_lshlrev_b32 v87, 16, v103
    v_mfma_f32_16x16x32_bf16 v[48:51], v[128:131], a[240:243], v[48:51]
    ds_read_b128 v[112:115], v14 offset:40960
    v_mfma_f32_16x16x32_bf16 v[48:51], v[124:127], a[232:235], v[48:51]
    ds_read_b128 v[116:119], v14 offset:45056
    v_lshlrev_b32 v27, 16, v27
    v_mfma_f32_16x16x32_bf16 v[48:51], v[120:123], a[224:227], v[48:51]
L_Dc:
L_pl_D_0:
    s_cbranch_execz L_wret
    s_waitcnt lgkmcnt(2)
    v_mfma_f32_16x16x32_bf16 v[32:35], v[104:107], v[220:223], v[32:35]
    s_add_u32 m0, s73, 114176
    v_mfma_f32_16x16x32_bf16 v[32:35], v[108:111], v[228:231], v[32:35]
    buffer_load_dwordx4 v21, s[44:47], s22 offen offset:512 sc1 lds
    s_waitcnt lgkmcnt(0)
    v_mfma_f32_16x16x32_bf16 v[32:35], v[112:115], v[236:239], v[32:35]
    ds_read_b128 v[120:123], v14 offset:33792
    v_mfma_f32_16x16x32_bf16 v[32:35], v[116:119], v[244:247], v[32:35]
    ds_read_b128 v[124:127], v14 offset:37888
    v_mfma_f32_16x16x32_bf16 v[36:39], v[116:119], v[248:251], v[36:39]
    ds_read_b128 v[128:131], v14 offset:41984
    buffer_load_dword v189, v188, s[44:47], 0 offen sc1
    v_mfma_f32_16x16x32_bf16 v[36:39], v[112:115], v[240:243], v[36:39]
    ds_read_b128 v[132:135], v14 offset:46080
    v_mfma_f32_16x16x32_bf16 v[36:39], v[108:111], v[232:235], v[36:39]
    s_add_u32 m0, s73, 115712
    v_mfma_f32_16x16x32_bf16 v[36:39], v[104:107], v[224:227], v[36:39]
    buffer_load_dwordx4 v21, s[44:47], s23 offen offset:0 sc1 lds
    s_waitcnt lgkmcnt(2)
    v_mfma_f32_16x16x32_bf16 v[44:47], v[120:123], v[224:227], v[44:47]
    s_add_u32 m0, s73, 116224
    v_mfma_f32_16x16x32_bf16 v[44:47], v[124:127], v[232:235], v[44:47]
    buffer_load_dwordx4 v21, s[44:47], s23 offen offset:512 sc1 lds
    s_waitcnt lgkmcnt(0)
    v_mfma_f32_16x16x32_bf16 v[44:47], v[128:131], v[240:243], v[44:47]
    ds_read_b128 v[104:107], v14 offset:34816
    v_mfma_f32_16x16x32_bf16 v[44:47], v[132:135], v[248:251], v[44:47]
    ds_read_b128 v[108:111], v14 offset:38912
    v_mfma_f32_16x16x32_bf16 v[40:43], v[132:135], v[244:247], v[40:43]
    ds_read_b128 v[112:115], v14 offset:43008
    v_mfma_f32_16x16x32_bf16 v[40:43], v[128:131], v[236:239], v[40:43]
    ds_read_b128 v[116:119], v14 offset:47104
    v_mfma_f32_16x16x32_bf16 v[40:43], v[124:127], v[228:231], v[40:43]
    s_add_u32 m0, s73, 117760
    v_mfma_f32_16x16x32_bf16 v[40:43], v[120:123], v[220:223], v[40:43]
    buffer_load_dwordx4 v21, s[44:47], s24 offen offset:0 sc1 lds
    s_waitcnt lgkmcnt(2)
    v_mfma_f32_16x16x32_bf16 v[48:51], v[104:107], v[220:223], v[48:51]
    v_mfma_f32_16x16x32_bf16 v[48:51], v[108:111], v[228:231], v[48:51]
    s_waitcnt lgkmcnt(0)
    v_mfma_f32_16x16x32_bf16 v[48:51], v[112:115], v[236:239], v[48:51]
    ds_read_b128 v[120:123], v14 offset:35840
    v_mfma_f32_16x16x32_bf16 v[48:51], v[116:119], v[244:247], v[48:51]
    ds_read_b128 v[124:127], v14 offset:39936
    v_mfma_f32_16x16x32_bf16 v[52:55], v[116:119], v[248:251], v[52:55]
    ds_read_b128 v[128:131], v14 offset:44032
    v_mfma_f32_16x16x32_bf16 v[52:55], v[112:115], v[240:243], v[52:55]
    ds_read_b128 v[132:135], v14 offset:48128
    v_mfma_f32_16x16x32_bf16 v[52:55], v[108:111], v[232:235], v[52:55]
    v_mfma_f32_16x16x32_bf16 v[52:55], v[104:107], v[224:227], v[52:55]
    s_waitcnt lgkmcnt(2)
    v_mfma_f32_16x16x32_bf16 v[60:63], v[120:123], a[4:7], 0
    v_mfma_f32_16x16x32_bf16 v[60:63], v[124:127], a[12:15], v[60:63]
    s_waitcnt lgkmcnt(0)
    v_mfma_f32_16x16x32_bf16 v[60:63], v[128:131], a[20:23], v[60:63]
    s_waitcnt vmcnt(12)
    s_barrier
    v_mfma_f32_16x16x32_bf16 v[60:63], v[132:135], a[28:31], v[60:63]
    ds_read_b128 v[104:107], v14 offset:49152
    v_mfma_f32_16x16x32_bf16 v[56:59], v[132:135], a[24:27], 0
    ds_read_b128 v[108:111], v14 offset:53248
    v_mfma_f32_16x16x32_bf16 v[56:59], v[128:131], a[16:19], v[56:59]
    ds_read_b128 v[112:115], v14 offset:57344
    v_cvt_pk_bf16_f32 v192, v32, v33
    v_mfma_f32_16x16x32_bf16 v[56:59], v[124:127], a[8:11], v[56:59]
    ds_read_b128 v[116:119], v14 offset:61440
    v_mfma_f32_16x16x32_bf16 v[56:59], v[120:123], a[0:3], v[56:59]
    s_waitcnt lgkmcnt(2)
    v_mfma_f32_16x16x32_bf16 v[64:67], v[104:107], a[0:3], 0
    s_add_u32 m0, s73, 130560
    v_mfma_f32_16x16x32_bf16 v[64:67], v[108:111], a[8:11], v[64:67]
    buffer_load_dwordx4 v21, s[44:47], s24 offen offset:512 sc1 lds
    s_waitcnt lgkmcnt(0)
    v_mfma_f32_16x16x32_bf16 v[64:67], v[112:115], a[16:19], v[64:67]
    ds_read_b128 v[120:123], v14 offset:50176
    v_cvt_pk_bf16_f32 v193, v34, v35
    v_mfma_f32_16x16x32_bf16 v[64:67], v[116:119], a[24:27], v[64:67]
    ds_read_b128 v[124:127], v14 offset:54272
    v_mfma_f32_16x16x32_bf16 v[68:71], v[116:119], a[28:31], 0
    ds_read_b128 v[128:131], v14 offset:58368
    v_mfma_f32_16x16x32_bf16 v[68:71], v[112:115], a[20:23], v[68:71]
    buffer_store_dwordx4 v[192:195], v136, s[44:47], s32 offen sc1
    ds_read_b128 v[132:135], v14 offset:62464
    v_mfma_f32_16x16x32_bf16 v[68:71], v[108:111], a[12:15], v[68:71]
    s_add_u32 m0, s73, 132096
    v_mfma_f32_16x16x32_bf16 v[68:71], v[104:107], a[4:7], v[68:71]
    buffer_load_dwordx4 v21, s[44:47], s25 offen offset:0 sc1 lds
    s_waitcnt lgkmcnt(2)
    v_mfma_f32_16x16x32_bf16 v[60:63], v[120:123], a[36:39], v[60:63]
    s_add_u32 m0, s73, 132608
    v_mfma_f32_16x16x32_bf16 v[60:63], v[124:127], a[44:47], v[60:63]
    buffer_load_dwordx4 v21, s[44:47], s25 offen offset:512 sc1 lds
    s_waitcnt lgkmcnt(0)
    v_mfma_f32_16x16x32_bf16 v[60:63], v[128:131], a[52:55], v[60:63]
    ds_read_b128 v[104:107], v14 offset:51200
    v_mfma_f32_16x16x32_bf16 v[60:63], v[132:135], a[60:63], v[60:63]
    ds_read_b128 v[108:111], v14 offset:55296
    v_mfma_f32_16x16x32_bf16 v[56:59], v[132:135], a[56:59], v[56:59]
    ds_read_b128 v[112:115], v14 offset:59392
    v_mfma_f32_16x16x32_bf16 v[56:59], v[128:131], a[48:51], v[56:59]
    ds_read_b128 v[116:119], v14 offset:63488
    v_mfma_f32_16x16x32_bf16 v[56:59], v[124:127], a[40:43], v[56:59]
    s_add_u32 m0, s73, 134144
    v_cvt_pk_bf16_f32 v196, v36, v37
    v_mfma_f32_16x16x32_bf16 v[56:59], v[120:123], a[32:35], v[56:59]
    buffer_load_dwordx4 v21, s[44:47], s26 offen offset:0 sc1 lds
    s_waitcnt lgkmcnt(2)
    v_mfma_f32_16x16x32_bf16 v[64:67], v[104:107], a[32:35], v[64:67]
    v_mfma_f32_16x16x32_bf16 v[64:67], v[108:111], a[40:43], v[64:67]
    s_waitcnt lgkmcnt(0)
    v_mfma_f32_16x16x32_bf16 v[64:67], v[112:115], a[48:51], v[64:67]
    ds_read_b128 v[120:123], v14 offset:52224
    v_cvt_pk_bf16_f32 v197, v38, v39
    v_mfma_f32_16x16x32_bf16 v[64:67], v[116:119], a[56:59], v[64:67]
    ds_read_b128 v[124:127], v14 offset:56320
    v_mfma_f32_16x16x32_bf16 v[68:71], v[116:119], a[60:63], v[68:71]
    ds_read_b128 v[128:131], v14 offset:60416
    v_mfma_f32_16x16x32_bf16 v[68:71], v[112:115], a[52:55], v[68:71]
    ds_read_b128 v[132:135], v14 offset:64512
    v_mfma_f32_16x16x32_bf16 v[68:71], v[108:111], a[44:47], v[68:71]
    buffer_store_dwordx4 v[196:199], v136, s[44:47], s33 offen sc1
    v_mfma_f32_16x16x32_bf16 v[68:71], v[104:107], a[36:39], v[68:71]
    s_waitcnt lgkmcnt(2)
    v_mfma_f32_16x16x32_bf16 v[60:63], v[120:123], a[68:71], v[60:63]
    v_mfma_f32_16x16x32_bf16 v[60:63], v[124:127], a[76:79], v[60:63]
    s_waitcnt lgkmcnt(0)
    v_mfma_f32_16x16x32_bf16 v[60:63], v[128:131], a[84:87], v[60:63]
    s_waitcnt vmcnt(12)
    s_barrier
    v_mfma_f32_16x16x32_bf16 v[60:63], v[132:135], a[92:95], v[60:63]
    ds_read_b128 v[104:107], v14 offset:0
    v_mfma_f32_16x16x32_bf16 v[56:59], v[132:135], a[88:91], v[56:59]
    ds_read_b128 v[108:111], v14 offset:4096
    v_mfma_f32_16x16x32_bf16 v[56:59], v[128:131], a[80:83], v[56:59]
    ds_read_b128 v[112:115], v14 offset:8192
    v_cvt_pk_bf16_f32 v192, v40, v41
    v_mfma_f32_16x16x32_bf16 v[56:59], v[124:127], a[72:75], v[56:59]
    ds_read_b128 v[116:119], v14 offset:12288
    v_mfma_f32_16x16x32_bf16 v[56:59], v[120:123], a[64:67], v[56:59]
    s_waitcnt lgkmcnt(2)
    v_mfma_f32_16x16x32_bf16 v[64:67], v[104:107], a[64:67], v[64:67]
    s_add_u32 m0, s73, 146944
    v_cvt_pk_bf16_f32 v193, v42, v43
    s_waitcnt vmcnt(11)
    v_mfma_f32_16x16x32_bf16 v[64:67], v[108:111], a[72:75], v[64:67]
    buffer_load_dwordx4 v21, s[44:47], s26 offen offset:512 sc1 lds
    s_waitcnt lgkmcnt(0)
    v_mfma_f32_16x16x32_bf16 v[64:67], v[112:115], a[80:83], v[64:67]
    ds_read_b128 v[120:123], v14 offset:1024
    v_mul_f32 v96, v96, v97
    v_mfma_f32_16x16x32_bf16 v[64:67], v[116:119], a[88:91], v[64:67]
    ds_read_b128 v[124:127], v14 offset:5120
    v_cvt_pk_bf16_f32 v194, v44, v45
    v_mfma_f32_16x16x32_bf16 v[68:71], v[116:119], a[92:95], v[68:71]
    ds_read_b128 v[128:131], v14 offset:9216
    v_mul_f32 v98, v98, v99
    v_mfma_f32_16x16x32_bf16 v[68:71], v[112:115], a[84:87], v[68:71]
    ds_read_b128 v[132:135], v14 offset:13312
    v_mul_f32 v100, v100, v101
    v_mfma_f32_16x16x32_bf16 v[68:71], v[108:111], a[76:79], v[68:71]
    buffer_store_dwordx4 v[192:195], v136, s[44:47], s30 offen offset:0 sc1
    s_add_u32 m0, s73, 148480
    v_permlane16_swap_b32 v88, v90
    v_mfma_f32_16x16x32_bf16 v[68:71], v[104:107], a[68:71], v[68:71]
    buffer_load_dwordx4 v22, s[44:47], s18 offen offset:0 sc1 lds
    s_waitcnt lgkmcnt(2)
    v_mfma_f32_16x16x32_bf16 v[60:63], v[120:123], a[100:103], v[60:63]
    s_add_u32 m0, s73, 148992
    v_permlane16_swap_b32 v89, v91
    v_permlane16_swap_b32 v92, v94
    v_mfma_f32_16x16x32_bf16 v[60:63], v[124:127], a[108:111], v[60:63]
    buffer_load_dwordx4 v22, s[44:47], s18 offen offset:512 sc1 lds
    s_waitcnt vmcnt(13)
    s_waitcnt lgkmcnt(0)
    v_mfma_f32_16x16x32_bf16 v[60:63], v[128:131], a[116:119], v[60:63]
    ds_read_b128 v[104:107], v14 offset:2048
    v_permlane16_swap_b32 v93, v95
    v_mfma_f32_16x16x32_bf16 v[60:63], v[132:135], a[124:127], v[60:63]
    ds_read_b128 v[108:111], v14 offset:6144
    v_cmp_ne_u32 vcc, s68, v189
    v_mfma_f32_16x16x32_bf16 v[56:59], v[132:135], a[120:123], v[56:59]
    ds_read_b128 v[112:115], v14 offset:10240
    v_and_b32 v145, 0xffff0000, v88
    v_mfma_f32_16x16x32_bf16 v[56:59], v[128:131], a[112:115], v[56:59]
    ds_read_b128 v[116:119], v14 offset:14336
    v_cvt_pk_bf16_f32 v196, v46, v47
    v_mfma_f32_16x16x32_bf16 v[56:59], v[124:127], a[104:107], v[56:59]
    s_add_u32 m0, s73, 150528
    s_cbranch_vccnz L_rs_p3
L_ok_p3:
    v_lshlrev_b32 v144, 16, v88
    v_mfma_f32_16x16x32_bf16 v[56:59], v[120:123], a[96:99], v[56:59]
    buffer_load_dwordx4 v22, s[44:47], s19 offen offset:0 sc1 lds
    s_waitcnt lgkmcnt(2)
    v_mfma_f32_16x16x32_bf16 v[64:67], v[104:107], a[96:99], v[64:67]
    s_add_u32 m0, s73, 81920
    v_cvt_pk_bf16_f32 v197, v48, v49
    v_and_b32 v147, 0xffff0000, v89
    v_mfma_f32_16x16x32_bf16 v[64:67], v[108:111], a[104:107], v[64:67]
    buffer_load_dwordx4 v184, s[44:47], s37 offen offset:0 sc1 lds
    s_waitcnt lgkmcnt(0)
    v_mfma_f32_16x16x32_bf16 v[64:67], v[112:115], a[112:115], v[64:67]
    ds_read_b128 v[120:123], v14 offset:3072
    buffer_load_dwordx4 v185, s[44:47], s37 offen offset:1024 sc1 lds
    v_mfma_f32_16x16x32_bf16 v[64:67], v[116:119], a[120:123], v[64:67]
    ds_read_b128 v[124:127], v14 offset:7168
    s_add_u32 m0, s73, 83968
    v_cvt_pk_bf16_f32 v198, v50, v51
    v_mfma_f32_16x16x32_bf16 v[68:71], v[116:119], a[124:127], v[68:71]
    ds_read_b128 v[128:131], v14 offset:11264
    buffer_load_dwordx4 v184, s[44:47], s16 offen offset:0 sc1 lds
    v_mfma_f32_16x16x32_bf16 v[68:71], v[112:115], a[116:119], v[68:71]
    ds_read_b128 v[132:135], v14 offset:15360
    buffer_load_dwordx4 v185, s[44:47], s16 offen offset:1024 sc1 lds
    v_mfma_f32_16x16x32_bf16 v[68:71], v[108:111], a[108:111], v[68:71]
    buffer_store_dwordx4 v[196:199], v136, s[44:47], s30 offen offset:1024 sc1
    v_lshlrev_b32 v146, 16, v89
    v_and_b32 v149, 0xffff0000, v92
    v_lshlrev_b32 v148, 16, v92
    v_mfma_f32_16x16x32_bf16 v[68:71], v[104:107], a[100:103], v[68:71]
    s_waitcnt lgkmcnt(2)
    v_mfma_f32_16x16x32_bf16 v[60:63], v[120:123], a[132:135], v[60:63]
    v_and_b32 v151, 0xffff0000, v93
    v_mfma_f32_16x16x32_bf16 v[60:63], v[124:127], a[140:143], v[60:63]
    v_lshlrev_b32 v150, 16, v93
    s_waitcnt lgkmcnt(0)
    v_mfma_f32_16x16x32_bf16 v[60:63], v[128:131], a[148:151], v[60:63]
    s_waitcnt vmcnt(16)
    s_barrier
    v_mfma_f32_16x16x32_bf16 v[60:63], v[132:135], a[156:159], v[60:63]
    ds_read_b128 v[104:107], v14 offset:16384
    v_and_b32 v153, 0xffff0000, v90
    v_mfma_f32_16x16x32_bf16 v[56:59], v[132:135], a[152:155], v[56:59]
    ds_read_b128 v[108:111], v14 offset:20480
    v_lshlrev_b32 v152, 16, v90
    v_mfma_f32_16x16x32_bf16 v[56:59], v[128:131], a[144:147], v[56:59]
    ds_read_b128 v[112:115], v14 offset:24576
L_pl_D_1:
    s_cbranch_execz L_wret
    v_cvt_pk_bf16_f32 v200, v52, v53
    v_mfma_f32_16x16x32_bf16 v[56:59], v[124:127], a[136:139], v[56:59]
    ds_read_b128 v[116:119], v14 offset:28672
    v_and_b32 v155, 0xffff0000, v91
    v_mfma_f32_16x16x32_bf16 v[56:59], v[120:123], a[128:131], v[56:59]
    s_waitcnt lgkmcnt(2)
    v_mfma_f32_16x16x32_bf16 v[64:67], v[104:107], a[128:131], v[64:67]
    s_add_u32 m0, s73, 97792
    v_lshlrev_b32 v154, 16, v91
    v_mfma_f32_16x16x32_bf16 v[64:67], v[108:111], a[136:139], v[64:67]
    buffer_load_dwordx4 v22, s[44:47], s19 offen offset:512 sc1 lds
    s_waitcnt lgkmcnt(0)
    v_mfma_f32_16x16x32_bf16 v[64:67], v[112:115], a[144:147], v[64:67]
    ds_read_b128 v[120:123], v14 offset:17408
    v_cvt_pk_bf16_f32 v201, v54, v55
    v_mfma_f32_16x16x32_bf16 v[64:67], v[116:119], a[152:155], v[64:67]
    ds_read_b128 v[124:127], v14 offset:21504
    v_and_b32 v157, 0xffff0000, v94
    v_mfma_f32_16x16x32_bf16 v[68:71], v[116:119], a[156:159], v[68:71]
    ds_read_b128 v[128:131], v14 offset:25600
    v_lshlrev_b32 v156, 16, v94
    v_mfma_f32_16x16x32_bf16 v[68:71], v[112:115], a[148:151], v[68:71]
    buffer_store_dwordx4 v[200:203], v136, s[44:47], s30 offen offset:2048 sc1
    ds_read_b128 v[132:135], v14 offset:29696
    v_and_b32 v159, 0xffff0000, v95
    v_mfma_f32_16x16x32_bf16 v[68:71], v[108:111], a[140:143], v[68:71]
    s_add_u32 m0, s73, 99328
    v_lshlrev_b32 v158, 16, v95
    v_mfma_f32_16x16x32_bf16 v[68:71], v[104:107], a[132:135], v[68:71]
    buffer_load_dwordx4 v22, s[44:47], s20 offen offset:0 sc1 lds
    s_waitcnt lgkmcnt(2)
    v_mfma_f32_16x16x32_bf16 v[60:63], v[120:123], a[164:167], v[60:63]
    s_add_u32 m0, s73, 99840
    v_and_b32 v161, 0xffff0000, v142
    v_mfma_f32_16x16x32_bf16 v[60:63], v[124:127], a[172:175], v[60:63]
    buffer_load_dwordx4 v22, s[44:47], s20 offen offset:512 sc1 lds
    s_waitcnt lgkmcnt(0)
    v_mfma_f32_16x16x32_bf16 v[60:63], v[128:131], a[180:183], v[60:63]
    ds_read_b128 v[104:107], v14 offset:18432
    v_lshlrev_b32 v160, 16, v142
    v_mfma_f32_16x16x32_bf16 v[60:63], v[132:135], a[188:191], v[60:63]
    ds_read_b128 v[108:111], v14 offset:22528
    v_mfma_f32_16x16x32_bf16 v[56:59], v[132:135], a[184:187], v[56:59]
    ds_read_b128 v[112:115], v14 offset:26624
    v_and_b32 v163, 0xffff0000, v143
    v_mfma_f32_16x16x32_bf16 v[56:59], v[128:131], a[176:179], v[56:59]
    ds_read_b128 v[116:119], v14 offset:30720
    v_lshlrev_b32 v162, 16, v143
    v_mfma_f32_16x16x32_bf16 v[56:59], v[124:127], a[168:171], v[56:59]
    s_add_u32 m0, s73, 101376
    v_mfma_f32_16x16x32_bf16 v[56:59], v[120:123], a[160:163], v[56:59]
    buffer_load_dwordx4 v22, s[44:47], s21 offen offset:0 sc1 lds
    s_waitcnt lgkmcnt(2)
    v_mfma_f32_16x16x32_bf16 v[64:67], v[104:107], a[160:163], v[64:67]
    v_fma_f32 v164, v144, v97, -v96
    v_mfma_f32_16x16x32_bf16 v[64:67], v[108:111], a[168:171], v[64:67]
    v_fma_f32 v165, v145, v97, -v96
    s_waitcnt lgkmcnt(0)
    v_mfma_f32_16x16x32_bf16 v[64:67], v[112:115], a[176:179], v[64:67]
    ds_read_b128 v[120:123], v14 offset:19456
    v_fma_f32 v166, v146, v97, -v96
    v_mfma_f32_16x16x32_bf16 v[64:67], v[116:119], a[184:187], v[64:67]
    ds_read_b128 v[124:127], v14 offset:23552
    v_mfma_f32_16x16x32_bf16 v[68:71], v[116:119], a[188:191], v[68:71]
    ds_read_b128 v[128:131], v14 offset:27648
    v_fma_f32 v167, v147, v97, -v96
    v_mfma_f32_16x16x32_bf16 v[68:71], v[112:115], a[180:183], v[68:71]
    ds_read_b128 v[132:135], v14 offset:31744
    v_mfma_f32_16x16x32_bf16 v[68:71], v[108:111], a[172:175], v[68:71]
    v_fma_f32 v168, v148, v99, -v98
    v_mfma_f32_16x16x32_bf16 v[68:71], v[104:107], a[164:167], v[68:71]
    v_fma_f32 v169, v149, v99, -v98
    s_waitcnt lgkmcnt(2)
    v_mfma_f32_16x16x32_bf16 v[60:63], v[120:123], a[196:199], v[60:63]
    v_mfma_f32_16x16x32_bf16 v[60:63], v[124:127], a[204:207], v[60:63]
    v_fma_f32 v170, v150, v99, -v98
    s_waitcnt lgkmcnt(0)
    v_mfma_f32_16x16x32_bf16 v[60:63], v[128:131], a[212:215], v[60:63]
    s_waitcnt vmcnt(16)
    s_barrier
    v_mfma_f32_16x16x32_bf16 v[60:63], v[132:135], a[220:223], v[60:63]
    ds_read_b128 v[104:107], v14 offset:32768
    v_fma_f32 v171, v151, v99, -v98
    v_mfma_f32_16x16x32_bf16 v[56:59], v[132:135], a[216:219], v[56:59]
    ds_read_b128 v[108:111], v14 offset:36864
    v_fma_f32 v172, v152, v97, -v96
    v_mfma_f32_16x16x32_bf16 v[56:59], v[128:131], a[208:211], v[56:59]
    ds_read_b128 v[112:115], v14 offset:40960
    v_mfma_f32_16x16x32_bf16 v[56:59], v[124:127], a[200:203], v[56:59]
    ds_read_b128 v[116:119], v14 offset:45056
    v_fma_f32 v173, v153, v97, -v96
    v_mfma_f32_16x16x32_bf16 v[56:59], v[120:123], a[192:195], v[56:59]
    s_waitcnt lgkmcnt(2)
    v_mfma_f32_16x16x32_bf16 v[64:67], v[104:107], a[192:195], v[64:67]
    s_add_u32 m0, s73, 114176
    v_fma_f32 v174, v154, v97, -v96
    v_mfma_f32_16x16x32_bf16 v[64:67], v[108:111], a[200:203], v[64:67]
    buffer_load_dwordx4 v22, s[44:47], s21 offen offset:512 sc1 lds
    s_waitcnt lgkmcnt(0)
    v_mfma_f32_16x16x32_bf16 v[64:67], v[112:115], a[208:211], v[64:67]
    ds_read_b128 v[120:123], v14 offset:33792
    v_fma_f32 v175, v155, v97, -v96
    v_mfma_f32_16x16x32_bf16 v[64:67], v[116:119], a[216:219], v[64:67]
    ds_read_b128 v[124:127], v14 offset:37888
    v_fma_f32 v176, v156, v99, -v98
    v_mfma_f32_16x16x32_bf16 v[68:71], v[116:119], a[220:223], v[68:71]
    ds_read_b128 v[128:131], v14 offset:41984
    v_mfma_f32_16x16x32_bf16 v[68:71], v[112:115], a[212:215], v[68:71]
    ds_read_b128 v[132:135], v14 offset:46080
    v_fma_f32 v177, v157, v99, -v98
    v_mfma_f32_16x16x32_bf16 v[68:71], v[108:111], a[204:207], v[68:71]
    s_add_u32 m0, s73, 115712
    v_fma_f32 v178, v158, v99, -v98
    v_mfma_f32_16x16x32_bf16 v[68:71], v[104:107], a[196:199], v[68:71]
    buffer_load_dwordx4 v22, s[44:47], s22 offen offset:0 sc1 lds
    s_waitcnt lgkmcnt(2)
    v_mfma_f32_16x16x32_bf16 v[60:63], v[120:123], a[228:231], v[60:63]
    s_add_u32 m0, s73, 116224
    v_fma_f32 v179, v159, v99, -v98
    v_mfma_f32_16x16x32_bf16 v[60:63], v[124:127], a[236:239], v[60:63]
    buffer_load_dwordx4 v22, s[44:47], s22 offen offset:512 sc1 lds
    s_waitcnt lgkmcnt(0)
    v_mfma_f32_16x16x32_bf16 v[60:63], v[128:131], a[244:247], v[60:63]
    ds_read_b128 v[104:107], v14 offset:34816
    v_fma_f32 v180, v160, v101, -v100
    v_mfma_f32_16x16x32_bf16 v[60:63], v[132:135], a[252:255], v[60:63]
    ds_read_b128 v[108:111], v14 offset:38912
    v_fma_f32 v181, v161, v101, -v100
    v_mfma_f32_16x16x32_bf16 v[56:59], v[132:135], a[248:251], v[56:59]
    ds_read_b128 v[112:115], v14 offset:43008
    v_mfma_f32_16x16x32_bf16 v[56:59], v[128:131], a[240:243], v[56:59]
    ds_read_b128 v[116:119], v14 offset:47104
    v_fma_f32 v182, v162, v101, -v100
    v_mfma_f32_16x16x32_bf16 v[56:59], v[124:127], a[232:235], v[56:59]
    s_add_u32 m0, s73, 117760
    v_fma_f32 v183, v163, v101, -v100
    v_mfma_f32_16x16x32_bf16 v[56:59], v[120:123], a[224:227], v[56:59]
    buffer_load_dwordx4 v22, s[44:47], s23 offen offset:0 sc1 lds
    s_waitcnt lgkmcnt(2)
    v_mfma_f32_16x16x32_bf16 v[64:67], v[104:107], a[224:227], v[64:67]
    v_mfma_f32_16x16x32_bf16 v[64:67], v[108:111], a[232:235], v[64:67]
    s_waitcnt lgkmcnt(0)
    v_mfma_f32_16x16x32_bf16 v[64:67], v[112:115], a[240:243], v[64:67]
    ds_read_b128 v[120:123], v14 offset:35840
    v_mfma_f32_16x16x32_bf16 v[64:67], v[116:119], a[248:251], v[64:67]
    ds_read_b128 v[124:127], v14 offset:39936
    v_mfma_f32_16x16x32_bf16 v[68:71], v[116:119], a[252:255], v[68:71]
    ds_read_b128 v[128:131], v14 offset:44032
    v_mfma_f32_16x16x32_bf16 v[68:71], v[112:115], a[244:247], v[68:71]
    ds_read_b128 v[132:135], v14 offset:48128
    v_mfma_f32_16x16x32_bf16 v[68:71], v[108:111], a[236:239], v[68:71]
    v_mfma_f32_16x16x32_bf16 v[68:71], v[104:107], a[228:231], v[68:71]
    s_waitcnt lgkmcnt(2)
    v_mfma_f32_16x16x32_bf16 v[60:63], v[120:123], v[224:227], v[60:63]
    v_mfma_f32_16x16x32_bf16 v[60:63], v[124:127], v[232:235], v[60:63]
    s_waitcnt lgkmcnt(0)
    v_mfma_f32_16x16x32_bf16 v[60:63], v[128:131], v[240:243], v[60:63]
    s_waitcnt vmcnt(10)
    s_barrier
    v_mfma_f32_16x16x32_bf16 v[60:63], v[132:135], v[248:251], v[60:63]
    ds_read_b128 v[104:107], v14 offset:49152
    v_mfma_f32_16x16x32_bf16 v[56:59], v[132:135], v[244:247], v[56:59]
    ds_read_b128 v[108:111], v14 offset:53248
    v_mfma_f32_16x16x32_bf16 v[56:59], v[128:131], v[236:239], v[56:59]
    ds_read_b128 v[112:115], v14 offset:57344
    v_mfma_f32_16x16x32_bf16 v[56:59], v[124:127], v[228:231], v[56:59]
    ds_read_b128 v[116:119], v14 offset:61440
    v_mfma_f32_16x16x32_bf16 v[56:59], v[120:123], v[220:223], v[56:59]
    s_waitcnt lgkmcnt(2)
    v_mfma_f32_16x16x32_bf16 v[64:67], v[104:107], v[220:223], v[64:67]
    s_add_u32 m0, s73, 130560
    v_xor_b32 v186, s41, v10
    v_add_u32 v186, s43, v186
    v_mfma_f32_16x16x32_bf16 v[64:67], v[108:111], v[228:231], v[64:67]
    buffer_load_dwordx4 v22, s[44:47], s23 offen offset:512 sc1 lds
    ds_read_b64_tr_b16 v[12:13], v10 offset:16384
    s_waitcnt lgkmcnt(1)
    v_mfma_f32_16x16x32_bf16 v[64:67], v[112:115], v[236:239], v[64:67]
    ds_read_b128 v[120:123], v14 offset:50176
    v_mfma_f32_16x16x32_bf16 v[64:67], v[116:119], v[244:247], v[64:67]
    ds_read_b128 v[124:127], v14 offset:54272
    v_mfma_f32_16x16x32_bf16 v[68:71], v[116:119], v[248:251], v[68:71]
    ds_read_b128 v[128:131], v14 offset:58368
    ds_read_b64_tr_b16 v[24:25], v11 offset:16384
    v_mfma_f32_16x16x32_bf16 v[68:71], v[112:115], v[240:243], v[68:71]
    ds_read_b128 v[132:135], v14 offset:62464
    ds_read_b64_tr_b16 v[28:29], v10 offset:20480
    v_mfma_f32_16x16x32_bf16 v[68:71], v[108:111], v[232:235], v[68:71]
    s_add_u32 m0, s73, 132096
    ds_read_b64_tr_b16 v[190:191], v11 offset:20480
    v_mfma_f32_16x16x32_bf16 v[68:71], v[104:107], v[224:227], v[68:71]
    buffer_load_dwordx4 v22, s[44:47], s24 offen offset:0 sc1 lds
    ds_read_b64_tr_b16 v[142:143], v186 offset:18432
    s_waitcnt lgkmcnt(6)
    v_mfma_f32_16x16x32_bf16 v[76:79], v[120:123], a[4:7], v[76:79]
    s_add_u32 m0, s73, 132608
    s_waitcnt lgkmcnt(0)
    v_mfma_f32_16x16x32_bf16 v[76:79], v[124:127], a[12:15], v[76:79]
    buffer_load_dwordx4 v22, s[44:47], s24 offen offset:512 sc1 lds
    v_mfma_f32_16x16x32_bf16 v[76:79], v[128:131], a[20:23], v[76:79]
    ds_read_b128 v[104:107], v14 offset:51200
    v_and_b32 v9, 0xffff0000, v12
    v_mfma_f32_16x16x32_bf16 v[76:79], v[132:135], a[28:31], v[76:79]
    ds_read_b128 v[108:111], v14 offset:55296
    v_mfma_f32_16x16x32_bf16 v[72:75], v[132:135], a[24:27], v[72:75]
    ds_read_b128 v[112:115], v14 offset:59392
    v_lshlrev_b32 v8, 16, v12
    v_mfma_f32_16x16x32_bf16 v[72:75], v[128:131], a[16:19], v[72:75]
    ds_read_b128 v[116:119], v14 offset:63488
    v_cvt_pk_bf16_f32 v192, v56, v57
    v_mfma_f32_16x16x32_bf16 v[72:75], v[124:127], a[8:11], v[72:75]
    s_add_u32 m0, s73, 134144
    v_mul_f32 v165, v165, v9
    v_mfma_f32_16x16x32_bf16 v[72:75], v[120:123], a[0:3], v[72:75]
    buffer_load_dwordx4 v22, s[44:47], s25 offen offset:0 sc1 lds
    s_waitcnt lgkmcnt(2)
    v_mfma_f32_16x16x32_bf16 v[80:83], v[104:107], a[0:3], v[80:83]
    v_cvt_pk_bf16_f32 v193, v58, v59
    v_mul_f32 v164, v164, v8
    v_mfma_f32_16x16x32_bf16 v[80:83], v[108:111], a[8:11], v[80:83]
    v_and_b32 v31, 0xffff0000, v13
    s_waitcnt lgkmcnt(0)
    v_mfma_f32_16x16x32_bf16 v[80:83], v[112:115], a[16:19], v[80:83]
    ds_read_b128 v[120:123], v14 offset:52224
    v_lshlrev_b32 v30, 16, v13
    v_mfma_f32_16x16x32_bf16 v[80:83], v[116:119], a[24:27], v[80:83]
    ds_read_b128 v[124:127], v14 offset:56320
    v_cvt_pk_bf16_f32 v194, v60, v61
    v_mfma_f32_16x16x32_bf16 v[84:87], v[116:119], a[28:31], v[84:87]
    ds_read_b128 v[128:131], v14 offset:60416
    v_mfma_f32_16x16x32_bf16 v[84:87], v[112:115], a[20:23], v[84:87]
    ds_read_b128 v[132:135], v14 offset:64512
    v_mul_f32 v167, v167, v31
    v_mfma_f32_16x16x32_bf16 v[84:87], v[108:111], a[12:15], v[84:87]
    buffer_store_dwordx4 v[192:195], v136, s[44:47], s15 offen offset:0 sc1
    v_mul_f32 v166, v166, v30
    v_mfma_f32_16x16x32_bf16 v[84:87], v[104:107], a[4:7], v[84:87]
    s_waitcnt lgkmcnt(2)
    v_mfma_f32_16x16x32_bf16 v[76:79], v[120:123], a[36:39], v[76:79]
    v_and_b32 v9, 0xffff0000, v24
    v_mfma_f32_16x16x32_bf16 v[76:79], v[124:127], a[44:47], v[76:79]
    v_cvt_pk_bf16_f32 v196, v62, v63
    s_waitcnt lgkmcnt(0)
    v_mfma_f32_16x16x32_bf16 v[76:79], v[128:131], a[52:55], v[76:79]
    s_waitcnt vmcnt(9)
    s_barrier
    v_lshlrev_b32 v8, 16, v24
    v_mfma_f32_16x16x32_bf16 v[76:79], v[132:135], a[60:63], v[76:79]
    ds_read_b128 v[104:107], v14 offset:0
    v_mul_f32 v169, v169, v9
    v_mfma_f32_16x16x32_bf16 v[72:75], v[132:135], a[56:59], v[72:75]
    ds_read_b128 v[108:111], v14 offset:4096
    v_cvt_pk_bf16_f32 v197, v64, v65
    v_mfma_f32_16x16x32_bf16 v[72:75], v[128:131], a[48:51], v[72:75]
    ds_read_b128 v[112:115], v14 offset:8192
    v_mul_f32 v168, v168, v8
    v_mfma_f32_16x16x32_bf16 v[72:75], v[124:127], a[40:43], v[72:75]
    ds_read_b128 v[116:119], v14 offset:12288
    v_mfma_f32_16x16x32_bf16 v[72:75], v[120:123], a[32:35], v[72:75]
    v_cvt_pk_bf16_f32 v198, v66, v67
    s_waitcnt lgkmcnt(2)
    v_mfma_f32_16x16x32_bf16 v[80:83], v[104:107], a[32:35], v[80:83]
    s_add_u32 m0, s73, 146944
    v_and_b32 v31, 0xffff0000, v25
    v_lshlrev_b32 v30, 16, v25
    v_mfma_f32_16x16x32_bf16 v[80:83], v[108:111], a[40:43], v[80:83]
    buffer_load_dwordx4 v22, s[44:47], s25 offen offset:512 sc1 lds
    s_waitcnt lgkmcnt(0)
    v_mfma_f32_16x16x32_bf16 v[80:83], v[112:115], a[48:51], v[80:83]
    buffer_store_dwordx4 v[196:199], v136, s[44:47], s15 offen offset:1024 sc1
    ds_read_b128 v[120:123], v14 offset:1024
    v_mfma_f32_16x16x32_bf16 v[80:83], v[116:119], a[56:59], v[80:83]
    ds_read_b128 v[124:127], v14 offset:5120
    v_mul_f32 v171, v171, v31
    v_mfma_f32_16x16x32_bf16 v[84:87], v[116:119], a[60:63], v[84:87]
    ds_read_b128 v[128:131], v14 offset:9216
    v_mul_f32 v170, v170, v30
    v_mfma_f32_16x16x32_bf16 v[84:87], v[112:115], a[52:55], v[84:87]
    ds_read_b128 v[132:135], v14 offset:13312
    v_mfma_f32_16x16x32_bf16 v[84:87], v[108:111], a[44:47], v[84:87]
    s_add_u32 m0, s73, 148480
    v_cvt_pk_bf16_f32 v200, v68, v69
    v_and_b32 v9, 0xffff0000, v28
    v_mfma_f32_16x16x32_bf16 v[84:87], v[104:107], a[36:39], v[84:87]
    buffer_load_dwordx4 v22, s[44:47], s26 offen offset:0 sc1 lds
    s_waitcnt lgkmcnt(2)
    v_mfma_f32_16x16x32_bf16 v[76:79], v[120:123], a[68:71], v[76:79]
    s_add_u32 m0, s73, 148992
    v_lshlrev_b32 v8, 16, v28
    v_mfma_f32_16x16x32_bf16 v[76:79], v[124:127], a[76:79], v[76:79]
    buffer_load_dwordx4 v22, s[44:47], s26 offen offset:512 sc1 lds
    s_waitcnt lgkmcnt(0)
    v_mfma_f32_16x16x32_bf16 v[76:79], v[128:131], a[84:87], v[76:79]
    ds_read_b128 v[104:107], v14 offset:2048
    v_cvt_pk_bf16_f32 v201, v70, v71
    v_mfma_f32_16x16x32_bf16 v[76:79], v[132:135], a[92:95], v[76:79]
    ds_read_b128 v[108:111], v14 offset:6144
    v_mul_f32 v173, v173, v9
    v_mfma_f32_16x16x32_bf16 v[72:75], v[132:135], a[88:91], v[72:75]
    ds_read_b128 v[112:115], v14 offset:10240
    v_mul_f32 v172, v172, v8
    v_mfma_f32_16x16x32_bf16 v[72:75], v[128:131], a[80:83], v[72:75]
    ds_read_b128 v[116:119], v14 offset:14336
    v_and_b32 v31, 0xffff0000, v29
    v_mfma_f32_16x16x32_bf16 v[72:75], v[124:127], a[72:75], v[72:75]
    buffer_store_dwordx4 v[200:203], v136, s[44:47], s15 offen offset:2048 sc1
    s_add_u32 m0, s73, 150528
    v_mfma_f32_16x16x32_bf16 v[72:75], v[120:123], a[64:67], v[72:75]
    buffer_load_dwordx4 v19, s[44:47], s18 offen offset:0 sc1 lds
    s_waitcnt lgkmcnt(2)
    v_mfma_f32_16x16x32_bf16 v[80:83], v[104:107], a[64:67], v[80:83]
    v_lshlrev_b32 v30, 16, v29
    v_mul_f32 v175, v175, v31
    v_mfma_f32_16x16x32_bf16 v[80:83], v[108:111], a[72:75], v[80:83]
    buffer_load_dwordx4 v[40:43], v136, s[44:47], s34 offen offset:0 sc1
    s_waitcnt lgkmcnt(0)
    v_mfma_f32_16x16x32_bf16 v[80:83], v[112:115], a[80:83], v[80:83]
    ds_read_b128 v[120:123], v14 offset:3072
    v_mfma_f32_16x16x32_bf16 v[80:83], v[116:119], a[88:91], v[80:83]
    ds_read_b128 v[124:127], v14 offset:7168
    v_mul_f32 v174, v174, v30
    v_mfma_f32_16x16x32_bf16 v[84:87], v[116:119], a[92:95], v[84:87]
    ds_read_b128 v[128:131], v14 offset:11264
    v_and_b32 v9, 0xffff0000, v190
    v_mfma_f32_16x16x32_bf16 v[84:87], v[112:115], a[84:87], v[84:87]
    ds_read_b128 v[132:135], v14 offset:15360
    buffer_load_dwordx4 v[44:47], v136, s[44:47], s34 offen offset:1024 sc1
    v_mfma_f32_16x16x32_bf16 v[84:87], v[108:111], a[76:79], v[84:87]
    v_lshlrev_b32 v8, 16, v190
    v_mfma_f32_16x16x32_bf16 v[84:87], v[104:107], a[68:71], v[84:87]
    s_waitcnt lgkmcnt(2)
    v_mfma_f32_16x16x32_bf16 v[76:79], v[120:123], a[100:103], v[76:79]
    buffer_load_dwordx4 v[48:51], v136, s[44:47], s34 offen offset:2048 sc1
    v_mul_f32 v177, v177, v9
    v_mfma_f32_16x16x32_bf16 v[76:79], v[124:127], a[108:111], v[76:79]
    s_waitcnt lgkmcnt(0)
    v_mfma_f32_16x16x32_bf16 v[76:79], v[128:131], a[116:119], v[76:79]
    s_waitcnt vmcnt(14)
    s_barrier
    v_mul_f32 v176, v176, v8
    v_mfma_f32_16x16x32_bf16 v[76:79], v[132:135], a[124:127], v[76:79]
    ds_read_b128 v[104:107], v14 offset:16384
    v_and_b32 v31, 0xffff0000, v191
    v_mfma_f32_16x16x32_bf16 v[72:75], v[132:135], a[120:123], v[72:75]
    ds_read_b128 v[108:111], v14 offset:20480
    buffer_load_dwordx4 v[204:207], v136, s[44:47], s35 offen offset:0 sc1
    v_mfma_f32_16x16x32_bf16 v[72:75], v[128:131], a[112:115], v[72:75]
    ds_read_b128 v[112:115], v14 offset:24576
    v_lshlrev_b32 v30, 16, v191
    v_mfma_f32_16x16x32_bf16 v[72:75], v[124:127], a[104:107], v[72:75]
    ds_read_b128 v[116:119], v14 offset:28672
    v_mul_f32 v179, v179, v31
    v_mfma_f32_16x16x32_bf16 v[72:75], v[120:123], a[96:99], v[72:75]
    buffer_load_dwordx4 v[208:211], v136, s[44:47], s35 offen offset:1024 sc1
    s_waitcnt lgkmcnt(2)
    v_mfma_f32_16x16x32_bf16 v[80:83], v[104:107], a[96:99], v[80:83]
    v_mfma_f32_16x16x32_bf16 v[80:83], v[108:111], a[104:107], v[80:83]
    v_mul_f32 v178, v178, v30
    s_waitcnt lgkmcnt(0)
    v_mfma_f32_16x16x32_bf16 v[80:83], v[112:115], a[112:115], v[80:83]
    ds_read_b128 v[120:123], v14 offset:17408
    buffer_load_dwordx4 v[212:215], v136, s[44:47], s35 offen offset:2048 sc1
    v_mfma_f32_16x16x32_bf16 v[80:83], v[116:119], a[120:123], v[80:83]
    ds_read_b128 v[124:127], v14 offset:21504
    v_and_b32 v9, 0xffff0000, v142
    v_mfma_f32_16x16x32_bf16 v[84:87], v[116:119], a[124:127], v[84:87]
    ds_read_b128 v[128:131], v14 offset:25600
    v_lshlrev_b32 v8, 16, v142
    v_mfma_f32_16x16x32_bf16 v[84:87], v[112:115], a[116:119], v[84:87]
    ds_read_b128 v[132:135], v14 offset:29696
    v_mfma_f32_16x16x32_bf16 v[84:87], v[108:111], a[108:111], v[84:87]
    buffer_load_dwordx4 v[216:219], v136, s[44:47], s35 offen offset:3072 sc1
    v_mul_f32 v181, v181, v9
    v_mfma_f32_16x16x32_bf16 v[84:87], v[104:107], a[100:103], v[84:87]
    s_waitcnt lgkmcnt(2)
    v_mfma_f32_16x16x32_bf16 v[76:79], v[120:123], a[132:135], v[76:79]
    v_mul_f32 v180, v180, v8
    v_mfma_f32_16x16x32_bf16 v[76:79], v[124:127], a[140:143], v[76:79]
    v_and_b32 v31, 0xffff0000, v143
    s_waitcnt lgkmcnt(0)
    v_mfma_f32_16x16x32_bf16 v[76:79], v[128:131], a[148:151], v[76:79]
    ds_read_b128 v[104:107], v14 offset:18432
    v_mfma_f32_16x16x32_bf16 v[76:79], v[132:135], a[156:159], v[76:79]
    ds_read_b128 v[108:111], v14 offset:22528
    v_lshlrev_b32 v30, 16, v143
    v_mfma_f32_16x16x32_bf16 v[72:75], v[132:135], a[152:155], v[72:75]
    ds_read_b128 v[112:115], v14 offset:26624
    v_mfma_f32_16x16x32_bf16 v[72:75], v[128:131], a[144:147], v[72:75]
    ds_read_b128 v[116:119], v14 offset:30720
    v_mul_f32 v183, v183, v31
    v_mfma_f32_16x16x32_bf16 v[72:75], v[124:127], a[136:139], v[72:75]
    v_mfma_f32_16x16x32_bf16 v[72:75], v[120:123], a[128:131], v[72:75]
    v_mul_f32 v182, v182, v30
    s_waitcnt lgkmcnt(2)
    v_mfma_f32_16x16x32_bf16 v[80:83], v[104:107], a[128:131], v[80:83]
    v_mfma_f32_16x16x32_bf16 v[80:83], v[108:111], a[136:139], v[80:83]
    s_waitcnt lgkmcnt(0)
    v_mfma_f32_16x16x32_bf16 v[80:83], v[112:115], a[144:147], v[80:83]
    ds_read_b128 v[120:123], v14 offset:19456
    v_mfma_f32_16x16x32_bf16 v[80:83], v[116:119], a[152:155], v[80:83]
    ds_read_b128 v[124:127], v14 offset:23552
    v_mfma_f32_16x16x32_bf16 v[84:87], v[116:119], a[156:159], v[84:87]
    ds_read_b128 v[128:131], v14 offset:27648
    v_mfma_f32_16x16x32_bf16 v[84:87], v[112:115], a[148:151], v[84:87]
    ds_read_b128 v[132:135], v14 offset:31744
    v_mfma_f32_16x16x32_bf16 v[84:87], v[108:111], a[140:143], v[84:87]
    v_mfma_f32_16x16x32_bf16 v[84:87], v[104:107], a[132:135], v[84:87]
    s_waitcnt lgkmcnt(2)
    v_mfma_f32_16x16x32_bf16 v[76:79], v[120:123], a[164:167], v[76:79]
    s_add_u32 m0, s73, 97792
    v_mfma_f32_16x16x32_bf16 v[76:79], v[124:127], a[172:175], v[76:79]
    buffer_load_dwordx4 v19, s[44:47], s18 offen offset:512 sc1 lds
    s_waitcnt lgkmcnt(0)
    v_mfma_f32_16x16x32_bf16 v[76:79], v[128:131], a[180:183], v[76:79]
    s_waitcnt vmcnt(15)
    s_barrier
    v_mfma_f32_16x16x32_bf16 v[76:79], v[132:135], a[188:191], v[76:79]
    ds_read_b128 v[104:107], v14 offset:32768
    v_mfma_f32_16x16x32_bf16 v[72:75], v[132:135], a[184:187], v[72:75]
    ds_read_b128 v[108:111], v14 offset:36864
    v_mfma_f32_16x16x32_bf16 v[72:75], v[128:131], a[176:179], v[72:75]
    ds_read_b128 v[112:115], v14 offset:40960
    v_mfma_f32_16x16x32_bf16 v[72:75], v[124:127], a[168:171], v[72:75]
    ds_read_b128 v[116:119], v14 offset:45056
    s_add_u32 m0, s73, 99328
    v_mfma_f32_16x16x32_bf16 v[72:75], v[120:123], a[160:163], v[72:75]
    buffer_load_dwordx4 v19, s[44:47], s19 offen offset:0 sc1 lds
    s_waitcnt lgkmcnt(2)
    v_mfma_f32_16x16x32_bf16 v[80:83], v[104:107], a[160:163], v[80:83]
    s_add_u32 m0, s73, 99840
    v_mfma_f32_16x16x32_bf16 v[80:83], v[108:111], a[168:171], v[80:83]
    buffer_load_dwordx4 v19, s[44:47], s19 offen offset:512 sc1 lds
    s_waitcnt lgkmcnt(0)
    v_mfma_f32_16x16x32_bf16 v[80:83], v[112:115], a[176:179], v[80:83]
    ds_read_b128 v[120:123], v14 offset:33792
    v_mfma_f32_16x16x32_bf16 v[80:83], v[116:119], a[184:187], v[80:83]
    ds_read_b128 v[124:127], v14 offset:37888
    v_mfma_f32_16x16x32_bf16 v[84:87], v[116:119], a[188:191], v[84:87]
    ds_read_b128 v[128:131], v14 offset:41984
    v_mfma_f32_16x16x32_bf16 v[84:87], v[112:115], a[180:183], v[84:87]
    ds_read_b128 v[132:135], v14 offset:46080
    v_mfma_f32_16x16x32_bf16 v[84:87], v[108:111], a[172:175], v[84:87]
    s_add_u32 m0, s73, 101376
    v_mfma_f32_16x16x32_bf16 v[84:87], v[104:107], a[164:167], v[84:87]
    buffer_load_dwordx4 v19, s[44:47], s20 offen offset:0 sc1 lds
    s_waitcnt lgkmcnt(2)
    v_mfma_f32_16x16x32_bf16 v[76:79], v[120:123], a[196:199], v[76:79]
    s_add_u32 m0, s73, 114176
    v_mov_b32 v141, 0
    v_mfma_f32_16x16x32_bf16 v[76:79], v[124:127], a[204:207], v[76:79]
    buffer_load_dwordx4 v19, s[44:47], s20 offen offset:512 sc1 lds
    s_waitcnt lgkmcnt(0)
    v_mfma_f32_16x16x32_bf16 v[76:79], v[128:131], a[212:215], v[76:79]
    ds_read_b128 v[104:107], v14 offset:34816
    v_mfma_f32_16x16x32_bf16 v[76:79], v[132:135], a[220:223], v[76:79]
    ds_read_b128 v[108:111], v14 offset:38912
    buffer_atomic_add v141, v139, s[44:47], s11 offen offset:2060 sc0 sc1
    v_mfma_f32_16x16x32_bf16 v[72:75], v[132:135], a[216:219], v[72:75]
    ds_read_b128 v[112:115], v14 offset:43008
    v_mfma_f32_16x16x32_bf16 v[72:75], v[128:131], a[208:211], v[72:75]
    ds_read_b128 v[116:119], v14 offset:47104
    v_mfma_f32_16x16x32_bf16 v[72:75], v[124:127], a[200:203], v[72:75]
    s_add_u32 m0, s73, 115712
    v_mfma_f32_16x16x32_bf16 v[72:75], v[120:123], a[192:195], v[72:75]
    buffer_load_dwordx4 v19, s[44:47], s21 offen offset:0 sc1 lds
    s_waitcnt lgkmcnt(2)
    v_mfma_f32_16x16x32_bf16 v[80:83], v[104:107], a[192:195], v[80:83]
    s_add_u32 m0, s73, 116224
    v_mfma_f32_16x16x32_bf16 v[80:83], v[108:111], a[200:203], v[80:83]
    buffer_load_dwordx4 v19, s[44:47], s21 offen offset:512 sc1 lds
    s_waitcnt lgkmcnt(0)
    v_mfma_f32_16x16x32_bf16 v[80:83], v[112:115], a[208:211], v[80:83]
    ds_read_b128 v[120:123], v14 offset:35840
    v_mfma_f32_16x16x32_bf16 v[80:83], v[116:119], a[216:219], v[80:83]
    ds_read_b128 v[124:127], v14 offset:39936
    v_mfma_f32_16x16x32_bf16 v[84:87], v[116:119], a[220:223], v[84:87]
    ds_read_b128 v[128:131], v14 offset:44032
    v_mfma_f32_16x16x32_bf16 v[84:87], v[112:115], a[212:215], v[84:87]
    ds_read_b128 v[132:135], v14 offset:48128
    v_mfma_f32_16x16x32_bf16 v[84:87], v[108:111], a[204:207], v[84:87]
    s_add_u32 m0, s73, 117760
    v_mfma_f32_16x16x32_bf16 v[84:87], v[104:107], a[196:199], v[84:87]
    buffer_load_dwordx4 v19, s[44:47], s22 offen offset:0 sc1 lds
    s_waitcnt lgkmcnt(2)
    v_mfma_f32_16x16x32_bf16 v[76:79], v[120:123], a[228:231], v[76:79]
    v_mfma_f32_16x16x32_bf16 v[76:79], v[124:127], a[236:239], v[76:79]
    s_waitcnt lgkmcnt(0)
    v_mfma_f32_16x16x32_bf16 v[76:79], v[128:131], a[244:247], v[76:79]
    s_waitcnt vmcnt(16)
    s_barrier
    v_mfma_f32_16x16x32_bf16 v[76:79], v[132:135], a[252:255], v[76:79]
    ds_read_b128 v[104:107], v14 offset:49152
    v_mfma_f32_16x16x32_bf16 v[72:75], v[132:135], a[248:251], v[72:75]
    ds_read_b128 v[108:111], v14 offset:53248
    v_mfma_f32_16x16x32_bf16 v[72:75], v[128:131], a[240:243], v[72:75]
    ds_read_b128 v[112:115], v14 offset:57344
    v_mfma_f32_16x16x32_bf16 v[72:75], v[124:127], a[232:235], v[72:75]
    ds_read_b128 v[116:119], v14 offset:61440
    v_mfma_f32_16x16x32_bf16 v[72:75], v[120:123], a[224:227], v[72:75]
    s_waitcnt lgkmcnt(2)
    v_mfma_f32_16x16x32_bf16 v[80:83], v[104:107], a[224:227], v[80:83]
    s_add_u32 m0, s73, 130560
    v_mfma_f32_16x16x32_bf16 v[80:83], v[108:111], a[232:235], v[80:83]
    buffer_load_dwordx4 v19, s[44:47], s22 offen offset:512 sc1 lds
    s_waitcnt lgkmcnt(0)
    v_mfma_f32_16x16x32_bf16 v[80:83], v[112:115], a[240:243], v[80:83]
    ds_read_b128 v[120:123], v14 offset:50176
    v_mfma_f32_16x16x32_bf16 v[80:83], v[116:119], a[248:251], v[80:83]
    ds_read_b128 v[124:127], v14 offset:54272
    v_mfma_f32_16x16x32_bf16 v[84:87], v[116:119], a[252:255], v[84:87]
    ds_read_b128 v[128:131], v14 offset:58368
    v_mfma_f32_16x16x32_bf16 v[84:87], v[112:115], a[244:247], v[84:87]
    ds_read_b128 v[132:135], v14 offset:62464
    v_mfma_f32_16x16x32_bf16 v[84:87], v[108:111], a[236:239], v[84:87]
    s_add_u32 m0, s73, 132096
    v_mfma_f32_16x16x32_bf16 v[84:87], v[104:107], a[228:231], v[84:87]
    buffer_load_dwordx4 v19, s[44:47], s23 offen offset:0 sc1 lds
    s_waitcnt lgkmcnt(2)
    v_mfma_f32_16x16x32_bf16 v[76:79], v[120:123], v[224:227], v[76:79]
    s_add_u32 m0, s73, 132608
    s_waitcnt vmcnt(15)
    v_bitop3_b32 v43, v43, v47, s68 bitop3:0x7e
    v_bitop3_b32 v43, v43, v51, s68 bitop3:0xf6
    v_cmp_ne_u32 vcc, 0, v43
    v_mfma_f32_16x16x32_bf16 v[76:79], v[124:127], v[232:235], v[76:79]
    buffer_load_dwordx4 v19, s[44:47], s23 offen offset:512 sc1 lds
    s_waitcnt lgkmcnt(0)
    v_mfma_f32_16x16x32_bf16 v[76:79], v[128:131], v[240:243], v[76:79]
    ds_read_b128 v[104:107], v14 offset:51200
    s_cbranch_vccnz L_xs_a
L_xo_a:
    v_and_b32 v89, 0xffff0000, v40
    v_mfma_f32_16x16x32_bf16 v[76:79], v[132:135], v[248:251], v[76:79]
    ds_read_b128 v[108:111], v14 offset:55296
    v_lshlrev_b32 v88, 16, v40
    v_mfma_f32_16x16x32_bf16 v[72:75], v[132:135], v[244:247], v[72:75]
    ds_read_b128 v[112:115], v14 offset:59392
    v_and_b32 v91, 0xffff0000, v41
    v_mfma_f32_16x16x32_bf16 v[72:75], v[128:131], v[236:239], v[72:75]
    ds_read_b128 v[116:119], v14 offset:63488
    v_lshlrev_b32 v90, 16, v41
    v_mfma_f32_16x16x32_bf16 v[72:75], v[124:127], v[228:231], v[72:75]
    s_add_u32 m0, s73, 134144
    v_and_b32 v93, 0xffff0000, v42
    v_lshlrev_b32 v92, 16, v42
    v_mfma_f32_16x16x32_bf16 v[72:75], v[120:123], v[220:223], v[72:75]
    buffer_load_dwordx4 v19, s[44:47], s24 offen offset:0 sc1 lds
    s_waitcnt lgkmcnt(2)
    v_mfma_f32_16x16x32_bf16 v[80:83], v[104:107], v[220:223], v[80:83]
    v_and_b32 v95, 0xffff0000, v44
    v_lshlrev_b32 v94, 16, v44
    v_mfma_f32_16x16x32_bf16 v[80:83], v[108:111], v[228:231], v[80:83]
    v_and_b32 v97, 0xffff0000, v45
    s_waitcnt lgkmcnt(0)
    v_mfma_f32_16x16x32_bf16 v[80:83], v[112:115], v[236:239], v[80:83]
    ds_read_b128 v[120:123], v14 offset:52224
    v_lshlrev_b32 v96, 16, v45
    v_mfma_f32_16x16x32_bf16 v[80:83], v[116:119], v[244:247], v[80:83]
    ds_read_b128 v[124:127], v14 offset:56320
    v_and_b32 v99, 0xffff0000, v46
    v_lshlrev_b32 v98, 16, v46
    v_mfma_f32_16x16x32_bf16 v[84:87], v[116:119], v[248:251], v[84:87]
    ds_read_b128 v[128:131], v14 offset:60416
    s_waitcnt vmcnt(7)
    v_and_b32 v101, 0xffff0000, v48
    v_mfma_f32_16x16x32_bf16 v[84:87], v[112:115], v[240:243], v[84:87]
    ds_read_b128 v[132:135], v14 offset:64512
    v_lshlrev_b32 v100, 16, v48
    v_cmp_ne_u32 vcc, v140, v141
    v_mfma_f32_16x16x32_bf16 v[84:87], v[108:111], v[232:235], v[84:87]
    v_and_b32 v103, 0xffff0000, v49
L_pl_D_2:
    s_cbranch_execz L_wret
    v_lshlrev_b32 v102, 16, v49
    v_mfma_f32_16x16x32_bf16 v[84:87], v[104:107], v[224:227], v[84:87]
    s_cbranch_vccnz L_as_b
L_ao_b:
    s_waitcnt lgkmcnt(2)
    v_mfma_f32_16x16x32_bf16 v[92:95], v[120:123], a[4:7], v[92:95]
    buffer_load_dwordx4 v[56:59], v136, s[44:47], s11 offen offset:0 sc1
    v_mfma_f32_16x16x32_bf16 v[92:95], v[124:127], a[12:15], v[92:95]
    s_waitcnt lgkmcnt(0)
    v_mfma_f32_16x16x32_bf16 v[92:95], v[128:131], a[20:23], v[92:95]
    buffer_load_dwordx4 v[60:63], v136, s[44:47], s11 offen offset:1024 sc1
    s_barrier
    v_mfma_f32_16x16x32_bf16 v[92:95], v[132:135], a[28:31], v[92:95]
    ds_read_b128 v[104:107], v14 offset:0
    buffer_load_dwordx4 v[64:67], v136, s[44:47], s11 offen offset:2048 sc1
    v_mfma_f32_16x16x32_bf16 v[88:91], v[132:135], a[24:27], v[88:91]
    ds_read_b128 v[108:111], v14 offset:4096
    v_cvt_pk_bf16_f32 v192, v72, v73
    v_mfma_f32_16x16x32_bf16 v[88:91], v[128:131], a[16:19], v[88:91]
    ds_read_b128 v[112:115], v14 offset:8192
    v_cvt_pk_bf16_f32 v193, v74, v75
    v_mfma_f32_16x16x32_bf16 v[88:91], v[124:127], a[8:11], v[88:91]
    ds_read_b128 v[116:119], v14 offset:12288
    v_cvt_pk_bf16_f32 v194, v76, v77
    v_mfma_f32_16x16x32_bf16 v[88:91], v[120:123], a[0:3], v[88:91]
    buffer_store_dwordx4 v[192:195], v136, s[44:47], s31 offen offset:0 sc1
    s_waitcnt lgkmcnt(2)
    v_mfma_f32_16x16x32_bf16 v[96:99], v[104:107], a[0:3], v[96:99]
    s_add_u32 m0, s73, 146944
    v_cvt_pk_bf16_f32 v196, v78, v79
    v_cvt_pk_bf16_f32 v197, v80, v81
    v_mfma_f32_16x16x32_bf16 v[96:99], v[108:111], a[8:11], v[96:99]
    buffer_load_dwordx4 v19, s[44:47], s24 offen offset:512 sc1 lds
    s_waitcnt lgkmcnt(0)
    v_mfma_f32_16x16x32_bf16 v[96:99], v[112:115], a[16:19], v[96:99]
    ds_read_b128 v[120:123], v14 offset:1024
    v_cvt_pk_bf16_f32 v198, v82, v83
    v_mfma_f32_16x16x32_bf16 v[96:99], v[116:119], a[24:27], v[96:99]
    buffer_store_dwordx4 v[196:199], v136, s[44:47], s31 offen offset:1024 sc1
    ds_read_b128 v[124:127], v14 offset:5120
    v_bitop3_b32 v207, v207, v211, s36 bitop3:0x7e
    v_bitop3_b32 v207, v207, v215, s36 bitop3:0xf6
    v_mfma_f32_16x16x32_bf16 v[100:103], v[116:119], a[28:31], v[100:103]
    ds_read_b128 v[128:131], v14 offset:9216
    v_cvt_pk_bf16_f32 v200, v84, v85
    v_mfma_f32_16x16x32_bf16 v[100:103], v[112:115], a[20:23], v[100:103]
    ds_read_b128 v[132:135], v14 offset:13312
    v_cvt_pk_bf16_f32 v201, v86, v87
    v_mfma_f32_16x16x32_bf16 v[100:103], v[108:111], a[12:15], v[100:103]
    buffer_store_dwordx4 v[200:203], v136, s[44:47], s31 offen offset:2048 sc1
    s_add_u32 m0, s73, 148480
    v_bitop3_b32 v207, v207, v219, s36 bitop3:0xf6
    v_cmp_ne_u32 vcc, 0, v207
    v_mfma_f32_16x16x32_bf16 v[100:103], v[104:107], a[4:7], v[100:103]
    buffer_load_dwordx4 v19, s[44:47], s25 offen offset:0 sc1 lds
    s_waitcnt lgkmcnt(2)
    v_mfma_f32_16x16x32_bf16 v[92:95], v[120:123], a[36:39], v[92:95]
    s_add_u32 m0, s73, 148992
    s_cbranch_vccnz L_xs_8
L_xo_8:
    v_mfma_f32_16x16x32_bf16 v[92:95], v[124:127], a[44:47], v[92:95]
    buffer_load_dwordx4 v19, s[44:47], s25 offen offset:512 sc1 lds
    s_waitcnt lgkmcnt(0)
    v_mfma_f32_16x16x32_bf16 v[92:95], v[128:131], a[52:55], v[92:95]
    ds_read_b128 v[104:107], v14 offset:2048
    v_and_b32 v33, 0xffff0000, v204
    v_mfma_f32_16x16x32_bf16 v[92:95], v[132:135], a[60:63], v[92:95]
    ds_read_b128 v[108:111], v14 offset:6144
    v_lshlrev_b32 v32, 16, v204
    v_mfma_f32_16x16x32_bf16 v[88:91], v[132:135], a[56:59], v[88:91]
    ds_read_b128 v[112:115], v14 offset:10240
    v_and_b32 v35, 0xffff0000, v205
    v_mfma_f32_16x16x32_bf16 v[88:91], v[128:131], a[48:51], v[88:91]
    ds_read_b128 v[116:119], v14 offset:14336
    v_mfma_f32_16x16x32_bf16 v[88:91], v[124:127], a[40:43], v[88:91]
    s_add_u32 m0, s73, 150528
    v_lshlrev_b32 v34, 16, v205
    v_mfma_f32_16x16x32_bf16 v[88:91], v[120:123], a[32:35], v[88:91]
    buffer_load_dwordx4 v19, s[44:47], s26 offen offset:0 sc1 lds
    s_waitcnt lgkmcnt(2)
    v_mfma_f32_16x16x32_bf16 v[96:99], v[104:107], a[32:35], v[96:99]
    v_add_f32 v32, v32, v27
    v_mfma_f32_16x16x32_bf16 v[96:99], v[108:111], a[40:43], v[96:99]
    v_add_f32 v33, v33, v27
    s_waitcnt lgkmcnt(0)
    v_mfma_f32_16x16x32_bf16 v[96:99], v[112:115], a[48:51], v[96:99]
    ds_read_b128 v[120:123], v14 offset:3072
    v_add_f32 v34, v34, v27
    v_mfma_f32_16x16x32_bf16 v[96:99], v[116:119], a[56:59], v[96:99]
    ds_read_b128 v[124:127], v14 offset:7168
    v_mfma_f32_16x16x32_bf16 v[100:103], v[116:119], a[60:63], v[100:103]
    ds_read_b128 v[128:131], v14 offset:11264
    v_add_f32 v35, v35, v27
    v_mfma_f32_16x16x32_bf16 v[100:103], v[112:115], a[52:55], v[100:103]
    ds_read_b128 v[132:135], v14 offset:15360
    v_and_b32 v37, 0xffff0000, v208
    v_mfma_f32_16x16x32_bf16 v[100:103], v[108:111], a[44:47], v[100:103]
    v_mfma_f32_16x16x32_bf16 v[100:103], v[104:107], a[36:39], v[100:103]
    v_lshlrev_b32 v36, 16, v208
    s_waitcnt lgkmcnt(2)
    v_mfma_f32_16x16x32_bf16 v[92:95], v[120:123], a[68:71], v[92:95]
    v_and_b32 v39, 0xffff0000, v209
    v_mfma_f32_16x16x32_bf16 v[92:95], v[124:127], a[76:79], v[92:95]
    s_waitcnt lgkmcnt(0)
    v_mfma_f32_16x16x32_bf16 v[92:95], v[128:131], a[84:87], v[92:95]
    s_waitcnt vmcnt(14)
    s_barrier
    v_lshlrev_b32 v38, 16, v209
    v_mfma_f32_16x16x32_bf16 v[92:95], v[132:135], a[92:95], v[92:95]
    ds_read_b128 v[104:107], v14 offset:16384
    v_add_f32 v32, v32, v36
    v_mfma_f32_16x16x32_bf16 v[88:91], v[132:135], a[88:91], v[88:91]
    ds_read_b128 v[108:111], v14 offset:20480
    v_mfma_f32_16x16x32_bf16 v[88:91], v[128:131], a[80:83], v[88:91]
    ds_read_b128 v[112:115], v14 offset:24576
    v_add_f32 v33, v33, v37
    v_mfma_f32_16x16x32_bf16 v[88:91], v[124:127], a[72:75], v[88:91]
    ds_read_b128 v[116:119], v14 offset:28672
    v_add_f32 v34, v34, v38
    v_mfma_f32_16x16x32_bf16 v[88:91], v[120:123], a[64:67], v[88:91]
    s_waitcnt lgkmcnt(2)
    v_mfma_f32_16x16x32_bf16 v[96:99], v[104:107], a[64:67], v[96:99]
    s_add_u32 m0, s73, 97792
    v_add_f32 v35, v35, v39
    v_mfma_f32_16x16x32_bf16 v[96:99], v[108:111], a[72:75], v[96:99]
    buffer_load_dwordx4 v19, s[44:47], s26 offen offset:512 sc1 lds
    s_waitcnt lgkmcnt(0)
    v_mfma_f32_16x16x32_bf16 v[96:99], v[112:115], a[80:83], v[96:99]
    ds_read_b128 v[120:123], v14 offset:17408
    v_and_b32 v37, 0xffff0000, v212
    v_mfma_f32_16x16x32_bf16 v[96:99], v[116:119], a[88:91], v[96:99]
    ds_read_b128 v[124:127], v14 offset:21504
    v_lshlrev_b32 v36, 16, v212
    v_mfma_f32_16x16x32_bf16 v[100:103], v[116:119], a[92:95], v[100:103]
    ds_read_b128 v[128:131], v14 offset:25600
    v_and_b32 v39, 0xffff0000, v213
    v_mfma_f32_16x16x32_bf16 v[100:103], v[112:115], a[84:87], v[100:103]
    ds_read_b128 v[132:135], v14 offset:29696
    v_mfma_f32_16x16x32_bf16 v[100:103], v[108:111], a[76:79], v[100:103]
    v_lshlrev_b32 v38, 16, v213
    v_mfma_f32_16x16x32_bf16 v[100:103], v[104:107], a[68:71], v[100:103]
    v_add_f32 v32, v32, v36
    s_waitcnt lgkmcnt(2)
    v_mfma_f32_16x16x32_bf16 v[92:95], v[120:123], a[100:103], v[92:95]
    v_mfma_f32_16x16x32_bf16 v[92:95], v[124:127], a[108:111], v[92:95]
    v_add_f32 v33, v33, v37
    s_waitcnt lgkmcnt(0)
    v_mfma_f32_16x16x32_bf16 v[92:95], v[128:131], a[116:119], v[92:95]
    ds_read_b128 v[104:107], v14 offset:18432
    v_add_f32 v34, v34, v38
    v_mfma_f32_16x16x32_bf16 v[92:95], v[132:135], a[124:127], v[92:95]
    ds_read_b128 v[108:111], v14 offset:22528
    v_add_f32 v35, v35, v39
    v_mfma_f32_16x16x32_bf16 v[88:91], v[132:135], a[120:123], v[88:91]
    ds_read_b128 v[112:115], v14 offset:26624
    v_and_b32 v37, 0xffff0000, v216
    v_mfma_f32_16x16x32_bf16 v[88:91], v[128:131], a[112:115], v[88:91]
    ds_read_b128 v[116:119], v14 offset:30720
    v_lshlrev_b32 v36, 16, v216
    v_mfma_f32_16x16x32_bf16 v[88:91], v[124:127], a[104:107], v[88:91]
    v_and_b32 v39, 0xffff0000, v217
    v_lshlrev_b32 v38, 16, v217
    v_mfma_f32_16x16x32_bf16 v[88:91], v[120:123], a[96:99], v[88:91]
    v_add_f32 v32, v32, v36
    s_waitcnt lgkmcnt(2)
    v_mfma_f32_16x16x32_bf16 v[96:99], v[104:107], a[96:99], v[96:99]
    v_add_f32 v33, v33, v37
    v_add_f32 v34, v34, v38
    v_mfma_f32_16x16x32_bf16 v[96:99], v[108:111], a[104:107], v[96:99]
    v_add_f32 v35, v35, v39
    s_waitcnt lgkmcnt(0)
    v_mfma_f32_16x16x32_bf16 v[96:99], v[112:115], a[112:115], v[96:99]
    ds_read_b128 v[120:123], v14 offset:19456
    v_mul_f32 v36, s38, v32
    v_mfma_f32_16x16x32_bf16 v[96:99], v[116:119], a[120:123], v[96:99]
    ds_read_b128 v[124:127], v14 offset:23552
    v_mul_f32 v37, s38, v33
    v_mfma_f32_16x16x32_bf16 v[100:103], v[116:119], a[124:127], v[100:103]
    ds_read_b128 v[128:131], v14 offset:27648
    v_mul_f32 v38, s38, v34
    v_mfma_f32_16x16x32_bf16 v[100:103], v[112:115], a[116:119], v[100:103]
    ds_read_b128 v[132:135], v14 offset:31744
    v_mul_f32 v39, s38, v35
    v_mfma_f32_16x16x32_bf16 v[100:103], v[108:111], a[108:111], v[100:103]
    v_exp_f32 v36, v36
    v_mfma_f32_16x16x32_bf16 v[100:103], v[104:107], a[100:103], v[100:103]
    s_waitcnt lgkmcnt(2)
    v_mfma_f32_16x16x32_bf16 v[92:95], v[120:123], a[132:135], v[92:95]
    v_exp_f32 v37, v37
    v_mfma_f32_16x16x32_bf16 v[92:95], v[124:127], a[140:143], v[92:95]
    s_waitcnt lgkmcnt(0)
    v_mfma_f32_16x16x32_bf16 v[92:95], v[128:131], a[148:151], v[92:95]
    s_waitcnt vmcnt(11)
    s_barrier
    v_mfma_f32_16x16x32_bf16 v[92:95], v[132:135], a[156:159], v[92:95]
    ds_read_b128 v[104:107], v14 offset:32768
    v_mfma_f32_16x16x32_bf16 v[88:91], v[132:135], a[152:155], v[88:91]
    ds_read_b128 v[108:111], v14 offset:36864
    v_exp_f32 v38, v38
    v_mfma_f32_16x16x32_bf16 v[88:91], v[128:131], a[144:147], v[88:91]
    ds_read_b128 v[112:115], v14 offset:40960
    v_exp_f32 v39, v39
    v_mfma_f32_16x16x32_bf16 v[88:91], v[124:127], a[136:139], v[88:91]
    ds_read_b128 v[116:119], v14 offset:45056
    v_mul_f32 v180, v180, v32
    v_mfma_f32_16x16x32_bf16 v[88:91], v[120:123], a[128:131], v[88:91]
    v_mul_f32 v181, v181, v33
    s_waitcnt lgkmcnt(2)
    v_mfma_f32_16x16x32_bf16 v[96:99], v[104:107], a[128:131], v[96:99]
    v_mul_f32 v182, v182, v34
    v_mul_f32 v183, v183, v35
    v_mfma_f32_16x16x32_bf16 v[96:99], v[108:111], a[136:139], v[96:99]
    v_add_f32 v36, 1.0, v36
    s_waitcnt lgkmcnt(0)
    v_mfma_f32_16x16x32_bf16 v[96:99], v[112:115], a[144:147], v[96:99]
    ds_read_b128 v[120:123], v14 offset:33792
    v_add_f32 v37, 1.0, v37
    v_mfma_f32_16x16x32_bf16 v[96:99], v[116:119], a[152:155], v[96:99]
    ds_read_b128 v[124:127], v14 offset:37888
    v_add_f32 v38, 1.0, v38
    v_mfma_f32_16x16x32_bf16 v[100:103], v[116:119], a[156:159], v[100:103]
    ds_read_b128 v[128:131], v14 offset:41984
    v_add_f32 v39, 1.0, v39
    v_mfma_f32_16x16x32_bf16 v[100:103], v[112:115], a[148:151], v[100:103]
    ds_read_b128 v[132:135], v14 offset:46080
    v_rcp_f32 v36, v36
    v_mfma_f32_16x16x32_bf16 v[100:103], v[108:111], a[140:143], v[100:103]
    v_rcp_f32 v37, v37
    v_mfma_f32_16x16x32_bf16 v[100:103], v[104:107], a[132:135], v[100:103]
    v_rcp_f32 v38, v38
    s_waitcnt lgkmcnt(2)
    v_mfma_f32_16x16x32_bf16 v[92:95], v[120:123], a[164:167], v[92:95]
    s_waitcnt vmcnt(8)
    v_bitop3_b32 v59, v59, v63, s68 bitop3:0x7e
    v_rcp_f32 v39, v39
    v_mfma_f32_16x16x32_bf16 v[92:95], v[124:127], a[172:175], v[92:95]
    buffer_load_dwordx4 v[72:75], v136, s[44:47], s12 offen offset:0 sc1
    s_waitcnt lgkmcnt(0)
    v_mfma_f32_16x16x32_bf16 v[92:95], v[128:131], a[180:183], v[92:95]
    ds_read_b128 v[104:107], v14 offset:34816
    v_bitop3_b32 v59, v59, v67, s68 bitop3:0xf6
    v_mfma_f32_16x16x32_bf16 v[92:95], v[132:135], a[188:191], v[92:95]
    ds_read_b128 v[108:111], v14 offset:38912
    v_cmp_ne_u32 vcc, 0, v59
    v_mfma_f32_16x16x32_bf16 v[88:91], v[132:135], a[184:187], v[88:91]
    ds_read_b128 v[112:115], v14 offset:43008
    buffer_load_dwordx4 v[76:79], v136, s[44:47], s12 offen offset:1024 sc1
    v_mfma_f32_16x16x32_bf16 v[88:91], v[128:131], a[176:179], v[88:91]
    ds_read_b128 v[116:119], v14 offset:47104
    s_cbranch_vccnz L_xs_b
L_xo_b:
    v_fma_f32 v180, v180, v36, v160
    v_mfma_f32_16x16x32_bf16 v[88:91], v[124:127], a[168:171], v[88:91]
    buffer_load_dwordx4 v[80:83], v136, s[44:47], s12 offen offset:2048 sc1
    v_and_b32 v41, 0xffff0000, v56
    v_mfma_f32_16x16x32_bf16 v[88:91], v[120:123], a[160:163], v[88:91]
    v_lshlrev_b32 v40, 16, v56
    s_waitcnt lgkmcnt(2)
    v_mfma_f32_16x16x32_bf16 v[96:99], v[104:107], a[160:163], v[96:99]
    v_and_b32 v43, 0xffff0000, v57
    v_fma_f32 v181, v181, v37, v161
    v_mfma_f32_16x16x32_bf16 v[96:99], v[108:111], a[168:171], v[96:99]
    v_lshlrev_b32 v42, 16, v57
    s_waitcnt lgkmcnt(0)
    v_mfma_f32_16x16x32_bf16 v[96:99], v[112:115], a[176:179], v[96:99]
    ds_read_b128 v[120:123], v14 offset:35840
    v_and_b32 v45, 0xffff0000, v58
    v_mfma_f32_16x16x32_bf16 v[96:99], v[116:119], a[184:187], v[96:99]
    ds_read_b128 v[124:127], v14 offset:39936
    v_fma_f32 v182, v182, v38, v162
    v_mfma_f32_16x16x32_bf16 v[100:103], v[116:119], a[188:191], v[100:103]
    ds_read_b128 v[128:131], v14 offset:44032
    v_lshlrev_b32 v44, 16, v58
    v_mfma_f32_16x16x32_bf16 v[100:103], v[112:115], a[180:183], v[100:103]
    ds_read_b128 v[132:135], v14 offset:48128
    v_and_b32 v47, 0xffff0000, v60
    v_mfma_f32_16x16x32_bf16 v[100:103], v[108:111], a[172:175], v[100:103]
    v_lshlrev_b32 v46, 16, v60
    v_fma_f32 v183, v183, v39, v163
    v_mfma_f32_16x16x32_bf16 v[100:103], v[104:107], a[164:167], v[100:103]
    v_and_b32 v49, 0xffff0000, v61
    s_waitcnt lgkmcnt(2)
    v_mfma_f32_16x16x32_bf16 v[92:95], v[120:123], a[196:199], v[92:95]
    v_lshlrev_b32 v48, 16, v61
    v_cvt_pk_bf16_f32 v142, v180, v181
    v_mfma_f32_16x16x32_bf16 v[92:95], v[124:127], a[204:207], v[92:95]
    v_and_b32 v51, 0xffff0000, v62
    s_waitcnt lgkmcnt(0)
    v_mfma_f32_16x16x32_bf16 v[92:95], v[128:131], a[212:215], v[92:95]
    s_waitcnt vmcnt(4)
    s_barrier
    v_lshlrev_b32 v50, 16, v62
    v_mfma_f32_16x16x32_bf16 v[92:95], v[132:135], a[220:223], v[92:95]
    ds_read_b128 v[104:107], v14 offset:49152
    v_cvt_pk_bf16_f32 v143, v182, v183
    v_mfma_f32_16x16x32_bf16 v[88:91], v[132:135], a[216:219], v[88:91]
    ds_read_b128 v[108:111], v14 offset:53248
    v_and_b32 v53, 0xffff0000, v64
    v_mfma_f32_16x16x32_bf16 v[88:91], v[128:131], a[208:211], v[88:91]
    ds_read_b128 v[112:115], v14 offset:57344
    v_lshlrev_b32 v52, 16, v64
    v_mfma_f32_16x16x32_bf16 v[88:91], v[124:127], a[200:203], v[88:91]
    ds_read_b128 v[116:119], v14 offset:61440
    v_and_b32 v55, 0xffff0000, v65
    v_mfma_f32_16x16x32_bf16 v[88:91], v[120:123], a[192:195], v[88:91]
    v_lshlrev_b32 v54, 16, v65
    s_waitcnt lgkmcnt(2)
    v_mfma_f32_16x16x32_bf16 v[96:99], v[104:107], a[192:195], v[96:99]
    v_mfma_f32_16x16x32_bf16 v[96:99], v[108:111], a[200:203], v[96:99]
    s_waitcnt lgkmcnt(0)
    v_mfma_f32_16x16x32_bf16 v[96:99], v[112:115], a[208:211], v[96:99]
    ds_read_b128 v[120:123], v14 offset:50176
    v_add_f32 v92, v92, v44
    v_add_f32 v93, v93, v45
    v_mfma_f32_16x16x32_bf16 v[96:99], v[116:119], a[216:219], v[96:99]
    ds_read_b128 v[124:127], v14 offset:54272
    v_add_f32 v94, v94, v46
    v_mfma_f32_16x16x32_bf16 v[100:103], v[116:119], a[220:223], v[100:103]
    ds_read_b128 v[128:131], v14 offset:58368
    v_add_f32 v95, v95, v47
    v_add_f32 v88, v88, v40
    v_mfma_f32_16x16x32_bf16 v[100:103], v[112:115], a[212:215], v[100:103]
    ds_read_b128 v[132:135], v14 offset:62464
    v_add_f32 v89, v89, v41
    v_mfma_f32_16x16x32_bf16 v[100:103], v[108:111], a[204:207], v[100:103]
    v_add_f32 v90, v90, v42
    v_add_f32 v91, v91, v43
    v_mfma_f32_16x16x32_bf16 v[100:103], v[104:107], a[196:199], v[100:103]
    s_waitcnt lgkmcnt(2)
    v_mfma_f32_16x16x32_bf16 v[92:95], v[120:123], a[228:231], v[92:95]
    v_mfma_f32_16x16x32_bf16 v[92:95], v[124:127], a[236:239], v[92:95]
    s_waitcnt lgkmcnt(0)
    v_mfma_f32_16x16x32_bf16 v[92:95], v[128:131], a[244:247], v[92:95]
    ds_read_b128 v[104:107], v14 offset:51200
    v_add_f32 v96, v96, v48
    v_add_f32 v97, v97, v49
    v_mfma_f32_16x16x32_bf16 v[92:95], v[132:135], a[252:255], v[92:95]
    ds_read_b128 v[108:111], v14 offset:55296
    v_add_f32 v98, v98, v50
    v_mfma_f32_16x16x32_bf16 v[88:91], v[132:135], a[248:251], v[88:91]
    ds_read_b128 v[112:115], v14 offset:59392
    v_add_f32 v99, v99, v51
    v_add_f32 v100, v100, v52
    v_mfma_f32_16x16x32_bf16 v[88:91], v[128:131], a[240:243], v[88:91]
    ds_read_b128 v[116:119], v14 offset:63488
    v_add_f32 v101, v101, v53
    v_mfma_f32_16x16x32_bf16 v[88:91], v[124:127], a[232:235], v[88:91]
    v_add_f32 v102, v102, v54
    v_add_f32 v103, v103, v55
    v_mfma_f32_16x16x32_bf16 v[88:91], v[120:123], a[224:227], v[88:91]
    s_waitcnt lgkmcnt(2)
    v_mfma_f32_16x16x32_bf16 v[96:99], v[104:107], a[224:227], v[96:99]
    v_mfma_f32_16x16x32_bf16 v[96:99], v[108:111], a[232:235], v[96:99]
    s_waitcnt lgkmcnt(0)
    v_mfma_f32_16x16x32_bf16 v[96:99], v[112:115], a[240:243], v[96:99]
    ds_read_b128 v[120:123], v14 offset:52224
    v_mfma_f32_16x16x32_bf16 v[96:99], v[116:119], a[248:251], v[96:99]
    ds_read_b128 v[124:127], v14 offset:56320
    v_mfma_f32_16x16x32_bf16 v[100:103], v[116:119], a[252:255], v[100:103]
    buffer_store_dwordx2 v[142:143], v253, s[64:67], 0 offen sc1
    ds_read_b128 v[128:131], v14 offset:60416
    v_mfma_f32_16x16x32_bf16 v[100:103], v[112:115], a[244:247], v[100:103]
    ds_read_b128 v[132:135], v14 offset:64512
    v_mfma_f32_16x16x32_bf16 v[100:103], v[108:111], a[236:239], v[100:103]
    v_mfma_f32_16x16x32_bf16 v[100:103], v[104:107], a[228:231], v[100:103]
    s_waitcnt lgkmcnt(2)
    v_mfma_f32_16x16x32_bf16 v[92:95], v[120:123], v[224:227], v[92:95]
    v_mfma_f32_16x16x32_bf16 v[92:95], v[124:127], v[232:235], v[92:95]
    s_waitcnt lgkmcnt(0)
    v_mfma_f32_16x16x32_bf16 v[92:95], v[128:131], v[240:243], v[92:95]
    s_waitcnt vmcnt(4)
    s_barrier
    v_mfma_f32_16x16x32_bf16 v[92:95], v[132:135], v[248:251], v[92:95]
    ds_read_b128 v[104:107], v14 offset:0
    v_mfma_f32_16x16x32_bf16 v[88:91], v[132:135], v[244:247], v[88:91]
    ds_read_b128 v[108:111], v14 offset:4096
    v_mfma_f32_16x16x32_bf16 v[88:91], v[128:131], v[236:239], v[88:91]
    ds_read_b128 v[112:115], v14 offset:8192
    v_mfma_f32_16x16x32_bf16 v[88:91], v[124:127], v[228:231], v[88:91]
    ds_read_b128 v[116:119], v14 offset:12288
    v_mfma_f32_16x16x32_bf16 v[88:91], v[120:123], v[220:223], v[88:91]
    s_waitcnt lgkmcnt(2)
    v_mfma_f32_16x16x32_bf16 v[96:99], v[104:107], v[220:223], v[96:99]
    v_mfma_f32_16x16x32_bf16 v[96:99], v[108:111], v[228:231], v[96:99]
    s_waitcnt lgkmcnt(0)
    v_mfma_f32_16x16x32_bf16 v[96:99], v[112:115], v[236:239], v[96:99]
    v_mfma_f32_16x16x32_bf16 v[96:99], v[116:119], v[244:247], v[96:99]
    v_mfma_f32_16x16x32_bf16 v[100:103], v[116:119], v[248:251], v[100:103]
    v_mfma_f32_16x16x32_bf16 v[100:103], v[112:115], v[240:243], v[100:103]
    v_mfma_f32_16x16x32_bf16 v[100:103], v[108:111], v[232:235], v[100:103]
    v_mfma_f32_16x16x32_bf16 v[100:103], v[104:107], v[224:227], v[100:103]
    s_waitcnt vmcnt(1)
    v_bitop3_b32 v75, v75, v79, s68 bitop3:0x7e
    v_bitop3_b32 v75, v75, v83, s68 bitop3:0xf6
    v_cmp_ne_u32 vcc, 0, v75
    s_cbranch_vccnz L_xs_z
L_xo_z:
    v_and_b32 v41, 0xffff0000, v72
    v_lshlrev_b32 v40, 16, v72
    v_and_b32 v43, 0xffff0000, v73
    v_lshlrev_b32 v42, 16, v73
    v_and_b32 v45, 0xffff0000, v74
    v_lshlrev_b32 v44, 16, v74
    v_and_b32 v47, 0xffff0000, v76
    v_lshlrev_b32 v46, 16, v76
    v_and_b32 v49, 0xffff0000, v77
    v_lshlrev_b32 v48, 16, v77
    v_and_b32 v51, 0xffff0000, v78
    v_lshlrev_b32 v50, 16, v78
    v_and_b32 v53, 0xffff0000, v80
    v_lshlrev_b32 v52, 16, v80
    v_and_b32 v55, 0xffff0000, v81
    v_lshlrev_b32 v54, 16, v81
    v_pk_add_f32 v[88:89], v[88:89], v[40:41]
    v_pk_add_f32 v[90:91], v[90:91], v[42:43]
    v_pk_add_f32 v[96:97], v[96:97], v[48:49]
    v_pk_add_f32 v[98:99], v[98:99], v[50:51]
    v_pk_mul_f32 v[56:57], v[88:89], s[38:39] op_sel_hi:[1,0]
    v_pk_mul_f32 v[58:59], v[90:91], s[38:39] op_sel_hi:[1,0]
    v_pk_mul_f32 v[64:65], v[96:97], s[38:39] op_sel_hi:[1,0]
    v_pk_mul_f32 v[66:67], v[98:99], s[38:39] op_sel_hi:[1,0]
    v_exp_f32 v56, v56
    v_exp_f32 v57, v57
    v_exp_f32 v58, v58
    v_exp_f32 v59, v59
    v_exp_f32 v64, v64
    v_exp_f32 v65, v65
    v_exp_f32 v66, v66
    v_exp_f32 v67, v67
    v_pk_mul_f32 v[164:165], v[164:165], v[88:89]
    v_pk_mul_f32 v[166:167], v[166:167], v[90:91]
    v_pk_mul_f32 v[172:173], v[172:173], v[96:97]
    v_pk_mul_f32 v[174:175], v[174:175], v[98:99]
    v_pk_add_f32 v[56:57], v[56:57], 1.0 op_sel_hi:[1,0]
    v_pk_add_f32 v[58:59], v[58:59], 1.0 op_sel_hi:[1,0]
    v_pk_add_f32 v[64:65], v[64:65], 1.0 op_sel_hi:[1,0]
    v_pk_add_f32 v[66:67], v[66:67], 1.0 op_sel_hi:[1,0]
    v_rcp_f32 v56, v56
    v_rcp_f32 v57, v57
    v_rcp_f32 v58, v58
    v_rcp_f32 v59, v59
    v_rcp_f32 v64, v64
    v_rcp_f32 v65, v65
    v_rcp_f32 v66, v66
    v_rcp_f32 v67, v67
    v_pk_fma_f32 v[164:165], v[164:165], v[56:57], v[144:145]
    v_pk_fma_f32 v[166:167], v[166:167], v[58:59], v[146:147]
    v_pk_fma_f32 v[172:173], v[172:173], v[64:65], v[152:153]
    v_pk_fma_f32 v[174:175], v[174:175], v[66:67], v[154:155]
    v_cvt_pk_bf16_f32 v88, v164, v165
    v_cvt_pk_bf16_f32 v90, v172, v173
    v_cvt_pk_bf16_f32 v89, v166, v167
    v_cvt_pk_bf16_f32 v91, v174, v175
    v_permlane16_swap_b32 v88, v90
    s_nop 0
    v_permlane16_swap_b32 v89, v91
    buffer_store_dwordx4 v[88:91], v252, s[64:67], 0 offen sc1
    v_pk_add_f32 v[92:93], v[92:93], v[44:45]
    v_pk_add_f32 v[94:95], v[94:95], v[46:47]
    v_pk_add_f32 v[100:101], v[100:101], v[52:53]
    v_pk_add_f32 v[102:103], v[102:103], v[54:55]
    v_pk_mul_f32 v[60:61], v[92:93], s[38:39] op_sel_hi:[1,0]
    v_pk_mul_f32 v[62:63], v[94:95], s[38:39] op_sel_hi:[1,0]
    v_pk_mul_f32 v[68:69], v[100:101], s[38:39] op_sel_hi:[1,0]
    v_pk_mul_f32 v[70:71], v[102:103], s[38:39] op_sel_hi:[1,0]
    v_exp_f32 v60, v60
    v_exp_f32 v61, v61
    v_exp_f32 v62, v62
    v_exp_f32 v63, v63
    v_exp_f32 v68, v68
    v_exp_f32 v69, v69
    v_exp_f32 v70, v70
    v_exp_f32 v71, v71
    v_pk_mul_f32 v[168:169], v[168:169], v[92:93]
    v_pk_mul_f32 v[170:171], v[170:171], v[94:95]
    v_pk_mul_f32 v[176:177], v[176:177], v[100:101]
    v_pk_mul_f32 v[178:179], v[178:179], v[102:103]
    v_pk_add_f32 v[60:61], v[60:61], 1.0 op_sel_hi:[1,0]
    v_pk_add_f32 v[62:63], v[62:63], 1.0 op_sel_hi:[1,0]
    v_pk_add_f32 v[68:69], v[68:69], 1.0 op_sel_hi:[1,0]
    v_pk_add_f32 v[70:71], v[70:71], 1.0 op_sel_hi:[1,0]
    v_rcp_f32 v60, v60
    v_rcp_f32 v61, v61
    v_rcp_f32 v62, v62
    v_rcp_f32 v63, v63
    v_rcp_f32 v68, v68
    v_rcp_f32 v69, v69
    v_rcp_f32 v70, v70
    v_rcp_f32 v71, v71
    v_pk_fma_f32 v[168:169], v[168:169], v[60:61], v[148:149]
    v_pk_fma_f32 v[170:171], v[170:171], v[62:63], v[150:151]
    v_pk_fma_f32 v[176:177], v[176:177], v[68:69], v[156:157]
    v_pk_fma_f32 v[178:179], v[178:179], v[70:71], v[158:159]
    v_cvt_pk_bf16_f32 v92, v168, v169
    v_cvt_pk_bf16_f32 v94, v176, v177
    v_cvt_pk_bf16_f32 v93, v170, v171
    v_cvt_pk_bf16_f32 v95, v178, v179
    v_permlane16_swap_b32 v92, v94
    s_nop 0
    v_permlane16_swap_b32 v93, v95
    buffer_store_dwordx4 v[92:95], v252, s[64:67], s40 offen sc1
    s_endpgm
L_segE:
.p2align 12
L_aux:
    s_bfe_u32 s101, s2, 0x20003
    s_mul_i32 s101, s101, 3
    s_mul_i32 s84, s101, 305844
    s_lshr_b32 s84, s84, 18
    s_add_u32 s84, s84, 0
    s_add_u32 s85, s84, 1
    s_cmp_eq_u32 s85, 14
    s_cselect_b32 s85, 0, s85
    s_add_u32 s86, s85, 1
    s_cmp_eq_u32 s86, 14
    s_cselect_b32 s86, 0, s86
    s_add_u32 s87, s86, 1
    s_cmp_eq_u32 s87, 14
    s_cselect_b32 s87, 0, s87
    s_add_u32 s88, s87, 1
    s_cmp_eq_u32 s88, 14
    s_cselect_b32 s88, 0, s88
    s_add_u32 s89, s88, 1
    s_cmp_eq_u32 s89, 14
    s_cselect_b32 s89, 0, s89
    s_add_u32 s90, s89, 1
    s_cmp_eq_u32 s90, 14
    s_cselect_b32 s90, 0, s90
    s_add_u32 s91, s90, 1
    s_cmp_eq_u32 s91, 14
    s_cselect_b32 s91, 0, s91
    s_add_u32 s92, s91, 1
    s_cmp_eq_u32 s92, 14
    s_cselect_b32 s92, 0, s92
    s_add_u32 s93, s92, 1
    s_cmp_eq_u32 s93, 14
    s_cselect_b32 s93, 0, s93
    s_add_u32 s94, s93, 1
    s_cmp_eq_u32 s94, 14
    s_cselect_b32 s94, 0, s94
    s_add_u32 s95, s94, 1
    s_cmp_eq_u32 s95, 14
    s_cselect_b32 s95, 0, s95
    s_add_u32 s96, s95, 1
    s_cmp_eq_u32 s96, 14
    s_cselect_b32 s96, 0, s96
    s_add_u32 s97, s96, 1
    s_cmp_eq_u32 s97, 14
    s_cselect_b32 s97, 0, s97
    s_mul_i32 s98, s101, 87384
    s_lshr_b32 s98, s98, 18
    s_add_u32 s98, s98, 14
    s_add_u32 s99, s98, 1
    s_cmp_eq_u32 s99, 18
    s_cselect_b32 s99, 14, s99
    s_add_u32 s100, s99, 1
    s_cmp_eq_u32 s100, 18
    s_cselect_b32 s100, 14, s100
    s_add_u32 s101, s100, 1
    s_cmp_eq_u32 s101, 18
    s_cselect_b32 s101, 14, s101
    s_lshl2_add_u32 s7, s5, s6
    s_add_u32 s7, s7, 188
    s_add_u32 s8, s5, 248
    s_cmp_eq_u32 s6, 27
    s_cselect_b32 s75, s8, s7
    s_mov_b32 s48, s24
    s_and_b32 s49, s25, 0xffff
    s_mov_b32 s50, 2359296
    s_mov_b32 s51, 0x20000
    v_lshlrev_b32 v240, 4, v2
    s_mul_i32 s74, s3, 16640
    s_add_u32 s74, s74, 73728
    s_sub_u32 s69, s75, 216
    s_lshl_b32 s70, s69, 4
    s_add_u32 s70, s70, s3
    s_lshl_b32 s12, s70, 12
    s_lshl_b32 s70, s70, 1
    s_mov_b32 s9, 144896
    s_mov_b32 s11, 8192
    v_mul_u32_u24 v48, 1216, v3
    v_mad_u32_u24 v48, v4, 12, v48
    v_add_u32 v48, s9, v48
    v_mov_b32 v47, 0x40000000
    v_lshlrev_b32 v3, 3, v3
    s_lshl_b32 s5, s68, 6
    s_add_u32 s5, s5, 12386304
    v_cmp_eq_u32 vcc, 0, v4
    s_nop 1
    v_cndmask_b32 v49, v47, v3, vcc
    v_lshrrev_b32 v5, 4, v0
    v_and_b32 v4, 3, v2
    v_lshlrev_b32 v4, 3, v4
    v_lshl_add_u32 v5, v5, 5, v4
    v_bfe_u32 v6, v2, 2, 2
    v_mul_u32_u24 v4, 1216, v6
    v_mul_u32_u24 v6, 1152, v6
    v_add3_u32 v50, v4, v5, s9
    v_add3_u32 v51, v6, v5, s11
    s_mul_i32 s4, s3, 2176
    v_add_u32 v55, s4, v51
    v_lshlrev_b32 v52, 4, v0
    s_add_u32 s7, s15, 4096
    s_add_u32 s8, s15, 8192
    s_cmp_eq_u32 s3, 0
    s_cselect_b32 s8, s8, 0x40000000
    v_add_u32 v53, 2359296, v52
    v_mov_b32 v54, 0
    v_add_u32 v4, 0, v52
    v_lshrrev_b32 v5, 7, v4
    v_mul_u32_u24 v6, 9363, v5
    v_lshrrev_b32 v6, 16, v6
    v_mad_i32_i24 v5, v6, -7, v5
    v_cmp_lt_u32 vcc, 2, v5
    s_nop 1
    v_addc_co_u32 v6, vcc, 0, v6, vcc
    v_lshl_add_u32 v93, v6, 7, v4
    v_add_u32 v4, 4096, v52
    v_lshrrev_b32 v5, 7, v4
    v_mul_u32_u24 v6, 9363, v5
    v_lshrrev_b32 v6, 16, v6
    v_mad_i32_i24 v5, v6, -7, v5
    v_cmp_lt_u32 vcc, 2, v5
    s_nop 1
    v_addc_co_u32 v6, vcc, 0, v6, vcc
    v_lshl_add_u32 v94, v6, 7, v4
    v_add_u32 v4, 8192, v52
    v_lshrrev_b32 v5, 7, v4
    v_mul_u32_u24 v6, 9363, v5
    v_lshrrev_b32 v6, 16, v6
    v_mad_i32_i24 v5, v6, -7, v5
    v_cmp_lt_u32 vcc, 2, v5
    s_nop 1
    v_addc_co_u32 v6, vcc, 0, v6, vcc
    v_lshl_add_u32 v95, v6, 7, v4
    s_mul_i32 s10, s68, 11264
    s_add_u32 s10, s10, 36585472
    s_cmp_eq_u32 s3, 0
    s_cselect_b32 s83, s10, 0x40000000
    s_add_u32 s7, s10, 2883584
    s_add_u32 s8, s83, 2883584
    s_mul_i32 s4, s3, 1028
    s_sub_u32 s4, 8204, s4
    v_add_u32 v90, s4, v53
    s_bfe_u32 s6, s68, 0x20001
    s_lshl_b32 s6, s6, 6
    s_lshr_b32 s9, s68, 3
    s_lshl1_add_u32 s6, s9, s6
    s_and_b32 s9, s68, 1
    s_add_u32 s6, s6, s9
    s_lshl_b32 s4, s6, 2
    s_add_u32 s4, s4, 12533760
    v_lshl_add_u32 v1, v0, 10, s4
    s_lshl_b32 s4, s68, 2
    s_add_u32 s4, s4, 12599296
    v_lshl_add_u32 v46, v0, 10, s4
    v_cmp_gt_u32 vcc, 8, v0
    s_nop 1
    v_cndmask_b32 v1, v47, v1, vcc
    v_cmp_gt_u32 vcc, 4, v0
    s_nop 1
    v_cndmask_b32 v46, v47, v46, vcc
    s_waitcnt vmcnt(9)
    v_and_b32 v21, 0xffff0000, v8
    v_lshlrev_b32 v20, 16, v8
    v_and_b32 v23, 0xffff0000, v9
    v_lshlrev_b32 v22, 16, v9
    v_and_b32 v25, 0xffff0000, v10
    v_lshlrev_b32 v24, 16, v10
    v_and_b32 v27, 0xffff0000, v12
    v_lshlrev_b32 v26, 16, v12
    v_and_b32 v29, 0xffff0000, v13
    v_lshlrev_b32 v28, 16, v13
    v_and_b32 v31, 0xffff0000, v14
    v_lshlrev_b32 v30, 16, v14
    v_and_b32 v33, 0xffff0000, v16
    v_lshlrev_b32 v32, 16, v16
    v_and_b32 v35, 0xffff0000, v17
    v_lshlrev_b32 v34, 16, v17
    v_and_b32 v37, 0xffff0000, v18
    v_lshlrev_b32 v36, 16, v18
    v_pk_add_f32 v[38:39], v[20:21], v[22:23]
    v_pk_add_f32 v[40:41], v[24:25], v[26:27]
    v_pk_add_f32 v[42:43], v[28:29], v[30:31]
    v_pk_add_f32 v[44:45], v[32:33], v[34:35]
    v_pk_add_f32 v[38:39], v[38:39], v[40:41]
    v_pk_add_f32 v[42:43], v[42:43], v[44:45]
    v_pk_add_f32 v[38:39], v[38:39], v[36:37]
    v_pk_add_f32 v[38:39], v[38:39], v[42:43]
    v_add_f32 v56, v38, v39
    s_nop 1
    v_add_f32_dpp v56, v56, v56 row_ror:8 row_mask:0xf bank_mask:0xf
    s_nop 1
    v_add_f32_dpp v56, v56, v56 row_ror:4 row_mask:0xf bank_mask:0xf
    s_nop 1
    v_add_f32_dpp v56, v56, v56 row_ror:2 row_mask:0xf bank_mask:0xf
    s_nop 1
    v_add_f32_dpp v56, v56, v56 row_ror:1 row_mask:0xf bank_mask:0xf
    v_mov_b32 v57, v56
    s_nop 1
    v_permlane16_swap_b32 v56, v57
    v_add_f32 v56, v56, v57
    v_mul_f32 v56, 0x3ae38e39, v56
    v_pk_add_f32 v[20:21], v[20:21], v[56:57] op_sel_hi:[1,0] neg_lo:[0,1] neg_hi:[0,1]
    v_pk_add_f32 v[22:23], v[22:23], v[56:57] op_sel_hi:[1,0] neg_lo:[0,1] neg_hi:[0,1]
    v_pk_add_f32 v[24:25], v[24:25], v[56:57] op_sel_hi:[1,0] neg_lo:[0,1] neg_hi:[0,1]
    v_pk_add_f32 v[26:27], v[26:27], v[56:57] op_sel_hi:[1,0] neg_lo:[0,1] neg_hi:[0,1]
    v_pk_add_f32 v[28:29], v[28:29], v[56:57] op_sel_hi:[1,0] neg_lo:[0,1] neg_hi:[0,1]
    v_pk_add_f32 v[30:31], v[30:31], v[56:57] op_sel_hi:[1,0] neg_lo:[0,1] neg_hi:[0,1]
    v_pk_add_f32 v[32:33], v[32:33], v[56:57] op_sel_hi:[1,0] neg_lo:[0,1] neg_hi:[0,1]
    v_pk_add_f32 v[34:35], v[34:35], v[56:57] op_sel_hi:[1,0] neg_lo:[0,1] neg_hi:[0,1]
    v_pk_add_f32 v[36:37], v[36:37], v[56:57] op_sel_hi:[1,0] neg_lo:[0,1] neg_hi:[0,1]
    v_pk_mul_f32 v[38:39], v[20:21], v[20:21]
    v_pk_mul_f32 v[40:41], v[22:23], v[22:23]
    v_pk_fma_f32 v[38:39], v[24:25], v[24:25], v[38:39]
    v_pk_fma_f32 v[40:41], v[26:27], v[26:27], v[40:41]
    v_pk_fma_f32 v[38:39], v[28:29], v[28:29], v[38:39]
    v_pk_fma_f32 v[40:41], v[30:31], v[30:31], v[40:41]
    v_pk_fma_f32 v[38:39], v[32:33], v[32:33], v[38:39]
    v_pk_fma_f32 v[40:41], v[34:35], v[34:35], v[40:41]
    v_pk_fma_f32 v[38:39], v[36:37], v[36:37], v[38:39]
    v_pk_add_f32 v[38:39], v[38:39], v[40:41]
    v_add_f32 v18, v38, v39
    s_nop 1
    v_add_f32_dpp v18, v18, v18 row_ror:8 row_mask:0xf bank_mask:0xf
    s_nop 1
    v_add_f32_dpp v18, v18, v18 row_ror:4 row_mask:0xf bank_mask:0xf
    s_nop 1
    v_add_f32_dpp v18, v18, v18 row_ror:2 row_mask:0xf bank_mask:0xf
    s_nop 1
    v_add_f32_dpp v18, v18, v18 row_ror:1 row_mask:0xf bank_mask:0xf
    v_mov_b32 v19, v18
    s_nop 1
    v_permlane16_swap_b32 v18, v19
    v_add_f32 v18, v18, v19
    v_mul_f32 v18, 0x3ae38e39, v18
    v_cvt_pk_bf16_f32 v38, v56, v18
    v_lshlrev_b32 v106, 16, v38
    v_and_b32 v38, 0xffff0000, v38
    v_add_f32 v38, 0x3727c5ac, v38
    v_sub_f32 v56, v56, v106
    v_cvt_pk_bf16_f32 v38, v38, v38
    v_lshlrev_b32 v38, 16, v38
    v_sqrt_f32 v38, v38
    s_nop 0
    v_cvt_pk_bf16_f32 v38, v38, v38
    v_lshlrev_b32 v38, 16, v38
    v_rcp_f32 v107, v38
    s_nop 0
    v_mul_f32 v56, v56, v107
    v_mul_f32 v18, v18, v107
    v_mul_f32 v18, v18, v107
    v_cvt_pk_bf16_f32 v38, v56, v18
    v_lshlrev_b32 v39, 16, v38
    v_and_b32 v38, 0xffff0000, v38
    v_add_f32 v38, 0x3727c5ac, v38
    v_sub_f32 v56, v56, v39
    v_cvt_pk_bf16_f32 v38, v38, v38
    v_lshlrev_b32 v38, 16, v38
    v_sqrt_f32 v38, v38
    s_nop 0
    v_cvt_pk_bf16_f32 v38, v38, v38
    v_lshlrev_b32 v38, 16, v38
    v_rcp_f32 v38, v38
    s_nop 0
    v_mul_f32 v18, v107, v38
    v_mul_f32 v56, v56, v38
    v_pk_fma_f32 v[20:21], v[20:21], v[18:19], v[56:57] op_sel_hi:[1,0,0]
    v_pk_fma_f32 v[22:23], v[22:23], v[18:19], v[56:57] op_sel_hi:[1,0,0]
    v_pk_fma_f32 v[24:25], v[24:25], v[18:19], v[56:57] op_sel_hi:[1,0,0]
    v_pk_fma_f32 v[26:27], v[26:27], v[18:19], v[56:57] op_sel_hi:[1,0,0]
    v_pk_fma_f32 v[28:29], v[28:29], v[18:19], v[56:57] op_sel_hi:[1,0,0]
    v_pk_fma_f32 v[30:31], v[30:31], v[18:19], v[56:57] op_sel_hi:[1,0,0]
    v_pk_fma_f32 v[32:33], v[32:33], v[18:19], v[56:57] op_sel_hi:[1,0,0]
    v_pk_fma_f32 v[34:35], v[34:35], v[18:19], v[56:57] op_sel_hi:[1,0,0]
    v_pk_fma_f32 v[36:37], v[36:37], v[18:19], v[56:57] op_sel_hi:[1,0,0]
    v_cvt_pk_bf16_f32 v8, v20, v21
    v_cvt_pk_bf16_f32 v9, v22, v23
    v_cvt_pk_bf16_f32 v10, v24, v25
    v_cvt_pk_bf16_f32 v11, v26, v27
    v_cvt_pk_bf16_f32 v12, v28, v29
    v_cvt_pk_bf16_f32 v13, v30, v31
    v_cvt_pk_bf16_f32 v14, v32, v33
    v_cvt_pk_bf16_f32 v15, v34, v35
    v_cvt_pk_bf16_f32 v16, v36, v37
    ds_write_b32 v48, v8 offset:0
    ds_write_b32 v48, v9 offset:4
    ds_write_b32 v48, v10 offset:8
    ds_write_b32 v48, v11 offset:384
    ds_write_b32 v48, v12 offset:388
    ds_write_b32 v48, v13 offset:392
    ds_write_b32 v48, v14 offset:768
    ds_write_b32 v48, v15 offset:772
    ds_write_b32 v48, v16 offset:776
    buffer_store_dwordx2 v[106:107], v49, s[44:47], s5 offen sc1
    s_waitcnt lgkmcnt(0)
    s_barrier
    ds_read_b64_tr_b16 v[20:21], v50 offset:0
    ds_read_b64_tr_b16 v[22:23], v50 offset:4864
    ds_read_b64_tr_b16 v[24:25], v50 offset:512
    ds_read_b64_tr_b16 v[26:27], v50 offset:5376
    ds_read_b64_tr_b16 v[28:29], v50 offset:1024
    ds_read_b64_tr_b16 v[30:31], v50 offset:5888
    s_waitcnt lgkmcnt(4)
    buffer_store_dwordx4 v[20:23], v93, s[44:47], s10 offen sc1
    s_waitcnt lgkmcnt(2)
    buffer_store_dwordx4 v[24:27], v94, s[44:47], s10 offen sc1
    s_waitcnt lgkmcnt(0)
    buffer_store_dwordx4 v[28:31], v95, s[44:47], s83 offen sc1
    buffer_load_dword v45, v54, s[64:67], 0 offen sc1
    s_waitcnt vmcnt(5)
    s_barrier
    ds_read_b64_tr_b16 v[60:61], v51 offset:0
    ds_read_b64_tr_b16 v[62:63], v51 offset:4608
    ds_read_b64_tr_b16 v[64:65], v51 offset:9216
    ds_read_b64_tr_b16 v[66:67], v51 offset:12672
    ds_read_b64_tr_b16 v[68:69], v51 offset:17280
    ds_read_b64_tr_b16 v[70:71], v51 offset:512
    ds_read_b64_tr_b16 v[72:73], v51 offset:5120
    ds_read_b64_tr_b16 v[74:75], v51 offset:9728
    ds_read_b64_tr_b16 v[76:77], v51 offset:13184
    ds_read_b64_tr_b16 v[78:79], v51 offset:17792
    v_alignbit_b32 v114, v99, v99, 16
    v_alignbit_b32 v115, v98, v98, 16
    s_waitcnt lgkmcnt(5)
    v_alignbit_b32 v108, v61, v60, 16
    v_alignbit_b32 v109, v62, v61, 16
    v_alignbit_b32 v110, v63, v62, 16
    v_alignbit_b32 v111, v64, v63, 16
    v_alignbit_b32 v112, v65, v64, 16
    v_dot2_f32_bf16 v116, v60, v114, 0
    ds_read_b64_tr_b16 v[80:81], v51 offset:1024
    v_dot2_f32_bf16 v117, v108, v114, 0
    v_dot2_f32_bf16 v118, v61, v114, 0
    v_dot2_f32_bf16 v119, v109, v114, 0
    v_dot2_f32_bf16 v120, v62, v114, 0
    ds_read_b64_tr_b16 v[82:83], v51 offset:5632
    v_dot2_f32_bf16 v121, v110, v114, 0
    v_dot2_f32_bf16 v122, v63, v114, 0
    v_dot2_f32_bf16 v123, v111, v114, 0
    v_dot2_f32_bf16 v116, v61, v115, v116
    v_dot2_f32_bf16 v117, v109, v115, v117
    ds_read_b64_tr_b16 v[84:85], v51 offset:10240
    v_dot2_f32_bf16 v118, v62, v115, v118
    v_dot2_f32_bf16 v119, v110, v115, v119
    v_dot2_f32_bf16 v120, v63, v115, v120
    v_dot2_f32_bf16 v121, v111, v115, v121
    v_dot2_f32_bf16 v122, v64, v115, v122
    ds_read_b64_tr_b16 v[86:87], v51 offset:13696
    v_dot2_f32_bf16 v123, v112, v115, v123
    v_and_b32 v133, 0xffff0000, v66
    v_lshlrev_b32 v132, 16, v66
    v_and_b32 v135, 0xffff0000, v67
    v_lshlrev_b32 v134, 16, v67
    ds_read_b64_tr_b16 v[88:89], v51 offset:18304
    v_and_b32 v137, 0xffff0000, v68
    v_lshlrev_b32 v136, 16, v68
    v_and_b32 v139, 0xffff0000, v69
    v_lshlrev_b32 v138, 16, v69
    v_pk_mul_f32 v[116:117], v[116:117], v[132:133]
    v_pk_mul_f32 v[118:119], v[118:119], v[134:135]
    v_pk_mul_f32 v[120:121], v[120:121], v[136:137]
    v_pk_mul_f32 v[122:123], v[122:123], v[138:139]
    v_cvt_pk_bf16_f32 v160, v123, v122
    v_cvt_pk_bf16_f32 v161, v121, v120
    v_cvt_pk_bf16_f32 v162, v119, v118
    v_cvt_pk_bf16_f32 v163, v117, v116
    buffer_store_dwordx4 v[160:163], v93, s[44:47], s7 offen sc1
    v_alignbit_b32 v114, v101, v101, 16
    v_alignbit_b32 v115, v100, v100, 16
    s_waitcnt lgkmcnt(5)
    v_alignbit_b32 v108, v71, v70, 16
    v_alignbit_b32 v109, v72, v71, 16
    v_alignbit_b32 v110, v73, v72, 16
    v_alignbit_b32 v111, v74, v73, 16
    v_alignbit_b32 v112, v75, v74, 16
    v_dot2_f32_bf16 v124, v70, v114, 0
    v_dot2_f32_bf16 v125, v108, v114, 0
    v_dot2_f32_bf16 v126, v71, v114, 0
    v_dot2_f32_bf16 v127, v109, v114, 0
    v_dot2_f32_bf16 v128, v72, v114, 0
    v_dot2_f32_bf16 v129, v110, v114, 0
    v_dot2_f32_bf16 v130, v73, v114, 0
    v_dot2_f32_bf16 v131, v111, v114, 0
    v_dot2_f32_bf16 v124, v71, v115, v124
    v_dot2_f32_bf16 v125, v109, v115, v125
    v_dot2_f32_bf16 v126, v72, v115, v126
    v_dot2_f32_bf16 v127, v110, v115, v127
    v_dot2_f32_bf16 v128, v73, v115, v128
    v_dot2_f32_bf16 v129, v111, v115, v129
    v_dot2_f32_bf16 v130, v74, v115, v130
    v_dot2_f32_bf16 v131, v112, v115, v131
    v_and_b32 v133, 0xffff0000, v76
    v_lshlrev_b32 v132, 16, v76
    v_and_b32 v135, 0xffff0000, v77
    v_lshlrev_b32 v134, 16, v77
    v_and_b32 v137, 0xffff0000, v78
    v_lshlrev_b32 v136, 16, v78
    v_and_b32 v139, 0xffff0000, v79
    v_lshlrev_b32 v138, 16, v79
    v_pk_mul_f32 v[124:125], v[124:125], v[132:133]
    v_pk_mul_f32 v[126:127], v[126:127], v[134:135]
    v_pk_mul_f32 v[128:129], v[128:129], v[136:137]
    v_pk_mul_f32 v[130:131], v[130:131], v[138:139]
    v_cvt_pk_bf16_f32 v164, v131, v130
    v_cvt_pk_bf16_f32 v165, v129, v128
    v_cvt_pk_bf16_f32 v166, v127, v126
    v_cvt_pk_bf16_f32 v167, v125, v124
    buffer_store_dwordx4 v[164:167], v94, s[44:47], s7 offen sc1
    v_alignbit_b32 v114, v103, v103, 16
    v_alignbit_b32 v115, v102, v102, 16
    s_waitcnt lgkmcnt(0)
    v_alignbit_b32 v108, v81, v80, 16
    v_alignbit_b32 v109, v82, v81, 16
    v_alignbit_b32 v110, v83, v82, 16
    v_alignbit_b32 v111, v84, v83, 16
    v_alignbit_b32 v112, v85, v84, 16
    v_dot2_f32_bf16 v116, v80, v114, 0
    v_dot2_f32_bf16 v117, v108, v114, 0
    v_dot2_f32_bf16 v118, v81, v114, 0
    v_dot2_f32_bf16 v119, v109, v114, 0
    v_dot2_f32_bf16 v120, v82, v114, 0
    v_dot2_f32_bf16 v121, v110, v114, 0
    v_dot2_f32_bf16 v122, v83, v114, 0
    v_dot2_f32_bf16 v123, v111, v114, 0
    v_dot2_f32_bf16 v116, v81, v115, v116
    v_dot2_f32_bf16 v117, v109, v115, v117
    v_dot2_f32_bf16 v118, v82, v115, v118
    v_dot2_f32_bf16 v119, v110, v115, v119
    v_dot2_f32_bf16 v120, v83, v115, v120
    v_dot2_f32_bf16 v121, v111, v115, v121
    v_dot2_f32_bf16 v122, v84, v115, v122
    v_dot2_f32_bf16 v123, v112, v115, v123
    v_and_b32 v133, 0xffff0000, v86
    v_lshlrev_b32 v132, 16, v86
    v_and_b32 v135, 0xffff0000, v87
    v_lshlrev_b32 v134, 16, v87
    v_and_b32 v137, 0xffff0000, v88
    v_lshlrev_b32 v136, 16, v88
    v_and_b32 v139, 0xffff0000, v89
    v_lshlrev_b32 v138, 16, v89
    v_pk_mul_f32 v[116:117], v[116:117], v[132:133]
    v_pk_mul_f32 v[118:119], v[118:119], v[134:135]
    v_pk_mul_f32 v[120:121], v[120:121], v[136:137]
    v_pk_mul_f32 v[122:123], v[122:123], v[138:139]
    v_cvt_pk_bf16_f32 v168, v123, v122
    v_cvt_pk_bf16_f32 v169, v121, v120
    v_cvt_pk_bf16_f32 v170, v119, v118
    v_cvt_pk_bf16_f32 v171, v117, v116
    buffer_store_dwordx4 v[168:171], v95, s[44:47], s8 offen sc1
    s_add_u32 m0, s74, 32
    s_add_u32 s13, s12, 0
    buffer_load_dwordx4 v240, s[48:51], s13 offen offset:0 lds
    buffer_load_dwordx4 v240, s[48:51], s13 offen offset:1024 lds
    buffer_load_dwordx4 v240, s[48:51], s13 offen offset:2048 lds
    buffer_load_dwordx4 v240, s[48:51], s13 offen offset:3072 lds
    s_mov_b64 exec, 0
    s_call_b64 s[82:83], L_wc_X
    s_mov_b64 exec, -1
    s_waitcnt vmcnt(7)
    v_readfirstlane_b32 s68, v45
    s_nop 1
    s_cmp_eq_u32 s68, 0
    s_cbranch_scc1 L_nw_X
L_ng_X:
    s_barrier
    v_mov_b32 v3, s68
    buffer_store_dword v3, v1, s[44:47], 0 offen sc1
    s_waitcnt vmcnt(5)
    s_barrier
    buffer_store_dword v3, v46, s[44:47], 0 offen sc1
L_segX:
L_pl_X_0:
    s_cbranch_execz L_pl_X_4
    s_cmp_lt_u32 s75, 252
    s_cbranch_scc0 L_idle
    s_mov_b32 s56, s26
    s_and_b32 s57, s27, 0xffff
    s_mov_b32 s58, 1152
    s_mov_b32 s59, 0x20000
    v_mov_b32 v9, 0
    buffer_load_ushort v9, v9, s[56:59], s70 offen
    s_lshr_b32 s4, s2, 1
    s_and_b32 s4, s4, 3
    s_lshl2_add_u32 s4, s4, s3
    s_lshl_b32 s4, s4, 8
    s_add_u32 s4, s4, 12599296
    v_lshl_add_u32 v28, v2, 2, s4
    v_add_u32 v241, s74, v240
    v_cmp_eq_u32 vcc, 0, v2
    v_mov_b32 v196, 4136
    s_nop 0
    v_cndmask_b32 v196, v196, 30, vcc
    v_add_u32 v242, s74, v196
    v_bfe_u32 v196, v2, 3, 2
    v_mul_u32_u24 v196, 4160, v196
    v_and_b32 v197, 7, v2
    v_lshl_add_u32 v196, v197, 2, v196
    v_add_u32 v200, s74, v196
    v_mov_b32 v196, 0
    v_mov_b32 v197, 0
    v_mov_b32 v198, 0
    v_mov_b32 v199, 0
    ds_write_b32 v200, v196
    v_lshlrev_b32 v201, 4, v0
    ds_write_b128 v201, v[196:199]
    ds_write_b128 v201, v[196:199] offset:36864
    s_waitcnt vmcnt(3)
    ds_read_b128 v[212:215], v241 offset:32
    ds_read_b32 v216, v241 offset:48
    ds_read_b128 v[218:221], v241 offset:1056
    ds_read_b32 v222, v241 offset:1072
    ds_read_b128 v[224:227], v241 offset:2080
    ds_read_b32 v228, v241 offset:2096
    ds_read_b128 v[230:233], v241 offset:3104
    ds_read_b32 v234, v241 offset:3120
    v_lshrrev_b32 v202, 3, v2
    v_and_b32 v203, 7, v2
    v_lshrrev_b32 v204, 1, v202
    v_xor_b32 v203, v203, v204
    v_mul_u32_u24 v202, 11264, v202
    v_lshl_add_u32 v15, v203, 4, v202
    v_xor_b32 v16, 64, v15
    v_and_b32 v202, 15, v2
    v_add_u32 v202, 1, v202
    v_and_b32 v203, 1, v202
    v_mul_u32_u24 v203, 4160, v203
    v_lshrrev_b32 v202, 1, v202
    v_lshl_add_u32 v203, v202, 2, v203
    v_lshrrev_b32 v204, 4, v2
    v_lshl_add_u32 v203, v204, 4, v203
    v_add_u32 v236, s74, v203
    v_add_u32 v237, 1024, v236
    v_add_u32 v238, 1024, v237
    v_add_u32 v239, 1024, v238
    s_waitcnt lgkmcnt(0)
    s_waitcnt vmcnt(0)
    v_lshlrev_b32 v9, 16, v9
    v_lshlrev_b32 v208, 16, v212
    v_add_f32 v9, v9, v208
    v_cvt_pk_bf16_f32 v9, v9, v9
    ds_write_b16 v242, v9 offset:4160
    ds_write_b16 v242, v9 offset:2
    v_alignbit_b32 v212, v213, v212, 16
    v_alignbit_b32 v213, v214, v213, 16
    v_alignbit_b32 v214, v215, v214, 16
    v_alignbit_b32 v215, v216, v215, 16
    ds_write_b128 v241, v[212:215] offset:4192
    v_alignbit_b32 v218, v219, v218, 16
    v_alignbit_b32 v219, v220, v219, 16
    v_alignbit_b32 v220, v221, v220, 16
    v_alignbit_b32 v221, v222, v221, 16
    ds_write_b128 v241, v[218:221] offset:5216
    v_alignbit_b32 v224, v225, v224, 16
    v_alignbit_b32 v225, v226, v225, 16
    v_alignbit_b32 v226, v227, v226, 16
    v_alignbit_b32 v227, v228, v227, 16
    ds_write_b128 v241, v[224:227] offset:6240
    v_alignbit_b32 v230, v231, v230, 16
    v_alignbit_b32 v231, v232, v231, 16
    v_alignbit_b32 v232, v233, v232, 16
    v_alignbit_b32 v233, v234, v233, 16
    ds_write_b128 v241, v[230:233] offset:7264
    v_and_b32 v202, 15, v2
    v_lshlrev_b32 v202, 1, v202
    v_sub_u32 v202, v202, v204
    v_add_u32 v202, 17, v202
    v_bfe_u32 v203, v202, 1, 3
    v_xor_b32 v203, s3, v203
    v_lshlrev_b32 v203, 4, v203
    v_lshl_add_u32 v244, v202, 7, v203
    v_and_b32 v202, 15, v2
    v_lshlrev_b32 v202, 1, v202
    v_sub_u32 v202, v202, v204
    v_add_u32 v202, 13, v202
    v_bfe_u32 v203, v202, 1, 3
    v_xor_b32 v203, s3, v203
    v_lshlrev_b32 v203, 4, v203
    v_lshl_add_u32 v245, v202, 7, v203
    v_and_b32 v202, 15, v2
    v_lshlrev_b32 v202, 1, v202
    v_sub_u32 v202, v202, v204
    v_add_u32 v202, 9, v202
    v_bfe_u32 v203, v202, 1, 3
    v_xor_b32 v203, s3, v203
    v_lshlrev_b32 v203, 4, v203
    v_lshl_add_u32 v246, v202, 7, v203
    v_and_b32 v202, 15, v2
    v_lshlrev_b32 v202, 1, v202
    v_sub_u32 v202, v202, v204
    v_add_u32 v202, 5, v202
    v_bfe_u32 v203, v202, 1, 3
    v_xor_b32 v203, s3, v203
    v_lshlrev_b32 v203, 4, v203
    v_lshl_add_u32 v247, v202, 7, v203
    v_and_b32 v202, 15, v2
    v_lshlrev_b32 v202, 5, v202
    v_lshl_add_u32 v8, v204, 3, v202
    s_mul_i32 s7, s3, 589824
    s_lshl_b32 s8, s69, 8
    s_add_u32 s7, s7, s8
    s_add_u32 s10, s7, 2359296
    s_lshl_b32 s9, s3, 13
    s_add_u32 s9, s9, 4096
    s_lshl1_add_u32 s4, s69, 0
    s_mul_i32 s5, s4, 9363
    s_lshr_b32 s5, s5, 16
    s_mul_i32 s7, s5, 7
    s_sub_u32 s7, s4, s7
    s_cmp_gt_u32 s7, 2
    s_addc_u32 s4, s4, s5
    s_lshl_b32 s4, s4, 7
    s_mul_i32 s7, s3, 720896
    s_add_u32 s4, s4, s7
    s_add_u32 s10, s4, 39469056
    s_lshl1_add_u32 s4, s69, 1
    s_mul_i32 s5, s4, 9363
    s_lshr_b32 s5, s5, 16
    s_mul_i32 s7, s5, 7
    s_sub_u32 s7, s4, s7
    s_cmp_gt_u32 s7, 2
    s_addc_u32 s4, s4, s5
    s_lshl_b32 s4, s4, 7
    s_mul_i32 s7, s3, 720896
    s_add_u32 s4, s4, s7
    s_add_u32 s11, s4, 39469056
    ds_read2_b32 v[64:65], v236 offset0:0 offset1:1
    ds_read2_b32 v[66:67], v236 offset0:2 offset1:3
    ds_read2_b32 v[68:69], v236 offset0:128 offset1:129
    ds_read2_b32 v[70:71], v236 offset0:130 offset1:131
    ds_read2_b32 v[72:73], v237 offset0:0 offset1:1
    ds_read2_b32 v[74:75], v237 offset0:2 offset1:3
    ds_read2_b32 v[76:77], v237 offset0:128 offset1:129
    ds_read2_b32 v[78:79], v237 offset0:130 offset1:131
    ds_read2_b32 v[80:81], v238 offset0:0 offset1:1
    ds_read2_b32 v[82:83], v238 offset0:2 offset1:3
    ds_read2_b32 v[84:85], v238 offset0:128 offset1:129
    ds_read2_b32 v[86:87], v238 offset0:130 offset1:131
    ds_read2_b32 v[88:89], v239 offset0:0 offset1:1
    ds_read2_b32 v[90:91], v239 offset0:2 offset1:3
    ds_read2_b32 v[92:93], v239 offset0:128 offset1:129
    ds_read2_b32 v[94:95], v239 offset0:130 offset1:131
    v_mov_b32 v29, 0
    buffer_atomic_add v29, v28, s[44:47], 0 offen sc0 sc1
    s_waitcnt vmcnt(0)
    v_cmp_ne_u32 vcc, s68, v29
    s_cbranch_vccnz L_rs_p1X
L_ok_p1X:
    s_add_u32 m0, s9, 0
    s_add_u32 s13, s10, 0
    buffer_load_dwordx4 v15, s[44:47], s13 offen sc1 lds
    s_add_u32 m0, s9, 1024
    s_add_u32 s13, s10, 90112
    buffer_load_dwordx4 v16, s[44:47], s13 offen sc1 lds
    s_add_u32 m0, s9, 2048
    s_add_u32 s13, s10, 180224
    buffer_load_dwordx4 v15, s[44:47], s13 offen sc1 lds
    s_add_u32 m0, s9, 3072
    s_add_u32 s13, s10, 270336
    buffer_load_dwordx4 v16, s[44:47], s13 offen sc1 lds
    s_add_u32 m0, s9, 4096
    s_add_u32 s13, s10, 360448
L_pl_X_1:
    s_cbranch_execz L_pl_X_5
    buffer_load_dwordx4 v15, s[44:47], s13 offen sc1 lds
    s_add_u32 m0, s9, 5120
    s_add_u32 s13, s10, 450560
    buffer_load_dwordx4 v16, s[44:47], s13 offen sc1 lds
    s_add_u32 m0, s9, 6144
    s_add_u32 s13, s10, 540672
    buffer_load_dwordx4 v15, s[44:47], s13 offen sc1 lds
    s_add_u32 m0, s9, 7168
    s_add_u32 s13, s10, 630784
    buffer_load_dwordx4 v16, s[44:47], s13 offen sc1 lds
    s_mov_b64 exec, 0
    s_call_b64 s[82:83], L_wc_D
    s_mov_b64 exec, -1
    s_mov_b32 s60, s36
    s_and_b32 s61, s37, 0xffff
    s_mov_b32 s62, 4096
    s_mov_b32 s63, 0x20000
    v_and_b32 v24, 15, v2
    s_lshl_b32 s7, s71, 6
    v_add_u32 v24, s7, v24
    s_and_b32 s8, s3, 1
    s_lshl_b32 s4, s8, 5
    v_add_u32 v25, s4, v24
    v_lshlrev_b32 v26, 3, v25
    v_mul_u32_u24 v25, 1152, v25
    v_bfe_u32 v31, v2, 4, 1
    v_lshl_add_u32 v25, v31, 5, v25
    v_lshrrev_b32 v31, 5, v2
    v_lshl_add_u32 v25, v31, 4, v25
    s_bfe_u32 s7, s2, 0x20003
    s_mul_i32 s7, s7, 288
    s_lshl_b32 s4, s72, 6
    s_add_u32 s4, s4, s7
    v_add_u32 v252, s4, v25
    s_xor_b32 s8, s3, s72
    s_and_b32 s4, s72, 1
    s_lshl1_add_u32 s4, s4, s8
    v_lshl_add_u32 v24, s4, 4, v24
    s_add_u32 s7, s7, 256
    s_cmp_lt_u32 s8, 2
    s_cselect_b32 s7, s7, 0x40000000
    v_lshlrev_b32 v18, 3, v24
    v_mul_u32_u24 v24, 1152, v24
    v_lshrrev_b32 v31, 4, v2
    v_lshl_add_u32 v24, v31, 3, v24
    v_add_u32 v253, s7, v24
    v_lshrrev_b32 v24, 3, v2
    v_and_b32 v25, 7, v2
    v_bfe_u32 v31, v2, 4, 2
    v_lshlrev_b32 v31, 1, v31
    v_xor_b32 v25, v25, v31
    v_lshlrev_b32 v24, 12, v24
    v_lshl_add_u32 v24, v25, 4, v24
    s_mul_i32 s7, s72, 36
    s_bitcmp1_b32 s3, 0
    s_addc_u32 s7, s7, 0
    s_lshl_b32 s7, s7, 17
    s_lshl_b32 s8, s71, 7
    s_add_u32 s7, s7, s8
    v_add_u32 v4, s7, v24
    v_add_u32 v5, 31744, v4
    v_add_u32 v6, 31744, v5
    v_add_u32 v7, 31744, v6
    v_lshrrev_b32 v24, 2, v2
    v_lshlrev_b32 v24, 7, v24
    v_and_b32 v25, 3, v2
    v_lshl_add_u32 v24, v25, 3, v24
    s_and_b32 s7, s73, 8192
    v_add_u32 v24, s7, v24
    v_bfe_u32 v31, v2, 3, 2
    s_and_b32 s7, s3, 1
    s_lshl_b32 s7, s7, 1
    v_xor_b32 v31, s7, v31
    v_lshl_add_u32 v10, v31, 5, v24
    v_xor_b32 v11, 32, v10
    v_and_b32 v24, 15, v2
    v_lshrrev_b32 v25, 4, v2
    v_mul_u32_u24 v25, 17408, v25
    v_lshl_add_u32 v24, v24, 4, v25
    s_mul_i32 s7, s72, 36
    s_and_b32 s8, s3, 1
    s_add_u32 s7, s7, s8
    s_mul_i32 s7, s7, 69632
    s_bfe_u32 s8, s2, 0x20003
    s_lshl_b32 s8, s8, 12
    s_add_u32 s7, s7, s8
    s_add_u32 s7, s7, 12795904
    v_add_u32 v23, s7, v24
    s_xor_b32 s7, s72, 0
    v_lshl_add_u32 v19, s7, 10, v23
    s_xor_b32 s7, s72, 1
    v_lshl_add_u32 v20, s7, 10, v23
    s_xor_b32 s7, s72, 2
    v_lshl_add_u32 v21, s7, 10, v23
    s_xor_b32 s7, s72, 3
    v_lshl_add_u32 v22, s7, 10, v23
    v_lshlrev_b32 v14, 4, v2
    v_add_u32 v14, 98304, v14
    v_add_u32 v1, 0x10000, v14
    s_bitcmp1_b32 s3, 1
    s_cselect_b32 s18, s85, s84
    s_mul_i32 s18, s18, 139264
    s_cselect_b32 s19, s87, s86
    s_mul_i32 s19, s19, 139264
    s_cselect_b32 s20, s89, s88
    s_mul_i32 s20, s20, 139264
    s_cselect_b32 s21, s91, s90
    s_mul_i32 s21, s21, 139264
    s_cselect_b32 s22, s93, s92
    s_mul_i32 s22, s22, 139264
    s_cselect_b32 s23, s95, s94
    s_mul_i32 s23, s23, 139264
    s_cselect_b32 s24, s97, s96
    s_mul_i32 s24, s24, 139264
    s_cselect_b32 s25, s99, s98
    s_mul_i32 s25, s25, 139264
    s_cselect_b32 s26, s101, s100
    s_mul_i32 s26, s26, 139264
    v_add_u32 v10, 131072, v10
    v_add_u32 v11, 131072, v11
    s_waitcnt vmcnt(0) lgkmcnt(0)
    s_barrier
    ds_read_b128 v[96:99], v244 offset:2048
    ds_read_b128 v[100:103], v244 offset:6144
    ds_read_b128 v[104:107], v244 offset:10240
    ds_read_b128 v[108:111], v244 offset:14336
    ds_read_b128 v[112:115], v244 offset:18432
    ds_read_b128 v[116:119], v244 offset:22528
    ds_read_b128 v[120:123], v244 offset:26624
    ds_read_b128 v[124:127], v244 offset:30720
    s_waitcnt lgkmcnt(0)
    v_mfma_f32_16x16x32_bf16 v[32:35], v[64:67], v[96:99], 0
    s_lshl_b32 s14, s84, 18
    ds_read_b128 v[160:163], v245 offset:2048
    v_mfma_f32_16x16x32_bf16 v[36:39], v[68:71], v[96:99], 0
    s_add_u32 m0, s73, 147456
    v_mfma_f32_16x16x32_bf16 v[36:39], v[64:67], v[100:103], v[36:39]
    buffer_load_dwordx4 v4, s[52:55], s14 offen offset:0 lds
    ds_read2_b32 v[128:129], v236 offset0:16 offset1:17
    v_mfma_f32_16x16x32_bf16 v[40:43], v[64:67], v[104:107], 0
    ds_read2_b32 v[130:131], v236 offset0:18 offset1:19
    v_mfma_f32_16x16x32_bf16 v[40:43], v[68:71], v[100:103], v[40:43]
    v_mfma_f32_16x16x32_bf16 v[40:43], v[72:75], v[96:99], v[40:43]
    ds_read_b128 v[164:167], v245 offset:6144
    v_mfma_f32_16x16x32_bf16 v[44:47], v[76:79], v[96:99], 0
    ds_read2_b32 v[132:133], v236 offset0:144 offset1:145
    v_mfma_f32_16x16x32_bf16 v[44:47], v[72:75], v[100:103], v[44:47]
    s_add_u32 s13, s12, 16384
    v_mfma_f32_16x16x32_bf16 v[44:47], v[68:71], v[104:107], v[44:47]
    ds_read2_b32 v[134:135], v236 offset0:146 offset1:147
    v_mfma_f32_16x16x32_bf16 v[44:47], v[64:67], v[108:111], v[44:47]
    s_add_u32 m0, s74, 8352
    ds_read_b128 v[168:171], v245 offset:10240
    v_mfma_f32_16x16x32_bf16 v[48:51], v[64:67], v[112:115], 0
    buffer_load_dwordx4 v240, s[48:51], s13 offen offset:0 lds
    ds_read2_b32 v[136:137], v237 offset0:16 offset1:17
    v_mfma_f32_16x16x32_bf16 v[48:51], v[68:71], v[108:111], v[48:51]
    v_mfma_f32_16x16x32_bf16 v[48:51], v[72:75], v[104:107], v[48:51]
    s_add_u32 m0, s73, 147456
    ds_read2_b32 v[138:139], v237 offset0:18 offset1:19
    v_mfma_f32_16x16x32_bf16 v[48:51], v[76:79], v[100:103], v[48:51]
    buffer_load_dwordx4 v5, s[52:55], s14 offen offset:1024 lds
    ds_read_b128 v[172:175], v245 offset:14336
    v_mfma_f32_16x16x32_bf16 v[48:51], v[80:83], v[96:99], v[48:51]
    v_mfma_f32_16x16x32_bf16 v[52:55], v[84:87], v[96:99], 0
    ds_read2_b32 v[140:141], v237 offset0:144 offset1:145
    v_mfma_f32_16x16x32_bf16 v[52:55], v[80:83], v[100:103], v[52:55]
    s_add_u32 m0, s74, 8352
    ds_read2_b32 v[142:143], v237 offset0:146 offset1:147
    v_mfma_f32_16x16x32_bf16 v[52:55], v[76:79], v[104:107], v[52:55]
    buffer_load_dwordx4 v240, s[48:51], s13 offen offset:1024 lds
    v_mfma_f32_16x16x32_bf16 v[52:55], v[72:75], v[108:111], v[52:55]
    ds_read_b128 v[176:179], v245 offset:18432
    v_mfma_f32_16x16x32_bf16 v[52:55], v[68:71], v[112:115], v[52:55]
    ds_read2_b32 v[144:145], v238 offset0:16 offset1:17
    v_mfma_f32_16x16x32_bf16 v[52:55], v[64:67], v[116:119], v[52:55]
    v_mfma_f32_16x16x32_bf16 v[56:59], v[64:67], v[120:123], 0
    ds_read2_b32 v[146:147], v238 offset0:18 offset1:19
    v_mfma_f32_16x16x32_bf16 v[56:59], v[68:71], v[116:119], v[56:59]
    ds_read_b128 v[180:183], v245 offset:22528
    v_mfma_f32_16x16x32_bf16 v[56:59], v[72:75], v[112:115], v[56:59]
    v_mfma_f32_16x16x32_bf16 v[56:59], v[76:79], v[108:111], v[56:59]
    s_add_u32 m0, s73, 147456
    ds_read2_b32 v[148:149], v238 offset0:144 offset1:145
    v_mfma_f32_16x16x32_bf16 v[56:59], v[80:83], v[104:107], v[56:59]
    buffer_load_dwordx4 v6, s[52:55], s14 offen offset:2048 lds
    ds_read2_b32 v[150:151], v238 offset0:146 offset1:147
    v_mfma_f32_16x16x32_bf16 v[56:59], v[84:87], v[100:103], v[56:59]
    s_add_u32 m0, s74, 8352
    ds_read_b128 v[184:187], v245 offset:26624
    v_mfma_f32_16x16x32_bf16 v[56:59], v[88:91], v[96:99], v[56:59]
    buffer_load_dwordx4 v240, s[48:51], s13 offen offset:2048 lds
    v_mfma_f32_16x16x32_bf16 v[60:63], v[92:95], v[96:99], 0
    ds_read2_b32 v[152:153], v239 offset0:16 offset1:17
    v_mfma_f32_16x16x32_bf16 v[60:63], v[88:91], v[100:103], v[60:63]
    ds_read2_b32 v[154:155], v239 offset0:18 offset1:19
    v_mfma_f32_16x16x32_bf16 v[60:63], v[84:87], v[104:107], v[60:63]
    v_mfma_f32_16x16x32_bf16 v[60:63], v[80:83], v[108:111], v[60:63]
    ds_read_b128 v[188:191], v245 offset:30720
    v_mfma_f32_16x16x32_bf16 v[60:63], v[76:79], v[112:115], v[60:63]
    s_add_u32 m0, s74, 8352
    ds_read2_b32 v[156:157], v239 offset0:144 offset1:145
    v_mfma_f32_16x16x32_bf16 v[60:63], v[72:75], v[116:119], v[60:63]
    buffer_load_dwordx4 v240, s[48:51], s13 offen offset:3072 lds
    v_mfma_f32_16x16x32_bf16 v[60:63], v[68:71], v[120:123], v[60:63]
    ds_read2_b32 v[158:159], v239 offset0:146 offset1:147
    v_mfma_f32_16x16x32_bf16 v[60:63], v[64:67], v[124:127], v[60:63]
    s_waitcnt lgkmcnt(12)
    v_mfma_f32_16x16x32_bf16 v[32:35], v[128:131], v[160:163], v[32:35]
    s_add_u32 m0, s73, 147456
    ds_read_b128 v[96:99], v246 offset:2048
    v_mfma_f32_16x16x32_bf16 v[36:39], v[132:135], v[160:163], v[36:39]
    buffer_load_dwordx4 v7, s[52:55], s14 offen offset:3072 lds
    v_mfma_f32_16x16x32_bf16 v[36:39], v[128:131], v[164:167], v[36:39]
    ds_read2_b32 v[64:65], v236 offset0:32 offset1:33
    v_mfma_f32_16x16x32_bf16 v[40:43], v[128:131], v[168:171], v[40:43]
    ds_read2_b32 v[66:67], v236 offset0:34 offset1:35
    v_mfma_f32_16x16x32_bf16 v[40:43], v[132:135], v[164:167], v[40:43]
    v_mfma_f32_16x16x32_bf16 v[40:43], v[136:139], v[160:163], v[40:43]
    ds_read_b128 v[100:103], v246 offset:6144
    v_mfma_f32_16x16x32_bf16 v[44:47], v[140:143], v[160:163], v[44:47]
    ds_read2_b32 v[68:69], v236 offset0:160 offset1:161
    v_mfma_f32_16x16x32_bf16 v[44:47], v[136:139], v[164:167], v[44:47]
    v_mfma_f32_16x16x32_bf16 v[44:47], v[132:135], v[168:171], v[44:47]
    ds_read2_b32 v[70:71], v236 offset0:162 offset1:163
    v_mfma_f32_16x16x32_bf16 v[44:47], v[128:131], v[172:175], v[44:47]
    ds_read_b128 v[104:107], v246 offset:10240
    s_waitcnt lgkmcnt(7)
    v_mfma_f32_16x16x32_bf16 v[48:51], v[128:131], v[176:179], v[48:51]
    ds_read2_b32 v[72:73], v237 offset0:32 offset1:33
    v_mfma_f32_16x16x32_bf16 v[48:51], v[132:135], v[172:175], v[48:51]
    ds_read2_b32 v[74:75], v237 offset0:34 offset1:35
    v_mfma_f32_16x16x32_bf16 v[48:51], v[136:139], v[168:171], v[48:51]
    v_mov_b32 v9, 8
    buffer_load_ushort v9, v9, s[56:59], s70 offen
    v_mfma_f32_16x16x32_bf16 v[48:51], v[140:143], v[164:167], v[48:51]
    ds_read_b128 v[108:111], v246 offset:14336
    v_mfma_f32_16x16x32_bf16 v[48:51], v[144:147], v[160:163], v[48:51]
    v_mfma_f32_16x16x32_bf16 v[52:55], v[148:151], v[160:163], v[52:55]
    ds_read2_b32 v[76:77], v237 offset0:160 offset1:161
    v_mfma_f32_16x16x32_bf16 v[52:55], v[144:147], v[164:167], v[52:55]
    ds_read2_b32 v[78:79], v237 offset0:162 offset1:163
    v_mfma_f32_16x16x32_bf16 v[52:55], v[140:143], v[168:171], v[52:55]
    v_mfma_f32_16x16x32_bf16 v[52:55], v[136:139], v[172:175], v[52:55]
    ds_read_b128 v[112:115], v246 offset:18432
    v_mfma_f32_16x16x32_bf16 v[52:55], v[132:135], v[176:179], v[52:55]
    ds_read2_b32 v[80:81], v238 offset0:32 offset1:33
    v_mfma_f32_16x16x32_bf16 v[52:55], v[128:131], v[180:183], v[52:55]
    v_mfma_f32_16x16x32_bf16 v[56:59], v[128:131], v[184:187], v[56:59]
    ds_read2_b32 v[82:83], v238 offset0:34 offset1:35
    v_mfma_f32_16x16x32_bf16 v[56:59], v[132:135], v[180:183], v[56:59]
    ds_read_b128 v[116:119], v246 offset:22528
    v_mfma_f32_16x16x32_bf16 v[56:59], v[136:139], v[176:179], v[56:59]
    v_mfma_f32_16x16x32_bf16 v[56:59], v[140:143], v[172:175], v[56:59]
    ds_read2_b32 v[84:85], v238 offset0:160 offset1:161
    v_mfma_f32_16x16x32_bf16 v[56:59], v[144:147], v[168:171], v[56:59]
    ds_read2_b32 v[86:87], v238 offset0:162 offset1:163
    v_mfma_f32_16x16x32_bf16 v[56:59], v[148:151], v[164:167], v[56:59]
    ds_read_b128 v[120:123], v246 offset:26624
    v_mfma_f32_16x16x32_bf16 v[56:59], v[152:155], v[160:163], v[56:59]
    v_mfma_f32_16x16x32_bf16 v[60:63], v[156:159], v[160:163], v[60:63]
    ds_read2_b32 v[88:89], v239 offset0:32 offset1:33
    v_mfma_f32_16x16x32_bf16 v[60:63], v[152:155], v[164:167], v[60:63]
    ds_read2_b32 v[90:91], v239 offset0:34 offset1:35
    v_mfma_f32_16x16x32_bf16 v[60:63], v[148:151], v[168:171], v[60:63]
    v_mfma_f32_16x16x32_bf16 v[60:63], v[144:147], v[172:175], v[60:63]
    ds_read_b128 v[124:127], v246 offset:30720
    v_mfma_f32_16x16x32_bf16 v[60:63], v[140:143], v[176:179], v[60:63]
    ds_read2_b32 v[92:93], v239 offset0:160 offset1:161
    v_mfma_f32_16x16x32_bf16 v[60:63], v[136:139], v[180:183], v[60:63]
    v_mfma_f32_16x16x32_bf16 v[60:63], v[132:135], v[184:187], v[60:63]
    ds_read2_b32 v[94:95], v239 offset0:162 offset1:163
    v_mfma_f32_16x16x32_bf16 v[60:63], v[128:131], v[188:191], v[60:63]
    s_waitcnt lgkmcnt(12)
    v_mfma_f32_16x16x32_bf16 v[32:35], v[64:67], v[96:99], v[32:35]
    s_lshl_b32 s14, s85, 18
    ds_read_b128 v[160:163], v247 offset:2048
    v_mfma_f32_16x16x32_bf16 v[36:39], v[68:71], v[96:99], v[36:39]
    s_add_u32 m0, s73, 49152
    v_mfma_f32_16x16x32_bf16 v[36:39], v[64:67], v[100:103], v[36:39]
    buffer_load_dwordx4 v4, s[52:55], s14 offen offset:0 lds
    ds_read2_b32 v[128:129], v236 offset0:48 offset1:49
    v_mfma_f32_16x16x32_bf16 v[40:43], v[64:67], v[104:107], v[40:43]
    ds_read2_b32 v[130:131], v236 offset0:50 offset1:51
    v_mfma_f32_16x16x32_bf16 v[40:43], v[68:71], v[100:103], v[40:43]
    v_mfma_f32_16x16x32_bf16 v[40:43], v[72:75], v[96:99], v[40:43]
    ds_read_b128 v[164:167], v247 offset:6144
    v_mfma_f32_16x16x32_bf16 v[44:47], v[76:79], v[96:99], v[44:47]
    ds_read2_b32 v[132:133], v236 offset0:176 offset1:177
    v_mfma_f32_16x16x32_bf16 v[44:47], v[72:75], v[100:103], v[44:47]
    v_mfma_f32_16x16x32_bf16 v[44:47], v[68:71], v[104:107], v[44:47]
    ds_read2_b32 v[134:135], v236 offset0:178 offset1:179
    v_mfma_f32_16x16x32_bf16 v[44:47], v[64:67], v[108:111], v[44:47]
    ds_read_b128 v[168:171], v247 offset:10240
    s_waitcnt lgkmcnt(7)
    v_mfma_f32_16x16x32_bf16 v[48:51], v[64:67], v[112:115], v[48:51]
    ds_read2_b32 v[136:137], v237 offset0:48 offset1:49
    v_mfma_f32_16x16x32_bf16 v[48:51], v[68:71], v[108:111], v[48:51]
    v_mfma_f32_16x16x32_bf16 v[48:51], v[72:75], v[104:107], v[48:51]
    s_add_u32 m0, s73, 49152
    ds_read2_b32 v[138:139], v237 offset0:50 offset1:51
    v_mfma_f32_16x16x32_bf16 v[48:51], v[76:79], v[100:103], v[48:51]
    buffer_load_dwordx4 v5, s[52:55], s14 offen offset:1024 lds
    ds_read_b128 v[172:175], v247 offset:14336
    v_mfma_f32_16x16x32_bf16 v[48:51], v[80:83], v[96:99], v[48:51]
    v_mfma_f32_16x16x32_bf16 v[52:55], v[84:87], v[96:99], v[52:55]
    ds_read2_b32 v[140:141], v237 offset0:176 offset1:177
    v_mfma_f32_16x16x32_bf16 v[52:55], v[80:83], v[100:103], v[52:55]
    ds_read2_b32 v[142:143], v237 offset0:178 offset1:179
    v_mfma_f32_16x16x32_bf16 v[52:55], v[76:79], v[104:107], v[52:55]
    v_mfma_f32_16x16x32_bf16 v[52:55], v[72:75], v[108:111], v[52:55]
    ds_read_b128 v[176:179], v247 offset:18432
    v_mfma_f32_16x16x32_bf16 v[52:55], v[68:71], v[112:115], v[52:55]
    ds_read2_b32 v[144:145], v238 offset0:48 offset1:49
    v_mfma_f32_16x16x32_bf16 v[52:55], v[64:67], v[116:119], v[52:55]
    v_mfma_f32_16x16x32_bf16 v[56:59], v[64:67], v[120:123], v[56:59]
    ds_read2_b32 v[146:147], v238 offset0:50 offset1:51
    v_mfma_f32_16x16x32_bf16 v[56:59], v[68:71], v[116:119], v[56:59]
    ds_read_b128 v[180:183], v247 offset:22528
    v_mfma_f32_16x16x32_bf16 v[56:59], v[72:75], v[112:115], v[56:59]
    v_mfma_f32_16x16x32_bf16 v[56:59], v[76:79], v[108:111], v[56:59]
    s_add_u32 m0, s73, 49152
    ds_read2_b32 v[148:149], v238 offset0:176 offset1:177
    v_mfma_f32_16x16x32_bf16 v[56:59], v[80:83], v[104:107], v[56:59]
    buffer_load_dwordx4 v6, s[52:55], s14 offen offset:2048 lds
    ds_read2_b32 v[150:151], v238 offset0:178 offset1:179
    v_mfma_f32_16x16x32_bf16 v[56:59], v[84:87], v[100:103], v[56:59]
    ds_read_b128 v[184:187], v247 offset:26624
    v_mfma_f32_16x16x32_bf16 v[56:59], v[88:91], v[96:99], v[56:59]
    v_mfma_f32_16x16x32_bf16 v[60:63], v[92:95], v[96:99], v[60:63]
    ds_read2_b32 v[152:153], v239 offset0:48 offset1:49
    v_mfma_f32_16x16x32_bf16 v[60:63], v[88:91], v[100:103], v[60:63]
    ds_read2_b32 v[154:155], v239 offset0:50 offset1:51
    v_mfma_f32_16x16x32_bf16 v[60:63], v[84:87], v[104:107], v[60:63]
    v_mfma_f32_16x16x32_bf16 v[60:63], v[80:83], v[108:111], v[60:63]
    ds_read_b128 v[188:191], v247 offset:30720
    v_mfma_f32_16x16x32_bf16 v[60:63], v[76:79], v[112:115], v[60:63]
    ds_read2_b32 v[156:157], v239 offset0:176 offset1:177
    v_mfma_f32_16x16x32_bf16 v[60:63], v[72:75], v[116:119], v[60:63]
    v_mfma_f32_16x16x32_bf16 v[60:63], v[68:71], v[120:123], v[60:63]
    ds_read2_b32 v[158:159], v239 offset0:178 offset1:179
    v_mfma_f32_16x16x32_bf16 v[60:63], v[64:67], v[124:127], v[60:63]
    s_waitcnt lgkmcnt(12)
    v_mfma_f32_16x16x32_bf16 v[32:35], v[128:131], v[160:163], v[32:35]
    s_add_u32 m0, s73, 49152
    ds_read_b128 v[96:99], v244 offset:0
    v_mfma_f32_16x16x32_bf16 v[36:39], v[132:135], v[160:163], v[36:39]
    buffer_load_dwordx4 v7, s[52:55], s14 offen offset:3072 lds
    v_mfma_f32_16x16x32_bf16 v[36:39], v[128:131], v[164:167], v[36:39]
    ds_read2_b32 v[64:65], v236 offset0:64 offset1:65
    v_mfma_f32_16x16x32_bf16 v[40:43], v[128:131], v[168:171], v[40:43]
    ds_read2_b32 v[66:67], v236 offset0:66 offset1:67
    v_mfma_f32_16x16x32_bf16 v[40:43], v[132:135], v[164:167], v[40:43]
    v_mfma_f32_16x16x32_bf16 v[40:43], v[136:139], v[160:163], v[40:43]
    ds_read_b128 v[100:103], v244 offset:4096
    v_mfma_f32_16x16x32_bf16 v[44:47], v[140:143], v[160:163], v[44:47]
    ds_read2_b32 v[68:69], v236 offset0:192 offset1:193
    v_mfma_f32_16x16x32_bf16 v[44:47], v[136:139], v[164:167], v[44:47]
    v_mfma_f32_16x16x32_bf16 v[44:47], v[132:135], v[168:171], v[44:47]
    ds_read2_b32 v[70:71], v236 offset0:194 offset1:195
    v_mfma_f32_16x16x32_bf16 v[44:47], v[128:131], v[172:175], v[44:47]
    ds_read_b128 v[104:107], v244 offset:8192
    s_waitcnt lgkmcnt(7)
    v_mfma_f32_16x16x32_bf16 v[48:51], v[128:131], v[176:179], v[48:51]
    ds_read2_b32 v[72:73], v237 offset0:64 offset1:65
    v_mfma_f32_16x16x32_bf16 v[48:51], v[132:135], v[172:175], v[48:51]
    ds_read2_b32 v[74:75], v237 offset0:66 offset1:67
    v_mfma_f32_16x16x32_bf16 v[48:51], v[136:139], v[168:171], v[48:51]
    ds_read_b128 v[108:111], v244 offset:12288
    v_mfma_f32_16x16x32_bf16 v[48:51], v[140:143], v[164:167], v[48:51]
    ds_read2_b32 v[76:77], v237 offset0:192 offset1:193
    v_mfma_f32_16x16x32_bf16 v[48:51], v[144:147], v[160:163], v[48:51]
    ds_read2_b32 v[78:79], v237 offset0:194 offset1:195
    v_mfma_f32_16x16x32_bf16 v[52:55], v[148:151], v[160:163], v[52:55]
    ds_read_b128 v[112:115], v244 offset:16384
    v_mfma_f32_16x16x32_bf16 v[52:55], v[144:147], v[164:167], v[52:55]
    ds_read2_b32 v[80:81], v238 offset0:64 offset1:65
    v_mfma_f32_16x16x32_bf16 v[52:55], v[140:143], v[168:171], v[52:55]
    ds_read2_b32 v[82:83], v238 offset0:66 offset1:67
    v_mfma_f32_16x16x32_bf16 v[52:55], v[136:139], v[172:175], v[52:55]
    ds_read_b128 v[116:119], v244 offset:20480
    v_mfma_f32_16x16x32_bf16 v[52:55], v[132:135], v[176:179], v[52:55]
    ds_read2_b32 v[84:85], v238 offset0:192 offset1:193
    v_mfma_f32_16x16x32_bf16 v[52:55], v[128:131], v[180:183], v[52:55]
    ds_read2_b32 v[86:87], v238 offset0:194 offset1:195
    v_mfma_f32_16x16x32_bf16 v[56:59], v[128:131], v[184:187], v[56:59]
    ds_read_b128 v[120:123], v244 offset:24576
    s_waitcnt vmcnt(5)
    s_barrier
    v_mfma_f32_16x16x32_bf16 v[56:59], v[132:135], v[180:183], v[56:59]
    ds_read2_b32 v[88:89], v239 offset0:64 offset1:65
    v_mfma_f32_16x16x32_bf16 v[56:59], v[136:139], v[176:179], v[56:59]
    ds_read_b64_tr_b16 a[0:1], v10 offset:16384
    v_mfma_f32_16x16x32_bf16 v[56:59], v[140:143], v[172:175], v[56:59]
    ds_read_b64_tr_b16 a[2:3], v10 offset:18432
    v_mfma_f32_16x16x32_bf16 v[56:59], v[144:147], v[168:171], v[56:59]
    ds_read_b64_tr_b16 a[8:9], v10 offset:20480
    v_mfma_f32_16x16x32_bf16 v[56:59], v[148:151], v[164:167], v[56:59]
    ds_read2_b32 v[90:91], v239 offset0:66 offset1:67
    v_mfma_f32_16x16x32_bf16 v[56:59], v[152:155], v[160:163], v[56:59]
    ds_read_b64_tr_b16 a[10:11], v10 offset:22528
    v_mfma_f32_16x16x32_bf16 v[60:63], v[156:159], v[160:163], v[60:63]
    ds_read_b64_tr_b16 a[4:5], v11 offset:16384
    v_mfma_f32_16x16x32_bf16 v[60:63], v[152:155], v[164:167], v[60:63]
    ds_read_b128 v[124:127], v244 offset:28672
    v_mfma_f32_16x16x32_bf16 v[60:63], v[148:151], v[168:171], v[60:63]
    ds_read_b64_tr_b16 a[6:7], v11 offset:18432
    v_mfma_f32_16x16x32_bf16 v[60:63], v[144:147], v[172:175], v[60:63]
    ds_read_b64_tr_b16 a[12:13], v11 offset:20480
    v_mfma_f32_16x16x32_bf16 v[60:63], v[140:143], v[176:179], v[60:63]
    ds_read2_b32 v[92:93], v239 offset0:192 offset1:193
    v_mfma_f32_16x16x32_bf16 v[60:63], v[136:139], v[180:183], v[60:63]
    ds_read_b64_tr_b16 a[14:15], v11 offset:22528
    v_mfma_f32_16x16x32_bf16 v[60:63], v[132:135], v[184:187], v[60:63]
    ds_read2_b32 v[94:95], v239 offset0:194 offset1:195
    v_mfma_f32_16x16x32_bf16 v[60:63], v[128:131], v[188:191], v[60:63]
    s_waitcnt lgkmcnt(15)
    v_mfma_f32_16x16x32_bf16 v[32:35], v[64:67], v[96:99], v[32:35]
    ds_read_b128 v[160:163], v245 offset:0
    s_waitcnt lgkmcnt(2)
    s_barrier
    v_mfma_f32_16x16x32_bf16 v[36:39], v[68:71], v[96:99], v[36:39]
    v_mfma_f32_16x16x32_bf16 v[36:39], v[64:67], v[100:103], v[36:39]
    ds_read2_b32 v[128:129], v236 offset0:80 offset1:81
    v_mfma_f32_16x16x32_bf16 v[40:43], v[64:67], v[104:107], v[40:43]
    s_lshl_b32 s14, s86, 18
    ds_read2_b32 v[130:131], v236 offset0:82 offset1:83
    v_mfma_f32_16x16x32_bf16 v[40:43], v[68:71], v[100:103], v[40:43]
    s_add_u32 m0, s73, 147456
    v_mfma_f32_16x16x32_bf16 v[40:43], v[72:75], v[96:99], v[40:43]
    buffer_load_dwordx4 v4, s[52:55], s14 offen offset:0 lds
    ds_read_b128 v[164:167], v245 offset:4096
    v_mfma_f32_16x16x32_bf16 v[44:47], v[76:79], v[96:99], v[44:47]
    ds_read2_b32 v[132:133], v236 offset0:208 offset1:209
    v_mfma_f32_16x16x32_bf16 v[44:47], v[72:75], v[100:103], v[44:47]
    v_mfma_f32_16x16x32_bf16 v[44:47], v[68:71], v[104:107], v[44:47]
    ds_read2_b32 v[134:135], v236 offset0:210 offset1:211
    v_mfma_f32_16x16x32_bf16 v[44:47], v[64:67], v[108:111], v[44:47]
    ds_read_b128 v[168:171], v245 offset:8192
    s_waitcnt lgkmcnt(7)
    v_mfma_f32_16x16x32_bf16 v[48:51], v[64:67], v[112:115], v[48:51]
    ds_read2_b32 v[136:137], v237 offset0:80 offset1:81
    v_mfma_f32_16x16x32_bf16 v[48:51], v[68:71], v[108:111], v[48:51]
    ds_read2_b32 v[138:139], v237 offset0:82 offset1:83
    v_mfma_f32_16x16x32_bf16 v[48:51], v[72:75], v[104:107], v[48:51]
    ds_read_b128 v[172:175], v245 offset:12288
    v_mfma_f32_16x16x32_bf16 v[48:51], v[76:79], v[100:103], v[48:51]
    ds_read2_b32 v[140:141], v237 offset0:208 offset1:209
    v_mfma_f32_16x16x32_bf16 v[48:51], v[80:83], v[96:99], v[48:51]
    ds_read2_b32 v[142:143], v237 offset0:210 offset1:211
    v_mfma_f32_16x16x32_bf16 v[52:55], v[84:87], v[96:99], v[52:55]
    ds_read_b128 v[176:179], v245 offset:16384
    v_mfma_f32_16x16x32_bf16 v[52:55], v[80:83], v[100:103], v[52:55]
    s_add_u32 m0, s73, 147456
    ds_read2_b32 v[144:145], v238 offset0:80 offset1:81
    v_mfma_f32_16x16x32_bf16 v[52:55], v[76:79], v[104:107], v[52:55]
    buffer_load_dwordx4 v5, s[52:55], s14 offen offset:1024 lds
    ds_read2_b32 v[146:147], v238 offset0:82 offset1:83
    v_mfma_f32_16x16x32_bf16 v[52:55], v[72:75], v[108:111], v[52:55]
    ds_read_b128 v[180:183], v245 offset:20480
    v_mfma_f32_16x16x32_bf16 v[52:55], v[68:71], v[112:115], v[52:55]
    ds_read_b128 v[212:215], v241 offset:8352
    v_mfma_f32_16x16x32_bf16 v[52:55], v[64:67], v[116:119], v[52:55]
    ds_read2_b32 v[148:149], v238 offset0:208 offset1:209
    v_mfma_f32_16x16x32_bf16 v[56:59], v[64:67], v[120:123], v[56:59]
    ds_read_b32 v216, v241 offset:8368
    v_mfma_f32_16x16x32_bf16 v[56:59], v[68:71], v[116:119], v[56:59]
    ds_read2_b32 v[150:151], v238 offset0:210 offset1:211
    v_mfma_f32_16x16x32_bf16 v[56:59], v[72:75], v[112:115], v[56:59]
    ds_read_b128 v[218:221], v241 offset:9376
    v_mfma_f32_16x16x32_bf16 v[56:59], v[76:79], v[108:111], v[56:59]
    ds_read_b128 v[184:187], v245 offset:24576
    v_mfma_f32_16x16x32_bf16 v[56:59], v[80:83], v[104:107], v[56:59]
    ds_read2_b32 v[152:153], v239 offset0:80 offset1:81
    v_mfma_f32_16x16x32_bf16 v[56:59], v[84:87], v[100:103], v[56:59]
    ds_read_b32 v222, v241 offset:9392
    v_mfma_f32_16x16x32_bf16 v[56:59], v[88:91], v[96:99], v[56:59]
    ds_read2_b32 v[154:155], v239 offset0:82 offset1:83
    v_mfma_f32_16x16x32_bf16 v[60:63], v[92:95], v[96:99], v[60:63]
    s_add_u32 m0, s73, 147456
    ds_read_b128 v[224:227], v241 offset:10400
    v_mfma_f32_16x16x32_bf16 v[60:63], v[88:91], v[100:103], v[60:63]
    buffer_load_dwordx4 v6, s[52:55], s14 offen offset:2048 lds
    ds_read_b128 v[188:191], v245 offset:28672
    v_mfma_f32_16x16x32_bf16 v[60:63], v[84:87], v[104:107], v[60:63]
    ds_read_b32 v228, v241 offset:10416
    v_mfma_f32_16x16x32_bf16 v[60:63], v[80:83], v[108:111], v[60:63]
    ds_read2_b32 v[156:157], v239 offset0:208 offset1:209
    v_mfma_f32_16x16x32_bf16 v[60:63], v[76:79], v[112:115], v[60:63]
    ds_read_b128 v[230:233], v241 offset:11424
    v_mfma_f32_16x16x32_bf16 v[60:63], v[72:75], v[116:119], v[60:63]
    ds_read2_b32 v[158:159], v239 offset0:210 offset1:211
    v_mfma_f32_16x16x32_bf16 v[60:63], v[68:71], v[120:123], v[60:63]
    ds_read_b32 v234, v241 offset:11440
    v_mfma_f32_16x16x32_bf16 v[60:63], v[64:67], v[124:127], v[60:63]
    s_waitcnt lgkmcnt(15)
    v_mfma_f32_16x16x32_bf16 v[32:35], v[128:131], v[160:163], v[32:35]
    ds_read_b128 v[96:99], v246 offset:0
    v_mfma_f32_16x16x32_bf16 v[36:39], v[132:135], v[160:163], v[36:39]
    ds_read2_b32 v[64:65], v236 offset0:96 offset1:97
    v_mfma_f32_16x16x32_bf16 v[36:39], v[128:131], v[164:167], v[36:39]
    ds_read2_b32 v[66:67], v236 offset0:98 offset1:99
    v_mfma_f32_16x16x32_bf16 v[40:43], v[128:131], v[168:171], v[40:43]
    s_add_u32 m0, s73, 147456
    ds_read_b128 v[100:103], v246 offset:4096
    v_mfma_f32_16x16x32_bf16 v[40:43], v[132:135], v[164:167], v[40:43]
    buffer_load_dwordx4 v7, s[52:55], s14 offen offset:3072 lds
    ds_read2_b32 v[68:69], v236 offset0:224 offset1:225
    s_waitcnt lgkmcnt(5)
    v_mfma_f32_16x16x32_bf16 v[40:43], v[136:139], v[160:163], v[40:43]
    ds_read2_b32 v[70:71], v236 offset0:226 offset1:227
    v_mfma_f32_16x16x32_bf16 v[44:47], v[140:143], v[160:163], v[44:47]
    s_waitcnt vmcnt(8)
    ds_read_b128 v[104:107], v246 offset:8192
    v_mfma_f32_16x16x32_bf16 v[44:47], v[136:139], v[164:167], v[44:47]
    ds_read2_b32 v[72:73], v237 offset0:96 offset1:97
    v_mfma_f32_16x16x32_bf16 v[44:47], v[132:135], v[168:171], v[44:47]
    ds_read2_b32 v[74:75], v237 offset0:98 offset1:99
    v_lshlrev_b32 v9, 16, v9
    v_mfma_f32_16x16x32_bf16 v[44:47], v[128:131], v[172:175], v[44:47]
    ds_read_b128 v[108:111], v246 offset:12288
    v_mfma_f32_16x16x32_bf16 v[48:51], v[128:131], v[176:179], v[48:51]
    ds_read2_b32 v[76:77], v237 offset0:224 offset1:225
    v_lshlrev_b32 v208, 16, v212
    v_mfma_f32_16x16x32_bf16 v[48:51], v[132:135], v[172:175], v[48:51]
    ds_read2_b32 v[78:79], v237 offset0:226 offset1:227
    v_mfma_f32_16x16x32_bf16 v[48:51], v[136:139], v[168:171], v[48:51]
    ds_read_b128 v[112:115], v246 offset:16384
    v_add_f32 v9, v9, v208
    v_mfma_f32_16x16x32_bf16 v[48:51], v[140:143], v[164:167], v[48:51]
    ds_read2_b32 v[80:81], v238 offset0:96 offset1:97
    v_cvt_pk_bf16_f32 v9, v9, v9
    v_mfma_f32_16x16x32_bf16 v[48:51], v[144:147], v[160:163], v[48:51]
    ds_read2_b32 v[82:83], v238 offset0:98 offset1:99
    v_mfma_f32_16x16x32_bf16 v[52:55], v[148:151], v[160:163], v[52:55]
    ds_write_b16 v242, v9 offset:12480
    v_mfma_f32_16x16x32_bf16 v[52:55], v[144:147], v[164:167], v[52:55]
    ds_read_b128 v[116:119], v246 offset:20480
    v_mfma_f32_16x16x32_bf16 v[52:55], v[140:143], v[168:171], v[52:55]
    ds_write_b16 v242, v9 offset:8322
    v_mfma_f32_16x16x32_bf16 v[52:55], v[136:139], v[172:175], v[52:55]
    ds_read2_b32 v[84:85], v238 offset0:224 offset1:225
    v_mfma_f32_16x16x32_bf16 v[52:55], v[132:135], v[176:179], v[52:55]
    ds_read2_b32 v[86:87], v238 offset0:226 offset1:227
    v_alignbit_b32 v212, v213, v212, 16
    v_mfma_f32_16x16x32_bf16 v[52:55], v[128:131], v[180:183], v[52:55]
    ds_read_b128 v[120:123], v246 offset:24576
    v_alignbit_b32 v213, v214, v213, 16
    v_mfma_f32_16x16x32_bf16 v[56:59], v[128:131], v[184:187], v[56:59]
    ds_read2_b32 v[88:89], v239 offset0:96 offset1:97
    s_waitcnt vmcnt(4)
    s_barrier
    v_mfma_f32_16x16x32_bf16 v[56:59], v[132:135], v[180:183], v[56:59]
    v_add_u32 v10, -131072, v10
    v_alignbit_b32 v214, v215, v214, 16
    v_mfma_f32_16x16x32_bf16 v[56:59], v[136:139], v[176:179], v[56:59]
    ds_read_b64_tr_b16 a[16:17], v10 offset:49152
    v_alignbit_b32 v215, v216, v215, 16
L_pl_X_2:
    s_cbranch_execz L_pl_X_6
    v_mfma_f32_16x16x32_bf16 v[56:59], v[140:143], v[172:175], v[56:59]
    ds_write_b128 v241, v[212:215] offset:12512
    v_mfma_f32_16x16x32_bf16 v[56:59], v[144:147], v[168:171], v[56:59]
    ds_read_b64_tr_b16 a[18:19], v10 offset:51200
    v_mfma_f32_16x16x32_bf16 v[56:59], v[148:151], v[164:167], v[56:59]
    ds_read_b64_tr_b16 a[24:25], v10 offset:53248
    v_mfma_f32_16x16x32_bf16 v[56:59], v[152:155], v[160:163], v[56:59]
    ds_read_b64_tr_b16 a[26:27], v10 offset:55296
    v_mfma_f32_16x16x32_bf16 v[60:63], v[156:159], v[160:163], v[60:63]
    ds_read2_b32 v[90:91], v239 offset0:98 offset1:99
    v_add_u32 v11, -131072, v11
    v_alignbit_b32 v218, v219, v218, 16
    v_mfma_f32_16x16x32_bf16 v[60:63], v[152:155], v[164:167], v[60:63]
    ds_read_b64_tr_b16 a[20:21], v11 offset:49152
    v_alignbit_b32 v219, v220, v219, 16
    v_mfma_f32_16x16x32_bf16 v[60:63], v[148:151], v[168:171], v[60:63]
    ds_read_b128 v[124:127], v246 offset:28672
    ds_read2_b32 v[92:93], v239 offset0:224 offset1:225
    v_mfma_f32_16x16x32_bf16 v[60:63], v[144:147], v[172:175], v[60:63]
    ds_read_b64_tr_b16 a[22:23], v11 offset:51200
    v_alignbit_b32 v220, v221, v220, 16
    v_mfma_f32_16x16x32_bf16 v[60:63], v[140:143], v[176:179], v[60:63]
    ds_read_b64_tr_b16 a[28:29], v11 offset:53248
    ds_read2_b32 v[94:95], v239 offset0:226 offset1:227
    v_mfma_f32_16x16x32_bf16 v[60:63], v[136:139], v[180:183], v[60:63]
    ds_read_b64_tr_b16 a[30:31], v11 offset:55296
    v_alignbit_b32 v221, v222, v221, 16
    v_mfma_f32_16x16x32_bf16 v[60:63], v[132:135], v[184:187], v[60:63]
    ds_write_b128 v241, v[218:221] offset:13536
    v_mfma_f32_16x16x32_bf16 v[60:63], v[128:131], v[188:191], v[60:63]
    s_waitcnt lgkmcnt(15)
    v_mfma_f32_16x16x32_bf16 v[32:35], v[64:67], v[96:99], v[32:35]
    ds_read_b128 v[160:163], v247 offset:0
    s_waitcnt lgkmcnt(2)
    s_barrier
    v_mfma_f32_16x16x32_bf16 v[36:39], v[68:71], v[96:99], v[36:39]
    v_alignbit_b32 v224, v225, v224, 16
    v_mfma_f32_16x16x32_bf16 v[36:39], v[64:67], v[100:103], v[36:39]
    ds_read_b128 v[164:167], v247 offset:4096
    v_mfma_f32_16x16x32_bf16 v[40:43], v[64:67], v[104:107], v[40:43]
    s_lshl_b32 s14, s87, 18
    ds_read_b128 v[168:171], v247 offset:8192
    v_mfma_f32_16x16x32_bf16 v[40:43], v[68:71], v[100:103], v[40:43]
    s_add_u32 m0, s73, 49152
    ds_read_b128 v[172:175], v247 offset:12288
    v_mfma_f32_16x16x32_bf16 v[40:43], v[72:75], v[96:99], v[40:43]
    buffer_load_dwordx4 v4, s[52:55], s14 offen offset:0 lds
    v_alignbit_b32 v225, v226, v225, 16
    v_mfma_f32_16x16x32_bf16 v[44:47], v[76:79], v[96:99], v[44:47]
    ds_read_b128 v[176:179], v247 offset:16384
    v_mfma_f32_16x16x32_bf16 v[44:47], v[72:75], v[100:103], v[44:47]
    ds_read_b128 v[180:183], v247 offset:20480
    v_mfma_f32_16x16x32_bf16 v[44:47], v[68:71], v[104:107], v[44:47]
    ds_read_b128 v[184:187], v247 offset:24576
    v_mfma_f32_16x16x32_bf16 v[44:47], v[64:67], v[108:111], v[44:47]
    v_alignbit_b32 v226, v227, v226, 16
    v_mfma_f32_16x16x32_bf16 v[48:51], v[64:67], v[112:115], v[48:51]
    ds_read_b128 v[188:191], v247 offset:28672
    v_mfma_f32_16x16x32_bf16 v[48:51], v[68:71], v[108:111], v[48:51]
    ds_read2_b32 v[128:129], v236 offset0:112 offset1:113
    v_mfma_f32_16x16x32_bf16 v[48:51], v[72:75], v[104:107], v[48:51]
    v_alignbit_b32 v227, v228, v227, 16
    v_mfma_f32_16x16x32_bf16 v[48:51], v[76:79], v[100:103], v[48:51]
    ds_read2_b32 v[130:131], v236 offset0:114 offset1:115
    v_mfma_f32_16x16x32_bf16 v[48:51], v[80:83], v[96:99], v[48:51]
    ds_read2_b32 v[132:133], v236 offset0:240 offset1:241
    v_mfma_f32_16x16x32_bf16 v[52:55], v[84:87], v[96:99], v[52:55]
    ds_write_b128 v241, v[224:227] offset:14560
    v_mfma_f32_16x16x32_bf16 v[52:55], v[80:83], v[100:103], v[52:55]
    s_add_u32 m0, s73, 49152
    ds_read2_b32 v[134:135], v236 offset0:242 offset1:243
    v_mfma_f32_16x16x32_bf16 v[52:55], v[76:79], v[104:107], v[52:55]
    buffer_load_dwordx4 v5, s[52:55], s14 offen offset:1024 lds
    ds_read2_b32 v[136:137], v237 offset0:112 offset1:113
    v_mfma_f32_16x16x32_bf16 v[52:55], v[72:75], v[108:111], v[52:55]
    s_add_u32 s6, s12, 4718592
    ds_read2_b32 v[138:139], v237 offset0:114 offset1:115
    v_mfma_f32_16x16x32_bf16 v[52:55], v[68:71], v[112:115], v[52:55]
    ds_read2_b32 v[140:141], v237 offset0:240 offset1:241
    v_alignbit_b32 v230, v231, v230, 16
    v_mfma_f32_16x16x32_bf16 v[52:55], v[64:67], v[116:119], v[52:55]
    ds_read2_b32 v[142:143], v237 offset0:242 offset1:243
    v_xor_b32 v244, 64, v244
    v_mfma_f32_16x16x32_bf16 v[56:59], v[64:67], v[120:123], v[56:59]
    ds_read2_b32 v[144:145], v238 offset0:112 offset1:113
    v_mfma_f32_16x16x32_bf16 v[56:59], v[68:71], v[116:119], v[56:59]
    ds_read2_b32 v[146:147], v238 offset0:114 offset1:115
    v_mfma_f32_16x16x32_bf16 v[56:59], v[72:75], v[112:115], v[56:59]
    ds_read2_b32 v[148:149], v238 offset0:240 offset1:241
    v_alignbit_b32 v231, v232, v231, 16
    v_mfma_f32_16x16x32_bf16 v[56:59], v[76:79], v[108:111], v[56:59]
    ds_read2_b32 v[150:151], v238 offset0:242 offset1:243
    v_xor_b32 v245, 64, v245
    v_mfma_f32_16x16x32_bf16 v[56:59], v[80:83], v[104:107], v[56:59]
    ds_read2_b32 v[152:153], v239 offset0:112 offset1:113
    v_mfma_f32_16x16x32_bf16 v[56:59], v[84:87], v[100:103], v[56:59]
    ds_read2_b32 v[154:155], v239 offset0:114 offset1:115
    v_mfma_f32_16x16x32_bf16 v[56:59], v[88:91], v[96:99], v[56:59]
    ds_read2_b32 v[156:157], v239 offset0:240 offset1:241
    v_alignbit_b32 v232, v233, v232, 16
    v_mfma_f32_16x16x32_bf16 v[60:63], v[92:95], v[96:99], v[60:63]
    s_add_u32 m0, s73, 49152
    ds_read2_b32 v[158:159], v239 offset0:242 offset1:243
    v_mfma_f32_16x16x32_bf16 v[60:63], v[88:91], v[100:103], v[60:63]
    buffer_load_dwordx4 v6, s[52:55], s14 offen offset:2048 lds
    v_xor_b32 v246, 64, v246
    v_mfma_f32_16x16x32_bf16 v[60:63], v[84:87], v[104:107], v[60:63]
    v_alignbit_b32 v233, v234, v233, 16
    v_add_u32 v236, 8320, v236
    v_mfma_f32_16x16x32_bf16 v[60:63], v[80:83], v[108:111], v[60:63]
    v_add_u32 v237, 8320, v237
    v_mfma_f32_16x16x32_bf16 v[60:63], v[76:79], v[112:115], v[60:63]
    v_mfma_f32_16x16x32_bf16 v[60:63], v[72:75], v[116:119], v[60:63]
    v_xor_b32 v247, 64, v247
    v_add_u32 v238, 8320, v238
    v_mfma_f32_16x16x32_bf16 v[60:63], v[68:71], v[120:123], v[60:63]
    ds_write_b128 v241, v[230:233] offset:15584
    v_mfma_f32_16x16x32_bf16 v[60:63], v[64:67], v[124:127], v[60:63]
    v_add_u32 v239, 8320, v239
    s_waitcnt lgkmcnt(1)
    v_mfma_f32_16x16x32_bf16 v[60:63], v[128:131], v[188:191], v[60:63]
    ds_read_b128 v[96:99], v244 offset:2048
    v_mfma_f32_16x16x32_bf16 v[60:63], v[132:135], v[184:187], v[60:63]
    ds_read2_b32 v[64:65], v236 offset0:0 offset1:1
    v_mfma_f32_16x16x32_bf16 v[60:63], v[136:139], v[180:183], v[60:63]
    ds_read2_b32 v[66:67], v236 offset0:2 offset1:3
    v_mfma_f32_16x16x32_bf16 v[60:63], v[140:143], v[176:179], v[60:63]
    s_add_u32 m0, s73, 49152
    ds_read_b128 v[100:103], v244 offset:6144
    v_mfma_f32_16x16x32_bf16 v[60:63], v[144:147], v[172:175], v[60:63]
    buffer_load_dwordx4 v7, s[52:55], s14 offen offset:3072 lds
    ds_read2_b32 v[68:69], v236 offset0:128 offset1:129
    v_mfma_f32_16x16x32_bf16 v[60:63], v[148:151], v[168:171], v[60:63]
    ds_read2_b32 v[70:71], v236 offset0:130 offset1:131
    v_mfma_f32_16x16x32_bf16 v[60:63], v[152:155], v[164:167], v[60:63]
    ds_read_b128 v[104:107], v244 offset:10240
    v_mfma_f32_16x16x32_bf16 v[60:63], v[156:159], v[160:163], v[60:63]
    ds_read2_b32 v[72:73], v237 offset0:0 offset1:1
    v_mfma_f32_16x16x32_bf16 v[56:59], v[128:131], v[184:187], v[56:59]
    ds_read2_b32 v[74:75], v237 offset0:2 offset1:3
    v_mfma_f32_16x16x32_bf16 v[56:59], v[132:135], v[180:183], v[56:59]
    ds_read_b128 v[108:111], v244 offset:14336
    v_mfma_f32_16x16x32_bf16 v[56:59], v[136:139], v[176:179], v[56:59]
    ds_read2_b32 v[76:77], v237 offset0:128 offset1:129
    v_mfma_f32_16x16x32_bf16 v[56:59], v[140:143], v[172:175], v[56:59]
    ds_read2_b32 v[78:79], v237 offset0:130 offset1:131
    v_mfma_f32_16x16x32_bf16 v[56:59], v[144:147], v[168:171], v[56:59]
    ds_read_b128 v[112:115], v244 offset:18432
    v_mfma_f32_16x16x32_bf16 v[56:59], v[148:151], v[164:167], v[56:59]
    ds_read2_b32 v[80:81], v238 offset0:0 offset1:1
    v_cvt_pk_bf16_f32 v206, v60, v61
    v_mfma_f32_16x16x32_bf16 v[56:59], v[152:155], v[160:163], v[56:59]
    ds_read2_b32 v[82:83], v238 offset0:2 offset1:3
    v_mfma_f32_16x16x32_bf16 v[52:55], v[128:131], v[180:183], v[52:55]
    ds_read_b128 v[116:119], v244 offset:22528
    v_mfma_f32_16x16x32_bf16 v[52:55], v[132:135], v[176:179], v[52:55]
    ds_read2_b32 v[84:85], v238 offset0:128 offset1:129
    v_cvt_pk_bf16_f32 v207, v62, v63
    v_mfma_f32_16x16x32_bf16 v[52:55], v[136:139], v[172:175], v[52:55]
    ds_read2_b32 v[86:87], v238 offset0:130 offset1:131
    v_mfma_f32_16x16x32_bf16 v[52:55], v[140:143], v[168:171], v[52:55]
    buffer_store_dwordx2 v[206:207], v8, s[44:47], s6 offen offset:3584 sc1
    ds_read_b128 v[120:123], v244 offset:26624
    v_mfma_f32_16x16x32_bf16 v[52:55], v[144:147], v[164:167], v[52:55]
    ds_read2_b32 v[88:89], v239 offset0:0 offset1:1
    v_mfma_f32_16x16x32_bf16 v[52:55], v[148:151], v[160:163], v[52:55]
    ds_read2_b32 v[90:91], v239 offset0:2 offset1:3
    v_mfma_f32_16x16x32_bf16 v[48:51], v[128:131], v[176:179], v[48:51]
    s_waitcnt vmcnt(5)
    s_barrier
    v_cvt_pk_bf16_f32 v204, v56, v57
    v_mfma_f32_16x16x32_bf16 v[48:51], v[132:135], v[172:175], v[48:51]
    ds_read_b128 v[124:127], v244 offset:30720
    v_add_u32 v10, 131072, v10
    v_mfma_f32_16x16x32_bf16 v[48:51], v[136:139], v[168:171], v[48:51]
    ds_read_b64_tr_b16 a[32:33], v10 offset:16384
    v_mfma_f32_16x16x32_bf16 v[48:51], v[140:143], v[164:167], v[48:51]
    ds_read2_b32 v[92:93], v239 offset0:128 offset1:129
    v_cvt_pk_bf16_f32 v205, v58, v59
    v_mfma_f32_16x16x32_bf16 v[48:51], v[144:147], v[160:163], v[48:51]
    ds_read_b64_tr_b16 a[34:35], v10 offset:18432
    v_mfma_f32_16x16x32_bf16 v[44:47], v[128:131], v[172:175], v[44:47]
    buffer_store_dwordx2 v[204:205], v8, s[44:47], s6 offen offset:3072 sc1
    ds_read_b64_tr_b16 a[40:41], v10 offset:20480
    v_mfma_f32_16x16x32_bf16 v[44:47], v[132:135], v[168:171], v[44:47]
    ds_read_b64_tr_b16 a[42:43], v10 offset:22528
    v_mfma_f32_16x16x32_bf16 v[44:47], v[136:139], v[164:167], v[44:47]
    ds_read2_b32 v[94:95], v239 offset0:130 offset1:131
    v_add_u32 v11, 131072, v11
    v_mfma_f32_16x16x32_bf16 v[44:47], v[140:143], v[160:163], v[44:47]
    ds_read_b64_tr_b16 a[36:37], v11 offset:16384
    v_cvt_pk_bf16_f32 v202, v52, v53
    v_mfma_f32_16x16x32_bf16 v[40:43], v[128:131], v[168:171], v[40:43]
    v_mfma_f32_16x16x32_bf16 v[40:43], v[132:135], v[164:167], v[40:43]
    ds_read_b64_tr_b16 a[38:39], v11 offset:18432
    v_mfma_f32_16x16x32_bf16 v[40:43], v[136:139], v[160:163], v[40:43]
    ds_read_b64_tr_b16 a[44:45], v11 offset:20480
    v_cvt_pk_bf16_f32 v203, v54, v55
    v_mfma_f32_16x16x32_bf16 v[36:39], v[128:131], v[164:167], v[36:39]
    ds_read_b64_tr_b16 a[46:47], v11 offset:22528
    v_mfma_f32_16x16x32_bf16 v[36:39], v[132:135], v[160:163], v[36:39]
    buffer_store_dwordx2 v[202:203], v8, s[44:47], s6 offen offset:2560 sc1
    v_mfma_f32_16x16x32_bf16 v[32:35], v[128:131], v[160:163], v[32:35]
    s_waitcnt lgkmcnt(4)
    v_mfma_f32_16x16x32_bf16 v[60:63], v[64:67], v[124:127], 0
    ds_read_b128 v[160:163], v245 offset:2048
    s_waitcnt lgkmcnt(1)
    s_barrier
    v_mfma_f32_16x16x32_bf16 v[60:63], v[68:71], v[120:123], v[60:63]
    v_cvt_pk_bf16_f32 v200, v48, v49
    v_mfma_f32_16x16x32_bf16 v[60:63], v[72:75], v[116:119], v[60:63]
    ds_read2_b32 v[128:129], v236 offset0:16 offset1:17
    v_mfma_f32_16x16x32_bf16 v[60:63], v[76:79], v[112:115], v[60:63]
    ds_read2_b32 v[130:131], v236 offset0:18 offset1:19
    s_lshl_b32 s14, s88, 18
    v_cvt_pk_bf16_f32 v201, v50, v51
    v_mfma_f32_16x16x32_bf16 v[60:63], v[80:83], v[108:111], v[60:63]
    s_add_u32 m0, s73, 147456
    v_mfma_f32_16x16x32_bf16 v[60:63], v[84:87], v[104:107], v[60:63]
    buffer_load_dwordx4 v4, s[52:55], s14 offen offset:0 lds
    ds_read_b128 v[164:167], v245 offset:6144
    v_mfma_f32_16x16x32_bf16 v[60:63], v[88:91], v[100:103], v[60:63]
    buffer_store_dwordx2 v[200:201], v8, s[44:47], s6 offen offset:2048 sc1
    ds_read2_b32 v[132:133], v236 offset0:144 offset1:145
    v_mfma_f32_16x16x32_bf16 v[60:63], v[92:95], v[96:99], v[60:63]
    s_add_u32 s13, s12, 32768
    v_cvt_pk_bf16_f32 v198, v44, v45
    v_mfma_f32_16x16x32_bf16 v[56:59], v[64:67], v[120:123], 0
    ds_read2_b32 v[134:135], v236 offset0:146 offset1:147
    v_mfma_f32_16x16x32_bf16 v[56:59], v[68:71], v[116:119], v[56:59]
    s_add_u32 m0, s74, 32
    ds_read_b128 v[168:171], v245 offset:10240
    v_mfma_f32_16x16x32_bf16 v[56:59], v[72:75], v[112:115], v[56:59]
    buffer_load_dwordx4 v240, s[48:51], s13 offen offset:0 lds
    v_cvt_pk_bf16_f32 v199, v46, v47
    v_mfma_f32_16x16x32_bf16 v[56:59], v[76:79], v[108:111], v[56:59]
    ds_read2_b32 v[136:137], v237 offset0:16 offset1:17
    v_mfma_f32_16x16x32_bf16 v[56:59], v[80:83], v[104:107], v[56:59]
    buffer_store_dwordx2 v[198:199], v8, s[44:47], s6 offen offset:1536 sc1
    ds_read2_b32 v[138:139], v237 offset0:18 offset1:19
    v_mfma_f32_16x16x32_bf16 v[56:59], v[84:87], v[100:103], v[56:59]
    ds_read_b128 v[172:175], v245 offset:14336
    v_mfma_f32_16x16x32_bf16 v[56:59], v[88:91], v[96:99], v[56:59]
    v_cvt_pk_bf16_f32 v196, v40, v41
    v_mfma_f32_16x16x32_bf16 v[52:55], v[64:67], v[116:119], 0
    ds_read2_b32 v[140:141], v237 offset0:144 offset1:145
    v_mfma_f32_16x16x32_bf16 v[52:55], v[68:71], v[112:115], v[52:55]
    ds_read2_b32 v[142:143], v237 offset0:146 offset1:147
    s_add_u32 m0, s73, 147456
    v_cvt_pk_bf16_f32 v197, v42, v43
    v_mfma_f32_16x16x32_bf16 v[52:55], v[72:75], v[108:111], v[52:55]
    buffer_load_dwordx4 v5, s[52:55], s14 offen offset:1024 lds
    v_mfma_f32_16x16x32_bf16 v[52:55], v[76:79], v[104:107], v[52:55]
    buffer_store_dwordx2 v[196:197], v8, s[44:47], s6 offen offset:1024 sc1
    ds_read_b128 v[176:179], v245 offset:18432
    s_add_u32 m0, s74, 32
    v_mfma_f32_16x16x32_bf16 v[52:55], v[80:83], v[100:103], v[52:55]
    buffer_load_dwordx4 v240, s[48:51], s13 offen offset:1024 lds
    ds_read2_b32 v[144:145], v238 offset0:16 offset1:17
    v_mfma_f32_16x16x32_bf16 v[52:55], v[84:87], v[96:99], v[52:55]
    v_mfma_f32_16x16x32_bf16 v[48:51], v[64:67], v[112:115], 0
    ds_read2_b32 v[146:147], v238 offset0:18 offset1:19
    v_cvt_pk_bf16_f32 v194, v36, v37
    v_mfma_f32_16x16x32_bf16 v[48:51], v[68:71], v[108:111], v[48:51]
    ds_read_b128 v[180:183], v245 offset:22528
    v_mfma_f32_16x16x32_bf16 v[48:51], v[72:75], v[104:107], v[48:51]
    v_cvt_pk_bf16_f32 v195, v38, v39
    v_mfma_f32_16x16x32_bf16 v[48:51], v[76:79], v[100:103], v[48:51]
    buffer_store_dwordx2 v[194:195], v8, s[44:47], s6 offen offset:512 sc1
    ds_read2_b32 v[148:149], v238 offset0:144 offset1:145
    s_add_u32 m0, s74, 32
    v_mfma_f32_16x16x32_bf16 v[48:51], v[80:83], v[96:99], v[48:51]
    buffer_load_dwordx4 v240, s[48:51], s13 offen offset:2048 lds
    ds_read2_b32 v[150:151], v238 offset0:146 offset1:147
    v_mfma_f32_16x16x32_bf16 v[44:47], v[64:67], v[108:111], 0
    ds_read_b128 v[184:187], v245 offset:26624
    v_mfma_f32_16x16x32_bf16 v[44:47], v[68:71], v[104:107], v[44:47]
    v_cvt_pk_bf16_f32 v192, v32, v33
    v_mfma_f32_16x16x32_bf16 v[44:47], v[72:75], v[100:103], v[44:47]
    s_add_u32 m0, s73, 147456
    ds_read2_b32 v[152:153], v239 offset0:16 offset1:17
    v_mfma_f32_16x16x32_bf16 v[44:47], v[76:79], v[96:99], v[44:47]
    buffer_load_dwordx4 v6, s[52:55], s14 offen offset:2048 lds
    v_cvt_pk_bf16_f32 v193, v34, v35
    v_mfma_f32_16x16x32_bf16 v[40:43], v[64:67], v[104:107], 0
    ds_read2_b32 v[154:155], v239 offset0:18 offset1:19
    v_mfma_f32_16x16x32_bf16 v[40:43], v[68:71], v[100:103], v[40:43]
    buffer_store_dwordx2 v[192:193], v8, s[44:47], s6 offen offset:0 sc1
    ds_read_b128 v[188:191], v245 offset:30720
    v_mfma_f32_16x16x32_bf16 v[40:43], v[72:75], v[96:99], v[40:43]
    s_add_u32 m0, s74, 32
    ds_read2_b32 v[156:157], v239 offset0:144 offset1:145
    v_mfma_f32_16x16x32_bf16 v[36:39], v[64:67], v[100:103], 0
    buffer_load_dwordx4 v240, s[48:51], s13 offen offset:3072 lds
    v_mfma_f32_16x16x32_bf16 v[36:39], v[68:71], v[96:99], v[36:39]
    ds_read2_b32 v[158:159], v239 offset0:146 offset1:147
    v_mfma_f32_16x16x32_bf16 v[32:35], v[64:67], v[96:99], 0
    s_waitcnt lgkmcnt(12)
    v_mfma_f32_16x16x32_bf16 v[32:35], v[128:131], v[160:163], v[32:35]
    ds_read_b128 v[96:99], v246 offset:2048
    v_mfma_f32_16x16x32_bf16 v[36:39], v[132:135], v[160:163], v[36:39]
    v_mfma_f32_16x16x32_bf16 v[36:39], v[128:131], v[164:167], v[36:39]
    ds_read2_b32 v[64:65], v236 offset0:32 offset1:33
    v_mfma_f32_16x16x32_bf16 v[40:43], v[128:131], v[168:171], v[40:43]
    s_add_u32 m0, s73, 147456
    ds_read2_b32 v[66:67], v236 offset0:34 offset1:35
    v_mfma_f32_16x16x32_bf16 v[40:43], v[132:135], v[164:167], v[40:43]
    buffer_load_dwordx4 v7, s[52:55], s14 offen offset:3072 lds
    v_mfma_f32_16x16x32_bf16 v[40:43], v[136:139], v[160:163], v[40:43]
    ds_read_b128 v[100:103], v246 offset:6144
    v_mfma_f32_16x16x32_bf16 v[44:47], v[140:143], v[160:163], v[44:47]
    ds_read2_b32 v[68:69], v236 offset0:160 offset1:161
    v_mfma_f32_16x16x32_bf16 v[44:47], v[136:139], v[164:167], v[44:47]
    ds_read2_b32 v[70:71], v236 offset0:162 offset1:163
    v_mfma_f32_16x16x32_bf16 v[44:47], v[132:135], v[168:171], v[44:47]
    ds_read_b128 v[104:107], v246 offset:10240
    v_mfma_f32_16x16x32_bf16 v[44:47], v[128:131], v[172:175], v[44:47]
    ds_read2_b32 v[72:73], v237 offset0:32 offset1:33
    s_waitcnt lgkmcnt(8)
    v_mfma_f32_16x16x32_bf16 v[48:51], v[128:131], v[176:179], v[48:51]
    ds_read2_b32 v[74:75], v237 offset0:34 offset1:35
    v_mfma_f32_16x16x32_bf16 v[48:51], v[132:135], v[172:175], v[48:51]
    ds_read_b128 v[108:111], v246 offset:14336
    v_mfma_f32_16x16x32_bf16 v[48:51], v[136:139], v[168:171], v[48:51]
    v_mov_b32 v9, 16
    buffer_load_ushort v9, v9, s[56:59], s70 offen
    v_mfma_f32_16x16x32_bf16 v[48:51], v[140:143], v[164:167], v[48:51]
    ds_read2_b32 v[76:77], v237 offset0:160 offset1:161
    v_mfma_f32_16x16x32_bf16 v[48:51], v[144:147], v[160:163], v[48:51]
    ds_read2_b32 v[78:79], v237 offset0:162 offset1:163
    s_waitcnt vmcnt(17)
    s_barrier
    v_mfma_f32_16x16x32_bf16 v[52:55], v[148:151], v[160:163], v[52:55]
    ds_read_b128 v[112:115], v246 offset:18432
    v_add_u32 v10, -131072, v10
    v_mfma_f32_16x16x32_bf16 v[52:55], v[144:147], v[164:167], v[52:55]
    ds_read_b64_tr_b16 a[48:49], v10 offset:49152
    v_mfma_f32_16x16x32_bf16 v[52:55], v[140:143], v[168:171], v[52:55]
    ds_read_b64_tr_b16 a[50:51], v10 offset:51200
    v_mfma_f32_16x16x32_bf16 v[52:55], v[136:139], v[172:175], v[52:55]
    ds_read2_b32 v[80:81], v238 offset0:32 offset1:33
    v_mfma_f32_16x16x32_bf16 v[52:55], v[132:135], v[176:179], v[52:55]
    ds_read_b64_tr_b16 a[56:57], v10 offset:53248
    v_mfma_f32_16x16x32_bf16 v[52:55], v[128:131], v[180:183], v[52:55]
    ds_read_b64_tr_b16 a[58:59], v10 offset:55296
    v_mfma_f32_16x16x32_bf16 v[56:59], v[128:131], v[184:187], v[56:59]
    ds_read2_b32 v[82:83], v238 offset0:34 offset1:35
    v_add_u32 v11, -131072, v11
    v_mfma_f32_16x16x32_bf16 v[56:59], v[132:135], v[180:183], v[56:59]
    ds_read_b64_tr_b16 a[52:53], v11 offset:49152
    v_mfma_f32_16x16x32_bf16 v[56:59], v[136:139], v[176:179], v[56:59]
    ds_read_b64_tr_b16 a[54:55], v11 offset:51200
    v_mfma_f32_16x16x32_bf16 v[56:59], v[140:143], v[172:175], v[56:59]
    ds_read_b128 v[116:119], v246 offset:22528
    v_mfma_f32_16x16x32_bf16 v[56:59], v[144:147], v[168:171], v[56:59]
    ds_read_b64_tr_b16 a[60:61], v11 offset:53248
    v_mfma_f32_16x16x32_bf16 v[56:59], v[148:151], v[164:167], v[56:59]
    ds_read_b64_tr_b16 a[62:63], v11 offset:55296
    v_mfma_f32_16x16x32_bf16 v[56:59], v[152:155], v[160:163], v[56:59]
    ds_read2_b32 v[84:85], v238 offset0:160 offset1:161
    v_mfma_f32_16x16x32_bf16 v[60:63], v[156:159], v[160:163], v[60:63]
    ds_read2_b32 v[86:87], v238 offset0:162 offset1:163
    v_mfma_f32_16x16x32_bf16 v[60:63], v[152:155], v[164:167], v[60:63]
    ds_read_b128 v[120:123], v246 offset:26624
    v_mfma_f32_16x16x32_bf16 v[60:63], v[148:151], v[168:171], v[60:63]
    ds_read2_b32 v[88:89], v239 offset0:32 offset1:33
    v_mfma_f32_16x16x32_bf16 v[60:63], v[144:147], v[172:175], v[60:63]
    ds_read2_b32 v[90:91], v239 offset0:34 offset1:35
    v_mfma_f32_16x16x32_bf16 v[60:63], v[140:143], v[176:179], v[60:63]
    ds_read_b128 v[124:127], v246 offset:30720
    v_mfma_f32_16x16x32_bf16 v[60:63], v[136:139], v[180:183], v[60:63]
    ds_read2_b32 v[92:93], v239 offset0:160 offset1:161
    v_mfma_f32_16x16x32_bf16 v[60:63], v[132:135], v[184:187], v[60:63]
    ds_read2_b32 v[94:95], v239 offset0:162 offset1:163
    v_mfma_f32_16x16x32_bf16 v[60:63], v[128:131], v[188:191], v[60:63]
    s_waitcnt lgkmcnt(15)
    v_mfma_f32_16x16x32_bf16 v[32:35], v[64:67], v[96:99], v[32:35]
    ds_read_b128 v[160:163], v247 offset:2048
    v_mfma_f32_16x16x32_bf16 v[36:39], v[68:71], v[96:99], v[36:39]
    v_mfma_f32_16x16x32_bf16 v[36:39], v[64:67], v[100:103], v[36:39]
    ds_read2_b32 v[128:129], v236 offset0:48 offset1:49
    v_mfma_f32_16x16x32_bf16 v[40:43], v[64:67], v[104:107], v[40:43]
    ds_read2_b32 v[130:131], v236 offset0:50 offset1:51
    v_mfma_f32_16x16x32_bf16 v[40:43], v[68:71], v[100:103], v[40:43]
    v_mfma_f32_16x16x32_bf16 v[40:43], v[72:75], v[96:99], v[40:43]
    ds_read_b128 v[164:167], v247 offset:6144
    v_mfma_f32_16x16x32_bf16 v[44:47], v[76:79], v[96:99], v[44:47]
    ds_read2_b32 v[132:133], v236 offset0:176 offset1:177
    v_mfma_f32_16x16x32_bf16 v[44:47], v[72:75], v[100:103], v[44:47]
    s_waitcnt lgkmcnt(13)
    s_barrier
    v_mfma_f32_16x16x32_bf16 v[44:47], v[68:71], v[104:107], v[44:47]
    ds_read2_b32 v[134:135], v236 offset0:178 offset1:179
    v_mfma_f32_16x16x32_bf16 v[44:47], v[64:67], v[108:111], v[44:47]
    ds_read_b128 v[168:171], v247 offset:10240
    s_waitcnt lgkmcnt(7)
    v_mfma_f32_16x16x32_bf16 v[48:51], v[64:67], v[112:115], v[48:51]
    ds_read2_b32 v[136:137], v237 offset0:48 offset1:49
    v_mfma_f32_16x16x32_bf16 v[48:51], v[68:71], v[108:111], v[48:51]
    v_mfma_f32_16x16x32_bf16 v[48:51], v[72:75], v[104:107], v[48:51]
    ds_read2_b32 v[138:139], v237 offset0:50 offset1:51
    v_mfma_f32_16x16x32_bf16 v[48:51], v[76:79], v[100:103], v[48:51]
    ds_read_b128 v[172:175], v247 offset:14336
    v_mfma_f32_16x16x32_bf16 v[48:51], v[80:83], v[96:99], v[48:51]
    v_mfma_f32_16x16x32_bf16 v[52:55], v[84:87], v[96:99], v[52:55]
    ds_read2_b32 v[140:141], v237 offset0:176 offset1:177
    v_mfma_f32_16x16x32_bf16 v[52:55], v[80:83], v[100:103], v[52:55]
    ds_read2_b32 v[142:143], v237 offset0:178 offset1:179
    v_mfma_f32_16x16x32_bf16 v[52:55], v[76:79], v[104:107], v[52:55]
    v_mfma_f32_16x16x32_bf16 v[52:55], v[72:75], v[108:111], v[52:55]
    ds_read_b128 v[176:179], v247 offset:18432
    v_mfma_f32_16x16x32_bf16 v[52:55], v[68:71], v[112:115], v[52:55]
    ds_read2_b32 v[144:145], v238 offset0:48 offset1:49
    v_mfma_f32_16x16x32_bf16 v[52:55], v[64:67], v[116:119], v[52:55]
    v_mfma_f32_16x16x32_bf16 v[56:59], v[64:67], v[120:123], v[56:59]
    ds_read2_b32 v[146:147], v238 offset0:50 offset1:51
    v_mfma_f32_16x16x32_bf16 v[56:59], v[68:71], v[116:119], v[56:59]
    ds_read_b128 v[180:183], v247 offset:22528
    v_mfma_f32_16x16x32_bf16 v[56:59], v[72:75], v[112:115], v[56:59]
    v_mfma_f32_16x16x32_bf16 v[56:59], v[76:79], v[108:111], v[56:59]
    ds_read2_b32 v[148:149], v238 offset0:176 offset1:177
    v_mfma_f32_16x16x32_bf16 v[56:59], v[80:83], v[104:107], v[56:59]
    ds_read2_b32 v[150:151], v238 offset0:178 offset1:179
    v_mfma_f32_16x16x32_bf16 v[56:59], v[84:87], v[100:103], v[56:59]
    ds_read_b128 v[184:187], v247 offset:26624
    v_mfma_f32_16x16x32_bf16 v[56:59], v[88:91], v[96:99], v[56:59]
    v_mfma_f32_16x16x32_bf16 v[60:63], v[92:95], v[96:99], v[60:63]
    ds_read2_b32 v[152:153], v239 offset0:48 offset1:49
    v_mfma_f32_16x16x32_bf16 v[60:63], v[88:91], v[100:103], v[60:63]
    ds_read2_b32 v[154:155], v239 offset0:50 offset1:51
    v_mfma_f32_16x16x32_bf16 v[60:63], v[84:87], v[104:107], v[60:63]
    v_mfma_f32_16x16x32_bf16 v[60:63], v[80:83], v[108:111], v[60:63]
    ds_read_b128 v[188:191], v247 offset:30720
    v_mfma_f32_16x16x32_bf16 v[60:63], v[76:79], v[112:115], v[60:63]
    ds_read2_b32 v[156:157], v239 offset0:176 offset1:177
    v_mfma_f32_16x16x32_bf16 v[60:63], v[72:75], v[116:119], v[60:63]
    v_mfma_f32_16x16x32_bf16 v[60:63], v[68:71], v[120:123], v[60:63]
    ds_read2_b32 v[158:159], v239 offset0:178 offset1:179
    v_mfma_f32_16x16x32_bf16 v[60:63], v[64:67], v[124:127], v[60:63]
    s_waitcnt lgkmcnt(12)
    v_mfma_f32_16x16x32_bf16 v[32:35], v[128:131], v[160:163], v[32:35]
    ds_read_b128 v[96:99], v244 offset:0
    v_mfma_f32_16x16x32_bf16 v[36:39], v[132:135], v[160:163], v[36:39]
    v_mfma_f32_16x16x32_bf16 v[36:39], v[128:131], v[164:167], v[36:39]
    ds_read2_b32 v[64:65], v236 offset0:64 offset1:65
    v_mfma_f32_16x16x32_bf16 v[40:43], v[128:131], v[168:171], v[40:43]
    ds_read2_b32 v[66:67], v236 offset0:66 offset1:67
    v_mfma_f32_16x16x32_bf16 v[40:43], v[132:135], v[164:167], v[40:43]
    v_mfma_f32_16x16x32_bf16 v[40:43], v[136:139], v[160:163], v[40:43]
    ds_read_b128 v[100:103], v244 offset:4096
    v_mfma_f32_16x16x32_bf16 v[44:47], v[140:143], v[160:163], v[44:47]
    ds_read2_b32 v[68:69], v236 offset0:192 offset1:193
    v_mfma_f32_16x16x32_bf16 v[44:47], v[136:139], v[164:167], v[44:47]
    s_add_u32 m0, s9, 36864
    s_add_u32 s13, s11, 0
    v_mfma_f32_16x16x32_bf16 v[44:47], v[132:135], v[168:171], v[44:47]
    buffer_load_dwordx4 v15, s[44:47], s13 offen sc1 lds
    ds_read2_b32 v[70:71], v236 offset0:194 offset1:195
    v_mfma_f32_16x16x32_bf16 v[44:47], v[128:131], v[172:175], v[44:47]
    ds_read_b128 v[104:107], v244 offset:8192
    s_waitcnt lgkmcnt(7)
    v_mfma_f32_16x16x32_bf16 v[48:51], v[128:131], v[176:179], v[48:51]
    ds_read2_b32 v[72:73], v237 offset0:64 offset1:65
    v_mfma_f32_16x16x32_bf16 v[48:51], v[132:135], v[172:175], v[48:51]
    ds_read2_b32 v[74:75], v237 offset0:66 offset1:67
    v_mfma_f32_16x16x32_bf16 v[48:51], v[136:139], v[168:171], v[48:51]
    ds_read_b128 v[108:111], v244 offset:12288
    v_mfma_f32_16x16x32_bf16 v[48:51], v[140:143], v[164:167], v[48:51]
    ds_read2_b32 v[76:77], v237 offset0:192 offset1:193
    v_mfma_f32_16x16x32_bf16 v[48:51], v[144:147], v[160:163], v[48:51]
    ds_read2_b32 v[78:79], v237 offset0:194 offset1:195
    v_mfma_f32_16x16x32_bf16 v[52:55], v[148:151], v[160:163], v[52:55]
    ds_read_b128 v[112:115], v244 offset:16384
    v_mfma_f32_16x16x32_bf16 v[52:55], v[144:147], v[164:167], v[52:55]
    ds_read2_b32 v[80:81], v238 offset0:64 offset1:65
    s_add_u32 m0, s9, 37888
    s_add_u32 s13, s11, 90112
    v_mfma_f32_16x16x32_bf16 v[52:55], v[140:143], v[168:171], v[52:55]
    buffer_load_dwordx4 v16, s[44:47], s13 offen sc1 lds
    ds_read2_b32 v[82:83], v238 offset0:66 offset1:67
    v_mfma_f32_16x16x32_bf16 v[52:55], v[136:139], v[172:175], v[52:55]
    ds_read_b128 v[116:119], v244 offset:20480
    v_mfma_f32_16x16x32_bf16 v[52:55], v[132:135], v[176:179], v[52:55]
    ds_read2_b32 v[84:85], v238 offset0:192 offset1:193
    v_mfma_f32_16x16x32_bf16 v[52:55], v[128:131], v[180:183], v[52:55]
    ds_read2_b32 v[86:87], v238 offset0:194 offset1:195
    v_mfma_f32_16x16x32_bf16 v[56:59], v[128:131], v[184:187], v[56:59]
    ds_read_b128 v[120:123], v244 offset:24576
    s_waitcnt vmcnt(3)
    s_barrier
    v_mfma_f32_16x16x32_bf16 v[56:59], v[132:135], v[180:183], v[56:59]
    ds_read2_b32 v[88:89], v239 offset0:64 offset1:65
    v_add_u32 v10, 131072, v10
    v_mfma_f32_16x16x32_bf16 v[56:59], v[136:139], v[176:179], v[56:59]
    ds_read_b64_tr_b16 a[64:65], v10 offset:16384
    v_mfma_f32_16x16x32_bf16 v[56:59], v[140:143], v[172:175], v[56:59]
    ds_read2_b32 v[90:91], v239 offset0:66 offset1:67
    v_mfma_f32_16x16x32_bf16 v[56:59], v[144:147], v[168:171], v[56:59]
    ds_read_b64_tr_b16 a[66:67], v10 offset:18432
    s_add_u32 m0, s9, 38912
    s_add_u32 s13, s11, 180224
    v_mfma_f32_16x16x32_bf16 v[56:59], v[148:151], v[164:167], v[56:59]
    ds_read_b64_tr_b16 a[72:73], v10 offset:20480
    buffer_load_dwordx4 v15, s[44:47], s13 offen sc1 lds
    v_mfma_f32_16x16x32_bf16 v[56:59], v[152:155], v[160:163], v[56:59]
    ds_read_b64_tr_b16 a[74:75], v10 offset:22528
    v_mfma_f32_16x16x32_bf16 v[60:63], v[156:159], v[160:163], v[60:63]
    ds_read_b128 v[124:127], v244 offset:28672
    v_add_u32 v11, 131072, v11
    v_mfma_f32_16x16x32_bf16 v[60:63], v[152:155], v[164:167], v[60:63]
    ds_read_b64_tr_b16 a[68:69], v11 offset:16384
    v_mfma_f32_16x16x32_bf16 v[60:63], v[148:151], v[168:171], v[60:63]
    ds_read2_b32 v[92:93], v239 offset0:192 offset1:193
    v_mfma_f32_16x16x32_bf16 v[60:63], v[144:147], v[172:175], v[60:63]
    ds_read_b64_tr_b16 a[70:71], v11 offset:18432
    v_mfma_f32_16x16x32_bf16 v[60:63], v[140:143], v[176:179], v[60:63]
    ds_read_b64_tr_b16 a[76:77], v11 offset:20480
    v_mfma_f32_16x16x32_bf16 v[60:63], v[136:139], v[180:183], v[60:63]
    ds_read_b64_tr_b16 a[78:79], v11 offset:22528
    v_mfma_f32_16x16x32_bf16 v[60:63], v[132:135], v[184:187], v[60:63]
    ds_read2_b32 v[94:95], v239 offset0:194 offset1:195
    s_add_u32 m0, s9, 39936
    s_add_u32 s13, s11, 270336
    v_mfma_f32_16x16x32_bf16 v[60:63], v[128:131], v[188:191], v[60:63]
    buffer_load_dwordx4 v16, s[44:47], s13 offen sc1 lds
    s_waitcnt lgkmcnt(15)
    v_mfma_f32_16x16x32_bf16 v[32:35], v[64:67], v[96:99], v[32:35]
    ds_read_b128 v[160:163], v245 offset:0
L_pl_X_3:
    s_cbranch_execz L_pl_X_7
    s_waitcnt lgkmcnt(2)
    s_barrier
    v_mfma_f32_16x16x32_bf16 v[36:39], v[68:71], v[96:99], v[36:39]
    v_mfma_f32_16x16x32_bf16 v[36:39], v[64:67], v[100:103], v[36:39]
    ds_read2_b32 v[128:129], v236 offset0:80 offset1:81
    v_mfma_f32_16x16x32_bf16 v[40:43], v[64:67], v[104:107], v[40:43]
    s_lshl_b32 s14, s89, 18
    ds_read2_b32 v[130:131], v236 offset0:82 offset1:83
    v_mfma_f32_16x16x32_bf16 v[40:43], v[68:71], v[100:103], v[40:43]
    s_add_u32 m0, s73, 147456
    v_mfma_f32_16x16x32_bf16 v[40:43], v[72:75], v[96:99], v[40:43]
    buffer_load_dwordx4 v4, s[52:55], s14 offen offset:0 lds
    ds_read_b128 v[164:167], v245 offset:4096
    v_mfma_f32_16x16x32_bf16 v[44:47], v[76:79], v[96:99], v[44:47]
    ds_read2_b32 v[132:133], v236 offset0:208 offset1:209
    v_mfma_f32_16x16x32_bf16 v[44:47], v[72:75], v[100:103], v[44:47]
    s_add_u32 m0, s9, 40960
    s_add_u32 s13, s11, 360448
    v_mfma_f32_16x16x32_bf16 v[44:47], v[68:71], v[104:107], v[44:47]
    buffer_load_dwordx4 v15, s[44:47], s13 offen sc1 lds
    ds_read2_b32 v[134:135], v236 offset0:210 offset1:211
    v_mfma_f32_16x16x32_bf16 v[44:47], v[64:67], v[108:111], v[44:47]
    ds_read_b128 v[168:171], v245 offset:8192
    s_waitcnt lgkmcnt(7)
    v_mfma_f32_16x16x32_bf16 v[48:51], v[64:67], v[112:115], v[48:51]
    ds_read2_b32 v[136:137], v237 offset0:80 offset1:81
    v_mfma_f32_16x16x32_bf16 v[48:51], v[68:71], v[108:111], v[48:51]
    ds_read2_b32 v[138:139], v237 offset0:82 offset1:83
    v_mfma_f32_16x16x32_bf16 v[48:51], v[72:75], v[104:107], v[48:51]
    ds_read_b128 v[172:175], v245 offset:12288
    v_mfma_f32_16x16x32_bf16 v[48:51], v[76:79], v[100:103], v[48:51]
    ds_read2_b32 v[140:141], v237 offset0:208 offset1:209
    v_mfma_f32_16x16x32_bf16 v[48:51], v[80:83], v[96:99], v[48:51]
    ds_read2_b32 v[142:143], v237 offset0:210 offset1:211
    v_mfma_f32_16x16x32_bf16 v[52:55], v[84:87], v[96:99], v[52:55]
    ds_read_b128 v[176:179], v245 offset:16384
    v_mfma_f32_16x16x32_bf16 v[52:55], v[80:83], v[100:103], v[52:55]
    s_add_u32 m0, s73, 147456
    ds_read2_b32 v[144:145], v238 offset0:80 offset1:81
    v_mfma_f32_16x16x32_bf16 v[52:55], v[76:79], v[104:107], v[52:55]
    buffer_load_dwordx4 v5, s[52:55], s14 offen offset:1024 lds
    ds_read2_b32 v[146:147], v238 offset0:82 offset1:83
    v_mfma_f32_16x16x32_bf16 v[52:55], v[72:75], v[108:111], v[52:55]
    ds_read_b128 v[180:183], v245 offset:20480
    s_add_u32 m0, s9, 41984
    s_add_u32 s13, s11, 450560
    v_mfma_f32_16x16x32_bf16 v[52:55], v[68:71], v[112:115], v[52:55]
    buffer_load_dwordx4 v16, s[44:47], s13 offen sc1 lds
    ds_read_b128 v[212:215], v241 offset:32
    v_mfma_f32_16x16x32_bf16 v[52:55], v[64:67], v[116:119], v[52:55]
    ds_read2_b32 v[148:149], v238 offset0:208 offset1:209
    v_mfma_f32_16x16x32_bf16 v[56:59], v[64:67], v[120:123], v[56:59]
    ds_read_b32 v216, v241 offset:48
    v_mfma_f32_16x16x32_bf16 v[56:59], v[68:71], v[116:119], v[56:59]
    ds_read2_b32 v[150:151], v238 offset0:210 offset1:211
    v_mfma_f32_16x16x32_bf16 v[56:59], v[72:75], v[112:115], v[56:59]
    ds_read_b128 v[218:221], v241 offset:1056
    v_mfma_f32_16x16x32_bf16 v[56:59], v[76:79], v[108:111], v[56:59]
    ds_read_b128 v[184:187], v245 offset:24576
    v_mfma_f32_16x16x32_bf16 v[56:59], v[80:83], v[104:107], v[56:59]
    ds_read2_b32 v[152:153], v239 offset0:80 offset1:81
    s_add_u32 m0, s9, 43008
    s_add_u32 s13, s11, 540672
    v_mfma_f32_16x16x32_bf16 v[56:59], v[84:87], v[100:103], v[56:59]
    buffer_load_dwordx4 v15, s[44:47], s13 offen sc1 lds
    ds_read_b32 v222, v241 offset:1072
    v_mfma_f32_16x16x32_bf16 v[56:59], v[88:91], v[96:99], v[56:59]
    ds_read2_b32 v[154:155], v239 offset0:82 offset1:83
    v_mfma_f32_16x16x32_bf16 v[60:63], v[92:95], v[96:99], v[60:63]
    s_add_u32 m0, s73, 147456
    ds_read_b128 v[224:227], v241 offset:2080
    v_mfma_f32_16x16x32_bf16 v[60:63], v[88:91], v[100:103], v[60:63]
    buffer_load_dwordx4 v6, s[52:55], s14 offen offset:2048 lds
    ds_read_b128 v[188:191], v245 offset:28672
    v_mfma_f32_16x16x32_bf16 v[60:63], v[84:87], v[104:107], v[60:63]
    ds_read_b32 v228, v241 offset:2096
    v_mfma_f32_16x16x32_bf16 v[60:63], v[80:83], v[108:111], v[60:63]
    ds_read2_b32 v[156:157], v239 offset0:208 offset1:209
    v_mfma_f32_16x16x32_bf16 v[60:63], v[76:79], v[112:115], v[60:63]
    ds_read_b128 v[230:233], v241 offset:3104
    v_mfma_f32_16x16x32_bf16 v[60:63], v[72:75], v[116:119], v[60:63]
    ds_read2_b32 v[158:159], v239 offset0:210 offset1:211
    v_mfma_f32_16x16x32_bf16 v[60:63], v[68:71], v[120:123], v[60:63]
    ds_read_b32 v234, v241 offset:3120
    s_add_u32 m0, s9, 44032
    s_add_u32 s13, s11, 630784
    v_mfma_f32_16x16x32_bf16 v[60:63], v[64:67], v[124:127], v[60:63]
    buffer_load_dwordx4 v16, s[44:47], s13 offen sc1 lds
    s_waitcnt lgkmcnt(15)
    v_mfma_f32_16x16x32_bf16 v[32:35], v[128:131], v[160:163], v[32:35]
    ds_read_b128 v[96:99], v246 offset:0
    v_mfma_f32_16x16x32_bf16 v[36:39], v[132:135], v[160:163], v[36:39]
    v_mfma_f32_16x16x32_bf16 v[36:39], v[128:131], v[164:167], v[36:39]
    ds_read2_b32 v[64:65], v236 offset0:96 offset1:97
    v_mfma_f32_16x16x32_bf16 v[40:43], v[128:131], v[168:171], v[40:43]
    s_add_u32 m0, s73, 147456
    ds_read2_b32 v[66:67], v236 offset0:98 offset1:99
    v_mfma_f32_16x16x32_bf16 v[40:43], v[132:135], v[164:167], v[40:43]
    buffer_load_dwordx4 v7, s[52:55], s14 offen offset:3072 lds
    s_waitcnt lgkmcnt(3)
    v_mfma_f32_16x16x32_bf16 v[40:43], v[136:139], v[160:163], v[40:43]
    ds_read_b128 v[100:103], v246 offset:4096
    v_mfma_f32_16x16x32_bf16 v[44:47], v[140:143], v[160:163], v[44:47]
    s_waitcnt vmcnt(12)
    ds_read2_b32 v[68:69], v236 offset0:224 offset1:225
    v_mfma_f32_16x16x32_bf16 v[44:47], v[136:139], v[164:167], v[44:47]
    v_mfma_f32_16x16x32_bf16 v[44:47], v[132:135], v[168:171], v[44:47]
    ds_read2_b32 v[70:71], v236 offset0:226 offset1:227
    v_lshlrev_b32 v9, 16, v9
    v_mfma_f32_16x16x32_bf16 v[44:47], v[128:131], v[172:175], v[44:47]
    ds_read_b128 v[104:107], v246 offset:8192
    v_mfma_f32_16x16x32_bf16 v[48:51], v[128:131], v[176:179], v[48:51]
    ds_read2_b32 v[72:73], v237 offset0:96 offset1:97
    v_lshlrev_b32 v208, 16, v212
    v_mfma_f32_16x16x32_bf16 v[48:51], v[132:135], v[172:175], v[48:51]
    v_mfma_f32_16x16x32_bf16 v[48:51], v[136:139], v[168:171], v[48:51]
    ds_read2_b32 v[74:75], v237 offset0:98 offset1:99
    v_add_f32 v9, v9, v208
    v_mfma_f32_16x16x32_bf16 v[48:51], v[140:143], v[164:167], v[48:51]
    ds_read_b128 v[108:111], v246 offset:12288
    v_cvt_pk_bf16_f32 v9, v9, v9
    v_mfma_f32_16x16x32_bf16 v[48:51], v[144:147], v[160:163], v[48:51]
    ds_read2_b32 v[76:77], v237 offset0:224 offset1:225
    v_mfma_f32_16x16x32_bf16 v[52:55], v[148:151], v[160:163], v[52:55]
    ds_write_b16 v242, v9 offset:4160
    v_mfma_f32_16x16x32_bf16 v[52:55], v[144:147], v[164:167], v[52:55]
    ds_read2_b32 v[78:79], v237 offset0:226 offset1:227
    v_mfma_f32_16x16x32_bf16 v[52:55], v[140:143], v[168:171], v[52:55]
    ds_write_b16 v242, v9 offset:2
    v_mfma_f32_16x16x32_bf16 v[52:55], v[136:139], v[172:175], v[52:55]
    ds_read_b128 v[112:115], v246 offset:16384
    v_mfma_f32_16x16x32_bf16 v[52:55], v[132:135], v[176:179], v[52:55]
    ds_read2_b32 v[80:81], v238 offset0:96 offset1:97
    v_alignbit_b32 v212, v213, v212, 16
    v_mfma_f32_16x16x32_bf16 v[52:55], v[128:131], v[180:183], v[52:55]
    v_alignbit_b32 v213, v214, v213, 16
    v_mfma_f32_16x16x32_bf16 v[56:59], v[128:131], v[184:187], v[56:59]
    ds_read2_b32 v[82:83], v238 offset0:98 offset1:99
    v_mfma_f32_16x16x32_bf16 v[56:59], v[132:135], v[180:183], v[56:59]
    ds_read_b128 v[116:119], v246 offset:20480
    v_alignbit_b32 v214, v215, v214, 16
    v_mfma_f32_16x16x32_bf16 v[56:59], v[136:139], v[176:179], v[56:59]
    v_mfma_f32_16x16x32_bf16 v[56:59], v[140:143], v[172:175], v[56:59]
    ds_read2_b32 v[84:85], v238 offset0:224 offset1:225
    v_alignbit_b32 v215, v216, v215, 16
    v_mfma_f32_16x16x32_bf16 v[56:59], v[144:147], v[168:171], v[56:59]
    ds_read2_b32 v[86:87], v238 offset0:226 offset1:227
    v_mfma_f32_16x16x32_bf16 v[56:59], v[148:151], v[164:167], v[56:59]
    ds_write_b128 v241, v[212:215] offset:4192
    v_mfma_f32_16x16x32_bf16 v[56:59], v[152:155], v[160:163], v[56:59]
    ds_read_b128 v[120:123], v246 offset:24576
    v_mfma_f32_16x16x32_bf16 v[60:63], v[156:159], v[160:163], v[60:63]
    ds_read2_b32 v[88:89], v239 offset0:96 offset1:97
    v_alignbit_b32 v218, v219, v218, 16
    v_mfma_f32_16x16x32_bf16 v[60:63], v[152:155], v[164:167], v[60:63]
    ds_read2_b32 v[90:91], v239 offset0:98 offset1:99
    v_alignbit_b32 v219, v220, v219, 16
    v_mfma_f32_16x16x32_bf16 v[60:63], v[148:151], v[168:171], v[60:63]
    v_mfma_f32_16x16x32_bf16 v[60:63], v[144:147], v[172:175], v[60:63]
    ds_read_b128 v[124:127], v246 offset:28672
    v_alignbit_b32 v220, v221, v220, 16
    v_mfma_f32_16x16x32_bf16 v[60:63], v[140:143], v[176:179], v[60:63]
    ds_read2_b32 v[92:93], v239 offset0:224 offset1:225
    v_mfma_f32_16x16x32_bf16 v[60:63], v[136:139], v[180:183], v[60:63]
    ds_read2_b32 v[94:95], v239 offset0:226 offset1:227
    v_alignbit_b32 v221, v222, v221, 16
    v_mfma_f32_16x16x32_bf16 v[60:63], v[132:135], v[184:187], v[60:63]
    ds_write_b128 v241, v[218:221] offset:5216
    v_mfma_f32_16x16x32_bf16 v[60:63], v[128:131], v[188:191], v[60:63]
    s_waitcnt lgkmcnt(15)
    v_mfma_f32_16x16x32_bf16 v[32:35], v[64:67], v[96:99], v[32:35]
    ds_read_b128 v[160:163], v247 offset:0
    v_mfma_f32_16x16x32_bf16 v[36:39], v[68:71], v[96:99], v[36:39]
    v_alignbit_b32 v224, v225, v224, 16
    v_mfma_f32_16x16x32_bf16 v[36:39], v[64:67], v[100:103], v[36:39]
    ds_read_b128 v[164:167], v247 offset:4096
    v_mfma_f32_16x16x32_bf16 v[40:43], v[64:67], v[104:107], v[40:43]
    ds_read_b128 v[168:171], v247 offset:8192
    v_mfma_f32_16x16x32_bf16 v[40:43], v[68:71], v[100:103], v[40:43]
    ds_read_b128 v[172:175], v247 offset:12288
    v_mfma_f32_16x16x32_bf16 v[40:43], v[72:75], v[96:99], v[40:43]
    v_alignbit_b32 v225, v226, v225, 16
    v_mfma_f32_16x16x32_bf16 v[44:47], v[76:79], v[96:99], v[44:47]
    ds_read_b128 v[176:179], v247 offset:16384
    v_mfma_f32_16x16x32_bf16 v[44:47], v[72:75], v[100:103], v[44:47]
    ds_read_b128 v[180:183], v247 offset:20480
    v_mfma_f32_16x16x32_bf16 v[44:47], v[68:71], v[104:107], v[44:47]
    ds_read_b128 v[184:187], v247 offset:24576
    v_mfma_f32_16x16x32_bf16 v[44:47], v[64:67], v[108:111], v[44:47]
    v_alignbit_b32 v226, v227, v226, 16
    s_waitcnt lgkmcnt(8)
    v_mfma_f32_16x16x32_bf16 v[48:51], v[64:67], v[112:115], v[48:51]
    ds_read_b128 v[188:191], v247 offset:28672
    v_mfma_f32_16x16x32_bf16 v[48:51], v[68:71], v[108:111], v[48:51]
    ds_read2_b32 v[128:129], v236 offset0:112 offset1:113
    v_mfma_f32_16x16x32_bf16 v[48:51], v[72:75], v[104:107], v[48:51]
    v_alignbit_b32 v227, v228, v227, 16
    v_mfma_f32_16x16x32_bf16 v[48:51], v[76:79], v[100:103], v[48:51]
    ds_read2_b32 v[130:131], v236 offset0:114 offset1:115
    v_mfma_f32_16x16x32_bf16 v[48:51], v[80:83], v[96:99], v[48:51]
    ds_read2_b32 v[132:133], v236 offset0:240 offset1:241
    v_mfma_f32_16x16x32_bf16 v[52:55], v[84:87], v[96:99], v[52:55]
    ds_read2_b32 v[134:135], v236 offset0:242 offset1:243
    v_mfma_f32_16x16x32_bf16 v[52:55], v[80:83], v[100:103], v[52:55]
    ds_write_b128 v241, v[224:227] offset:6240
    v_mfma_f32_16x16x32_bf16 v[52:55], v[76:79], v[104:107], v[52:55]
    ds_read2_b32 v[136:137], v237 offset0:112 offset1:113
    ds_read2_b32 v[138:139], v237 offset0:114 offset1:115
    v_mfma_f32_16x16x32_bf16 v[52:55], v[72:75], v[108:111], v[52:55]
    s_add_u32 s6, s12, 4734976
    ds_read2_b32 v[140:141], v237 offset0:240 offset1:241
    v_mfma_f32_16x16x32_bf16 v[52:55], v[68:71], v[112:115], v[52:55]
    ds_read2_b32 v[142:143], v237 offset0:242 offset1:243
    v_alignbit_b32 v230, v231, v230, 16
    v_xor_b32 v244, 64, v244
    v_mfma_f32_16x16x32_bf16 v[52:55], v[64:67], v[116:119], v[52:55]
    ds_read2_b32 v[144:145], v238 offset0:112 offset1:113
    v_mfma_f32_16x16x32_bf16 v[56:59], v[64:67], v[120:123], v[56:59]
    ds_read2_b32 v[146:147], v238 offset0:114 offset1:115
    v_xor_b32 v245, 64, v245
    v_mfma_f32_16x16x32_bf16 v[56:59], v[68:71], v[116:119], v[56:59]
    ds_read2_b32 v[148:149], v238 offset0:240 offset1:241
    v_mfma_f32_16x16x32_bf16 v[56:59], v[72:75], v[112:115], v[56:59]
    v_alignbit_b32 v231, v232, v231, 16
    v_xor_b32 v246, 64, v246
    v_mfma_f32_16x16x32_bf16 v[56:59], v[76:79], v[108:111], v[56:59]
    ds_read2_b32 v[150:151], v238 offset0:242 offset1:243
    v_mfma_f32_16x16x32_bf16 v[56:59], v[80:83], v[104:107], v[56:59]
    ds_read2_b32 v[152:153], v239 offset0:112 offset1:113
    v_xor_b32 v247, 64, v247
    v_mfma_f32_16x16x32_bf16 v[56:59], v[84:87], v[100:103], v[56:59]
    ds_read2_b32 v[154:155], v239 offset0:114 offset1:115
    v_mfma_f32_16x16x32_bf16 v[56:59], v[88:91], v[96:99], v[56:59]
    ds_read2_b32 v[156:157], v239 offset0:240 offset1:241
    v_alignbit_b32 v232, v233, v232, 16
    v_mfma_f32_16x16x32_bf16 v[60:63], v[92:95], v[96:99], v[60:63]
    ds_read2_b32 v[158:159], v239 offset0:242 offset1:243
    v_add_u32 v244, 36864, v244
    v_mfma_f32_16x16x32_bf16 v[60:63], v[88:91], v[100:103], v[60:63]
    v_add_u32 v236, -8320, v236
    v_mfma_f32_16x16x32_bf16 v[60:63], v[84:87], v[104:107], v[60:63]
    v_alignbit_b32 v233, v234, v233, 16
    v_add_u32 v245, 36864, v245
    v_mfma_f32_16x16x32_bf16 v[60:63], v[80:83], v[108:111], v[60:63]
    v_add_u32 v237, -8320, v237
    v_mfma_f32_16x16x32_bf16 v[60:63], v[76:79], v[112:115], v[60:63]
    s_waitcnt vmcnt(1)
    s_barrier
    v_add_u32 v246, 36864, v246
    v_mfma_f32_16x16x32_bf16 v[60:63], v[72:75], v[116:119], v[60:63]
    v_add_u32 v238, -8320, v238
    v_add_u32 v239, -8320, v239
    v_mfma_f32_16x16x32_bf16 v[60:63], v[68:71], v[120:123], v[60:63]
    ds_write_b128 v241, v[230:233] offset:7264
    v_mfma_f32_16x16x32_bf16 v[60:63], v[64:67], v[124:127], v[60:63]
    v_add_u32 v247, 36864, v247
    s_waitcnt lgkmcnt(1)
    v_mfma_f32_16x16x32_bf16 v[60:63], v[128:131], v[188:191], v[60:63]
    ds_read_b128 v[96:99], v244 offset:2048
    v_mfma_f32_16x16x32_bf16 v[60:63], v[132:135], v[184:187], v[60:63]
    ds_read2_b32 v[64:65], v236 offset0:0 offset1:1
    v_mfma_f32_16x16x32_bf16 v[60:63], v[136:139], v[180:183], v[60:63]
    ds_read2_b32 v[66:67], v236 offset0:2 offset1:3
    v_mfma_f32_16x16x32_bf16 v[60:63], v[140:143], v[176:179], v[60:63]
    ds_read_b128 v[100:103], v244 offset:6144
    v_mfma_f32_16x16x32_bf16 v[60:63], v[144:147], v[172:175], v[60:63]
    ds_read2_b32 v[68:69], v236 offset0:128 offset1:129
    v_mfma_f32_16x16x32_bf16 v[60:63], v[148:151], v[168:171], v[60:63]
    ds_read2_b32 v[70:71], v236 offset0:130 offset1:131
    v_mfma_f32_16x16x32_bf16 v[60:63], v[152:155], v[164:167], v[60:63]
    ds_read_b128 v[104:107], v244 offset:10240
    v_mfma_f32_16x16x32_bf16 v[60:63], v[156:159], v[160:163], v[60:63]
    ds_read2_b32 v[72:73], v237 offset0:0 offset1:1
    v_mfma_f32_16x16x32_bf16 v[56:59], v[128:131], v[184:187], v[56:59]
    ds_read2_b32 v[74:75], v237 offset0:2 offset1:3
    v_mfma_f32_16x16x32_bf16 v[56:59], v[132:135], v[180:183], v[56:59]
    ds_read_b128 v[108:111], v244 offset:14336
    v_mfma_f32_16x16x32_bf16 v[56:59], v[136:139], v[176:179], v[56:59]
    ds_read2_b32 v[76:77], v237 offset0:128 offset1:129
    v_mfma_f32_16x16x32_bf16 v[56:59], v[140:143], v[172:175], v[56:59]
    ds_read2_b32 v[78:79], v237 offset0:130 offset1:131
    v_mfma_f32_16x16x32_bf16 v[56:59], v[144:147], v[168:171], v[56:59]
    ds_read_b128 v[112:115], v244 offset:18432
    v_mfma_f32_16x16x32_bf16 v[56:59], v[148:151], v[164:167], v[56:59]
    ds_read2_b32 v[80:81], v238 offset0:0 offset1:1
    v_cvt_pk_bf16_f32 v206, v60, v61
    v_mfma_f32_16x16x32_bf16 v[56:59], v[152:155], v[160:163], v[56:59]
    ds_read2_b32 v[82:83], v238 offset0:2 offset1:3
    v_mfma_f32_16x16x32_bf16 v[52:55], v[128:131], v[180:183], v[52:55]
    ds_read_b128 v[116:119], v244 offset:22528
    v_mfma_f32_16x16x32_bf16 v[52:55], v[132:135], v[176:179], v[52:55]
    ds_read2_b32 v[84:85], v238 offset0:128 offset1:129
    v_cvt_pk_bf16_f32 v207, v62, v63
    v_mfma_f32_16x16x32_bf16 v[52:55], v[136:139], v[172:175], v[52:55]
    ds_read2_b32 v[86:87], v238 offset0:130 offset1:131
    v_mfma_f32_16x16x32_bf16 v[52:55], v[140:143], v[168:171], v[52:55]
    buffer_store_dwordx2 v[206:207], v8, s[44:47], s6 offen offset:3584 sc1
    ds_read_b128 v[120:123], v244 offset:26624
    v_mfma_f32_16x16x32_bf16 v[52:55], v[144:147], v[164:167], v[52:55]
    ds_read2_b32 v[88:89], v239 offset0:0 offset1:1
    v_mfma_f32_16x16x32_bf16 v[52:55], v[148:151], v[160:163], v[52:55]
    ds_read2_b32 v[90:91], v239 offset0:2 offset1:3
    v_mfma_f32_16x16x32_bf16 v[48:51], v[128:131], v[176:179], v[48:51]
    s_waitcnt vmcnt(1)
    s_barrier
    v_cvt_pk_bf16_f32 v204, v56, v57
    v_mfma_f32_16x16x32_bf16 v[48:51], v[132:135], v[172:175], v[48:51]
    ds_read_b128 v[124:127], v244 offset:30720
    v_mfma_f32_16x16x32_bf16 v[48:51], v[136:139], v[168:171], v[48:51]
    ds_read_b64_tr_b16 a[80:81], v10 offset:16384
    v_mfma_f32_16x16x32_bf16 v[48:51], v[140:143], v[164:167], v[48:51]
    ds_read_b64_tr_b16 a[82:83], v10 offset:18432
    v_cvt_pk_bf16_f32 v205, v58, v59
    v_mfma_f32_16x16x32_bf16 v[48:51], v[144:147], v[160:163], v[48:51]
    ds_read_b64_tr_b16 a[88:89], v10 offset:20480
    v_mfma_f32_16x16x32_bf16 v[44:47], v[128:131], v[172:175], v[44:47]
    buffer_store_dwordx2 v[204:205], v8, s[44:47], s6 offen offset:3072 sc1
    ds_read2_b32 v[92:93], v239 offset0:128 offset1:129
    v_mfma_f32_16x16x32_bf16 v[44:47], v[132:135], v[168:171], v[44:47]
    ds_read_b64_tr_b16 a[90:91], v10 offset:22528
    v_mfma_f32_16x16x32_bf16 v[44:47], v[136:139], v[164:167], v[44:47]
    ds_read_b64_tr_b16 a[84:85], v11 offset:16384
    ds_read2_b32 v[94:95], v239 offset0:130 offset1:131
    v_mfma_f32_16x16x32_bf16 v[44:47], v[140:143], v[160:163], v[44:47]
    v_cvt_pk_bf16_f32 v202, v52, v53
    v_mfma_f32_16x16x32_bf16 v[40:43], v[128:131], v[168:171], v[40:43]
    ds_read_b64_tr_b16 a[86:87], v11 offset:18432
    v_mfma_f32_16x16x32_bf16 v[40:43], v[132:135], v[164:167], v[40:43]
    ds_read_b64_tr_b16 a[92:93], v11 offset:20480
    v_mfma_f32_16x16x32_bf16 v[40:43], v[136:139], v[160:163], v[40:43]
    v_cvt_pk_bf16_f32 v203, v54, v55
    v_mfma_f32_16x16x32_bf16 v[36:39], v[128:131], v[164:167], v[36:39]
    ds_read_b64_tr_b16 a[94:95], v11 offset:22528
    v_mfma_f32_16x16x32_bf16 v[36:39], v[132:135], v[160:163], v[36:39]
    buffer_store_dwordx2 v[202:203], v8, s[44:47], s6 offen offset:2560 sc1
    v_mfma_f32_16x16x32_bf16 v[32:35], v[128:131], v[160:163], v[32:35]
    s_waitcnt lgkmcnt(3)
    v_mfma_f32_16x16x32_bf16 v[60:63], v[64:67], v[124:127], 0
    ds_read_b128 v[160:163], v245 offset:2048
    s_waitcnt lgkmcnt(1)
    s_barrier
    v_mfma_f32_16x16x32_bf16 v[60:63], v[68:71], v[120:123], v[60:63]
    v_cvt_pk_bf16_f32 v200, v48, v49
    v_mfma_f32_16x16x32_bf16 v[60:63], v[72:75], v[116:119], v[60:63]
    ds_read2_b32 v[128:129], v236 offset0:16 offset1:17
    v_mfma_f32_16x16x32_bf16 v[60:63], v[76:79], v[112:115], v[60:63]
    ds_read2_b32 v[130:131], v236 offset0:18 offset1:19
    s_lshl_b32 s14, s90, 18
    v_cvt_pk_bf16_f32 v201, v50, v51
    v_mfma_f32_16x16x32_bf16 v[60:63], v[80:83], v[108:111], v[60:63]
    s_add_u32 m0, s73, 147456
    v_mfma_f32_16x16x32_bf16 v[60:63], v[84:87], v[104:107], v[60:63]
    buffer_load_dwordx4 v4, s[52:55], s14 offen offset:0 lds
    ds_read_b128 v[164:167], v245 offset:6144
    v_mfma_f32_16x16x32_bf16 v[60:63], v[88:91], v[100:103], v[60:63]
    buffer_store_dwordx2 v[200:201], v8, s[44:47], s6 offen offset:2048 sc1
    ds_read2_b32 v[132:133], v236 offset0:144 offset1:145
    v_mfma_f32_16x16x32_bf16 v[60:63], v[92:95], v[96:99], v[60:63]
    s_add_u32 s13, s12, 49152
    v_cvt_pk_bf16_f32 v198, v44, v45
    v_mfma_f32_16x16x32_bf16 v[56:59], v[64:67], v[120:123], 0
    ds_read2_b32 v[134:135], v236 offset0:146 offset1:147
    v_mfma_f32_16x16x32_bf16 v[56:59], v[68:71], v[116:119], v[56:59]
    s_add_u32 m0, s74, 8352
    ds_read_b128 v[168:171], v245 offset:10240
    v_mfma_f32_16x16x32_bf16 v[56:59], v[72:75], v[112:115], v[56:59]
    buffer_load_dwordx4 v240, s[48:51], s13 offen offset:0 lds
    v_cvt_pk_bf16_f32 v199, v46, v47
    v_mfma_f32_16x16x32_bf16 v[56:59], v[76:79], v[108:111], v[56:59]
    ds_read2_b32 v[136:137], v237 offset0:16 offset1:17
    v_mfma_f32_16x16x32_bf16 v[56:59], v[80:83], v[104:107], v[56:59]
    buffer_store_dwordx2 v[198:199], v8, s[44:47], s6 offen offset:1536 sc1
    ds_read2_b32 v[138:139], v237 offset0:18 offset1:19
    v_mfma_f32_16x16x32_bf16 v[56:59], v[84:87], v[100:103], v[56:59]
    ds_read_b128 v[172:175], v245 offset:14336
    v_mfma_f32_16x16x32_bf16 v[56:59], v[88:91], v[96:99], v[56:59]
    v_cvt_pk_bf16_f32 v196, v40, v41
    v_mfma_f32_16x16x32_bf16 v[52:55], v[64:67], v[116:119], 0
    ds_read2_b32 v[140:141], v237 offset0:144 offset1:145
    v_mfma_f32_16x16x32_bf16 v[52:55], v[68:71], v[112:115], v[52:55]
    ds_read2_b32 v[142:143], v237 offset0:146 offset1:147
    s_add_u32 m0, s73, 147456
    v_cvt_pk_bf16_f32 v197, v42, v43
    v_mfma_f32_16x16x32_bf16 v[52:55], v[72:75], v[108:111], v[52:55]
    buffer_load_dwordx4 v5, s[52:55], s14 offen offset:1024 lds
    v_mfma_f32_16x16x32_bf16 v[52:55], v[76:79], v[104:107], v[52:55]
    buffer_store_dwordx2 v[196:197], v8, s[44:47], s6 offen offset:1024 sc1
    ds_read_b128 v[176:179], v245 offset:18432
    s_add_u32 m0, s74, 8352
    v_mfma_f32_16x16x32_bf16 v[52:55], v[80:83], v[100:103], v[52:55]
    buffer_load_dwordx4 v240, s[48:51], s13 offen offset:1024 lds
    ds_read2_b32 v[144:145], v238 offset0:16 offset1:17
    v_mfma_f32_16x16x32_bf16 v[52:55], v[84:87], v[96:99], v[52:55]
    v_mfma_f32_16x16x32_bf16 v[48:51], v[64:67], v[112:115], 0
    ds_read2_b32 v[146:147], v238 offset0:18 offset1:19
    v_cvt_pk_bf16_f32 v194, v36, v37
    v_mfma_f32_16x16x32_bf16 v[48:51], v[68:71], v[108:111], v[48:51]
    ds_read_b128 v[180:183], v245 offset:22528
    v_mfma_f32_16x16x32_bf16 v[48:51], v[72:75], v[104:107], v[48:51]
    v_cvt_pk_bf16_f32 v195, v38, v39
    v_mfma_f32_16x16x32_bf16 v[48:51], v[76:79], v[100:103], v[48:51]
    buffer_store_dwordx2 v[194:195], v8, s[44:47], s6 offen offset:512 sc1
    ds_read2_b32 v[148:149], v238 offset0:144 offset1:145
    s_add_u32 m0, s74, 8352
    v_mfma_f32_16x16x32_bf16 v[48:51], v[80:83], v[96:99], v[48:51]
    buffer_load_dwordx4 v240, s[48:51], s13 offen offset:2048 lds
    ds_read2_b32 v[150:151], v238 offset0:146 offset1:147
    v_mfma_f32_16x16x32_bf16 v[44:47], v[64:67], v[108:111], 0
    ds_read_b128 v[184:187], v245 offset:26624
    v_mfma_f32_16x16x32_bf16 v[44:47], v[68:71], v[104:107], v[44:47]
    v_cvt_pk_bf16_f32 v192, v32, v33
    v_mfma_f32_16x16x32_bf16 v[44:47], v[72:75], v[100:103], v[44:47]
    s_add_u32 m0, s73, 147456
    ds_read2_b32 v[152:153], v239 offset0:16 offset1:17
    v_mfma_f32_16x16x32_bf16 v[44:47], v[76:79], v[96:99], v[44:47]
    buffer_load_dwordx4 v6, s[52:55], s14 offen offset:2048 lds
    v_cvt_pk_bf16_f32 v193, v34, v35
    v_mfma_f32_16x16x32_bf16 v[40:43], v[64:67], v[104:107], 0
    ds_read2_b32 v[154:155], v239 offset0:18 offset1:19
    v_mfma_f32_16x16x32_bf16 v[40:43], v[68:71], v[100:103], v[40:43]
    buffer_store_dwordx2 v[192:193], v8, s[44:47], s6 offen offset:0 sc1
    ds_read_b128 v[188:191], v245 offset:30720
    v_mfma_f32_16x16x32_bf16 v[40:43], v[72:75], v[96:99], v[40:43]
    s_add_u32 m0, s74, 8352
    ds_read2_b32 v[156:157], v239 offset0:144 offset1:145
    v_mfma_f32_16x16x32_bf16 v[36:39], v[64:67], v[100:103], 0
    buffer_load_dwordx4 v240, s[48:51], s13 offen offset:3072 lds
    v_mfma_f32_16x16x32_bf16 v[36:39], v[68:71], v[96:99], v[36:39]
    ds_read2_b32 v[158:159], v239 offset0:146 offset1:147
    v_mfma_f32_16x16x32_bf16 v[32:35], v[64:67], v[96:99], 0
    s_waitcnt lgkmcnt(12)
    v_mfma_f32_16x16x32_bf16 v[32:35], v[128:131], v[160:163], v[32:35]
    ds_read_b128 v[96:99], v246 offset:2048
    v_mfma_f32_16x16x32_bf16 v[36:39], v[132:135], v[160:163], v[36:39]
    v_mfma_f32_16x16x32_bf16 v[36:39], v[128:131], v[164:167], v[36:39]
    ds_read2_b32 v[64:65], v236 offset0:32 offset1:33
    v_mfma_f32_16x16x32_bf16 v[40:43], v[128:131], v[168:171], v[40:43]
    s_barrier
    ds_read2_b32 v[66:67], v236 offset0:34 offset1:35
    s_add_u32 m0, s73, 147456
    v_mfma_f32_16x16x32_bf16 v[40:43], v[132:135], v[164:167], v[40:43]
    buffer_load_dwordx4 v7, s[52:55], s14 offen offset:3072 lds
    v_mfma_f32_16x16x32_bf16 v[40:43], v[136:139], v[160:163], v[40:43]
    ds_read_b128 v[100:103], v246 offset:6144
    v_mfma_f32_16x16x32_bf16 v[44:47], v[140:143], v[160:163], v[44:47]
    ds_read2_b32 v[68:69], v236 offset0:160 offset1:161
    v_mfma_f32_16x16x32_bf16 v[44:47], v[136:139], v[164:167], v[44:47]
    v_mfma_f32_16x16x32_bf16 v[44:47], v[132:135], v[168:171], v[44:47]
    ds_read2_b32 v[70:71], v236 offset0:162 offset1:163
    v_mfma_f32_16x16x32_bf16 v[44:47], v[128:131], v[172:175], v[44:47]
    ds_read_b128 v[104:107], v246 offset:10240
    s_waitcnt lgkmcnt(7)
    v_mfma_f32_16x16x32_bf16 v[48:51], v[128:131], v[176:179], v[48:51]
    ds_read2_b32 v[72:73], v237 offset0:32 offset1:33
    v_mfma_f32_16x16x32_bf16 v[48:51], v[132:135], v[172:175], v[48:51]
    ds_read2_b32 v[74:75], v237 offset0:34 offset1:35
    v_mfma_f32_16x16x32_bf16 v[48:51], v[136:139], v[168:171], v[48:51]
    v_mov_b32 v9, 24
    buffer_load_ushort v9, v9, s[56:59], s70 offen
    v_mfma_f32_16x16x32_bf16 v[48:51], v[140:143], v[164:167], v[48:51]
    ds_read_b128 v[108:111], v246 offset:14336
    v_mfma_f32_16x16x32_bf16 v[48:51], v[144:147], v[160:163], v[48:51]
    v_mfma_f32_16x16x32_bf16 v[52:55], v[148:151], v[160:163], v[52:55]
    ds_read2_b32 v[76:77], v237 offset0:160 offset1:161
    v_mfma_f32_16x16x32_bf16 v[52:55], v[144:147], v[164:167], v[52:55]
    ds_read2_b32 v[78:79], v237 offset0:162 offset1:163
    v_mfma_f32_16x16x32_bf16 v[52:55], v[140:143], v[168:171], v[52:55]
    v_mfma_f32_16x16x32_bf16 v[52:55], v[136:139], v[172:175], v[52:55]
    s_lshl_b32 s14, s91, 18
    ds_read_b128 v[112:115], v246 offset:18432
    v_mfma_f32_16x16x32_bf16 v[52:55], v[132:135], v[176:179], v[52:55]
    s_add_u32 m0, s73, 0
    ds_read2_b32 v[80:81], v238 offset0:32 offset1:33
    v_mfma_f32_16x16x32_bf16 v[52:55], v[128:131], v[180:183], v[52:55]
    buffer_load_dwordx4 v4, s[52:55], s14 offen offset:0 lds
    v_mfma_f32_16x16x32_bf16 v[56:59], v[128:131], v[184:187], v[56:59]
    ds_read2_b32 v[82:83], v238 offset0:34 offset1:35
    v_mfma_f32_16x16x32_bf16 v[56:59], v[132:135], v[180:183], v[56:59]
    ds_read_b128 v[116:119], v246 offset:22528
    v_mfma_f32_16x16x32_bf16 v[56:59], v[136:139], v[176:179], v[56:59]
    v_mfma_f32_16x16x32_bf16 v[56:59], v[140:143], v[172:175], v[56:59]
    ds_read2_b32 v[84:85], v238 offset0:160 offset1:161
    v_mfma_f32_16x16x32_bf16 v[56:59], v[144:147], v[168:171], v[56:59]
    ds_read2_b32 v[86:87], v238 offset0:162 offset1:163
    v_mfma_f32_16x16x32_bf16 v[56:59], v[148:151], v[164:167], v[56:59]
    ds_read_b128 v[120:123], v246 offset:26624
    v_mfma_f32_16x16x32_bf16 v[56:59], v[152:155], v[160:163], v[56:59]
    v_mfma_f32_16x16x32_bf16 v[60:63], v[156:159], v[160:163], v[60:63]
    ds_read2_b32 v[88:89], v239 offset0:32 offset1:33
    v_mfma_f32_16x16x32_bf16 v[60:63], v[152:155], v[164:167], v[60:63]
    ds_read2_b32 v[90:91], v239 offset0:34 offset1:35
    v_mfma_f32_16x16x32_bf16 v[60:63], v[148:151], v[168:171], v[60:63]
    s_add_u32 m0, s73, 0
    v_mfma_f32_16x16x32_bf16 v[60:63], v[144:147], v[172:175], v[60:63]
    buffer_load_dwordx4 v5, s[52:55], s14 offen offset:1024 lds
    ds_read_b128 v[124:127], v246 offset:30720
    v_mfma_f32_16x16x32_bf16 v[60:63], v[140:143], v[176:179], v[60:63]
    ds_read2_b32 v[92:93], v239 offset0:160 offset1:161
    v_mfma_f32_16x16x32_bf16 v[60:63], v[136:139], v[180:183], v[60:63]
    v_mfma_f32_16x16x32_bf16 v[60:63], v[132:135], v[184:187], v[60:63]
    ds_read2_b32 v[94:95], v239 offset0:162 offset1:163
    v_mfma_f32_16x16x32_bf16 v[60:63], v[128:131], v[188:191], v[60:63]
    s_waitcnt lgkmcnt(12)
    v_mfma_f32_16x16x32_bf16 v[32:35], v[64:67], v[96:99], v[32:35]
    ds_read_b128 v[160:163], v247 offset:2048
    v_mfma_f32_16x16x32_bf16 v[36:39], v[68:71], v[96:99], v[36:39]
    v_mfma_f32_16x16x32_bf16 v[36:39], v[64:67], v[100:103], v[36:39]
    ds_read2_b32 v[128:129], v236 offset0:48 offset1:49
    v_mfma_f32_16x16x32_bf16 v[40:43], v[64:67], v[104:107], v[40:43]
    ds_read2_b32 v[130:131], v236 offset0:50 offset1:51
    v_mfma_f32_16x16x32_bf16 v[40:43], v[68:71], v[100:103], v[40:43]
    v_mfma_f32_16x16x32_bf16 v[40:43], v[72:75], v[96:99], v[40:43]
    ds_read_b128 v[164:167], v247 offset:6144
    v_mfma_f32_16x16x32_bf16 v[44:47], v[76:79], v[96:99], v[44:47]
    s_add_u32 m0, s73, 0
    ds_read2_b32 v[132:133], v236 offset0:176 offset1:177
    v_mfma_f32_16x16x32_bf16 v[44:47], v[72:75], v[100:103], v[44:47]
    buffer_load_dwordx4 v6, s[52:55], s14 offen offset:2048 lds
    v_mfma_f32_16x16x32_bf16 v[44:47], v[68:71], v[104:107], v[44:47]
    ds_read2_b32 v[134:135], v236 offset0:178 offset1:179
    v_mfma_f32_16x16x32_bf16 v[44:47], v[64:67], v[108:111], v[44:47]
    ds_read_b128 v[168:171], v247 offset:10240
    s_waitcnt lgkmcnt(7)
    v_mfma_f32_16x16x32_bf16 v[48:51], v[64:67], v[112:115], v[48:51]
    ds_read2_b32 v[136:137], v237 offset0:48 offset1:49
    v_mfma_f32_16x16x32_bf16 v[48:51], v[68:71], v[108:111], v[48:51]
    v_mfma_f32_16x16x32_bf16 v[48:51], v[72:75], v[104:107], v[48:51]
    ds_read2_b32 v[138:139], v237 offset0:50 offset1:51
    v_mfma_f32_16x16x32_bf16 v[48:51], v[76:79], v[100:103], v[48:51]
L_pl_X_4:
    s_cbranch_execz L_wret
    ds_read_b128 v[172:175], v247 offset:14336
    v_mfma_f32_16x16x32_bf16 v[48:51], v[80:83], v[96:99], v[48:51]
    v_mfma_f32_16x16x32_bf16 v[52:55], v[84:87], v[96:99], v[52:55]
    ds_read2_b32 v[140:141], v237 offset0:176 offset1:177
    v_mfma_f32_16x16x32_bf16 v[52:55], v[80:83], v[100:103], v[52:55]
    ds_read2_b32 v[142:143], v237 offset0:178 offset1:179
    v_mfma_f32_16x16x32_bf16 v[52:55], v[76:79], v[104:107], v[52:55]
    v_mfma_f32_16x16x32_bf16 v[52:55], v[72:75], v[108:111], v[52:55]
    s_add_u32 m0, s73, 0
    ds_read_b128 v[176:179], v247 offset:18432
    v_mfma_f32_16x16x32_bf16 v[52:55], v[68:71], v[112:115], v[52:55]
    buffer_load_dwordx4 v7, s[52:55], s14 offen offset:3072 lds
    ds_read2_b32 v[144:145], v238 offset0:48 offset1:49
    v_mfma_f32_16x16x32_bf16 v[52:55], v[64:67], v[116:119], v[52:55]
    v_mfma_f32_16x16x32_bf16 v[56:59], v[64:67], v[120:123], v[56:59]
    ds_read2_b32 v[146:147], v238 offset0:50 offset1:51
    v_mfma_f32_16x16x32_bf16 v[56:59], v[68:71], v[116:119], v[56:59]
    ds_read_b128 v[180:183], v247 offset:22528
    v_mfma_f32_16x16x32_bf16 v[56:59], v[72:75], v[112:115], v[56:59]
    v_mfma_f32_16x16x32_bf16 v[56:59], v[76:79], v[108:111], v[56:59]
    ds_read2_b32 v[148:149], v238 offset0:176 offset1:177
    v_mfma_f32_16x16x32_bf16 v[56:59], v[80:83], v[104:107], v[56:59]
    ds_read2_b32 v[150:151], v238 offset0:178 offset1:179
    v_mfma_f32_16x16x32_bf16 v[56:59], v[84:87], v[100:103], v[56:59]
    ds_read_b128 v[184:187], v247 offset:26624
    v_mfma_f32_16x16x32_bf16 v[56:59], v[88:91], v[96:99], v[56:59]
    v_mfma_f32_16x16x32_bf16 v[60:63], v[92:95], v[96:99], v[60:63]
    s_lshl_b32 s14, s92, 18
    ds_read2_b32 v[152:153], v239 offset0:48 offset1:49
    v_mfma_f32_16x16x32_bf16 v[60:63], v[88:91], v[100:103], v[60:63]
    s_add_u32 m0, s73, 16384
    ds_read2_b32 v[154:155], v239 offset0:50 offset1:51
    v_mfma_f32_16x16x32_bf16 v[60:63], v[84:87], v[104:107], v[60:63]
    buffer_load_dwordx4 v4, s[52:55], s14 offen offset:0 lds
    v_mfma_f32_16x16x32_bf16 v[60:63], v[80:83], v[108:111], v[60:63]
    ds_read_b128 v[188:191], v247 offset:30720
    v_mfma_f32_16x16x32_bf16 v[60:63], v[76:79], v[112:115], v[60:63]
    ds_read2_b32 v[156:157], v239 offset0:176 offset1:177
    v_mfma_f32_16x16x32_bf16 v[60:63], v[72:75], v[116:119], v[60:63]
    v_mfma_f32_16x16x32_bf16 v[60:63], v[68:71], v[120:123], v[60:63]
    ds_read2_b32 v[158:159], v239 offset0:178 offset1:179
    v_mfma_f32_16x16x32_bf16 v[60:63], v[64:67], v[124:127], v[60:63]
    s_waitcnt lgkmcnt(12)
    v_mfma_f32_16x16x32_bf16 v[32:35], v[128:131], v[160:163], v[32:35]
    ds_read_b128 v[96:99], v244 offset:0
    v_mfma_f32_16x16x32_bf16 v[36:39], v[132:135], v[160:163], v[36:39]
    ds_read2_b32 v[64:65], v236 offset0:64 offset1:65
    v_mfma_f32_16x16x32_bf16 v[36:39], v[128:131], v[164:167], v[36:39]
    ds_read2_b32 v[66:67], v236 offset0:66 offset1:67
    v_mfma_f32_16x16x32_bf16 v[40:43], v[128:131], v[168:171], v[40:43]
    ds_read_b128 v[100:103], v244 offset:4096
    v_mfma_f32_16x16x32_bf16 v[40:43], v[132:135], v[164:167], v[40:43]
    ds_read2_b32 v[68:69], v236 offset0:192 offset1:193
    v_mfma_f32_16x16x32_bf16 v[40:43], v[136:139], v[160:163], v[40:43]
    s_add_u32 m0, s73, 16384
    ds_read2_b32 v[70:71], v236 offset0:194 offset1:195
    v_mfma_f32_16x16x32_bf16 v[44:47], v[140:143], v[160:163], v[44:47]
    buffer_load_dwordx4 v5, s[52:55], s14 offen offset:1024 lds
    ds_read_b128 v[104:107], v244 offset:8192
    v_mfma_f32_16x16x32_bf16 v[44:47], v[136:139], v[164:167], v[44:47]
    ds_read2_b32 v[72:73], v237 offset0:64 offset1:65
    s_waitcnt vmcnt(7)
    s_barrier
    v_mfma_f32_16x16x32_bf16 v[44:47], v[132:135], v[168:171], v[44:47]
    ds_read_b64_tr_b16 a[96:97], v10 offset:16384
    v_mfma_f32_16x16x32_bf16 v[44:47], v[128:131], v[172:175], v[44:47]
    ds_read2_b32 v[74:75], v237 offset0:66 offset1:67
    s_waitcnt lgkmcnt(10)
    v_mfma_f32_16x16x32_bf16 v[48:51], v[128:131], v[176:179], v[48:51]
    ds_read_b64_tr_b16 a[98:99], v10 offset:18432
    v_mfma_f32_16x16x32_bf16 v[48:51], v[132:135], v[172:175], v[48:51]
    ds_read_b64_tr_b16 a[104:105], v10 offset:20480
    v_mfma_f32_16x16x32_bf16 v[48:51], v[136:139], v[168:171], v[48:51]
    ds_read_b64_tr_b16 a[106:107], v10 offset:22528
    v_mfma_f32_16x16x32_bf16 v[48:51], v[140:143], v[164:167], v[48:51]
    ds_read_b128 v[108:111], v244 offset:12288
    v_mfma_f32_16x16x32_bf16 v[48:51], v[144:147], v[160:163], v[48:51]
    ds_read_b64_tr_b16 a[100:101], v11 offset:16384
    v_mfma_f32_16x16x32_bf16 v[52:55], v[148:151], v[160:163], v[52:55]
    ds_read_b64_tr_b16 a[102:103], v11 offset:18432
    v_mfma_f32_16x16x32_bf16 v[52:55], v[144:147], v[164:167], v[52:55]
    ds_read2_b32 v[76:77], v237 offset0:192 offset1:193
    v_mfma_f32_16x16x32_bf16 v[52:55], v[140:143], v[168:171], v[52:55]
    ds_read_b64_tr_b16 a[108:109], v11 offset:20480
    s_add_u32 m0, s73, 16384
    v_mfma_f32_16x16x32_bf16 v[52:55], v[136:139], v[172:175], v[52:55]
    ds_read_b64_tr_b16 a[110:111], v11 offset:22528
    buffer_load_dwordx4 v6, s[52:55], s14 offen offset:2048 lds
    v_mfma_f32_16x16x32_bf16 v[52:55], v[132:135], v[176:179], v[52:55]
    ds_read2_b32 v[78:79], v237 offset0:194 offset1:195
    v_mfma_f32_16x16x32_bf16 v[52:55], v[128:131], v[180:183], v[52:55]
    ds_read_b128 v[112:115], v244 offset:16384
    v_mfma_f32_16x16x32_bf16 v[56:59], v[128:131], v[184:187], v[56:59]
    ds_read2_b32 v[80:81], v238 offset0:64 offset1:65
    v_mfma_f32_16x16x32_bf16 v[56:59], v[132:135], v[180:183], v[56:59]
    ds_read2_b32 v[82:83], v238 offset0:66 offset1:67
    v_mfma_f32_16x16x32_bf16 v[56:59], v[136:139], v[176:179], v[56:59]
    ds_read_b128 v[116:119], v244 offset:20480
    v_mfma_f32_16x16x32_bf16 v[56:59], v[140:143], v[172:175], v[56:59]
    ds_read2_b32 v[84:85], v238 offset0:192 offset1:193
    v_mfma_f32_16x16x32_bf16 v[56:59], v[144:147], v[168:171], v[56:59]
    ds_read2_b32 v[86:87], v238 offset0:194 offset1:195
    v_mfma_f32_16x16x32_bf16 v[56:59], v[148:151], v[164:167], v[56:59]
    ds_read_b128 v[120:123], v244 offset:24576
    v_mfma_f32_16x16x32_bf16 v[56:59], v[152:155], v[160:163], v[56:59]
    v_mfma_f32_16x16x32_bf16 v[60:63], v[156:159], v[160:163], v[60:63]
    s_add_u32 m0, s73, 16384
    ds_read2_b32 v[88:89], v239 offset0:64 offset1:65
    v_mfma_f32_16x16x32_bf16 v[60:63], v[152:155], v[164:167], v[60:63]
    buffer_load_dwordx4 v7, s[52:55], s14 offen offset:3072 lds
    ds_read2_b32 v[90:91], v239 offset0:66 offset1:67
    v_mfma_f32_16x16x32_bf16 v[60:63], v[148:151], v[168:171], v[60:63]
    v_mfma_f32_16x16x32_bf16 v[60:63], v[144:147], v[172:175], v[60:63]
    ds_read_b128 v[124:127], v244 offset:28672
    v_mfma_f32_16x16x32_bf16 v[60:63], v[140:143], v[176:179], v[60:63]
    ds_read2_b32 v[92:93], v239 offset0:192 offset1:193
    v_mfma_f32_16x16x32_bf16 v[60:63], v[136:139], v[180:183], v[60:63]
    v_mfma_f32_16x16x32_bf16 v[60:63], v[132:135], v[184:187], v[60:63]
    ds_read2_b32 v[94:95], v239 offset0:194 offset1:195
    v_mfma_f32_16x16x32_bf16 v[60:63], v[128:131], v[188:191], v[60:63]
    s_waitcnt lgkmcnt(12)
    v_mfma_f32_16x16x32_bf16 v[32:35], v[64:67], v[96:99], v[32:35]
    ds_read_b128 v[160:163], v245 offset:0
    v_mfma_f32_16x16x32_bf16 v[36:39], v[68:71], v[96:99], v[36:39]
    ds_read2_b32 v[128:129], v236 offset0:80 offset1:81
    v_mfma_f32_16x16x32_bf16 v[36:39], v[64:67], v[100:103], v[36:39]
    ds_read2_b32 v[130:131], v236 offset0:82 offset1:83
    v_mfma_f32_16x16x32_bf16 v[40:43], v[64:67], v[104:107], v[40:43]
    ds_read_b128 v[164:167], v245 offset:4096
    s_barrier
    v_mfma_f32_16x16x32_bf16 v[40:43], v[68:71], v[100:103], v[40:43]
    ds_read2_b32 v[132:133], v236 offset0:208 offset1:209
    v_mfma_f32_16x16x32_bf16 v[40:43], v[72:75], v[96:99], v[40:43]
    ds_read2_b32 v[134:135], v236 offset0:210 offset1:211
    v_mfma_f32_16x16x32_bf16 v[44:47], v[76:79], v[96:99], v[44:47]
    ds_read_b128 v[168:171], v245 offset:8192
    v_mfma_f32_16x16x32_bf16 v[44:47], v[72:75], v[100:103], v[44:47]
    s_lshl_b32 s14, s93, 18
    ds_read2_b32 v[136:137], v237 offset0:80 offset1:81
    v_mfma_f32_16x16x32_bf16 v[44:47], v[68:71], v[104:107], v[44:47]
    s_add_u32 m0, s73, 147456
    ds_read2_b32 v[138:139], v237 offset0:82 offset1:83
    v_mfma_f32_16x16x32_bf16 v[44:47], v[64:67], v[108:111], v[44:47]
    buffer_load_dwordx4 v4, s[52:55], s14 offen offset:0 lds
    ds_read_b128 v[172:175], v245 offset:12288
    s_waitcnt lgkmcnt(10)
    v_mfma_f32_16x16x32_bf16 v[48:51], v[64:67], v[112:115], v[48:51]
    ds_read2_b32 v[140:141], v237 offset0:208 offset1:209
    v_mfma_f32_16x16x32_bf16 v[48:51], v[68:71], v[108:111], v[48:51]
    ds_read2_b32 v[142:143], v237 offset0:210 offset1:211
    v_mfma_f32_16x16x32_bf16 v[48:51], v[72:75], v[104:107], v[48:51]
    ds_read_b128 v[176:179], v245 offset:16384
    v_mfma_f32_16x16x32_bf16 v[48:51], v[76:79], v[100:103], v[48:51]
    ds_read2_b32 v[144:145], v238 offset0:80 offset1:81
    v_mfma_f32_16x16x32_bf16 v[48:51], v[80:83], v[96:99], v[48:51]
    ds_read2_b32 v[146:147], v238 offset0:82 offset1:83
    v_mfma_f32_16x16x32_bf16 v[52:55], v[84:87], v[96:99], v[52:55]
    ds_read_b128 v[180:183], v245 offset:20480
    v_mfma_f32_16x16x32_bf16 v[52:55], v[80:83], v[100:103], v[52:55]
    ds_read2_b32 v[148:149], v238 offset0:208 offset1:209
    v_mfma_f32_16x16x32_bf16 v[52:55], v[76:79], v[104:107], v[52:55]
    ds_read2_b32 v[150:151], v238 offset0:210 offset1:211
    v_mfma_f32_16x16x32_bf16 v[52:55], v[72:75], v[108:111], v[52:55]
    ds_read_b128 v[184:187], v245 offset:24576
    v_mfma_f32_16x16x32_bf16 v[52:55], v[68:71], v[112:115], v[52:55]
    s_add_u32 m0, s73, 147456
    ds_read_b128 v[212:215], v241 offset:8352
    v_mfma_f32_16x16x32_bf16 v[52:55], v[64:67], v[116:119], v[52:55]
    buffer_load_dwordx4 v5, s[52:55], s14 offen offset:1024 lds
    ds_read2_b32 v[152:153], v239 offset0:80 offset1:81
    v_mfma_f32_16x16x32_bf16 v[56:59], v[64:67], v[120:123], v[56:59]
    ds_read_b32 v216, v241 offset:8368
    v_mfma_f32_16x16x32_bf16 v[56:59], v[68:71], v[116:119], v[56:59]
    ds_read_b128 v[218:221], v241 offset:9376
    v_mfma_f32_16x16x32_bf16 v[56:59], v[72:75], v[112:115], v[56:59]
    ds_read_b32 v222, v241 offset:9392
    v_mfma_f32_16x16x32_bf16 v[56:59], v[76:79], v[108:111], v[56:59]
    ds_read_b128 v[224:227], v241 offset:10400
    v_mfma_f32_16x16x32_bf16 v[56:59], v[80:83], v[104:107], v[56:59]
    ds_read_b32 v228, v241 offset:10416
    s_waitcnt vmcnt(6)
    s_barrier
    v_mfma_f32_16x16x32_bf16 v[56:59], v[84:87], v[100:103], v[56:59]
    ds_read_b128 v[230:233], v241 offset:11424
    v_add_u32 v10, -131072, v10
    v_mfma_f32_16x16x32_bf16 v[56:59], v[88:91], v[96:99], v[56:59]
    ds_read_b64_tr_b16 a[112:113], v10 offset:0
    v_mfma_f32_16x16x32_bf16 v[60:63], v[92:95], v[96:99], v[60:63]
    ds_read_b64_tr_b16 a[114:115], v10 offset:2048
    v_mfma_f32_16x16x32_bf16 v[60:63], v[88:91], v[100:103], v[60:63]
    ds_read_b64_tr_b16 a[120:121], v10 offset:4096
    ds_read2_b32 v[154:155], v239 offset0:82 offset1:83
    v_mfma_f32_16x16x32_bf16 v[60:63], v[84:87], v[104:107], v[60:63]
    ds_read_b32 v234, v241 offset:11440
    v_mfma_f32_16x16x32_bf16 v[60:63], v[80:83], v[108:111], v[60:63]
    ds_read_b64_tr_b16 a[122:123], v10 offset:6144
    s_add_u32 m0, s73, 147456
    ds_read_b128 v[188:191], v245 offset:28672
    v_mfma_f32_16x16x32_bf16 v[60:63], v[76:79], v[112:115], v[60:63]
    v_add_u32 v11, -131072, v11
    buffer_load_dwordx4 v6, s[52:55], s14 offen offset:2048 lds
    ds_read2_b32 v[156:157], v239 offset0:208 offset1:209
    v_mfma_f32_16x16x32_bf16 v[60:63], v[72:75], v[116:119], v[60:63]
    ds_read_b64_tr_b16 a[116:117], v11 offset:0
    v_mfma_f32_16x16x32_bf16 v[60:63], v[68:71], v[120:123], v[60:63]
    ds_read_b64_tr_b16 a[118:119], v11 offset:2048
    ds_read2_b32 v[158:159], v239 offset0:210 offset1:211
    v_mfma_f32_16x16x32_bf16 v[60:63], v[64:67], v[124:127], v[60:63]
    ds_read_b64_tr_b16 a[124:125], v11 offset:4096
    s_waitcnt lgkmcnt(15)
    v_mfma_f32_16x16x32_bf16 v[32:35], v[128:131], v[160:163], v[32:35]
    ds_read_b64_tr_b16 a[126:127], v11 offset:6144
    v_mfma_f32_16x16x32_bf16 v[36:39], v[132:135], v[160:163], v[36:39]
    ds_read_b128 v[96:99], v246 offset:0
    v_mfma_f32_16x16x32_bf16 v[36:39], v[128:131], v[164:167], v[36:39]
    ds_read2_b32 v[64:65], v236 offset0:96 offset1:97
    v_mfma_f32_16x16x32_bf16 v[40:43], v[128:131], v[168:171], v[40:43]
    ds_read2_b32 v[66:67], v236 offset0:98 offset1:99
    v_mfma_f32_16x16x32_bf16 v[40:43], v[132:135], v[164:167], v[40:43]
    s_waitcnt lgkmcnt(11)
    v_mfma_f32_16x16x32_bf16 v[40:43], v[136:139], v[160:163], v[40:43]
    ds_read_b128 v[100:103], v246 offset:4096
    v_mfma_f32_16x16x32_bf16 v[44:47], v[140:143], v[160:163], v[44:47]
    ds_read2_b32 v[68:69], v236 offset0:224 offset1:225
    v_mfma_f32_16x16x32_bf16 v[44:47], v[136:139], v[164:167], v[44:47]
    s_add_u32 m0, s73, 147456
    ds_read2_b32 v[70:71], v236 offset0:226 offset1:227
    v_mfma_f32_16x16x32_bf16 v[44:47], v[132:135], v[168:171], v[44:47]
    buffer_load_dwordx4 v7, s[52:55], s14 offen offset:3072 lds
    v_lshlrev_b32 v9, 16, v9
    v_mfma_f32_16x16x32_bf16 v[44:47], v[128:131], v[172:175], v[44:47]
    ds_read_b128 v[104:107], v246 offset:8192
    s_waitcnt lgkmcnt(9)
    v_mfma_f32_16x16x32_bf16 v[48:51], v[128:131], v[176:179], v[48:51]
    ds_read2_b32 v[72:73], v237 offset0:96 offset1:97
    v_lshlrev_b32 v208, 16, v212
    v_mfma_f32_16x16x32_bf16 v[48:51], v[132:135], v[172:175], v[48:51]
    v_mfma_f32_16x16x32_bf16 v[48:51], v[136:139], v[168:171], v[48:51]
    ds_read2_b32 v[74:75], v237 offset0:98 offset1:99
    v_add_f32 v9, v9, v208
    v_mfma_f32_16x16x32_bf16 v[48:51], v[140:143], v[164:167], v[48:51]
    ds_read_b128 v[108:111], v246 offset:12288
    v_cvt_pk_bf16_f32 v9, v9, v9
    v_mfma_f32_16x16x32_bf16 v[48:51], v[144:147], v[160:163], v[48:51]
    ds_read2_b32 v[76:77], v237 offset0:224 offset1:225
    s_waitcnt lgkmcnt(11)
    s_barrier
    v_mfma_f32_16x16x32_bf16 v[52:55], v[148:151], v[160:163], v[52:55]
    ds_write_b16 v242, v9 offset:12480
    v_mfma_f32_16x16x32_bf16 v[52:55], v[144:147], v[164:167], v[52:55]
    ds_read2_b32 v[78:79], v237 offset0:226 offset1:227
    v_mfma_f32_16x16x32_bf16 v[52:55], v[140:143], v[168:171], v[52:55]
    ds_write_b16 v242, v9 offset:8322
    v_mfma_f32_16x16x32_bf16 v[52:55], v[136:139], v[172:175], v[52:55]
    s_lshl_b32 s14, s94, 18
    ds_read_b128 v[112:115], v246 offset:16384
    v_mfma_f32_16x16x32_bf16 v[52:55], v[132:135], v[176:179], v[52:55]
    ds_read2_b32 v[80:81], v238 offset0:96 offset1:97
    s_add_u32 m0, s73, 0
    v_alignbit_b32 v212, v213, v212, 16
    v_mfma_f32_16x16x32_bf16 v[52:55], v[128:131], v[180:183], v[52:55]
    buffer_load_dwordx4 v4, s[52:55], s14 offen offset:0 lds
    v_alignbit_b32 v213, v214, v213, 16
    v_mfma_f32_16x16x32_bf16 v[56:59], v[128:131], v[184:187], v[56:59]
    ds_read2_b32 v[82:83], v238 offset0:98 offset1:99
    v_mfma_f32_16x16x32_bf16 v[56:59], v[132:135], v[180:183], v[56:59]
    ds_read_b128 v[116:119], v246 offset:20480
    v_alignbit_b32 v214, v215, v214, 16
    v_mfma_f32_16x16x32_bf16 v[56:59], v[136:139], v[176:179], v[56:59]
    v_mfma_f32_16x16x32_bf16 v[56:59], v[140:143], v[172:175], v[56:59]
    ds_read2_b32 v[84:85], v238 offset0:224 offset1:225
    v_alignbit_b32 v215, v216, v215, 16
    v_mfma_f32_16x16x32_bf16 v[56:59], v[144:147], v[168:171], v[56:59]
    ds_read2_b32 v[86:87], v238 offset0:226 offset1:227
    v_mfma_f32_16x16x32_bf16 v[56:59], v[148:151], v[164:167], v[56:59]
    ds_write_b128 v241, v[212:215] offset:12512
    v_mfma_f32_16x16x32_bf16 v[56:59], v[152:155], v[160:163], v[56:59]
    ds_read_b128 v[120:123], v246 offset:24576
    v_mfma_f32_16x16x32_bf16 v[60:63], v[156:159], v[160:163], v[60:63]
    ds_read2_b32 v[88:89], v239 offset0:96 offset1:97
    v_alignbit_b32 v218, v219, v218, 16
    v_mfma_f32_16x16x32_bf16 v[60:63], v[152:155], v[164:167], v[60:63]
    ds_read2_b32 v[90:91], v239 offset0:98 offset1:99
    v_alignbit_b32 v219, v220, v219, 16
    v_mfma_f32_16x16x32_bf16 v[60:63], v[148:151], v[168:171], v[60:63]
    s_add_u32 m0, s73, 0
    ds_read_b128 v[124:127], v246 offset:28672
    v_mfma_f32_16x16x32_bf16 v[60:63], v[144:147], v[172:175], v[60:63]
    buffer_load_dwordx4 v5, s[52:55], s14 offen offset:1024 lds
    v_alignbit_b32 v220, v221, v220, 16
    v_mfma_f32_16x16x32_bf16 v[60:63], v[140:143], v[176:179], v[60:63]
    ds_read2_b32 v[92:93], v239 offset0:224 offset1:225
    v_mfma_f32_16x16x32_bf16 v[60:63], v[136:139], v[180:183], v[60:63]
    ds_read2_b32 v[94:95], v239 offset0:226 offset1:227
    v_alignbit_b32 v221, v222, v221, 16
    v_mfma_f32_16x16x32_bf16 v[60:63], v[132:135], v[184:187], v[60:63]
    ds_write_b128 v241, v[218:221] offset:13536
    v_mfma_f32_16x16x32_bf16 v[60:63], v[128:131], v[188:191], v[60:63]
    s_waitcnt lgkmcnt(15)
    v_mfma_f32_16x16x32_bf16 v[32:35], v[64:67], v[96:99], v[32:35]
    ds_read_b128 v[160:163], v247 offset:0
    s_waitcnt vmcnt(6)
    s_barrier
    v_mfma_f32_16x16x32_bf16 v[36:39], v[68:71], v[96:99], v[36:39]
    ds_read_b64_tr_b16 a[128:129], v10 offset:16384
    v_alignbit_b32 v224, v225, v224, 16
    v_mfma_f32_16x16x32_bf16 v[36:39], v[64:67], v[100:103], v[36:39]
    ds_read_b64_tr_b16 a[130:131], v10 offset:18432
    ds_read_b128 v[164:167], v247 offset:4096
    v_mfma_f32_16x16x32_bf16 v[40:43], v[64:67], v[104:107], v[40:43]
    ds_read_b128 v[168:171], v247 offset:8192
    v_mfma_f32_16x16x32_bf16 v[40:43], v[68:71], v[100:103], v[40:43]
    ds_read_b64_tr_b16 a[136:137], v10 offset:20480
    ds_read_b128 v[172:175], v247 offset:12288
    v_mfma_f32_16x16x32_bf16 v[40:43], v[72:75], v[96:99], v[40:43]
    ds_read_b64_tr_b16 a[138:139], v10 offset:22528
    v_alignbit_b32 v225, v226, v225, 16
    v_mfma_f32_16x16x32_bf16 v[44:47], v[76:79], v[96:99], v[44:47]
    s_add_u32 m0, s73, 0
    ds_read_b128 v[176:179], v247 offset:16384
    v_mfma_f32_16x16x32_bf16 v[44:47], v[72:75], v[100:103], v[44:47]
    ds_read_b64_tr_b16 a[132:133], v11 offset:16384
    buffer_load_dwordx4 v6, s[52:55], s14 offen offset:2048 lds
    ds_read_b128 v[180:183], v247 offset:20480
    v_mfma_f32_16x16x32_bf16 v[44:47], v[68:71], v[104:107], v[44:47]
    ds_read_b64_tr_b16 a[134:135], v11 offset:18432
    v_mfma_f32_16x16x32_bf16 v[44:47], v[64:67], v[108:111], v[44:47]
    ds_read_b128 v[184:187], v247 offset:24576
    v_alignbit_b32 v226, v227, v226, 16
    s_waitcnt lgkmcnt(14)
    v_mfma_f32_16x16x32_bf16 v[48:51], v[64:67], v[112:115], v[48:51]
    ds_read_b64_tr_b16 a[140:141], v11 offset:20480
    ds_read_b128 v[188:191], v247 offset:28672
    v_mfma_f32_16x16x32_bf16 v[48:51], v[68:71], v[108:111], v[48:51]
    ds_read_b64_tr_b16 a[142:143], v11 offset:22528
    v_mfma_f32_16x16x32_bf16 v[48:51], v[72:75], v[104:107], v[48:51]
    ds_read2_b32 v[128:129], v236 offset0:112 offset1:113
    v_alignbit_b32 v227, v228, v227, 16
    v_mfma_f32_16x16x32_bf16 v[48:51], v[76:79], v[100:103], v[48:51]
    ds_read2_b32 v[130:131], v236 offset0:114 offset1:115
    v_mfma_f32_16x16x32_bf16 v[48:51], v[80:83], v[96:99], v[48:51]
    ds_read2_b32 v[132:133], v236 offset0:240 offset1:241
    v_mfma_f32_16x16x32_bf16 v[52:55], v[84:87], v[96:99], v[52:55]
    ds_read2_b32 v[134:135], v236 offset0:242 offset1:243
    v_mfma_f32_16x16x32_bf16 v[52:55], v[80:83], v[100:103], v[52:55]
    ds_write_b128 v241, v[224:227] offset:14560
    v_mfma_f32_16x16x32_bf16 v[52:55], v[76:79], v[104:107], v[52:55]
    ds_read2_b32 v[136:137], v237 offset0:112 offset1:113
    ds_read2_b32 v[138:139], v237 offset0:114 offset1:115
    v_mfma_f32_16x16x32_bf16 v[52:55], v[72:75], v[108:111], v[52:55]
    s_add_u32 m0, s73, 0
    ds_read2_b32 v[140:141], v237 offset0:240 offset1:241
    s_add_u32 s6, s12, 4751360
    v_mfma_f32_16x16x32_bf16 v[52:55], v[68:71], v[112:115], v[52:55]
    buffer_load_dwordx4 v7, s[52:55], s14 offen offset:3072 lds
    v_alignbit_b32 v230, v231, v230, 16
    v_mfma_f32_16x16x32_bf16 v[52:55], v[64:67], v[116:119], v[52:55]
    ds_read2_b32 v[142:143], v237 offset0:242 offset1:243
    v_xor_b32 v244, 64, v244
    v_mfma_f32_16x16x32_bf16 v[56:59], v[64:67], v[120:123], v[56:59]
    ds_read2_b32 v[144:145], v238 offset0:112 offset1:113
    v_mfma_f32_16x16x32_bf16 v[56:59], v[68:71], v[116:119], v[56:59]
    ds_read2_b32 v[146:147], v238 offset0:114 offset1:115
    v_mfma_f32_16x16x32_bf16 v[56:59], v[72:75], v[112:115], v[56:59]
    ds_read2_b32 v[148:149], v238 offset0:240 offset1:241
    v_alignbit_b32 v231, v232, v231, 16
    v_mfma_f32_16x16x32_bf16 v[56:59], v[76:79], v[108:111], v[56:59]
    ds_read2_b32 v[150:151], v238 offset0:242 offset1:243
    v_xor_b32 v245, 64, v245
    v_mfma_f32_16x16x32_bf16 v[56:59], v[80:83], v[104:107], v[56:59]
    ds_read2_b32 v[152:153], v239 offset0:112 offset1:113
    s_waitcnt lgkmcnt(14)
    s_barrier
    v_mfma_f32_16x16x32_bf16 v[56:59], v[84:87], v[100:103], v[56:59]
    ds_read2_b32 v[154:155], v239 offset0:114 offset1:115
    v_mfma_f32_16x16x32_bf16 v[56:59], v[88:91], v[96:99], v[56:59]
    ds_read2_b32 v[156:157], v239 offset0:240 offset1:241
    v_alignbit_b32 v232, v233, v232, 16
    v_mfma_f32_16x16x32_bf16 v[60:63], v[92:95], v[96:99], v[60:63]
    s_lshl_b32 s14, s95, 18
    ds_read2_b32 v[158:159], v239 offset0:242 offset1:243
    v_mfma_f32_16x16x32_bf16 v[60:63], v[88:91], v[100:103], v[60:63]
    s_add_u32 m0, s73, 16384
    v_xor_b32 v246, 64, v246
    v_add_u32 v236, 8320, v236
    v_mfma_f32_16x16x32_bf16 v[60:63], v[84:87], v[104:107], v[60:63]
    buffer_load_dwordx4 v4, s[52:55], s14 offen offset:0 lds
    v_alignbit_b32 v233, v234, v233, 16
    v_mfma_f32_16x16x32_bf16 v[60:63], v[80:83], v[108:111], v[60:63]
    v_add_u32 v237, 8320, v237
    v_mfma_f32_16x16x32_bf16 v[60:63], v[76:79], v[112:115], v[60:63]
    v_mfma_f32_16x16x32_bf16 v[60:63], v[72:75], v[116:119], v[60:63]
    v_xor_b32 v247, 64, v247
    v_add_u32 v238, 8320, v238
    v_mfma_f32_16x16x32_bf16 v[60:63], v[68:71], v[120:123], v[60:63]
    ds_write_b128 v241, v[230:233] offset:15584
    v_mfma_f32_16x16x32_bf16 v[60:63], v[64:67], v[124:127], v[60:63]
    v_add_u32 v239, 8320, v239
    s_waitcnt lgkmcnt(1)
    v_mfma_f32_16x16x32_bf16 v[60:63], v[128:131], v[188:191], v[60:63]
    ds_read_b128 v[96:99], v244 offset:2048
    v_mfma_f32_16x16x32_bf16 v[60:63], v[132:135], v[184:187], v[60:63]
    ds_read2_b32 v[64:65], v236 offset0:0 offset1:1
    v_mfma_f32_16x16x32_bf16 v[60:63], v[136:139], v[180:183], v[60:63]
    ds_read2_b32 v[66:67], v236 offset0:2 offset1:3
    v_mfma_f32_16x16x32_bf16 v[60:63], v[140:143], v[176:179], v[60:63]
    ds_read_b128 v[100:103], v244 offset:6144
    v_mfma_f32_16x16x32_bf16 v[60:63], v[144:147], v[172:175], v[60:63]
    ds_read2_b32 v[68:69], v236 offset0:128 offset1:129
    v_mfma_f32_16x16x32_bf16 v[60:63], v[148:151], v[168:171], v[60:63]
    s_add_u32 m0, s73, 16384
    ds_read2_b32 v[70:71], v236 offset0:130 offset1:131
    v_mfma_f32_16x16x32_bf16 v[60:63], v[152:155], v[164:167], v[60:63]
    buffer_load_dwordx4 v5, s[52:55], s14 offen offset:1024 lds
    ds_read_b128 v[104:107], v244 offset:10240
    v_mfma_f32_16x16x32_bf16 v[60:63], v[156:159], v[160:163], v[60:63]
    ds_read2_b32 v[72:73], v237 offset0:0 offset1:1
    v_mfma_f32_16x16x32_bf16 v[56:59], v[128:131], v[184:187], v[56:59]
    ds_read2_b32 v[74:75], v237 offset0:2 offset1:3
    v_mfma_f32_16x16x32_bf16 v[56:59], v[132:135], v[180:183], v[56:59]
    ds_read_b128 v[108:111], v244 offset:14336
    v_mfma_f32_16x16x32_bf16 v[56:59], v[136:139], v[176:179], v[56:59]
    ds_read2_b32 v[76:77], v237 offset0:128 offset1:129
    v_mfma_f32_16x16x32_bf16 v[56:59], v[140:143], v[172:175], v[56:59]
    ds_read2_b32 v[78:79], v237 offset0:130 offset1:131
    v_mfma_f32_16x16x32_bf16 v[56:59], v[144:147], v[168:171], v[56:59]
    ds_read_b128 v[112:115], v244 offset:18432
    v_mfma_f32_16x16x32_bf16 v[56:59], v[148:151], v[164:167], v[56:59]
    ds_read2_b32 v[80:81], v238 offset0:0 offset1:1
    v_cvt_pk_bf16_f32 v206, v60, v61
    v_mfma_f32_16x16x32_bf16 v[56:59], v[152:155], v[160:163], v[56:59]
    ds_read2_b32 v[82:83], v238 offset0:2 offset1:3
    s_waitcnt vmcnt(6)
    s_barrier
    v_mfma_f32_16x16x32_bf16 v[52:55], v[128:131], v[180:183], v[52:55]
    ds_read_b128 v[116:119], v244 offset:22528
    v_add_u32 v10, 131072, v10
    v_mfma_f32_16x16x32_bf16 v[52:55], v[132:135], v[176:179], v[52:55]
    ds_read_b64_tr_b16 a[144:145], v10 offset:16384
    v_cvt_pk_bf16_f32 v207, v62, v63
    v_mfma_f32_16x16x32_bf16 v[52:55], v[136:139], v[172:175], v[52:55]
    ds_read_b64_tr_b16 a[146:147], v10 offset:18432
    s_add_u32 m0, s73, 16384
    v_mfma_f32_16x16x32_bf16 v[52:55], v[140:143], v[168:171], v[52:55]
    buffer_load_dwordx4 v6, s[52:55], s14 offen offset:2048 lds
    ds_read2_b32 v[84:85], v238 offset0:128 offset1:129
    v_mfma_f32_16x16x32_bf16 v[52:55], v[144:147], v[164:167], v[52:55]
    buffer_store_dwordx2 v[206:207], v8, s[44:47], s6 offen offset:3584 sc1
    ds_read_b64_tr_b16 a[152:153], v10 offset:20480
    v_mfma_f32_16x16x32_bf16 v[52:55], v[148:151], v[160:163], v[52:55]
    ds_read_b64_tr_b16 a[154:155], v10 offset:22528
    v_mfma_f32_16x16x32_bf16 v[48:51], v[128:131], v[176:179], v[48:51]
    ds_read2_b32 v[86:87], v238 offset0:130 offset1:131
    v_add_u32 v11, 131072, v11
    v_cvt_pk_bf16_f32 v204, v56, v57
    v_mfma_f32_16x16x32_bf16 v[48:51], v[132:135], v[172:175], v[48:51]
    ds_read_b64_tr_b16 a[148:149], v11 offset:16384
    ds_read_b128 v[120:123], v244 offset:26624
    v_mfma_f32_16x16x32_bf16 v[48:51], v[136:139], v[168:171], v[48:51]
    ds_read_b64_tr_b16 a[150:151], v11 offset:18432
    ds_read2_b32 v[88:89], v239 offset0:0 offset1:1
    v_mfma_f32_16x16x32_bf16 v[48:51], v[140:143], v[164:167], v[48:51]
    ds_read2_b32 v[90:91], v239 offset0:2 offset1:3
    v_cvt_pk_bf16_f32 v205, v58, v59
    v_mfma_f32_16x16x32_bf16 v[48:51], v[144:147], v[160:163], v[48:51]
    ds_read_b64_tr_b16 a[156:157], v11 offset:20480
    ds_read_b128 v[124:127], v244 offset:30720
    v_mfma_f32_16x16x32_bf16 v[44:47], v[128:131], v[172:175], v[44:47]
    buffer_store_dwordx2 v[204:205], v8, s[44:47], s6 offen offset:3072 sc1
    ds_read_b64_tr_b16 a[158:159], v11 offset:22528
    v_mfma_f32_16x16x32_bf16 v[44:47], v[132:135], v[168:171], v[44:47]
    ds_read2_b32 v[92:93], v239 offset0:128 offset1:129
    v_mfma_f32_16x16x32_bf16 v[44:47], v[136:139], v[164:167], v[44:47]
    s_add_u32 m0, s73, 16384
    ds_read2_b32 v[94:95], v239 offset0:130 offset1:131
    v_mfma_f32_16x16x32_bf16 v[44:47], v[140:143], v[160:163], v[44:47]
    buffer_load_dwordx4 v7, s[52:55], s14 offen offset:3072 lds
    v_cvt_pk_bf16_f32 v202, v52, v53
    v_mfma_f32_16x16x32_bf16 v[40:43], v[128:131], v[168:171], v[40:43]
    v_mfma_f32_16x16x32_bf16 v[40:43], v[132:135], v[164:167], v[40:43]
    v_mfma_f32_16x16x32_bf16 v[40:43], v[136:139], v[160:163], v[40:43]
    v_cvt_pk_bf16_f32 v203, v54, v55
    v_mfma_f32_16x16x32_bf16 v[36:39], v[128:131], v[164:167], v[36:39]
    v_mfma_f32_16x16x32_bf16 v[36:39], v[132:135], v[160:163], v[36:39]
    buffer_store_dwordx2 v[202:203], v8, s[44:47], s6 offen offset:2560 sc1
    v_mfma_f32_16x16x32_bf16 v[32:35], v[128:131], v[160:163], v[32:35]
    s_waitcnt lgkmcnt(0)
    v_mfma_f32_16x16x32_bf16 v[60:63], v[64:67], v[124:127], 0
    ds_read_b128 v[160:163], v245 offset:2048
    v_mfma_f32_16x16x32_bf16 v[60:63], v[68:71], v[120:123], v[60:63]
    v_cvt_pk_bf16_f32 v200, v48, v49
    v_mfma_f32_16x16x32_bf16 v[60:63], v[72:75], v[116:119], v[60:63]
    ds_read2_b32 v[128:129], v236 offset0:16 offset1:17
    v_mfma_f32_16x16x32_bf16 v[60:63], v[76:79], v[112:115], v[60:63]
    s_barrier
    v_cvt_pk_bf16_f32 v201, v50, v51
    v_mfma_f32_16x16x32_bf16 v[60:63], v[80:83], v[108:111], v[60:63]
    ds_read2_b32 v[130:131], v236 offset0:18 offset1:19
    v_mfma_f32_16x16x32_bf16 v[60:63], v[84:87], v[104:107], v[60:63]
    buffer_store_dwordx2 v[200:201], v8, s[44:47], s6 offen offset:2048 sc1
    ds_read_b128 v[164:167], v245 offset:6144
    v_mfma_f32_16x16x32_bf16 v[60:63], v[88:91], v[100:103], v[60:63]
    ds_read2_b32 v[132:133], v236 offset0:144 offset1:145
    v_mfma_f32_16x16x32_bf16 v[60:63], v[92:95], v[96:99], v[60:63]
    ds_read2_b32 v[134:135], v236 offset0:146 offset1:147
    s_lshl_b32 s14, s96, 18
    v_cvt_pk_bf16_f32 v198, v44, v45
    v_mfma_f32_16x16x32_bf16 v[56:59], v[64:67], v[120:123], 0
    s_add_u32 m0, s73, 147456
    ds_read_b128 v[168:171], v245 offset:10240
    v_mfma_f32_16x16x32_bf16 v[56:59], v[68:71], v[116:119], v[56:59]
    buffer_load_dwordx4 v4, s[52:55], s14 offen offset:0 lds
    ds_read2_b32 v[136:137], v237 offset0:16 offset1:17
    v_mfma_f32_16x16x32_bf16 v[56:59], v[72:75], v[112:115], v[56:59]
    ds_read2_b32 v[138:139], v237 offset0:18 offset1:19
    v_cvt_pk_bf16_f32 v199, v46, v47
    v_mfma_f32_16x16x32_bf16 v[56:59], v[76:79], v[108:111], v[56:59]
    ds_read_b128 v[172:175], v245 offset:14336
    v_mfma_f32_16x16x32_bf16 v[56:59], v[80:83], v[104:107], v[56:59]
    buffer_store_dwordx2 v[198:199], v8, s[44:47], s6 offen offset:1536 sc1
    ds_read2_b32 v[140:141], v237 offset0:144 offset1:145
    v_mfma_f32_16x16x32_bf16 v[56:59], v[84:87], v[100:103], v[56:59]
    ds_read2_b32 v[142:143], v237 offset0:146 offset1:147
    v_mfma_f32_16x16x32_bf16 v[56:59], v[88:91], v[96:99], v[56:59]
    ds_read_b128 v[176:179], v245 offset:18432
    v_cvt_pk_bf16_f32 v196, v40, v41
    v_mfma_f32_16x16x32_bf16 v[52:55], v[64:67], v[116:119], 0
    ds_read2_b32 v[144:145], v238 offset0:16 offset1:17
    v_mfma_f32_16x16x32_bf16 v[52:55], v[68:71], v[112:115], v[52:55]
    ds_read2_b32 v[146:147], v238 offset0:18 offset1:19
    v_cvt_pk_bf16_f32 v197, v42, v43
    v_mfma_f32_16x16x32_bf16 v[52:55], v[72:75], v[108:111], v[52:55]
    ds_read_b128 v[180:183], v245 offset:22528
L_pl_X_5:
    s_cbranch_execz L_wret
    v_mfma_f32_16x16x32_bf16 v[52:55], v[76:79], v[104:107], v[52:55]
    buffer_store_dwordx2 v[196:197], v8, s[44:47], s6 offen offset:1024 sc1
    ds_read2_b32 v[148:149], v238 offset0:144 offset1:145
    v_mfma_f32_16x16x32_bf16 v[52:55], v[80:83], v[100:103], v[52:55]
    s_add_u32 m0, s73, 147456
    ds_read2_b32 v[150:151], v238 offset0:146 offset1:147
    v_mfma_f32_16x16x32_bf16 v[52:55], v[84:87], v[96:99], v[52:55]
    buffer_load_dwordx4 v5, s[52:55], s14 offen offset:1024 lds
    ds_read_b128 v[184:187], v245 offset:26624
    v_mfma_f32_16x16x32_bf16 v[48:51], v[64:67], v[112:115], 0
    ds_read2_b32 v[152:153], v239 offset0:16 offset1:17
    v_cvt_pk_bf16_f32 v194, v36, v37
    v_mfma_f32_16x16x32_bf16 v[48:51], v[68:71], v[108:111], v[48:51]
    ds_read2_b32 v[154:155], v239 offset0:18 offset1:19
    v_mfma_f32_16x16x32_bf16 v[48:51], v[72:75], v[104:107], v[48:51]
    ds_read_b128 v[188:191], v245 offset:30720
    v_cvt_pk_bf16_f32 v195, v38, v39
    v_mfma_f32_16x16x32_bf16 v[48:51], v[76:79], v[100:103], v[48:51]
    ds_read2_b32 v[156:157], v239 offset0:144 offset1:145
    v_mfma_f32_16x16x32_bf16 v[48:51], v[80:83], v[96:99], v[48:51]
    buffer_store_dwordx2 v[194:195], v8, s[44:47], s6 offen offset:512 sc1
    s_waitcnt vmcnt(13)
    s_barrier
    v_mfma_f32_16x16x32_bf16 v[44:47], v[64:67], v[108:111], 0
    v_add_u32 v10, -131072, v10
    v_cvt_pk_bf16_f32 v192, v32, v33
    v_mfma_f32_16x16x32_bf16 v[44:47], v[68:71], v[104:107], v[44:47]
    ds_read_b64_tr_b16 a[160:161], v10 offset:0
    v_mfma_f32_16x16x32_bf16 v[44:47], v[72:75], v[100:103], v[44:47]
    ds_read_b64_tr_b16 a[162:163], v10 offset:2048
    v_mfma_f32_16x16x32_bf16 v[44:47], v[76:79], v[96:99], v[44:47]
    ds_read_b64_tr_b16 a[168:169], v10 offset:4096
    v_cvt_pk_bf16_f32 v193, v34, v35
    v_mfma_f32_16x16x32_bf16 v[40:43], v[64:67], v[104:107], 0
    ds_read2_b32 v[158:159], v239 offset0:146 offset1:147
    v_mfma_f32_16x16x32_bf16 v[40:43], v[68:71], v[100:103], v[40:43]
    buffer_store_dwordx2 v[192:193], v8, s[44:47], s6 offen offset:0 sc1
    ds_read_b64_tr_b16 a[170:171], v10 offset:6144
    s_add_u32 m0, s73, 147456
    v_mfma_f32_16x16x32_bf16 v[40:43], v[72:75], v[96:99], v[40:43]
    v_add_u32 v11, -131072, v11
    buffer_load_dwordx4 v6, s[52:55], s14 offen offset:2048 lds
    v_mfma_f32_16x16x32_bf16 v[36:39], v[64:67], v[100:103], 0
    ds_read_b64_tr_b16 a[164:165], v11 offset:0
    v_mfma_f32_16x16x32_bf16 v[36:39], v[68:71], v[96:99], v[36:39]
    ds_read_b64_tr_b16 a[166:167], v11 offset:2048
    v_mfma_f32_16x16x32_bf16 v[32:35], v[64:67], v[96:99], 0
    ds_read_b64_tr_b16 a[172:173], v11 offset:4096
    s_waitcnt lgkmcnt(15)
    v_mfma_f32_16x16x32_bf16 v[32:35], v[128:131], v[160:163], v[32:35]
    ds_read_b64_tr_b16 a[174:175], v11 offset:6144
    v_mfma_f32_16x16x32_bf16 v[36:39], v[132:135], v[160:163], v[36:39]
    ds_read_b128 v[96:99], v246 offset:2048
    v_mfma_f32_16x16x32_bf16 v[36:39], v[128:131], v[164:167], v[36:39]
    ds_read2_b32 v[64:65], v236 offset0:32 offset1:33
    v_mfma_f32_16x16x32_bf16 v[40:43], v[128:131], v[168:171], v[40:43]
    ds_read2_b32 v[66:67], v236 offset0:34 offset1:35
    v_mfma_f32_16x16x32_bf16 v[40:43], v[132:135], v[164:167], v[40:43]
    v_mfma_f32_16x16x32_bf16 v[40:43], v[136:139], v[160:163], v[40:43]
    ds_read_b128 v[100:103], v246 offset:6144
    v_mfma_f32_16x16x32_bf16 v[44:47], v[140:143], v[160:163], v[44:47]
    ds_read2_b32 v[68:69], v236 offset0:160 offset1:161
    v_mfma_f32_16x16x32_bf16 v[44:47], v[136:139], v[164:167], v[44:47]
    s_add_u32 m0, s73, 147456
    v_mfma_f32_16x16x32_bf16 v[44:47], v[132:135], v[168:171], v[44:47]
    buffer_load_dwordx4 v7, s[52:55], s14 offen offset:3072 lds
    ds_read2_b32 v[70:71], v236 offset0:162 offset1:163
    v_mfma_f32_16x16x32_bf16 v[44:47], v[128:131], v[172:175], v[44:47]
    ds_read_b128 v[104:107], v246 offset:10240
    s_waitcnt lgkmcnt(12)
    v_mfma_f32_16x16x32_bf16 v[48:51], v[128:131], v[176:179], v[48:51]
    ds_read2_b32 v[72:73], v237 offset0:32 offset1:33
    v_mfma_f32_16x16x32_bf16 v[48:51], v[132:135], v[172:175], v[48:51]
    v_mfma_f32_16x16x32_bf16 v[48:51], v[136:139], v[168:171], v[48:51]
    ds_read2_b32 v[74:75], v237 offset0:34 offset1:35
    v_mfma_f32_16x16x32_bf16 v[48:51], v[140:143], v[164:167], v[48:51]
    ds_read_b128 v[108:111], v246 offset:14336
    v_mfma_f32_16x16x32_bf16 v[48:51], v[144:147], v[160:163], v[48:51]
    s_waitcnt lgkmcnt(10)
    s_barrier
    v_mfma_f32_16x16x32_bf16 v[52:55], v[148:151], v[160:163], v[52:55]
    ds_read2_b32 v[76:77], v237 offset0:160 offset1:161
    v_mfma_f32_16x16x32_bf16 v[52:55], v[144:147], v[164:167], v[52:55]
    ds_read2_b32 v[78:79], v237 offset0:162 offset1:163
    v_mfma_f32_16x16x32_bf16 v[52:55], v[140:143], v[168:171], v[52:55]
    v_mfma_f32_16x16x32_bf16 v[52:55], v[136:139], v[172:175], v[52:55]
    s_lshl_b32 s14, s97, 18
    ds_read_b128 v[112:115], v246 offset:18432
    v_mfma_f32_16x16x32_bf16 v[52:55], v[132:135], v[176:179], v[52:55]
    s_add_u32 m0, s73, 0
    ds_read2_b32 v[80:81], v238 offset0:32 offset1:33
    v_mfma_f32_16x16x32_bf16 v[52:55], v[128:131], v[180:183], v[52:55]
    buffer_load_dwordx4 v4, s[52:55], s14 offen offset:0 lds
    v_mfma_f32_16x16x32_bf16 v[56:59], v[128:131], v[184:187], v[56:59]
    ds_read2_b32 v[82:83], v238 offset0:34 offset1:35
    v_mfma_f32_16x16x32_bf16 v[56:59], v[132:135], v[180:183], v[56:59]
    ds_read_b128 v[116:119], v246 offset:22528
    v_mfma_f32_16x16x32_bf16 v[56:59], v[136:139], v[176:179], v[56:59]
    v_mfma_f32_16x16x32_bf16 v[56:59], v[140:143], v[172:175], v[56:59]
    ds_read2_b32 v[84:85], v238 offset0:160 offset1:161
    v_mfma_f32_16x16x32_bf16 v[56:59], v[144:147], v[168:171], v[56:59]
    ds_read2_b32 v[86:87], v238 offset0:162 offset1:163
    v_mfma_f32_16x16x32_bf16 v[56:59], v[148:151], v[164:167], v[56:59]
    ds_read_b128 v[120:123], v246 offset:26624
    v_mfma_f32_16x16x32_bf16 v[56:59], v[152:155], v[160:163], v[56:59]
    v_mfma_f32_16x16x32_bf16 v[60:63], v[156:159], v[160:163], v[60:63]
    ds_read2_b32 v[88:89], v239 offset0:32 offset1:33
    v_mfma_f32_16x16x32_bf16 v[60:63], v[152:155], v[164:167], v[60:63]
    ds_read2_b32 v[90:91], v239 offset0:34 offset1:35
    v_mfma_f32_16x16x32_bf16 v[60:63], v[148:151], v[168:171], v[60:63]
    s_add_u32 m0, s73, 0
    v_mfma_f32_16x16x32_bf16 v[60:63], v[144:147], v[172:175], v[60:63]
    buffer_load_dwordx4 v5, s[52:55], s14 offen offset:1024 lds
    ds_read_b128 v[124:127], v246 offset:30720
    v_mfma_f32_16x16x32_bf16 v[60:63], v[140:143], v[176:179], v[60:63]
    ds_read2_b32 v[92:93], v239 offset0:160 offset1:161
    v_mfma_f32_16x16x32_bf16 v[60:63], v[136:139], v[180:183], v[60:63]
    v_mfma_f32_16x16x32_bf16 v[60:63], v[132:135], v[184:187], v[60:63]
    ds_read2_b32 v[94:95], v239 offset0:162 offset1:163
    v_mfma_f32_16x16x32_bf16 v[60:63], v[128:131], v[188:191], v[60:63]
    s_waitcnt lgkmcnt(12)
    v_mfma_f32_16x16x32_bf16 v[32:35], v[64:67], v[96:99], v[32:35]
    ds_read_b128 v[160:163], v247 offset:2048
    s_waitcnt vmcnt(12)
    s_barrier
    v_mfma_f32_16x16x32_bf16 v[36:39], v[68:71], v[96:99], v[36:39]
    ds_read_b64_tr_b16 a[176:177], v10 offset:16384
    v_mfma_f32_16x16x32_bf16 v[36:39], v[64:67], v[100:103], v[36:39]
    ds_read_b64_tr_b16 a[178:179], v10 offset:18432
    v_mfma_f32_16x16x32_bf16 v[40:43], v[64:67], v[104:107], v[40:43]
    ds_read2_b32 v[128:129], v236 offset0:48 offset1:49
    v_mfma_f32_16x16x32_bf16 v[40:43], v[68:71], v[100:103], v[40:43]
    ds_read_b64_tr_b16 a[184:185], v10 offset:20480
    v_mfma_f32_16x16x32_bf16 v[40:43], v[72:75], v[96:99], v[40:43]
    ds_read_b64_tr_b16 a[186:187], v10 offset:22528
    v_mfma_f32_16x16x32_bf16 v[44:47], v[76:79], v[96:99], v[44:47]
    s_add_u32 m0, s73, 0
    ds_read2_b32 v[130:131], v236 offset0:50 offset1:51
    v_mfma_f32_16x16x32_bf16 v[44:47], v[72:75], v[100:103], v[44:47]
    ds_read_b64_tr_b16 a[180:181], v11 offset:16384
    buffer_load_dwordx4 v6, s[52:55], s14 offen offset:2048 lds
    v_mfma_f32_16x16x32_bf16 v[44:47], v[68:71], v[104:107], v[44:47]
    ds_read_b64_tr_b16 a[182:183], v11 offset:18432
    v_mfma_f32_16x16x32_bf16 v[44:47], v[64:67], v[108:111], v[44:47]
    ds_read_b128 v[164:167], v247 offset:6144
    s_waitcnt lgkmcnt(10)
    v_mfma_f32_16x16x32_bf16 v[48:51], v[64:67], v[112:115], v[48:51]
    ds_read_b64_tr_b16 a[188:189], v11 offset:20480
    v_mfma_f32_16x16x32_bf16 v[48:51], v[68:71], v[108:111], v[48:51]
    ds_read_b64_tr_b16 a[190:191], v11 offset:22528
    v_mfma_f32_16x16x32_bf16 v[48:51], v[72:75], v[104:107], v[48:51]
    ds_read2_b32 v[132:133], v236 offset0:176 offset1:177
    v_mfma_f32_16x16x32_bf16 v[48:51], v[76:79], v[100:103], v[48:51]
    ds_read2_b32 v[134:135], v236 offset0:178 offset1:179
    v_mfma_f32_16x16x32_bf16 v[48:51], v[80:83], v[96:99], v[48:51]
    ds_read_b128 v[168:171], v247 offset:10240
    v_mfma_f32_16x16x32_bf16 v[52:55], v[84:87], v[96:99], v[52:55]
    ds_read2_b32 v[136:137], v237 offset0:48 offset1:49
    v_mfma_f32_16x16x32_bf16 v[52:55], v[80:83], v[100:103], v[52:55]
    ds_read2_b32 v[138:139], v237 offset0:50 offset1:51
    v_mfma_f32_16x16x32_bf16 v[52:55], v[76:79], v[104:107], v[52:55]
    ds_read_b128 v[172:175], v247 offset:14336
    v_mfma_f32_16x16x32_bf16 v[52:55], v[72:75], v[108:111], v[52:55]
    s_add_u32 m0, s73, 0
    ds_read2_b32 v[140:141], v237 offset0:176 offset1:177
    v_mfma_f32_16x16x32_bf16 v[52:55], v[68:71], v[112:115], v[52:55]
    buffer_load_dwordx4 v7, s[52:55], s14 offen offset:3072 lds
    ds_read2_b32 v[142:143], v237 offset0:178 offset1:179
    v_mfma_f32_16x16x32_bf16 v[52:55], v[64:67], v[116:119], v[52:55]
    ds_read_b128 v[176:179], v247 offset:18432
    v_mfma_f32_16x16x32_bf16 v[56:59], v[64:67], v[120:123], v[56:59]
    ds_read2_b32 v[144:145], v238 offset0:48 offset1:49
    v_mfma_f32_16x16x32_bf16 v[56:59], v[68:71], v[116:119], v[56:59]
    ds_read2_b32 v[146:147], v238 offset0:50 offset1:51
    v_mfma_f32_16x16x32_bf16 v[56:59], v[72:75], v[112:115], v[56:59]
    ds_read_b128 v[180:183], v247 offset:22528
    v_mfma_f32_16x16x32_bf16 v[56:59], v[76:79], v[108:111], v[56:59]
    ds_read2_b32 v[148:149], v238 offset0:176 offset1:177
    v_mfma_f32_16x16x32_bf16 v[56:59], v[80:83], v[104:107], v[56:59]
    ds_read2_b32 v[150:151], v238 offset0:178 offset1:179
    s_waitcnt lgkmcnt(14)
    s_barrier
    v_mfma_f32_16x16x32_bf16 v[56:59], v[84:87], v[100:103], v[56:59]
    ds_read_b128 v[184:187], v247 offset:26624
    v_mfma_f32_16x16x32_bf16 v[56:59], v[88:91], v[96:99], v[56:59]
    v_mfma_f32_16x16x32_bf16 v[60:63], v[92:95], v[96:99], v[60:63]
    s_lshl_b32 s14, s98, 18
    ds_read2_b32 v[152:153], v239 offset0:48 offset1:49
    v_mfma_f32_16x16x32_bf16 v[60:63], v[88:91], v[100:103], v[60:63]
    s_add_u32 m0, s73, 16384
    ds_read2_b32 v[154:155], v239 offset0:50 offset1:51
    v_mfma_f32_16x16x32_bf16 v[60:63], v[84:87], v[104:107], v[60:63]
    buffer_load_dwordx4 v4, s[52:55], s14 offen offset:0 lds
    v_mfma_f32_16x16x32_bf16 v[60:63], v[80:83], v[108:111], v[60:63]
    ds_read_b128 v[188:191], v247 offset:30720
    v_mfma_f32_16x16x32_bf16 v[60:63], v[76:79], v[112:115], v[60:63]
    ds_read2_b32 v[156:157], v239 offset0:176 offset1:177
    v_mfma_f32_16x16x32_bf16 v[60:63], v[72:75], v[116:119], v[60:63]
    v_mfma_f32_16x16x32_bf16 v[60:63], v[68:71], v[120:123], v[60:63]
    ds_read2_b32 v[158:159], v239 offset0:178 offset1:179
    v_mfma_f32_16x16x32_bf16 v[60:63], v[64:67], v[124:127], v[60:63]
    s_waitcnt lgkmcnt(12)
    v_mfma_f32_16x16x32_bf16 v[32:35], v[128:131], v[160:163], v[32:35]
    ds_read_b128 v[96:99], v244 offset:0
    v_mfma_f32_16x16x32_bf16 v[36:39], v[132:135], v[160:163], v[36:39]
    v_mfma_f32_16x16x32_bf16 v[36:39], v[128:131], v[164:167], v[36:39]
    ds_read2_b32 v[64:65], v236 offset0:64 offset1:65
    v_mfma_f32_16x16x32_bf16 v[40:43], v[128:131], v[168:171], v[40:43]
    ds_read2_b32 v[66:67], v236 offset0:66 offset1:67
    v_mfma_f32_16x16x32_bf16 v[40:43], v[132:135], v[164:167], v[40:43]
    v_mfma_f32_16x16x32_bf16 v[40:43], v[136:139], v[160:163], v[40:43]
    s_add_u32 m0, s73, 16384
    ds_read_b128 v[100:103], v244 offset:4096
    v_mfma_f32_16x16x32_bf16 v[44:47], v[140:143], v[160:163], v[44:47]
    buffer_load_dwordx4 v5, s[52:55], s14 offen offset:1024 lds
    ds_read2_b32 v[68:69], v236 offset0:192 offset1:193
    v_mfma_f32_16x16x32_bf16 v[44:47], v[136:139], v[164:167], v[44:47]
    v_mfma_f32_16x16x32_bf16 v[44:47], v[132:135], v[168:171], v[44:47]
    ds_read2_b32 v[70:71], v236 offset0:194 offset1:195
    v_mfma_f32_16x16x32_bf16 v[44:47], v[128:131], v[172:175], v[44:47]
    ds_read_b128 v[104:107], v244 offset:8192
    s_waitcnt lgkmcnt(7)
    v_mfma_f32_16x16x32_bf16 v[48:51], v[128:131], v[176:179], v[48:51]
    ds_read2_b32 v[72:73], v237 offset0:64 offset1:65
    v_mfma_f32_16x16x32_bf16 v[48:51], v[132:135], v[172:175], v[48:51]
    ds_read2_b32 v[74:75], v237 offset0:66 offset1:67
    v_mfma_f32_16x16x32_bf16 v[48:51], v[136:139], v[168:171], v[48:51]
    ds_read_b128 v[108:111], v244 offset:12288
    v_mfma_f32_16x16x32_bf16 v[48:51], v[140:143], v[164:167], v[48:51]
    ds_read2_b32 v[76:77], v237 offset0:192 offset1:193
    v_mfma_f32_16x16x32_bf16 v[48:51], v[144:147], v[160:163], v[48:51]
    ds_read2_b32 v[78:79], v237 offset0:194 offset1:195
    s_waitcnt vmcnt(6)
    s_barrier
    v_mfma_f32_16x16x32_bf16 v[52:55], v[148:151], v[160:163], v[52:55]
    ds_read_b128 v[112:115], v244 offset:16384
    v_add_u32 v10, 131072, v10
    v_mfma_f32_16x16x32_bf16 v[52:55], v[144:147], v[164:167], v[52:55]
    ds_read_b64_tr_b16 a[192:193], v10 offset:16384
    v_mfma_f32_16x16x32_bf16 v[52:55], v[140:143], v[168:171], v[52:55]
    ds_read_b64_tr_b16 a[194:195], v10 offset:18432
    s_add_u32 m0, s73, 16384
    v_mfma_f32_16x16x32_bf16 v[52:55], v[136:139], v[172:175], v[52:55]
    buffer_load_dwordx4 v6, s[52:55], s14 offen offset:2048 lds
    ds_read2_b32 v[80:81], v238 offset0:64 offset1:65
    v_mfma_f32_16x16x32_bf16 v[52:55], v[132:135], v[176:179], v[52:55]
    ds_read_b64_tr_b16 a[200:201], v10 offset:20480
    v_mfma_f32_16x16x32_bf16 v[52:55], v[128:131], v[180:183], v[52:55]
    ds_read_b64_tr_b16 a[202:203], v10 offset:22528
    v_mfma_f32_16x16x32_bf16 v[56:59], v[128:131], v[184:187], v[56:59]
    ds_read2_b32 v[82:83], v238 offset0:66 offset1:67
    v_add_u32 v11, 131072, v11
    v_mfma_f32_16x16x32_bf16 v[56:59], v[132:135], v[180:183], v[56:59]
    ds_read_b64_tr_b16 a[196:197], v11 offset:16384
    v_mfma_f32_16x16x32_bf16 v[56:59], v[136:139], v[176:179], v[56:59]
    ds_read_b64_tr_b16 a[198:199], v11 offset:18432
    v_mfma_f32_16x16x32_bf16 v[56:59], v[140:143], v[172:175], v[56:59]
    ds_read_b128 v[116:119], v244 offset:20480
    v_mfma_f32_16x16x32_bf16 v[56:59], v[144:147], v[168:171], v[56:59]
    ds_read_b64_tr_b16 a[204:205], v11 offset:20480
    v_mfma_f32_16x16x32_bf16 v[56:59], v[148:151], v[164:167], v[56:59]
    ds_read_b64_tr_b16 a[206:207], v11 offset:22528
    v_mfma_f32_16x16x32_bf16 v[56:59], v[152:155], v[160:163], v[56:59]
    ds_read2_b32 v[84:85], v238 offset0:192 offset1:193
    v_mfma_f32_16x16x32_bf16 v[60:63], v[156:159], v[160:163], v[60:63]
    s_add_u32 m0, s73, 16384
    ds_read2_b32 v[86:87], v238 offset0:194 offset1:195
    v_mfma_f32_16x16x32_bf16 v[60:63], v[152:155], v[164:167], v[60:63]
    buffer_load_dwordx4 v7, s[52:55], s14 offen offset:3072 lds
    ds_read_b128 v[120:123], v244 offset:24576
    v_mfma_f32_16x16x32_bf16 v[60:63], v[148:151], v[168:171], v[60:63]
    ds_read2_b32 v[88:89], v239 offset0:64 offset1:65
    v_mfma_f32_16x16x32_bf16 v[60:63], v[144:147], v[172:175], v[60:63]
    ds_read2_b32 v[90:91], v239 offset0:66 offset1:67
    v_mfma_f32_16x16x32_bf16 v[60:63], v[140:143], v[176:179], v[60:63]
    ds_read_b128 v[124:127], v244 offset:28672
    v_mfma_f32_16x16x32_bf16 v[60:63], v[136:139], v[180:183], v[60:63]
    ds_read2_b32 v[92:93], v239 offset0:192 offset1:193
    v_mfma_f32_16x16x32_bf16 v[60:63], v[132:135], v[184:187], v[60:63]
    ds_read2_b32 v[94:95], v239 offset0:194 offset1:195
    v_mfma_f32_16x16x32_bf16 v[60:63], v[128:131], v[188:191], v[60:63]
    s_waitcnt lgkmcnt(15)
    v_mfma_f32_16x16x32_bf16 v[32:35], v[64:67], v[96:99], v[32:35]
    ds_read_b128 v[160:163], v245 offset:0
    v_mfma_f32_16x16x32_bf16 v[36:39], v[68:71], v[96:99], v[36:39]
    v_mfma_f32_16x16x32_bf16 v[36:39], v[64:67], v[100:103], v[36:39]
    ds_read2_b32 v[128:129], v236 offset0:80 offset1:81
    v_mfma_f32_16x16x32_bf16 v[40:43], v[64:67], v[104:107], v[40:43]
    ds_read2_b32 v[130:131], v236 offset0:82 offset1:83
    s_waitcnt lgkmcnt(11)
    s_barrier
    v_mfma_f32_16x16x32_bf16 v[40:43], v[68:71], v[100:103], v[40:43]
    v_mfma_f32_16x16x32_bf16 v[40:43], v[72:75], v[96:99], v[40:43]
    ds_read_b128 v[164:167], v245 offset:4096
    v_mfma_f32_16x16x32_bf16 v[44:47], v[76:79], v[96:99], v[44:47]
    ds_read2_b32 v[132:133], v236 offset0:208 offset1:209
    v_mfma_f32_16x16x32_bf16 v[44:47], v[72:75], v[100:103], v[44:47]
    s_lshl_b32 s14, s99, 18
    v_mfma_f32_16x16x32_bf16 v[44:47], v[68:71], v[104:107], v[44:47]
    s_add_u32 m0, s73, 147456
    ds_read2_b32 v[134:135], v236 offset0:210 offset1:211
    v_mfma_f32_16x16x32_bf16 v[44:47], v[64:67], v[108:111], v[44:47]
    buffer_load_dwordx4 v4, s[52:55], s14 offen offset:0 lds
    ds_read_b128 v[168:171], v245 offset:8192
    s_waitcnt lgkmcnt(7)
    v_mfma_f32_16x16x32_bf16 v[48:51], v[64:67], v[112:115], v[48:51]
    ds_read2_b32 v[136:137], v237 offset0:80 offset1:81
    v_mfma_f32_16x16x32_bf16 v[48:51], v[68:71], v[108:111], v[48:51]
    v_mfma_f32_16x16x32_bf16 v[48:51], v[72:75], v[104:107], v[48:51]
    ds_read2_b32 v[138:139], v237 offset0:82 offset1:83
    v_mfma_f32_16x16x32_bf16 v[48:51], v[76:79], v[100:103], v[48:51]
    ds_read_b128 v[172:175], v245 offset:12288
    v_mfma_f32_16x16x32_bf16 v[48:51], v[80:83], v[96:99], v[48:51]
    ds_read2_b32 v[140:141], v237 offset0:208 offset1:209
    v_mfma_f32_16x16x32_bf16 v[52:55], v[84:87], v[96:99], v[52:55]
    ds_read2_b32 v[142:143], v237 offset0:210 offset1:211
    v_mfma_f32_16x16x32_bf16 v[52:55], v[80:83], v[100:103], v[52:55]
    ds_read_b128 v[176:179], v245 offset:16384
    v_mfma_f32_16x16x32_bf16 v[52:55], v[76:79], v[104:107], v[52:55]
    ds_read2_b32 v[144:145], v238 offset0:80 offset1:81
    v_mfma_f32_16x16x32_bf16 v[52:55], v[72:75], v[108:111], v[52:55]
    ds_read2_b32 v[146:147], v238 offset0:82 offset1:83
    v_mfma_f32_16x16x32_bf16 v[52:55], v[68:71], v[112:115], v[52:55]
    s_add_u32 m0, s73, 147456
    ds_read_b128 v[180:183], v245 offset:20480
    v_mfma_f32_16x16x32_bf16 v[52:55], v[64:67], v[116:119], v[52:55]
    buffer_load_dwordx4 v5, s[52:55], s14 offen offset:1024 lds
    ds_read2_b32 v[148:149], v238 offset0:208 offset1:209
    v_mfma_f32_16x16x32_bf16 v[56:59], v[64:67], v[120:123], v[56:59]
    ds_read2_b32 v[150:151], v238 offset0:210 offset1:211
    v_mfma_f32_16x16x32_bf16 v[56:59], v[68:71], v[116:119], v[56:59]
    ds_read_b128 v[184:187], v245 offset:24576
    v_mfma_f32_16x16x32_bf16 v[56:59], v[72:75], v[112:115], v[56:59]
    ds_read2_b32 v[152:153], v239 offset0:80 offset1:81
    v_mfma_f32_16x16x32_bf16 v[56:59], v[76:79], v[108:111], v[56:59]
    ds_read2_b32 v[154:155], v239 offset0:82 offset1:83
    v_mfma_f32_16x16x32_bf16 v[56:59], v[80:83], v[104:107], v[56:59]
    ds_read_b128 v[188:191], v245 offset:28672
    s_waitcnt vmcnt(6)
    s_barrier
    v_mfma_f32_16x16x32_bf16 v[56:59], v[84:87], v[100:103], v[56:59]
    ds_read2_b32 v[156:157], v239 offset0:208 offset1:209
    v_add_u32 v10, -131072, v10
    v_mfma_f32_16x16x32_bf16 v[56:59], v[88:91], v[96:99], v[56:59]
    ds_read_b64_tr_b16 a[208:209], v10 offset:0
    v_mfma_f32_16x16x32_bf16 v[60:63], v[92:95], v[96:99], v[60:63]
    ds_read_b64_tr_b16 a[210:211], v10 offset:2048
    v_mfma_f32_16x16x32_bf16 v[60:63], v[88:91], v[100:103], v[60:63]
    ds_read_b64_tr_b16 a[216:217], v10 offset:4096
    v_mfma_f32_16x16x32_bf16 v[60:63], v[84:87], v[104:107], v[60:63]
    ds_read2_b32 v[158:159], v239 offset0:210 offset1:211
    v_mfma_f32_16x16x32_bf16 v[60:63], v[80:83], v[108:111], v[60:63]
    ds_read_b64_tr_b16 a[218:219], v10 offset:6144
    s_add_u32 m0, s73, 147456
    v_mfma_f32_16x16x32_bf16 v[60:63], v[76:79], v[112:115], v[60:63]
    v_add_u32 v11, -131072, v11
    buffer_load_dwordx4 v6, s[52:55], s14 offen offset:2048 lds
    v_mfma_f32_16x16x32_bf16 v[60:63], v[72:75], v[116:119], v[60:63]
    ds_read_b64_tr_b16 a[212:213], v11 offset:0
    v_mfma_f32_16x16x32_bf16 v[60:63], v[68:71], v[120:123], v[60:63]
    ds_read_b64_tr_b16 a[214:215], v11 offset:2048
    v_mfma_f32_16x16x32_bf16 v[60:63], v[64:67], v[124:127], v[60:63]
    ds_read_b64_tr_b16 a[220:221], v11 offset:4096
    s_waitcnt lgkmcnt(15)
    v_mfma_f32_16x16x32_bf16 v[32:35], v[128:131], v[160:163], v[32:35]
    ds_read_b64_tr_b16 a[222:223], v11 offset:6144
    v_mfma_f32_16x16x32_bf16 v[36:39], v[132:135], v[160:163], v[36:39]
    ds_read_b128 v[96:99], v246 offset:0
    v_mfma_f32_16x16x32_bf16 v[36:39], v[128:131], v[164:167], v[36:39]
    ds_read2_b32 v[64:65], v236 offset0:96 offset1:97
    v_mfma_f32_16x16x32_bf16 v[40:43], v[128:131], v[168:171], v[40:43]
    ds_read2_b32 v[66:67], v236 offset0:98 offset1:99
    v_mfma_f32_16x16x32_bf16 v[40:43], v[132:135], v[164:167], v[40:43]
    v_mfma_f32_16x16x32_bf16 v[40:43], v[136:139], v[160:163], v[40:43]
    ds_read_b128 v[100:103], v246 offset:4096
    v_mfma_f32_16x16x32_bf16 v[44:47], v[140:143], v[160:163], v[44:47]
    ds_read2_b32 v[68:69], v236 offset0:224 offset1:225
    v_mfma_f32_16x16x32_bf16 v[44:47], v[136:139], v[164:167], v[44:47]
    s_add_u32 m0, s73, 147456
    v_mfma_f32_16x16x32_bf16 v[44:47], v[132:135], v[168:171], v[44:47]
    buffer_load_dwordx4 v7, s[52:55], s14 offen offset:3072 lds
    ds_read2_b32 v[70:71], v236 offset0:226 offset1:227
    v_mfma_f32_16x16x32_bf16 v[44:47], v[128:131], v[172:175], v[44:47]
    ds_read_b128 v[104:107], v246 offset:8192
    s_waitcnt lgkmcnt(12)
    v_mfma_f32_16x16x32_bf16 v[48:51], v[128:131], v[176:179], v[48:51]
    ds_read2_b32 v[72:73], v237 offset0:96 offset1:97
    v_mfma_f32_16x16x32_bf16 v[48:51], v[132:135], v[172:175], v[48:51]
    v_mfma_f32_16x16x32_bf16 v[48:51], v[136:139], v[168:171], v[48:51]
    ds_read2_b32 v[74:75], v237 offset0:98 offset1:99
    v_mfma_f32_16x16x32_bf16 v[48:51], v[140:143], v[164:167], v[48:51]
    ds_read_b128 v[108:111], v246 offset:12288
    v_mfma_f32_16x16x32_bf16 v[48:51], v[144:147], v[160:163], v[48:51]
    s_waitcnt lgkmcnt(10)
    s_barrier
    v_mfma_f32_16x16x32_bf16 v[52:55], v[148:151], v[160:163], v[52:55]
    ds_read2_b32 v[76:77], v237 offset0:224 offset1:225
    v_mfma_f32_16x16x32_bf16 v[52:55], v[144:147], v[164:167], v[52:55]
    ds_read2_b32 v[78:79], v237 offset0:226 offset1:227
    v_mfma_f32_16x16x32_bf16 v[52:55], v[140:143], v[168:171], v[52:55]
    v_mfma_f32_16x16x32_bf16 v[52:55], v[136:139], v[172:175], v[52:55]
    s_lshl_b32 s14, s100, 18
    ds_read_b128 v[112:115], v246 offset:16384
    v_mfma_f32_16x16x32_bf16 v[52:55], v[132:135], v[176:179], v[52:55]
    s_add_u32 m0, s73, 0
    ds_read2_b32 v[80:81], v238 offset0:96 offset1:97
    v_mfma_f32_16x16x32_bf16 v[52:55], v[128:131], v[180:183], v[52:55]
    buffer_load_dwordx4 v4, s[52:55], s14 offen offset:0 lds
    v_mfma_f32_16x16x32_bf16 v[56:59], v[128:131], v[184:187], v[56:59]
    ds_read2_b32 v[82:83], v238 offset0:98 offset1:99
    v_mfma_f32_16x16x32_bf16 v[56:59], v[132:135], v[180:183], v[56:59]
    ds_read_b128 v[116:119], v246 offset:20480
    v_mfma_f32_16x16x32_bf16 v[56:59], v[136:139], v[176:179], v[56:59]
    v_mfma_f32_16x16x32_bf16 v[56:59], v[140:143], v[172:175], v[56:59]
    ds_read2_b32 v[84:85], v238 offset0:224 offset1:225
    v_mfma_f32_16x16x32_bf16 v[56:59], v[144:147], v[168:171], v[56:59]
    ds_read2_b32 v[86:87], v238 offset0:226 offset1:227
    v_mfma_f32_16x16x32_bf16 v[56:59], v[148:151], v[164:167], v[56:59]
    ds_read_b128 v[120:123], v246 offset:24576
    v_mfma_f32_16x16x32_bf16 v[56:59], v[152:155], v[160:163], v[56:59]
    v_mfma_f32_16x16x32_bf16 v[60:63], v[156:159], v[160:163], v[60:63]
    ds_read2_b32 v[88:89], v239 offset0:96 offset1:97
    v_mfma_f32_16x16x32_bf16 v[60:63], v[152:155], v[164:167], v[60:63]
    s_add_u32 m0, s73, 0
    ds_read2_b32 v[90:91], v239 offset0:98 offset1:99
    v_mfma_f32_16x16x32_bf16 v[60:63], v[148:151], v[168:171], v[60:63]
    buffer_load_dwordx4 v5, s[52:55], s14 offen offset:1024 lds
    v_mfma_f32_16x16x32_bf16 v[60:63], v[144:147], v[172:175], v[60:63]
    ds_read_b128 v[124:127], v246 offset:28672
    v_mfma_f32_16x16x32_bf16 v[60:63], v[140:143], v[176:179], v[60:63]
    ds_read2_b32 v[92:93], v239 offset0:224 offset1:225
    v_mfma_f32_16x16x32_bf16 v[60:63], v[136:139], v[180:183], v[60:63]
    v_mfma_f32_16x16x32_bf16 v[60:63], v[132:135], v[184:187], v[60:63]
    ds_read2_b32 v[94:95], v239 offset0:226 offset1:227
    v_mfma_f32_16x16x32_bf16 v[60:63], v[128:131], v[188:191], v[60:63]
    s_waitcnt lgkmcnt(12)
    v_mfma_f32_16x16x32_bf16 v[32:35], v[64:67], v[96:99], v[32:35]
    ds_read_b128 v[160:163], v247 offset:0
    s_waitcnt vmcnt(6)
    s_barrier
    v_mfma_f32_16x16x32_bf16 v[36:39], v[68:71], v[96:99], v[36:39]
    ds_read_b64_tr_b16 a[224:225], v10 offset:16384
    s_bfe_u32 s4, s2, 0x20003
    v_mfma_f32_16x16x32_bf16 v[36:39], v[64:67], v[100:103], v[36:39]
    ds_read_b64_tr_b16 a[226:227], v10 offset:18432
    ds_read_b128 v[164:167], v247 offset:4096
    v_mfma_f32_16x16x32_bf16 v[40:43], v[64:67], v[104:107], v[40:43]
    s_lshl2_add_u32 s4, s72, s4
    ds_read_b128 v[168:171], v247 offset:8192
    v_mfma_f32_16x16x32_bf16 v[40:43], v[68:71], v[100:103], v[40:43]
    ds_read_b64_tr_b16 a[232:233], v10 offset:20480
    s_add_u32 m0, s73, 0
    ds_read_b128 v[172:175], v247 offset:12288
    v_mfma_f32_16x16x32_bf16 v[40:43], v[72:75], v[96:99], v[40:43]
    ds_read_b64_tr_b16 a[234:235], v10 offset:22528
    buffer_load_dwordx4 v6, s[52:55], s14 offen offset:2048 lds
    s_lshl_b32 s4, s4, 3
    v_mfma_f32_16x16x32_bf16 v[44:47], v[76:79], v[96:99], v[44:47]
    ds_read_b128 v[176:179], v247 offset:16384
    v_mfma_f32_16x16x32_bf16 v[44:47], v[72:75], v[100:103], v[44:47]
    ds_read_b64_tr_b16 a[228:229], v11 offset:16384
    s_lshr_b32 s5, s2, 4
    ds_read_b128 v[180:183], v247 offset:20480
    v_mfma_f32_16x16x32_bf16 v[44:47], v[68:71], v[104:107], v[44:47]
    ds_read_b64_tr_b16 a[230:231], v11 offset:18432
    v_mfma_f32_16x16x32_bf16 v[44:47], v[64:67], v[108:111], v[44:47]
    s_and_b32 s5, s5, 6
    ds_read_b128 v[184:187], v247 offset:24576
    s_waitcnt lgkmcnt(13)
    v_mfma_f32_16x16x32_bf16 v[48:51], v[64:67], v[112:115], v[48:51]
    ds_read_b64_tr_b16 a[236:237], v11 offset:20480
    ds_read_b128 v[188:191], v247 offset:28672
    v_mfma_f32_16x16x32_bf16 v[48:51], v[68:71], v[108:111], v[48:51]
    ds_read_b64_tr_b16 a[238:239], v11 offset:22528
    s_add_u32 s4, s4, s5
    v_mfma_f32_16x16x32_bf16 v[48:51], v[72:75], v[104:107], v[48:51]
    ds_read2_b32 v[128:129], v236 offset0:112 offset1:113
    v_mfma_f32_16x16x32_bf16 v[48:51], v[76:79], v[100:103], v[48:51]
    s_and_b32 s5, s2, 1
    ds_read2_b32 v[130:131], v236 offset0:114 offset1:115
    v_mfma_f32_16x16x32_bf16 v[48:51], v[80:83], v[96:99], v[48:51]
    ds_read2_b32 v[132:133], v236 offset0:240 offset1:241
    v_mfma_f32_16x16x32_bf16 v[52:55], v[84:87], v[96:99], v[52:55]
    s_add_u32 m0, s73, 0
    ds_read2_b32 v[134:135], v236 offset0:242 offset1:243
    s_add_u32 s4, s4, s5
    v_mfma_f32_16x16x32_bf16 v[52:55], v[80:83], v[100:103], v[52:55]
    buffer_load_dwordx4 v7, s[52:55], s14 offen offset:3072 lds
    ds_read2_b32 v[136:137], v237 offset0:112 offset1:113
    v_mfma_f32_16x16x32_bf16 v[52:55], v[76:79], v[104:107], v[52:55]
    s_lshl_b32 s4, s4, 7
    ds_read2_b32 v[138:139], v237 offset0:114 offset1:115
    v_mfma_f32_16x16x32_bf16 v[52:55], v[72:75], v[108:111], v[52:55]
    s_add_u32 s4, s4, 12566528
    ds_read2_b32 v[140:141], v237 offset0:240 offset1:241
    s_add_u32 s6, s12, 4767744
    v_mfma_f32_16x16x32_bf16 v[52:55], v[68:71], v[112:115], v[52:55]
    ds_read2_b32 v[142:143], v237 offset0:242 offset1:243
    v_mfma_f32_16x16x32_bf16 v[52:55], v[64:67], v[116:119], v[52:55]
    ds_read2_b32 v[144:145], v238 offset0:112 offset1:113
    v_lshl_add_u32 v28, v2, 2, s4
    v_mfma_f32_16x16x32_bf16 v[56:59], v[64:67], v[120:123], v[56:59]
    s_waitcnt lgkmcnt(9)
    s_barrier
    v_mfma_f32_16x16x32_bf16 v[56:59], v[68:71], v[116:119], v[56:59]
    ds_read2_b32 v[146:147], v238 offset0:114 offset1:115
    s_cmp_eq_u32 s3, 0
    s_cselect_b32 s4, 18, 0
    v_mfma_f32_16x16x32_bf16 v[56:59], v[72:75], v[112:115], v[56:59]
    ds_read2_b32 v[148:149], v238 offset0:240 offset1:241
    v_mfma_f32_16x16x32_bf16 v[56:59], v[76:79], v[108:111], v[56:59]
    ds_read2_b32 v[150:151], v238 offset0:242 offset1:243
    v_cmp_gt_u32 vcc, s4, v2
    v_mfma_f32_16x16x32_bf16 v[56:59], v[80:83], v[104:107], v[56:59]
    s_lshl_b32 s14, s101, 18
    ds_read2_b32 v[152:153], v239 offset0:112 offset1:113
    v_mfma_f32_16x16x32_bf16 v[56:59], v[84:87], v[100:103], v[56:59]
    ds_read2_b32 v[154:155], v239 offset0:114 offset1:115
    s_add_u32 m0, s73, 16384
    v_mov_b32 v13, 0x40000000
    v_mfma_f32_16x16x32_bf16 v[56:59], v[88:91], v[96:99], v[56:59]
    buffer_load_dwordx4 v4, s[52:55], s14 offen offset:0 lds
    ds_read2_b32 v[156:157], v239 offset0:240 offset1:241
    v_mfma_f32_16x16x32_bf16 v[60:63], v[92:95], v[96:99], v[60:63]
    ds_read2_b32 v[158:159], v239 offset0:242 offset1:243
    v_cndmask_b32 v28, v13, v28, vcc
    v_mfma_f32_16x16x32_bf16 v[60:63], v[88:91], v[100:103], v[60:63]
    v_mfma_f32_16x16x32_bf16 v[60:63], v[84:87], v[104:107], v[60:63]
    v_mov_b32 v13, s68
    v_mfma_f32_16x16x32_bf16 v[60:63], v[80:83], v[108:111], v[60:63]
    v_mfma_f32_16x16x32_bf16 v[60:63], v[76:79], v[112:115], v[60:63]
    v_cndmask_b32 v13, 0, v13, vcc
    v_mfma_f32_16x16x32_bf16 v[60:63], v[72:75], v[116:119], v[60:63]
    v_mfma_f32_16x16x32_bf16 v[60:63], v[68:71], v[120:123], v[60:63]
    v_mfma_f32_16x16x32_bf16 v[60:63], v[64:67], v[124:127], v[60:63]
    s_waitcnt lgkmcnt(0)
    v_mfma_f32_16x16x32_bf16 v[60:63], v[128:131], v[188:191], v[60:63]
    v_mfma_f32_16x16x32_bf16 v[60:63], v[132:135], v[184:187], v[60:63]
    s_add_u32 m0, s73, 16384
    v_mfma_f32_16x16x32_bf16 v[60:63], v[136:139], v[180:183], v[60:63]
    buffer_load_dwordx4 v5, s[52:55], s14 offen offset:1024 lds
    v_mfma_f32_16x16x32_bf16 v[60:63], v[140:143], v[176:179], v[60:63]
L_pl_X_6:
    s_cbranch_execz L_wret
    v_mfma_f32_16x16x32_bf16 v[60:63], v[144:147], v[172:175], v[60:63]
    v_mfma_f32_16x16x32_bf16 v[60:63], v[148:151], v[168:171], v[60:63]
    v_mfma_f32_16x16x32_bf16 v[60:63], v[152:155], v[164:167], v[60:63]
    v_mfma_f32_16x16x32_bf16 v[60:63], v[156:159], v[160:163], v[60:63]
    v_mfma_f32_16x16x32_bf16 v[56:59], v[128:131], v[184:187], v[56:59]
    v_mfma_f32_16x16x32_bf16 v[56:59], v[132:135], v[180:183], v[56:59]
    v_mfma_f32_16x16x32_bf16 v[56:59], v[136:139], v[176:179], v[56:59]
    v_mfma_f32_16x16x32_bf16 v[56:59], v[140:143], v[172:175], v[56:59]
    s_add_u32 m0, s73, 16384
    v_mfma_f32_16x16x32_bf16 v[56:59], v[144:147], v[168:171], v[56:59]
    buffer_load_dwordx4 v6, s[52:55], s14 offen offset:2048 lds
    v_mfma_f32_16x16x32_bf16 v[56:59], v[148:151], v[164:167], v[56:59]
    v_cvt_pk_bf16_f32 v206, v60, v61
    v_mfma_f32_16x16x32_bf16 v[56:59], v[152:155], v[160:163], v[56:59]
    s_waitcnt vmcnt(7)
    s_barrier
    v_mfma_f32_16x16x32_bf16 v[52:55], v[128:131], v[180:183], v[52:55]
    v_add_u32 v10, 131072, v10
    v_mfma_f32_16x16x32_bf16 v[52:55], v[132:135], v[176:179], v[52:55]
    ds_read_b64_tr_b16 a[240:241], v10 offset:16384
    v_cvt_pk_bf16_f32 v207, v62, v63
    v_mfma_f32_16x16x32_bf16 v[52:55], v[136:139], v[172:175], v[52:55]
    ds_read_b64_tr_b16 a[242:243], v10 offset:18432
    v_mfma_f32_16x16x32_bf16 v[52:55], v[140:143], v[168:171], v[52:55]
    buffer_store_dwordx2 v[206:207], v8, s[44:47], s6 offen offset:3584 sc1
    v_mfma_f32_16x16x32_bf16 v[52:55], v[144:147], v[164:167], v[52:55]
    ds_read_b64_tr_b16 a[248:249], v10 offset:20480
    v_mfma_f32_16x16x32_bf16 v[52:55], v[148:151], v[160:163], v[52:55]
    ds_read_b64_tr_b16 a[250:251], v10 offset:22528
    v_mfma_f32_16x16x32_bf16 v[48:51], v[128:131], v[176:179], v[48:51]
    v_add_u32 v11, 131072, v11
    v_cvt_pk_bf16_f32 v204, v56, v57
    v_mfma_f32_16x16x32_bf16 v[48:51], v[132:135], v[172:175], v[48:51]
    ds_read_b64_tr_b16 a[244:245], v11 offset:16384
    s_add_u32 m0, s73, 16384
    v_mfma_f32_16x16x32_bf16 v[48:51], v[136:139], v[168:171], v[48:51]
    ds_read_b64_tr_b16 a[246:247], v11 offset:18432
    buffer_load_dwordx4 v7, s[52:55], s14 offen offset:3072 lds
    v_mfma_f32_16x16x32_bf16 v[48:51], v[140:143], v[164:167], v[48:51]
    v_cvt_pk_bf16_f32 v205, v58, v59
    v_mfma_f32_16x16x32_bf16 v[48:51], v[144:147], v[160:163], v[48:51]
    ds_read_b64_tr_b16 a[252:253], v11 offset:20480
    v_mfma_f32_16x16x32_bf16 v[44:47], v[128:131], v[172:175], v[44:47]
    buffer_store_dwordx2 v[204:205], v8, s[44:47], s6 offen offset:3072 sc1
    ds_read_b64_tr_b16 a[254:255], v11 offset:22528
    v_mfma_f32_16x16x32_bf16 v[44:47], v[132:135], v[168:171], v[44:47]
    v_mfma_f32_16x16x32_bf16 v[44:47], v[136:139], v[164:167], v[44:47]
    v_mfma_f32_16x16x32_bf16 v[44:47], v[140:143], v[160:163], v[44:47]
    v_cvt_pk_bf16_f32 v202, v52, v53
    v_mfma_f32_16x16x32_bf16 v[40:43], v[128:131], v[168:171], v[40:43]
    v_mfma_f32_16x16x32_bf16 v[40:43], v[132:135], v[164:167], v[40:43]
    v_mfma_f32_16x16x32_bf16 v[40:43], v[136:139], v[160:163], v[40:43]
    v_cvt_pk_bf16_f32 v203, v54, v55
    v_mfma_f32_16x16x32_bf16 v[36:39], v[128:131], v[164:167], v[36:39]
    v_mfma_f32_16x16x32_bf16 v[36:39], v[132:135], v[160:163], v[36:39]
    buffer_store_dwordx2 v[202:203], v8, s[44:47], s6 offen offset:2560 sc1
    v_mfma_f32_16x16x32_bf16 v[32:35], v[128:131], v[160:163], v[32:35]
    v_mov_b32 v29, 0
    buffer_atomic_add v29, v28, s[44:47], 0 offen sc0 sc1
    v_cvt_pk_bf16_f32 v200, v48, v49
    v_cvt_pk_bf16_f32 v201, v50, v51
    buffer_store_dwordx2 v[200:201], v8, s[44:47], s6 offen offset:2048 sc1
    v_cvt_pk_bf16_f32 v198, v44, v45
    v_cvt_pk_bf16_f32 v199, v46, v47
    buffer_store_dwordx2 v[198:199], v8, s[44:47], s6 offen offset:1536 sc1
    v_cvt_pk_bf16_f32 v196, v40, v41
    v_cvt_pk_bf16_f32 v197, v42, v43
    buffer_store_dwordx2 v[196:197], v8, s[44:47], s6 offen offset:1024 sc1
    v_cvt_pk_bf16_f32 v194, v36, v37
    v_cvt_pk_bf16_f32 v195, v38, v39
    buffer_store_dwordx2 v[194:195], v8, s[44:47], s6 offen offset:512 sc1
    v_cvt_pk_bf16_f32 v192, v32, v33
    v_cvt_pk_bf16_f32 v193, v34, v35
    buffer_store_dwordx2 v[192:193], v8, s[44:47], s6 offen offset:0 sc1
    v_add_u32 v10, -131072, v10
    v_add_u32 v11, -131072, v11
    s_waitcnt lgkmcnt(0)
    s_barrier
L_DX:
    s_waitcnt vmcnt(0)
    v_cmp_ne_u32 vcc, v13, v29
    s_cbranch_vccnz L_rs_p2X
L_ok_p2X:
    s_barrier
    s_add_u32 m0, s73, 97536
    s_nop 0
    buffer_load_dwordx4 v23, s[44:47], s18 offen offset:768 sc1 lds
    s_add_u32 m0, s73, 99328
    s_nop 0
    buffer_load_dwordx4 v20, s[44:47], s18 offen offset:0 sc1 lds
    s_add_u32 m0, s73, 99840
    s_nop 0
    buffer_load_dwordx4 v20, s[44:47], s18 offen offset:512 sc1 lds
    s_add_u32 m0, s73, 100608
    s_nop 0
    buffer_load_dwordx4 v23, s[44:47], s19 offen offset:768 sc1 lds
    s_add_u32 m0, s73, 114688
    s_nop 0
    buffer_load_dwordx4 v20, s[44:47], s19 offen offset:0 sc1 lds
    s_add_u32 m0, s73, 115200
    s_nop 0
    buffer_load_dwordx4 v20, s[44:47], s19 offen offset:512 sc1 lds
    s_add_u32 m0, s73, 115968
    s_nop 0
    buffer_load_dwordx4 v23, s[44:47], s20 offen offset:768 sc1 lds
    s_add_u32 m0, s73, 117760
    s_nop 0
    buffer_load_dwordx4 v20, s[44:47], s20 offen offset:0 sc1 lds
    s_mov_b32 s56, s16
    s_and_b32 s57, s17, 0xffff
    s_mov_b32 s58, 2359296
    s_mov_b32 s59, 0x20000
    s_mov_b32 s40, 18432
    s_mov_b32 s42, 12386304
    s_mov_b32 s64, s38
    s_and_b32 s65, s39, 0xffff
    s_mov_b32 s66, 2359296
    s_mov_b32 s67, 0x20000
    v_lshlrev_b32 v136, 4, v2
    s_mul_i32 s7, s72, 36
    s_bitcmp1_b32 s3, 0
    s_addc_u32 s7, s7, 0
    s_lshl_b32 s7, s7, 17
    v_subrev_u32 v184, s7, v4
    v_subrev_u32 v185, s7, v5
    s_bfe_u32 s4, s2, 0x20003
    s_mul_i32 s4, s4, 9
    s_lshl1_add_u32 s7, s72, s4
    s_and_b32 s8, s3, 1
    s_add_u32 s7, s7, s8
    s_lshl_b32 s37, s7, 16
    s_add_u32 s37, s37, 4718592
    s_add_u32 s4, s4, 8
    s_lshl_b32 s16, s4, 16
    s_add_u32 s16, s16, 4718592
    s_sub_u32 s4, s4, s7
    s_lshl_b32 s4, s4, 7
    s_lshl_b32 s7, s7, 7
    s_add_u32 s7, s7, 12582912
    v_bfe_u32 v24, v2, 2, 1
    v_mul_u32_u24 v24, s4, v24
    v_and_b32 v25, 3, v2
    v_lshl_add_u32 v24, v25, 2, v24
    v_add_u32 v188, s7, v24
    s_lshl2_add_u32 s7, s2, s3
    s_mul_i32 s8, s7, 3072
    s_add_u32 s34, s8, 22953984
    s_add_u32 s11, s8, 26099712
    s_add_u32 s12, s8, 29245440
    s_lshl_b32 s35, s7, 12
    s_add_u32 s35, s35, 32391168
    s_xor_b32 s8, s7, 8
    s_mul_i32 s8, s8, 3072
    s_add_u32 s30, s8, 22953984
    s_xor_b32 s8, s7, 16
    s_mul_i32 s8, s8, 3072
    s_add_u32 s15, s8, 26099712
    s_xor_b32 s8, s7, 24
    s_mul_i32 s8, s8, 3072
    s_add_u32 s31, s8, 29245440
    s_andn2_b32 s7, s7, 24
    s_lshl3_add_u32 s7, s3, s7
    s_lshl2_add_u32 s8, s7, s72
    s_lshl_b32 s8, s8, 10
    s_add_u32 s32, s8, 32391168
    s_xor_b32 s8, s8, 4096
    s_add_u32 s33, s8, 32391168
    s_xor_b32 s8, s3, s72
    s_cmp_lt_u32 s8, 2
    s_cselect_b32 s35, s35, 0x40000000
    s_cselect_b32 s16, s16, 0x40000000
    s_cselect_b32 s36, s68, 0
    s_mov_b32 s38, 0xbfb8aa3b
    s_and_b32 s8, s8, 1
    s_mul_i32 s41, s8, 96
    s_and_b32 s43, s73, 4096
    v_lshlrev_b32 v24, 10, v2
    v_add_u32 v24, s35, v24
    s_add_u32 s7, s34, 2048
    v_mov_b32 v25, s36
    v_cmp_gt_u32 vcc, 4, v2
    s_nop 1
    v_cndmask_b32 v138, 0, v25, vcc
    v_mov_b32 v25, 0x40000000
    v_cndmask_b32 v137, v25, v24, vcc
    v_writelane_b32 v137, s7, 4
    v_writelane_b32 v138, s68, 4
    v_min_u32 v139, 1, v2
    v_lshlrev_b32 v139, 30, v139
    v_mov_b32 v140, 0
    v_writelane_b32 v140, s68, 0
    v_mov_b32 v195, s68
    v_mov_b32 v199, s68
    v_mov_b32 v202, s68
    v_mov_b32 v203, s68
    s_waitcnt vmcnt(4)
    s_barrier
    ds_read_b128 v[104:107], v14 offset:0
    ds_read_b128 v[108:111], v14 offset:4096
    ds_read_b128 v[112:115], v14 offset:8192
    ds_read_b128 v[116:119], v14 offset:12288
    s_waitcnt lgkmcnt(2)
    v_mfma_f32_16x16x32_bf16 v[32:35], v[104:107], a[0:3], 0
    s_add_u32 m0, s73, 130560
    s_sub_u32 s4, s75, 216
    s_lshl_b32 s7, s4, 7
    v_mfma_f32_16x16x32_bf16 v[32:35], v[108:111], a[8:11], v[32:35]
    buffer_load_dwordx4 v20, s[44:47], s20 offen offset:512 sc1 lds
    s_waitcnt lgkmcnt(0)
    v_mfma_f32_16x16x32_bf16 v[32:35], v[112:115], a[16:19], v[32:35]
    ds_read_b128 v[120:123], v14 offset:1024
    s_lshl2_add_u32 s7, s3, s7
    s_add_u32 s7, s7, 12582912
    v_mfma_f32_16x16x32_bf16 v[32:35], v[116:119], a[24:27], v[32:35]
    ds_read_b128 v[124:127], v14 offset:5120
    v_mfma_f32_16x16x32_bf16 v[36:39], v[116:119], a[28:31], 0
    ds_read_b128 v[128:131], v14 offset:9216
    s_cmp_lt_u32 s4, 36
    s_cselect_b32 s7, s7, 0x40000000
    v_mfma_f32_16x16x32_bf16 v[36:39], v[112:115], a[20:23], v[36:39]
    ds_read_b128 v[132:135], v14 offset:13312
    v_min_u32 v28, 1, v2
    v_mfma_f32_16x16x32_bf16 v[36:39], v[108:111], a[12:15], v[36:39]
    s_add_u32 m0, s73, 131328
    v_lshlrev_b32 v28, 30, v28
    v_mov_b32 v29, s68
    v_mfma_f32_16x16x32_bf16 v[36:39], v[104:107], a[4:7], v[36:39]
    buffer_load_dwordx4 v23, s[44:47], s21 offen offset:768 sc1 lds
    s_waitcnt lgkmcnt(2)
    v_mfma_f32_16x16x32_bf16 v[44:47], v[120:123], a[4:7], 0
    buffer_store_dword v29, v28, s[44:47], s7 offen sc1
    s_add_u32 m0, s73, 133120
    v_mfma_f32_16x16x32_bf16 v[44:47], v[124:127], a[12:15], v[44:47]
    buffer_load_dwordx4 v20, s[44:47], s21 offen offset:0 sc1 lds
    s_waitcnt lgkmcnt(0)
    v_mfma_f32_16x16x32_bf16 v[44:47], v[128:131], a[20:23], v[44:47]
    ds_read_b128 v[104:107], v14 offset:2048
    v_mfma_f32_16x16x32_bf16 v[44:47], v[132:135], a[28:31], v[44:47]
    ds_read_b128 v[108:111], v14 offset:6144
    v_mfma_f32_16x16x32_bf16 v[40:43], v[132:135], a[24:27], 0
    ds_read_b128 v[112:115], v14 offset:10240
    v_mfma_f32_16x16x32_bf16 v[40:43], v[128:131], a[16:19], v[40:43]
    ds_read_b128 v[116:119], v14 offset:14336
    v_mfma_f32_16x16x32_bf16 v[40:43], v[124:127], a[8:11], v[40:43]
    s_add_u32 m0, s73, 133632
    v_mfma_f32_16x16x32_bf16 v[40:43], v[120:123], a[0:3], v[40:43]
    buffer_load_dwordx4 v20, s[44:47], s21 offen offset:512 sc1 lds
    s_waitcnt lgkmcnt(2)
    v_mfma_f32_16x16x32_bf16 v[48:51], v[104:107], a[0:3], 0
    s_add_u32 m0, s73, 146688
    v_mfma_f32_16x16x32_bf16 v[48:51], v[108:111], a[8:11], v[48:51]
    buffer_load_dwordx4 v23, s[44:47], s22 offen offset:768 sc1 lds
    s_waitcnt lgkmcnt(0)
    v_mfma_f32_16x16x32_bf16 v[48:51], v[112:115], a[16:19], v[48:51]
    ds_read_b128 v[120:123], v14 offset:3072
    v_mfma_f32_16x16x32_bf16 v[48:51], v[116:119], a[24:27], v[48:51]
    ds_read_b128 v[124:127], v14 offset:7168
    v_mfma_f32_16x16x32_bf16 v[52:55], v[116:119], a[28:31], 0
    ds_read_b128 v[128:131], v14 offset:11264
    v_mfma_f32_16x16x32_bf16 v[52:55], v[112:115], a[20:23], v[52:55]
    ds_read_b128 v[132:135], v14 offset:15360
    v_mfma_f32_16x16x32_bf16 v[52:55], v[108:111], a[12:15], v[52:55]
    s_add_u32 m0, s73, 148480
    v_mfma_f32_16x16x32_bf16 v[52:55], v[104:107], a[4:7], v[52:55]
    buffer_load_dwordx4 v20, s[44:47], s22 offen offset:0 sc1 lds
    s_waitcnt lgkmcnt(2)
    v_mfma_f32_16x16x32_bf16 v[36:39], v[120:123], a[36:39], v[36:39]
    s_add_u32 m0, s73, 148992
    v_mfma_f32_16x16x32_bf16 v[36:39], v[124:127], a[44:47], v[36:39]
    buffer_load_dwordx4 v20, s[44:47], s22 offen offset:512 sc1 lds
    s_waitcnt lgkmcnt(0)
    v_mfma_f32_16x16x32_bf16 v[36:39], v[128:131], a[52:55], v[36:39]
    s_waitcnt vmcnt(8)
    s_barrier
    v_mfma_f32_16x16x32_bf16 v[36:39], v[132:135], a[60:63], v[36:39]
    ds_read_b128 v[104:107], v14 offset:16384
    v_mfma_f32_16x16x32_bf16 v[32:35], v[132:135], a[56:59], v[32:35]
    ds_read_b128 v[108:111], v14 offset:20480
    v_mfma_f32_16x16x32_bf16 v[32:35], v[128:131], a[48:51], v[32:35]
    ds_read_b128 v[112:115], v14 offset:24576
    v_mfma_f32_16x16x32_bf16 v[32:35], v[124:127], a[40:43], v[32:35]
    ds_read_b128 v[116:119], v14 offset:28672
    s_add_u32 m0, s73, 149760
    v_mfma_f32_16x16x32_bf16 v[32:35], v[120:123], a[32:35], v[32:35]
    buffer_load_dwordx4 v23, s[44:47], s23 offen offset:768 sc1 lds
    ds_read_b64_tr_b16 v[220:221], v10 offset:0
    s_waitcnt lgkmcnt(3)
    v_mfma_f32_16x16x32_bf16 v[40:43], v[104:107], a[32:35], v[40:43]
    s_add_u32 m0, s73, 98304
    ds_read_b64_tr_b16 v[222:223], v10 offset:2048
    v_mfma_f32_16x16x32_bf16 v[40:43], v[108:111], a[40:43], v[40:43]
    buffer_load_dwordx4 v20, s[44:47], s23 offen offset:0 sc1 lds
    s_waitcnt lgkmcnt(2)
    v_mfma_f32_16x16x32_bf16 v[40:43], v[112:115], a[48:51], v[40:43]
    ds_read_b128 v[120:123], v14 offset:17408
    v_mfma_f32_16x16x32_bf16 v[40:43], v[116:119], a[56:59], v[40:43]
    ds_read_b128 v[124:127], v14 offset:21504
    v_mfma_f32_16x16x32_bf16 v[44:47], v[116:119], a[60:63], v[44:47]
    ds_read_b128 v[128:131], v14 offset:25600
    v_mfma_f32_16x16x32_bf16 v[44:47], v[112:115], a[52:55], v[44:47]
    ds_read_b128 v[132:135], v14 offset:29696
    v_mfma_f32_16x16x32_bf16 v[44:47], v[108:111], a[44:47], v[44:47]
    s_add_u32 m0, s73, 98816
    ds_read_b64_tr_b16 v[228:229], v10 offset:4096
    v_mfma_f32_16x16x32_bf16 v[44:47], v[104:107], a[36:39], v[44:47]
    buffer_load_dwordx4 v20, s[44:47], s23 offen offset:512 sc1 lds
    s_waitcnt lgkmcnt(3)
    v_mfma_f32_16x16x32_bf16 v[52:55], v[120:123], a[36:39], v[52:55]
    s_add_u32 m0, s73, 99584
    ds_read_b64_tr_b16 v[230:231], v10 offset:6144
    v_mfma_f32_16x16x32_bf16 v[52:55], v[124:127], a[44:47], v[52:55]
    buffer_load_dwordx4 v23, s[44:47], s24 offen offset:768 sc1 lds
    s_waitcnt lgkmcnt(2)
    v_mfma_f32_16x16x32_bf16 v[52:55], v[128:131], a[52:55], v[52:55]
    ds_read_b128 v[104:107], v14 offset:18432
    v_mfma_f32_16x16x32_bf16 v[52:55], v[132:135], a[60:63], v[52:55]
    ds_read_b128 v[108:111], v14 offset:22528
    v_mfma_f32_16x16x32_bf16 v[48:51], v[132:135], a[56:59], v[48:51]
    ds_read_b128 v[112:115], v14 offset:26624
    v_mfma_f32_16x16x32_bf16 v[48:51], v[128:131], a[48:51], v[48:51]
    ds_read_b128 v[116:119], v14 offset:30720
    v_mfma_f32_16x16x32_bf16 v[48:51], v[124:127], a[40:43], v[48:51]
    s_add_u32 m0, s73, 101376
    ds_read_b64_tr_b16 v[224:225], v11 offset:0
    v_mfma_f32_16x16x32_bf16 v[48:51], v[120:123], a[32:35], v[48:51]
    buffer_load_dwordx4 v20, s[44:47], s24 offen offset:0 sc1 lds
    s_waitcnt lgkmcnt(3)
    v_mfma_f32_16x16x32_bf16 v[32:35], v[104:107], a[64:67], v[32:35]
    ds_read_b64_tr_b16 v[226:227], v11 offset:2048
    v_mfma_f32_16x16x32_bf16 v[32:35], v[108:111], a[72:75], v[32:35]
    s_waitcnt lgkmcnt(2)
    v_mfma_f32_16x16x32_bf16 v[32:35], v[112:115], a[80:83], v[32:35]
    ds_read_b128 v[120:123], v14 offset:19456
    v_mfma_f32_16x16x32_bf16 v[32:35], v[116:119], a[88:91], v[32:35]
    ds_read_b128 v[124:127], v14 offset:23552
    v_mfma_f32_16x16x32_bf16 v[36:39], v[116:119], a[92:95], v[36:39]
    ds_read_b128 v[128:131], v14 offset:27648
    v_mfma_f32_16x16x32_bf16 v[36:39], v[112:115], a[84:87], v[36:39]
    ds_read_b128 v[132:135], v14 offset:31744
    v_mfma_f32_16x16x32_bf16 v[36:39], v[108:111], a[76:79], v[36:39]
    ds_read_b64_tr_b16 v[232:233], v11 offset:4096
    v_mfma_f32_16x16x32_bf16 v[36:39], v[104:107], a[68:71], v[36:39]
    s_waitcnt lgkmcnt(3)
    v_mfma_f32_16x16x32_bf16 v[44:47], v[120:123], a[68:71], v[44:47]
    ds_read_b64_tr_b16 v[234:235], v11 offset:6144
    v_mfma_f32_16x16x32_bf16 v[44:47], v[124:127], a[76:79], v[44:47]
    s_waitcnt lgkmcnt(2)
    v_mfma_f32_16x16x32_bf16 v[44:47], v[128:131], a[84:87], v[44:47]
    s_waitcnt vmcnt(8) lgkmcnt(0)
    s_barrier
    v_mfma_f32_16x16x32_bf16 v[44:47], v[132:135], a[92:95], v[44:47]
    ds_read_b128 v[104:107], v14 offset:32768
    v_mfma_f32_16x16x32_bf16 v[40:43], v[132:135], a[88:91], v[40:43]
    ds_read_b128 v[108:111], v14 offset:36864
    v_mfma_f32_16x16x32_bf16 v[40:43], v[128:131], a[80:83], v[40:43]
    ds_read_b128 v[112:115], v14 offset:40960
    v_mfma_f32_16x16x32_bf16 v[40:43], v[124:127], a[72:75], v[40:43]
    ds_read_b128 v[116:119], v14 offset:45056
    v_mfma_f32_16x16x32_bf16 v[40:43], v[120:123], a[64:67], v[40:43]
    ds_read_b64_tr_b16 v[236:237], v10 offset:16384
    s_waitcnt lgkmcnt(3)
    v_mfma_f32_16x16x32_bf16 v[48:51], v[104:107], a[64:67], v[48:51]
    s_add_u32 m0, s73, 114176
    ds_read_b64_tr_b16 v[238:239], v10 offset:18432
    v_mfma_f32_16x16x32_bf16 v[48:51], v[108:111], a[72:75], v[48:51]
    buffer_load_dwordx4 v20, s[44:47], s24 offen offset:512 sc1 lds
    s_waitcnt lgkmcnt(2)
    v_mfma_f32_16x16x32_bf16 v[48:51], v[112:115], a[80:83], v[48:51]
    ds_read_b128 v[120:123], v14 offset:33792
    v_mfma_f32_16x16x32_bf16 v[48:51], v[116:119], a[88:91], v[48:51]
    ds_read_b128 v[124:127], v14 offset:37888
    v_lshrrev_b32 v30, 2, v26
    v_mfma_f32_16x16x32_bf16 v[52:55], v[116:119], a[92:95], v[52:55]
    ds_read_b128 v[128:131], v14 offset:41984
    v_mfma_f32_16x16x32_bf16 v[52:55], v[112:115], a[84:87], v[52:55]
    ds_read_b128 v[132:135], v14 offset:46080
    v_mfma_f32_16x16x32_bf16 v[52:55], v[108:111], a[76:79], v[52:55]
    s_add_u32 m0, s73, 114944
    ds_read_b64_tr_b16 v[244:245], v10 offset:20480
    v_mfma_f32_16x16x32_bf16 v[52:55], v[104:107], a[68:71], v[52:55]
    buffer_load_dwordx4 v23, s[44:47], s25 offen offset:768 sc1 lds
    s_waitcnt lgkmcnt(3)
    v_mfma_f32_16x16x32_bf16 v[36:39], v[120:123], a[100:103], v[36:39]
    s_add_u32 m0, s73, 116736
    ds_read_b64_tr_b16 v[246:247], v10 offset:22528
    v_mfma_f32_16x16x32_bf16 v[36:39], v[124:127], a[108:111], v[36:39]
    buffer_load_dwordx4 v20, s[44:47], s25 offen offset:0 sc1 lds
    s_waitcnt lgkmcnt(2)
    v_mfma_f32_16x16x32_bf16 v[36:39], v[128:131], a[116:119], v[36:39]
    ds_read_b128 v[104:107], v14 offset:34816
    v_lshrrev_b32 v31, 2, v18
    v_mfma_f32_16x16x32_bf16 v[36:39], v[132:135], a[124:127], v[36:39]
    ds_read_b128 v[108:111], v14 offset:38912
    v_mfma_f32_16x16x32_bf16 v[32:35], v[132:135], a[120:123], v[32:35]
    ds_read_b128 v[112:115], v14 offset:43008
    v_mfma_f32_16x16x32_bf16 v[32:35], v[128:131], a[112:115], v[32:35]
    ds_read_b128 v[116:119], v14 offset:47104
    v_mfma_f32_16x16x32_bf16 v[32:35], v[124:127], a[104:107], v[32:35]
    s_add_u32 m0, s73, 117248
    ds_read_b64_tr_b16 v[240:241], v11 offset:16384
    v_mfma_f32_16x16x32_bf16 v[32:35], v[120:123], a[96:99], v[32:35]
    buffer_load_dwordx4 v20, s[44:47], s25 offen offset:512 sc1 lds
    s_waitcnt lgkmcnt(3)
    v_mfma_f32_16x16x32_bf16 v[40:43], v[104:107], a[96:99], v[40:43]
    ds_read_b64_tr_b16 v[242:243], v11 offset:18432
    buffer_load_ushort v102, v30, s[60:63], 0 offen offset:0
    v_mfma_f32_16x16x32_bf16 v[40:43], v[108:111], a[104:107], v[40:43]
    s_waitcnt lgkmcnt(2)
    v_mfma_f32_16x16x32_bf16 v[40:43], v[112:115], a[112:115], v[40:43]
    ds_read_b128 v[120:123], v14 offset:35840
    v_mfma_f32_16x16x32_bf16 v[40:43], v[116:119], a[120:123], v[40:43]
    ds_read_b128 v[124:127], v14 offset:39936
    v_mfma_f32_16x16x32_bf16 v[44:47], v[116:119], a[124:127], v[44:47]
    ds_read_b128 v[128:131], v14 offset:44032
    v_mfma_f32_16x16x32_bf16 v[44:47], v[112:115], a[116:119], v[44:47]
    ds_read_b128 v[132:135], v14 offset:48128
    v_mfma_f32_16x16x32_bf16 v[44:47], v[108:111], a[108:111], v[44:47]
    ds_read_b64_tr_b16 v[248:249], v11 offset:20480
    buffer_load_ushort v103, v30, s[60:63], 0 offen offset:32
    v_mfma_f32_16x16x32_bf16 v[44:47], v[104:107], a[100:103], v[44:47]
    s_waitcnt lgkmcnt(3)
    v_mfma_f32_16x16x32_bf16 v[52:55], v[120:123], a[100:103], v[52:55]
    ds_read_b64_tr_b16 v[250:251], v11 offset:22528
    v_mfma_f32_16x16x32_bf16 v[52:55], v[124:127], a[108:111], v[52:55]
    s_waitcnt lgkmcnt(2)
    v_mfma_f32_16x16x32_bf16 v[52:55], v[128:131], a[116:119], v[52:55]
    s_waitcnt vmcnt(10) lgkmcnt(0)
    s_barrier
    v_mfma_f32_16x16x32_bf16 v[52:55], v[132:135], a[124:127], v[52:55]
    ds_read_b128 v[104:107], v14 offset:49152
    v_mfma_f32_16x16x32_bf16 v[48:51], v[132:135], a[120:123], v[48:51]
    ds_read_b128 v[108:111], v14 offset:53248
    buffer_load_ushort v27, v31, s[60:63], 0 offen offset:0
    v_mfma_f32_16x16x32_bf16 v[48:51], v[128:131], a[112:115], v[48:51]
    ds_read_b128 v[112:115], v14 offset:57344
    v_mfma_f32_16x16x32_bf16 v[48:51], v[124:127], a[104:107], v[48:51]
    ds_read_b128 v[116:119], v14 offset:61440
    v_mfma_f32_16x16x32_bf16 v[48:51], v[120:123], a[96:99], v[48:51]
    s_waitcnt lgkmcnt(2)
    v_mfma_f32_16x16x32_bf16 v[32:35], v[104:107], a[128:131], v[32:35]
    s_add_u32 m0, s73, 130304
    v_mfma_f32_16x16x32_bf16 v[32:35], v[108:111], a[136:139], v[32:35]
    buffer_load_dwordx4 v23, s[44:47], s26 offen offset:768 sc1 lds
    s_waitcnt lgkmcnt(0)
    v_mfma_f32_16x16x32_bf16 v[32:35], v[112:115], a[144:147], v[32:35]
    ds_read_b128 v[120:123], v14 offset:50176
    v_mfma_f32_16x16x32_bf16 v[32:35], v[116:119], a[152:155], v[32:35]
    ds_read_b128 v[124:127], v14 offset:54272
    v_mfma_f32_16x16x32_bf16 v[36:39], v[116:119], a[156:159], v[36:39]
    ds_read_b128 v[128:131], v14 offset:58368
    v_mfma_f32_16x16x32_bf16 v[36:39], v[112:115], a[148:151], v[36:39]
    ds_read_b128 v[132:135], v14 offset:62464
    v_mfma_f32_16x16x32_bf16 v[36:39], v[108:111], a[140:143], v[36:39]
    s_add_u32 m0, s73, 132096
    v_mfma_f32_16x16x32_bf16 v[36:39], v[104:107], a[132:135], v[36:39]
    buffer_load_dwordx4 v20, s[44:47], s26 offen offset:0 sc1 lds
    s_waitcnt lgkmcnt(2)
    v_mfma_f32_16x16x32_bf16 v[44:47], v[120:123], a[132:135], v[44:47]
    s_add_u32 m0, s73, 132608
    buffer_load_dwordx4 v[88:91], v252, s[56:59], 0 offen
    v_mfma_f32_16x16x32_bf16 v[44:47], v[124:127], a[140:143], v[44:47]
    buffer_load_dwordx4 v20, s[44:47], s26 offen offset:512 sc1 lds
    s_waitcnt lgkmcnt(0)
    v_mfma_f32_16x16x32_bf16 v[44:47], v[128:131], a[148:151], v[44:47]
    ds_read_b128 v[104:107], v14 offset:51200
    v_mfma_f32_16x16x32_bf16 v[44:47], v[132:135], a[156:159], v[44:47]
    ds_read_b128 v[108:111], v14 offset:55296
    v_mfma_f32_16x16x32_bf16 v[40:43], v[132:135], a[152:155], v[40:43]
    ds_read_b128 v[112:115], v14 offset:59392
    v_mfma_f32_16x16x32_bf16 v[40:43], v[128:131], a[144:147], v[40:43]
    ds_read_b128 v[116:119], v14 offset:63488
    v_mfma_f32_16x16x32_bf16 v[40:43], v[124:127], a[136:139], v[40:43]
    s_add_u32 m0, s73, 134144
    v_mfma_f32_16x16x32_bf16 v[40:43], v[120:123], a[128:131], v[40:43]
    buffer_load_dwordx4 v21, s[44:47], s18 offen offset:0 sc1 lds
    s_waitcnt lgkmcnt(2)
    v_mfma_f32_16x16x32_bf16 v[48:51], v[104:107], a[128:131], v[48:51]
    v_mfma_f32_16x16x32_bf16 v[48:51], v[108:111], a[136:139], v[48:51]
    s_waitcnt lgkmcnt(0)
    v_mfma_f32_16x16x32_bf16 v[48:51], v[112:115], a[144:147], v[48:51]
    ds_read_b128 v[120:123], v14 offset:52224
    v_mfma_f32_16x16x32_bf16 v[48:51], v[116:119], a[152:155], v[48:51]
    ds_read_b128 v[124:127], v14 offset:56320
    v_mfma_f32_16x16x32_bf16 v[52:55], v[116:119], a[156:159], v[52:55]
    ds_read_b128 v[128:131], v14 offset:60416
    v_mfma_f32_16x16x32_bf16 v[52:55], v[112:115], a[148:151], v[52:55]
    ds_read_b128 v[132:135], v14 offset:64512
    v_mfma_f32_16x16x32_bf16 v[52:55], v[108:111], a[140:143], v[52:55]
    v_mfma_f32_16x16x32_bf16 v[52:55], v[104:107], a[132:135], v[52:55]
    s_waitcnt lgkmcnt(2)
    v_mfma_f32_16x16x32_bf16 v[36:39], v[120:123], a[164:167], v[36:39]
    buffer_load_dwordx4 v[92:95], v252, s[56:59], s40 offen
    v_mfma_f32_16x16x32_bf16 v[36:39], v[124:127], a[172:175], v[36:39]
    s_waitcnt lgkmcnt(0)
    v_mfma_f32_16x16x32_bf16 v[36:39], v[128:131], a[180:183], v[36:39]
    s_waitcnt vmcnt(13)
    s_barrier
    v_mfma_f32_16x16x32_bf16 v[36:39], v[132:135], a[188:191], v[36:39]
    ds_read_b128 v[104:107], v14 offset:0
    v_mfma_f32_16x16x32_bf16 v[32:35], v[132:135], a[184:187], v[32:35]
    ds_read_b128 v[108:111], v14 offset:4096
    v_mfma_f32_16x16x32_bf16 v[32:35], v[128:131], a[176:179], v[32:35]
    ds_read_b128 v[112:115], v14 offset:8192
    v_mfma_f32_16x16x32_bf16 v[32:35], v[124:127], a[168:171], v[32:35]
    ds_read_b128 v[116:119], v14 offset:12288
    v_mfma_f32_16x16x32_bf16 v[32:35], v[120:123], a[160:163], v[32:35]
    s_waitcnt lgkmcnt(2)
    v_mfma_f32_16x16x32_bf16 v[40:43], v[104:107], a[160:163], v[40:43]
    s_add_u32 m0, s73, 146944
    v_mfma_f32_16x16x32_bf16 v[40:43], v[108:111], a[168:171], v[40:43]
    buffer_load_dwordx4 v21, s[44:47], s18 offen offset:512 sc1 lds
    s_waitcnt lgkmcnt(0)
    v_mfma_f32_16x16x32_bf16 v[40:43], v[112:115], a[176:179], v[40:43]
    ds_read_b128 v[120:123], v14 offset:1024
    v_mfma_f32_16x16x32_bf16 v[40:43], v[116:119], a[184:187], v[40:43]
    ds_read_b128 v[124:127], v14 offset:5120
    v_mfma_f32_16x16x32_bf16 v[44:47], v[116:119], a[188:191], v[44:47]
    ds_read_b128 v[128:131], v14 offset:9216
    v_mfma_f32_16x16x32_bf16 v[44:47], v[112:115], a[180:183], v[44:47]
    ds_read_b128 v[132:135], v14 offset:13312
    v_mfma_f32_16x16x32_bf16 v[44:47], v[108:111], a[172:175], v[44:47]
    s_add_u32 m0, s73, 148480
    v_mfma_f32_16x16x32_bf16 v[44:47], v[104:107], a[164:167], v[44:47]
    buffer_load_dwordx4 v21, s[44:47], s19 offen offset:0 sc1 lds
    s_waitcnt lgkmcnt(2)
    v_mfma_f32_16x16x32_bf16 v[52:55], v[120:123], a[164:167], v[52:55]
    s_add_u32 m0, s73, 148992
    buffer_load_dwordx2 v[142:143], v253, s[56:59], 0 offen
    v_mfma_f32_16x16x32_bf16 v[52:55], v[124:127], a[172:175], v[52:55]
    buffer_load_dwordx4 v21, s[44:47], s19 offen offset:512 sc1 lds
    s_waitcnt lgkmcnt(0)
    v_mfma_f32_16x16x32_bf16 v[52:55], v[128:131], a[180:183], v[52:55]
    ds_read_b128 v[104:107], v14 offset:2048
    v_mfma_f32_16x16x32_bf16 v[52:55], v[132:135], a[188:191], v[52:55]
    ds_read_b128 v[108:111], v14 offset:6144
    v_mfma_f32_16x16x32_bf16 v[48:51], v[132:135], a[184:187], v[48:51]
    ds_read_b128 v[112:115], v14 offset:10240
    v_mfma_f32_16x16x32_bf16 v[48:51], v[128:131], a[176:179], v[48:51]
    ds_read_b128 v[116:119], v14 offset:14336
    v_mfma_f32_16x16x32_bf16 v[48:51], v[124:127], a[168:171], v[48:51]
    s_add_u32 m0, s73, 150528
    v_mfma_f32_16x16x32_bf16 v[48:51], v[120:123], a[160:163], v[48:51]
    buffer_load_dwordx4 v21, s[44:47], s20 offen offset:0 sc1 lds
    s_waitcnt lgkmcnt(2)
    v_mfma_f32_16x16x32_bf16 v[32:35], v[104:107], a[192:195], v[32:35]
    v_mfma_f32_16x16x32_bf16 v[32:35], v[108:111], a[200:203], v[32:35]
    s_waitcnt vmcnt(11)
    s_waitcnt lgkmcnt(0)
    v_mfma_f32_16x16x32_bf16 v[32:35], v[112:115], a[208:211], v[32:35]
    ds_read_b128 v[120:123], v14 offset:3072
    v_mfma_f32_16x16x32_bf16 v[32:35], v[116:119], a[216:219], v[32:35]
    ds_read_b128 v[124:127], v14 offset:7168
    v_mfma_f32_16x16x32_bf16 v[36:39], v[116:119], a[220:223], v[36:39]
    ds_read_b128 v[128:131], v14 offset:11264
    v_lshlrev_b32 v72, 16, v102
    v_mfma_f32_16x16x32_bf16 v[36:39], v[112:115], a[212:215], v[36:39]
    ds_read_b128 v[132:135], v14 offset:15360
    v_mfma_f32_16x16x32_bf16 v[36:39], v[108:111], a[204:207], v[36:39]
    v_lshlrev_b32 v73, 16, v102
    v_mfma_f32_16x16x32_bf16 v[36:39], v[104:107], a[196:199], v[36:39]
    buffer_load_dwordx2 v[96:97], v26, s[44:47], s42 offen offset:0 sc1
    s_waitcnt lgkmcnt(2)
    v_mfma_f32_16x16x32_bf16 v[44:47], v[120:123], a[196:199], v[44:47]
    v_mfma_f32_16x16x32_bf16 v[44:47], v[124:127], a[204:207], v[44:47]
    v_lshlrev_b32 v74, 16, v102
    s_waitcnt lgkmcnt(0)
    v_mfma_f32_16x16x32_bf16 v[44:47], v[128:131], a[212:215], v[44:47]
    s_barrier
    v_mfma_f32_16x16x32_bf16 v[44:47], v[132:135], a[220:223], v[44:47]
    ds_read_b128 v[104:107], v14 offset:16384
    v_mfma_f32_16x16x32_bf16 v[40:43], v[132:135], a[216:219], v[40:43]
    ds_read_b128 v[108:111], v14 offset:20480
    v_lshlrev_b32 v75, 16, v102
    v_mfma_f32_16x16x32_bf16 v[40:43], v[128:131], a[208:211], v[40:43]
    ds_read_b128 v[112:115], v14 offset:24576
    v_mfma_f32_16x16x32_bf16 v[40:43], v[124:127], a[200:203], v[40:43]
    ds_read_b128 v[116:119], v14 offset:28672
    v_lshlrev_b32 v76, 16, v103
    v_mfma_f32_16x16x32_bf16 v[40:43], v[120:123], a[192:195], v[40:43]
    s_waitcnt lgkmcnt(2)
    v_mfma_f32_16x16x32_bf16 v[48:51], v[104:107], a[192:195], v[48:51]
L_pl_X_7:
    s_cbranch_execz L_wret
    s_add_u32 m0, s73, 97792
    v_lshlrev_b32 v77, 16, v103
    v_mfma_f32_16x16x32_bf16 v[48:51], v[108:111], a[200:203], v[48:51]
    buffer_load_dwordx4 v21, s[44:47], s20 offen offset:512 sc1 lds
    s_waitcnt lgkmcnt(0)
    v_mfma_f32_16x16x32_bf16 v[48:51], v[112:115], a[208:211], v[48:51]
    ds_read_b128 v[120:123], v14 offset:17408
    v_mfma_f32_16x16x32_bf16 v[48:51], v[116:119], a[216:219], v[48:51]
    ds_read_b128 v[124:127], v14 offset:21504
    v_mfma_f32_16x16x32_bf16 v[52:55], v[116:119], a[220:223], v[52:55]
    ds_read_b128 v[128:131], v14 offset:25600
    v_lshlrev_b32 v78, 16, v103
    v_mfma_f32_16x16x32_bf16 v[52:55], v[112:115], a[212:215], v[52:55]
    ds_read_b128 v[132:135], v14 offset:29696
    v_mfma_f32_16x16x32_bf16 v[52:55], v[108:111], a[204:207], v[52:55]
    s_add_u32 m0, s73, 99328
    v_lshlrev_b32 v79, 16, v103
    v_mfma_f32_16x16x32_bf16 v[52:55], v[104:107], a[196:199], v[52:55]
    buffer_load_dwordx4 v21, s[44:47], s21 offen offset:0 sc1 lds
    s_waitcnt lgkmcnt(2)
    v_mfma_f32_16x16x32_bf16 v[36:39], v[120:123], a[228:231], v[36:39]
    buffer_load_dwordx2 v[98:99], v26, s[44:47], s42 offen offset:128 sc1
    s_add_u32 m0, s73, 99840
    v_lshlrev_b32 v80, 16, v102
    v_mfma_f32_16x16x32_bf16 v[36:39], v[124:127], a[236:239], v[36:39]
    buffer_load_dwordx4 v21, s[44:47], s21 offen offset:512 sc1 lds
    s_waitcnt lgkmcnt(0)
    v_mfma_f32_16x16x32_bf16 v[36:39], v[128:131], a[244:247], v[36:39]
    ds_read_b128 v[104:107], v14 offset:18432
    v_mfma_f32_16x16x32_bf16 v[36:39], v[132:135], a[252:255], v[36:39]
    ds_read_b128 v[108:111], v14 offset:22528
    v_mfma_f32_16x16x32_bf16 v[32:35], v[132:135], a[248:251], v[32:35]
    ds_read_b128 v[112:115], v14 offset:26624
    v_lshlrev_b32 v81, 16, v102
    v_mfma_f32_16x16x32_bf16 v[32:35], v[128:131], a[240:243], v[32:35]
    ds_read_b128 v[116:119], v14 offset:30720
    v_mfma_f32_16x16x32_bf16 v[32:35], v[124:127], a[232:235], v[32:35]
    s_add_u32 m0, s73, 101376
    v_lshlrev_b32 v82, 16, v102
    v_mfma_f32_16x16x32_bf16 v[32:35], v[120:123], a[224:227], v[32:35]
    buffer_load_dwordx4 v21, s[44:47], s22 offen offset:0 sc1 lds
    s_waitcnt lgkmcnt(2)
    v_mfma_f32_16x16x32_bf16 v[40:43], v[104:107], a[224:227], v[40:43]
    v_mfma_f32_16x16x32_bf16 v[40:43], v[108:111], a[232:235], v[40:43]
    v_lshlrev_b32 v83, 16, v102
    s_waitcnt lgkmcnt(0)
    v_mfma_f32_16x16x32_bf16 v[40:43], v[112:115], a[240:243], v[40:43]
    ds_read_b128 v[120:123], v14 offset:19456
    v_mfma_f32_16x16x32_bf16 v[40:43], v[116:119], a[248:251], v[40:43]
    ds_read_b128 v[124:127], v14 offset:23552
    v_mfma_f32_16x16x32_bf16 v[44:47], v[116:119], a[252:255], v[44:47]
    ds_read_b128 v[128:131], v14 offset:27648
    v_lshlrev_b32 v84, 16, v103
    v_mfma_f32_16x16x32_bf16 v[44:47], v[112:115], a[244:247], v[44:47]
    ds_read_b128 v[132:135], v14 offset:31744
    v_mfma_f32_16x16x32_bf16 v[44:47], v[108:111], a[236:239], v[44:47]
    v_lshlrev_b32 v85, 16, v103
    v_mfma_f32_16x16x32_bf16 v[44:47], v[104:107], a[228:231], v[44:47]
    buffer_load_dwordx2 v[100:101], v18, s[44:47], s42 offen offset:0 sc1
    s_waitcnt lgkmcnt(2)
    v_mfma_f32_16x16x32_bf16 v[52:55], v[120:123], a[228:231], v[52:55]
    v_mfma_f32_16x16x32_bf16 v[52:55], v[124:127], a[236:239], v[52:55]
    v_lshlrev_b32 v86, 16, v103
    s_waitcnt lgkmcnt(0)
    v_mfma_f32_16x16x32_bf16 v[52:55], v[128:131], a[244:247], v[52:55]
    s_waitcnt vmcnt(13)
    s_barrier
    v_mfma_f32_16x16x32_bf16 v[52:55], v[132:135], a[252:255], v[52:55]
    ds_read_b128 v[104:107], v14 offset:32768
    v_lshlrev_b32 v87, 16, v103
    v_mfma_f32_16x16x32_bf16 v[48:51], v[132:135], a[248:251], v[48:51]
    ds_read_b128 v[108:111], v14 offset:36864
    v_add_u32 v10, 65536, v10
    v_mfma_f32_16x16x32_bf16 v[48:51], v[128:131], a[240:243], v[48:51]
    ds_read_b128 v[112:115], v14 offset:40960
    v_mfma_f32_16x16x32_bf16 v[48:51], v[124:127], a[232:235], v[48:51]
    ds_read_b128 v[116:119], v14 offset:45056
    v_add_u32 v11, 65536, v11
    v_mfma_f32_16x16x32_bf16 v[48:51], v[120:123], a[224:227], v[48:51]
    v_lshlrev_b32 v27, 16, v27
    s_branch L_Dc
L_idle:
    s_waitcnt vmcnt(0)
    s_barrier
    s_mov_b64 exec, 0
    s_call_b64 s[82:83], L_wc_D
    s_mov_b64 exec, -1
    s_mov_b32 s60, s36
    s_and_b32 s61, s37, 0xffff
    s_mov_b32 s62, 4096
    s_mov_b32 s63, 0x20000
    v_and_b32 v24, 15, v2
    s_lshl_b32 s7, s71, 6
    v_add_u32 v24, s7, v24
    s_and_b32 s8, s3, 1
    s_lshl_b32 s4, s8, 5
    v_add_u32 v25, s4, v24
    v_lshlrev_b32 v26, 3, v25
    v_mul_u32_u24 v25, 1152, v25
    v_bfe_u32 v31, v2, 4, 1
    v_lshl_add_u32 v25, v31, 5, v25
    v_lshrrev_b32 v31, 5, v2
    v_lshl_add_u32 v25, v31, 4, v25
    s_bfe_u32 s7, s2, 0x20003
    s_mul_i32 s7, s7, 288
    s_lshl_b32 s4, s72, 6
    s_add_u32 s4, s4, s7
    v_add_u32 v252, s4, v25
    s_xor_b32 s8, s3, s72
    s_and_b32 s4, s72, 1
    s_lshl1_add_u32 s4, s4, s8
    v_lshl_add_u32 v24, s4, 4, v24
    s_add_u32 s7, s7, 256
    s_cmp_lt_u32 s8, 2
    s_cselect_b32 s7, s7, 0x40000000
    v_lshlrev_b32 v18, 3, v24
    v_mul_u32_u24 v24, 1152, v24
    v_lshrrev_b32 v31, 4, v2
    v_lshl_add_u32 v24, v31, 3, v24
    v_add_u32 v253, s7, v24
    v_lshrrev_b32 v24, 3, v2
    v_and_b32 v25, 7, v2
    v_bfe_u32 v31, v2, 4, 2
    v_lshlrev_b32 v31, 1, v31
    v_xor_b32 v25, v25, v31
    v_lshlrev_b32 v24, 12, v24
    v_lshl_add_u32 v24, v25, 4, v24
    s_mul_i32 s7, s72, 36
    s_bitcmp1_b32 s3, 0
    s_addc_u32 s7, s7, 0
    s_lshl_b32 s7, s7, 17
    s_lshl_b32 s8, s71, 7
    s_add_u32 s7, s7, s8
    v_add_u32 v4, s7, v24
    v_add_u32 v5, 31744, v4
    v_add_u32 v6, 31744, v5
    v_add_u32 v7, 31744, v6
    v_lshrrev_b32 v24, 2, v2
    v_lshlrev_b32 v24, 7, v24
    v_and_b32 v25, 3, v2
    v_lshl_add_u32 v24, v25, 3, v24
    s_and_b32 s7, s73, 8192
    v_add_u32 v24, s7, v24
    v_bfe_u32 v31, v2, 3, 2
    s_and_b32 s7, s3, 1
    s_lshl_b32 s7, s7, 1
    v_xor_b32 v31, s7, v31
    v_lshl_add_u32 v10, v31, 5, v24
    v_xor_b32 v11, 32, v10
    v_and_b32 v24, 15, v2
    v_lshrrev_b32 v25, 4, v2
    v_mul_u32_u24 v25, 17408, v25
    v_lshl_add_u32 v24, v24, 4, v25
    s_mul_i32 s7, s72, 36
    s_and_b32 s8, s3, 1
    s_add_u32 s7, s7, s8
    s_mul_i32 s7, s7, 69632
    s_bfe_u32 s8, s2, 0x20003
    s_lshl_b32 s8, s8, 12
    s_add_u32 s7, s7, s8
    s_add_u32 s7, s7, 12795904
    v_add_u32 v23, s7, v24
    s_xor_b32 s7, s72, 0
    v_lshl_add_u32 v19, s7, 10, v23
    s_xor_b32 s7, s72, 1
    v_lshl_add_u32 v20, s7, 10, v23
    s_xor_b32 s7, s72, 2
    v_lshl_add_u32 v21, s7, 10, v23
    s_xor_b32 s7, s72, 3
    v_lshl_add_u32 v22, s7, 10, v23
    v_lshlrev_b32 v14, 4, v2
    v_add_u32 v14, 98304, v14
    v_add_u32 v1, 0x10000, v14
    s_bitcmp1_b32 s3, 1
    s_cselect_b32 s18, s85, s84
    s_mul_i32 s18, s18, 139264
    s_cselect_b32 s19, s87, s86
    s_mul_i32 s19, s19, 139264
    s_cselect_b32 s20, s89, s88
    s_mul_i32 s20, s20, 139264
    s_cselect_b32 s21, s91, s90
    s_mul_i32 s21, s21, 139264
    s_cselect_b32 s22, s93, s92
    s_mul_i32 s22, s22, 139264
    s_cselect_b32 s23, s95, s94
    s_mul_i32 s23, s23, 139264
    s_cselect_b32 s24, s97, s96
    s_mul_i32 s24, s24, 139264
    s_cselect_b32 s25, s99, s98
    s_mul_i32 s25, s25, 139264
    s_cselect_b32 s26, s101, s100
    s_mul_i32 s26, s26, 139264
    s_sub_u32 s4, s75, 252
    s_mul_i32 s4, s4, 1152
    s_mul_i32 s5, s3, 64
    s_add_u32 s4, s4, s5
    s_add_u32 s4, s4, 896
    s_lshl_b32 s4, s4, 12
    s_add_u32 s4, s4, 384
    v_lshlrev_b32 v24, 10, v2
    buffer_load_dword v255, v24, s[52:55], s4 offen
    s_add_u32 s4, s4, 65536
    buffer_load_dword v255, v24, s[52:55], s4 offen
    s_add_u32 s4, s4, 65536
    buffer_load_dword v255, v24, s[52:55], s4 offen
    s_add_u32 s4, s4, 65536
    buffer_load_dword v255, v24, s[52:55], s4 offen
    s_add_u32 s4, s4, 65536
    s_add_u32 m0, s73, 32768
    s_lshl_b32 s14, s84, 18
    buffer_load_dwordx4 v4, s[52:55], s14 offen offset:0 lds
    buffer_load_dwordx4 v5, s[52:55], s14 offen offset:1024 lds
    buffer_load_dwordx4 v6, s[52:55], s14 offen offset:2048 lds
    buffer_load_dwordx4 v7, s[52:55], s14 offen offset:3072 lds
    s_add_u32 m0, s73, 49152
    s_lshl_b32 s14, s85, 18
    buffer_load_dwordx4 v4, s[52:55], s14 offen offset:0 lds
    buffer_load_dwordx4 v5, s[52:55], s14 offen offset:1024 lds
    buffer_load_dwordx4 v6, s[52:55], s14 offen offset:2048 lds
    buffer_load_dwordx4 v7, s[52:55], s14 offen offset:3072 lds
    s_add_u32 m0, s73, 65536
    s_lshl_b32 s14, s86, 18
    buffer_load_dwordx4 v4, s[52:55], s14 offen offset:0 lds
    buffer_load_dwordx4 v5, s[52:55], s14 offen offset:1024 lds
    buffer_load_dwordx4 v6, s[52:55], s14 offen offset:2048 lds
    buffer_load_dwordx4 v7, s[52:55], s14 offen offset:3072 lds
    s_add_u32 m0, s73, 81920
    s_lshl_b32 s14, s87, 18
    buffer_load_dwordx4 v4, s[52:55], s14 offen offset:0 lds
    buffer_load_dwordx4 v5, s[52:55], s14 offen offset:1024 lds
    buffer_load_dwordx4 v6, s[52:55], s14 offen offset:2048 lds
    buffer_load_dwordx4 v7, s[52:55], s14 offen offset:3072 lds
    s_add_u32 m0, s73, 98304
    s_lshl_b32 s14, s88, 18
    buffer_load_dwordx4 v4, s[52:55], s14 offen offset:0 lds
    buffer_load_dwordx4 v5, s[52:55], s14 offen offset:1024 lds
    buffer_load_dwordx4 v6, s[52:55], s14 offen offset:2048 lds
    buffer_load_dwordx4 v7, s[52:55], s14 offen offset:3072 lds
    s_add_u32 m0, s73, 114688
    s_lshl_b32 s14, s89, 18
    buffer_load_dwordx4 v4, s[52:55], s14 offen offset:0 lds
    buffer_load_dwordx4 v5, s[52:55], s14 offen offset:1024 lds
    buffer_load_dwordx4 v6, s[52:55], s14 offen offset:2048 lds
    buffer_load_dwordx4 v7, s[52:55], s14 offen offset:3072 lds
    s_add_u32 m0, s73, 131072
    s_lshl_b32 s14, s90, 18
    buffer_load_dwordx4 v4, s[52:55], s14 offen offset:0 lds
    buffer_load_dwordx4 v5, s[52:55], s14 offen offset:1024 lds
    buffer_load_dwordx4 v6, s[52:55], s14 offen offset:2048 lds
    buffer_load_dwordx4 v7, s[52:55], s14 offen offset:3072 lds
    s_add_u32 m0, s73, 147456
    s_lshl_b32 s14, s91, 18
    buffer_load_dwordx4 v4, s[52:55], s14 offen offset:0 lds
    buffer_load_dwordx4 v5, s[52:55], s14 offen offset:1024 lds
    buffer_load_dwordx4 v6, s[52:55], s14 offen offset:2048 lds
    buffer_load_dwordx4 v7, s[52:55], s14 offen offset:3072 lds
    s_waitcnt vmcnt(28)
    s_barrier
    ds_read_b64_tr_b16 a[0:1], v10 offset:32768
    ds_read_b64_tr_b16 a[2:3], v10 offset:34816
    ds_read_b64_tr_b16 a[8:9], v10 offset:36864
    ds_read_b64_tr_b16 a[10:11], v10 offset:38912
    ds_read_b64_tr_b16 a[4:5], v11 offset:32768
    ds_read_b64_tr_b16 a[6:7], v11 offset:34816
    ds_read_b64_tr_b16 a[12:13], v11 offset:36864
    ds_read_b64_tr_b16 a[14:15], v11 offset:38912
    s_waitcnt vmcnt(24) lgkmcnt(0)
    s_barrier
    ds_read_b64_tr_b16 a[16:17], v10 offset:49152
    s_add_u32 m0, s73, 32768
    s_lshl_b32 s14, s92, 18
    ds_read_b64_tr_b16 a[18:19], v10 offset:51200
    buffer_load_dwordx4 v4, s[52:55], s14 offen offset:0 lds
    ds_read_b64_tr_b16 a[24:25], v10 offset:53248
    ds_read_b64_tr_b16 a[26:27], v10 offset:55296
    buffer_load_dwordx4 v5, s[52:55], s14 offen offset:1024 lds
    ds_read_b64_tr_b16 a[20:21], v11 offset:49152
    buffer_load_dwordx4 v6, s[52:55], s14 offen offset:2048 lds
    ds_read_b64_tr_b16 a[22:23], v11 offset:51200
    ds_read_b64_tr_b16 a[28:29], v11 offset:53248
    buffer_load_dwordx4 v7, s[52:55], s14 offen offset:3072 lds
    ds_read_b64_tr_b16 a[30:31], v11 offset:55296
    s_waitcnt vmcnt(24) lgkmcnt(0)
    s_barrier
    v_add_u32 v10, 65536, v10
    ds_read_b64_tr_b16 a[32:33], v10 offset:0
    s_add_u32 m0, s73, 49152
    s_lshl_b32 s14, s93, 18
    ds_read_b64_tr_b16 a[34:35], v10 offset:2048
    buffer_load_dwordx4 v4, s[52:55], s14 offen offset:0 lds
    ds_read_b64_tr_b16 a[40:41], v10 offset:4096
    ds_read_b64_tr_b16 a[42:43], v10 offset:6144
    buffer_load_dwordx4 v5, s[52:55], s14 offen offset:1024 lds
    v_add_u32 v11, 65536, v11
    ds_read_b64_tr_b16 a[36:37], v11 offset:0
    buffer_load_dwordx4 v6, s[52:55], s14 offen offset:2048 lds
    ds_read_b64_tr_b16 a[38:39], v11 offset:2048
    ds_read_b64_tr_b16 a[44:45], v11 offset:4096
    buffer_load_dwordx4 v7, s[52:55], s14 offen offset:3072 lds
    ds_read_b64_tr_b16 a[46:47], v11 offset:6144
    s_waitcnt vmcnt(24) lgkmcnt(0)
    s_barrier
    ds_read_b64_tr_b16 a[48:49], v10 offset:16384
    s_add_u32 m0, s73, 65536
    s_lshl_b32 s14, s94, 18
    ds_read_b64_tr_b16 a[50:51], v10 offset:18432
    buffer_load_dwordx4 v4, s[52:55], s14 offen offset:0 lds
    ds_read_b64_tr_b16 a[56:57], v10 offset:20480
    ds_read_b64_tr_b16 a[58:59], v10 offset:22528
    buffer_load_dwordx4 v5, s[52:55], s14 offen offset:1024 lds
    ds_read_b64_tr_b16 a[52:53], v11 offset:16384
    buffer_load_dwordx4 v6, s[52:55], s14 offen offset:2048 lds
    ds_read_b64_tr_b16 a[54:55], v11 offset:18432
    ds_read_b64_tr_b16 a[60:61], v11 offset:20480
    buffer_load_dwordx4 v7, s[52:55], s14 offen offset:3072 lds
    ds_read_b64_tr_b16 a[62:63], v11 offset:22528
    s_waitcnt vmcnt(24) lgkmcnt(0)
    s_barrier
    ds_read_b64_tr_b16 a[64:65], v10 offset:32768
    s_add_u32 m0, s73, 81920
    s_lshl_b32 s14, s95, 18
    ds_read_b64_tr_b16 a[66:67], v10 offset:34816
    buffer_load_dwordx4 v4, s[52:55], s14 offen offset:0 lds
    ds_read_b64_tr_b16 a[72:73], v10 offset:36864
    ds_read_b64_tr_b16 a[74:75], v10 offset:38912
    buffer_load_dwordx4 v5, s[52:55], s14 offen offset:1024 lds
    ds_read_b64_tr_b16 a[68:69], v11 offset:32768
    buffer_load_dwordx4 v6, s[52:55], s14 offen offset:2048 lds
    ds_read_b64_tr_b16 a[70:71], v11 offset:34816
    ds_read_b64_tr_b16 a[76:77], v11 offset:36864
    buffer_load_dwordx4 v7, s[52:55], s14 offen offset:3072 lds
    ds_read_b64_tr_b16 a[78:79], v11 offset:38912
    s_waitcnt vmcnt(24) lgkmcnt(0)
    s_barrier
    ds_read_b64_tr_b16 a[80:81], v10 offset:49152
    s_add_u32 m0, s73, 98304
    s_lshl_b32 s14, s96, 18
    ds_read_b64_tr_b16 a[82:83], v10 offset:51200
    buffer_load_dwordx4 v4, s[52:55], s14 offen offset:0 lds
    ds_read_b64_tr_b16 a[88:89], v10 offset:53248
    ds_read_b64_tr_b16 a[90:91], v10 offset:55296
    buffer_load_dwordx4 v5, s[52:55], s14 offen offset:1024 lds
    ds_read_b64_tr_b16 a[84:85], v11 offset:49152
    buffer_load_dwordx4 v6, s[52:55], s14 offen offset:2048 lds
    ds_read_b64_tr_b16 a[86:87], v11 offset:51200
    ds_read_b64_tr_b16 a[92:93], v11 offset:53248
    buffer_load_dwordx4 v7, s[52:55], s14 offen offset:3072 lds
    ds_read_b64_tr_b16 a[94:95], v11 offset:55296
    s_waitcnt vmcnt(24) lgkmcnt(0)
    s_barrier
    v_add_u32 v10, 65536, v10
    ds_read_b64_tr_b16 a[96:97], v10 offset:0
    s_add_u32 m0, s73, 114688
    s_lshl_b32 s14, s97, 18
    ds_read_b64_tr_b16 a[98:99], v10 offset:2048
    buffer_load_dwordx4 v4, s[52:55], s14 offen offset:0 lds
    ds_read_b64_tr_b16 a[104:105], v10 offset:4096
    ds_read_b64_tr_b16 a[106:107], v10 offset:6144
    buffer_load_dwordx4 v5, s[52:55], s14 offen offset:1024 lds
    v_add_u32 v11, 65536, v11
    ds_read_b64_tr_b16 a[100:101], v11 offset:0
    buffer_load_dwordx4 v6, s[52:55], s14 offen offset:2048 lds
    ds_read_b64_tr_b16 a[102:103], v11 offset:2048
    ds_read_b64_tr_b16 a[108:109], v11 offset:4096
    buffer_load_dwordx4 v7, s[52:55], s14 offen offset:3072 lds
    ds_read_b64_tr_b16 a[110:111], v11 offset:6144
    s_waitcnt vmcnt(24) lgkmcnt(0)
    s_barrier
    ds_read_b64_tr_b16 a[112:113], v10 offset:16384
    s_add_u32 m0, s73, 131072
    s_lshl_b32 s14, s98, 18
    ds_read_b64_tr_b16 a[114:115], v10 offset:18432
    buffer_load_dwordx4 v4, s[52:55], s14 offen offset:0 lds
    ds_read_b64_tr_b16 a[120:121], v10 offset:20480
    ds_read_b64_tr_b16 a[122:123], v10 offset:22528
    buffer_load_dwordx4 v5, s[52:55], s14 offen offset:1024 lds
    ds_read_b64_tr_b16 a[116:117], v11 offset:16384
    buffer_load_dwordx4 v6, s[52:55], s14 offen offset:2048 lds
    ds_read_b64_tr_b16 a[118:119], v11 offset:18432
    ds_read_b64_tr_b16 a[124:125], v11 offset:20480
    buffer_load_dwordx4 v7, s[52:55], s14 offen offset:3072 lds
    ds_read_b64_tr_b16 a[126:127], v11 offset:22528
    s_waitcnt vmcnt(24) lgkmcnt(0)
    s_barrier
    v_add_u32 v10, -131072, v10
    ds_read_b64_tr_b16 a[128:129], v10 offset:32768
    s_add_u32 m0, s73, 147456
    s_lshl_b32 s14, s99, 18
    ds_read_b64_tr_b16 a[130:131], v10 offset:34816
    buffer_load_dwordx4 v4, s[52:55], s14 offen offset:0 lds
    ds_read_b64_tr_b16 a[136:137], v10 offset:36864
    ds_read_b64_tr_b16 a[138:139], v10 offset:38912
    buffer_load_dwordx4 v5, s[52:55], s14 offen offset:1024 lds
    v_add_u32 v11, -131072, v11
    ds_read_b64_tr_b16 a[132:133], v11 offset:32768
    buffer_load_dwordx4 v6, s[52:55], s14 offen offset:2048 lds
    ds_read_b64_tr_b16 a[134:135], v11 offset:34816
    ds_read_b64_tr_b16 a[140:141], v11 offset:36864
    buffer_load_dwordx4 v7, s[52:55], s14 offen offset:3072 lds
    ds_read_b64_tr_b16 a[142:143], v11 offset:38912
    s_waitcnt vmcnt(24) lgkmcnt(0)
    s_barrier
    ds_read_b64_tr_b16 a[144:145], v10 offset:49152
    s_add_u32 m0, s73, 0
    s_lshl_b32 s14, s100, 18
    ds_read_b64_tr_b16 a[146:147], v10 offset:51200
    buffer_load_dwordx4 v4, s[52:55], s14 offen offset:0 lds
    ds_read_b64_tr_b16 a[152:153], v10 offset:53248
    ds_read_b64_tr_b16 a[154:155], v10 offset:55296
    buffer_load_dwordx4 v5, s[52:55], s14 offen offset:1024 lds
    ds_read_b64_tr_b16 a[148:149], v11 offset:49152
    buffer_load_dwordx4 v6, s[52:55], s14 offen offset:2048 lds
    ds_read_b64_tr_b16 a[150:151], v11 offset:51200
    ds_read_b64_tr_b16 a[156:157], v11 offset:53248
    buffer_load_dwordx4 v7, s[52:55], s14 offen offset:3072 lds
    ds_read_b64_tr_b16 a[158:159], v11 offset:55296
    s_waitcnt vmcnt(24) lgkmcnt(0)
    s_barrier
    v_add_u32 v10, 65536, v10
    ds_read_b64_tr_b16 a[160:161], v10 offset:0
    s_add_u32 m0, s73, 16384
    s_lshl_b32 s14, s101, 18
    ds_read_b64_tr_b16 a[162:163], v10 offset:2048
    buffer_load_dwordx4 v4, s[52:55], s14 offen offset:0 lds
    ds_read_b64_tr_b16 a[168:169], v10 offset:4096
    ds_read_b64_tr_b16 a[170:171], v10 offset:6144
    buffer_load_dwordx4 v5, s[52:55], s14 offen offset:1024 lds
    v_add_u32 v11, 65536, v11
    ds_read_b64_tr_b16 a[164:165], v11 offset:0
    buffer_load_dwordx4 v6, s[52:55], s14 offen offset:2048 lds
    ds_read_b64_tr_b16 a[166:167], v11 offset:2048
    ds_read_b64_tr_b16 a[172:173], v11 offset:4096
    buffer_load_dwordx4 v7, s[52:55], s14 offen offset:3072 lds
    ds_read_b64_tr_b16 a[174:175], v11 offset:6144
    s_waitcnt vmcnt(24) lgkmcnt(0)
    s_barrier
    ds_read_b64_tr_b16 a[176:177], v10 offset:16384
    ds_read_b64_tr_b16 a[178:179], v10 offset:18432
    ds_read_b64_tr_b16 a[184:185], v10 offset:20480
    ds_read_b64_tr_b16 a[186:187], v10 offset:22528
    ds_read_b64_tr_b16 a[180:181], v11 offset:16384
    ds_read_b64_tr_b16 a[182:183], v11 offset:18432
    ds_read_b64_tr_b16 a[188:189], v11 offset:20480
    ds_read_b64_tr_b16 a[190:191], v11 offset:22528
    s_waitcnt vmcnt(20) lgkmcnt(0)
    s_barrier
    ds_read_b64_tr_b16 a[192:193], v10 offset:32768
    ds_read_b64_tr_b16 a[194:195], v10 offset:34816
    ds_read_b64_tr_b16 a[200:201], v10 offset:36864
    ds_read_b64_tr_b16 a[202:203], v10 offset:38912
    ds_read_b64_tr_b16 a[196:197], v11 offset:32768
    ds_read_b64_tr_b16 a[198:199], v11 offset:34816
    ds_read_b64_tr_b16 a[204:205], v11 offset:36864
    ds_read_b64_tr_b16 a[206:207], v11 offset:38912
    s_waitcnt vmcnt(16) lgkmcnt(0)
    s_barrier
    ds_read_b64_tr_b16 a[208:209], v10 offset:49152
    ds_read_b64_tr_b16 a[210:211], v10 offset:51200
    ds_read_b64_tr_b16 a[216:217], v10 offset:53248
    ds_read_b64_tr_b16 a[218:219], v10 offset:55296
    ds_read_b64_tr_b16 a[212:213], v11 offset:49152
    ds_read_b64_tr_b16 a[214:215], v11 offset:51200
    ds_read_b64_tr_b16 a[220:221], v11 offset:53248
    ds_read_b64_tr_b16 a[222:223], v11 offset:55296
    s_waitcnt vmcnt(12) lgkmcnt(0)
    s_barrier
    v_add_u32 v10, 65536, v10
    ds_read_b64_tr_b16 a[224:225], v10 offset:0
    ds_read_b64_tr_b16 a[226:227], v10 offset:2048
    ds_read_b64_tr_b16 a[232:233], v10 offset:4096
    ds_read_b64_tr_b16 a[234:235], v10 offset:6144
    v_add_u32 v11, 65536, v11
    ds_read_b64_tr_b16 a[228:229], v11 offset:0
    ds_read_b64_tr_b16 a[230:231], v11 offset:2048
    ds_read_b64_tr_b16 a[236:237], v11 offset:4096
    ds_read_b64_tr_b16 a[238:239], v11 offset:6144
    s_waitcnt vmcnt(8) lgkmcnt(0)
    s_barrier
    ds_read_b64_tr_b16 a[240:241], v10 offset:16384
    ds_read_b64_tr_b16 a[242:243], v10 offset:18432
    ds_read_b64_tr_b16 a[248:249], v10 offset:20480
    ds_read_b64_tr_b16 a[250:251], v10 offset:22528
    ds_read_b64_tr_b16 a[244:245], v11 offset:16384
    ds_read_b64_tr_b16 a[246:247], v11 offset:18432
    ds_read_b64_tr_b16 a[252:253], v11 offset:20480
    ds_read_b64_tr_b16 a[254:255], v11 offset:22528
    s_waitcnt lgkmcnt(0)
    s_barrier
    v_add_u32 v10, -131072, v10
    v_add_u32 v11, -131072, v11
    s_mov_b64 exec, 0
    s_call_b64 s[82:83], L_wc_D
    s_mov_b64 exec, -1
    s_bfe_u32 s4, s2, 0x20003
    s_lshl2_add_u32 s4, s72, s4
    s_lshl_b32 s4, s4, 3
    s_lshr_b32 s5, s2, 4
    s_and_b32 s5, s5, 6
    s_add_u32 s4, s4, s5
    s_and_b32 s5, s2, 1
    s_add_u32 s4, s4, s5
    s_lshl_b32 s4, s4, 7
    s_add_u32 s4, s4, 12566528
    v_lshl_add_u32 v28, v2, 2, s4
    s_cmp_eq_u32 s3, 0
    s_cselect_b32 s4, 18, 0
    v_cmp_gt_u32 vcc, s4, v2
    v_mov_b32 v13, 0x40000000
    s_nop 0
    v_cndmask_b32 v28, v13, v28, vcc
    v_mov_b32 v13, s68
    v_cndmask_b32 v13, 0, v13, vcc
    s_mov_b32 s5, 0
L_iw:
    s_sleep 16
    v_mov_b32 v29, 0
    buffer_atomic_add v29, v28, s[44:47], 0 offen sc0 sc1
    s_waitcnt vmcnt(0)
    v_cmp_eq_u32 vcc, 0, v13
    s_nop 1
    s_mov_b64 s[6:7], vcc
    v_cmp_ne_u32 vcc, v13, v29
    s_nop 1
    s_andn2_b64 s[8:9], exec, vcc
    s_andn2_b64 s[8:9], s[8:9], s[6:7]
    s_cbranch_scc1 L_ix
    s_cmp_eq_u64 s[6:7], exec
    s_cbranch_scc1 L_ix
    s_add_u32 s5, s5, 1
    s_cmp_lt_u32 s5, 100000
    s_cbranch_scc1 L_iw
L_ix:
    v_mov_b32 v29, 0
    buffer_atomic_add v29, v28, s[44:47], 0 offen sc0 sc1
    s_branch L_DX
L_end:
.section .rodata,"a"
.p2align 6
.amdhsa_kernel recurrent_scan__ssm_conv_h3__mixer_token_mlp__prompt_kernel
  .amdhsa_next_free_vgpr 512
  .amdhsa_next_free_sgpr 102
  .amdhsa_accum_offset 256
  .amdhsa_group_segment_fixed_size 0
  .amdhsa_kernarg_size 112
  .amdhsa_user_sgpr_count 2
  .amdhsa_user_sgpr_kernarg_segment_ptr 1
  .amdhsa_system_sgpr_workgroup_id_x 1
  .amdhsa_float_denorm_mode_32 3
.end_amdhsa_kernel
```

```asm
; @launch grid=(256,1,1) block=(256,1,1) lds=163840
.amdgcn_target "amdgcn-amd-amdhsa--gfx950"
.text
.globl recurrent_scan__ssm_conv_h3__mixer_token_mlp__prompt_kernel
.p2align 8
.type recurrent_scan__ssm_conv_h3__mixer_token_mlp__prompt_kernel,@function
recurrent_scan__ssm_conv_h3__mixer_token_mlp__prompt_kernel:
    s_cmp_lt_u32 s2, 256
    s_cbranch_scc0 L_exit
    s_load_dwordx2 s[56:57], s[0:1], 0
    s_load_dwordx2 s[48:49], s[0:1], 8
    s_load_dwordx2 s[52:53], s[0:1], 16
    s_load_dwordx2 s[60:61], s[0:1], 24
    s_load_dwordx16 s[16:31], s[0:1], 0
    s_load_dwordx8 s[32:39], s[0:1], 64
    s_load_dwordx4 s[40:43], s[0:1], 96
    s_memrealtime s[12:13]
    v_lshrrev_b32 v1, 6, v0
    v_and_b32 v2, 63, v0
    s_getpc_b64 s[6:7]
L_pc:
    s_lshr_b32 s4, s2, 1
    s_and_b32 s4, s4, 124
    v_add_u32 v22, s4, v1
    v_lshl_add_u32 v22, v2, 7, v22
    v_lshlrev_b32 v22, 7, v22
    v_min_u32 v22, L_end-L_pc-4, v22
    s_mov_b64 exec, 31
    global_load_dword v255, v22, s[6:7]
    s_mov_b64 exec, -1
    v_readfirstlane_b32 s3, v1
    s_and_b32 s4, s2, 7
    s_lshr_b32 s5, s2, 3
    s_lshl_b32 s4, s4, 5
    s_add_u32 s68, s4, s5
    v_lshrrev_b32 v3, 5, v0
    v_and_b32 v4, 31, v0
    v_mul_u32_u24 v5, 1152, v3
    v_mad_u32_u24 v5, v4, 12, v5
    s_mul_i32 s15, s68, 9216
    s_mul_i32 s4, s3, 3072
    s_add_u32 s5, s4, s15
    s_sub_u32 s5, s5, 3456
    v_lshlrev_b32 v6, 4, v2
    v_add_u32 v7, s5, v6
    v_add_u32 v58, 1024, v7
    s_add_u32 s4, s4, 114688
    s_lshl_b32 s5, s3, 11
    s_add_u32 s11, s5, s15
    s_add_u32 s5, s5, 127360
    s_cmp_lt_u32 s2, 216
    s_cselect_b32 s9, 0, 106496
    s_sub_u32 s4, s4, s9
    s_sub_u32 s5, s5, s9
    s_mov_b32 m0, s4
    s_mov_b32 s58, 2359296
    s_mov_b32 s59, 0x20000
    s_mov_b32 s50, 2359296
    s_mov_b32 s51, 0x20000
    s_mov_b32 s54, 2359296
    s_mov_b32 s55, 0x20000
    s_mov_b32 s62, 4608
    s_mov_b32 s63, 0x20000
    v_lshlrev_b32 v59, 3, v0
    s_movk_i32 s10, 4096
    v_lshlrev_b32 v91, 3, v2
    v_or_b32 v22, s2, v0
    v_lshlrev_b32 v22, 8, v22
    s_mov_b32 s66, 256
    s_mov_b32 s67, 0x20000
    s_waitcnt lgkmcnt(0)
    buffer_load_dwordx3 v[8:10], v5, s[56:59], s15 offen offset:0
    buffer_load_dwordx3 v[12:14], v5, s[56:59], s15 offen offset:384
    buffer_load_dwordx3 v[16:18], v5, s[56:59], s15 offen offset:768
    s_mov_b32 s64, s40
    s_and_b32 s65, s41, 0xffff
    s_or_b32 s12, s12, 1
    v_mov_b32 v23, s12
    buffer_store_dword v23, v22, s[64:67], 0 offen sc1
    buffer_load_dwordx4 v7, s[48:51], 0 offen lds
    s_add_u32 m0, s4, 1024
    s_cmp_eq_u32 s3, 3
    buffer_load_dwordx4 v58, s[48:51], 0 offen lds
    buffer_load_dwordx4 v58, s[48:51], 0 offen offset:1024 lds
    s_cbranch_scc1 L_xld
L_nox:
    s_mov_b32 m0, s5
    buffer_load_dwordx2 v[98:99], v59, s[60:63], 0 offen
    buffer_load_dwordx4 v6, s[52:55], s11 offen lds
    buffer_load_dwordx4 v6, s[52:55], s11 offen offset:1024 lds
    buffer_load_dwordx2 v[100:101], v59, s[60:63], 0 offen offset:2048
    buffer_load_dwordx2 v[102:103], v59, s[60:63], s10 offen
    s_mov_b32 s44, s42
    s_and_b32 s45, s43, 0xffff
    s_mov_b32 s46, 42352640
    s_mov_b32 s47, 0x20000
    s_and_b32 s5, s2, 7
    s_lshr_b32 s6, s2, 3
    s_lshr_b32 s7, s6, 2
    s_lshr_b32 s8, s3, 1
    s_lshl1_add_u32 s9, s7, s8
    s_cmp_ge_u32 s9, 10
    s_addc_u32 s14, s9, 0
    s_cmp_ge_u32 s9, 3
    s_addc_u32 s14, s14, 0
    s_lshl3_add_u32 s8, s8, 3
    s_cmp_eq_u32 s7, 7
    s_cselect_b32 s14, s8, s14
    s_and_b32 s4, s5, 1
    s_lshl4_add_u32 s71, s4, s14
    s_lshr_b32 s13, s5, 1
    s_mov_b32 s72, s13
    s_lshl_b32 s73, s3, 12
    s_mov_b32 s52, s34
    s_and_b32 s53, s35, 0xffff
    s_mov_b32 s54, 18874368
    s_mov_b32 s55, 0x20000
    s_cmp_lt_u32 s6, 27
    s_cbranch_scc0 L_aux
    s_branch L_org
L_exit:
    s_endpgm
L_xld:
    s_mov_b64 exec, 0xffffff
    buffer_load_dwordx4 v58, s[48:51], 0 offen offset:2048 lds
    s_mov_b64 exec, -1
    s_mov_b32 m0, s5
    s_nop 0
    buffer_load_dwordx4 v6, s[52:55], s11 offen offset:2048 lds
    s_branch L_nox
L_nw_G:
    s_mov_b32 s5, 0
L_nl_G:
    buffer_load_dword v45, v54, s[64:67], 0 offen sc1
    s_waitcnt vmcnt(0)
    v_readfirstlane_b32 s68, v45
    s_nop 1
    s_cmp_lg_u32 s68, 0
    s_cbranch_scc1 L_ng_G
    s_add_u32 s5, s5, 1
    s_cmp_lt_u32 s5, 100000
    s_cbranch_scc1 L_nl_G
    s_branch L_ng_G
L_rs_p1G:
    s_mov_b32 s5, 0
L_rt_p1G:
    s_mov_b64 exec, vcc
    v_mov_b32 v29, 0
    buffer_atomic_add v29, v28, s[44:47], 0 offen sc0 sc1
    s_waitcnt vmcnt(0)
    v_cmp_ne_u32 vcc, v12, v29
    s_cbranch_vccz L_rx_p1G
    s_add_u32 s5, s5, 1
    s_cmp_lt_u32 s5, 100000
    s_cbranch_scc1 L_rt_p1G
L_rx_p1G:
    s_mov_b64 exec, -1
    s_branch L_ok_p1G
L_rs_p5:
    s_mov_b32 s5, 0
L_rt_p5:
    s_mov_b64 exec, vcc
    buffer_load_dword v29, v28, s[44:47], 0 offen sc1
    s_waitcnt vmcnt(0)
    v_cmp_ne_u32 vcc, s68, v29
    s_cbranch_vccz L_rx_p5
    s_add_u32 s5, s5, 1
    s_cmp_lt_u32 s5, 100000
    s_cbranch_scc1 L_rt_p5
L_rx_p5:
    s_mov_b64 exec, -1
    s_branch L_ok_p5
L_nw_X:
    s_mov_b32 s5, 0
L_nl_X:
    buffer_load_dword v45, v54, s[64:67], 0 offen sc1
    s_waitcnt vmcnt(0)
    v_readfirstlane_b32 s68, v45
    s_nop 1
    s_cmp_lg_u32 s68, 0
    s_cbranch_scc1 L_ng_X
    s_add_u32 s5, s5, 1
    s_cmp_lt_u32 s5, 100000
    s_cbranch_scc1 L_nl_X
    s_branch L_ng_X
L_rs_p1X:
    s_mov_b32 s5, 0
L_rt_p1X:
    s_mov_b64 exec, vcc
    v_mov_b32 v29, 0
    buffer_atomic_add v29, v28, s[44:47], 0 offen sc0 sc1
    s_waitcnt vmcnt(0)
    v_cmp_ne_u32 vcc, s68, v29
    s_cbranch_vccz L_rx_p1X
    s_add_u32 s5, s5, 1
    s_cmp_lt_u32 s5, 100000
    s_cbranch_scc1 L_rt_p1X
L_rx_p1X:
    s_mov_b64 exec, -1
    s_branch L_ok_p1X
L_rs_p2G:
    s_mov_b32 s5, 0
L_rt_p2G:
    s_mov_b64 exec, vcc
    v_mov_b32 v16, 0
    buffer_atomic_add v16, v15, s[44:47], 0 offen sc0 sc1
    s_waitcnt vmcnt(0)
    v_cmp_ne_u32 vcc, v13, v16
    s_cbranch_vccz L_rx_p2G
    s_add_u32 s5, s5, 1
    s_cmp_lt_u32 s5, 100000
    s_cbranch_scc1 L_rt_p2G
L_rx_p2G:
    s_mov_b64 exec, -1
    s_branch L_ok_p2G
L_xs_a:
    s_mov_b32 s5, 0
L_xt_a:
    v_mov_b32 v187, 0
    buffer_atomic_add v187, v137, s[44:47], 0 offen offset:12 sc0 sc1
    s_waitcnt vmcnt(0)
    v_cmp_ne_u32 vcc, v138, v187
    s_cbranch_vccz L_xr_a
    s_add_u32 s5, s5, 1
    s_cmp_lt_u32 s5, 100000
    s_cbranch_scc1 L_xt_a
L_xr_a:
    buffer_load_dwordx4 v[40:43], v136, s[44:47], s34 offen offset:0 sc1
    buffer_load_dwordx4 v[44:47], v136, s[44:47], s34 offen offset:1024 sc1
    buffer_load_dwordx4 v[48:51], v136, s[44:47], s34 offen offset:2048 sc1
    s_waitcnt vmcnt(0)
    v_bitop3_b32 v43, v43, v47, s68 bitop3:0x7e
    v_bitop3_b32 v43, v43, v51, s68 bitop3:0xf6
    v_cmp_ne_u32 vcc, 0, v43
    s_cbranch_vccz L_xo_a
    s_add_u32 s5, s5, 1
    s_cmp_lt_u32 s5, 100000
    s_cbranch_scc1 L_xt_a
    s_branch L_xo_a
L_as_b:
    s_mov_b32 s5, 0
L_at_b:
    v_mov_b32 v141, 0
    buffer_atomic_add v141, v139, s[44:47], s11 offen offset:2060 sc0 sc1
    s_waitcnt vmcnt(0)
    v_cmp_ne_u32 vcc, v140, v141
    s_cbranch_vccz L_ao_b
    s_add_u32 s5, s5, 1
    s_cmp_lt_u32 s5, 100000
    s_cbranch_scc1 L_at_b
    s_branch L_ao_b
L_xs_b:
    s_mov_b32 s5, 0
L_xt_b:
    buffer_load_dwordx4 v[56:59], v136, s[44:47], s11 offen offset:0 sc1
    buffer_load_dwordx4 v[60:63], v136, s[44:47], s11 offen offset:1024 sc1
    buffer_load_dwordx4 v[64:67], v136, s[44:47], s11 offen offset:2048 sc1
    s_waitcnt vmcnt(0)
    v_bitop3_b32 v59, v59, v63, s68 bitop3:0x7e
    v_bitop3_b32 v59, v59, v67, s68 bitop3:0xf6
    v_cmp_ne_u32 vcc, 0, v59
    s_cbranch_vccz L_xo_b
    s_add_u32 s5, s5, 1
    s_cmp_lt_u32 s5, 100000
    s_cbranch_scc1 L_xt_b
    s_branch L_xo_b
L_xs_z:
    s_mov_b32 s5, 0
L_xt_z:
    buffer_load_dwordx4 v[72:75], v136, s[44:47], s12 offen offset:0 sc1
    buffer_load_dwordx4 v[76:79], v136, s[44:47], s12 offen offset:1024 sc1
    buffer_load_dwordx4 v[80:83], v136, s[44:47], s12 offen offset:2048 sc1
    s_waitcnt vmcnt(0)
    v_bitop3_b32 v75, v75, v79, s68 bitop3:0x7e
    v_bitop3_b32 v75, v75, v83, s68 bitop3:0xf6
    v_cmp_ne_u32 vcc, 0, v75
    s_cbranch_vccz L_xo_z
    s_add_u32 s5, s5, 1
    s_cmp_lt_u32 s5, 100000
    s_cbranch_scc1 L_xt_z
    s_branch L_xo_z
L_rs_p3:
    s_mov_b32 s5, 0
L_rt_p3:
    s_mov_b64 exec, vcc
    buffer_load_dword v189, v188, s[44:47], 0 offen sc1
    s_waitcnt vmcnt(0)
    v_cmp_ne_u32 vcc, s68, v189
    s_cbranch_vccz L_rx_p3
    s_add_u32 s5, s5, 1
    s_cmp_lt_u32 s5, 100000
    s_cbranch_scc1 L_rt_p3
L_rx_p3:
    s_mov_b64 exec, -1
    s_branch L_ok_p3
L_xs_8:
    s_mov_b32 s5, 0
L_xt_8:
    v_mov_b32 v187, 0
    buffer_atomic_add v187, v137, s[44:47], 0 offen offset:12 sc0 sc1
    s_waitcnt vmcnt(0)
    v_cmp_ne_u32 vcc, v138, v187
    s_cbranch_vccz L_xr_8
    s_add_u32 s5, s5, 1
    s_cmp_lt_u32 s5, 100000
    s_cbranch_scc1 L_xt_8
L_xr_8:
    buffer_load_dwordx4 v[204:207], v136, s[44:47], s35 offen offset:0 sc1
    buffer_load_dwordx4 v[208:211], v136, s[44:47], s35 offen offset:1024 sc1
    buffer_load_dwordx4 v[212:215], v136, s[44:47], s35 offen offset:2048 sc1
    buffer_load_dwordx4 v[216:219], v136, s[44:47], s35 offen offset:3072 sc1
    s_waitcnt vmcnt(0)
    v_bitop3_b32 v207, v207, v211, s36 bitop3:0x7e
    v_bitop3_b32 v207, v207, v215, s36 bitop3:0xf6
    v_bitop3_b32 v207, v207, v219, s36 bitop3:0xf6
    v_cmp_ne_u32 vcc, 0, v207
    s_cbranch_vccz L_xo_8
    s_add_u32 s5, s5, 1
    s_cmp_lt_u32 s5, 100000
    s_cbranch_scc1 L_xt_8
    s_branch L_xo_8
L_rs_p2X:
    s_mov_b32 s5, 0
L_rt_p2X:
    s_mov_b64 exec, vcc
    v_mov_b32 v29, 0
    buffer_atomic_add v29, v28, s[44:47], 0 offen sc0 sc1
    s_waitcnt vmcnt(0)
    v_cmp_ne_u32 vcc, v13, v29
    s_cbranch_vccz L_rx_p2X
    s_add_u32 s5, s5, 1
    s_cmp_lt_u32 s5, 100000
    s_cbranch_scc1 L_rt_p2X
L_rx_p2X:
    s_mov_b64 exec, -1
    s_branch L_ok_p2X
L_wc_G:
    s_cmp_eq_u32 s3, 0
    s_cbranch_scc1 L_pl_G_0
    s_cmp_eq_u32 s3, 1
    s_cbranch_scc1 L_pl_G_1
    s_cmp_eq_u32 s3, 2
    s_cbranch_scc1 L_pl_G_2
    s_branch L_pl_G_3
L_wc_X:
    s_cmp_eq_u32 s3, 0
    s_cbranch_scc1 L_pl_X_0
    s_cmp_eq_u32 s3, 1
    s_cbranch_scc1 L_pl_X_1
    s_cmp_eq_u32 s3, 2
    s_cbranch_scc1 L_pl_X_2
    s_branch L_pl_X_3
L_wc_D:
    s_cmp_eq_u32 s3, 0
    s_cbranch_scc1 L_pl_D_0
    s_cmp_eq_u32 s3, 1
    s_cbranch_scc1 L_pl_D_1
    s_cmp_eq_u32 s3, 2
    s_cbranch_scc1 L_pl_D_2
    s_branch L_wret
L_wret:
    s_setpc_b64 s[82:83]
.p2align 12
L_org:
    s_mul_i32 s7, s6, 21846
    s_lshr_b32 s7, s7, 16
    s_mul_i32 s8, s7, 3
    s_sub_u32 s12, s6, s8
    s_mul_i32 s8, s13, 9
    s_add_u32 s69, s8, s7
    s_lshl1_add_u32 s70, s12, s4
    s_mul_i32 s8, s69, 6
    s_add_u32 s75, s8, s70
    s_mov_b32 s48, s30
    s_and_b32 s49, s31, 0xffff
    s_mov_b32 s50, 18874368
    s_mov_b32 s51, 0x20000
    s_add_u32 s12, s12, s7
    s_mul_i32 s8, s12, 21846
    s_lshr_b32 s8, s8, 16
    s_mul_i32 s8, s8, 3
    s_sub_u32 s12, s12, s8
    s_mul_i32 s4, s4, 16
    s_mul_i32 s7, s12, 65538
    s_lshr_b32 s7, s7, 16
    s_mul_i32 s7, s7, 1
    s_add_u32 s5, s4, 0
    s_add_u32 s18, s7, s5
    s_add_u32 s8, s5, 3
    s_add_u32 s19, s18, 1
    s_cmp_eq_u32 s19, s8
    s_cselect_b32 s19, s5, s19
    s_add_u32 s20, s19, 1
    s_cmp_eq_u32 s20, s8
    s_cselect_b32 s20, s5, s20
    s_mul_i32 s7, s12, 65538
    s_lshr_b32 s7, s7, 16
    s_mul_i32 s7, s7, 1
    s_add_u32 s5, s4, 3
    s_add_u32 s21, s7, s5
    s_add_u32 s8, s5, 3
    s_add_u32 s22, s21, 1
    s_cmp_eq_u32 s22, s8
    s_cselect_b32 s22, s5, s22
    s_add_u32 s23, s22, 1
    s_cmp_eq_u32 s23, s8
    s_cselect_b32 s23, s5, s23
    s_mul_i32 s7, s12, 87384
    s_lshr_b32 s7, s7, 16
    s_mul_i32 s7, s7, 1
    s_add_u32 s5, s4, 6
    s_add_u32 s24, s7, s5
    s_add_u32 s8, s5, 4
    s_add_u32 s25, s24, 1
    s_cmp_eq_u32 s25, s8
    s_cselect_b32 s25, s5, s25
    s_add_u32 s26, s25, 1
    s_cmp_eq_u32 s26, s8
    s_cselect_b32 s26, s5, s26
    s_add_u32 s27, s26, 1
    s_cmp_eq_u32 s27, s8
    s_cselect_b32 s27, s5, s27
    s_mul_i32 s7, s12, 131076
    s_lshr_b32 s7, s7, 16
    s_mul_i32 s7, s7, 1
    s_add_u32 s5, s4, 10
    s_add_u32 s76, s7, s5
    s_add_u32 s8, s5, 6
    s_add_u32 s77, s76, 1
    s_cmp_eq_u32 s77, s8
    s_cselect_b32 s77, s5, s77
    s_add_u32 s78, s77, 1
    s_cmp_eq_u32 s78, s8
    s_cselect_b32 s78, s5, s78
    s_add_u32 s79, s78, 1
    s_cmp_eq_u32 s79, s8
    s_cselect_b32 s79, s5, s79
    s_add_u32 s80, s79, 1
    s_cmp_eq_u32 s80, s8
    s_cselect_b32 s80, s5, s80
    s_add_u32 s81, s80, 1
    s_cmp_eq_u32 s81, s8
    s_cselect_b32 s81, s5, s81
    v_lshrrev_b32 v24, 4, v2
    v_and_b32 v25, 15, v2
    v_lshlrev_b32 v26, 1, v24
    v_xor_b32 v25, v25, v26
    v_mul_u32_u24 v24, 9216, v24
    v_lshl_add_u32 v24, v25, 4, v24
    s_mul_i32 s7, s3, 147456
    s_lshl_b32 s8, s69, 8
    s_add_u32 s7, s7, s8
    v_add_u32 v148, s7, v24
    v_add_u32 v149, 35840, v148
    v_xor_b32 v24, 128, v148
    v_add_u32 v150, 71680, v24
    v_add_u32 v151, 35840, v150
    s_mov_b32 s9, 144896
    s_mov_b32 s11, 114688
    v_mul_u32_u24 v48, 1216, v3
    v_mad_u32_u24 v48, v4, 12, v48
    v_add_u32 v48, s9, v48
    v_mov_b32 v47, 0x40000000
    v_lshlrev_b32 v3, 3, v3
    s_lshl_b32 s5, s68, 6
    s_add_u32 s5, s5, 12386304
    v_cmp_eq_u32 vcc, 0, v4
    s_nop 1
    v_cndmask_b32 v49, v47, v3, vcc
    v_lshrrev_b32 v5, 4, v0
    v_and_b32 v4, 3, v2
    v_lshlrev_b32 v4, 3, v4
    v_lshl_add_u32 v5, v5, 5, v4
    v_bfe_u32 v6, v2, 2, 2
    v_mul_u32_u24 v4, 1216, v6
    v_mul_u32_u24 v6, 1152, v6
    v_add3_u32 v50, v4, v5, s9
    v_add3_u32 v51, v6, v5, s11
    s_mul_i32 s4, s3, 2176
    v_add_u32 v55, s4, v51
    v_lshlrev_b32 v52, 4, v0
    s_add_u32 s7, s15, 4096
    s_add_u32 s8, s15, 8192
    s_cmp_eq_u32 s3, 0
    s_cselect_b32 s8, s8, 0x40000000
    v_add_u32 v53, 2359296, v52
    v_mov_b32 v54, 0
    v_add_u32 v4, 0, v52
    v_lshrrev_b32 v5, 7, v4
    v_mul_u32_u24 v6, 9363, v5
    v_lshrrev_b32 v6, 16, v6
    v_mad_i32_i24 v5, v6, -7, v5
    v_cmp_lt_u32 vcc, 2, v5
    s_nop 1
    v_addc_co_u32 v6, vcc, 0, v6, vcc
    v_lshl_add_u32 v93, v6, 7, v4
    v_add_u32 v4, 4096, v52
    v_lshrrev_b32 v5, 7, v4
    v_mul_u32_u24 v6, 9363, v5
    v_lshrrev_b32 v6, 16, v6
    v_mad_i32_i24 v5, v6, -7, v5
    v_cmp_lt_u32 vcc, 2, v5
    s_nop 1
    v_addc_co_u32 v6, vcc, 0, v6, vcc
    v_lshl_add_u32 v94, v6, 7, v4
    v_add_u32 v4, 8192, v52
    v_lshrrev_b32 v5, 7, v4
    v_mul_u32_u24 v6, 9363, v5
    v_lshrrev_b32 v6, 16, v6
    v_mad_i32_i24 v5, v6, -7, v5
    v_cmp_lt_u32 vcc, 2, v5
    s_nop 1
    v_addc_co_u32 v6, vcc, 0, v6, vcc
    v_lshl_add_u32 v95, v6, 7, v4
    s_mul_i32 s10, s68, 11264
    s_add_u32 s10, s10, 36585472
    s_cmp_eq_u32 s3, 0
    s_cselect_b32 s83, s10, 0x40000000
    s_add_u32 s7, s10, 2883584
    s_add_u32 s8, s83, 2883584
    s_mul_i32 s4, s3, 1028
    s_sub_u32 s4, 8204, s4
    v_add_u32 v90, s4, v53
    s_bfe_u32 s6, s68, 0x20001
    s_lshl_b32 s6, s6, 6
    s_lshr_b32 s9, s68, 3
    s_lshl1_add_u32 s6, s9, s6
    s_and_b32 s9, s68, 1
    s_add_u32 s6, s6, s9
    s_lshl_b32 s4, s6, 2
    s_add_u32 s4, s4, 12533760
    v_lshl_add_u32 v1, v0, 10, s4
    s_lshl_b32 s4, s68, 2
    s_add_u32 s4, s4, 12599296
    v_lshl_add_u32 v46, v0, 10, s4
    v_cmp_gt_u32 vcc, 8, v0
    s_nop 1
    v_cndmask_b32 v1, v47, v1, vcc
    v_cmp_gt_u32 vcc, 4, v0
    s_nop 1
    v_cndmask_b32 v46, v47, v46, vcc
    s_waitcnt vmcnt(9)
    v_and_b32 v21, 0xffff0000, v8
    s_add_u32 m0, s73, 81920
    s_mul_i32 s14, s18, 589824
    buffer_load_dwordx4 v148, s[48:51], s14 offen offset:0 lds
    v_lshlrev_b32 v20, 16, v8
    v_and_b32 v23, 0xffff0000, v9
    v_lshlrev_b32 v22, 16, v9
    v_and_b32 v25, 0xffff0000, v10
    v_lshlrev_b32 v24, 16, v10
    v_and_b32 v27, 0xffff0000, v12
    v_lshlrev_b32 v26, 16, v12
    v_and_b32 v29, 0xffff0000, v13
    v_lshlrev_b32 v28, 16, v13
    v_and_b32 v31, 0xffff0000, v14
    v_lshlrev_b32 v30, 16, v14
    v_and_b32 v33, 0xffff0000, v16
    v_lshlrev_b32 v32, 16, v16
    v_and_b32 v35, 0xffff0000, v17
    v_lshlrev_b32 v34, 16, v17
    v_and_b32 v37, 0xffff0000, v18
    v_lshlrev_b32 v36, 16, v18
    v_pk_add_f32 v[38:39], v[20:21], v[22:23]
    v_pk_add_f32 v[40:41], v[24:25], v[26:27]
    v_pk_add_f32 v[42:43], v[28:29], v[30:31]
    v_pk_add_f32 v[44:45], v[32:33], v[34:35]
    v_pk_add_f32 v[38:39], v[38:39], v[40:41]
    v_pk_add_f32 v[42:43], v[42:43], v[44:45]
    v_pk_add_f32 v[38:39], v[38:39], v[36:37]
    v_pk_add_f32 v[38:39], v[38:39], v[42:43]
    v_add_f32 v56, v38, v39
    buffer_load_dwordx4 v149, s[48:51], s14 offen offset:1024 lds
    s_nop 0
    v_add_f32_dpp v56, v56, v56 row_ror:8 row_mask:0xf bank_mask:0xf
    s_nop 1
    v_add_f32_dpp v56, v56, v56 row_ror:4 row_mask:0xf bank_mask:0xf
    s_nop 1
    v_add_f32_dpp v56, v56, v56 row_ror:2 row_mask:0xf bank_mask:0xf
    s_nop 1
    v_add_f32_dpp v56, v56, v56 row_ror:1 row_mask:0xf bank_mask:0xf
    v_mov_b32 v57, v56
    s_nop 1
    v_permlane16_swap_b32 v56, v57
    v_add_f32 v56, v56, v57
    v_mul_f32 v56, 0x3ae38e39, v56
    v_pk_add_f32 v[20:21], v[20:21], v[56:57] op_sel_hi:[1,0] neg_lo:[0,1] neg_hi:[0,1]
    v_pk_add_f32 v[22:23], v[22:23], v[56:57] op_sel_hi:[1,0] neg_lo:[0,1] neg_hi:[0,1]
    v_pk_add_f32 v[24:25], v[24:25], v[56:57] op_sel_hi:[1,0] neg_lo:[0,1] neg_hi:[0,1]
    v_pk_add_f32 v[26:27], v[26:27], v[56:57] op_sel_hi:[1,0] neg_lo:[0,1] neg_hi:[0,1]
    v_pk_add_f32 v[28:29], v[28:29], v[56:57] op_sel_hi:[1,0] neg_lo:[0,1] neg_hi:[0,1]
    v_pk_add_f32 v[30:31], v[30:31], v[56:57] op_sel_hi:[1,0] neg_lo:[0,1] neg_hi:[0,1]
    v_pk_add_f32 v[32:33], v[32:33], v[56:57] op_sel_hi:[1,0] neg_lo:[0,1] neg_hi:[0,1]
    v_pk_add_f32 v[34:35], v[34:35], v[56:57] op_sel_hi:[1,0] neg_lo:[0,1] neg_hi:[0,1]
    v_pk_add_f32 v[36:37], v[36:37], v[56:57] op_sel_hi:[1,0] neg_lo:[0,1] neg_hi:[0,1]
    v_pk_mul_f32 v[38:39], v[20:21], v[20:21]
    v_pk_mul_f32 v[40:41], v[22:23], v[22:23]
    v_pk_fma_f32 v[38:39], v[24:25], v[24:25], v[38:39]
    v_pk_fma_f32 v[40:41], v[26:27], v[26:27], v[40:41]
    v_pk_fma_f32 v[38:39], v[28:29], v[28:29], v[38:39]
    v_pk_fma_f32 v[40:41], v[30:31], v[30:31], v[40:41]
    v_pk_fma_f32 v[38:39], v[32:33], v[32:33], v[38:39]
    v_pk_fma_f32 v[40:41], v[34:35], v[34:35], v[40:41]
    v_pk_fma_f32 v[38:39], v[36:37], v[36:37], v[38:39]
    buffer_load_dwordx4 v150, s[48:51], s14 offen offset:2048 lds
    v_pk_add_f32 v[38:39], v[38:39], v[40:41]
    v_add_f32 v18, v38, v39
    s_nop 1
    v_add_f32_dpp v18, v18, v18 row_ror:8 row_mask:0xf bank_mask:0xf
    s_nop 1
    v_add_f32_dpp v18, v18, v18 row_ror:4 row_mask:0xf bank_mask:0xf
    s_nop 1
    v_add_f32_dpp v18, v18, v18 row_ror:2 row_mask:0xf bank_mask:0xf
    s_nop 1
    v_add_f32_dpp v18, v18, v18 row_ror:1 row_mask:0xf bank_mask:0xf
    v_mov_b32 v19, v18
    s_nop 1
    v_permlane16_swap_b32 v18, v19
    v_add_f32 v18, v18, v19
    v_mul_f32 v18, 0x3ae38e39, v18
    v_cvt_pk_bf16_f32 v38, v56, v18
    v_lshlrev_b32 v106, 16, v38
    v_and_b32 v38, 0xffff0000, v38
    v_add_f32 v38, 0x3727c5ac, v38
    v_sub_f32 v56, v56, v106
    v_cvt_pk_bf16_f32 v38, v38, v38
    v_lshlrev_b32 v38, 16, v38
    v_sqrt_f32 v38, v38
    s_nop 0
    v_cvt_pk_bf16_f32 v38, v38, v38
    v_lshlrev_b32 v38, 16, v38
    v_rcp_f32 v107, v38
    s_nop 0
    v_mul_f32 v56, v56, v107
    v_mul_f32 v18, v18, v107
    v_mul_f32 v18, v18, v107
    v_cvt_pk_bf16_f32 v38, v56, v18
    v_lshlrev_b32 v39, 16, v38
    buffer_load_dwordx4 v151, s[48:51], s14 offen offset:3072 lds
    v_and_b32 v38, 0xffff0000, v38
    v_add_f32 v38, 0x3727c5ac, v38
    v_sub_f32 v56, v56, v39
    v_cvt_pk_bf16_f32 v38, v38, v38
    v_lshlrev_b32 v38, 16, v38
    v_sqrt_f32 v38, v38
    s_nop 0
    v_cvt_pk_bf16_f32 v38, v38, v38
    v_lshlrev_b32 v38, 16, v38
    v_rcp_f32 v38, v38
    s_nop 0
    v_mul_f32 v18, v107, v38
    v_mul_f32 v56, v56, v38
    v_pk_fma_f32 v[20:21], v[20:21], v[18:19], v[56:57] op_sel_hi:[1,0,0]
    v_pk_fma_f32 v[22:23], v[22:23], v[18:19], v[56:57] op_sel_hi:[1,0,0]
    v_pk_fma_f32 v[24:25], v[24:25], v[18:19], v[56:57] op_sel_hi:[1,0,0]
    v_pk_fma_f32 v[26:27], v[26:27], v[18:19], v[56:57] op_sel_hi:[1,0,0]
    v_pk_fma_f32 v[28:29], v[28:29], v[18:19], v[56:57] op_sel_hi:[1,0,0]
    v_pk_fma_f32 v[30:31], v[30:31], v[18:19], v[56:57] op_sel_hi:[1,0,0]
    v_pk_fma_f32 v[32:33], v[32:33], v[18:19], v[56:57] op_sel_hi:[1,0,0]
    v_pk_fma_f32 v[34:35], v[34:35], v[18:19], v[56:57] op_sel_hi:[1,0,0]
    v_pk_fma_f32 v[36:37], v[36:37], v[18:19], v[56:57] op_sel_hi:[1,0,0]
    v_cvt_pk_bf16_f32 v8, v20, v21
    v_cvt_pk_bf16_f32 v9, v22, v23
    v_cvt_pk_bf16_f32 v10, v24, v25
    v_cvt_pk_bf16_f32 v11, v26, v27
    v_cvt_pk_bf16_f32 v12, v28, v29
    v_cvt_pk_bf16_f32 v13, v30, v31
    v_cvt_pk_bf16_f32 v14, v32, v33
    v_cvt_pk_bf16_f32 v15, v34, v35
    v_cvt_pk_bf16_f32 v16, v36, v37
    ds_write_b32 v48, v8 offset:0
    ds_write_b32 v48, v9 offset:4
    ds_write_b32 v48, v10 offset:8
    ds_write_b32 v48, v11 offset:384
    ds_write_b32 v48, v12 offset:388
    ds_write_b32 v48, v13 offset:392
    ds_write_b32 v48, v14 offset:768
    ds_write_b32 v48, v15 offset:772
    ds_write_b32 v48, v16 offset:776
    buffer_store_dwordx2 v[106:107], v49, s[44:47], s5 offen sc1
    s_waitcnt lgkmcnt(0)
    s_barrier
    ds_read_b64_tr_b16 v[20:21], v50 offset:0
    ds_read_b64_tr_b16 v[22:23], v50 offset:4864
    ds_read_b64_tr_b16 v[24:25], v50 offset:512
    ds_read_b64_tr_b16 v[26:27], v50 offset:5376
    ds_read_b64_tr_b16 v[28:29], v50 offset:1024
    ds_read_b64_tr_b16 v[30:31], v50 offset:5888
    s_waitcnt lgkmcnt(4)
    buffer_store_dwordx4 v[20:23], v93, s[44:47], s10 offen sc1
    s_waitcnt lgkmcnt(2)
    buffer_store_dwordx4 v[24:27], v94, s[44:47], s10 offen sc1
    s_waitcnt lgkmcnt(0)
    buffer_store_dwordx4 v[28:31], v95, s[44:47], s83 offen sc1
    buffer_load_dword v45, v54, s[64:67], 0 offen sc1
    s_waitcnt vmcnt(9)
    s_barrier
    ds_read_b64_tr_b16 v[60:61], v51 offset:0
    ds_read_b64_tr_b16 v[62:63], v51 offset:4608
    ds_read_b64_tr_b16 v[64:65], v51 offset:9216
    ds_read_b64_tr_b16 v[66:67], v51 offset:12672
    ds_read_b64_tr_b16 v[68:69], v51 offset:17280
    ds_read_b64_tr_b16 v[70:71], v51 offset:512
    ds_read_b64_tr_b16 v[72:73], v51 offset:5120
    ds_read_b64_tr_b16 v[74:75], v51 offset:9728
    ds_read_b64_tr_b16 v[76:77], v51 offset:13184
    ds_read_b64_tr_b16 v[78:79], v51 offset:17792
    v_alignbit_b32 v114, v99, v99, 16
    v_alignbit_b32 v115, v98, v98, 16
    s_waitcnt lgkmcnt(5)
    v_alignbit_b32 v108, v61, v60, 16
    v_alignbit_b32 v109, v62, v61, 16
    v_alignbit_b32 v110, v63, v62, 16
    v_alignbit_b32 v111, v64, v63, 16
    v_alignbit_b32 v112, v65, v64, 16
    v_dot2_f32_bf16 v116, v60, v114, 0
    ds_read_b64_tr_b16 v[80:81], v51 offset:1024
    v_dot2_f32_bf16 v117, v108, v114, 0
    s_add_u32 m0, s73, 98304
    s_mul_i32 s14, s19, 589824
    buffer_load_dwordx4 v148, s[48:51], s14 offen offset:0 lds
    v_dot2_f32_bf16 v118, v61, v114, 0
    v_dot2_f32_bf16 v119, v109, v114, 0
    v_dot2_f32_bf16 v120, v62, v114, 0
    ds_read_b64_tr_b16 v[82:83], v51 offset:5632
    v_dot2_f32_bf16 v121, v110, v114, 0
    v_dot2_f32_bf16 v122, v63, v114, 0
    v_dot2_f32_bf16 v123, v111, v114, 0
    v_dot2_f32_bf16 v116, v61, v115, v116
    v_dot2_f32_bf16 v117, v109, v115, v117
    ds_read_b64_tr_b16 v[84:85], v51 offset:10240
    v_dot2_f32_bf16 v118, v62, v115, v118
    v_dot2_f32_bf16 v119, v110, v115, v119
    v_dot2_f32_bf16 v120, v63, v115, v120
    v_dot2_f32_bf16 v121, v111, v115, v121
    v_dot2_f32_bf16 v122, v64, v115, v122
    ds_read_b64_tr_b16 v[86:87], v51 offset:13696
    v_dot2_f32_bf16 v123, v112, v115, v123
    v_and_b32 v133, 0xffff0000, v66
    v_lshlrev_b32 v132, 16, v66
    v_and_b32 v135, 0xffff0000, v67
    v_lshlrev_b32 v134, 16, v67
    ds_read_b64_tr_b16 v[88:89], v51 offset:18304
    v_and_b32 v137, 0xffff0000, v68
    v_lshlrev_b32 v136, 16, v68
    v_and_b32 v139, 0xffff0000, v69
    v_lshlrev_b32 v138, 16, v69
    v_pk_mul_f32 v[116:117], v[116:117], v[132:133]
    v_pk_mul_f32 v[118:119], v[118:119], v[134:135]
    v_pk_mul_f32 v[120:121], v[120:121], v[136:137]
    v_pk_mul_f32 v[122:123], v[122:123], v[138:139]
    buffer_load_dwordx4 v149, s[48:51], s14 offen offset:1024 lds
    v_cvt_pk_bf16_f32 v160, v123, v122
    v_cvt_pk_bf16_f32 v161, v121, v120
    v_cvt_pk_bf16_f32 v162, v119, v118
    v_cvt_pk_bf16_f32 v163, v117, v116
    buffer_store_dwordx4 v[160:163], v93, s[44:47], s7 offen sc1
    v_alignbit_b32 v114, v101, v101, 16
    v_alignbit_b32 v115, v100, v100, 16
    s_waitcnt lgkmcnt(5)
    v_alignbit_b32 v108, v71, v70, 16
    v_alignbit_b32 v109, v72, v71, 16
    v_alignbit_b32 v110, v73, v72, 16
    v_alignbit_b32 v111, v74, v73, 16
    v_alignbit_b32 v112, v75, v74, 16
    v_dot2_f32_bf16 v124, v70, v114, 0
    v_dot2_f32_bf16 v125, v108, v114, 0
    v_dot2_f32_bf16 v126, v71, v114, 0
    v_dot2_f32_bf16 v127, v109, v114, 0
    v_dot2_f32_bf16 v128, v72, v114, 0
    v_dot2_f32_bf16 v129, v110, v114, 0
    v_dot2_f32_bf16 v130, v73, v114, 0
    v_dot2_f32_bf16 v131, v111, v114, 0
    v_dot2_f32_bf16 v124, v71, v115, v124
    v_dot2_f32_bf16 v125, v109, v115, v125
    v_dot2_f32_bf16 v126, v72, v115, v126
    v_dot2_f32_bf16 v127, v110, v115, v127
    v_dot2_f32_bf16 v128, v73, v115, v128
    v_dot2_f32_bf16 v129, v111, v115, v129
    v_dot2_f32_bf16 v130, v74, v115, v130
    v_dot2_f32_bf16 v131, v112, v115, v131
    v_and_b32 v133, 0xffff0000, v76
    buffer_load_dwordx4 v150, s[48:51], s14 offen offset:2048 lds
    v_lshlrev_b32 v132, 16, v76
    v_and_b32 v135, 0xffff0000, v77
    v_lshlrev_b32 v134, 16, v77
    v_and_b32 v137, 0xffff0000, v78
    v_lshlrev_b32 v136, 16, v78
    v_and_b32 v139, 0xffff0000, v79
    v_lshlrev_b32 v138, 16, v79
    v_pk_mul_f32 v[124:125], v[124:125], v[132:133]
    v_pk_mul_f32 v[126:127], v[126:127], v[134:135]
    v_pk_mul_f32 v[128:129], v[128:129], v[136:137]
    v_pk_mul_f32 v[130:131], v[130:131], v[138:139]
    v_cvt_pk_bf16_f32 v164, v131, v130
    v_cvt_pk_bf16_f32 v165, v129, v128
    v_cvt_pk_bf16_f32 v166, v127, v126
    v_cvt_pk_bf16_f32 v167, v125, v124
    buffer_store_dwordx4 v[164:167], v94, s[44:47], s7 offen sc1
    v_alignbit_b32 v114, v103, v103, 16
    v_alignbit_b32 v115, v102, v102, 16
    s_waitcnt lgkmcnt(0)
    v_alignbit_b32 v108, v81, v80, 16
    v_alignbit_b32 v109, v82, v81, 16
    v_alignbit_b32 v110, v83, v82, 16
    v_alignbit_b32 v111, v84, v83, 16
    v_alignbit_b32 v112, v85, v84, 16
    v_dot2_f32_bf16 v116, v80, v114, 0
    v_dot2_f32_bf16 v117, v108, v114, 0
    v_dot2_f32_bf16 v118, v81, v114, 0
    v_dot2_f32_bf16 v119, v109, v114, 0
    v_dot2_f32_bf16 v120, v82, v114, 0
    v_dot2_f32_bf16 v121, v110, v114, 0
    buffer_load_dwordx4 v151, s[48:51], s14 offen offset:3072 lds
    v_dot2_f32_bf16 v122, v83, v114, 0
    v_dot2_f32_bf16 v123, v111, v114, 0
    v_dot2_f32_bf16 v116, v81, v115, v116
    v_dot2_f32_bf16 v117, v109, v115, v117
    v_dot2_f32_bf16 v118, v82, v115, v118
    v_dot2_f32_bf16 v119, v110, v115, v119
    v_dot2_f32_bf16 v120, v83, v115, v120
    v_dot2_f32_bf16 v121, v111, v115, v121
    v_dot2_f32_bf16 v122, v84, v115, v122
    v_dot2_f32_bf16 v123, v112, v115, v123
    v_and_b32 v133, 0xffff0000, v86
    v_lshlrev_b32 v132, 16, v86
    v_and_b32 v135, 0xffff0000, v87
    v_lshlrev_b32 v134, 16, v87
    v_and_b32 v137, 0xffff0000, v88
    v_lshlrev_b32 v136, 16, v88
    v_and_b32 v139, 0xffff0000, v89
    v_lshlrev_b32 v138, 16, v89
    v_pk_mul_f32 v[116:117], v[116:117], v[132:133]
    v_pk_mul_f32 v[118:119], v[118:119], v[134:135]
    v_pk_mul_f32 v[120:121], v[120:121], v[136:137]
    v_pk_mul_f32 v[122:123], v[122:123], v[138:139]
    v_cvt_pk_bf16_f32 v168, v123, v122
    v_cvt_pk_bf16_f32 v169, v121, v120
    v_cvt_pk_bf16_f32 v170, v119, v118
    v_cvt_pk_bf16_f32 v171, v117, v116
    buffer_store_dwordx4 v[168:171], v95, s[44:47], s8 offen sc1
    s_add_u32 m0, s73, 0
    s_mul_i32 s14, s20, 589824
    buffer_load_dwordx4 v148, s[48:51], s14 offen offset:0 lds
    buffer_load_dwordx4 v149, s[48:51], s14 offen offset:1024 lds
    buffer_load_dwordx4 v150, s[48:51], s14 offen offset:2048 lds
    buffer_load_dwordx4 v151, s[48:51], s14 offen offset:3072 lds
    s_add_u32 m0, s73, 16384
    s_mul_i32 s14, s21, 589824
    buffer_load_dwordx4 v148, s[48:51], s14 offen offset:0 lds
    buffer_load_dwordx4 v149, s[48:51], s14 offen offset:1024 lds
    buffer_load_dwordx4 v150, s[48:51], s14 offen offset:2048 lds
    buffer_load_dwordx4 v151, s[48:51], s14 offen offset:3072 lds
    s_waitcnt vmcnt(15)
    v_readfirstlane_b32 s68, v45
    s_nop 1
    s_cmp_eq_u32 s68, 0
    s_cbranch_scc1 L_nw_G
L_ng_G:
    s_barrier
    v_mov_b32 v3, s68
    buffer_store_dword v3, v1, s[44:47], 0 offen sc1
    s_mov_b64 exec, 0
    s_call_b64 s[82:83], L_wc_G
    s_mov_b64 exec, -1
    s_waitcnt vmcnt(9)
    s_barrier
    buffer_store_dword v3, v46, s[44:47], 0 offen sc1
L_segG:
L_pl_G_0:
    s_cbranch_execz L_pl_G_4
    s_add_u32 m0, s73, 32768
    s_mul_i32 s14, s22, 589824
    buffer_load_dwordx4 v148, s[48:51], s14 offen offset:0 lds
    buffer_load_dwordx4 v149, s[48:51], s14 offen offset:1024 lds
    buffer_load_dwordx4 v150, s[48:51], s14 offen offset:2048 lds
    buffer_load_dwordx4 v151, s[48:51], s14 offen offset:3072 lds
    s_add_u32 m0, s73, 49152
    s_mul_i32 s14, s23, 589824
    buffer_load_dwordx4 v148, s[48:51], s14 offen offset:0 lds
    buffer_load_dwordx4 v149, s[48:51], s14 offen offset:1024 lds
    buffer_load_dwordx4 v150, s[48:51], s14 offen offset:2048 lds
    buffer_load_dwordx4 v151, s[48:51], s14 offen offset:3072 lds
    s_add_u32 m0, s73, 65536
    s_mul_i32 s14, s24, 589824
    buffer_load_dwordx4 v148, s[48:51], s14 offen offset:0 lds
    buffer_load_dwordx4 v149, s[48:51], s14 offen offset:1024 lds
    buffer_load_dwordx4 v150, s[48:51], s14 offen offset:2048 lds
    buffer_load_dwordx4 v151, s[48:51], s14 offen offset:3072 lds
    v_bfe_u32 v140, v2, 2, 2
    v_lshrrev_b32 v141, 4, v2
    v_lshl_add_u32 v142, v141, 3, v140
    v_lshlrev_b32 v142, 8, v142
    v_and_b32 v143, 3, v2
    v_lshl_add_u32 v142, v143, 3, v142
    v_and_b32 v141, 1, v141
    v_lshl_add_u32 v140, v141, 2, v140
    s_lshl_b32 s7, s3, 1
    v_xor_b32 v140, s7, v140
    v_lshl_add_u32 v152, v140, 5, v142
    v_xor_b32 v153, 32, v152
    v_add_u32 v154, 0x10000, v152
    v_add_u32 v155, 0x10000, v153
    v_and_b32 v24, 15, v2
    v_lshrrev_b32 v25, 4, v2
    v_mul_u32_u24 v26, 17408, v25
    v_lshl_add_u32 v26, v24, 4, v26
    v_mul_u32_u24 v25, 1536, v25
    v_lshl_add_u32 v25, v24, 4, v25
    v_add_u32 v159, 81920, v25
    v_add_u32 v250, 36864, v159
    s_mul_i32 s7, s3, 18432
    s_xor_b32 s8, s70, 1
    s_mul_i32 s8, s8, 1536
    s_add_u32 s7, s7, s8
    v_lshlrev_b32 v246, 4, v2
    v_add_u32 v156, s7, v246
    v_lshrrev_b32 v25, 5, v2
    v_mul_u32_u24 v25, 7680, v25
    v_add_u32 v157, v156, v25
    v_add_u32 v158, 7680, v156
    s_mul_i32 s74, s3, 3072
    s_add_u32 s74, s74, 81920
    v_mov_b32 v245, v26
    s_mov_b64 exec, 0
    s_call_b64 s[82:83], L_wc_D
    s_mov_b64 exec, -1
    s_mov_b32 s56, s32
    s_and_b32 s57, s33, 0xffff
    s_mov_b32 s58, 9216
    s_mov_b32 s59, 0x20000
    s_mov_b32 s60, s36
    s_and_b32 s61, s37, 0xffff
    s_mov_b32 s62, 4096
    s_mov_b32 s63, 0x20000
    s_and_b32 s4, s70, 1
    s_lshl1_add_u32 s4, s3, s4
    s_lshl_b32 s4, s4, 7
    s_bfe_u32 s5, s2, 0x10003
    s_lshl1_add_u32 s5, s72, s5
    s_lshr_b32 s5, s5, 0
    s_lshl_b32 s5, s5, 10
    s_add_u32 s4, s4, s5
    s_add_u32 s4, s4, 12533760
    v_lshl_add_u32 v28, v2, 2, s4
    v_cmp_gt_u32 vcc, 32, v2
    v_mov_b32 v12, 0x40000000
    s_nop 0
    v_cndmask_b32 v28, v12, v28, vcc
    v_mov_b32 v12, s68
    v_cndmask_b32 v12, 0, v12, vcc
    v_lshrrev_b32 v24, 4, v2
    v_lshlrev_b32 v25, 3, v24
    s_lshl_b32 s7, s69, 8
    s_lshl_b32 s8, s3, 6
    s_add_u32 s7, s7, s8
    buffer_load_dwordx2 v[144:145], v25, s[56:59], s7 offen
    buffer_load_dwordx2 v[146:147], v25, s[56:59], s7 offen offset:32
    s_barrier
    ds_read_b64_tr_b16 a[0:1], v154 offset:16384
    ds_read_b64_tr_b16 a[2:3], v154 offset:17408
    ds_read_b64_tr_b16 a[4:5], v155 offset:16384
    ds_read_b64_tr_b16 a[6:7], v155 offset:17408
    ds_read_b64_tr_b16 a[8:9], v154 offset:24576
    ds_read_b64_tr_b16 a[10:11], v154 offset:25600
    ds_read_b64_tr_b16 a[12:13], v155 offset:24576
    ds_read_b64_tr_b16 a[14:15], v155 offset:25600
    ds_read_b64_tr_b16 a[16:17], v154 offset:32768
    ds_read_b64_tr_b16 a[18:19], v154 offset:33792
    ds_read_b64_tr_b16 a[20:21], v155 offset:32768
    ds_read_b64_tr_b16 a[22:23], v155 offset:33792
    ds_read_b64_tr_b16 a[24:25], v154 offset:40960
    ds_read_b64_tr_b16 a[26:27], v154 offset:41984
    ds_read_b64_tr_b16 a[28:29], v155 offset:40960
    ds_read_b64_tr_b16 a[30:31], v155 offset:41984
    s_waitcnt vmcnt(20)
    s_barrier
    ds_read_b64_tr_b16 a[32:33], v152 offset:0
    ds_read_b64_tr_b16 a[34:35], v152 offset:1024
    ds_read_b64_tr_b16 a[36:37], v153 offset:0
    ds_read_b64_tr_b16 a[38:39], v153 offset:1024
    ds_read_b64_tr_b16 a[40:41], v152 offset:8192
    ds_read_b64_tr_b16 a[42:43], v152 offset:9216
    ds_read_b64_tr_b16 a[44:45], v153 offset:8192
    ds_read_b64_tr_b16 a[46:47], v153 offset:9216
    s_waitcnt vmcnt(16)
    s_barrier
    ds_read_b64_tr_b16 a[48:49], v152 offset:16384
    ds_read_b64_tr_b16 a[50:51], v152 offset:17408
    ds_read_b64_tr_b16 a[52:53], v153 offset:16384
    ds_read_b64_tr_b16 a[54:55], v153 offset:17408
    ds_read_b64_tr_b16 a[56:57], v152 offset:24576
    ds_read_b64_tr_b16 a[58:59], v152 offset:25600
    ds_read_b64_tr_b16 a[60:61], v153 offset:24576
    ds_read_b64_tr_b16 a[62:63], v153 offset:25600
    v_mov_b32 v29, 0
    buffer_atomic_add v29, v28, s[44:47], 0 offen sc0 sc1
    s_waitcnt vmcnt(11)
    s_barrier
    ds_read_b64_tr_b16 a[64:65], v152 offset:32768
    ds_read_b64_tr_b16 a[66:67], v152 offset:33792
    ds_read_b64_tr_b16 a[68:69], v153 offset:32768
    ds_read_b64_tr_b16 a[70:71], v153 offset:33792
    ds_read_b64_tr_b16 a[72:73], v152 offset:40960
    ds_read_b64_tr_b16 a[74:75], v152 offset:41984
    ds_read_b64_tr_b16 a[76:77], v153 offset:40960
    ds_read_b64_tr_b16 a[78:79], v153 offset:41984
L_pl_G_1:
    s_cbranch_execz L_pl_G_5
    s_waitcnt lgkmcnt(0)
    s_barrier
    s_xor_b32 s8, s70, 1
    s_mul_i32 s8, s8, 1536
    s_mul_i32 s7, s3, 22528
    s_add_u32 s7, s7, 36585472
    v_add_u32 v24, 0, v246
    v_cmp_lt_u32 vcc, 1535, v24
    s_nop 1
    v_cndmask_b32 v25, 0, 1, vcc
    v_mul_u32_u24 v30, 1536, v25
    v_sub_u32 v24, v24, v30
    v_add_u32 v24, s8, v24
    v_lshrrev_b32 v30, 7, v24
    v_mul_u32_u24 v31, 9363, v30
    v_lshrrev_b32 v31, 16, v31
    v_mad_i32_i24 v30, v31, -7, v30
    v_cmp_lt_u32 vcc, 2, v30
    s_nop 1
    v_addc_co_u32 v31, vcc, 0, v31, vcc
    v_lshl_add_u32 v24, v31, 7, v24
    v_mul_u32_u24 v25, 11264, v25
    v_add3_u32 v24, v24, v25, s7
    v_subrev_u32 v156, 0, v24
    v_add_u32 v24, 1024, v246
    v_cmp_lt_u32 vcc, 1535, v24
    s_nop 1
    v_cndmask_b32 v25, 0, 1, vcc
    v_mul_u32_u24 v30, 1536, v25
    v_sub_u32 v24, v24, v30
    v_add_u32 v24, s8, v24
    v_lshrrev_b32 v30, 7, v24
    v_mul_u32_u24 v31, 9363, v30
    v_lshrrev_b32 v31, 16, v31
    v_mad_i32_i24 v30, v31, -7, v30
    v_cmp_lt_u32 vcc, 2, v30
    s_nop 1
    v_addc_co_u32 v31, vcc, 0, v31, vcc
    v_lshl_add_u32 v24, v31, 7, v24
    v_mul_u32_u24 v25, 11264, v25
    v_add3_u32 v24, v24, v25, s7
    v_subrev_u32 v157, 1024, v24
    v_add_u32 v24, 2048, v246
    v_cmp_lt_u32 vcc, 1535, v24
    s_nop 1
    v_cndmask_b32 v25, 0, 1, vcc
    v_mul_u32_u24 v30, 1536, v25
    v_sub_u32 v24, v24, v30
    v_add_u32 v24, s8, v24
    v_lshrrev_b32 v30, 7, v24
    v_mul_u32_u24 v31, 9363, v30
    v_lshrrev_b32 v31, 16, v31
    v_mad_i32_i24 v30, v31, -7, v30
    v_cmp_lt_u32 vcc, 2, v30
    s_nop 1
    v_addc_co_u32 v31, vcc, 0, v31, vcc
    v_lshl_add_u32 v24, v31, 7, v24
    v_mul_u32_u24 v25, 11264, v25
    v_add3_u32 v24, v24, v25, s7
    v_subrev_u32 v158, 2048, v24
    s_xor_b32 s8, s70, 0
    s_mul_i32 s8, s8, 1536
    s_mul_i32 s7, s3, 22528
    s_add_u32 s7, s7, 36585472
    v_add_u32 v24, 0, v246
    v_cmp_lt_u32 vcc, 1535, v24
    s_nop 1
    v_cndmask_b32 v25, 0, 1, vcc
    v_mul_u32_u24 v30, 1536, v25
    v_sub_u32 v24, v24, v30
    v_add_u32 v24, s8, v24
    v_lshrrev_b32 v30, 7, v24
    v_mul_u32_u24 v31, 9363, v30
    v_lshrrev_b32 v31, 16, v31
    v_mad_i32_i24 v30, v31, -7, v30
    v_cmp_lt_u32 vcc, 2, v30
    s_nop 1
    v_addc_co_u32 v31, vcc, 0, v31, vcc
    v_lshl_add_u32 v24, v31, 7, v24
    v_mul_u32_u24 v25, 11264, v25
    v_add3_u32 v24, v24, v25, s7
    v_subrev_u32 v8, 0, v24
    v_add_u32 v24, 1024, v246
    v_cmp_lt_u32 vcc, 1535, v24
    s_nop 1
    v_cndmask_b32 v25, 0, 1, vcc
    v_mul_u32_u24 v30, 1536, v25
    v_sub_u32 v24, v24, v30
    v_add_u32 v24, s8, v24
    v_lshrrev_b32 v30, 7, v24
    v_mul_u32_u24 v31, 9363, v30
    v_lshrrev_b32 v31, 16, v31
    v_mad_i32_i24 v30, v31, -7, v30
    v_cmp_lt_u32 vcc, 2, v30
    s_nop 1
    v_addc_co_u32 v31, vcc, 0, v31, vcc
    v_lshl_add_u32 v24, v31, 7, v24
    v_mul_u32_u24 v25, 11264, v25
    v_add3_u32 v24, v24, v25, s7
    v_subrev_u32 v9, 1024, v24
    v_add_u32 v24, 2048, v246
    v_cmp_lt_u32 vcc, 1535, v24
    s_nop 1
    v_cndmask_b32 v25, 0, 1, vcc
    v_mul_u32_u24 v30, 1536, v25
    v_sub_u32 v24, v24, v30
    v_add_u32 v24, s8, v24
    v_lshrrev_b32 v30, 7, v24
    v_mul_u32_u24 v31, 9363, v30
    v_lshrrev_b32 v31, 16, v31
    v_mad_i32_i24 v30, v31, -7, v30
    v_cmp_lt_u32 vcc, 2, v30
    s_nop 1
    v_addc_co_u32 v31, vcc, 0, v31, vcc
    v_lshl_add_u32 v24, v31, 7, v24
    v_mul_u32_u24 v25, 11264, v25
    v_add3_u32 v24, v24, v25, s7
    v_subrev_u32 v3, 2048, v24
    s_waitcnt vmcnt(0)
    v_cmp_ne_u32 vcc, v12, v29
    s_cbranch_vccnz L_rs_p1G
L_ok_p1G:
    s_add_u32 m0, s74, 0
    s_mul_i32 s13, s18, 90112
    buffer_load_dwordx4 v156, s[44:47], s13 offen offset:0 sc1 lds
    buffer_load_dwordx4 v157, s[44:47], s13 offen offset:1024 sc1 lds
    buffer_load_dwordx4 v158, s[44:47], s13 offen offset:2048 sc1 lds
    s_add_u32 m0, s74, 12288
    s_mul_i32 s13, s19, 90112
    buffer_load_dwordx4 v156, s[44:47], s13 offen offset:0 sc1 lds
    buffer_load_dwordx4 v157, s[44:47], s13 offen offset:1024 sc1 lds
    buffer_load_dwordx4 v158, s[44:47], s13 offen offset:2048 sc1 lds
    s_add_u32 m0, s74, 24576
    s_mul_i32 s13, s20, 90112
    buffer_load_dwordx4 v156, s[44:47], s13 offen offset:0 sc1 lds
    buffer_load_dwordx4 v157, s[44:47], s13 offen offset:1024 sc1 lds
    buffer_load_dwordx4 v158, s[44:47], s13 offen offset:2048 sc1 lds
    s_add_u32 m0, s74, 36864
    s_mul_i32 s13, s21, 90112
    buffer_load_dwordx4 v156, s[44:47], s13 offen offset:0 sc1 lds
    buffer_load_dwordx4 v157, s[44:47], s13 offen offset:1024 sc1 lds
    buffer_load_dwordx4 v158, s[44:47], s13 offen offset:2048 sc1 lds
    s_waitcnt vmcnt(9) lgkmcnt(0)
    s_barrier
    ds_read_b128 v[80:83], v159 offset:0
    ds_read_b128 v[84:87], v159 offset:6144
    ds_read_b128 v[88:91], v159 offset:256
    ds_read_b128 v[92:95], v159 offset:6400
    ds_read_b128 v[96:99], v159 offset:512
    ds_read_b128 v[100:103], v159 offset:6656
    s_waitcnt lgkmcnt(0)
    v_mfma_f32_16x16x32_bf16 v[192:195], a[0:3], v[80:83], 0
    v_mfma_f32_16x16x32_bf16 v[192:195], a[8:11], v[84:87], v[192:195]
    ds_read_b128 v[104:107], v159 offset:768
    v_mfma_f32_16x16x32_bf16 v[196:199], a[12:15], v[84:87], 0
    ds_read_b128 v[108:111], v159 offset:6912
    v_mfma_f32_16x16x32_bf16 v[196:199], a[4:7], v[80:83], v[196:199]
    ds_read_b128 v[112:115], v159 offset:1024
    v_mfma_f32_16x16x32_bf16 v[204:207], a[4:7], v[88:91], 0
    ds_read_b128 v[116:119], v159 offset:7168
    v_mfma_f32_16x16x32_bf16 v[204:207], a[12:15], v[92:95], v[204:207]
    ds_read_b128 v[120:123], v159 offset:1280
    v_mfma_f32_16x16x32_bf16 v[200:203], a[8:11], v[92:95], 0
    ds_read_b128 v[124:127], v159 offset:7424
    v_and_b32 v24, 15, v2
    s_lshl_b32 s7, s71, 6
    v_add_u32 v24, s7, v24
    s_and_b32 s8, s3, 1
    s_lshl_b32 s4, s8, 5
    v_add_u32 v25, s4, v24
    v_lshlrev_b32 v26, 3, v25
    v_mul_u32_u24 v25, 1152, v25
    v_bfe_u32 v31, v2, 4, 1
    v_lshl_add_u32 v25, v31, 5, v25
    v_lshrrev_b32 v31, 5, v2
    v_lshl_add_u32 v25, v31, 4, v25
    s_bfe_u32 s7, s2, 0x20003
    s_mul_i32 s7, s7, 288
    s_lshl_b32 s4, s72, 6
    s_add_u32 s4, s4, s7
    v_add_u32 v252, s4, v25
    s_xor_b32 s8, s3, s72
    s_and_b32 s4, s72, 1
    s_lshl1_add_u32 s4, s4, s8
    v_lshl_add_u32 v24, s4, 4, v24
    s_add_u32 s7, s7, 256
    s_cmp_lt_u32 s8, 2
    s_cselect_b32 s7, s7, 0x40000000
    v_lshlrev_b32 v18, 3, v24
    v_mul_u32_u24 v24, 1152, v24
    v_lshrrev_b32 v31, 4, v2
    v_lshl_add_u32 v24, v31, 3, v24
    v_add_u32 v253, s7, v24
    v_lshrrev_b32 v24, 3, v2
    v_and_b32 v25, 7, v2
    v_mfma_f32_16x16x32_bf16 v[200:203], a[0:3], v[88:91], v[200:203]
    v_mfma_f32_16x16x32_bf16 v[208:211], a[0:3], v[96:99], 0
    v_mfma_f32_16x16x32_bf16 v[208:211], a[8:11], v[100:103], v[208:211]
    v_mfma_f32_16x16x32_bf16 v[212:215], a[12:15], v[100:103], 0
    v_mfma_f32_16x16x32_bf16 v[212:215], a[4:7], v[96:99], v[212:215]
    s_waitcnt lgkmcnt(0)
    v_mfma_f32_16x16x32_bf16 v[220:223], a[4:7], v[104:107], 0
    s_waitcnt vmcnt(6)
    s_barrier
    v_mfma_f32_16x16x32_bf16 v[220:223], a[12:15], v[108:111], v[220:223]
    ds_read_b128 v[80:83], v159 offset:12288
    s_add_u32 m0, s74, 49152
    s_mul_i32 s13, s22, 90112
    v_mfma_f32_16x16x32_bf16 v[216:219], a[8:11], v[108:111], 0
    ds_read_b128 v[84:87], v159 offset:18432
    buffer_load_dwordx4 v156, s[44:47], s13 offen offset:0 sc1 lds
    v_mfma_f32_16x16x32_bf16 v[216:219], a[0:3], v[104:107], v[216:219]
    ds_read_b128 v[88:91], v159 offset:12544
    v_mfma_f32_16x16x32_bf16 v[224:227], a[0:3], v[112:115], 0
    ds_read_b128 v[92:95], v159 offset:18688
    buffer_load_dwordx4 v157, s[44:47], s13 offen offset:1024 sc1 lds
    v_mfma_f32_16x16x32_bf16 v[224:227], a[8:11], v[116:119], v[224:227]
    ds_read_b128 v[96:99], v159 offset:12800
    v_mfma_f32_16x16x32_bf16 v[228:231], a[12:15], v[116:119], 0
    ds_read_b128 v[100:103], v159 offset:18944
    buffer_load_dwordx4 v158, s[44:47], s13 offen offset:2048 sc1 lds
    v_bfe_u32 v31, v2, 4, 2
    v_lshlrev_b32 v31, 1, v31
    v_xor_b32 v25, v25, v31
    v_lshlrev_b32 v24, 12, v24
    v_lshl_add_u32 v24, v25, 4, v24
    s_mul_i32 s7, s72, 36
    s_bitcmp1_b32 s3, 0
    s_addc_u32 s7, s7, 0
    s_lshl_b32 s7, s7, 17
    s_lshl_b32 s8, s71, 7
    s_add_u32 s7, s7, s8
    v_add_u32 v4, s7, v24
    v_add_u32 v5, 31744, v4
    v_add_u32 v6, 31744, v5
    v_add_u32 v7, 31744, v6
    v_lshrrev_b32 v24, 2, v2
    v_lshlrev_b32 v24, 7, v24
    v_and_b32 v25, 3, v2
    v_lshl_add_u32 v24, v25, 3, v24
    s_and_b32 s7, s73, 8192
    v_add_u32 v24, s7, v24
    v_bfe_u32 v31, v2, 3, 2
    s_and_b32 s7, s3, 1
    s_lshl_b32 s7, s7, 1
    v_xor_b32 v31, s7, v31
    v_lshl_add_u32 v10, v31, 5, v24
    v_xor_b32 v11, 32, v10
    s_bfe_u32 s101, s2, 0x20003
    s_mul_i32 s101, s101, 3
    s_mul_i32 s84, s101, 305844
    s_lshr_b32 s84, s84, 18
    s_add_u32 s84, s84, 0
    v_mfma_f32_16x16x32_bf16 v[228:231], a[4:7], v[112:115], v[228:231]
    ds_read_b64_tr_b16 a[80:81], v152 offset:49152
    v_mfma_f32_16x16x32_bf16 v[236:239], a[4:7], v[120:123], 0
    ds_read_b64_tr_b16 a[82:83], v152 offset:50176
    s_add_u32 m0, s74, 61440
    s_mul_i32 s13, s23, 90112
    v_mfma_f32_16x16x32_bf16 v[236:239], a[12:15], v[124:127], v[236:239]
    v_mfma_f32_16x16x32_bf16 v[232:235], a[8:11], v[124:127], 0
    ds_read_b64_tr_b16 a[84:85], v153 offset:49152
    buffer_load_dwordx4 v156, s[44:47], s13 offen offset:0 sc1 lds
    v_mfma_f32_16x16x32_bf16 v[232:235], a[0:3], v[120:123], v[232:235]
    ds_read_b64_tr_b16 a[86:87], v153 offset:50176
    s_waitcnt lgkmcnt(4)
    v_mfma_f32_16x16x32_bf16 v[192:195], a[16:19], v[80:83], v[192:195]
    buffer_load_dwordx4 v157, s[44:47], s13 offen offset:1024 sc1 lds
    v_mfma_f32_16x16x32_bf16 v[192:195], a[24:27], v[84:87], v[192:195]
    ds_read_b128 v[104:107], v159 offset:13056
    buffer_load_dwordx4 v158, s[44:47], s13 offen offset:2048 sc1 lds
    v_mfma_f32_16x16x32_bf16 v[196:199], a[28:31], v[84:87], v[196:199]
    ds_read_b128 v[108:111], v159 offset:19200
    v_mfma_f32_16x16x32_bf16 v[196:199], a[20:23], v[80:83], v[196:199]
    ds_read_b128 v[112:115], v159 offset:13312
    s_add_u32 m0, s73, 0
    s_mul_i32 s14, s25, 589824
    v_mfma_f32_16x16x32_bf16 v[204:207], a[20:23], v[88:91], v[204:207]
    ds_read_b128 v[116:119], v159 offset:19456
    v_mfma_f32_16x16x32_bf16 v[204:207], a[28:31], v[92:95], v[204:207]
    ds_read_b128 v[120:123], v159 offset:13568
    buffer_load_dwordx4 v148, s[48:51], s14 offen offset:0 lds
    v_mfma_f32_16x16x32_bf16 v[200:203], a[24:27], v[92:95], v[200:203]
    ds_read_b128 v[124:127], v159 offset:19712
    buffer_load_dwordx4 v149, s[48:51], s14 offen offset:1024 lds
    s_add_u32 s85, s84, 1
    s_cmp_eq_u32 s85, 14
    s_cselect_b32 s85, 0, s85
    s_add_u32 s86, s85, 1
    s_cmp_eq_u32 s86, 14
    s_cselect_b32 s86, 0, s86
    s_add_u32 s87, s86, 1
    s_cmp_eq_u32 s87, 14
    s_cselect_b32 s87, 0, s87
    s_add_u32 s88, s87, 1
    s_cmp_eq_u32 s88, 14
    s_cselect_b32 s88, 0, s88
    s_add_u32 s89, s88, 1
    s_cmp_eq_u32 s89, 14
    s_cselect_b32 s89, 0, s89
    s_add_u32 s90, s89, 1
    s_cmp_eq_u32 s90, 14
    s_cselect_b32 s90, 0, s90
    s_add_u32 s91, s90, 1
    s_cmp_eq_u32 s91, 14
    s_cselect_b32 s91, 0, s91
    s_add_u32 s92, s91, 1
    s_cmp_eq_u32 s92, 14
    s_cselect_b32 s92, 0, s92
    s_add_u32 s93, s92, 1
    s_cmp_eq_u32 s93, 14
    s_cselect_b32 s93, 0, s93
    s_add_u32 s94, s93, 1
    s_cmp_eq_u32 s94, 14
    s_cselect_b32 s94, 0, s94
    s_add_u32 s95, s94, 1
    s_cmp_eq_u32 s95, 14
    s_cselect_b32 s95, 0, s95
    s_add_u32 s96, s95, 1
    s_cmp_eq_u32 s96, 14
    s_cselect_b32 s96, 0, s96
    s_add_u32 s97, s96, 1
    s_cmp_eq_u32 s97, 14
    s_cselect_b32 s97, 0, s97
    s_mul_i32 s98, s101, 87384
    s_lshr_b32 s98, s98, 18
    s_add_u32 s98, s98, 14
    s_add_u32 s99, s98, 1
    s_cmp_eq_u32 s99, 18
    s_cselect_b32 s99, 14, s99
    s_add_u32 s100, s99, 1
    s_cmp_eq_u32 s100, 18
    s_cselect_b32 s100, 14, s100
    s_add_u32 s101, s100, 1
    s_cmp_eq_u32 s101, 18
    s_cselect_b32 s101, 14, s101
    s_mul_i32 s7, s70, 6
    s_add_u32 s7, s7, 0
    s_mul_i32 s8, s7, 7282
    s_lshr_b32 s8, s8, 16
    s_mul_i32 s5, s8, 9
    s_sub_u32 s7, s7, s5
    s_lshl_b32 s7, s7, 2
    s_mov_b32 s4, 0xeca86420
    s_mov_b32 s5, 3
    s_lshr_b64 s[4:5], s[4:5], s7
    v_mfma_f32_16x16x32_bf16 v[200:203], a[16:19], v[88:91], v[200:203]
    ds_read_b64_tr_b16 a[88:89], v152 offset:57344
    v_mfma_f32_16x16x32_bf16 v[208:211], a[16:19], v[96:99], v[208:211]
    ds_read_b64_tr_b16 a[90:91], v152 offset:58368
    buffer_load_dwordx4 v150, s[48:51], s14 offen offset:2048 lds
    v_mfma_f32_16x16x32_bf16 v[208:211], a[24:27], v[100:103], v[208:211]
    v_mfma_f32_16x16x32_bf16 v[212:215], a[28:31], v[100:103], v[212:215]
    ds_read_b64_tr_b16 a[92:93], v153 offset:57344
    buffer_load_dwordx4 v151, s[48:51], s14 offen offset:3072 lds
    v_mfma_f32_16x16x32_bf16 v[212:215], a[20:23], v[96:99], v[212:215]
    ds_read_b64_tr_b16 a[94:95], v153 offset:58368
    s_waitcnt lgkmcnt(4)
    v_mfma_f32_16x16x32_bf16 v[220:223], a[20:23], v[104:107], v[220:223]
    s_waitcnt vmcnt(13)
    s_barrier
    v_mfma_f32_16x16x32_bf16 v[220:223], a[28:31], v[108:111], v[220:223]
    ds_read_b128 v[80:83], v159 offset:24576
    s_add_u32 m0, s74, 0
    s_mul_i32 s13, s24, 90112
    v_mfma_f32_16x16x32_bf16 v[216:219], a[24:27], v[108:111], v[216:219]
    ds_read_b128 v[84:87], v159 offset:30720
    buffer_load_dwordx4 v156, s[44:47], s13 offen offset:0 sc1 lds
    v_mfma_f32_16x16x32_bf16 v[216:219], a[16:19], v[104:107], v[216:219]
    ds_read_b128 v[88:91], v159 offset:24832
    v_mfma_f32_16x16x32_bf16 v[224:227], a[16:19], v[112:115], v[224:227]
    ds_read_b128 v[92:95], v159 offset:30976
    buffer_load_dwordx4 v157, s[44:47], s13 offen offset:1024 sc1 lds
    v_mfma_f32_16x16x32_bf16 v[224:227], a[24:27], v[116:119], v[224:227]
    ds_read_b128 v[96:99], v159 offset:25088
    v_mfma_f32_16x16x32_bf16 v[228:231], a[28:31], v[116:119], v[228:231]
    ds_read_b128 v[100:103], v159 offset:31232
    buffer_load_dwordx4 v158, s[44:47], s13 offen offset:2048 sc1 lds
    s_and_b32 s4, s4, 15
    s_lshl4_add_u32 s4, s8, s4
    v_lshl_add_u32 v240, s4, 8, v245
    s_mul_i32 s7, s70, 6
    s_add_u32 s7, s7, 1
    s_mul_i32 s8, s7, 7282
    s_lshr_b32 s8, s8, 16
    s_mul_i32 s5, s8, 9
    s_sub_u32 s7, s7, s5
    s_lshl_b32 s7, s7, 2
    s_mov_b32 s4, 0xeca86420
    s_mov_b32 s5, 3
    s_lshr_b64 s[4:5], s[4:5], s7
    s_and_b32 s4, s4, 15
    s_lshl4_add_u32 s4, s8, s4
    v_lshl_add_u32 v241, s4, 8, v245
    s_mul_i32 s7, s70, 6
    s_add_u32 s7, s7, 2
    s_mul_i32 s8, s7, 7282
    s_lshr_b32 s8, s8, 16
    s_mul_i32 s5, s8, 9
    s_sub_u32 s7, s7, s5
    s_lshl_b32 s7, s7, 2
    s_mov_b32 s4, 0xeca86420
    s_mov_b32 s5, 3
    v_mfma_f32_16x16x32_bf16 v[228:231], a[20:23], v[112:115], v[228:231]
    ds_read_b64_tr_b16 a[96:97], v154 offset:0
    v_mfma_f32_16x16x32_bf16 v[236:239], a[20:23], v[120:123], v[236:239]
    ds_read_b64_tr_b16 a[98:99], v154 offset:1024
    s_add_u32 m0, s74, 12288
    s_mul_i32 s13, s25, 90112
    v_mfma_f32_16x16x32_bf16 v[236:239], a[28:31], v[124:127], v[236:239]
    v_mfma_f32_16x16x32_bf16 v[232:235], a[24:27], v[124:127], v[232:235]
    ds_read_b64_tr_b16 a[100:101], v155 offset:0
    buffer_load_dwordx4 v156, s[44:47], s13 offen offset:0 sc1 lds
    v_mfma_f32_16x16x32_bf16 v[232:235], a[16:19], v[120:123], v[232:235]
    ds_read_b64_tr_b16 a[102:103], v155 offset:1024
    s_waitcnt lgkmcnt(4)
    v_mfma_f32_16x16x32_bf16 v[192:195], a[32:35], v[80:83], v[192:195]
    buffer_load_dwordx4 v157, s[44:47], s13 offen offset:1024 sc1 lds
    v_mfma_f32_16x16x32_bf16 v[192:195], a[40:43], v[84:87], v[192:195]
    ds_read_b128 v[104:107], v159 offset:25344
    buffer_load_dwordx4 v158, s[44:47], s13 offen offset:2048 sc1 lds
    v_mfma_f32_16x16x32_bf16 v[196:199], a[44:47], v[84:87], v[196:199]
    ds_read_b128 v[108:111], v159 offset:31488
    v_mfma_f32_16x16x32_bf16 v[196:199], a[36:39], v[80:83], v[196:199]
    ds_read_b128 v[112:115], v159 offset:25600
    s_add_u32 m0, s73, 16384
    s_mul_i32 s14, s26, 589824
    v_mfma_f32_16x16x32_bf16 v[204:207], a[36:39], v[88:91], v[204:207]
    ds_read_b128 v[116:119], v159 offset:31744
    v_mfma_f32_16x16x32_bf16 v[204:207], a[44:47], v[92:95], v[204:207]
    ds_read_b128 v[120:123], v159 offset:25856
    buffer_load_dwordx4 v148, s[48:51], s14 offen offset:0 lds
    v_mfma_f32_16x16x32_bf16 v[200:203], a[40:43], v[92:95], v[200:203]
    ds_read_b128 v[124:127], v159 offset:32000
    buffer_load_dwordx4 v149, s[48:51], s14 offen offset:1024 lds
    s_lshr_b64 s[4:5], s[4:5], s7
    s_and_b32 s4, s4, 15
    s_lshl4_add_u32 s4, s8, s4
    v_lshl_add_u32 v242, s4, 8, v245
    s_mul_i32 s7, s70, 6
    s_add_u32 s7, s7, 3
    s_mul_i32 s8, s7, 7282
    s_lshr_b32 s8, s8, 16
    s_mul_i32 s5, s8, 9
    s_sub_u32 s7, s7, s5
    s_lshl_b32 s7, s7, 2
    s_mov_b32 s4, 0xeca86420
    s_mov_b32 s5, 3
    s_lshr_b64 s[4:5], s[4:5], s7
    s_and_b32 s4, s4, 15
    s_lshl4_add_u32 s4, s8, s4
    v_lshl_add_u32 v243, s4, 8, v245
    s_mul_i32 s7, s70, 6
    s_add_u32 s7, s7, 4
    s_mul_i32 s8, s7, 7282
    s_lshr_b32 s8, s8, 16
    s_mul_i32 s5, s8, 9
    s_sub_u32 s7, s7, s5
    s_lshl_b32 s7, s7, 2
    s_mov_b32 s4, 0xeca86420
    v_mfma_f32_16x16x32_bf16 v[200:203], a[32:35], v[88:91], v[200:203]
    ds_read_b64_tr_b16 a[104:105], v154 offset:8192
    v_mfma_f32_16x16x32_bf16 v[208:211], a[32:35], v[96:99], v[208:211]
    ds_read_b64_tr_b16 a[106:107], v154 offset:9216
    buffer_load_dwordx4 v150, s[48:51], s14 offen offset:2048 lds
    v_mfma_f32_16x16x32_bf16 v[208:211], a[40:43], v[100:103], v[208:211]
    v_mfma_f32_16x16x32_bf16 v[212:215], a[44:47], v[100:103], v[212:215]
    ds_read_b64_tr_b16 a[108:109], v155 offset:8192
    buffer_load_dwordx4 v151, s[48:51], s14 offen offset:3072 lds
    v_mfma_f32_16x16x32_bf16 v[212:215], a[36:39], v[96:99], v[212:215]
    ds_read_b64_tr_b16 a[110:111], v155 offset:9216
    s_waitcnt lgkmcnt(4)
    v_mfma_f32_16x16x32_bf16 v[220:223], a[36:39], v[104:107], v[220:223]
    s_waitcnt vmcnt(20)
    s_barrier
    v_mfma_f32_16x16x32_bf16 v[220:223], a[44:47], v[108:111], v[220:223]
    ds_read_b128 v[80:83], v250 offset:0
    s_add_u32 m0, s74, 24576
    s_mul_i32 s13, s26, 90112
    v_mfma_f32_16x16x32_bf16 v[216:219], a[40:43], v[108:111], v[216:219]
    ds_read_b128 v[84:87], v250 offset:6144
    v_mfma_f32_16x16x32_bf16 v[216:219], a[32:35], v[104:107], v[216:219]
    ds_read_b128 v[88:91], v250 offset:256
    buffer_load_dwordx4 v156, s[44:47], s13 offen offset:0 sc1 lds
    v_mfma_f32_16x16x32_bf16 v[224:227], a[32:35], v[112:115], v[224:227]
    ds_read_b128 v[92:95], v250 offset:6400
    v_mfma_f32_16x16x32_bf16 v[224:227], a[40:43], v[116:119], v[224:227]
    ds_read_b128 v[96:99], v250 offset:512
    v_mfma_f32_16x16x32_bf16 v[228:231], a[44:47], v[116:119], v[228:231]
    ds_read_b128 v[100:103], v250 offset:6656
    buffer_load_dwordx4 v157, s[44:47], s13 offen offset:1024 sc1 lds
    s_mov_b32 s5, 3
    s_lshr_b64 s[4:5], s[4:5], s7
    s_and_b32 s4, s4, 15
    s_lshl4_add_u32 s4, s8, s4
    v_lshl_add_u32 v244, s4, 8, v245
    s_mul_i32 s7, s70, 6
    s_add_u32 s7, s7, 5
    s_mul_i32 s8, s7, 7282
    s_lshr_b32 s8, s8, 16
    s_mul_i32 s5, s8, 9
    s_sub_u32 s7, s7, s5
    s_lshl_b32 s7, s7, 2
    s_mov_b32 s4, 0xeca86420
    s_mov_b32 s5, 3
    s_lshr_b64 s[4:5], s[4:5], s7
    s_and_b32 s4, s4, 15
    s_lshl4_add_u32 s4, s8, s4
    v_lshl_add_u32 v245, s4, 8, v245
    s_xor_b32 s7, s75, 1
    s_lshl2_add_u32 s7, s7, s3
    s_mul_i32 s9, s7, 6144
    s_add_u32 s9, s9, 7077888
    s_lshl_b32 s7, s7, 7
    s_add_u32 s6, s7, 22822912
    s_lshl2_add_u32 s7, s75, s3
    s_mul_i32 s10, s7, 6144
    s_add_u32 s10, s10, 7077888
    s_lshl_b32 s7, s7, 7
    v_mfma_f32_16x16x32_bf16 v[228:231], a[36:39], v[112:115], v[228:231]
    v_mfma_f32_16x16x32_bf16 v[236:239], a[36:39], v[120:123], v[236:239]
    v_mfma_f32_16x16x32_bf16 v[236:239], a[44:47], v[124:127], v[236:239]
    buffer_load_dwordx4 v158, s[44:47], s13 offen offset:2048 sc1 lds
    v_mfma_f32_16x16x32_bf16 v[232:235], a[40:43], v[124:127], v[232:235]
    v_mfma_f32_16x16x32_bf16 v[232:235], a[32:35], v[120:123], v[232:235]
    s_waitcnt lgkmcnt(0)
    v_mfma_f32_16x16x32_bf16 v[192:195], a[48:51], v[80:83], v[192:195]
    s_add_u32 m0, s73, 32768
    s_mul_i32 s14, s27, 589824
    v_mfma_f32_16x16x32_bf16 v[192:195], a[56:59], v[84:87], v[192:195]
    ds_read_b128 v[104:107], v250 offset:768
    v_mfma_f32_16x16x32_bf16 v[196:199], a[60:63], v[84:87], v[196:199]
    ds_read_b128 v[108:111], v250 offset:6912
    buffer_load_dwordx4 v148, s[48:51], s14 offen offset:0 lds
    v_mfma_f32_16x16x32_bf16 v[196:199], a[52:55], v[80:83], v[196:199]
    ds_read_b128 v[112:115], v250 offset:1024
    v_mfma_f32_16x16x32_bf16 v[204:207], a[52:55], v[88:91], v[204:207]
    ds_read_b128 v[116:119], v250 offset:7168
    buffer_load_dwordx4 v149, s[48:51], s14 offen offset:1024 lds
    v_mfma_f32_16x16x32_bf16 v[204:207], a[60:63], v[92:95], v[204:207]
    ds_read_b128 v[120:123], v250 offset:1280
    v_mfma_f32_16x16x32_bf16 v[200:203], a[56:59], v[92:95], v[200:203]
    ds_read_b128 v[124:127], v250 offset:7424
    s_add_u32 s7, s7, 22822912
    v_mov_b32 v28, s7
    v_add_u32 v247, 3072, v246
    v_cmp_eq_u32 vcc, 0, v2
    v_mov_b32 v248, 0x40000000
    s_nop 0
    v_cndmask_b32 v248, v248, 0, vcc
    v_mov_b32 v249, s68
    v_and_b32 v129, 0xffff0000, v144
    v_lshlrev_b32 v128, 16, v144
    v_and_b32 v131, 0xffff0000, v145
    v_lshlrev_b32 v130, 16, v145
    v_and_b32 v133, 0xffff0000, v146
    v_lshlrev_b32 v132, 16, v146
    v_and_b32 v135, 0xffff0000, v147
    v_lshlrev_b32 v134, 16, v147
    s_mul_i32 s4, s70, 43691
    s_lshr_b32 s4, s4, 16
    s_mul_i32 s5, s70, 21846
    s_lshr_b32 s5, s5, 16
    s_mul_i32 s5, s5, 3
    s_sub_u32 s5, s70, s5
    v_mfma_f32_16x16x32_bf16 v[200:203], a[48:51], v[88:91], v[200:203]
    buffer_load_dwordx4 v150, s[48:51], s14 offen offset:2048 lds
    v_mfma_f32_16x16x32_bf16 v[208:211], a[48:51], v[96:99], v[208:211]
    v_mfma_f32_16x16x32_bf16 v[208:211], a[56:59], v[100:103], v[208:211]
    buffer_load_dwordx4 v151, s[48:51], s14 offen offset:3072 lds
    v_mfma_f32_16x16x32_bf16 v[212:215], a[60:63], v[100:103], v[212:215]
    v_mfma_f32_16x16x32_bf16 v[212:215], a[52:55], v[96:99], v[212:215]
    s_waitcnt lgkmcnt(0)
    v_mfma_f32_16x16x32_bf16 v[220:223], a[52:55], v[104:107], v[220:223]
    s_waitcnt vmcnt(17)
    s_barrier
    v_mfma_f32_16x16x32_bf16 v[220:223], a[60:63], v[108:111], v[220:223]
    ds_read_b128 v[80:83], v250 offset:12288
    s_add_u32 m0, s74, 36864
    s_mul_i32 s13, s27, 90112
    v_mfma_f32_16x16x32_bf16 v[216:219], a[56:59], v[108:111], v[216:219]
    ds_read_b128 v[84:87], v250 offset:18432
    v_mfma_f32_16x16x32_bf16 v[216:219], a[48:51], v[104:107], v[216:219]
    ds_read_b128 v[88:91], v250 offset:12544
    buffer_load_dwordx4 v156, s[44:47], s13 offen offset:0 sc1 lds
    v_mfma_f32_16x16x32_bf16 v[224:227], a[48:51], v[112:115], v[224:227]
    ds_read_b128 v[92:95], v250 offset:18688
    v_mfma_f32_16x16x32_bf16 v[224:227], a[56:59], v[116:119], v[224:227]
    ds_read_b128 v[96:99], v250 offset:12800
    v_mfma_f32_16x16x32_bf16 v[228:231], a[60:63], v[116:119], v[228:231]
    ds_read_b128 v[100:103], v250 offset:18944
    buffer_load_dwordx4 v157, s[44:47], s13 offen offset:1024 sc1 lds
    s_lshl2_add_u32 s4, s72, s4
    s_lshl_b32 s4, s4, 10
    s_mul_i32 s7, s72, 9
    s_sub_u32 s7, s69, s7
    s_lshl3_add_u32 s4, s7, s4
    s_add_u32 s4, s4, 12566528
    s_cmp_eq_u32 s5, 1
    s_cselect_b32 s7, 16, 8
    s_cmp_lg_u32 s5, 0
    s_cselect_b32 s5, 4, 0
    v_lshlrev_b32 v17, 7, v0
    v_add_u32 v17, s4, v17
    v_cmp_gt_u32 vcc, 8, v0
    v_mov_b32 v24, s5
    s_nop 0
    v_cndmask_b32 v24, 0, v24, vcc
    v_add_u32 v17, v17, v24
    v_cmp_gt_u32 vcc, s7, v0
    v_mov_b32 v24, 0x40000000
    s_nop 0
    v_cndmask_b32 v17, v24, v17, vcc
    s_bfe_u32 s4, s2, 0x20003
    s_lshl2_add_u32 s4, s72, s4
    s_lshl_b32 s4, s4, 3
    s_lshr_b32 s5, s2, 4
    v_mfma_f32_16x16x32_bf16 v[228:231], a[52:55], v[112:115], v[228:231]
    ds_read_b64_tr_b16 a[112:113], v152 offset:0
    v_mfma_f32_16x16x32_bf16 v[236:239], a[52:55], v[120:123], v[236:239]
    ds_read_b64_tr_b16 a[114:115], v152 offset:1024
    v_mfma_f32_16x16x32_bf16 v[236:239], a[60:63], v[124:127], v[236:239]
    buffer_load_dwordx4 v158, s[44:47], s13 offen offset:2048 sc1 lds
    v_mfma_f32_16x16x32_bf16 v[232:235], a[56:59], v[124:127], v[232:235]
    ds_read_b64_tr_b16 a[116:117], v153 offset:0
    v_mfma_f32_16x16x32_bf16 v[232:235], a[48:51], v[120:123], v[232:235]
    ds_read_b64_tr_b16 a[118:119], v153 offset:1024
    s_waitcnt lgkmcnt(4)
    v_mfma_f32_16x16x32_bf16 v[192:195], a[64:67], v[80:83], v[192:195]
    s_add_u32 m0, s73, 49152
    s_mul_i32 s14, s76, 589824
    v_mfma_f32_16x16x32_bf16 v[192:195], a[72:75], v[84:87], v[192:195]
    ds_read_b128 v[104:107], v250 offset:13056
    v_mfma_f32_16x16x32_bf16 v[196:199], a[76:79], v[84:87], v[196:199]
    ds_read_b128 v[108:111], v250 offset:19200
    buffer_load_dwordx4 v148, s[48:51], s14 offen offset:0 lds
    v_mfma_f32_16x16x32_bf16 v[196:199], a[68:71], v[80:83], v[196:199]
    ds_read_b128 v[112:115], v250 offset:13312
    v_mfma_f32_16x16x32_bf16 v[204:207], a[68:71], v[88:91], v[204:207]
    ds_read_b128 v[116:119], v250 offset:19456
    buffer_load_dwordx4 v149, s[48:51], s14 offen offset:1024 lds
    v_mfma_f32_16x16x32_bf16 v[204:207], a[76:79], v[92:95], v[204:207]
    ds_read_b128 v[120:123], v250 offset:13568
    v_mfma_f32_16x16x32_bf16 v[200:203], a[72:75], v[92:95], v[200:203]
    ds_read_b128 v[124:127], v250 offset:19712
    s_and_b32 s5, s5, 6
    s_add_u32 s4, s4, s5
    s_and_b32 s5, s2, 1
    s_add_u32 s4, s4, s5
    s_lshl_b32 s4, s4, 7
    s_add_u32 s4, s4, 12566528
    v_lshl_add_u32 v15, v2, 2, s4
L_pl_G_2:
    s_cbranch_execz L_pl_G_6
    s_cmp_eq_u32 s3, 0
    s_cselect_b32 s4, 18, 0
    v_cmp_gt_u32 vcc, s4, v2
    v_mov_b32 v13, 0x40000000
    s_nop 0
    v_cndmask_b32 v15, v13, v15, vcc
    v_mov_b32 v13, s68
    v_cndmask_b32 v13, 0, v13, vcc
    v_and_b32 v24, 15, v2
    v_lshrrev_b32 v25, 4, v2
    v_mul_u32_u24 v25, 17408, v25
    v_lshl_add_u32 v24, v24, 4, v25
    s_mul_i32 s7, s72, 36
    s_and_b32 s8, s3, 1
    v_mfma_f32_16x16x32_bf16 v[200:203], a[64:67], v[88:91], v[200:203]
    ds_read_b64_tr_b16 a[120:121], v152 offset:8192
    buffer_load_dwordx4 v150, s[48:51], s14 offen offset:2048 lds
    v_mfma_f32_16x16x32_bf16 v[208:211], a[64:67], v[96:99], v[208:211]
    ds_read_b64_tr_b16 a[122:123], v152 offset:9216
    v_mfma_f32_16x16x32_bf16 v[208:211], a[72:75], v[100:103], v[208:211]
    buffer_load_dwordx4 v151, s[48:51], s14 offen offset:3072 lds
    v_mfma_f32_16x16x32_bf16 v[212:215], a[76:79], v[100:103], v[212:215]
    ds_read_b64_tr_b16 a[124:125], v153 offset:8192
    v_mfma_f32_16x16x32_bf16 v[212:215], a[68:71], v[96:99], v[212:215]
    ds_read_b64_tr_b16 a[126:127], v153 offset:9216
    s_waitcnt lgkmcnt(4)
    v_mfma_f32_16x16x32_bf16 v[220:223], a[68:71], v[104:107], v[220:223]
    s_waitcnt vmcnt(14)
    s_barrier
    v_mfma_f32_16x16x32_bf16 v[220:223], a[76:79], v[108:111], v[220:223]
    ds_read_b128 v[80:83], v250 offset:24576
    s_add_u32 m0, s74, 49152
    s_mul_i32 s13, s76, 90112
    v_mfma_f32_16x16x32_bf16 v[216:219], a[72:75], v[108:111], v[216:219]
    ds_read_b128 v[84:87], v250 offset:30720
    v_mfma_f32_16x16x32_bf16 v[216:219], a[64:67], v[104:107], v[216:219]
    ds_read_b128 v[88:91], v250 offset:24832
    buffer_load_dwordx4 v156, s[44:47], s13 offen offset:0 sc1 lds
    v_mfma_f32_16x16x32_bf16 v[224:227], a[64:67], v[112:115], v[224:227]
    ds_read_b128 v[92:95], v250 offset:30976
    v_mfma_f32_16x16x32_bf16 v[224:227], a[72:75], v[116:119], v[224:227]
    ds_read_b128 v[96:99], v250 offset:25088
    v_mfma_f32_16x16x32_bf16 v[228:231], a[76:79], v[116:119], v[228:231]
    ds_read_b128 v[100:103], v250 offset:31232
    buffer_load_dwordx4 v157, s[44:47], s13 offen offset:1024 sc1 lds
    s_add_u32 s7, s7, s8
    s_mul_i32 s7, s7, 69632
    s_bfe_u32 s8, s2, 0x20003
    s_lshl_b32 s8, s8, 12
    s_add_u32 s7, s7, s8
    s_add_u32 s7, s7, 12795904
    v_add_u32 v23, s7, v24
    s_xor_b32 s7, s72, 0
    v_lshl_add_u32 v19, s7, 10, v23
    s_xor_b32 s7, s72, 1
    v_lshl_add_u32 v20, s7, 10, v23
    s_xor_b32 s7, s72, 2
    v_lshl_add_u32 v21, s7, 10, v23
    s_xor_b32 s7, s72, 3
    v_lshl_add_u32 v22, s7, 10, v23
    v_lshlrev_b32 v14, 4, v2
    v_add_u32 v14, 98304, v14
    v_mfma_f32_16x16x32_bf16 v[228:231], a[68:71], v[112:115], v[228:231]
    ds_read_b64_tr_b16 a[128:129], v152 offset:16384
    v_mfma_f32_16x16x32_bf16 v[236:239], a[68:71], v[120:123], v[236:239]
    ds_read_b64_tr_b16 a[130:131], v152 offset:17408
    v_mfma_f32_16x16x32_bf16 v[236:239], a[76:79], v[124:127], v[236:239]
    buffer_load_dwordx4 v158, s[44:47], s13 offen offset:2048 sc1 lds
    v_mfma_f32_16x16x32_bf16 v[232:235], a[72:75], v[124:127], v[232:235]
    ds_read_b64_tr_b16 a[132:133], v153 offset:16384
    v_mfma_f32_16x16x32_bf16 v[232:235], a[64:67], v[120:123], v[232:235]
    ds_read_b64_tr_b16 a[134:135], v153 offset:17408
    s_waitcnt lgkmcnt(4)
    v_mfma_f32_16x16x32_bf16 v[192:195], a[80:83], v[80:83], v[192:195]
    s_add_u32 m0, s73, 65536
    s_mul_i32 s14, s77, 589824
    v_mfma_f32_16x16x32_bf16 v[192:195], a[88:91], v[84:87], v[192:195]
    ds_read_b128 v[104:107], v250 offset:25344
    v_mfma_f32_16x16x32_bf16 v[196:199], a[92:95], v[84:87], v[196:199]
    ds_read_b128 v[108:111], v250 offset:31488
    buffer_load_dwordx4 v148, s[48:51], s14 offen offset:0 lds
    v_mfma_f32_16x16x32_bf16 v[196:199], a[84:87], v[80:83], v[196:199]
    ds_read_b128 v[112:115], v250 offset:25600
    v_mfma_f32_16x16x32_bf16 v[204:207], a[84:87], v[88:91], v[204:207]
    ds_read_b128 v[116:119], v250 offset:31744
    buffer_load_dwordx4 v149, s[48:51], s14 offen offset:1024 lds
    v_mfma_f32_16x16x32_bf16 v[204:207], a[92:95], v[92:95], v[204:207]
    ds_read_b128 v[120:123], v250 offset:25856
    v_mfma_f32_16x16x32_bf16 v[200:203], a[88:91], v[92:95], v[200:203]
    ds_read_b128 v[124:127], v250 offset:32000
    v_add_u32 v1, 0x10000, v14
    s_mov_b32 s56, s16
    s_and_b32 s57, s17, 0xffff
    s_mov_b32 s58, 2359296
    s_mov_b32 s59, 0x20000
    s_mov_b32 s40, 18432
    s_mov_b32 s42, 12386304
    s_mov_b32 s64, s38
    s_and_b32 s65, s39, 0xffff
    s_mov_b32 s66, 2359296
    s_mov_b32 s67, 0x20000
    v_lshlrev_b32 v136, 4, v2
    s_mul_i32 s7, s72, 36
    s_bitcmp1_b32 s3, 0
    s_addc_u32 s7, s7, 0
    s_lshl_b32 s7, s7, 17
    v_subrev_u32 v184, s7, v4
    v_subrev_u32 v185, s7, v5
    v_mfma_f32_16x16x32_bf16 v[200:203], a[80:83], v[88:91], v[200:203]
    ds_read_b64_tr_b16 a[136:137], v152 offset:24576
    buffer_load_dwordx4 v150, s[48:51], s14 offen offset:2048 lds
    v_mfma_f32_16x16x32_bf16 v[208:211], a[80:83], v[96:99], v[208:211]
    ds_read_b64_tr_b16 a[138:139], v152 offset:25600
    v_mfma_f32_16x16x32_bf16 v[208:211], a[88:91], v[100:103], v[208:211]
    buffer_load_dwordx4 v151, s[48:51], s14 offen offset:3072 lds
    v_mfma_f32_16x16x32_bf16 v[212:215], a[92:95], v[100:103], v[212:215]
    ds_read_b64_tr_b16 a[140:141], v153 offset:24576
    v_mfma_f32_16x16x32_bf16 v[212:215], a[84:87], v[96:99], v[212:215]
    ds_read_b64_tr_b16 a[142:143], v153 offset:25600
    s_waitcnt lgkmcnt(4)
    v_mfma_f32_16x16x32_bf16 v[220:223], a[84:87], v[104:107], v[220:223]
    s_waitcnt vmcnt(14)
    s_barrier
    v_mfma_f32_16x16x32_bf16 v[220:223], a[92:95], v[108:111], v[220:223]
    ds_read_b128 v[80:83], v159 offset:0
    s_add_u32 m0, s74, 61440
    s_mul_i32 s13, s77, 90112
    v_mfma_f32_16x16x32_bf16 v[216:219], a[88:91], v[108:111], v[216:219]
    ds_read_b128 v[84:87], v159 offset:6144
    v_mfma_f32_16x16x32_bf16 v[216:219], a[80:83], v[104:107], v[216:219]
    ds_read_b128 v[88:91], v159 offset:256
    buffer_load_dwordx4 v156, s[44:47], s13 offen offset:0 sc1 lds
    v_mfma_f32_16x16x32_bf16 v[224:227], a[80:83], v[112:115], v[224:227]
    ds_read_b128 v[92:95], v159 offset:6400
    v_mfma_f32_16x16x32_bf16 v[224:227], a[88:91], v[116:119], v[224:227]
    ds_read_b128 v[96:99], v159 offset:512
    v_mfma_f32_16x16x32_bf16 v[228:231], a[92:95], v[116:119], v[228:231]
    ds_read_b128 v[100:103], v159 offset:6656
    buffer_load_dwordx4 v157, s[44:47], s13 offen offset:1024 sc1 lds
    s_bfe_u32 s4, s2, 0x20003
    s_mul_i32 s4, s4, 9
    s_lshl1_add_u32 s7, s72, s4
    s_and_b32 s8, s3, 1
    s_add_u32 s7, s7, s8
    s_lshl_b32 s37, s7, 16
    s_add_u32 s37, s37, 4718592
    s_add_u32 s4, s4, 8
    s_lshl_b32 s16, s4, 16
    s_add_u32 s16, s16, 4718592
    s_sub_u32 s4, s4, s7
    s_lshl_b32 s4, s4, 7
    s_lshl_b32 s7, s7, 7
    s_add_u32 s7, s7, 12582912
    v_bfe_u32 v24, v2, 2, 1
    v_mfma_f32_16x16x32_bf16 v[228:231], a[84:87], v[112:115], v[228:231]
    ds_read_b64_tr_b16 a[144:145], v152 offset:32768
    v_mfma_f32_16x16x32_bf16 v[236:239], a[84:87], v[120:123], v[236:239]
    ds_read_b64_tr_b16 a[146:147], v152 offset:33792
    v_mfma_f32_16x16x32_bf16 v[236:239], a[92:95], v[124:127], v[236:239]
    buffer_load_dwordx4 v158, s[44:47], s13 offen offset:2048 sc1 lds
    v_mfma_f32_16x16x32_bf16 v[232:235], a[88:91], v[124:127], v[232:235]
    ds_read_b64_tr_b16 a[148:149], v153 offset:32768
    v_mfma_f32_16x16x32_bf16 v[232:235], a[80:83], v[120:123], v[232:235]
    ds_read_b64_tr_b16 a[150:151], v153 offset:33792
    s_waitcnt lgkmcnt(4)
    v_mfma_f32_16x16x32_bf16 v[192:195], a[96:99], v[80:83], v[192:195]
    s_add_u32 m0, s73, 0
    s_mul_i32 s14, s78, 589824
    v_mfma_f32_16x16x32_bf16 v[192:195], a[104:107], v[84:87], v[192:195]
    ds_read_b128 v[104:107], v159 offset:768
    v_mfma_f32_16x16x32_bf16 v[196:199], a[108:111], v[84:87], v[196:199]
    ds_read_b128 v[108:111], v159 offset:6912
    buffer_load_dwordx4 v148, s[48:51], s14 offen offset:0 lds
    v_mfma_f32_16x16x32_bf16 v[196:199], a[100:103], v[80:83], v[196:199]
    ds_read_b128 v[112:115], v159 offset:1024
    v_mfma_f32_16x16x32_bf16 v[204:207], a[100:103], v[88:91], v[204:207]
    ds_read_b128 v[116:119], v159 offset:7168
    buffer_load_dwordx4 v149, s[48:51], s14 offen offset:1024 lds
    v_mfma_f32_16x16x32_bf16 v[204:207], a[108:111], v[92:95], v[204:207]
    ds_read_b128 v[120:123], v159 offset:1280
    v_mfma_f32_16x16x32_bf16 v[200:203], a[104:107], v[92:95], v[200:203]
    ds_read_b128 v[124:127], v159 offset:7424
    v_mul_u32_u24 v24, s4, v24
    v_and_b32 v25, 3, v2
    v_lshl_add_u32 v24, v25, 2, v24
    v_add_u32 v188, s7, v24
    s_lshl2_add_u32 s7, s2, s3
    s_mul_i32 s8, s7, 3072
    s_add_u32 s34, s8, 22953984
    s_add_u32 s11, s8, 26099712
    s_add_u32 s12, s8, 29245440
    s_lshl_b32 s35, s7, 12
    s_add_u32 s35, s35, 32391168
    s_xor_b32 s8, s7, 8
    s_mul_i32 s8, s8, 3072
    s_add_u32 s30, s8, 22953984
    v_mfma_f32_16x16x32_bf16 v[200:203], a[96:99], v[88:91], v[200:203]
    ds_read_b64_tr_b16 a[152:153], v152 offset:40960
    buffer_load_dwordx4 v150, s[48:51], s14 offen offset:2048 lds
    v_mfma_f32_16x16x32_bf16 v[208:211], a[96:99], v[96:99], v[208:211]
    ds_read_b64_tr_b16 a[154:155], v152 offset:41984
    v_mfma_f32_16x16x32_bf16 v[208:211], a[104:107], v[100:103], v[208:211]
    buffer_load_dwordx4 v151, s[48:51], s14 offen offset:3072 lds
    v_mfma_f32_16x16x32_bf16 v[212:215], a[108:111], v[100:103], v[212:215]
    ds_read_b64_tr_b16 a[156:157], v153 offset:40960
    v_mfma_f32_16x16x32_bf16 v[212:215], a[100:103], v[96:99], v[212:215]
    ds_read_b64_tr_b16 a[158:159], v153 offset:41984
    s_waitcnt lgkmcnt(4)
    v_mfma_f32_16x16x32_bf16 v[220:223], a[100:103], v[104:107], v[220:223]
    s_waitcnt vmcnt(14)
    s_barrier
    v_mfma_f32_16x16x32_bf16 v[220:223], a[108:111], v[108:111], v[220:223]
    ds_read_b128 v[80:83], v159 offset:12288
    s_add_u32 m0, s74, 0
    s_mul_i32 s13, s78, 90112
    v_mfma_f32_16x16x32_bf16 v[216:219], a[104:107], v[108:111], v[216:219]
    ds_read_b128 v[84:87], v159 offset:18432
    v_mfma_f32_16x16x32_bf16 v[216:219], a[96:99], v[104:107], v[216:219]
    ds_read_b128 v[88:91], v159 offset:12544
    buffer_load_dwordx4 v156, s[44:47], s13 offen offset:0 sc1 lds
    v_mfma_f32_16x16x32_bf16 v[224:227], a[96:99], v[112:115], v[224:227]
    ds_read_b128 v[92:95], v159 offset:18688
    v_mfma_f32_16x16x32_bf16 v[224:227], a[104:107], v[116:119], v[224:227]
    ds_read_b128 v[96:99], v159 offset:12800
    v_mfma_f32_16x16x32_bf16 v[228:231], a[108:111], v[116:119], v[228:231]
    ds_read_b128 v[100:103], v159 offset:18944
    buffer_load_dwordx4 v157, s[44:47], s13 offen offset:1024 sc1 lds
    s_xor_b32 s8, s7, 16
    s_mul_i32 s8, s8, 3072
    s_add_u32 s15, s8, 26099712
    s_xor_b32 s8, s7, 24
    s_mul_i32 s8, s8, 3072
    s_add_u32 s31, s8, 29245440
    s_andn2_b32 s7, s7, 24
    s_lshl3_add_u32 s7, s3, s7
    s_lshl2_add_u32 s8, s7, s72
    s_lshl_b32 s8, s8, 10
    s_add_u32 s32, s8, 32391168
    s_xor_b32 s8, s8, 4096
    v_mfma_f32_16x16x32_bf16 v[228:231], a[100:103], v[112:115], v[228:231]
    ds_read_b64_tr_b16 a[160:161], v152 offset:49152
    v_mfma_f32_16x16x32_bf16 v[236:239], a[100:103], v[120:123], v[236:239]
    ds_read_b64_tr_b16 a[162:163], v152 offset:50176
    v_mfma_f32_16x16x32_bf16 v[236:239], a[108:111], v[124:127], v[236:239]
    buffer_load_dwordx4 v158, s[44:47], s13 offen offset:2048 sc1 lds
    v_mfma_f32_16x16x32_bf16 v[232:235], a[104:107], v[124:127], v[232:235]
    ds_read_b64_tr_b16 a[164:165], v153 offset:49152
    v_mfma_f32_16x16x32_bf16 v[232:235], a[96:99], v[120:123], v[232:235]
    ds_read_b64_tr_b16 a[166:167], v153 offset:50176
    s_waitcnt lgkmcnt(4)
    v_mfma_f32_16x16x32_bf16 v[192:195], a[112:115], v[80:83], v[192:195]
    s_add_u32 m0, s73, 16384
    s_mul_i32 s14, s79, 589824
    v_mfma_f32_16x16x32_bf16 v[192:195], a[120:123], v[84:87], v[192:195]
    ds_read_b128 v[104:107], v159 offset:13056
    v_mfma_f32_16x16x32_bf16 v[196:199], a[124:127], v[84:87], v[196:199]
    ds_read_b128 v[108:111], v159 offset:19200
    buffer_load_dwordx4 v148, s[48:51], s14 offen offset:0 lds
    v_mfma_f32_16x16x32_bf16 v[196:199], a[116:119], v[80:83], v[196:199]
    ds_read_b128 v[112:115], v159 offset:13312
    v_mfma_f32_16x16x32_bf16 v[204:207], a[116:119], v[88:91], v[204:207]
    ds_read_b128 v[116:119], v159 offset:19456
    buffer_load_dwordx4 v149, s[48:51], s14 offen offset:1024 lds
    v_mfma_f32_16x16x32_bf16 v[204:207], a[124:127], v[92:95], v[204:207]
    ds_read_b128 v[120:123], v159 offset:13568
    v_mfma_f32_16x16x32_bf16 v[200:203], a[120:123], v[92:95], v[200:203]
    ds_read_b128 v[124:127], v159 offset:19712
    s_add_u32 s33, s8, 32391168
    s_xor_b32 s8, s3, s72
    s_cmp_lt_u32 s8, 2
    s_cselect_b32 s35, s35, 0x40000000
    s_cselect_b32 s16, s16, 0x40000000
    s_cselect_b32 s36, s68, 0
    s_mov_b32 s38, 0xbfb8aa3b
    s_and_b32 s8, s8, 1
    s_mul_i32 s41, s8, 96
    s_and_b32 s43, s73, 4096
    v_lshlrev_b32 v24, 10, v2
    v_add_u32 v24, s35, v24
    s_add_u32 s7, s34, 2048
    v_mov_b32 v25, s36
    v_mfma_f32_16x16x32_bf16 v[200:203], a[112:115], v[88:91], v[200:203]
    ds_read_b64_tr_b16 a[168:169], v152 offset:57344
    buffer_load_dwordx4 v150, s[48:51], s14 offen offset:2048 lds
    v_mfma_f32_16x16x32_bf16 v[208:211], a[112:115], v[96:99], v[208:211]
    ds_read_b64_tr_b16 a[170:171], v152 offset:58368
    v_mfma_f32_16x16x32_bf16 v[208:211], a[120:123], v[100:103], v[208:211]
    buffer_load_dwordx4 v151, s[48:51], s14 offen offset:3072 lds
    v_mfma_f32_16x16x32_bf16 v[212:215], a[124:127], v[100:103], v[212:215]
    ds_read_b64_tr_b16 a[172:173], v153 offset:57344
    v_mfma_f32_16x16x32_bf16 v[212:215], a[116:119], v[96:99], v[212:215]
    ds_read_b64_tr_b16 a[174:175], v153 offset:58368
    s_waitcnt lgkmcnt(4)
    v_mfma_f32_16x16x32_bf16 v[220:223], a[116:119], v[104:107], v[220:223]
    s_waitcnt vmcnt(14)
    s_barrier
    v_mfma_f32_16x16x32_bf16 v[220:223], a[124:127], v[108:111], v[220:223]
    ds_read_b128 v[80:83], v159 offset:24576
    s_add_u32 m0, s74, 12288
    s_mul_i32 s13, s79, 90112
    v_mfma_f32_16x16x32_bf16 v[216:219], a[120:123], v[108:111], v[216:219]
    ds_read_b128 v[84:87], v159 offset:30720
    v_mfma_f32_16x16x32_bf16 v[216:219], a[112:115], v[104:107], v[216:219]
    ds_read_b128 v[88:91], v159 offset:24832
    buffer_load_dwordx4 v156, s[44:47], s13 offen offset:0 sc1 lds
    v_mfma_f32_16x16x32_bf16 v[224:227], a[112:115], v[112:115], v[224:227]
    ds_read_b128 v[92:95], v159 offset:30976
    v_mfma_f32_16x16x32_bf16 v[224:227], a[120:123], v[116:119], v[224:227]
    ds_read_b128 v[96:99], v159 offset:25088
    v_mfma_f32_16x16x32_bf16 v[228:231], a[124:127], v[116:119], v[228:231]
    ds_read_b128 v[100:103], v159 offset:31232
    buffer_load_dwordx4 v157, s[44:47], s13 offen offset:1024 sc1 lds
    v_cmp_gt_u32 vcc, 4, v2
    s_nop 1
    v_cndmask_b32 v138, 0, v25, vcc
    v_mov_b32 v25, 0x40000000
    v_cndmask_b32 v137, v25, v24, vcc
    v_writelane_b32 v137, s7, 4
    v_writelane_b32 v138, s68, 4
    v_min_u32 v139, 1, v2
    v_lshlrev_b32 v139, 30, v139
    v_mov_b32 v140, 0
    v_writelane_b32 v140, s68, 0
    v_mfma_f32_16x16x32_bf16 v[228:231], a[116:119], v[112:115], v[228:231]
    ds_read_b64_tr_b16 a[176:177], v154 offset:0
    v_mfma_f32_16x16x32_bf16 v[236:239], a[116:119], v[120:123], v[236:239]
    ds_read_b64_tr_b16 a[178:179], v154 offset:1024
    v_mfma_f32_16x16x32_bf16 v[236:239], a[124:127], v[124:127], v[236:239]
    buffer_load_dwordx4 v158, s[44:47], s13 offen offset:2048 sc1 lds
    v_mfma_f32_16x16x32_bf16 v[232:235], a[120:123], v[124:127], v[232:235]
    ds_read_b64_tr_b16 a[180:181], v155 offset:0
    v_mfma_f32_16x16x32_bf16 v[232:235], a[112:115], v[120:123], v[232:235]
    ds_read_b64_tr_b16 a[182:183], v155 offset:1024
    s_waitcnt lgkmcnt(4)
    v_mfma_f32_16x16x32_bf16 v[192:195], a[128:131], v[80:83], v[192:195]
    s_add_u32 m0, s73, 32768
    s_mul_i32 s14, s80, 589824
    v_mfma_f32_16x16x32_bf16 v[192:195], a[136:139], v[84:87], v[192:195]
    ds_read_b128 v[104:107], v159 offset:25344
    v_mfma_f32_16x16x32_bf16 v[196:199], a[140:143], v[84:87], v[196:199]
    ds_read_b128 v[108:111], v159 offset:31488
    buffer_load_dwordx4 v148, s[48:51], s14 offen offset:0 lds
    v_mfma_f32_16x16x32_bf16 v[196:199], a[132:135], v[80:83], v[196:199]
    ds_read_b128 v[112:115], v159 offset:25600
    v_mfma_f32_16x16x32_bf16 v[204:207], a[132:135], v[88:91], v[204:207]
    ds_read_b128 v[116:119], v159 offset:31744
    buffer_load_dwordx4 v149, s[48:51], s14 offen offset:1024 lds
    v_mfma_f32_16x16x32_bf16 v[204:207], a[140:143], v[92:95], v[204:207]
    ds_read_b128 v[120:123], v159 offset:25856
    v_mfma_f32_16x16x32_bf16 v[200:203], a[136:139], v[92:95], v[200:203]
    ds_read_b128 v[124:127], v159 offset:32000
    v_mfma_f32_16x16x32_bf16 v[200:203], a[128:131], v[88:91], v[200:203]
    ds_read_b64_tr_b16 a[184:185], v154 offset:8192
    buffer_load_dwordx4 v150, s[48:51], s14 offen offset:2048 lds
    v_mfma_f32_16x16x32_bf16 v[208:211], a[128:131], v[96:99], v[208:211]
    ds_read_b64_tr_b16 a[186:187], v154 offset:9216
    v_mfma_f32_16x16x32_bf16 v[208:211], a[136:139], v[100:103], v[208:211]
    buffer_load_dwordx4 v151, s[48:51], s14 offen offset:3072 lds
    v_mfma_f32_16x16x32_bf16 v[212:215], a[140:143], v[100:103], v[212:215]
    ds_read_b64_tr_b16 a[188:189], v155 offset:8192
    v_mfma_f32_16x16x32_bf16 v[212:215], a[132:135], v[96:99], v[212:215]
    ds_read_b64_tr_b16 a[190:191], v155 offset:9216
    s_waitcnt lgkmcnt(4)
    v_mfma_f32_16x16x32_bf16 v[220:223], a[132:135], v[104:107], v[220:223]
    s_waitcnt vmcnt(14)
    s_barrier
    v_mfma_f32_16x16x32_bf16 v[220:223], a[140:143], v[108:111], v[220:223]
    ds_read_b128 v[80:83], v250 offset:0
    s_add_u32 m0, s74, 24576
    s_mul_i32 s13, s80, 90112
    v_mfma_f32_16x16x32_bf16 v[216:219], a[136:139], v[108:111], v[216:219]
    ds_read_b128 v[84:87], v250 offset:6144
    v_mfma_f32_16x16x32_bf16 v[216:219], a[128:131], v[104:107], v[216:219]
    ds_read_b128 v[88:91], v250 offset:256
    buffer_load_dwordx4 v156, s[44:47], s13 offen offset:0 sc1 lds
    v_mfma_f32_16x16x32_bf16 v[224:227], a[128:131], v[112:115], v[224:227]
    ds_read_b128 v[92:95], v250 offset:6400
    v_mfma_f32_16x16x32_bf16 v[224:227], a[136:139], v[116:119], v[224:227]
    ds_read_b128 v[96:99], v250 offset:512
    v_mfma_f32_16x16x32_bf16 v[228:231], a[140:143], v[116:119], v[228:231]
    ds_read_b128 v[100:103], v250 offset:6656
    buffer_load_dwordx4 v157, s[44:47], s13 offen offset:1024 sc1 lds
    v_mfma_f32_16x16x32_bf16 v[228:231], a[132:135], v[112:115], v[228:231]
    ds_read_b64_tr_b16 a[192:193], v152 offset:0
    v_mfma_f32_16x16x32_bf16 v[236:239], a[132:135], v[120:123], v[236:239]
    ds_read_b64_tr_b16 a[194:195], v152 offset:1024
    v_mfma_f32_16x16x32_bf16 v[236:239], a[140:143], v[124:127], v[236:239]
    buffer_load_dwordx4 v158, s[44:47], s13 offen offset:2048 sc1 lds
    v_mfma_f32_16x16x32_bf16 v[232:235], a[136:139], v[124:127], v[232:235]
    ds_read_b64_tr_b16 a[196:197], v153 offset:0
    v_mfma_f32_16x16x32_bf16 v[232:235], a[128:131], v[120:123], v[232:235]
    ds_read_b64_tr_b16 a[198:199], v153 offset:1024
    s_waitcnt lgkmcnt(4)
    v_mfma_f32_16x16x32_bf16 v[192:195], a[144:147], v[80:83], v[192:195]
    s_add_u32 m0, s73, 49152
    s_mul_i32 s14, s81, 589824
    v_mfma_f32_16x16x32_bf16 v[192:195], a[152:155], v[84:87], v[192:195]
    ds_read_b128 v[104:107], v250 offset:768
    v_mfma_f32_16x16x32_bf16 v[196:199], a[156:159], v[84:87], v[196:199]
    ds_read_b128 v[108:111], v250 offset:6912
    buffer_load_dwordx4 v148, s[48:51], s14 offen offset:0 lds
    v_mfma_f32_16x16x32_bf16 v[196:199], a[148:151], v[80:83], v[196:199]
    ds_read_b128 v[112:115], v250 offset:1024
    v_mfma_f32_16x16x32_bf16 v[204:207], a[148:151], v[88:91], v[204:207]
    ds_read_b128 v[116:119], v250 offset:7168
    buffer_load_dwordx4 v149, s[48:51], s14 offen offset:1024 lds
    v_mfma_f32_16x16x32_bf16 v[204:207], a[156:159], v[92:95], v[204:207]
    ds_read_b128 v[120:123], v250 offset:1280
    v_mfma_f32_16x16x32_bf16 v[200:203], a[152:155], v[92:95], v[200:203]
    ds_read_b128 v[124:127], v250 offset:7424
    v_mfma_f32_16x16x32_bf16 v[200:203], a[144:147], v[88:91], v[200:203]
    ds_read_b64_tr_b16 a[200:201], v152 offset:8192
    buffer_load_dwordx4 v150, s[48:51], s14 offen offset:2048 lds
    v_mfma_f32_16x16x32_bf16 v[208:211], a[144:147], v[96:99], v[208:211]
    ds_read_b64_tr_b16 a[202:203], v152 offset:9216
    v_mfma_f32_16x16x32_bf16 v[208:211], a[152:155], v[100:103], v[208:211]
    buffer_load_dwordx4 v151, s[48:51], s14 offen offset:3072 lds
    v_mfma_f32_16x16x32_bf16 v[212:215], a[156:159], v[100:103], v[212:215]
    ds_read_b64_tr_b16 a[204:205], v153 offset:8192
    v_mfma_f32_16x16x32_bf16 v[212:215], a[148:151], v[96:99], v[212:215]
    ds_read_b64_tr_b16 a[206:207], v153 offset:9216
    s_waitcnt lgkmcnt(4)
    v_mfma_f32_16x16x32_bf16 v[220:223], a[148:151], v[104:107], v[220:223]
    s_waitcnt vmcnt(14)
    s_barrier
    v_mfma_f32_16x16x32_bf16 v[220:223], a[156:159], v[108:111], v[220:223]
    ds_read_b128 v[80:83], v250 offset:12288
    s_add_u32 m0, s74, 36864
    s_mul_i32 s13, s81, 90112
    v_mfma_f32_16x16x32_bf16 v[216:219], a[152:155], v[108:111], v[216:219]
    ds_read_b128 v[84:87], v250 offset:18432
    v_mfma_f32_16x16x32_bf16 v[216:219], a[144:147], v[104:107], v[216:219]
    ds_read_b128 v[88:91], v250 offset:12544
    buffer_load_dwordx4 v156, s[44:47], s13 offen offset:0 sc1 lds
    v_mfma_f32_16x16x32_bf16 v[224:227], a[144:147], v[112:115], v[224:227]
    ds_read_b128 v[92:95], v250 offset:18688
    v_mfma_f32_16x16x32_bf16 v[224:227], a[152:155], v[116:119], v[224:227]
    ds_read_b128 v[96:99], v250 offset:12800
    v_mfma_f32_16x16x32_bf16 v[228:231], a[156:159], v[116:119], v[228:231]
    ds_read_b128 v[100:103], v250 offset:18944
    buffer_load_dwordx4 v157, s[44:47], s13 offen offset:1024 sc1 lds
    v_mfma_f32_16x16x32_bf16 v[228:231], a[148:151], v[112:115], v[228:231]
    ds_read_b64_tr_b16 a[208:209], v152 offset:16384
    v_mfma_f32_16x16x32_bf16 v[236:239], a[148:151], v[120:123], v[236:239]
    ds_read_b64_tr_b16 a[210:211], v152 offset:17408
    v_mfma_f32_16x16x32_bf16 v[236:239], a[156:159], v[124:127], v[236:239]
    buffer_load_dwordx4 v158, s[44:47], s13 offen offset:2048 sc1 lds
    v_mfma_f32_16x16x32_bf16 v[232:235], a[152:155], v[124:127], v[232:235]
    ds_read_b64_tr_b16 a[212:213], v153 offset:16384
    v_mfma_f32_16x16x32_bf16 v[232:235], a[144:147], v[120:123], v[232:235]
    ds_read_b64_tr_b16 a[214:215], v153 offset:17408
    s_waitcnt lgkmcnt(4)
    v_mfma_f32_16x16x32_bf16 v[192:195], a[160:163], v[80:83], v[192:195]
    s_add_u32 m0, s73, 65536
    s_lshl_b32 s14, s84, 18
    v_mfma_f32_16x16x32_bf16 v[192:195], a[168:171], v[84:87], v[192:195]
    ds_read_b128 v[104:107], v250 offset:13056
    v_mfma_f32_16x16x32_bf16 v[196:199], a[172:175], v[84:87], v[196:199]
    ds_read_b128 v[108:111], v250 offset:19200
    buffer_load_dwordx4 v4, s[52:55], s14 offen offset:0 lds
    v_mfma_f32_16x16x32_bf16 v[196:199], a[164:167], v[80:83], v[196:199]
    ds_read_b128 v[112:115], v250 offset:13312
    v_mfma_f32_16x16x32_bf16 v[204:207], a[164:167], v[88:91], v[204:207]
    ds_read_b128 v[116:119], v250 offset:19456
    buffer_load_dwordx4 v5, s[52:55], s14 offen offset:1024 lds
    v_mfma_f32_16x16x32_bf16 v[204:207], a[172:175], v[92:95], v[204:207]
    ds_read_b128 v[120:123], v250 offset:13568
    v_mfma_f32_16x16x32_bf16 v[200:203], a[168:171], v[92:95], v[200:203]
    ds_read_b128 v[124:127], v250 offset:19712
    v_mfma_f32_16x16x32_bf16 v[200:203], a[160:163], v[88:91], v[200:203]
    ds_read_b64_tr_b16 a[216:217], v152 offset:24576
    buffer_load_dwordx4 v6, s[52:55], s14 offen offset:2048 lds
    v_mfma_f32_16x16x32_bf16 v[208:211], a[160:163], v[96:99], v[208:211]
    ds_read_b64_tr_b16 a[218:219], v152 offset:25600
    v_mfma_f32_16x16x32_bf16 v[208:211], a[168:171], v[100:103], v[208:211]
    buffer_load_dwordx4 v7, s[52:55], s14 offen offset:3072 lds
    v_mfma_f32_16x16x32_bf16 v[212:215], a[172:175], v[100:103], v[212:215]
    ds_read_b64_tr_b16 a[220:221], v153 offset:24576
    v_mfma_f32_16x16x32_bf16 v[212:215], a[164:167], v[96:99], v[212:215]
    ds_read_b64_tr_b16 a[222:223], v153 offset:25600
    s_waitcnt lgkmcnt(4)
    v_mfma_f32_16x16x32_bf16 v[220:223], a[164:167], v[104:107], v[220:223]
    s_waitcnt vmcnt(14)
    s_barrier
    v_mfma_f32_16x16x32_bf16 v[220:223], a[172:175], v[108:111], v[220:223]
    ds_read_b128 v[80:83], v250 offset:24576
    v_mfma_f32_16x16x32_bf16 v[216:219], a[168:171], v[108:111], v[216:219]
    ds_read_b128 v[84:87], v250 offset:30720
    v_mfma_f32_16x16x32_bf16 v[216:219], a[160:163], v[104:107], v[216:219]
    ds_read_b128 v[88:91], v250 offset:24832
    v_mfma_f32_16x16x32_bf16 v[224:227], a[160:163], v[112:115], v[224:227]
    ds_read_b128 v[92:95], v250 offset:30976
    v_mfma_f32_16x16x32_bf16 v[224:227], a[168:171], v[116:119], v[224:227]
    ds_read_b128 v[96:99], v250 offset:25088
    v_mfma_f32_16x16x32_bf16 v[228:231], a[172:175], v[116:119], v[228:231]
    ds_read_b128 v[100:103], v250 offset:31232
    v_mfma_f32_16x16x32_bf16 v[228:231], a[164:167], v[112:115], v[228:231]
    ds_read_b64_tr_b16 a[224:225], v152 offset:32768
    v_mfma_f32_16x16x32_bf16 v[236:239], a[164:167], v[120:123], v[236:239]
    ds_read_b64_tr_b16 a[226:227], v152 offset:33792
    v_mfma_f32_16x16x32_bf16 v[236:239], a[172:175], v[124:127], v[236:239]
    v_mfma_f32_16x16x32_bf16 v[232:235], a[168:171], v[124:127], v[232:235]
    ds_read_b64_tr_b16 a[228:229], v153 offset:32768
    v_mfma_f32_16x16x32_bf16 v[232:235], a[160:163], v[120:123], v[232:235]
    ds_read_b64_tr_b16 a[230:231], v153 offset:33792
    s_waitcnt lgkmcnt(4)
    v_mfma_f32_16x16x32_bf16 v[192:195], a[176:179], v[80:83], v[192:195]
    v_mfma_f32_16x16x32_bf16 v[192:195], a[184:187], v[84:87], v[192:195]
    ds_read_b128 v[104:107], v250 offset:25344
    v_mfma_f32_16x16x32_bf16 v[196:199], a[188:191], v[84:87], v[196:199]
    ds_read_b128 v[108:111], v250 offset:31488
    v_mfma_f32_16x16x32_bf16 v[196:199], a[180:183], v[80:83], v[196:199]
    ds_read_b128 v[112:115], v250 offset:25600
    v_mfma_f32_16x16x32_bf16 v[204:207], a[180:183], v[88:91], v[204:207]
    ds_read_b128 v[116:119], v250 offset:31744
    v_mfma_f32_16x16x32_bf16 v[204:207], a[188:191], v[92:95], v[204:207]
    ds_read_b128 v[120:123], v250 offset:25856
    v_mfma_f32_16x16x32_bf16 v[200:203], a[184:187], v[92:95], v[200:203]
    ds_read_b128 v[124:127], v250 offset:32000
    v_mfma_f32_16x16x32_bf16 v[200:203], a[176:179], v[88:91], v[200:203]
    ds_read_b64_tr_b16 a[232:233], v152 offset:40960
    v_mfma_f32_16x16x32_bf16 v[208:211], a[176:179], v[96:99], v[208:211]
    ds_read_b64_tr_b16 a[234:235], v152 offset:41984
    v_mfma_f32_16x16x32_bf16 v[208:211], a[184:187], v[100:103], v[208:211]
    v_mfma_f32_16x16x32_bf16 v[212:215], a[188:191], v[100:103], v[212:215]
    ds_read_b64_tr_b16 a[236:237], v153 offset:40960
    v_mfma_f32_16x16x32_bf16 v[212:215], a[180:183], v[96:99], v[212:215]
    ds_read_b64_tr_b16 a[238:239], v153 offset:41984
    s_waitcnt lgkmcnt(4)
    v_mfma_f32_16x16x32_bf16 v[220:223], a[180:183], v[104:107], v[220:223]
    s_waitcnt vmcnt(7)
    s_barrier
    v_mfma_f32_16x16x32_bf16 v[220:223], a[188:191], v[108:111], v[220:223]
    ds_read_b128 v[80:83], v159 offset:0
    v_mfma_f32_16x16x32_bf16 v[216:219], a[184:187], v[108:111], v[216:219]
    ds_read_b128 v[84:87], v159 offset:6144
    v_mfma_f32_16x16x32_bf16 v[216:219], a[176:179], v[104:107], v[216:219]
    ds_read_b128 v[88:91], v159 offset:256
    v_mfma_f32_16x16x32_bf16 v[224:227], a[176:179], v[112:115], v[224:227]
    ds_read_b128 v[92:95], v159 offset:6400
    v_mfma_f32_16x16x32_bf16 v[224:227], a[184:187], v[116:119], v[224:227]
    ds_read_b128 v[96:99], v159 offset:512
    v_mfma_f32_16x16x32_bf16 v[228:231], a[188:191], v[116:119], v[228:231]
    ds_read_b128 v[100:103], v159 offset:6656
    v_mfma_f32_16x16x32_bf16 v[228:231], a[180:183], v[112:115], v[228:231]
    ds_read_b64_tr_b16 a[240:241], v152 offset:49152
    v_mfma_f32_16x16x32_bf16 v[236:239], a[180:183], v[120:123], v[236:239]
    ds_read_b64_tr_b16 a[242:243], v152 offset:50176
    v_mfma_f32_16x16x32_bf16 v[236:239], a[188:191], v[124:127], v[236:239]
    v_mfma_f32_16x16x32_bf16 v[232:235], a[184:187], v[124:127], v[232:235]
    ds_read_b64_tr_b16 a[244:245], v153 offset:49152
    v_mfma_f32_16x16x32_bf16 v[232:235], a[176:179], v[120:123], v[232:235]
    ds_read_b64_tr_b16 a[246:247], v153 offset:50176
    s_waitcnt lgkmcnt(4)
    v_mfma_f32_16x16x32_bf16 v[192:195], a[192:195], v[80:83], v[192:195]
    v_mfma_f32_16x16x32_bf16 v[192:195], a[200:203], v[84:87], v[192:195]
    ds_read_b128 v[104:107], v159 offset:768
    v_mfma_f32_16x16x32_bf16 v[196:199], a[204:207], v[84:87], v[196:199]
    ds_read_b128 v[108:111], v159 offset:6912
    v_mfma_f32_16x16x32_bf16 v[196:199], a[196:199], v[80:83], v[196:199]
    ds_read_b128 v[112:115], v159 offset:1024
    v_mfma_f32_16x16x32_bf16 v[204:207], a[196:199], v[88:91], v[204:207]
    ds_read_b128 v[116:119], v159 offset:7168
    v_mfma_f32_16x16x32_bf16 v[204:207], a[204:207], v[92:95], v[204:207]
L_pl_G_3:
    s_cbranch_execz L_wret
    ds_read_b128 v[120:123], v159 offset:1280
    v_mfma_f32_16x16x32_bf16 v[200:203], a[200:203], v[92:95], v[200:203]
    ds_read_b128 v[124:127], v159 offset:7424
    v_mfma_f32_16x16x32_bf16 v[200:203], a[192:195], v[88:91], v[200:203]
    ds_read_b64_tr_b16 a[248:249], v152 offset:57344
    v_mfma_f32_16x16x32_bf16 v[208:211], a[192:195], v[96:99], v[208:211]
    ds_read_b64_tr_b16 a[250:251], v152 offset:58368
    v_mfma_f32_16x16x32_bf16 v[208:211], a[200:203], v[100:103], v[208:211]
    v_mfma_f32_16x16x32_bf16 v[212:215], a[204:207], v[100:103], v[212:215]
    ds_read_b64_tr_b16 a[252:253], v153 offset:57344
    v_mfma_f32_16x16x32_bf16 v[212:215], a[196:199], v[96:99], v[212:215]
    ds_read_b64_tr_b16 a[254:255], v153 offset:58368
    s_waitcnt lgkmcnt(4)
    v_mfma_f32_16x16x32_bf16 v[220:223], a[196:199], v[104:107], v[220:223]
    s_barrier
    v_mfma_f32_16x16x32_bf16 v[220:223], a[204:207], v[108:111], v[220:223]
    ds_read_b128 v[80:83], v159 offset:12288
    s_add_u32 m0, s74, 49152
    s_mul_i32 s13, s18, 90112
    v_mfma_f32_16x16x32_bf16 v[216:219], a[200:203], v[108:111], v[216:219]
    ds_read_b128 v[84:87], v159 offset:18432
    v_mfma_f32_16x16x32_bf16 v[216:219], a[192:195], v[104:107], v[216:219]
    ds_read_b128 v[88:91], v159 offset:12544
    buffer_load_dwordx4 v8, s[44:47], s13 offen offset:0 sc1 lds
    v_mfma_f32_16x16x32_bf16 v[224:227], a[192:195], v[112:115], v[224:227]
    ds_read_b128 v[92:95], v159 offset:18688
    v_mfma_f32_16x16x32_bf16 v[224:227], a[200:203], v[116:119], v[224:227]
    ds_read_b128 v[96:99], v159 offset:12800
    v_mfma_f32_16x16x32_bf16 v[228:231], a[204:207], v[116:119], v[228:231]
    ds_read_b128 v[100:103], v159 offset:18944
    buffer_load_dwordx4 v9, s[44:47], s13 offen offset:1024 sc1 lds
    v_mfma_f32_16x16x32_bf16 v[228:231], a[196:199], v[112:115], v[228:231]
    v_mfma_f32_16x16x32_bf16 v[236:239], a[196:199], v[120:123], v[236:239]
    v_mfma_f32_16x16x32_bf16 v[236:239], a[204:207], v[124:127], v[236:239]
    buffer_load_dwordx4 v3, s[44:47], s13 offen offset:2048 sc1 lds
    v_mfma_f32_16x16x32_bf16 v[232:235], a[200:203], v[124:127], v[232:235]
    v_mfma_f32_16x16x32_bf16 v[232:235], a[192:195], v[120:123], v[232:235]
    s_waitcnt lgkmcnt(0)
    v_mfma_f32_16x16x32_bf16 v[192:195], a[208:211], v[80:83], v[192:195]
    s_add_u32 m0, s74, 61440
    s_mul_i32 s13, s19, 90112
    v_mfma_f32_16x16x32_bf16 v[192:195], a[216:219], v[84:87], v[192:195]
    ds_read_b128 v[104:107], v159 offset:13056
    v_mfma_f32_16x16x32_bf16 v[196:199], a[220:223], v[84:87], v[196:199]
    ds_read_b128 v[108:111], v159 offset:19200
    v_mfma_f32_16x16x32_bf16 v[196:199], a[212:215], v[80:83], v[196:199]
    ds_read_b128 v[112:115], v159 offset:13312
    buffer_load_dwordx4 v8, s[44:47], s13 offen offset:0 sc1 lds
    v_mfma_f32_16x16x32_bf16 v[204:207], a[212:215], v[88:91], v[204:207]
    ds_read_b128 v[116:119], v159 offset:19456
    v_mfma_f32_16x16x32_bf16 v[204:207], a[220:223], v[92:95], v[204:207]
    ds_read_b128 v[120:123], v159 offset:13568
    v_mfma_f32_16x16x32_bf16 v[200:203], a[216:219], v[92:95], v[200:203]
    ds_read_b128 v[124:127], v159 offset:19712
    buffer_load_dwordx4 v9, s[44:47], s13 offen offset:1024 sc1 lds
    v_mfma_f32_16x16x32_bf16 v[200:203], a[208:211], v[88:91], v[200:203]
    v_mfma_f32_16x16x32_bf16 v[208:211], a[208:211], v[96:99], v[208:211]
    v_mfma_f32_16x16x32_bf16 v[208:211], a[216:219], v[100:103], v[208:211]
    buffer_load_dwordx4 v3, s[44:47], s13 offen offset:2048 sc1 lds
    v_mfma_f32_16x16x32_bf16 v[212:215], a[220:223], v[100:103], v[212:215]
    v_mfma_f32_16x16x32_bf16 v[212:215], a[212:215], v[96:99], v[212:215]
    s_waitcnt lgkmcnt(0)
    v_mfma_f32_16x16x32_bf16 v[220:223], a[212:215], v[104:107], v[220:223]
    s_barrier
    v_mfma_f32_16x16x32_bf16 v[220:223], a[220:223], v[108:111], v[220:223]
    ds_read_b128 v[80:83], v159 offset:24576
    s_add_u32 m0, s74, 0
    s_mul_i32 s13, s20, 90112
    v_mfma_f32_16x16x32_bf16 v[216:219], a[216:219], v[108:111], v[216:219]
    ds_read_b128 v[84:87], v159 offset:30720
    v_mfma_f32_16x16x32_bf16 v[216:219], a[208:211], v[104:107], v[216:219]
    ds_read_b128 v[88:91], v159 offset:24832
    buffer_load_dwordx4 v8, s[44:47], s13 offen offset:0 sc1 lds
    v_mfma_f32_16x16x32_bf16 v[224:227], a[208:211], v[112:115], v[224:227]
    ds_read_b128 v[92:95], v159 offset:30976
    v_mfma_f32_16x16x32_bf16 v[224:227], a[216:219], v[116:119], v[224:227]
    ds_read_b128 v[96:99], v159 offset:25088
    v_mfma_f32_16x16x32_bf16 v[228:231], a[220:223], v[116:119], v[228:231]
    ds_read_b128 v[100:103], v159 offset:31232
    buffer_load_dwordx4 v9, s[44:47], s13 offen offset:1024 sc1 lds
    v_mfma_f32_16x16x32_bf16 v[228:231], a[212:215], v[112:115], v[228:231]
    v_mfma_f32_16x16x32_bf16 v[236:239], a[212:215], v[120:123], v[236:239]
    v_mfma_f32_16x16x32_bf16 v[236:239], a[220:223], v[124:127], v[236:239]
    buffer_load_dwordx4 v3, s[44:47], s13 offen offset:2048 sc1 lds
    v_mfma_f32_16x16x32_bf16 v[232:235], a[216:219], v[124:127], v[232:235]
    v_mfma_f32_16x16x32_bf16 v[232:235], a[208:211], v[120:123], v[232:235]
    s_waitcnt lgkmcnt(0)
    v_mfma_f32_16x16x32_bf16 v[192:195], a[224:227], v[80:83], v[192:195]
    s_add_u32 m0, s74, 12288
    s_mul_i32 s13, s21, 90112
    v_mfma_f32_16x16x32_bf16 v[192:195], a[232:235], v[84:87], v[192:195]
    ds_read_b128 v[104:107], v159 offset:25344
    v_mfma_f32_16x16x32_bf16 v[196:199], a[236:239], v[84:87], v[196:199]
    ds_read_b128 v[108:111], v159 offset:31488
    v_mfma_f32_16x16x32_bf16 v[196:199], a[228:231], v[80:83], v[196:199]
    ds_read_b128 v[112:115], v159 offset:25600
    buffer_load_dwordx4 v8, s[44:47], s13 offen offset:0 sc1 lds
    v_mfma_f32_16x16x32_bf16 v[204:207], a[228:231], v[88:91], v[204:207]
    ds_read_b128 v[116:119], v159 offset:31744
    v_mfma_f32_16x16x32_bf16 v[204:207], a[236:239], v[92:95], v[204:207]
    ds_read_b128 v[120:123], v159 offset:25856
    v_mfma_f32_16x16x32_bf16 v[200:203], a[232:235], v[92:95], v[200:203]
    ds_read_b128 v[124:127], v159 offset:32000
    buffer_load_dwordx4 v9, s[44:47], s13 offen offset:1024 sc1 lds
    v_mfma_f32_16x16x32_bf16 v[200:203], a[224:227], v[88:91], v[200:203]
    v_mfma_f32_16x16x32_bf16 v[208:211], a[224:227], v[96:99], v[208:211]
    v_mfma_f32_16x16x32_bf16 v[208:211], a[232:235], v[100:103], v[208:211]
    buffer_load_dwordx4 v3, s[44:47], s13 offen offset:2048 sc1 lds
    v_mfma_f32_16x16x32_bf16 v[212:215], a[236:239], v[100:103], v[212:215]
    v_mfma_f32_16x16x32_bf16 v[212:215], a[228:231], v[96:99], v[212:215]
    s_waitcnt lgkmcnt(0)
    v_mfma_f32_16x16x32_bf16 v[220:223], a[228:231], v[104:107], v[220:223]
    s_waitcnt vmcnt(16)
    s_barrier
    v_mfma_f32_16x16x32_bf16 v[220:223], a[236:239], v[108:111], v[220:223]
    ds_read_b128 v[80:83], v250 offset:0
    s_add_u32 m0, s74, 24576
    s_mul_i32 s13, s22, 90112
    v_mfma_f32_16x16x32_bf16 v[216:219], a[232:235], v[108:111], v[216:219]
    ds_read_b128 v[84:87], v250 offset:6144
    v_mfma_f32_16x16x32_bf16 v[216:219], a[224:227], v[104:107], v[216:219]
    ds_read_b128 v[88:91], v250 offset:256
    buffer_load_dwordx4 v8, s[44:47], s13 offen offset:0 sc1 lds
    v_mfma_f32_16x16x32_bf16 v[224:227], a[224:227], v[112:115], v[224:227]
    ds_read_b128 v[92:95], v250 offset:6400
    v_mfma_f32_16x16x32_bf16 v[224:227], a[232:235], v[116:119], v[224:227]
    ds_read_b128 v[96:99], v250 offset:512
    v_mfma_f32_16x16x32_bf16 v[228:231], a[236:239], v[116:119], v[228:231]
    ds_read_b128 v[100:103], v250 offset:6656
    buffer_load_dwordx4 v9, s[44:47], s13 offen offset:1024 sc1 lds
    v_mfma_f32_16x16x32_bf16 v[228:231], a[228:231], v[112:115], v[228:231]
    v_mfma_f32_16x16x32_bf16 v[236:239], a[228:231], v[120:123], v[236:239]
    v_mfma_f32_16x16x32_bf16 v[236:239], a[236:239], v[124:127], v[236:239]
    buffer_load_dwordx4 v3, s[44:47], s13 offen offset:2048 sc1 lds
    v_mfma_f32_16x16x32_bf16 v[232:235], a[232:235], v[124:127], v[232:235]
    v_mfma_f32_16x16x32_bf16 v[232:235], a[224:227], v[120:123], v[232:235]
    s_waitcnt lgkmcnt(0)
    v_mfma_f32_16x16x32_bf16 v[192:195], a[240:243], v[80:83], v[192:195]
    s_add_u32 m0, s73, 0
    s_lshl_b32 s14, s85, 18
    v_mfma_f32_16x16x32_bf16 v[192:195], a[248:251], v[84:87], v[192:195]
    ds_read_b128 v[104:107], v250 offset:768
    v_mfma_f32_16x16x32_bf16 v[196:199], a[252:255], v[84:87], v[196:199]
    ds_read_b128 v[108:111], v250 offset:6912
    buffer_load_dwordx4 v4, s[52:55], s14 offen offset:0 lds
    v_mfma_f32_16x16x32_bf16 v[196:199], a[244:247], v[80:83], v[196:199]
    ds_read_b128 v[112:115], v250 offset:1024
    v_mfma_f32_16x16x32_bf16 v[204:207], a[244:247], v[88:91], v[204:207]
    ds_read_b128 v[116:119], v250 offset:7168
    buffer_load_dwordx4 v5, s[52:55], s14 offen offset:1024 lds
    v_mfma_f32_16x16x32_bf16 v[204:207], a[252:255], v[92:95], v[204:207]
    ds_read_b128 v[120:123], v250 offset:1280
    v_mfma_f32_16x16x32_bf16 v[200:203], a[248:251], v[92:95], v[200:203]
    ds_read_b128 v[124:127], v250 offset:7424
    v_mfma_f32_16x16x32_bf16 v[200:203], a[240:243], v[88:91], v[200:203]
    buffer_load_dwordx4 v6, s[52:55], s14 offen offset:2048 lds
    v_mfma_f32_16x16x32_bf16 v[208:211], a[240:243], v[96:99], v[208:211]
    v_mfma_f32_16x16x32_bf16 v[208:211], a[248:251], v[100:103], v[208:211]
    buffer_load_dwordx4 v7, s[52:55], s14 offen offset:3072 lds
    v_mfma_f32_16x16x32_bf16 v[212:215], a[252:255], v[100:103], v[212:215]
    v_mfma_f32_16x16x32_bf16 v[212:215], a[244:247], v[96:99], v[212:215]
    s_waitcnt lgkmcnt(0)
    v_mfma_f32_16x16x32_bf16 v[220:223], a[244:247], v[104:107], v[220:223]
    s_waitcnt vmcnt(16)
    s_barrier
    v_mfma_f32_16x16x32_bf16 v[220:223], a[252:255], v[108:111], v[220:223]
    ds_read_b128 v[80:83], v250 offset:12288
    v_mfma_f32_16x16x32_bf16 v[216:219], a[248:251], v[108:111], v[216:219]
    ds_read_b128 v[84:87], v250 offset:18432
    v_mfma_f32_16x16x32_bf16 v[216:219], a[240:243], v[104:107], v[216:219]
    ds_read_b128 v[88:91], v250 offset:12544
    v_mfma_f32_16x16x32_bf16 v[224:227], a[240:243], v[112:115], v[224:227]
    ds_read_b128 v[92:95], v250 offset:18688
    v_cvt_pk_bf16_f32 v192, v192, v193
    v_mfma_f32_16x16x32_bf16 v[224:227], a[248:251], v[116:119], v[224:227]
    ds_read_b128 v[96:99], v250 offset:12800
    v_mfma_f32_16x16x32_bf16 v[228:231], a[252:255], v[116:119], v[228:231]
    ds_read_b128 v[100:103], v250 offset:18944
    v_cvt_pk_bf16_f32 v193, v194, v195
    v_mfma_f32_16x16x32_bf16 v[228:231], a[244:247], v[112:115], v[228:231]
    v_mfma_f32_16x16x32_bf16 v[236:239], a[244:247], v[120:123], v[236:239]
    v_cvt_pk_bf16_f32 v194, v196, v197
    v_mfma_f32_16x16x32_bf16 v[236:239], a[252:255], v[124:127], v[236:239]
    v_cvt_pk_bf16_f32 v195, v198, v199
    v_mfma_f32_16x16x32_bf16 v[232:235], a[248:251], v[124:127], v[232:235]
    v_mfma_f32_16x16x32_bf16 v[232:235], a[240:243], v[120:123], v[232:235]
    buffer_store_dwordx4 v[192:195], v246, s[44:47], s9 offen offset:0 sc1
    s_waitcnt lgkmcnt(0)
    v_mfma_f32_16x16x32_bf16 v[32:35], a[0:3], v[80:83], v[128:131]
    v_mfma_f32_16x16x32_bf16 v[32:35], a[8:11], v[84:87], v[32:35]
    ds_read_b128 v[104:107], v250 offset:13056
    v_mfma_f32_16x16x32_bf16 v[36:39], a[12:15], v[84:87], v[132:135]
    ds_read_b128 v[108:111], v250 offset:19200
    v_mfma_f32_16x16x32_bf16 v[36:39], a[4:7], v[80:83], v[36:39]
    ds_read_b128 v[112:115], v250 offset:13312
    v_mfma_f32_16x16x32_bf16 v[44:47], a[4:7], v[88:91], v[132:135]
    ds_read_b128 v[116:119], v250 offset:19456
    v_cvt_pk_bf16_f32 v200, v200, v201
    v_mfma_f32_16x16x32_bf16 v[44:47], a[12:15], v[92:95], v[44:47]
    ds_read_b128 v[120:123], v250 offset:13568
    v_mfma_f32_16x16x32_bf16 v[40:43], a[8:11], v[92:95], v[128:131]
    ds_read_b128 v[124:127], v250 offset:19712
    v_cvt_pk_bf16_f32 v201, v202, v203
    v_mfma_f32_16x16x32_bf16 v[40:43], a[0:3], v[88:91], v[40:43]
    v_mfma_f32_16x16x32_bf16 v[48:51], a[0:3], v[96:99], v[128:131]
    v_cvt_pk_bf16_f32 v202, v204, v205
    v_mfma_f32_16x16x32_bf16 v[48:51], a[8:11], v[100:103], v[48:51]
    v_cvt_pk_bf16_f32 v203, v206, v207
    v_mfma_f32_16x16x32_bf16 v[52:55], a[12:15], v[100:103], v[132:135]
    v_mfma_f32_16x16x32_bf16 v[52:55], a[4:7], v[96:99], v[52:55]
    buffer_store_dwordx4 v[200:203], v246, s[44:47], s9 offen offset:1024 sc1
    s_waitcnt lgkmcnt(0)
    v_mfma_f32_16x16x32_bf16 v[60:63], a[4:7], v[104:107], v[132:135]
    s_waitcnt vmcnt(15)
    s_barrier
    v_mfma_f32_16x16x32_bf16 v[60:63], a[12:15], v[108:111], v[60:63]
    ds_read_b128 v[80:83], v250 offset:24576
    v_cvt_pk_bf16_f32 v208, v208, v209
    v_mfma_f32_16x16x32_bf16 v[56:59], a[8:11], v[108:111], v[128:131]
    ds_read_b128 v[84:87], v250 offset:30720
    v_mfma_f32_16x16x32_bf16 v[56:59], a[0:3], v[104:107], v[56:59]
    ds_read_b128 v[88:91], v250 offset:24832
    v_cvt_pk_bf16_f32 v209, v210, v211
    v_mfma_f32_16x16x32_bf16 v[64:67], a[0:3], v[112:115], v[128:131]
    ds_read_b128 v[92:95], v250 offset:30976
    v_mfma_f32_16x16x32_bf16 v[64:67], a[8:11], v[116:119], v[64:67]
    ds_read_b128 v[96:99], v250 offset:25088
    v_mfma_f32_16x16x32_bf16 v[68:71], a[12:15], v[116:119], v[132:135]
    ds_read_b128 v[100:103], v250 offset:31232
    v_cvt_pk_bf16_f32 v210, v212, v213
    v_mfma_f32_16x16x32_bf16 v[68:71], a[4:7], v[112:115], v[68:71]
    v_mfma_f32_16x16x32_bf16 v[76:79], a[4:7], v[120:123], v[132:135]
    v_cvt_pk_bf16_f32 v211, v214, v215
    v_mfma_f32_16x16x32_bf16 v[76:79], a[12:15], v[124:127], v[76:79]
    v_mfma_f32_16x16x32_bf16 v[72:75], a[8:11], v[124:127], v[128:131]
    buffer_store_dwordx4 v[208:211], v246, s[44:47], s9 offen offset:2048 sc1
    v_mfma_f32_16x16x32_bf16 v[72:75], a[0:3], v[120:123], v[72:75]
    s_waitcnt lgkmcnt(0)
    v_mfma_f32_16x16x32_bf16 v[32:35], a[16:19], v[80:83], v[32:35]
    v_mfma_f32_16x16x32_bf16 v[32:35], a[24:27], v[84:87], v[32:35]
    ds_read_b128 v[104:107], v250 offset:25344
    v_cvt_pk_bf16_f32 v216, v216, v217
    v_mfma_f32_16x16x32_bf16 v[36:39], a[28:31], v[84:87], v[36:39]
    ds_read_b128 v[108:111], v250 offset:31488
    v_mfma_f32_16x16x32_bf16 v[36:39], a[20:23], v[80:83], v[36:39]
    ds_read_b128 v[112:115], v250 offset:25600
    v_cvt_pk_bf16_f32 v217, v218, v219
    v_mfma_f32_16x16x32_bf16 v[44:47], a[20:23], v[88:91], v[44:47]
    ds_read_b128 v[116:119], v250 offset:31744
    v_mfma_f32_16x16x32_bf16 v[44:47], a[28:31], v[92:95], v[44:47]
    ds_read_b128 v[120:123], v250 offset:25856
    v_mfma_f32_16x16x32_bf16 v[40:43], a[24:27], v[92:95], v[40:43]
    ds_read_b128 v[124:127], v250 offset:32000
    v_cvt_pk_bf16_f32 v218, v220, v221
    v_mfma_f32_16x16x32_bf16 v[40:43], a[16:19], v[88:91], v[40:43]
    v_mfma_f32_16x16x32_bf16 v[48:51], a[16:19], v[96:99], v[48:51]
    v_cvt_pk_bf16_f32 v219, v222, v223
    v_mfma_f32_16x16x32_bf16 v[48:51], a[24:27], v[100:103], v[48:51]
    v_mfma_f32_16x16x32_bf16 v[52:55], a[28:31], v[100:103], v[52:55]
    buffer_store_dwordx4 v[216:219], v247, s[44:47], s9 offen offset:0 sc1
    v_mfma_f32_16x16x32_bf16 v[52:55], a[20:23], v[96:99], v[52:55]
    s_waitcnt lgkmcnt(0)
    v_mfma_f32_16x16x32_bf16 v[60:63], a[20:23], v[104:107], v[60:63]
    s_waitcnt vmcnt(14)
    s_barrier
    v_cvt_pk_bf16_f32 v224, v224, v225
    v_mfma_f32_16x16x32_bf16 v[60:63], a[28:31], v[108:111], v[60:63]
    ds_read_b128 v[80:83], v159 offset:0
    s_add_u32 m0, s74, 36864
    s_mul_i32 s13, s23, 90112
    v_mfma_f32_16x16x32_bf16 v[56:59], a[24:27], v[108:111], v[56:59]
    ds_read_b128 v[84:87], v159 offset:6144
    v_mfma_f32_16x16x32_bf16 v[56:59], a[16:19], v[104:107], v[56:59]
    ds_read_b128 v[88:91], v159 offset:256
    buffer_load_dwordx4 v8, s[44:47], s13 offen offset:0 sc1 lds
    v_mfma_f32_16x16x32_bf16 v[64:67], a[16:19], v[112:115], v[64:67]
    ds_read_b128 v[92:95], v159 offset:6400
    v_cvt_pk_bf16_f32 v225, v226, v227
    v_mfma_f32_16x16x32_bf16 v[64:67], a[24:27], v[116:119], v[64:67]
    ds_read_b128 v[96:99], v159 offset:512
    v_cvt_pk_bf16_f32 v226, v228, v229
    v_mfma_f32_16x16x32_bf16 v[68:71], a[28:31], v[116:119], v[68:71]
    ds_read_b128 v[100:103], v159 offset:6656
    buffer_load_dwordx4 v9, s[44:47], s13 offen offset:1024 sc1 lds
    v_mfma_f32_16x16x32_bf16 v[68:71], a[20:23], v[112:115], v[68:71]
    v_add_u32 v10, 65536, v10
    v_mfma_f32_16x16x32_bf16 v[76:79], a[20:23], v[120:123], v[76:79]
    ds_read_b64_tr_b16 a[0:1], v10 offset:0
    v_cvt_pk_bf16_f32 v227, v230, v231
    v_mfma_f32_16x16x32_bf16 v[76:79], a[28:31], v[124:127], v[76:79]
    ds_read_b64_tr_b16 a[2:3], v10 offset:2048
    buffer_load_dwordx4 v3, s[44:47], s13 offen offset:2048 sc1 lds
    v_mfma_f32_16x16x32_bf16 v[72:75], a[24:27], v[124:127], v[72:75]
    buffer_store_dwordx4 v[224:227], v247, s[44:47], s9 offen offset:1024 sc1
    ds_read_b64_tr_b16 a[8:9], v10 offset:4096
    v_mfma_f32_16x16x32_bf16 v[72:75], a[16:19], v[120:123], v[72:75]
    ds_read_b64_tr_b16 a[10:11], v10 offset:6144
    s_waitcnt lgkmcnt(4)
    v_mfma_f32_16x16x32_bf16 v[32:35], a[32:35], v[80:83], v[32:35]
    s_add_u32 m0, s74, 49152
    s_mul_i32 s13, s24, 90112
    v_mfma_f32_16x16x32_bf16 v[32:35], a[40:43], v[84:87], v[32:35]
    ds_read_b128 v[104:107], v159 offset:768
    v_cvt_pk_bf16_f32 v232, v232, v233
    v_mfma_f32_16x16x32_bf16 v[36:39], a[44:47], v[84:87], v[36:39]
    ds_read_b128 v[108:111], v159 offset:6912
    v_mfma_f32_16x16x32_bf16 v[36:39], a[36:39], v[80:83], v[36:39]
    ds_read_b128 v[112:115], v159 offset:1024
    buffer_load_dwordx4 v8, s[44:47], s13 offen offset:0 sc1 lds
    v_mfma_f32_16x16x32_bf16 v[44:47], a[36:39], v[88:91], v[44:47]
    ds_read_b128 v[116:119], v159 offset:7168
    v_cvt_pk_bf16_f32 v233, v234, v235
    v_mfma_f32_16x16x32_bf16 v[44:47], a[44:47], v[92:95], v[44:47]
    ds_read_b128 v[120:123], v159 offset:1280
    v_cvt_pk_bf16_f32 v234, v236, v237
    v_mfma_f32_16x16x32_bf16 v[40:43], a[40:43], v[92:95], v[40:43]
    ds_read_b128 v[124:127], v159 offset:7424
    buffer_load_dwordx4 v9, s[44:47], s13 offen offset:1024 sc1 lds
    v_mfma_f32_16x16x32_bf16 v[40:43], a[32:35], v[88:91], v[40:43]
    v_add_u32 v11, 65536, v11
    v_mfma_f32_16x16x32_bf16 v[48:51], a[32:35], v[96:99], v[48:51]
    ds_read_b64_tr_b16 a[4:5], v11 offset:0
    v_cvt_pk_bf16_f32 v235, v238, v239
    v_mfma_f32_16x16x32_bf16 v[48:51], a[40:43], v[100:103], v[48:51]
    ds_read_b64_tr_b16 a[6:7], v11 offset:2048
    buffer_load_dwordx4 v3, s[44:47], s13 offen offset:2048 sc1 lds
    v_mfma_f32_16x16x32_bf16 v[52:55], a[44:47], v[100:103], v[52:55]
    buffer_store_dwordx4 v[232:235], v247, s[44:47], s9 offen offset:2048 sc1
    ds_read_b64_tr_b16 a[12:13], v11 offset:4096
    v_mfma_f32_16x16x32_bf16 v[52:55], a[36:39], v[96:99], v[52:55]
    ds_read_b64_tr_b16 a[14:15], v11 offset:6144
    s_waitcnt lgkmcnt(4)
    v_mfma_f32_16x16x32_bf16 v[60:63], a[36:39], v[104:107], v[60:63]
    s_waitcnt vmcnt(19)
    s_barrier
    v_mfma_f32_16x16x32_bf16 v[60:63], a[44:47], v[108:111], v[60:63]
    ds_read_b128 v[80:83], v159 offset:12288
    s_add_u32 m0, s74, 61440
    s_mul_i32 s13, s25, 90112
    v_mfma_f32_16x16x32_bf16 v[56:59], a[40:43], v[108:111], v[56:59]
    ds_read_b128 v[84:87], v159 offset:18432
    v_mfma_f32_16x16x32_bf16 v[56:59], a[32:35], v[104:107], v[56:59]
    ds_read_b128 v[88:91], v159 offset:12544
    buffer_load_dwordx4 v8, s[44:47], s13 offen offset:0 sc1 lds
    v_mfma_f32_16x16x32_bf16 v[64:67], a[32:35], v[112:115], v[64:67]
    ds_read_b128 v[92:95], v159 offset:18688
    v_mfma_f32_16x16x32_bf16 v[64:67], a[40:43], v[116:119], v[64:67]
    ds_read_b128 v[96:99], v159 offset:12800
    v_mfma_f32_16x16x32_bf16 v[68:71], a[44:47], v[116:119], v[68:71]
    ds_read_b128 v[100:103], v159 offset:18944
    buffer_load_dwordx4 v9, s[44:47], s13 offen offset:1024 sc1 lds
    v_mfma_f32_16x16x32_bf16 v[68:71], a[36:39], v[112:115], v[68:71]
    v_mfma_f32_16x16x32_bf16 v[76:79], a[36:39], v[120:123], v[76:79]
    v_mfma_f32_16x16x32_bf16 v[76:79], a[44:47], v[124:127], v[76:79]
    buffer_load_dwordx4 v3, s[44:47], s13 offen offset:2048 sc1 lds
    v_mfma_f32_16x16x32_bf16 v[72:75], a[40:43], v[124:127], v[72:75]
    v_mfma_f32_16x16x32_bf16 v[72:75], a[32:35], v[120:123], v[72:75]
    s_waitcnt lgkmcnt(0)
    v_mfma_f32_16x16x32_bf16 v[32:35], a[48:51], v[80:83], v[32:35]
    s_add_u32 m0, s74, 0
    s_mul_i32 s13, s26, 90112
    v_mfma_f32_16x16x32_bf16 v[32:35], a[56:59], v[84:87], v[32:35]
    ds_read_b128 v[104:107], v159 offset:13056
    v_mfma_f32_16x16x32_bf16 v[36:39], a[60:63], v[84:87], v[36:39]
    ds_read_b128 v[108:111], v159 offset:19200
    v_mfma_f32_16x16x32_bf16 v[36:39], a[52:55], v[80:83], v[36:39]
    ds_read_b128 v[112:115], v159 offset:13312
    buffer_load_dwordx4 v8, s[44:47], s13 offen offset:0 sc1 lds
    v_mfma_f32_16x16x32_bf16 v[44:47], a[52:55], v[88:91], v[44:47]
    ds_read_b128 v[116:119], v159 offset:19456
    v_mfma_f32_16x16x32_bf16 v[44:47], a[60:63], v[92:95], v[44:47]
    ds_read_b128 v[120:123], v159 offset:13568
    v_mfma_f32_16x16x32_bf16 v[40:43], a[56:59], v[92:95], v[40:43]
    ds_read_b128 v[124:127], v159 offset:19712
    buffer_load_dwordx4 v9, s[44:47], s13 offen offset:1024 sc1 lds
    v_mfma_f32_16x16x32_bf16 v[40:43], a[48:51], v[88:91], v[40:43]
    v_mfma_f32_16x16x32_bf16 v[48:51], a[48:51], v[96:99], v[48:51]
    v_mfma_f32_16x16x32_bf16 v[48:51], a[56:59], v[100:103], v[48:51]
    buffer_load_dwordx4 v3, s[44:47], s13 offen offset:2048 sc1 lds
    v_mfma_f32_16x16x32_bf16 v[52:55], a[60:63], v[100:103], v[52:55]
    v_mfma_f32_16x16x32_bf16 v[52:55], a[52:55], v[96:99], v[52:55]
    s_waitcnt lgkmcnt(0)
    v_mfma_f32_16x16x32_bf16 v[60:63], a[52:55], v[104:107], v[60:63]
    s_waitcnt vmcnt(18)
    s_barrier
    v_mfma_f32_16x16x32_bf16 v[60:63], a[60:63], v[108:111], v[60:63]
    ds_read_b128 v[80:83], v159 offset:24576
    s_add_u32 m0, s74, 12288
    s_mul_i32 s13, s27, 90112
    v_mfma_f32_16x16x32_bf16 v[56:59], a[56:59], v[108:111], v[56:59]
    ds_read_b128 v[84:87], v159 offset:30720
    v_mfma_f32_16x16x32_bf16 v[56:59], a[48:51], v[104:107], v[56:59]
    ds_read_b128 v[88:91], v159 offset:24832
    buffer_load_dwordx4 v8, s[44:47], s13 offen offset:0 sc1 lds
    v_mfma_f32_16x16x32_bf16 v[64:67], a[48:51], v[112:115], v[64:67]
    ds_read_b128 v[92:95], v159 offset:30976
    v_mfma_f32_16x16x32_bf16 v[64:67], a[56:59], v[116:119], v[64:67]
    ds_read_b128 v[96:99], v159 offset:25088
    v_mfma_f32_16x16x32_bf16 v[68:71], a[60:63], v[116:119], v[68:71]
    ds_read_b128 v[100:103], v159 offset:31232
    buffer_load_dwordx4 v9, s[44:47], s13 offen offset:1024 sc1 lds
    v_mfma_f32_16x16x32_bf16 v[68:71], a[52:55], v[112:115], v[68:71]
    v_add_u32 v10, -65536, v10
    v_mfma_f32_16x16x32_bf16 v[76:79], a[52:55], v[120:123], v[76:79]
    ds_read_b64_tr_b16 a[16:17], v10 offset:0
    v_mfma_f32_16x16x32_bf16 v[76:79], a[60:63], v[124:127], v[76:79]
    ds_read_b64_tr_b16 a[18:19], v10 offset:2048
    buffer_load_dwordx4 v3, s[44:47], s13 offen offset:2048 sc1 lds
    v_mfma_f32_16x16x32_bf16 v[72:75], a[56:59], v[124:127], v[72:75]
    ds_read_b64_tr_b16 a[24:25], v10 offset:4096
    v_mfma_f32_16x16x32_bf16 v[72:75], a[48:51], v[120:123], v[72:75]
    ds_read_b64_tr_b16 a[26:27], v10 offset:6144
    s_waitcnt lgkmcnt(4)
    v_mfma_f32_16x16x32_bf16 v[32:35], a[64:67], v[80:83], v[32:35]
    s_add_u32 m0, s73, 16384
    s_lshl_b32 s14, s86, 18
    v_mfma_f32_16x16x32_bf16 v[32:35], a[72:75], v[84:87], v[32:35]
    ds_read_b128 v[104:107], v159 offset:25344
    v_mfma_f32_16x16x32_bf16 v[36:39], a[76:79], v[84:87], v[36:39]
    ds_read_b128 v[108:111], v159 offset:31488
    buffer_load_dwordx4 v4, s[52:55], s14 offen offset:0 lds
    v_mfma_f32_16x16x32_bf16 v[36:39], a[68:71], v[80:83], v[36:39]
    ds_read_b128 v[112:115], v159 offset:25600
    v_mfma_f32_16x16x32_bf16 v[44:47], a[68:71], v[88:91], v[44:47]
    ds_read_b128 v[116:119], v159 offset:31744
    buffer_load_dwordx4 v5, s[52:55], s14 offen offset:1024 lds
    v_mfma_f32_16x16x32_bf16 v[44:47], a[76:79], v[92:95], v[44:47]
    ds_read_b128 v[120:123], v159 offset:25856
    v_mfma_f32_16x16x32_bf16 v[40:43], a[72:75], v[92:95], v[40:43]
    ds_read_b128 v[124:127], v159 offset:32000
    v_mfma_f32_16x16x32_bf16 v[40:43], a[64:67], v[88:91], v[40:43]
    buffer_load_dwordx4 v6, s[52:55], s14 offen offset:2048 lds
    v_add_u32 v11, -65536, v11
    v_mfma_f32_16x16x32_bf16 v[48:51], a[64:67], v[96:99], v[48:51]
    ds_read_b64_tr_b16 a[20:21], v11 offset:0
    v_mfma_f32_16x16x32_bf16 v[48:51], a[72:75], v[100:103], v[48:51]
    ds_read_b64_tr_b16 a[22:23], v11 offset:2048
    buffer_load_dwordx4 v7, s[52:55], s14 offen offset:3072 lds
    v_mfma_f32_16x16x32_bf16 v[52:55], a[76:79], v[100:103], v[52:55]
    ds_read_b64_tr_b16 a[28:29], v11 offset:4096
    v_mfma_f32_16x16x32_bf16 v[52:55], a[68:71], v[96:99], v[52:55]
    ds_read_b64_tr_b16 a[30:31], v11 offset:6144
    s_waitcnt lgkmcnt(4)
    v_mfma_f32_16x16x32_bf16 v[60:63], a[68:71], v[104:107], v[60:63]
    s_waitcnt vmcnt(18)
    s_barrier
    v_mfma_f32_16x16x32_bf16 v[60:63], a[76:79], v[108:111], v[60:63]
    ds_read_b128 v[80:83], v250 offset:0
    v_mfma_f32_16x16x32_bf16 v[56:59], a[72:75], v[108:111], v[56:59]
    ds_read_b128 v[84:87], v250 offset:6144
    v_mfma_f32_16x16x32_bf16 v[56:59], a[64:67], v[104:107], v[56:59]
    ds_read_b128 v[88:91], v250 offset:256
    v_mfma_f32_16x16x32_bf16 v[64:67], a[64:67], v[112:115], v[64:67]
    ds_read_b128 v[92:95], v250 offset:6400
    v_mfma_f32_16x16x32_bf16 v[64:67], a[72:75], v[116:119], v[64:67]
    ds_read_b128 v[96:99], v250 offset:512
    v_mfma_f32_16x16x32_bf16 v[68:71], a[76:79], v[116:119], v[68:71]
    ds_read_b128 v[100:103], v250 offset:6656
    v_mfma_f32_16x16x32_bf16 v[68:71], a[68:71], v[112:115], v[68:71]
    v_mfma_f32_16x16x32_bf16 v[76:79], a[68:71], v[120:123], v[76:79]
    v_mfma_f32_16x16x32_bf16 v[76:79], a[76:79], v[124:127], v[76:79]
    v_mfma_f32_16x16x32_bf16 v[72:75], a[72:75], v[124:127], v[72:75]
    v_mfma_f32_16x16x32_bf16 v[72:75], a[64:67], v[120:123], v[72:75]
    s_waitcnt lgkmcnt(0)
    v_mfma_f32_16x16x32_bf16 v[32:35], a[80:83], v[80:83], v[32:35]
    v_mfma_f32_16x16x32_bf16 v[32:35], a[88:91], v[84:87], v[32:35]
    ds_read_b128 v[104:107], v250 offset:768
    v_mfma_f32_16x16x32_bf16 v[36:39], a[92:95], v[84:87], v[36:39]
    ds_read_b128 v[108:111], v250 offset:6912
    v_mfma_f32_16x16x32_bf16 v[36:39], a[84:87], v[80:83], v[36:39]
    ds_read_b128 v[112:115], v250 offset:1024
    v_mfma_f32_16x16x32_bf16 v[44:47], a[84:87], v[88:91], v[44:47]
    ds_read_b128 v[116:119], v250 offset:7168
    v_mfma_f32_16x16x32_bf16 v[44:47], a[92:95], v[92:95], v[44:47]
    ds_read_b128 v[120:123], v250 offset:1280
    v_mfma_f32_16x16x32_bf16 v[40:43], a[88:91], v[92:95], v[40:43]
    ds_read_b128 v[124:127], v250 offset:7424
    v_mfma_f32_16x16x32_bf16 v[40:43], a[80:83], v[88:91], v[40:43]
    s_waitcnt vmcnt(13)
    buffer_store_dword v249, v248, s[44:47], s6 offen sc1
    v_mfma_f32_16x16x32_bf16 v[48:51], a[80:83], v[96:99], v[48:51]
    v_mfma_f32_16x16x32_bf16 v[48:51], a[88:91], v[100:103], v[48:51]
    v_mfma_f32_16x16x32_bf16 v[52:55], a[92:95], v[100:103], v[52:55]
    v_mfma_f32_16x16x32_bf16 v[52:55], a[84:87], v[96:99], v[52:55]
    s_waitcnt lgkmcnt(0)
    v_mfma_f32_16x16x32_bf16 v[60:63], a[84:87], v[104:107], v[60:63]
    s_barrier
    v_mfma_f32_16x16x32_bf16 v[60:63], a[92:95], v[108:111], v[60:63]
    ds_read_b128 v[80:83], v250 offset:12288
    v_mfma_f32_16x16x32_bf16 v[56:59], a[88:91], v[108:111], v[56:59]
    ds_read_b128 v[84:87], v250 offset:18432
    v_mfma_f32_16x16x32_bf16 v[56:59], a[80:83], v[104:107], v[56:59]
    ds_read_b128 v[88:91], v250 offset:12544
    v_mfma_f32_16x16x32_bf16 v[64:67], a[80:83], v[112:115], v[64:67]
    ds_read_b128 v[92:95], v250 offset:18688
    v_mfma_f32_16x16x32_bf16 v[64:67], a[88:91], v[116:119], v[64:67]
    ds_read_b128 v[96:99], v250 offset:12800
    v_mfma_f32_16x16x32_bf16 v[68:71], a[92:95], v[116:119], v[68:71]
    ds_read_b128 v[100:103], v250 offset:18944
    v_mfma_f32_16x16x32_bf16 v[68:71], a[84:87], v[112:115], v[68:71]
    v_mfma_f32_16x16x32_bf16 v[76:79], a[84:87], v[120:123], v[76:79]
    v_mfma_f32_16x16x32_bf16 v[76:79], a[92:95], v[124:127], v[76:79]
    v_mfma_f32_16x16x32_bf16 v[72:75], a[88:91], v[124:127], v[72:75]
    v_mfma_f32_16x16x32_bf16 v[72:75], a[80:83], v[120:123], v[72:75]
    s_waitcnt lgkmcnt(0)
    v_mfma_f32_16x16x32_bf16 v[32:35], a[96:99], v[80:83], v[32:35]
    v_mfma_f32_16x16x32_bf16 v[32:35], a[104:107], v[84:87], v[32:35]
    ds_read_b128 v[104:107], v250 offset:13056
    v_mfma_f32_16x16x32_bf16 v[36:39], a[108:111], v[84:87], v[36:39]
    ds_read_b128 v[108:111], v250 offset:19200
    v_mfma_f32_16x16x32_bf16 v[36:39], a[100:103], v[80:83], v[36:39]
    ds_read_b128 v[112:115], v250 offset:13312
    v_mfma_f32_16x16x32_bf16 v[44:47], a[100:103], v[88:91], v[44:47]
    ds_read_b128 v[116:119], v250 offset:19456
    v_mfma_f32_16x16x32_bf16 v[44:47], a[108:111], v[92:95], v[44:47]
    ds_read_b128 v[120:123], v250 offset:13568
    v_mfma_f32_16x16x32_bf16 v[40:43], a[104:107], v[92:95], v[40:43]
    ds_read_b128 v[124:127], v250 offset:19712
    v_mfma_f32_16x16x32_bf16 v[40:43], a[96:99], v[88:91], v[40:43]
    v_mfma_f32_16x16x32_bf16 v[48:51], a[96:99], v[96:99], v[48:51]
    v_mfma_f32_16x16x32_bf16 v[48:51], a[104:107], v[100:103], v[48:51]
    v_mfma_f32_16x16x32_bf16 v[52:55], a[108:111], v[100:103], v[52:55]
    v_mfma_f32_16x16x32_bf16 v[52:55], a[100:103], v[96:99], v[52:55]
    s_waitcnt lgkmcnt(0)
    v_mfma_f32_16x16x32_bf16 v[60:63], a[100:103], v[104:107], v[60:63]
    s_waitcnt vmcnt(11)
    s_barrier
    v_mfma_f32_16x16x32_bf16 v[60:63], a[108:111], v[108:111], v[60:63]
    ds_read_b128 v[80:83], v250 offset:24576
    s_add_u32 m0, s74, 24576
    s_mul_i32 s13, s76, 90112
    v_mfma_f32_16x16x32_bf16 v[56:59], a[104:107], v[108:111], v[56:59]
    ds_read_b128 v[84:87], v250 offset:30720
    v_mfma_f32_16x16x32_bf16 v[56:59], a[96:99], v[104:107], v[56:59]
L_pl_G_4:
    s_cbranch_execz L_wret
    ds_read_b128 v[88:91], v250 offset:24832
    buffer_load_dwordx4 v8, s[44:47], s13 offen offset:0 sc1 lds
    v_mfma_f32_16x16x32_bf16 v[64:67], a[96:99], v[112:115], v[64:67]
    ds_read_b128 v[92:95], v250 offset:30976
    v_mfma_f32_16x16x32_bf16 v[64:67], a[104:107], v[116:119], v[64:67]
    ds_read_b128 v[96:99], v250 offset:25088
    v_mfma_f32_16x16x32_bf16 v[68:71], a[108:111], v[116:119], v[68:71]
    ds_read_b128 v[100:103], v250 offset:31232
    buffer_load_dwordx4 v9, s[44:47], s13 offen offset:1024 sc1 lds
    v_mfma_f32_16x16x32_bf16 v[68:71], a[100:103], v[112:115], v[68:71]
    v_mfma_f32_16x16x32_bf16 v[76:79], a[100:103], v[120:123], v[76:79]
    v_mfma_f32_16x16x32_bf16 v[76:79], a[108:111], v[124:127], v[76:79]
    buffer_load_dwordx4 v3, s[44:47], s13 offen offset:2048 sc1 lds
    v_mfma_f32_16x16x32_bf16 v[72:75], a[104:107], v[124:127], v[72:75]
    v_mfma_f32_16x16x32_bf16 v[72:75], a[96:99], v[120:123], v[72:75]
    s_waitcnt lgkmcnt(0)
    v_mfma_f32_16x16x32_bf16 v[32:35], a[112:115], v[80:83], v[32:35]
    s_add_u32 m0, s74, 36864
    s_mul_i32 s13, s77, 90112
    v_mfma_f32_16x16x32_bf16 v[32:35], a[120:123], v[84:87], v[32:35]
    ds_read_b128 v[104:107], v250 offset:25344
    v_mfma_f32_16x16x32_bf16 v[36:39], a[124:127], v[84:87], v[36:39]
    ds_read_b128 v[108:111], v250 offset:31488
    v_mfma_f32_16x16x32_bf16 v[36:39], a[116:119], v[80:83], v[36:39]
    ds_read_b128 v[112:115], v250 offset:25600
    buffer_load_dwordx4 v8, s[44:47], s13 offen offset:0 sc1 lds
    v_mfma_f32_16x16x32_bf16 v[44:47], a[116:119], v[88:91], v[44:47]
    ds_read_b128 v[116:119], v250 offset:31744
    v_mfma_f32_16x16x32_bf16 v[44:47], a[124:127], v[92:95], v[44:47]
    ds_read_b128 v[120:123], v250 offset:25856
    v_mfma_f32_16x16x32_bf16 v[40:43], a[120:123], v[92:95], v[40:43]
    ds_read_b128 v[124:127], v250 offset:32000
    buffer_load_dwordx4 v9, s[44:47], s13 offen offset:1024 sc1 lds
    v_mfma_f32_16x16x32_bf16 v[40:43], a[112:115], v[88:91], v[40:43]
    v_mfma_f32_16x16x32_bf16 v[48:51], a[112:115], v[96:99], v[48:51]
    v_mfma_f32_16x16x32_bf16 v[48:51], a[120:123], v[100:103], v[48:51]
    buffer_load_dwordx4 v3, s[44:47], s13 offen offset:2048 sc1 lds
    v_mfma_f32_16x16x32_bf16 v[52:55], a[124:127], v[100:103], v[52:55]
    v_mfma_f32_16x16x32_bf16 v[52:55], a[116:119], v[96:99], v[52:55]
    s_waitcnt lgkmcnt(0)
    v_mfma_f32_16x16x32_bf16 v[60:63], a[116:119], v[104:107], v[60:63]
    s_waitcnt vmcnt(14)
    s_barrier
    v_mfma_f32_16x16x32_bf16 v[60:63], a[124:127], v[108:111], v[60:63]
    ds_read_b128 v[80:83], v159 offset:0
    s_add_u32 m0, s74, 49152
    s_mul_i32 s13, s78, 90112
    v_mfma_f32_16x16x32_bf16 v[56:59], a[120:123], v[108:111], v[56:59]
    ds_read_b128 v[84:87], v159 offset:6144
    v_mfma_f32_16x16x32_bf16 v[56:59], a[112:115], v[104:107], v[56:59]
    ds_read_b128 v[88:91], v159 offset:256
    buffer_load_dwordx4 v8, s[44:47], s13 offen offset:0 sc1 lds
    v_mfma_f32_16x16x32_bf16 v[64:67], a[112:115], v[112:115], v[64:67]
    ds_read_b128 v[92:95], v159 offset:6400
    v_mfma_f32_16x16x32_bf16 v[64:67], a[120:123], v[116:119], v[64:67]
    ds_read_b128 v[96:99], v159 offset:512
    v_mfma_f32_16x16x32_bf16 v[68:71], a[124:127], v[116:119], v[68:71]
    ds_read_b128 v[100:103], v159 offset:6656
    buffer_load_dwordx4 v9, s[44:47], s13 offen offset:1024 sc1 lds
    v_mfma_f32_16x16x32_bf16 v[68:71], a[116:119], v[112:115], v[68:71]
    v_mfma_f32_16x16x32_bf16 v[76:79], a[116:119], v[120:123], v[76:79]
    v_mfma_f32_16x16x32_bf16 v[76:79], a[124:127], v[124:127], v[76:79]
    buffer_load_dwordx4 v3, s[44:47], s13 offen offset:2048 sc1 lds
    v_mfma_f32_16x16x32_bf16 v[72:75], a[120:123], v[124:127], v[72:75]
    v_mfma_f32_16x16x32_bf16 v[72:75], a[112:115], v[120:123], v[72:75]
    s_waitcnt lgkmcnt(0)
    v_mfma_f32_16x16x32_bf16 v[32:35], a[128:131], v[80:83], v[32:35]
    s_add_u32 m0, s74, 61440
    s_mul_i32 s13, s79, 90112
    v_mfma_f32_16x16x32_bf16 v[32:35], a[136:139], v[84:87], v[32:35]
    ds_read_b128 v[104:107], v159 offset:768
    v_mfma_f32_16x16x32_bf16 v[36:39], a[140:143], v[84:87], v[36:39]
    ds_read_b128 v[108:111], v159 offset:6912
    v_mfma_f32_16x16x32_bf16 v[36:39], a[132:135], v[80:83], v[36:39]
    ds_read_b128 v[112:115], v159 offset:1024
    buffer_load_dwordx4 v8, s[44:47], s13 offen offset:0 sc1 lds
    v_mfma_f32_16x16x32_bf16 v[44:47], a[132:135], v[88:91], v[44:47]
    ds_read_b128 v[116:119], v159 offset:7168
    v_mfma_f32_16x16x32_bf16 v[44:47], a[140:143], v[92:95], v[44:47]
    ds_read_b128 v[120:123], v159 offset:1280
    v_mfma_f32_16x16x32_bf16 v[40:43], a[136:139], v[92:95], v[40:43]
    ds_read_b128 v[124:127], v159 offset:7424
    buffer_load_dwordx4 v9, s[44:47], s13 offen offset:1024 sc1 lds
    v_mfma_f32_16x16x32_bf16 v[40:43], a[128:131], v[88:91], v[40:43]
    v_mfma_f32_16x16x32_bf16 v[48:51], a[128:131], v[96:99], v[48:51]
    v_mfma_f32_16x16x32_bf16 v[48:51], a[136:139], v[100:103], v[48:51]
    buffer_load_dwordx4 v3, s[44:47], s13 offen offset:2048 sc1 lds
    v_mfma_f32_16x16x32_bf16 v[52:55], a[140:143], v[100:103], v[52:55]
    v_mfma_f32_16x16x32_bf16 v[52:55], a[132:135], v[96:99], v[52:55]
    s_waitcnt lgkmcnt(0)
    v_mfma_f32_16x16x32_bf16 v[60:63], a[132:135], v[104:107], v[60:63]
    s_waitcnt vmcnt(13)
    s_barrier
    v_mfma_f32_16x16x32_bf16 v[60:63], a[140:143], v[108:111], v[60:63]
    ds_read_b128 v[80:83], v159 offset:12288
    s_add_u32 m0, s74, 0
    s_mul_i32 s13, s80, 90112
    v_mfma_f32_16x16x32_bf16 v[56:59], a[136:139], v[108:111], v[56:59]
    ds_read_b128 v[84:87], v159 offset:18432
    v_mfma_f32_16x16x32_bf16 v[56:59], a[128:131], v[104:107], v[56:59]
    ds_read_b128 v[88:91], v159 offset:12544
    buffer_load_dwordx4 v8, s[44:47], s13 offen offset:0 sc1 lds
    v_mfma_f32_16x16x32_bf16 v[64:67], a[128:131], v[112:115], v[64:67]
    ds_read_b128 v[92:95], v159 offset:18688
    v_mfma_f32_16x16x32_bf16 v[64:67], a[136:139], v[116:119], v[64:67]
    ds_read_b128 v[96:99], v159 offset:12800
    buffer_load_dword v29, v28, s[44:47], 0 offen sc1
    v_mfma_f32_16x16x32_bf16 v[68:71], a[140:143], v[116:119], v[68:71]
    ds_read_b128 v[100:103], v159 offset:18944
    buffer_load_dwordx4 v9, s[44:47], s13 offen offset:1024 sc1 lds
    v_mfma_f32_16x16x32_bf16 v[68:71], a[132:135], v[112:115], v[68:71]
    ds_read_b64_tr_b16 a[32:33], v10 offset:16384
    v_mfma_f32_16x16x32_bf16 v[76:79], a[132:135], v[120:123], v[76:79]
    ds_read_b64_tr_b16 a[34:35], v10 offset:18432
    v_mfma_f32_16x16x32_bf16 v[76:79], a[140:143], v[124:127], v[76:79]
    buffer_load_dwordx4 v3, s[44:47], s13 offen offset:2048 sc1 lds
    v_mfma_f32_16x16x32_bf16 v[72:75], a[136:139], v[124:127], v[72:75]
    ds_read_b64_tr_b16 a[40:41], v10 offset:20480
    v_mfma_f32_16x16x32_bf16 v[72:75], a[128:131], v[120:123], v[72:75]
    ds_read_b64_tr_b16 a[42:43], v10 offset:22528
    s_waitcnt lgkmcnt(4)
    v_mfma_f32_16x16x32_bf16 v[32:35], a[144:147], v[80:83], v[32:35]
    s_add_u32 m0, s73, 32768
    s_lshl_b32 s14, s87, 18
    v_mfma_f32_16x16x32_bf16 v[32:35], a[152:155], v[84:87], v[32:35]
    ds_read_b128 v[104:107], v159 offset:13056
    v_mfma_f32_16x16x32_bf16 v[36:39], a[156:159], v[84:87], v[36:39]
    ds_read_b128 v[108:111], v159 offset:19200
    buffer_load_dwordx4 v4, s[52:55], s14 offen offset:0 lds
    v_mfma_f32_16x16x32_bf16 v[36:39], a[148:151], v[80:83], v[36:39]
    ds_read_b128 v[112:115], v159 offset:13312
    v_mfma_f32_16x16x32_bf16 v[44:47], a[148:151], v[88:91], v[44:47]
    ds_read_b128 v[116:119], v159 offset:19456
    buffer_load_dwordx4 v5, s[52:55], s14 offen offset:1024 lds
    v_mfma_f32_16x16x32_bf16 v[44:47], a[156:159], v[92:95], v[44:47]
    ds_read_b128 v[120:123], v159 offset:13568
    v_mfma_f32_16x16x32_bf16 v[40:43], a[152:155], v[92:95], v[40:43]
    ds_read_b128 v[124:127], v159 offset:19712
    v_mfma_f32_16x16x32_bf16 v[40:43], a[144:147], v[88:91], v[40:43]
    ds_read_b64_tr_b16 a[36:37], v11 offset:16384
    buffer_load_dwordx4 v6, s[52:55], s14 offen offset:2048 lds
    v_mfma_f32_16x16x32_bf16 v[48:51], a[144:147], v[96:99], v[48:51]
    ds_read_b64_tr_b16 a[38:39], v11 offset:18432
    v_mfma_f32_16x16x32_bf16 v[48:51], a[152:155], v[100:103], v[48:51]
    buffer_load_dwordx4 v7, s[52:55], s14 offen offset:3072 lds
    v_mfma_f32_16x16x32_bf16 v[52:55], a[156:159], v[100:103], v[52:55]
    ds_read_b64_tr_b16 a[44:45], v11 offset:20480
    v_mfma_f32_16x16x32_bf16 v[52:55], a[148:151], v[96:99], v[52:55]
    ds_read_b64_tr_b16 a[46:47], v11 offset:22528
    s_waitcnt lgkmcnt(4)
    v_mfma_f32_16x16x32_bf16 v[60:63], a[148:151], v[104:107], v[60:63]
    s_waitcnt vmcnt(17)
    s_barrier
    v_mfma_f32_16x16x32_bf16 v[60:63], a[156:159], v[108:111], v[60:63]
    ds_read_b128 v[80:83], v159 offset:24576
    v_mfma_f32_16x16x32_bf16 v[56:59], a[152:155], v[108:111], v[56:59]
    ds_read_b128 v[84:87], v159 offset:30720
    v_mfma_f32_16x16x32_bf16 v[56:59], a[144:147], v[104:107], v[56:59]
    ds_read_b128 v[88:91], v159 offset:24832
    v_mfma_f32_16x16x32_bf16 v[64:67], a[144:147], v[112:115], v[64:67]
    ds_read_b128 v[92:95], v159 offset:30976
    v_mfma_f32_16x16x32_bf16 v[64:67], a[152:155], v[116:119], v[64:67]
    ds_read_b128 v[96:99], v159 offset:25088
    v_mfma_f32_16x16x32_bf16 v[68:71], a[156:159], v[116:119], v[68:71]
    ds_read_b128 v[100:103], v159 offset:31232
    v_mfma_f32_16x16x32_bf16 v[68:71], a[148:151], v[112:115], v[68:71]
    v_mfma_f32_16x16x32_bf16 v[76:79], a[148:151], v[120:123], v[76:79]
    v_mfma_f32_16x16x32_bf16 v[76:79], a[156:159], v[124:127], v[76:79]
    v_mfma_f32_16x16x32_bf16 v[72:75], a[152:155], v[124:127], v[72:75]
    v_mfma_f32_16x16x32_bf16 v[72:75], a[144:147], v[120:123], v[72:75]
    s_waitcnt lgkmcnt(0)
    v_mfma_f32_16x16x32_bf16 v[32:35], a[160:163], v[80:83], v[32:35]
    v_mfma_f32_16x16x32_bf16 v[32:35], a[168:171], v[84:87], v[32:35]
    ds_read_b128 v[104:107], v159 offset:25344
    v_mfma_f32_16x16x32_bf16 v[36:39], a[172:175], v[84:87], v[36:39]
    ds_read_b128 v[108:111], v159 offset:31488
    v_mfma_f32_16x16x32_bf16 v[36:39], a[164:167], v[80:83], v[36:39]
    ds_read_b128 v[112:115], v159 offset:25600
    v_mfma_f32_16x16x32_bf16 v[44:47], a[164:167], v[88:91], v[44:47]
    ds_read_b128 v[116:119], v159 offset:31744
    v_mfma_f32_16x16x32_bf16 v[44:47], a[172:175], v[92:95], v[44:47]
    ds_read_b128 v[120:123], v159 offset:25856
    v_mfma_f32_16x16x32_bf16 v[40:43], a[168:171], v[92:95], v[40:43]
    ds_read_b128 v[124:127], v159 offset:32000
    v_mfma_f32_16x16x32_bf16 v[40:43], a[160:163], v[88:91], v[40:43]
    v_mfma_f32_16x16x32_bf16 v[48:51], a[160:163], v[96:99], v[48:51]
    v_mfma_f32_16x16x32_bf16 v[48:51], a[168:171], v[100:103], v[48:51]
    v_mfma_f32_16x16x32_bf16 v[52:55], a[172:175], v[100:103], v[52:55]
    v_mfma_f32_16x16x32_bf16 v[52:55], a[164:167], v[96:99], v[52:55]
    s_waitcnt lgkmcnt(0)
    v_mfma_f32_16x16x32_bf16 v[60:63], a[164:167], v[104:107], v[60:63]
    s_waitcnt vmcnt(14)
    s_barrier
    v_mfma_f32_16x16x32_bf16 v[60:63], a[172:175], v[108:111], v[60:63]
    ds_read_b128 v[80:83], v250 offset:0
    s_waitcnt vmcnt(6)
    v_mfma_f32_16x16x32_bf16 v[56:59], a[168:171], v[108:111], v[56:59]
    ds_read_b128 v[84:87], v250 offset:6144
    v_cmp_ne_u32 vcc, s68, v29
    v_mfma_f32_16x16x32_bf16 v[56:59], a[160:163], v[104:107], v[56:59]
    ds_read_b128 v[88:91], v250 offset:256
    v_mfma_f32_16x16x32_bf16 v[64:67], a[160:163], v[112:115], v[64:67]
    ds_read_b128 v[92:95], v250 offset:6400
    v_mfma_f32_16x16x32_bf16 v[64:67], a[168:171], v[116:119], v[64:67]
    ds_read_b128 v[96:99], v250 offset:512
    s_cbranch_vccnz L_rs_p5
L_ok_p5:
    v_mfma_f32_16x16x32_bf16 v[68:71], a[172:175], v[116:119], v[68:71]
    ds_read_b128 v[100:103], v250 offset:6656
    buffer_load_dwordx4 v[160:163], v246, s[44:47], s10 offen offset:0 sc1
    v_mfma_f32_16x16x32_bf16 v[68:71], a[164:167], v[112:115], v[68:71]
    v_mfma_f32_16x16x32_bf16 v[76:79], a[164:167], v[120:123], v[76:79]
    v_mfma_f32_16x16x32_bf16 v[76:79], a[172:175], v[124:127], v[76:79]
    buffer_load_dwordx4 v[164:167], v246, s[44:47], s10 offen offset:1024 sc1
    v_mfma_f32_16x16x32_bf16 v[72:75], a[168:171], v[124:127], v[72:75]
    buffer_load_dwordx4 v[168:171], v246, s[44:47], s10 offen offset:2048 sc1
    v_mfma_f32_16x16x32_bf16 v[72:75], a[160:163], v[120:123], v[72:75]
    s_waitcnt lgkmcnt(0)
    v_mfma_f32_16x16x32_bf16 v[32:35], a[176:179], v[80:83], v[32:35]
    v_mfma_f32_16x16x32_bf16 v[32:35], a[184:187], v[84:87], v[32:35]
    ds_read_b128 v[104:107], v250 offset:768
    v_mfma_f32_16x16x32_bf16 v[36:39], a[188:191], v[84:87], v[36:39]
    ds_read_b128 v[108:111], v250 offset:6912
    buffer_load_dwordx4 v[172:175], v247, s[44:47], s10 offen offset:0 sc1
    v_mfma_f32_16x16x32_bf16 v[36:39], a[180:183], v[80:83], v[36:39]
    ds_read_b128 v[112:115], v250 offset:1024
    v_mfma_f32_16x16x32_bf16 v[44:47], a[180:183], v[88:91], v[44:47]
    ds_read_b128 v[116:119], v250 offset:7168
    v_mfma_f32_16x16x32_bf16 v[44:47], a[188:191], v[92:95], v[44:47]
    ds_read_b128 v[120:123], v250 offset:1280
    buffer_load_dwordx4 v[176:179], v247, s[44:47], s10 offen offset:1024 sc1
    v_mfma_f32_16x16x32_bf16 v[40:43], a[184:187], v[92:95], v[40:43]
    ds_read_b128 v[124:127], v250 offset:7424
    v_mfma_f32_16x16x32_bf16 v[40:43], a[176:179], v[88:91], v[40:43]
    v_mfma_f32_16x16x32_bf16 v[48:51], a[176:179], v[96:99], v[48:51]
    v_mfma_f32_16x16x32_bf16 v[48:51], a[184:187], v[100:103], v[48:51]
    v_mfma_f32_16x16x32_bf16 v[52:55], a[188:191], v[100:103], v[52:55]
    buffer_load_dwordx4 v[180:183], v247, s[44:47], s10 offen offset:2048 sc1
    v_mfma_f32_16x16x32_bf16 v[52:55], a[180:183], v[96:99], v[52:55]
    s_waitcnt lgkmcnt(0)
    v_mfma_f32_16x16x32_bf16 v[60:63], a[180:183], v[104:107], v[60:63]
    s_barrier
    v_mfma_f32_16x16x32_bf16 v[60:63], a[188:191], v[108:111], v[60:63]
    ds_read_b128 v[80:83], v250 offset:12288
    s_add_u32 m0, s74, 12288
    s_mul_i32 s13, s81, 90112
    v_mfma_f32_16x16x32_bf16 v[56:59], a[184:187], v[108:111], v[56:59]
    ds_read_b128 v[84:87], v250 offset:18432
    v_mfma_f32_16x16x32_bf16 v[56:59], a[176:179], v[104:107], v[56:59]
    ds_read_b128 v[88:91], v250 offset:12544
    buffer_load_dwordx4 v8, s[44:47], s13 offen offset:0 sc1 lds
    v_mfma_f32_16x16x32_bf16 v[64:67], a[176:179], v[112:115], v[64:67]
    ds_read_b128 v[92:95], v250 offset:18688
    v_mfma_f32_16x16x32_bf16 v[64:67], a[184:187], v[116:119], v[64:67]
    ds_read_b128 v[96:99], v250 offset:12800
    v_mfma_f32_16x16x32_bf16 v[68:71], a[188:191], v[116:119], v[68:71]
    ds_read_b128 v[100:103], v250 offset:18944
    buffer_load_dwordx4 v9, s[44:47], s13 offen offset:1024 sc1 lds
    v_mfma_f32_16x16x32_bf16 v[68:71], a[180:183], v[112:115], v[68:71]
    v_mfma_f32_16x16x32_bf16 v[76:79], a[180:183], v[120:123], v[76:79]
    v_mfma_f32_16x16x32_bf16 v[76:79], a[188:191], v[124:127], v[76:79]
    buffer_load_dwordx4 v3, s[44:47], s13 offen offset:2048 sc1 lds
    v_mfma_f32_16x16x32_bf16 v[72:75], a[184:187], v[124:127], v[72:75]
    v_mfma_f32_16x16x32_bf16 v[72:75], a[176:179], v[120:123], v[72:75]
    s_waitcnt lgkmcnt(0)
    v_mfma_f32_16x16x32_bf16 v[32:35], a[192:195], v[80:83], v[32:35]
    s_add_u32 m0, s73, 49152
    s_lshl_b32 s14, s88, 18
    v_mfma_f32_16x16x32_bf16 v[32:35], a[200:203], v[84:87], v[32:35]
    ds_read_b128 v[104:107], v250 offset:13056
    v_mfma_f32_16x16x32_bf16 v[36:39], a[204:207], v[84:87], v[36:39]
    ds_read_b128 v[108:111], v250 offset:19200
    buffer_load_dwordx4 v4, s[52:55], s14 offen offset:0 lds
    v_mfma_f32_16x16x32_bf16 v[36:39], a[196:199], v[80:83], v[36:39]
    ds_read_b128 v[112:115], v250 offset:13312
    v_mfma_f32_16x16x32_bf16 v[44:47], a[196:199], v[88:91], v[44:47]
    ds_read_b128 v[116:119], v250 offset:19456
    buffer_load_dwordx4 v5, s[52:55], s14 offen offset:1024 lds
    v_mfma_f32_16x16x32_bf16 v[44:47], a[204:207], v[92:95], v[44:47]
    ds_read_b128 v[120:123], v250 offset:13568
    v_mfma_f32_16x16x32_bf16 v[40:43], a[200:203], v[92:95], v[40:43]
    ds_read_b128 v[124:127], v250 offset:19712
    v_mfma_f32_16x16x32_bf16 v[40:43], a[192:195], v[88:91], v[40:43]
    buffer_load_dwordx4 v6, s[52:55], s14 offen offset:2048 lds
    v_mfma_f32_16x16x32_bf16 v[48:51], a[192:195], v[96:99], v[48:51]
    v_mfma_f32_16x16x32_bf16 v[48:51], a[200:203], v[100:103], v[48:51]
    buffer_load_dwordx4 v7, s[52:55], s14 offen offset:3072 lds
    v_mfma_f32_16x16x32_bf16 v[52:55], a[204:207], v[100:103], v[52:55]
    v_mfma_f32_16x16x32_bf16 v[52:55], a[196:199], v[96:99], v[52:55]
    s_waitcnt lgkmcnt(0)
    v_mfma_f32_16x16x32_bf16 v[60:63], a[196:199], v[104:107], v[60:63]
    s_barrier
    v_mfma_f32_16x16x32_bf16 v[60:63], a[204:207], v[108:111], v[60:63]
    ds_read_b128 v[80:83], v250 offset:24576
    v_mfma_f32_16x16x32_bf16 v[56:59], a[200:203], v[108:111], v[56:59]
    ds_read_b128 v[84:87], v250 offset:30720
    v_mfma_f32_16x16x32_bf16 v[56:59], a[192:195], v[104:107], v[56:59]
    ds_read_b128 v[88:91], v250 offset:24832
    v_mfma_f32_16x16x32_bf16 v[64:67], a[192:195], v[112:115], v[64:67]
    ds_read_b128 v[92:95], v250 offset:30976
    v_mfma_f32_16x16x32_bf16 v[64:67], a[200:203], v[116:119], v[64:67]
    ds_read_b128 v[96:99], v250 offset:25088
    v_mfma_f32_16x16x32_bf16 v[68:71], a[204:207], v[116:119], v[68:71]
    ds_read_b128 v[100:103], v250 offset:31232
    s_waitcnt vmcnt(7)
    v_mfma_f32_16x16x32_bf16 v[68:71], a[196:199], v[112:115], v[68:71]
    v_mfma_f32_16x16x32_bf16 v[76:79], a[196:199], v[120:123], v[76:79]
    v_mfma_f32_16x16x32_bf16 v[76:79], a[204:207], v[124:127], v[76:79]
    v_mfma_f32_16x16x32_bf16 v[72:75], a[200:203], v[124:127], v[72:75]
    v_mfma_f32_16x16x32_bf16 v[72:75], a[192:195], v[120:123], v[72:75]
    s_waitcnt lgkmcnt(0)
    v_mfma_f32_16x16x32_bf16 v[32:35], a[208:211], v[80:83], v[32:35]
    s_add_u32 m0, s73, 65536
    s_lshl_b32 s14, s89, 18
    v_mfma_f32_16x16x32_bf16 v[32:35], a[216:219], v[84:87], v[32:35]
    ds_read_b128 v[104:107], v250 offset:25344
    v_mfma_f32_16x16x32_bf16 v[36:39], a[220:223], v[84:87], v[36:39]
    ds_read_b128 v[108:111], v250 offset:31488
    buffer_load_dwordx4 v4, s[52:55], s14 offen offset:0 lds
    v_and_b32 v193, 0xffff0000, v172
    v_lshlrev_b32 v192, 16, v172
    v_mfma_f32_16x16x32_bf16 v[36:39], a[212:215], v[80:83], v[36:39]
    ds_read_b128 v[112:115], v250 offset:25600
    v_and_b32 v195, 0xffff0000, v173
    v_lshlrev_b32 v194, 16, v173
    v_mfma_f32_16x16x32_bf16 v[44:47], a[212:215], v[88:91], v[44:47]
    ds_read_b128 v[116:119], v250 offset:31744
    buffer_load_dwordx4 v5, s[52:55], s14 offen offset:1024 lds
    v_add_f32 v56, v56, v192
    v_mfma_f32_16x16x32_bf16 v[44:47], a[220:223], v[92:95], v[44:47]
    ds_read_b128 v[120:123], v250 offset:25856
    v_add_f32 v57, v57, v193
    v_add_f32 v58, v58, v194
    v_mfma_f32_16x16x32_bf16 v[40:43], a[216:219], v[92:95], v[40:43]
    ds_read_b128 v[124:127], v250 offset:32000
    v_add_f32 v59, v59, v195
    v_and_b32 v197, 0xffff0000, v174
    v_mfma_f32_16x16x32_bf16 v[40:43], a[208:211], v[88:91], v[40:43]
    buffer_load_dwordx4 v6, s[52:55], s14 offen offset:2048 lds
    v_lshlrev_b32 v196, 16, v174
    v_and_b32 v199, 0xffff0000, v175
    v_mfma_f32_16x16x32_bf16 v[48:51], a[208:211], v[96:99], v[48:51]
    v_lshlrev_b32 v198, 16, v175
    v_add_f32 v60, v60, v196
    v_mfma_f32_16x16x32_bf16 v[48:51], a[216:219], v[100:103], v[48:51]
    buffer_load_dwordx4 v7, s[52:55], s14 offen offset:3072 lds
    v_add_f32 v61, v61, v197
    v_mfma_f32_16x16x32_bf16 v[52:55], a[220:223], v[100:103], v[52:55]
    v_add_f32 v62, v62, v198
    v_add_f32 v63, v63, v199
    v_mfma_f32_16x16x32_bf16 v[52:55], a[212:215], v[96:99], v[52:55]
    s_waitcnt lgkmcnt(0)
    v_mfma_f32_16x16x32_bf16 v[60:63], a[212:215], v[104:107], v[60:63]
    s_barrier
    v_mfma_f32_16x16x32_bf16 v[60:63], a[220:223], v[108:111], v[60:63]
    ds_read_b128 v[80:83], v159 offset:0
    v_mfma_f32_16x16x32_bf16 v[56:59], a[216:219], v[108:111], v[56:59]
    ds_read_b128 v[84:87], v159 offset:6144
    v_and_b32 v193, 0xffff0000, v160
    v_lshlrev_b32 v192, 16, v160
    v_mfma_f32_16x16x32_bf16 v[56:59], a[208:211], v[104:107], v[56:59]
    ds_read_b128 v[88:91], v159 offset:256
    v_and_b32 v195, 0xffff0000, v161
    v_lshlrev_b32 v194, 16, v161
    v_mfma_f32_16x16x32_bf16 v[64:67], a[208:211], v[112:115], v[64:67]
    ds_read_b128 v[92:95], v159 offset:6400
    v_add_f32 v32, v32, v192
    v_mfma_f32_16x16x32_bf16 v[64:67], a[216:219], v[116:119], v[64:67]
    ds_read_b128 v[96:99], v159 offset:512
    v_add_f32 v33, v33, v193
    v_add_f32 v34, v34, v194
    v_mfma_f32_16x16x32_bf16 v[68:71], a[220:223], v[116:119], v[68:71]
    ds_read_b128 v[100:103], v159 offset:6656
    v_add_f32 v35, v35, v195
    v_and_b32 v197, 0xffff0000, v162
    v_mfma_f32_16x16x32_bf16 v[68:71], a[212:215], v[112:115], v[68:71]
    ds_read_b64_tr_b16 a[48:49], v10 offset:32768
    v_lshlrev_b32 v196, 16, v162
    v_and_b32 v199, 0xffff0000, v163
    v_mfma_f32_16x16x32_bf16 v[76:79], a[212:215], v[120:123], v[76:79]
    ds_read_b64_tr_b16 a[50:51], v10 offset:34816
    v_lshlrev_b32 v198, 16, v163
    v_mfma_f32_16x16x32_bf16 v[76:79], a[220:223], v[124:127], v[76:79]
    v_add_f32 v36, v36, v196
    v_add_f32 v37, v37, v197
    v_mfma_f32_16x16x32_bf16 v[72:75], a[216:219], v[124:127], v[72:75]
    ds_read_b64_tr_b16 a[56:57], v10 offset:36864
    v_add_f32 v38, v38, v198
    v_add_f32 v39, v39, v199
    v_mfma_f32_16x16x32_bf16 v[72:75], a[208:211], v[120:123], v[72:75]
    ds_read_b64_tr_b16 a[58:59], v10 offset:38912
    s_waitcnt lgkmcnt(4)
    v_mfma_f32_16x16x32_bf16 v[32:35], a[224:227], v[80:83], v[32:35]
    s_add_u32 m0, s73, 0
    s_lshl_b32 s14, s90, 18
    v_mfma_f32_16x16x32_bf16 v[32:35], a[232:235], v[84:87], v[32:35]
    ds_read_b128 v[104:107], v159 offset:768
    v_mfma_f32_16x16x32_bf16 v[36:39], a[236:239], v[84:87], v[36:39]
    ds_read_b128 v[108:111], v159 offset:6912
    buffer_load_dwordx4 v4, s[52:55], s14 offen offset:0 lds
    v_and_b32 v193, 0xffff0000, v176
    v_lshlrev_b32 v192, 16, v176
    v_mfma_f32_16x16x32_bf16 v[36:39], a[228:231], v[80:83], v[36:39]
    ds_read_b128 v[112:115], v159 offset:1024
    v_and_b32 v195, 0xffff0000, v177
    v_lshlrev_b32 v194, 16, v177
    v_mfma_f32_16x16x32_bf16 v[44:47], a[228:231], v[88:91], v[44:47]
    ds_read_b128 v[116:119], v159 offset:7168
    buffer_load_dwordx4 v5, s[52:55], s14 offen offset:1024 lds
    v_add_f32 v64, v64, v192
    v_mfma_f32_16x16x32_bf16 v[44:47], a[236:239], v[92:95], v[44:47]
    ds_read_b128 v[120:123], v159 offset:1280
    v_add_f32 v65, v65, v193
    v_add_f32 v66, v66, v194
    v_mfma_f32_16x16x32_bf16 v[40:43], a[232:235], v[92:95], v[40:43]
    ds_read_b128 v[124:127], v159 offset:7424
    v_add_f32 v67, v67, v195
    v_and_b32 v197, 0xffff0000, v178
    v_mfma_f32_16x16x32_bf16 v[40:43], a[224:227], v[88:91], v[40:43]
    ds_read_b64_tr_b16 a[52:53], v11 offset:32768
    buffer_load_dwordx4 v6, s[52:55], s14 offen offset:2048 lds
    v_lshlrev_b32 v196, 16, v178
    v_and_b32 v199, 0xffff0000, v179
    v_mfma_f32_16x16x32_bf16 v[48:51], a[224:227], v[96:99], v[48:51]
    ds_read_b64_tr_b16 a[54:55], v11 offset:34816
    v_lshlrev_b32 v198, 16, v179
    v_mfma_f32_16x16x32_bf16 v[48:51], a[232:235], v[100:103], v[48:51]
    buffer_load_dwordx4 v7, s[52:55], s14 offen offset:3072 lds
    v_add_f32 v68, v68, v196
    v_add_f32 v69, v69, v197
    v_mfma_f32_16x16x32_bf16 v[52:55], a[236:239], v[100:103], v[52:55]
    ds_read_b64_tr_b16 a[60:61], v11 offset:36864
    v_add_f32 v70, v70, v198
    v_add_f32 v71, v71, v199
    v_mfma_f32_16x16x32_bf16 v[52:55], a[228:231], v[96:99], v[52:55]
    ds_read_b64_tr_b16 a[62:63], v11 offset:38912
    s_waitcnt lgkmcnt(4)
    v_mfma_f32_16x16x32_bf16 v[60:63], a[228:231], v[104:107], v[60:63]
    s_waitcnt vmcnt(12)
    s_barrier
    v_mfma_f32_16x16x32_bf16 v[60:63], a[236:239], v[108:111], v[60:63]
    ds_read_b128 v[80:83], v159 offset:12288
    v_mfma_f32_16x16x32_bf16 v[56:59], a[232:235], v[108:111], v[56:59]
    ds_read_b128 v[84:87], v159 offset:18432
    v_and_b32 v193, 0xffff0000, v164
    v_lshlrev_b32 v192, 16, v164
    v_mfma_f32_16x16x32_bf16 v[56:59], a[224:227], v[104:107], v[56:59]
    ds_read_b128 v[88:91], v159 offset:12544
    v_and_b32 v195, 0xffff0000, v165
    v_lshlrev_b32 v194, 16, v165
    v_mfma_f32_16x16x32_bf16 v[64:67], a[224:227], v[112:115], v[64:67]
    ds_read_b128 v[92:95], v159 offset:18688
    v_add_f32 v40, v40, v192
    v_mfma_f32_16x16x32_bf16 v[64:67], a[232:235], v[116:119], v[64:67]
    ds_read_b128 v[96:99], v159 offset:12800
    v_add_f32 v41, v41, v193
    v_add_f32 v42, v42, v194
    v_mfma_f32_16x16x32_bf16 v[68:71], a[236:239], v[116:119], v[68:71]
    ds_read_b128 v[100:103], v159 offset:18944
    v_add_f32 v43, v43, v195
    v_mfma_f32_16x16x32_bf16 v[68:71], a[228:231], v[112:115], v[68:71]
    v_and_b32 v197, 0xffff0000, v166
    v_lshlrev_b32 v196, 16, v166
    v_mfma_f32_16x16x32_bf16 v[76:79], a[228:231], v[120:123], v[76:79]
    v_and_b32 v199, 0xffff0000, v167
    v_lshlrev_b32 v198, 16, v167
    v_mfma_f32_16x16x32_bf16 v[76:79], a[236:239], v[124:127], v[76:79]
    v_add_f32 v44, v44, v196
    v_add_f32 v45, v45, v197
    v_mfma_f32_16x16x32_bf16 v[72:75], a[232:235], v[124:127], v[72:75]
    v_add_f32 v46, v46, v198
    v_add_f32 v47, v47, v199
    v_mfma_f32_16x16x32_bf16 v[72:75], a[224:227], v[120:123], v[72:75]
    s_waitcnt lgkmcnt(0)
    v_mfma_f32_16x16x32_bf16 v[32:35], a[240:243], v[80:83], v[32:35]
    s_add_u32 m0, s73, 16384
    s_lshl_b32 s14, s91, 18
    v_mfma_f32_16x16x32_bf16 v[32:35], a[248:251], v[84:87], v[32:35]
    ds_read_b128 v[104:107], v159 offset:13056
    v_mfma_f32_16x16x32_bf16 v[36:39], a[252:255], v[84:87], v[36:39]
    ds_read_b128 v[108:111], v159 offset:19200
    buffer_load_dwordx4 v4, s[52:55], s14 offen offset:0 lds
    v_and_b32 v193, 0xffff0000, v180
    v_lshlrev_b32 v192, 16, v180
    v_mfma_f32_16x16x32_bf16 v[36:39], a[244:247], v[80:83], v[36:39]
    ds_read_b128 v[112:115], v159 offset:13312
    v_and_b32 v195, 0xffff0000, v181
    v_lshlrev_b32 v194, 16, v181
    v_mfma_f32_16x16x32_bf16 v[44:47], a[244:247], v[88:91], v[44:47]
    ds_read_b128 v[116:119], v159 offset:19456
    buffer_load_dwordx4 v5, s[52:55], s14 offen offset:1024 lds
    v_add_f32 v72, v72, v192
    v_mfma_f32_16x16x32_bf16 v[44:47], a[252:255], v[92:95], v[44:47]
    ds_read_b128 v[120:123], v159 offset:13568
    v_add_f32 v73, v73, v193
    v_add_f32 v74, v74, v194
    v_mfma_f32_16x16x32_bf16 v[40:43], a[248:251], v[92:95], v[40:43]
    ds_read_b128 v[124:127], v159 offset:19712
    v_add_f32 v75, v75, v195
    v_and_b32 v197, 0xffff0000, v182
    v_mfma_f32_16x16x32_bf16 v[40:43], a[240:243], v[88:91], v[40:43]
    buffer_load_dwordx4 v6, s[52:55], s14 offen offset:2048 lds
    v_lshlrev_b32 v196, 16, v182
    v_and_b32 v199, 0xffff0000, v183
    v_mfma_f32_16x16x32_bf16 v[48:51], a[240:243], v[96:99], v[48:51]
    v_lshlrev_b32 v198, 16, v183
    v_add_f32 v76, v76, v196
    v_mfma_f32_16x16x32_bf16 v[48:51], a[248:251], v[100:103], v[48:51]
    buffer_load_dwordx4 v7, s[52:55], s14 offen offset:3072 lds
    v_add_f32 v77, v77, v197
    v_mfma_f32_16x16x32_bf16 v[52:55], a[252:255], v[100:103], v[52:55]
    v_add_f32 v78, v78, v198
    v_add_f32 v79, v79, v199
    v_mfma_f32_16x16x32_bf16 v[52:55], a[244:247], v[96:99], v[52:55]
    s_waitcnt lgkmcnt(0)
    v_mfma_f32_16x16x32_bf16 v[60:63], a[244:247], v[104:107], v[60:63]
    s_barrier
    v_mfma_f32_16x16x32_bf16 v[60:63], a[252:255], v[108:111], v[60:63]
    s_add_u32 m0, s73, 131072
    s_lshl_b32 s14, s92, 18
    v_mfma_f32_16x16x32_bf16 v[56:59], a[248:251], v[108:111], v[56:59]
    buffer_load_dwordx4 v4, s[52:55], s14 offen offset:0 lds
    v_and_b32 v193, 0xffff0000, v168
    v_lshlrev_b32 v192, 16, v168
    v_mfma_f32_16x16x32_bf16 v[56:59], a[240:243], v[104:107], v[56:59]
    buffer_load_dwordx4 v5, s[52:55], s14 offen offset:1024 lds
    v_and_b32 v195, 0xffff0000, v169
    v_lshlrev_b32 v194, 16, v169
    v_mfma_f32_16x16x32_bf16 v[64:67], a[240:243], v[112:115], v[64:67]
    buffer_load_dwordx4 v6, s[52:55], s14 offen offset:2048 lds
    v_add_f32 v48, v48, v192
    v_mfma_f32_16x16x32_bf16 v[64:67], a[248:251], v[116:119], v[64:67]
    buffer_load_dwordx4 v7, s[52:55], s14 offen offset:3072 lds
    v_add_f32 v49, v49, v193
    v_add_f32 v50, v50, v194
    v_mfma_f32_16x16x32_bf16 v[68:71], a[252:255], v[116:119], v[68:71]
    s_add_u32 m0, s73, 147456
    s_lshl_b32 s14, s93, 18
    v_add_f32 v51, v51, v195
    v_and_b32 v197, 0xffff0000, v170
    v_mfma_f32_16x16x32_bf16 v[68:71], a[244:247], v[112:115], v[68:71]
    buffer_load_dwordx4 v4, s[52:55], s14 offen offset:0 lds
    v_lshlrev_b32 v196, 16, v170
    v_and_b32 v199, 0xffff0000, v171
    v_mfma_f32_16x16x32_bf16 v[76:79], a[244:247], v[120:123], v[76:79]
    buffer_load_dwordx4 v5, s[52:55], s14 offen offset:1024 lds
    v_lshlrev_b32 v198, 16, v171
    v_mfma_f32_16x16x32_bf16 v[76:79], a[252:255], v[124:127], v[76:79]
    buffer_load_dwordx4 v6, s[52:55], s14 offen offset:2048 lds
    v_add_f32 v52, v52, v196
    v_add_f32 v53, v53, v197
    v_mfma_f32_16x16x32_bf16 v[72:75], a[248:251], v[124:127], v[72:75]
    buffer_load_dwordx4 v7, s[52:55], s14 offen offset:3072 lds
    v_add_f32 v54, v54, v198
    v_add_f32 v55, v55, v199
    v_mfma_f32_16x16x32_bf16 v[72:75], a[240:243], v[120:123], v[72:75]
    s_waitcnt lgkmcnt(0)
    v_mov_b32 v88, 0xc0135761
    s_mov_b32 s10, 0xbdd2d3e8
    s_lshl_b32 s9, s69, 2
    s_add_u32 s9, s9, s3
    s_mul_i32 s9, s9, 69632
    s_add_u32 s9, s9, 12795904
    v_pk_mul_f32 v[160:161], v[32:33], v[32:33]
    v_pk_mul_f32 v[162:163], v[34:35], v[34:35]
    v_pk_mul_f32 v[164:165], v[36:37], v[36:37]
    v_pk_mul_f32 v[166:167], v[38:39], v[38:39]
    v_pk_mul_f32 v[168:169], v[40:41], v[40:41]
    v_pk_mul_f32 v[170:171], v[42:43], v[42:43]
    v_pk_mul_f32 v[172:173], v[44:45], v[44:45]
    v_pk_mul_f32 v[174:175], v[46:47], v[46:47]
    v_pk_fma_f32 v[160:161], v[160:161], s[10:11], v[88:89] op_sel_hi:[1,0,0]
    v_pk_fma_f32 v[162:163], v[162:163], s[10:11], v[88:89] op_sel_hi:[1,0,0]
L_pl_G_5:
    s_cbranch_execz L_wret
    v_pk_fma_f32 v[164:165], v[164:165], s[10:11], v[88:89] op_sel_hi:[1,0,0]
    v_pk_fma_f32 v[166:167], v[166:167], s[10:11], v[88:89] op_sel_hi:[1,0,0]
    v_pk_fma_f32 v[168:169], v[168:169], s[10:11], v[88:89] op_sel_hi:[1,0,0]
    v_pk_fma_f32 v[170:171], v[170:171], s[10:11], v[88:89] op_sel_hi:[1,0,0]
    v_pk_fma_f32 v[172:173], v[172:173], s[10:11], v[88:89] op_sel_hi:[1,0,0]
    v_pk_fma_f32 v[174:175], v[174:175], s[10:11], v[88:89] op_sel_hi:[1,0,0]
    v_pk_mul_f32 v[160:161], v[160:161], v[32:33]
    v_pk_mul_f32 v[162:163], v[162:163], v[34:35]
    v_pk_mul_f32 v[164:165], v[164:165], v[36:37]
    v_pk_mul_f32 v[166:167], v[166:167], v[38:39]
    v_pk_mul_f32 v[168:169], v[168:169], v[40:41]
    v_pk_mul_f32 v[170:171], v[170:171], v[42:43]
    v_pk_mul_f32 v[172:173], v[172:173], v[44:45]
    v_pk_mul_f32 v[174:175], v[174:175], v[46:47]
    v_exp_f32 v160, v160
    v_exp_f32 v161, v161
    v_exp_f32 v162, v162
    v_exp_f32 v163, v163
    v_exp_f32 v164, v164
    v_exp_f32 v165, v165
    v_exp_f32 v166, v166
    v_exp_f32 v167, v167
    v_exp_f32 v168, v168
    v_exp_f32 v169, v169
    v_exp_f32 v170, v170
    v_exp_f32 v171, v171
    v_exp_f32 v172, v172
    v_exp_f32 v173, v173
    v_exp_f32 v174, v174
    v_exp_f32 v175, v175
    v_pk_add_f32 v[160:161], v[160:161], 1.0 op_sel_hi:[1,0]
    v_pk_add_f32 v[162:163], v[162:163], 1.0 op_sel_hi:[1,0]
    v_pk_add_f32 v[164:165], v[164:165], 1.0 op_sel_hi:[1,0]
    v_pk_add_f32 v[166:167], v[166:167], 1.0 op_sel_hi:[1,0]
    v_pk_add_f32 v[168:169], v[168:169], 1.0 op_sel_hi:[1,0]
    v_pk_add_f32 v[170:171], v[170:171], 1.0 op_sel_hi:[1,0]
    v_pk_add_f32 v[172:173], v[172:173], 1.0 op_sel_hi:[1,0]
    v_pk_add_f32 v[174:175], v[174:175], 1.0 op_sel_hi:[1,0]
    v_rcp_f32 v160, v160
    v_rcp_f32 v161, v161
    v_rcp_f32 v162, v162
    v_rcp_f32 v163, v163
    v_rcp_f32 v164, v164
    v_rcp_f32 v165, v165
    v_rcp_f32 v166, v166
    v_rcp_f32 v167, v167
    v_rcp_f32 v168, v168
    v_rcp_f32 v169, v169
    v_rcp_f32 v170, v170
    v_rcp_f32 v171, v171
    v_rcp_f32 v172, v172
    v_rcp_f32 v173, v173
    v_rcp_f32 v174, v174
    v_rcp_f32 v175, v175
    v_pk_mul_f32 v[32:33], v[32:33], v[160:161]
    v_pk_mul_f32 v[34:35], v[34:35], v[162:163]
    v_pk_mul_f32 v[36:37], v[36:37], v[164:165]
    v_pk_mul_f32 v[38:39], v[38:39], v[166:167]
    v_pk_mul_f32 v[40:41], v[40:41], v[168:169]
    v_pk_mul_f32 v[42:43], v[42:43], v[170:171]
    v_pk_mul_f32 v[44:45], v[44:45], v[172:173]
    v_pk_mul_f32 v[46:47], v[46:47], v[174:175]
    v_cvt_pk_bf16_f32 v96, v32, v33
    v_cvt_pk_bf16_f32 v97, v34, v35
    v_cvt_pk_bf16_f32 v98, v36, v37
    v_cvt_pk_bf16_f32 v99, v38, v39
    v_cvt_pk_bf16_f32 v100, v40, v41
    v_cvt_pk_bf16_f32 v101, v42, v43
    v_cvt_pk_bf16_f32 v102, v44, v45
    v_cvt_pk_bf16_f32 v103, v46, v47
    buffer_store_dwordx4 v[96:99], v240, s[44:47], s9 offen sc1
    buffer_store_dwordx4 v[100:103], v241, s[44:47], s9 offen sc1
    v_pk_mul_f32 v[160:161], v[48:49], v[48:49]
    v_pk_mul_f32 v[162:163], v[50:51], v[50:51]
    v_pk_mul_f32 v[164:165], v[52:53], v[52:53]
    v_pk_mul_f32 v[166:167], v[54:55], v[54:55]
    v_pk_mul_f32 v[168:169], v[56:57], v[56:57]
    v_pk_mul_f32 v[170:171], v[58:59], v[58:59]
    v_pk_mul_f32 v[172:173], v[60:61], v[60:61]
    v_pk_mul_f32 v[174:175], v[62:63], v[62:63]
    v_pk_fma_f32 v[160:161], v[160:161], s[10:11], v[88:89] op_sel_hi:[1,0,0]
    v_pk_fma_f32 v[162:163], v[162:163], s[10:11], v[88:89] op_sel_hi:[1,0,0]
    v_pk_fma_f32 v[164:165], v[164:165], s[10:11], v[88:89] op_sel_hi:[1,0,0]
    v_pk_fma_f32 v[166:167], v[166:167], s[10:11], v[88:89] op_sel_hi:[1,0,0]
    v_pk_fma_f32 v[168:169], v[168:169], s[10:11], v[88:89] op_sel_hi:[1,0,0]
    v_pk_fma_f32 v[170:171], v[170:171], s[10:11], v[88:89] op_sel_hi:[1,0,0]
    v_pk_fma_f32 v[172:173], v[172:173], s[10:11], v[88:89] op_sel_hi:[1,0,0]
    v_pk_fma_f32 v[174:175], v[174:175], s[10:11], v[88:89] op_sel_hi:[1,0,0]
    v_pk_mul_f32 v[160:161], v[160:161], v[48:49]
    v_pk_mul_f32 v[162:163], v[162:163], v[50:51]
    v_pk_mul_f32 v[164:165], v[164:165], v[52:53]
    v_pk_mul_f32 v[166:167], v[166:167], v[54:55]
    v_pk_mul_f32 v[168:169], v[168:169], v[56:57]
    v_pk_mul_f32 v[170:171], v[170:171], v[58:59]
    v_pk_mul_f32 v[172:173], v[172:173], v[60:61]
    v_pk_mul_f32 v[174:175], v[174:175], v[62:63]
    v_exp_f32 v160, v160
    v_exp_f32 v161, v161
    v_exp_f32 v162, v162
    v_exp_f32 v163, v163
    v_exp_f32 v164, v164
    v_exp_f32 v165, v165
    v_exp_f32 v166, v166
    v_exp_f32 v167, v167
    v_exp_f32 v168, v168
    v_exp_f32 v169, v169
    v_exp_f32 v170, v170
    v_exp_f32 v171, v171
    v_exp_f32 v172, v172
    v_exp_f32 v173, v173
    v_exp_f32 v174, v174
    v_exp_f32 v175, v175
    v_pk_add_f32 v[160:161], v[160:161], 1.0 op_sel_hi:[1,0]
    v_pk_add_f32 v[162:163], v[162:163], 1.0 op_sel_hi:[1,0]
    v_pk_add_f32 v[164:165], v[164:165], 1.0 op_sel_hi:[1,0]
    v_pk_add_f32 v[166:167], v[166:167], 1.0 op_sel_hi:[1,0]
    v_pk_add_f32 v[168:169], v[168:169], 1.0 op_sel_hi:[1,0]
    v_pk_add_f32 v[170:171], v[170:171], 1.0 op_sel_hi:[1,0]
    v_pk_add_f32 v[172:173], v[172:173], 1.0 op_sel_hi:[1,0]
    v_pk_add_f32 v[174:175], v[174:175], 1.0 op_sel_hi:[1,0]
    v_rcp_f32 v160, v160
    v_rcp_f32 v161, v161
    v_rcp_f32 v162, v162
    v_rcp_f32 v163, v163
    v_rcp_f32 v164, v164
    v_rcp_f32 v165, v165
    v_rcp_f32 v166, v166
    v_rcp_f32 v167, v167
    v_rcp_f32 v168, v168
    v_rcp_f32 v169, v169
    v_rcp_f32 v170, v170
    v_rcp_f32 v171, v171
    v_rcp_f32 v172, v172
    v_rcp_f32 v173, v173
    v_rcp_f32 v174, v174
    v_rcp_f32 v175, v175
    v_pk_mul_f32 v[48:49], v[48:49], v[160:161]
    v_pk_mul_f32 v[50:51], v[50:51], v[162:163]
    v_pk_mul_f32 v[52:53], v[52:53], v[164:165]
    v_pk_mul_f32 v[54:55], v[54:55], v[166:167]
    v_pk_mul_f32 v[56:57], v[56:57], v[168:169]
    v_pk_mul_f32 v[58:59], v[58:59], v[170:171]
    v_pk_mul_f32 v[60:61], v[60:61], v[172:173]
    v_pk_mul_f32 v[62:63], v[62:63], v[174:175]
    v_cvt_pk_bf16_f32 v104, v48, v49
    v_cvt_pk_bf16_f32 v105, v50, v51
    v_cvt_pk_bf16_f32 v106, v52, v53
    v_cvt_pk_bf16_f32 v107, v54, v55
    v_cvt_pk_bf16_f32 v108, v56, v57
    v_cvt_pk_bf16_f32 v109, v58, v59
    v_cvt_pk_bf16_f32 v110, v60, v61
    v_cvt_pk_bf16_f32 v111, v62, v63
    buffer_store_dwordx4 v[104:107], v242, s[44:47], s9 offen sc1
    buffer_store_dwordx4 v[108:111], v243, s[44:47], s9 offen sc1
    v_pk_mul_f32 v[160:161], v[64:65], v[64:65]
    v_pk_mul_f32 v[162:163], v[66:67], v[66:67]
    v_pk_mul_f32 v[164:165], v[68:69], v[68:69]
    v_pk_mul_f32 v[166:167], v[70:71], v[70:71]
    v_pk_mul_f32 v[168:169], v[72:73], v[72:73]
    v_pk_mul_f32 v[170:171], v[74:75], v[74:75]
    v_pk_mul_f32 v[172:173], v[76:77], v[76:77]
    v_pk_mul_f32 v[174:175], v[78:79], v[78:79]
    v_pk_fma_f32 v[160:161], v[160:161], s[10:11], v[88:89] op_sel_hi:[1,0,0]
    v_pk_fma_f32 v[162:163], v[162:163], s[10:11], v[88:89] op_sel_hi:[1,0,0]
    v_pk_fma_f32 v[164:165], v[164:165], s[10:11], v[88:89] op_sel_hi:[1,0,0]
    v_pk_fma_f32 v[166:167], v[166:167], s[10:11], v[88:89] op_sel_hi:[1,0,0]
    v_pk_fma_f32 v[168:169], v[168:169], s[10:11], v[88:89] op_sel_hi:[1,0,0]
    v_pk_fma_f32 v[170:171], v[170:171], s[10:11], v[88:89] op_sel_hi:[1,0,0]
    v_pk_fma_f32 v[172:173], v[172:173], s[10:11], v[88:89] op_sel_hi:[1,0,0]
    v_pk_fma_f32 v[174:175], v[174:175], s[10:11], v[88:89] op_sel_hi:[1,0,0]
    v_pk_mul_f32 v[160:161], v[160:161], v[64:65]
    v_pk_mul_f32 v[162:163], v[162:163], v[66:67]
    v_pk_mul_f32 v[164:165], v[164:165], v[68:69]
    v_pk_mul_f32 v[166:167], v[166:167], v[70:71]
    v_pk_mul_f32 v[168:169], v[168:169], v[72:73]
    v_pk_mul_f32 v[170:171], v[170:171], v[74:75]
    v_pk_mul_f32 v[172:173], v[172:173], v[76:77]
    v_pk_mul_f32 v[174:175], v[174:175], v[78:79]
    v_exp_f32 v160, v160
    v_exp_f32 v161, v161
    v_exp_f32 v162, v162
    v_exp_f32 v163, v163
    v_exp_f32 v164, v164
    v_exp_f32 v165, v165
    v_exp_f32 v166, v166
    v_exp_f32 v167, v167
    v_exp_f32 v168, v168
    v_exp_f32 v169, v169
    v_exp_f32 v170, v170
    v_exp_f32 v171, v171
    v_exp_f32 v172, v172
    v_exp_f32 v173, v173
    v_exp_f32 v174, v174
    v_exp_f32 v175, v175
    v_pk_add_f32 v[160:161], v[160:161], 1.0 op_sel_hi:[1,0]
    v_pk_add_f32 v[162:163], v[162:163], 1.0 op_sel_hi:[1,0]
    v_pk_add_f32 v[164:165], v[164:165], 1.0 op_sel_hi:[1,0]
    v_pk_add_f32 v[166:167], v[166:167], 1.0 op_sel_hi:[1,0]
    v_pk_add_f32 v[168:169], v[168:169], 1.0 op_sel_hi:[1,0]
    v_pk_add_f32 v[170:171], v[170:171], 1.0 op_sel_hi:[1,0]
    v_pk_add_f32 v[172:173], v[172:173], 1.0 op_sel_hi:[1,0]
    v_pk_add_f32 v[174:175], v[174:175], 1.0 op_sel_hi:[1,0]
    v_rcp_f32 v160, v160
    v_rcp_f32 v161, v161
    v_rcp_f32 v162, v162
    v_rcp_f32 v163, v163
    v_rcp_f32 v164, v164
    v_rcp_f32 v165, v165
    v_rcp_f32 v166, v166
    v_rcp_f32 v167, v167
    v_rcp_f32 v168, v168
    v_rcp_f32 v169, v169
    v_rcp_f32 v170, v170
    v_rcp_f32 v171, v171
    v_rcp_f32 v172, v172
    v_rcp_f32 v173, v173
    v_rcp_f32 v174, v174
    v_rcp_f32 v175, v175
    v_pk_mul_f32 v[64:65], v[64:65], v[160:161]
    v_pk_mul_f32 v[66:67], v[66:67], v[162:163]
    v_pk_mul_f32 v[68:69], v[68:69], v[164:165]
    v_pk_mul_f32 v[70:71], v[70:71], v[166:167]
    v_pk_mul_f32 v[72:73], v[72:73], v[168:169]
    v_pk_mul_f32 v[74:75], v[74:75], v[170:171]
    v_pk_mul_f32 v[76:77], v[76:77], v[172:173]
    v_pk_mul_f32 v[78:79], v[78:79], v[174:175]
    v_cvt_pk_bf16_f32 v112, v64, v65
    v_cvt_pk_bf16_f32 v113, v66, v67
    v_cvt_pk_bf16_f32 v114, v68, v69
    v_cvt_pk_bf16_f32 v115, v70, v71
    v_cvt_pk_bf16_f32 v116, v72, v73
    v_cvt_pk_bf16_f32 v117, v74, v75
    v_cvt_pk_bf16_f32 v118, v76, v77
    v_cvt_pk_bf16_f32 v119, v78, v79
    buffer_store_dwordx4 v[112:115], v244, s[44:47], s9 offen sc1
    buffer_store_dwordx4 v[116:119], v245, s[44:47], s9 offen sc1
    s_waitcnt vmcnt(6)
    s_barrier
    ds_read_b64_tr_b16 a[64:65], v10 offset:49152
    s_add_u32 m0, s73, 32768
    s_lshl_b32 s14, s94, 18
    ds_read_b64_tr_b16 a[66:67], v10 offset:51200
    ds_read_b64_tr_b16 a[72:73], v10 offset:53248
    ds_read_b64_tr_b16 a[74:75], v10 offset:55296
    ds_read_b64_tr_b16 a[68:69], v11 offset:49152
    buffer_load_dwordx4 v4, s[52:55], s14 offen offset:0 lds
    ds_read_b64_tr_b16 a[70:71], v11 offset:51200
    ds_read_b64_tr_b16 a[76:77], v11 offset:53248
    ds_read_b64_tr_b16 a[78:79], v11 offset:55296
    v_add_u32 v10, 65536, v10
    ds_read_b64_tr_b16 a[80:81], v10 offset:0
    ds_read_b64_tr_b16 a[82:83], v10 offset:2048
    buffer_load_dwordx4 v5, s[52:55], s14 offen offset:1024 lds
    ds_read_b64_tr_b16 a[88:89], v10 offset:4096
    ds_read_b64_tr_b16 a[90:91], v10 offset:6144
    v_add_u32 v11, 65536, v11
    ds_read_b64_tr_b16 a[84:85], v11 offset:0
    ds_read_b64_tr_b16 a[86:87], v11 offset:2048
    ds_read_b64_tr_b16 a[92:93], v11 offset:4096
    buffer_load_dwordx4 v6, s[52:55], s14 offen offset:2048 lds
    ds_read_b64_tr_b16 a[94:95], v11 offset:6144
    v_add_u32 v10, -65536, v10
    ds_read_b64_tr_b16 a[96:97], v10 offset:0
    ds_read_b64_tr_b16 a[98:99], v10 offset:2048
    ds_read_b64_tr_b16 a[104:105], v10 offset:4096
    ds_read_b64_tr_b16 a[106:107], v10 offset:6144
    buffer_load_dwordx4 v7, s[52:55], s14 offen offset:3072 lds
    v_add_u32 v11, -65536, v11
    ds_read_b64_tr_b16 a[100:101], v11 offset:0
    ds_read_b64_tr_b16 a[102:103], v11 offset:2048
    ds_read_b64_tr_b16 a[108:109], v11 offset:4096
    ds_read_b64_tr_b16 a[110:111], v11 offset:6144
    ds_read_b64_tr_b16 a[112:113], v10 offset:16384
    s_add_u32 m0, s73, 81920
    s_lshl_b32 s14, s95, 18
    ds_read_b64_tr_b16 a[114:115], v10 offset:18432
    ds_read_b64_tr_b16 a[120:121], v10 offset:20480
    ds_read_b64_tr_b16 a[122:123], v10 offset:22528
    ds_read_b64_tr_b16 a[116:117], v11 offset:16384
    buffer_load_dwordx4 v4, s[52:55], s14 offen offset:0 lds
    ds_read_b64_tr_b16 a[118:119], v11 offset:18432
    ds_read_b64_tr_b16 a[124:125], v11 offset:20480
    ds_read_b64_tr_b16 a[126:127], v11 offset:22528
    v_add_u32 v10, 131072, v10
    ds_read_b64_tr_b16 a[128:129], v10 offset:0
    ds_read_b64_tr_b16 a[130:131], v10 offset:2048
    buffer_load_dwordx4 v5, s[52:55], s14 offen offset:1024 lds
    ds_read_b64_tr_b16 a[136:137], v10 offset:4096
    ds_read_b64_tr_b16 a[138:139], v10 offset:6144
    v_add_u32 v11, 131072, v11
    ds_read_b64_tr_b16 a[132:133], v11 offset:0
    ds_read_b64_tr_b16 a[134:135], v11 offset:2048
    ds_read_b64_tr_b16 a[140:141], v11 offset:4096
    buffer_load_dwordx4 v6, s[52:55], s14 offen offset:2048 lds
    ds_read_b64_tr_b16 a[142:143], v11 offset:6144
    ds_read_b64_tr_b16 a[144:145], v10 offset:16384
    ds_read_b64_tr_b16 a[146:147], v10 offset:18432
    ds_read_b64_tr_b16 a[152:153], v10 offset:20480
    ds_read_b64_tr_b16 a[154:155], v10 offset:22528
    buffer_load_dwordx4 v7, s[52:55], s14 offen offset:3072 lds
    ds_read_b64_tr_b16 a[148:149], v11 offset:16384
    ds_read_b64_tr_b16 a[150:151], v11 offset:18432
    ds_read_b64_tr_b16 a[156:157], v11 offset:20480
    ds_read_b64_tr_b16 a[158:159], v11 offset:22528
    s_bitcmp1_b32 s3, 1
    s_cselect_b32 s18, s85, s84
    s_mul_i32 s18, s18, 139264
    s_cselect_b32 s19, s87, s86
    s_mul_i32 s19, s19, 139264
    s_cselect_b32 s20, s89, s88
    s_mul_i32 s20, s20, 139264
    s_cselect_b32 s21, s91, s90
    s_mul_i32 s21, s21, 139264
    s_cselect_b32 s22, s93, s92
    s_mul_i32 s22, s22, 139264
    s_cselect_b32 s23, s95, s94
    s_mul_i32 s23, s23, 139264
    s_cselect_b32 s24, s97, s96
    s_mul_i32 s24, s24, 139264
    s_cselect_b32 s25, s99, s98
    s_mul_i32 s25, s25, 139264
    s_cselect_b32 s26, s101, s100
    s_mul_i32 s26, s26, 139264
    s_waitcnt vmcnt(8) lgkmcnt(0)
    s_barrier
    buffer_store_dword v249, v17, s[44:47], 0 offen sc1
    s_add_u32 m0, s73, 0
    s_lshl_b32 s14, s96, 18
    buffer_load_dwordx4 v4, s[52:55], s14 offen offset:0 lds
    buffer_load_dwordx4 v5, s[52:55], s14 offen offset:1024 lds
    buffer_load_dwordx4 v6, s[52:55], s14 offen offset:2048 lds
    buffer_load_dwordx4 v7, s[52:55], s14 offen offset:3072 lds
    s_add_u32 m0, s73, 16384
    s_lshl_b32 s14, s97, 18
    buffer_load_dwordx4 v4, s[52:55], s14 offen offset:0 lds
    buffer_load_dwordx4 v5, s[52:55], s14 offen offset:1024 lds
    buffer_load_dwordx4 v6, s[52:55], s14 offen offset:2048 lds
    buffer_load_dwordx4 v7, s[52:55], s14 offen offset:3072 lds
    v_mov_b32 v16, 0
    buffer_atomic_add v16, v15, s[44:47], 0 offen sc0 sc1
    s_add_u32 m0, s73, 49152
    s_lshl_b32 s14, s98, 18
    buffer_load_dwordx4 v4, s[52:55], s14 offen offset:0 lds
    buffer_load_dwordx4 v5, s[52:55], s14 offen offset:1024 lds
    buffer_load_dwordx4 v6, s[52:55], s14 offen offset:2048 lds
    buffer_load_dwordx4 v7, s[52:55], s14 offen offset:3072 lds
    s_add_u32 m0, s73, 65536
    s_lshl_b32 s14, s99, 18
    buffer_load_dwordx4 v4, s[52:55], s14 offen offset:0 lds
    buffer_load_dwordx4 v5, s[52:55], s14 offen offset:1024 lds
    buffer_load_dwordx4 v6, s[52:55], s14 offen offset:2048 lds
    buffer_load_dwordx4 v7, s[52:55], s14 offen offset:3072 lds
L_DG:
    s_waitcnt vmcnt(8)
    v_cmp_ne_u32 vcc, v13, v16
    s_cbranch_vccnz L_rs_p2G
L_ok_p2G:
    s_barrier
    s_add_u32 m0, s73, 97536
    s_nop 0
    buffer_load_dwordx4 v23, s[44:47], s18 offen offset:768 sc1 lds
    s_add_u32 m0, s73, 99328
    s_nop 0
    buffer_load_dwordx4 v20, s[44:47], s18 offen offset:0 sc1 lds
    s_add_u32 m0, s73, 99840
    s_nop 0
    buffer_load_dwordx4 v20, s[44:47], s18 offen offset:512 sc1 lds
    s_add_u32 m0, s73, 100608
    s_nop 0
    buffer_load_dwordx4 v23, s[44:47], s19 offen offset:768 sc1 lds
    s_add_u32 m0, s73, 114688
    s_nop 0
    buffer_load_dwordx4 v20, s[44:47], s19 offen offset:0 sc1 lds
    s_add_u32 m0, s73, 115200
    s_nop 0
    buffer_load_dwordx4 v20, s[44:47], s19 offen offset:512 sc1 lds
    s_add_u32 m0, s73, 115968
    s_nop 0
    buffer_load_dwordx4 v23, s[44:47], s20 offen offset:768 sc1 lds
    s_add_u32 m0, s73, 117760
    s_nop 0
    buffer_load_dwordx4 v20, s[44:47], s20 offen offset:0 sc1 lds
    v_mov_b32 v195, s68
    v_mov_b32 v199, s68
    v_mov_b32 v202, s68
    v_mov_b32 v203, s68
    s_waitcnt vmcnt(4)
    s_barrier
    ds_read_b128 v[104:107], v14 offset:0
    ds_read_b128 v[108:111], v14 offset:4096
    ds_read_b128 v[112:115], v14 offset:8192
    ds_read_b128 v[116:119], v14 offset:12288
    s_waitcnt lgkmcnt(2)
    v_mfma_f32_16x16x32_bf16 v[32:35], v[104:107], a[0:3], 0
    s_add_u32 m0, s73, 130560
    v_mfma_f32_16x16x32_bf16 v[32:35], v[108:111], a[8:11], v[32:35]
    buffer_load_dwordx4 v20, s[44:47], s20 offen offset:512 sc1 lds
    s_waitcnt lgkmcnt(0)
    v_mfma_f32_16x16x32_bf16 v[32:35], v[112:115], a[16:19], v[32:35]
    ds_read_b128 v[120:123], v14 offset:1024
    v_mfma_f32_16x16x32_bf16 v[32:35], v[116:119], a[24:27], v[32:35]
    ds_read_b128 v[124:127], v14 offset:5120
    v_mfma_f32_16x16x32_bf16 v[36:39], v[116:119], a[28:31], 0
    ds_read_b128 v[128:131], v14 offset:9216
    v_mfma_f32_16x16x32_bf16 v[36:39], v[112:115], a[20:23], v[36:39]
    ds_read_b128 v[132:135], v14 offset:13312
    v_mfma_f32_16x16x32_bf16 v[36:39], v[108:111], a[12:15], v[36:39]
    s_add_u32 m0, s73, 131328
    v_mfma_f32_16x16x32_bf16 v[36:39], v[104:107], a[4:7], v[36:39]
    buffer_load_dwordx4 v23, s[44:47], s21 offen offset:768 sc1 lds
    s_waitcnt lgkmcnt(2)
    v_mfma_f32_16x16x32_bf16 v[44:47], v[120:123], a[4:7], 0
    s_add_u32 m0, s73, 133120
    v_mfma_f32_16x16x32_bf16 v[44:47], v[124:127], a[12:15], v[44:47]
    buffer_load_dwordx4 v20, s[44:47], s21 offen offset:0 sc1 lds
    s_waitcnt lgkmcnt(0)
    v_mfma_f32_16x16x32_bf16 v[44:47], v[128:131], a[20:23], v[44:47]
    ds_read_b128 v[104:107], v14 offset:2048
    v_mfma_f32_16x16x32_bf16 v[44:47], v[132:135], a[28:31], v[44:47]
    ds_read_b128 v[108:111], v14 offset:6144
    v_mfma_f32_16x16x32_bf16 v[40:43], v[132:135], a[24:27], 0
    ds_read_b128 v[112:115], v14 offset:10240
    v_mfma_f32_16x16x32_bf16 v[40:43], v[128:131], a[16:19], v[40:43]
    ds_read_b128 v[116:119], v14 offset:14336
    v_mfma_f32_16x16x32_bf16 v[40:43], v[124:127], a[8:11], v[40:43]
    s_add_u32 m0, s73, 133632
    v_mfma_f32_16x16x32_bf16 v[40:43], v[120:123], a[0:3], v[40:43]
    buffer_load_dwordx4 v20, s[44:47], s21 offen offset:512 sc1 lds
    s_waitcnt lgkmcnt(2)
    v_mfma_f32_16x16x32_bf16 v[48:51], v[104:107], a[0:3], 0
    s_add_u32 m0, s73, 146688
    v_mfma_f32_16x16x32_bf16 v[48:51], v[108:111], a[8:11], v[48:51]
    buffer_load_dwordx4 v23, s[44:47], s22 offen offset:768 sc1 lds
    s_waitcnt lgkmcnt(0)
    v_mfma_f32_16x16x32_bf16 v[48:51], v[112:115], a[16:19], v[48:51]
    ds_read_b128 v[120:123], v14 offset:3072
    v_mfma_f32_16x16x32_bf16 v[48:51], v[116:119], a[24:27], v[48:51]
    ds_read_b128 v[124:127], v14 offset:7168
    v_mfma_f32_16x16x32_bf16 v[52:55], v[116:119], a[28:31], 0
    ds_read_b128 v[128:131], v14 offset:11264
    v_mfma_f32_16x16x32_bf16 v[52:55], v[112:115], a[20:23], v[52:55]
    ds_read_b128 v[132:135], v14 offset:15360
    v_mfma_f32_16x16x32_bf16 v[52:55], v[108:111], a[12:15], v[52:55]
    s_add_u32 m0, s73, 148480
    v_mfma_f32_16x16x32_bf16 v[52:55], v[104:107], a[4:7], v[52:55]
    buffer_load_dwordx4 v20, s[44:47], s22 offen offset:0 sc1 lds
    s_waitcnt lgkmcnt(2)
    v_mfma_f32_16x16x32_bf16 v[36:39], v[120:123], a[36:39], v[36:39]
    s_add_u32 m0, s73, 148992
    v_mfma_f32_16x16x32_bf16 v[36:39], v[124:127], a[44:47], v[36:39]
    buffer_load_dwordx4 v20, s[44:47], s22 offen offset:512 sc1 lds
    s_waitcnt lgkmcnt(0)
    v_mfma_f32_16x16x32_bf16 v[36:39], v[128:131], a[52:55], v[36:39]
    s_waitcnt vmcnt(7)
    s_barrier
    v_mfma_f32_16x16x32_bf16 v[36:39], v[132:135], a[60:63], v[36:39]
    ds_read_b128 v[104:107], v14 offset:16384
    v_add_u32 v10, -131072, v10
    v_mfma_f32_16x16x32_bf16 v[32:35], v[132:135], a[56:59], v[32:35]
    ds_read_b128 v[108:111], v14 offset:20480
    v_mfma_f32_16x16x32_bf16 v[32:35], v[128:131], a[48:51], v[32:35]
    ds_read_b128 v[112:115], v14 offset:24576
    ds_read_b64_tr_b16 a[160:161], v10 offset:32768
    v_mfma_f32_16x16x32_bf16 v[32:35], v[124:127], a[40:43], v[32:35]
    ds_read_b128 v[116:119], v14 offset:28672
    s_add_u32 m0, s73, 149760
    v_mfma_f32_16x16x32_bf16 v[32:35], v[120:123], a[32:35], v[32:35]
    buffer_load_dwordx4 v23, s[44:47], s23 offen offset:768 sc1 lds
    ds_read_b64_tr_b16 a[162:163], v10 offset:34816
    s_waitcnt lgkmcnt(4)
    v_mfma_f32_16x16x32_bf16 v[40:43], v[104:107], a[32:35], v[40:43]
    s_add_u32 m0, s73, 98304
    ds_read_b64_tr_b16 a[168:169], v10 offset:36864
    v_mfma_f32_16x16x32_bf16 v[40:43], v[108:111], a[40:43], v[40:43]
    buffer_load_dwordx4 v20, s[44:47], s23 offen offset:0 sc1 lds
    ds_read_b64_tr_b16 a[170:171], v10 offset:38912
    s_waitcnt lgkmcnt(3)
    v_mfma_f32_16x16x32_bf16 v[40:43], v[112:115], a[48:51], v[40:43]
    ds_read_b128 v[120:123], v14 offset:17408
    v_mfma_f32_16x16x32_bf16 v[40:43], v[116:119], a[56:59], v[40:43]
    ds_read_b128 v[124:127], v14 offset:21504
    v_add_u32 v11, -131072, v11
    v_mfma_f32_16x16x32_bf16 v[44:47], v[116:119], a[60:63], v[44:47]
    ds_read_b128 v[128:131], v14 offset:25600
    v_mfma_f32_16x16x32_bf16 v[44:47], v[112:115], a[52:55], v[44:47]
    ds_read_b128 v[132:135], v14 offset:29696
    v_mfma_f32_16x16x32_bf16 v[44:47], v[108:111], a[44:47], v[44:47]
    s_add_u32 m0, s73, 98816
    ds_read_b64_tr_b16 a[164:165], v11 offset:32768
    v_mfma_f32_16x16x32_bf16 v[44:47], v[104:107], a[36:39], v[44:47]
    buffer_load_dwordx4 v20, s[44:47], s23 offen offset:512 sc1 lds
    ds_read_b64_tr_b16 a[166:167], v11 offset:34816
    s_waitcnt lgkmcnt(4)
    v_mfma_f32_16x16x32_bf16 v[52:55], v[120:123], a[36:39], v[52:55]
    s_add_u32 m0, s73, 99584
    ds_read_b64_tr_b16 a[172:173], v11 offset:36864
    v_mfma_f32_16x16x32_bf16 v[52:55], v[124:127], a[44:47], v[52:55]
    buffer_load_dwordx4 v23, s[44:47], s24 offen offset:768 sc1 lds
    ds_read_b64_tr_b16 a[174:175], v11 offset:38912
    s_waitcnt lgkmcnt(4)
    v_mfma_f32_16x16x32_bf16 v[52:55], v[128:131], a[52:55], v[52:55]
    ds_read_b128 v[104:107], v14 offset:18432
    v_mfma_f32_16x16x32_bf16 v[52:55], v[132:135], a[60:63], v[52:55]
    ds_read_b128 v[108:111], v14 offset:22528
    v_add_u32 v10, 65536, v10
    v_mfma_f32_16x16x32_bf16 v[48:51], v[132:135], a[56:59], v[48:51]
    ds_read_b128 v[112:115], v14 offset:26624
    v_mfma_f32_16x16x32_bf16 v[48:51], v[128:131], a[48:51], v[48:51]
    ds_read_b128 v[116:119], v14 offset:30720
    v_mfma_f32_16x16x32_bf16 v[48:51], v[124:127], a[40:43], v[48:51]
    s_add_u32 m0, s73, 101376
    ds_read_b64_tr_b16 a[176:177], v10 offset:16384
    v_mfma_f32_16x16x32_bf16 v[48:51], v[120:123], a[32:35], v[48:51]
    buffer_load_dwordx4 v20, s[44:47], s24 offen offset:0 sc1 lds
    ds_read_b64_tr_b16 a[178:179], v10 offset:18432
    s_waitcnt lgkmcnt(4)
    v_mfma_f32_16x16x32_bf16 v[32:35], v[104:107], a[64:67], v[32:35]
    ds_read_b64_tr_b16 a[184:185], v10 offset:20480
    v_mfma_f32_16x16x32_bf16 v[32:35], v[108:111], a[72:75], v[32:35]
    ds_read_b64_tr_b16 a[186:187], v10 offset:22528
    s_waitcnt lgkmcnt(4)
    v_mfma_f32_16x16x32_bf16 v[32:35], v[112:115], a[80:83], v[32:35]
    ds_read_b128 v[120:123], v14 offset:19456
    v_mfma_f32_16x16x32_bf16 v[32:35], v[116:119], a[88:91], v[32:35]
    ds_read_b128 v[124:127], v14 offset:23552
    v_add_u32 v11, 65536, v11
    v_mfma_f32_16x16x32_bf16 v[36:39], v[116:119], a[92:95], v[36:39]
    ds_read_b128 v[128:131], v14 offset:27648
    v_mfma_f32_16x16x32_bf16 v[36:39], v[112:115], a[84:87], v[36:39]
    ds_read_b128 v[132:135], v14 offset:31744
    v_mfma_f32_16x16x32_bf16 v[36:39], v[108:111], a[76:79], v[36:39]
    ds_read_b64_tr_b16 a[180:181], v11 offset:16384
    v_mfma_f32_16x16x32_bf16 v[36:39], v[104:107], a[68:71], v[36:39]
    ds_read_b64_tr_b16 a[182:183], v11 offset:18432
    s_waitcnt lgkmcnt(4)
    v_mfma_f32_16x16x32_bf16 v[44:47], v[120:123], a[68:71], v[44:47]
    ds_read_b64_tr_b16 a[188:189], v11 offset:20480
    v_mfma_f32_16x16x32_bf16 v[44:47], v[124:127], a[76:79], v[44:47]
    ds_read_b64_tr_b16 a[190:191], v11 offset:22528
    s_waitcnt lgkmcnt(4)
    v_mfma_f32_16x16x32_bf16 v[44:47], v[128:131], a[84:87], v[44:47]
    s_waitcnt vmcnt(8) lgkmcnt(0)
    s_barrier
    v_mfma_f32_16x16x32_bf16 v[44:47], v[132:135], a[92:95], v[44:47]
    ds_read_b128 v[104:107], v14 offset:32768
    s_lshl_b32 s14, s100, 18
    s_add_u32 m0, s73, 32768
    v_add_u32 v10, -65536, v10
    v_mfma_f32_16x16x32_bf16 v[40:43], v[132:135], a[88:91], v[40:43]
    ds_read_b128 v[108:111], v14 offset:36864
    buffer_load_dwordx4 v4, s[52:55], s14 offen offset:0 lds
    v_mfma_f32_16x16x32_bf16 v[40:43], v[128:131], a[80:83], v[40:43]
    ds_read_b128 v[112:115], v14 offset:40960
    ds_read_b64_tr_b16 a[192:193], v10 offset:0
    v_mfma_f32_16x16x32_bf16 v[40:43], v[124:127], a[72:75], v[40:43]
    ds_read_b128 v[116:119], v14 offset:45056
    v_mfma_f32_16x16x32_bf16 v[40:43], v[120:123], a[64:67], v[40:43]
    ds_read_b64_tr_b16 a[194:195], v10 offset:2048
    s_waitcnt lgkmcnt(4)
    v_mfma_f32_16x16x32_bf16 v[48:51], v[104:107], a[64:67], v[48:51]
    s_add_u32 m0, s73, 114176
    ds_read_b64_tr_b16 a[200:201], v10 offset:4096
    v_mfma_f32_16x16x32_bf16 v[48:51], v[108:111], a[72:75], v[48:51]
    buffer_load_dwordx4 v20, s[44:47], s24 offen offset:512 sc1 lds
    ds_read_b64_tr_b16 a[202:203], v10 offset:6144
    s_waitcnt lgkmcnt(3)
    v_mfma_f32_16x16x32_bf16 v[48:51], v[112:115], a[80:83], v[48:51]
    ds_read_b128 v[120:123], v14 offset:33792
    s_add_u32 m0, s73, 32768
    v_lshrrev_b32 v30, 2, v26
    v_mfma_f32_16x16x32_bf16 v[48:51], v[116:119], a[88:91], v[48:51]
    ds_read_b128 v[124:127], v14 offset:37888
    buffer_load_dwordx4 v5, s[52:55], s14 offen offset:1024 lds
    v_mfma_f32_16x16x32_bf16 v[52:55], v[116:119], a[92:95], v[52:55]
    ds_read_b128 v[128:131], v14 offset:41984
    v_add_u32 v11, -65536, v11
    v_mfma_f32_16x16x32_bf16 v[52:55], v[112:115], a[84:87], v[52:55]
    ds_read_b128 v[132:135], v14 offset:46080
    v_mfma_f32_16x16x32_bf16 v[52:55], v[108:111], a[76:79], v[52:55]
    s_add_u32 m0, s73, 114944
    ds_read_b64_tr_b16 a[196:197], v11 offset:0
    v_mfma_f32_16x16x32_bf16 v[52:55], v[104:107], a[68:71], v[52:55]
    buffer_load_dwordx4 v23, s[44:47], s25 offen offset:768 sc1 lds
    ds_read_b64_tr_b16 a[198:199], v11 offset:2048
    s_waitcnt lgkmcnt(4)
    v_mfma_f32_16x16x32_bf16 v[36:39], v[120:123], a[100:103], v[36:39]
    s_add_u32 m0, s73, 116736
    ds_read_b64_tr_b16 a[204:205], v11 offset:4096
    v_mfma_f32_16x16x32_bf16 v[36:39], v[124:127], a[108:111], v[36:39]
    buffer_load_dwordx4 v20, s[44:47], s25 offen offset:0 sc1 lds
    ds_read_b64_tr_b16 a[206:207], v11 offset:6144
    s_waitcnt lgkmcnt(4)
    v_mfma_f32_16x16x32_bf16 v[36:39], v[128:131], a[116:119], v[36:39]
    ds_read_b128 v[104:107], v14 offset:34816
L_pl_G_6:
    s_cbranch_execz L_wret
    s_add_u32 m0, s73, 32768
    v_lshrrev_b32 v31, 2, v18
    v_mfma_f32_16x16x32_bf16 v[36:39], v[132:135], a[124:127], v[36:39]
    ds_read_b128 v[108:111], v14 offset:38912
    buffer_load_dwordx4 v6, s[52:55], s14 offen offset:2048 lds
    v_mfma_f32_16x16x32_bf16 v[32:35], v[132:135], a[120:123], v[32:35]
    ds_read_b128 v[112:115], v14 offset:43008
    v_mfma_f32_16x16x32_bf16 v[32:35], v[128:131], a[112:115], v[32:35]
    ds_read_b128 v[116:119], v14 offset:47104
    v_mfma_f32_16x16x32_bf16 v[32:35], v[124:127], a[104:107], v[32:35]
    s_add_u32 m0, s73, 117248
    ds_read_b64_tr_b16 a[208:209], v10 offset:16384
    v_mfma_f32_16x16x32_bf16 v[32:35], v[120:123], a[96:99], v[32:35]
    buffer_load_dwordx4 v20, s[44:47], s25 offen offset:512 sc1 lds
    ds_read_b64_tr_b16 a[210:211], v10 offset:18432
    s_waitcnt lgkmcnt(4)
    v_mfma_f32_16x16x32_bf16 v[40:43], v[104:107], a[96:99], v[40:43]
    ds_read_b64_tr_b16 a[216:217], v10 offset:20480
    buffer_load_ushort v102, v30, s[60:63], 0 offen offset:0
    s_add_u32 m0, s73, 32768
    v_mfma_f32_16x16x32_bf16 v[40:43], v[108:111], a[104:107], v[40:43]
    ds_read_b64_tr_b16 a[218:219], v10 offset:22528
    buffer_load_dwordx4 v7, s[52:55], s14 offen offset:3072 lds
    s_waitcnt lgkmcnt(4)
    v_mfma_f32_16x16x32_bf16 v[40:43], v[112:115], a[112:115], v[40:43]
    ds_read_b128 v[120:123], v14 offset:35840
    v_mfma_f32_16x16x32_bf16 v[40:43], v[116:119], a[120:123], v[40:43]
    ds_read_b128 v[124:127], v14 offset:39936
    v_mfma_f32_16x16x32_bf16 v[44:47], v[116:119], a[124:127], v[44:47]
    ds_read_b128 v[128:131], v14 offset:44032
    v_mfma_f32_16x16x32_bf16 v[44:47], v[112:115], a[116:119], v[44:47]
    ds_read_b128 v[132:135], v14 offset:48128
    v_mfma_f32_16x16x32_bf16 v[44:47], v[108:111], a[108:111], v[44:47]
    ds_read_b64_tr_b16 a[212:213], v11 offset:16384
    buffer_load_ushort v103, v30, s[60:63], 0 offen offset:32
    v_mfma_f32_16x16x32_bf16 v[44:47], v[104:107], a[100:103], v[44:47]
    ds_read_b64_tr_b16 a[214:215], v11 offset:18432
    s_waitcnt lgkmcnt(4)
    v_mfma_f32_16x16x32_bf16 v[52:55], v[120:123], a[100:103], v[52:55]
    ds_read_b64_tr_b16 a[220:221], v11 offset:20480
    v_mfma_f32_16x16x32_bf16 v[52:55], v[124:127], a[108:111], v[52:55]
    ds_read_b64_tr_b16 a[222:223], v11 offset:22528
    s_waitcnt lgkmcnt(4)
    v_mfma_f32_16x16x32_bf16 v[52:55], v[128:131], a[116:119], v[52:55]
    s_waitcnt vmcnt(14) lgkmcnt(0)
    s_barrier
    v_mfma_f32_16x16x32_bf16 v[52:55], v[132:135], a[124:127], v[52:55]
    ds_read_b128 v[104:107], v14 offset:49152
    s_lshl_b32 s14, s101, 18
    ds_read_b64_tr_b16 a[224:225], v10 offset:49152
    s_add_u32 m0, s73, 81920
    v_mfma_f32_16x16x32_bf16 v[48:51], v[132:135], a[120:123], v[48:51]
    ds_read_b128 v[108:111], v14 offset:53248
    buffer_load_dwordx4 v4, s[52:55], s14 offen offset:0 lds
    v_mfma_f32_16x16x32_bf16 v[48:51], v[128:131], a[112:115], v[48:51]
    ds_read_b128 v[112:115], v14 offset:57344
    buffer_load_ushort v27, v31, s[60:63], 0 offen offset:0
    v_mfma_f32_16x16x32_bf16 v[48:51], v[124:127], a[104:107], v[48:51]
    ds_read_b128 v[116:119], v14 offset:61440
    v_mfma_f32_16x16x32_bf16 v[48:51], v[120:123], a[96:99], v[48:51]
    ds_read_b64_tr_b16 a[226:227], v10 offset:51200
    s_waitcnt lgkmcnt(3)
    v_mfma_f32_16x16x32_bf16 v[32:35], v[104:107], a[128:131], v[32:35]
    s_add_u32 m0, s73, 130304
    ds_read_b64_tr_b16 a[232:233], v10 offset:53248
    v_mfma_f32_16x16x32_bf16 v[32:35], v[108:111], a[136:139], v[32:35]
    buffer_load_dwordx4 v23, s[44:47], s26 offen offset:768 sc1 lds
    ds_read_b64_tr_b16 a[234:235], v10 offset:55296
    s_waitcnt lgkmcnt(3)
    v_mfma_f32_16x16x32_bf16 v[32:35], v[112:115], a[144:147], v[32:35]
    ds_read_b128 v[120:123], v14 offset:50176
    s_add_u32 m0, s73, 81920
    v_mfma_f32_16x16x32_bf16 v[32:35], v[116:119], a[152:155], v[32:35]
    ds_read_b128 v[124:127], v14 offset:54272
    buffer_load_dwordx4 v5, s[52:55], s14 offen offset:1024 lds
    v_mfma_f32_16x16x32_bf16 v[36:39], v[116:119], a[156:159], v[36:39]
    ds_read_b128 v[128:131], v14 offset:58368
    v_mfma_f32_16x16x32_bf16 v[36:39], v[112:115], a[148:151], v[36:39]
    ds_read_b128 v[132:135], v14 offset:62464
    v_mfma_f32_16x16x32_bf16 v[36:39], v[108:111], a[140:143], v[36:39]
    s_add_u32 m0, s73, 132096
    ds_read_b64_tr_b16 a[228:229], v11 offset:49152
    v_mfma_f32_16x16x32_bf16 v[36:39], v[104:107], a[132:135], v[36:39]
    buffer_load_dwordx4 v20, s[44:47], s26 offen offset:0 sc1 lds
    ds_read_b64_tr_b16 a[230:231], v11 offset:51200
    s_waitcnt lgkmcnt(4)
    v_mfma_f32_16x16x32_bf16 v[44:47], v[120:123], a[132:135], v[44:47]
    ds_read_b64_tr_b16 a[236:237], v11 offset:53248
    buffer_load_dwordx4 v[88:91], v252, s[56:59], 0 offen
    s_add_u32 m0, s73, 132608
    v_mfma_f32_16x16x32_bf16 v[44:47], v[124:127], a[140:143], v[44:47]
    buffer_load_dwordx4 v20, s[44:47], s26 offen offset:512 sc1 lds
    ds_read_b64_tr_b16 a[238:239], v11 offset:55296
    s_waitcnt lgkmcnt(4)
    v_mfma_f32_16x16x32_bf16 v[44:47], v[128:131], a[148:151], v[44:47]
    ds_read_b128 v[104:107], v14 offset:51200
    s_add_u32 m0, s73, 81920
    v_add_u32 v10, 65536, v10
    v_mfma_f32_16x16x32_bf16 v[44:47], v[132:135], a[156:159], v[44:47]
    ds_read_b128 v[108:111], v14 offset:55296
    buffer_load_dwordx4 v6, s[52:55], s14 offen offset:2048 lds
    v_mfma_f32_16x16x32_bf16 v[40:43], v[132:135], a[152:155], v[40:43]
    ds_read_b128 v[112:115], v14 offset:59392
    v_mfma_f32_16x16x32_bf16 v[40:43], v[128:131], a[144:147], v[40:43]
    ds_read_b128 v[116:119], v14 offset:63488
    v_mfma_f32_16x16x32_bf16 v[40:43], v[124:127], a[136:139], v[40:43]
    s_add_u32 m0, s73, 134144
    ds_read_b64_tr_b16 a[240:241], v10 offset:0
    v_mfma_f32_16x16x32_bf16 v[40:43], v[120:123], a[128:131], v[40:43]
    buffer_load_dwordx4 v21, s[44:47], s18 offen offset:0 sc1 lds
    ds_read_b64_tr_b16 a[242:243], v10 offset:2048
    s_waitcnt lgkmcnt(4)
    v_mfma_f32_16x16x32_bf16 v[48:51], v[104:107], a[128:131], v[48:51]
    ds_read_b64_tr_b16 a[248:249], v10 offset:4096
    s_add_u32 m0, s73, 81920
    v_mfma_f32_16x16x32_bf16 v[48:51], v[108:111], a[136:139], v[48:51]
    ds_read_b64_tr_b16 a[250:251], v10 offset:6144
    buffer_load_dwordx4 v7, s[52:55], s14 offen offset:3072 lds
    s_waitcnt lgkmcnt(4)
    v_mfma_f32_16x16x32_bf16 v[48:51], v[112:115], a[144:147], v[48:51]
    ds_read_b128 v[120:123], v14 offset:52224
    v_add_u32 v11, 65536, v11
    v_mfma_f32_16x16x32_bf16 v[48:51], v[116:119], a[152:155], v[48:51]
    ds_read_b128 v[124:127], v14 offset:56320
    v_mfma_f32_16x16x32_bf16 v[52:55], v[116:119], a[156:159], v[52:55]
    ds_read_b128 v[128:131], v14 offset:60416
    v_mfma_f32_16x16x32_bf16 v[52:55], v[112:115], a[148:151], v[52:55]
    ds_read_b128 v[132:135], v14 offset:64512
    v_mfma_f32_16x16x32_bf16 v[52:55], v[108:111], a[140:143], v[52:55]
    ds_read_b64_tr_b16 a[244:245], v11 offset:0
    v_mfma_f32_16x16x32_bf16 v[52:55], v[104:107], a[132:135], v[52:55]
    ds_read_b64_tr_b16 a[246:247], v11 offset:2048
    s_waitcnt lgkmcnt(4)
    v_mfma_f32_16x16x32_bf16 v[36:39], v[120:123], a[164:167], v[36:39]
    ds_read_b64_tr_b16 a[252:253], v11 offset:4096
    buffer_load_dwordx4 v[92:95], v252, s[56:59], s40 offen
    v_mfma_f32_16x16x32_bf16 v[36:39], v[124:127], a[172:175], v[36:39]
    ds_read_b64_tr_b16 a[254:255], v11 offset:6144
    s_waitcnt lgkmcnt(4)
    v_mfma_f32_16x16x32_bf16 v[36:39], v[128:131], a[180:183], v[36:39]
    s_waitcnt vmcnt(12) lgkmcnt(0)
    s_barrier
    v_mfma_f32_16x16x32_bf16 v[36:39], v[132:135], a[188:191], v[36:39]
    ds_read_b128 v[104:107], v14 offset:0
    v_mfma_f32_16x16x32_bf16 v[32:35], v[132:135], a[184:187], v[32:35]
    ds_read_b128 v[108:111], v14 offset:4096
    v_add_u32 v10, -65536, v10
    v_mfma_f32_16x16x32_bf16 v[32:35], v[128:131], a[176:179], v[32:35]
    ds_read_b128 v[112:115], v14 offset:8192
    v_mfma_f32_16x16x32_bf16 v[32:35], v[124:127], a[168:171], v[32:35]
    ds_read_b128 v[116:119], v14 offset:12288
    v_mfma_f32_16x16x32_bf16 v[32:35], v[120:123], a[160:163], v[32:35]
    ds_read_b64_tr_b16 v[220:221], v10 offset:32768
    s_waitcnt lgkmcnt(3)
    v_mfma_f32_16x16x32_bf16 v[40:43], v[104:107], a[160:163], v[40:43]
    s_add_u32 m0, s73, 146944
    v_mfma_f32_16x16x32_bf16 v[40:43], v[108:111], a[168:171], v[40:43]
    buffer_load_dwordx4 v21, s[44:47], s18 offen offset:512 sc1 lds
    ds_read_b64_tr_b16 v[222:223], v10 offset:34816
    s_waitcnt lgkmcnt(2)
    v_mfma_f32_16x16x32_bf16 v[40:43], v[112:115], a[176:179], v[40:43]
    ds_read_b128 v[120:123], v14 offset:1024
    v_mfma_f32_16x16x32_bf16 v[40:43], v[116:119], a[184:187], v[40:43]
    ds_read_b128 v[124:127], v14 offset:5120
    v_mfma_f32_16x16x32_bf16 v[44:47], v[116:119], a[188:191], v[44:47]
    ds_read_b128 v[128:131], v14 offset:9216
    v_mfma_f32_16x16x32_bf16 v[44:47], v[112:115], a[180:183], v[44:47]
    ds_read_b128 v[132:135], v14 offset:13312
    v_mfma_f32_16x16x32_bf16 v[44:47], v[108:111], a[172:175], v[44:47]
    s_add_u32 m0, s73, 148480
    ds_read_b64_tr_b16 v[228:229], v10 offset:36864
    v_mfma_f32_16x16x32_bf16 v[44:47], v[104:107], a[164:167], v[44:47]
    buffer_load_dwordx4 v21, s[44:47], s19 offen offset:0 sc1 lds
    s_waitcnt lgkmcnt(3)
    v_mfma_f32_16x16x32_bf16 v[52:55], v[120:123], a[164:167], v[52:55]
    ds_read_b64_tr_b16 v[230:231], v10 offset:38912
    buffer_load_dwordx2 v[142:143], v253, s[56:59], 0 offen
    s_add_u32 m0, s73, 148992
    v_mfma_f32_16x16x32_bf16 v[52:55], v[124:127], a[172:175], v[52:55]
    buffer_load_dwordx4 v21, s[44:47], s19 offen offset:512 sc1 lds
    s_waitcnt lgkmcnt(2)
    v_mfma_f32_16x16x32_bf16 v[52:55], v[128:131], a[180:183], v[52:55]
    ds_read_b128 v[104:107], v14 offset:2048
    v_mfma_f32_16x16x32_bf16 v[52:55], v[132:135], a[188:191], v[52:55]
    ds_read_b128 v[108:111], v14 offset:6144
    v_mfma_f32_16x16x32_bf16 v[48:51], v[132:135], a[184:187], v[48:51]
    ds_read_b128 v[112:115], v14 offset:10240
    v_add_u32 v11, -65536, v11
    v_mfma_f32_16x16x32_bf16 v[48:51], v[128:131], a[176:179], v[48:51]
    ds_read_b128 v[116:119], v14 offset:14336
    v_mfma_f32_16x16x32_bf16 v[48:51], v[124:127], a[168:171], v[48:51]
    s_add_u32 m0, s73, 150528
    v_mfma_f32_16x16x32_bf16 v[48:51], v[120:123], a[160:163], v[48:51]
    buffer_load_dwordx4 v21, s[44:47], s20 offen offset:0 sc1 lds
    ds_read_b64_tr_b16 v[224:225], v11 offset:32768
    s_waitcnt lgkmcnt(3)
    v_mfma_f32_16x16x32_bf16 v[32:35], v[104:107], a[192:195], v[32:35]
    v_mfma_f32_16x16x32_bf16 v[32:35], v[108:111], a[200:203], v[32:35]
    ds_read_b64_tr_b16 v[226:227], v11 offset:34816
    s_waitcnt vmcnt(14)
    s_waitcnt lgkmcnt(2)
    v_mfma_f32_16x16x32_bf16 v[32:35], v[112:115], a[208:211], v[32:35]
    ds_read_b128 v[120:123], v14 offset:3072
    v_mfma_f32_16x16x32_bf16 v[32:35], v[116:119], a[216:219], v[32:35]
    ds_read_b128 v[124:127], v14 offset:7168
    v_mfma_f32_16x16x32_bf16 v[36:39], v[116:119], a[220:223], v[36:39]
    ds_read_b128 v[128:131], v14 offset:11264
    v_lshlrev_b32 v72, 16, v102
    v_mfma_f32_16x16x32_bf16 v[36:39], v[112:115], a[212:215], v[36:39]
    ds_read_b128 v[132:135], v14 offset:15360
    v_mfma_f32_16x16x32_bf16 v[36:39], v[108:111], a[204:207], v[36:39]
    ds_read_b64_tr_b16 v[232:233], v11 offset:36864
    v_lshlrev_b32 v73, 16, v102
    v_mfma_f32_16x16x32_bf16 v[36:39], v[104:107], a[196:199], v[36:39]
    s_waitcnt lgkmcnt(3)
    v_mfma_f32_16x16x32_bf16 v[44:47], v[120:123], a[196:199], v[44:47]
    ds_read_b64_tr_b16 v[234:235], v11 offset:38912
    buffer_load_dwordx2 v[96:97], v26, s[44:47], s42 offen offset:0 sc1
    v_mfma_f32_16x16x32_bf16 v[44:47], v[124:127], a[204:207], v[44:47]
    v_lshlrev_b32 v74, 16, v102
    s_waitcnt lgkmcnt(2)
    v_mfma_f32_16x16x32_bf16 v[44:47], v[128:131], a[212:215], v[44:47]
    s_waitcnt vmcnt(7) lgkmcnt(0)
    s_barrier
    v_mfma_f32_16x16x32_bf16 v[44:47], v[132:135], a[220:223], v[44:47]
    ds_read_b128 v[104:107], v14 offset:16384
    v_lshlrev_b32 v75, 16, v102
    v_mfma_f32_16x16x32_bf16 v[40:43], v[132:135], a[216:219], v[40:43]
    ds_read_b128 v[108:111], v14 offset:20480
    v_add_u32 v10, 65536, v10
    v_mfma_f32_16x16x32_bf16 v[40:43], v[128:131], a[208:211], v[40:43]
    ds_read_b128 v[112:115], v14 offset:24576
    v_mfma_f32_16x16x32_bf16 v[40:43], v[124:127], a[200:203], v[40:43]
    ds_read_b128 v[116:119], v14 offset:28672
    v_lshlrev_b32 v76, 16, v103
    v_mfma_f32_16x16x32_bf16 v[40:43], v[120:123], a[192:195], v[40:43]
    ds_read_b64_tr_b16 v[236:237], v10 offset:16384
    s_waitcnt lgkmcnt(3)
    v_mfma_f32_16x16x32_bf16 v[48:51], v[104:107], a[192:195], v[48:51]
    s_add_u32 m0, s73, 97792
    v_lshlrev_b32 v77, 16, v103
    v_mfma_f32_16x16x32_bf16 v[48:51], v[108:111], a[200:203], v[48:51]
    buffer_load_dwordx4 v21, s[44:47], s20 offen offset:512 sc1 lds
    ds_read_b64_tr_b16 v[238:239], v10 offset:18432
    s_waitcnt lgkmcnt(2)
    v_mfma_f32_16x16x32_bf16 v[48:51], v[112:115], a[208:211], v[48:51]
    ds_read_b128 v[120:123], v14 offset:17408
    v_mfma_f32_16x16x32_bf16 v[48:51], v[116:119], a[216:219], v[48:51]
    ds_read_b128 v[124:127], v14 offset:21504
    v_mfma_f32_16x16x32_bf16 v[52:55], v[116:119], a[220:223], v[52:55]
    ds_read_b128 v[128:131], v14 offset:25600
    v_lshlrev_b32 v78, 16, v103
    v_mfma_f32_16x16x32_bf16 v[52:55], v[112:115], a[212:215], v[52:55]
    ds_read_b128 v[132:135], v14 offset:29696
    v_mfma_f32_16x16x32_bf16 v[52:55], v[108:111], a[204:207], v[52:55]
    ds_read_b64_tr_b16 v[244:245], v10 offset:20480
    s_add_u32 m0, s73, 99328
    v_lshlrev_b32 v79, 16, v103
    v_mfma_f32_16x16x32_bf16 v[52:55], v[104:107], a[196:199], v[52:55]
    buffer_load_dwordx4 v21, s[44:47], s21 offen offset:0 sc1 lds
    s_waitcnt lgkmcnt(3)
    v_mfma_f32_16x16x32_bf16 v[36:39], v[120:123], a[228:231], v[36:39]
    ds_read_b64_tr_b16 v[246:247], v10 offset:22528
    buffer_load_dwordx2 v[98:99], v26, s[44:47], s42 offen offset:128 sc1
    s_add_u32 m0, s73, 99840
    v_mfma_f32_16x16x32_bf16 v[36:39], v[124:127], a[236:239], v[36:39]
    buffer_load_dwordx4 v21, s[44:47], s21 offen offset:512 sc1 lds
    s_waitcnt lgkmcnt(2)
    v_mfma_f32_16x16x32_bf16 v[36:39], v[128:131], a[244:247], v[36:39]
    ds_read_b128 v[104:107], v14 offset:18432
    v_lshlrev_b32 v80, 16, v102
    v_mfma_f32_16x16x32_bf16 v[36:39], v[132:135], a[252:255], v[36:39]
    ds_read_b128 v[108:111], v14 offset:22528
    v_lshlrev_b32 v81, 16, v102
    v_mfma_f32_16x16x32_bf16 v[32:35], v[132:135], a[248:251], v[32:35]
    ds_read_b128 v[112:115], v14 offset:26624
    v_add_u32 v11, 65536, v11
    v_mfma_f32_16x16x32_bf16 v[32:35], v[128:131], a[240:243], v[32:35]
    ds_read_b128 v[116:119], v14 offset:30720
    v_mfma_f32_16x16x32_bf16 v[32:35], v[124:127], a[232:235], v[32:35]
    s_add_u32 m0, s73, 101376
    v_lshlrev_b32 v82, 16, v102
    v_mfma_f32_16x16x32_bf16 v[32:35], v[120:123], a[224:227], v[32:35]
    buffer_load_dwordx4 v21, s[44:47], s22 offen offset:0 sc1 lds
    ds_read_b64_tr_b16 v[240:241], v11 offset:16384
    s_waitcnt lgkmcnt(3)
    v_mfma_f32_16x16x32_bf16 v[40:43], v[104:107], a[224:227], v[40:43]
    v_lshlrev_b32 v83, 16, v102
    v_mfma_f32_16x16x32_bf16 v[40:43], v[108:111], a[232:235], v[40:43]
    ds_read_b64_tr_b16 v[242:243], v11 offset:18432
    s_waitcnt lgkmcnt(2)
    v_mfma_f32_16x16x32_bf16 v[40:43], v[112:115], a[240:243], v[40:43]
    ds_read_b128 v[120:123], v14 offset:19456
    v_mfma_f32_16x16x32_bf16 v[40:43], v[116:119], a[248:251], v[40:43]
    ds_read_b128 v[124:127], v14 offset:23552
    v_mfma_f32_16x16x32_bf16 v[44:47], v[116:119], a[252:255], v[44:47]
    ds_read_b128 v[128:131], v14 offset:27648
    v_lshlrev_b32 v84, 16, v103
    v_mfma_f32_16x16x32_bf16 v[44:47], v[112:115], a[244:247], v[44:47]
    ds_read_b128 v[132:135], v14 offset:31744
    v_mfma_f32_16x16x32_bf16 v[44:47], v[108:111], a[236:239], v[44:47]
    ds_read_b64_tr_b16 v[248:249], v11 offset:20480
    v_lshlrev_b32 v85, 16, v103
    v_mfma_f32_16x16x32_bf16 v[44:47], v[104:107], a[228:231], v[44:47]
    s_waitcnt lgkmcnt(3)
    v_mfma_f32_16x16x32_bf16 v[52:55], v[120:123], a[228:231], v[52:55]
    ds_read_b64_tr_b16 v[250:251], v11 offset:22528
    buffer_load_dwordx2 v[100:101], v18, s[44:47], s42 offen offset:0 sc1
    v_mfma_f32_16x16x32_bf16 v[52:55], v[124:127], a[236:239], v[52:55]
    v_lshlrev_b32 v86, 16, v103
    s_waitcnt lgkmcnt(2)
    v_mfma_f32_16x16x32_bf16 v[52:55], v[128:131], a[244:247], v[52:55]
    s_waitcnt lgkmcnt(0)
    s_barrier
    v_mfma_f32_16x16x32_bf16 v[52:55], v[132:135], a[252:255], v[52:55]
    ds_read_b128 v[104:107], v14 offset:32768
    v_mfma_f32_16x16x32_bf16 v[48:51], v[132:135], a[248:251], v[48:51]
    ds_read_b128 v[108:111], v14 offset:36864
    v_lshlrev_b32 v87, 16, v103
    v_mfma_f32_16x16x32_bf16 v[48:51], v[128:131], a[240:243], v[48:51]
    ds_read_b128 v[112:115], v14 offset:40960
    v_mfma_f32_16x16x32_bf16 v[48:51], v[124:127], a[232:235], v[48:51]
    ds_read_b128 v[116:119], v14 offset:45056
    v_lshlrev_b32 v27, 16, v27
    v_mfma_f32_16x16x32_bf16 v[48:51], v[120:123], a[224:227], v[48:51]
L_Dc:
L_pl_D_0:
    s_cbranch_execz L_wret
    s_waitcnt lgkmcnt(2)
    v_mfma_f32_16x16x32_bf16 v[32:35], v[104:107], v[220:223], v[32:35]
    s_add_u32 m0, s73, 114176
    v_mfma_f32_16x16x32_bf16 v[32:35], v[108:111], v[228:231], v[32:35]
    buffer_load_dwordx4 v21, s[44:47], s22 offen offset:512 sc1 lds
    s_waitcnt lgkmcnt(0)
    v_mfma_f32_16x16x32_bf16 v[32:35], v[112:115], v[236:239], v[32:35]
    ds_read_b128 v[120:123], v14 offset:33792
    v_mfma_f32_16x16x32_bf16 v[32:35], v[116:119], v[244:247], v[32:35]
    ds_read_b128 v[124:127], v14 offset:37888
    v_mfma_f32_16x16x32_bf16 v[36:39], v[116:119], v[248:251], v[36:39]
    ds_read_b128 v[128:131], v14 offset:41984
    buffer_load_dword v189, v188, s[44:47], 0 offen sc1
    v_mfma_f32_16x16x32_bf16 v[36:39], v[112:115], v[240:243], v[36:39]
    ds_read_b128 v[132:135], v14 offset:46080
    v_mfma_f32_16x16x32_bf16 v[36:39], v[108:111], v[232:235], v[36:39]
    s_add_u32 m0, s73, 115712
    v_mfma_f32_16x16x32_bf16 v[36:39], v[104:107], v[224:227], v[36:39]
    buffer_load_dwordx4 v21, s[44:47], s23 offen offset:0 sc1 lds
    s_waitcnt lgkmcnt(2)
    v_mfma_f32_16x16x32_bf16 v[44:47], v[120:123], v[224:227], v[44:47]
    s_add_u32 m0, s73, 116224
    v_mfma_f32_16x16x32_bf16 v[44:47], v[124:127], v[232:235], v[44:47]
    buffer_load_dwordx4 v21, s[44:47], s23 offen offset:512 sc1 lds
    s_waitcnt lgkmcnt(0)
    v_mfma_f32_16x16x32_bf16 v[44:47], v[128:131], v[240:243], v[44:47]
    ds_read_b128 v[104:107], v14 offset:34816
    v_mfma_f32_16x16x32_bf16 v[44:47], v[132:135], v[248:251], v[44:47]
    ds_read_b128 v[108:111], v14 offset:38912
    v_mfma_f32_16x16x32_bf16 v[40:43], v[132:135], v[244:247], v[40:43]
    ds_read_b128 v[112:115], v14 offset:43008
    v_mfma_f32_16x16x32_bf16 v[40:43], v[128:131], v[236:239], v[40:43]
    ds_read_b128 v[116:119], v14 offset:47104
    v_mfma_f32_16x16x32_bf16 v[40:43], v[124:127], v[228:231], v[40:43]
    s_add_u32 m0, s73, 117760
    v_mfma_f32_16x16x32_bf16 v[40:43], v[120:123], v[220:223], v[40:43]
    buffer_load_dwordx4 v21, s[44:47], s24 offen offset:0 sc1 lds
    s_waitcnt lgkmcnt(2)
    v_mfma_f32_16x16x32_bf16 v[48:51], v[104:107], v[220:223], v[48:51]
    v_mfma_f32_16x16x32_bf16 v[48:51], v[108:111], v[228:231], v[48:51]
    s_waitcnt lgkmcnt(0)
    v_mfma_f32_16x16x32_bf16 v[48:51], v[112:115], v[236:239], v[48:51]
    ds_read_b128 v[120:123], v14 offset:35840
    v_mfma_f32_16x16x32_bf16 v[48:51], v[116:119], v[244:247], v[48:51]
    ds_read_b128 v[124:127], v14 offset:39936
    v_mfma_f32_16x16x32_bf16 v[52:55], v[116:119], v[248:251], v[52:55]
    ds_read_b128 v[128:131], v14 offset:44032
    v_mfma_f32_16x16x32_bf16 v[52:55], v[112:115], v[240:243], v[52:55]
    ds_read_b128 v[132:135], v14 offset:48128
    v_mfma_f32_16x16x32_bf16 v[52:55], v[108:111], v[232:235], v[52:55]
    v_mfma_f32_16x16x32_bf16 v[52:55], v[104:107], v[224:227], v[52:55]
    s_waitcnt lgkmcnt(2)
    v_mfma_f32_16x16x32_bf16 v[60:63], v[120:123], a[4:7], 0
    v_mfma_f32_16x16x32_bf16 v[60:63], v[124:127], a[12:15], v[60:63]
    s_waitcnt lgkmcnt(0)
    v_mfma_f32_16x16x32_bf16 v[60:63], v[128:131], a[20:23], v[60:63]
    s_waitcnt vmcnt(12)
    s_barrier
    v_mfma_f32_16x16x32_bf16 v[60:63], v[132:135], a[28:31], v[60:63]
    ds_read_b128 v[104:107], v14 offset:49152
    v_mfma_f32_16x16x32_bf16 v[56:59], v[132:135], a[24:27], 0
    ds_read_b128 v[108:111], v14 offset:53248
    v_mfma_f32_16x16x32_bf16 v[56:59], v[128:131], a[16:19], v[56:59]
    ds_read_b128 v[112:115], v14 offset:57344
    v_cvt_pk_bf16_f32 v192, v32, v33
    v_mfma_f32_16x16x32_bf16 v[56:59], v[124:127], a[8:11], v[56:59]
    ds_read_b128 v[116:119], v14 offset:61440
    v_mfma_f32_16x16x32_bf16 v[56:59], v[120:123], a[0:3], v[56:59]
    s_waitcnt lgkmcnt(2)
    v_mfma_f32_16x16x32_bf16 v[64:67], v[104:107], a[0:3], 0
    s_add_u32 m0, s73, 130560
    v_mfma_f32_16x16x32_bf16 v[64:67], v[108:111], a[8:11], v[64:67]
    buffer_load_dwordx4 v21, s[44:47], s24 offen offset:512 sc1 lds
    s_waitcnt lgkmcnt(0)
    v_mfma_f32_16x16x32_bf16 v[64:67], v[112:115], a[16:19], v[64:67]
    ds_read_b128 v[120:123], v14 offset:50176
    v_cvt_pk_bf16_f32 v193, v34, v35
    v_mfma_f32_16x16x32_bf16 v[64:67], v[116:119], a[24:27], v[64:67]
    ds_read_b128 v[124:127], v14 offset:54272
    v_mfma_f32_16x16x32_bf16 v[68:71], v[116:119], a[28:31], 0
    ds_read_b128 v[128:131], v14 offset:58368
    v_mfma_f32_16x16x32_bf16 v[68:71], v[112:115], a[20:23], v[68:71]
    buffer_store_dwordx4 v[192:195], v136, s[44:47], s32 offen sc1
    ds_read_b128 v[132:135], v14 offset:62464
    v_mfma_f32_16x16x32_bf16 v[68:71], v[108:111], a[12:15], v[68:71]
    s_add_u32 m0, s73, 132096
    v_mfma_f32_16x16x32_bf16 v[68:71], v[104:107], a[4:7], v[68:71]
    buffer_load_dwordx4 v21, s[44:47], s25 offen offset:0 sc1 lds
    s_waitcnt lgkmcnt(2)
    v_mfma_f32_16x16x32_bf16 v[60:63], v[120:123], a[36:39], v[60:63]
    s_add_u32 m0, s73, 132608
    v_mfma_f32_16x16x32_bf16 v[60:63], v[124:127], a[44:47], v[60:63]
    buffer_load_dwordx4 v21, s[44:47], s25 offen offset:512 sc1 lds
    s_waitcnt lgkmcnt(0)
    v_mfma_f32_16x16x32_bf16 v[60:63], v[128:131], a[52:55], v[60:63]
    ds_read_b128 v[104:107], v14 offset:51200
    v_mfma_f32_16x16x32_bf16 v[60:63], v[132:135], a[60:63], v[60:63]
    ds_read_b128 v[108:111], v14 offset:55296
    v_mfma_f32_16x16x32_bf16 v[56:59], v[132:135], a[56:59], v[56:59]
    ds_read_b128 v[112:115], v14 offset:59392
    v_mfma_f32_16x16x32_bf16 v[56:59], v[128:131], a[48:51], v[56:59]
    ds_read_b128 v[116:119], v14 offset:63488
    v_mfma_f32_16x16x32_bf16 v[56:59], v[124:127], a[40:43], v[56:59]
    s_add_u32 m0, s73, 134144
    v_cvt_pk_bf16_f32 v196, v36, v37
    v_mfma_f32_16x16x32_bf16 v[56:59], v[120:123], a[32:35], v[56:59]
    buffer_load_dwordx4 v21, s[44:47], s26 offen offset:0 sc1 lds
    s_waitcnt lgkmcnt(2)
    v_mfma_f32_16x16x32_bf16 v[64:67], v[104:107], a[32:35], v[64:67]
    v_mfma_f32_16x16x32_bf16 v[64:67], v[108:111], a[40:43], v[64:67]
    s_waitcnt lgkmcnt(0)
    v_mfma_f32_16x16x32_bf16 v[64:67], v[112:115], a[48:51], v[64:67]
    ds_read_b128 v[120:123], v14 offset:52224
    v_cvt_pk_bf16_f32 v197, v38, v39
    v_mfma_f32_16x16x32_bf16 v[64:67], v[116:119], a[56:59], v[64:67]
    ds_read_b128 v[124:127], v14 offset:56320
    v_mfma_f32_16x16x32_bf16 v[68:71], v[116:119], a[60:63], v[68:71]
    ds_read_b128 v[128:131], v14 offset:60416
    v_mfma_f32_16x16x32_bf16 v[68:71], v[112:115], a[52:55], v[68:71]
    ds_read_b128 v[132:135], v14 offset:64512
    v_mfma_f32_16x16x32_bf16 v[68:71], v[108:111], a[44:47], v[68:71]
    buffer_store_dwordx4 v[196:199], v136, s[44:47], s33 offen sc1
    v_mfma_f32_16x16x32_bf16 v[68:71], v[104:107], a[36:39], v[68:71]
    s_waitcnt lgkmcnt(2)
    v_mfma_f32_16x16x32_bf16 v[60:63], v[120:123], a[68:71], v[60:63]
    v_mfma_f32_16x16x32_bf16 v[60:63], v[124:127], a[76:79], v[60:63]
    s_waitcnt lgkmcnt(0)
    v_mfma_f32_16x16x32_bf16 v[60:63], v[128:131], a[84:87], v[60:63]
    s_waitcnt vmcnt(12)
    s_barrier
    v_mfma_f32_16x16x32_bf16 v[60:63], v[132:135], a[92:95], v[60:63]
    ds_read_b128 v[104:107], v14 offset:0
    v_mfma_f32_16x16x32_bf16 v[56:59], v[132:135], a[88:91], v[56:59]
    ds_read_b128 v[108:111], v14 offset:4096
    v_mfma_f32_16x16x32_bf16 v[56:59], v[128:131], a[80:83], v[56:59]
    ds_read_b128 v[112:115], v14 offset:8192
    v_cvt_pk_bf16_f32 v192, v40, v41
    v_mfma_f32_16x16x32_bf16 v[56:59], v[124:127], a[72:75], v[56:59]
    ds_read_b128 v[116:119], v14 offset:12288
    v_mfma_f32_16x16x32_bf16 v[56:59], v[120:123], a[64:67], v[56:59]
    s_waitcnt lgkmcnt(2)
    v_mfma_f32_16x16x32_bf16 v[64:67], v[104:107], a[64:67], v[64:67]
    s_add_u32 m0, s73, 146944
    v_cvt_pk_bf16_f32 v193, v42, v43
    s_waitcnt vmcnt(11)
    v_mfma_f32_16x16x32_bf16 v[64:67], v[108:111], a[72:75], v[64:67]
    buffer_load_dwordx4 v21, s[44:47], s26 offen offset:512 sc1 lds
    s_waitcnt lgkmcnt(0)
    v_mfma_f32_16x16x32_bf16 v[64:67], v[112:115], a[80:83], v[64:67]
    ds_read_b128 v[120:123], v14 offset:1024
    v_mul_f32 v96, v96, v97
    v_mfma_f32_16x16x32_bf16 v[64:67], v[116:119], a[88:91], v[64:67]
    ds_read_b128 v[124:127], v14 offset:5120
    v_cvt_pk_bf16_f32 v194, v44, v45
    v_mfma_f32_16x16x32_bf16 v[68:71], v[116:119], a[92:95], v[68:71]
    ds_read_b128 v[128:131], v14 offset:9216
    v_mul_f32 v98, v98, v99
    v_mfma_f32_16x16x32_bf16 v[68:71], v[112:115], a[84:87], v[68:71]
    ds_read_b128 v[132:135], v14 offset:13312
    v_mul_f32 v100, v100, v101
    v_mfma_f32_16x16x32_bf16 v[68:71], v[108:111], a[76:79], v[68:71]
    buffer_store_dwordx4 v[192:195], v136, s[44:47], s30 offen offset:0 sc1
    s_add_u32 m0, s73, 148480
    v_permlane16_swap_b32 v88, v90
    v_mfma_f32_16x16x32_bf16 v[68:71], v[104:107], a[68:71], v[68:71]
    buffer_load_dwordx4 v22, s[44:47], s18 offen offset:0 sc1 lds
    s_waitcnt lgkmcnt(2)
    v_mfma_f32_16x16x32_bf16 v[60:63], v[120:123], a[100:103], v[60:63]
    s_add_u32 m0, s73, 148992
    v_permlane16_swap_b32 v89, v91
    v_permlane16_swap_b32 v92, v94
    v_mfma_f32_16x16x32_bf16 v[60:63], v[124:127], a[108:111], v[60:63]
    buffer_load_dwordx4 v22, s[44:47], s18 offen offset:512 sc1 lds
    s_waitcnt vmcnt(13)
    s_waitcnt lgkmcnt(0)
    v_mfma_f32_16x16x32_bf16 v[60:63], v[128:131], a[116:119], v[60:63]
    ds_read_b128 v[104:107], v14 offset:2048
    v_permlane16_swap_b32 v93, v95
    v_mfma_f32_16x16x32_bf16 v[60:63], v[132:135], a[124:127], v[60:63]
    ds_read_b128 v[108:111], v14 offset:6144
    v_cmp_ne_u32 vcc, s68, v189
    v_mfma_f32_16x16x32_bf16 v[56:59], v[132:135], a[120:123], v[56:59]
    ds_read_b128 v[112:115], v14 offset:10240
    v_and_b32 v145, 0xffff0000, v88
    v_mfma_f32_16x16x32_bf16 v[56:59], v[128:131], a[112:115], v[56:59]
    ds_read_b128 v[116:119], v14 offset:14336
    v_cvt_pk_bf16_f32 v196, v46, v47
    v_mfma_f32_16x16x32_bf16 v[56:59], v[124:127], a[104:107], v[56:59]
    s_add_u32 m0, s73, 150528
    s_cbranch_vccnz L_rs_p3
L_ok_p3:
    v_lshlrev_b32 v144, 16, v88
    v_mfma_f32_16x16x32_bf16 v[56:59], v[120:123], a[96:99], v[56:59]
    buffer_load_dwordx4 v22, s[44:47], s19 offen offset:0 sc1 lds
    s_waitcnt lgkmcnt(2)
    v_mfma_f32_16x16x32_bf16 v[64:67], v[104:107], a[96:99], v[64:67]
    s_add_u32 m0, s73, 81920
    v_cvt_pk_bf16_f32 v197, v48, v49
    v_and_b32 v147, 0xffff0000, v89
    v_mfma_f32_16x16x32_bf16 v[64:67], v[108:111], a[104:107], v[64:67]
    buffer_load_dwordx4 v184, s[44:47], s37 offen offset:0 sc1 lds
    s_waitcnt lgkmcnt(0)
    v_mfma_f32_16x16x32_bf16 v[64:67], v[112:115], a[112:115], v[64:67]
    ds_read_b128 v[120:123], v14 offset:3072
    buffer_load_dwordx4 v185, s[44:47], s37 offen offset:1024 sc1 lds
    v_mfma_f32_16x16x32_bf16 v[64:67], v[116:119], a[120:123], v[64:67]
    ds_read_b128 v[124:127], v14 offset:7168
    s_add_u32 m0, s73, 83968
    v_cvt_pk_bf16_f32 v198, v50, v51
    v_mfma_f32_16x16x32_bf16 v[68:71], v[116:119], a[124:127], v[68:71]
    ds_read_b128 v[128:131], v14 offset:11264
    buffer_load_dwordx4 v184, s[44:47], s16 offen offset:0 sc1 lds
    v_mfma_f32_16x16x32_bf16 v[68:71], v[112:115], a[116:119], v[68:71]
    ds_read_b128 v[132:135], v14 offset:15360
    buffer_load_dwordx4 v185, s[44:47], s16 offen offset:1024 sc1 lds
    v_mfma_f32_16x16x32_bf16 v[68:71], v[108:111], a[108:111], v[68:71]
    buffer_store_dwordx4 v[196:199], v136, s[44:47], s30 offen offset:1024 sc1
    v_lshlrev_b32 v146, 16, v89
    v_and_b32 v149, 0xffff0000, v92
    v_lshlrev_b32 v148, 16, v92
    v_mfma_f32_16x16x32_bf16 v[68:71], v[104:107], a[100:103], v[68:71]
    s_waitcnt lgkmcnt(2)
    v_mfma_f32_16x16x32_bf16 v[60:63], v[120:123], a[132:135], v[60:63]
    v_and_b32 v151, 0xffff0000, v93
    v_mfma_f32_16x16x32_bf16 v[60:63], v[124:127], a[140:143], v[60:63]
    v_lshlrev_b32 v150, 16, v93
    s_waitcnt lgkmcnt(0)
    v_mfma_f32_16x16x32_bf16 v[60:63], v[128:131], a[148:151], v[60:63]
    s_waitcnt vmcnt(16)
    s_barrier
    v_mfma_f32_16x16x32_bf16 v[60:63], v[132:135], a[156:159], v[60:63]
    ds_read_b128 v[104:107], v14 offset:16384
    v_and_b32 v153, 0xffff0000, v90
    v_mfma_f32_16x16x32_bf16 v[56:59], v[132:135], a[152:155], v[56:59]
    ds_read_b128 v[108:111], v14 offset:20480
    v_lshlrev_b32 v152, 16, v90
    v_mfma_f32_16x16x32_bf16 v[56:59], v[128:131], a[144:147], v[56:59]
    ds_read_b128 v[112:115], v14 offset:24576
L_pl_D_1:
    s_cbranch_execz L_wret
    v_cvt_pk_bf16_f32 v200, v52, v53
    v_mfma_f32_16x16x32_bf16 v[56:59], v[124:127], a[136:139], v[56:59]
    ds_read_b128 v[116:119], v14 offset:28672
    v_and_b32 v155, 0xffff0000, v91
    v_mfma_f32_16x16x32_bf16 v[56:59], v[120:123], a[128:131], v[56:59]
    s_waitcnt lgkmcnt(2)
    v_mfma_f32_16x16x32_bf16 v[64:67], v[104:107], a[128:131], v[64:67]
    s_add_u32 m0, s73, 97792
    v_lshlrev_b32 v154, 16, v91
    v_mfma_f32_16x16x32_bf16 v[64:67], v[108:111], a[136:139], v[64:67]
    buffer_load_dwordx4 v22, s[44:47], s19 offen offset:512 sc1 lds
    s_waitcnt lgkmcnt(0)
    v_mfma_f32_16x16x32_bf16 v[64:67], v[112:115], a[144:147], v[64:67]
    ds_read_b128 v[120:123], v14 offset:17408
    v_cvt_pk_bf16_f32 v201, v54, v55
    v_mfma_f32_16x16x32_bf16 v[64:67], v[116:119], a[152:155], v[64:67]
    ds_read_b128 v[124:127], v14 offset:21504
    v_and_b32 v157, 0xffff0000, v94
    v_mfma_f32_16x16x32_bf16 v[68:71], v[116:119], a[156:159], v[68:71]
    ds_read_b128 v[128:131], v14 offset:25600
    v_lshlrev_b32 v156, 16, v94
    v_mfma_f32_16x16x32_bf16 v[68:71], v[112:115], a[148:151], v[68:71]
    buffer_store_dwordx4 v[200:203], v136, s[44:47], s30 offen offset:2048 sc1
    ds_read_b128 v[132:135], v14 offset:29696
    v_and_b32 v159, 0xffff0000, v95
    v_mfma_f32_16x16x32_bf16 v[68:71], v[108:111], a[140:143], v[68:71]
    s_add_u32 m0, s73, 99328
    v_lshlrev_b32 v158, 16, v95
    v_mfma_f32_16x16x32_bf16 v[68:71], v[104:107], a[132:135], v[68:71]
    buffer_load_dwordx4 v22, s[44:47], s20 offen offset:0 sc1 lds
    s_waitcnt lgkmcnt(2)
    v_mfma_f32_16x16x32_bf16 v[60:63], v[120:123], a[164:167], v[60:63]
    s_add_u32 m0, s73, 99840
    v_and_b32 v161, 0xffff0000, v142
    v_mfma_f32_16x16x32_bf16 v[60:63], v[124:127], a[172:175], v[60:63]
    buffer_load_dwordx4 v22, s[44:47], s20 offen offset:512 sc1 lds
    s_waitcnt lgkmcnt(0)
    v_mfma_f32_16x16x32_bf16 v[60:63], v[128:131], a[180:183], v[60:63]
    ds_read_b128 v[104:107], v14 offset:18432
    v_lshlrev_b32 v160, 16, v142
    v_mfma_f32_16x16x32_bf16 v[60:63], v[132:135], a[188:191], v[60:63]
    ds_read_b128 v[108:111], v14 offset:22528
    v_mfma_f32_16x16x32_bf16 v[56:59], v[132:135], a[184:187], v[56:59]
    ds_read_b128 v[112:115], v14 offset:26624
    v_and_b32 v163, 0xffff0000, v143
    v_mfma_f32_16x16x32_bf16 v[56:59], v[128:131], a[176:179], v[56:59]
    ds_read_b128 v[116:119], v14 offset:30720
    v_lshlrev_b32 v162, 16, v143
    v_mfma_f32_16x16x32_bf16 v[56:59], v[124:127], a[168:171], v[56:59]
    s_add_u32 m0, s73, 101376
    v_mfma_f32_16x16x32_bf16 v[56:59], v[120:123], a[160:163], v[56:59]
    buffer_load_dwordx4 v22, s[44:47], s21 offen offset:0 sc1 lds
    s_waitcnt lgkmcnt(2)
    v_mfma_f32_16x16x32_bf16 v[64:67], v[104:107], a[160:163], v[64:67]
    v_fma_f32 v164, v144, v97, -v96
    v_mfma_f32_16x16x32_bf16 v[64:67], v[108:111], a[168:171], v[64:67]
    v_fma_f32 v165, v145, v97, -v96
    s_waitcnt lgkmcnt(0)
    v_mfma_f32_16x16x32_bf16 v[64:67], v[112:115], a[176:179], v[64:67]
    ds_read_b128 v[120:123], v14 offset:19456
    v_fma_f32 v166, v146, v97, -v96
    v_mfma_f32_16x16x32_bf16 v[64:67], v[116:119], a[184:187], v[64:67]
    ds_read_b128 v[124:127], v14 offset:23552
    v_mfma_f32_16x16x32_bf16 v[68:71], v[116:119], a[188:191], v[68:71]
    ds_read_b128 v[128:131], v14 offset:27648
    v_fma_f32 v167, v147, v97, -v96
    v_mfma_f32_16x16x32_bf16 v[68:71], v[112:115], a[180:183], v[68:71]
    ds_read_b128 v[132:135], v14 offset:31744
    v_mfma_f32_16x16x32_bf16 v[68:71], v[108:111], a[172:175], v[68:71]
    v_fma_f32 v168, v148, v99, -v98
    v_mfma_f32_16x16x32_bf16 v[68:71], v[104:107], a[164:167], v[68:71]
    v_fma_f32 v169, v149, v99, -v98
    s_waitcnt lgkmcnt(2)
    v_mfma_f32_16x16x32_bf16 v[60:63], v[120:123], a[196:199], v[60:63]
    v_mfma_f32_16x16x32_bf16 v[60:63], v[124:127], a[204:207], v[60:63]
    v_fma_f32 v170, v150, v99, -v98
    s_waitcnt lgkmcnt(0)
    v_mfma_f32_16x16x32_bf16 v[60:63], v[128:131], a[212:215], v[60:63]
    s_waitcnt vmcnt(16)
    s_barrier
    v_mfma_f32_16x16x32_bf16 v[60:63], v[132:135], a[220:223], v[60:63]
    ds_read_b128 v[104:107], v14 offset:32768
    v_fma_f32 v171, v151, v99, -v98
    v_mfma_f32_16x16x32_bf16 v[56:59], v[132:135], a[216:219], v[56:59]
    ds_read_b128 v[108:111], v14 offset:36864
    v_fma_f32 v172, v152, v97, -v96
    v_mfma_f32_16x16x32_bf16 v[56:59], v[128:131], a[208:211], v[56:59]
    ds_read_b128 v[112:115], v14 offset:40960
    v_mfma_f32_16x16x32_bf16 v[56:59], v[124:127], a[200:203], v[56:59]
    ds_read_b128 v[116:119], v14 offset:45056
    v_fma_f32 v173, v153, v97, -v96
    v_mfma_f32_16x16x32_bf16 v[56:59], v[120:123], a[192:195], v[56:59]
    s_waitcnt lgkmcnt(2)
    v_mfma_f32_16x16x32_bf16 v[64:67], v[104:107], a[192:195], v[64:67]
    s_add_u32 m0, s73, 114176
    v_fma_f32 v174, v154, v97, -v96
    v_mfma_f32_16x16x32_bf16 v[64:67], v[108:111], a[200:203], v[64:67]
    buffer_load_dwordx4 v22, s[44:47], s21 offen offset:512 sc1 lds
    s_waitcnt lgkmcnt(0)
    v_mfma_f32_16x16x32_bf16 v[64:67], v[112:115], a[208:211], v[64:67]
    ds_read_b128 v[120:123], v14 offset:33792
    v_fma_f32 v175, v155, v97, -v96
    v_mfma_f32_16x16x32_bf16 v[64:67], v[116:119], a[216:219], v[64:67]
    ds_read_b128 v[124:127], v14 offset:37888
    v_fma_f32 v176, v156, v99, -v98
    v_mfma_f32_16x16x32_bf16 v[68:71], v[116:119], a[220:223], v[68:71]
    ds_read_b128 v[128:131], v14 offset:41984
    v_mfma_f32_16x16x32_bf16 v[68:71], v[112:115], a[212:215], v[68:71]
    ds_read_b128 v[132:135], v14 offset:46080
    v_fma_f32 v177, v157, v99, -v98
    v_mfma_f32_16x16x32_bf16 v[68:71], v[108:111], a[204:207], v[68:71]
    s_add_u32 m0, s73, 115712
    v_fma_f32 v178, v158, v99, -v98
    v_mfma_f32_16x16x32_bf16 v[68:71], v[104:107], a[196:199], v[68:71]
    buffer_load_dwordx4 v22, s[44:47], s22 offen offset:0 sc1 lds
    s_waitcnt lgkmcnt(2)
    v_mfma_f32_16x16x32_bf16 v[60:63], v[120:123], a[228:231], v[60:63]
    s_add_u32 m0, s73, 116224
    v_fma_f32 v179, v159, v99, -v98
    v_mfma_f32_16x16x32_bf16 v[60:63], v[124:127], a[236:239], v[60:63]
    buffer_load_dwordx4 v22, s[44:47], s22 offen offset:512 sc1 lds
    s_waitcnt lgkmcnt(0)
    v_mfma_f32_16x16x32_bf16 v[60:63], v[128:131], a[244:247], v[60:63]
    ds_read_b128 v[104:107], v14 offset:34816
    v_fma_f32 v180, v160, v101, -v100
    v_mfma_f32_16x16x32_bf16 v[60:63], v[132:135], a[252:255], v[60:63]
    ds_read_b128 v[108:111], v14 offset:38912
    v_fma_f32 v181, v161, v101, -v100
    v_mfma_f32_16x16x32_bf16 v[56:59], v[132:135], a[248:251], v[56:59]
    ds_read_b128 v[112:115], v14 offset:43008
    v_mfma_f32_16x16x32_bf16 v[56:59], v[128:131], a[240:243], v[56:59]
    ds_read_b128 v[116:119], v14 offset:47104
    v_fma_f32 v182, v162, v101, -v100
    v_mfma_f32_16x16x32_bf16 v[56:59], v[124:127], a[232:235], v[56:59]
    s_add_u32 m0, s73, 117760
    v_fma_f32 v183, v163, v101, -v100
    v_mfma_f32_16x16x32_bf16 v[56:59], v[120:123], a[224:227], v[56:59]
    buffer_load_dwordx4 v22, s[44:47], s23 offen offset:0 sc1 lds
    s_waitcnt lgkmcnt(2)
    v_mfma_f32_16x16x32_bf16 v[64:67], v[104:107], a[224:227], v[64:67]
    v_mfma_f32_16x16x32_bf16 v[64:67], v[108:111], a[232:235], v[64:67]
    s_waitcnt lgkmcnt(0)
    v_mfma_f32_16x16x32_bf16 v[64:67], v[112:115], a[240:243], v[64:67]
    ds_read_b128 v[120:123], v14 offset:35840
    v_mfma_f32_16x16x32_bf16 v[64:67], v[116:119], a[248:251], v[64:67]
    ds_read_b128 v[124:127], v14 offset:39936
    v_mfma_f32_16x16x32_bf16 v[68:71], v[116:119], a[252:255], v[68:71]
    ds_read_b128 v[128:131], v14 offset:44032
    v_mfma_f32_16x16x32_bf16 v[68:71], v[112:115], a[244:247], v[68:71]
    ds_read_b128 v[132:135], v14 offset:48128
    v_mfma_f32_16x16x32_bf16 v[68:71], v[108:111], a[236:239], v[68:71]
    v_mfma_f32_16x16x32_bf16 v[68:71], v[104:107], a[228:231], v[68:71]
    s_waitcnt lgkmcnt(2)
    v_mfma_f32_16x16x32_bf16 v[60:63], v[120:123], v[224:227], v[60:63]
    v_mfma_f32_16x16x32_bf16 v[60:63], v[124:127], v[232:235], v[60:63]
    s_waitcnt lgkmcnt(0)
    v_mfma_f32_16x16x32_bf16 v[60:63], v[128:131], v[240:243], v[60:63]
    s_waitcnt vmcnt(10)
    s_barrier
    v_mfma_f32_16x16x32_bf16 v[60:63], v[132:135], v[248:251], v[60:63]
    ds_read_b128 v[104:107], v14 offset:49152
    v_mfma_f32_16x16x32_bf16 v[56:59], v[132:135], v[244:247], v[56:59]
    ds_read_b128 v[108:111], v14 offset:53248
    v_mfma_f32_16x16x32_bf16 v[56:59], v[128:131], v[236:239], v[56:59]
    ds_read_b128 v[112:115], v14 offset:57344
    v_mfma_f32_16x16x32_bf16 v[56:59], v[124:127], v[228:231], v[56:59]
    ds_read_b128 v[116:119], v14 offset:61440
    v_mfma_f32_16x16x32_bf16 v[56:59], v[120:123], v[220:223], v[56:59]
    s_waitcnt lgkmcnt(2)
    v_mfma_f32_16x16x32_bf16 v[64:67], v[104:107], v[220:223], v[64:67]
    s_add_u32 m0, s73, 130560
    v_xor_b32 v186, s41, v10
    v_add_u32 v186, s43, v186
    v_mfma_f32_16x16x32_bf16 v[64:67], v[108:111], v[228:231], v[64:67]
    buffer_load_dwordx4 v22, s[44:47], s23 offen offset:512 sc1 lds
    ds_read_b64_tr_b16 v[12:13], v10 offset:16384
    s_waitcnt lgkmcnt(1)
    v_mfma_f32_16x16x32_bf16 v[64:67], v[112:115], v[236:239], v[64:67]
    ds_read_b128 v[120:123], v14 offset:50176
    v_mfma_f32_16x16x32_bf16 v[64:67], v[116:119], v[244:247], v[64:67]
    ds_read_b128 v[124:127], v14 offset:54272
    v_mfma_f32_16x16x32_bf16 v[68:71], v[116:119], v[248:251], v[68:71]
    ds_read_b128 v[128:131], v14 offset:58368
    ds_read_b64_tr_b16 v[24:25], v11 offset:16384
    v_mfma_f32_16x16x32_bf16 v[68:71], v[112:115], v[240:243], v[68:71]
    ds_read_b128 v[132:135], v14 offset:62464
    ds_read_b64_tr_b16 v[28:29], v10 offset:20480
    v_mfma_f32_16x16x32_bf16 v[68:71], v[108:111], v[232:235], v[68:71]
    s_add_u32 m0, s73, 132096
    ds_read_b64_tr_b16 v[190:191], v11 offset:20480
    v_mfma_f32_16x16x32_bf16 v[68:71], v[104:107], v[224:227], v[68:71]
    buffer_load_dwordx4 v22, s[44:47], s24 offen offset:0 sc1 lds
    ds_read_b64_tr_b16 v[142:143], v186 offset:18432
    s_waitcnt lgkmcnt(6)
    v_mfma_f32_16x16x32_bf16 v[76:79], v[120:123], a[4:7], v[76:79]
    s_add_u32 m0, s73, 132608
    s_waitcnt lgkmcnt(0)
    v_mfma_f32_16x16x32_bf16 v[76:79], v[124:127], a[12:15], v[76:79]
    buffer_load_dwordx4 v22, s[44:47], s24 offen offset:512 sc1 lds
    v_mfma_f32_16x16x32_bf16 v[76:79], v[128:131], a[20:23], v[76:79]
    ds_read_b128 v[104:107], v14 offset:51200
    v_and_b32 v9, 0xffff0000, v12
    v_mfma_f32_16x16x32_bf16 v[76:79], v[132:135], a[28:31], v[76:79]
    ds_read_b128 v[108:111], v14 offset:55296
    v_mfma_f32_16x16x32_bf16 v[72:75], v[132:135], a[24:27], v[72:75]
    ds_read_b128 v[112:115], v14 offset:59392
    v_lshlrev_b32 v8, 16, v12
    v_mfma_f32_16x16x32_bf16 v[72:75], v[128:131], a[16:19], v[72:75]
    ds_read_b128 v[116:119], v14 offset:63488
    v_cvt_pk_bf16_f32 v192, v56, v57
    v_mfma_f32_16x16x32_bf16 v[72:75], v[124:127], a[8:11], v[72:75]
    s_add_u32 m0, s73, 134144
    v_mul_f32 v165, v165, v9
    v_mfma_f32_16x16x32_bf16 v[72:75], v[120:123], a[0:3], v[72:75]
    buffer_load_dwordx4 v22, s[44:47], s25 offen offset:0 sc1 lds
    s_waitcnt lgkmcnt(2)
    v_mfma_f32_16x16x32_bf16 v[80:83], v[104:107], a[0:3], v[80:83]
    v_cvt_pk_bf16_f32 v193, v58, v59
    v_mul_f32 v164, v164, v8
    v_mfma_f32_16x16x32_bf16 v[80:83], v[108:111], a[8:11], v[80:83]
    v_and_b32 v31, 0xffff0000, v13
    s_waitcnt lgkmcnt(0)
    v_mfma_f32_16x16x32_bf16 v[80:83], v[112:115], a[16:19], v[80:83]
    ds_read_b128 v[120:123], v14 offset:52224
    v_lshlrev_b32 v30, 16, v13
    v_mfma_f32_16x16x32_bf16 v[80:83], v[116:119], a[24:27], v[80:83]
    ds_read_b128 v[124:127], v14 offset:56320
    v_cvt_pk_bf16_f32 v194, v60, v61
    v_mfma_f32_16x16x32_bf16 v[84:87], v[116:119], a[28:31], v[84:87]
    ds_read_b128 v[128:131], v14 offset:60416
    v_mfma_f32_16x16x32_bf16 v[84:87], v[112:115], a[20:23], v[84:87]
    ds_read_b128 v[132:135], v14 offset:64512
    v_mul_f32 v167, v167, v31
    v_mfma_f32_16x16x32_bf16 v[84:87], v[108:111], a[12:15], v[84:87]
    buffer_store_dwordx4 v[192:195], v136, s[44:47], s15 offen offset:0 sc1
    v_mul_f32 v166, v166, v30
    v_mfma_f32_16x16x32_bf16 v[84:87], v[104:107], a[4:7], v[84:87]
    s_waitcnt lgkmcnt(2)
    v_mfma_f32_16x16x32_bf16 v[76:79], v[120:123], a[36:39], v[76:79]
    v_and_b32 v9, 0xffff0000, v24
    v_mfma_f32_16x16x32_bf16 v[76:79], v[124:127], a[44:47], v[76:79]
    v_cvt_pk_bf16_f32 v196, v62, v63
    s_waitcnt lgkmcnt(0)
    v_mfma_f32_16x16x32_bf16 v[76:79], v[128:131], a[52:55], v[76:79]
    s_waitcnt vmcnt(9)
    s_barrier
    v_lshlrev_b32 v8, 16, v24
    v_mfma_f32_16x16x32_bf16 v[76:79], v[132:135], a[60:63], v[76:79]
    ds_read_b128 v[104:107], v14 offset:0
    v_mul_f32 v169, v169, v9
    v_mfma_f32_16x16x32_bf16 v[72:75], v[132:135], a[56:59], v[72:75]
    ds_read_b128 v[108:111], v14 offset:4096
    v_cvt_pk_bf16_f32 v197, v64, v65
    v_mfma_f32_16x16x32_bf16 v[72:75], v[128:131], a[48:51], v[72:75]
    ds_read_b128 v[112:115], v14 offset:8192
    v_mul_f32 v168, v168, v8
    v_mfma_f32_16x16x32_bf16 v[72:75], v[124:127], a[40:43], v[72:75]
    ds_read_b128 v[116:119], v14 offset:12288
    v_mfma_f32_16x16x32_bf16 v[72:75], v[120:123], a[32:35], v[72:75]
    v_cvt_pk_bf16_f32 v198, v66, v67
    s_waitcnt lgkmcnt(2)
    v_mfma_f32_16x16x32_bf16 v[80:83], v[104:107], a[32:35], v[80:83]
    s_add_u32 m0, s73, 146944
    v_and_b32 v31, 0xffff0000, v25
    v_lshlrev_b32 v30, 16, v25
    v_mfma_f32_16x16x32_bf16 v[80:83], v[108:111], a[40:43], v[80:83]
    buffer_load_dwordx4 v22, s[44:47], s25 offen offset:512 sc1 lds
    s_waitcnt lgkmcnt(0)
    v_mfma_f32_16x16x32_bf16 v[80:83], v[112:115], a[48:51], v[80:83]
    buffer_store_dwordx4 v[196:199], v136, s[44:47], s15 offen offset:1024 sc1
    ds_read_b128 v[120:123], v14 offset:1024
    v_mfma_f32_16x16x32_bf16 v[80:83], v[116:119], a[56:59], v[80:83]
    ds_read_b128 v[124:127], v14 offset:5120
    v_mul_f32 v171, v171, v31
    v_mfma_f32_16x16x32_bf16 v[84:87], v[116:119], a[60:63], v[84:87]
    ds_read_b128 v[128:131], v14 offset:9216
    v_mul_f32 v170, v170, v30
    v_mfma_f32_16x16x32_bf16 v[84:87], v[112:115], a[52:55], v[84:87]
    ds_read_b128 v[132:135], v14 offset:13312
    v_mfma_f32_16x16x32_bf16 v[84:87], v[108:111], a[44:47], v[84:87]
    s_add_u32 m0, s73, 148480
    v_cvt_pk_bf16_f32 v200, v68, v69
    v_and_b32 v9, 0xffff0000, v28
    v_mfma_f32_16x16x32_bf16 v[84:87], v[104:107], a[36:39], v[84:87]
    buffer_load_dwordx4 v22, s[44:47], s26 offen offset:0 sc1 lds
    s_waitcnt lgkmcnt(2)
    v_mfma_f32_16x16x32_bf16 v[76:79], v[120:123], a[68:71], v[76:79]
    s_add_u32 m0, s73, 148992
    v_lshlrev_b32 v8, 16, v28
    v_mfma_f32_16x16x32_bf16 v[76:79], v[124:127], a[76:79], v[76:79]
    buffer_load_dwordx4 v22, s[44:47], s26 offen offset:512 sc1 lds
    s_waitcnt lgkmcnt(0)
    v_mfma_f32_16x16x32_bf16 v[76:79], v[128:131], a[84:87], v[76:79]
    ds_read_b128 v[104:107], v14 offset:2048
    v_cvt_pk_bf16_f32 v201, v70, v71
    v_mfma_f32_16x16x32_bf16 v[76:79], v[132:135], a[92:95], v[76:79]
    ds_read_b128 v[108:111], v14 offset:6144
    v_mul_f32 v173, v173, v9
    v_mfma_f32_16x16x32_bf16 v[72:75], v[132:135], a[88:91], v[72:75]
    ds_read_b128 v[112:115], v14 offset:10240
    v_mul_f32 v172, v172, v8
    v_mfma_f32_16x16x32_bf16 v[72:75], v[128:131], a[80:83], v[72:75]
    ds_read_b128 v[116:119], v14 offset:14336
    v_and_b32 v31, 0xffff0000, v29
    v_mfma_f32_16x16x32_bf16 v[72:75], v[124:127], a[72:75], v[72:75]
    buffer_store_dwordx4 v[200:203], v136, s[44:47], s15 offen offset:2048 sc1
    s_add_u32 m0, s73, 150528
    v_mfma_f32_16x16x32_bf16 v[72:75], v[120:123], a[64:67], v[72:75]
    buffer_load_dwordx4 v19, s[44:47], s18 offen offset:0 sc1 lds
    s_waitcnt lgkmcnt(2)
    v_mfma_f32_16x16x32_bf16 v[80:83], v[104:107], a[64:67], v[80:83]
    v_lshlrev_b32 v30, 16, v29
    v_mul_f32 v175, v175, v31
    v_mfma_f32_16x16x32_bf16 v[80:83], v[108:111], a[72:75], v[80:83]
    buffer_load_dwordx4 v[40:43], v136, s[44:47], s34 offen offset:0 sc1
    s_waitcnt lgkmcnt(0)
    v_mfma_f32_16x16x32_bf16 v[80:83], v[112:115], a[80:83], v[80:83]
    ds_read_b128 v[120:123], v14 offset:3072
    v_mfma_f32_16x16x32_bf16 v[80:83], v[116:119], a[88:91], v[80:83]
    ds_read_b128 v[124:127], v14 offset:7168
    v_mul_f32 v174, v174, v30
    v_mfma_f32_16x16x32_bf16 v[84:87], v[116:119], a[92:95], v[84:87]
    ds_read_b128 v[128:131], v14 offset:11264
    v_and_b32 v9, 0xffff0000, v190
    v_mfma_f32_16x16x32_bf16 v[84:87], v[112:115], a[84:87], v[84:87]
    ds_read_b128 v[132:135], v14 offset:15360
    buffer_load_dwordx4 v[44:47], v136, s[44:47], s34 offen offset:1024 sc1
    v_mfma_f32_16x16x32_bf16 v[84:87], v[108:111], a[76:79], v[84:87]
    v_lshlrev_b32 v8, 16, v190
    v_mfma_f32_16x16x32_bf16 v[84:87], v[104:107], a[68:71], v[84:87]
    s_waitcnt lgkmcnt(2)
    v_mfma_f32_16x16x32_bf16 v[76:79], v[120:123], a[100:103], v[76:79]
    buffer_load_dwordx4 v[48:51], v136, s[44:47], s34 offen offset:2048 sc1
    v_mul_f32 v177, v177, v9
    v_mfma_f32_16x16x32_bf16 v[76:79], v[124:127], a[108:111], v[76:79]
    s_waitcnt lgkmcnt(0)
    v_mfma_f32_16x16x32_bf16 v[76:79], v[128:131], a[116:119], v[76:79]
    s_waitcnt vmcnt(14)
    s_barrier
    v_mul_f32 v176, v176, v8
    v_mfma_f32_16x16x32_bf16 v[76:79], v[132:135], a[124:127], v[76:79]
    ds_read_b128 v[104:107], v14 offset:16384
    v_and_b32 v31, 0xffff0000, v191
    v_mfma_f32_16x16x32_bf16 v[72:75], v[132:135], a[120:123], v[72:75]
    ds_read_b128 v[108:111], v14 offset:20480
    buffer_load_dwordx4 v[204:207], v136, s[44:47], s35 offen offset:0 sc1
    v_mfma_f32_16x16x32_bf16 v[72:75], v[128:131], a[112:115], v[72:75]
    ds_read_b128 v[112:115], v14 offset:24576
    v_lshlrev_b32 v30, 16, v191
    v_mfma_f32_16x16x32_bf16 v[72:75], v[124:127], a[104:107], v[72:75]
    ds_read_b128 v[116:119], v14 offset:28672
    v_mul_f32 v179, v179, v31
    v_mfma_f32_16x16x32_bf16 v[72:75], v[120:123], a[96:99], v[72:75]
    buffer_load_dwordx4 v[208:211], v136, s[44:47], s35 offen offset:1024 sc1
    s_waitcnt lgkmcnt(2)
    v_mfma_f32_16x16x32_bf16 v[80:83], v[104:107], a[96:99], v[80:83]
    v_mfma_f32_16x16x32_bf16 v[80:83], v[108:111], a[104:107], v[80:83]
    v_mul_f32 v178, v178, v30
    s_waitcnt lgkmcnt(0)
    v_mfma_f32_16x16x32_bf16 v[80:83], v[112:115], a[112:115], v[80:83]
    ds_read_b128 v[120:123], v14 offset:17408
    buffer_load_dwordx4 v[212:215], v136, s[44:47], s35 offen offset:2048 sc1
    v_mfma_f32_16x16x32_bf16 v[80:83], v[116:119], a[120:123], v[80:83]
    ds_read_b128 v[124:127], v14 offset:21504
    v_and_b32 v9, 0xffff0000, v142
    v_mfma_f32_16x16x32_bf16 v[84:87], v[116:119], a[124:127], v[84:87]
    ds_read_b128 v[128:131], v14 offset:25600
    v_lshlrev_b32 v8, 16, v142
    v_mfma_f32_16x16x32_bf16 v[84:87], v[112:115], a[116:119], v[84:87]
    ds_read_b128 v[132:135], v14 offset:29696
    v_mfma_f32_16x16x32_bf16 v[84:87], v[108:111], a[108:111], v[84:87]
    buffer_load_dwordx4 v[216:219], v136, s[44:47], s35 offen offset:3072 sc1
    v_mul_f32 v181, v181, v9
    v_mfma_f32_16x16x32_bf16 v[84:87], v[104:107], a[100:103], v[84:87]
    s_waitcnt lgkmcnt(2)
    v_mfma_f32_16x16x32_bf16 v[76:79], v[120:123], a[132:135], v[76:79]
    v_mul_f32 v180, v180, v8
    v_mfma_f32_16x16x32_bf16 v[76:79], v[124:127], a[140:143], v[76:79]
    v_and_b32 v31, 0xffff0000, v143
    s_waitcnt lgkmcnt(0)
    v_mfma_f32_16x16x32_bf16 v[76:79], v[128:131], a[148:151], v[76:79]
    ds_read_b128 v[104:107], v14 offset:18432
    v_mfma_f32_16x16x32_bf16 v[76:79], v[132:135], a[156:159], v[76:79]
    ds_read_b128 v[108:111], v14 offset:22528
    v_lshlrev_b32 v30, 16, v143
    v_mfma_f32_16x16x32_bf16 v[72:75], v[132:135], a[152:155], v[72:75]
    ds_read_b128 v[112:115], v14 offset:26624
    v_mfma_f32_16x16x32_bf16 v[72:75], v[128:131], a[144:147], v[72:75]
    ds_read_b128 v[116:119], v14 offset:30720
    v_mul_f32 v183, v183, v31
    v_mfma_f32_16x16x32_bf16 v[72:75], v[124:127], a[136:139], v[72:75]
    v_mfma_f32_16x16x32_bf16 v[72:75], v[120:123], a[128:131], v[72:75]
    v_mul_f32 v182, v182, v30
    s_waitcnt lgkmcnt(2)
    v_mfma_f32_16x16x32_bf16 v[80:83], v[104:107], a[128:131], v[80:83]
    v_mfma_f32_16x16x32_bf16 v[80:83], v[108:111], a[136:139], v[80:83]
    s_waitcnt lgkmcnt(0)
    v_mfma_f32_16x16x32_bf16 v[80:83], v[112:115], a[144:147], v[80:83]
    ds_read_b128 v[120:123], v14 offset:19456
    v_mfma_f32_16x16x32_bf16 v[80:83], v[116:119], a[152:155], v[80:83]
    ds_read_b128 v[124:127], v14 offset:23552
    v_mfma_f32_16x16x32_bf16 v[84:87], v[116:119], a[156:159], v[84:87]
    ds_read_b128 v[128:131], v14 offset:27648
    v_mfma_f32_16x16x32_bf16 v[84:87], v[112:115], a[148:151], v[84:87]
    ds_read_b128 v[132:135], v14 offset:31744
    v_mfma_f32_16x16x32_bf16 v[84:87], v[108:111], a[140:143], v[84:87]
    v_mfma_f32_16x16x32_bf16 v[84:87], v[104:107], a[132:135], v[84:87]
    s_waitcnt lgkmcnt(2)
    v_mfma_f32_16x16x32_bf16 v[76:79], v[120:123], a[164:167], v[76:79]
    s_add_u32 m0, s73, 97792
    v_mfma_f32_16x16x32_bf16 v[76:79], v[124:127], a[172:175], v[76:79]
    buffer_load_dwordx4 v19, s[44:47], s18 offen offset:512 sc1 lds
    s_waitcnt lgkmcnt(0)
    v_mfma_f32_16x16x32_bf16 v[76:79], v[128:131], a[180:183], v[76:79]
    s_waitcnt vmcnt(15)
    s_barrier
    v_mfma_f32_16x16x32_bf16 v[76:79], v[132:135], a[188:191], v[76:79]
    ds_read_b128 v[104:107], v14 offset:32768
    v_mfma_f32_16x16x32_bf16 v[72:75], v[132:135], a[184:187], v[72:75]
    ds_read_b128 v[108:111], v14 offset:36864
    v_mfma_f32_16x16x32_bf16 v[72:75], v[128:131], a[176:179], v[72:75]
    ds_read_b128 v[112:115], v14 offset:40960
    v_mfma_f32_16x16x32_bf16 v[72:75], v[124:127], a[168:171], v[72:75]
    ds_read_b128 v[116:119], v14 offset:45056
    s_add_u32 m0, s73, 99328
    v_mfma_f32_16x16x32_bf16 v[72:75], v[120:123], a[160:163], v[72:75]
    buffer_load_dwordx4 v19, s[44:47], s19 offen offset:0 sc1 lds
    s_waitcnt lgkmcnt(2)
    v_mfma_f32_16x16x32_bf16 v[80:83], v[104:107], a[160:163], v[80:83]
    s_add_u32 m0, s73, 99840
    v_mfma_f32_16x16x32_bf16 v[80:83], v[108:111], a[168:171], v[80:83]
    buffer_load_dwordx4 v19, s[44:47], s19 offen offset:512 sc1 lds
    s_waitcnt lgkmcnt(0)
    v_mfma_f32_16x16x32_bf16 v[80:83], v[112:115], a[176:179], v[80:83]
    ds_read_b128 v[120:123], v14 offset:33792
    v_mfma_f32_16x16x32_bf16 v[80:83], v[116:119], a[184:187], v[80:83]
    ds_read_b128 v[124:127], v14 offset:37888
    v_mfma_f32_16x16x32_bf16 v[84:87], v[116:119], a[188:191], v[84:87]
    ds_read_b128 v[128:131], v14 offset:41984
    v_mfma_f32_16x16x32_bf16 v[84:87], v[112:115], a[180:183], v[84:87]
    ds_read_b128 v[132:135], v14 offset:46080
    v_mfma_f32_16x16x32_bf16 v[84:87], v[108:111], a[172:175], v[84:87]
    s_add_u32 m0, s73, 101376
    v_mfma_f32_16x16x32_bf16 v[84:87], v[104:107], a[164:167], v[84:87]
    buffer_load_dwordx4 v19, s[44:47], s20 offen offset:0 sc1 lds
    s_waitcnt lgkmcnt(2)
    v_mfma_f32_16x16x32_bf16 v[76:79], v[120:123], a[196:199], v[76:79]
    s_add_u32 m0, s73, 114176
    v_mov_b32 v141, 0
    v_mfma_f32_16x16x32_bf16 v[76:79], v[124:127], a[204:207], v[76:79]
    buffer_load_dwordx4 v19, s[44:47], s20 offen offset:512 sc1 lds
    s_waitcnt lgkmcnt(0)
    v_mfma_f32_16x16x32_bf16 v[76:79], v[128:131], a[212:215], v[76:79]
    ds_read_b128 v[104:107], v14 offset:34816
    v_mfma_f32_16x16x32_bf16 v[76:79], v[132:135], a[220:223], v[76:79]
    ds_read_b128 v[108:111], v14 offset:38912
    buffer_atomic_add v141, v139, s[44:47], s11 offen offset:2060 sc0 sc1
    v_mfma_f32_16x16x32_bf16 v[72:75], v[132:135], a[216:219], v[72:75]
    ds_read_b128 v[112:115], v14 offset:43008
    v_mfma_f32_16x16x32_bf16 v[72:75], v[128:131], a[208:211], v[72:75]
    ds_read_b128 v[116:119], v14 offset:47104
    v_mfma_f32_16x16x32_bf16 v[72:75], v[124:127], a[200:203], v[72:75]
    s_add_u32 m0, s73, 115712
    v_mfma_f32_16x16x32_bf16 v[72:75], v[120:123], a[192:195], v[72:75]
    buffer_load_dwordx4 v19, s[44:47], s21 offen offset:0 sc1 lds
    s_waitcnt lgkmcnt(2)
    v_mfma_f32_16x16x32_bf16 v[80:83], v[104:107], a[192:195], v[80:83]
    s_add_u32 m0, s73, 116224
    v_mfma_f32_16x16x32_bf16 v[80:83], v[108:111], a[200:203], v[80:83]
    buffer_load_dwordx4 v19, s[44:47], s21 offen offset:512 sc1 lds
    s_waitcnt lgkmcnt(0)
    v_mfma_f32_16x16x32_bf16 v[80:83], v[112:115], a[208:211], v[80:83]
    ds_read_b128 v[120:123], v14 offset:35840
    v_mfma_f32_16x16x32_bf16 v[80:83], v[116:119], a[216:219], v[80:83]
    ds_read_b128 v[124:127], v14 offset:39936
    v_mfma_f32_16x16x32_bf16 v[84:87], v[116:119], a[220:223], v[84:87]
    ds_read_b128 v[128:131], v14 offset:44032
    v_mfma_f32_16x16x32_bf16 v[84:87], v[112:115], a[212:215], v[84:87]
    ds_read_b128 v[132:135], v14 offset:48128
    v_mfma_f32_16x16x32_bf16 v[84:87], v[108:111], a[204:207], v[84:87]
    s_add_u32 m0, s73, 117760
    v_mfma_f32_16x16x32_bf16 v[84:87], v[104:107], a[196:199], v[84:87]
    buffer_load_dwordx4 v19, s[44:47], s22 offen offset:0 sc1 lds
    s_waitcnt lgkmcnt(2)
    v_mfma_f32_16x16x32_bf16 v[76:79], v[120:123], a[228:231], v[76:79]
    v_mfma_f32_16x16x32_bf16 v[76:79], v[124:127], a[236:239], v[76:79]
    s_waitcnt lgkmcnt(0)
    v_mfma_f32_16x16x32_bf16 v[76:79], v[128:131], a[244:247], v[76:79]
    s_waitcnt vmcnt(16)
    s_barrier
    v_mfma_f32_16x16x32_bf16 v[76:79], v[132:135], a[252:255], v[76:79]
    ds_read_b128 v[104:107], v14 offset:49152
    v_mfma_f32_16x16x32_bf16 v[72:75], v[132:135], a[248:251], v[72:75]
    ds_read_b128 v[108:111], v14 offset:53248
    v_mfma_f32_16x16x32_bf16 v[72:75], v[128:131], a[240:243], v[72:75]
    ds_read_b128 v[112:115], v14 offset:57344
    v_mfma_f32_16x16x32_bf16 v[72:75], v[124:127], a[232:235], v[72:75]
    ds_read_b128 v[116:119], v14 offset:61440
    v_mfma_f32_16x16x32_bf16 v[72:75], v[120:123], a[224:227], v[72:75]
    s_waitcnt lgkmcnt(2)
    v_mfma_f32_16x16x32_bf16 v[80:83], v[104:107], a[224:227], v[80:83]
    s_add_u32 m0, s73, 130560
    v_mfma_f32_16x16x32_bf16 v[80:83], v[108:111], a[232:235], v[80:83]
    buffer_load_dwordx4 v19, s[44:47], s22 offen offset:512 sc1 lds
    s_waitcnt lgkmcnt(0)
    v_mfma_f32_16x16x32_bf16 v[80:83], v[112:115], a[240:243], v[80:83]
    ds_read_b128 v[120:123], v14 offset:50176
    v_mfma_f32_16x16x32_bf16 v[80:83], v[116:119], a[248:251], v[80:83]
    ds_read_b128 v[124:127], v14 offset:54272
    v_mfma_f32_16x16x32_bf16 v[84:87], v[116:119], a[252:255], v[84:87]
    ds_read_b128 v[128:131], v14 offset:58368
    v_mfma_f32_16x16x32_bf16 v[84:87], v[112:115], a[244:247], v[84:87]
    ds_read_b128 v[132:135], v14 offset:62464
    v_mfma_f32_16x16x32_bf16 v[84:87], v[108:111], a[236:239], v[84:87]
    s_add_u32 m0, s73, 132096
    v_mfma_f32_16x16x32_bf16 v[84:87], v[104:107], a[228:231], v[84:87]
    buffer_load_dwordx4 v19, s[44:47], s23 offen offset:0 sc1 lds
    s_waitcnt lgkmcnt(2)
    v_mfma_f32_16x16x32_bf16 v[76:79], v[120:123], v[224:227], v[76:79]
    s_add_u32 m0, s73, 132608
    s_waitcnt vmcnt(15)
    v_bitop3_b32 v43, v43, v47, s68 bitop3:0x7e
    v_bitop3_b32 v43, v43, v51, s68 bitop3:0xf6
    v_cmp_ne_u32 vcc, 0, v43
    v_mfma_f32_16x16x32_bf16 v[76:79], v[124:127], v[232:235], v[76:79]
    buffer_load_dwordx4 v19, s[44:47], s23 offen offset:512 sc1 lds
    s_waitcnt lgkmcnt(0)
    v_mfma_f32_16x16x32_bf16 v[76:79], v[128:131], v[240:243], v[76:79]
    ds_read_b128 v[104:107], v14 offset:51200
    s_cbranch_vccnz L_xs_a
L_xo_a:
    v_and_b32 v89, 0xffff0000, v40
    v_mfma_f32_16x16x32_bf16 v[76:79], v[132:135], v[248:251], v[76:79]
    ds_read_b128 v[108:111], v14 offset:55296
    v_lshlrev_b32 v88, 16, v40
    v_mfma_f32_16x16x32_bf16 v[72:75], v[132:135], v[244:247], v[72:75]
    ds_read_b128 v[112:115], v14 offset:59392
    v_and_b32 v91, 0xffff0000, v41
    v_mfma_f32_16x16x32_bf16 v[72:75], v[128:131], v[236:239], v[72:75]
    ds_read_b128 v[116:119], v14 offset:63488
    v_lshlrev_b32 v90, 16, v41
    v_mfma_f32_16x16x32_bf16 v[72:75], v[124:127], v[228:231], v[72:75]
    s_add_u32 m0, s73, 134144
    v_and_b32 v93, 0xffff0000, v42
    v_lshlrev_b32 v92, 16, v42
    v_mfma_f32_16x16x32_bf16 v[72:75], v[120:123], v[220:223], v[72:75]
    buffer_load_dwordx4 v19, s[44:47], s24 offen offset:0 sc1 lds
    s_waitcnt lgkmcnt(2)
    v_mfma_f32_16x16x32_bf16 v[80:83], v[104:107], v[220:223], v[80:83]
    v_and_b32 v95, 0xffff0000, v44
    v_lshlrev_b32 v94, 16, v44
    v_mfma_f32_16x16x32_bf16 v[80:83], v[108:111], v[228:231], v[80:83]
    v_and_b32 v97, 0xffff0000, v45
    s_waitcnt lgkmcnt(0)
    v_mfma_f32_16x16x32_bf16 v[80:83], v[112:115], v[236:239], v[80:83]
    ds_read_b128 v[120:123], v14 offset:52224
    v_lshlrev_b32 v96, 16, v45
    v_mfma_f32_16x16x32_bf16 v[80:83], v[116:119], v[244:247], v[80:83]
    ds_read_b128 v[124:127], v14 offset:56320
    v_and_b32 v99, 0xffff0000, v46
    v_lshlrev_b32 v98, 16, v46
    v_mfma_f32_16x16x32_bf16 v[84:87], v[116:119], v[248:251], v[84:87]
    ds_read_b128 v[128:131], v14 offset:60416
    s_waitcnt vmcnt(7)
    v_and_b32 v101, 0xffff0000, v48
    v_mfma_f32_16x16x32_bf16 v[84:87], v[112:115], v[240:243], v[84:87]
    ds_read_b128 v[132:135], v14 offset:64512
    v_lshlrev_b32 v100, 16, v48
    v_cmp_ne_u32 vcc, v140, v141
    v_mfma_f32_16x16x32_bf16 v[84:87], v[108:111], v[232:235], v[84:87]
    v_and_b32 v103, 0xffff0000, v49
L_pl_D_2:
    s_cbranch_execz L_wret
    v_lshlrev_b32 v102, 16, v49
    v_mfma_f32_16x16x32_bf16 v[84:87], v[104:107], v[224:227], v[84:87]
    s_cbranch_vccnz L_as_b
L_ao_b:
    s_waitcnt lgkmcnt(2)
    v_mfma_f32_16x16x32_bf16 v[92:95], v[120:123], a[4:7], v[92:95]
    buffer_load_dwordx4 v[56:59], v136, s[44:47], s11 offen offset:0 sc1
    v_mfma_f32_16x16x32_bf16 v[92:95], v[124:127], a[12:15], v[92:95]
    s_waitcnt lgkmcnt(0)
    v_mfma_f32_16x16x32_bf16 v[92:95], v[128:131], a[20:23], v[92:95]
    buffer_load_dwordx4 v[60:63], v136, s[44:47], s11 offen offset:1024 sc1
    s_barrier
    v_mfma_f32_16x16x32_bf16 v[92:95], v[132:135], a[28:31], v[92:95]
    ds_read_b128 v[104:107], v14 offset:0
    buffer_load_dwordx4 v[64:67], v136, s[44:47], s11 offen offset:2048 sc1
    v_mfma_f32_16x16x32_bf16 v[88:91], v[132:135], a[24:27], v[88:91]
    ds_read_b128 v[108:111], v14 offset:4096
    v_cvt_pk_bf16_f32 v192, v72, v73
    v_mfma_f32_16x16x32_bf16 v[88:91], v[128:131], a[16:19], v[88:91]
    ds_read_b128 v[112:115], v14 offset:8192
    v_cvt_pk_bf16_f32 v193, v74, v75
    v_mfma_f32_16x16x32_bf16 v[88:91], v[124:127], a[8:11], v[88:91]
    ds_read_b128 v[116:119], v14 offset:12288
    v_cvt_pk_bf16_f32 v194, v76, v77
    v_mfma_f32_16x16x32_bf16 v[88:91], v[120:123], a[0:3], v[88:91]
    buffer_store_dwordx4 v[192:195], v136, s[44:47], s31 offen offset:0 sc1
    s_waitcnt lgkmcnt(2)
    v_mfma_f32_16x16x32_bf16 v[96:99], v[104:107], a[0:3], v[96:99]
    s_add_u32 m0, s73, 146944
    v_cvt_pk_bf16_f32 v196, v78, v79
    v_cvt_pk_bf16_f32 v197, v80, v81
    v_mfma_f32_16x16x32_bf16 v[96:99], v[108:111], a[8:11], v[96:99]
    buffer_load_dwordx4 v19, s[44:47], s24 offen offset:512 sc1 lds
    s_waitcnt lgkmcnt(0)
    v_mfma_f32_16x16x32_bf16 v[96:99], v[112:115], a[16:19], v[96:99]
    ds_read_b128 v[120:123], v14 offset:1024
    v_cvt_pk_bf16_f32 v198, v82, v83
    v_mfma_f32_16x16x32_bf16 v[96:99], v[116:119], a[24:27], v[96:99]
    buffer_store_dwordx4 v[196:199], v136, s[44:47], s31 offen offset:1024 sc1
    ds_read_b128 v[124:127], v14 offset:5120
    v_bitop3_b32 v207, v207, v211, s36 bitop3:0x7e
    v_bitop3_b32 v207, v207, v215, s36 bitop3:0xf6
    v_mfma_f32_16x16x32_bf16 v[100:103], v[116:119], a[28:31], v[100:103]
    ds_read_b128 v[128:131], v14 offset:9216
    v_cvt_pk_bf16_f32 v200, v84, v85
    v_mfma_f32_16x16x32_bf16 v[100:103], v[112:115], a[20:23], v[100:103]
    ds_read_b128 v[132:135], v14 offset:13312
    v_cvt_pk_bf16_f32 v201, v86, v87
    v_mfma_f32_16x16x32_bf16 v[100:103], v[108:111], a[12:15], v[100:103]
    buffer_store_dwordx4 v[200:203], v136, s[44:47], s31 offen offset:2048 sc1
    s_add_u32 m0, s73, 148480
    v_bitop3_b32 v207, v207, v219, s36 bitop3:0xf6
    v_cmp_ne_u32 vcc, 0, v207
    v_mfma_f32_16x16x32_bf16 v[100:103], v[104:107], a[4:7], v[100:103]
    buffer_load_dwordx4 v19, s[44:47], s25 offen offset:0 sc1 lds
    s_waitcnt lgkmcnt(2)
    v_mfma_f32_16x16x32_bf16 v[92:95], v[120:123], a[36:39], v[92:95]
    s_add_u32 m0, s73, 148992
    s_cbranch_vccnz L_xs_8
L_xo_8:
    v_mfma_f32_16x16x32_bf16 v[92:95], v[124:127], a[44:47], v[92:95]
    buffer_load_dwordx4 v19, s[44:47], s25 offen offset:512 sc1 lds
    s_waitcnt lgkmcnt(0)
    v_mfma_f32_16x16x32_bf16 v[92:95], v[128:131], a[52:55], v[92:95]
    ds_read_b128 v[104:107], v14 offset:2048
    v_and_b32 v33, 0xffff0000, v204
    v_mfma_f32_16x16x32_bf16 v[92:95], v[132:135], a[60:63], v[92:95]
    ds_read_b128 v[108:111], v14 offset:6144
    v_lshlrev_b32 v32, 16, v204
    v_mfma_f32_16x16x32_bf16 v[88:91], v[132:135], a[56:59], v[88:91]
    ds_read_b128 v[112:115], v14 offset:10240
    v_and_b32 v35, 0xffff0000, v205
    v_mfma_f32_16x16x32_bf16 v[88:91], v[128:131], a[48:51], v[88:91]
    ds_read_b128 v[116:119], v14 offset:14336
    v_mfma_f32_16x16x32_bf16 v[88:91], v[124:127], a[40:43], v[88:91]
    s_add_u32 m0, s73, 150528
    v_lshlrev_b32 v34, 16, v205
    v_mfma_f32_16x16x32_bf16 v[88:91], v[120:123], a[32:35], v[88:91]
    buffer_load_dwordx4 v19, s[44:47], s26 offen offset:0 sc1 lds
    s_waitcnt lgkmcnt(2)
    v_mfma_f32_16x16x32_bf16 v[96:99], v[104:107], a[32:35], v[96:99]
    v_add_f32 v32, v32, v27
    v_mfma_f32_16x16x32_bf16 v[96:99], v[108:111], a[40:43], v[96:99]
    v_add_f32 v33, v33, v27
    s_waitcnt lgkmcnt(0)
    v_mfma_f32_16x16x32_bf16 v[96:99], v[112:115], a[48:51], v[96:99]
    ds_read_b128 v[120:123], v14 offset:3072
    v_add_f32 v34, v34, v27
    v_mfma_f32_16x16x32_bf16 v[96:99], v[116:119], a[56:59], v[96:99]
    ds_read_b128 v[124:127], v14 offset:7168
    v_mfma_f32_16x16x32_bf16 v[100:103], v[116:119], a[60:63], v[100:103]
    ds_read_b128 v[128:131], v14 offset:11264
    v_add_f32 v35, v35, v27
    v_mfma_f32_16x16x32_bf16 v[100:103], v[112:115], a[52:55], v[100:103]
    ds_read_b128 v[132:135], v14 offset:15360
    v_and_b32 v37, 0xffff0000, v208
    v_mfma_f32_16x16x32_bf16 v[100:103], v[108:111], a[44:47], v[100:103]
    v_mfma_f32_16x16x32_bf16 v[100:103], v[104:107], a[36:39], v[100:103]
    v_lshlrev_b32 v36, 16, v208
    s_waitcnt lgkmcnt(2)
    v_mfma_f32_16x16x32_bf16 v[92:95], v[120:123], a[68:71], v[92:95]
    v_and_b32 v39, 0xffff0000, v209
    v_mfma_f32_16x16x32_bf16 v[92:95], v[124:127], a[76:79], v[92:95]
    s_waitcnt lgkmcnt(0)
    v_mfma_f32_16x16x32_bf16 v[92:95], v[128:131], a[84:87], v[92:95]
    s_waitcnt vmcnt(14)
    s_barrier
    v_lshlrev_b32 v38, 16, v209
    v_mfma_f32_16x16x32_bf16 v[92:95], v[132:135], a[92:95], v[92:95]
    ds_read_b128 v[104:107], v14 offset:16384
    v_add_f32 v32, v32, v36
    v_mfma_f32_16x16x32_bf16 v[88:91], v[132:135], a[88:91], v[88:91]
    ds_read_b128 v[108:111], v14 offset:20480
    v_mfma_f32_16x16x32_bf16 v[88:91], v[128:131], a[80:83], v[88:91]
    ds_read_b128 v[112:115], v14 offset:24576
    v_add_f32 v33, v33, v37
    v_mfma_f32_16x16x32_bf16 v[88:91], v[124:127], a[72:75], v[88:91]
    ds_read_b128 v[116:119], v14 offset:28672
    v_add_f32 v34, v34, v38
    v_mfma_f32_16x16x32_bf16 v[88:91], v[120:123], a[64:67], v[88:91]
    s_waitcnt lgkmcnt(2)
    v_mfma_f32_16x16x32_bf16 v[96:99], v[104:107], a[64:67], v[96:99]
    s_add_u32 m0, s73, 97792
    v_add_f32 v35, v35, v39
    v_mfma_f32_16x16x32_bf16 v[96:99], v[108:111], a[72:75], v[96:99]
    buffer_load_dwordx4 v19, s[44:47], s26 offen offset:512 sc1 lds
    s_waitcnt lgkmcnt(0)
    v_mfma_f32_16x16x32_bf16 v[96:99], v[112:115], a[80:83], v[96:99]
    ds_read_b128 v[120:123], v14 offset:17408
    v_and_b32 v37, 0xffff0000, v212
    v_mfma_f32_16x16x32_bf16 v[96:99], v[116:119], a[88:91], v[96:99]
    ds_read_b128 v[124:127], v14 offset:21504
    v_lshlrev_b32 v36, 16, v212
    v_mfma_f32_16x16x32_bf16 v[100:103], v[116:119], a[92:95], v[100:103]
    ds_read_b128 v[128:131], v14 offset:25600
    v_and_b32 v39, 0xffff0000, v213
    v_mfma_f32_16x16x32_bf16 v[100:103], v[112:115], a[84:87], v[100:103]
    ds_read_b128 v[132:135], v14 offset:29696
    v_mfma_f32_16x16x32_bf16 v[100:103], v[108:111], a[76:79], v[100:103]
    v_lshlrev_b32 v38, 16, v213
    v_mfma_f32_16x16x32_bf16 v[100:103], v[104:107], a[68:71], v[100:103]
    v_add_f32 v32, v32, v36
    s_waitcnt lgkmcnt(2)
    v_mfma_f32_16x16x32_bf16 v[92:95], v[120:123], a[100:103], v[92:95]
    v_mfma_f32_16x16x32_bf16 v[92:95], v[124:127], a[108:111], v[92:95]
    v_add_f32 v33, v33, v37
    s_waitcnt lgkmcnt(0)
    v_mfma_f32_16x16x32_bf16 v[92:95], v[128:131], a[116:119], v[92:95]
    ds_read_b128 v[104:107], v14 offset:18432
    v_add_f32 v34, v34, v38
    v_mfma_f32_16x16x32_bf16 v[92:95], v[132:135], a[124:127], v[92:95]
    ds_read_b128 v[108:111], v14 offset:22528
    v_add_f32 v35, v35, v39
    v_mfma_f32_16x16x32_bf16 v[88:91], v[132:135], a[120:123], v[88:91]
    ds_read_b128 v[112:115], v14 offset:26624
    v_and_b32 v37, 0xffff0000, v216
    v_mfma_f32_16x16x32_bf16 v[88:91], v[128:131], a[112:115], v[88:91]
    ds_read_b128 v[116:119], v14 offset:30720
    v_lshlrev_b32 v36, 16, v216
    v_mfma_f32_16x16x32_bf16 v[88:91], v[124:127], a[104:107], v[88:91]
    v_and_b32 v39, 0xffff0000, v217
    v_lshlrev_b32 v38, 16, v217
    v_mfma_f32_16x16x32_bf16 v[88:91], v[120:123], a[96:99], v[88:91]
    v_add_f32 v32, v32, v36
    s_waitcnt lgkmcnt(2)
    v_mfma_f32_16x16x32_bf16 v[96:99], v[104:107], a[96:99], v[96:99]
    v_add_f32 v33, v33, v37
    v_add_f32 v34, v34, v38
    v_mfma_f32_16x16x32_bf16 v[96:99], v[108:111], a[104:107], v[96:99]
    v_add_f32 v35, v35, v39
    s_waitcnt lgkmcnt(0)
    v_mfma_f32_16x16x32_bf16 v[96:99], v[112:115], a[112:115], v[96:99]
    ds_read_b128 v[120:123], v14 offset:19456
    v_mul_f32 v36, s38, v32
    v_mfma_f32_16x16x32_bf16 v[96:99], v[116:119], a[120:123], v[96:99]
    ds_read_b128 v[124:127], v14 offset:23552
    v_mul_f32 v37, s38, v33
    v_mfma_f32_16x16x32_bf16 v[100:103], v[116:119], a[124:127], v[100:103]
    ds_read_b128 v[128:131], v14 offset:27648
    v_mul_f32 v38, s38, v34
    v_mfma_f32_16x16x32_bf16 v[100:103], v[112:115], a[116:119], v[100:103]
    ds_read_b128 v[132:135], v14 offset:31744
    v_mul_f32 v39, s38, v35
    v_mfma_f32_16x16x32_bf16 v[100:103], v[108:111], a[108:111], v[100:103]
    v_exp_f32 v36, v36
    v_mfma_f32_16x16x32_bf16 v[100:103], v[104:107], a[100:103], v[100:103]
    s_waitcnt lgkmcnt(2)
    v_mfma_f32_16x16x32_bf16 v[92:95], v[120:123], a[132:135], v[92:95]
    v_exp_f32 v37, v37
    v_mfma_f32_16x16x32_bf16 v[92:95], v[124:127], a[140:143], v[92:95]
    s_waitcnt lgkmcnt(0)
    v_mfma_f32_16x16x32_bf16 v[92:95], v[128:131], a[148:151], v[92:95]
    s_waitcnt vmcnt(11)
    s_barrier
    v_mfma_f32_16x16x32_bf16 v[92:95], v[132:135], a[156:159], v[92:95]
    ds_read_b128 v[104:107], v14 offset:32768
    v_mfma_f32_16x16x32_bf16 v[88:91], v[132:135], a[152:155], v[88:91]
    ds_read_b128 v[108:111], v14 offset:36864
    v_exp_f32 v38, v38
    v_mfma_f32_16x16x32_bf16 v[88:91], v[128:131], a[144:147], v[88:91]
    ds_read_b128 v[112:115], v14 offset:40960
    v_exp_f32 v39, v39
    v_mfma_f32_16x16x32_bf16 v[88:91], v[124:127], a[136:139], v[88:91]
    ds_read_b128 v[116:119], v14 offset:45056
    v_mul_f32 v180, v180, v32
    v_mfma_f32_16x16x32_bf16 v[88:91], v[120:123], a[128:131], v[88:91]
    v_mul_f32 v181, v181, v33
    s_waitcnt lgkmcnt(2)
    v_mfma_f32_16x16x32_bf16 v[96:99], v[104:107], a[128:131], v[96:99]
    v_mul_f32 v182, v182, v34
    v_mul_f32 v183, v183, v35
    v_mfma_f32_16x16x32_bf16 v[96:99], v[108:111], a[136:139], v[96:99]
    v_add_f32 v36, 1.0, v36
    s_waitcnt lgkmcnt(0)
    v_mfma_f32_16x16x32_bf16 v[96:99], v[112:115], a[144:147], v[96:99]
    ds_read_b128 v[120:123], v14 offset:33792
    v_add_f32 v37, 1.0, v37
    v_mfma_f32_16x16x32_bf16 v[96:99], v[116:119], a[152:155], v[96:99]
    ds_read_b128 v[124:127], v14 offset:37888
    v_add_f32 v38, 1.0, v38
    v_mfma_f32_16x16x32_bf16 v[100:103], v[116:119], a[156:159], v[100:103]
    ds_read_b128 v[128:131], v14 offset:41984
    v_add_f32 v39, 1.0, v39
    v_mfma_f32_16x16x32_bf16 v[100:103], v[112:115], a[148:151], v[100:103]
    ds_read_b128 v[132:135], v14 offset:46080
    v_rcp_f32 v36, v36
    v_mfma_f32_16x16x32_bf16 v[100:103], v[108:111], a[140:143], v[100:103]
    v_rcp_f32 v37, v37
    v_mfma_f32_16x16x32_bf16 v[100:103], v[104:107], a[132:135], v[100:103]
    v_rcp_f32 v38, v38
    s_waitcnt lgkmcnt(2)
    v_mfma_f32_16x16x32_bf16 v[92:95], v[120:123], a[164:167], v[92:95]
    s_waitcnt vmcnt(8)
    v_bitop3_b32 v59, v59, v63, s68 bitop3:0x7e
    v_rcp_f32 v39, v39
    v_mfma_f32_16x16x32_bf16 v[92:95], v[124:127], a[172:175], v[92:95]
    buffer_load_dwordx4 v[72:75], v136, s[44:47], s12 offen offset:0 sc1
    s_waitcnt lgkmcnt(0)
    v_mfma_f32_16x16x32_bf16 v[92:95], v[128:131], a[180:183], v[92:95]
    ds_read_b128 v[104:107], v14 offset:34816
    v_bitop3_b32 v59, v59, v67, s68 bitop3:0xf6
    v_mfma_f32_16x16x32_bf16 v[92:95], v[132:135], a[188:191], v[92:95]
    ds_read_b128 v[108:111], v14 offset:38912
    v_cmp_ne_u32 vcc, 0, v59
    v_mfma_f32_16x16x32_bf16 v[88:91], v[132:135], a[184:187], v[88:91]
    ds_read_b128 v[112:115], v14 offset:43008
    buffer_load_dwordx4 v[76:79], v136, s[44:47], s12 offen offset:1024 sc1
    v_mfma_f32_16x16x32_bf16 v[88:91], v[128:131], a[176:179], v[88:91]
    ds_read_b128 v[116:119], v14 offset:47104
    s_cbranch_vccnz L_xs_b
L_xo_b:
    v_fma_f32 v180, v180, v36, v160
    v_mfma_f32_16x16x32_bf16 v[88:91], v[124:127], a[168:171], v[88:91]
    buffer_load_dwordx4 v[80:83], v136, s[44:47], s12 offen offset:2048 sc1
    v_and_b32 v41, 0xffff0000, v56
    v_mfma_f32_16x16x32_bf16 v[88:91], v[120:123], a[160:163], v[88:91]
    v_lshlrev_b32 v40, 16, v56
    s_waitcnt lgkmcnt(2)
    v_mfma_f32_16x16x32_bf16 v[96:99], v[104:107], a[160:163], v[96:99]
    v_and_b32 v43, 0xffff0000, v57
    v_fma_f32 v181, v181, v37, v161
    v_mfma_f32_16x16x32_bf16 v[96:99], v[108:111], a[168:171], v[96:99]
    v_lshlrev_b32 v42, 16, v57
    s_waitcnt lgkmcnt(0)
    v_mfma_f32_16x16x32_bf16 v[96:99], v[112:115], a[176:179], v[96:99]
    ds_read_b128 v[120:123], v14 offset:35840
    v_and_b32 v45, 0xffff0000, v58
    v_mfma_f32_16x16x32_bf16 v[96:99], v[116:119], a[184:187], v[96:99]
    ds_read_b128 v[124:127], v14 offset:39936
    v_fma_f32 v182, v182, v38, v162
    v_mfma_f32_16x16x32_bf16 v[100:103], v[116:119], a[188:191], v[100:103]
    ds_read_b128 v[128:131], v14 offset:44032
    v_lshlrev_b32 v44, 16, v58
    v_mfma_f32_16x16x32_bf16 v[100:103], v[112:115], a[180:183], v[100:103]
    ds_read_b128 v[132:135], v14 offset:48128
    v_and_b32 v47, 0xffff0000, v60
    v_mfma_f32_16x16x32_bf16 v[100:103], v[108:111], a[172:175], v[100:103]
    v_lshlrev_b32 v46, 16, v60
    v_fma_f32 v183, v183, v39, v163
    v_mfma_f32_16x16x32_bf16 v[100:103], v[104:107], a[164:167], v[100:103]
    v_and_b32 v49, 0xffff0000, v61
    s_waitcnt lgkmcnt(2)
    v_mfma_f32_16x16x32_bf16 v[92:95], v[120:123], a[196:199], v[92:95]
    v_lshlrev_b32 v48, 16, v61
    v_cvt_pk_bf16_f32 v142, v180, v181
    v_mfma_f32_16x16x32_bf16 v[92:95], v[124:127], a[204:207], v[92:95]
    v_and_b32 v51, 0xffff0000, v62
    s_waitcnt lgkmcnt(0)
    v_mfma_f32_16x16x32_bf16 v[92:95], v[128:131], a[212:215], v[92:95]
    s_waitcnt vmcnt(4)
    s_barrier
    v_lshlrev_b32 v50, 16, v62
    v_mfma_f32_16x16x32_bf16 v[92:95], v[132:135], a[220:223], v[92:95]
    ds_read_b128 v[104:107], v14 offset:49152
    v_cvt_pk_bf16_f32 v143, v182, v183
    v_mfma_f32_16x16x32_bf16 v[88:91], v[132:135], a[216:219], v[88:91]
    ds_read_b128 v[108:111], v14 offset:53248
    v_and_b32 v53, 0xffff0000, v64
    v_mfma_f32_16x16x32_bf16 v[88:91], v[128:131], a[208:211], v[88:91]
    ds_read_b128 v[112:115], v14 offset:57344
    v_lshlrev_b32 v52, 16, v64
    v_mfma_f32_16x16x32_bf16 v[88:91], v[124:127], a[200:203], v[88:91]
    ds_read_b128 v[116:119], v14 offset:61440
    v_and_b32 v55, 0xffff0000, v65
    v_mfma_f32_16x16x32_bf16 v[88:91], v[120:123], a[192:195], v[88:91]
    v_lshlrev_b32 v54, 16, v65
    s_waitcnt lgkmcnt(2)
    v_mfma_f32_16x16x32_bf16 v[96:99], v[104:107], a[192:195], v[96:99]
    v_mfma_f32_16x16x32_bf16 v[96:99], v[108:111], a[200:203], v[96:99]
    s_waitcnt lgkmcnt(0)
    v_mfma_f32_16x16x32_bf16 v[96:99], v[112:115], a[208:211], v[96:99]
    ds_read_b128 v[120:123], v14 offset:50176
    v_add_f32 v92, v92, v44
    v_add_f32 v93, v93, v45
    v_mfma_f32_16x16x32_bf16 v[96:99], v[116:119], a[216:219], v[96:99]
    ds_read_b128 v[124:127], v14 offset:54272
    v_add_f32 v94, v94, v46
    v_mfma_f32_16x16x32_bf16 v[100:103], v[116:119], a[220:223], v[100:103]
    ds_read_b128 v[128:131], v14 offset:58368
    v_add_f32 v95, v95, v47
    v_add_f32 v88, v88, v40
    v_mfma_f32_16x16x32_bf16 v[100:103], v[112:115], a[212:215], v[100:103]
    ds_read_b128 v[132:135], v14 offset:62464
    v_add_f32 v89, v89, v41
    v_mfma_f32_16x16x32_bf16 v[100:103], v[108:111], a[204:207], v[100:103]
    v_add_f32 v90, v90, v42
    v_add_f32 v91, v91, v43
    v_mfma_f32_16x16x32_bf16 v[100:103], v[104:107], a[196:199], v[100:103]
    s_waitcnt lgkmcnt(2)
    v_mfma_f32_16x16x32_bf16 v[92:95], v[120:123], a[228:231], v[92:95]
    v_mfma_f32_16x16x32_bf16 v[92:95], v[124:127], a[236:239], v[92:95]
    s_waitcnt lgkmcnt(0)
    v_mfma_f32_16x16x32_bf16 v[92:95], v[128:131], a[244:247], v[92:95]
    ds_read_b128 v[104:107], v14 offset:51200
    v_add_f32 v96, v96, v48
    v_add_f32 v97, v97, v49
    v_mfma_f32_16x16x32_bf16 v[92:95], v[132:135], a[252:255], v[92:95]
    ds_read_b128 v[108:111], v14 offset:55296
    v_add_f32 v98, v98, v50
    v_mfma_f32_16x16x32_bf16 v[88:91], v[132:135], a[248:251], v[88:91]
    ds_read_b128 v[112:115], v14 offset:59392
    v_add_f32 v99, v99, v51
    v_add_f32 v100, v100, v52
    v_mfma_f32_16x16x32_bf16 v[88:91], v[128:131], a[240:243], v[88:91]
    ds_read_b128 v[116:119], v14 offset:63488
    v_add_f32 v101, v101, v53
    v_mfma_f32_16x16x32_bf16 v[88:91], v[124:127], a[232:235], v[88:91]
    v_add_f32 v102, v102, v54
    v_add_f32 v103, v103, v55
    v_mfma_f32_16x16x32_bf16 v[88:91], v[120:123], a[224:227], v[88:91]
    s_waitcnt lgkmcnt(2)
    v_mfma_f32_16x16x32_bf16 v[96:99], v[104:107], a[224:227], v[96:99]
    v_mfma_f32_16x16x32_bf16 v[96:99], v[108:111], a[232:235], v[96:99]
    s_waitcnt lgkmcnt(0)
    v_mfma_f32_16x16x32_bf16 v[96:99], v[112:115], a[240:243], v[96:99]
    ds_read_b128 v[120:123], v14 offset:52224
    v_mfma_f32_16x16x32_bf16 v[96:99], v[116:119], a[248:251], v[96:99]
    ds_read_b128 v[124:127], v14 offset:56320
    v_mfma_f32_16x16x32_bf16 v[100:103], v[116:119], a[252:255], v[100:103]
    buffer_store_dwordx2 v[142:143], v253, s[64:67], 0 offen sc1
    ds_read_b128 v[128:131], v14 offset:60416
    v_mfma_f32_16x16x32_bf16 v[100:103], v[112:115], a[244:247], v[100:103]
    ds_read_b128 v[132:135], v14 offset:64512
    v_mfma_f32_16x16x32_bf16 v[100:103], v[108:111], a[236:239], v[100:103]
    v_mfma_f32_16x16x32_bf16 v[100:103], v[104:107], a[228:231], v[100:103]
    s_waitcnt lgkmcnt(2)
    v_mfma_f32_16x16x32_bf16 v[92:95], v[120:123], v[224:227], v[92:95]
    v_mfma_f32_16x16x32_bf16 v[92:95], v[124:127], v[232:235], v[92:95]
    s_waitcnt lgkmcnt(0)
    v_mfma_f32_16x16x32_bf16 v[92:95], v[128:131], v[240:243], v[92:95]
    s_waitcnt vmcnt(4)
    s_barrier
    v_mfma_f32_16x16x32_bf16 v[92:95], v[132:135], v[248:251], v[92:95]
    ds_read_b128 v[104:107], v14 offset:0
    v_mfma_f32_16x16x32_bf16 v[88:91], v[132:135], v[244:247], v[88:91]
    ds_read_b128 v[108:111], v14 offset:4096
    v_mfma_f32_16x16x32_bf16 v[88:91], v[128:131], v[236:239], v[88:91]
    ds_read_b128 v[112:115], v14 offset:8192
    v_mfma_f32_16x16x32_bf16 v[88:91], v[124:127], v[228:231], v[88:91]
    ds_read_b128 v[116:119], v14 offset:12288
    v_mfma_f32_16x16x32_bf16 v[88:91], v[120:123], v[220:223], v[88:91]
    s_waitcnt lgkmcnt(2)
    v_mfma_f32_16x16x32_bf16 v[96:99], v[104:107], v[220:223], v[96:99]
    v_mfma_f32_16x16x32_bf16 v[96:99], v[108:111], v[228:231], v[96:99]
    s_waitcnt lgkmcnt(0)
    v_mfma_f32_16x16x32_bf16 v[96:99], v[112:115], v[236:239], v[96:99]
    v_mfma_f32_16x16x32_bf16 v[96:99], v[116:119], v[244:247], v[96:99]
    v_mfma_f32_16x16x32_bf16 v[100:103], v[116:119], v[248:251], v[100:103]
    v_mfma_f32_16x16x32_bf16 v[100:103], v[112:115], v[240:243], v[100:103]
    v_mfma_f32_16x16x32_bf16 v[100:103], v[108:111], v[232:235], v[100:103]
    v_mfma_f32_16x16x32_bf16 v[100:103], v[104:107], v[224:227], v[100:103]
    s_waitcnt vmcnt(1)
    v_bitop3_b32 v75, v75, v79, s68 bitop3:0x7e
    v_bitop3_b32 v75, v75, v83, s68 bitop3:0xf6
    v_cmp_ne_u32 vcc, 0, v75
    s_cbranch_vccnz L_xs_z
L_xo_z:
    v_and_b32 v41, 0xffff0000, v72
    v_lshlrev_b32 v40, 16, v72
    v_and_b32 v43, 0xffff0000, v73
    v_lshlrev_b32 v42, 16, v73
    v_and_b32 v45, 0xffff0000, v74
    v_lshlrev_b32 v44, 16, v74
    v_and_b32 v47, 0xffff0000, v76
    v_lshlrev_b32 v46, 16, v76
    v_and_b32 v49, 0xffff0000, v77
    v_lshlrev_b32 v48, 16, v77
    v_and_b32 v51, 0xffff0000, v78
    v_lshlrev_b32 v50, 16, v78
    v_and_b32 v53, 0xffff0000, v80
    v_lshlrev_b32 v52, 16, v80
    v_and_b32 v55, 0xffff0000, v81
    v_lshlrev_b32 v54, 16, v81
    v_pk_add_f32 v[88:89], v[88:89], v[40:41]
    v_pk_add_f32 v[90:91], v[90:91], v[42:43]
    v_pk_add_f32 v[96:97], v[96:97], v[48:49]
    v_pk_add_f32 v[98:99], v[98:99], v[50:51]
    v_pk_mul_f32 v[56:57], v[88:89], s[38:39] op_sel_hi:[1,0]
    v_pk_mul_f32 v[58:59], v[90:91], s[38:39] op_sel_hi:[1,0]
    v_pk_mul_f32 v[64:65], v[96:97], s[38:39] op_sel_hi:[1,0]
    v_pk_mul_f32 v[66:67], v[98:99], s[38:39] op_sel_hi:[1,0]
    v_exp_f32 v56, v56
    v_exp_f32 v57, v57
    v_exp_f32 v58, v58
    v_exp_f32 v59, v59
    v_exp_f32 v64, v64
    v_exp_f32 v65, v65
    v_exp_f32 v66, v66
    v_exp_f32 v67, v67
    v_pk_mul_f32 v[164:165], v[164:165], v[88:89]
    v_pk_mul_f32 v[166:167], v[166:167], v[90:91]
    v_pk_mul_f32 v[172:173], v[172:173], v[96:97]
    v_pk_mul_f32 v[174:175], v[174:175], v[98:99]
    v_pk_add_f32 v[56:57], v[56:57], 1.0 op_sel_hi:[1,0]
    v_pk_add_f32 v[58:59], v[58:59], 1.0 op_sel_hi:[1,0]
    v_pk_add_f32 v[64:65], v[64:65], 1.0 op_sel_hi:[1,0]
    v_pk_add_f32 v[66:67], v[66:67], 1.0 op_sel_hi:[1,0]
    v_rcp_f32 v56, v56
    v_rcp_f32 v57, v57
    v_rcp_f32 v58, v58
    v_rcp_f32 v59, v59
    v_rcp_f32 v64, v64
    v_rcp_f32 v65, v65
    v_rcp_f32 v66, v66
    v_rcp_f32 v67, v67
    v_pk_fma_f32 v[164:165], v[164:165], v[56:57], v[144:145]
    v_pk_fma_f32 v[166:167], v[166:167], v[58:59], v[146:147]
    v_pk_fma_f32 v[172:173], v[172:173], v[64:65], v[152:153]
    v_pk_fma_f32 v[174:175], v[174:175], v[66:67], v[154:155]
    v_cvt_pk_bf16_f32 v88, v164, v165
    v_cvt_pk_bf16_f32 v90, v172, v173
    v_cvt_pk_bf16_f32 v89, v166, v167
    v_cvt_pk_bf16_f32 v91, v174, v175
    v_permlane16_swap_b32 v88, v90
    s_nop 0
    v_permlane16_swap_b32 v89, v91
    buffer_store_dwordx4 v[88:91], v252, s[64:67], 0 offen sc1
    v_pk_add_f32 v[92:93], v[92:93], v[44:45]
    v_pk_add_f32 v[94:95], v[94:95], v[46:47]
    v_pk_add_f32 v[100:101], v[100:101], v[52:53]
    v_pk_add_f32 v[102:103], v[102:103], v[54:55]
    v_pk_mul_f32 v[60:61], v[92:93], s[38:39] op_sel_hi:[1,0]
    v_pk_mul_f32 v[62:63], v[94:95], s[38:39] op_sel_hi:[1,0]
    v_pk_mul_f32 v[68:69], v[100:101], s[38:39] op_sel_hi:[1,0]
    v_pk_mul_f32 v[70:71], v[102:103], s[38:39] op_sel_hi:[1,0]
    v_exp_f32 v60, v60
    v_exp_f32 v61, v61
    v_exp_f32 v62, v62
    v_exp_f32 v63, v63
    v_exp_f32 v68, v68
    v_exp_f32 v69, v69
    v_exp_f32 v70, v70
    v_exp_f32 v71, v71
    v_pk_mul_f32 v[168:169], v[168:169], v[92:93]
    v_pk_mul_f32 v[170:171], v[170:171], v[94:95]
    v_pk_mul_f32 v[176:177], v[176:177], v[100:101]
    v_pk_mul_f32 v[178:179], v[178:179], v[102:103]
    v_pk_add_f32 v[60:61], v[60:61], 1.0 op_sel_hi:[1,0]
    v_pk_add_f32 v[62:63], v[62:63], 1.0 op_sel_hi:[1,0]
    v_pk_add_f32 v[68:69], v[68:69], 1.0 op_sel_hi:[1,0]
    v_pk_add_f32 v[70:71], v[70:71], 1.0 op_sel_hi:[1,0]
    v_rcp_f32 v60, v60
    v_rcp_f32 v61, v61
    v_rcp_f32 v62, v62
    v_rcp_f32 v63, v63
    v_rcp_f32 v68, v68
    v_rcp_f32 v69, v69
    v_rcp_f32 v70, v70
    v_rcp_f32 v71, v71
    v_pk_fma_f32 v[168:169], v[168:169], v[60:61], v[148:149]
    v_pk_fma_f32 v[170:171], v[170:171], v[62:63], v[150:151]
    v_pk_fma_f32 v[176:177], v[176:177], v[68:69], v[156:157]
    v_pk_fma_f32 v[178:179], v[178:179], v[70:71], v[158:159]
    v_cvt_pk_bf16_f32 v92, v168, v169
    v_cvt_pk_bf16_f32 v94, v176, v177
    v_cvt_pk_bf16_f32 v93, v170, v171
    v_cvt_pk_bf16_f32 v95, v178, v179
    v_permlane16_swap_b32 v92, v94
    s_nop 0
    v_permlane16_swap_b32 v93, v95
    buffer_store_dwordx4 v[92:95], v252, s[64:67], s40 offen sc1
    s_endpgm
L_segE:
.p2align 12
L_aux:
    s_bfe_u32 s101, s2, 0x20003
    s_mul_i32 s101, s101, 3
    s_mul_i32 s84, s101, 305844
    s_lshr_b32 s84, s84, 18
    s_add_u32 s84, s84, 0
    s_add_u32 s85, s84, 1
    s_cmp_eq_u32 s85, 14
    s_cselect_b32 s85, 0, s85
    s_add_u32 s86, s85, 1
    s_cmp_eq_u32 s86, 14
    s_cselect_b32 s86, 0, s86
    s_add_u32 s87, s86, 1
    s_cmp_eq_u32 s87, 14
    s_cselect_b32 s87, 0, s87
    s_add_u32 s88, s87, 1
    s_cmp_eq_u32 s88, 14
    s_cselect_b32 s88, 0, s88
    s_add_u32 s89, s88, 1
    s_cmp_eq_u32 s89, 14
    s_cselect_b32 s89, 0, s89
    s_add_u32 s90, s89, 1
    s_cmp_eq_u32 s90, 14
    s_cselect_b32 s90, 0, s90
    s_add_u32 s91, s90, 1
    s_cmp_eq_u32 s91, 14
    s_cselect_b32 s91, 0, s91
    s_add_u32 s92, s91, 1
    s_cmp_eq_u32 s92, 14
    s_cselect_b32 s92, 0, s92
    s_add_u32 s93, s92, 1
    s_cmp_eq_u32 s93, 14
    s_cselect_b32 s93, 0, s93
    s_add_u32 s94, s93, 1
    s_cmp_eq_u32 s94, 14
    s_cselect_b32 s94, 0, s94
    s_add_u32 s95, s94, 1
    s_cmp_eq_u32 s95, 14
    s_cselect_b32 s95, 0, s95
    s_add_u32 s96, s95, 1
    s_cmp_eq_u32 s96, 14
    s_cselect_b32 s96, 0, s96
    s_add_u32 s97, s96, 1
    s_cmp_eq_u32 s97, 14
    s_cselect_b32 s97, 0, s97
    s_mul_i32 s98, s101, 87384
    s_lshr_b32 s98, s98, 18
    s_add_u32 s98, s98, 14
    s_add_u32 s99, s98, 1
    s_cmp_eq_u32 s99, 18
    s_cselect_b32 s99, 14, s99
    s_add_u32 s100, s99, 1
    s_cmp_eq_u32 s100, 18
    s_cselect_b32 s100, 14, s100
    s_add_u32 s101, s100, 1
    s_cmp_eq_u32 s101, 18
    s_cselect_b32 s101, 14, s101
    s_lshl2_add_u32 s7, s5, s6
    s_add_u32 s7, s7, 188
    s_add_u32 s8, s5, 248
    s_cmp_eq_u32 s6, 27
    s_cselect_b32 s75, s8, s7
    s_mov_b32 s48, s24
    s_and_b32 s49, s25, 0xffff
    s_mov_b32 s50, 2359296
    s_mov_b32 s51, 0x20000
    v_lshlrev_b32 v240, 4, v2
    s_mul_i32 s74, s3, 16640
    s_add_u32 s74, s74, 73728
    s_sub_u32 s69, s75, 216
    s_lshl_b32 s70, s69, 4
    s_add_u32 s70, s70, s3
    s_lshl_b32 s12, s70, 12
    s_lshl_b32 s70, s70, 1
    s_mov_b32 s9, 144896
    s_mov_b32 s11, 8192
    v_mul_u32_u24 v48, 1216, v3
    v_mad_u32_u24 v48, v4, 12, v48
    v_add_u32 v48, s9, v48
    v_mov_b32 v47, 0x40000000
    v_lshlrev_b32 v3, 3, v3
    s_lshl_b32 s5, s68, 6
    s_add_u32 s5, s5, 12386304
    v_cmp_eq_u32 vcc, 0, v4
    s_nop 1
    v_cndmask_b32 v49, v47, v3, vcc
    v_lshrrev_b32 v5, 4, v0
    v_and_b32 v4, 3, v2
    v_lshlrev_b32 v4, 3, v4
    v_lshl_add_u32 v5, v5, 5, v4
    v_bfe_u32 v6, v2, 2, 2
    v_mul_u32_u24 v4, 1216, v6
    v_mul_u32_u24 v6, 1152, v6
    v_add3_u32 v50, v4, v5, s9
    v_add3_u32 v51, v6, v5, s11
    s_mul_i32 s4, s3, 2176
    v_add_u32 v55, s4, v51
    v_lshlrev_b32 v52, 4, v0
    s_add_u32 s7, s15, 4096
    s_add_u32 s8, s15, 8192
    s_cmp_eq_u32 s3, 0
    s_cselect_b32 s8, s8, 0x40000000
    v_add_u32 v53, 2359296, v52
    v_mov_b32 v54, 0
    v_add_u32 v4, 0, v52
    v_lshrrev_b32 v5, 7, v4
    v_mul_u32_u24 v6, 9363, v5
    v_lshrrev_b32 v6, 16, v6
    v_mad_i32_i24 v5, v6, -7, v5
    v_cmp_lt_u32 vcc, 2, v5
    s_nop 1
    v_addc_co_u32 v6, vcc, 0, v6, vcc
    v_lshl_add_u32 v93, v6, 7, v4
    v_add_u32 v4, 4096, v52
    v_lshrrev_b32 v5, 7, v4
    v_mul_u32_u24 v6, 9363, v5
    v_lshrrev_b32 v6, 16, v6
    v_mad_i32_i24 v5, v6, -7, v5
    v_cmp_lt_u32 vcc, 2, v5
    s_nop 1
    v_addc_co_u32 v6, vcc, 0, v6, vcc
    v_lshl_add_u32 v94, v6, 7, v4
    v_add_u32 v4, 8192, v52
    v_lshrrev_b32 v5, 7, v4
    v_mul_u32_u24 v6, 9363, v5
    v_lshrrev_b32 v6, 16, v6
    v_mad_i32_i24 v5, v6, -7, v5
    v_cmp_lt_u32 vcc, 2, v5
    s_nop 1
    v_addc_co_u32 v6, vcc, 0, v6, vcc
    v_lshl_add_u32 v95, v6, 7, v4
    s_mul_i32 s10, s68, 11264
    s_add_u32 s10, s10, 36585472
    s_cmp_eq_u32 s3, 0
    s_cselect_b32 s83, s10, 0x40000000
    s_add_u32 s7, s10, 2883584
    s_add_u32 s8, s83, 2883584
    s_mul_i32 s4, s3, 1028
    s_sub_u32 s4, 8204, s4
    v_add_u32 v90, s4, v53
    s_bfe_u32 s6, s68, 0x20001
    s_lshl_b32 s6, s6, 6
    s_lshr_b32 s9, s68, 3
    s_lshl1_add_u32 s6, s9, s6
    s_and_b32 s9, s68, 1
    s_add_u32 s6, s6, s9
    s_lshl_b32 s4, s6, 2
    s_add_u32 s4, s4, 12533760
    v_lshl_add_u32 v1, v0, 10, s4
    s_lshl_b32 s4, s68, 2
    s_add_u32 s4, s4, 12599296
    v_lshl_add_u32 v46, v0, 10, s4
    v_cmp_gt_u32 vcc, 8, v0
    s_nop 1
    v_cndmask_b32 v1, v47, v1, vcc
    v_cmp_gt_u32 vcc, 4, v0
    s_nop 1
    v_cndmask_b32 v46, v47, v46, vcc
    s_waitcnt vmcnt(9)
    v_and_b32 v21, 0xffff0000, v8
    v_lshlrev_b32 v20, 16, v8
    v_and_b32 v23, 0xffff0000, v9
    v_lshlrev_b32 v22, 16, v9
    v_and_b32 v25, 0xffff0000, v10
    v_lshlrev_b32 v24, 16, v10
    v_and_b32 v27, 0xffff0000, v12
    v_lshlrev_b32 v26, 16, v12
    v_and_b32 v29, 0xffff0000, v13
    v_lshlrev_b32 v28, 16, v13
    v_and_b32 v31, 0xffff0000, v14
    v_lshlrev_b32 v30, 16, v14
    v_and_b32 v33, 0xffff0000, v16
    v_lshlrev_b32 v32, 16, v16
    v_and_b32 v35, 0xffff0000, v17
    v_lshlrev_b32 v34, 16, v17
    v_and_b32 v37, 0xffff0000, v18
    v_lshlrev_b32 v36, 16, v18
    v_pk_add_f32 v[38:39], v[20:21], v[22:23]
    v_pk_add_f32 v[40:41], v[24:25], v[26:27]
    v_pk_add_f32 v[42:43], v[28:29], v[30:31]
    v_pk_add_f32 v[44:45], v[32:33], v[34:35]
    v_pk_add_f32 v[38:39], v[38:39], v[40:41]
    v_pk_add_f32 v[42:43], v[42:43], v[44:45]
    v_pk_add_f32 v[38:39], v[38:39], v[36:37]
    v_pk_add_f32 v[38:39], v[38:39], v[42:43]
    v_add_f32 v56, v38, v39
    s_nop 1
    v_add_f32_dpp v56, v56, v56 row_ror:8 row_mask:0xf bank_mask:0xf
    s_nop 1
    v_add_f32_dpp v56, v56, v56 row_ror:4 row_mask:0xf bank_mask:0xf
    s_nop 1
    v_add_f32_dpp v56, v56, v56 row_ror:2 row_mask:0xf bank_mask:0xf
    s_nop 1
    v_add_f32_dpp v56, v56, v56 row_ror:1 row_mask:0xf bank_mask:0xf
    v_mov_b32 v57, v56
    s_nop 1
    v_permlane16_swap_b32 v56, v57
    v_add_f32 v56, v56, v57
    v_mul_f32 v56, 0x3ae38e39, v56
    v_pk_add_f32 v[20:21], v[20:21], v[56:57] op_sel_hi:[1,0] neg_lo:[0,1] neg_hi:[0,1]
    v_pk_add_f32 v[22:23], v[22:23], v[56:57] op_sel_hi:[1,0] neg_lo:[0,1] neg_hi:[0,1]
    v_pk_add_f32 v[24:25], v[24:25], v[56:57] op_sel_hi:[1,0] neg_lo:[0,1] neg_hi:[0,1]
    v_pk_add_f32 v[26:27], v[26:27], v[56:57] op_sel_hi:[1,0] neg_lo:[0,1] neg_hi:[0,1]
    v_pk_add_f32 v[28:29], v[28:29], v[56:57] op_sel_hi:[1,0] neg_lo:[0,1] neg_hi:[0,1]
    v_pk_add_f32 v[30:31], v[30:31], v[56:57] op_sel_hi:[1,0] neg_lo:[0,1] neg_hi:[0,1]
    v_pk_add_f32 v[32:33], v[32:33], v[56:57] op_sel_hi:[1,0] neg_lo:[0,1] neg_hi:[0,1]
    v_pk_add_f32 v[34:35], v[34:35], v[56:57] op_sel_hi:[1,0] neg_lo:[0,1] neg_hi:[0,1]
    v_pk_add_f32 v[36:37], v[36:37], v[56:57] op_sel_hi:[1,0] neg_lo:[0,1] neg_hi:[0,1]
    v_pk_mul_f32 v[38:39], v[20:21], v[20:21]
    v_pk_mul_f32 v[40:41], v[22:23], v[22:23]
    v_pk_fma_f32 v[38:39], v[24:25], v[24:25], v[38:39]
    v_pk_fma_f32 v[40:41], v[26:27], v[26:27], v[40:41]
    v_pk_fma_f32 v[38:39], v[28:29], v[28:29], v[38:39]
    v_pk_fma_f32 v[40:41], v[30:31], v[30:31], v[40:41]
    v_pk_fma_f32 v[38:39], v[32:33], v[32:33], v[38:39]
    v_pk_fma_f32 v[40:41], v[34:35], v[34:35], v[40:41]
    v_pk_fma_f32 v[38:39], v[36:37], v[36:37], v[38:39]
    v_pk_add_f32 v[38:39], v[38:39], v[40:41]
    v_add_f32 v18, v38, v39
    s_nop 1
    v_add_f32_dpp v18, v18, v18 row_ror:8 row_mask:0xf bank_mask:0xf
    s_nop 1
    v_add_f32_dpp v18, v18, v18 row_ror:4 row_mask:0xf bank_mask:0xf
    s_nop 1
    v_add_f32_dpp v18, v18, v18 row_ror:2 row_mask:0xf bank_mask:0xf
    s_nop 1
    v_add_f32_dpp v18, v18, v18 row_ror:1 row_mask:0xf bank_mask:0xf
    v_mov_b32 v19, v18
    s_nop 1
    v_permlane16_swap_b32 v18, v19
    v_add_f32 v18, v18, v19
    v_mul_f32 v18, 0x3ae38e39, v18
    v_cvt_pk_bf16_f32 v38, v56, v18
    v_lshlrev_b32 v106, 16, v38
    v_and_b32 v38, 0xffff0000, v38
    v_add_f32 v38, 0x3727c5ac, v38
    v_sub_f32 v56, v56, v106
    v_cvt_pk_bf16_f32 v38, v38, v38
    v_lshlrev_b32 v38, 16, v38
    v_sqrt_f32 v38, v38
    s_nop 0
    v_cvt_pk_bf16_f32 v38, v38, v38
    v_lshlrev_b32 v38, 16, v38
    v_rcp_f32 v107, v38
    s_nop 0
    v_mul_f32 v56, v56, v107
    v_mul_f32 v18, v18, v107
    v_mul_f32 v18, v18, v107
    v_cvt_pk_bf16_f32 v38, v56, v18
    v_lshlrev_b32 v39, 16, v38
    v_and_b32 v38, 0xffff0000, v38
    v_add_f32 v38, 0x3727c5ac, v38
    v_sub_f32 v56, v56, v39
    v_cvt_pk_bf16_f32 v38, v38, v38
    v_lshlrev_b32 v38, 16, v38
    v_sqrt_f32 v38, v38
    s_nop 0
    v_cvt_pk_bf16_f32 v38, v38, v38
    v_lshlrev_b32 v38, 16, v38
    v_rcp_f32 v38, v38
    s_nop 0
    v_mul_f32 v18, v107, v38
    v_mul_f32 v56, v56, v38
    v_pk_fma_f32 v[20:21], v[20:21], v[18:19], v[56:57] op_sel_hi:[1,0,0]
    v_pk_fma_f32 v[22:23], v[22:23], v[18:19], v[56:57] op_sel_hi:[1,0,0]
    v_pk_fma_f32 v[24:25], v[24:25], v[18:19], v[56:57] op_sel_hi:[1,0,0]
    v_pk_fma_f32 v[26:27], v[26:27], v[18:19], v[56:57] op_sel_hi:[1,0,0]
    v_pk_fma_f32 v[28:29], v[28:29], v[18:19], v[56:57] op_sel_hi:[1,0,0]
    v_pk_fma_f32 v[30:31], v[30:31], v[18:19], v[56:57] op_sel_hi:[1,0,0]
    v_pk_fma_f32 v[32:33], v[32:33], v[18:19], v[56:57] op_sel_hi:[1,0,0]
    v_pk_fma_f32 v[34:35], v[34:35], v[18:19], v[56:57] op_sel_hi:[1,0,0]
    v_pk_fma_f32 v[36:37], v[36:37], v[18:19], v[56:57] op_sel_hi:[1,0,0]
    v_cvt_pk_bf16_f32 v8, v20, v21
    v_cvt_pk_bf16_f32 v9, v22, v23
    v_cvt_pk_bf16_f32 v10, v24, v25
    v_cvt_pk_bf16_f32 v11, v26, v27
    v_cvt_pk_bf16_f32 v12, v28, v29
    v_cvt_pk_bf16_f32 v13, v30, v31
    v_cvt_pk_bf16_f32 v14, v32, v33
    v_cvt_pk_bf16_f32 v15, v34, v35
    v_cvt_pk_bf16_f32 v16, v36, v37
    ds_write_b32 v48, v8 offset:0
    ds_write_b32 v48, v9 offset:4
    ds_write_b32 v48, v10 offset:8
    ds_write_b32 v48, v11 offset:384
    ds_write_b32 v48, v12 offset:388
    ds_write_b32 v48, v13 offset:392
    ds_write_b32 v48, v14 offset:768
    ds_write_b32 v48, v15 offset:772
    ds_write_b32 v48, v16 offset:776
    buffer_store_dwordx2 v[106:107], v49, s[44:47], s5 offen sc1
    s_waitcnt lgkmcnt(0)
    s_barrier
    ds_read_b64_tr_b16 v[20:21], v50 offset:0
    ds_read_b64_tr_b16 v[22:23], v50 offset:4864
    ds_read_b64_tr_b16 v[24:25], v50 offset:512
    ds_read_b64_tr_b16 v[26:27], v50 offset:5376
    ds_read_b64_tr_b16 v[28:29], v50 offset:1024
    ds_read_b64_tr_b16 v[30:31], v50 offset:5888
    s_waitcnt lgkmcnt(4)
    buffer_store_dwordx4 v[20:23], v93, s[44:47], s10 offen sc1
    s_waitcnt lgkmcnt(2)
    buffer_store_dwordx4 v[24:27], v94, s[44:47], s10 offen sc1
    s_waitcnt lgkmcnt(0)
    buffer_store_dwordx4 v[28:31], v95, s[44:47], s83 offen sc1
    buffer_load_dword v45, v54, s[64:67], 0 offen sc1
    s_waitcnt vmcnt(5)
    s_barrier
    ds_read_b64_tr_b16 v[60:61], v51 offset:0
    ds_read_b64_tr_b16 v[62:63], v51 offset:4608
    ds_read_b64_tr_b16 v[64:65], v51 offset:9216
    ds_read_b64_tr_b16 v[66:67], v51 offset:12672
    ds_read_b64_tr_b16 v[68:69], v51 offset:17280
    ds_read_b64_tr_b16 v[70:71], v51 offset:512
    ds_read_b64_tr_b16 v[72:73], v51 offset:5120
    ds_read_b64_tr_b16 v[74:75], v51 offset:9728
    ds_read_b64_tr_b16 v[76:77], v51 offset:13184
    ds_read_b64_tr_b16 v[78:79], v51 offset:17792
    v_alignbit_b32 v114, v99, v99, 16
    v_alignbit_b32 v115, v98, v98, 16
    s_waitcnt lgkmcnt(5)
    v_alignbit_b32 v108, v61, v60, 16
    v_alignbit_b32 v109, v62, v61, 16
    v_alignbit_b32 v110, v63, v62, 16
    v_alignbit_b32 v111, v64, v63, 16
    v_alignbit_b32 v112, v65, v64, 16
    v_dot2_f32_bf16 v116, v60, v114, 0
    ds_read_b64_tr_b16 v[80:81], v51 offset:1024
    v_dot2_f32_bf16 v117, v108, v114, 0
    v_dot2_f32_bf16 v118, v61, v114, 0
    v_dot2_f32_bf16 v119, v109, v114, 0
    v_dot2_f32_bf16 v120, v62, v114, 0
    ds_read_b64_tr_b16 v[82:83], v51 offset:5632
    v_dot2_f32_bf16 v121, v110, v114, 0
    v_dot2_f32_bf16 v122, v63, v114, 0
    v_dot2_f32_bf16 v123, v111, v114, 0
    v_dot2_f32_bf16 v116, v61, v115, v116
    v_dot2_f32_bf16 v117, v109, v115, v117
    ds_read_b64_tr_b16 v[84:85], v51 offset:10240
    v_dot2_f32_bf16 v118, v62, v115, v118
    v_dot2_f32_bf16 v119, v110, v115, v119
    v_dot2_f32_bf16 v120, v63, v115, v120
    v_dot2_f32_bf16 v121, v111, v115, v121
    v_dot2_f32_bf16 v122, v64, v115, v122
    ds_read_b64_tr_b16 v[86:87], v51 offset:13696
    v_dot2_f32_bf16 v123, v112, v115, v123
    v_and_b32 v133, 0xffff0000, v66
    v_lshlrev_b32 v132, 16, v66
    v_and_b32 v135, 0xffff0000, v67
    v_lshlrev_b32 v134, 16, v67
    ds_read_b64_tr_b16 v[88:89], v51 offset:18304
    v_and_b32 v137, 0xffff0000, v68
    v_lshlrev_b32 v136, 16, v68
    v_and_b32 v139, 0xffff0000, v69
    v_lshlrev_b32 v138, 16, v69
    v_pk_mul_f32 v[116:117], v[116:117], v[132:133]
    v_pk_mul_f32 v[118:119], v[118:119], v[134:135]
    v_pk_mul_f32 v[120:121], v[120:121], v[136:137]
    v_pk_mul_f32 v[122:123], v[122:123], v[138:139]
    v_cvt_pk_bf16_f32 v160, v123, v122
    v_cvt_pk_bf16_f32 v161, v121, v120
    v_cvt_pk_bf16_f32 v162, v119, v118
    v_cvt_pk_bf16_f32 v163, v117, v116
    buffer_store_dwordx4 v[160:163], v93, s[44:47], s7 offen sc1
    v_alignbit_b32 v114, v101, v101, 16
    v_alignbit_b32 v115, v100, v100, 16
    s_waitcnt lgkmcnt(5)
    v_alignbit_b32 v108, v71, v70, 16
    v_alignbit_b32 v109, v72, v71, 16
    v_alignbit_b32 v110, v73, v72, 16
    v_alignbit_b32 v111, v74, v73, 16
    v_alignbit_b32 v112, v75, v74, 16
    v_dot2_f32_bf16 v124, v70, v114, 0
    v_dot2_f32_bf16 v125, v108, v114, 0
    v_dot2_f32_bf16 v126, v71, v114, 0
    v_dot2_f32_bf16 v127, v109, v114, 0
    v_dot2_f32_bf16 v128, v72, v114, 0
    v_dot2_f32_bf16 v129, v110, v114, 0
    v_dot2_f32_bf16 v130, v73, v114, 0
    v_dot2_f32_bf16 v131, v111, v114, 0
    v_dot2_f32_bf16 v124, v71, v115, v124
    v_dot2_f32_bf16 v125, v109, v115, v125
    v_dot2_f32_bf16 v126, v72, v115, v126
    v_dot2_f32_bf16 v127, v110, v115, v127
    v_dot2_f32_bf16 v128, v73, v115, v128
    v_dot2_f32_bf16 v129, v111, v115, v129
    v_dot2_f32_bf16 v130, v74, v115, v130
    v_dot2_f32_bf16 v131, v112, v115, v131
    v_and_b32 v133, 0xffff0000, v76
    v_lshlrev_b32 v132, 16, v76
    v_and_b32 v135, 0xffff0000, v77
    v_lshlrev_b32 v134, 16, v77
    v_and_b32 v137, 0xffff0000, v78
    v_lshlrev_b32 v136, 16, v78
    v_and_b32 v139, 0xffff0000, v79
    v_lshlrev_b32 v138, 16, v79
    v_pk_mul_f32 v[124:125], v[124:125], v[132:133]
    v_pk_mul_f32 v[126:127], v[126:127], v[134:135]
    v_pk_mul_f32 v[128:129], v[128:129], v[136:137]
    v_pk_mul_f32 v[130:131], v[130:131], v[138:139]
    v_cvt_pk_bf16_f32 v164, v131, v130
    v_cvt_pk_bf16_f32 v165, v129, v128
    v_cvt_pk_bf16_f32 v166, v127, v126
    v_cvt_pk_bf16_f32 v167, v125, v124
    buffer_store_dwordx4 v[164:167], v94, s[44:47], s7 offen sc1
    v_alignbit_b32 v114, v103, v103, 16
    v_alignbit_b32 v115, v102, v102, 16
    s_waitcnt lgkmcnt(0)
    v_alignbit_b32 v108, v81, v80, 16
    v_alignbit_b32 v109, v82, v81, 16
    v_alignbit_b32 v110, v83, v82, 16
    v_alignbit_b32 v111, v84, v83, 16
    v_alignbit_b32 v112, v85, v84, 16
    v_dot2_f32_bf16 v116, v80, v114, 0
    v_dot2_f32_bf16 v117, v108, v114, 0
    v_dot2_f32_bf16 v118, v81, v114, 0
    v_dot2_f32_bf16 v119, v109, v114, 0
    v_dot2_f32_bf16 v120, v82, v114, 0
    v_dot2_f32_bf16 v121, v110, v114, 0
    v_dot2_f32_bf16 v122, v83, v114, 0
    v_dot2_f32_bf16 v123, v111, v114, 0
    v_dot2_f32_bf16 v116, v81, v115, v116
    v_dot2_f32_bf16 v117, v109, v115, v117
    v_dot2_f32_bf16 v118, v82, v115, v118
    v_dot2_f32_bf16 v119, v110, v115, v119
    v_dot2_f32_bf16 v120, v83, v115, v120
    v_dot2_f32_bf16 v121, v111, v115, v121
    v_dot2_f32_bf16 v122, v84, v115, v122
    v_dot2_f32_bf16 v123, v112, v115, v123
    v_and_b32 v133, 0xffff0000, v86
    v_lshlrev_b32 v132, 16, v86
    v_and_b32 v135, 0xffff0000, v87
    v_lshlrev_b32 v134, 16, v87
    v_and_b32 v137, 0xffff0000, v88
    v_lshlrev_b32 v136, 16, v88
    v_and_b32 v139, 0xffff0000, v89
    v_lshlrev_b32 v138, 16, v89
    v_pk_mul_f32 v[116:117], v[116:117], v[132:133]
    v_pk_mul_f32 v[118:119], v[118:119], v[134:135]
    v_pk_mul_f32 v[120:121], v[120:121], v[136:137]
    v_pk_mul_f32 v[122:123], v[122:123], v[138:139]
    v_cvt_pk_bf16_f32 v168, v123, v122
    v_cvt_pk_bf16_f32 v169, v121, v120
    v_cvt_pk_bf16_f32 v170, v119, v118
    v_cvt_pk_bf16_f32 v171, v117, v116
    buffer_store_dwordx4 v[168:171], v95, s[44:47], s8 offen sc1
    s_add_u32 m0, s74, 32
    s_add_u32 s13, s12, 0
    buffer_load_dwordx4 v240, s[48:51], s13 offen offset:0 lds
    buffer_load_dwordx4 v240, s[48:51], s13 offen offset:1024 lds
    buffer_load_dwordx4 v240, s[48:51], s13 offen offset:2048 lds
    buffer_load_dwordx4 v240, s[48:51], s13 offen offset:3072 lds
    s_add_u32 m0, s74, 8352
    s_add_u32 s13, s12, 16384
    buffer_load_dwordx4 v240, s[48:51], s13 offen offset:0 lds
    buffer_load_dwordx4 v240, s[48:51], s13 offen offset:1024 lds
    buffer_load_dwordx4 v240, s[48:51], s13 offen offset:2048 lds
    s_waitcnt vmcnt(10)
    v_readfirstlane_b32 s68, v45
    s_nop 1
    s_cmp_eq_u32 s68, 0
    s_cbranch_scc1 L_nw_X
L_ng_X:
    s_barrier
    v_mov_b32 v3, s68
    buffer_store_dword v3, v1, s[44:47], 0 offen sc1
    buffer_load_dwordx4 v240, s[48:51], s13 offen offset:3072 lds
    s_mov_b64 exec, 0
    s_call_b64 s[82:83], L_wc_X
    s_mov_b64 exec, -1
    s_waitcnt vmcnt(9)
    s_barrier
    buffer_store_dword v3, v46, s[44:47], 0 offen sc1
L_segX:
L_pl_X_0:
    s_cbranch_execz L_pl_X_4
    s_cmp_lt_u32 s75, 252
    s_cbranch_scc0 L_idle
    s_mov_b32 s56, s26
    s_and_b32 s57, s27, 0xffff
    s_mov_b32 s58, 1152
    s_mov_b32 s59, 0x20000
    v_mov_b32 v9, 0
    buffer_load_ushort v9, v9, s[56:59], s70 offen
    s_lshr_b32 s4, s2, 1
    s_and_b32 s4, s4, 3
    s_lshl2_add_u32 s4, s4, s3
    s_lshl_b32 s4, s4, 8
    s_add_u32 s4, s4, 12599296
    v_lshl_add_u32 v28, v2, 2, s4
    v_add_u32 v241, s74, v240
    v_cmp_eq_u32 vcc, 0, v2
    v_mov_b32 v196, 4136
    s_nop 0
    v_cndmask_b32 v196, v196, 30, vcc
    v_add_u32 v242, s74, v196
    v_bfe_u32 v196, v2, 3, 2
    v_mul_u32_u24 v196, 4160, v196
    v_and_b32 v197, 7, v2
    v_lshl_add_u32 v196, v197, 2, v196
    v_add_u32 v200, s74, v196
    v_mov_b32 v196, 0
    v_mov_b32 v197, 0
    v_mov_b32 v198, 0
    v_mov_b32 v199, 0
    ds_write_b32 v200, v196
    v_lshlrev_b32 v201, 4, v0
    ds_write_b128 v201, v[196:199]
    ds_write_b128 v201, v[196:199] offset:36864
    s_waitcnt vmcnt(7)
    ds_read_b128 v[212:215], v241 offset:32
    ds_read_b32 v216, v241 offset:48
    ds_read_b128 v[218:221], v241 offset:1056
    ds_read_b32 v222, v241 offset:1072
    ds_read_b128 v[224:227], v241 offset:2080
    ds_read_b32 v228, v241 offset:2096
    ds_read_b128 v[230:233], v241 offset:3104
    ds_read_b32 v234, v241 offset:3120
    v_lshrrev_b32 v202, 3, v2
    v_and_b32 v203, 7, v2
    v_lshrrev_b32 v204, 1, v202
    v_xor_b32 v203, v203, v204
    v_mul_u32_u24 v202, 11264, v202
    v_lshl_add_u32 v15, v203, 4, v202
    v_xor_b32 v16, 64, v15
    v_and_b32 v202, 15, v2
    v_add_u32 v202, 1, v202
    v_and_b32 v203, 1, v202
    v_mul_u32_u24 v203, 4160, v203
    v_lshrrev_b32 v202, 1, v202
    v_lshl_add_u32 v203, v202, 2, v203
    v_lshrrev_b32 v204, 4, v2
    v_lshl_add_u32 v203, v204, 4, v203
    v_add_u32 v236, s74, v203
    v_add_u32 v237, 1024, v236
    v_add_u32 v238, 1024, v237
    v_add_u32 v239, 1024, v238
    s_waitcnt lgkmcnt(0)
    s_waitcnt vmcnt(0)
    v_lshlrev_b32 v9, 16, v9
    v_lshlrev_b32 v208, 16, v212
    v_add_f32 v9, v9, v208
    v_cvt_pk_bf16_f32 v9, v9, v9
    ds_write_b16 v242, v9 offset:4160
    ds_write_b16 v242, v9 offset:2
    v_alignbit_b32 v212, v213, v212, 16
    v_alignbit_b32 v213, v214, v213, 16
    v_alignbit_b32 v214, v215, v214, 16
    v_alignbit_b32 v215, v216, v215, 16
    ds_write_b128 v241, v[212:215] offset:4192
    v_alignbit_b32 v218, v219, v218, 16
    v_alignbit_b32 v219, v220, v219, 16
    v_alignbit_b32 v220, v221, v220, 16
    v_alignbit_b32 v221, v222, v221, 16
    ds_write_b128 v241, v[218:221] offset:5216
    v_alignbit_b32 v224, v225, v224, 16
    v_alignbit_b32 v225, v226, v225, 16
    v_alignbit_b32 v226, v227, v226, 16
    v_alignbit_b32 v227, v228, v227, 16
    ds_write_b128 v241, v[224:227] offset:6240
    v_alignbit_b32 v230, v231, v230, 16
    v_alignbit_b32 v231, v232, v231, 16
    v_alignbit_b32 v232, v233, v232, 16
    v_alignbit_b32 v233, v234, v233, 16
    ds_write_b128 v241, v[230:233] offset:7264
    v_and_b32 v202, 15, v2
    v_lshlrev_b32 v202, 1, v202
    v_sub_u32 v202, v202, v204
    v_add_u32 v202, 17, v202
    v_bfe_u32 v203, v202, 1, 3
    v_xor_b32 v203, s3, v203
    v_lshlrev_b32 v203, 4, v203
    v_lshl_add_u32 v244, v202, 7, v203
    v_and_b32 v202, 15, v2
    v_lshlrev_b32 v202, 1, v202
    v_sub_u32 v202, v202, v204
    v_add_u32 v202, 13, v202
    v_bfe_u32 v203, v202, 1, 3
    v_xor_b32 v203, s3, v203
    v_lshlrev_b32 v203, 4, v203
    v_lshl_add_u32 v245, v202, 7, v203
    v_and_b32 v202, 15, v2
    v_lshlrev_b32 v202, 1, v202
    v_sub_u32 v202, v202, v204
    v_add_u32 v202, 9, v202
    v_bfe_u32 v203, v202, 1, 3
    v_xor_b32 v203, s3, v203
    v_lshlrev_b32 v203, 4, v203
    v_lshl_add_u32 v246, v202, 7, v203
    v_and_b32 v202, 15, v2
    v_lshlrev_b32 v202, 1, v202
    v_sub_u32 v202, v202, v204
    v_add_u32 v202, 5, v202
    v_bfe_u32 v203, v202, 1, 3
    v_xor_b32 v203, s3, v203
    v_lshlrev_b32 v203, 4, v203
    v_lshl_add_u32 v247, v202, 7, v203
    v_and_b32 v202, 15, v2
    v_lshlrev_b32 v202, 5, v202
    v_lshl_add_u32 v8, v204, 3, v202
    s_mul_i32 s7, s3, 589824
    s_lshl_b32 s8, s69, 8
    s_add_u32 s7, s7, s8
    s_add_u32 s10, s7, 2359296
    s_lshl_b32 s9, s3, 13
    s_add_u32 s9, s9, 4096
    s_lshl1_add_u32 s4, s69, 0
    s_mul_i32 s5, s4, 9363
    s_lshr_b32 s5, s5, 16
    s_mul_i32 s7, s5, 7
    s_sub_u32 s7, s4, s7
    s_cmp_gt_u32 s7, 2
    s_addc_u32 s4, s4, s5
    s_lshl_b32 s4, s4, 7
    s_mul_i32 s7, s3, 720896
    s_add_u32 s4, s4, s7
    s_add_u32 s10, s4, 39469056
    s_lshl1_add_u32 s4, s69, 1
    s_mul_i32 s5, s4, 9363
    s_lshr_b32 s5, s5, 16
    s_mul_i32 s7, s5, 7
    s_sub_u32 s7, s4, s7
    s_cmp_gt_u32 s7, 2
    s_addc_u32 s4, s4, s5
    s_lshl_b32 s4, s4, 7
    s_mul_i32 s7, s3, 720896
    s_add_u32 s4, s4, s7
    s_add_u32 s11, s4, 39469056
    ds_read2_b32 v[64:65], v236 offset0:0 offset1:1
    ds_read2_b32 v[66:67], v236 offset0:2 offset1:3
    ds_read2_b32 v[68:69], v236 offset0:128 offset1:129
    ds_read2_b32 v[70:71], v236 offset0:130 offset1:131
    ds_read2_b32 v[72:73], v237 offset0:0 offset1:1
    ds_read2_b32 v[74:75], v237 offset0:2 offset1:3
    ds_read2_b32 v[76:77], v237 offset0:128 offset1:129
    ds_read2_b32 v[78:79], v237 offset0:130 offset1:131
    ds_read2_b32 v[80:81], v238 offset0:0 offset1:1
    ds_read2_b32 v[82:83], v238 offset0:2 offset1:3
    ds_read2_b32 v[84:85], v238 offset0:128 offset1:129
    ds_read2_b32 v[86:87], v238 offset0:130 offset1:131
    ds_read2_b32 v[88:89], v239 offset0:0 offset1:1
    ds_read2_b32 v[90:91], v239 offset0:2 offset1:3
    ds_read2_b32 v[92:93], v239 offset0:128 offset1:129
    ds_read2_b32 v[94:95], v239 offset0:130 offset1:131
    v_mov_b32 v29, 0
    buffer_atomic_add v29, v28, s[44:47], 0 offen sc0 sc1
    s_waitcnt vmcnt(0)
    v_cmp_ne_u32 vcc, s68, v29
    s_cbranch_vccnz L_rs_p1X
L_ok_p1X:
    s_add_u32 m0, s9, 0
    s_add_u32 s13, s10, 0
    buffer_load_dwordx4 v15, s[44:47], s13 offen sc1 lds
    s_add_u32 m0, s9, 1024
    s_add_u32 s13, s10, 90112
    buffer_load_dwordx4 v16, s[44:47], s13 offen sc1 lds
    s_add_u32 m0, s9, 2048
    s_add_u32 s13, s10, 180224
L_pl_X_1:
    s_cbranch_execz L_pl_X_5
    buffer_load_dwordx4 v15, s[44:47], s13 offen sc1 lds
    s_add_u32 m0, s9, 3072
    s_add_u32 s13, s10, 270336
    buffer_load_dwordx4 v16, s[44:47], s13 offen sc1 lds
    s_add_u32 m0, s9, 4096
    s_add_u32 s13, s10, 360448
    buffer_load_dwordx4 v15, s[44:47], s13 offen sc1 lds
    s_add_u32 m0, s9, 5120
    s_add_u32 s13, s10, 450560
    buffer_load_dwordx4 v16, s[44:47], s13 offen sc1 lds
    s_add_u32 m0, s9, 6144
    s_add_u32 s13, s10, 540672
    buffer_load_dwordx4 v15, s[44:47], s13 offen sc1 lds
    s_add_u32 m0, s9, 7168
    s_add_u32 s13, s10, 630784
    buffer_load_dwordx4 v16, s[44:47], s13 offen sc1 lds
    s_mov_b64 exec, 0
    s_call_b64 s[82:83], L_wc_D
    s_mov_b64 exec, -1
    s_mov_b32 s60, s36
    s_and_b32 s61, s37, 0xffff
    s_mov_b32 s62, 4096
    s_mov_b32 s63, 0x20000
    v_and_b32 v24, 15, v2
    s_lshl_b32 s7, s71, 6
    v_add_u32 v24, s7, v24
    s_and_b32 s8, s3, 1
    s_lshl_b32 s4, s8, 5
    v_add_u32 v25, s4, v24
    v_lshlrev_b32 v26, 3, v25
    v_mul_u32_u24 v25, 1152, v25
    v_bfe_u32 v31, v2, 4, 1
    v_lshl_add_u32 v25, v31, 5, v25
    v_lshrrev_b32 v31, 5, v2
    v_lshl_add_u32 v25, v31, 4, v25
    s_bfe_u32 s7, s2, 0x20003
    s_mul_i32 s7, s7, 288
    s_lshl_b32 s4, s72, 6
    s_add_u32 s4, s4, s7
    v_add_u32 v252, s4, v25
    s_xor_b32 s8, s3, s72
    s_and_b32 s4, s72, 1
    s_lshl1_add_u32 s4, s4, s8
    v_lshl_add_u32 v24, s4, 4, v24
    s_add_u32 s7, s7, 256
    s_cmp_lt_u32 s8, 2
    s_cselect_b32 s7, s7, 0x40000000
    v_lshlrev_b32 v18, 3, v24
    v_mul_u32_u24 v24, 1152, v24
    v_lshrrev_b32 v31, 4, v2
    v_lshl_add_u32 v24, v31, 3, v24
    v_add_u32 v253, s7, v24
    v_lshrrev_b32 v24, 3, v2
    v_and_b32 v25, 7, v2
    v_bfe_u32 v31, v2, 4, 2
    v_lshlrev_b32 v31, 1, v31
    v_xor_b32 v25, v25, v31
    v_lshlrev_b32 v24, 12, v24
    v_lshl_add_u32 v24, v25, 4, v24
    s_mul_i32 s7, s72, 36
    s_bitcmp1_b32 s3, 0
    s_addc_u32 s7, s7, 0
    s_lshl_b32 s7, s7, 17
    s_lshl_b32 s8, s71, 7
    s_add_u32 s7, s7, s8
    v_add_u32 v4, s7, v24
    v_add_u32 v5, 31744, v4
    v_add_u32 v6, 31744, v5
    v_add_u32 v7, 31744, v6
    v_lshrrev_b32 v24, 2, v2
    v_lshlrev_b32 v24, 7, v24
    v_and_b32 v25, 3, v2
    v_lshl_add_u32 v24, v25, 3, v24
    s_and_b32 s7, s73, 8192
    v_add_u32 v24, s7, v24
    v_bfe_u32 v31, v2, 3, 2
    s_and_b32 s7, s3, 1
    s_lshl_b32 s7, s7, 1
    v_xor_b32 v31, s7, v31
    v_lshl_add_u32 v10, v31, 5, v24
    v_xor_b32 v11, 32, v10
    v_and_b32 v24, 15, v2
    v_lshrrev_b32 v25, 4, v2
    v_mul_u32_u24 v25, 17408, v25
    v_lshl_add_u32 v24, v24, 4, v25
    s_mul_i32 s7, s72, 36
    s_and_b32 s8, s3, 1
    s_add_u32 s7, s7, s8
    s_mul_i32 s7, s7, 69632
    s_bfe_u32 s8, s2, 0x20003
    s_lshl_b32 s8, s8, 12
    s_add_u32 s7, s7, s8
    s_add_u32 s7, s7, 12795904
    v_add_u32 v23, s7, v24
    s_xor_b32 s7, s72, 0
    v_lshl_add_u32 v19, s7, 10, v23
    s_xor_b32 s7, s72, 1
    v_lshl_add_u32 v20, s7, 10, v23
    s_xor_b32 s7, s72, 2
    v_lshl_add_u32 v21, s7, 10, v23
    s_xor_b32 s7, s72, 3
    v_lshl_add_u32 v22, s7, 10, v23
    v_lshlrev_b32 v14, 4, v2
    v_add_u32 v14, 98304, v14
    v_add_u32 v1, 0x10000, v14
    s_bitcmp1_b32 s3, 1
    s_cselect_b32 s18, s85, s84
    s_mul_i32 s18, s18, 139264
    s_cselect_b32 s19, s87, s86
    s_mul_i32 s19, s19, 139264
    s_cselect_b32 s20, s89, s88
    s_mul_i32 s20, s20, 139264
    s_cselect_b32 s21, s91, s90
    s_mul_i32 s21, s21, 139264
    s_cselect_b32 s22, s93, s92
    s_mul_i32 s22, s22, 139264
    s_cselect_b32 s23, s95, s94
    s_mul_i32 s23, s23, 139264
    s_cselect_b32 s24, s97, s96
    s_mul_i32 s24, s24, 139264
    s_cselect_b32 s25, s99, s98
    s_mul_i32 s25, s25, 139264
    s_cselect_b32 s26, s101, s100
    s_mul_i32 s26, s26, 139264
    v_add_u32 v10, 131072, v10
    v_add_u32 v11, 131072, v11
    s_waitcnt vmcnt(0) lgkmcnt(0)
    s_barrier
    ds_read_b128 v[96:99], v244 offset:2048
    ds_read_b128 v[100:103], v244 offset:6144
    ds_read_b128 v[104:107], v244 offset:10240
    ds_read_b128 v[108:111], v244 offset:14336
    ds_read_b128 v[112:115], v244 offset:18432
    ds_read_b128 v[116:119], v244 offset:22528
    ds_read_b128 v[120:123], v244 offset:26624
    ds_read_b128 v[124:127], v244 offset:30720
    s_waitcnt lgkmcnt(0)
    v_mfma_f32_16x16x32_bf16 v[32:35], v[64:67], v[96:99], 0
    s_lshl_b32 s14, s84, 18
    ds_read_b128 v[160:163], v245 offset:2048
    v_mfma_f32_16x16x32_bf16 v[36:39], v[68:71], v[96:99], 0
    s_add_u32 m0, s73, 147456
    v_mfma_f32_16x16x32_bf16 v[36:39], v[64:67], v[100:103], v[36:39]
    buffer_load_dwordx4 v4, s[52:55], s14 offen offset:0 lds
    ds_read2_b32 v[128:129], v236 offset0:16 offset1:17
    v_mfma_f32_16x16x32_bf16 v[40:43], v[64:67], v[104:107], 0
    ds_read2_b32 v[130:131], v236 offset0:18 offset1:19
    v_mfma_f32_16x16x32_bf16 v[40:43], v[68:71], v[100:103], v[40:43]
    v_mfma_f32_16x16x32_bf16 v[40:43], v[72:75], v[96:99], v[40:43]
    ds_read_b128 v[164:167], v245 offset:6144
    v_mfma_f32_16x16x32_bf16 v[44:47], v[76:79], v[96:99], 0
    ds_read2_b32 v[132:133], v236 offset0:144 offset1:145
    v_mfma_f32_16x16x32_bf16 v[44:47], v[72:75], v[100:103], v[44:47]
    v_mfma_f32_16x16x32_bf16 v[44:47], v[68:71], v[104:107], v[44:47]
    s_add_u32 m0, s73, 147456
    ds_read2_b32 v[134:135], v236 offset0:146 offset1:147
    v_mfma_f32_16x16x32_bf16 v[44:47], v[64:67], v[108:111], v[44:47]
    buffer_load_dwordx4 v5, s[52:55], s14 offen offset:1024 lds
    ds_read_b128 v[168:171], v245 offset:10240
    v_mfma_f32_16x16x32_bf16 v[48:51], v[64:67], v[112:115], 0
    ds_read2_b32 v[136:137], v237 offset0:16 offset1:17
    v_mfma_f32_16x16x32_bf16 v[48:51], v[68:71], v[108:111], v[48:51]
    v_mfma_f32_16x16x32_bf16 v[48:51], v[72:75], v[104:107], v[48:51]
    ds_read2_b32 v[138:139], v237 offset0:18 offset1:19
    v_mfma_f32_16x16x32_bf16 v[48:51], v[76:79], v[100:103], v[48:51]
    ds_read_b128 v[172:175], v245 offset:14336
    v_mfma_f32_16x16x32_bf16 v[48:51], v[80:83], v[96:99], v[48:51]
    v_mfma_f32_16x16x32_bf16 v[52:55], v[84:87], v[96:99], 0
    s_add_u32 m0, s73, 147456
    ds_read2_b32 v[140:141], v237 offset0:144 offset1:145
    v_mfma_f32_16x16x32_bf16 v[52:55], v[80:83], v[100:103], v[52:55]
    buffer_load_dwordx4 v6, s[52:55], s14 offen offset:2048 lds
    ds_read2_b32 v[142:143], v237 offset0:146 offset1:147
    v_mfma_f32_16x16x32_bf16 v[52:55], v[76:79], v[104:107], v[52:55]
    v_mfma_f32_16x16x32_bf16 v[52:55], v[72:75], v[108:111], v[52:55]
    ds_read_b128 v[176:179], v245 offset:18432
    v_mfma_f32_16x16x32_bf16 v[52:55], v[68:71], v[112:115], v[52:55]
    ds_read2_b32 v[144:145], v238 offset0:16 offset1:17
    v_mfma_f32_16x16x32_bf16 v[52:55], v[64:67], v[116:119], v[52:55]
    v_mfma_f32_16x16x32_bf16 v[56:59], v[64:67], v[120:123], 0
    ds_read2_b32 v[146:147], v238 offset0:18 offset1:19
    v_mfma_f32_16x16x32_bf16 v[56:59], v[68:71], v[116:119], v[56:59]
    s_add_u32 m0, s73, 147456
    ds_read_b128 v[180:183], v245 offset:22528
    v_mfma_f32_16x16x32_bf16 v[56:59], v[72:75], v[112:115], v[56:59]
    buffer_load_dwordx4 v7, s[52:55], s14 offen offset:3072 lds
    v_mfma_f32_16x16x32_bf16 v[56:59], v[76:79], v[108:111], v[56:59]
    ds_read2_b32 v[148:149], v238 offset0:144 offset1:145
    v_mfma_f32_16x16x32_bf16 v[56:59], v[80:83], v[104:107], v[56:59]
    ds_read2_b32 v[150:151], v238 offset0:146 offset1:147
    v_mfma_f32_16x16x32_bf16 v[56:59], v[84:87], v[100:103], v[56:59]
    ds_read_b128 v[184:187], v245 offset:26624
    v_mfma_f32_16x16x32_bf16 v[56:59], v[88:91], v[96:99], v[56:59]
    v_mfma_f32_16x16x32_bf16 v[60:63], v[92:95], v[96:99], 0
    ds_read2_b32 v[152:153], v239 offset0:16 offset1:17
    v_mfma_f32_16x16x32_bf16 v[60:63], v[88:91], v[100:103], v[60:63]
    ds_read2_b32 v[154:155], v239 offset0:18 offset1:19
    v_mfma_f32_16x16x32_bf16 v[60:63], v[84:87], v[104:107], v[60:63]
    v_mfma_f32_16x16x32_bf16 v[60:63], v[80:83], v[108:111], v[60:63]
    ds_read_b128 v[188:191], v245 offset:30720
    v_mfma_f32_16x16x32_bf16 v[60:63], v[76:79], v[112:115], v[60:63]
    ds_read2_b32 v[156:157], v239 offset0:144 offset1:145
    v_mfma_f32_16x16x32_bf16 v[60:63], v[72:75], v[116:119], v[60:63]
    v_mfma_f32_16x16x32_bf16 v[60:63], v[68:71], v[120:123], v[60:63]
    ds_read2_b32 v[158:159], v239 offset0:146 offset1:147
    v_mfma_f32_16x16x32_bf16 v[60:63], v[64:67], v[124:127], v[60:63]
    s_waitcnt lgkmcnt(12)
    v_mfma_f32_16x16x32_bf16 v[32:35], v[128:131], v[160:163], v[32:35]
    ds_read_b128 v[96:99], v246 offset:2048
    v_mfma_f32_16x16x32_bf16 v[36:39], v[132:135], v[160:163], v[36:39]
    v_mfma_f32_16x16x32_bf16 v[36:39], v[128:131], v[164:167], v[36:39]
    ds_read2_b32 v[64:65], v236 offset0:32 offset1:33
    v_mfma_f32_16x16x32_bf16 v[40:43], v[128:131], v[168:171], v[40:43]
    ds_read2_b32 v[66:67], v236 offset0:34 offset1:35
    v_mfma_f32_16x16x32_bf16 v[40:43], v[132:135], v[164:167], v[40:43]
    v_mfma_f32_16x16x32_bf16 v[40:43], v[136:139], v[160:163], v[40:43]
    ds_read_b128 v[100:103], v246 offset:6144
    v_mfma_f32_16x16x32_bf16 v[44:47], v[140:143], v[160:163], v[44:47]
    ds_read2_b32 v[68:69], v236 offset0:160 offset1:161
    v_mfma_f32_16x16x32_bf16 v[44:47], v[136:139], v[164:167], v[44:47]
    v_mfma_f32_16x16x32_bf16 v[44:47], v[132:135], v[168:171], v[44:47]
    ds_read2_b32 v[70:71], v236 offset0:162 offset1:163
    v_mfma_f32_16x16x32_bf16 v[44:47], v[128:131], v[172:175], v[44:47]
    ds_read_b128 v[104:107], v246 offset:10240
    s_waitcnt lgkmcnt(7)
    v_mfma_f32_16x16x32_bf16 v[48:51], v[128:131], v[176:179], v[48:51]
    s_lshl_b32 s14, s85, 18
    ds_read2_b32 v[72:73], v237 offset0:32 offset1:33
    v_mfma_f32_16x16x32_bf16 v[48:51], v[132:135], v[172:175], v[48:51]
    s_add_u32 m0, s73, 49152
    ds_read2_b32 v[74:75], v237 offset0:34 offset1:35
    v_mfma_f32_16x16x32_bf16 v[48:51], v[136:139], v[168:171], v[48:51]
    buffer_load_dwordx4 v4, s[52:55], s14 offen offset:0 lds
    v_mov_b32 v9, 8
    buffer_load_ushort v9, v9, s[56:59], s70 offen
    v_mfma_f32_16x16x32_bf16 v[48:51], v[140:143], v[164:167], v[48:51]
    ds_read_b128 v[108:111], v246 offset:14336
    v_mfma_f32_16x16x32_bf16 v[48:51], v[144:147], v[160:163], v[48:51]
    v_mfma_f32_16x16x32_bf16 v[52:55], v[148:151], v[160:163], v[52:55]
    ds_read2_b32 v[76:77], v237 offset0:160 offset1:161
    v_mfma_f32_16x16x32_bf16 v[52:55], v[144:147], v[164:167], v[52:55]
    ds_read2_b32 v[78:79], v237 offset0:162 offset1:163
    v_mfma_f32_16x16x32_bf16 v[52:55], v[140:143], v[168:171], v[52:55]
    v_mfma_f32_16x16x32_bf16 v[52:55], v[136:139], v[172:175], v[52:55]
    ds_read_b128 v[112:115], v246 offset:18432
    v_mfma_f32_16x16x32_bf16 v[52:55], v[132:135], v[176:179], v[52:55]
    s_add_u32 m0, s73, 49152
    ds_read2_b32 v[80:81], v238 offset0:32 offset1:33
    v_mfma_f32_16x16x32_bf16 v[52:55], v[128:131], v[180:183], v[52:55]
    buffer_load_dwordx4 v5, s[52:55], s14 offen offset:1024 lds
    v_mfma_f32_16x16x32_bf16 v[56:59], v[128:131], v[184:187], v[56:59]
    ds_read2_b32 v[82:83], v238 offset0:34 offset1:35
    v_mfma_f32_16x16x32_bf16 v[56:59], v[132:135], v[180:183], v[56:59]
    ds_read_b128 v[116:119], v246 offset:22528
    v_mfma_f32_16x16x32_bf16 v[56:59], v[136:139], v[176:179], v[56:59]
    v_mfma_f32_16x16x32_bf16 v[56:59], v[140:143], v[172:175], v[56:59]
    ds_read2_b32 v[84:85], v238 offset0:160 offset1:161
    v_mfma_f32_16x16x32_bf16 v[56:59], v[144:147], v[168:171], v[56:59]
    ds_read2_b32 v[86:87], v238 offset0:162 offset1:163
    v_mfma_f32_16x16x32_bf16 v[56:59], v[148:151], v[164:167], v[56:59]
    s_add_u32 m0, s73, 49152
    ds_read_b128 v[120:123], v246 offset:26624
    v_mfma_f32_16x16x32_bf16 v[56:59], v[152:155], v[160:163], v[56:59]
    buffer_load_dwordx4 v6, s[52:55], s14 offen offset:2048 lds
    v_mfma_f32_16x16x32_bf16 v[60:63], v[156:159], v[160:163], v[60:63]
    ds_read2_b32 v[88:89], v239 offset0:32 offset1:33
    v_mfma_f32_16x16x32_bf16 v[60:63], v[152:155], v[164:167], v[60:63]
    ds_read2_b32 v[90:91], v239 offset0:34 offset1:35
    v_mfma_f32_16x16x32_bf16 v[60:63], v[148:151], v[168:171], v[60:63]
    v_mfma_f32_16x16x32_bf16 v[60:63], v[144:147], v[172:175], v[60:63]
    ds_read_b128 v[124:127], v246 offset:30720
    v_mfma_f32_16x16x32_bf16 v[60:63], v[140:143], v[176:179], v[60:63]
    ds_read2_b32 v[92:93], v239 offset0:160 offset1:161
    v_mfma_f32_16x16x32_bf16 v[60:63], v[136:139], v[180:183], v[60:63]
    s_add_u32 m0, s73, 49152
    v_mfma_f32_16x16x32_bf16 v[60:63], v[132:135], v[184:187], v[60:63]
    buffer_load_dwordx4 v7, s[52:55], s14 offen offset:3072 lds
    ds_read2_b32 v[94:95], v239 offset0:162 offset1:163
    v_mfma_f32_16x16x32_bf16 v[60:63], v[128:131], v[188:191], v[60:63]
    s_waitcnt lgkmcnt(12)
    v_mfma_f32_16x16x32_bf16 v[32:35], v[64:67], v[96:99], v[32:35]
    ds_read_b128 v[160:163], v247 offset:2048
    v_mfma_f32_16x16x32_bf16 v[36:39], v[68:71], v[96:99], v[36:39]
    v_mfma_f32_16x16x32_bf16 v[36:39], v[64:67], v[100:103], v[36:39]
    ds_read2_b32 v[128:129], v236 offset0:48 offset1:49
    v_mfma_f32_16x16x32_bf16 v[40:43], v[64:67], v[104:107], v[40:43]
    ds_read2_b32 v[130:131], v236 offset0:50 offset1:51
    v_mfma_f32_16x16x32_bf16 v[40:43], v[68:71], v[100:103], v[40:43]
    v_mfma_f32_16x16x32_bf16 v[40:43], v[72:75], v[96:99], v[40:43]
    ds_read_b128 v[164:167], v247 offset:6144
    v_mfma_f32_16x16x32_bf16 v[44:47], v[76:79], v[96:99], v[44:47]
    ds_read2_b32 v[132:133], v236 offset0:176 offset1:177
    v_mfma_f32_16x16x32_bf16 v[44:47], v[72:75], v[100:103], v[44:47]
    v_mfma_f32_16x16x32_bf16 v[44:47], v[68:71], v[104:107], v[44:47]
    ds_read2_b32 v[134:135], v236 offset0:178 offset1:179
    v_mfma_f32_16x16x32_bf16 v[44:47], v[64:67], v[108:111], v[44:47]
    ds_read_b128 v[168:171], v247 offset:10240
    s_waitcnt lgkmcnt(7)
    v_mfma_f32_16x16x32_bf16 v[48:51], v[64:67], v[112:115], v[48:51]
    ds_read2_b32 v[136:137], v237 offset0:48 offset1:49
    v_mfma_f32_16x16x32_bf16 v[48:51], v[68:71], v[108:111], v[48:51]
    v_mfma_f32_16x16x32_bf16 v[48:51], v[72:75], v[104:107], v[48:51]
    ds_read2_b32 v[138:139], v237 offset0:50 offset1:51
    v_mfma_f32_16x16x32_bf16 v[48:51], v[76:79], v[100:103], v[48:51]
    ds_read_b128 v[172:175], v247 offset:14336
    v_mfma_f32_16x16x32_bf16 v[48:51], v[80:83], v[96:99], v[48:51]
    v_mfma_f32_16x16x32_bf16 v[52:55], v[84:87], v[96:99], v[52:55]
    ds_read2_b32 v[140:141], v237 offset0:176 offset1:177
    v_mfma_f32_16x16x32_bf16 v[52:55], v[80:83], v[100:103], v[52:55]
    ds_read2_b32 v[142:143], v237 offset0:178 offset1:179
    v_mfma_f32_16x16x32_bf16 v[52:55], v[76:79], v[104:107], v[52:55]
    v_mfma_f32_16x16x32_bf16 v[52:55], v[72:75], v[108:111], v[52:55]
    ds_read_b128 v[176:179], v247 offset:18432
    v_mfma_f32_16x16x32_bf16 v[52:55], v[68:71], v[112:115], v[52:55]
    ds_read2_b32 v[144:145], v238 offset0:48 offset1:49
    v_mfma_f32_16x16x32_bf16 v[52:55], v[64:67], v[116:119], v[52:55]
    v_mfma_f32_16x16x32_bf16 v[56:59], v[64:67], v[120:123], v[56:59]
    ds_read2_b32 v[146:147], v238 offset0:50 offset1:51
    v_mfma_f32_16x16x32_bf16 v[56:59], v[68:71], v[116:119], v[56:59]
    ds_read_b128 v[180:183], v247 offset:22528
    v_mfma_f32_16x16x32_bf16 v[56:59], v[72:75], v[112:115], v[56:59]
    v_mfma_f32_16x16x32_bf16 v[56:59], v[76:79], v[108:111], v[56:59]
    ds_read2_b32 v[148:149], v238 offset0:176 offset1:177
    v_mfma_f32_16x16x32_bf16 v[56:59], v[80:83], v[104:107], v[56:59]
    ds_read2_b32 v[150:151], v238 offset0:178 offset1:179
    v_mfma_f32_16x16x32_bf16 v[56:59], v[84:87], v[100:103], v[56:59]
    ds_read_b128 v[184:187], v247 offset:26624
    v_mfma_f32_16x16x32_bf16 v[56:59], v[88:91], v[96:99], v[56:59]
    v_mfma_f32_16x16x32_bf16 v[60:63], v[92:95], v[96:99], v[60:63]
    ds_read2_b32 v[152:153], v239 offset0:48 offset1:49
    v_mfma_f32_16x16x32_bf16 v[60:63], v[88:91], v[100:103], v[60:63]
    ds_read2_b32 v[154:155], v239 offset0:50 offset1:51
    v_mfma_f32_16x16x32_bf16 v[60:63], v[84:87], v[104:107], v[60:63]
    v_mfma_f32_16x16x32_bf16 v[60:63], v[80:83], v[108:111], v[60:63]
    ds_read_b128 v[188:191], v247 offset:30720
    v_mfma_f32_16x16x32_bf16 v[60:63], v[76:79], v[112:115], v[60:63]
    ds_read2_b32 v[156:157], v239 offset0:176 offset1:177
    v_mfma_f32_16x16x32_bf16 v[60:63], v[72:75], v[116:119], v[60:63]
    v_mfma_f32_16x16x32_bf16 v[60:63], v[68:71], v[120:123], v[60:63]
    ds_read2_b32 v[158:159], v239 offset0:178 offset1:179
    v_mfma_f32_16x16x32_bf16 v[60:63], v[64:67], v[124:127], v[60:63]
    s_waitcnt lgkmcnt(12)
    v_mfma_f32_16x16x32_bf16 v[32:35], v[128:131], v[160:163], v[32:35]
    ds_read_b128 v[96:99], v244 offset:0
    v_mfma_f32_16x16x32_bf16 v[36:39], v[132:135], v[160:163], v[36:39]
    v_mfma_f32_16x16x32_bf16 v[36:39], v[128:131], v[164:167], v[36:39]
    ds_read2_b32 v[64:65], v236 offset0:64 offset1:65
    v_mfma_f32_16x16x32_bf16 v[40:43], v[128:131], v[168:171], v[40:43]
    ds_read2_b32 v[66:67], v236 offset0:66 offset1:67
    v_mfma_f32_16x16x32_bf16 v[40:43], v[132:135], v[164:167], v[40:43]
    v_mfma_f32_16x16x32_bf16 v[40:43], v[136:139], v[160:163], v[40:43]
    ds_read_b128 v[100:103], v244 offset:4096
    v_mfma_f32_16x16x32_bf16 v[44:47], v[140:143], v[160:163], v[44:47]
    ds_read2_b32 v[68:69], v236 offset0:192 offset1:193
    v_mfma_f32_16x16x32_bf16 v[44:47], v[136:139], v[164:167], v[44:47]
    v_mfma_f32_16x16x32_bf16 v[44:47], v[132:135], v[168:171], v[44:47]
    ds_read2_b32 v[70:71], v236 offset0:194 offset1:195
    v_mfma_f32_16x16x32_bf16 v[44:47], v[128:131], v[172:175], v[44:47]
    ds_read_b128 v[104:107], v244 offset:8192
    s_waitcnt lgkmcnt(7)
    v_mfma_f32_16x16x32_bf16 v[48:51], v[128:131], v[176:179], v[48:51]
    ds_read2_b32 v[72:73], v237 offset0:64 offset1:65
    v_mfma_f32_16x16x32_bf16 v[48:51], v[132:135], v[172:175], v[48:51]
    ds_read2_b32 v[74:75], v237 offset0:66 offset1:67
    v_mfma_f32_16x16x32_bf16 v[48:51], v[136:139], v[168:171], v[48:51]
    ds_read_b128 v[108:111], v244 offset:12288
    v_mfma_f32_16x16x32_bf16 v[48:51], v[140:143], v[164:167], v[48:51]
    ds_read2_b32 v[76:77], v237 offset0:192 offset1:193
    v_mfma_f32_16x16x32_bf16 v[48:51], v[144:147], v[160:163], v[48:51]
    ds_read2_b32 v[78:79], v237 offset0:194 offset1:195
    s_waitcnt vmcnt(5)
    s_barrier
    v_mfma_f32_16x16x32_bf16 v[52:55], v[148:151], v[160:163], v[52:55]
    ds_read_b64_tr_b16 a[0:1], v10 offset:16384
    v_mfma_f32_16x16x32_bf16 v[52:55], v[144:147], v[164:167], v[52:55]
    ds_read_b128 v[112:115], v244 offset:16384
    v_mfma_f32_16x16x32_bf16 v[52:55], v[140:143], v[168:171], v[52:55]
    ds_read_b64_tr_b16 a[2:3], v10 offset:18432
    v_mfma_f32_16x16x32_bf16 v[52:55], v[136:139], v[172:175], v[52:55]
    ds_read_b64_tr_b16 a[8:9], v10 offset:20480
    v_mfma_f32_16x16x32_bf16 v[52:55], v[132:135], v[176:179], v[52:55]
    ds_read2_b32 v[80:81], v238 offset0:64 offset1:65
    v_mfma_f32_16x16x32_bf16 v[52:55], v[128:131], v[180:183], v[52:55]
    ds_read_b64_tr_b16 a[10:11], v10 offset:22528
    v_mfma_f32_16x16x32_bf16 v[56:59], v[128:131], v[184:187], v[56:59]
    ds_read_b64_tr_b16 a[4:5], v11 offset:16384
    v_mfma_f32_16x16x32_bf16 v[56:59], v[132:135], v[180:183], v[56:59]
    ds_read2_b32 v[82:83], v238 offset0:66 offset1:67
    v_mfma_f32_16x16x32_bf16 v[56:59], v[136:139], v[176:179], v[56:59]
    ds_read_b64_tr_b16 a[6:7], v11 offset:18432
    v_mfma_f32_16x16x32_bf16 v[56:59], v[140:143], v[172:175], v[56:59]
    ds_read_b64_tr_b16 a[12:13], v11 offset:20480
    v_mfma_f32_16x16x32_bf16 v[56:59], v[144:147], v[168:171], v[56:59]
    ds_read_b64_tr_b16 a[14:15], v11 offset:22528
    v_mfma_f32_16x16x32_bf16 v[56:59], v[148:151], v[164:167], v[56:59]
    ds_read_b128 v[116:119], v244 offset:20480
    v_mfma_f32_16x16x32_bf16 v[56:59], v[152:155], v[160:163], v[56:59]
    ds_read2_b32 v[84:85], v238 offset0:192 offset1:193
    v_mfma_f32_16x16x32_bf16 v[60:63], v[156:159], v[160:163], v[60:63]
    ds_read2_b32 v[86:87], v238 offset0:194 offset1:195
    s_waitcnt lgkmcnt(3)
    s_barrier
    v_mfma_f32_16x16x32_bf16 v[60:63], v[152:155], v[164:167], v[60:63]
    ds_read_b128 v[120:123], v244 offset:24576
    v_mfma_f32_16x16x32_bf16 v[60:63], v[148:151], v[168:171], v[60:63]
    ds_read2_b32 v[88:89], v239 offset0:64 offset1:65
    v_mfma_f32_16x16x32_bf16 v[60:63], v[144:147], v[172:175], v[60:63]
    ds_read2_b32 v[90:91], v239 offset0:66 offset1:67
    v_mfma_f32_16x16x32_bf16 v[60:63], v[140:143], v[176:179], v[60:63]
    s_lshl_b32 s14, s86, 18
    ds_read_b128 v[124:127], v244 offset:28672
    v_mfma_f32_16x16x32_bf16 v[60:63], v[136:139], v[180:183], v[60:63]
    s_add_u32 m0, s73, 147456
    ds_read2_b32 v[92:93], v239 offset0:192 offset1:193
    v_mfma_f32_16x16x32_bf16 v[60:63], v[132:135], v[184:187], v[60:63]
    buffer_load_dwordx4 v4, s[52:55], s14 offen offset:0 lds
    ds_read2_b32 v[94:95], v239 offset0:194 offset1:195
    v_mfma_f32_16x16x32_bf16 v[60:63], v[128:131], v[188:191], v[60:63]
    v_mfma_f32_16x16x32_bf16 v[32:35], v[64:67], v[96:99], v[32:35]
    ds_read_b128 v[160:163], v245 offset:0
    v_mfma_f32_16x16x32_bf16 v[36:39], v[68:71], v[96:99], v[36:39]
    ds_read2_b32 v[128:129], v236 offset0:80 offset1:81
    v_mfma_f32_16x16x32_bf16 v[36:39], v[64:67], v[100:103], v[36:39]
    ds_read2_b32 v[130:131], v236 offset0:82 offset1:83
    v_mfma_f32_16x16x32_bf16 v[40:43], v[64:67], v[104:107], v[40:43]
    ds_read_b128 v[164:167], v245 offset:4096
    v_mfma_f32_16x16x32_bf16 v[40:43], v[68:71], v[100:103], v[40:43]
    s_add_u32 m0, s73, 147456
    ds_read2_b32 v[132:133], v236 offset0:208 offset1:209
    v_mfma_f32_16x16x32_bf16 v[40:43], v[72:75], v[96:99], v[40:43]
    buffer_load_dwordx4 v5, s[52:55], s14 offen offset:1024 lds
    ds_read2_b32 v[134:135], v236 offset0:210 offset1:211
    v_mfma_f32_16x16x32_bf16 v[44:47], v[76:79], v[96:99], v[44:47]
    ds_read_b128 v[168:171], v245 offset:8192
    v_mfma_f32_16x16x32_bf16 v[44:47], v[72:75], v[100:103], v[44:47]
    ds_read2_b32 v[136:137], v237 offset0:80 offset1:81
    v_mfma_f32_16x16x32_bf16 v[44:47], v[68:71], v[104:107], v[44:47]
    ds_read2_b32 v[138:139], v237 offset0:82 offset1:83
    v_mfma_f32_16x16x32_bf16 v[44:47], v[64:67], v[108:111], v[44:47]
    ds_read_b128 v[172:175], v245 offset:12288
    s_waitcnt lgkmcnt(10)
    v_mfma_f32_16x16x32_bf16 v[48:51], v[64:67], v[112:115], v[48:51]
    ds_read2_b32 v[140:141], v237 offset0:208 offset1:209
    v_mfma_f32_16x16x32_bf16 v[48:51], v[68:71], v[108:111], v[48:51]
    s_add_u32 m0, s73, 147456
    ds_read2_b32 v[142:143], v237 offset0:210 offset1:211
    v_mfma_f32_16x16x32_bf16 v[48:51], v[72:75], v[104:107], v[48:51]
    buffer_load_dwordx4 v6, s[52:55], s14 offen offset:2048 lds
    ds_read_b128 v[176:179], v245 offset:16384
    v_mfma_f32_16x16x32_bf16 v[48:51], v[76:79], v[100:103], v[48:51]
    ds_read2_b32 v[144:145], v238 offset0:80 offset1:81
    v_mfma_f32_16x16x32_bf16 v[48:51], v[80:83], v[96:99], v[48:51]
    ds_read2_b32 v[146:147], v238 offset0:82 offset1:83
    v_mfma_f32_16x16x32_bf16 v[52:55], v[84:87], v[96:99], v[52:55]
    ds_read_b128 v[180:183], v245 offset:20480
    v_mfma_f32_16x16x32_bf16 v[52:55], v[80:83], v[100:103], v[52:55]
    ds_read2_b32 v[148:149], v238 offset0:208 offset1:209
    v_mfma_f32_16x16x32_bf16 v[52:55], v[76:79], v[104:107], v[52:55]
    ds_read2_b32 v[150:151], v238 offset0:210 offset1:211
    v_mfma_f32_16x16x32_bf16 v[52:55], v[72:75], v[108:111], v[52:55]
    ds_read_b128 v[184:187], v245 offset:24576
    v_mfma_f32_16x16x32_bf16 v[52:55], v[68:71], v[112:115], v[52:55]
    s_add_u32 m0, s73, 147456
    ds_read_b128 v[212:215], v241 offset:8352
    v_mfma_f32_16x16x32_bf16 v[52:55], v[64:67], v[116:119], v[52:55]
    buffer_load_dwordx4 v7, s[52:55], s14 offen offset:3072 lds
    ds_read2_b32 v[152:153], v239 offset0:80 offset1:81
    v_mfma_f32_16x16x32_bf16 v[56:59], v[64:67], v[120:123], v[56:59]
    ds_read_b32 v216, v241 offset:8368
    v_mfma_f32_16x16x32_bf16 v[56:59], v[68:71], v[116:119], v[56:59]
    ds_read2_b32 v[154:155], v239 offset0:82 offset1:83
    v_mfma_f32_16x16x32_bf16 v[56:59], v[72:75], v[112:115], v[56:59]
    ds_read_b128 v[218:221], v241 offset:9376
    v_mfma_f32_16x16x32_bf16 v[56:59], v[76:79], v[108:111], v[56:59]
    ds_read_b32 v222, v241 offset:9392
    v_mfma_f32_16x16x32_bf16 v[56:59], v[80:83], v[104:107], v[56:59]
    ds_read_b128 v[224:227], v241 offset:10400
    s_waitcnt vmcnt(4)
    s_barrier
    v_mfma_f32_16x16x32_bf16 v[56:59], v[84:87], v[100:103], v[56:59]
    ds_read_b32 v228, v241 offset:10416
    v_add_u32 v10, -131072, v10
    v_mfma_f32_16x16x32_bf16 v[56:59], v[88:91], v[96:99], v[56:59]
    ds_read_b64_tr_b16 a[16:17], v10 offset:49152
    v_mfma_f32_16x16x32_bf16 v[60:63], v[92:95], v[96:99], v[60:63]
    ds_read_b64_tr_b16 a[18:19], v10 offset:51200
    v_mfma_f32_16x16x32_bf16 v[60:63], v[88:91], v[100:103], v[60:63]
    ds_read_b64_tr_b16 a[24:25], v10 offset:53248
    v_mfma_f32_16x16x32_bf16 v[60:63], v[84:87], v[104:107], v[60:63]
    ds_read_b128 v[230:233], v241 offset:11424
    v_mfma_f32_16x16x32_bf16 v[60:63], v[80:83], v[108:111], v[60:63]
    ds_read_b64_tr_b16 a[26:27], v10 offset:55296
    ds_read_b128 v[188:191], v245 offset:28672
    v_mfma_f32_16x16x32_bf16 v[60:63], v[76:79], v[112:115], v[60:63]
    ds_read_b32 v234, v241 offset:11440
    v_add_u32 v11, -131072, v11
    v_mfma_f32_16x16x32_bf16 v[60:63], v[72:75], v[116:119], v[60:63]
    ds_read_b64_tr_b16 a[20:21], v11 offset:49152
    ds_read2_b32 v[156:157], v239 offset0:208 offset1:209
    v_mfma_f32_16x16x32_bf16 v[60:63], v[68:71], v[120:123], v[60:63]
    ds_read_b64_tr_b16 a[22:23], v11 offset:51200
    ds_read2_b32 v[158:159], v239 offset0:210 offset1:211
    v_mfma_f32_16x16x32_bf16 v[60:63], v[64:67], v[124:127], v[60:63]
    ds_read_b64_tr_b16 a[28:29], v11 offset:53248
    s_waitcnt lgkmcnt(15)
    v_mfma_f32_16x16x32_bf16 v[32:35], v[128:131], v[160:163], v[32:35]
    ds_read_b64_tr_b16 a[30:31], v11 offset:55296
    v_mfma_f32_16x16x32_bf16 v[36:39], v[132:135], v[160:163], v[36:39]
    ds_read_b128 v[96:99], v246 offset:0
    v_mfma_f32_16x16x32_bf16 v[36:39], v[128:131], v[164:167], v[36:39]
    ds_read2_b32 v[64:65], v236 offset0:96 offset1:97
    v_mfma_f32_16x16x32_bf16 v[40:43], v[128:131], v[168:171], v[40:43]
    ds_read2_b32 v[66:67], v236 offset0:98 offset1:99
    s_waitcnt lgkmcnt(3)
    s_barrier
    v_mfma_f32_16x16x32_bf16 v[40:43], v[132:135], v[164:167], v[40:43]
    v_mfma_f32_16x16x32_bf16 v[40:43], v[136:139], v[160:163], v[40:43]
    ds_read_b128 v[100:103], v246 offset:4096
    v_mfma_f32_16x16x32_bf16 v[44:47], v[140:143], v[160:163], v[44:47]
    ds_read2_b32 v[68:69], v236 offset0:224 offset1:225
    v_mfma_f32_16x16x32_bf16 v[44:47], v[136:139], v[164:167], v[44:47]
    s_lshl_b32 s14, s87, 18
    v_mfma_f32_16x16x32_bf16 v[44:47], v[132:135], v[168:171], v[44:47]
    ds_read2_b32 v[70:71], v236 offset0:226 offset1:227
    s_add_u32 m0, s73, 49152
    v_lshlrev_b32 v9, 16, v9
    v_mfma_f32_16x16x32_bf16 v[44:47], v[128:131], v[172:175], v[44:47]
    buffer_load_dwordx4 v4, s[52:55], s14 offen offset:0 lds
    ds_read_b128 v[104:107], v246 offset:8192
    v_mfma_f32_16x16x32_bf16 v[48:51], v[128:131], v[176:179], v[48:51]
    ds_read2_b32 v[72:73], v237 offset0:96 offset1:97
    v_lshlrev_b32 v208, 16, v212
    v_mfma_f32_16x16x32_bf16 v[48:51], v[132:135], v[172:175], v[48:51]
    v_mfma_f32_16x16x32_bf16 v[48:51], v[136:139], v[168:171], v[48:51]
    ds_read2_b32 v[74:75], v237 offset0:98 offset1:99
    v_add_f32 v9, v9, v208
    v_mfma_f32_16x16x32_bf16 v[48:51], v[140:143], v[164:167], v[48:51]
    ds_read_b128 v[108:111], v246 offset:12288
    v_cvt_pk_bf16_f32 v9, v9, v9
    v_mfma_f32_16x16x32_bf16 v[48:51], v[144:147], v[160:163], v[48:51]
    ds_write_b16 v242, v9 offset:12480
    v_mfma_f32_16x16x32_bf16 v[52:55], v[148:151], v[160:163], v[52:55]
    s_add_u32 m0, s73, 49152
    ds_read2_b32 v[76:77], v237 offset0:224 offset1:225
    v_mfma_f32_16x16x32_bf16 v[52:55], v[144:147], v[164:167], v[52:55]
    buffer_load_dwordx4 v5, s[52:55], s14 offen offset:1024 lds
    ds_read2_b32 v[78:79], v237 offset0:226 offset1:227
    v_mfma_f32_16x16x32_bf16 v[52:55], v[140:143], v[168:171], v[52:55]
    ds_write_b16 v242, v9 offset:8322
    v_mfma_f32_16x16x32_bf16 v[52:55], v[136:139], v[172:175], v[52:55]
    ds_read_b128 v[112:115], v246 offset:16384
    v_mfma_f32_16x16x32_bf16 v[52:55], v[132:135], v[176:179], v[52:55]
    ds_read2_b32 v[80:81], v238 offset0:96 offset1:97
    v_alignbit_b32 v212, v213, v212, 16
    v_mfma_f32_16x16x32_bf16 v[52:55], v[128:131], v[180:183], v[52:55]
    v_alignbit_b32 v213, v214, v213, 16
    v_mfma_f32_16x16x32_bf16 v[56:59], v[128:131], v[184:187], v[56:59]
    ds_read2_b32 v[82:83], v238 offset0:98 offset1:99
L_pl_X_2:
    s_cbranch_execz L_pl_X_6
    v_mfma_f32_16x16x32_bf16 v[56:59], v[132:135], v[180:183], v[56:59]
    ds_read_b128 v[116:119], v246 offset:20480
    s_add_u32 m0, s73, 49152
    v_alignbit_b32 v214, v215, v214, 16
    v_mfma_f32_16x16x32_bf16 v[56:59], v[136:139], v[176:179], v[56:59]
    buffer_load_dwordx4 v6, s[52:55], s14 offen offset:2048 lds
    v_mfma_f32_16x16x32_bf16 v[56:59], v[140:143], v[172:175], v[56:59]
    ds_read2_b32 v[84:85], v238 offset0:224 offset1:225
    v_alignbit_b32 v215, v216, v215, 16
    v_mfma_f32_16x16x32_bf16 v[56:59], v[144:147], v[168:171], v[56:59]
    ds_read2_b32 v[86:87], v238 offset0:226 offset1:227
    v_mfma_f32_16x16x32_bf16 v[56:59], v[148:151], v[164:167], v[56:59]
    ds_write_b128 v241, v[212:215] offset:12512
    v_mfma_f32_16x16x32_bf16 v[56:59], v[152:155], v[160:163], v[56:59]
    ds_read_b128 v[120:123], v246 offset:24576
    v_mfma_f32_16x16x32_bf16 v[60:63], v[156:159], v[160:163], v[60:63]
    ds_read2_b32 v[88:89], v239 offset0:96 offset1:97
    v_alignbit_b32 v218, v219, v218, 16
    v_mfma_f32_16x16x32_bf16 v[60:63], v[152:155], v[164:167], v[60:63]
    ds_read2_b32 v[90:91], v239 offset0:98 offset1:99
    s_add_u32 m0, s73, 49152
    v_alignbit_b32 v219, v220, v219, 16
    v_mfma_f32_16x16x32_bf16 v[60:63], v[148:151], v[168:171], v[60:63]
    buffer_load_dwordx4 v7, s[52:55], s14 offen offset:3072 lds
    v_mfma_f32_16x16x32_bf16 v[60:63], v[144:147], v[172:175], v[60:63]
    ds_read_b128 v[124:127], v246 offset:28672
    v_alignbit_b32 v220, v221, v220, 16
    v_mfma_f32_16x16x32_bf16 v[60:63], v[140:143], v[176:179], v[60:63]
    ds_read2_b32 v[92:93], v239 offset0:224 offset1:225
    v_mfma_f32_16x16x32_bf16 v[60:63], v[136:139], v[180:183], v[60:63]
    ds_read2_b32 v[94:95], v239 offset0:226 offset1:227
    v_alignbit_b32 v221, v222, v221, 16
    v_mfma_f32_16x16x32_bf16 v[60:63], v[132:135], v[184:187], v[60:63]
    ds_write_b128 v241, v[218:221] offset:13536
    v_mfma_f32_16x16x32_bf16 v[60:63], v[128:131], v[188:191], v[60:63]
    s_waitcnt lgkmcnt(15)
    v_mfma_f32_16x16x32_bf16 v[32:35], v[64:67], v[96:99], v[32:35]
    ds_read_b128 v[160:163], v247 offset:0
    v_mfma_f32_16x16x32_bf16 v[36:39], v[68:71], v[96:99], v[36:39]
    v_alignbit_b32 v224, v225, v224, 16
    v_mfma_f32_16x16x32_bf16 v[36:39], v[64:67], v[100:103], v[36:39]
    ds_read_b128 v[164:167], v247 offset:4096
    v_mfma_f32_16x16x32_bf16 v[40:43], v[64:67], v[104:107], v[40:43]
    ds_read_b128 v[168:171], v247 offset:8192
    v_mfma_f32_16x16x32_bf16 v[40:43], v[68:71], v[100:103], v[40:43]
    ds_read_b128 v[172:175], v247 offset:12288
    v_mfma_f32_16x16x32_bf16 v[40:43], v[72:75], v[96:99], v[40:43]
    v_alignbit_b32 v225, v226, v225, 16
    v_mfma_f32_16x16x32_bf16 v[44:47], v[76:79], v[96:99], v[44:47]
    ds_read_b128 v[176:179], v247 offset:16384
    v_mfma_f32_16x16x32_bf16 v[44:47], v[72:75], v[100:103], v[44:47]
    ds_read_b128 v[180:183], v247 offset:20480
    v_mfma_f32_16x16x32_bf16 v[44:47], v[68:71], v[104:107], v[44:47]
    ds_read_b128 v[184:187], v247 offset:24576
    v_mfma_f32_16x16x32_bf16 v[44:47], v[64:67], v[108:111], v[44:47]
    v_alignbit_b32 v226, v227, v226, 16
    s_waitcnt lgkmcnt(8)
    v_mfma_f32_16x16x32_bf16 v[48:51], v[64:67], v[112:115], v[48:51]
    ds_read_b128 v[188:191], v247 offset:28672
    v_mfma_f32_16x16x32_bf16 v[48:51], v[68:71], v[108:111], v[48:51]
    ds_read2_b32 v[128:129], v236 offset0:112 offset1:113
    v_mfma_f32_16x16x32_bf16 v[48:51], v[72:75], v[104:107], v[48:51]
    v_alignbit_b32 v227, v228, v227, 16
    v_mfma_f32_16x16x32_bf16 v[48:51], v[76:79], v[100:103], v[48:51]
    ds_read2_b32 v[130:131], v236 offset0:114 offset1:115
    v_mfma_f32_16x16x32_bf16 v[48:51], v[80:83], v[96:99], v[48:51]
    ds_read2_b32 v[132:133], v236 offset0:240 offset1:241
    v_mfma_f32_16x16x32_bf16 v[52:55], v[84:87], v[96:99], v[52:55]
    ds_read2_b32 v[134:135], v236 offset0:242 offset1:243
    v_mfma_f32_16x16x32_bf16 v[52:55], v[80:83], v[100:103], v[52:55]
    ds_write_b128 v241, v[224:227] offset:14560
    v_mfma_f32_16x16x32_bf16 v[52:55], v[76:79], v[104:107], v[52:55]
    ds_read2_b32 v[136:137], v237 offset0:112 offset1:113
    v_mfma_f32_16x16x32_bf16 v[52:55], v[72:75], v[108:111], v[52:55]
    s_add_u32 s6, s12, 4718592
    ds_read2_b32 v[138:139], v237 offset0:114 offset1:115
    v_mfma_f32_16x16x32_bf16 v[52:55], v[68:71], v[112:115], v[52:55]
    ds_read2_b32 v[140:141], v237 offset0:240 offset1:241
    v_alignbit_b32 v230, v231, v230, 16
    v_mfma_f32_16x16x32_bf16 v[52:55], v[64:67], v[116:119], v[52:55]
    ds_read2_b32 v[142:143], v237 offset0:242 offset1:243
    v_xor_b32 v244, 64, v244
    v_mfma_f32_16x16x32_bf16 v[56:59], v[64:67], v[120:123], v[56:59]
    ds_read2_b32 v[144:145], v238 offset0:112 offset1:113
    v_mfma_f32_16x16x32_bf16 v[56:59], v[68:71], v[116:119], v[56:59]
    ds_read2_b32 v[146:147], v238 offset0:114 offset1:115
    v_mfma_f32_16x16x32_bf16 v[56:59], v[72:75], v[112:115], v[56:59]
    ds_read2_b32 v[148:149], v238 offset0:240 offset1:241
    v_alignbit_b32 v231, v232, v231, 16
    v_mfma_f32_16x16x32_bf16 v[56:59], v[76:79], v[108:111], v[56:59]
    ds_read2_b32 v[150:151], v238 offset0:242 offset1:243
    v_xor_b32 v245, 64, v245
    v_mfma_f32_16x16x32_bf16 v[56:59], v[80:83], v[104:107], v[56:59]
    ds_read2_b32 v[152:153], v239 offset0:112 offset1:113
    v_mfma_f32_16x16x32_bf16 v[56:59], v[84:87], v[100:103], v[56:59]
    ds_read2_b32 v[154:155], v239 offset0:114 offset1:115
    v_mfma_f32_16x16x32_bf16 v[56:59], v[88:91], v[96:99], v[56:59]
    ds_read2_b32 v[156:157], v239 offset0:240 offset1:241
    v_alignbit_b32 v232, v233, v232, 16
    v_mfma_f32_16x16x32_bf16 v[60:63], v[92:95], v[96:99], v[60:63]
    ds_read2_b32 v[158:159], v239 offset0:242 offset1:243
    v_mfma_f32_16x16x32_bf16 v[60:63], v[88:91], v[100:103], v[60:63]
    v_xor_b32 v246, 64, v246
    v_add_u32 v236, 8320, v236
    v_mfma_f32_16x16x32_bf16 v[60:63], v[84:87], v[104:107], v[60:63]
    v_alignbit_b32 v233, v234, v233, 16
    v_mfma_f32_16x16x32_bf16 v[60:63], v[80:83], v[108:111], v[60:63]
    v_add_u32 v237, 8320, v237
    v_mfma_f32_16x16x32_bf16 v[60:63], v[76:79], v[112:115], v[60:63]
    v_mfma_f32_16x16x32_bf16 v[60:63], v[72:75], v[116:119], v[60:63]
    v_xor_b32 v247, 64, v247
    v_add_u32 v238, 8320, v238
    v_mfma_f32_16x16x32_bf16 v[60:63], v[68:71], v[120:123], v[60:63]
    ds_write_b128 v241, v[230:233] offset:15584
    v_mfma_f32_16x16x32_bf16 v[60:63], v[64:67], v[124:127], v[60:63]
    v_add_u32 v239, 8320, v239
    s_waitcnt lgkmcnt(1)
    v_mfma_f32_16x16x32_bf16 v[60:63], v[128:131], v[188:191], v[60:63]
    ds_read_b128 v[96:99], v244 offset:2048
    v_mfma_f32_16x16x32_bf16 v[60:63], v[132:135], v[184:187], v[60:63]
    ds_read2_b32 v[64:65], v236 offset0:0 offset1:1
    v_mfma_f32_16x16x32_bf16 v[60:63], v[136:139], v[180:183], v[60:63]
    ds_read2_b32 v[66:67], v236 offset0:2 offset1:3
    v_mfma_f32_16x16x32_bf16 v[60:63], v[140:143], v[176:179], v[60:63]
    ds_read_b128 v[100:103], v244 offset:6144
    v_mfma_f32_16x16x32_bf16 v[60:63], v[144:147], v[172:175], v[60:63]
    ds_read2_b32 v[68:69], v236 offset0:128 offset1:129
    v_mfma_f32_16x16x32_bf16 v[60:63], v[148:151], v[168:171], v[60:63]
    ds_read2_b32 v[70:71], v236 offset0:130 offset1:131
    v_mfma_f32_16x16x32_bf16 v[60:63], v[152:155], v[164:167], v[60:63]
    ds_read_b128 v[104:107], v244 offset:10240
    v_mfma_f32_16x16x32_bf16 v[60:63], v[156:159], v[160:163], v[60:63]
    s_waitcnt vmcnt(4)
    s_barrier
    s_add_u32 s13, s12, 32768
    v_mfma_f32_16x16x32_bf16 v[56:59], v[128:131], v[184:187], v[56:59]
    ds_read2_b32 v[72:73], v237 offset0:0 offset1:1
    v_add_u32 v10, 131072, v10
    v_mfma_f32_16x16x32_bf16 v[56:59], v[132:135], v[180:183], v[56:59]
    ds_read_b64_tr_b16 a[32:33], v10 offset:16384
    s_add_u32 m0, s74, 32
    v_mfma_f32_16x16x32_bf16 v[56:59], v[136:139], v[176:179], v[56:59]
    ds_read_b64_tr_b16 a[34:35], v10 offset:18432
    buffer_load_dwordx4 v240, s[48:51], s13 offen offset:0 lds
    ds_read2_b32 v[74:75], v237 offset0:2 offset1:3
    v_mfma_f32_16x16x32_bf16 v[56:59], v[140:143], v[172:175], v[56:59]
    ds_read_b64_tr_b16 a[40:41], v10 offset:20480
    ds_read_b128 v[108:111], v244 offset:14336
    v_mfma_f32_16x16x32_bf16 v[56:59], v[144:147], v[168:171], v[56:59]
    ds_read2_b32 v[76:77], v237 offset0:128 offset1:129
    v_mfma_f32_16x16x32_bf16 v[56:59], v[148:151], v[164:167], v[56:59]
    ds_read_b64_tr_b16 a[42:43], v10 offset:22528
    v_cvt_pk_bf16_f32 v206, v60, v61
    v_mfma_f32_16x16x32_bf16 v[56:59], v[152:155], v[160:163], v[56:59]
    ds_read2_b32 v[78:79], v237 offset0:130 offset1:131
    v_add_u32 v11, 131072, v11
    v_mfma_f32_16x16x32_bf16 v[52:55], v[128:131], v[180:183], v[52:55]
    ds_read_b64_tr_b16 a[36:37], v11 offset:16384
    ds_read_b128 v[112:115], v244 offset:18432
    v_mfma_f32_16x16x32_bf16 v[52:55], v[132:135], v[176:179], v[52:55]
    ds_read_b64_tr_b16 a[38:39], v11 offset:18432
    s_add_u32 m0, s74, 32
    v_cvt_pk_bf16_f32 v207, v62, v63
    v_mfma_f32_16x16x32_bf16 v[52:55], v[136:139], v[172:175], v[52:55]
    ds_read_b64_tr_b16 a[44:45], v11 offset:20480
    buffer_load_dwordx4 v240, s[48:51], s13 offen offset:1024 lds
    ds_read2_b32 v[80:81], v238 offset0:0 offset1:1
    v_mfma_f32_16x16x32_bf16 v[52:55], v[140:143], v[168:171], v[52:55]
    buffer_store_dwordx2 v[206:207], v8, s[44:47], s6 offen offset:3584 sc1
    ds_read_b64_tr_b16 a[46:47], v11 offset:22528
    v_mfma_f32_16x16x32_bf16 v[52:55], v[144:147], v[164:167], v[52:55]
    ds_read2_b32 v[82:83], v238 offset0:2 offset1:3
    v_mfma_f32_16x16x32_bf16 v[52:55], v[148:151], v[160:163], v[52:55]
    ds_read_b128 v[116:119], v244 offset:22528
    v_mfma_f32_16x16x32_bf16 v[48:51], v[128:131], v[176:179], v[48:51]
    ds_read2_b32 v[84:85], v238 offset0:128 offset1:129
    v_cvt_pk_bf16_f32 v204, v56, v57
    v_mfma_f32_16x16x32_bf16 v[48:51], v[132:135], v[172:175], v[48:51]
    ds_read2_b32 v[86:87], v238 offset0:130 offset1:131
    v_mfma_f32_16x16x32_bf16 v[48:51], v[136:139], v[168:171], v[48:51]
    ds_read_b128 v[120:123], v244 offset:26624
    v_mfma_f32_16x16x32_bf16 v[48:51], v[140:143], v[164:167], v[48:51]
    ds_read2_b32 v[88:89], v239 offset0:0 offset1:1
    s_add_u32 m0, s74, 32
    v_cvt_pk_bf16_f32 v205, v58, v59
    v_mfma_f32_16x16x32_bf16 v[48:51], v[144:147], v[160:163], v[48:51]
    buffer_load_dwordx4 v240, s[48:51], s13 offen offset:2048 lds
    ds_read2_b32 v[90:91], v239 offset0:2 offset1:3
    v_mfma_f32_16x16x32_bf16 v[44:47], v[128:131], v[172:175], v[44:47]
    buffer_store_dwordx2 v[204:205], v8, s[44:47], s6 offen offset:3072 sc1
    ds_read_b128 v[124:127], v244 offset:30720
    v_mfma_f32_16x16x32_bf16 v[44:47], v[132:135], v[168:171], v[44:47]
    ds_read2_b32 v[92:93], v239 offset0:128 offset1:129
    v_mfma_f32_16x16x32_bf16 v[44:47], v[136:139], v[164:167], v[44:47]
    ds_read2_b32 v[94:95], v239 offset0:130 offset1:131
    v_mfma_f32_16x16x32_bf16 v[44:47], v[140:143], v[160:163], v[44:47]
    v_cvt_pk_bf16_f32 v202, v52, v53
    v_mfma_f32_16x16x32_bf16 v[40:43], v[128:131], v[168:171], v[40:43]
    v_mfma_f32_16x16x32_bf16 v[40:43], v[132:135], v[164:167], v[40:43]
    v_mfma_f32_16x16x32_bf16 v[40:43], v[136:139], v[160:163], v[40:43]
    s_add_u32 m0, s74, 32
    v_cvt_pk_bf16_f32 v203, v54, v55
    v_mfma_f32_16x16x32_bf16 v[36:39], v[128:131], v[164:167], v[36:39]
    buffer_load_dwordx4 v240, s[48:51], s13 offen offset:3072 lds
    v_mfma_f32_16x16x32_bf16 v[36:39], v[132:135], v[160:163], v[36:39]
    buffer_store_dwordx2 v[202:203], v8, s[44:47], s6 offen offset:2560 sc1
    v_mfma_f32_16x16x32_bf16 v[32:35], v[128:131], v[160:163], v[32:35]
    s_waitcnt lgkmcnt(0)
    v_mfma_f32_16x16x32_bf16 v[60:63], v[64:67], v[124:127], 0
    ds_read_b128 v[160:163], v245 offset:2048
    v_mfma_f32_16x16x32_bf16 v[60:63], v[68:71], v[120:123], v[60:63]
    v_cvt_pk_bf16_f32 v200, v48, v49
    v_mfma_f32_16x16x32_bf16 v[60:63], v[72:75], v[116:119], v[60:63]
    ds_read2_b32 v[128:129], v236 offset0:16 offset1:17
    v_mfma_f32_16x16x32_bf16 v[60:63], v[76:79], v[112:115], v[60:63]
    ds_read2_b32 v[130:131], v236 offset0:18 offset1:19
    v_cvt_pk_bf16_f32 v201, v50, v51
    v_mfma_f32_16x16x32_bf16 v[60:63], v[80:83], v[108:111], v[60:63]
    v_mfma_f32_16x16x32_bf16 v[60:63], v[84:87], v[104:107], v[60:63]
    buffer_store_dwordx2 v[200:201], v8, s[44:47], s6 offen offset:2048 sc1
    ds_read_b128 v[164:167], v245 offset:6144
    v_mfma_f32_16x16x32_bf16 v[60:63], v[88:91], v[100:103], v[60:63]
    ds_read2_b32 v[132:133], v236 offset0:144 offset1:145
    v_mfma_f32_16x16x32_bf16 v[60:63], v[92:95], v[96:99], v[60:63]
    ds_read2_b32 v[134:135], v236 offset0:146 offset1:147
    v_cvt_pk_bf16_f32 v198, v44, v45
    v_mfma_f32_16x16x32_bf16 v[56:59], v[64:67], v[120:123], 0
    ds_read_b128 v[168:171], v245 offset:10240
    v_mfma_f32_16x16x32_bf16 v[56:59], v[68:71], v[116:119], v[56:59]
    ds_read2_b32 v[136:137], v237 offset0:16 offset1:17
    v_mfma_f32_16x16x32_bf16 v[56:59], v[72:75], v[112:115], v[56:59]
    ds_read2_b32 v[138:139], v237 offset0:18 offset1:19
    v_cvt_pk_bf16_f32 v199, v46, v47
    v_mfma_f32_16x16x32_bf16 v[56:59], v[76:79], v[108:111], v[56:59]
    ds_read_b128 v[172:175], v245 offset:14336
    v_mfma_f32_16x16x32_bf16 v[56:59], v[80:83], v[104:107], v[56:59]
    buffer_store_dwordx2 v[198:199], v8, s[44:47], s6 offen offset:1536 sc1
    ds_read2_b32 v[140:141], v237 offset0:144 offset1:145
    v_mfma_f32_16x16x32_bf16 v[56:59], v[84:87], v[100:103], v[56:59]
    ds_read2_b32 v[142:143], v237 offset0:146 offset1:147
    v_mfma_f32_16x16x32_bf16 v[56:59], v[88:91], v[96:99], v[56:59]
    ds_read_b128 v[176:179], v245 offset:18432
    v_cvt_pk_bf16_f32 v196, v40, v41
    v_mfma_f32_16x16x32_bf16 v[52:55], v[64:67], v[116:119], 0
    ds_read2_b32 v[144:145], v238 offset0:16 offset1:17
    v_mfma_f32_16x16x32_bf16 v[52:55], v[68:71], v[112:115], v[52:55]
    ds_read2_b32 v[146:147], v238 offset0:18 offset1:19
    v_cvt_pk_bf16_f32 v197, v42, v43
    v_mfma_f32_16x16x32_bf16 v[52:55], v[72:75], v[108:111], v[52:55]
    ds_read_b128 v[180:183], v245 offset:22528
    v_mfma_f32_16x16x32_bf16 v[52:55], v[76:79], v[104:107], v[52:55]
    buffer_store_dwordx2 v[196:197], v8, s[44:47], s6 offen offset:1024 sc1
    ds_read2_b32 v[148:149], v238 offset0:144 offset1:145
    v_mfma_f32_16x16x32_bf16 v[52:55], v[80:83], v[100:103], v[52:55]
    ds_read2_b32 v[150:151], v238 offset0:146 offset1:147
    v_mfma_f32_16x16x32_bf16 v[52:55], v[84:87], v[96:99], v[52:55]
    ds_read_b128 v[184:187], v245 offset:26624
    v_mfma_f32_16x16x32_bf16 v[48:51], v[64:67], v[112:115], 0
    s_waitcnt vmcnt(10)
    s_barrier
    v_cvt_pk_bf16_f32 v194, v36, v37
    v_mfma_f32_16x16x32_bf16 v[48:51], v[68:71], v[108:111], v[48:51]
    ds_read2_b32 v[152:153], v239 offset0:16 offset1:17
    v_add_u32 v10, -131072, v10
    v_mfma_f32_16x16x32_bf16 v[48:51], v[72:75], v[104:107], v[48:51]
    ds_read_b64_tr_b16 a[48:49], v10 offset:49152
    v_cvt_pk_bf16_f32 v195, v38, v39
    v_mfma_f32_16x16x32_bf16 v[48:51], v[76:79], v[100:103], v[48:51]
    buffer_store_dwordx2 v[194:195], v8, s[44:47], s6 offen offset:512 sc1
    ds_read2_b32 v[154:155], v239 offset0:18 offset1:19
    v_mfma_f32_16x16x32_bf16 v[48:51], v[80:83], v[96:99], v[48:51]
    ds_read_b64_tr_b16 a[50:51], v10 offset:51200
    v_mfma_f32_16x16x32_bf16 v[44:47], v[64:67], v[108:111], 0
    ds_read_b64_tr_b16 a[56:57], v10 offset:53248
    v_mfma_f32_16x16x32_bf16 v[44:47], v[68:71], v[104:107], v[44:47]
    ds_read_b64_tr_b16 a[58:59], v10 offset:55296
    v_cvt_pk_bf16_f32 v192, v32, v33
    v_mfma_f32_16x16x32_bf16 v[44:47], v[72:75], v[100:103], v[44:47]
    ds_read_b128 v[188:191], v245 offset:30720
    v_add_u32 v11, -131072, v11
    v_mfma_f32_16x16x32_bf16 v[44:47], v[76:79], v[96:99], v[44:47]
    ds_read_b64_tr_b16 a[52:53], v11 offset:49152
    v_cvt_pk_bf16_f32 v193, v34, v35
    v_mfma_f32_16x16x32_bf16 v[40:43], v[64:67], v[104:107], 0
    buffer_store_dwordx2 v[192:193], v8, s[44:47], s6 offen offset:0 sc1
    ds_read2_b32 v[156:157], v239 offset0:144 offset1:145
    v_mfma_f32_16x16x32_bf16 v[40:43], v[68:71], v[100:103], v[40:43]
    ds_read_b64_tr_b16 a[54:55], v11 offset:51200
    v_mfma_f32_16x16x32_bf16 v[40:43], v[72:75], v[96:99], v[40:43]
    ds_read_b64_tr_b16 a[60:61], v11 offset:53248
    v_mfma_f32_16x16x32_bf16 v[36:39], v[64:67], v[100:103], 0
    ds_read_b64_tr_b16 a[62:63], v11 offset:55296
    v_mfma_f32_16x16x32_bf16 v[36:39], v[68:71], v[96:99], v[36:39]
    ds_read2_b32 v[158:159], v239 offset0:146 offset1:147
    v_mfma_f32_16x16x32_bf16 v[32:35], v[64:67], v[96:99], 0
    s_waitcnt lgkmcnt(15)
    v_mfma_f32_16x16x32_bf16 v[32:35], v[128:131], v[160:163], v[32:35]
    ds_read_b128 v[96:99], v246 offset:2048
    v_mfma_f32_16x16x32_bf16 v[36:39], v[132:135], v[160:163], v[36:39]
    v_mfma_f32_16x16x32_bf16 v[36:39], v[128:131], v[164:167], v[36:39]
    ds_read2_b32 v[64:65], v236 offset0:32 offset1:33
    v_mfma_f32_16x16x32_bf16 v[40:43], v[128:131], v[168:171], v[40:43]
    ds_read2_b32 v[66:67], v236 offset0:34 offset1:35
    v_mfma_f32_16x16x32_bf16 v[40:43], v[132:135], v[164:167], v[40:43]
    v_mfma_f32_16x16x32_bf16 v[40:43], v[136:139], v[160:163], v[40:43]
    ds_read_b128 v[100:103], v246 offset:6144
    v_mfma_f32_16x16x32_bf16 v[44:47], v[140:143], v[160:163], v[44:47]
    ds_read2_b32 v[68:69], v236 offset0:160 offset1:161
    v_mfma_f32_16x16x32_bf16 v[44:47], v[136:139], v[164:167], v[44:47]
    v_mfma_f32_16x16x32_bf16 v[44:47], v[132:135], v[168:171], v[44:47]
    ds_read2_b32 v[70:71], v236 offset0:162 offset1:163
    v_mfma_f32_16x16x32_bf16 v[44:47], v[128:131], v[172:175], v[44:47]
    ds_read_b128 v[104:107], v246 offset:10240
    s_waitcnt lgkmcnt(7)
    v_mfma_f32_16x16x32_bf16 v[48:51], v[128:131], v[176:179], v[48:51]
    ds_read2_b32 v[72:73], v237 offset0:32 offset1:33
    v_mfma_f32_16x16x32_bf16 v[48:51], v[132:135], v[172:175], v[48:51]
    ds_read2_b32 v[74:75], v237 offset0:34 offset1:35
    v_mfma_f32_16x16x32_bf16 v[48:51], v[136:139], v[168:171], v[48:51]
    v_mov_b32 v9, 16
    buffer_load_ushort v9, v9, s[56:59], s70 offen
    v_mfma_f32_16x16x32_bf16 v[48:51], v[140:143], v[164:167], v[48:51]
    ds_read_b128 v[108:111], v246 offset:14336
    v_mfma_f32_16x16x32_bf16 v[48:51], v[144:147], v[160:163], v[48:51]
    v_mfma_f32_16x16x32_bf16 v[52:55], v[148:151], v[160:163], v[52:55]
    ds_read2_b32 v[76:77], v237 offset0:160 offset1:161
    v_mfma_f32_16x16x32_bf16 v[52:55], v[144:147], v[164:167], v[52:55]
    ds_read2_b32 v[78:79], v237 offset0:162 offset1:163
    v_mfma_f32_16x16x32_bf16 v[52:55], v[140:143], v[168:171], v[52:55]
    v_mfma_f32_16x16x32_bf16 v[52:55], v[136:139], v[172:175], v[52:55]
    s_lshl_b32 s14, s88, 18
    ds_read_b128 v[112:115], v246 offset:18432
    v_mfma_f32_16x16x32_bf16 v[52:55], v[132:135], v[176:179], v[52:55]
    s_add_u32 m0, s73, 147456
    ds_read2_b32 v[80:81], v238 offset0:32 offset1:33
    v_mfma_f32_16x16x32_bf16 v[52:55], v[128:131], v[180:183], v[52:55]
    buffer_load_dwordx4 v4, s[52:55], s14 offen offset:0 lds
    v_mfma_f32_16x16x32_bf16 v[56:59], v[128:131], v[184:187], v[56:59]
    ds_read2_b32 v[82:83], v238 offset0:34 offset1:35
    v_mfma_f32_16x16x32_bf16 v[56:59], v[132:135], v[180:183], v[56:59]
    ds_read_b128 v[116:119], v246 offset:22528
    v_mfma_f32_16x16x32_bf16 v[56:59], v[136:139], v[176:179], v[56:59]
    v_mfma_f32_16x16x32_bf16 v[56:59], v[140:143], v[172:175], v[56:59]
    ds_read2_b32 v[84:85], v238 offset0:160 offset1:161
    v_mfma_f32_16x16x32_bf16 v[56:59], v[144:147], v[168:171], v[56:59]
    ds_read2_b32 v[86:87], v238 offset0:162 offset1:163
    v_mfma_f32_16x16x32_bf16 v[56:59], v[148:151], v[164:167], v[56:59]
    s_add_u32 m0, s73, 147456
    ds_read_b128 v[120:123], v246 offset:26624
    v_mfma_f32_16x16x32_bf16 v[56:59], v[152:155], v[160:163], v[56:59]
    buffer_load_dwordx4 v5, s[52:55], s14 offen offset:1024 lds
    v_mfma_f32_16x16x32_bf16 v[60:63], v[156:159], v[160:163], v[60:63]
    ds_read2_b32 v[88:89], v239 offset0:32 offset1:33
    v_mfma_f32_16x16x32_bf16 v[60:63], v[152:155], v[164:167], v[60:63]
    ds_read2_b32 v[90:91], v239 offset0:34 offset1:35
    v_mfma_f32_16x16x32_bf16 v[60:63], v[148:151], v[168:171], v[60:63]
    v_mfma_f32_16x16x32_bf16 v[60:63], v[144:147], v[172:175], v[60:63]
    ds_read_b128 v[124:127], v246 offset:30720
    v_mfma_f32_16x16x32_bf16 v[60:63], v[140:143], v[176:179], v[60:63]
    ds_read2_b32 v[92:93], v239 offset0:160 offset1:161
    v_mfma_f32_16x16x32_bf16 v[60:63], v[136:139], v[180:183], v[60:63]
    s_add_u32 m0, s73, 147456
    v_mfma_f32_16x16x32_bf16 v[60:63], v[132:135], v[184:187], v[60:63]
    buffer_load_dwordx4 v6, s[52:55], s14 offen offset:2048 lds
    ds_read2_b32 v[94:95], v239 offset0:162 offset1:163
    v_mfma_f32_16x16x32_bf16 v[60:63], v[128:131], v[188:191], v[60:63]
    s_waitcnt lgkmcnt(12)
    v_mfma_f32_16x16x32_bf16 v[32:35], v[64:67], v[96:99], v[32:35]
    ds_read_b128 v[160:163], v247 offset:2048
    v_mfma_f32_16x16x32_bf16 v[36:39], v[68:71], v[96:99], v[36:39]
    v_mfma_f32_16x16x32_bf16 v[36:39], v[64:67], v[100:103], v[36:39]
    ds_read2_b32 v[128:129], v236 offset0:48 offset1:49
    v_mfma_f32_16x16x32_bf16 v[40:43], v[64:67], v[104:107], v[40:43]
    ds_read2_b32 v[130:131], v236 offset0:50 offset1:51
    v_mfma_f32_16x16x32_bf16 v[40:43], v[68:71], v[100:103], v[40:43]
    s_add_u32 m0, s73, 147456
    v_mfma_f32_16x16x32_bf16 v[40:43], v[72:75], v[96:99], v[40:43]
    buffer_load_dwordx4 v7, s[52:55], s14 offen offset:3072 lds
    ds_read_b128 v[164:167], v247 offset:6144
    v_mfma_f32_16x16x32_bf16 v[44:47], v[76:79], v[96:99], v[44:47]
    ds_read2_b32 v[132:133], v236 offset0:176 offset1:177
    v_mfma_f32_16x16x32_bf16 v[44:47], v[72:75], v[100:103], v[44:47]
    s_barrier
    v_mfma_f32_16x16x32_bf16 v[44:47], v[68:71], v[104:107], v[44:47]
    ds_read2_b32 v[134:135], v236 offset0:178 offset1:179
    v_mfma_f32_16x16x32_bf16 v[44:47], v[64:67], v[108:111], v[44:47]
    ds_read_b128 v[168:171], v247 offset:10240
    s_waitcnt lgkmcnt(7)
    v_mfma_f32_16x16x32_bf16 v[48:51], v[64:67], v[112:115], v[48:51]
    ds_read2_b32 v[136:137], v237 offset0:48 offset1:49
    v_mfma_f32_16x16x32_bf16 v[48:51], v[68:71], v[108:111], v[48:51]
    v_mfma_f32_16x16x32_bf16 v[48:51], v[72:75], v[104:107], v[48:51]
    ds_read2_b32 v[138:139], v237 offset0:50 offset1:51
    v_mfma_f32_16x16x32_bf16 v[48:51], v[76:79], v[100:103], v[48:51]
    ds_read_b128 v[172:175], v247 offset:14336
    v_mfma_f32_16x16x32_bf16 v[48:51], v[80:83], v[96:99], v[48:51]
    v_mfma_f32_16x16x32_bf16 v[52:55], v[84:87], v[96:99], v[52:55]
    ds_read2_b32 v[140:141], v237 offset0:176 offset1:177
    v_mfma_f32_16x16x32_bf16 v[52:55], v[80:83], v[100:103], v[52:55]
    ds_read2_b32 v[142:143], v237 offset0:178 offset1:179
    v_mfma_f32_16x16x32_bf16 v[52:55], v[76:79], v[104:107], v[52:55]
    v_mfma_f32_16x16x32_bf16 v[52:55], v[72:75], v[108:111], v[52:55]
    ds_read_b128 v[176:179], v247 offset:18432
    v_mfma_f32_16x16x32_bf16 v[52:55], v[68:71], v[112:115], v[52:55]
    ds_read2_b32 v[144:145], v238 offset0:48 offset1:49
    v_mfma_f32_16x16x32_bf16 v[52:55], v[64:67], v[116:119], v[52:55]
    v_mfma_f32_16x16x32_bf16 v[56:59], v[64:67], v[120:123], v[56:59]
    ds_read2_b32 v[146:147], v238 offset0:50 offset1:51
    v_mfma_f32_16x16x32_bf16 v[56:59], v[68:71], v[116:119], v[56:59]
    ds_read_b128 v[180:183], v247 offset:22528
    v_mfma_f32_16x16x32_bf16 v[56:59], v[72:75], v[112:115], v[56:59]
    v_mfma_f32_16x16x32_bf16 v[56:59], v[76:79], v[108:111], v[56:59]
    ds_read2_b32 v[148:149], v238 offset0:176 offset1:177
    v_mfma_f32_16x16x32_bf16 v[56:59], v[80:83], v[104:107], v[56:59]
    ds_read2_b32 v[150:151], v238 offset0:178 offset1:179
    v_mfma_f32_16x16x32_bf16 v[56:59], v[84:87], v[100:103], v[56:59]
    ds_read_b128 v[184:187], v247 offset:26624
    v_mfma_f32_16x16x32_bf16 v[56:59], v[88:91], v[96:99], v[56:59]
    v_mfma_f32_16x16x32_bf16 v[60:63], v[92:95], v[96:99], v[60:63]
    ds_read2_b32 v[152:153], v239 offset0:48 offset1:49
    v_mfma_f32_16x16x32_bf16 v[60:63], v[88:91], v[100:103], v[60:63]
    ds_read2_b32 v[154:155], v239 offset0:50 offset1:51
    v_mfma_f32_16x16x32_bf16 v[60:63], v[84:87], v[104:107], v[60:63]
    v_mfma_f32_16x16x32_bf16 v[60:63], v[80:83], v[108:111], v[60:63]
    ds_read_b128 v[188:191], v247 offset:30720
    v_mfma_f32_16x16x32_bf16 v[60:63], v[76:79], v[112:115], v[60:63]
    ds_read2_b32 v[156:157], v239 offset0:176 offset1:177
    v_mfma_f32_16x16x32_bf16 v[60:63], v[72:75], v[116:119], v[60:63]
    v_mfma_f32_16x16x32_bf16 v[60:63], v[68:71], v[120:123], v[60:63]
    ds_read2_b32 v[158:159], v239 offset0:178 offset1:179
    v_mfma_f32_16x16x32_bf16 v[60:63], v[64:67], v[124:127], v[60:63]
    s_waitcnt lgkmcnt(12)
    v_mfma_f32_16x16x32_bf16 v[32:35], v[128:131], v[160:163], v[32:35]
    ds_read_b128 v[96:99], v244 offset:0
    v_mfma_f32_16x16x32_bf16 v[36:39], v[132:135], v[160:163], v[36:39]
    v_mfma_f32_16x16x32_bf16 v[36:39], v[128:131], v[164:167], v[36:39]
    ds_read2_b32 v[64:65], v236 offset0:64 offset1:65
    v_mfma_f32_16x16x32_bf16 v[40:43], v[128:131], v[168:171], v[40:43]
    ds_read2_b32 v[66:67], v236 offset0:66 offset1:67
    v_mfma_f32_16x16x32_bf16 v[40:43], v[132:135], v[164:167], v[40:43]
    v_mfma_f32_16x16x32_bf16 v[40:43], v[136:139], v[160:163], v[40:43]
    ds_read_b128 v[100:103], v244 offset:4096
    v_mfma_f32_16x16x32_bf16 v[44:47], v[140:143], v[160:163], v[44:47]
    ds_read2_b32 v[68:69], v236 offset0:192 offset1:193
    v_mfma_f32_16x16x32_bf16 v[44:47], v[136:139], v[164:167], v[44:47]
    s_add_u32 m0, s9, 36864
    s_add_u32 s13, s11, 0
    v_mfma_f32_16x16x32_bf16 v[44:47], v[132:135], v[168:171], v[44:47]
    buffer_load_dwordx4 v15, s[44:47], s13 offen sc1 lds
    ds_read2_b32 v[70:71], v236 offset0:194 offset1:195
    v_mfma_f32_16x16x32_bf16 v[44:47], v[128:131], v[172:175], v[44:47]
    ds_read_b128 v[104:107], v244 offset:8192
    s_waitcnt lgkmcnt(7)
    v_mfma_f32_16x16x32_bf16 v[48:51], v[128:131], v[176:179], v[48:51]
    ds_read2_b32 v[72:73], v237 offset0:64 offset1:65
    v_mfma_f32_16x16x32_bf16 v[48:51], v[132:135], v[172:175], v[48:51]
    v_mfma_f32_16x16x32_bf16 v[48:51], v[136:139], v[168:171], v[48:51]
    ds_read2_b32 v[74:75], v237 offset0:66 offset1:67
    v_mfma_f32_16x16x32_bf16 v[48:51], v[140:143], v[164:167], v[48:51]
    ds_read_b128 v[108:111], v244 offset:12288
    v_mfma_f32_16x16x32_bf16 v[48:51], v[144:147], v[160:163], v[48:51]
    v_mfma_f32_16x16x32_bf16 v[52:55], v[148:151], v[160:163], v[52:55]
    ds_read2_b32 v[76:77], v237 offset0:192 offset1:193
    v_mfma_f32_16x16x32_bf16 v[52:55], v[144:147], v[164:167], v[52:55]
    ds_read2_b32 v[78:79], v237 offset0:194 offset1:195
    s_add_u32 m0, s9, 37888
    s_add_u32 s13, s11, 90112
    v_mfma_f32_16x16x32_bf16 v[52:55], v[140:143], v[168:171], v[52:55]
    buffer_load_dwordx4 v16, s[44:47], s13 offen sc1 lds
    v_mfma_f32_16x16x32_bf16 v[52:55], v[136:139], v[172:175], v[52:55]
    ds_read_b128 v[112:115], v244 offset:16384
    v_mfma_f32_16x16x32_bf16 v[52:55], v[132:135], v[176:179], v[52:55]
    ds_read2_b32 v[80:81], v238 offset0:64 offset1:65
    v_mfma_f32_16x16x32_bf16 v[52:55], v[128:131], v[180:183], v[52:55]
    v_mfma_f32_16x16x32_bf16 v[56:59], v[128:131], v[184:187], v[56:59]
    ds_read2_b32 v[82:83], v238 offset0:66 offset1:67
    v_mfma_f32_16x16x32_bf16 v[56:59], v[132:135], v[180:183], v[56:59]
    ds_read_b128 v[116:119], v244 offset:20480
    v_mfma_f32_16x16x32_bf16 v[56:59], v[136:139], v[176:179], v[56:59]
    v_mfma_f32_16x16x32_bf16 v[56:59], v[140:143], v[172:175], v[56:59]
    ds_read2_b32 v[84:85], v238 offset0:192 offset1:193
    v_mfma_f32_16x16x32_bf16 v[56:59], v[144:147], v[168:171], v[56:59]
    ds_read2_b32 v[86:87], v238 offset0:194 offset1:195
    s_add_u32 m0, s9, 38912
    s_add_u32 s13, s11, 180224
    v_mfma_f32_16x16x32_bf16 v[56:59], v[148:151], v[164:167], v[56:59]
    buffer_load_dwordx4 v15, s[44:47], s13 offen sc1 lds
    ds_read_b128 v[120:123], v244 offset:24576
    v_mfma_f32_16x16x32_bf16 v[56:59], v[152:155], v[160:163], v[56:59]
    v_mfma_f32_16x16x32_bf16 v[60:63], v[156:159], v[160:163], v[60:63]
    ds_read2_b32 v[88:89], v239 offset0:64 offset1:65
    v_mfma_f32_16x16x32_bf16 v[60:63], v[152:155], v[164:167], v[60:63]
    ds_read2_b32 v[90:91], v239 offset0:66 offset1:67
    v_mfma_f32_16x16x32_bf16 v[60:63], v[148:151], v[168:171], v[60:63]
    v_mfma_f32_16x16x32_bf16 v[60:63], v[144:147], v[172:175], v[60:63]
    ds_read_b128 v[124:127], v244 offset:28672
    v_mfma_f32_16x16x32_bf16 v[60:63], v[140:143], v[176:179], v[60:63]
    ds_read2_b32 v[92:93], v239 offset0:192 offset1:193
    v_mfma_f32_16x16x32_bf16 v[60:63], v[136:139], v[180:183], v[60:63]
    v_mfma_f32_16x16x32_bf16 v[60:63], v[132:135], v[184:187], v[60:63]
    ds_read2_b32 v[94:95], v239 offset0:194 offset1:195
    s_add_u32 m0, s9, 39936
    s_add_u32 s13, s11, 270336
    v_mfma_f32_16x16x32_bf16 v[60:63], v[128:131], v[188:191], v[60:63]
    buffer_load_dwordx4 v16, s[44:47], s13 offen sc1 lds
    s_waitcnt lgkmcnt(12)
    v_mfma_f32_16x16x32_bf16 v[32:35], v[64:67], v[96:99], v[32:35]
    ds_read_b128 v[160:163], v245 offset:0
    s_waitcnt vmcnt(4)
    s_barrier
    v_mfma_f32_16x16x32_bf16 v[36:39], v[68:71], v[96:99], v[36:39]
    ds_read2_b32 v[128:129], v236 offset0:80 offset1:81
    v_add_u32 v10, 131072, v10
    v_mfma_f32_16x16x32_bf16 v[36:39], v[64:67], v[100:103], v[36:39]
    ds_read_b64_tr_b16 a[64:65], v10 offset:16384
    v_mfma_f32_16x16x32_bf16 v[40:43], v[64:67], v[104:107], v[40:43]
    ds_read_b64_tr_b16 a[66:67], v10 offset:18432
    ds_read2_b32 v[130:131], v236 offset0:82 offset1:83
    v_mfma_f32_16x16x32_bf16 v[40:43], v[68:71], v[100:103], v[40:43]
    ds_read_b64_tr_b16 a[72:73], v10 offset:20480
    v_mfma_f32_16x16x32_bf16 v[40:43], v[72:75], v[96:99], v[40:43]
    ds_read_b64_tr_b16 a[74:75], v10 offset:22528
    ds_read_b128 v[164:167], v245 offset:4096
    v_mfma_f32_16x16x32_bf16 v[44:47], v[76:79], v[96:99], v[44:47]
    ds_read2_b32 v[132:133], v236 offset0:208 offset1:209
    v_mfma_f32_16x16x32_bf16 v[44:47], v[72:75], v[100:103], v[44:47]
L_pl_X_3:
    s_cbranch_execz L_pl_X_7
    v_add_u32 v11, 131072, v11
    s_add_u32 m0, s9, 40960
    s_add_u32 s13, s11, 360448
    v_mfma_f32_16x16x32_bf16 v[44:47], v[68:71], v[104:107], v[44:47]
    ds_read_b64_tr_b16 a[68:69], v11 offset:16384
    buffer_load_dwordx4 v15, s[44:47], s13 offen sc1 lds
    ds_read2_b32 v[134:135], v236 offset0:210 offset1:211
    v_mfma_f32_16x16x32_bf16 v[44:47], v[64:67], v[108:111], v[44:47]
    ds_read_b64_tr_b16 a[70:71], v11 offset:18432
    ds_read_b128 v[168:171], v245 offset:8192
    s_waitcnt lgkmcnt(13)
    v_mfma_f32_16x16x32_bf16 v[48:51], v[64:67], v[112:115], v[48:51]
    ds_read_b64_tr_b16 a[76:77], v11 offset:20480
    v_mfma_f32_16x16x32_bf16 v[48:51], v[68:71], v[108:111], v[48:51]
    ds_read_b64_tr_b16 a[78:79], v11 offset:22528
    v_mfma_f32_16x16x32_bf16 v[48:51], v[72:75], v[104:107], v[48:51]
    ds_read2_b32 v[136:137], v237 offset0:80 offset1:81
    v_mfma_f32_16x16x32_bf16 v[48:51], v[76:79], v[100:103], v[48:51]
    ds_read2_b32 v[138:139], v237 offset0:82 offset1:83
    v_mfma_f32_16x16x32_bf16 v[48:51], v[80:83], v[96:99], v[48:51]
    ds_read_b128 v[172:175], v245 offset:12288
    v_mfma_f32_16x16x32_bf16 v[52:55], v[84:87], v[96:99], v[52:55]
    ds_read2_b32 v[140:141], v237 offset0:208 offset1:209
    v_mfma_f32_16x16x32_bf16 v[52:55], v[80:83], v[100:103], v[52:55]
    ds_read2_b32 v[142:143], v237 offset0:210 offset1:211
    s_add_u32 m0, s9, 41984
    s_add_u32 s13, s11, 450560
    v_mfma_f32_16x16x32_bf16 v[52:55], v[76:79], v[104:107], v[52:55]
    buffer_load_dwordx4 v16, s[44:47], s13 offen sc1 lds
    ds_read_b128 v[176:179], v245 offset:16384
    v_mfma_f32_16x16x32_bf16 v[52:55], v[72:75], v[108:111], v[52:55]
    ds_read2_b32 v[144:145], v238 offset0:80 offset1:81
    v_mfma_f32_16x16x32_bf16 v[52:55], v[68:71], v[112:115], v[52:55]
    ds_read_b128 v[212:215], v241 offset:32
    v_mfma_f32_16x16x32_bf16 v[52:55], v[64:67], v[116:119], v[52:55]
    ds_read2_b32 v[146:147], v238 offset0:82 offset1:83
    v_mfma_f32_16x16x32_bf16 v[56:59], v[64:67], v[120:123], v[56:59]
    ds_read_b32 v216, v241 offset:48
    v_mfma_f32_16x16x32_bf16 v[56:59], v[68:71], v[116:119], v[56:59]
    ds_read_b128 v[180:183], v245 offset:20480
    v_mfma_f32_16x16x32_bf16 v[56:59], v[72:75], v[112:115], v[56:59]
    ds_read_b128 v[218:221], v241 offset:1056
    v_mfma_f32_16x16x32_bf16 v[56:59], v[76:79], v[108:111], v[56:59]
    ds_read2_b32 v[148:149], v238 offset0:208 offset1:209
    v_mfma_f32_16x16x32_bf16 v[56:59], v[80:83], v[104:107], v[56:59]
    ds_read2_b32 v[150:151], v238 offset0:210 offset1:211
    s_add_u32 m0, s9, 43008
    s_add_u32 s13, s11, 540672
    v_mfma_f32_16x16x32_bf16 v[56:59], v[84:87], v[100:103], v[56:59]
    buffer_load_dwordx4 v15, s[44:47], s13 offen sc1 lds
    ds_read_b32 v222, v241 offset:1072
    v_mfma_f32_16x16x32_bf16 v[56:59], v[88:91], v[96:99], v[56:59]
    ds_read_b128 v[184:187], v245 offset:24576
    v_mfma_f32_16x16x32_bf16 v[60:63], v[92:95], v[96:99], v[60:63]
    ds_read_b128 v[224:227], v241 offset:2080
    ds_read2_b32 v[152:153], v239 offset0:80 offset1:81
    v_mfma_f32_16x16x32_bf16 v[60:63], v[88:91], v[100:103], v[60:63]
    ds_read2_b32 v[154:155], v239 offset0:82 offset1:83
    v_mfma_f32_16x16x32_bf16 v[60:63], v[84:87], v[104:107], v[60:63]
    ds_read_b32 v228, v241 offset:2096
    v_mfma_f32_16x16x32_bf16 v[60:63], v[80:83], v[108:111], v[60:63]
    ds_read_b128 v[188:191], v245 offset:28672
    v_mfma_f32_16x16x32_bf16 v[60:63], v[76:79], v[112:115], v[60:63]
    ds_read_b128 v[230:233], v241 offset:3104
    ds_read2_b32 v[156:157], v239 offset0:208 offset1:209
    v_mfma_f32_16x16x32_bf16 v[60:63], v[72:75], v[116:119], v[60:63]
    ds_read2_b32 v[158:159], v239 offset0:210 offset1:211
    v_mfma_f32_16x16x32_bf16 v[60:63], v[68:71], v[120:123], v[60:63]
    ds_read_b32 v234, v241 offset:3120
    s_add_u32 m0, s9, 44032
    s_add_u32 s13, s11, 630784
    v_mfma_f32_16x16x32_bf16 v[60:63], v[64:67], v[124:127], v[60:63]
    buffer_load_dwordx4 v16, s[44:47], s13 offen sc1 lds
    s_waitcnt lgkmcnt(15)
    v_mfma_f32_16x16x32_bf16 v[32:35], v[128:131], v[160:163], v[32:35]
    ds_read_b128 v[96:99], v246 offset:0
    v_mfma_f32_16x16x32_bf16 v[36:39], v[132:135], v[160:163], v[36:39]
    v_mfma_f32_16x16x32_bf16 v[36:39], v[128:131], v[164:167], v[36:39]
    ds_read2_b32 v[64:65], v236 offset0:96 offset1:97
    v_mfma_f32_16x16x32_bf16 v[40:43], v[128:131], v[168:171], v[40:43]
    ds_read2_b32 v[66:67], v236 offset0:98 offset1:99
    v_mfma_f32_16x16x32_bf16 v[40:43], v[132:135], v[164:167], v[40:43]
    s_waitcnt lgkmcnt(3)
    v_mfma_f32_16x16x32_bf16 v[40:43], v[136:139], v[160:163], v[40:43]
    ds_read_b128 v[100:103], v246 offset:4096
    v_mfma_f32_16x16x32_bf16 v[44:47], v[140:143], v[160:163], v[44:47]
    ds_read2_b32 v[68:69], v236 offset0:224 offset1:225
    v_mfma_f32_16x16x32_bf16 v[44:47], v[136:139], v[164:167], v[44:47]
    v_mfma_f32_16x16x32_bf16 v[44:47], v[132:135], v[168:171], v[44:47]
    ds_read2_b32 v[70:71], v236 offset0:226 offset1:227
    v_lshlrev_b32 v9, 16, v9
    v_mfma_f32_16x16x32_bf16 v[44:47], v[128:131], v[172:175], v[44:47]
    ds_read_b128 v[104:107], v246 offset:8192
    v_mfma_f32_16x16x32_bf16 v[48:51], v[128:131], v[176:179], v[48:51]
    ds_read2_b32 v[72:73], v237 offset0:96 offset1:97
    v_lshlrev_b32 v208, 16, v212
    v_mfma_f32_16x16x32_bf16 v[48:51], v[132:135], v[172:175], v[48:51]
    v_mfma_f32_16x16x32_bf16 v[48:51], v[136:139], v[168:171], v[48:51]
    ds_read2_b32 v[74:75], v237 offset0:98 offset1:99
    v_add_f32 v9, v9, v208
    v_mfma_f32_16x16x32_bf16 v[48:51], v[140:143], v[164:167], v[48:51]
    ds_read_b128 v[108:111], v246 offset:12288
    v_cvt_pk_bf16_f32 v9, v9, v9
    v_mfma_f32_16x16x32_bf16 v[48:51], v[144:147], v[160:163], v[48:51]
    ds_read2_b32 v[76:77], v237 offset0:224 offset1:225
    s_barrier
    v_mfma_f32_16x16x32_bf16 v[52:55], v[148:151], v[160:163], v[52:55]
    ds_write_b16 v242, v9 offset:4160
    v_mfma_f32_16x16x32_bf16 v[52:55], v[144:147], v[164:167], v[52:55]
    ds_read2_b32 v[78:79], v237 offset0:226 offset1:227
    v_mfma_f32_16x16x32_bf16 v[52:55], v[140:143], v[168:171], v[52:55]
    ds_write_b16 v242, v9 offset:2
    v_mfma_f32_16x16x32_bf16 v[52:55], v[136:139], v[172:175], v[52:55]
    s_lshl_b32 s14, s89, 18
    ds_read_b128 v[112:115], v246 offset:16384
    v_mfma_f32_16x16x32_bf16 v[52:55], v[132:135], v[176:179], v[52:55]
    ds_read2_b32 v[80:81], v238 offset0:96 offset1:97
    s_add_u32 m0, s73, 147456
    v_alignbit_b32 v212, v213, v212, 16
    v_mfma_f32_16x16x32_bf16 v[52:55], v[128:131], v[180:183], v[52:55]
    buffer_load_dwordx4 v4, s[52:55], s14 offen offset:0 lds
    v_alignbit_b32 v213, v214, v213, 16
    v_mfma_f32_16x16x32_bf16 v[56:59], v[128:131], v[184:187], v[56:59]
    ds_read2_b32 v[82:83], v238 offset0:98 offset1:99
    v_mfma_f32_16x16x32_bf16 v[56:59], v[132:135], v[180:183], v[56:59]
    ds_read_b128 v[116:119], v246 offset:20480
    v_alignbit_b32 v214, v215, v214, 16
    v_mfma_f32_16x16x32_bf16 v[56:59], v[136:139], v[176:179], v[56:59]
    v_mfma_f32_16x16x32_bf16 v[56:59], v[140:143], v[172:175], v[56:59]
    ds_read2_b32 v[84:85], v238 offset0:224 offset1:225
    v_alignbit_b32 v215, v216, v215, 16
    v_mfma_f32_16x16x32_bf16 v[56:59], v[144:147], v[168:171], v[56:59]
    ds_write_b128 v241, v[212:215] offset:4192
    v_mfma_f32_16x16x32_bf16 v[56:59], v[148:151], v[164:167], v[56:59]
    s_add_u32 m0, s73, 147456
    ds_read2_b32 v[86:87], v238 offset0:226 offset1:227
    v_mfma_f32_16x16x32_bf16 v[56:59], v[152:155], v[160:163], v[56:59]
    buffer_load_dwordx4 v5, s[52:55], s14 offen offset:1024 lds
    ds_read_b128 v[120:123], v246 offset:24576
    v_mfma_f32_16x16x32_bf16 v[60:63], v[156:159], v[160:163], v[60:63]
    ds_read2_b32 v[88:89], v239 offset0:96 offset1:97
    v_alignbit_b32 v218, v219, v218, 16
    v_mfma_f32_16x16x32_bf16 v[60:63], v[152:155], v[164:167], v[60:63]
    ds_read2_b32 v[90:91], v239 offset0:98 offset1:99
    v_alignbit_b32 v219, v220, v219, 16
    v_mfma_f32_16x16x32_bf16 v[60:63], v[148:151], v[168:171], v[60:63]
    ds_read_b128 v[124:127], v246 offset:28672
    v_mfma_f32_16x16x32_bf16 v[60:63], v[144:147], v[172:175], v[60:63]
    v_alignbit_b32 v220, v221, v220, 16
    v_alignbit_b32 v221, v222, v221, 16
    v_mfma_f32_16x16x32_bf16 v[60:63], v[140:143], v[176:179], v[60:63]
    ds_write_b128 v241, v[218:221] offset:5216
    v_mfma_f32_16x16x32_bf16 v[60:63], v[136:139], v[180:183], v[60:63]
    s_add_u32 m0, s73, 147456
    ds_read2_b32 v[92:93], v239 offset0:224 offset1:225
    v_mfma_f32_16x16x32_bf16 v[60:63], v[132:135], v[184:187], v[60:63]
    buffer_load_dwordx4 v6, s[52:55], s14 offen offset:2048 lds
    ds_read2_b32 v[94:95], v239 offset0:226 offset1:227
    v_mfma_f32_16x16x32_bf16 v[60:63], v[128:131], v[188:191], v[60:63]
    s_waitcnt lgkmcnt(15)
    v_mfma_f32_16x16x32_bf16 v[32:35], v[64:67], v[96:99], v[32:35]
    ds_read_b128 v[160:163], v247 offset:0
    v_mfma_f32_16x16x32_bf16 v[36:39], v[68:71], v[96:99], v[36:39]
    v_alignbit_b32 v224, v225, v224, 16
    v_mfma_f32_16x16x32_bf16 v[36:39], v[64:67], v[100:103], v[36:39]
    ds_read_b128 v[164:167], v247 offset:4096
    v_mfma_f32_16x16x32_bf16 v[40:43], v[64:67], v[104:107], v[40:43]
    ds_read_b128 v[168:171], v247 offset:8192
    v_mfma_f32_16x16x32_bf16 v[40:43], v[68:71], v[100:103], v[40:43]
    s_add_u32 m0, s73, 147456
    ds_read_b128 v[172:175], v247 offset:12288
    v_mfma_f32_16x16x32_bf16 v[40:43], v[72:75], v[96:99], v[40:43]
    buffer_load_dwordx4 v7, s[52:55], s14 offen offset:3072 lds
    v_alignbit_b32 v225, v226, v225, 16
    v_mfma_f32_16x16x32_bf16 v[44:47], v[76:79], v[96:99], v[44:47]
    ds_read_b128 v[176:179], v247 offset:16384
    v_mfma_f32_16x16x32_bf16 v[44:47], v[72:75], v[100:103], v[44:47]
    ds_read_b128 v[180:183], v247 offset:20480
    v_mfma_f32_16x16x32_bf16 v[44:47], v[68:71], v[104:107], v[44:47]
    ds_read_b128 v[184:187], v247 offset:24576
    v_mfma_f32_16x16x32_bf16 v[44:47], v[64:67], v[108:111], v[44:47]
    v_alignbit_b32 v226, v227, v226, 16
    s_waitcnt lgkmcnt(7)
    v_mfma_f32_16x16x32_bf16 v[48:51], v[64:67], v[112:115], v[48:51]
    ds_read_b128 v[188:191], v247 offset:28672
    v_mfma_f32_16x16x32_bf16 v[48:51], v[68:71], v[108:111], v[48:51]
    ds_read2_b32 v[128:129], v236 offset0:112 offset1:113
    v_mfma_f32_16x16x32_bf16 v[48:51], v[72:75], v[104:107], v[48:51]
    v_alignbit_b32 v227, v228, v227, 16
    v_mfma_f32_16x16x32_bf16 v[48:51], v[76:79], v[100:103], v[48:51]
    ds_read2_b32 v[130:131], v236 offset0:114 offset1:115
    v_mfma_f32_16x16x32_bf16 v[48:51], v[80:83], v[96:99], v[48:51]
    ds_read2_b32 v[132:133], v236 offset0:240 offset1:241
    v_mfma_f32_16x16x32_bf16 v[52:55], v[84:87], v[96:99], v[52:55]
    ds_read2_b32 v[134:135], v236 offset0:242 offset1:243
    v_mfma_f32_16x16x32_bf16 v[52:55], v[80:83], v[100:103], v[52:55]
    ds_write_b128 v241, v[224:227] offset:6240
    v_mfma_f32_16x16x32_bf16 v[52:55], v[76:79], v[104:107], v[52:55]
    ds_read2_b32 v[136:137], v237 offset0:112 offset1:113
    ds_read2_b32 v[138:139], v237 offset0:114 offset1:115
    v_mfma_f32_16x16x32_bf16 v[52:55], v[72:75], v[108:111], v[52:55]
    s_add_u32 s6, s12, 4734976
    ds_read2_b32 v[140:141], v237 offset0:240 offset1:241
    v_mfma_f32_16x16x32_bf16 v[52:55], v[68:71], v[112:115], v[52:55]
    ds_read2_b32 v[142:143], v237 offset0:242 offset1:243
    v_alignbit_b32 v230, v231, v230, 16
    v_xor_b32 v244, 64, v244
    v_mfma_f32_16x16x32_bf16 v[52:55], v[64:67], v[116:119], v[52:55]
    ds_read2_b32 v[144:145], v238 offset0:112 offset1:113
    v_mfma_f32_16x16x32_bf16 v[56:59], v[64:67], v[120:123], v[56:59]
    ds_read2_b32 v[146:147], v238 offset0:114 offset1:115
    v_xor_b32 v245, 64, v245
    v_mfma_f32_16x16x32_bf16 v[56:59], v[68:71], v[116:119], v[56:59]
    ds_read2_b32 v[148:149], v238 offset0:240 offset1:241
    v_mfma_f32_16x16x32_bf16 v[56:59], v[72:75], v[112:115], v[56:59]
    v_alignbit_b32 v231, v232, v231, 16
    v_xor_b32 v246, 64, v246
    v_mfma_f32_16x16x32_bf16 v[56:59], v[76:79], v[108:111], v[56:59]
    ds_read2_b32 v[150:151], v238 offset0:242 offset1:243
    v_mfma_f32_16x16x32_bf16 v[56:59], v[80:83], v[104:107], v[56:59]
    ds_read2_b32 v[152:153], v239 offset0:112 offset1:113
    v_xor_b32 v247, 64, v247
    v_mfma_f32_16x16x32_bf16 v[56:59], v[84:87], v[100:103], v[56:59]
    ds_read2_b32 v[154:155], v239 offset0:114 offset1:115
    v_mfma_f32_16x16x32_bf16 v[56:59], v[88:91], v[96:99], v[56:59]
    ds_read2_b32 v[156:157], v239 offset0:240 offset1:241
    v_alignbit_b32 v232, v233, v232, 16
    v_mfma_f32_16x16x32_bf16 v[60:63], v[92:95], v[96:99], v[60:63]
    ds_read2_b32 v[158:159], v239 offset0:242 offset1:243
    v_add_u32 v244, 36864, v244
    v_mfma_f32_16x16x32_bf16 v[60:63], v[88:91], v[100:103], v[60:63]
    v_add_u32 v236, -8320, v236
    v_mfma_f32_16x16x32_bf16 v[60:63], v[84:87], v[104:107], v[60:63]
    v_alignbit_b32 v233, v234, v233, 16
    v_add_u32 v245, 36864, v245
    v_mfma_f32_16x16x32_bf16 v[60:63], v[80:83], v[108:111], v[60:63]
    v_add_u32 v237, -8320, v237
    v_mfma_f32_16x16x32_bf16 v[60:63], v[76:79], v[112:115], v[60:63]
    s_waitcnt vmcnt(4)
    s_barrier
    v_add_u32 v246, 36864, v246
    v_mfma_f32_16x16x32_bf16 v[60:63], v[72:75], v[116:119], v[60:63]
    v_add_u32 v238, -8320, v238
    v_add_u32 v239, -8320, v239
    v_mfma_f32_16x16x32_bf16 v[60:63], v[68:71], v[120:123], v[60:63]
    ds_write_b128 v241, v[230:233] offset:7264
    v_mfma_f32_16x16x32_bf16 v[60:63], v[64:67], v[124:127], v[60:63]
    v_add_u32 v247, 36864, v247
    s_waitcnt lgkmcnt(1)
    v_mfma_f32_16x16x32_bf16 v[60:63], v[128:131], v[188:191], v[60:63]
    ds_read_b128 v[96:99], v244 offset:2048
    v_mfma_f32_16x16x32_bf16 v[60:63], v[132:135], v[184:187], v[60:63]
    ds_read2_b32 v[64:65], v236 offset0:0 offset1:1
    v_mfma_f32_16x16x32_bf16 v[60:63], v[136:139], v[180:183], v[60:63]
    ds_read2_b32 v[66:67], v236 offset0:2 offset1:3
    v_mfma_f32_16x16x32_bf16 v[60:63], v[140:143], v[176:179], v[60:63]
    ds_read_b128 v[100:103], v244 offset:6144
    v_mfma_f32_16x16x32_bf16 v[60:63], v[144:147], v[172:175], v[60:63]
    ds_read2_b32 v[68:69], v236 offset0:128 offset1:129
    v_mfma_f32_16x16x32_bf16 v[60:63], v[148:151], v[168:171], v[60:63]
    ds_read2_b32 v[70:71], v236 offset0:130 offset1:131
    v_mfma_f32_16x16x32_bf16 v[60:63], v[152:155], v[164:167], v[60:63]
    ds_read_b128 v[104:107], v244 offset:10240
    v_mfma_f32_16x16x32_bf16 v[60:63], v[156:159], v[160:163], v[60:63]
    s_add_u32 s13, s12, 49152
    ds_read2_b32 v[72:73], v237 offset0:0 offset1:1
    v_mfma_f32_16x16x32_bf16 v[56:59], v[128:131], v[184:187], v[56:59]
    ds_read2_b32 v[74:75], v237 offset0:2 offset1:3
    v_mfma_f32_16x16x32_bf16 v[56:59], v[132:135], v[180:183], v[56:59]
    s_add_u32 m0, s74, 8352
    ds_read_b128 v[108:111], v244 offset:14336
    v_mfma_f32_16x16x32_bf16 v[56:59], v[136:139], v[176:179], v[56:59]
    buffer_load_dwordx4 v240, s[48:51], s13 offen offset:0 lds
    ds_read2_b32 v[76:77], v237 offset0:128 offset1:129
    v_mfma_f32_16x16x32_bf16 v[56:59], v[140:143], v[172:175], v[56:59]
    ds_read2_b32 v[78:79], v237 offset0:130 offset1:131
    v_mfma_f32_16x16x32_bf16 v[56:59], v[144:147], v[168:171], v[56:59]
    ds_read_b128 v[112:115], v244 offset:18432
    v_mfma_f32_16x16x32_bf16 v[56:59], v[148:151], v[164:167], v[56:59]
    ds_read2_b32 v[80:81], v238 offset0:0 offset1:1
    v_cvt_pk_bf16_f32 v206, v60, v61
    v_mfma_f32_16x16x32_bf16 v[56:59], v[152:155], v[160:163], v[56:59]
    ds_read2_b32 v[82:83], v238 offset0:2 offset1:3
    v_mfma_f32_16x16x32_bf16 v[52:55], v[128:131], v[180:183], v[52:55]
    ds_read_b128 v[116:119], v244 offset:22528
    v_mfma_f32_16x16x32_bf16 v[52:55], v[132:135], v[176:179], v[52:55]
    ds_read2_b32 v[84:85], v238 offset0:128 offset1:129
    s_add_u32 m0, s74, 8352
    v_cvt_pk_bf16_f32 v207, v62, v63
    v_mfma_f32_16x16x32_bf16 v[52:55], v[136:139], v[172:175], v[52:55]
    buffer_load_dwordx4 v240, s[48:51], s13 offen offset:1024 lds
    ds_read2_b32 v[86:87], v238 offset0:130 offset1:131
    v_mfma_f32_16x16x32_bf16 v[52:55], v[140:143], v[168:171], v[52:55]
    buffer_store_dwordx2 v[206:207], v8, s[44:47], s6 offen offset:3584 sc1
    ds_read_b128 v[120:123], v244 offset:26624
    v_mfma_f32_16x16x32_bf16 v[52:55], v[144:147], v[164:167], v[52:55]
    ds_read2_b32 v[88:89], v239 offset0:0 offset1:1
    v_mfma_f32_16x16x32_bf16 v[52:55], v[148:151], v[160:163], v[52:55]
    ds_read2_b32 v[90:91], v239 offset0:2 offset1:3
    v_mfma_f32_16x16x32_bf16 v[48:51], v[128:131], v[176:179], v[48:51]
    s_waitcnt vmcnt(3)
    s_barrier
    v_cvt_pk_bf16_f32 v204, v56, v57
    v_mfma_f32_16x16x32_bf16 v[48:51], v[132:135], v[172:175], v[48:51]
    ds_read_b128 v[124:127], v244 offset:30720
    v_mfma_f32_16x16x32_bf16 v[48:51], v[136:139], v[168:171], v[48:51]
    ds_read_b64_tr_b16 a[80:81], v10 offset:16384
    v_mfma_f32_16x16x32_bf16 v[48:51], v[140:143], v[164:167], v[48:51]
    ds_read_b64_tr_b16 a[82:83], v10 offset:18432
    s_add_u32 m0, s74, 8352
    v_cvt_pk_bf16_f32 v205, v58, v59
    v_mfma_f32_16x16x32_bf16 v[48:51], v[144:147], v[160:163], v[48:51]
    ds_read_b64_tr_b16 a[88:89], v10 offset:20480
    buffer_load_dwordx4 v240, s[48:51], s13 offen offset:2048 lds
    v_mfma_f32_16x16x32_bf16 v[44:47], v[128:131], v[172:175], v[44:47]
    buffer_store_dwordx2 v[204:205], v8, s[44:47], s6 offen offset:3072 sc1
    ds_read2_b32 v[92:93], v239 offset0:128 offset1:129
    v_mfma_f32_16x16x32_bf16 v[44:47], v[132:135], v[168:171], v[44:47]
    ds_read_b64_tr_b16 a[90:91], v10 offset:22528
    v_mfma_f32_16x16x32_bf16 v[44:47], v[136:139], v[164:167], v[44:47]
    ds_read_b64_tr_b16 a[84:85], v11 offset:16384
    ds_read2_b32 v[94:95], v239 offset0:130 offset1:131
    v_mfma_f32_16x16x32_bf16 v[44:47], v[140:143], v[160:163], v[44:47]
    v_cvt_pk_bf16_f32 v202, v52, v53
    v_mfma_f32_16x16x32_bf16 v[40:43], v[128:131], v[168:171], v[40:43]
    ds_read_b64_tr_b16 a[86:87], v11 offset:18432
    v_mfma_f32_16x16x32_bf16 v[40:43], v[132:135], v[164:167], v[40:43]
    ds_read_b64_tr_b16 a[92:93], v11 offset:20480
    v_mfma_f32_16x16x32_bf16 v[40:43], v[136:139], v[160:163], v[40:43]
    s_add_u32 m0, s74, 8352
    v_cvt_pk_bf16_f32 v203, v54, v55
    v_mfma_f32_16x16x32_bf16 v[36:39], v[128:131], v[164:167], v[36:39]
    ds_read_b64_tr_b16 a[94:95], v11 offset:22528
    buffer_load_dwordx4 v240, s[48:51], s13 offen offset:3072 lds
    v_mfma_f32_16x16x32_bf16 v[36:39], v[132:135], v[160:163], v[36:39]
    buffer_store_dwordx2 v[202:203], v8, s[44:47], s6 offen offset:2560 sc1
    v_mfma_f32_16x16x32_bf16 v[32:35], v[128:131], v[160:163], v[32:35]
    s_waitcnt lgkmcnt(3)
    v_mfma_f32_16x16x32_bf16 v[60:63], v[64:67], v[124:127], 0
    ds_read_b128 v[160:163], v245 offset:2048
    v_mfma_f32_16x16x32_bf16 v[60:63], v[68:71], v[120:123], v[60:63]
    v_cvt_pk_bf16_f32 v200, v48, v49
    v_mfma_f32_16x16x32_bf16 v[60:63], v[72:75], v[116:119], v[60:63]
    ds_read2_b32 v[128:129], v236 offset0:16 offset1:17
    v_mfma_f32_16x16x32_bf16 v[60:63], v[76:79], v[112:115], v[60:63]
    ds_read2_b32 v[130:131], v236 offset0:18 offset1:19
    v_cvt_pk_bf16_f32 v201, v50, v51
    v_mfma_f32_16x16x32_bf16 v[60:63], v[80:83], v[108:111], v[60:63]
    v_mfma_f32_16x16x32_bf16 v[60:63], v[84:87], v[104:107], v[60:63]
    buffer_store_dwordx2 v[200:201], v8, s[44:47], s6 offen offset:2048 sc1
    ds_read_b128 v[164:167], v245 offset:6144
    v_mfma_f32_16x16x32_bf16 v[60:63], v[88:91], v[100:103], v[60:63]
    ds_read2_b32 v[132:133], v236 offset0:144 offset1:145
    v_mfma_f32_16x16x32_bf16 v[60:63], v[92:95], v[96:99], v[60:63]
    v_cvt_pk_bf16_f32 v198, v44, v45
    v_mfma_f32_16x16x32_bf16 v[56:59], v[64:67], v[120:123], 0
    ds_read2_b32 v[134:135], v236 offset0:146 offset1:147
    v_mfma_f32_16x16x32_bf16 v[56:59], v[68:71], v[116:119], v[56:59]
    ds_read_b128 v[168:171], v245 offset:10240
    v_mfma_f32_16x16x32_bf16 v[56:59], v[72:75], v[112:115], v[56:59]
    ds_read2_b32 v[136:137], v237 offset0:16 offset1:17
    v_cvt_pk_bf16_f32 v199, v46, v47
    v_mfma_f32_16x16x32_bf16 v[56:59], v[76:79], v[108:111], v[56:59]
    v_mfma_f32_16x16x32_bf16 v[56:59], v[80:83], v[104:107], v[56:59]
    buffer_store_dwordx2 v[198:199], v8, s[44:47], s6 offen offset:1536 sc1
    ds_read2_b32 v[138:139], v237 offset0:18 offset1:19
    v_mfma_f32_16x16x32_bf16 v[56:59], v[84:87], v[100:103], v[56:59]
    ds_read_b128 v[172:175], v245 offset:14336
    v_mfma_f32_16x16x32_bf16 v[56:59], v[88:91], v[96:99], v[56:59]
    v_cvt_pk_bf16_f32 v196, v40, v41
    v_mfma_f32_16x16x32_bf16 v[52:55], v[64:67], v[116:119], 0
    ds_read2_b32 v[140:141], v237 offset0:144 offset1:145
    v_mfma_f32_16x16x32_bf16 v[52:55], v[68:71], v[112:115], v[52:55]
    ds_read2_b32 v[142:143], v237 offset0:146 offset1:147
    v_cvt_pk_bf16_f32 v197, v42, v43
    v_mfma_f32_16x16x32_bf16 v[52:55], v[72:75], v[108:111], v[52:55]
    v_mfma_f32_16x16x32_bf16 v[52:55], v[76:79], v[104:107], v[52:55]
    buffer_store_dwordx2 v[196:197], v8, s[44:47], s6 offen offset:1024 sc1
    ds_read_b128 v[176:179], v245 offset:18432
    v_mfma_f32_16x16x32_bf16 v[52:55], v[80:83], v[100:103], v[52:55]
    ds_read2_b32 v[144:145], v238 offset0:16 offset1:17
    v_mfma_f32_16x16x32_bf16 v[52:55], v[84:87], v[96:99], v[52:55]
    v_mfma_f32_16x16x32_bf16 v[48:51], v[64:67], v[112:115], 0
    ds_read2_b32 v[146:147], v238 offset0:18 offset1:19
    v_cvt_pk_bf16_f32 v194, v36, v37
    v_mfma_f32_16x16x32_bf16 v[48:51], v[68:71], v[108:111], v[48:51]
    ds_read_b128 v[180:183], v245 offset:22528
    v_mfma_f32_16x16x32_bf16 v[48:51], v[72:75], v[104:107], v[48:51]
    v_cvt_pk_bf16_f32 v195, v38, v39
    v_mfma_f32_16x16x32_bf16 v[48:51], v[76:79], v[100:103], v[48:51]
    ds_read2_b32 v[148:149], v238 offset0:144 offset1:145
    v_mfma_f32_16x16x32_bf16 v[48:51], v[80:83], v[96:99], v[48:51]
    buffer_store_dwordx2 v[194:195], v8, s[44:47], s6 offen offset:512 sc1
    ds_read2_b32 v[150:151], v238 offset0:146 offset1:147
    v_mfma_f32_16x16x32_bf16 v[44:47], v[64:67], v[108:111], 0
    ds_read_b128 v[184:187], v245 offset:26624
    v_mfma_f32_16x16x32_bf16 v[44:47], v[68:71], v[104:107], v[44:47]
    v_cvt_pk_bf16_f32 v192, v32, v33
    v_mfma_f32_16x16x32_bf16 v[44:47], v[72:75], v[100:103], v[44:47]
    ds_read2_b32 v[152:153], v239 offset0:16 offset1:17
    v_mfma_f32_16x16x32_bf16 v[44:47], v[76:79], v[96:99], v[44:47]
    ds_read2_b32 v[154:155], v239 offset0:18 offset1:19
    v_cvt_pk_bf16_f32 v193, v34, v35
    v_mfma_f32_16x16x32_bf16 v[40:43], v[64:67], v[104:107], 0
    v_mfma_f32_16x16x32_bf16 v[40:43], v[68:71], v[100:103], v[40:43]
    buffer_store_dwordx2 v[192:193], v8, s[44:47], s6 offen offset:0 sc1
    ds_read_b128 v[188:191], v245 offset:30720
    v_mfma_f32_16x16x32_bf16 v[40:43], v[72:75], v[96:99], v[40:43]
    ds_read2_b32 v[156:157], v239 offset0:144 offset1:145
    v_mfma_f32_16x16x32_bf16 v[36:39], v[64:67], v[100:103], 0
    v_mfma_f32_16x16x32_bf16 v[36:39], v[68:71], v[96:99], v[36:39]
    ds_read2_b32 v[158:159], v239 offset0:146 offset1:147
    v_mfma_f32_16x16x32_bf16 v[32:35], v[64:67], v[96:99], 0
    s_waitcnt lgkmcnt(12)
    v_mfma_f32_16x16x32_bf16 v[32:35], v[128:131], v[160:163], v[32:35]
    ds_read_b128 v[96:99], v246 offset:2048
    v_mfma_f32_16x16x32_bf16 v[36:39], v[132:135], v[160:163], v[36:39]
    v_mfma_f32_16x16x32_bf16 v[36:39], v[128:131], v[164:167], v[36:39]
    ds_read2_b32 v[64:65], v236 offset0:32 offset1:33
    v_mfma_f32_16x16x32_bf16 v[40:43], v[128:131], v[168:171], v[40:43]
    ds_read2_b32 v[66:67], v236 offset0:34 offset1:35
    s_barrier
    v_mfma_f32_16x16x32_bf16 v[40:43], v[132:135], v[164:167], v[40:43]
    v_mfma_f32_16x16x32_bf16 v[40:43], v[136:139], v[160:163], v[40:43]
    ds_read_b128 v[100:103], v246 offset:6144
    v_mfma_f32_16x16x32_bf16 v[44:47], v[140:143], v[160:163], v[44:47]
    ds_read2_b32 v[68:69], v236 offset0:160 offset1:161
    v_mfma_f32_16x16x32_bf16 v[44:47], v[136:139], v[164:167], v[44:47]
    v_mfma_f32_16x16x32_bf16 v[44:47], v[132:135], v[168:171], v[44:47]
    ds_read2_b32 v[70:71], v236 offset0:162 offset1:163
    v_mfma_f32_16x16x32_bf16 v[44:47], v[128:131], v[172:175], v[44:47]
    ds_read_b128 v[104:107], v246 offset:10240
    s_waitcnt lgkmcnt(7)
    v_mfma_f32_16x16x32_bf16 v[48:51], v[128:131], v[176:179], v[48:51]
    ds_read2_b32 v[72:73], v237 offset0:32 offset1:33
    v_mfma_f32_16x16x32_bf16 v[48:51], v[132:135], v[172:175], v[48:51]
    ds_read2_b32 v[74:75], v237 offset0:34 offset1:35
    v_mfma_f32_16x16x32_bf16 v[48:51], v[136:139], v[168:171], v[48:51]
    v_mov_b32 v9, 24
    buffer_load_ushort v9, v9, s[56:59], s70 offen
    v_mfma_f32_16x16x32_bf16 v[48:51], v[140:143], v[164:167], v[48:51]
    ds_read_b128 v[108:111], v246 offset:14336
    v_mfma_f32_16x16x32_bf16 v[48:51], v[144:147], v[160:163], v[48:51]
    s_lshl_b32 s14, s90, 18
    v_mfma_f32_16x16x32_bf16 v[52:55], v[148:151], v[160:163], v[52:55]
    s_add_u32 m0, s73, 147456
    ds_read2_b32 v[76:77], v237 offset0:160 offset1:161
    v_mfma_f32_16x16x32_bf16 v[52:55], v[144:147], v[164:167], v[52:55]
    buffer_load_dwordx4 v4, s[52:55], s14 offen offset:0 lds
    ds_read2_b32 v[78:79], v237 offset0:162 offset1:163
    v_mfma_f32_16x16x32_bf16 v[52:55], v[140:143], v[168:171], v[52:55]
    v_mfma_f32_16x16x32_bf16 v[52:55], v[136:139], v[172:175], v[52:55]
    ds_read_b128 v[112:115], v246 offset:18432
    v_mfma_f32_16x16x32_bf16 v[52:55], v[132:135], v[176:179], v[52:55]
    ds_read2_b32 v[80:81], v238 offset0:32 offset1:33
    v_mfma_f32_16x16x32_bf16 v[52:55], v[128:131], v[180:183], v[52:55]
    v_mfma_f32_16x16x32_bf16 v[56:59], v[128:131], v[184:187], v[56:59]
    ds_read2_b32 v[82:83], v238 offset0:34 offset1:35
    v_mfma_f32_16x16x32_bf16 v[56:59], v[132:135], v[180:183], v[56:59]
    s_add_u32 m0, s73, 147456
    ds_read_b128 v[116:119], v246 offset:22528
    v_mfma_f32_16x16x32_bf16 v[56:59], v[136:139], v[176:179], v[56:59]
    buffer_load_dwordx4 v5, s[52:55], s14 offen offset:1024 lds
    v_mfma_f32_16x16x32_bf16 v[56:59], v[140:143], v[172:175], v[56:59]
    ds_read2_b32 v[84:85], v238 offset0:160 offset1:161
    v_mfma_f32_16x16x32_bf16 v[56:59], v[144:147], v[168:171], v[56:59]
    ds_read2_b32 v[86:87], v238 offset0:162 offset1:163
    v_mfma_f32_16x16x32_bf16 v[56:59], v[148:151], v[164:167], v[56:59]
    ds_read_b128 v[120:123], v246 offset:26624
    v_mfma_f32_16x16x32_bf16 v[56:59], v[152:155], v[160:163], v[56:59]
    v_mfma_f32_16x16x32_bf16 v[60:63], v[156:159], v[160:163], v[60:63]
    ds_read2_b32 v[88:89], v239 offset0:32 offset1:33
    v_mfma_f32_16x16x32_bf16 v[60:63], v[152:155], v[164:167], v[60:63]
    s_add_u32 m0, s73, 147456
    ds_read2_b32 v[90:91], v239 offset0:34 offset1:35
    v_mfma_f32_16x16x32_bf16 v[60:63], v[148:151], v[168:171], v[60:63]
    buffer_load_dwordx4 v6, s[52:55], s14 offen offset:2048 lds
    v_mfma_f32_16x16x32_bf16 v[60:63], v[144:147], v[172:175], v[60:63]
    ds_read_b128 v[124:127], v246 offset:30720
    v_mfma_f32_16x16x32_bf16 v[60:63], v[140:143], v[176:179], v[60:63]
    ds_read2_b32 v[92:93], v239 offset0:160 offset1:161
    v_mfma_f32_16x16x32_bf16 v[60:63], v[136:139], v[180:183], v[60:63]
    v_mfma_f32_16x16x32_bf16 v[60:63], v[132:135], v[184:187], v[60:63]
    ds_read2_b32 v[94:95], v239 offset0:162 offset1:163
    v_mfma_f32_16x16x32_bf16 v[60:63], v[128:131], v[188:191], v[60:63]
    s_waitcnt lgkmcnt(12)
    v_mfma_f32_16x16x32_bf16 v[32:35], v[64:67], v[96:99], v[32:35]
    ds_read_b128 v[160:163], v247 offset:2048
    v_mfma_f32_16x16x32_bf16 v[36:39], v[68:71], v[96:99], v[36:39]
    s_add_u32 m0, s73, 147456
    v_mfma_f32_16x16x32_bf16 v[36:39], v[64:67], v[100:103], v[36:39]
    buffer_load_dwordx4 v7, s[52:55], s14 offen offset:3072 lds
    ds_read2_b32 v[128:129], v236 offset0:48 offset1:49
    v_mfma_f32_16x16x32_bf16 v[40:43], v[64:67], v[104:107], v[40:43]
    ds_read2_b32 v[130:131], v236 offset0:50 offset1:51
    v_mfma_f32_16x16x32_bf16 v[40:43], v[68:71], v[100:103], v[40:43]
    v_mfma_f32_16x16x32_bf16 v[40:43], v[72:75], v[96:99], v[40:43]
    ds_read_b128 v[164:167], v247 offset:6144
    v_mfma_f32_16x16x32_bf16 v[44:47], v[76:79], v[96:99], v[44:47]
    ds_read2_b32 v[132:133], v236 offset0:176 offset1:177
    v_mfma_f32_16x16x32_bf16 v[44:47], v[72:75], v[100:103], v[44:47]
    v_mfma_f32_16x16x32_bf16 v[44:47], v[68:71], v[104:107], v[44:47]
    ds_read2_b32 v[134:135], v236 offset0:178 offset1:179
    v_mfma_f32_16x16x32_bf16 v[44:47], v[64:67], v[108:111], v[44:47]
    ds_read_b128 v[168:171], v247 offset:10240
    s_waitcnt lgkmcnt(7)
    v_mfma_f32_16x16x32_bf16 v[48:51], v[64:67], v[112:115], v[48:51]
    ds_read2_b32 v[136:137], v237 offset0:48 offset1:49
    v_mfma_f32_16x16x32_bf16 v[48:51], v[68:71], v[108:111], v[48:51]
    v_mfma_f32_16x16x32_bf16 v[48:51], v[72:75], v[104:107], v[48:51]
    ds_read2_b32 v[138:139], v237 offset0:50 offset1:51
    v_mfma_f32_16x16x32_bf16 v[48:51], v[76:79], v[100:103], v[48:51]
    ds_read_b128 v[172:175], v247 offset:14336
    v_mfma_f32_16x16x32_bf16 v[48:51], v[80:83], v[96:99], v[48:51]
    v_mfma_f32_16x16x32_bf16 v[52:55], v[84:87], v[96:99], v[52:55]
    ds_read2_b32 v[140:141], v237 offset0:176 offset1:177
    v_mfma_f32_16x16x32_bf16 v[52:55], v[80:83], v[100:103], v[52:55]
    ds_read2_b32 v[142:143], v237 offset0:178 offset1:179
    v_mfma_f32_16x16x32_bf16 v[52:55], v[76:79], v[104:107], v[52:55]
    v_mfma_f32_16x16x32_bf16 v[52:55], v[72:75], v[108:111], v[52:55]
    ds_read_b128 v[176:179], v247 offset:18432
    v_mfma_f32_16x16x32_bf16 v[52:55], v[68:71], v[112:115], v[52:55]
    ds_read2_b32 v[144:145], v238 offset0:48 offset1:49
    v_mfma_f32_16x16x32_bf16 v[52:55], v[64:67], v[116:119], v[52:55]
    v_mfma_f32_16x16x32_bf16 v[56:59], v[64:67], v[120:123], v[56:59]
L_pl_X_4:
    s_cbranch_execz L_wret
    s_lshl_b32 s14, s91, 18
    ds_read2_b32 v[146:147], v238 offset0:50 offset1:51
    v_mfma_f32_16x16x32_bf16 v[56:59], v[68:71], v[116:119], v[56:59]
    s_add_u32 m0, s73, 0
    ds_read_b128 v[180:183], v247 offset:22528
    v_mfma_f32_16x16x32_bf16 v[56:59], v[72:75], v[112:115], v[56:59]
    buffer_load_dwordx4 v4, s[52:55], s14 offen offset:0 lds
    v_mfma_f32_16x16x32_bf16 v[56:59], v[76:79], v[108:111], v[56:59]
    ds_read2_b32 v[148:149], v238 offset0:176 offset1:177
    v_mfma_f32_16x16x32_bf16 v[56:59], v[80:83], v[104:107], v[56:59]
    ds_read2_b32 v[150:151], v238 offset0:178 offset1:179
    v_mfma_f32_16x16x32_bf16 v[56:59], v[84:87], v[100:103], v[56:59]
    ds_read_b128 v[184:187], v247 offset:26624
    v_mfma_f32_16x16x32_bf16 v[56:59], v[88:91], v[96:99], v[56:59]
    v_mfma_f32_16x16x32_bf16 v[60:63], v[92:95], v[96:99], v[60:63]
    ds_read2_b32 v[152:153], v239 offset0:48 offset1:49
    v_mfma_f32_16x16x32_bf16 v[60:63], v[88:91], v[100:103], v[60:63]
    s_add_u32 m0, s73, 0
    ds_read2_b32 v[154:155], v239 offset0:50 offset1:51
    v_mfma_f32_16x16x32_bf16 v[60:63], v[84:87], v[104:107], v[60:63]
    buffer_load_dwordx4 v5, s[52:55], s14 offen offset:1024 lds
    v_mfma_f32_16x16x32_bf16 v[60:63], v[80:83], v[108:111], v[60:63]
    ds_read_b128 v[188:191], v247 offset:30720
    v_mfma_f32_16x16x32_bf16 v[60:63], v[76:79], v[112:115], v[60:63]
    ds_read2_b32 v[156:157], v239 offset0:176 offset1:177
    v_mfma_f32_16x16x32_bf16 v[60:63], v[72:75], v[116:119], v[60:63]
    v_mfma_f32_16x16x32_bf16 v[60:63], v[68:71], v[120:123], v[60:63]
    ds_read2_b32 v[158:159], v239 offset0:178 offset1:179
    v_mfma_f32_16x16x32_bf16 v[60:63], v[64:67], v[124:127], v[60:63]
    s_waitcnt lgkmcnt(12)
    v_mfma_f32_16x16x32_bf16 v[32:35], v[128:131], v[160:163], v[32:35]
    ds_read_b128 v[96:99], v244 offset:0
    v_mfma_f32_16x16x32_bf16 v[36:39], v[132:135], v[160:163], v[36:39]
    s_add_u32 m0, s73, 0
    v_mfma_f32_16x16x32_bf16 v[36:39], v[128:131], v[164:167], v[36:39]
    buffer_load_dwordx4 v6, s[52:55], s14 offen offset:2048 lds
    ds_read2_b32 v[64:65], v236 offset0:64 offset1:65
    v_mfma_f32_16x16x32_bf16 v[40:43], v[128:131], v[168:171], v[40:43]
    ds_read2_b32 v[66:67], v236 offset0:66 offset1:67
    v_mfma_f32_16x16x32_bf16 v[40:43], v[132:135], v[164:167], v[40:43]
    v_mfma_f32_16x16x32_bf16 v[40:43], v[136:139], v[160:163], v[40:43]
    ds_read_b128 v[100:103], v244 offset:4096
    v_mfma_f32_16x16x32_bf16 v[44:47], v[140:143], v[160:163], v[44:47]
    ds_read2_b32 v[68:69], v236 offset0:192 offset1:193
    v_mfma_f32_16x16x32_bf16 v[44:47], v[136:139], v[164:167], v[44:47]
    v_mfma_f32_16x16x32_bf16 v[44:47], v[132:135], v[168:171], v[44:47]
    s_add_u32 m0, s73, 0
    ds_read2_b32 v[70:71], v236 offset0:194 offset1:195
    v_mfma_f32_16x16x32_bf16 v[44:47], v[128:131], v[172:175], v[44:47]
    buffer_load_dwordx4 v7, s[52:55], s14 offen offset:3072 lds
    ds_read_b128 v[104:107], v244 offset:8192
    s_waitcnt lgkmcnt(7)
    v_mfma_f32_16x16x32_bf16 v[48:51], v[128:131], v[176:179], v[48:51]
    ds_read2_b32 v[72:73], v237 offset0:64 offset1:65
    v_mfma_f32_16x16x32_bf16 v[48:51], v[132:135], v[172:175], v[48:51]
    v_mfma_f32_16x16x32_bf16 v[48:51], v[136:139], v[168:171], v[48:51]
    ds_read2_b32 v[74:75], v237 offset0:66 offset1:67
    v_mfma_f32_16x16x32_bf16 v[48:51], v[140:143], v[164:167], v[48:51]
    ds_read_b128 v[108:111], v244 offset:12288
    v_mfma_f32_16x16x32_bf16 v[48:51], v[144:147], v[160:163], v[48:51]
    v_mfma_f32_16x16x32_bf16 v[52:55], v[148:151], v[160:163], v[52:55]
    ds_read2_b32 v[76:77], v237 offset0:192 offset1:193
    v_mfma_f32_16x16x32_bf16 v[52:55], v[144:147], v[164:167], v[52:55]
    ds_read2_b32 v[78:79], v237 offset0:194 offset1:195
    v_mfma_f32_16x16x32_bf16 v[52:55], v[140:143], v[168:171], v[52:55]
    v_mfma_f32_16x16x32_bf16 v[52:55], v[136:139], v[172:175], v[52:55]
    ds_read_b128 v[112:115], v244 offset:16384
    v_mfma_f32_16x16x32_bf16 v[52:55], v[132:135], v[176:179], v[52:55]
    ds_read2_b32 v[80:81], v238 offset0:64 offset1:65
    v_mfma_f32_16x16x32_bf16 v[52:55], v[128:131], v[180:183], v[52:55]
    v_mfma_f32_16x16x32_bf16 v[56:59], v[128:131], v[184:187], v[56:59]
    ds_read2_b32 v[82:83], v238 offset0:66 offset1:67
    v_mfma_f32_16x16x32_bf16 v[56:59], v[132:135], v[180:183], v[56:59]
    ds_read_b128 v[116:119], v244 offset:20480
    v_mfma_f32_16x16x32_bf16 v[56:59], v[136:139], v[176:179], v[56:59]
    v_mfma_f32_16x16x32_bf16 v[56:59], v[140:143], v[172:175], v[56:59]
    ds_read2_b32 v[84:85], v238 offset0:192 offset1:193
    v_mfma_f32_16x16x32_bf16 v[56:59], v[144:147], v[168:171], v[56:59]
    ds_read2_b32 v[86:87], v238 offset0:194 offset1:195
    v_mfma_f32_16x16x32_bf16 v[56:59], v[148:151], v[164:167], v[56:59]
    ds_read_b128 v[120:123], v244 offset:24576
    v_mfma_f32_16x16x32_bf16 v[56:59], v[152:155], v[160:163], v[56:59]
    v_mfma_f32_16x16x32_bf16 v[60:63], v[156:159], v[160:163], v[60:63]
    s_lshl_b32 s14, s92, 18
    ds_read2_b32 v[88:89], v239 offset0:64 offset1:65
    v_mfma_f32_16x16x32_bf16 v[60:63], v[152:155], v[164:167], v[60:63]
    s_add_u32 m0, s73, 16384
    ds_read2_b32 v[90:91], v239 offset0:66 offset1:67
    v_mfma_f32_16x16x32_bf16 v[60:63], v[148:151], v[168:171], v[60:63]
    buffer_load_dwordx4 v4, s[52:55], s14 offen offset:0 lds
    v_mfma_f32_16x16x32_bf16 v[60:63], v[144:147], v[172:175], v[60:63]
    ds_read_b128 v[124:127], v244 offset:28672
    v_mfma_f32_16x16x32_bf16 v[60:63], v[140:143], v[176:179], v[60:63]
    ds_read2_b32 v[92:93], v239 offset0:192 offset1:193
    v_mfma_f32_16x16x32_bf16 v[60:63], v[136:139], v[180:183], v[60:63]
    v_mfma_f32_16x16x32_bf16 v[60:63], v[132:135], v[184:187], v[60:63]
    ds_read2_b32 v[94:95], v239 offset0:194 offset1:195
    v_mfma_f32_16x16x32_bf16 v[60:63], v[128:131], v[188:191], v[60:63]
    s_waitcnt lgkmcnt(12)
    v_mfma_f32_16x16x32_bf16 v[32:35], v[64:67], v[96:99], v[32:35]
    ds_read_b128 v[160:163], v245 offset:0
    v_mfma_f32_16x16x32_bf16 v[36:39], v[68:71], v[96:99], v[36:39]
    s_add_u32 m0, s73, 16384
    ds_read2_b32 v[128:129], v236 offset0:80 offset1:81
    v_mfma_f32_16x16x32_bf16 v[36:39], v[64:67], v[100:103], v[36:39]
    buffer_load_dwordx4 v5, s[52:55], s14 offen offset:1024 lds
    ds_read2_b32 v[130:131], v236 offset0:82 offset1:83
    v_mfma_f32_16x16x32_bf16 v[40:43], v[64:67], v[104:107], v[40:43]
    ds_read_b128 v[164:167], v245 offset:4096
    v_mfma_f32_16x16x32_bf16 v[40:43], v[68:71], v[100:103], v[40:43]
    ds_read2_b32 v[132:133], v236 offset0:208 offset1:209
    v_mfma_f32_16x16x32_bf16 v[40:43], v[72:75], v[96:99], v[40:43]
    ds_read2_b32 v[134:135], v236 offset0:210 offset1:211
    v_mfma_f32_16x16x32_bf16 v[44:47], v[76:79], v[96:99], v[44:47]
    ds_read_b128 v[168:171], v245 offset:8192
    v_mfma_f32_16x16x32_bf16 v[44:47], v[72:75], v[100:103], v[44:47]
    ds_read2_b32 v[136:137], v237 offset0:80 offset1:81
    v_mfma_f32_16x16x32_bf16 v[44:47], v[68:71], v[104:107], v[44:47]
    s_add_u32 m0, s73, 16384
    ds_read2_b32 v[138:139], v237 offset0:82 offset1:83
    v_mfma_f32_16x16x32_bf16 v[44:47], v[64:67], v[108:111], v[44:47]
    buffer_load_dwordx4 v6, s[52:55], s14 offen offset:2048 lds
    ds_read_b128 v[172:175], v245 offset:12288
    s_waitcnt lgkmcnt(10)
    v_mfma_f32_16x16x32_bf16 v[48:51], v[64:67], v[112:115], v[48:51]
    ds_read2_b32 v[140:141], v237 offset0:208 offset1:209
    v_mfma_f32_16x16x32_bf16 v[48:51], v[68:71], v[108:111], v[48:51]
    ds_read2_b32 v[142:143], v237 offset0:210 offset1:211
    v_mfma_f32_16x16x32_bf16 v[48:51], v[72:75], v[104:107], v[48:51]
    ds_read_b128 v[176:179], v245 offset:16384
    v_mfma_f32_16x16x32_bf16 v[48:51], v[76:79], v[100:103], v[48:51]
    ds_read2_b32 v[144:145], v238 offset0:80 offset1:81
    v_mfma_f32_16x16x32_bf16 v[48:51], v[80:83], v[96:99], v[48:51]
    ds_read2_b32 v[146:147], v238 offset0:82 offset1:83
    s_waitcnt vmcnt(7)
    s_barrier
    v_mfma_f32_16x16x32_bf16 v[52:55], v[84:87], v[96:99], v[52:55]
    ds_read_b64_tr_b16 a[96:97], v10 offset:16384
    s_add_u32 m0, s73, 16384
    v_mfma_f32_16x16x32_bf16 v[52:55], v[80:83], v[100:103], v[52:55]
    buffer_load_dwordx4 v7, s[52:55], s14 offen offset:3072 lds
    ds_read_b128 v[180:183], v245 offset:20480
    v_mfma_f32_16x16x32_bf16 v[52:55], v[76:79], v[104:107], v[52:55]
    ds_read_b64_tr_b16 a[98:99], v10 offset:18432
    v_mfma_f32_16x16x32_bf16 v[52:55], v[72:75], v[108:111], v[52:55]
    ds_read_b64_tr_b16 a[104:105], v10 offset:20480
    v_mfma_f32_16x16x32_bf16 v[52:55], v[68:71], v[112:115], v[52:55]
    ds_read_b128 v[212:215], v241 offset:8352
    v_mfma_f32_16x16x32_bf16 v[52:55], v[64:67], v[116:119], v[52:55]
    ds_read_b64_tr_b16 a[106:107], v10 offset:22528
    v_mfma_f32_16x16x32_bf16 v[56:59], v[64:67], v[120:123], v[56:59]
    ds_read_b64_tr_b16 a[100:101], v11 offset:16384
    v_mfma_f32_16x16x32_bf16 v[56:59], v[68:71], v[116:119], v[56:59]
    ds_read_b32 v216, v241 offset:8368
    v_mfma_f32_16x16x32_bf16 v[56:59], v[72:75], v[112:115], v[56:59]
    ds_read_b64_tr_b16 a[102:103], v11 offset:18432
    v_mfma_f32_16x16x32_bf16 v[56:59], v[76:79], v[108:111], v[56:59]
    ds_read_b64_tr_b16 a[108:109], v11 offset:20480
    ds_read2_b32 v[148:149], v238 offset0:208 offset1:209
    v_mfma_f32_16x16x32_bf16 v[56:59], v[80:83], v[104:107], v[56:59]
    ds_read_b64_tr_b16 a[110:111], v11 offset:22528
    ds_read2_b32 v[150:151], v238 offset0:210 offset1:211
    v_mfma_f32_16x16x32_bf16 v[56:59], v[84:87], v[100:103], v[56:59]
    ds_read_b128 v[218:221], v241 offset:9376
    ds_read_b128 v[184:187], v245 offset:24576
    v_mfma_f32_16x16x32_bf16 v[56:59], v[88:91], v[96:99], v[56:59]
    ds_read_b32 v222, v241 offset:9392
    v_mfma_f32_16x16x32_bf16 v[60:63], v[92:95], v[96:99], v[60:63]
    ds_read_b128 v[224:227], v241 offset:10400
    ds_read2_b32 v[152:153], v239 offset0:80 offset1:81
    v_mfma_f32_16x16x32_bf16 v[60:63], v[88:91], v[100:103], v[60:63]
    ds_read2_b32 v[154:155], v239 offset0:82 offset1:83
    v_mfma_f32_16x16x32_bf16 v[60:63], v[84:87], v[104:107], v[60:63]
    ds_read_b32 v228, v241 offset:10416
    v_mfma_f32_16x16x32_bf16 v[60:63], v[80:83], v[108:111], v[60:63]
    ds_read_b128 v[188:191], v245 offset:28672
    v_mfma_f32_16x16x32_bf16 v[60:63], v[76:79], v[112:115], v[60:63]
    ds_read_b128 v[230:233], v241 offset:11424
    s_waitcnt lgkmcnt(10)
    s_barrier
    v_mfma_f32_16x16x32_bf16 v[60:63], v[72:75], v[116:119], v[60:63]
    ds_read2_b32 v[156:157], v239 offset0:208 offset1:209
    v_mfma_f32_16x16x32_bf16 v[60:63], v[68:71], v[120:123], v[60:63]
    ds_read_b32 v234, v241 offset:11440
    ds_read2_b32 v[158:159], v239 offset0:210 offset1:211
    v_mfma_f32_16x16x32_bf16 v[60:63], v[64:67], v[124:127], v[60:63]
    v_mfma_f32_16x16x32_bf16 v[32:35], v[128:131], v[160:163], v[32:35]
    s_lshl_b32 s14, s93, 18
    ds_read_b128 v[96:99], v246 offset:0
    v_mfma_f32_16x16x32_bf16 v[36:39], v[132:135], v[160:163], v[36:39]
    s_add_u32 m0, s73, 147456
    ds_read2_b32 v[64:65], v236 offset0:96 offset1:97
    v_mfma_f32_16x16x32_bf16 v[36:39], v[128:131], v[164:167], v[36:39]
    buffer_load_dwordx4 v4, s[52:55], s14 offen offset:0 lds
    ds_read2_b32 v[66:67], v236 offset0:98 offset1:99
    v_mfma_f32_16x16x32_bf16 v[40:43], v[128:131], v[168:171], v[40:43]
    ds_read_b128 v[100:103], v246 offset:4096
    v_mfma_f32_16x16x32_bf16 v[40:43], v[132:135], v[164:167], v[40:43]
    s_waitcnt lgkmcnt(5)
    ds_read2_b32 v[68:69], v236 offset0:224 offset1:225
    v_mfma_f32_16x16x32_bf16 v[40:43], v[136:139], v[160:163], v[40:43]
    ds_read2_b32 v[70:71], v236 offset0:226 offset1:227
    v_mfma_f32_16x16x32_bf16 v[44:47], v[140:143], v[160:163], v[44:47]
    ds_read_b128 v[104:107], v246 offset:8192
    v_mfma_f32_16x16x32_bf16 v[44:47], v[136:139], v[164:167], v[44:47]
    ds_read2_b32 v[72:73], v237 offset0:96 offset1:97
    v_mfma_f32_16x16x32_bf16 v[44:47], v[132:135], v[168:171], v[44:47]
    ds_read2_b32 v[74:75], v237 offset0:98 offset1:99
    s_add_u32 m0, s73, 147456
    v_lshlrev_b32 v9, 16, v9
    v_mfma_f32_16x16x32_bf16 v[44:47], v[128:131], v[172:175], v[44:47]
    buffer_load_dwordx4 v5, s[52:55], s14 offen offset:1024 lds
    ds_read_b128 v[108:111], v246 offset:12288
    s_waitcnt lgkmcnt(10)
    v_mfma_f32_16x16x32_bf16 v[48:51], v[128:131], v[176:179], v[48:51]
    ds_read2_b32 v[76:77], v237 offset0:224 offset1:225
    v_lshlrev_b32 v208, 16, v212
    v_mfma_f32_16x16x32_bf16 v[48:51], v[132:135], v[172:175], v[48:51]
    ds_read2_b32 v[78:79], v237 offset0:226 offset1:227
    v_mfma_f32_16x16x32_bf16 v[48:51], v[136:139], v[168:171], v[48:51]
    ds_read_b128 v[112:115], v246 offset:16384
    v_add_f32 v9, v9, v208
    v_mfma_f32_16x16x32_bf16 v[48:51], v[140:143], v[164:167], v[48:51]
    ds_read2_b32 v[80:81], v238 offset0:96 offset1:97
    v_cvt_pk_bf16_f32 v9, v9, v9
    v_mfma_f32_16x16x32_bf16 v[48:51], v[144:147], v[160:163], v[48:51]
    ds_write_b16 v242, v9 offset:12480
    v_mfma_f32_16x16x32_bf16 v[52:55], v[148:151], v[160:163], v[52:55]
    s_add_u32 m0, s73, 147456
    ds_read2_b32 v[82:83], v238 offset0:98 offset1:99
    v_mfma_f32_16x16x32_bf16 v[52:55], v[144:147], v[164:167], v[52:55]
    buffer_load_dwordx4 v6, s[52:55], s14 offen offset:2048 lds
    ds_read_b128 v[116:119], v246 offset:20480
    v_mfma_f32_16x16x32_bf16 v[52:55], v[140:143], v[168:171], v[52:55]
    ds_write_b16 v242, v9 offset:8322
    v_mfma_f32_16x16x32_bf16 v[52:55], v[136:139], v[172:175], v[52:55]
    ds_read2_b32 v[84:85], v238 offset0:224 offset1:225
    v_mfma_f32_16x16x32_bf16 v[52:55], v[132:135], v[176:179], v[52:55]
    ds_read2_b32 v[86:87], v238 offset0:226 offset1:227
    v_alignbit_b32 v212, v213, v212, 16
    v_mfma_f32_16x16x32_bf16 v[52:55], v[128:131], v[180:183], v[52:55]
    v_alignbit_b32 v213, v214, v213, 16
    v_alignbit_b32 v214, v215, v214, 16
    v_mfma_f32_16x16x32_bf16 v[56:59], v[128:131], v[184:187], v[56:59]
    s_waitcnt vmcnt(7)
    s_barrier
    v_alignbit_b32 v215, v216, v215, 16
    v_mfma_f32_16x16x32_bf16 v[56:59], v[132:135], v[180:183], v[56:59]
    v_add_u32 v10, -131072, v10
    s_add_u32 m0, s73, 147456
    v_mfma_f32_16x16x32_bf16 v[56:59], v[136:139], v[176:179], v[56:59]
    ds_read_b64_tr_b16 a[112:113], v10 offset:0
    buffer_load_dwordx4 v7, s[52:55], s14 offen offset:3072 lds
    v_mfma_f32_16x16x32_bf16 v[56:59], v[140:143], v[172:175], v[56:59]
    ds_write_b128 v241, v[212:215] offset:12512
    v_mfma_f32_16x16x32_bf16 v[56:59], v[144:147], v[168:171], v[56:59]
    ds_read_b64_tr_b16 a[114:115], v10 offset:2048
    ds_read_b128 v[120:123], v246 offset:24576
    v_mfma_f32_16x16x32_bf16 v[56:59], v[148:151], v[164:167], v[56:59]
    ds_read_b64_tr_b16 a[120:121], v10 offset:4096
    ds_read2_b32 v[88:89], v239 offset0:96 offset1:97
    v_mfma_f32_16x16x32_bf16 v[56:59], v[152:155], v[160:163], v[56:59]
    ds_read_b64_tr_b16 a[122:123], v10 offset:6144
    v_alignbit_b32 v218, v219, v218, 16
    v_mfma_f32_16x16x32_bf16 v[60:63], v[156:159], v[160:163], v[60:63]
    ds_read2_b32 v[90:91], v239 offset0:98 offset1:99
    v_add_u32 v11, -131072, v11
    v_mfma_f32_16x16x32_bf16 v[60:63], v[152:155], v[164:167], v[60:63]
    ds_read_b64_tr_b16 a[116:117], v11 offset:0
    v_alignbit_b32 v219, v220, v219, 16
    v_mfma_f32_16x16x32_bf16 v[60:63], v[148:151], v[168:171], v[60:63]
    ds_read_b128 v[124:127], v246 offset:28672
    ds_read2_b32 v[92:93], v239 offset0:224 offset1:225
    v_mfma_f32_16x16x32_bf16 v[60:63], v[144:147], v[172:175], v[60:63]
    ds_read_b64_tr_b16 a[118:119], v11 offset:2048
    v_alignbit_b32 v220, v221, v220, 16
    v_mfma_f32_16x16x32_bf16 v[60:63], v[140:143], v[176:179], v[60:63]
    ds_read_b64_tr_b16 a[124:125], v11 offset:4096
    ds_read2_b32 v[94:95], v239 offset0:226 offset1:227
    v_mfma_f32_16x16x32_bf16 v[60:63], v[136:139], v[180:183], v[60:63]
    ds_read_b64_tr_b16 a[126:127], v11 offset:6144
    v_alignbit_b32 v221, v222, v221, 16
    v_mfma_f32_16x16x32_bf16 v[60:63], v[132:135], v[184:187], v[60:63]
    ds_write_b128 v241, v[218:221] offset:13536
    v_mfma_f32_16x16x32_bf16 v[60:63], v[128:131], v[188:191], v[60:63]
    s_waitcnt lgkmcnt(15)
    v_mfma_f32_16x16x32_bf16 v[32:35], v[64:67], v[96:99], v[32:35]
    ds_read_b128 v[160:163], v247 offset:0
    v_mfma_f32_16x16x32_bf16 v[36:39], v[68:71], v[96:99], v[36:39]
    v_alignbit_b32 v224, v225, v224, 16
    v_mfma_f32_16x16x32_bf16 v[36:39], v[64:67], v[100:103], v[36:39]
    ds_read_b128 v[164:167], v247 offset:4096
    v_mfma_f32_16x16x32_bf16 v[40:43], v[64:67], v[104:107], v[40:43]
    ds_read_b128 v[168:171], v247 offset:8192
    s_waitcnt lgkmcnt(4)
    s_barrier
    v_mfma_f32_16x16x32_bf16 v[40:43], v[68:71], v[100:103], v[40:43]
    ds_read_b128 v[172:175], v247 offset:12288
    v_mfma_f32_16x16x32_bf16 v[40:43], v[72:75], v[96:99], v[40:43]
    v_alignbit_b32 v225, v226, v225, 16
    v_mfma_f32_16x16x32_bf16 v[44:47], v[76:79], v[96:99], v[44:47]
    ds_read_b128 v[176:179], v247 offset:16384
    v_mfma_f32_16x16x32_bf16 v[44:47], v[72:75], v[100:103], v[44:47]
    s_lshl_b32 s14, s94, 18
    ds_read_b128 v[180:183], v247 offset:20480
    v_mfma_f32_16x16x32_bf16 v[44:47], v[68:71], v[104:107], v[44:47]
    s_add_u32 m0, s73, 0
    v_alignbit_b32 v226, v227, v226, 16
    v_mfma_f32_16x16x32_bf16 v[44:47], v[64:67], v[108:111], v[44:47]
    buffer_load_dwordx4 v4, s[52:55], s14 offen offset:0 lds
    ds_read_b128 v[184:187], v247 offset:24576
    v_mfma_f32_16x16x32_bf16 v[48:51], v[64:67], v[112:115], v[48:51]
    ds_read_b128 v[188:191], v247 offset:28672
    v_mfma_f32_16x16x32_bf16 v[48:51], v[68:71], v[108:111], v[48:51]
    ds_read2_b32 v[128:129], v236 offset0:112 offset1:113
    v_mfma_f32_16x16x32_bf16 v[48:51], v[72:75], v[104:107], v[48:51]
    v_alignbit_b32 v227, v228, v227, 16
    v_mfma_f32_16x16x32_bf16 v[48:51], v[76:79], v[100:103], v[48:51]
    ds_read2_b32 v[130:131], v236 offset0:114 offset1:115
    v_mfma_f32_16x16x32_bf16 v[48:51], v[80:83], v[96:99], v[48:51]
    ds_read2_b32 v[132:133], v236 offset0:240 offset1:241
    v_mfma_f32_16x16x32_bf16 v[52:55], v[84:87], v[96:99], v[52:55]
    s_add_u32 m0, s73, 0
    ds_read2_b32 v[134:135], v236 offset0:242 offset1:243
    v_mfma_f32_16x16x32_bf16 v[52:55], v[80:83], v[100:103], v[52:55]
    buffer_load_dwordx4 v5, s[52:55], s14 offen offset:1024 lds
    ds_read2_b32 v[136:137], v237 offset0:112 offset1:113
    v_mfma_f32_16x16x32_bf16 v[52:55], v[76:79], v[104:107], v[52:55]
    ds_write_b128 v241, v[224:227] offset:14560
    v_mfma_f32_16x16x32_bf16 v[52:55], v[72:75], v[108:111], v[52:55]
    ds_read2_b32 v[138:139], v237 offset0:114 offset1:115
    s_add_u32 s6, s12, 4751360
    ds_read2_b32 v[140:141], v237 offset0:240 offset1:241
    v_mfma_f32_16x16x32_bf16 v[52:55], v[68:71], v[112:115], v[52:55]
    ds_read2_b32 v[142:143], v237 offset0:242 offset1:243
    v_alignbit_b32 v230, v231, v230, 16
    v_mfma_f32_16x16x32_bf16 v[52:55], v[64:67], v[116:119], v[52:55]
    ds_read2_b32 v[144:145], v238 offset0:112 offset1:113
    v_xor_b32 v244, 64, v244
    v_mfma_f32_16x16x32_bf16 v[56:59], v[64:67], v[120:123], v[56:59]
    ds_read2_b32 v[146:147], v238 offset0:114 offset1:115
    v_mfma_f32_16x16x32_bf16 v[56:59], v[68:71], v[116:119], v[56:59]
    s_add_u32 m0, s73, 0
    ds_read2_b32 v[148:149], v238 offset0:240 offset1:241
    v_mfma_f32_16x16x32_bf16 v[56:59], v[72:75], v[112:115], v[56:59]
    buffer_load_dwordx4 v6, s[52:55], s14 offen offset:2048 lds
    v_alignbit_b32 v231, v232, v231, 16
    v_mfma_f32_16x16x32_bf16 v[56:59], v[76:79], v[108:111], v[56:59]
    ds_read2_b32 v[150:151], v238 offset0:242 offset1:243
    v_xor_b32 v245, 64, v245
    v_mfma_f32_16x16x32_bf16 v[56:59], v[80:83], v[104:107], v[56:59]
    ds_read2_b32 v[152:153], v239 offset0:112 offset1:113
    v_mfma_f32_16x16x32_bf16 v[56:59], v[84:87], v[100:103], v[56:59]
    ds_read2_b32 v[154:155], v239 offset0:114 offset1:115
    v_mfma_f32_16x16x32_bf16 v[56:59], v[88:91], v[96:99], v[56:59]
    ds_read2_b32 v[156:157], v239 offset0:240 offset1:241
    v_alignbit_b32 v232, v233, v232, 16
    v_mfma_f32_16x16x32_bf16 v[60:63], v[92:95], v[96:99], v[60:63]
    ds_read2_b32 v[158:159], v239 offset0:242 offset1:243
    s_waitcnt vmcnt(7)
    s_barrier
    v_mfma_f32_16x16x32_bf16 v[60:63], v[88:91], v[100:103], v[60:63]
    s_add_u32 m0, s73, 0
    v_xor_b32 v246, 64, v246
    v_add_u32 v236, 8320, v236
    v_mfma_f32_16x16x32_bf16 v[60:63], v[84:87], v[104:107], v[60:63]
    ds_read_b64_tr_b16 a[128:129], v10 offset:16384
    buffer_load_dwordx4 v7, s[52:55], s14 offen offset:3072 lds
    v_mfma_f32_16x16x32_bf16 v[60:63], v[80:83], v[108:111], v[60:63]
    ds_read_b64_tr_b16 a[130:131], v10 offset:18432
    v_alignbit_b32 v233, v234, v233, 16
    v_add_u32 v237, 8320, v237
    v_mfma_f32_16x16x32_bf16 v[60:63], v[76:79], v[112:115], v[60:63]
    ds_write_b128 v241, v[230:233] offset:15584
    v_mfma_f32_16x16x32_bf16 v[60:63], v[72:75], v[116:119], v[60:63]
    ds_read_b64_tr_b16 a[136:137], v10 offset:20480
    v_xor_b32 v247, 64, v247
    v_mfma_f32_16x16x32_bf16 v[60:63], v[68:71], v[120:123], v[60:63]
    ds_read_b64_tr_b16 a[138:139], v10 offset:22528
    v_add_u32 v238, 8320, v238
    v_mfma_f32_16x16x32_bf16 v[60:63], v[64:67], v[124:127], v[60:63]
    v_add_u32 v239, 8320, v239
    s_waitcnt lgkmcnt(5)
    v_mfma_f32_16x16x32_bf16 v[60:63], v[128:131], v[188:191], v[60:63]
    ds_read_b64_tr_b16 a[132:133], v11 offset:16384
    v_mfma_f32_16x16x32_bf16 v[60:63], v[132:135], v[184:187], v[60:63]
    ds_read_b64_tr_b16 a[134:135], v11 offset:18432
    v_mfma_f32_16x16x32_bf16 v[60:63], v[136:139], v[180:183], v[60:63]
    ds_read_b64_tr_b16 a[140:141], v11 offset:20480
    v_mfma_f32_16x16x32_bf16 v[60:63], v[140:143], v[176:179], v[60:63]
    ds_read_b128 v[96:99], v244 offset:2048
    v_mfma_f32_16x16x32_bf16 v[60:63], v[144:147], v[172:175], v[60:63]
    ds_read_b64_tr_b16 a[142:143], v11 offset:22528
    v_mfma_f32_16x16x32_bf16 v[60:63], v[148:151], v[168:171], v[60:63]
    ds_read2_b32 v[64:65], v236 offset0:0 offset1:1
    v_mfma_f32_16x16x32_bf16 v[60:63], v[152:155], v[164:167], v[60:63]
    ds_read2_b32 v[66:67], v236 offset0:2 offset1:3
    v_mfma_f32_16x16x32_bf16 v[60:63], v[156:159], v[160:163], v[60:63]
    ds_read_b128 v[100:103], v244 offset:6144
    v_mfma_f32_16x16x32_bf16 v[56:59], v[128:131], v[184:187], v[56:59]
    ds_read2_b32 v[68:69], v236 offset0:128 offset1:129
    v_mfma_f32_16x16x32_bf16 v[56:59], v[132:135], v[180:183], v[56:59]
    ds_read2_b32 v[70:71], v236 offset0:130 offset1:131
    v_mfma_f32_16x16x32_bf16 v[56:59], v[136:139], v[176:179], v[56:59]
    ds_read_b128 v[104:107], v244 offset:10240
    s_waitcnt lgkmcnt(6)
    s_barrier
    v_mfma_f32_16x16x32_bf16 v[56:59], v[140:143], v[172:175], v[56:59]
    ds_read2_b32 v[72:73], v237 offset0:0 offset1:1
    v_mfma_f32_16x16x32_bf16 v[56:59], v[144:147], v[168:171], v[56:59]
    ds_read2_b32 v[74:75], v237 offset0:2 offset1:3
    v_mfma_f32_16x16x32_bf16 v[56:59], v[148:151], v[164:167], v[56:59]
    ds_read_b128 v[108:111], v244 offset:14336
    v_cvt_pk_bf16_f32 v206, v60, v61
    v_mfma_f32_16x16x32_bf16 v[56:59], v[152:155], v[160:163], v[56:59]
    s_lshl_b32 s14, s95, 18
    ds_read2_b32 v[76:77], v237 offset0:128 offset1:129
    v_mfma_f32_16x16x32_bf16 v[52:55], v[128:131], v[180:183], v[52:55]
    s_add_u32 m0, s73, 16384
    ds_read2_b32 v[78:79], v237 offset0:130 offset1:131
    v_mfma_f32_16x16x32_bf16 v[52:55], v[132:135], v[176:179], v[52:55]
    buffer_load_dwordx4 v4, s[52:55], s14 offen offset:0 lds
    v_cvt_pk_bf16_f32 v207, v62, v63
    v_mfma_f32_16x16x32_bf16 v[52:55], v[136:139], v[172:175], v[52:55]
    ds_read_b128 v[112:115], v244 offset:18432
    v_mfma_f32_16x16x32_bf16 v[52:55], v[140:143], v[168:171], v[52:55]
    buffer_store_dwordx2 v[206:207], v8, s[44:47], s6 offen offset:3584 sc1
    ds_read2_b32 v[80:81], v238 offset0:0 offset1:1
    v_mfma_f32_16x16x32_bf16 v[52:55], v[144:147], v[164:167], v[52:55]
    ds_read2_b32 v[82:83], v238 offset0:2 offset1:3
    v_mfma_f32_16x16x32_bf16 v[52:55], v[148:151], v[160:163], v[52:55]
    ds_read_b128 v[116:119], v244 offset:22528
    v_mfma_f32_16x16x32_bf16 v[48:51], v[128:131], v[176:179], v[48:51]
    ds_read2_b32 v[84:85], v238 offset0:128 offset1:129
    v_cvt_pk_bf16_f32 v204, v56, v57
    v_mfma_f32_16x16x32_bf16 v[48:51], v[132:135], v[172:175], v[48:51]
    s_add_u32 m0, s73, 16384
    ds_read2_b32 v[86:87], v238 offset0:130 offset1:131
    v_mfma_f32_16x16x32_bf16 v[48:51], v[136:139], v[168:171], v[48:51]
    buffer_load_dwordx4 v5, s[52:55], s14 offen offset:1024 lds
    ds_read_b128 v[120:123], v244 offset:26624
    v_mfma_f32_16x16x32_bf16 v[48:51], v[140:143], v[164:167], v[48:51]
    ds_read2_b32 v[88:89], v239 offset0:0 offset1:1
    v_cvt_pk_bf16_f32 v205, v58, v59
    v_mfma_f32_16x16x32_bf16 v[48:51], v[144:147], v[160:163], v[48:51]
    ds_read2_b32 v[90:91], v239 offset0:2 offset1:3
    v_mfma_f32_16x16x32_bf16 v[44:47], v[128:131], v[172:175], v[44:47]
    buffer_store_dwordx2 v[204:205], v8, s[44:47], s6 offen offset:3072 sc1
    ds_read_b128 v[124:127], v244 offset:30720
    v_mfma_f32_16x16x32_bf16 v[44:47], v[132:135], v[168:171], v[44:47]
    ds_read2_b32 v[92:93], v239 offset0:128 offset1:129
    v_mfma_f32_16x16x32_bf16 v[44:47], v[136:139], v[164:167], v[44:47]
    ds_read2_b32 v[94:95], v239 offset0:130 offset1:131
    v_mfma_f32_16x16x32_bf16 v[44:47], v[140:143], v[160:163], v[44:47]
    s_add_u32 m0, s73, 16384
    v_cvt_pk_bf16_f32 v202, v52, v53
    v_mfma_f32_16x16x32_bf16 v[40:43], v[128:131], v[168:171], v[40:43]
    buffer_load_dwordx4 v6, s[52:55], s14 offen offset:2048 lds
    v_mfma_f32_16x16x32_bf16 v[40:43], v[132:135], v[164:167], v[40:43]
    v_mfma_f32_16x16x32_bf16 v[40:43], v[136:139], v[160:163], v[40:43]
    v_cvt_pk_bf16_f32 v203, v54, v55
    v_mfma_f32_16x16x32_bf16 v[36:39], v[128:131], v[164:167], v[36:39]
    v_mfma_f32_16x16x32_bf16 v[36:39], v[132:135], v[160:163], v[36:39]
    buffer_store_dwordx2 v[202:203], v8, s[44:47], s6 offen offset:2560 sc1
    v_mfma_f32_16x16x32_bf16 v[32:35], v[128:131], v[160:163], v[32:35]
    s_waitcnt lgkmcnt(0)
    v_mfma_f32_16x16x32_bf16 v[60:63], v[64:67], v[124:127], 0
    ds_read_b128 v[160:163], v245 offset:2048
    s_waitcnt vmcnt(10)
    s_barrier
    v_cvt_pk_bf16_f32 v200, v48, v49
    v_mfma_f32_16x16x32_bf16 v[60:63], v[68:71], v[120:123], v[60:63]
    v_add_u32 v10, 131072, v10
    s_add_u32 m0, s73, 16384
    v_mfma_f32_16x16x32_bf16 v[60:63], v[72:75], v[116:119], v[60:63]
    ds_read_b64_tr_b16 a[144:145], v10 offset:16384
    buffer_load_dwordx4 v7, s[52:55], s14 offen offset:3072 lds
    v_mfma_f32_16x16x32_bf16 v[60:63], v[76:79], v[112:115], v[60:63]
    ds_read_b64_tr_b16 a[146:147], v10 offset:18432
    v_cvt_pk_bf16_f32 v201, v50, v51
    v_mfma_f32_16x16x32_bf16 v[60:63], v[80:83], v[108:111], v[60:63]
    ds_read_b64_tr_b16 a[152:153], v10 offset:20480
    v_mfma_f32_16x16x32_bf16 v[60:63], v[84:87], v[104:107], v[60:63]
    buffer_store_dwordx2 v[200:201], v8, s[44:47], s6 offen offset:2048 sc1
    ds_read_b64_tr_b16 a[154:155], v10 offset:22528
    v_mfma_f32_16x16x32_bf16 v[60:63], v[88:91], v[100:103], v[60:63]
    ds_read2_b32 v[128:129], v236 offset0:16 offset1:17
    v_mfma_f32_16x16x32_bf16 v[60:63], v[92:95], v[96:99], v[60:63]
    v_add_u32 v11, 131072, v11
    v_cvt_pk_bf16_f32 v198, v44, v45
    v_mfma_f32_16x16x32_bf16 v[56:59], v[64:67], v[120:123], 0
    ds_read_b64_tr_b16 a[148:149], v11 offset:16384
    v_mfma_f32_16x16x32_bf16 v[56:59], v[68:71], v[116:119], v[56:59]
    ds_read_b64_tr_b16 a[150:151], v11 offset:18432
    v_mfma_f32_16x16x32_bf16 v[56:59], v[72:75], v[112:115], v[56:59]
    ds_read_b64_tr_b16 a[156:157], v11 offset:20480
    v_cvt_pk_bf16_f32 v199, v46, v47
    v_mfma_f32_16x16x32_bf16 v[56:59], v[76:79], v[108:111], v[56:59]
    ds_read_b64_tr_b16 a[158:159], v11 offset:22528
    v_mfma_f32_16x16x32_bf16 v[56:59], v[80:83], v[104:107], v[56:59]
    buffer_store_dwordx2 v[198:199], v8, s[44:47], s6 offen offset:1536 sc1
    ds_read2_b32 v[130:131], v236 offset0:18 offset1:19
    v_mfma_f32_16x16x32_bf16 v[56:59], v[84:87], v[100:103], v[56:59]
    ds_read_b128 v[164:167], v245 offset:6144
    v_mfma_f32_16x16x32_bf16 v[56:59], v[88:91], v[96:99], v[56:59]
    ds_read2_b32 v[132:133], v236 offset0:144 offset1:145
    v_cvt_pk_bf16_f32 v196, v40, v41
    v_mfma_f32_16x16x32_bf16 v[52:55], v[64:67], v[116:119], 0
    ds_read2_b32 v[134:135], v236 offset0:146 offset1:147
    v_mfma_f32_16x16x32_bf16 v[52:55], v[68:71], v[112:115], v[52:55]
    ds_read_b128 v[168:171], v245 offset:10240
    v_cvt_pk_bf16_f32 v197, v42, v43
    v_mfma_f32_16x16x32_bf16 v[52:55], v[72:75], v[108:111], v[52:55]
    ds_read2_b32 v[136:137], v237 offset0:16 offset1:17
    v_mfma_f32_16x16x32_bf16 v[52:55], v[76:79], v[104:107], v[52:55]
    buffer_store_dwordx2 v[196:197], v8, s[44:47], s6 offen offset:1024 sc1
    ds_read2_b32 v[138:139], v237 offset0:18 offset1:19
    s_waitcnt lgkmcnt(7)
    s_barrier
    v_mfma_f32_16x16x32_bf16 v[52:55], v[80:83], v[100:103], v[52:55]
    ds_read_b128 v[172:175], v245 offset:14336
    v_mfma_f32_16x16x32_bf16 v[52:55], v[84:87], v[96:99], v[52:55]
    ds_read2_b32 v[140:141], v237 offset0:144 offset1:145
    v_cvt_pk_bf16_f32 v194, v36, v37
    v_mfma_f32_16x16x32_bf16 v[48:51], v[64:67], v[112:115], 0
    s_lshl_b32 s14, s96, 18
    ds_read2_b32 v[142:143], v237 offset0:146 offset1:147
    v_mfma_f32_16x16x32_bf16 v[48:51], v[68:71], v[108:111], v[48:51]
    s_add_u32 m0, s73, 147456
    ds_read_b128 v[176:179], v245 offset:18432
    v_mfma_f32_16x16x32_bf16 v[48:51], v[72:75], v[104:107], v[48:51]
    buffer_load_dwordx4 v4, s[52:55], s14 offen offset:0 lds
    v_cvt_pk_bf16_f32 v195, v38, v39
    v_mfma_f32_16x16x32_bf16 v[48:51], v[76:79], v[100:103], v[48:51]
L_pl_X_5:
    s_cbranch_execz L_wret
    ds_read2_b32 v[144:145], v238 offset0:16 offset1:17
    v_mfma_f32_16x16x32_bf16 v[48:51], v[80:83], v[96:99], v[48:51]
    buffer_store_dwordx2 v[194:195], v8, s[44:47], s6 offen offset:512 sc1
    ds_read2_b32 v[146:147], v238 offset0:18 offset1:19
    v_mfma_f32_16x16x32_bf16 v[44:47], v[64:67], v[108:111], 0
    ds_read_b128 v[180:183], v245 offset:22528
    v_mfma_f32_16x16x32_bf16 v[44:47], v[68:71], v[104:107], v[44:47]
    ds_read2_b32 v[148:149], v238 offset0:144 offset1:145
    v_cvt_pk_bf16_f32 v192, v32, v33
    v_mfma_f32_16x16x32_bf16 v[44:47], v[72:75], v[100:103], v[44:47]
    ds_read2_b32 v[150:151], v238 offset0:146 offset1:147
    v_mfma_f32_16x16x32_bf16 v[44:47], v[76:79], v[96:99], v[44:47]
    ds_read_b128 v[184:187], v245 offset:26624
    s_add_u32 m0, s73, 147456
    v_cvt_pk_bf16_f32 v193, v34, v35
    v_mfma_f32_16x16x32_bf16 v[40:43], v[64:67], v[104:107], 0
    buffer_load_dwordx4 v5, s[52:55], s14 offen offset:1024 lds
    ds_read2_b32 v[152:153], v239 offset0:16 offset1:17
    v_mfma_f32_16x16x32_bf16 v[40:43], v[68:71], v[100:103], v[40:43]
    buffer_store_dwordx2 v[192:193], v8, s[44:47], s6 offen offset:0 sc1
    ds_read2_b32 v[154:155], v239 offset0:18 offset1:19
    v_mfma_f32_16x16x32_bf16 v[40:43], v[72:75], v[96:99], v[40:43]
    ds_read_b128 v[188:191], v245 offset:30720
    v_mfma_f32_16x16x32_bf16 v[36:39], v[64:67], v[100:103], 0
    ds_read2_b32 v[156:157], v239 offset0:144 offset1:145
    v_mfma_f32_16x16x32_bf16 v[36:39], v[68:71], v[96:99], v[36:39]
    ds_read2_b32 v[158:159], v239 offset0:146 offset1:147
    v_mfma_f32_16x16x32_bf16 v[32:35], v[64:67], v[96:99], 0
    s_waitcnt lgkmcnt(12)
    v_mfma_f32_16x16x32_bf16 v[32:35], v[128:131], v[160:163], v[32:35]
    ds_read_b128 v[96:99], v246 offset:2048
    v_mfma_f32_16x16x32_bf16 v[36:39], v[132:135], v[160:163], v[36:39]
    s_add_u32 m0, s73, 147456
    ds_read2_b32 v[64:65], v236 offset0:32 offset1:33
    v_mfma_f32_16x16x32_bf16 v[36:39], v[128:131], v[164:167], v[36:39]
    buffer_load_dwordx4 v6, s[52:55], s14 offen offset:2048 lds
    ds_read2_b32 v[66:67], v236 offset0:34 offset1:35
    v_mfma_f32_16x16x32_bf16 v[40:43], v[128:131], v[168:171], v[40:43]
    ds_read_b128 v[100:103], v246 offset:6144
    v_mfma_f32_16x16x32_bf16 v[40:43], v[132:135], v[164:167], v[40:43]
    ds_read2_b32 v[68:69], v236 offset0:160 offset1:161
    v_mfma_f32_16x16x32_bf16 v[40:43], v[136:139], v[160:163], v[40:43]
    ds_read2_b32 v[70:71], v236 offset0:162 offset1:163
    v_mfma_f32_16x16x32_bf16 v[44:47], v[140:143], v[160:163], v[44:47]
    ds_read_b128 v[104:107], v246 offset:10240
    v_mfma_f32_16x16x32_bf16 v[44:47], v[136:139], v[164:167], v[44:47]
    ds_read2_b32 v[72:73], v237 offset0:32 offset1:33
    s_waitcnt vmcnt(15)
    s_barrier
    v_mfma_f32_16x16x32_bf16 v[44:47], v[132:135], v[168:171], v[44:47]
    v_add_u32 v10, -131072, v10
    s_add_u32 m0, s73, 147456
    v_mfma_f32_16x16x32_bf16 v[44:47], v[128:131], v[172:175], v[44:47]
    ds_read_b64_tr_b16 a[160:161], v10 offset:0
    buffer_load_dwordx4 v7, s[52:55], s14 offen offset:3072 lds
    s_waitcnt lgkmcnt(9)
    v_mfma_f32_16x16x32_bf16 v[48:51], v[128:131], v[176:179], v[48:51]
    ds_read_b64_tr_b16 a[162:163], v10 offset:2048
    v_mfma_f32_16x16x32_bf16 v[48:51], v[132:135], v[172:175], v[48:51]
    ds_read_b64_tr_b16 a[168:169], v10 offset:4096
    v_mfma_f32_16x16x32_bf16 v[48:51], v[136:139], v[168:171], v[48:51]
    ds_read2_b32 v[74:75], v237 offset0:34 offset1:35
    v_mfma_f32_16x16x32_bf16 v[48:51], v[140:143], v[164:167], v[48:51]
    ds_read_b64_tr_b16 a[170:171], v10 offset:6144
    v_mfma_f32_16x16x32_bf16 v[48:51], v[144:147], v[160:163], v[48:51]
    ds_read_b128 v[108:111], v246 offset:14336
    v_add_u32 v11, -131072, v11
    v_mfma_f32_16x16x32_bf16 v[52:55], v[148:151], v[160:163], v[52:55]
    ds_read_b64_tr_b16 a[164:165], v11 offset:0
    v_mfma_f32_16x16x32_bf16 v[52:55], v[144:147], v[164:167], v[52:55]
    ds_read_b64_tr_b16 a[166:167], v11 offset:2048
    v_mfma_f32_16x16x32_bf16 v[52:55], v[140:143], v[168:171], v[52:55]
    ds_read_b64_tr_b16 a[172:173], v11 offset:4096
    v_mfma_f32_16x16x32_bf16 v[52:55], v[136:139], v[172:175], v[52:55]
    ds_read_b64_tr_b16 a[174:175], v11 offset:6144
    v_mfma_f32_16x16x32_bf16 v[52:55], v[132:135], v[176:179], v[52:55]
    ds_read2_b32 v[76:77], v237 offset0:160 offset1:161
    v_mfma_f32_16x16x32_bf16 v[52:55], v[128:131], v[180:183], v[52:55]
    ds_read2_b32 v[78:79], v237 offset0:162 offset1:163
    v_mfma_f32_16x16x32_bf16 v[56:59], v[128:131], v[184:187], v[56:59]
    ds_read_b128 v[112:115], v246 offset:18432
    v_mfma_f32_16x16x32_bf16 v[56:59], v[132:135], v[180:183], v[56:59]
    ds_read2_b32 v[80:81], v238 offset0:32 offset1:33
    v_mfma_f32_16x16x32_bf16 v[56:59], v[136:139], v[176:179], v[56:59]
    ds_read2_b32 v[82:83], v238 offset0:34 offset1:35
    v_mfma_f32_16x16x32_bf16 v[56:59], v[140:143], v[172:175], v[56:59]
    ds_read_b128 v[116:119], v246 offset:22528
    v_mfma_f32_16x16x32_bf16 v[56:59], v[144:147], v[168:171], v[56:59]
    ds_read2_b32 v[84:85], v238 offset0:160 offset1:161
    s_waitcnt lgkmcnt(7)
    s_barrier
    v_mfma_f32_16x16x32_bf16 v[56:59], v[148:151], v[164:167], v[56:59]
    ds_read2_b32 v[86:87], v238 offset0:162 offset1:163
    v_mfma_f32_16x16x32_bf16 v[56:59], v[152:155], v[160:163], v[56:59]
    ds_read_b128 v[120:123], v246 offset:26624
    v_mfma_f32_16x16x32_bf16 v[60:63], v[156:159], v[160:163], v[60:63]
    s_lshl_b32 s14, s97, 18
    ds_read2_b32 v[88:89], v239 offset0:32 offset1:33
    v_mfma_f32_16x16x32_bf16 v[60:63], v[152:155], v[164:167], v[60:63]
    s_add_u32 m0, s73, 0
    ds_read2_b32 v[90:91], v239 offset0:34 offset1:35
    v_mfma_f32_16x16x32_bf16 v[60:63], v[148:151], v[168:171], v[60:63]
    buffer_load_dwordx4 v4, s[52:55], s14 offen offset:0 lds
    v_mfma_f32_16x16x32_bf16 v[60:63], v[144:147], v[172:175], v[60:63]
    ds_read_b128 v[124:127], v246 offset:30720
    v_mfma_f32_16x16x32_bf16 v[60:63], v[140:143], v[176:179], v[60:63]
    ds_read2_b32 v[92:93], v239 offset0:160 offset1:161
    v_mfma_f32_16x16x32_bf16 v[60:63], v[136:139], v[180:183], v[60:63]
    v_mfma_f32_16x16x32_bf16 v[60:63], v[132:135], v[184:187], v[60:63]
    ds_read2_b32 v[94:95], v239 offset0:162 offset1:163
    v_mfma_f32_16x16x32_bf16 v[60:63], v[128:131], v[188:191], v[60:63]
    s_waitcnt lgkmcnt(12)
    v_mfma_f32_16x16x32_bf16 v[32:35], v[64:67], v[96:99], v[32:35]
    ds_read_b128 v[160:163], v247 offset:2048
    v_mfma_f32_16x16x32_bf16 v[36:39], v[68:71], v[96:99], v[36:39]
    s_add_u32 m0, s73, 0
    v_mfma_f32_16x16x32_bf16 v[36:39], v[64:67], v[100:103], v[36:39]
    buffer_load_dwordx4 v5, s[52:55], s14 offen offset:1024 lds
    ds_read2_b32 v[128:129], v236 offset0:48 offset1:49
    v_mfma_f32_16x16x32_bf16 v[40:43], v[64:67], v[104:107], v[40:43]
    ds_read2_b32 v[130:131], v236 offset0:50 offset1:51
    v_mfma_f32_16x16x32_bf16 v[40:43], v[68:71], v[100:103], v[40:43]
    v_mfma_f32_16x16x32_bf16 v[40:43], v[72:75], v[96:99], v[40:43]
    ds_read_b128 v[164:167], v247 offset:6144
    v_mfma_f32_16x16x32_bf16 v[44:47], v[76:79], v[96:99], v[44:47]
    ds_read2_b32 v[132:133], v236 offset0:176 offset1:177
    v_mfma_f32_16x16x32_bf16 v[44:47], v[72:75], v[100:103], v[44:47]
    v_mfma_f32_16x16x32_bf16 v[44:47], v[68:71], v[104:107], v[44:47]
    s_add_u32 m0, s73, 0
    ds_read2_b32 v[134:135], v236 offset0:178 offset1:179
    v_mfma_f32_16x16x32_bf16 v[44:47], v[64:67], v[108:111], v[44:47]
    buffer_load_dwordx4 v6, s[52:55], s14 offen offset:2048 lds
    ds_read_b128 v[168:171], v247 offset:10240
    s_waitcnt lgkmcnt(7)
    v_mfma_f32_16x16x32_bf16 v[48:51], v[64:67], v[112:115], v[48:51]
    ds_read2_b32 v[136:137], v237 offset0:48 offset1:49
    v_mfma_f32_16x16x32_bf16 v[48:51], v[68:71], v[108:111], v[48:51]
    ds_read2_b32 v[138:139], v237 offset0:50 offset1:51
    v_mfma_f32_16x16x32_bf16 v[48:51], v[72:75], v[104:107], v[48:51]
    ds_read_b128 v[172:175], v247 offset:14336
    v_mfma_f32_16x16x32_bf16 v[48:51], v[76:79], v[100:103], v[48:51]
    ds_read2_b32 v[140:141], v237 offset0:176 offset1:177
    v_mfma_f32_16x16x32_bf16 v[48:51], v[80:83], v[96:99], v[48:51]
    ds_read2_b32 v[142:143], v237 offset0:178 offset1:179
    s_waitcnt vmcnt(12)
    s_barrier
    v_mfma_f32_16x16x32_bf16 v[52:55], v[84:87], v[96:99], v[52:55]
    ds_read_b64_tr_b16 a[176:177], v10 offset:16384
    s_add_u32 m0, s73, 0
    v_mfma_f32_16x16x32_bf16 v[52:55], v[80:83], v[100:103], v[52:55]
    buffer_load_dwordx4 v7, s[52:55], s14 offen offset:3072 lds
    ds_read_b128 v[176:179], v247 offset:18432
    v_mfma_f32_16x16x32_bf16 v[52:55], v[76:79], v[104:107], v[52:55]
    ds_read_b64_tr_b16 a[178:179], v10 offset:18432
    v_mfma_f32_16x16x32_bf16 v[52:55], v[72:75], v[108:111], v[52:55]
    ds_read_b64_tr_b16 a[184:185], v10 offset:20480
    v_mfma_f32_16x16x32_bf16 v[52:55], v[68:71], v[112:115], v[52:55]
    ds_read2_b32 v[144:145], v238 offset0:48 offset1:49
    v_mfma_f32_16x16x32_bf16 v[52:55], v[64:67], v[116:119], v[52:55]
    ds_read_b64_tr_b16 a[186:187], v10 offset:22528
    v_mfma_f32_16x16x32_bf16 v[56:59], v[64:67], v[120:123], v[56:59]
    ds_read_b64_tr_b16 a[180:181], v11 offset:16384
    v_mfma_f32_16x16x32_bf16 v[56:59], v[68:71], v[116:119], v[56:59]
    ds_read2_b32 v[146:147], v238 offset0:50 offset1:51
    v_mfma_f32_16x16x32_bf16 v[56:59], v[72:75], v[112:115], v[56:59]
    ds_read_b64_tr_b16 a[182:183], v11 offset:18432
    v_mfma_f32_16x16x32_bf16 v[56:59], v[76:79], v[108:111], v[56:59]
    ds_read_b64_tr_b16 a[188:189], v11 offset:20480
    v_mfma_f32_16x16x32_bf16 v[56:59], v[80:83], v[104:107], v[56:59]
    ds_read_b64_tr_b16 a[190:191], v11 offset:22528
    v_mfma_f32_16x16x32_bf16 v[56:59], v[84:87], v[100:103], v[56:59]
    ds_read_b128 v[180:183], v247 offset:22528
    v_mfma_f32_16x16x32_bf16 v[56:59], v[88:91], v[96:99], v[56:59]
    ds_read2_b32 v[148:149], v238 offset0:176 offset1:177
    v_mfma_f32_16x16x32_bf16 v[60:63], v[92:95], v[96:99], v[60:63]
    ds_read2_b32 v[150:151], v238 offset0:178 offset1:179
    v_mfma_f32_16x16x32_bf16 v[60:63], v[88:91], v[100:103], v[60:63]
    ds_read_b128 v[184:187], v247 offset:26624
    v_mfma_f32_16x16x32_bf16 v[60:63], v[84:87], v[104:107], v[60:63]
    ds_read2_b32 v[152:153], v239 offset0:48 offset1:49
    v_mfma_f32_16x16x32_bf16 v[60:63], v[80:83], v[108:111], v[60:63]
    ds_read2_b32 v[154:155], v239 offset0:50 offset1:51
    v_mfma_f32_16x16x32_bf16 v[60:63], v[76:79], v[112:115], v[60:63]
    ds_read_b128 v[188:191], v247 offset:30720
    s_waitcnt lgkmcnt(7)
    s_barrier
    v_mfma_f32_16x16x32_bf16 v[60:63], v[72:75], v[116:119], v[60:63]
    ds_read2_b32 v[156:157], v239 offset0:176 offset1:177
    v_mfma_f32_16x16x32_bf16 v[60:63], v[68:71], v[120:123], v[60:63]
    ds_read2_b32 v[158:159], v239 offset0:178 offset1:179
    v_mfma_f32_16x16x32_bf16 v[60:63], v[64:67], v[124:127], v[60:63]
    v_mfma_f32_16x16x32_bf16 v[32:35], v[128:131], v[160:163], v[32:35]
    s_lshl_b32 s14, s98, 18
    ds_read_b128 v[96:99], v244 offset:0
    v_mfma_f32_16x16x32_bf16 v[36:39], v[132:135], v[160:163], v[36:39]
    s_add_u32 m0, s73, 16384
    v_mfma_f32_16x16x32_bf16 v[36:39], v[128:131], v[164:167], v[36:39]
    buffer_load_dwordx4 v4, s[52:55], s14 offen offset:0 lds
    ds_read2_b32 v[64:65], v236 offset0:64 offset1:65
    v_mfma_f32_16x16x32_bf16 v[40:43], v[128:131], v[168:171], v[40:43]
    ds_read2_b32 v[66:67], v236 offset0:66 offset1:67
    v_mfma_f32_16x16x32_bf16 v[40:43], v[132:135], v[164:167], v[40:43]
    v_mfma_f32_16x16x32_bf16 v[40:43], v[136:139], v[160:163], v[40:43]
    ds_read_b128 v[100:103], v244 offset:4096
    v_mfma_f32_16x16x32_bf16 v[44:47], v[140:143], v[160:163], v[44:47]
    ds_read2_b32 v[68:69], v236 offset0:192 offset1:193
    v_mfma_f32_16x16x32_bf16 v[44:47], v[136:139], v[164:167], v[44:47]
    ds_read2_b32 v[70:71], v236 offset0:194 offset1:195
    v_mfma_f32_16x16x32_bf16 v[44:47], v[132:135], v[168:171], v[44:47]
    s_add_u32 m0, s73, 16384
    ds_read_b128 v[104:107], v244 offset:8192
    v_mfma_f32_16x16x32_bf16 v[44:47], v[128:131], v[172:175], v[44:47]
    buffer_load_dwordx4 v5, s[52:55], s14 offen offset:1024 lds
    ds_read2_b32 v[72:73], v237 offset0:64 offset1:65
    s_waitcnt lgkmcnt(8)
    v_mfma_f32_16x16x32_bf16 v[48:51], v[128:131], v[176:179], v[48:51]
    ds_read2_b32 v[74:75], v237 offset0:66 offset1:67
    v_mfma_f32_16x16x32_bf16 v[48:51], v[132:135], v[172:175], v[48:51]
    ds_read_b128 v[108:111], v244 offset:12288
    v_mfma_f32_16x16x32_bf16 v[48:51], v[136:139], v[168:171], v[48:51]
    ds_read2_b32 v[76:77], v237 offset0:192 offset1:193
    v_mfma_f32_16x16x32_bf16 v[48:51], v[140:143], v[164:167], v[48:51]
    ds_read2_b32 v[78:79], v237 offset0:194 offset1:195
    v_mfma_f32_16x16x32_bf16 v[48:51], v[144:147], v[160:163], v[48:51]
    ds_read_b128 v[112:115], v244 offset:16384
    v_mfma_f32_16x16x32_bf16 v[52:55], v[148:151], v[160:163], v[52:55]
    s_add_u32 m0, s73, 16384
    ds_read2_b32 v[80:81], v238 offset0:64 offset1:65
    v_mfma_f32_16x16x32_bf16 v[52:55], v[144:147], v[164:167], v[52:55]
    buffer_load_dwordx4 v6, s[52:55], s14 offen offset:2048 lds
    ds_read2_b32 v[82:83], v238 offset0:66 offset1:67
    v_mfma_f32_16x16x32_bf16 v[52:55], v[140:143], v[168:171], v[52:55]
    ds_read_b128 v[116:119], v244 offset:20480
    v_mfma_f32_16x16x32_bf16 v[52:55], v[136:139], v[172:175], v[52:55]
    ds_read2_b32 v[84:85], v238 offset0:192 offset1:193
    v_mfma_f32_16x16x32_bf16 v[52:55], v[132:135], v[176:179], v[52:55]
    ds_read2_b32 v[86:87], v238 offset0:194 offset1:195
    v_mfma_f32_16x16x32_bf16 v[52:55], v[128:131], v[180:183], v[52:55]
    ds_read_b128 v[120:123], v244 offset:24576
    v_mfma_f32_16x16x32_bf16 v[56:59], v[128:131], v[184:187], v[56:59]
    ds_read2_b32 v[88:89], v239 offset0:64 offset1:65
    s_waitcnt vmcnt(7)
    s_barrier
    v_mfma_f32_16x16x32_bf16 v[56:59], v[132:135], v[180:183], v[56:59]
    v_add_u32 v10, 131072, v10
    s_add_u32 m0, s73, 16384
    v_mfma_f32_16x16x32_bf16 v[56:59], v[136:139], v[176:179], v[56:59]
    ds_read_b64_tr_b16 a[192:193], v10 offset:16384
    buffer_load_dwordx4 v7, s[52:55], s14 offen offset:3072 lds
    v_mfma_f32_16x16x32_bf16 v[56:59], v[140:143], v[172:175], v[56:59]
    ds_read2_b32 v[90:91], v239 offset0:66 offset1:67
    v_mfma_f32_16x16x32_bf16 v[56:59], v[144:147], v[168:171], v[56:59]
    ds_read_b64_tr_b16 a[194:195], v10 offset:18432
    v_mfma_f32_16x16x32_bf16 v[56:59], v[148:151], v[164:167], v[56:59]
    ds_read_b64_tr_b16 a[200:201], v10 offset:20480
    v_mfma_f32_16x16x32_bf16 v[56:59], v[152:155], v[160:163], v[56:59]
    ds_read_b64_tr_b16 a[202:203], v10 offset:22528
    v_mfma_f32_16x16x32_bf16 v[60:63], v[156:159], v[160:163], v[60:63]
    ds_read_b128 v[124:127], v244 offset:28672
    v_add_u32 v11, 131072, v11
    v_mfma_f32_16x16x32_bf16 v[60:63], v[152:155], v[164:167], v[60:63]
    ds_read_b64_tr_b16 a[196:197], v11 offset:16384
    v_mfma_f32_16x16x32_bf16 v[60:63], v[148:151], v[168:171], v[60:63]
    ds_read2_b32 v[92:93], v239 offset0:192 offset1:193
    v_mfma_f32_16x16x32_bf16 v[60:63], v[144:147], v[172:175], v[60:63]
    ds_read_b64_tr_b16 a[198:199], v11 offset:18432
    v_mfma_f32_16x16x32_bf16 v[60:63], v[140:143], v[176:179], v[60:63]
    ds_read_b64_tr_b16 a[204:205], v11 offset:20480
    v_mfma_f32_16x16x32_bf16 v[60:63], v[136:139], v[180:183], v[60:63]
    ds_read_b64_tr_b16 a[206:207], v11 offset:22528
    v_mfma_f32_16x16x32_bf16 v[60:63], v[132:135], v[184:187], v[60:63]
    ds_read2_b32 v[94:95], v239 offset0:194 offset1:195
    v_mfma_f32_16x16x32_bf16 v[60:63], v[128:131], v[188:191], v[60:63]
    s_waitcnt lgkmcnt(15)
    v_mfma_f32_16x16x32_bf16 v[32:35], v[64:67], v[96:99], v[32:35]
    ds_read_b128 v[160:163], v245 offset:0
    v_mfma_f32_16x16x32_bf16 v[36:39], v[68:71], v[96:99], v[36:39]
    v_mfma_f32_16x16x32_bf16 v[36:39], v[64:67], v[100:103], v[36:39]
    ds_read2_b32 v[128:129], v236 offset0:80 offset1:81
    v_mfma_f32_16x16x32_bf16 v[40:43], v[64:67], v[104:107], v[40:43]
    ds_read2_b32 v[130:131], v236 offset0:82 offset1:83
    s_waitcnt lgkmcnt(4)
    s_barrier
    v_mfma_f32_16x16x32_bf16 v[40:43], v[68:71], v[100:103], v[40:43]
    v_mfma_f32_16x16x32_bf16 v[40:43], v[72:75], v[96:99], v[40:43]
    ds_read_b128 v[164:167], v245 offset:4096
    v_mfma_f32_16x16x32_bf16 v[44:47], v[76:79], v[96:99], v[44:47]
    ds_read2_b32 v[132:133], v236 offset0:208 offset1:209
    v_mfma_f32_16x16x32_bf16 v[44:47], v[72:75], v[100:103], v[44:47]
    s_lshl_b32 s14, s99, 18
    v_mfma_f32_16x16x32_bf16 v[44:47], v[68:71], v[104:107], v[44:47]
    s_add_u32 m0, s73, 147456
    ds_read2_b32 v[134:135], v236 offset0:210 offset1:211
    v_mfma_f32_16x16x32_bf16 v[44:47], v[64:67], v[108:111], v[44:47]
    buffer_load_dwordx4 v4, s[52:55], s14 offen offset:0 lds
    ds_read_b128 v[168:171], v245 offset:8192
    s_waitcnt lgkmcnt(7)
    v_mfma_f32_16x16x32_bf16 v[48:51], v[64:67], v[112:115], v[48:51]
    ds_read2_b32 v[136:137], v237 offset0:80 offset1:81
    v_mfma_f32_16x16x32_bf16 v[48:51], v[68:71], v[108:111], v[48:51]
    v_mfma_f32_16x16x32_bf16 v[48:51], v[72:75], v[104:107], v[48:51]
    ds_read2_b32 v[138:139], v237 offset0:82 offset1:83
    v_mfma_f32_16x16x32_bf16 v[48:51], v[76:79], v[100:103], v[48:51]
    ds_read_b128 v[172:175], v245 offset:12288
    v_mfma_f32_16x16x32_bf16 v[48:51], v[80:83], v[96:99], v[48:51]
    v_mfma_f32_16x16x32_bf16 v[52:55], v[84:87], v[96:99], v[52:55]
    s_add_u32 m0, s73, 147456
    ds_read2_b32 v[140:141], v237 offset0:208 offset1:209
    v_mfma_f32_16x16x32_bf16 v[52:55], v[80:83], v[100:103], v[52:55]
    buffer_load_dwordx4 v5, s[52:55], s14 offen offset:1024 lds
    ds_read2_b32 v[142:143], v237 offset0:210 offset1:211
    v_mfma_f32_16x16x32_bf16 v[52:55], v[76:79], v[104:107], v[52:55]
    v_mfma_f32_16x16x32_bf16 v[52:55], v[72:75], v[108:111], v[52:55]
    ds_read_b128 v[176:179], v245 offset:16384
    v_mfma_f32_16x16x32_bf16 v[52:55], v[68:71], v[112:115], v[52:55]
    ds_read2_b32 v[144:145], v238 offset0:80 offset1:81
    v_mfma_f32_16x16x32_bf16 v[52:55], v[64:67], v[116:119], v[52:55]
    ds_read2_b32 v[146:147], v238 offset0:82 offset1:83
    v_mfma_f32_16x16x32_bf16 v[56:59], v[64:67], v[120:123], v[56:59]
    ds_read_b128 v[180:183], v245 offset:20480
    v_mfma_f32_16x16x32_bf16 v[56:59], v[68:71], v[116:119], v[56:59]
    s_add_u32 m0, s73, 147456
    ds_read2_b32 v[148:149], v238 offset0:208 offset1:209
    v_mfma_f32_16x16x32_bf16 v[56:59], v[72:75], v[112:115], v[56:59]
    buffer_load_dwordx4 v6, s[52:55], s14 offen offset:2048 lds
    ds_read2_b32 v[150:151], v238 offset0:210 offset1:211
    v_mfma_f32_16x16x32_bf16 v[56:59], v[76:79], v[108:111], v[56:59]
    ds_read_b128 v[184:187], v245 offset:24576
    v_mfma_f32_16x16x32_bf16 v[56:59], v[80:83], v[104:107], v[56:59]
    ds_read2_b32 v[152:153], v239 offset0:80 offset1:81
    v_mfma_f32_16x16x32_bf16 v[56:59], v[84:87], v[100:103], v[56:59]
    ds_read2_b32 v[154:155], v239 offset0:82 offset1:83
    v_mfma_f32_16x16x32_bf16 v[56:59], v[88:91], v[96:99], v[56:59]
    ds_read_b128 v[188:191], v245 offset:28672
    v_mfma_f32_16x16x32_bf16 v[60:63], v[92:95], v[96:99], v[60:63]
    ds_read2_b32 v[156:157], v239 offset0:208 offset1:209
    s_waitcnt vmcnt(7)
    s_barrier
    v_mfma_f32_16x16x32_bf16 v[60:63], v[88:91], v[100:103], v[60:63]
    v_add_u32 v10, -131072, v10
    s_add_u32 m0, s73, 147456
    v_mfma_f32_16x16x32_bf16 v[60:63], v[84:87], v[104:107], v[60:63]
    buffer_load_dwordx4 v7, s[52:55], s14 offen offset:3072 lds
    ds_read2_b32 v[158:159], v239 offset0:210 offset1:211
    v_mfma_f32_16x16x32_bf16 v[60:63], v[80:83], v[108:111], v[60:63]
    ds_read_b64_tr_b16 a[208:209], v10 offset:0
    v_mfma_f32_16x16x32_bf16 v[60:63], v[76:79], v[112:115], v[60:63]
    ds_read_b64_tr_b16 a[210:211], v10 offset:2048
    v_mfma_f32_16x16x32_bf16 v[60:63], v[72:75], v[116:119], v[60:63]
    ds_read_b64_tr_b16 a[216:217], v10 offset:4096
    v_mfma_f32_16x16x32_bf16 v[60:63], v[68:71], v[120:123], v[60:63]
    ds_read_b64_tr_b16 a[218:219], v10 offset:6144
    v_mfma_f32_16x16x32_bf16 v[60:63], v[64:67], v[124:127], v[60:63]
    v_add_u32 v11, -131072, v11
    s_waitcnt lgkmcnt(15)
    v_mfma_f32_16x16x32_bf16 v[32:35], v[128:131], v[160:163], v[32:35]
    ds_read_b128 v[96:99], v246 offset:0
    v_mfma_f32_16x16x32_bf16 v[36:39], v[132:135], v[160:163], v[36:39]
    ds_read_b64_tr_b16 a[212:213], v11 offset:0
    v_mfma_f32_16x16x32_bf16 v[36:39], v[128:131], v[164:167], v[36:39]
    ds_read_b64_tr_b16 a[214:215], v11 offset:2048
    v_mfma_f32_16x16x32_bf16 v[40:43], v[128:131], v[168:171], v[40:43]
    ds_read_b64_tr_b16 a[220:221], v11 offset:4096
    v_mfma_f32_16x16x32_bf16 v[40:43], v[132:135], v[164:167], v[40:43]
    ds_read_b64_tr_b16 a[222:223], v11 offset:6144
    v_mfma_f32_16x16x32_bf16 v[40:43], v[136:139], v[160:163], v[40:43]
    ds_read2_b32 v[64:65], v236 offset0:96 offset1:97
    v_mfma_f32_16x16x32_bf16 v[44:47], v[140:143], v[160:163], v[44:47]
    ds_read2_b32 v[66:67], v236 offset0:98 offset1:99
    v_mfma_f32_16x16x32_bf16 v[44:47], v[136:139], v[164:167], v[44:47]
    ds_read_b128 v[100:103], v246 offset:4096
    v_mfma_f32_16x16x32_bf16 v[44:47], v[132:135], v[168:171], v[44:47]
    ds_read2_b32 v[68:69], v236 offset0:224 offset1:225
    v_mfma_f32_16x16x32_bf16 v[44:47], v[128:131], v[172:175], v[44:47]
    ds_read2_b32 v[70:71], v236 offset0:226 offset1:227
    s_waitcnt lgkmcnt(14)
    v_mfma_f32_16x16x32_bf16 v[48:51], v[128:131], v[176:179], v[48:51]
    ds_read_b128 v[104:107], v246 offset:8192
    s_waitcnt lgkmcnt(6)
    s_barrier
    v_mfma_f32_16x16x32_bf16 v[48:51], v[132:135], v[172:175], v[48:51]
    ds_read2_b32 v[72:73], v237 offset0:96 offset1:97
    v_mfma_f32_16x16x32_bf16 v[48:51], v[136:139], v[168:171], v[48:51]
    ds_read2_b32 v[74:75], v237 offset0:98 offset1:99
    v_mfma_f32_16x16x32_bf16 v[48:51], v[140:143], v[164:167], v[48:51]
    ds_read_b128 v[108:111], v246 offset:12288
    v_mfma_f32_16x16x32_bf16 v[48:51], v[144:147], v[160:163], v[48:51]
    s_lshl_b32 s14, s100, 18
    v_mfma_f32_16x16x32_bf16 v[52:55], v[148:151], v[160:163], v[52:55]
    s_add_u32 m0, s73, 0
    ds_read2_b32 v[76:77], v237 offset0:224 offset1:225
    v_mfma_f32_16x16x32_bf16 v[52:55], v[144:147], v[164:167], v[52:55]
    buffer_load_dwordx4 v4, s[52:55], s14 offen offset:0 lds
    ds_read2_b32 v[78:79], v237 offset0:226 offset1:227
    v_mfma_f32_16x16x32_bf16 v[52:55], v[140:143], v[168:171], v[52:55]
    v_mfma_f32_16x16x32_bf16 v[52:55], v[136:139], v[172:175], v[52:55]
    ds_read_b128 v[112:115], v246 offset:16384
    v_mfma_f32_16x16x32_bf16 v[52:55], v[132:135], v[176:179], v[52:55]
    ds_read2_b32 v[80:81], v238 offset0:96 offset1:97
    v_mfma_f32_16x16x32_bf16 v[52:55], v[128:131], v[180:183], v[52:55]
    v_mfma_f32_16x16x32_bf16 v[56:59], v[128:131], v[184:187], v[56:59]
    ds_read2_b32 v[82:83], v238 offset0:98 offset1:99
    v_mfma_f32_16x16x32_bf16 v[56:59], v[132:135], v[180:183], v[56:59]
    s_add_u32 m0, s73, 0
    ds_read_b128 v[116:119], v246 offset:20480
    v_mfma_f32_16x16x32_bf16 v[56:59], v[136:139], v[176:179], v[56:59]
    buffer_load_dwordx4 v5, s[52:55], s14 offen offset:1024 lds
    v_mfma_f32_16x16x32_bf16 v[56:59], v[140:143], v[172:175], v[56:59]
    ds_read2_b32 v[84:85], v238 offset0:224 offset1:225
    v_mfma_f32_16x16x32_bf16 v[56:59], v[144:147], v[168:171], v[56:59]
    ds_read2_b32 v[86:87], v238 offset0:226 offset1:227
    v_mfma_f32_16x16x32_bf16 v[56:59], v[148:151], v[164:167], v[56:59]
    ds_read_b128 v[120:123], v246 offset:24576
    v_mfma_f32_16x16x32_bf16 v[56:59], v[152:155], v[160:163], v[56:59]
    v_mfma_f32_16x16x32_bf16 v[60:63], v[156:159], v[160:163], v[60:63]
    ds_read2_b32 v[88:89], v239 offset0:96 offset1:97
    v_mfma_f32_16x16x32_bf16 v[60:63], v[152:155], v[164:167], v[60:63]
    s_add_u32 m0, s73, 0
    ds_read2_b32 v[90:91], v239 offset0:98 offset1:99
    v_mfma_f32_16x16x32_bf16 v[60:63], v[148:151], v[168:171], v[60:63]
    buffer_load_dwordx4 v6, s[52:55], s14 offen offset:2048 lds
    v_mfma_f32_16x16x32_bf16 v[60:63], v[144:147], v[172:175], v[60:63]
    ds_read_b128 v[124:127], v246 offset:28672
    v_mfma_f32_16x16x32_bf16 v[60:63], v[140:143], v[176:179], v[60:63]
    ds_read2_b32 v[92:93], v239 offset0:224 offset1:225
    v_mfma_f32_16x16x32_bf16 v[60:63], v[136:139], v[180:183], v[60:63]
    v_mfma_f32_16x16x32_bf16 v[60:63], v[132:135], v[184:187], v[60:63]
    ds_read2_b32 v[94:95], v239 offset0:226 offset1:227
    v_mfma_f32_16x16x32_bf16 v[60:63], v[128:131], v[188:191], v[60:63]
    s_waitcnt lgkmcnt(12)
    v_mfma_f32_16x16x32_bf16 v[32:35], v[64:67], v[96:99], v[32:35]
    ds_read_b128 v[160:163], v247 offset:0
    s_waitcnt vmcnt(7)
    s_barrier
    v_mfma_f32_16x16x32_bf16 v[36:39], v[68:71], v[96:99], v[36:39]
    ds_read_b64_tr_b16 a[224:225], v10 offset:16384
    s_add_u32 m0, s73, 0
    s_bfe_u32 s4, s2, 0x20003
    v_mfma_f32_16x16x32_bf16 v[36:39], v[64:67], v[100:103], v[36:39]
    ds_read_b64_tr_b16 a[226:227], v10 offset:18432
    buffer_load_dwordx4 v7, s[52:55], s14 offen offset:3072 lds
    ds_read_b128 v[164:167], v247 offset:4096
    v_mfma_f32_16x16x32_bf16 v[40:43], v[64:67], v[104:107], v[40:43]
    s_lshl2_add_u32 s4, s72, s4
    ds_read_b128 v[168:171], v247 offset:8192
    v_mfma_f32_16x16x32_bf16 v[40:43], v[68:71], v[100:103], v[40:43]
    ds_read_b64_tr_b16 a[232:233], v10 offset:20480
    ds_read_b128 v[172:175], v247 offset:12288
    v_mfma_f32_16x16x32_bf16 v[40:43], v[72:75], v[96:99], v[40:43]
    ds_read_b64_tr_b16 a[234:235], v10 offset:22528
    s_lshl_b32 s4, s4, 3
    v_mfma_f32_16x16x32_bf16 v[44:47], v[76:79], v[96:99], v[44:47]
    ds_read_b128 v[176:179], v247 offset:16384
    v_mfma_f32_16x16x32_bf16 v[44:47], v[72:75], v[100:103], v[44:47]
    ds_read_b64_tr_b16 a[228:229], v11 offset:16384
    s_lshr_b32 s5, s2, 4
    ds_read_b128 v[180:183], v247 offset:20480
    v_mfma_f32_16x16x32_bf16 v[44:47], v[68:71], v[104:107], v[44:47]
    ds_read_b64_tr_b16 a[230:231], v11 offset:18432
    v_mfma_f32_16x16x32_bf16 v[44:47], v[64:67], v[108:111], v[44:47]
    s_and_b32 s5, s5, 6
    ds_read_b128 v[184:187], v247 offset:24576
    s_waitcnt lgkmcnt(13)
    v_mfma_f32_16x16x32_bf16 v[48:51], v[64:67], v[112:115], v[48:51]
    ds_read_b64_tr_b16 a[236:237], v11 offset:20480
    ds_read_b128 v[188:191], v247 offset:28672
    v_mfma_f32_16x16x32_bf16 v[48:51], v[68:71], v[108:111], v[48:51]
    ds_read_b64_tr_b16 a[238:239], v11 offset:22528
    s_add_u32 s4, s4, s5
    v_mfma_f32_16x16x32_bf16 v[48:51], v[72:75], v[104:107], v[48:51]
    ds_read2_b32 v[128:129], v236 offset0:112 offset1:113
    v_mfma_f32_16x16x32_bf16 v[48:51], v[76:79], v[100:103], v[48:51]
    s_and_b32 s5, s2, 1
    ds_read2_b32 v[130:131], v236 offset0:114 offset1:115
    v_mfma_f32_16x16x32_bf16 v[48:51], v[80:83], v[96:99], v[48:51]
    ds_read2_b32 v[132:133], v236 offset0:240 offset1:241
    v_mfma_f32_16x16x32_bf16 v[52:55], v[84:87], v[96:99], v[52:55]
    s_add_u32 s4, s4, s5
    ds_read2_b32 v[134:135], v236 offset0:242 offset1:243
    v_mfma_f32_16x16x32_bf16 v[52:55], v[80:83], v[100:103], v[52:55]
    ds_read2_b32 v[136:137], v237 offset0:112 offset1:113
    v_mfma_f32_16x16x32_bf16 v[52:55], v[76:79], v[104:107], v[52:55]
    s_lshl_b32 s4, s4, 7
    ds_read2_b32 v[138:139], v237 offset0:114 offset1:115
    s_add_u32 s6, s12, 4767744
    v_mfma_f32_16x16x32_bf16 v[52:55], v[72:75], v[108:111], v[52:55]
    s_waitcnt lgkmcnt(6)
    s_barrier
    ds_read2_b32 v[140:141], v237 offset0:240 offset1:241
    s_add_u32 s4, s4, 12566528
    v_mfma_f32_16x16x32_bf16 v[52:55], v[68:71], v[112:115], v[52:55]
    ds_read2_b32 v[142:143], v237 offset0:242 offset1:243
    v_mfma_f32_16x16x32_bf16 v[52:55], v[64:67], v[116:119], v[52:55]
    ds_read2_b32 v[144:145], v238 offset0:112 offset1:113
    v_lshl_add_u32 v28, v2, 2, s4
    v_mfma_f32_16x16x32_bf16 v[56:59], v[64:67], v[120:123], v[56:59]
    s_lshl_b32 s14, s101, 18
    ds_read2_b32 v[146:147], v238 offset0:114 offset1:115
    v_mfma_f32_16x16x32_bf16 v[56:59], v[68:71], v[116:119], v[56:59]
    s_add_u32 m0, s73, 16384
    s_cmp_eq_u32 s3, 0
    s_cselect_b32 s4, 18, 0
    v_mfma_f32_16x16x32_bf16 v[56:59], v[72:75], v[112:115], v[56:59]
    buffer_load_dwordx4 v4, s[52:55], s14 offen offset:0 lds
    ds_read2_b32 v[148:149], v238 offset0:240 offset1:241
    v_mfma_f32_16x16x32_bf16 v[56:59], v[76:79], v[108:111], v[56:59]
    ds_read2_b32 v[150:151], v238 offset0:242 offset1:243
    v_cmp_gt_u32 vcc, s4, v2
    v_mfma_f32_16x16x32_bf16 v[56:59], v[80:83], v[104:107], v[56:59]
    ds_read2_b32 v[152:153], v239 offset0:112 offset1:113
    v_mfma_f32_16x16x32_bf16 v[56:59], v[84:87], v[100:103], v[56:59]
    ds_read2_b32 v[154:155], v239 offset0:114 offset1:115
    v_mov_b32 v13, 0x40000000
    v_mfma_f32_16x16x32_bf16 v[56:59], v[88:91], v[96:99], v[56:59]
    ds_read2_b32 v[156:157], v239 offset0:240 offset1:241
    v_mfma_f32_16x16x32_bf16 v[60:63], v[92:95], v[96:99], v[60:63]
    ds_read2_b32 v[158:159], v239 offset0:242 offset1:243
    v_cndmask_b32 v28, v13, v28, vcc
    v_mfma_f32_16x16x32_bf16 v[60:63], v[88:91], v[100:103], v[60:63]
    s_add_u32 m0, s73, 16384
    v_mfma_f32_16x16x32_bf16 v[60:63], v[84:87], v[104:107], v[60:63]
    buffer_load_dwordx4 v5, s[52:55], s14 offen offset:1024 lds
    v_mov_b32 v13, s68
    v_mfma_f32_16x16x32_bf16 v[60:63], v[80:83], v[108:111], v[60:63]
    v_mfma_f32_16x16x32_bf16 v[60:63], v[76:79], v[112:115], v[60:63]
    v_cndmask_b32 v13, 0, v13, vcc
    v_mfma_f32_16x16x32_bf16 v[60:63], v[72:75], v[116:119], v[60:63]
    v_mfma_f32_16x16x32_bf16 v[60:63], v[68:71], v[120:123], v[60:63]
    v_mfma_f32_16x16x32_bf16 v[60:63], v[64:67], v[124:127], v[60:63]
    s_waitcnt lgkmcnt(0)
    v_mfma_f32_16x16x32_bf16 v[60:63], v[128:131], v[188:191], v[60:63]
    v_mfma_f32_16x16x32_bf16 v[60:63], v[132:135], v[184:187], v[60:63]
    s_add_u32 m0, s73, 16384
    v_mfma_f32_16x16x32_bf16 v[60:63], v[136:139], v[180:183], v[60:63]
    buffer_load_dwordx4 v6, s[52:55], s14 offen offset:2048 lds
    v_mfma_f32_16x16x32_bf16 v[60:63], v[140:143], v[176:179], v[60:63]
    v_mfma_f32_16x16x32_bf16 v[60:63], v[144:147], v[172:175], v[60:63]
    v_mfma_f32_16x16x32_bf16 v[60:63], v[148:151], v[168:171], v[60:63]
    v_mfma_f32_16x16x32_bf16 v[60:63], v[152:155], v[164:167], v[60:63]
    v_mfma_f32_16x16x32_bf16 v[60:63], v[156:159], v[160:163], v[60:63]
    s_waitcnt vmcnt(7)
    s_barrier
    v_mfma_f32_16x16x32_bf16 v[56:59], v[128:131], v[184:187], v[56:59]
L_pl_X_6:
    s_cbranch_execz L_wret
    v_add_u32 v10, 131072, v10
    s_add_u32 m0, s73, 16384
    v_mfma_f32_16x16x32_bf16 v[56:59], v[132:135], v[180:183], v[56:59]
    ds_read_b64_tr_b16 a[240:241], v10 offset:16384
    buffer_load_dwordx4 v7, s[52:55], s14 offen offset:3072 lds
    v_mfma_f32_16x16x32_bf16 v[56:59], v[136:139], v[176:179], v[56:59]
    ds_read_b64_tr_b16 a[242:243], v10 offset:18432
    v_mfma_f32_16x16x32_bf16 v[56:59], v[140:143], v[172:175], v[56:59]
    ds_read_b64_tr_b16 a[248:249], v10 offset:20480
    v_mfma_f32_16x16x32_bf16 v[56:59], v[144:147], v[168:171], v[56:59]
    v_mfma_f32_16x16x32_bf16 v[56:59], v[148:151], v[164:167], v[56:59]
    ds_read_b64_tr_b16 a[250:251], v10 offset:22528
    v_cvt_pk_bf16_f32 v206, v60, v61
    v_mfma_f32_16x16x32_bf16 v[56:59], v[152:155], v[160:163], v[56:59]
    v_add_u32 v11, 131072, v11
    v_mfma_f32_16x16x32_bf16 v[52:55], v[128:131], v[180:183], v[52:55]
    ds_read_b64_tr_b16 a[244:245], v11 offset:16384
    v_mfma_f32_16x16x32_bf16 v[52:55], v[132:135], v[176:179], v[52:55]
    ds_read_b64_tr_b16 a[246:247], v11 offset:18432
    v_cvt_pk_bf16_f32 v207, v62, v63
    v_mfma_f32_16x16x32_bf16 v[52:55], v[136:139], v[172:175], v[52:55]
    ds_read_b64_tr_b16 a[252:253], v11 offset:20480
    v_mfma_f32_16x16x32_bf16 v[52:55], v[140:143], v[168:171], v[52:55]
    buffer_store_dwordx2 v[206:207], v8, s[44:47], s6 offen offset:3584 sc1
    ds_read_b64_tr_b16 a[254:255], v11 offset:22528
    v_mfma_f32_16x16x32_bf16 v[52:55], v[144:147], v[164:167], v[52:55]
    v_mfma_f32_16x16x32_bf16 v[52:55], v[148:151], v[160:163], v[52:55]
    v_mfma_f32_16x16x32_bf16 v[48:51], v[128:131], v[176:179], v[48:51]
    v_cvt_pk_bf16_f32 v204, v56, v57
    v_mfma_f32_16x16x32_bf16 v[48:51], v[132:135], v[172:175], v[48:51]
    v_mfma_f32_16x16x32_bf16 v[48:51], v[136:139], v[168:171], v[48:51]
    v_mfma_f32_16x16x32_bf16 v[48:51], v[140:143], v[164:167], v[48:51]
    v_cvt_pk_bf16_f32 v205, v58, v59
    v_mfma_f32_16x16x32_bf16 v[48:51], v[144:147], v[160:163], v[48:51]
    v_mfma_f32_16x16x32_bf16 v[44:47], v[128:131], v[172:175], v[44:47]
    buffer_store_dwordx2 v[204:205], v8, s[44:47], s6 offen offset:3072 sc1
    v_mfma_f32_16x16x32_bf16 v[44:47], v[132:135], v[168:171], v[44:47]
    v_mfma_f32_16x16x32_bf16 v[44:47], v[136:139], v[164:167], v[44:47]
    v_mfma_f32_16x16x32_bf16 v[44:47], v[140:143], v[160:163], v[44:47]
    v_cvt_pk_bf16_f32 v202, v52, v53
    v_mfma_f32_16x16x32_bf16 v[40:43], v[128:131], v[168:171], v[40:43]
    v_mfma_f32_16x16x32_bf16 v[40:43], v[132:135], v[164:167], v[40:43]
    v_mfma_f32_16x16x32_bf16 v[40:43], v[136:139], v[160:163], v[40:43]
    v_cvt_pk_bf16_f32 v203, v54, v55
    v_mfma_f32_16x16x32_bf16 v[36:39], v[128:131], v[164:167], v[36:39]
    v_mfma_f32_16x16x32_bf16 v[36:39], v[132:135], v[160:163], v[36:39]
    buffer_store_dwordx2 v[202:203], v8, s[44:47], s6 offen offset:2560 sc1
    v_mfma_f32_16x16x32_bf16 v[32:35], v[128:131], v[160:163], v[32:35]
    v_mov_b32 v29, 0
    buffer_atomic_add v29, v28, s[44:47], 0 offen sc0 sc1
    v_cvt_pk_bf16_f32 v200, v48, v49
    v_cvt_pk_bf16_f32 v201, v50, v51
    buffer_store_dwordx2 v[200:201], v8, s[44:47], s6 offen offset:2048 sc1
    v_cvt_pk_bf16_f32 v198, v44, v45
    v_cvt_pk_bf16_f32 v199, v46, v47
    buffer_store_dwordx2 v[198:199], v8, s[44:47], s6 offen offset:1536 sc1
    v_cvt_pk_bf16_f32 v196, v40, v41
    v_cvt_pk_bf16_f32 v197, v42, v43
    buffer_store_dwordx2 v[196:197], v8, s[44:47], s6 offen offset:1024 sc1
    v_cvt_pk_bf16_f32 v194, v36, v37
    v_cvt_pk_bf16_f32 v195, v38, v39
    buffer_store_dwordx2 v[194:195], v8, s[44:47], s6 offen offset:512 sc1
    v_cvt_pk_bf16_f32 v192, v32, v33
    v_cvt_pk_bf16_f32 v193, v34, v35
    buffer_store_dwordx2 v[192:193], v8, s[44:47], s6 offen offset:0 sc1
    v_add_u32 v10, -131072, v10
    v_add_u32 v11, -131072, v11
    s_waitcnt lgkmcnt(0)
    s_barrier
L_DX:
    s_waitcnt vmcnt(0)
    v_cmp_ne_u32 vcc, v13, v29
    s_cbranch_vccnz L_rs_p2X
L_ok_p2X:
    s_barrier
    s_add_u32 m0, s73, 97536
    s_nop 0
    buffer_load_dwordx4 v23, s[44:47], s18 offen offset:768 sc1 lds
    s_add_u32 m0, s73, 99328
    s_nop 0
    buffer_load_dwordx4 v20, s[44:47], s18 offen offset:0 sc1 lds
    s_add_u32 m0, s73, 99840
    s_nop 0
    buffer_load_dwordx4 v20, s[44:47], s18 offen offset:512 sc1 lds
    s_add_u32 m0, s73, 100608
    s_nop 0
    buffer_load_dwordx4 v23, s[44:47], s19 offen offset:768 sc1 lds
    s_add_u32 m0, s73, 114688
    s_nop 0
    buffer_load_dwordx4 v20, s[44:47], s19 offen offset:0 sc1 lds
    s_add_u32 m0, s73, 115200
    s_nop 0
    buffer_load_dwordx4 v20, s[44:47], s19 offen offset:512 sc1 lds
    s_add_u32 m0, s73, 115968
    s_nop 0
    buffer_load_dwordx4 v23, s[44:47], s20 offen offset:768 sc1 lds
    s_add_u32 m0, s73, 117760
    s_nop 0
    buffer_load_dwordx4 v20, s[44:47], s20 offen offset:0 sc1 lds
    s_mov_b32 s56, s16
    s_and_b32 s57, s17, 0xffff
    s_mov_b32 s58, 2359296
    s_mov_b32 s59, 0x20000
    s_mov_b32 s40, 18432
    s_mov_b32 s42, 12386304
    s_mov_b32 s64, s38
    s_and_b32 s65, s39, 0xffff
    s_mov_b32 s66, 2359296
    s_mov_b32 s67, 0x20000
    v_lshlrev_b32 v136, 4, v2
    s_mul_i32 s7, s72, 36
    s_bitcmp1_b32 s3, 0
    s_addc_u32 s7, s7, 0
    s_lshl_b32 s7, s7, 17
    v_subrev_u32 v184, s7, v4
    v_subrev_u32 v185, s7, v5
    s_bfe_u32 s4, s2, 0x20003
    s_mul_i32 s4, s4, 9
    s_lshl1_add_u32 s7, s72, s4
    s_and_b32 s8, s3, 1
    s_add_u32 s7, s7, s8
    s_lshl_b32 s37, s7, 16
    s_add_u32 s37, s37, 4718592
    s_add_u32 s4, s4, 8
    s_lshl_b32 s16, s4, 16
    s_add_u32 s16, s16, 4718592
    s_sub_u32 s4, s4, s7
    s_lshl_b32 s4, s4, 7
    s_lshl_b32 s7, s7, 7
    s_add_u32 s7, s7, 12582912
    v_bfe_u32 v24, v2, 2, 1
    v_mul_u32_u24 v24, s4, v24
    v_and_b32 v25, 3, v2
    v_lshl_add_u32 v24, v25, 2, v24
    v_add_u32 v188, s7, v24
    s_lshl2_add_u32 s7, s2, s3
    s_mul_i32 s8, s7, 3072
    s_add_u32 s34, s8, 22953984
    s_add_u32 s11, s8, 26099712
    s_add_u32 s12, s8, 29245440
    s_lshl_b32 s35, s7, 12
    s_add_u32 s35, s35, 32391168
    s_xor_b32 s8, s7, 8
    s_mul_i32 s8, s8, 3072
    s_add_u32 s30, s8, 22953984
    s_xor_b32 s8, s7, 16
    s_mul_i32 s8, s8, 3072
    s_add_u32 s15, s8, 26099712
    s_xor_b32 s8, s7, 24
    s_mul_i32 s8, s8, 3072
    s_add_u32 s31, s8, 29245440
    s_andn2_b32 s7, s7, 24
    s_lshl3_add_u32 s7, s3, s7
    s_lshl2_add_u32 s8, s7, s72
    s_lshl_b32 s8, s8, 10
    s_add_u32 s32, s8, 32391168
    s_xor_b32 s8, s8, 4096
    s_add_u32 s33, s8, 32391168
    s_xor_b32 s8, s3, s72
    s_cmp_lt_u32 s8, 2
    s_cselect_b32 s35, s35, 0x40000000
    s_cselect_b32 s16, s16, 0x40000000
    s_cselect_b32 s36, s68, 0
    s_mov_b32 s38, 0xbfb8aa3b
    s_and_b32 s8, s8, 1
    s_mul_i32 s41, s8, 96
    s_and_b32 s43, s73, 4096
    v_lshlrev_b32 v24, 10, v2
    v_add_u32 v24, s35, v24
    s_add_u32 s7, s34, 2048
    v_mov_b32 v25, s36
    v_cmp_gt_u32 vcc, 4, v2
    s_nop 1
    v_cndmask_b32 v138, 0, v25, vcc
    v_mov_b32 v25, 0x40000000
    v_cndmask_b32 v137, v25, v24, vcc
    v_writelane_b32 v137, s7, 4
    v_writelane_b32 v138, s68, 4
    v_min_u32 v139, 1, v2
    v_lshlrev_b32 v139, 30, v139
    v_mov_b32 v140, 0
    v_writelane_b32 v140, s68, 0
    v_mov_b32 v195, s68
    v_mov_b32 v199, s68
    v_mov_b32 v202, s68
    v_mov_b32 v203, s68
    s_waitcnt vmcnt(4)
    s_barrier
    ds_read_b128 v[104:107], v14 offset:0
    ds_read_b128 v[108:111], v14 offset:4096
    ds_read_b128 v[112:115], v14 offset:8192
    ds_read_b128 v[116:119], v14 offset:12288
    s_waitcnt lgkmcnt(2)
    v_mfma_f32_16x16x32_bf16 v[32:35], v[104:107], a[0:3], 0
    s_add_u32 m0, s73, 130560
    s_sub_u32 s4, s75, 216
    s_lshl_b32 s7, s4, 7
    v_mfma_f32_16x16x32_bf16 v[32:35], v[108:111], a[8:11], v[32:35]
    buffer_load_dwordx4 v20, s[44:47], s20 offen offset:512 sc1 lds
    s_waitcnt lgkmcnt(0)
    v_mfma_f32_16x16x32_bf16 v[32:35], v[112:115], a[16:19], v[32:35]
    ds_read_b128 v[120:123], v14 offset:1024
    s_lshl2_add_u32 s7, s3, s7
    s_add_u32 s7, s7, 12582912
    v_mfma_f32_16x16x32_bf16 v[32:35], v[116:119], a[24:27], v[32:35]
    ds_read_b128 v[124:127], v14 offset:5120
    v_mfma_f32_16x16x32_bf16 v[36:39], v[116:119], a[28:31], 0
    ds_read_b128 v[128:131], v14 offset:9216
    s_cmp_lt_u32 s4, 36
    s_cselect_b32 s7, s7, 0x40000000
    v_mfma_f32_16x16x32_bf16 v[36:39], v[112:115], a[20:23], v[36:39]
    ds_read_b128 v[132:135], v14 offset:13312
    v_min_u32 v28, 1, v2
    v_mfma_f32_16x16x32_bf16 v[36:39], v[108:111], a[12:15], v[36:39]
    s_add_u32 m0, s73, 131328
    v_lshlrev_b32 v28, 30, v28
    v_mov_b32 v29, s68
    v_mfma_f32_16x16x32_bf16 v[36:39], v[104:107], a[4:7], v[36:39]
    buffer_load_dwordx4 v23, s[44:47], s21 offen offset:768 sc1 lds
    s_waitcnt lgkmcnt(2)
    v_mfma_f32_16x16x32_bf16 v[44:47], v[120:123], a[4:7], 0
    buffer_store_dword v29, v28, s[44:47], s7 offen sc1
    s_add_u32 m0, s73, 133120
    v_mfma_f32_16x16x32_bf16 v[44:47], v[124:127], a[12:15], v[44:47]
    buffer_load_dwordx4 v20, s[44:47], s21 offen offset:0 sc1 lds
    s_waitcnt lgkmcnt(0)
    v_mfma_f32_16x16x32_bf16 v[44:47], v[128:131], a[20:23], v[44:47]
    ds_read_b128 v[104:107], v14 offset:2048
    v_mfma_f32_16x16x32_bf16 v[44:47], v[132:135], a[28:31], v[44:47]
    ds_read_b128 v[108:111], v14 offset:6144
    v_mfma_f32_16x16x32_bf16 v[40:43], v[132:135], a[24:27], 0
    ds_read_b128 v[112:115], v14 offset:10240
    v_mfma_f32_16x16x32_bf16 v[40:43], v[128:131], a[16:19], v[40:43]
    ds_read_b128 v[116:119], v14 offset:14336
    v_mfma_f32_16x16x32_bf16 v[40:43], v[124:127], a[8:11], v[40:43]
    s_add_u32 m0, s73, 133632
    v_mfma_f32_16x16x32_bf16 v[40:43], v[120:123], a[0:3], v[40:43]
    buffer_load_dwordx4 v20, s[44:47], s21 offen offset:512 sc1 lds
    s_waitcnt lgkmcnt(2)
    v_mfma_f32_16x16x32_bf16 v[48:51], v[104:107], a[0:3], 0
    s_add_u32 m0, s73, 146688
    v_mfma_f32_16x16x32_bf16 v[48:51], v[108:111], a[8:11], v[48:51]
    buffer_load_dwordx4 v23, s[44:47], s22 offen offset:768 sc1 lds
    s_waitcnt lgkmcnt(0)
    v_mfma_f32_16x16x32_bf16 v[48:51], v[112:115], a[16:19], v[48:51]
    ds_read_b128 v[120:123], v14 offset:3072
    v_mfma_f32_16x16x32_bf16 v[48:51], v[116:119], a[24:27], v[48:51]
    ds_read_b128 v[124:127], v14 offset:7168
    v_mfma_f32_16x16x32_bf16 v[52:55], v[116:119], a[28:31], 0
    ds_read_b128 v[128:131], v14 offset:11264
    v_mfma_f32_16x16x32_bf16 v[52:55], v[112:115], a[20:23], v[52:55]
    ds_read_b128 v[132:135], v14 offset:15360
    v_mfma_f32_16x16x32_bf16 v[52:55], v[108:111], a[12:15], v[52:55]
    s_add_u32 m0, s73, 148480
    v_mfma_f32_16x16x32_bf16 v[52:55], v[104:107], a[4:7], v[52:55]
    buffer_load_dwordx4 v20, s[44:47], s22 offen offset:0 sc1 lds
    s_waitcnt lgkmcnt(2)
    v_mfma_f32_16x16x32_bf16 v[36:39], v[120:123], a[36:39], v[36:39]
    s_add_u32 m0, s73, 148992
    v_mfma_f32_16x16x32_bf16 v[36:39], v[124:127], a[44:47], v[36:39]
    buffer_load_dwordx4 v20, s[44:47], s22 offen offset:512 sc1 lds
    s_waitcnt lgkmcnt(0)
    v_mfma_f32_16x16x32_bf16 v[36:39], v[128:131], a[52:55], v[36:39]
    s_waitcnt vmcnt(8)
    s_barrier
    v_mfma_f32_16x16x32_bf16 v[36:39], v[132:135], a[60:63], v[36:39]
    ds_read_b128 v[104:107], v14 offset:16384
    v_mfma_f32_16x16x32_bf16 v[32:35], v[132:135], a[56:59], v[32:35]
    ds_read_b128 v[108:111], v14 offset:20480
    v_mfma_f32_16x16x32_bf16 v[32:35], v[128:131], a[48:51], v[32:35]
    ds_read_b128 v[112:115], v14 offset:24576
    v_mfma_f32_16x16x32_bf16 v[32:35], v[124:127], a[40:43], v[32:35]
    ds_read_b128 v[116:119], v14 offset:28672
    s_add_u32 m0, s73, 149760
    v_mfma_f32_16x16x32_bf16 v[32:35], v[120:123], a[32:35], v[32:35]
    buffer_load_dwordx4 v23, s[44:47], s23 offen offset:768 sc1 lds
    ds_read_b64_tr_b16 v[220:221], v10 offset:0
    s_waitcnt lgkmcnt(3)
    v_mfma_f32_16x16x32_bf16 v[40:43], v[104:107], a[32:35], v[40:43]
    s_add_u32 m0, s73, 98304
    ds_read_b64_tr_b16 v[222:223], v10 offset:2048
    v_mfma_f32_16x16x32_bf16 v[40:43], v[108:111], a[40:43], v[40:43]
    buffer_load_dwordx4 v20, s[44:47], s23 offen offset:0 sc1 lds
    s_waitcnt lgkmcnt(2)
    v_mfma_f32_16x16x32_bf16 v[40:43], v[112:115], a[48:51], v[40:43]
    ds_read_b128 v[120:123], v14 offset:17408
    v_mfma_f32_16x16x32_bf16 v[40:43], v[116:119], a[56:59], v[40:43]
    ds_read_b128 v[124:127], v14 offset:21504
    v_mfma_f32_16x16x32_bf16 v[44:47], v[116:119], a[60:63], v[44:47]
    ds_read_b128 v[128:131], v14 offset:25600
    v_mfma_f32_16x16x32_bf16 v[44:47], v[112:115], a[52:55], v[44:47]
    ds_read_b128 v[132:135], v14 offset:29696
    v_mfma_f32_16x16x32_bf16 v[44:47], v[108:111], a[44:47], v[44:47]
    s_add_u32 m0, s73, 98816
    ds_read_b64_tr_b16 v[228:229], v10 offset:4096
    v_mfma_f32_16x16x32_bf16 v[44:47], v[104:107], a[36:39], v[44:47]
    buffer_load_dwordx4 v20, s[44:47], s23 offen offset:512 sc1 lds
    s_waitcnt lgkmcnt(3)
    v_mfma_f32_16x16x32_bf16 v[52:55], v[120:123], a[36:39], v[52:55]
    s_add_u32 m0, s73, 99584
    ds_read_b64_tr_b16 v[230:231], v10 offset:6144
    v_mfma_f32_16x16x32_bf16 v[52:55], v[124:127], a[44:47], v[52:55]
    buffer_load_dwordx4 v23, s[44:47], s24 offen offset:768 sc1 lds
    s_waitcnt lgkmcnt(2)
    v_mfma_f32_16x16x32_bf16 v[52:55], v[128:131], a[52:55], v[52:55]
    ds_read_b128 v[104:107], v14 offset:18432
    v_mfma_f32_16x16x32_bf16 v[52:55], v[132:135], a[60:63], v[52:55]
    ds_read_b128 v[108:111], v14 offset:22528
    v_mfma_f32_16x16x32_bf16 v[48:51], v[132:135], a[56:59], v[48:51]
    ds_read_b128 v[112:115], v14 offset:26624
    v_mfma_f32_16x16x32_bf16 v[48:51], v[128:131], a[48:51], v[48:51]
    ds_read_b128 v[116:119], v14 offset:30720
    v_mfma_f32_16x16x32_bf16 v[48:51], v[124:127], a[40:43], v[48:51]
    s_add_u32 m0, s73, 101376
    ds_read_b64_tr_b16 v[224:225], v11 offset:0
    v_mfma_f32_16x16x32_bf16 v[48:51], v[120:123], a[32:35], v[48:51]
    buffer_load_dwordx4 v20, s[44:47], s24 offen offset:0 sc1 lds
    s_waitcnt lgkmcnt(3)
    v_mfma_f32_16x16x32_bf16 v[32:35], v[104:107], a[64:67], v[32:35]
    ds_read_b64_tr_b16 v[226:227], v11 offset:2048
    v_mfma_f32_16x16x32_bf16 v[32:35], v[108:111], a[72:75], v[32:35]
    s_waitcnt lgkmcnt(2)
    v_mfma_f32_16x16x32_bf16 v[32:35], v[112:115], a[80:83], v[32:35]
    ds_read_b128 v[120:123], v14 offset:19456
    v_mfma_f32_16x16x32_bf16 v[32:35], v[116:119], a[88:91], v[32:35]
    ds_read_b128 v[124:127], v14 offset:23552
    v_mfma_f32_16x16x32_bf16 v[36:39], v[116:119], a[92:95], v[36:39]
    ds_read_b128 v[128:131], v14 offset:27648
    v_mfma_f32_16x16x32_bf16 v[36:39], v[112:115], a[84:87], v[36:39]
    ds_read_b128 v[132:135], v14 offset:31744
    v_mfma_f32_16x16x32_bf16 v[36:39], v[108:111], a[76:79], v[36:39]
    ds_read_b64_tr_b16 v[232:233], v11 offset:4096
    v_mfma_f32_16x16x32_bf16 v[36:39], v[104:107], a[68:71], v[36:39]
    s_waitcnt lgkmcnt(3)
    v_mfma_f32_16x16x32_bf16 v[44:47], v[120:123], a[68:71], v[44:47]
    ds_read_b64_tr_b16 v[234:235], v11 offset:6144
    v_mfma_f32_16x16x32_bf16 v[44:47], v[124:127], a[76:79], v[44:47]
    s_waitcnt lgkmcnt(2)
    v_mfma_f32_16x16x32_bf16 v[44:47], v[128:131], a[84:87], v[44:47]
    s_waitcnt vmcnt(8) lgkmcnt(0)
    s_barrier
    v_mfma_f32_16x16x32_bf16 v[44:47], v[132:135], a[92:95], v[44:47]
    ds_read_b128 v[104:107], v14 offset:32768
    v_mfma_f32_16x16x32_bf16 v[40:43], v[132:135], a[88:91], v[40:43]
    ds_read_b128 v[108:111], v14 offset:36864
    v_mfma_f32_16x16x32_bf16 v[40:43], v[128:131], a[80:83], v[40:43]
    ds_read_b128 v[112:115], v14 offset:40960
    v_mfma_f32_16x16x32_bf16 v[40:43], v[124:127], a[72:75], v[40:43]
    ds_read_b128 v[116:119], v14 offset:45056
    v_mfma_f32_16x16x32_bf16 v[40:43], v[120:123], a[64:67], v[40:43]
    ds_read_b64_tr_b16 v[236:237], v10 offset:16384
    s_waitcnt lgkmcnt(3)
    v_mfma_f32_16x16x32_bf16 v[48:51], v[104:107], a[64:67], v[48:51]
    s_add_u32 m0, s73, 114176
    ds_read_b64_tr_b16 v[238:239], v10 offset:18432
    v_mfma_f32_16x16x32_bf16 v[48:51], v[108:111], a[72:75], v[48:51]
    buffer_load_dwordx4 v20, s[44:47], s24 offen offset:512 sc1 lds
    s_waitcnt lgkmcnt(2)
    v_mfma_f32_16x16x32_bf16 v[48:51], v[112:115], a[80:83], v[48:51]
    ds_read_b128 v[120:123], v14 offset:33792
    v_mfma_f32_16x16x32_bf16 v[48:51], v[116:119], a[88:91], v[48:51]
    ds_read_b128 v[124:127], v14 offset:37888
    v_lshrrev_b32 v30, 2, v26
    v_mfma_f32_16x16x32_bf16 v[52:55], v[116:119], a[92:95], v[52:55]
    ds_read_b128 v[128:131], v14 offset:41984
    v_mfma_f32_16x16x32_bf16 v[52:55], v[112:115], a[84:87], v[52:55]
    ds_read_b128 v[132:135], v14 offset:46080
    v_mfma_f32_16x16x32_bf16 v[52:55], v[108:111], a[76:79], v[52:55]
    s_add_u32 m0, s73, 114944
    ds_read_b64_tr_b16 v[244:245], v10 offset:20480
    v_mfma_f32_16x16x32_bf16 v[52:55], v[104:107], a[68:71], v[52:55]
    buffer_load_dwordx4 v23, s[44:47], s25 offen offset:768 sc1 lds
    s_waitcnt lgkmcnt(3)
    v_mfma_f32_16x16x32_bf16 v[36:39], v[120:123], a[100:103], v[36:39]
    s_add_u32 m0, s73, 116736
    ds_read_b64_tr_b16 v[246:247], v10 offset:22528
    v_mfma_f32_16x16x32_bf16 v[36:39], v[124:127], a[108:111], v[36:39]
    buffer_load_dwordx4 v20, s[44:47], s25 offen offset:0 sc1 lds
    s_waitcnt lgkmcnt(2)
    v_mfma_f32_16x16x32_bf16 v[36:39], v[128:131], a[116:119], v[36:39]
    ds_read_b128 v[104:107], v14 offset:34816
    v_lshrrev_b32 v31, 2, v18
    v_mfma_f32_16x16x32_bf16 v[36:39], v[132:135], a[124:127], v[36:39]
    ds_read_b128 v[108:111], v14 offset:38912
    v_mfma_f32_16x16x32_bf16 v[32:35], v[132:135], a[120:123], v[32:35]
    ds_read_b128 v[112:115], v14 offset:43008
    v_mfma_f32_16x16x32_bf16 v[32:35], v[128:131], a[112:115], v[32:35]
    ds_read_b128 v[116:119], v14 offset:47104
    v_mfma_f32_16x16x32_bf16 v[32:35], v[124:127], a[104:107], v[32:35]
    s_add_u32 m0, s73, 117248
    ds_read_b64_tr_b16 v[240:241], v11 offset:16384
    v_mfma_f32_16x16x32_bf16 v[32:35], v[120:123], a[96:99], v[32:35]
    buffer_load_dwordx4 v20, s[44:47], s25 offen offset:512 sc1 lds
    s_waitcnt lgkmcnt(3)
    v_mfma_f32_16x16x32_bf16 v[40:43], v[104:107], a[96:99], v[40:43]
    ds_read_b64_tr_b16 v[242:243], v11 offset:18432
    buffer_load_ushort v102, v30, s[60:63], 0 offen offset:0
    v_mfma_f32_16x16x32_bf16 v[40:43], v[108:111], a[104:107], v[40:43]
    s_waitcnt lgkmcnt(2)
    v_mfma_f32_16x16x32_bf16 v[40:43], v[112:115], a[112:115], v[40:43]
    ds_read_b128 v[120:123], v14 offset:35840
    v_mfma_f32_16x16x32_bf16 v[40:43], v[116:119], a[120:123], v[40:43]
    ds_read_b128 v[124:127], v14 offset:39936
    v_mfma_f32_16x16x32_bf16 v[44:47], v[116:119], a[124:127], v[44:47]
    ds_read_b128 v[128:131], v14 offset:44032
    v_mfma_f32_16x16x32_bf16 v[44:47], v[112:115], a[116:119], v[44:47]
    ds_read_b128 v[132:135], v14 offset:48128
    v_mfma_f32_16x16x32_bf16 v[44:47], v[108:111], a[108:111], v[44:47]
    ds_read_b64_tr_b16 v[248:249], v11 offset:20480
    buffer_load_ushort v103, v30, s[60:63], 0 offen offset:32
    v_mfma_f32_16x16x32_bf16 v[44:47], v[104:107], a[100:103], v[44:47]
    s_waitcnt lgkmcnt(3)
    v_mfma_f32_16x16x32_bf16 v[52:55], v[120:123], a[100:103], v[52:55]
    ds_read_b64_tr_b16 v[250:251], v11 offset:22528
    v_mfma_f32_16x16x32_bf16 v[52:55], v[124:127], a[108:111], v[52:55]
    s_waitcnt lgkmcnt(2)
    v_mfma_f32_16x16x32_bf16 v[52:55], v[128:131], a[116:119], v[52:55]
    s_waitcnt vmcnt(10) lgkmcnt(0)
    s_barrier
    v_mfma_f32_16x16x32_bf16 v[52:55], v[132:135], a[124:127], v[52:55]
    ds_read_b128 v[104:107], v14 offset:49152
    v_mfma_f32_16x16x32_bf16 v[48:51], v[132:135], a[120:123], v[48:51]
    ds_read_b128 v[108:111], v14 offset:53248
    buffer_load_ushort v27, v31, s[60:63], 0 offen offset:0
    v_mfma_f32_16x16x32_bf16 v[48:51], v[128:131], a[112:115], v[48:51]
    ds_read_b128 v[112:115], v14 offset:57344
    v_mfma_f32_16x16x32_bf16 v[48:51], v[124:127], a[104:107], v[48:51]
    ds_read_b128 v[116:119], v14 offset:61440
    v_mfma_f32_16x16x32_bf16 v[48:51], v[120:123], a[96:99], v[48:51]
    s_waitcnt lgkmcnt(2)
    v_mfma_f32_16x16x32_bf16 v[32:35], v[104:107], a[128:131], v[32:35]
    s_add_u32 m0, s73, 130304
    v_mfma_f32_16x16x32_bf16 v[32:35], v[108:111], a[136:139], v[32:35]
    buffer_load_dwordx4 v23, s[44:47], s26 offen offset:768 sc1 lds
    s_waitcnt lgkmcnt(0)
    v_mfma_f32_16x16x32_bf16 v[32:35], v[112:115], a[144:147], v[32:35]
    ds_read_b128 v[120:123], v14 offset:50176
    v_mfma_f32_16x16x32_bf16 v[32:35], v[116:119], a[152:155], v[32:35]
    ds_read_b128 v[124:127], v14 offset:54272
    v_mfma_f32_16x16x32_bf16 v[36:39], v[116:119], a[156:159], v[36:39]
    ds_read_b128 v[128:131], v14 offset:58368
    v_mfma_f32_16x16x32_bf16 v[36:39], v[112:115], a[148:151], v[36:39]
    ds_read_b128 v[132:135], v14 offset:62464
    v_mfma_f32_16x16x32_bf16 v[36:39], v[108:111], a[140:143], v[36:39]
    s_add_u32 m0, s73, 132096
    v_mfma_f32_16x16x32_bf16 v[36:39], v[104:107], a[132:135], v[36:39]
    buffer_load_dwordx4 v20, s[44:47], s26 offen offset:0 sc1 lds
    s_waitcnt lgkmcnt(2)
    v_mfma_f32_16x16x32_bf16 v[44:47], v[120:123], a[132:135], v[44:47]
    s_add_u32 m0, s73, 132608
    buffer_load_dwordx4 v[88:91], v252, s[56:59], 0 offen
    v_mfma_f32_16x16x32_bf16 v[44:47], v[124:127], a[140:143], v[44:47]
    buffer_load_dwordx4 v20, s[44:47], s26 offen offset:512 sc1 lds
    s_waitcnt lgkmcnt(0)
    v_mfma_f32_16x16x32_bf16 v[44:47], v[128:131], a[148:151], v[44:47]
    ds_read_b128 v[104:107], v14 offset:51200
    v_mfma_f32_16x16x32_bf16 v[44:47], v[132:135], a[156:159], v[44:47]
    ds_read_b128 v[108:111], v14 offset:55296
    v_mfma_f32_16x16x32_bf16 v[40:43], v[132:135], a[152:155], v[40:43]
    ds_read_b128 v[112:115], v14 offset:59392
    v_mfma_f32_16x16x32_bf16 v[40:43], v[128:131], a[144:147], v[40:43]
    ds_read_b128 v[116:119], v14 offset:63488
    v_mfma_f32_16x16x32_bf16 v[40:43], v[124:127], a[136:139], v[40:43]
    s_add_u32 m0, s73, 134144
    v_mfma_f32_16x16x32_bf16 v[40:43], v[120:123], a[128:131], v[40:43]
    buffer_load_dwordx4 v21, s[44:47], s18 offen offset:0 sc1 lds
    s_waitcnt lgkmcnt(2)
    v_mfma_f32_16x16x32_bf16 v[48:51], v[104:107], a[128:131], v[48:51]
    v_mfma_f32_16x16x32_bf16 v[48:51], v[108:111], a[136:139], v[48:51]
    s_waitcnt lgkmcnt(0)
    v_mfma_f32_16x16x32_bf16 v[48:51], v[112:115], a[144:147], v[48:51]
    ds_read_b128 v[120:123], v14 offset:52224
    v_mfma_f32_16x16x32_bf16 v[48:51], v[116:119], a[152:155], v[48:51]
    ds_read_b128 v[124:127], v14 offset:56320
    v_mfma_f32_16x16x32_bf16 v[52:55], v[116:119], a[156:159], v[52:55]
    ds_read_b128 v[128:131], v14 offset:60416
    v_mfma_f32_16x16x32_bf16 v[52:55], v[112:115], a[148:151], v[52:55]
    ds_read_b128 v[132:135], v14 offset:64512
    v_mfma_f32_16x16x32_bf16 v[52:55], v[108:111], a[140:143], v[52:55]
    v_mfma_f32_16x16x32_bf16 v[52:55], v[104:107], a[132:135], v[52:55]
    s_waitcnt lgkmcnt(2)
    v_mfma_f32_16x16x32_bf16 v[36:39], v[120:123], a[164:167], v[36:39]
    buffer_load_dwordx4 v[92:95], v252, s[56:59], s40 offen
    v_mfma_f32_16x16x32_bf16 v[36:39], v[124:127], a[172:175], v[36:39]
    s_waitcnt lgkmcnt(0)
    v_mfma_f32_16x16x32_bf16 v[36:39], v[128:131], a[180:183], v[36:39]
    s_waitcnt vmcnt(13)
    s_barrier
    v_mfma_f32_16x16x32_bf16 v[36:39], v[132:135], a[188:191], v[36:39]
    ds_read_b128 v[104:107], v14 offset:0
    v_mfma_f32_16x16x32_bf16 v[32:35], v[132:135], a[184:187], v[32:35]
    ds_read_b128 v[108:111], v14 offset:4096
    v_mfma_f32_16x16x32_bf16 v[32:35], v[128:131], a[176:179], v[32:35]
    ds_read_b128 v[112:115], v14 offset:8192
    v_mfma_f32_16x16x32_bf16 v[32:35], v[124:127], a[168:171], v[32:35]
    ds_read_b128 v[116:119], v14 offset:12288
    v_mfma_f32_16x16x32_bf16 v[32:35], v[120:123], a[160:163], v[32:35]
    s_waitcnt lgkmcnt(2)
    v_mfma_f32_16x16x32_bf16 v[40:43], v[104:107], a[160:163], v[40:43]
    s_add_u32 m0, s73, 146944
    v_mfma_f32_16x16x32_bf16 v[40:43], v[108:111], a[168:171], v[40:43]
    buffer_load_dwordx4 v21, s[44:47], s18 offen offset:512 sc1 lds
    s_waitcnt lgkmcnt(0)
    v_mfma_f32_16x16x32_bf16 v[40:43], v[112:115], a[176:179], v[40:43]
    ds_read_b128 v[120:123], v14 offset:1024
    v_mfma_f32_16x16x32_bf16 v[40:43], v[116:119], a[184:187], v[40:43]
    ds_read_b128 v[124:127], v14 offset:5120
    v_mfma_f32_16x16x32_bf16 v[44:47], v[116:119], a[188:191], v[44:47]
    ds_read_b128 v[128:131], v14 offset:9216
    v_mfma_f32_16x16x32_bf16 v[44:47], v[112:115], a[180:183], v[44:47]
    ds_read_b128 v[132:135], v14 offset:13312
    v_mfma_f32_16x16x32_bf16 v[44:47], v[108:111], a[172:175], v[44:47]
    s_add_u32 m0, s73, 148480
    v_mfma_f32_16x16x32_bf16 v[44:47], v[104:107], a[164:167], v[44:47]
    buffer_load_dwordx4 v21, s[44:47], s19 offen offset:0 sc1 lds
    s_waitcnt lgkmcnt(2)
    v_mfma_f32_16x16x32_bf16 v[52:55], v[120:123], a[164:167], v[52:55]
    s_add_u32 m0, s73, 148992
    buffer_load_dwordx2 v[142:143], v253, s[56:59], 0 offen
    v_mfma_f32_16x16x32_bf16 v[52:55], v[124:127], a[172:175], v[52:55]
    buffer_load_dwordx4 v21, s[44:47], s19 offen offset:512 sc1 lds
    s_waitcnt lgkmcnt(0)
    v_mfma_f32_16x16x32_bf16 v[52:55], v[128:131], a[180:183], v[52:55]
    ds_read_b128 v[104:107], v14 offset:2048
    v_mfma_f32_16x16x32_bf16 v[52:55], v[132:135], a[188:191], v[52:55]
    ds_read_b128 v[108:111], v14 offset:6144
    v_mfma_f32_16x16x32_bf16 v[48:51], v[132:135], a[184:187], v[48:51]
    ds_read_b128 v[112:115], v14 offset:10240
    v_mfma_f32_16x16x32_bf16 v[48:51], v[128:131], a[176:179], v[48:51]
    ds_read_b128 v[116:119], v14 offset:14336
    v_mfma_f32_16x16x32_bf16 v[48:51], v[124:127], a[168:171], v[48:51]
    s_add_u32 m0, s73, 150528
    v_mfma_f32_16x16x32_bf16 v[48:51], v[120:123], a[160:163], v[48:51]
    buffer_load_dwordx4 v21, s[44:47], s20 offen offset:0 sc1 lds
    s_waitcnt lgkmcnt(2)
    v_mfma_f32_16x16x32_bf16 v[32:35], v[104:107], a[192:195], v[32:35]
    v_mfma_f32_16x16x32_bf16 v[32:35], v[108:111], a[200:203], v[32:35]
    s_waitcnt vmcnt(11)
    s_waitcnt lgkmcnt(0)
    v_mfma_f32_16x16x32_bf16 v[32:35], v[112:115], a[208:211], v[32:35]
    ds_read_b128 v[120:123], v14 offset:3072
    v_mfma_f32_16x16x32_bf16 v[32:35], v[116:119], a[216:219], v[32:35]
    ds_read_b128 v[124:127], v14 offset:7168
    v_mfma_f32_16x16x32_bf16 v[36:39], v[116:119], a[220:223], v[36:39]
    ds_read_b128 v[128:131], v14 offset:11264
    v_lshlrev_b32 v72, 16, v102
    v_mfma_f32_16x16x32_bf16 v[36:39], v[112:115], a[212:215], v[36:39]
    ds_read_b128 v[132:135], v14 offset:15360
    v_mfma_f32_16x16x32_bf16 v[36:39], v[108:111], a[204:207], v[36:39]
    v_lshlrev_b32 v73, 16, v102
    v_mfma_f32_16x16x32_bf16 v[36:39], v[104:107], a[196:199], v[36:39]
    buffer_load_dwordx2 v[96:97], v26, s[44:47], s42 offen offset:0 sc1
    s_waitcnt lgkmcnt(2)
    v_mfma_f32_16x16x32_bf16 v[44:47], v[120:123], a[196:199], v[44:47]
    v_mfma_f32_16x16x32_bf16 v[44:47], v[124:127], a[204:207], v[44:47]
    v_lshlrev_b32 v74, 16, v102
    s_waitcnt lgkmcnt(0)
    v_mfma_f32_16x16x32_bf16 v[44:47], v[128:131], a[212:215], v[44:47]
    s_barrier
    v_mfma_f32_16x16x32_bf16 v[44:47], v[132:135], a[220:223], v[44:47]
    ds_read_b128 v[104:107], v14 offset:16384
    v_mfma_f32_16x16x32_bf16 v[40:43], v[132:135], a[216:219], v[40:43]
    ds_read_b128 v[108:111], v14 offset:20480
    v_lshlrev_b32 v75, 16, v102
    v_mfma_f32_16x16x32_bf16 v[40:43], v[128:131], a[208:211], v[40:43]
    ds_read_b128 v[112:115], v14 offset:24576
    v_mfma_f32_16x16x32_bf16 v[40:43], v[124:127], a[200:203], v[40:43]
    ds_read_b128 v[116:119], v14 offset:28672
    v_lshlrev_b32 v76, 16, v103
    v_mfma_f32_16x16x32_bf16 v[40:43], v[120:123], a[192:195], v[40:43]
    s_waitcnt lgkmcnt(2)
    v_mfma_f32_16x16x32_bf16 v[48:51], v[104:107], a[192:195], v[48:51]
    s_add_u32 m0, s73, 97792
    v_lshlrev_b32 v77, 16, v103
    v_mfma_f32_16x16x32_bf16 v[48:51], v[108:111], a[200:203], v[48:51]
    buffer_load_dwordx4 v21, s[44:47], s20 offen offset:512 sc1 lds
    s_waitcnt lgkmcnt(0)
    v_mfma_f32_16x16x32_bf16 v[48:51], v[112:115], a[208:211], v[48:51]
    ds_read_b128 v[120:123], v14 offset:17408
    v_mfma_f32_16x16x32_bf16 v[48:51], v[116:119], a[216:219], v[48:51]
    ds_read_b128 v[124:127], v14 offset:21504
L_pl_X_7:
    s_cbranch_execz L_wret
    v_mfma_f32_16x16x32_bf16 v[52:55], v[116:119], a[220:223], v[52:55]
    ds_read_b128 v[128:131], v14 offset:25600
    v_lshlrev_b32 v78, 16, v103
    v_mfma_f32_16x16x32_bf16 v[52:55], v[112:115], a[212:215], v[52:55]
    ds_read_b128 v[132:135], v14 offset:29696
    v_mfma_f32_16x16x32_bf16 v[52:55], v[108:111], a[204:207], v[52:55]
    s_add_u32 m0, s73, 99328
    v_lshlrev_b32 v79, 16, v103
    v_mfma_f32_16x16x32_bf16 v[52:55], v[104:107], a[196:199], v[52:55]
    buffer_load_dwordx4 v21, s[44:47], s21 offen offset:0 sc1 lds
    s_waitcnt lgkmcnt(2)
    v_mfma_f32_16x16x32_bf16 v[36:39], v[120:123], a[228:231], v[36:39]
    buffer_load_dwordx2 v[98:99], v26, s[44:47], s42 offen offset:128 sc1
    s_add_u32 m0, s73, 99840
    v_lshlrev_b32 v80, 16, v102
    v_mfma_f32_16x16x32_bf16 v[36:39], v[124:127], a[236:239], v[36:39]
    buffer_load_dwordx4 v21, s[44:47], s21 offen offset:512 sc1 lds
    s_waitcnt lgkmcnt(0)
    v_mfma_f32_16x16x32_bf16 v[36:39], v[128:131], a[244:247], v[36:39]
    ds_read_b128 v[104:107], v14 offset:18432
    v_mfma_f32_16x16x32_bf16 v[36:39], v[132:135], a[252:255], v[36:39]
    ds_read_b128 v[108:111], v14 offset:22528
    v_mfma_f32_16x16x32_bf16 v[32:35], v[132:135], a[248:251], v[32:35]
    ds_read_b128 v[112:115], v14 offset:26624
    v_lshlrev_b32 v81, 16, v102
    v_mfma_f32_16x16x32_bf16 v[32:35], v[128:131], a[240:243], v[32:35]
    ds_read_b128 v[116:119], v14 offset:30720
    v_mfma_f32_16x16x32_bf16 v[32:35], v[124:127], a[232:235], v[32:35]
    s_add_u32 m0, s73, 101376
    v_lshlrev_b32 v82, 16, v102
    v_mfma_f32_16x16x32_bf16 v[32:35], v[120:123], a[224:227], v[32:35]
    buffer_load_dwordx4 v21, s[44:47], s22 offen offset:0 sc1 lds
    s_waitcnt lgkmcnt(2)
    v_mfma_f32_16x16x32_bf16 v[40:43], v[104:107], a[224:227], v[40:43]
    v_mfma_f32_16x16x32_bf16 v[40:43], v[108:111], a[232:235], v[40:43]
    v_lshlrev_b32 v83, 16, v102
    s_waitcnt lgkmcnt(0)
    v_mfma_f32_16x16x32_bf16 v[40:43], v[112:115], a[240:243], v[40:43]
    ds_read_b128 v[120:123], v14 offset:19456
    v_mfma_f32_16x16x32_bf16 v[40:43], v[116:119], a[248:251], v[40:43]
    ds_read_b128 v[124:127], v14 offset:23552
    v_mfma_f32_16x16x32_bf16 v[44:47], v[116:119], a[252:255], v[44:47]
    ds_read_b128 v[128:131], v14 offset:27648
    v_lshlrev_b32 v84, 16, v103
    v_mfma_f32_16x16x32_bf16 v[44:47], v[112:115], a[244:247], v[44:47]
    ds_read_b128 v[132:135], v14 offset:31744
    v_mfma_f32_16x16x32_bf16 v[44:47], v[108:111], a[236:239], v[44:47]
    v_lshlrev_b32 v85, 16, v103
    v_mfma_f32_16x16x32_bf16 v[44:47], v[104:107], a[228:231], v[44:47]
    buffer_load_dwordx2 v[100:101], v18, s[44:47], s42 offen offset:0 sc1
    s_waitcnt lgkmcnt(2)
    v_mfma_f32_16x16x32_bf16 v[52:55], v[120:123], a[228:231], v[52:55]
    v_mfma_f32_16x16x32_bf16 v[52:55], v[124:127], a[236:239], v[52:55]
    v_lshlrev_b32 v86, 16, v103
    s_waitcnt lgkmcnt(0)
    v_mfma_f32_16x16x32_bf16 v[52:55], v[128:131], a[244:247], v[52:55]
    s_waitcnt vmcnt(13)
    s_barrier
    v_mfma_f32_16x16x32_bf16 v[52:55], v[132:135], a[252:255], v[52:55]
    ds_read_b128 v[104:107], v14 offset:32768
    v_lshlrev_b32 v87, 16, v103
    v_mfma_f32_16x16x32_bf16 v[48:51], v[132:135], a[248:251], v[48:51]
    ds_read_b128 v[108:111], v14 offset:36864
    v_add_u32 v10, 65536, v10
    v_mfma_f32_16x16x32_bf16 v[48:51], v[128:131], a[240:243], v[48:51]
    ds_read_b128 v[112:115], v14 offset:40960
    v_mfma_f32_16x16x32_bf16 v[48:51], v[124:127], a[232:235], v[48:51]
    ds_read_b128 v[116:119], v14 offset:45056
    v_add_u32 v11, 65536, v11
    v_mfma_f32_16x16x32_bf16 v[48:51], v[120:123], a[224:227], v[48:51]
    v_lshlrev_b32 v27, 16, v27
    s_branch L_Dc
L_idle:
    s_waitcnt vmcnt(0)
    s_barrier
    s_mov_b64 exec, 0
    s_call_b64 s[82:83], L_wc_D
    s_mov_b64 exec, -1
    s_mov_b32 s60, s36
    s_and_b32 s61, s37, 0xffff
    s_mov_b32 s62, 4096
    s_mov_b32 s63, 0x20000
    v_and_b32 v24, 15, v2
    s_lshl_b32 s7, s71, 6
    v_add_u32 v24, s7, v24
    s_and_b32 s8, s3, 1
    s_lshl_b32 s4, s8, 5
    v_add_u32 v25, s4, v24
    v_lshlrev_b32 v26, 3, v25
    v_mul_u32_u24 v25, 1152, v25
    v_bfe_u32 v31, v2, 4, 1
    v_lshl_add_u32 v25, v31, 5, v25
    v_lshrrev_b32 v31, 5, v2
    v_lshl_add_u32 v25, v31, 4, v25
    s_bfe_u32 s7, s2, 0x20003
    s_mul_i32 s7, s7, 288
    s_lshl_b32 s4, s72, 6
    s_add_u32 s4, s4, s7
    v_add_u32 v252, s4, v25
    s_xor_b32 s8, s3, s72
    s_and_b32 s4, s72, 1
    s_lshl1_add_u32 s4, s4, s8
    v_lshl_add_u32 v24, s4, 4, v24
    s_add_u32 s7, s7, 256
    s_cmp_lt_u32 s8, 2
    s_cselect_b32 s7, s7, 0x40000000
    v_lshlrev_b32 v18, 3, v24
    v_mul_u32_u24 v24, 1152, v24
    v_lshrrev_b32 v31, 4, v2
    v_lshl_add_u32 v24, v31, 3, v24
    v_add_u32 v253, s7, v24
    v_lshrrev_b32 v24, 3, v2
    v_and_b32 v25, 7, v2
    v_bfe_u32 v31, v2, 4, 2
    v_lshlrev_b32 v31, 1, v31
    v_xor_b32 v25, v25, v31
    v_lshlrev_b32 v24, 12, v24
    v_lshl_add_u32 v24, v25, 4, v24
    s_mul_i32 s7, s72, 36
    s_bitcmp1_b32 s3, 0
    s_addc_u32 s7, s7, 0
    s_lshl_b32 s7, s7, 17
    s_lshl_b32 s8, s71, 7
    s_add_u32 s7, s7, s8
    v_add_u32 v4, s7, v24
    v_add_u32 v5, 31744, v4
    v_add_u32 v6, 31744, v5
    v_add_u32 v7, 31744, v6
    v_lshrrev_b32 v24, 2, v2
    v_lshlrev_b32 v24, 7, v24
    v_and_b32 v25, 3, v2
    v_lshl_add_u32 v24, v25, 3, v24
    s_and_b32 s7, s73, 8192
    v_add_u32 v24, s7, v24
    v_bfe_u32 v31, v2, 3, 2
    s_and_b32 s7, s3, 1
    s_lshl_b32 s7, s7, 1
    v_xor_b32 v31, s7, v31
    v_lshl_add_u32 v10, v31, 5, v24
    v_xor_b32 v11, 32, v10
    v_and_b32 v24, 15, v2
    v_lshrrev_b32 v25, 4, v2
    v_mul_u32_u24 v25, 17408, v25
    v_lshl_add_u32 v24, v24, 4, v25
    s_mul_i32 s7, s72, 36
    s_and_b32 s8, s3, 1
    s_add_u32 s7, s7, s8
    s_mul_i32 s7, s7, 69632
    s_bfe_u32 s8, s2, 0x20003
    s_lshl_b32 s8, s8, 12
    s_add_u32 s7, s7, s8
    s_add_u32 s7, s7, 12795904
    v_add_u32 v23, s7, v24
    s_xor_b32 s7, s72, 0
    v_lshl_add_u32 v19, s7, 10, v23
    s_xor_b32 s7, s72, 1
    v_lshl_add_u32 v20, s7, 10, v23
    s_xor_b32 s7, s72, 2
    v_lshl_add_u32 v21, s7, 10, v23
    s_xor_b32 s7, s72, 3
    v_lshl_add_u32 v22, s7, 10, v23
    v_lshlrev_b32 v14, 4, v2
    v_add_u32 v14, 98304, v14
    v_add_u32 v1, 0x10000, v14
    s_bitcmp1_b32 s3, 1
    s_cselect_b32 s18, s85, s84
    s_mul_i32 s18, s18, 139264
    s_cselect_b32 s19, s87, s86
    s_mul_i32 s19, s19, 139264
    s_cselect_b32 s20, s89, s88
    s_mul_i32 s20, s20, 139264
    s_cselect_b32 s21, s91, s90
    s_mul_i32 s21, s21, 139264
    s_cselect_b32 s22, s93, s92
    s_mul_i32 s22, s22, 139264
    s_cselect_b32 s23, s95, s94
    s_mul_i32 s23, s23, 139264
    s_cselect_b32 s24, s97, s96
    s_mul_i32 s24, s24, 139264
    s_cselect_b32 s25, s99, s98
    s_mul_i32 s25, s25, 139264
    s_cselect_b32 s26, s101, s100
    s_mul_i32 s26, s26, 139264
    s_sub_u32 s4, s75, 252
    s_mul_i32 s4, s4, 1152
    s_mul_i32 s5, s3, 64
    s_add_u32 s4, s4, s5
    s_add_u32 s4, s4, 896
    s_lshl_b32 s4, s4, 12
    s_add_u32 s4, s4, 384
    v_lshlrev_b32 v24, 10, v2
    buffer_load_dword v255, v24, s[52:55], s4 offen
    s_add_u32 s4, s4, 65536
    buffer_load_dword v255, v24, s[52:55], s4 offen
    s_add_u32 s4, s4, 65536
    buffer_load_dword v255, v24, s[52:55], s4 offen
    s_add_u32 s4, s4, 65536
    buffer_load_dword v255, v24, s[52:55], s4 offen
    s_add_u32 s4, s4, 65536
    s_add_u32 m0, s73, 32768
    s_lshl_b32 s14, s84, 18
    buffer_load_dwordx4 v4, s[52:55], s14 offen offset:0 lds
    buffer_load_dwordx4 v5, s[52:55], s14 offen offset:1024 lds
    buffer_load_dwordx4 v6, s[52:55], s14 offen offset:2048 lds
    buffer_load_dwordx4 v7, s[52:55], s14 offen offset:3072 lds
    s_add_u32 m0, s73, 49152
    s_lshl_b32 s14, s85, 18
    buffer_load_dwordx4 v4, s[52:55], s14 offen offset:0 lds
    buffer_load_dwordx4 v5, s[52:55], s14 offen offset:1024 lds
    buffer_load_dwordx4 v6, s[52:55], s14 offen offset:2048 lds
    buffer_load_dwordx4 v7, s[52:55], s14 offen offset:3072 lds
    s_add_u32 m0, s73, 65536
    s_lshl_b32 s14, s86, 18
    buffer_load_dwordx4 v4, s[52:55], s14 offen offset:0 lds
    buffer_load_dwordx4 v5, s[52:55], s14 offen offset:1024 lds
    buffer_load_dwordx4 v6, s[52:55], s14 offen offset:2048 lds
    buffer_load_dwordx4 v7, s[52:55], s14 offen offset:3072 lds
    s_add_u32 m0, s73, 81920
    s_lshl_b32 s14, s87, 18
    buffer_load_dwordx4 v4, s[52:55], s14 offen offset:0 lds
    buffer_load_dwordx4 v5, s[52:55], s14 offen offset:1024 lds
    buffer_load_dwordx4 v6, s[52:55], s14 offen offset:2048 lds
    buffer_load_dwordx4 v7, s[52:55], s14 offen offset:3072 lds
    s_add_u32 m0, s73, 98304
    s_lshl_b32 s14, s88, 18
    buffer_load_dwordx4 v4, s[52:55], s14 offen offset:0 lds
    buffer_load_dwordx4 v5, s[52:55], s14 offen offset:1024 lds
    buffer_load_dwordx4 v6, s[52:55], s14 offen offset:2048 lds
    buffer_load_dwordx4 v7, s[52:55], s14 offen offset:3072 lds
    s_add_u32 m0, s73, 114688
    s_lshl_b32 s14, s89, 18
    buffer_load_dwordx4 v4, s[52:55], s14 offen offset:0 lds
    buffer_load_dwordx4 v5, s[52:55], s14 offen offset:1024 lds
    buffer_load_dwordx4 v6, s[52:55], s14 offen offset:2048 lds
    buffer_load_dwordx4 v7, s[52:55], s14 offen offset:3072 lds
    s_add_u32 m0, s73, 131072
    s_lshl_b32 s14, s90, 18
    buffer_load_dwordx4 v4, s[52:55], s14 offen offset:0 lds
    buffer_load_dwordx4 v5, s[52:55], s14 offen offset:1024 lds
    buffer_load_dwordx4 v6, s[52:55], s14 offen offset:2048 lds
    buffer_load_dwordx4 v7, s[52:55], s14 offen offset:3072 lds
    s_add_u32 m0, s73, 147456
    s_lshl_b32 s14, s91, 18
    buffer_load_dwordx4 v4, s[52:55], s14 offen offset:0 lds
    buffer_load_dwordx4 v5, s[52:55], s14 offen offset:1024 lds
    buffer_load_dwordx4 v6, s[52:55], s14 offen offset:2048 lds
    buffer_load_dwordx4 v7, s[52:55], s14 offen offset:3072 lds
    s_waitcnt vmcnt(28)
    s_barrier
    ds_read_b64_tr_b16 a[0:1], v10 offset:32768
    ds_read_b64_tr_b16 a[2:3], v10 offset:34816
    ds_read_b64_tr_b16 a[8:9], v10 offset:36864
    ds_read_b64_tr_b16 a[10:11], v10 offset:38912
    ds_read_b64_tr_b16 a[4:5], v11 offset:32768
    ds_read_b64_tr_b16 a[6:7], v11 offset:34816
    ds_read_b64_tr_b16 a[12:13], v11 offset:36864
    ds_read_b64_tr_b16 a[14:15], v11 offset:38912
    s_waitcnt vmcnt(24) lgkmcnt(0)
    s_barrier
    ds_read_b64_tr_b16 a[16:17], v10 offset:49152
    s_add_u32 m0, s73, 32768
    s_lshl_b32 s14, s92, 18
    ds_read_b64_tr_b16 a[18:19], v10 offset:51200
    buffer_load_dwordx4 v4, s[52:55], s14 offen offset:0 lds
    ds_read_b64_tr_b16 a[24:25], v10 offset:53248
    ds_read_b64_tr_b16 a[26:27], v10 offset:55296
    buffer_load_dwordx4 v5, s[52:55], s14 offen offset:1024 lds
    ds_read_b64_tr_b16 a[20:21], v11 offset:49152
    buffer_load_dwordx4 v6, s[52:55], s14 offen offset:2048 lds
    ds_read_b64_tr_b16 a[22:23], v11 offset:51200
    ds_read_b64_tr_b16 a[28:29], v11 offset:53248
    buffer_load_dwordx4 v7, s[52:55], s14 offen offset:3072 lds
    ds_read_b64_tr_b16 a[30:31], v11 offset:55296
    s_waitcnt vmcnt(24) lgkmcnt(0)
    s_barrier
    v_add_u32 v10, 65536, v10
    ds_read_b64_tr_b16 a[32:33], v10 offset:0
    s_add_u32 m0, s73, 49152
    s_lshl_b32 s14, s93, 18
    ds_read_b64_tr_b16 a[34:35], v10 offset:2048
    buffer_load_dwordx4 v4, s[52:55], s14 offen offset:0 lds
    ds_read_b64_tr_b16 a[40:41], v10 offset:4096
    ds_read_b64_tr_b16 a[42:43], v10 offset:6144
    buffer_load_dwordx4 v5, s[52:55], s14 offen offset:1024 lds
    v_add_u32 v11, 65536, v11
    ds_read_b64_tr_b16 a[36:37], v11 offset:0
    buffer_load_dwordx4 v6, s[52:55], s14 offen offset:2048 lds
    ds_read_b64_tr_b16 a[38:39], v11 offset:2048
    ds_read_b64_tr_b16 a[44:45], v11 offset:4096
    buffer_load_dwordx4 v7, s[52:55], s14 offen offset:3072 lds
    ds_read_b64_tr_b16 a[46:47], v11 offset:6144
    s_waitcnt vmcnt(24) lgkmcnt(0)
    s_barrier
    ds_read_b64_tr_b16 a[48:49], v10 offset:16384
    s_add_u32 m0, s73, 65536
    s_lshl_b32 s14, s94, 18
    ds_read_b64_tr_b16 a[50:51], v10 offset:18432
    buffer_load_dwordx4 v4, s[52:55], s14 offen offset:0 lds
    ds_read_b64_tr_b16 a[56:57], v10 offset:20480
    ds_read_b64_tr_b16 a[58:59], v10 offset:22528
    buffer_load_dwordx4 v5, s[52:55], s14 offen offset:1024 lds
    ds_read_b64_tr_b16 a[52:53], v11 offset:16384
    buffer_load_dwordx4 v6, s[52:55], s14 offen offset:2048 lds
    ds_read_b64_tr_b16 a[54:55], v11 offset:18432
    ds_read_b64_tr_b16 a[60:61], v11 offset:20480
    buffer_load_dwordx4 v7, s[52:55], s14 offen offset:3072 lds
    ds_read_b64_tr_b16 a[62:63], v11 offset:22528
    s_waitcnt vmcnt(24) lgkmcnt(0)
    s_barrier
    ds_read_b64_tr_b16 a[64:65], v10 offset:32768
    s_add_u32 m0, s73, 81920
    s_lshl_b32 s14, s95, 18
    ds_read_b64_tr_b16 a[66:67], v10 offset:34816
    buffer_load_dwordx4 v4, s[52:55], s14 offen offset:0 lds
    ds_read_b64_tr_b16 a[72:73], v10 offset:36864
    ds_read_b64_tr_b16 a[74:75], v10 offset:38912
    buffer_load_dwordx4 v5, s[52:55], s14 offen offset:1024 lds
    ds_read_b64_tr_b16 a[68:69], v11 offset:32768
    buffer_load_dwordx4 v6, s[52:55], s14 offen offset:2048 lds
    ds_read_b64_tr_b16 a[70:71], v11 offset:34816
    ds_read_b64_tr_b16 a[76:77], v11 offset:36864
    buffer_load_dwordx4 v7, s[52:55], s14 offen offset:3072 lds
    ds_read_b64_tr_b16 a[78:79], v11 offset:38912
    s_waitcnt vmcnt(24) lgkmcnt(0)
    s_barrier
    ds_read_b64_tr_b16 a[80:81], v10 offset:49152
    s_add_u32 m0, s73, 98304
    s_lshl_b32 s14, s96, 18
    ds_read_b64_tr_b16 a[82:83], v10 offset:51200
    buffer_load_dwordx4 v4, s[52:55], s14 offen offset:0 lds
    ds_read_b64_tr_b16 a[88:89], v10 offset:53248
    ds_read_b64_tr_b16 a[90:91], v10 offset:55296
    buffer_load_dwordx4 v5, s[52:55], s14 offen offset:1024 lds
    ds_read_b64_tr_b16 a[84:85], v11 offset:49152
    buffer_load_dwordx4 v6, s[52:55], s14 offen offset:2048 lds
    ds_read_b64_tr_b16 a[86:87], v11 offset:51200
    ds_read_b64_tr_b16 a[92:93], v11 offset:53248
    buffer_load_dwordx4 v7, s[52:55], s14 offen offset:3072 lds
    ds_read_b64_tr_b16 a[94:95], v11 offset:55296
    s_waitcnt vmcnt(24) lgkmcnt(0)
    s_barrier
    v_add_u32 v10, 65536, v10
    ds_read_b64_tr_b16 a[96:97], v10 offset:0
    s_add_u32 m0, s73, 114688
    s_lshl_b32 s14, s97, 18
    ds_read_b64_tr_b16 a[98:99], v10 offset:2048
    buffer_load_dwordx4 v4, s[52:55], s14 offen offset:0 lds
    ds_read_b64_tr_b16 a[104:105], v10 offset:4096
    ds_read_b64_tr_b16 a[106:107], v10 offset:6144
    buffer_load_dwordx4 v5, s[52:55], s14 offen offset:1024 lds
    v_add_u32 v11, 65536, v11
    ds_read_b64_tr_b16 a[100:101], v11 offset:0
    buffer_load_dwordx4 v6, s[52:55], s14 offen offset:2048 lds
    ds_read_b64_tr_b16 a[102:103], v11 offset:2048
    ds_read_b64_tr_b16 a[108:109], v11 offset:4096
    buffer_load_dwordx4 v7, s[52:55], s14 offen offset:3072 lds
    ds_read_b64_tr_b16 a[110:111], v11 offset:6144
    s_waitcnt vmcnt(24) lgkmcnt(0)
    s_barrier
    ds_read_b64_tr_b16 a[112:113], v10 offset:16384
    s_add_u32 m0, s73, 131072
    s_lshl_b32 s14, s98, 18
    ds_read_b64_tr_b16 a[114:115], v10 offset:18432
    buffer_load_dwordx4 v4, s[52:55], s14 offen offset:0 lds
    ds_read_b64_tr_b16 a[120:121], v10 offset:20480
    ds_read_b64_tr_b16 a[122:123], v10 offset:22528
    buffer_load_dwordx4 v5, s[52:55], s14 offen offset:1024 lds
    ds_read_b64_tr_b16 a[116:117], v11 offset:16384
    buffer_load_dwordx4 v6, s[52:55], s14 offen offset:2048 lds
    ds_read_b64_tr_b16 a[118:119], v11 offset:18432
    ds_read_b64_tr_b16 a[124:125], v11 offset:20480
    buffer_load_dwordx4 v7, s[52:55], s14 offen offset:3072 lds
    ds_read_b64_tr_b16 a[126:127], v11 offset:22528
    s_waitcnt vmcnt(24) lgkmcnt(0)
    s_barrier
    v_add_u32 v10, -131072, v10
    ds_read_b64_tr_b16 a[128:129], v10 offset:32768
    s_add_u32 m0, s73, 147456
    s_lshl_b32 s14, s99, 18
    ds_read_b64_tr_b16 a[130:131], v10 offset:34816
    buffer_load_dwordx4 v4, s[52:55], s14 offen offset:0 lds
    ds_read_b64_tr_b16 a[136:137], v10 offset:36864
    ds_read_b64_tr_b16 a[138:139], v10 offset:38912
    buffer_load_dwordx4 v5, s[52:55], s14 offen offset:1024 lds
    v_add_u32 v11, -131072, v11
    ds_read_b64_tr_b16 a[132:133], v11 offset:32768
    buffer_load_dwordx4 v6, s[52:55], s14 offen offset:2048 lds
    ds_read_b64_tr_b16 a[134:135], v11 offset:34816
    ds_read_b64_tr_b16 a[140:141], v11 offset:36864
    buffer_load_dwordx4 v7, s[52:55], s14 offen offset:3072 lds
    ds_read_b64_tr_b16 a[142:143], v11 offset:38912
    s_waitcnt vmcnt(24) lgkmcnt(0)
    s_barrier
    ds_read_b64_tr_b16 a[144:145], v10 offset:49152
    s_add_u32 m0, s73, 0
    s_lshl_b32 s14, s100, 18
    ds_read_b64_tr_b16 a[146:147], v10 offset:51200
    buffer_load_dwordx4 v4, s[52:55], s14 offen offset:0 lds
    ds_read_b64_tr_b16 a[152:153], v10 offset:53248
    ds_read_b64_tr_b16 a[154:155], v10 offset:55296
    buffer_load_dwordx4 v5, s[52:55], s14 offen offset:1024 lds
    ds_read_b64_tr_b16 a[148:149], v11 offset:49152
    buffer_load_dwordx4 v6, s[52:55], s14 offen offset:2048 lds
    ds_read_b64_tr_b16 a[150:151], v11 offset:51200
    ds_read_b64_tr_b16 a[156:157], v11 offset:53248
    buffer_load_dwordx4 v7, s[52:55], s14 offen offset:3072 lds
    ds_read_b64_tr_b16 a[158:159], v11 offset:55296
    s_waitcnt vmcnt(24) lgkmcnt(0)
    s_barrier
    v_add_u32 v10, 65536, v10
    ds_read_b64_tr_b16 a[160:161], v10 offset:0
    s_add_u32 m0, s73, 16384
    s_lshl_b32 s14, s101, 18
    ds_read_b64_tr_b16 a[162:163], v10 offset:2048
    buffer_load_dwordx4 v4, s[52:55], s14 offen offset:0 lds
    ds_read_b64_tr_b16 a[168:169], v10 offset:4096
    ds_read_b64_tr_b16 a[170:171], v10 offset:6144
    buffer_load_dwordx4 v5, s[52:55], s14 offen offset:1024 lds
    v_add_u32 v11, 65536, v11
    ds_read_b64_tr_b16 a[164:165], v11 offset:0
    buffer_load_dwordx4 v6, s[52:55], s14 offen offset:2048 lds
    ds_read_b64_tr_b16 a[166:167], v11 offset:2048
    ds_read_b64_tr_b16 a[172:173], v11 offset:4096
    buffer_load_dwordx4 v7, s[52:55], s14 offen offset:3072 lds
    ds_read_b64_tr_b16 a[174:175], v11 offset:6144
    s_waitcnt vmcnt(24) lgkmcnt(0)
    s_barrier
    ds_read_b64_tr_b16 a[176:177], v10 offset:16384
    ds_read_b64_tr_b16 a[178:179], v10 offset:18432
    ds_read_b64_tr_b16 a[184:185], v10 offset:20480
    ds_read_b64_tr_b16 a[186:187], v10 offset:22528
    ds_read_b64_tr_b16 a[180:181], v11 offset:16384
    ds_read_b64_tr_b16 a[182:183], v11 offset:18432
    ds_read_b64_tr_b16 a[188:189], v11 offset:20480
    ds_read_b64_tr_b16 a[190:191], v11 offset:22528
    s_waitcnt vmcnt(20) lgkmcnt(0)
    s_barrier
    ds_read_b64_tr_b16 a[192:193], v10 offset:32768
    ds_read_b64_tr_b16 a[194:195], v10 offset:34816
    ds_read_b64_tr_b16 a[200:201], v10 offset:36864
    ds_read_b64_tr_b16 a[202:203], v10 offset:38912
    ds_read_b64_tr_b16 a[196:197], v11 offset:32768
    ds_read_b64_tr_b16 a[198:199], v11 offset:34816
    ds_read_b64_tr_b16 a[204:205], v11 offset:36864
    ds_read_b64_tr_b16 a[206:207], v11 offset:38912
    s_waitcnt vmcnt(16) lgkmcnt(0)
    s_barrier
    ds_read_b64_tr_b16 a[208:209], v10 offset:49152
    ds_read_b64_tr_b16 a[210:211], v10 offset:51200
    ds_read_b64_tr_b16 a[216:217], v10 offset:53248
    ds_read_b64_tr_b16 a[218:219], v10 offset:55296
    ds_read_b64_tr_b16 a[212:213], v11 offset:49152
    ds_read_b64_tr_b16 a[214:215], v11 offset:51200
    ds_read_b64_tr_b16 a[220:221], v11 offset:53248
    ds_read_b64_tr_b16 a[222:223], v11 offset:55296
    s_waitcnt vmcnt(12) lgkmcnt(0)
    s_barrier
    v_add_u32 v10, 65536, v10
    ds_read_b64_tr_b16 a[224:225], v10 offset:0
    ds_read_b64_tr_b16 a[226:227], v10 offset:2048
    ds_read_b64_tr_b16 a[232:233], v10 offset:4096
    ds_read_b64_tr_b16 a[234:235], v10 offset:6144
    v_add_u32 v11, 65536, v11
    ds_read_b64_tr_b16 a[228:229], v11 offset:0
    ds_read_b64_tr_b16 a[230:231], v11 offset:2048
    ds_read_b64_tr_b16 a[236:237], v11 offset:4096
    ds_read_b64_tr_b16 a[238:239], v11 offset:6144
    s_waitcnt vmcnt(8) lgkmcnt(0)
    s_barrier
    ds_read_b64_tr_b16 a[240:241], v10 offset:16384
    ds_read_b64_tr_b16 a[242:243], v10 offset:18432
    ds_read_b64_tr_b16 a[248:249], v10 offset:20480
    ds_read_b64_tr_b16 a[250:251], v10 offset:22528
    ds_read_b64_tr_b16 a[244:245], v11 offset:16384
    ds_read_b64_tr_b16 a[246:247], v11 offset:18432
    ds_read_b64_tr_b16 a[252:253], v11 offset:20480
    ds_read_b64_tr_b16 a[254:255], v11 offset:22528
    s_waitcnt lgkmcnt(0)
    s_barrier
    v_add_u32 v10, -131072, v10
    v_add_u32 v11, -131072, v11
    s_mov_b64 exec, 0
    s_call_b64 s[82:83], L_wc_D
    s_mov_b64 exec, -1
    s_bfe_u32 s4, s2, 0x20003
    s_lshl2_add_u32 s4, s72, s4
    s_lshl_b32 s4, s4, 3
    s_lshr_b32 s5, s2, 4
    s_and_b32 s5, s5, 6
    s_add_u32 s4, s4, s5
    s_and_b32 s5, s2, 1
    s_add_u32 s4, s4, s5
    s_lshl_b32 s4, s4, 7
    s_add_u32 s4, s4, 12566528
    v_lshl_add_u32 v28, v2, 2, s4
    s_cmp_eq_u32 s3, 0
    s_cselect_b32 s4, 18, 0
    v_cmp_gt_u32 vcc, s4, v2
    v_mov_b32 v13, 0x40000000
    s_nop 0
    v_cndmask_b32 v28, v13, v28, vcc
    v_mov_b32 v13, s68
    v_cndmask_b32 v13, 0, v13, vcc
    s_mov_b32 s5, 0
L_iw:
    s_sleep 16
    v_mov_b32 v29, 0
    buffer_atomic_add v29, v28, s[44:47], 0 offen sc0 sc1
    s_waitcnt vmcnt(0)
    v_cmp_eq_u32 vcc, 0, v13
    s_nop 1
    s_mov_b64 s[6:7], vcc
    v_cmp_ne_u32 vcc, v13, v29
    s_nop 1
    s_andn2_b64 s[8:9], exec, vcc
    s_andn2_b64 s[8:9], s[8:9], s[6:7]
    s_cbranch_scc1 L_ix
    s_cmp_eq_u64 s[6:7], exec
    s_cbranch_scc1 L_ix
    s_add_u32 s5, s5, 1
    s_cmp_lt_u32 s5, 100000
    s_cbranch_scc1 L_iw
L_ix:
    v_mov_b32 v29, 0
    buffer_atomic_add v29, v28, s[44:47], 0 offen sc0 sc1
    s_branch L_DX
L_end:
.section .rodata,"a"
.p2align 6
.amdhsa_kernel recurrent_scan__ssm_conv_h3__mixer_token_mlp__prompt_kernel
  .amdhsa_next_free_vgpr 512
  .amdhsa_next_free_sgpr 102
  .amdhsa_accum_offset 256
  .amdhsa_group_segment_fixed_size 0
  .amdhsa_kernarg_size 112
  .amdhsa_user_sgpr_count 2
  .amdhsa_user_sgpr_kernarg_segment_ptr 1
  .amdhsa_system_sgpr_workgroup_id_x 1
  .amdhsa_float_denorm_mode_32 3
.end_amdhsa_kernel
```

```asm
; @launch grid=(256,1,1) block=(256,1,1) lds=163840
.amdgcn_target "amdgcn-amd-amdhsa--gfx950"
.text
.globl recurrent_scan__ssm_conv_h3__mixer_token_mlp__prompt_kernel
.p2align 8
.type recurrent_scan__ssm_conv_h3__mixer_token_mlp__prompt_kernel,@function
recurrent_scan__ssm_conv_h3__mixer_token_mlp__prompt_kernel:
    s_cmp_lt_u32 s2, 256
    s_cbranch_scc0 L_exit
    s_load_dwordx2 s[56:57], s[0:1], 0
    s_load_dwordx2 s[48:49], s[0:1], 8
    s_load_dwordx2 s[52:53], s[0:1], 16
    s_load_dwordx2 s[60:61], s[0:1], 24
    s_load_dwordx16 s[16:31], s[0:1], 0
    s_load_dwordx8 s[32:39], s[0:1], 64
    s_load_dwordx4 s[40:43], s[0:1], 96
    s_memrealtime s[12:13]
    v_lshrrev_b32 v1, 6, v0
    v_and_b32 v2, 63, v0
    s_getpc_b64 s[6:7]
L_pc:
    s_lshr_b32 s4, s2, 1
    s_and_b32 s4, s4, 124
    v_add_u32 v22, s4, v1
    v_lshl_add_u32 v22, v2, 7, v22
    v_lshlrev_b32 v22, 7, v22
    v_min_u32 v22, L_end-L_pc-4, v22
    s_mov_b64 exec, 31
    global_load_dword v255, v22, s[6:7]
    s_mov_b64 exec, -1
    v_readfirstlane_b32 s3, v1
    s_and_b32 s4, s2, 7
    s_lshr_b32 s5, s2, 3
    s_lshl_b32 s4, s4, 5
    s_add_u32 s68, s4, s5
    v_lshrrev_b32 v3, 5, v0
    v_and_b32 v4, 31, v0
    v_mul_u32_u24 v5, 1152, v3
    v_mad_u32_u24 v5, v4, 12, v5
    s_mul_i32 s15, s68, 9216
    s_mul_i32 s4, s3, 3072
    s_add_u32 s5, s4, s15
    s_sub_u32 s5, s5, 3456
    v_lshlrev_b32 v6, 4, v2
    v_add_u32 v7, s5, v6
    v_add_u32 v58, 1024, v7
    s_add_u32 s4, s4, 114688
    s_lshl_b32 s5, s3, 11
    s_add_u32 s11, s5, s15
    s_add_u32 s5, s5, 127360
    s_cmp_lt_u32 s2, 216
    s_cselect_b32 s9, 0, 106496
    s_sub_u32 s4, s4, s9
    s_sub_u32 s5, s5, s9
    s_mov_b32 m0, s4
    s_mov_b32 s58, 2359296
    s_mov_b32 s59, 0x20000
    s_mov_b32 s50, 2359296
    s_mov_b32 s51, 0x20000
    s_mov_b32 s54, 2359296
    s_mov_b32 s55, 0x20000
    s_mov_b32 s62, 4608
    s_mov_b32 s63, 0x20000
    v_lshlrev_b32 v59, 3, v0
    s_movk_i32 s10, 4096
    v_lshlrev_b32 v91, 3, v2
    v_or_b32 v22, s2, v0
    v_lshlrev_b32 v22, 8, v22
    s_mov_b32 s66, 256
    s_mov_b32 s67, 0x20000
    s_waitcnt lgkmcnt(0)
    buffer_load_dwordx3 v[8:10], v5, s[56:59], s15 offen offset:0
    buffer_load_dwordx3 v[12:14], v5, s[56:59], s15 offen offset:384
    buffer_load_dwordx3 v[16:18], v5, s[56:59], s15 offen offset:768
    s_mov_b32 s64, s40
    s_and_b32 s65, s41, 0xffff
    s_or_b32 s12, s12, 1
    v_mov_b32 v23, s12
    buffer_store_dword v23, v22, s[64:67], 0 offen sc1
    buffer_load_dwordx4 v7, s[48:51], 0 offen lds
    s_add_u32 m0, s4, 1024
    s_cmp_eq_u32 s3, 3
    buffer_load_dwordx4 v58, s[48:51], 0 offen lds
    buffer_load_dwordx4 v58, s[48:51], 0 offen offset:1024 lds
    s_cbranch_scc1 L_xld
L_nox:
    s_mov_b32 m0, s5
    buffer_load_dwordx2 v[98:99], v59, s[60:63], 0 offen
    buffer_load_dwordx4 v6, s[52:55], s11 offen lds
    buffer_load_dwordx4 v6, s[52:55], s11 offen offset:1024 lds
    buffer_load_dwordx2 v[100:101], v59, s[60:63], 0 offen offset:2048
    buffer_load_dwordx2 v[102:103], v59, s[60:63], s10 offen
    s_mov_b32 s44, s42
    s_and_b32 s45, s43, 0xffff
    s_mov_b32 s46, 42352640
    s_mov_b32 s47, 0x20000
    s_and_b32 s5, s2, 7
    s_lshr_b32 s6, s2, 3
    s_lshr_b32 s7, s6, 2
    s_lshr_b32 s8, s3, 1
    s_lshl1_add_u32 s9, s7, s8
    s_cmp_ge_u32 s9, 10
    s_addc_u32 s14, s9, 0
    s_cmp_ge_u32 s9, 3
    s_addc_u32 s14, s14, 0
    s_lshl3_add_u32 s8, s8, 3
    s_cmp_eq_u32 s7, 7
    s_cselect_b32 s14, s8, s14
    s_and_b32 s4, s5, 1
    s_lshl4_add_u32 s71, s4, s14
    s_lshr_b32 s13, s5, 1
    s_mov_b32 s72, s13
    s_lshl_b32 s73, s3, 12
    s_mov_b32 s52, s34
    s_and_b32 s53, s35, 0xffff
    s_mov_b32 s54, 18874368
    s_mov_b32 s55, 0x20000
    s_cmp_lt_u32 s6, 27
    s_cbranch_scc0 L_aux
    s_branch L_org
L_exit:
    s_endpgm
L_xld:
    s_mov_b64 exec, 0xffffff
    buffer_load_dwordx4 v58, s[48:51], 0 offen offset:2048 lds
    s_mov_b64 exec, -1
    s_mov_b32 m0, s5
    s_nop 0
    buffer_load_dwordx4 v6, s[52:55], s11 offen offset:2048 lds
    s_branch L_nox
L_nw_G:
    s_mov_b32 s5, 0
L_nl_G:
    buffer_load_dword v45, v54, s[64:67], 0 offen sc1
    s_waitcnt vmcnt(0)
    v_readfirstlane_b32 s68, v45
    s_nop 1
    s_cmp_lg_u32 s68, 0
    s_cbranch_scc1 L_ng_G
    s_add_u32 s5, s5, 1
    s_cmp_lt_u32 s5, 100000
    s_cbranch_scc1 L_nl_G
    s_branch L_ng_G
L_rs_p1G:
    s_mov_b32 s5, 0
L_rt_p1G:
    s_mov_b64 exec, vcc
    v_mov_b32 v29, 0
    buffer_atomic_add v29, v28, s[44:47], 0 offen sc0 sc1
    s_waitcnt vmcnt(0)
    v_cmp_ne_u32 vcc, v12, v29
    s_cbranch_vccz L_rx_p1G
    s_add_u32 s5, s5, 1
    s_cmp_lt_u32 s5, 100000
    s_cbranch_scc1 L_rt_p1G
L_rx_p1G:
    s_mov_b64 exec, -1
    s_branch L_ok_p1G
L_rs_p5:
    s_mov_b32 s5, 0
L_rt_p5:
    s_mov_b64 exec, vcc
    buffer_load_dword v29, v28, s[44:47], 0 offen sc1
    s_waitcnt vmcnt(0)
    v_cmp_ne_u32 vcc, s68, v29
    s_cbranch_vccz L_rx_p5
    s_add_u32 s5, s5, 1
    s_cmp_lt_u32 s5, 100000
    s_cbranch_scc1 L_rt_p5
L_rx_p5:
    s_mov_b64 exec, -1
    s_branch L_ok_p5
L_nw_X:
    s_mov_b32 s5, 0
L_nl_X:
    buffer_load_dword v45, v54, s[64:67], 0 offen sc1
    s_waitcnt vmcnt(0)
    v_readfirstlane_b32 s68, v45
    s_nop 1
    s_cmp_lg_u32 s68, 0
    s_cbranch_scc1 L_ng_X
    s_add_u32 s5, s5, 1
    s_cmp_lt_u32 s5, 100000
    s_cbranch_scc1 L_nl_X
    s_branch L_ng_X
L_rs_p1X:
    s_mov_b32 s5, 0
L_rt_p1X:
    s_mov_b64 exec, vcc
    v_mov_b32 v29, 0
    buffer_atomic_add v29, v28, s[44:47], 0 offen sc0 sc1
    s_waitcnt vmcnt(0)
    v_cmp_ne_u32 vcc, s68, v29
    s_cbranch_vccz L_rx_p1X
    s_add_u32 s5, s5, 1
    s_cmp_lt_u32 s5, 100000
    s_cbranch_scc1 L_rt_p1X
L_rx_p1X:
    s_mov_b64 exec, -1
    s_branch L_ok_p1X
L_rs_p2G:
    s_mov_b32 s5, 0
L_rt_p2G:
    s_mov_b64 exec, vcc
    v_mov_b32 v16, 0
    buffer_atomic_add v16, v15, s[44:47], 0 offen sc0 sc1
    s_waitcnt vmcnt(0)
    v_cmp_ne_u32 vcc, v13, v16
    s_cbranch_vccz L_rx_p2G
    s_add_u32 s5, s5, 1
    s_cmp_lt_u32 s5, 100000
    s_cbranch_scc1 L_rt_p2G
L_rx_p2G:
    s_mov_b64 exec, -1
    s_branch L_ok_p2G
L_xs_a:
    s_mov_b32 s5, 0
L_xt_a:
    v_mov_b32 v187, 0
    buffer_atomic_add v187, v137, s[44:47], 0 offen offset:12 sc0 sc1
    s_waitcnt vmcnt(0)
    v_cmp_ne_u32 vcc, v138, v187
    s_cbranch_vccz L_xr_a
    s_add_u32 s5, s5, 1
    s_cmp_lt_u32 s5, 100000
    s_cbranch_scc1 L_xt_a
L_xr_a:
    buffer_load_dwordx4 v[40:43], v136, s[44:47], s34 offen offset:0 sc1
    buffer_load_dwordx4 v[44:47], v136, s[44:47], s34 offen offset:1024 sc1
    buffer_load_dwordx4 v[48:51], v136, s[44:47], s34 offen offset:2048 sc1
    s_waitcnt vmcnt(0)
    v_bitop3_b32 v43, v43, v47, s68 bitop3:0x7e
    v_bitop3_b32 v43, v43, v51, s68 bitop3:0xf6
    v_cmp_ne_u32 vcc, 0, v43
    s_cbranch_vccz L_xo_a
    s_add_u32 s5, s5, 1
    s_cmp_lt_u32 s5, 100000
    s_cbranch_scc1 L_xt_a
    s_branch L_xo_a
L_as_b:
    s_mov_b32 s5, 0
L_at_b:
    v_mov_b32 v141, 0
    buffer_atomic_add v141, v139, s[44:47], s11 offen offset:2060 sc0 sc1
    s_waitcnt vmcnt(0)
    v_cmp_ne_u32 vcc, v140, v141
    s_cbranch_vccz L_ao_b
    s_add_u32 s5, s5, 1
    s_cmp_lt_u32 s5, 100000
    s_cbranch_scc1 L_at_b
    s_branch L_ao_b
L_xs_b:
    s_mov_b32 s5, 0
L_xt_b:
    buffer_load_dwordx4 v[56:59], v136, s[44:47], s11 offen offset:0 sc1
    buffer_load_dwordx4 v[60:63], v136, s[44:47], s11 offen offset:1024 sc1
    buffer_load_dwordx4 v[64:67], v136, s[44:47], s11 offen offset:2048 sc1
    s_waitcnt vmcnt(0)
    v_bitop3_b32 v59, v59, v63, s68 bitop3:0x7e
    v_bitop3_b32 v59, v59, v67, s68 bitop3:0xf6
    v_cmp_ne_u32 vcc, 0, v59
    s_cbranch_vccz L_xo_b
    s_add_u32 s5, s5, 1
    s_cmp_lt_u32 s5, 100000
    s_cbranch_scc1 L_xt_b
    s_branch L_xo_b
L_xs_z:
    s_mov_b32 s5, 0
L_xt_z:
    buffer_load_dwordx4 v[72:75], v136, s[44:47], s12 offen offset:0 sc1
    buffer_load_dwordx4 v[76:79], v136, s[44:47], s12 offen offset:1024 sc1
    buffer_load_dwordx4 v[80:83], v136, s[44:47], s12 offen offset:2048 sc1
    s_waitcnt vmcnt(0)
    v_bitop3_b32 v75, v75, v79, s68 bitop3:0x7e
    v_bitop3_b32 v75, v75, v83, s68 bitop3:0xf6
    v_cmp_ne_u32 vcc, 0, v75
    s_cbranch_vccz L_xo_z
    s_add_u32 s5, s5, 1
    s_cmp_lt_u32 s5, 100000
    s_cbranch_scc1 L_xt_z
    s_branch L_xo_z
L_rs_p3:
    s_mov_b32 s5, 0
L_rt_p3:
    s_mov_b64 exec, vcc
    buffer_load_dword v189, v188, s[44:47], 0 offen sc1
    s_waitcnt vmcnt(0)
    v_cmp_ne_u32 vcc, s68, v189
    s_cbranch_vccz L_rx_p3
    s_add_u32 s5, s5, 1
    s_cmp_lt_u32 s5, 100000
    s_cbranch_scc1 L_rt_p3
L_rx_p3:
    s_mov_b64 exec, -1
    s_branch L_ok_p3
L_xs_8:
    s_mov_b32 s5, 0
L_xt_8:
    v_mov_b32 v187, 0
    buffer_atomic_add v187, v137, s[44:47], 0 offen offset:12 sc0 sc1
    s_waitcnt vmcnt(0)
    v_cmp_ne_u32 vcc, v138, v187
    s_cbranch_vccz L_xr_8
    s_add_u32 s5, s5, 1
    s_cmp_lt_u32 s5, 100000
    s_cbranch_scc1 L_xt_8
L_xr_8:
    buffer_load_dwordx4 v[204:207], v136, s[44:47], s35 offen offset:0 sc1
    buffer_load_dwordx4 v[208:211], v136, s[44:47], s35 offen offset:1024 sc1
    buffer_load_dwordx4 v[212:215], v136, s[44:47], s35 offen offset:2048 sc1
    buffer_load_dwordx4 v[216:219], v136, s[44:47], s35 offen offset:3072 sc1
    s_waitcnt vmcnt(0)
    v_bitop3_b32 v207, v207, v211, s36 bitop3:0x7e
    v_bitop3_b32 v207, v207, v215, s36 bitop3:0xf6
    v_bitop3_b32 v207, v207, v219, s36 bitop3:0xf6
    v_cmp_ne_u32 vcc, 0, v207
    s_cbranch_vccz L_xo_8
    s_add_u32 s5, s5, 1
    s_cmp_lt_u32 s5, 100000
    s_cbranch_scc1 L_xt_8
    s_branch L_xo_8
L_rs_p2X:
    s_mov_b32 s5, 0
L_rt_p2X:
    s_mov_b64 exec, vcc
    v_mov_b32 v29, 0
    buffer_atomic_add v29, v28, s[44:47], 0 offen sc0 sc1
    s_waitcnt vmcnt(0)
    v_cmp_ne_u32 vcc, v13, v29
    s_cbranch_vccz L_rx_p2X
    s_add_u32 s5, s5, 1
    s_cmp_lt_u32 s5, 100000
    s_cbranch_scc1 L_rt_p2X
L_rx_p2X:
    s_mov_b64 exec, -1
    s_branch L_ok_p2X
L_wc_G:
    s_cmp_eq_u32 s3, 0
    s_cbranch_scc1 L_pl_G_0
    s_cmp_eq_u32 s3, 1
    s_cbranch_scc1 L_pl_G_1
    s_cmp_eq_u32 s3, 2
    s_cbranch_scc1 L_pl_G_2
    s_branch L_pl_G_3
L_wc_X:
    s_cmp_eq_u32 s3, 0
    s_cbranch_scc1 L_pl_X_0
    s_cmp_eq_u32 s3, 1
    s_cbranch_scc1 L_pl_X_1
    s_cmp_eq_u32 s3, 2
    s_cbranch_scc1 L_pl_X_2
    s_branch L_pl_X_3
L_wc_D:
    s_cmp_eq_u32 s3, 0
    s_cbranch_scc1 L_pl_D_0
    s_cmp_eq_u32 s3, 1
    s_cbranch_scc1 L_pl_D_1
    s_cmp_eq_u32 s3, 2
    s_cbranch_scc1 L_pl_D_2
    s_branch L_wret
L_wret:
    s_setpc_b64 s[82:83]
.p2align 12
L_org:
    s_mul_i32 s7, s6, 21846
    s_lshr_b32 s7, s7, 16
    s_mul_i32 s8, s7, 3
    s_sub_u32 s12, s6, s8
    s_mul_i32 s8, s13, 9
    s_add_u32 s69, s8, s7
    s_lshl1_add_u32 s70, s12, s4
    s_mul_i32 s8, s69, 6
    s_add_u32 s75, s8, s70
    s_mov_b32 s48, s30
    s_and_b32 s49, s31, 0xffff
    s_mov_b32 s50, 18874368
    s_mov_b32 s51, 0x20000
    s_add_u32 s12, s12, s7
    s_mul_i32 s8, s12, 21846
    s_lshr_b32 s8, s8, 16
    s_mul_i32 s8, s8, 3
    s_sub_u32 s12, s12, s8
    s_mul_i32 s4, s4, 16
    s_mul_i32 s7, s12, 65538
    s_lshr_b32 s7, s7, 16
    s_mul_i32 s7, s7, 1
    s_add_u32 s5, s4, 0
    s_add_u32 s18, s7, s5
    s_add_u32 s8, s5, 3
    s_add_u32 s19, s18, 1
    s_cmp_eq_u32 s19, s8
    s_cselect_b32 s19, s5, s19
    s_add_u32 s20, s19, 1
    s_cmp_eq_u32 s20, s8
    s_cselect_b32 s20, s5, s20
    s_mul_i32 s7, s12, 65538
    s_lshr_b32 s7, s7, 16
    s_mul_i32 s7, s7, 1
    s_add_u32 s5, s4, 3
    s_add_u32 s21, s7, s5
    s_add_u32 s8, s5, 3
    s_add_u32 s22, s21, 1
    s_cmp_eq_u32 s22, s8
    s_cselect_b32 s22, s5, s22
    s_add_u32 s23, s22, 1
    s_cmp_eq_u32 s23, s8
    s_cselect_b32 s23, s5, s23
    s_mul_i32 s7, s12, 87384
    s_lshr_b32 s7, s7, 16
    s_mul_i32 s7, s7, 1
    s_add_u32 s5, s4, 6
    s_add_u32 s24, s7, s5
    s_add_u32 s8, s5, 4
    s_add_u32 s25, s24, 1
    s_cmp_eq_u32 s25, s8
    s_cselect_b32 s25, s5, s25
    s_add_u32 s26, s25, 1
    s_cmp_eq_u32 s26, s8
    s_cselect_b32 s26, s5, s26
    s_add_u32 s27, s26, 1
    s_cmp_eq_u32 s27, s8
    s_cselect_b32 s27, s5, s27
    s_mul_i32 s7, s12, 131076
    s_lshr_b32 s7, s7, 16
    s_mul_i32 s7, s7, 1
    s_add_u32 s5, s4, 10
    s_add_u32 s76, s7, s5
    s_add_u32 s8, s5, 6
    s_add_u32 s77, s76, 1
    s_cmp_eq_u32 s77, s8
    s_cselect_b32 s77, s5, s77
    s_add_u32 s78, s77, 1
    s_cmp_eq_u32 s78, s8
    s_cselect_b32 s78, s5, s78
    s_add_u32 s79, s78, 1
    s_cmp_eq_u32 s79, s8
    s_cselect_b32 s79, s5, s79
    s_add_u32 s80, s79, 1
    s_cmp_eq_u32 s80, s8
    s_cselect_b32 s80, s5, s80
    s_add_u32 s81, s80, 1
    s_cmp_eq_u32 s81, s8
    s_cselect_b32 s81, s5, s81
    v_lshrrev_b32 v24, 4, v2
    v_and_b32 v25, 15, v2
    v_lshlrev_b32 v26, 1, v24
    v_xor_b32 v25, v25, v26
    v_mul_u32_u24 v24, 9216, v24
    v_lshl_add_u32 v24, v25, 4, v24
    s_mul_i32 s7, s3, 147456
    s_lshl_b32 s8, s69, 8
    s_add_u32 s7, s7, s8
    v_add_u32 v148, s7, v24
    v_add_u32 v149, 35840, v148
    v_xor_b32 v24, 128, v148
    v_add_u32 v150, 71680, v24
    v_add_u32 v151, 35840, v150
    s_mov_b32 s9, 144896
    s_mov_b32 s11, 114688
    v_mul_u32_u24 v48, 1216, v3
    v_mad_u32_u24 v48, v4, 12, v48
    v_add_u32 v48, s9, v48
    v_mov_b32 v47, 0x40000000
    v_lshlrev_b32 v3, 3, v3
    s_lshl_b32 s5, s68, 6
    s_add_u32 s5, s5, 12386304
    v_cmp_eq_u32 vcc, 0, v4
    s_nop 1
    v_cndmask_b32 v49, v47, v3, vcc
    v_lshrrev_b32 v5, 4, v0
    v_and_b32 v4, 3, v2
    v_lshlrev_b32 v4, 3, v4
    v_lshl_add_u32 v5, v5, 5, v4
    v_bfe_u32 v6, v2, 2, 2
    v_mul_u32_u24 v4, 1216, v6
    v_mul_u32_u24 v6, 1152, v6
    v_add3_u32 v50, v4, v5, s9
    v_add3_u32 v51, v6, v5, s11
    s_mul_i32 s4, s3, 2176
    v_add_u32 v55, s4, v51
    v_lshlrev_b32 v52, 4, v0
    s_add_u32 s7, s15, 4096
    s_add_u32 s8, s15, 8192
    s_cmp_eq_u32 s3, 0
    s_cselect_b32 s8, s8, 0x40000000
    v_add_u32 v53, 2359296, v52
    v_mov_b32 v54, 0
    v_add_u32 v4, 0, v52
    v_lshrrev_b32 v5, 7, v4
    v_mul_u32_u24 v6, 9363, v5
    v_lshrrev_b32 v6, 16, v6
    v_mad_i32_i24 v5, v6, -7, v5
    v_cmp_lt_u32 vcc, 2, v5
    s_nop 1
    v_addc_co_u32 v6, vcc, 0, v6, vcc
    v_lshl_add_u32 v93, v6, 7, v4
    v_add_u32 v4, 4096, v52
    v_lshrrev_b32 v5, 7, v4
    v_mul_u32_u24 v6, 9363, v5
    v_lshrrev_b32 v6, 16, v6
    v_mad_i32_i24 v5, v6, -7, v5
    v_cmp_lt_u32 vcc, 2, v5
    s_nop 1
    v_addc_co_u32 v6, vcc, 0, v6, vcc
    v_lshl_add_u32 v94, v6, 7, v4
    v_add_u32 v4, 8192, v52
    v_lshrrev_b32 v5, 7, v4
    v_mul_u32_u24 v6, 9363, v5
    v_lshrrev_b32 v6, 16, v6
    v_mad_i32_i24 v5, v6, -7, v5
    v_cmp_lt_u32 vcc, 2, v5
    s_nop 1
    v_addc_co_u32 v6, vcc, 0, v6, vcc
    v_lshl_add_u32 v95, v6, 7, v4
    s_mul_i32 s10, s68, 11264
    s_add_u32 s10, s10, 36585472
    s_cmp_eq_u32 s3, 0
    s_cselect_b32 s83, s10, 0x40000000
    s_add_u32 s7, s10, 2883584
    s_add_u32 s8, s83, 2883584
    s_mul_i32 s4, s3, 1028
    s_sub_u32 s4, 8204, s4
    v_add_u32 v90, s4, v53
    s_bfe_u32 s6, s68, 0x20001
    s_lshl_b32 s6, s6, 6
    s_lshr_b32 s9, s68, 3
    s_lshl1_add_u32 s6, s9, s6
    s_and_b32 s9, s68, 1
    s_add_u32 s6, s6, s9
    s_lshl_b32 s4, s6, 2
    s_add_u32 s4, s4, 12533760
    v_lshl_add_u32 v1, v0, 10, s4
    s_lshl_b32 s4, s68, 2
    s_add_u32 s4, s4, 12599296
    v_lshl_add_u32 v46, v0, 10, s4
    v_cmp_gt_u32 vcc, 8, v0
    s_nop 1
    v_cndmask_b32 v1, v47, v1, vcc
    v_cmp_gt_u32 vcc, 4, v0
    s_nop 1
    v_cndmask_b32 v46, v47, v46, vcc
    s_waitcnt vmcnt(9)
    v_and_b32 v21, 0xffff0000, v8
    s_add_u32 m0, s73, 81920
    s_mul_i32 s14, s18, 589824
    buffer_load_dwordx4 v148, s[48:51], s14 offen offset:0 lds
    v_lshlrev_b32 v20, 16, v8
    v_and_b32 v23, 0xffff0000, v9
    v_lshlrev_b32 v22, 16, v9
    v_and_b32 v25, 0xffff0000, v10
    v_lshlrev_b32 v24, 16, v10
    v_and_b32 v27, 0xffff0000, v12
    v_lshlrev_b32 v26, 16, v12
    v_and_b32 v29, 0xffff0000, v13
    v_lshlrev_b32 v28, 16, v13
    v_and_b32 v31, 0xffff0000, v14
    v_lshlrev_b32 v30, 16, v14
    v_and_b32 v33, 0xffff0000, v16
    v_lshlrev_b32 v32, 16, v16
    v_and_b32 v35, 0xffff0000, v17
    v_lshlrev_b32 v34, 16, v17
    v_and_b32 v37, 0xffff0000, v18
    v_lshlrev_b32 v36, 16, v18
    v_pk_add_f32 v[38:39], v[20:21], v[22:23]
    v_pk_add_f32 v[40:41], v[24:25], v[26:27]
    v_pk_add_f32 v[42:43], v[28:29], v[30:31]
    v_pk_add_f32 v[44:45], v[32:33], v[34:35]
    v_pk_add_f32 v[38:39], v[38:39], v[40:41]
    v_pk_add_f32 v[42:43], v[42:43], v[44:45]
    v_pk_add_f32 v[38:39], v[38:39], v[36:37]
    v_pk_add_f32 v[38:39], v[38:39], v[42:43]
    v_add_f32 v56, v38, v39
    buffer_load_dwordx4 v149, s[48:51], s14 offen offset:1024 lds
    s_nop 0
    v_add_f32_dpp v56, v56, v56 row_ror:8 row_mask:0xf bank_mask:0xf
    s_nop 1
    v_add_f32_dpp v56, v56, v56 row_ror:4 row_mask:0xf bank_mask:0xf
    s_nop 1
    v_add_f32_dpp v56, v56, v56 row_ror:2 row_mask:0xf bank_mask:0xf
    s_nop 1
    v_add_f32_dpp v56, v56, v56 row_ror:1 row_mask:0xf bank_mask:0xf
    v_mov_b32 v57, v56
    s_nop 1
    v_permlane16_swap_b32 v56, v57
    v_add_f32 v56, v56, v57
    v_mul_f32 v56, 0x3ae38e39, v56
    v_pk_add_f32 v[20:21], v[20:21], v[56:57] op_sel_hi:[1,0] neg_lo:[0,1] neg_hi:[0,1]
    v_pk_add_f32 v[22:23], v[22:23], v[56:57] op_sel_hi:[1,0] neg_lo:[0,1] neg_hi:[0,1]
    v_pk_add_f32 v[24:25], v[24:25], v[56:57] op_sel_hi:[1,0] neg_lo:[0,1] neg_hi:[0,1]
    v_pk_add_f32 v[26:27], v[26:27], v[56:57] op_sel_hi:[1,0] neg_lo:[0,1] neg_hi:[0,1]
    v_pk_add_f32 v[28:29], v[28:29], v[56:57] op_sel_hi:[1,0] neg_lo:[0,1] neg_hi:[0,1]
    v_pk_add_f32 v[30:31], v[30:31], v[56:57] op_sel_hi:[1,0] neg_lo:[0,1] neg_hi:[0,1]
    v_pk_add_f32 v[32:33], v[32:33], v[56:57] op_sel_hi:[1,0] neg_lo:[0,1] neg_hi:[0,1]
    v_pk_add_f32 v[34:35], v[34:35], v[56:57] op_sel_hi:[1,0] neg_lo:[0,1] neg_hi:[0,1]
    v_pk_add_f32 v[36:37], v[36:37], v[56:57] op_sel_hi:[1,0] neg_lo:[0,1] neg_hi:[0,1]
    v_pk_mul_f32 v[38:39], v[20:21], v[20:21]
    v_pk_mul_f32 v[40:41], v[22:23], v[22:23]
    v_pk_fma_f32 v[38:39], v[24:25], v[24:25], v[38:39]
    v_pk_fma_f32 v[40:41], v[26:27], v[26:27], v[40:41]
    v_pk_fma_f32 v[38:39], v[28:29], v[28:29], v[38:39]
    v_pk_fma_f32 v[40:41], v[30:31], v[30:31], v[40:41]
    v_pk_fma_f32 v[38:39], v[32:33], v[32:33], v[38:39]
    v_pk_fma_f32 v[40:41], v[34:35], v[34:35], v[40:41]
    v_pk_fma_f32 v[38:39], v[36:37], v[36:37], v[38:39]
    buffer_load_dwordx4 v150, s[48:51], s14 offen offset:2048 lds
    v_pk_add_f32 v[38:39], v[38:39], v[40:41]
    v_add_f32 v18, v38, v39
    s_nop 1
    v_add_f32_dpp v18, v18, v18 row_ror:8 row_mask:0xf bank_mask:0xf
    s_nop 1
    v_add_f32_dpp v18, v18, v18 row_ror:4 row_mask:0xf bank_mask:0xf
    s_nop 1
    v_add_f32_dpp v18, v18, v18 row_ror:2 row_mask:0xf bank_mask:0xf
    s_nop 1
    v_add_f32_dpp v18, v18, v18 row_ror:1 row_mask:0xf bank_mask:0xf
    v_mov_b32 v19, v18
    s_nop 1
    v_permlane16_swap_b32 v18, v19
    v_add_f32 v18, v18, v19
    v_mul_f32 v18, 0x3ae38e39, v18
    v_cvt_pk_bf16_f32 v38, v56, v18
    v_lshlrev_b32 v106, 16, v38
    v_and_b32 v38, 0xffff0000, v38
    v_add_f32 v38, 0x3727c5ac, v38
    v_sub_f32 v56, v56, v106
    v_cvt_pk_bf16_f32 v38, v38, v38
    v_lshlrev_b32 v38, 16, v38
    v_sqrt_f32 v38, v38
    s_nop 0
    v_cvt_pk_bf16_f32 v38, v38, v38
    v_lshlrev_b32 v38, 16, v38
    v_rcp_f32 v107, v38
    s_nop 0
    v_mul_f32 v56, v56, v107
    v_mul_f32 v18, v18, v107
    v_mul_f32 v18, v18, v107
    v_cvt_pk_bf16_f32 v38, v56, v18
    v_lshlrev_b32 v39, 16, v38
    buffer_load_dwordx4 v151, s[48:51], s14 offen offset:3072 lds
    v_and_b32 v38, 0xffff0000, v38
    v_add_f32 v38, 0x3727c5ac, v38
    v_sub_f32 v56, v56, v39
    v_cvt_pk_bf16_f32 v38, v38, v38
    v_lshlrev_b32 v38, 16, v38
    v_sqrt_f32 v38, v38
    s_nop 0
    v_cvt_pk_bf16_f32 v38, v38, v38
    v_lshlrev_b32 v38, 16, v38
    v_rcp_f32 v38, v38
    s_nop 0
    v_mul_f32 v18, v107, v38
    v_mul_f32 v56, v56, v38
    v_pk_fma_f32 v[20:21], v[20:21], v[18:19], v[56:57] op_sel_hi:[1,0,0]
    v_pk_fma_f32 v[22:23], v[22:23], v[18:19], v[56:57] op_sel_hi:[1,0,0]
    v_pk_fma_f32 v[24:25], v[24:25], v[18:19], v[56:57] op_sel_hi:[1,0,0]
    v_pk_fma_f32 v[26:27], v[26:27], v[18:19], v[56:57] op_sel_hi:[1,0,0]
    v_pk_fma_f32 v[28:29], v[28:29], v[18:19], v[56:57] op_sel_hi:[1,0,0]
    v_pk_fma_f32 v[30:31], v[30:31], v[18:19], v[56:57] op_sel_hi:[1,0,0]
    v_pk_fma_f32 v[32:33], v[32:33], v[18:19], v[56:57] op_sel_hi:[1,0,0]
    v_pk_fma_f32 v[34:35], v[34:35], v[18:19], v[56:57] op_sel_hi:[1,0,0]
    v_pk_fma_f32 v[36:37], v[36:37], v[18:19], v[56:57] op_sel_hi:[1,0,0]
    v_cvt_pk_bf16_f32 v8, v20, v21
    v_cvt_pk_bf16_f32 v9, v22, v23
    v_cvt_pk_bf16_f32 v10, v24, v25
    v_cvt_pk_bf16_f32 v11, v26, v27
    v_cvt_pk_bf16_f32 v12, v28, v29
    v_cvt_pk_bf16_f32 v13, v30, v31
    v_cvt_pk_bf16_f32 v14, v32, v33
    v_cvt_pk_bf16_f32 v15, v34, v35
    v_cvt_pk_bf16_f32 v16, v36, v37
    ds_write_b32 v48, v8 offset:0
    ds_write_b32 v48, v9 offset:4
    ds_write_b32 v48, v10 offset:8
    ds_write_b32 v48, v11 offset:384
    ds_write_b32 v48, v12 offset:388
    ds_write_b32 v48, v13 offset:392
    ds_write_b32 v48, v14 offset:768
    ds_write_b32 v48, v15 offset:772
    ds_write_b32 v48, v16 offset:776
    buffer_store_dwordx2 v[106:107], v49, s[44:47], s5 offen sc1
    s_waitcnt lgkmcnt(0)
    s_barrier
    ds_read_b64_tr_b16 v[20:21], v50 offset:0
    ds_read_b64_tr_b16 v[22:23], v50 offset:4864
    ds_read_b64_tr_b16 v[24:25], v50 offset:512
    ds_read_b64_tr_b16 v[26:27], v50 offset:5376
    ds_read_b64_tr_b16 v[28:29], v50 offset:1024
    ds_read_b64_tr_b16 v[30:31], v50 offset:5888
    s_waitcnt lgkmcnt(4)
    buffer_store_dwordx4 v[20:23], v93, s[44:47], s10 offen sc1
    s_waitcnt lgkmcnt(2)
    buffer_store_dwordx4 v[24:27], v94, s[44:47], s10 offen sc1
    s_waitcnt lgkmcnt(0)
    buffer_store_dwordx4 v[28:31], v95, s[44:47], s83 offen sc1
    buffer_load_dword v45, v54, s[64:67], 0 offen sc1
    s_waitcnt vmcnt(9)
    s_barrier
    ds_read_b64_tr_b16 v[60:61], v51 offset:0
    ds_read_b64_tr_b16 v[62:63], v51 offset:4608
    ds_read_b64_tr_b16 v[64:65], v51 offset:9216
    ds_read_b64_tr_b16 v[66:67], v51 offset:12672
    ds_read_b64_tr_b16 v[68:69], v51 offset:17280
    ds_read_b64_tr_b16 v[70:71], v51 offset:512
    ds_read_b64_tr_b16 v[72:73], v51 offset:5120
    ds_read_b64_tr_b16 v[74:75], v51 offset:9728
    ds_read_b64_tr_b16 v[76:77], v51 offset:13184
    ds_read_b64_tr_b16 v[78:79], v51 offset:17792
    v_alignbit_b32 v114, v99, v99, 16
    v_alignbit_b32 v115, v98, v98, 16
    s_waitcnt lgkmcnt(5)
    v_alignbit_b32 v108, v61, v60, 16
    v_alignbit_b32 v109, v62, v61, 16
    v_alignbit_b32 v110, v63, v62, 16
    v_alignbit_b32 v111, v64, v63, 16
    v_alignbit_b32 v112, v65, v64, 16
    v_dot2_f32_bf16 v116, v60, v114, 0
    ds_read_b64_tr_b16 v[80:81], v51 offset:1024
    v_dot2_f32_bf16 v117, v108, v114, 0
    v_dot2_f32_bf16 v118, v61, v114, 0
    v_dot2_f32_bf16 v119, v109, v114, 0
    v_dot2_f32_bf16 v120, v62, v114, 0
    ds_read_b64_tr_b16 v[82:83], v51 offset:5632
    v_dot2_f32_bf16 v121, v110, v114, 0
    v_dot2_f32_bf16 v122, v63, v114, 0
    v_dot2_f32_bf16 v123, v111, v114, 0
    v_dot2_f32_bf16 v116, v61, v115, v116
    v_dot2_f32_bf16 v117, v109, v115, v117
    ds_read_b64_tr_b16 v[84:85], v51 offset:10240
    v_dot2_f32_bf16 v118, v62, v115, v118
    v_dot2_f32_bf16 v119, v110, v115, v119
    v_dot2_f32_bf16 v120, v63, v115, v120
    v_dot2_f32_bf16 v121, v111, v115, v121
    v_dot2_f32_bf16 v122, v64, v115, v122
    ds_read_b64_tr_b16 v[86:87], v51 offset:13696
    v_dot2_f32_bf16 v123, v112, v115, v123
    v_and_b32 v133, 0xffff0000, v66
    v_lshlrev_b32 v132, 16, v66
    v_and_b32 v135, 0xffff0000, v67
    v_lshlrev_b32 v134, 16, v67
    ds_read_b64_tr_b16 v[88:89], v51 offset:18304
    v_and_b32 v137, 0xffff0000, v68
    v_lshlrev_b32 v136, 16, v68
    v_and_b32 v139, 0xffff0000, v69
    v_lshlrev_b32 v138, 16, v69
    v_pk_mul_f32 v[116:117], v[116:117], v[132:133]
    v_pk_mul_f32 v[118:119], v[118:119], v[134:135]
    v_pk_mul_f32 v[120:121], v[120:121], v[136:137]
    v_pk_mul_f32 v[122:123], v[122:123], v[138:139]
    v_cvt_pk_bf16_f32 v160, v123, v122
    v_cvt_pk_bf16_f32 v161, v121, v120
    v_cvt_pk_bf16_f32 v162, v119, v118
    v_cvt_pk_bf16_f32 v163, v117, v116
    buffer_store_dwordx4 v[160:163], v93, s[44:47], s7 offen sc1
    v_alignbit_b32 v114, v101, v101, 16
    v_alignbit_b32 v115, v100, v100, 16
    s_waitcnt lgkmcnt(5)
    v_alignbit_b32 v108, v71, v70, 16
    v_alignbit_b32 v109, v72, v71, 16
    v_alignbit_b32 v110, v73, v72, 16
    v_alignbit_b32 v111, v74, v73, 16
    v_alignbit_b32 v112, v75, v74, 16
    v_dot2_f32_bf16 v124, v70, v114, 0
    v_dot2_f32_bf16 v125, v108, v114, 0
    v_dot2_f32_bf16 v126, v71, v114, 0
    v_dot2_f32_bf16 v127, v109, v114, 0
    v_dot2_f32_bf16 v128, v72, v114, 0
    v_dot2_f32_bf16 v129, v110, v114, 0
    v_dot2_f32_bf16 v130, v73, v114, 0
    v_dot2_f32_bf16 v131, v111, v114, 0
    v_dot2_f32_bf16 v124, v71, v115, v124
    v_dot2_f32_bf16 v125, v109, v115, v125
    v_dot2_f32_bf16 v126, v72, v115, v126
    v_dot2_f32_bf16 v127, v110, v115, v127
    v_dot2_f32_bf16 v128, v73, v115, v128
    v_dot2_f32_bf16 v129, v111, v115, v129
    v_dot2_f32_bf16 v130, v74, v115, v130
    v_dot2_f32_bf16 v131, v112, v115, v131
    v_and_b32 v133, 0xffff0000, v76
    v_lshlrev_b32 v132, 16, v76
    v_and_b32 v135, 0xffff0000, v77
    v_lshlrev_b32 v134, 16, v77
    v_and_b32 v137, 0xffff0000, v78
    v_lshlrev_b32 v136, 16, v78
    v_and_b32 v139, 0xffff0000, v79
    v_lshlrev_b32 v138, 16, v79
    v_pk_mul_f32 v[124:125], v[124:125], v[132:133]
    v_pk_mul_f32 v[126:127], v[126:127], v[134:135]
    v_pk_mul_f32 v[128:129], v[128:129], v[136:137]
    v_pk_mul_f32 v[130:131], v[130:131], v[138:139]
    v_cvt_pk_bf16_f32 v164, v131, v130
    v_cvt_pk_bf16_f32 v165, v129, v128
    v_cvt_pk_bf16_f32 v166, v127, v126
    v_cvt_pk_bf16_f32 v167, v125, v124
    buffer_store_dwordx4 v[164:167], v94, s[44:47], s7 offen sc1
    v_alignbit_b32 v114, v103, v103, 16
    v_alignbit_b32 v115, v102, v102, 16
    s_waitcnt lgkmcnt(0)
    v_alignbit_b32 v108, v81, v80, 16
    v_alignbit_b32 v109, v82, v81, 16
    v_alignbit_b32 v110, v83, v82, 16
    v_alignbit_b32 v111, v84, v83, 16
    v_alignbit_b32 v112, v85, v84, 16
    v_dot2_f32_bf16 v116, v80, v114, 0
    v_dot2_f32_bf16 v117, v108, v114, 0
    v_dot2_f32_bf16 v118, v81, v114, 0
    v_dot2_f32_bf16 v119, v109, v114, 0
    v_dot2_f32_bf16 v120, v82, v114, 0
    v_dot2_f32_bf16 v121, v110, v114, 0
    v_dot2_f32_bf16 v122, v83, v114, 0
    v_dot2_f32_bf16 v123, v111, v114, 0
    v_dot2_f32_bf16 v116, v81, v115, v116
    v_dot2_f32_bf16 v117, v109, v115, v117
    v_dot2_f32_bf16 v118, v82, v115, v118
    v_dot2_f32_bf16 v119, v110, v115, v119
    v_dot2_f32_bf16 v120, v83, v115, v120
    v_dot2_f32_bf16 v121, v111, v115, v121
    v_dot2_f32_bf16 v122, v84, v115, v122
    v_dot2_f32_bf16 v123, v112, v115, v123
    v_and_b32 v133, 0xffff0000, v86
    v_lshlrev_b32 v132, 16, v86
    v_and_b32 v135, 0xffff0000, v87
    v_lshlrev_b32 v134, 16, v87
    v_and_b32 v137, 0xffff0000, v88
    v_lshlrev_b32 v136, 16, v88
    v_and_b32 v139, 0xffff0000, v89
    v_lshlrev_b32 v138, 16, v89
    v_pk_mul_f32 v[116:117], v[116:117], v[132:133]
    v_pk_mul_f32 v[118:119], v[118:119], v[134:135]
    v_pk_mul_f32 v[120:121], v[120:121], v[136:137]
    v_pk_mul_f32 v[122:123], v[122:123], v[138:139]
    v_cvt_pk_bf16_f32 v168, v123, v122
    v_cvt_pk_bf16_f32 v169, v121, v120
    v_cvt_pk_bf16_f32 v170, v119, v118
    v_cvt_pk_bf16_f32 v171, v117, v116
    buffer_store_dwordx4 v[168:171], v95, s[44:47], s8 offen sc1
    s_add_u32 m0, s73, 98304
    s_mul_i32 s14, s19, 589824
    buffer_load_dwordx4 v148, s[48:51], s14 offen offset:0 lds
    buffer_load_dwordx4 v149, s[48:51], s14 offen offset:1024 lds
    buffer_load_dwordx4 v150, s[48:51], s14 offen offset:2048 lds
    buffer_load_dwordx4 v151, s[48:51], s14 offen offset:3072 lds
    s_add_u32 m0, s73, 0
    s_mul_i32 s14, s20, 589824
    buffer_load_dwordx4 v148, s[48:51], s14 offen offset:0 lds
    buffer_load_dwordx4 v149, s[48:51], s14 offen offset:1024 lds
    buffer_load_dwordx4 v150, s[48:51], s14 offen offset:2048 lds
    buffer_load_dwordx4 v151, s[48:51], s14 offen offset:3072 lds
    s_add_u32 m0, s73, 16384
    s_mul_i32 s14, s21, 589824
    buffer_load_dwordx4 v148, s[48:51], s14 offen offset:0 lds
    buffer_load_dwordx4 v149, s[48:51], s14 offen offset:1024 lds
    s_waitcnt vmcnt(13)
    v_readfirstlane_b32 s68, v45
    s_nop 1
    s_cmp_eq_u32 s68, 0
    s_cbranch_scc1 L_nw_G
L_ng_G:
    s_barrier
    v_mov_b32 v3, s68
    buffer_store_dword v3, v1, s[44:47], 0 offen sc1
    s_mov_b64 exec, 0
    s_call_b64 s[82:83], L_wc_G
    s_mov_b64 exec, -1
    s_waitcnt vmcnt(11)
    s_barrier
    buffer_store_dword v3, v46, s[44:47], 0 offen sc1
L_segG:
L_pl_G_0:
    s_cbranch_execz L_pl_G_4
    buffer_load_dwordx4 v150, s[48:51], s14 offen offset:2048 lds
    buffer_load_dwordx4 v151, s[48:51], s14 offen offset:3072 lds
    s_add_u32 m0, s73, 32768
    s_mul_i32 s14, s22, 589824
    buffer_load_dwordx4 v148, s[48:51], s14 offen offset:0 lds
    buffer_load_dwordx4 v149, s[48:51], s14 offen offset:1024 lds
    buffer_load_dwordx4 v150, s[48:51], s14 offen offset:2048 lds
    buffer_load_dwordx4 v151, s[48:51], s14 offen offset:3072 lds
    s_add_u32 m0, s73, 49152
    s_mul_i32 s14, s23, 589824
    buffer_load_dwordx4 v148, s[48:51], s14 offen offset:0 lds
    buffer_load_dwordx4 v149, s[48:51], s14 offen offset:1024 lds
    buffer_load_dwordx4 v150, s[48:51], s14 offen offset:2048 lds
    buffer_load_dwordx4 v151, s[48:51], s14 offen offset:3072 lds
    s_add_u32 m0, s73, 65536
    s_mul_i32 s14, s24, 589824
    buffer_load_dwordx4 v148, s[48:51], s14 offen offset:0 lds
    buffer_load_dwordx4 v149, s[48:51], s14 offen offset:1024 lds
    buffer_load_dwordx4 v150, s[48:51], s14 offen offset:2048 lds
    buffer_load_dwordx4 v151, s[48:51], s14 offen offset:3072 lds
    v_bfe_u32 v140, v2, 2, 2
    v_lshrrev_b32 v141, 4, v2
    v_lshl_add_u32 v142, v141, 3, v140
    v_lshlrev_b32 v142, 8, v142
    v_and_b32 v143, 3, v2
    v_lshl_add_u32 v142, v143, 3, v142
    v_and_b32 v141, 1, v141
    v_lshl_add_u32 v140, v141, 2, v140
    s_lshl_b32 s7, s3, 1
    v_xor_b32 v140, s7, v140
    v_lshl_add_u32 v152, v140, 5, v142
    v_xor_b32 v153, 32, v152
    v_add_u32 v154, 0x10000, v152
    v_add_u32 v155, 0x10000, v153
    v_and_b32 v24, 15, v2
    v_lshrrev_b32 v25, 4, v2
    v_mul_u32_u24 v26, 17408, v25
    v_lshl_add_u32 v26, v24, 4, v26
    v_mul_u32_u24 v25, 1536, v25
    v_lshl_add_u32 v25, v24, 4, v25
    v_add_u32 v159, 81920, v25
    v_add_u32 v250, 36864, v159
    s_mul_i32 s7, s3, 18432
    s_xor_b32 s8, s70, 1
    s_mul_i32 s8, s8, 1536
    s_add_u32 s7, s7, s8
    v_lshlrev_b32 v246, 4, v2
    v_add_u32 v156, s7, v246
    v_lshrrev_b32 v25, 5, v2
    v_mul_u32_u24 v25, 7680, v25
    v_add_u32 v157, v156, v25
    v_add_u32 v158, 7680, v156
    s_mul_i32 s74, s3, 3072
    s_add_u32 s74, s74, 81920
    v_mov_b32 v245, v26
    s_mov_b64 exec, 0
    s_call_b64 s[82:83], L_wc_D
    s_mov_b64 exec, -1
    s_mov_b32 s56, s32
    s_and_b32 s57, s33, 0xffff
    s_mov_b32 s58, 9216
    s_mov_b32 s59, 0x20000
    s_mov_b32 s60, s36
    s_and_b32 s61, s37, 0xffff
    s_mov_b32 s62, 4096
    s_mov_b32 s63, 0x20000
    s_and_b32 s4, s70, 1
    s_lshl1_add_u32 s4, s3, s4
    s_lshl_b32 s4, s4, 7
    s_bfe_u32 s5, s2, 0x10003
    s_lshl1_add_u32 s5, s72, s5
    s_lshr_b32 s5, s5, 0
    s_lshl_b32 s5, s5, 10
    s_add_u32 s4, s4, s5
    s_add_u32 s4, s4, 12533760
    v_lshl_add_u32 v28, v2, 2, s4
    v_cmp_gt_u32 vcc, 32, v2
    v_mov_b32 v12, 0x40000000
    s_nop 0
    v_cndmask_b32 v28, v12, v28, vcc
    v_mov_b32 v12, s68
    v_cndmask_b32 v12, 0, v12, vcc
    v_lshrrev_b32 v24, 4, v2
    v_lshlrev_b32 v25, 3, v24
    s_lshl_b32 s7, s69, 8
    s_lshl_b32 s8, s3, 6
    s_add_u32 s7, s7, s8
    buffer_load_dwordx2 v[144:145], v25, s[56:59], s7 offen
    buffer_load_dwordx2 v[146:147], v25, s[56:59], s7 offen offset:32
    s_waitcnt vmcnt(24)
    s_barrier
    ds_read_b64_tr_b16 a[0:1], v154 offset:16384
    ds_read_b64_tr_b16 a[2:3], v154 offset:17408
    ds_read_b64_tr_b16 a[4:5], v155 offset:16384
    ds_read_b64_tr_b16 a[6:7], v155 offset:17408
    ds_read_b64_tr_b16 a[8:9], v154 offset:24576
    ds_read_b64_tr_b16 a[10:11], v154 offset:25600
    ds_read_b64_tr_b16 a[12:13], v155 offset:24576
    ds_read_b64_tr_b16 a[14:15], v155 offset:25600
    ds_read_b64_tr_b16 a[16:17], v154 offset:32768
    ds_read_b64_tr_b16 a[18:19], v154 offset:33792
    ds_read_b64_tr_b16 a[20:21], v155 offset:32768
    ds_read_b64_tr_b16 a[22:23], v155 offset:33792
    ds_read_b64_tr_b16 a[24:25], v154 offset:40960
    ds_read_b64_tr_b16 a[26:27], v154 offset:41984
    ds_read_b64_tr_b16 a[28:29], v155 offset:40960
    ds_read_b64_tr_b16 a[30:31], v155 offset:41984
    s_waitcnt vmcnt(20)
    s_barrier
    ds_read_b64_tr_b16 a[32:33], v152 offset:0
    ds_read_b64_tr_b16 a[34:35], v152 offset:1024
    ds_read_b64_tr_b16 a[36:37], v153 offset:0
    ds_read_b64_tr_b16 a[38:39], v153 offset:1024
    ds_read_b64_tr_b16 a[40:41], v152 offset:8192
    ds_read_b64_tr_b16 a[42:43], v152 offset:9216
    ds_read_b64_tr_b16 a[44:45], v153 offset:8192
    ds_read_b64_tr_b16 a[46:47], v153 offset:9216
    s_waitcnt vmcnt(14)
    s_barrier
    ds_read_b64_tr_b16 a[48:49], v152 offset:16384
    ds_read_b64_tr_b16 a[50:51], v152 offset:17408
    ds_read_b64_tr_b16 a[52:53], v153 offset:16384
    ds_read_b64_tr_b16 a[54:55], v153 offset:17408
    ds_read_b64_tr_b16 a[56:57], v152 offset:24576
    ds_read_b64_tr_b16 a[58:59], v152 offset:25600
    ds_read_b64_tr_b16 a[60:61], v153 offset:24576
    ds_read_b64_tr_b16 a[62:63], v153 offset:25600
    v_mov_b32 v29, 0
    buffer_atomic_add v29, v28, s[44:47], 0 offen sc0 sc1
    s_waitcnt vmcnt(11)
    s_barrier
    ds_read_b64_tr_b16 a[64:65], v152 offset:32768
    ds_read_b64_tr_b16 a[66:67], v152 offset:33792
    ds_read_b64_tr_b16 a[68:69], v153 offset:32768
    ds_read_b64_tr_b16 a[70:71], v153 offset:33792
    ds_read_b64_tr_b16 a[72:73], v152 offset:40960
    ds_read_b64_tr_b16 a[74:75], v152 offset:41984
    ds_read_b64_tr_b16 a[76:77], v153 offset:40960
    ds_read_b64_tr_b16 a[78:79], v153 offset:41984
L_pl_G_1:
    s_cbranch_execz L_pl_G_5
    s_waitcnt lgkmcnt(0)
    s_barrier
    s_xor_b32 s8, s70, 1
    s_mul_i32 s8, s8, 1536
    s_mul_i32 s7, s3, 22528
    s_add_u32 s7, s7, 36585472
    v_add_u32 v24, 0, v246
    v_cmp_lt_u32 vcc, 1535, v24
    s_nop 1
    v_cndmask_b32 v25, 0, 1, vcc
    v_mul_u32_u24 v30, 1536, v25
    v_sub_u32 v24, v24, v30
    v_add_u32 v24, s8, v24
    v_lshrrev_b32 v30, 7, v24
    v_mul_u32_u24 v31, 9363, v30
    v_lshrrev_b32 v31, 16, v31
    v_mad_i32_i24 v30, v31, -7, v30
    v_cmp_lt_u32 vcc, 2, v30
    s_nop 1
    v_addc_co_u32 v31, vcc, 0, v31, vcc
    v_lshl_add_u32 v24, v31, 7, v24
    v_mul_u32_u24 v25, 11264, v25
    v_add3_u32 v24, v24, v25, s7
    v_subrev_u32 v156, 0, v24
    v_add_u32 v24, 1024, v246
    v_cmp_lt_u32 vcc, 1535, v24
    s_nop 1
    v_cndmask_b32 v25, 0, 1, vcc
    v_mul_u32_u24 v30, 1536, v25
    v_sub_u32 v24, v24, v30
    v_add_u32 v24, s8, v24
    v_lshrrev_b32 v30, 7, v24
    v_mul_u32_u24 v31, 9363, v30
    v_lshrrev_b32 v31, 16, v31
    v_mad_i32_i24 v30, v31, -7, v30
    v_cmp_lt_u32 vcc, 2, v30
    s_nop 1
    v_addc_co_u32 v31, vcc, 0, v31, vcc
    v_lshl_add_u32 v24, v31, 7, v24
    v_mul_u32_u24 v25, 11264, v25
    v_add3_u32 v24, v24, v25, s7
    v_subrev_u32 v157, 1024, v24
    v_add_u32 v24, 2048, v246
    v_cmp_lt_u32 vcc, 1535, v24
    s_nop 1
    v_cndmask_b32 v25, 0, 1, vcc
    v_mul_u32_u24 v30, 1536, v25
    v_sub_u32 v24, v24, v30
    v_add_u32 v24, s8, v24
    v_lshrrev_b32 v30, 7, v24
    v_mul_u32_u24 v31, 9363, v30
    v_lshrrev_b32 v31, 16, v31
    v_mad_i32_i24 v30, v31, -7, v30
    v_cmp_lt_u32 vcc, 2, v30
    s_nop 1
    v_addc_co_u32 v31, vcc, 0, v31, vcc
    v_lshl_add_u32 v24, v31, 7, v24
    v_mul_u32_u24 v25, 11264, v25
    v_add3_u32 v24, v24, v25, s7
    v_subrev_u32 v158, 2048, v24
    s_xor_b32 s8, s70, 0
    s_mul_i32 s8, s8, 1536
    s_mul_i32 s7, s3, 22528
    s_add_u32 s7, s7, 36585472
    v_add_u32 v24, 0, v246
    v_cmp_lt_u32 vcc, 1535, v24
    s_nop 1
    v_cndmask_b32 v25, 0, 1, vcc
    v_mul_u32_u24 v30, 1536, v25
    v_sub_u32 v24, v24, v30
    v_add_u32 v24, s8, v24
    v_lshrrev_b32 v30, 7, v24
    v_mul_u32_u24 v31, 9363, v30
    v_lshrrev_b32 v31, 16, v31
    v_mad_i32_i24 v30, v31, -7, v30
    v_cmp_lt_u32 vcc, 2, v30
    s_nop 1
    v_addc_co_u32 v31, vcc, 0, v31, vcc
    v_lshl_add_u32 v24, v31, 7, v24
    v_mul_u32_u24 v25, 11264, v25
    v_add3_u32 v24, v24, v25, s7
    v_subrev_u32 v8, 0, v24
    v_add_u32 v24, 1024, v246
    v_cmp_lt_u32 vcc, 1535, v24
    s_nop 1
    v_cndmask_b32 v25, 0, 1, vcc
    v_mul_u32_u24 v30, 1536, v25
    v_sub_u32 v24, v24, v30
    v_add_u32 v24, s8, v24
    v_lshrrev_b32 v30, 7, v24
    v_mul_u32_u24 v31, 9363, v30
    v_lshrrev_b32 v31, 16, v31
    v_mad_i32_i24 v30, v31, -7, v30
    v_cmp_lt_u32 vcc, 2, v30
    s_nop 1
    v_addc_co_u32 v31, vcc, 0, v31, vcc
    v_lshl_add_u32 v24, v31, 7, v24
    v_mul_u32_u24 v25, 11264, v25
    v_add3_u32 v24, v24, v25, s7
    v_subrev_u32 v9, 1024, v24
    v_add_u32 v24, 2048, v246
    v_cmp_lt_u32 vcc, 1535, v24
    s_nop 1
    v_cndmask_b32 v25, 0, 1, vcc
    v_mul_u32_u24 v30, 1536, v25
    v_sub_u32 v24, v24, v30
    v_add_u32 v24, s8, v24
    v_lshrrev_b32 v30, 7, v24
    v_mul_u32_u24 v31, 9363, v30
    v_lshrrev_b32 v31, 16, v31
    v_mad_i32_i24 v30, v31, -7, v30
    v_cmp_lt_u32 vcc, 2, v30
    s_nop 1
    v_addc_co_u32 v31, vcc, 0, v31, vcc
    v_lshl_add_u32 v24, v31, 7, v24
    v_mul_u32_u24 v25, 11264, v25
    v_add3_u32 v24, v24, v25, s7
    v_subrev_u32 v3, 2048, v24
    s_waitcnt vmcnt(0)
    v_cmp_ne_u32 vcc, v12, v29
    s_cbranch_vccnz L_rs_p1G
L_ok_p1G:
    s_add_u32 m0, s74, 0
    s_mul_i32 s13, s18, 90112
    buffer_load_dwordx4 v156, s[44:47], s13 offen offset:0 sc1 lds
    buffer_load_dwordx4 v157, s[44:47], s13 offen offset:1024 sc1 lds
    buffer_load_dwordx4 v158, s[44:47], s13 offen offset:2048 sc1 lds
    s_add_u32 m0, s74, 12288
    s_mul_i32 s13, s19, 90112
    buffer_load_dwordx4 v156, s[44:47], s13 offen offset:0 sc1 lds
    buffer_load_dwordx4 v157, s[44:47], s13 offen offset:1024 sc1 lds
    buffer_load_dwordx4 v158, s[44:47], s13 offen offset:2048 sc1 lds
    s_add_u32 m0, s74, 24576
    s_mul_i32 s13, s20, 90112
    buffer_load_dwordx4 v156, s[44:47], s13 offen offset:0 sc1 lds
    buffer_load_dwordx4 v157, s[44:47], s13 offen offset:1024 sc1 lds
    buffer_load_dwordx4 v158, s[44:47], s13 offen offset:2048 sc1 lds
    s_add_u32 m0, s74, 36864
    s_mul_i32 s13, s21, 90112
    buffer_load_dwordx4 v156, s[44:47], s13 offen offset:0 sc1 lds
    buffer_load_dwordx4 v157, s[44:47], s13 offen offset:1024 sc1 lds
    buffer_load_dwordx4 v158, s[44:47], s13 offen offset:2048 sc1 lds
    s_waitcnt vmcnt(9) lgkmcnt(0)
    s_barrier
    ds_read_b128 v[80:83], v159 offset:0
    ds_read_b128 v[84:87], v159 offset:6144
    ds_read_b128 v[88:91], v159 offset:256
    ds_read_b128 v[92:95], v159 offset:6400
    ds_read_b128 v[96:99], v159 offset:512
    ds_read_b128 v[100:103], v159 offset:6656
    s_waitcnt lgkmcnt(0)
    v_mfma_f32_16x16x32_bf16 v[192:195], a[0:3], v[80:83], 0
    v_mfma_f32_16x16x32_bf16 v[192:195], a[8:11], v[84:87], v[192:195]
    ds_read_b128 v[104:107], v159 offset:768
    v_mfma_f32_16x16x32_bf16 v[196:199], a[12:15], v[84:87], 0
    ds_read_b128 v[108:111], v159 offset:6912
    v_mfma_f32_16x16x32_bf16 v[196:199], a[4:7], v[80:83], v[196:199]
    ds_read_b128 v[112:115], v159 offset:1024
    v_mfma_f32_16x16x32_bf16 v[204:207], a[4:7], v[88:91], 0
    ds_read_b128 v[116:119], v159 offset:7168
    v_mfma_f32_16x16x32_bf16 v[204:207], a[12:15], v[92:95], v[204:207]
    ds_read_b128 v[120:123], v159 offset:1280
    v_mfma_f32_16x16x32_bf16 v[200:203], a[8:11], v[92:95], 0
    ds_read_b128 v[124:127], v159 offset:7424
    v_and_b32 v24, 15, v2
    s_lshl_b32 s7, s71, 6
    v_add_u32 v24, s7, v24
    s_and_b32 s8, s3, 1
    s_lshl_b32 s4, s8, 5
    v_add_u32 v25, s4, v24
    v_lshlrev_b32 v26, 3, v25
    v_mul_u32_u24 v25, 1152, v25
    v_bfe_u32 v31, v2, 4, 1
    v_lshl_add_u32 v25, v31, 5, v25
    v_lshrrev_b32 v31, 5, v2
    v_lshl_add_u32 v25, v31, 4, v25
    s_bfe_u32 s7, s2, 0x20003
    s_mul_i32 s7, s7, 288
    s_bfe_u32 s5, s2, 0x10003
    s_mul_i32 s5, s5, 32
    s_lshl_b32 s4, s72, 6
    s_add_u32 s4, s4, s7
    s_add_u32 s4, s4, s5
    s_lshl_b32 s5, s5, 3
    s_sub_u32 s7, s7, s5
    v_add_u32 v252, s4, v25
    s_xor_b32 s8, s3, s72
    s_and_b32 s4, s72, 1
    s_lshl1_add_u32 s4, s4, s8
    v_lshl_add_u32 v24, s4, 4, v24
    s_add_u32 s7, s7, 256
    s_cmp_lt_u32 s8, 2
    s_cselect_b32 s7, s7, 0x40000000
    v_lshlrev_b32 v18, 3, v24
    v_mul_u32_u24 v24, 1152, v24
    v_mfma_f32_16x16x32_bf16 v[200:203], a[0:3], v[88:91], v[200:203]
    v_mfma_f32_16x16x32_bf16 v[208:211], a[0:3], v[96:99], 0
    v_mfma_f32_16x16x32_bf16 v[208:211], a[8:11], v[100:103], v[208:211]
    v_mfma_f32_16x16x32_bf16 v[212:215], a[12:15], v[100:103], 0
    v_mfma_f32_16x16x32_bf16 v[212:215], a[4:7], v[96:99], v[212:215]
    s_waitcnt lgkmcnt(0)
    v_mfma_f32_16x16x32_bf16 v[220:223], a[4:7], v[104:107], 0
    s_waitcnt vmcnt(6)
    s_barrier
    v_mfma_f32_16x16x32_bf16 v[220:223], a[12:15], v[108:111], v[220:223]
    ds_read_b128 v[80:83], v159 offset:12288
    s_add_u32 m0, s74, 49152
    s_mul_i32 s13, s22, 90112
    v_mfma_f32_16x16x32_bf16 v[216:219], a[8:11], v[108:111], 0
    ds_read_b128 v[84:87], v159 offset:18432
    buffer_load_dwordx4 v156, s[44:47], s13 offen offset:0 sc1 lds
    v_mfma_f32_16x16x32_bf16 v[216:219], a[0:3], v[104:107], v[216:219]
    ds_read_b128 v[88:91], v159 offset:12544
    v_mfma_f32_16x16x32_bf16 v[224:227], a[0:3], v[112:115], 0
    ds_read_b128 v[92:95], v159 offset:18688
    buffer_load_dwordx4 v157, s[44:47], s13 offen offset:1024 sc1 lds
    v_mfma_f32_16x16x32_bf16 v[224:227], a[8:11], v[116:119], v[224:227]
    ds_read_b128 v[96:99], v159 offset:12800
    v_mfma_f32_16x16x32_bf16 v[228:231], a[12:15], v[116:119], 0
    ds_read_b128 v[100:103], v159 offset:18944
    buffer_load_dwordx4 v158, s[44:47], s13 offen offset:2048 sc1 lds
    v_lshrrev_b32 v31, 4, v2
    v_lshl_add_u32 v24, v31, 3, v24
    v_add_u32 v253, s7, v24
    v_lshrrev_b32 v24, 3, v2
    v_and_b32 v25, 7, v2
    v_bfe_u32 v31, v2, 4, 2
    v_lshlrev_b32 v31, 1, v31
    v_xor_b32 v25, v25, v31
    v_lshlrev_b32 v24, 12, v24
    v_lshl_add_u32 v24, v25, 4, v24
    s_mul_i32 s7, s72, 36
    s_bitcmp1_b32 s3, 0
    s_addc_u32 s7, s7, 0
    s_lshl_b32 s7, s7, 17
    s_lshl_b32 s8, s71, 7
    s_add_u32 s7, s7, s8
    v_add_u32 v4, s7, v24
    v_add_u32 v5, 31744, v4
    v_add_u32 v6, 31744, v5
    v_add_u32 v7, 31744, v6
    v_lshrrev_b32 v24, 2, v2
    v_lshlrev_b32 v24, 7, v24
    v_and_b32 v25, 3, v2
    v_lshl_add_u32 v24, v25, 3, v24
    s_and_b32 s7, s73, 8192
    v_add_u32 v24, s7, v24
    v_bfe_u32 v31, v2, 3, 2
    s_and_b32 s7, s3, 1
    s_lshl_b32 s7, s7, 1
    v_xor_b32 v31, s7, v31
    v_mfma_f32_16x16x32_bf16 v[228:231], a[4:7], v[112:115], v[228:231]
    ds_read_b64_tr_b16 a[80:81], v152 offset:49152
    v_mfma_f32_16x16x32_bf16 v[236:239], a[4:7], v[120:123], 0
    ds_read_b64_tr_b16 a[82:83], v152 offset:50176
    s_add_u32 m0, s74, 61440
    s_mul_i32 s13, s23, 90112
    v_mfma_f32_16x16x32_bf16 v[236:239], a[12:15], v[124:127], v[236:239]
    v_mfma_f32_16x16x32_bf16 v[232:235], a[8:11], v[124:127], 0
    ds_read_b64_tr_b16 a[84:85], v153 offset:49152
    buffer_load_dwordx4 v156, s[44:47], s13 offen offset:0 sc1 lds
    v_mfma_f32_16x16x32_bf16 v[232:235], a[0:3], v[120:123], v[232:235]
    ds_read_b64_tr_b16 a[86:87], v153 offset:50176
    s_waitcnt lgkmcnt(4)
    v_mfma_f32_16x16x32_bf16 v[192:195], a[16:19], v[80:83], v[192:195]
    buffer_load_dwordx4 v157, s[44:47], s13 offen offset:1024 sc1 lds
    v_mfma_f32_16x16x32_bf16 v[192:195], a[24:27], v[84:87], v[192:195]
    ds_read_b128 v[104:107], v159 offset:13056
    buffer_load_dwordx4 v158, s[44:47], s13 offen offset:2048 sc1 lds
    v_mfma_f32_16x16x32_bf16 v[196:199], a[28:31], v[84:87], v[196:199]
    ds_read_b128 v[108:111], v159 offset:19200
    v_mfma_f32_16x16x32_bf16 v[196:199], a[20:23], v[80:83], v[196:199]
    ds_read_b128 v[112:115], v159 offset:13312
    s_add_u32 m0, s73, 0
    s_mul_i32 s14, s25, 589824
    v_mfma_f32_16x16x32_bf16 v[204:207], a[20:23], v[88:91], v[204:207]
    ds_read_b128 v[116:119], v159 offset:19456
    v_mfma_f32_16x16x32_bf16 v[204:207], a[28:31], v[92:95], v[204:207]
    ds_read_b128 v[120:123], v159 offset:13568
    buffer_load_dwordx4 v148, s[48:51], s14 offen offset:0 lds
    v_mfma_f32_16x16x32_bf16 v[200:203], a[24:27], v[92:95], v[200:203]
    ds_read_b128 v[124:127], v159 offset:19712
    buffer_load_dwordx4 v149, s[48:51], s14 offen offset:1024 lds
    v_lshl_add_u32 v10, v31, 5, v24
    v_xor_b32 v11, 32, v10
    s_bfe_u32 s101, s2, 0x20003
    s_mul_i32 s101, s101, 3
    s_mul_i32 s84, s101, 305844
    s_lshr_b32 s84, s84, 18
    s_add_u32 s84, s84, 0
    s_add_u32 s85, s84, 1
    s_cmp_eq_u32 s85, 14
    s_cselect_b32 s85, 0, s85
    s_add_u32 s86, s85, 1
    s_cmp_eq_u32 s86, 14
    s_cselect_b32 s86, 0, s86
    s_add_u32 s87, s86, 1
    s_cmp_eq_u32 s87, 14
    s_cselect_b32 s87, 0, s87
    s_add_u32 s88, s87, 1
    s_cmp_eq_u32 s88, 14
    s_cselect_b32 s88, 0, s88
    s_add_u32 s89, s88, 1
    s_cmp_eq_u32 s89, 14
    s_cselect_b32 s89, 0, s89
    s_add_u32 s90, s89, 1
    s_cmp_eq_u32 s90, 14
    s_cselect_b32 s90, 0, s90
    s_add_u32 s91, s90, 1
    s_cmp_eq_u32 s91, 14
    s_cselect_b32 s91, 0, s91
    s_add_u32 s92, s91, 1
    s_cmp_eq_u32 s92, 14
    s_cselect_b32 s92, 0, s92
    s_add_u32 s93, s92, 1
    s_cmp_eq_u32 s93, 14
    s_cselect_b32 s93, 0, s93
    s_add_u32 s94, s93, 1
    s_cmp_eq_u32 s94, 14
    s_cselect_b32 s94, 0, s94
    s_add_u32 s95, s94, 1
    s_cmp_eq_u32 s95, 14
    s_cselect_b32 s95, 0, s95
    s_add_u32 s96, s95, 1
    s_cmp_eq_u32 s96, 14
    s_cselect_b32 s96, 0, s96
    s_add_u32 s97, s96, 1
    s_cmp_eq_u32 s97, 14
    s_cselect_b32 s97, 0, s97
    s_mul_i32 s98, s101, 87384
    s_lshr_b32 s98, s98, 18
    s_add_u32 s98, s98, 14
    s_add_u32 s99, s98, 1
    s_cmp_eq_u32 s99, 18
    s_cselect_b32 s99, 14, s99
    s_add_u32 s100, s99, 1
    s_cmp_eq_u32 s100, 18
    s_cselect_b32 s100, 14, s100
    s_add_u32 s101, s100, 1
    s_cmp_eq_u32 s101, 18
    s_cselect_b32 s101, 14, s101
    s_mul_i32 s7, s70, 6
    s_add_u32 s7, s7, 0
    s_mul_i32 s8, s7, 7282
    s_lshr_b32 s8, s8, 16
    s_mul_i32 s5, s8, 9
    s_sub_u32 s7, s7, s5
    s_lshl_b32 s7, s7, 2
    v_mfma_f32_16x16x32_bf16 v[200:203], a[16:19], v[88:91], v[200:203]
    ds_read_b64_tr_b16 a[88:89], v152 offset:57344
    v_mfma_f32_16x16x32_bf16 v[208:211], a[16:19], v[96:99], v[208:211]
    ds_read_b64_tr_b16 a[90:91], v152 offset:58368
    buffer_load_dwordx4 v150, s[48:51], s14 offen offset:2048 lds
    v_mfma_f32_16x16x32_bf16 v[208:211], a[24:27], v[100:103], v[208:211]
    v_mfma_f32_16x16x32_bf16 v[212:215], a[28:31], v[100:103], v[212:215]
    ds_read_b64_tr_b16 a[92:93], v153 offset:57344
    buffer_load_dwordx4 v151, s[48:51], s14 offen offset:3072 lds
    v_mfma_f32_16x16x32_bf16 v[212:215], a[20:23], v[96:99], v[212:215]
    ds_read_b64_tr_b16 a[94:95], v153 offset:58368
    s_waitcnt lgkmcnt(4)
    v_mfma_f32_16x16x32_bf16 v[220:223], a[20:23], v[104:107], v[220:223]
    s_waitcnt vmcnt(13)
    s_barrier
    v_mfma_f32_16x16x32_bf16 v[220:223], a[28:31], v[108:111], v[220:223]
    ds_read_b128 v[80:83], v159 offset:24576
    s_add_u32 m0, s74, 0
    s_mul_i32 s13, s24, 90112
    v_mfma_f32_16x16x32_bf16 v[216:219], a[24:27], v[108:111], v[216:219]
    ds_read_b128 v[84:87], v159 offset:30720
    buffer_load_dwordx4 v156, s[44:47], s13 offen offset:0 sc1 lds
    v_mfma_f32_16x16x32_bf16 v[216:219], a[16:19], v[104:107], v[216:219]
    ds_read_b128 v[88:91], v159 offset:24832
    v_mfma_f32_16x16x32_bf16 v[224:227], a[16:19], v[112:115], v[224:227]
    ds_read_b128 v[92:95], v159 offset:30976
    buffer_load_dwordx4 v157, s[44:47], s13 offen offset:1024 sc1 lds
    v_mfma_f32_16x16x32_bf16 v[224:227], a[24:27], v[116:119], v[224:227]
    ds_read_b128 v[96:99], v159 offset:25088
    v_mfma_f32_16x16x32_bf16 v[228:231], a[28:31], v[116:119], v[228:231]
    ds_read_b128 v[100:103], v159 offset:31232
    buffer_load_dwordx4 v158, s[44:47], s13 offen offset:2048 sc1 lds
    s_mov_b32 s4, 0xeca86420
    s_bitcmp1_b32 s8, 0
    s_cselect_b32 s4, 0xca864203, s4
    s_cselect_b32 s5, 14, 3
    s_lshr_b64 s[4:5], s[4:5], s7
    s_and_b32 s4, s4, 15
    s_lshl4_add_u32 s4, s8, s4
    v_lshl_add_u32 v240, s4, 8, v245
    s_mul_i32 s7, s70, 6
    s_add_u32 s7, s7, 1
    s_mul_i32 s8, s7, 7282
    s_lshr_b32 s8, s8, 16
    s_mul_i32 s5, s8, 9
    s_sub_u32 s7, s7, s5
    s_lshl_b32 s7, s7, 2
    s_mov_b32 s4, 0xeca86420
    s_bitcmp1_b32 s8, 0
    s_cselect_b32 s4, 0xca864203, s4
    s_cselect_b32 s5, 14, 3
    s_lshr_b64 s[4:5], s[4:5], s7
    s_and_b32 s4, s4, 15
    s_lshl4_add_u32 s4, s8, s4
    v_lshl_add_u32 v241, s4, 8, v245
    s_mul_i32 s7, s70, 6
    s_add_u32 s7, s7, 2
    s_mul_i32 s8, s7, 7282
    s_lshr_b32 s8, s8, 16
    s_mul_i32 s5, s8, 9
    s_sub_u32 s7, s7, s5
    s_lshl_b32 s7, s7, 2
    v_mfma_f32_16x16x32_bf16 v[228:231], a[20:23], v[112:115], v[228:231]
    ds_read_b64_tr_b16 a[96:97], v154 offset:0
    v_mfma_f32_16x16x32_bf16 v[236:239], a[20:23], v[120:123], v[236:239]
    ds_read_b64_tr_b16 a[98:99], v154 offset:1024
    s_add_u32 m0, s74, 12288
    s_mul_i32 s13, s25, 90112
    v_mfma_f32_16x16x32_bf16 v[236:239], a[28:31], v[124:127], v[236:239]
    v_mfma_f32_16x16x32_bf16 v[232:235], a[24:27], v[124:127], v[232:235]
    ds_read_b64_tr_b16 a[100:101], v155 offset:0
    buffer_load_dwordx4 v156, s[44:47], s13 offen offset:0 sc1 lds
    v_mfma_f32_16x16x32_bf16 v[232:235], a[16:19], v[120:123], v[232:235]
    ds_read_b64_tr_b16 a[102:103], v155 offset:1024
    s_waitcnt lgkmcnt(4)
    v_mfma_f32_16x16x32_bf16 v[192:195], a[32:35], v[80:83], v[192:195]
    buffer_load_dwordx4 v157, s[44:47], s13 offen offset:1024 sc1 lds
    v_mfma_f32_16x16x32_bf16 v[192:195], a[40:43], v[84:87], v[192:195]
    ds_read_b128 v[104:107], v159 offset:25344
    buffer_load_dwordx4 v158, s[44:47], s13 offen offset:2048 sc1 lds
    v_mfma_f32_16x16x32_bf16 v[196:199], a[44:47], v[84:87], v[196:199]
    ds_read_b128 v[108:111], v159 offset:31488
    v_mfma_f32_16x16x32_bf16 v[196:199], a[36:39], v[80:83], v[196:199]
    ds_read_b128 v[112:115], v159 offset:25600
    s_add_u32 m0, s73, 16384
    s_mul_i32 s14, s26, 589824
    v_mfma_f32_16x16x32_bf16 v[204:207], a[36:39], v[88:91], v[204:207]
    ds_read_b128 v[116:119], v159 offset:31744
    v_mfma_f32_16x16x32_bf16 v[204:207], a[44:47], v[92:95], v[204:207]
    ds_read_b128 v[120:123], v159 offset:25856
    buffer_load_dwordx4 v148, s[48:51], s14 offen offset:0 lds
    v_mfma_f32_16x16x32_bf16 v[200:203], a[40:43], v[92:95], v[200:203]
    ds_read_b128 v[124:127], v159 offset:32000
    buffer_load_dwordx4 v149, s[48:51], s14 offen offset:1024 lds
    s_mov_b32 s4, 0xeca86420
    s_bitcmp1_b32 s8, 0
    s_cselect_b32 s4, 0xca864203, s4
    s_cselect_b32 s5, 14, 3
    s_lshr_b64 s[4:5], s[4:5], s7
    s_and_b32 s4, s4, 15
    s_lshl4_add_u32 s4, s8, s4
    v_lshl_add_u32 v242, s4, 8, v245
    s_mul_i32 s7, s70, 6
    s_add_u32 s7, s7, 3
    s_mul_i32 s8, s7, 7282
    s_lshr_b32 s8, s8, 16
    s_mul_i32 s5, s8, 9
    s_sub_u32 s7, s7, s5
    s_lshl_b32 s7, s7, 2
    s_mov_b32 s4, 0xeca86420
    s_bitcmp1_b32 s8, 0
    s_cselect_b32 s4, 0xca864203, s4
    s_cselect_b32 s5, 14, 3
    s_lshr_b64 s[4:5], s[4:5], s7
    s_and_b32 s4, s4, 15
    s_lshl4_add_u32 s4, s8, s4
    v_lshl_add_u32 v243, s4, 8, v245
    s_mul_i32 s7, s70, 6
    s_add_u32 s7, s7, 4
    s_mul_i32 s8, s7, 7282
    s_lshr_b32 s8, s8, 16
    s_mul_i32 s5, s8, 9
    s_sub_u32 s7, s7, s5
    v_mfma_f32_16x16x32_bf16 v[200:203], a[32:35], v[88:91], v[200:203]
    ds_read_b64_tr_b16 a[104:105], v154 offset:8192
    v_mfma_f32_16x16x32_bf16 v[208:211], a[32:35], v[96:99], v[208:211]
    ds_read_b64_tr_b16 a[106:107], v154 offset:9216
    buffer_load_dwordx4 v150, s[48:51], s14 offen offset:2048 lds
    v_mfma_f32_16x16x32_bf16 v[208:211], a[40:43], v[100:103], v[208:211]
    v_mfma_f32_16x16x32_bf16 v[212:215], a[44:47], v[100:103], v[212:215]
    ds_read_b64_tr_b16 a[108:109], v155 offset:8192
    buffer_load_dwordx4 v151, s[48:51], s14 offen offset:3072 lds
    v_mfma_f32_16x16x32_bf16 v[212:215], a[36:39], v[96:99], v[212:215]
    ds_read_b64_tr_b16 a[110:111], v155 offset:9216
    s_waitcnt lgkmcnt(4)
    v_mfma_f32_16x16x32_bf16 v[220:223], a[36:39], v[104:107], v[220:223]
    s_waitcnt vmcnt(20)
    s_barrier
    v_mfma_f32_16x16x32_bf16 v[220:223], a[44:47], v[108:111], v[220:223]
    ds_read_b128 v[80:83], v250 offset:0
    s_add_u32 m0, s74, 24576
    s_mul_i32 s13, s26, 90112
    v_mfma_f32_16x16x32_bf16 v[216:219], a[40:43], v[108:111], v[216:219]
    ds_read_b128 v[84:87], v250 offset:6144
    v_mfma_f32_16x16x32_bf16 v[216:219], a[32:35], v[104:107], v[216:219]
    ds_read_b128 v[88:91], v250 offset:256
    buffer_load_dwordx4 v156, s[44:47], s13 offen offset:0 sc1 lds
    v_mfma_f32_16x16x32_bf16 v[224:227], a[32:35], v[112:115], v[224:227]
    ds_read_b128 v[92:95], v250 offset:6400
    v_mfma_f32_16x16x32_bf16 v[224:227], a[40:43], v[116:119], v[224:227]
    ds_read_b128 v[96:99], v250 offset:512
    v_mfma_f32_16x16x32_bf16 v[228:231], a[44:47], v[116:119], v[228:231]
    ds_read_b128 v[100:103], v250 offset:6656
    buffer_load_dwordx4 v157, s[44:47], s13 offen offset:1024 sc1 lds
    s_lshl_b32 s7, s7, 2
    s_mov_b32 s4, 0xeca86420
    s_bitcmp1_b32 s8, 0
    s_cselect_b32 s4, 0xca864203, s4
    s_cselect_b32 s5, 14, 3
    s_lshr_b64 s[4:5], s[4:5], s7
    s_and_b32 s4, s4, 15
    s_lshl4_add_u32 s4, s8, s4
    v_lshl_add_u32 v244, s4, 8, v245
    s_mul_i32 s7, s70, 6
    s_add_u32 s7, s7, 5
    s_mul_i32 s8, s7, 7282
    s_lshr_b32 s8, s8, 16
    s_mul_i32 s5, s8, 9
    s_sub_u32 s7, s7, s5
    s_lshl_b32 s7, s7, 2
    s_mov_b32 s4, 0xeca86420
    s_bitcmp1_b32 s8, 0
    s_cselect_b32 s4, 0xca864203, s4
    s_cselect_b32 s5, 14, 3
    s_lshr_b64 s[4:5], s[4:5], s7
    s_and_b32 s4, s4, 15
    s_lshl4_add_u32 s4, s8, s4
    v_lshl_add_u32 v245, s4, 8, v245
    s_xor_b32 s7, s75, 1
    s_lshl2_add_u32 s7, s7, s3
    s_mul_i32 s9, s7, 6144
    s_add_u32 s9, s9, 7077888
    s_lshl_b32 s7, s7, 7
    s_add_u32 s6, s7, 22822912
    s_lshl2_add_u32 s7, s75, s3
    s_mul_i32 s10, s7, 6144
    v_mfma_f32_16x16x32_bf16 v[228:231], a[36:39], v[112:115], v[228:231]
    v_mfma_f32_16x16x32_bf16 v[236:239], a[36:39], v[120:123], v[236:239]
    v_mfma_f32_16x16x32_bf16 v[236:239], a[44:47], v[124:127], v[236:239]
    buffer_load_dwordx4 v158, s[44:47], s13 offen offset:2048 sc1 lds
    v_mfma_f32_16x16x32_bf16 v[232:235], a[40:43], v[124:127], v[232:235]
    v_mfma_f32_16x16x32_bf16 v[232:235], a[32:35], v[120:123], v[232:235]
    s_waitcnt lgkmcnt(0)
    v_mfma_f32_16x16x32_bf16 v[192:195], a[48:51], v[80:83], v[192:195]
    s_add_u32 m0, s73, 32768
    s_mul_i32 s14, s27, 589824
    v_mfma_f32_16x16x32_bf16 v[192:195], a[56:59], v[84:87], v[192:195]
    ds_read_b128 v[104:107], v250 offset:768
    v_mfma_f32_16x16x32_bf16 v[196:199], a[60:63], v[84:87], v[196:199]
    ds_read_b128 v[108:111], v250 offset:6912
    buffer_load_dwordx4 v148, s[48:51], s14 offen offset:0 lds
    v_mfma_f32_16x16x32_bf16 v[196:199], a[52:55], v[80:83], v[196:199]
    ds_read_b128 v[112:115], v250 offset:1024
    v_mfma_f32_16x16x32_bf16 v[204:207], a[52:55], v[88:91], v[204:207]
    ds_read_b128 v[116:119], v250 offset:7168
    buffer_load_dwordx4 v149, s[48:51], s14 offen offset:1024 lds
    v_mfma_f32_16x16x32_bf16 v[204:207], a[60:63], v[92:95], v[204:207]
    ds_read_b128 v[120:123], v250 offset:1280
    v_mfma_f32_16x16x32_bf16 v[200:203], a[56:59], v[92:95], v[200:203]
    ds_read_b128 v[124:127], v250 offset:7424
    s_add_u32 s10, s10, 7077888
    s_lshl_b32 s7, s7, 7
    s_add_u32 s7, s7, 22822912
    v_mov_b32 v28, s7
    v_add_u32 v247, 3072, v246
    v_cmp_eq_u32 vcc, 0, v2
    v_mov_b32 v248, 0x40000000
    s_nop 0
    v_cndmask_b32 v248, v248, 0, vcc
    v_mov_b32 v249, s68
    v_and_b32 v129, 0xffff0000, v144
    v_lshlrev_b32 v128, 16, v144
    v_and_b32 v131, 0xffff0000, v145
    v_lshlrev_b32 v130, 16, v145
    v_and_b32 v133, 0xffff0000, v146
    v_lshlrev_b32 v132, 16, v146
    v_and_b32 v135, 0xffff0000, v147
    v_lshlrev_b32 v134, 16, v147
    s_mul_i32 s4, s70, 43691
    s_lshr_b32 s4, s4, 16
    s_mul_i32 s5, s70, 21846
    s_lshr_b32 s5, s5, 16
    s_mul_i32 s5, s5, 3
    s_sub_u32 s5, s70, s5
    v_mfma_f32_16x16x32_bf16 v[200:203], a[48:51], v[88:91], v[200:203]
    buffer_load_dwordx4 v150, s[48:51], s14 offen offset:2048 lds
    v_mfma_f32_16x16x32_bf16 v[208:211], a[48:51], v[96:99], v[208:211]
    v_mfma_f32_16x16x32_bf16 v[208:211], a[56:59], v[100:103], v[208:211]
    buffer_load_dwordx4 v151, s[48:51], s14 offen offset:3072 lds
    v_mfma_f32_16x16x32_bf16 v[212:215], a[60:63], v[100:103], v[212:215]
    v_mfma_f32_16x16x32_bf16 v[212:215], a[52:55], v[96:99], v[212:215]
    s_waitcnt lgkmcnt(0)
    v_mfma_f32_16x16x32_bf16 v[220:223], a[52:55], v[104:107], v[220:223]
    s_waitcnt vmcnt(17)
    s_barrier
    v_mfma_f32_16x16x32_bf16 v[220:223], a[60:63], v[108:111], v[220:223]
    ds_read_b128 v[80:83], v250 offset:12288
    s_add_u32 m0, s74, 36864
    s_mul_i32 s13, s27, 90112
    v_mfma_f32_16x16x32_bf16 v[216:219], a[56:59], v[108:111], v[216:219]
    ds_read_b128 v[84:87], v250 offset:18432
    v_mfma_f32_16x16x32_bf16 v[216:219], a[48:51], v[104:107], v[216:219]
    ds_read_b128 v[88:91], v250 offset:12544
    buffer_load_dwordx4 v156, s[44:47], s13 offen offset:0 sc1 lds
    v_mfma_f32_16x16x32_bf16 v[224:227], a[48:51], v[112:115], v[224:227]
    ds_read_b128 v[92:95], v250 offset:18688
    v_mfma_f32_16x16x32_bf16 v[224:227], a[56:59], v[116:119], v[224:227]
    ds_read_b128 v[96:99], v250 offset:12800
    v_mfma_f32_16x16x32_bf16 v[228:231], a[60:63], v[116:119], v[228:231]
    ds_read_b128 v[100:103], v250 offset:18944
    buffer_load_dwordx4 v157, s[44:47], s13 offen offset:1024 sc1 lds
    s_lshl2_add_u32 s4, s72, s4
    s_lshl_b32 s4, s4, 10
    s_mul_i32 s7, s72, 9
    s_sub_u32 s7, s69, s7
    s_lshl3_add_u32 s4, s7, s4
    s_add_u32 s4, s4, 12566528
    s_cmp_eq_u32 s5, 1
    s_cselect_b32 s7, 16, 8
    s_cmp_lg_u32 s5, 0
    s_cselect_b32 s5, 4, 0
    v_lshlrev_b32 v17, 7, v0
    v_add_u32 v17, s4, v17
    v_cmp_gt_u32 vcc, 8, v0
    v_mov_b32 v24, s5
    s_nop 0
    v_cndmask_b32 v24, 0, v24, vcc
    v_add_u32 v17, v17, v24
    v_cmp_gt_u32 vcc, s7, v0
    v_mov_b32 v24, 0x40000000
    s_nop 0
    v_cndmask_b32 v17, v24, v17, vcc
    s_bfe_u32 s4, s2, 0x20003
    s_lshl2_add_u32 s4, s72, s4
    s_lshl_b32 s4, s4, 3
    s_lshr_b32 s5, s2, 4
    v_mfma_f32_16x16x32_bf16 v[228:231], a[52:55], v[112:115], v[228:231]
    ds_read_b64_tr_b16 a[112:113], v152 offset:0
    v_mfma_f32_16x16x32_bf16 v[236:239], a[52:55], v[120:123], v[236:239]
    ds_read_b64_tr_b16 a[114:115], v152 offset:1024
    v_mfma_f32_16x16x32_bf16 v[236:239], a[60:63], v[124:127], v[236:239]
    buffer_load_dwordx4 v158, s[44:47], s13 offen offset:2048 sc1 lds
    v_mfma_f32_16x16x32_bf16 v[232:235], a[56:59], v[124:127], v[232:235]
    ds_read_b64_tr_b16 a[116:117], v153 offset:0
    v_mfma_f32_16x16x32_bf16 v[232:235], a[48:51], v[120:123], v[232:235]
    ds_read_b64_tr_b16 a[118:119], v153 offset:1024
    s_waitcnt lgkmcnt(4)
    v_mfma_f32_16x16x32_bf16 v[192:195], a[64:67], v[80:83], v[192:195]
    s_add_u32 m0, s73, 49152
    s_mul_i32 s14, s76, 589824
    v_mfma_f32_16x16x32_bf16 v[192:195], a[72:75], v[84:87], v[192:195]
    ds_read_b128 v[104:107], v250 offset:13056
    v_mfma_f32_16x16x32_bf16 v[196:199], a[76:79], v[84:87], v[196:199]
    ds_read_b128 v[108:111], v250 offset:19200
    buffer_load_dwordx4 v148, s[48:51], s14 offen offset:0 lds
    v_mfma_f32_16x16x32_bf16 v[196:199], a[68:71], v[80:83], v[196:199]
L_pl_G_2:
    s_cbranch_execz L_pl_G_6
    ds_read_b128 v[112:115], v250 offset:13312
    v_mfma_f32_16x16x32_bf16 v[204:207], a[68:71], v[88:91], v[204:207]
    ds_read_b128 v[116:119], v250 offset:19456
    buffer_load_dwordx4 v149, s[48:51], s14 offen offset:1024 lds
    v_mfma_f32_16x16x32_bf16 v[204:207], a[76:79], v[92:95], v[204:207]
    ds_read_b128 v[120:123], v250 offset:13568
    v_mfma_f32_16x16x32_bf16 v[200:203], a[72:75], v[92:95], v[200:203]
    ds_read_b128 v[124:127], v250 offset:19712
    s_and_b32 s5, s5, 6
    s_add_u32 s4, s4, s5
    s_and_b32 s5, s2, 1
    s_add_u32 s4, s4, s5
    s_lshl_b32 s4, s4, 7
    s_add_u32 s4, s4, 12566528
    v_lshl_add_u32 v15, v2, 2, s4
    s_cmp_eq_u32 s3, 0
    s_cselect_b32 s4, 18, 0
    v_cmp_gt_u32 vcc, s4, v2
    v_mov_b32 v13, 0x40000000
    s_nop 0
    v_cndmask_b32 v15, v13, v15, vcc
    v_mov_b32 v13, s68
    v_cndmask_b32 v13, 0, v13, vcc
    v_and_b32 v24, 15, v2
    v_lshrrev_b32 v25, 4, v2
    v_mul_u32_u24 v25, 17408, v25
    v_lshl_add_u32 v24, v24, 4, v25
    s_mul_i32 s7, s72, 36
    s_and_b32 s8, s3, 1
    s_add_u32 s7, s7, s8
    v_mfma_f32_16x16x32_bf16 v[200:203], a[64:67], v[88:91], v[200:203]
    ds_read_b64_tr_b16 a[120:121], v152 offset:8192
    buffer_load_dwordx4 v150, s[48:51], s14 offen offset:2048 lds
    v_mfma_f32_16x16x32_bf16 v[208:211], a[64:67], v[96:99], v[208:211]
    ds_read_b64_tr_b16 a[122:123], v152 offset:9216
    v_mfma_f32_16x16x32_bf16 v[208:211], a[72:75], v[100:103], v[208:211]
    buffer_load_dwordx4 v151, s[48:51], s14 offen offset:3072 lds
    v_mfma_f32_16x16x32_bf16 v[212:215], a[76:79], v[100:103], v[212:215]
    ds_read_b64_tr_b16 a[124:125], v153 offset:8192
    v_mfma_f32_16x16x32_bf16 v[212:215], a[68:71], v[96:99], v[212:215]
    ds_read_b64_tr_b16 a[126:127], v153 offset:9216
    s_waitcnt lgkmcnt(4)
    v_mfma_f32_16x16x32_bf16 v[220:223], a[68:71], v[104:107], v[220:223]
    s_waitcnt vmcnt(14)
    s_barrier
    v_mfma_f32_16x16x32_bf16 v[220:223], a[76:79], v[108:111], v[220:223]
    ds_read_b128 v[80:83], v250 offset:24576
    s_add_u32 m0, s74, 49152
    s_mul_i32 s13, s76, 90112
    v_mfma_f32_16x16x32_bf16 v[216:219], a[72:75], v[108:111], v[216:219]
    ds_read_b128 v[84:87], v250 offset:30720
    v_mfma_f32_16x16x32_bf16 v[216:219], a[64:67], v[104:107], v[216:219]
    ds_read_b128 v[88:91], v250 offset:24832
    buffer_load_dwordx4 v156, s[44:47], s13 offen offset:0 sc1 lds
    v_mfma_f32_16x16x32_bf16 v[224:227], a[64:67], v[112:115], v[224:227]
    ds_read_b128 v[92:95], v250 offset:30976
    v_mfma_f32_16x16x32_bf16 v[224:227], a[72:75], v[116:119], v[224:227]
    ds_read_b128 v[96:99], v250 offset:25088
    v_mfma_f32_16x16x32_bf16 v[228:231], a[76:79], v[116:119], v[228:231]
    ds_read_b128 v[100:103], v250 offset:31232
    buffer_load_dwordx4 v157, s[44:47], s13 offen offset:1024 sc1 lds
    s_mul_i32 s7, s7, 69632
    s_bfe_u32 s8, s2, 0x20003
    s_lshl_b32 s8, s8, 12
    s_add_u32 s7, s7, s8
    s_add_u32 s7, s7, 12795904
    v_add_u32 v23, s7, v24
    s_xor_b32 s7, s72, 0
    v_lshl_add_u32 v19, s7, 10, v23
    s_xor_b32 s7, s72, 1
    v_lshl_add_u32 v20, s7, 10, v23
    s_xor_b32 s7, s72, 2
    v_lshl_add_u32 v21, s7, 10, v23
    s_xor_b32 s7, s72, 3
    v_lshl_add_u32 v22, s7, 10, v23
    v_lshlrev_b32 v14, 4, v2
    v_add_u32 v14, 98304, v14
    v_add_u32 v1, 0x10000, v14
    s_mov_b32 s56, s16
    v_mfma_f32_16x16x32_bf16 v[228:231], a[68:71], v[112:115], v[228:231]
    ds_read_b64_tr_b16 a[128:129], v152 offset:16384
    v_mfma_f32_16x16x32_bf16 v[236:239], a[68:71], v[120:123], v[236:239]
    ds_read_b64_tr_b16 a[130:131], v152 offset:17408
    v_mfma_f32_16x16x32_bf16 v[236:239], a[76:79], v[124:127], v[236:239]
    buffer_load_dwordx4 v158, s[44:47], s13 offen offset:2048 sc1 lds
    v_mfma_f32_16x16x32_bf16 v[232:235], a[72:75], v[124:127], v[232:235]
    ds_read_b64_tr_b16 a[132:133], v153 offset:16384
    v_mfma_f32_16x16x32_bf16 v[232:235], a[64:67], v[120:123], v[232:235]
    ds_read_b64_tr_b16 a[134:135], v153 offset:17408
    s_waitcnt lgkmcnt(4)
    v_mfma_f32_16x16x32_bf16 v[192:195], a[80:83], v[80:83], v[192:195]
    s_add_u32 m0, s73, 65536
    s_mul_i32 s14, s77, 589824
    v_mfma_f32_16x16x32_bf16 v[192:195], a[88:91], v[84:87], v[192:195]
    ds_read_b128 v[104:107], v250 offset:25344
    v_mfma_f32_16x16x32_bf16 v[196:199], a[92:95], v[84:87], v[196:199]
    ds_read_b128 v[108:111], v250 offset:31488
    buffer_load_dwordx4 v148, s[48:51], s14 offen offset:0 lds
    v_mfma_f32_16x16x32_bf16 v[196:199], a[84:87], v[80:83], v[196:199]
    ds_read_b128 v[112:115], v250 offset:25600
    v_mfma_f32_16x16x32_bf16 v[204:207], a[84:87], v[88:91], v[204:207]
    ds_read_b128 v[116:119], v250 offset:31744
    buffer_load_dwordx4 v149, s[48:51], s14 offen offset:1024 lds
    v_mfma_f32_16x16x32_bf16 v[204:207], a[92:95], v[92:95], v[204:207]
    ds_read_b128 v[120:123], v250 offset:25856
    v_mfma_f32_16x16x32_bf16 v[200:203], a[88:91], v[92:95], v[200:203]
    ds_read_b128 v[124:127], v250 offset:32000
    s_and_b32 s57, s17, 0xffff
    s_mov_b32 s58, 2359296
    s_mov_b32 s59, 0x20000
    s_mov_b32 s40, 18432
    s_mov_b32 s42, 12386304
    s_mov_b32 s64, s38
    s_and_b32 s65, s39, 0xffff
    s_mov_b32 s66, 2359296
    s_mov_b32 s67, 0x20000
    v_lshlrev_b32 v136, 4, v2
    s_mul_i32 s7, s72, 36
    s_bitcmp1_b32 s3, 0
    s_addc_u32 s7, s7, 0
    s_lshl_b32 s7, s7, 17
    v_subrev_u32 v184, s7, v4
    v_subrev_u32 v185, s7, v5
    s_bfe_u32 s4, s2, 0x20003
    s_mul_i32 s4, s4, 9
    v_mfma_f32_16x16x32_bf16 v[200:203], a[80:83], v[88:91], v[200:203]
    ds_read_b64_tr_b16 a[136:137], v152 offset:24576
    buffer_load_dwordx4 v150, s[48:51], s14 offen offset:2048 lds
    v_mfma_f32_16x16x32_bf16 v[208:211], a[80:83], v[96:99], v[208:211]
    ds_read_b64_tr_b16 a[138:139], v152 offset:25600
    v_mfma_f32_16x16x32_bf16 v[208:211], a[88:91], v[100:103], v[208:211]
    buffer_load_dwordx4 v151, s[48:51], s14 offen offset:3072 lds
    v_mfma_f32_16x16x32_bf16 v[212:215], a[92:95], v[100:103], v[212:215]
    ds_read_b64_tr_b16 a[140:141], v153 offset:24576
    v_mfma_f32_16x16x32_bf16 v[212:215], a[84:87], v[96:99], v[212:215]
    ds_read_b64_tr_b16 a[142:143], v153 offset:25600
    s_waitcnt lgkmcnt(4)
    v_mfma_f32_16x16x32_bf16 v[220:223], a[84:87], v[104:107], v[220:223]
    s_waitcnt vmcnt(14)
    s_barrier
    v_mfma_f32_16x16x32_bf16 v[220:223], a[92:95], v[108:111], v[220:223]
    ds_read_b128 v[80:83], v159 offset:0
    s_add_u32 m0, s74, 61440
    s_mul_i32 s13, s77, 90112
    v_mfma_f32_16x16x32_bf16 v[216:219], a[88:91], v[108:111], v[216:219]
    ds_read_b128 v[84:87], v159 offset:6144
    v_mfma_f32_16x16x32_bf16 v[216:219], a[80:83], v[104:107], v[216:219]
    ds_read_b128 v[88:91], v159 offset:256
    buffer_load_dwordx4 v156, s[44:47], s13 offen offset:0 sc1 lds
    v_mfma_f32_16x16x32_bf16 v[224:227], a[80:83], v[112:115], v[224:227]
    ds_read_b128 v[92:95], v159 offset:6400
    v_mfma_f32_16x16x32_bf16 v[224:227], a[88:91], v[116:119], v[224:227]
    ds_read_b128 v[96:99], v159 offset:512
    v_mfma_f32_16x16x32_bf16 v[228:231], a[92:95], v[116:119], v[228:231]
    ds_read_b128 v[100:103], v159 offset:6656
    buffer_load_dwordx4 v157, s[44:47], s13 offen offset:1024 sc1 lds
    s_lshl1_add_u32 s7, s72, s4
    s_and_b32 s8, s3, 1
    s_add_u32 s7, s7, s8
    s_bfe_u32 s8, s2, 65539
    s_add_u32 s7, s7, s8
    s_lshl_b32 s8, s8, 3
    s_sub_u32 s4, s4, s8
    s_lshl_b32 s37, s7, 16
    s_add_u32 s37, s37, 4718592
    s_add_u32 s4, s4, 8
    s_lshl_b32 s16, s4, 16
    s_add_u32 s16, s16, 4718592
    s_sub_u32 s4, s4, s7
    s_lshl_b32 s4, s4, 7
    s_lshl_b32 s7, s7, 7
    v_mfma_f32_16x16x32_bf16 v[228:231], a[84:87], v[112:115], v[228:231]
    ds_read_b64_tr_b16 a[144:145], v152 offset:32768
    v_mfma_f32_16x16x32_bf16 v[236:239], a[84:87], v[120:123], v[236:239]
    ds_read_b64_tr_b16 a[146:147], v152 offset:33792
    v_mfma_f32_16x16x32_bf16 v[236:239], a[92:95], v[124:127], v[236:239]
    buffer_load_dwordx4 v158, s[44:47], s13 offen offset:2048 sc1 lds
    v_mfma_f32_16x16x32_bf16 v[232:235], a[88:91], v[124:127], v[232:235]
    ds_read_b64_tr_b16 a[148:149], v153 offset:32768
    v_mfma_f32_16x16x32_bf16 v[232:235], a[80:83], v[120:123], v[232:235]
    ds_read_b64_tr_b16 a[150:151], v153 offset:33792
    s_waitcnt lgkmcnt(4)
    v_mfma_f32_16x16x32_bf16 v[192:195], a[96:99], v[80:83], v[192:195]
    s_add_u32 m0, s73, 0
    s_mul_i32 s14, s78, 589824
    v_mfma_f32_16x16x32_bf16 v[192:195], a[104:107], v[84:87], v[192:195]
    ds_read_b128 v[104:107], v159 offset:768
    v_mfma_f32_16x16x32_bf16 v[196:199], a[108:111], v[84:87], v[196:199]
    ds_read_b128 v[108:111], v159 offset:6912
    buffer_load_dwordx4 v148, s[48:51], s14 offen offset:0 lds
    v_mfma_f32_16x16x32_bf16 v[196:199], a[100:103], v[80:83], v[196:199]
    ds_read_b128 v[112:115], v159 offset:1024
    v_mfma_f32_16x16x32_bf16 v[204:207], a[100:103], v[88:91], v[204:207]
    ds_read_b128 v[116:119], v159 offset:7168
    buffer_load_dwordx4 v149, s[48:51], s14 offen offset:1024 lds
    v_mfma_f32_16x16x32_bf16 v[204:207], a[108:111], v[92:95], v[204:207]
    ds_read_b128 v[120:123], v159 offset:1280
    v_mfma_f32_16x16x32_bf16 v[200:203], a[104:107], v[92:95], v[200:203]
    ds_read_b128 v[124:127], v159 offset:7424
    s_add_u32 s7, s7, 12582912
    v_bfe_u32 v24, v2, 2, 1
    v_mul_i32_i24 v24, s4, v24
    v_and_b32 v25, 3, v2
    v_lshl_add_u32 v24, v25, 2, v24
    v_add_u32 v188, s7, v24
    s_lshl2_add_u32 s7, s2, s3
    s_mul_i32 s8, s7, 3072
    s_add_u32 s34, s8, 22953984
    s_add_u32 s11, s8, 26099712
    s_add_u32 s12, s8, 29245440
    s_lshl_b32 s35, s7, 12
    s_add_u32 s35, s35, 32391168
    s_xor_b32 s8, s7, 8
    s_mul_i32 s8, s8, 3072
    v_mfma_f32_16x16x32_bf16 v[200:203], a[96:99], v[88:91], v[200:203]
    ds_read_b64_tr_b16 a[152:153], v152 offset:40960
    buffer_load_dwordx4 v150, s[48:51], s14 offen offset:2048 lds
    v_mfma_f32_16x16x32_bf16 v[208:211], a[96:99], v[96:99], v[208:211]
    ds_read_b64_tr_b16 a[154:155], v152 offset:41984
    v_mfma_f32_16x16x32_bf16 v[208:211], a[104:107], v[100:103], v[208:211]
    buffer_load_dwordx4 v151, s[48:51], s14 offen offset:3072 lds
    v_mfma_f32_16x16x32_bf16 v[212:215], a[108:111], v[100:103], v[212:215]
    ds_read_b64_tr_b16 a[156:157], v153 offset:40960
    v_mfma_f32_16x16x32_bf16 v[212:215], a[100:103], v[96:99], v[212:215]
    ds_read_b64_tr_b16 a[158:159], v153 offset:41984
    s_waitcnt lgkmcnt(4)
    v_mfma_f32_16x16x32_bf16 v[220:223], a[100:103], v[104:107], v[220:223]
    s_waitcnt vmcnt(14)
    s_barrier
    v_mfma_f32_16x16x32_bf16 v[220:223], a[108:111], v[108:111], v[220:223]
    ds_read_b128 v[80:83], v159 offset:12288
    s_add_u32 m0, s74, 0
    s_mul_i32 s13, s78, 90112
    v_mfma_f32_16x16x32_bf16 v[216:219], a[104:107], v[108:111], v[216:219]
    ds_read_b128 v[84:87], v159 offset:18432
    v_mfma_f32_16x16x32_bf16 v[216:219], a[96:99], v[104:107], v[216:219]
    ds_read_b128 v[88:91], v159 offset:12544
    buffer_load_dwordx4 v156, s[44:47], s13 offen offset:0 sc1 lds
    v_mfma_f32_16x16x32_bf16 v[224:227], a[96:99], v[112:115], v[224:227]
    ds_read_b128 v[92:95], v159 offset:18688
    v_mfma_f32_16x16x32_bf16 v[224:227], a[104:107], v[116:119], v[224:227]
    ds_read_b128 v[96:99], v159 offset:12800
    v_mfma_f32_16x16x32_bf16 v[228:231], a[108:111], v[116:119], v[228:231]
    ds_read_b128 v[100:103], v159 offset:18944
    buffer_load_dwordx4 v157, s[44:47], s13 offen offset:1024 sc1 lds
    s_add_u32 s30, s8, 22953984
    s_xor_b32 s8, s7, 16
    s_mul_i32 s8, s8, 3072
    s_add_u32 s15, s8, 26099712
    s_xor_b32 s8, s7, 24
    s_mul_i32 s8, s8, 3072
    s_add_u32 s31, s8, 29245440
    s_andn2_b32 s7, s7, 24
    s_lshl3_add_u32 s7, s3, s7
    s_lshl2_add_u32 s8, s7, s72
    s_lshl_b32 s8, s8, 10
    s_add_u32 s32, s8, 32391168
    v_mfma_f32_16x16x32_bf16 v[228:231], a[100:103], v[112:115], v[228:231]
    ds_read_b64_tr_b16 a[160:161], v152 offset:49152
    v_mfma_f32_16x16x32_bf16 v[236:239], a[100:103], v[120:123], v[236:239]
    ds_read_b64_tr_b16 a[162:163], v152 offset:50176
    v_mfma_f32_16x16x32_bf16 v[236:239], a[108:111], v[124:127], v[236:239]
    buffer_load_dwordx4 v158, s[44:47], s13 offen offset:2048 sc1 lds
    v_mfma_f32_16x16x32_bf16 v[232:235], a[104:107], v[124:127], v[232:235]
    ds_read_b64_tr_b16 a[164:165], v153 offset:49152
    v_mfma_f32_16x16x32_bf16 v[232:235], a[96:99], v[120:123], v[232:235]
    ds_read_b64_tr_b16 a[166:167], v153 offset:50176
    s_waitcnt lgkmcnt(4)
    v_mfma_f32_16x16x32_bf16 v[192:195], a[112:115], v[80:83], v[192:195]
    s_add_u32 m0, s73, 16384
    s_mul_i32 s14, s79, 589824
    v_mfma_f32_16x16x32_bf16 v[192:195], a[120:123], v[84:87], v[192:195]
    ds_read_b128 v[104:107], v159 offset:13056
    v_mfma_f32_16x16x32_bf16 v[196:199], a[124:127], v[84:87], v[196:199]
    ds_read_b128 v[108:111], v159 offset:19200
    buffer_load_dwordx4 v148, s[48:51], s14 offen offset:0 lds
    v_mfma_f32_16x16x32_bf16 v[196:199], a[116:119], v[80:83], v[196:199]
    ds_read_b128 v[112:115], v159 offset:13312
    v_mfma_f32_16x16x32_bf16 v[204:207], a[116:119], v[88:91], v[204:207]
    ds_read_b128 v[116:119], v159 offset:19456
    buffer_load_dwordx4 v149, s[48:51], s14 offen offset:1024 lds
    v_mfma_f32_16x16x32_bf16 v[204:207], a[124:127], v[92:95], v[204:207]
    ds_read_b128 v[120:123], v159 offset:13568
    v_mfma_f32_16x16x32_bf16 v[200:203], a[120:123], v[92:95], v[200:203]
    ds_read_b128 v[124:127], v159 offset:19712
    s_xor_b32 s8, s8, 4096
    s_add_u32 s33, s8, 32391168
    s_xor_b32 s8, s3, s72
    s_cmp_lt_u32 s8, 2
    s_cselect_b32 s35, s35, 0x40000000
    s_cselect_b32 s16, s16, 0x40000000
    s_cselect_b32 s36, s68, 0
    s_mov_b32 s38, 0xbfb8aa3b
    s_and_b32 s8, s8, 1
    s_mul_i32 s41, s8, 96
    s_and_b32 s43, s73, 4096
    v_lshlrev_b32 v24, 10, v2
    v_add_u32 v24, s35, v24
    s_add_u32 s7, s34, 2048
    v_mov_b32 v25, s36
    v_mfma_f32_16x16x32_bf16 v[200:203], a[112:115], v[88:91], v[200:203]
    ds_read_b64_tr_b16 a[168:169], v152 offset:57344
    buffer_load_dwordx4 v150, s[48:51], s14 offen offset:2048 lds
    v_mfma_f32_16x16x32_bf16 v[208:211], a[112:115], v[96:99], v[208:211]
    ds_read_b64_tr_b16 a[170:171], v152 offset:58368
    v_mfma_f32_16x16x32_bf16 v[208:211], a[120:123], v[100:103], v[208:211]
    buffer_load_dwordx4 v151, s[48:51], s14 offen offset:3072 lds
    v_mfma_f32_16x16x32_bf16 v[212:215], a[124:127], v[100:103], v[212:215]
    ds_read_b64_tr_b16 a[172:173], v153 offset:57344
    v_mfma_f32_16x16x32_bf16 v[212:215], a[116:119], v[96:99], v[212:215]
    ds_read_b64_tr_b16 a[174:175], v153 offset:58368
    s_waitcnt lgkmcnt(4)
    v_mfma_f32_16x16x32_bf16 v[220:223], a[116:119], v[104:107], v[220:223]
    s_waitcnt vmcnt(14)
    s_barrier
    v_mfma_f32_16x16x32_bf16 v[220:223], a[124:127], v[108:111], v[220:223]
    ds_read_b128 v[80:83], v159 offset:24576
    s_add_u32 m0, s74, 12288
    s_mul_i32 s13, s79, 90112
    v_mfma_f32_16x16x32_bf16 v[216:219], a[120:123], v[108:111], v[216:219]
    ds_read_b128 v[84:87], v159 offset:30720
    v_mfma_f32_16x16x32_bf16 v[216:219], a[112:115], v[104:107], v[216:219]
    ds_read_b128 v[88:91], v159 offset:24832
    buffer_load_dwordx4 v156, s[44:47], s13 offen offset:0 sc1 lds
    v_mfma_f32_16x16x32_bf16 v[224:227], a[112:115], v[112:115], v[224:227]
    ds_read_b128 v[92:95], v159 offset:30976
    v_mfma_f32_16x16x32_bf16 v[224:227], a[120:123], v[116:119], v[224:227]
    ds_read_b128 v[96:99], v159 offset:25088
    v_mfma_f32_16x16x32_bf16 v[228:231], a[124:127], v[116:119], v[228:231]
    ds_read_b128 v[100:103], v159 offset:31232
    buffer_load_dwordx4 v157, s[44:47], s13 offen offset:1024 sc1 lds
    v_cmp_gt_u32 vcc, 4, v2
    s_nop 1
    v_cndmask_b32 v138, 0, v25, vcc
    v_mov_b32 v25, 0x40000000
    v_cndmask_b32 v137, v25, v24, vcc
    v_writelane_b32 v137, s7, 4
    v_writelane_b32 v138, s68, 4
    v_min_u32 v139, 1, v2
    v_lshlrev_b32 v139, 30, v139
    v_mov_b32 v140, 0
    v_writelane_b32 v140, s68, 0
    v_mfma_f32_16x16x32_bf16 v[228:231], a[116:119], v[112:115], v[228:231]
    ds_read_b64_tr_b16 a[176:177], v154 offset:0
    v_mfma_f32_16x16x32_bf16 v[236:239], a[116:119], v[120:123], v[236:239]
    ds_read_b64_tr_b16 a[178:179], v154 offset:1024
    v_mfma_f32_16x16x32_bf16 v[236:239], a[124:127], v[124:127], v[236:239]
    buffer_load_dwordx4 v158, s[44:47], s13 offen offset:2048 sc1 lds
    v_mfma_f32_16x16x32_bf16 v[232:235], a[120:123], v[124:127], v[232:235]
    ds_read_b64_tr_b16 a[180:181], v155 offset:0
    v_mfma_f32_16x16x32_bf16 v[232:235], a[112:115], v[120:123], v[232:235]
    ds_read_b64_tr_b16 a[182:183], v155 offset:1024
    s_waitcnt lgkmcnt(4)
    v_mfma_f32_16x16x32_bf16 v[192:195], a[128:131], v[80:83], v[192:195]
    s_add_u32 m0, s73, 32768
    s_mul_i32 s14, s80, 589824
    v_mfma_f32_16x16x32_bf16 v[192:195], a[136:139], v[84:87], v[192:195]
    ds_read_b128 v[104:107], v159 offset:25344
    v_mfma_f32_16x16x32_bf16 v[196:199], a[140:143], v[84:87], v[196:199]
    ds_read_b128 v[108:111], v159 offset:31488
    buffer_load_dwordx4 v148, s[48:51], s14 offen offset:0 lds
    v_mfma_f32_16x16x32_bf16 v[196:199], a[132:135], v[80:83], v[196:199]
    ds_read_b128 v[112:115], v159 offset:25600
    v_mfma_f32_16x16x32_bf16 v[204:207], a[132:135], v[88:91], v[204:207]
    ds_read_b128 v[116:119], v159 offset:31744
    buffer_load_dwordx4 v149, s[48:51], s14 offen offset:1024 lds
    v_mfma_f32_16x16x32_bf16 v[204:207], a[140:143], v[92:95], v[204:207]
    ds_read_b128 v[120:123], v159 offset:25856
    v_mfma_f32_16x16x32_bf16 v[200:203], a[136:139], v[92:95], v[200:203]
    ds_read_b128 v[124:127], v159 offset:32000
    v_mfma_f32_16x16x32_bf16 v[200:203], a[128:131], v[88:91], v[200:203]
    ds_read_b64_tr_b16 a[184:185], v154 offset:8192
    buffer_load_dwordx4 v150, s[48:51], s14 offen offset:2048 lds
    v_mfma_f32_16x16x32_bf16 v[208:211], a[128:131], v[96:99], v[208:211]
    ds_read_b64_tr_b16 a[186:187], v154 offset:9216
    v_mfma_f32_16x16x32_bf16 v[208:211], a[136:139], v[100:103], v[208:211]
    buffer_load_dwordx4 v151, s[48:51], s14 offen offset:3072 lds
    v_mfma_f32_16x16x32_bf16 v[212:215], a[140:143], v[100:103], v[212:215]
    ds_read_b64_tr_b16 a[188:189], v155 offset:8192
    v_mfma_f32_16x16x32_bf16 v[212:215], a[132:135], v[96:99], v[212:215]
    ds_read_b64_tr_b16 a[190:191], v155 offset:9216
    s_waitcnt lgkmcnt(4)
    v_mfma_f32_16x16x32_bf16 v[220:223], a[132:135], v[104:107], v[220:223]
    s_waitcnt vmcnt(14)
    s_barrier
    v_mfma_f32_16x16x32_bf16 v[220:223], a[140:143], v[108:111], v[220:223]
    ds_read_b128 v[80:83], v250 offset:0
    s_add_u32 m0, s74, 24576
    s_mul_i32 s13, s80, 90112
    v_mfma_f32_16x16x32_bf16 v[216:219], a[136:139], v[108:111], v[216:219]
    ds_read_b128 v[84:87], v250 offset:6144
    v_mfma_f32_16x16x32_bf16 v[216:219], a[128:131], v[104:107], v[216:219]
    ds_read_b128 v[88:91], v250 offset:256
    buffer_load_dwordx4 v156, s[44:47], s13 offen offset:0 sc1 lds
    v_mfma_f32_16x16x32_bf16 v[224:227], a[128:131], v[112:115], v[224:227]
    ds_read_b128 v[92:95], v250 offset:6400
    v_mfma_f32_16x16x32_bf16 v[224:227], a[136:139], v[116:119], v[224:227]
    ds_read_b128 v[96:99], v250 offset:512
    v_mfma_f32_16x16x32_bf16 v[228:231], a[140:143], v[116:119], v[228:231]
    ds_read_b128 v[100:103], v250 offset:6656
    buffer_load_dwordx4 v157, s[44:47], s13 offen offset:1024 sc1 lds
    v_mfma_f32_16x16x32_bf16 v[228:231], a[132:135], v[112:115], v[228:231]
    ds_read_b64_tr_b16 a[192:193], v152 offset:0
    v_mfma_f32_16x16x32_bf16 v[236:239], a[132:135], v[120:123], v[236:239]
    ds_read_b64_tr_b16 a[194:195], v152 offset:1024
    v_mfma_f32_16x16x32_bf16 v[236:239], a[140:143], v[124:127], v[236:239]
    buffer_load_dwordx4 v158, s[44:47], s13 offen offset:2048 sc1 lds
    v_mfma_f32_16x16x32_bf16 v[232:235], a[136:139], v[124:127], v[232:235]
    ds_read_b64_tr_b16 a[196:197], v153 offset:0
    v_mfma_f32_16x16x32_bf16 v[232:235], a[128:131], v[120:123], v[232:235]
    ds_read_b64_tr_b16 a[198:199], v153 offset:1024
    s_waitcnt lgkmcnt(4)
    v_mfma_f32_16x16x32_bf16 v[192:195], a[144:147], v[80:83], v[192:195]
    s_add_u32 m0, s73, 49152
    s_mul_i32 s14, s81, 589824
    v_mfma_f32_16x16x32_bf16 v[192:195], a[152:155], v[84:87], v[192:195]
    ds_read_b128 v[104:107], v250 offset:768
    v_mfma_f32_16x16x32_bf16 v[196:199], a[156:159], v[84:87], v[196:199]
    ds_read_b128 v[108:111], v250 offset:6912
    buffer_load_dwordx4 v148, s[48:51], s14 offen offset:0 lds
    v_mfma_f32_16x16x32_bf16 v[196:199], a[148:151], v[80:83], v[196:199]
    ds_read_b128 v[112:115], v250 offset:1024
    v_mfma_f32_16x16x32_bf16 v[204:207], a[148:151], v[88:91], v[204:207]
    ds_read_b128 v[116:119], v250 offset:7168
    buffer_load_dwordx4 v149, s[48:51], s14 offen offset:1024 lds
    v_mfma_f32_16x16x32_bf16 v[204:207], a[156:159], v[92:95], v[204:207]
    ds_read_b128 v[120:123], v250 offset:1280
    v_mfma_f32_16x16x32_bf16 v[200:203], a[152:155], v[92:95], v[200:203]
    ds_read_b128 v[124:127], v250 offset:7424
    v_mfma_f32_16x16x32_bf16 v[200:203], a[144:147], v[88:91], v[200:203]
    ds_read_b64_tr_b16 a[200:201], v152 offset:8192
    buffer_load_dwordx4 v150, s[48:51], s14 offen offset:2048 lds
    v_mfma_f32_16x16x32_bf16 v[208:211], a[144:147], v[96:99], v[208:211]
    ds_read_b64_tr_b16 a[202:203], v152 offset:9216
    v_mfma_f32_16x16x32_bf16 v[208:211], a[152:155], v[100:103], v[208:211]
    buffer_load_dwordx4 v151, s[48:51], s14 offen offset:3072 lds
    v_mfma_f32_16x16x32_bf16 v[212:215], a[156:159], v[100:103], v[212:215]
    ds_read_b64_tr_b16 a[204:205], v153 offset:8192
    v_mfma_f32_16x16x32_bf16 v[212:215], a[148:151], v[96:99], v[212:215]
    ds_read_b64_tr_b16 a[206:207], v153 offset:9216
    s_waitcnt lgkmcnt(4)
    v_mfma_f32_16x16x32_bf16 v[220:223], a[148:151], v[104:107], v[220:223]
    s_waitcnt vmcnt(14)
    s_barrier
    v_mfma_f32_16x16x32_bf16 v[220:223], a[156:159], v[108:111], v[220:223]
    ds_read_b128 v[80:83], v250 offset:12288
    s_add_u32 m0, s74, 36864
    s_mul_i32 s13, s81, 90112
    v_mfma_f32_16x16x32_bf16 v[216:219], a[152:155], v[108:111], v[216:219]
    ds_read_b128 v[84:87], v250 offset:18432
    v_mfma_f32_16x16x32_bf16 v[216:219], a[144:147], v[104:107], v[216:219]
    ds_read_b128 v[88:91], v250 offset:12544
    buffer_load_dwordx4 v156, s[44:47], s13 offen offset:0 sc1 lds
    v_mfma_f32_16x16x32_bf16 v[224:227], a[144:147], v[112:115], v[224:227]
    ds_read_b128 v[92:95], v250 offset:18688
    v_mfma_f32_16x16x32_bf16 v[224:227], a[152:155], v[116:119], v[224:227]
    ds_read_b128 v[96:99], v250 offset:12800
    v_mfma_f32_16x16x32_bf16 v[228:231], a[156:159], v[116:119], v[228:231]
    ds_read_b128 v[100:103], v250 offset:18944
    buffer_load_dwordx4 v157, s[44:47], s13 offen offset:1024 sc1 lds
    v_mfma_f32_16x16x32_bf16 v[228:231], a[148:151], v[112:115], v[228:231]
    ds_read_b64_tr_b16 a[208:209], v152 offset:16384
    v_mfma_f32_16x16x32_bf16 v[236:239], a[148:151], v[120:123], v[236:239]
    ds_read_b64_tr_b16 a[210:211], v152 offset:17408
    v_mfma_f32_16x16x32_bf16 v[236:239], a[156:159], v[124:127], v[236:239]
    buffer_load_dwordx4 v158, s[44:47], s13 offen offset:2048 sc1 lds
    v_mfma_f32_16x16x32_bf16 v[232:235], a[152:155], v[124:127], v[232:235]
    ds_read_b64_tr_b16 a[212:213], v153 offset:16384
    v_mfma_f32_16x16x32_bf16 v[232:235], a[144:147], v[120:123], v[232:235]
    ds_read_b64_tr_b16 a[214:215], v153 offset:17408
    s_waitcnt lgkmcnt(4)
    v_mfma_f32_16x16x32_bf16 v[192:195], a[160:163], v[80:83], v[192:195]
    s_add_u32 m0, s73, 65536
    s_lshl_b32 s14, s84, 18
    v_mfma_f32_16x16x32_bf16 v[192:195], a[168:171], v[84:87], v[192:195]
    ds_read_b128 v[104:107], v250 offset:13056
    v_mfma_f32_16x16x32_bf16 v[196:199], a[172:175], v[84:87], v[196:199]
    ds_read_b128 v[108:111], v250 offset:19200
    buffer_load_dwordx4 v4, s[52:55], s14 offen offset:0 lds
    v_mfma_f32_16x16x32_bf16 v[196:199], a[164:167], v[80:83], v[196:199]
    ds_read_b128 v[112:115], v250 offset:13312
    v_mfma_f32_16x16x32_bf16 v[204:207], a[164:167], v[88:91], v[204:207]
    ds_read_b128 v[116:119], v250 offset:19456
    buffer_load_dwordx4 v5, s[52:55], s14 offen offset:1024 lds
    v_mfma_f32_16x16x32_bf16 v[204:207], a[172:175], v[92:95], v[204:207]
    ds_read_b128 v[120:123], v250 offset:13568
    v_mfma_f32_16x16x32_bf16 v[200:203], a[168:171], v[92:95], v[200:203]
    ds_read_b128 v[124:127], v250 offset:19712
    v_mfma_f32_16x16x32_bf16 v[200:203], a[160:163], v[88:91], v[200:203]
    ds_read_b64_tr_b16 a[216:217], v152 offset:24576
    buffer_load_dwordx4 v6, s[52:55], s14 offen offset:2048 lds
    v_mfma_f32_16x16x32_bf16 v[208:211], a[160:163], v[96:99], v[208:211]
    ds_read_b64_tr_b16 a[218:219], v152 offset:25600
    v_mfma_f32_16x16x32_bf16 v[208:211], a[168:171], v[100:103], v[208:211]
    buffer_load_dwordx4 v7, s[52:55], s14 offen offset:3072 lds
    v_mfma_f32_16x16x32_bf16 v[212:215], a[172:175], v[100:103], v[212:215]
    ds_read_b64_tr_b16 a[220:221], v153 offset:24576
    v_mfma_f32_16x16x32_bf16 v[212:215], a[164:167], v[96:99], v[212:215]
    ds_read_b64_tr_b16 a[222:223], v153 offset:25600
    s_waitcnt lgkmcnt(4)
    v_mfma_f32_16x16x32_bf16 v[220:223], a[164:167], v[104:107], v[220:223]
    s_waitcnt vmcnt(14)
    s_barrier
    v_mfma_f32_16x16x32_bf16 v[220:223], a[172:175], v[108:111], v[220:223]
    ds_read_b128 v[80:83], v250 offset:24576
    v_mfma_f32_16x16x32_bf16 v[216:219], a[168:171], v[108:111], v[216:219]
    ds_read_b128 v[84:87], v250 offset:30720
    v_mfma_f32_16x16x32_bf16 v[216:219], a[160:163], v[104:107], v[216:219]
    ds_read_b128 v[88:91], v250 offset:24832
    v_mfma_f32_16x16x32_bf16 v[224:227], a[160:163], v[112:115], v[224:227]
    ds_read_b128 v[92:95], v250 offset:30976
    v_mfma_f32_16x16x32_bf16 v[224:227], a[168:171], v[116:119], v[224:227]
    ds_read_b128 v[96:99], v250 offset:25088
    v_mfma_f32_16x16x32_bf16 v[228:231], a[172:175], v[116:119], v[228:231]
    ds_read_b128 v[100:103], v250 offset:31232
    v_mfma_f32_16x16x32_bf16 v[228:231], a[164:167], v[112:115], v[228:231]
    ds_read_b64_tr_b16 a[224:225], v152 offset:32768
    v_mfma_f32_16x16x32_bf16 v[236:239], a[164:167], v[120:123], v[236:239]
    ds_read_b64_tr_b16 a[226:227], v152 offset:33792
    v_mfma_f32_16x16x32_bf16 v[236:239], a[172:175], v[124:127], v[236:239]
    v_mfma_f32_16x16x32_bf16 v[232:235], a[168:171], v[124:127], v[232:235]
    ds_read_b64_tr_b16 a[228:229], v153 offset:32768
    v_mfma_f32_16x16x32_bf16 v[232:235], a[160:163], v[120:123], v[232:235]
    ds_read_b64_tr_b16 a[230:231], v153 offset:33792
    s_waitcnt lgkmcnt(4)
    v_mfma_f32_16x16x32_bf16 v[192:195], a[176:179], v[80:83], v[192:195]
    v_mfma_f32_16x16x32_bf16 v[192:195], a[184:187], v[84:87], v[192:195]
    ds_read_b128 v[104:107], v250 offset:25344
    v_mfma_f32_16x16x32_bf16 v[196:199], a[188:191], v[84:87], v[196:199]
    ds_read_b128 v[108:111], v250 offset:31488
    v_mfma_f32_16x16x32_bf16 v[196:199], a[180:183], v[80:83], v[196:199]
    ds_read_b128 v[112:115], v250 offset:25600
    v_mfma_f32_16x16x32_bf16 v[204:207], a[180:183], v[88:91], v[204:207]
    ds_read_b128 v[116:119], v250 offset:31744
    v_mfma_f32_16x16x32_bf16 v[204:207], a[188:191], v[92:95], v[204:207]
    ds_read_b128 v[120:123], v250 offset:25856
    v_mfma_f32_16x16x32_bf16 v[200:203], a[184:187], v[92:95], v[200:203]
    ds_read_b128 v[124:127], v250 offset:32000
    v_mfma_f32_16x16x32_bf16 v[200:203], a[176:179], v[88:91], v[200:203]
    ds_read_b64_tr_b16 a[232:233], v152 offset:40960
    v_mfma_f32_16x16x32_bf16 v[208:211], a[176:179], v[96:99], v[208:211]
    ds_read_b64_tr_b16 a[234:235], v152 offset:41984
    v_mfma_f32_16x16x32_bf16 v[208:211], a[184:187], v[100:103], v[208:211]
    v_mfma_f32_16x16x32_bf16 v[212:215], a[188:191], v[100:103], v[212:215]
    ds_read_b64_tr_b16 a[236:237], v153 offset:40960
    v_mfma_f32_16x16x32_bf16 v[212:215], a[180:183], v[96:99], v[212:215]
    ds_read_b64_tr_b16 a[238:239], v153 offset:41984
    s_waitcnt lgkmcnt(4)
    v_mfma_f32_16x16x32_bf16 v[220:223], a[180:183], v[104:107], v[220:223]
    s_waitcnt vmcnt(7)
    s_barrier
    v_mfma_f32_16x16x32_bf16 v[220:223], a[188:191], v[108:111], v[220:223]
    ds_read_b128 v[80:83], v159 offset:0
    v_mfma_f32_16x16x32_bf16 v[216:219], a[184:187], v[108:111], v[216:219]
    ds_read_b128 v[84:87], v159 offset:6144
    v_mfma_f32_16x16x32_bf16 v[216:219], a[176:179], v[104:107], v[216:219]
    ds_read_b128 v[88:91], v159 offset:256
    v_mfma_f32_16x16x32_bf16 v[224:227], a[176:179], v[112:115], v[224:227]
    ds_read_b128 v[92:95], v159 offset:6400
    v_mfma_f32_16x16x32_bf16 v[224:227], a[184:187], v[116:119], v[224:227]
    ds_read_b128 v[96:99], v159 offset:512
    v_mfma_f32_16x16x32_bf16 v[228:231], a[188:191], v[116:119], v[228:231]
    ds_read_b128 v[100:103], v159 offset:6656
    v_mfma_f32_16x16x32_bf16 v[228:231], a[180:183], v[112:115], v[228:231]
    ds_read_b64_tr_b16 a[240:241], v152 offset:49152
    v_mfma_f32_16x16x32_bf16 v[236:239], a[180:183], v[120:123], v[236:239]
    ds_read_b64_tr_b16 a[242:243], v152 offset:50176
L_pl_G_3:
    s_cbranch_execz L_wret
    v_mfma_f32_16x16x32_bf16 v[236:239], a[188:191], v[124:127], v[236:239]
    v_mfma_f32_16x16x32_bf16 v[232:235], a[184:187], v[124:127], v[232:235]
    ds_read_b64_tr_b16 a[244:245], v153 offset:49152
    v_mfma_f32_16x16x32_bf16 v[232:235], a[176:179], v[120:123], v[232:235]
    ds_read_b64_tr_b16 a[246:247], v153 offset:50176
    s_waitcnt lgkmcnt(4)
    v_mfma_f32_16x16x32_bf16 v[192:195], a[192:195], v[80:83], v[192:195]
    v_mfma_f32_16x16x32_bf16 v[192:195], a[200:203], v[84:87], v[192:195]
    ds_read_b128 v[104:107], v159 offset:768
    v_mfma_f32_16x16x32_bf16 v[196:199], a[204:207], v[84:87], v[196:199]
    ds_read_b128 v[108:111], v159 offset:6912
    v_mfma_f32_16x16x32_bf16 v[196:199], a[196:199], v[80:83], v[196:199]
    ds_read_b128 v[112:115], v159 offset:1024
    v_mfma_f32_16x16x32_bf16 v[204:207], a[196:199], v[88:91], v[204:207]
    ds_read_b128 v[116:119], v159 offset:7168
    v_mfma_f32_16x16x32_bf16 v[204:207], a[204:207], v[92:95], v[204:207]
    ds_read_b128 v[120:123], v159 offset:1280
    v_mfma_f32_16x16x32_bf16 v[200:203], a[200:203], v[92:95], v[200:203]
    ds_read_b128 v[124:127], v159 offset:7424
    v_mfma_f32_16x16x32_bf16 v[200:203], a[192:195], v[88:91], v[200:203]
    ds_read_b64_tr_b16 a[248:249], v152 offset:57344
    v_mfma_f32_16x16x32_bf16 v[208:211], a[192:195], v[96:99], v[208:211]
    ds_read_b64_tr_b16 a[250:251], v152 offset:58368
    v_mfma_f32_16x16x32_bf16 v[208:211], a[200:203], v[100:103], v[208:211]
    v_mfma_f32_16x16x32_bf16 v[212:215], a[204:207], v[100:103], v[212:215]
    ds_read_b64_tr_b16 a[252:253], v153 offset:57344
    v_mfma_f32_16x16x32_bf16 v[212:215], a[196:199], v[96:99], v[212:215]
    ds_read_b64_tr_b16 a[254:255], v153 offset:58368
    s_waitcnt lgkmcnt(4)
    v_mfma_f32_16x16x32_bf16 v[220:223], a[196:199], v[104:107], v[220:223]
    s_barrier
    v_mfma_f32_16x16x32_bf16 v[220:223], a[204:207], v[108:111], v[220:223]
    ds_read_b128 v[80:83], v159 offset:12288
    s_add_u32 m0, s74, 49152
    s_mul_i32 s13, s18, 90112
    v_mfma_f32_16x16x32_bf16 v[216:219], a[200:203], v[108:111], v[216:219]
    ds_read_b128 v[84:87], v159 offset:18432
    v_mfma_f32_16x16x32_bf16 v[216:219], a[192:195], v[104:107], v[216:219]
    ds_read_b128 v[88:91], v159 offset:12544
    buffer_load_dwordx4 v8, s[44:47], s13 offen offset:0 sc1 lds
    v_mfma_f32_16x16x32_bf16 v[224:227], a[192:195], v[112:115], v[224:227]
    ds_read_b128 v[92:95], v159 offset:18688
    v_mfma_f32_16x16x32_bf16 v[224:227], a[200:203], v[116:119], v[224:227]
    ds_read_b128 v[96:99], v159 offset:12800
    v_mfma_f32_16x16x32_bf16 v[228:231], a[204:207], v[116:119], v[228:231]
    ds_read_b128 v[100:103], v159 offset:18944
    buffer_load_dwordx4 v9, s[44:47], s13 offen offset:1024 sc1 lds
    v_mfma_f32_16x16x32_bf16 v[228:231], a[196:199], v[112:115], v[228:231]
    v_mfma_f32_16x16x32_bf16 v[236:239], a[196:199], v[120:123], v[236:239]
    v_mfma_f32_16x16x32_bf16 v[236:239], a[204:207], v[124:127], v[236:239]
    buffer_load_dwordx4 v3, s[44:47], s13 offen offset:2048 sc1 lds
    v_mfma_f32_16x16x32_bf16 v[232:235], a[200:203], v[124:127], v[232:235]
    v_mfma_f32_16x16x32_bf16 v[232:235], a[192:195], v[120:123], v[232:235]
    s_waitcnt lgkmcnt(0)
    v_mfma_f32_16x16x32_bf16 v[192:195], a[208:211], v[80:83], v[192:195]
    s_add_u32 m0, s74, 61440
    s_mul_i32 s13, s19, 90112
    v_mfma_f32_16x16x32_bf16 v[192:195], a[216:219], v[84:87], v[192:195]
    ds_read_b128 v[104:107], v159 offset:13056
    v_mfma_f32_16x16x32_bf16 v[196:199], a[220:223], v[84:87], v[196:199]
    ds_read_b128 v[108:111], v159 offset:19200
    v_mfma_f32_16x16x32_bf16 v[196:199], a[212:215], v[80:83], v[196:199]
    ds_read_b128 v[112:115], v159 offset:13312
    buffer_load_dwordx4 v8, s[44:47], s13 offen offset:0 sc1 lds
    v_mfma_f32_16x16x32_bf16 v[204:207], a[212:215], v[88:91], v[204:207]
    ds_read_b128 v[116:119], v159 offset:19456
    v_mfma_f32_16x16x32_bf16 v[204:207], a[220:223], v[92:95], v[204:207]
    ds_read_b128 v[120:123], v159 offset:13568
    v_mfma_f32_16x16x32_bf16 v[200:203], a[216:219], v[92:95], v[200:203]
    ds_read_b128 v[124:127], v159 offset:19712
    buffer_load_dwordx4 v9, s[44:47], s13 offen offset:1024 sc1 lds
    v_mfma_f32_16x16x32_bf16 v[200:203], a[208:211], v[88:91], v[200:203]
    v_mfma_f32_16x16x32_bf16 v[208:211], a[208:211], v[96:99], v[208:211]
    v_mfma_f32_16x16x32_bf16 v[208:211], a[216:219], v[100:103], v[208:211]
    buffer_load_dwordx4 v3, s[44:47], s13 offen offset:2048 sc1 lds
    v_mfma_f32_16x16x32_bf16 v[212:215], a[220:223], v[100:103], v[212:215]
    v_mfma_f32_16x16x32_bf16 v[212:215], a[212:215], v[96:99], v[212:215]
    s_waitcnt lgkmcnt(0)
    v_mfma_f32_16x16x32_bf16 v[220:223], a[212:215], v[104:107], v[220:223]
    s_barrier
    v_mfma_f32_16x16x32_bf16 v[220:223], a[220:223], v[108:111], v[220:223]
    ds_read_b128 v[80:83], v159 offset:24576
    s_add_u32 m0, s74, 0
    s_mul_i32 s13, s20, 90112
    v_mfma_f32_16x16x32_bf16 v[216:219], a[216:219], v[108:111], v[216:219]
    ds_read_b128 v[84:87], v159 offset:30720
    v_mfma_f32_16x16x32_bf16 v[216:219], a[208:211], v[104:107], v[216:219]
    ds_read_b128 v[88:91], v159 offset:24832
    buffer_load_dwordx4 v8, s[44:47], s13 offen offset:0 sc1 lds
    v_mfma_f32_16x16x32_bf16 v[224:227], a[208:211], v[112:115], v[224:227]
    ds_read_b128 v[92:95], v159 offset:30976
    v_mfma_f32_16x16x32_bf16 v[224:227], a[216:219], v[116:119], v[224:227]
    ds_read_b128 v[96:99], v159 offset:25088
    v_mfma_f32_16x16x32_bf16 v[228:231], a[220:223], v[116:119], v[228:231]
    ds_read_b128 v[100:103], v159 offset:31232
    buffer_load_dwordx4 v9, s[44:47], s13 offen offset:1024 sc1 lds
    v_mfma_f32_16x16x32_bf16 v[228:231], a[212:215], v[112:115], v[228:231]
    v_mfma_f32_16x16x32_bf16 v[236:239], a[212:215], v[120:123], v[236:239]
    v_mfma_f32_16x16x32_bf16 v[236:239], a[220:223], v[124:127], v[236:239]
    buffer_load_dwordx4 v3, s[44:47], s13 offen offset:2048 sc1 lds
    v_mfma_f32_16x16x32_bf16 v[232:235], a[216:219], v[124:127], v[232:235]
    v_mfma_f32_16x16x32_bf16 v[232:235], a[208:211], v[120:123], v[232:235]
    s_waitcnt lgkmcnt(0)
    v_mfma_f32_16x16x32_bf16 v[192:195], a[224:227], v[80:83], v[192:195]
    s_add_u32 m0, s74, 12288
    s_mul_i32 s13, s21, 90112
    v_mfma_f32_16x16x32_bf16 v[192:195], a[232:235], v[84:87], v[192:195]
    ds_read_b128 v[104:107], v159 offset:25344
    v_mfma_f32_16x16x32_bf16 v[196:199], a[236:239], v[84:87], v[196:199]
    ds_read_b128 v[108:111], v159 offset:31488
    v_mfma_f32_16x16x32_bf16 v[196:199], a[228:231], v[80:83], v[196:199]
    ds_read_b128 v[112:115], v159 offset:25600
    buffer_load_dwordx4 v8, s[44:47], s13 offen offset:0 sc1 lds
    v_mfma_f32_16x16x32_bf16 v[204:207], a[228:231], v[88:91], v[204:207]
    ds_read_b128 v[116:119], v159 offset:31744
    v_mfma_f32_16x16x32_bf16 v[204:207], a[236:239], v[92:95], v[204:207]
    ds_read_b128 v[120:123], v159 offset:25856
    v_mfma_f32_16x16x32_bf16 v[200:203], a[232:235], v[92:95], v[200:203]
    ds_read_b128 v[124:127], v159 offset:32000
    buffer_load_dwordx4 v9, s[44:47], s13 offen offset:1024 sc1 lds
    v_mfma_f32_16x16x32_bf16 v[200:203], a[224:227], v[88:91], v[200:203]
    v_mfma_f32_16x16x32_bf16 v[208:211], a[224:227], v[96:99], v[208:211]
    v_mfma_f32_16x16x32_bf16 v[208:211], a[232:235], v[100:103], v[208:211]
    buffer_load_dwordx4 v3, s[44:47], s13 offen offset:2048 sc1 lds
    v_mfma_f32_16x16x32_bf16 v[212:215], a[236:239], v[100:103], v[212:215]
    v_mfma_f32_16x16x32_bf16 v[212:215], a[228:231], v[96:99], v[212:215]
    s_waitcnt lgkmcnt(0)
    v_mfma_f32_16x16x32_bf16 v[220:223], a[228:231], v[104:107], v[220:223]
    s_waitcnt vmcnt(16)
    s_barrier
    v_mfma_f32_16x16x32_bf16 v[220:223], a[236:239], v[108:111], v[220:223]
    ds_read_b128 v[80:83], v250 offset:0
    s_add_u32 m0, s74, 24576
    s_mul_i32 s13, s22, 90112
    v_mfma_f32_16x16x32_bf16 v[216:219], a[232:235], v[108:111], v[216:219]
    ds_read_b128 v[84:87], v250 offset:6144
    v_mfma_f32_16x16x32_bf16 v[216:219], a[224:227], v[104:107], v[216:219]
    ds_read_b128 v[88:91], v250 offset:256
    buffer_load_dwordx4 v8, s[44:47], s13 offen offset:0 sc1 lds
    v_mfma_f32_16x16x32_bf16 v[224:227], a[224:227], v[112:115], v[224:227]
    ds_read_b128 v[92:95], v250 offset:6400
    v_mfma_f32_16x16x32_bf16 v[224:227], a[232:235], v[116:119], v[224:227]
    ds_read_b128 v[96:99], v250 offset:512
    v_mfma_f32_16x16x32_bf16 v[228:231], a[236:239], v[116:119], v[228:231]
    ds_read_b128 v[100:103], v250 offset:6656
    buffer_load_dwordx4 v9, s[44:47], s13 offen offset:1024 sc1 lds
    v_mfma_f32_16x16x32_bf16 v[228:231], a[228:231], v[112:115], v[228:231]
    v_mfma_f32_16x16x32_bf16 v[236:239], a[228:231], v[120:123], v[236:239]
    v_mfma_f32_16x16x32_bf16 v[236:239], a[236:239], v[124:127], v[236:239]
    buffer_load_dwordx4 v3, s[44:47], s13 offen offset:2048 sc1 lds
    v_mfma_f32_16x16x32_bf16 v[232:235], a[232:235], v[124:127], v[232:235]
    v_mfma_f32_16x16x32_bf16 v[232:235], a[224:227], v[120:123], v[232:235]
    s_waitcnt lgkmcnt(0)
    v_mfma_f32_16x16x32_bf16 v[192:195], a[240:243], v[80:83], v[192:195]
    s_add_u32 m0, s73, 0
    s_lshl_b32 s14, s85, 18
    v_mfma_f32_16x16x32_bf16 v[192:195], a[248:251], v[84:87], v[192:195]
    ds_read_b128 v[104:107], v250 offset:768
    v_mfma_f32_16x16x32_bf16 v[196:199], a[252:255], v[84:87], v[196:199]
    ds_read_b128 v[108:111], v250 offset:6912
    buffer_load_dwordx4 v4, s[52:55], s14 offen offset:0 lds
    v_mfma_f32_16x16x32_bf16 v[196:199], a[244:247], v[80:83], v[196:199]
    ds_read_b128 v[112:115], v250 offset:1024
    v_mfma_f32_16x16x32_bf16 v[204:207], a[244:247], v[88:91], v[204:207]
    ds_read_b128 v[116:119], v250 offset:7168
    buffer_load_dwordx4 v5, s[52:55], s14 offen offset:1024 lds
    v_mfma_f32_16x16x32_bf16 v[204:207], a[252:255], v[92:95], v[204:207]
    ds_read_b128 v[120:123], v250 offset:1280
    v_mfma_f32_16x16x32_bf16 v[200:203], a[248:251], v[92:95], v[200:203]
    ds_read_b128 v[124:127], v250 offset:7424
    v_mfma_f32_16x16x32_bf16 v[200:203], a[240:243], v[88:91], v[200:203]
    buffer_load_dwordx4 v6, s[52:55], s14 offen offset:2048 lds
    v_mfma_f32_16x16x32_bf16 v[208:211], a[240:243], v[96:99], v[208:211]
    v_mfma_f32_16x16x32_bf16 v[208:211], a[248:251], v[100:103], v[208:211]
    buffer_load_dwordx4 v7, s[52:55], s14 offen offset:3072 lds
    v_mfma_f32_16x16x32_bf16 v[212:215], a[252:255], v[100:103], v[212:215]
    v_mfma_f32_16x16x32_bf16 v[212:215], a[244:247], v[96:99], v[212:215]
    s_waitcnt lgkmcnt(0)
    v_mfma_f32_16x16x32_bf16 v[220:223], a[244:247], v[104:107], v[220:223]
    s_waitcnt vmcnt(16)
    s_barrier
    v_mfma_f32_16x16x32_bf16 v[220:223], a[252:255], v[108:111], v[220:223]
    ds_read_b128 v[80:83], v250 offset:12288
    v_mfma_f32_16x16x32_bf16 v[216:219], a[248:251], v[108:111], v[216:219]
    ds_read_b128 v[84:87], v250 offset:18432
    v_mfma_f32_16x16x32_bf16 v[216:219], a[240:243], v[104:107], v[216:219]
    ds_read_b128 v[88:91], v250 offset:12544
    v_mfma_f32_16x16x32_bf16 v[224:227], a[240:243], v[112:115], v[224:227]
    ds_read_b128 v[92:95], v250 offset:18688
    v_cvt_pk_bf16_f32 v192, v192, v193
    v_mfma_f32_16x16x32_bf16 v[224:227], a[248:251], v[116:119], v[224:227]
    ds_read_b128 v[96:99], v250 offset:12800
    v_mfma_f32_16x16x32_bf16 v[228:231], a[252:255], v[116:119], v[228:231]
    ds_read_b128 v[100:103], v250 offset:18944
    v_cvt_pk_bf16_f32 v193, v194, v195
    v_mfma_f32_16x16x32_bf16 v[228:231], a[244:247], v[112:115], v[228:231]
    v_mfma_f32_16x16x32_bf16 v[236:239], a[244:247], v[120:123], v[236:239]
    v_cvt_pk_bf16_f32 v194, v196, v197
    v_mfma_f32_16x16x32_bf16 v[236:239], a[252:255], v[124:127], v[236:239]
    v_cvt_pk_bf16_f32 v195, v198, v199
    v_mfma_f32_16x16x32_bf16 v[232:235], a[248:251], v[124:127], v[232:235]
    v_mfma_f32_16x16x32_bf16 v[232:235], a[240:243], v[120:123], v[232:235]
    buffer_store_dwordx4 v[192:195], v246, s[44:47], s9 offen offset:0 sc1
    s_waitcnt lgkmcnt(0)
    v_mfma_f32_16x16x32_bf16 v[32:35], a[0:3], v[80:83], v[128:131]
    v_mfma_f32_16x16x32_bf16 v[32:35], a[8:11], v[84:87], v[32:35]
    ds_read_b128 v[104:107], v250 offset:13056
    v_mfma_f32_16x16x32_bf16 v[36:39], a[12:15], v[84:87], v[132:135]
    ds_read_b128 v[108:111], v250 offset:19200
    v_mfma_f32_16x16x32_bf16 v[36:39], a[4:7], v[80:83], v[36:39]
    ds_read_b128 v[112:115], v250 offset:13312
    v_mfma_f32_16x16x32_bf16 v[44:47], a[4:7], v[88:91], v[132:135]
    ds_read_b128 v[116:119], v250 offset:19456
    v_cvt_pk_bf16_f32 v200, v200, v201
    v_mfma_f32_16x16x32_bf16 v[44:47], a[12:15], v[92:95], v[44:47]
    ds_read_b128 v[120:123], v250 offset:13568
    v_mfma_f32_16x16x32_bf16 v[40:43], a[8:11], v[92:95], v[128:131]
    ds_read_b128 v[124:127], v250 offset:19712
    v_cvt_pk_bf16_f32 v201, v202, v203
    v_mfma_f32_16x16x32_bf16 v[40:43], a[0:3], v[88:91], v[40:43]
    v_mfma_f32_16x16x32_bf16 v[48:51], a[0:3], v[96:99], v[128:131]
    v_cvt_pk_bf16_f32 v202, v204, v205
    v_mfma_f32_16x16x32_bf16 v[48:51], a[8:11], v[100:103], v[48:51]
    v_cvt_pk_bf16_f32 v203, v206, v207
    v_mfma_f32_16x16x32_bf16 v[52:55], a[12:15], v[100:103], v[132:135]
    v_mfma_f32_16x16x32_bf16 v[52:55], a[4:7], v[96:99], v[52:55]
    buffer_store_dwordx4 v[200:203], v246, s[44:47], s9 offen offset:1024 sc1
    s_waitcnt lgkmcnt(0)
    v_mfma_f32_16x16x32_bf16 v[60:63], a[4:7], v[104:107], v[132:135]
    s_waitcnt vmcnt(15)
    s_barrier
    v_mfma_f32_16x16x32_bf16 v[60:63], a[12:15], v[108:111], v[60:63]
    ds_read_b128 v[80:83], v250 offset:24576
    v_cvt_pk_bf16_f32 v208, v208, v209
    v_mfma_f32_16x16x32_bf16 v[56:59], a[8:11], v[108:111], v[128:131]
    ds_read_b128 v[84:87], v250 offset:30720
    v_mfma_f32_16x16x32_bf16 v[56:59], a[0:3], v[104:107], v[56:59]
    ds_read_b128 v[88:91], v250 offset:24832
    v_cvt_pk_bf16_f32 v209, v210, v211
    v_mfma_f32_16x16x32_bf16 v[64:67], a[0:3], v[112:115], v[128:131]
    ds_read_b128 v[92:95], v250 offset:30976
    v_mfma_f32_16x16x32_bf16 v[64:67], a[8:11], v[116:119], v[64:67]
    ds_read_b128 v[96:99], v250 offset:25088
    v_mfma_f32_16x16x32_bf16 v[68:71], a[12:15], v[116:119], v[132:135]
    ds_read_b128 v[100:103], v250 offset:31232
    v_cvt_pk_bf16_f32 v210, v212, v213
    v_mfma_f32_16x16x32_bf16 v[68:71], a[4:7], v[112:115], v[68:71]
    v_mfma_f32_16x16x32_bf16 v[76:79], a[4:7], v[120:123], v[132:135]
    v_cvt_pk_bf16_f32 v211, v214, v215
    v_mfma_f32_16x16x32_bf16 v[76:79], a[12:15], v[124:127], v[76:79]
    v_mfma_f32_16x16x32_bf16 v[72:75], a[8:11], v[124:127], v[128:131]
    buffer_store_dwordx4 v[208:211], v246, s[44:47], s9 offen offset:2048 sc1
    v_mfma_f32_16x16x32_bf16 v[72:75], a[0:3], v[120:123], v[72:75]
    s_waitcnt lgkmcnt(0)
    v_mfma_f32_16x16x32_bf16 v[32:35], a[16:19], v[80:83], v[32:35]
    v_mfma_f32_16x16x32_bf16 v[32:35], a[24:27], v[84:87], v[32:35]
    ds_read_b128 v[104:107], v250 offset:25344
    v_cvt_pk_bf16_f32 v216, v216, v217
    v_mfma_f32_16x16x32_bf16 v[36:39], a[28:31], v[84:87], v[36:39]
    ds_read_b128 v[108:111], v250 offset:31488
    v_mfma_f32_16x16x32_bf16 v[36:39], a[20:23], v[80:83], v[36:39]
    ds_read_b128 v[112:115], v250 offset:25600
    v_cvt_pk_bf16_f32 v217, v218, v219
    v_mfma_f32_16x16x32_bf16 v[44:47], a[20:23], v[88:91], v[44:47]
    ds_read_b128 v[116:119], v250 offset:31744
    v_mfma_f32_16x16x32_bf16 v[44:47], a[28:31], v[92:95], v[44:47]
    ds_read_b128 v[120:123], v250 offset:25856
    v_mfma_f32_16x16x32_bf16 v[40:43], a[24:27], v[92:95], v[40:43]
    ds_read_b128 v[124:127], v250 offset:32000
    v_cvt_pk_bf16_f32 v218, v220, v221
    v_mfma_f32_16x16x32_bf16 v[40:43], a[16:19], v[88:91], v[40:43]
    v_mfma_f32_16x16x32_bf16 v[48:51], a[16:19], v[96:99], v[48:51]
    v_cvt_pk_bf16_f32 v219, v222, v223
    v_mfma_f32_16x16x32_bf16 v[48:51], a[24:27], v[100:103], v[48:51]
    v_mfma_f32_16x16x32_bf16 v[52:55], a[28:31], v[100:103], v[52:55]
    buffer_store_dwordx4 v[216:219], v247, s[44:47], s9 offen offset:0 sc1
    v_mfma_f32_16x16x32_bf16 v[52:55], a[20:23], v[96:99], v[52:55]
    s_waitcnt lgkmcnt(0)
    v_mfma_f32_16x16x32_bf16 v[60:63], a[20:23], v[104:107], v[60:63]
    s_waitcnt vmcnt(14)
    s_barrier
    v_cvt_pk_bf16_f32 v224, v224, v225
    v_mfma_f32_16x16x32_bf16 v[60:63], a[28:31], v[108:111], v[60:63]
    ds_read_b128 v[80:83], v159 offset:0
    s_add_u32 m0, s74, 36864
    s_mul_i32 s13, s23, 90112
    v_mfma_f32_16x16x32_bf16 v[56:59], a[24:27], v[108:111], v[56:59]
    ds_read_b128 v[84:87], v159 offset:6144
    v_mfma_f32_16x16x32_bf16 v[56:59], a[16:19], v[104:107], v[56:59]
    ds_read_b128 v[88:91], v159 offset:256
    buffer_load_dwordx4 v8, s[44:47], s13 offen offset:0 sc1 lds
    v_mfma_f32_16x16x32_bf16 v[64:67], a[16:19], v[112:115], v[64:67]
    ds_read_b128 v[92:95], v159 offset:6400
    v_cvt_pk_bf16_f32 v225, v226, v227
    v_mfma_f32_16x16x32_bf16 v[64:67], a[24:27], v[116:119], v[64:67]
    ds_read_b128 v[96:99], v159 offset:512
    v_cvt_pk_bf16_f32 v226, v228, v229
    v_mfma_f32_16x16x32_bf16 v[68:71], a[28:31], v[116:119], v[68:71]
    ds_read_b128 v[100:103], v159 offset:6656
    buffer_load_dwordx4 v9, s[44:47], s13 offen offset:1024 sc1 lds
    v_mfma_f32_16x16x32_bf16 v[68:71], a[20:23], v[112:115], v[68:71]
    v_add_u32 v10, 65536, v10
    v_mfma_f32_16x16x32_bf16 v[76:79], a[20:23], v[120:123], v[76:79]
    ds_read_b64_tr_b16 a[0:1], v10 offset:0
    v_cvt_pk_bf16_f32 v227, v230, v231
    v_mfma_f32_16x16x32_bf16 v[76:79], a[28:31], v[124:127], v[76:79]
    ds_read_b64_tr_b16 a[2:3], v10 offset:2048
    buffer_load_dwordx4 v3, s[44:47], s13 offen offset:2048 sc1 lds
    v_mfma_f32_16x16x32_bf16 v[72:75], a[24:27], v[124:127], v[72:75]
    buffer_store_dwordx4 v[224:227], v247, s[44:47], s9 offen offset:1024 sc1
    ds_read_b64_tr_b16 a[8:9], v10 offset:4096
    v_mfma_f32_16x16x32_bf16 v[72:75], a[16:19], v[120:123], v[72:75]
    ds_read_b64_tr_b16 a[10:11], v10 offset:6144
    s_waitcnt lgkmcnt(4)
    v_mfma_f32_16x16x32_bf16 v[32:35], a[32:35], v[80:83], v[32:35]
    s_add_u32 m0, s74, 49152
    s_mul_i32 s13, s24, 90112
    v_mfma_f32_16x16x32_bf16 v[32:35], a[40:43], v[84:87], v[32:35]
    ds_read_b128 v[104:107], v159 offset:768
    v_cvt_pk_bf16_f32 v232, v232, v233
    v_mfma_f32_16x16x32_bf16 v[36:39], a[44:47], v[84:87], v[36:39]
    ds_read_b128 v[108:111], v159 offset:6912
    v_mfma_f32_16x16x32_bf16 v[36:39], a[36:39], v[80:83], v[36:39]
    ds_read_b128 v[112:115], v159 offset:1024
    buffer_load_dwordx4 v8, s[44:47], s13 offen offset:0 sc1 lds
    v_mfma_f32_16x16x32_bf16 v[44:47], a[36:39], v[88:91], v[44:47]
    ds_read_b128 v[116:119], v159 offset:7168
    v_cvt_pk_bf16_f32 v233, v234, v235
    v_mfma_f32_16x16x32_bf16 v[44:47], a[44:47], v[92:95], v[44:47]
    ds_read_b128 v[120:123], v159 offset:1280
    v_cvt_pk_bf16_f32 v234, v236, v237
    v_mfma_f32_16x16x32_bf16 v[40:43], a[40:43], v[92:95], v[40:43]
    ds_read_b128 v[124:127], v159 offset:7424
    buffer_load_dwordx4 v9, s[44:47], s13 offen offset:1024 sc1 lds
    v_mfma_f32_16x16x32_bf16 v[40:43], a[32:35], v[88:91], v[40:43]
    v_add_u32 v11, 65536, v11
    v_mfma_f32_16x16x32_bf16 v[48:51], a[32:35], v[96:99], v[48:51]
    ds_read_b64_tr_b16 a[4:5], v11 offset:0
    v_cvt_pk_bf16_f32 v235, v238, v239
    v_mfma_f32_16x16x32_bf16 v[48:51], a[40:43], v[100:103], v[48:51]
    ds_read_b64_tr_b16 a[6:7], v11 offset:2048
    buffer_load_dwordx4 v3, s[44:47], s13 offen offset:2048 sc1 lds
    v_mfma_f32_16x16x32_bf16 v[52:55], a[44:47], v[100:103], v[52:55]
    buffer_store_dwordx4 v[232:235], v247, s[44:47], s9 offen offset:2048 sc1
    ds_read_b64_tr_b16 a[12:13], v11 offset:4096
    v_mfma_f32_16x16x32_bf16 v[52:55], a[36:39], v[96:99], v[52:55]
    ds_read_b64_tr_b16 a[14:15], v11 offset:6144
    s_waitcnt lgkmcnt(4)
    v_mfma_f32_16x16x32_bf16 v[60:63], a[36:39], v[104:107], v[60:63]
    s_waitcnt vmcnt(19)
    s_barrier
    v_mfma_f32_16x16x32_bf16 v[60:63], a[44:47], v[108:111], v[60:63]
    ds_read_b128 v[80:83], v159 offset:12288
    s_add_u32 m0, s74, 61440
    s_mul_i32 s13, s25, 90112
    v_mfma_f32_16x16x32_bf16 v[56:59], a[40:43], v[108:111], v[56:59]
    ds_read_b128 v[84:87], v159 offset:18432
    v_mfma_f32_16x16x32_bf16 v[56:59], a[32:35], v[104:107], v[56:59]
    ds_read_b128 v[88:91], v159 offset:12544
    buffer_load_dwordx4 v8, s[44:47], s13 offen offset:0 sc1 lds
    v_mfma_f32_16x16x32_bf16 v[64:67], a[32:35], v[112:115], v[64:67]
    ds_read_b128 v[92:95], v159 offset:18688
    v_mfma_f32_16x16x32_bf16 v[64:67], a[40:43], v[116:119], v[64:67]
    ds_read_b128 v[96:99], v159 offset:12800
    v_mfma_f32_16x16x32_bf16 v[68:71], a[44:47], v[116:119], v[68:71]
    ds_read_b128 v[100:103], v159 offset:18944
    buffer_load_dwordx4 v9, s[44:47], s13 offen offset:1024 sc1 lds
    v_mfma_f32_16x16x32_bf16 v[68:71], a[36:39], v[112:115], v[68:71]
    v_mfma_f32_16x16x32_bf16 v[76:79], a[36:39], v[120:123], v[76:79]
    v_mfma_f32_16x16x32_bf16 v[76:79], a[44:47], v[124:127], v[76:79]
    buffer_load_dwordx4 v3, s[44:47], s13 offen offset:2048 sc1 lds
    v_mfma_f32_16x16x32_bf16 v[72:75], a[40:43], v[124:127], v[72:75]
    v_mfma_f32_16x16x32_bf16 v[72:75], a[32:35], v[120:123], v[72:75]
    s_waitcnt lgkmcnt(0)
    v_mfma_f32_16x16x32_bf16 v[32:35], a[48:51], v[80:83], v[32:35]
    s_add_u32 m0, s74, 0
    s_mul_i32 s13, s26, 90112
    v_mfma_f32_16x16x32_bf16 v[32:35], a[56:59], v[84:87], v[32:35]
    ds_read_b128 v[104:107], v159 offset:13056
    v_mfma_f32_16x16x32_bf16 v[36:39], a[60:63], v[84:87], v[36:39]
    ds_read_b128 v[108:111], v159 offset:19200
    v_mfma_f32_16x16x32_bf16 v[36:39], a[52:55], v[80:83], v[36:39]
    ds_read_b128 v[112:115], v159 offset:13312
    buffer_load_dwordx4 v8, s[44:47], s13 offen offset:0 sc1 lds
    v_mfma_f32_16x16x32_bf16 v[44:47], a[52:55], v[88:91], v[44:47]
    ds_read_b128 v[116:119], v159 offset:19456
    v_mfma_f32_16x16x32_bf16 v[44:47], a[60:63], v[92:95], v[44:47]
    ds_read_b128 v[120:123], v159 offset:13568
    v_mfma_f32_16x16x32_bf16 v[40:43], a[56:59], v[92:95], v[40:43]
    ds_read_b128 v[124:127], v159 offset:19712
    buffer_load_dwordx4 v9, s[44:47], s13 offen offset:1024 sc1 lds
    v_mfma_f32_16x16x32_bf16 v[40:43], a[48:51], v[88:91], v[40:43]
    v_mfma_f32_16x16x32_bf16 v[48:51], a[48:51], v[96:99], v[48:51]
    v_mfma_f32_16x16x32_bf16 v[48:51], a[56:59], v[100:103], v[48:51]
    buffer_load_dwordx4 v3, s[44:47], s13 offen offset:2048 sc1 lds
    v_mfma_f32_16x16x32_bf16 v[52:55], a[60:63], v[100:103], v[52:55]
    v_mfma_f32_16x16x32_bf16 v[52:55], a[52:55], v[96:99], v[52:55]
    s_waitcnt lgkmcnt(0)
    v_mfma_f32_16x16x32_bf16 v[60:63], a[52:55], v[104:107], v[60:63]
    s_waitcnt vmcnt(18)
    s_barrier
    v_mfma_f32_16x16x32_bf16 v[60:63], a[60:63], v[108:111], v[60:63]
    ds_read_b128 v[80:83], v159 offset:24576
    s_add_u32 m0, s74, 12288
    s_mul_i32 s13, s27, 90112
    v_mfma_f32_16x16x32_bf16 v[56:59], a[56:59], v[108:111], v[56:59]
    ds_read_b128 v[84:87], v159 offset:30720
    v_mfma_f32_16x16x32_bf16 v[56:59], a[48:51], v[104:107], v[56:59]
    ds_read_b128 v[88:91], v159 offset:24832
    buffer_load_dwordx4 v8, s[44:47], s13 offen offset:0 sc1 lds
    v_mfma_f32_16x16x32_bf16 v[64:67], a[48:51], v[112:115], v[64:67]
    ds_read_b128 v[92:95], v159 offset:30976
    v_mfma_f32_16x16x32_bf16 v[64:67], a[56:59], v[116:119], v[64:67]
    ds_read_b128 v[96:99], v159 offset:25088
    v_mfma_f32_16x16x32_bf16 v[68:71], a[60:63], v[116:119], v[68:71]
    ds_read_b128 v[100:103], v159 offset:31232
    buffer_load_dwordx4 v9, s[44:47], s13 offen offset:1024 sc1 lds
    v_mfma_f32_16x16x32_bf16 v[68:71], a[52:55], v[112:115], v[68:71]
    v_add_u32 v10, -65536, v10
    v_mfma_f32_16x16x32_bf16 v[76:79], a[52:55], v[120:123], v[76:79]
    ds_read_b64_tr_b16 a[16:17], v10 offset:0
    v_mfma_f32_16x16x32_bf16 v[76:79], a[60:63], v[124:127], v[76:79]
    ds_read_b64_tr_b16 a[18:19], v10 offset:2048
    buffer_load_dwordx4 v3, s[44:47], s13 offen offset:2048 sc1 lds
    v_mfma_f32_16x16x32_bf16 v[72:75], a[56:59], v[124:127], v[72:75]
    ds_read_b64_tr_b16 a[24:25], v10 offset:4096
    v_mfma_f32_16x16x32_bf16 v[72:75], a[48:51], v[120:123], v[72:75]
    ds_read_b64_tr_b16 a[26:27], v10 offset:6144
    s_waitcnt lgkmcnt(4)
    v_mfma_f32_16x16x32_bf16 v[32:35], a[64:67], v[80:83], v[32:35]
    s_add_u32 m0, s73, 16384
    s_lshl_b32 s14, s86, 18
    v_mfma_f32_16x16x32_bf16 v[32:35], a[72:75], v[84:87], v[32:35]
    ds_read_b128 v[104:107], v159 offset:25344
    v_mfma_f32_16x16x32_bf16 v[36:39], a[76:79], v[84:87], v[36:39]
    ds_read_b128 v[108:111], v159 offset:31488
    buffer_load_dwordx4 v4, s[52:55], s14 offen offset:0 lds
    v_mfma_f32_16x16x32_bf16 v[36:39], a[68:71], v[80:83], v[36:39]
    ds_read_b128 v[112:115], v159 offset:25600
    v_mfma_f32_16x16x32_bf16 v[44:47], a[68:71], v[88:91], v[44:47]
    ds_read_b128 v[116:119], v159 offset:31744
    buffer_load_dwordx4 v5, s[52:55], s14 offen offset:1024 lds
    v_mfma_f32_16x16x32_bf16 v[44:47], a[76:79], v[92:95], v[44:47]
    ds_read_b128 v[120:123], v159 offset:25856
    v_mfma_f32_16x16x32_bf16 v[40:43], a[72:75], v[92:95], v[40:43]
    ds_read_b128 v[124:127], v159 offset:32000
    v_mfma_f32_16x16x32_bf16 v[40:43], a[64:67], v[88:91], v[40:43]
    buffer_load_dwordx4 v6, s[52:55], s14 offen offset:2048 lds
    v_add_u32 v11, -65536, v11
    v_mfma_f32_16x16x32_bf16 v[48:51], a[64:67], v[96:99], v[48:51]
    ds_read_b64_tr_b16 a[20:21], v11 offset:0
    v_mfma_f32_16x16x32_bf16 v[48:51], a[72:75], v[100:103], v[48:51]
    ds_read_b64_tr_b16 a[22:23], v11 offset:2048
    buffer_load_dwordx4 v7, s[52:55], s14 offen offset:3072 lds
    v_mfma_f32_16x16x32_bf16 v[52:55], a[76:79], v[100:103], v[52:55]
    ds_read_b64_tr_b16 a[28:29], v11 offset:4096
    v_mfma_f32_16x16x32_bf16 v[52:55], a[68:71], v[96:99], v[52:55]
    ds_read_b64_tr_b16 a[30:31], v11 offset:6144
    s_waitcnt lgkmcnt(4)
    v_mfma_f32_16x16x32_bf16 v[60:63], a[68:71], v[104:107], v[60:63]
    s_waitcnt vmcnt(18)
    s_barrier
    v_mfma_f32_16x16x32_bf16 v[60:63], a[76:79], v[108:111], v[60:63]
    ds_read_b128 v[80:83], v250 offset:0
    v_mfma_f32_16x16x32_bf16 v[56:59], a[72:75], v[108:111], v[56:59]
    ds_read_b128 v[84:87], v250 offset:6144
    v_mfma_f32_16x16x32_bf16 v[56:59], a[64:67], v[104:107], v[56:59]
    ds_read_b128 v[88:91], v250 offset:256
    v_mfma_f32_16x16x32_bf16 v[64:67], a[64:67], v[112:115], v[64:67]
    ds_read_b128 v[92:95], v250 offset:6400
    v_mfma_f32_16x16x32_bf16 v[64:67], a[72:75], v[116:119], v[64:67]
    ds_read_b128 v[96:99], v250 offset:512
    v_mfma_f32_16x16x32_bf16 v[68:71], a[76:79], v[116:119], v[68:71]
    ds_read_b128 v[100:103], v250 offset:6656
    v_mfma_f32_16x16x32_bf16 v[68:71], a[68:71], v[112:115], v[68:71]
    v_mfma_f32_16x16x32_bf16 v[76:79], a[68:71], v[120:123], v[76:79]
    v_mfma_f32_16x16x32_bf16 v[76:79], a[76:79], v[124:127], v[76:79]
    v_mfma_f32_16x16x32_bf16 v[72:75], a[72:75], v[124:127], v[72:75]
    v_mfma_f32_16x16x32_bf16 v[72:75], a[64:67], v[120:123], v[72:75]
    s_waitcnt lgkmcnt(0)
    v_mfma_f32_16x16x32_bf16 v[32:35], a[80:83], v[80:83], v[32:35]
    v_mfma_f32_16x16x32_bf16 v[32:35], a[88:91], v[84:87], v[32:35]
    ds_read_b128 v[104:107], v250 offset:768
    v_mfma_f32_16x16x32_bf16 v[36:39], a[92:95], v[84:87], v[36:39]
    ds_read_b128 v[108:111], v250 offset:6912
    v_mfma_f32_16x16x32_bf16 v[36:39], a[84:87], v[80:83], v[36:39]
    ds_read_b128 v[112:115], v250 offset:1024
    v_mfma_f32_16x16x32_bf16 v[44:47], a[84:87], v[88:91], v[44:47]
    ds_read_b128 v[116:119], v250 offset:7168
    v_mfma_f32_16x16x32_bf16 v[44:47], a[92:95], v[92:95], v[44:47]
    ds_read_b128 v[120:123], v250 offset:1280
    v_mfma_f32_16x16x32_bf16 v[40:43], a[88:91], v[92:95], v[40:43]
    ds_read_b128 v[124:127], v250 offset:7424
    v_mfma_f32_16x16x32_bf16 v[40:43], a[80:83], v[88:91], v[40:43]
    s_waitcnt vmcnt(13)
    buffer_store_dword v249, v248, s[44:47], s6 offen sc1
    v_mfma_f32_16x16x32_bf16 v[48:51], a[80:83], v[96:99], v[48:51]
    v_mfma_f32_16x16x32_bf16 v[48:51], a[88:91], v[100:103], v[48:51]
    v_mfma_f32_16x16x32_bf16 v[52:55], a[92:95], v[100:103], v[52:55]
    v_mfma_f32_16x16x32_bf16 v[52:55], a[84:87], v[96:99], v[52:55]
    s_waitcnt lgkmcnt(0)
    v_mfma_f32_16x16x32_bf16 v[60:63], a[84:87], v[104:107], v[60:63]
    s_barrier
    v_mfma_f32_16x16x32_bf16 v[60:63], a[92:95], v[108:111], v[60:63]
    ds_read_b128 v[80:83], v250 offset:12288
    v_mfma_f32_16x16x32_bf16 v[56:59], a[88:91], v[108:111], v[56:59]
    ds_read_b128 v[84:87], v250 offset:18432
    v_mfma_f32_16x16x32_bf16 v[56:59], a[80:83], v[104:107], v[56:59]
    ds_read_b128 v[88:91], v250 offset:12544
    v_mfma_f32_16x16x32_bf16 v[64:67], a[80:83], v[112:115], v[64:67]
    ds_read_b128 v[92:95], v250 offset:18688
    v_mfma_f32_16x16x32_bf16 v[64:67], a[88:91], v[116:119], v[64:67]
    ds_read_b128 v[96:99], v250 offset:12800
    v_mfma_f32_16x16x32_bf16 v[68:71], a[92:95], v[116:119], v[68:71]
    ds_read_b128 v[100:103], v250 offset:18944
    v_mfma_f32_16x16x32_bf16 v[68:71], a[84:87], v[112:115], v[68:71]
    v_mfma_f32_16x16x32_bf16 v[76:79], a[84:87], v[120:123], v[76:79]
    v_mfma_f32_16x16x32_bf16 v[76:79], a[92:95], v[124:127], v[76:79]
    v_mfma_f32_16x16x32_bf16 v[72:75], a[88:91], v[124:127], v[72:75]
    v_mfma_f32_16x16x32_bf16 v[72:75], a[80:83], v[120:123], v[72:75]
    s_waitcnt lgkmcnt(0)
    v_mfma_f32_16x16x32_bf16 v[32:35], a[96:99], v[80:83], v[32:35]
    v_mfma_f32_16x16x32_bf16 v[32:35], a[104:107], v[84:87], v[32:35]
    ds_read_b128 v[104:107], v250 offset:13056
    v_mfma_f32_16x16x32_bf16 v[36:39], a[108:111], v[84:87], v[36:39]
    ds_read_b128 v[108:111], v250 offset:19200
    v_mfma_f32_16x16x32_bf16 v[36:39], a[100:103], v[80:83], v[36:39]
    ds_read_b128 v[112:115], v250 offset:13312
    v_mfma_f32_16x16x32_bf16 v[44:47], a[100:103], v[88:91], v[44:47]
    ds_read_b128 v[116:119], v250 offset:19456
    v_mfma_f32_16x16x32_bf16 v[44:47], a[108:111], v[92:95], v[44:47]
    ds_read_b128 v[120:123], v250 offset:13568
    v_mfma_f32_16x16x32_bf16 v[40:43], a[104:107], v[92:95], v[40:43]
    ds_read_b128 v[124:127], v250 offset:19712
L_pl_G_4:
    s_cbranch_execz L_wret
    v_mfma_f32_16x16x32_bf16 v[40:43], a[96:99], v[88:91], v[40:43]
    v_mfma_f32_16x16x32_bf16 v[48:51], a[96:99], v[96:99], v[48:51]
    v_mfma_f32_16x16x32_bf16 v[48:51], a[104:107], v[100:103], v[48:51]
    v_mfma_f32_16x16x32_bf16 v[52:55], a[108:111], v[100:103], v[52:55]
    v_mfma_f32_16x16x32_bf16 v[52:55], a[100:103], v[96:99], v[52:55]
    s_waitcnt lgkmcnt(0)
    v_mfma_f32_16x16x32_bf16 v[60:63], a[100:103], v[104:107], v[60:63]
    s_waitcnt vmcnt(11)
    s_barrier
    v_mfma_f32_16x16x32_bf16 v[60:63], a[108:111], v[108:111], v[60:63]
    ds_read_b128 v[80:83], v250 offset:24576
    s_add_u32 m0, s74, 24576
    s_mul_i32 s13, s76, 90112
    v_mfma_f32_16x16x32_bf16 v[56:59], a[104:107], v[108:111], v[56:59]
    ds_read_b128 v[84:87], v250 offset:30720
    v_mfma_f32_16x16x32_bf16 v[56:59], a[96:99], v[104:107], v[56:59]
    ds_read_b128 v[88:91], v250 offset:24832
    buffer_load_dwordx4 v8, s[44:47], s13 offen offset:0 sc1 lds
    v_mfma_f32_16x16x32_bf16 v[64:67], a[96:99], v[112:115], v[64:67]
    ds_read_b128 v[92:95], v250 offset:30976
    v_mfma_f32_16x16x32_bf16 v[64:67], a[104:107], v[116:119], v[64:67]
    ds_read_b128 v[96:99], v250 offset:25088
    v_mfma_f32_16x16x32_bf16 v[68:71], a[108:111], v[116:119], v[68:71]
    ds_read_b128 v[100:103], v250 offset:31232
    buffer_load_dwordx4 v9, s[44:47], s13 offen offset:1024 sc1 lds
    v_mfma_f32_16x16x32_bf16 v[68:71], a[100:103], v[112:115], v[68:71]
    v_mfma_f32_16x16x32_bf16 v[76:79], a[100:103], v[120:123], v[76:79]
    v_mfma_f32_16x16x32_bf16 v[76:79], a[108:111], v[124:127], v[76:79]
    buffer_load_dwordx4 v3, s[44:47], s13 offen offset:2048 sc1 lds
    v_mfma_f32_16x16x32_bf16 v[72:75], a[104:107], v[124:127], v[72:75]
    v_mfma_f32_16x16x32_bf16 v[72:75], a[96:99], v[120:123], v[72:75]
    s_waitcnt lgkmcnt(0)
    v_mfma_f32_16x16x32_bf16 v[32:35], a[112:115], v[80:83], v[32:35]
    s_add_u32 m0, s74, 36864
    s_mul_i32 s13, s77, 90112
    v_mfma_f32_16x16x32_bf16 v[32:35], a[120:123], v[84:87], v[32:35]
    ds_read_b128 v[104:107], v250 offset:25344
    v_mfma_f32_16x16x32_bf16 v[36:39], a[124:127], v[84:87], v[36:39]
    ds_read_b128 v[108:111], v250 offset:31488
    v_mfma_f32_16x16x32_bf16 v[36:39], a[116:119], v[80:83], v[36:39]
    ds_read_b128 v[112:115], v250 offset:25600
    buffer_load_dwordx4 v8, s[44:47], s13 offen offset:0 sc1 lds
    v_mfma_f32_16x16x32_bf16 v[44:47], a[116:119], v[88:91], v[44:47]
    ds_read_b128 v[116:119], v250 offset:31744
    v_mfma_f32_16x16x32_bf16 v[44:47], a[124:127], v[92:95], v[44:47]
    ds_read_b128 v[120:123], v250 offset:25856
    v_mfma_f32_16x16x32_bf16 v[40:43], a[120:123], v[92:95], v[40:43]
    ds_read_b128 v[124:127], v250 offset:32000
    buffer_load_dwordx4 v9, s[44:47], s13 offen offset:1024 sc1 lds
    v_mfma_f32_16x16x32_bf16 v[40:43], a[112:115], v[88:91], v[40:43]
    v_mfma_f32_16x16x32_bf16 v[48:51], a[112:115], v[96:99], v[48:51]
    v_mfma_f32_16x16x32_bf16 v[48:51], a[120:123], v[100:103], v[48:51]
    buffer_load_dwordx4 v3, s[44:47], s13 offen offset:2048 sc1 lds
    v_mfma_f32_16x16x32_bf16 v[52:55], a[124:127], v[100:103], v[52:55]
    v_mfma_f32_16x16x32_bf16 v[52:55], a[116:119], v[96:99], v[52:55]
    s_waitcnt lgkmcnt(0)
    v_mfma_f32_16x16x32_bf16 v[60:63], a[116:119], v[104:107], v[60:63]
    s_waitcnt vmcnt(14)
    s_barrier
    v_mfma_f32_16x16x32_bf16 v[60:63], a[124:127], v[108:111], v[60:63]
    ds_read_b128 v[80:83], v159 offset:0
    s_add_u32 m0, s74, 49152
    s_mul_i32 s13, s78, 90112
    v_mfma_f32_16x16x32_bf16 v[56:59], a[120:123], v[108:111], v[56:59]
    ds_read_b128 v[84:87], v159 offset:6144
    v_mfma_f32_16x16x32_bf16 v[56:59], a[112:115], v[104:107], v[56:59]
    ds_read_b128 v[88:91], v159 offset:256
    buffer_load_dwordx4 v8, s[44:47], s13 offen offset:0 sc1 lds
    v_mfma_f32_16x16x32_bf16 v[64:67], a[112:115], v[112:115], v[64:67]
    ds_read_b128 v[92:95], v159 offset:6400
    v_mfma_f32_16x16x32_bf16 v[64:67], a[120:123], v[116:119], v[64:67]
    ds_read_b128 v[96:99], v159 offset:512
    v_mfma_f32_16x16x32_bf16 v[68:71], a[124:127], v[116:119], v[68:71]
    ds_read_b128 v[100:103], v159 offset:6656
    buffer_load_dwordx4 v9, s[44:47], s13 offen offset:1024 sc1 lds
    v_mfma_f32_16x16x32_bf16 v[68:71], a[116:119], v[112:115], v[68:71]
    v_mfma_f32_16x16x32_bf16 v[76:79], a[116:119], v[120:123], v[76:79]
    v_mfma_f32_16x16x32_bf16 v[76:79], a[124:127], v[124:127], v[76:79]
    buffer_load_dwordx4 v3, s[44:47], s13 offen offset:2048 sc1 lds
    v_mfma_f32_16x16x32_bf16 v[72:75], a[120:123], v[124:127], v[72:75]
    v_mfma_f32_16x16x32_bf16 v[72:75], a[112:115], v[120:123], v[72:75]
    s_waitcnt lgkmcnt(0)
    v_mfma_f32_16x16x32_bf16 v[32:35], a[128:131], v[80:83], v[32:35]
    s_add_u32 m0, s74, 61440
    s_mul_i32 s13, s79, 90112
    v_mfma_f32_16x16x32_bf16 v[32:35], a[136:139], v[84:87], v[32:35]
    ds_read_b128 v[104:107], v159 offset:768
    v_mfma_f32_16x16x32_bf16 v[36:39], a[140:143], v[84:87], v[36:39]
    ds_read_b128 v[108:111], v159 offset:6912
    v_mfma_f32_16x16x32_bf16 v[36:39], a[132:135], v[80:83], v[36:39]
    ds_read_b128 v[112:115], v159 offset:1024
    buffer_load_dwordx4 v8, s[44:47], s13 offen offset:0 sc1 lds
    v_mfma_f32_16x16x32_bf16 v[44:47], a[132:135], v[88:91], v[44:47]
    ds_read_b128 v[116:119], v159 offset:7168
    v_mfma_f32_16x16x32_bf16 v[44:47], a[140:143], v[92:95], v[44:47]
    ds_read_b128 v[120:123], v159 offset:1280
    v_mfma_f32_16x16x32_bf16 v[40:43], a[136:139], v[92:95], v[40:43]
    ds_read_b128 v[124:127], v159 offset:7424
    buffer_load_dwordx4 v9, s[44:47], s13 offen offset:1024 sc1 lds
    v_mfma_f32_16x16x32_bf16 v[40:43], a[128:131], v[88:91], v[40:43]
    v_mfma_f32_16x16x32_bf16 v[48:51], a[128:131], v[96:99], v[48:51]
    v_mfma_f32_16x16x32_bf16 v[48:51], a[136:139], v[100:103], v[48:51]
    buffer_load_dwordx4 v3, s[44:47], s13 offen offset:2048 sc1 lds
    v_mfma_f32_16x16x32_bf16 v[52:55], a[140:143], v[100:103], v[52:55]
    v_mfma_f32_16x16x32_bf16 v[52:55], a[132:135], v[96:99], v[52:55]
    s_waitcnt lgkmcnt(0)
    v_mfma_f32_16x16x32_bf16 v[60:63], a[132:135], v[104:107], v[60:63]
    s_waitcnt vmcnt(13)
    s_barrier
    v_mfma_f32_16x16x32_bf16 v[60:63], a[140:143], v[108:111], v[60:63]
    ds_read_b128 v[80:83], v159 offset:12288
    s_add_u32 m0, s74, 0
    s_mul_i32 s13, s80, 90112
    v_mfma_f32_16x16x32_bf16 v[56:59], a[136:139], v[108:111], v[56:59]
    ds_read_b128 v[84:87], v159 offset:18432
    v_mfma_f32_16x16x32_bf16 v[56:59], a[128:131], v[104:107], v[56:59]
    ds_read_b128 v[88:91], v159 offset:12544
    buffer_load_dwordx4 v8, s[44:47], s13 offen offset:0 sc1 lds
    v_mfma_f32_16x16x32_bf16 v[64:67], a[128:131], v[112:115], v[64:67]
    ds_read_b128 v[92:95], v159 offset:18688
    v_mfma_f32_16x16x32_bf16 v[64:67], a[136:139], v[116:119], v[64:67]
    ds_read_b128 v[96:99], v159 offset:12800
    buffer_load_dword v29, v28, s[44:47], 0 offen sc1
    v_mfma_f32_16x16x32_bf16 v[68:71], a[140:143], v[116:119], v[68:71]
    ds_read_b128 v[100:103], v159 offset:18944
    buffer_load_dwordx4 v9, s[44:47], s13 offen offset:1024 sc1 lds
    v_mfma_f32_16x16x32_bf16 v[68:71], a[132:135], v[112:115], v[68:71]
    ds_read_b64_tr_b16 a[32:33], v10 offset:16384
    v_mfma_f32_16x16x32_bf16 v[76:79], a[132:135], v[120:123], v[76:79]
    ds_read_b64_tr_b16 a[34:35], v10 offset:18432
    v_mfma_f32_16x16x32_bf16 v[76:79], a[140:143], v[124:127], v[76:79]
    buffer_load_dwordx4 v3, s[44:47], s13 offen offset:2048 sc1 lds
    v_mfma_f32_16x16x32_bf16 v[72:75], a[136:139], v[124:127], v[72:75]
    ds_read_b64_tr_b16 a[40:41], v10 offset:20480
    v_mfma_f32_16x16x32_bf16 v[72:75], a[128:131], v[120:123], v[72:75]
    ds_read_b64_tr_b16 a[42:43], v10 offset:22528
    s_waitcnt lgkmcnt(4)
    v_mfma_f32_16x16x32_bf16 v[32:35], a[144:147], v[80:83], v[32:35]
    s_add_u32 m0, s73, 32768
    s_lshl_b32 s14, s87, 18
    v_mfma_f32_16x16x32_bf16 v[32:35], a[152:155], v[84:87], v[32:35]
    ds_read_b128 v[104:107], v159 offset:13056
    v_mfma_f32_16x16x32_bf16 v[36:39], a[156:159], v[84:87], v[36:39]
    ds_read_b128 v[108:111], v159 offset:19200
    buffer_load_dwordx4 v4, s[52:55], s14 offen offset:0 lds
    v_mfma_f32_16x16x32_bf16 v[36:39], a[148:151], v[80:83], v[36:39]
    ds_read_b128 v[112:115], v159 offset:13312
    v_mfma_f32_16x16x32_bf16 v[44:47], a[148:151], v[88:91], v[44:47]
    ds_read_b128 v[116:119], v159 offset:19456
    buffer_load_dwordx4 v5, s[52:55], s14 offen offset:1024 lds
    v_mfma_f32_16x16x32_bf16 v[44:47], a[156:159], v[92:95], v[44:47]
    ds_read_b128 v[120:123], v159 offset:13568
    v_mfma_f32_16x16x32_bf16 v[40:43], a[152:155], v[92:95], v[40:43]
    ds_read_b128 v[124:127], v159 offset:19712
    v_mfma_f32_16x16x32_bf16 v[40:43], a[144:147], v[88:91], v[40:43]
    ds_read_b64_tr_b16 a[36:37], v11 offset:16384
    buffer_load_dwordx4 v6, s[52:55], s14 offen offset:2048 lds
    v_mfma_f32_16x16x32_bf16 v[48:51], a[144:147], v[96:99], v[48:51]
    ds_read_b64_tr_b16 a[38:39], v11 offset:18432
    v_mfma_f32_16x16x32_bf16 v[48:51], a[152:155], v[100:103], v[48:51]
    buffer_load_dwordx4 v7, s[52:55], s14 offen offset:3072 lds
    v_mfma_f32_16x16x32_bf16 v[52:55], a[156:159], v[100:103], v[52:55]
    ds_read_b64_tr_b16 a[44:45], v11 offset:20480
    v_mfma_f32_16x16x32_bf16 v[52:55], a[148:151], v[96:99], v[52:55]
    ds_read_b64_tr_b16 a[46:47], v11 offset:22528
    s_waitcnt lgkmcnt(4)
    v_mfma_f32_16x16x32_bf16 v[60:63], a[148:151], v[104:107], v[60:63]
    s_waitcnt vmcnt(17)
    s_barrier
    v_mfma_f32_16x16x32_bf16 v[60:63], a[156:159], v[108:111], v[60:63]
    ds_read_b128 v[80:83], v159 offset:24576
    v_mfma_f32_16x16x32_bf16 v[56:59], a[152:155], v[108:111], v[56:59]
    ds_read_b128 v[84:87], v159 offset:30720
    v_mfma_f32_16x16x32_bf16 v[56:59], a[144:147], v[104:107], v[56:59]
    ds_read_b128 v[88:91], v159 offset:24832
    v_mfma_f32_16x16x32_bf16 v[64:67], a[144:147], v[112:115], v[64:67]
    ds_read_b128 v[92:95], v159 offset:30976
    v_mfma_f32_16x16x32_bf16 v[64:67], a[152:155], v[116:119], v[64:67]
    ds_read_b128 v[96:99], v159 offset:25088
    v_mfma_f32_16x16x32_bf16 v[68:71], a[156:159], v[116:119], v[68:71]
    ds_read_b128 v[100:103], v159 offset:31232
    v_mfma_f32_16x16x32_bf16 v[68:71], a[148:151], v[112:115], v[68:71]
    v_mfma_f32_16x16x32_bf16 v[76:79], a[148:151], v[120:123], v[76:79]
    v_mfma_f32_16x16x32_bf16 v[76:79], a[156:159], v[124:127], v[76:79]
    v_mfma_f32_16x16x32_bf16 v[72:75], a[152:155], v[124:127], v[72:75]
    v_mfma_f32_16x16x32_bf16 v[72:75], a[144:147], v[120:123], v[72:75]
    s_waitcnt lgkmcnt(0)
    v_mfma_f32_16x16x32_bf16 v[32:35], a[160:163], v[80:83], v[32:35]
    v_mfma_f32_16x16x32_bf16 v[32:35], a[168:171], v[84:87], v[32:35]
    ds_read_b128 v[104:107], v159 offset:25344
    v_mfma_f32_16x16x32_bf16 v[36:39], a[172:175], v[84:87], v[36:39]
    ds_read_b128 v[108:111], v159 offset:31488
    v_mfma_f32_16x16x32_bf16 v[36:39], a[164:167], v[80:83], v[36:39]
    ds_read_b128 v[112:115], v159 offset:25600
    v_mfma_f32_16x16x32_bf16 v[44:47], a[164:167], v[88:91], v[44:47]
    ds_read_b128 v[116:119], v159 offset:31744
    v_mfma_f32_16x16x32_bf16 v[44:47], a[172:175], v[92:95], v[44:47]
    ds_read_b128 v[120:123], v159 offset:25856
    v_mfma_f32_16x16x32_bf16 v[40:43], a[168:171], v[92:95], v[40:43]
    ds_read_b128 v[124:127], v159 offset:32000
    v_mfma_f32_16x16x32_bf16 v[40:43], a[160:163], v[88:91], v[40:43]
    v_mfma_f32_16x16x32_bf16 v[48:51], a[160:163], v[96:99], v[48:51]
    v_mfma_f32_16x16x32_bf16 v[48:51], a[168:171], v[100:103], v[48:51]
    v_mfma_f32_16x16x32_bf16 v[52:55], a[172:175], v[100:103], v[52:55]
    v_mfma_f32_16x16x32_bf16 v[52:55], a[164:167], v[96:99], v[52:55]
    s_waitcnt lgkmcnt(0)
    v_mfma_f32_16x16x32_bf16 v[60:63], a[164:167], v[104:107], v[60:63]
    s_waitcnt vmcnt(14)
    s_barrier
    v_mfma_f32_16x16x32_bf16 v[60:63], a[172:175], v[108:111], v[60:63]
    ds_read_b128 v[80:83], v250 offset:0
    s_waitcnt vmcnt(6)
    v_mfma_f32_16x16x32_bf16 v[56:59], a[168:171], v[108:111], v[56:59]
    ds_read_b128 v[84:87], v250 offset:6144
    v_cmp_ne_u32 vcc, s68, v29
    v_mfma_f32_16x16x32_bf16 v[56:59], a[160:163], v[104:107], v[56:59]
    ds_read_b128 v[88:91], v250 offset:256
    v_mfma_f32_16x16x32_bf16 v[64:67], a[160:163], v[112:115], v[64:67]
    ds_read_b128 v[92:95], v250 offset:6400
    v_mfma_f32_16x16x32_bf16 v[64:67], a[168:171], v[116:119], v[64:67]
    ds_read_b128 v[96:99], v250 offset:512
    s_cbranch_vccnz L_rs_p5
L_ok_p5:
    v_mfma_f32_16x16x32_bf16 v[68:71], a[172:175], v[116:119], v[68:71]
    ds_read_b128 v[100:103], v250 offset:6656
    buffer_load_dwordx4 v[160:163], v246, s[44:47], s10 offen offset:0 sc1
    v_mfma_f32_16x16x32_bf16 v[68:71], a[164:167], v[112:115], v[68:71]
    v_mfma_f32_16x16x32_bf16 v[76:79], a[164:167], v[120:123], v[76:79]
    v_mfma_f32_16x16x32_bf16 v[76:79], a[172:175], v[124:127], v[76:79]
    buffer_load_dwordx4 v[164:167], v246, s[44:47], s10 offen offset:1024 sc1
    v_mfma_f32_16x16x32_bf16 v[72:75], a[168:171], v[124:127], v[72:75]
    buffer_load_dwordx4 v[168:171], v246, s[44:47], s10 offen offset:2048 sc1
    v_mfma_f32_16x16x32_bf16 v[72:75], a[160:163], v[120:123], v[72:75]
    s_waitcnt lgkmcnt(0)
    v_mfma_f32_16x16x32_bf16 v[32:35], a[176:179], v[80:83], v[32:35]
    v_mfma_f32_16x16x32_bf16 v[32:35], a[184:187], v[84:87], v[32:35]
    ds_read_b128 v[104:107], v250 offset:768
    v_mfma_f32_16x16x32_bf16 v[36:39], a[188:191], v[84:87], v[36:39]
    ds_read_b128 v[108:111], v250 offset:6912
    buffer_load_dwordx4 v[172:175], v247, s[44:47], s10 offen offset:0 sc1
    v_mfma_f32_16x16x32_bf16 v[36:39], a[180:183], v[80:83], v[36:39]
    ds_read_b128 v[112:115], v250 offset:1024
    v_mfma_f32_16x16x32_bf16 v[44:47], a[180:183], v[88:91], v[44:47]
    ds_read_b128 v[116:119], v250 offset:7168
    v_mfma_f32_16x16x32_bf16 v[44:47], a[188:191], v[92:95], v[44:47]
    ds_read_b128 v[120:123], v250 offset:1280
    buffer_load_dwordx4 v[176:179], v247, s[44:47], s10 offen offset:1024 sc1
    v_mfma_f32_16x16x32_bf16 v[40:43], a[184:187], v[92:95], v[40:43]
    ds_read_b128 v[124:127], v250 offset:7424
    v_mfma_f32_16x16x32_bf16 v[40:43], a[176:179], v[88:91], v[40:43]
    v_mfma_f32_16x16x32_bf16 v[48:51], a[176:179], v[96:99], v[48:51]
    v_mfma_f32_16x16x32_bf16 v[48:51], a[184:187], v[100:103], v[48:51]
    v_mfma_f32_16x16x32_bf16 v[52:55], a[188:191], v[100:103], v[52:55]
    buffer_load_dwordx4 v[180:183], v247, s[44:47], s10 offen offset:2048 sc1
    v_mfma_f32_16x16x32_bf16 v[52:55], a[180:183], v[96:99], v[52:55]
    s_waitcnt lgkmcnt(0)
    v_mfma_f32_16x16x32_bf16 v[60:63], a[180:183], v[104:107], v[60:63]
    s_barrier
    v_mfma_f32_16x16x32_bf16 v[60:63], a[188:191], v[108:111], v[60:63]
    ds_read_b128 v[80:83], v250 offset:12288
    s_add_u32 m0, s74, 12288
    s_mul_i32 s13, s81, 90112
    v_mfma_f32_16x16x32_bf16 v[56:59], a[184:187], v[108:111], v[56:59]
    ds_read_b128 v[84:87], v250 offset:18432
    v_mfma_f32_16x16x32_bf16 v[56:59], a[176:179], v[104:107], v[56:59]
    ds_read_b128 v[88:91], v250 offset:12544
    buffer_load_dwordx4 v8, s[44:47], s13 offen offset:0 sc1 lds
    v_mfma_f32_16x16x32_bf16 v[64:67], a[176:179], v[112:115], v[64:67]
    ds_read_b128 v[92:95], v250 offset:18688
    v_mfma_f32_16x16x32_bf16 v[64:67], a[184:187], v[116:119], v[64:67]
    ds_read_b128 v[96:99], v250 offset:12800
    v_mfma_f32_16x16x32_bf16 v[68:71], a[188:191], v[116:119], v[68:71]
    ds_read_b128 v[100:103], v250 offset:18944
    buffer_load_dwordx4 v9, s[44:47], s13 offen offset:1024 sc1 lds
    v_mfma_f32_16x16x32_bf16 v[68:71], a[180:183], v[112:115], v[68:71]
    v_mfma_f32_16x16x32_bf16 v[76:79], a[180:183], v[120:123], v[76:79]
    v_mfma_f32_16x16x32_bf16 v[76:79], a[188:191], v[124:127], v[76:79]
    buffer_load_dwordx4 v3, s[44:47], s13 offen offset:2048 sc1 lds
    v_mfma_f32_16x16x32_bf16 v[72:75], a[184:187], v[124:127], v[72:75]
    v_mfma_f32_16x16x32_bf16 v[72:75], a[176:179], v[120:123], v[72:75]
    s_waitcnt lgkmcnt(0)
    v_mfma_f32_16x16x32_bf16 v[32:35], a[192:195], v[80:83], v[32:35]
    s_add_u32 m0, s73, 49152
    s_lshl_b32 s14, s88, 18
    v_mfma_f32_16x16x32_bf16 v[32:35], a[200:203], v[84:87], v[32:35]
    ds_read_b128 v[104:107], v250 offset:13056
    v_mfma_f32_16x16x32_bf16 v[36:39], a[204:207], v[84:87], v[36:39]
    ds_read_b128 v[108:111], v250 offset:19200
    buffer_load_dwordx4 v4, s[52:55], s14 offen offset:0 lds
    v_mfma_f32_16x16x32_bf16 v[36:39], a[196:199], v[80:83], v[36:39]
    ds_read_b128 v[112:115], v250 offset:13312
    v_mfma_f32_16x16x32_bf16 v[44:47], a[196:199], v[88:91], v[44:47]
    ds_read_b128 v[116:119], v250 offset:19456
    buffer_load_dwordx4 v5, s[52:55], s14 offen offset:1024 lds
    v_mfma_f32_16x16x32_bf16 v[44:47], a[204:207], v[92:95], v[44:47]
    ds_read_b128 v[120:123], v250 offset:13568
    v_mfma_f32_16x16x32_bf16 v[40:43], a[200:203], v[92:95], v[40:43]
    ds_read_b128 v[124:127], v250 offset:19712
    v_mfma_f32_16x16x32_bf16 v[40:43], a[192:195], v[88:91], v[40:43]
    buffer_load_dwordx4 v6, s[52:55], s14 offen offset:2048 lds
    v_mfma_f32_16x16x32_bf16 v[48:51], a[192:195], v[96:99], v[48:51]
    v_mfma_f32_16x16x32_bf16 v[48:51], a[200:203], v[100:103], v[48:51]
    buffer_load_dwordx4 v7, s[52:55], s14 offen offset:3072 lds
    v_mfma_f32_16x16x32_bf16 v[52:55], a[204:207], v[100:103], v[52:55]
    v_mfma_f32_16x16x32_bf16 v[52:55], a[196:199], v[96:99], v[52:55]
    s_waitcnt lgkmcnt(0)
    v_mfma_f32_16x16x32_bf16 v[60:63], a[196:199], v[104:107], v[60:63]
    s_barrier
    v_mfma_f32_16x16x32_bf16 v[60:63], a[204:207], v[108:111], v[60:63]
    ds_read_b128 v[80:83], v250 offset:24576
    v_mfma_f32_16x16x32_bf16 v[56:59], a[200:203], v[108:111], v[56:59]
    ds_read_b128 v[84:87], v250 offset:30720
    v_mfma_f32_16x16x32_bf16 v[56:59], a[192:195], v[104:107], v[56:59]
    ds_read_b128 v[88:91], v250 offset:24832
    v_mfma_f32_16x16x32_bf16 v[64:67], a[192:195], v[112:115], v[64:67]
    ds_read_b128 v[92:95], v250 offset:30976
    v_mfma_f32_16x16x32_bf16 v[64:67], a[200:203], v[116:119], v[64:67]
    ds_read_b128 v[96:99], v250 offset:25088
    v_mfma_f32_16x16x32_bf16 v[68:71], a[204:207], v[116:119], v[68:71]
    ds_read_b128 v[100:103], v250 offset:31232
    s_waitcnt vmcnt(7)
    v_mfma_f32_16x16x32_bf16 v[68:71], a[196:199], v[112:115], v[68:71]
    v_mfma_f32_16x16x32_bf16 v[76:79], a[196:199], v[120:123], v[76:79]
    v_mfma_f32_16x16x32_bf16 v[76:79], a[204:207], v[124:127], v[76:79]
    v_mfma_f32_16x16x32_bf16 v[72:75], a[200:203], v[124:127], v[72:75]
    v_mfma_f32_16x16x32_bf16 v[72:75], a[192:195], v[120:123], v[72:75]
    s_waitcnt lgkmcnt(0)
    v_mfma_f32_16x16x32_bf16 v[32:35], a[208:211], v[80:83], v[32:35]
    s_add_u32 m0, s73, 65536
    s_lshl_b32 s14, s89, 18
    v_mfma_f32_16x16x32_bf16 v[32:35], a[216:219], v[84:87], v[32:35]
    ds_read_b128 v[104:107], v250 offset:25344
    v_mfma_f32_16x16x32_bf16 v[36:39], a[220:223], v[84:87], v[36:39]
    ds_read_b128 v[108:111], v250 offset:31488
    buffer_load_dwordx4 v4, s[52:55], s14 offen offset:0 lds
    v_and_b32 v193, 0xffff0000, v172
    v_lshlrev_b32 v192, 16, v172
    v_mfma_f32_16x16x32_bf16 v[36:39], a[212:215], v[80:83], v[36:39]
    ds_read_b128 v[112:115], v250 offset:25600
    v_and_b32 v195, 0xffff0000, v173
    v_lshlrev_b32 v194, 16, v173
    v_mfma_f32_16x16x32_bf16 v[44:47], a[212:215], v[88:91], v[44:47]
    ds_read_b128 v[116:119], v250 offset:31744
    buffer_load_dwordx4 v5, s[52:55], s14 offen offset:1024 lds
    v_add_f32 v56, v56, v192
    v_mfma_f32_16x16x32_bf16 v[44:47], a[220:223], v[92:95], v[44:47]
    ds_read_b128 v[120:123], v250 offset:25856
    v_add_f32 v57, v57, v193
    v_add_f32 v58, v58, v194
    v_mfma_f32_16x16x32_bf16 v[40:43], a[216:219], v[92:95], v[40:43]
    ds_read_b128 v[124:127], v250 offset:32000
    v_add_f32 v59, v59, v195
    v_and_b32 v197, 0xffff0000, v174
    v_mfma_f32_16x16x32_bf16 v[40:43], a[208:211], v[88:91], v[40:43]
    buffer_load_dwordx4 v6, s[52:55], s14 offen offset:2048 lds
    v_lshlrev_b32 v196, 16, v174
    v_and_b32 v199, 0xffff0000, v175
    v_mfma_f32_16x16x32_bf16 v[48:51], a[208:211], v[96:99], v[48:51]
    v_lshlrev_b32 v198, 16, v175
    v_add_f32 v60, v60, v196
    v_mfma_f32_16x16x32_bf16 v[48:51], a[216:219], v[100:103], v[48:51]
    buffer_load_dwordx4 v7, s[52:55], s14 offen offset:3072 lds
    v_add_f32 v61, v61, v197
    v_mfma_f32_16x16x32_bf16 v[52:55], a[220:223], v[100:103], v[52:55]
    v_add_f32 v62, v62, v198
    v_add_f32 v63, v63, v199
    v_mfma_f32_16x16x32_bf16 v[52:55], a[212:215], v[96:99], v[52:55]
    s_waitcnt lgkmcnt(0)
    v_mfma_f32_16x16x32_bf16 v[60:63], a[212:215], v[104:107], v[60:63]
    s_barrier
    v_mfma_f32_16x16x32_bf16 v[60:63], a[220:223], v[108:111], v[60:63]
    ds_read_b128 v[80:83], v159 offset:0
    v_mfma_f32_16x16x32_bf16 v[56:59], a[216:219], v[108:111], v[56:59]
    ds_read_b128 v[84:87], v159 offset:6144
    v_and_b32 v193, 0xffff0000, v160
    v_lshlrev_b32 v192, 16, v160
    v_mfma_f32_16x16x32_bf16 v[56:59], a[208:211], v[104:107], v[56:59]
    ds_read_b128 v[88:91], v159 offset:256
    v_and_b32 v195, 0xffff0000, v161
    v_lshlrev_b32 v194, 16, v161
    v_mfma_f32_16x16x32_bf16 v[64:67], a[208:211], v[112:115], v[64:67]
    ds_read_b128 v[92:95], v159 offset:6400
    v_add_f32 v32, v32, v192
    v_mfma_f32_16x16x32_bf16 v[64:67], a[216:219], v[116:119], v[64:67]
    ds_read_b128 v[96:99], v159 offset:512
    v_add_f32 v33, v33, v193
    v_add_f32 v34, v34, v194
    v_mfma_f32_16x16x32_bf16 v[68:71], a[220:223], v[116:119], v[68:71]
    ds_read_b128 v[100:103], v159 offset:6656
    v_add_f32 v35, v35, v195
    v_and_b32 v197, 0xffff0000, v162
    v_mfma_f32_16x16x32_bf16 v[68:71], a[212:215], v[112:115], v[68:71]
    ds_read_b64_tr_b16 a[48:49], v10 offset:32768
    v_lshlrev_b32 v196, 16, v162
    v_and_b32 v199, 0xffff0000, v163
    v_mfma_f32_16x16x32_bf16 v[76:79], a[212:215], v[120:123], v[76:79]
    ds_read_b64_tr_b16 a[50:51], v10 offset:34816
    v_lshlrev_b32 v198, 16, v163
    v_mfma_f32_16x16x32_bf16 v[76:79], a[220:223], v[124:127], v[76:79]
    v_add_f32 v36, v36, v196
    v_add_f32 v37, v37, v197
    v_mfma_f32_16x16x32_bf16 v[72:75], a[216:219], v[124:127], v[72:75]
    ds_read_b64_tr_b16 a[56:57], v10 offset:36864
    v_add_f32 v38, v38, v198
    v_add_f32 v39, v39, v199
    v_mfma_f32_16x16x32_bf16 v[72:75], a[208:211], v[120:123], v[72:75]
    ds_read_b64_tr_b16 a[58:59], v10 offset:38912
    s_waitcnt lgkmcnt(4)
    v_mfma_f32_16x16x32_bf16 v[32:35], a[224:227], v[80:83], v[32:35]
    s_add_u32 m0, s73, 0
    s_lshl_b32 s14, s90, 18
    v_mfma_f32_16x16x32_bf16 v[32:35], a[232:235], v[84:87], v[32:35]
    ds_read_b128 v[104:107], v159 offset:768
    v_mfma_f32_16x16x32_bf16 v[36:39], a[236:239], v[84:87], v[36:39]
    ds_read_b128 v[108:111], v159 offset:6912
    buffer_load_dwordx4 v4, s[52:55], s14 offen offset:0 lds
    v_and_b32 v193, 0xffff0000, v176
    v_lshlrev_b32 v192, 16, v176
    v_mfma_f32_16x16x32_bf16 v[36:39], a[228:231], v[80:83], v[36:39]
    ds_read_b128 v[112:115], v159 offset:1024
    v_and_b32 v195, 0xffff0000, v177
    v_lshlrev_b32 v194, 16, v177
    v_mfma_f32_16x16x32_bf16 v[44:47], a[228:231], v[88:91], v[44:47]
    ds_read_b128 v[116:119], v159 offset:7168
    buffer_load_dwordx4 v5, s[52:55], s14 offen offset:1024 lds
    v_add_f32 v64, v64, v192
    v_mfma_f32_16x16x32_bf16 v[44:47], a[236:239], v[92:95], v[44:47]
    ds_read_b128 v[120:123], v159 offset:1280
    v_add_f32 v65, v65, v193
    v_add_f32 v66, v66, v194
    v_mfma_f32_16x16x32_bf16 v[40:43], a[232:235], v[92:95], v[40:43]
    ds_read_b128 v[124:127], v159 offset:7424
    v_add_f32 v67, v67, v195
    v_and_b32 v197, 0xffff0000, v178
    v_mfma_f32_16x16x32_bf16 v[40:43], a[224:227], v[88:91], v[40:43]
    ds_read_b64_tr_b16 a[52:53], v11 offset:32768
    buffer_load_dwordx4 v6, s[52:55], s14 offen offset:2048 lds
    v_lshlrev_b32 v196, 16, v178
    v_and_b32 v199, 0xffff0000, v179
    v_mfma_f32_16x16x32_bf16 v[48:51], a[224:227], v[96:99], v[48:51]
    ds_read_b64_tr_b16 a[54:55], v11 offset:34816
    v_lshlrev_b32 v198, 16, v179
    v_mfma_f32_16x16x32_bf16 v[48:51], a[232:235], v[100:103], v[48:51]
    buffer_load_dwordx4 v7, s[52:55], s14 offen offset:3072 lds
    v_add_f32 v68, v68, v196
    v_add_f32 v69, v69, v197
    v_mfma_f32_16x16x32_bf16 v[52:55], a[236:239], v[100:103], v[52:55]
    ds_read_b64_tr_b16 a[60:61], v11 offset:36864
    v_add_f32 v70, v70, v198
    v_add_f32 v71, v71, v199
    v_mfma_f32_16x16x32_bf16 v[52:55], a[228:231], v[96:99], v[52:55]
    ds_read_b64_tr_b16 a[62:63], v11 offset:38912
    s_waitcnt lgkmcnt(4)
    v_mfma_f32_16x16x32_bf16 v[60:63], a[228:231], v[104:107], v[60:63]
    s_waitcnt vmcnt(12)
    s_barrier
    v_mfma_f32_16x16x32_bf16 v[60:63], a[236:239], v[108:111], v[60:63]
    ds_read_b128 v[80:83], v159 offset:12288
    v_mfma_f32_16x16x32_bf16 v[56:59], a[232:235], v[108:111], v[56:59]
    ds_read_b128 v[84:87], v159 offset:18432
    v_and_b32 v193, 0xffff0000, v164
    v_lshlrev_b32 v192, 16, v164
    v_mfma_f32_16x16x32_bf16 v[56:59], a[224:227], v[104:107], v[56:59]
    ds_read_b128 v[88:91], v159 offset:12544
    v_and_b32 v195, 0xffff0000, v165
    v_lshlrev_b32 v194, 16, v165
    v_mfma_f32_16x16x32_bf16 v[64:67], a[224:227], v[112:115], v[64:67]
    ds_read_b128 v[92:95], v159 offset:18688
    v_add_f32 v40, v40, v192
    v_mfma_f32_16x16x32_bf16 v[64:67], a[232:235], v[116:119], v[64:67]
    ds_read_b128 v[96:99], v159 offset:12800
    v_add_f32 v41, v41, v193
    v_add_f32 v42, v42, v194
    v_mfma_f32_16x16x32_bf16 v[68:71], a[236:239], v[116:119], v[68:71]
    ds_read_b128 v[100:103], v159 offset:18944
    v_add_f32 v43, v43, v195
    v_mfma_f32_16x16x32_bf16 v[68:71], a[228:231], v[112:115], v[68:71]
    v_and_b32 v197, 0xffff0000, v166
    v_lshlrev_b32 v196, 16, v166
    v_mfma_f32_16x16x32_bf16 v[76:79], a[228:231], v[120:123], v[76:79]
    v_and_b32 v199, 0xffff0000, v167
    v_lshlrev_b32 v198, 16, v167
    v_mfma_f32_16x16x32_bf16 v[76:79], a[236:239], v[124:127], v[76:79]
    v_add_f32 v44, v44, v196
    v_add_f32 v45, v45, v197
    v_mfma_f32_16x16x32_bf16 v[72:75], a[232:235], v[124:127], v[72:75]
    v_add_f32 v46, v46, v198
    v_add_f32 v47, v47, v199
    v_mfma_f32_16x16x32_bf16 v[72:75], a[224:227], v[120:123], v[72:75]
    s_waitcnt lgkmcnt(0)
    v_mfma_f32_16x16x32_bf16 v[32:35], a[240:243], v[80:83], v[32:35]
    s_add_u32 m0, s73, 16384
    s_lshl_b32 s14, s91, 18
    v_mfma_f32_16x16x32_bf16 v[32:35], a[248:251], v[84:87], v[32:35]
    ds_read_b128 v[104:107], v159 offset:13056
    v_mfma_f32_16x16x32_bf16 v[36:39], a[252:255], v[84:87], v[36:39]
    ds_read_b128 v[108:111], v159 offset:19200
    buffer_load_dwordx4 v4, s[52:55], s14 offen offset:0 lds
    v_and_b32 v193, 0xffff0000, v180
    v_lshlrev_b32 v192, 16, v180
    v_mfma_f32_16x16x32_bf16 v[36:39], a[244:247], v[80:83], v[36:39]
    ds_read_b128 v[112:115], v159 offset:13312
    v_and_b32 v195, 0xffff0000, v181
    v_lshlrev_b32 v194, 16, v181
    v_mfma_f32_16x16x32_bf16 v[44:47], a[244:247], v[88:91], v[44:47]
    ds_read_b128 v[116:119], v159 offset:19456
    buffer_load_dwordx4 v5, s[52:55], s14 offen offset:1024 lds
    v_add_f32 v72, v72, v192
    v_mfma_f32_16x16x32_bf16 v[44:47], a[252:255], v[92:95], v[44:47]
    ds_read_b128 v[120:123], v159 offset:13568
    v_add_f32 v73, v73, v193
    v_add_f32 v74, v74, v194
    v_mfma_f32_16x16x32_bf16 v[40:43], a[248:251], v[92:95], v[40:43]
    ds_read_b128 v[124:127], v159 offset:19712
    v_add_f32 v75, v75, v195
    v_and_b32 v197, 0xffff0000, v182
    v_mfma_f32_16x16x32_bf16 v[40:43], a[240:243], v[88:91], v[40:43]
    buffer_load_dwordx4 v6, s[52:55], s14 offen offset:2048 lds
    v_lshlrev_b32 v196, 16, v182
    v_and_b32 v199, 0xffff0000, v183
    v_mfma_f32_16x16x32_bf16 v[48:51], a[240:243], v[96:99], v[48:51]
    v_lshlrev_b32 v198, 16, v183
    v_add_f32 v76, v76, v196
    v_mfma_f32_16x16x32_bf16 v[48:51], a[248:251], v[100:103], v[48:51]
    buffer_load_dwordx4 v7, s[52:55], s14 offen offset:3072 lds
    v_add_f32 v77, v77, v197
    v_mfma_f32_16x16x32_bf16 v[52:55], a[252:255], v[100:103], v[52:55]
    v_add_f32 v78, v78, v198
    v_add_f32 v79, v79, v199
    v_mfma_f32_16x16x32_bf16 v[52:55], a[244:247], v[96:99], v[52:55]
    s_waitcnt lgkmcnt(0)
    v_mfma_f32_16x16x32_bf16 v[60:63], a[244:247], v[104:107], v[60:63]
    s_barrier
    v_mfma_f32_16x16x32_bf16 v[60:63], a[252:255], v[108:111], v[60:63]
    s_add_u32 m0, s73, 131072
    s_lshl_b32 s14, s92, 18
    v_mfma_f32_16x16x32_bf16 v[56:59], a[248:251], v[108:111], v[56:59]
    buffer_load_dwordx4 v4, s[52:55], s14 offen offset:0 lds
    v_and_b32 v193, 0xffff0000, v168
    v_lshlrev_b32 v192, 16, v168
    v_mfma_f32_16x16x32_bf16 v[56:59], a[240:243], v[104:107], v[56:59]
    buffer_load_dwordx4 v5, s[52:55], s14 offen offset:1024 lds
    v_and_b32 v195, 0xffff0000, v169
    v_lshlrev_b32 v194, 16, v169
    v_mfma_f32_16x16x32_bf16 v[64:67], a[240:243], v[112:115], v[64:67]
    buffer_load_dwordx4 v6, s[52:55], s14 offen offset:2048 lds
    v_add_f32 v48, v48, v192
    v_mfma_f32_16x16x32_bf16 v[64:67], a[248:251], v[116:119], v[64:67]
    buffer_load_dwordx4 v7, s[52:55], s14 offen offset:3072 lds
    v_add_f32 v49, v49, v193
    v_add_f32 v50, v50, v194
    v_mfma_f32_16x16x32_bf16 v[68:71], a[252:255], v[116:119], v[68:71]
    s_add_u32 m0, s73, 147456
    s_lshl_b32 s14, s93, 18
    v_add_f32 v51, v51, v195
    v_and_b32 v197, 0xffff0000, v170
    v_mfma_f32_16x16x32_bf16 v[68:71], a[244:247], v[112:115], v[68:71]
    buffer_load_dwordx4 v4, s[52:55], s14 offen offset:0 lds
    v_lshlrev_b32 v196, 16, v170
    v_and_b32 v199, 0xffff0000, v171
    v_mfma_f32_16x16x32_bf16 v[76:79], a[244:247], v[120:123], v[76:79]
    buffer_load_dwordx4 v5, s[52:55], s14 offen offset:1024 lds
    v_lshlrev_b32 v198, 16, v171
    v_mfma_f32_16x16x32_bf16 v[76:79], a[252:255], v[124:127], v[76:79]
    buffer_load_dwordx4 v6, s[52:55], s14 offen offset:2048 lds
    v_add_f32 v52, v52, v196
    v_add_f32 v53, v53, v197
    v_mfma_f32_16x16x32_bf16 v[72:75], a[248:251], v[124:127], v[72:75]
    buffer_load_dwordx4 v7, s[52:55], s14 offen offset:3072 lds
    v_add_f32 v54, v54, v198
    v_add_f32 v55, v55, v199
    v_mfma_f32_16x16x32_bf16 v[72:75], a[240:243], v[120:123], v[72:75]
L_pl_G_5:
    s_cbranch_execz L_wret
    s_waitcnt lgkmcnt(0)
    v_mov_b32 v88, 0xc0135761
    s_mov_b32 s10, 0xbdd2d3e8
    s_lshl_b32 s9, s69, 2
    s_add_u32 s9, s9, s3
    s_mul_i32 s9, s9, 69632
    s_add_u32 s9, s9, 12795904
    v_pk_mul_f32 v[160:161], v[32:33], v[32:33]
    v_pk_mul_f32 v[162:163], v[34:35], v[34:35]
    v_pk_mul_f32 v[164:165], v[36:37], v[36:37]
    v_pk_mul_f32 v[166:167], v[38:39], v[38:39]
    v_pk_mul_f32 v[168:169], v[40:41], v[40:41]
    v_pk_mul_f32 v[170:171], v[42:43], v[42:43]
    v_pk_mul_f32 v[172:173], v[44:45], v[44:45]
    v_pk_mul_f32 v[174:175], v[46:47], v[46:47]
    v_pk_fma_f32 v[160:161], v[160:161], s[10:11], v[88:89] op_sel_hi:[1,0,0]
    v_pk_fma_f32 v[162:163], v[162:163], s[10:11], v[88:89] op_sel_hi:[1,0,0]
    v_pk_fma_f32 v[164:165], v[164:165], s[10:11], v[88:89] op_sel_hi:[1,0,0]
    v_pk_fma_f32 v[166:167], v[166:167], s[10:11], v[88:89] op_sel_hi:[1,0,0]
    v_pk_fma_f32 v[168:169], v[168:169], s[10:11], v[88:89] op_sel_hi:[1,0,0]
    v_pk_fma_f32 v[170:171], v[170:171], s[10:11], v[88:89] op_sel_hi:[1,0,0]
    v_pk_fma_f32 v[172:173], v[172:173], s[10:11], v[88:89] op_sel_hi:[1,0,0]
    v_pk_fma_f32 v[174:175], v[174:175], s[10:11], v[88:89] op_sel_hi:[1,0,0]
    v_pk_mul_f32 v[160:161], v[160:161], v[32:33]
    v_pk_mul_f32 v[162:163], v[162:163], v[34:35]
    v_pk_mul_f32 v[164:165], v[164:165], v[36:37]
    v_pk_mul_f32 v[166:167], v[166:167], v[38:39]
    v_pk_mul_f32 v[168:169], v[168:169], v[40:41]
    v_pk_mul_f32 v[170:171], v[170:171], v[42:43]
    v_pk_mul_f32 v[172:173], v[172:173], v[44:45]
    v_pk_mul_f32 v[174:175], v[174:175], v[46:47]
    v_exp_f32 v160, v160
    v_exp_f32 v161, v161
    v_exp_f32 v162, v162
    v_exp_f32 v163, v163
    v_exp_f32 v164, v164
    v_exp_f32 v165, v165
    v_exp_f32 v166, v166
    v_exp_f32 v167, v167
    v_exp_f32 v168, v168
    v_exp_f32 v169, v169
    v_exp_f32 v170, v170
    v_exp_f32 v171, v171
    v_exp_f32 v172, v172
    v_exp_f32 v173, v173
    v_exp_f32 v174, v174
    v_exp_f32 v175, v175
    v_pk_add_f32 v[160:161], v[160:161], 1.0 op_sel_hi:[1,0]
    v_pk_add_f32 v[162:163], v[162:163], 1.0 op_sel_hi:[1,0]
    v_pk_add_f32 v[164:165], v[164:165], 1.0 op_sel_hi:[1,0]
    v_pk_add_f32 v[166:167], v[166:167], 1.0 op_sel_hi:[1,0]
    v_pk_add_f32 v[168:169], v[168:169], 1.0 op_sel_hi:[1,0]
    v_pk_add_f32 v[170:171], v[170:171], 1.0 op_sel_hi:[1,0]
    v_pk_add_f32 v[172:173], v[172:173], 1.0 op_sel_hi:[1,0]
    v_pk_add_f32 v[174:175], v[174:175], 1.0 op_sel_hi:[1,0]
    v_rcp_f32 v160, v160
    v_rcp_f32 v161, v161
    v_rcp_f32 v162, v162
    v_rcp_f32 v163, v163
    v_rcp_f32 v164, v164
    v_rcp_f32 v165, v165
    v_rcp_f32 v166, v166
    v_rcp_f32 v167, v167
    v_rcp_f32 v168, v168
    v_rcp_f32 v169, v169
    v_rcp_f32 v170, v170
    v_rcp_f32 v171, v171
    v_rcp_f32 v172, v172
    v_rcp_f32 v173, v173
    v_rcp_f32 v174, v174
    v_rcp_f32 v175, v175
    v_pk_mul_f32 v[32:33], v[32:33], v[160:161]
    v_pk_mul_f32 v[34:35], v[34:35], v[162:163]
    v_pk_mul_f32 v[36:37], v[36:37], v[164:165]
    v_pk_mul_f32 v[38:39], v[38:39], v[166:167]
    v_pk_mul_f32 v[40:41], v[40:41], v[168:169]
    v_pk_mul_f32 v[42:43], v[42:43], v[170:171]
    v_pk_mul_f32 v[44:45], v[44:45], v[172:173]
    v_pk_mul_f32 v[46:47], v[46:47], v[174:175]
    v_cvt_pk_bf16_f32 v96, v32, v33
    v_cvt_pk_bf16_f32 v97, v34, v35
    v_cvt_pk_bf16_f32 v98, v36, v37
    v_cvt_pk_bf16_f32 v99, v38, v39
    v_cvt_pk_bf16_f32 v100, v40, v41
    v_cvt_pk_bf16_f32 v101, v42, v43
    v_cvt_pk_bf16_f32 v102, v44, v45
    v_cvt_pk_bf16_f32 v103, v46, v47
    buffer_store_dwordx4 v[96:99], v240, s[44:47], s9 offen sc1
    buffer_store_dwordx4 v[100:103], v241, s[44:47], s9 offen sc1
    v_pk_mul_f32 v[160:161], v[48:49], v[48:49]
    v_pk_mul_f32 v[162:163], v[50:51], v[50:51]
    v_pk_mul_f32 v[164:165], v[52:53], v[52:53]
    v_pk_mul_f32 v[166:167], v[54:55], v[54:55]
    v_pk_mul_f32 v[168:169], v[56:57], v[56:57]
    v_pk_mul_f32 v[170:171], v[58:59], v[58:59]
    v_pk_mul_f32 v[172:173], v[60:61], v[60:61]
    v_pk_mul_f32 v[174:175], v[62:63], v[62:63]
    v_pk_fma_f32 v[160:161], v[160:161], s[10:11], v[88:89] op_sel_hi:[1,0,0]
    v_pk_fma_f32 v[162:163], v[162:163], s[10:11], v[88:89] op_sel_hi:[1,0,0]
    v_pk_fma_f32 v[164:165], v[164:165], s[10:11], v[88:89] op_sel_hi:[1,0,0]
    v_pk_fma_f32 v[166:167], v[166:167], s[10:11], v[88:89] op_sel_hi:[1,0,0]
    v_pk_fma_f32 v[168:169], v[168:169], s[10:11], v[88:89] op_sel_hi:[1,0,0]
    v_pk_fma_f32 v[170:171], v[170:171], s[10:11], v[88:89] op_sel_hi:[1,0,0]
    v_pk_fma_f32 v[172:173], v[172:173], s[10:11], v[88:89] op_sel_hi:[1,0,0]
    v_pk_fma_f32 v[174:175], v[174:175], s[10:11], v[88:89] op_sel_hi:[1,0,0]
    v_pk_mul_f32 v[160:161], v[160:161], v[48:49]
    v_pk_mul_f32 v[162:163], v[162:163], v[50:51]
    v_pk_mul_f32 v[164:165], v[164:165], v[52:53]
    v_pk_mul_f32 v[166:167], v[166:167], v[54:55]
    v_pk_mul_f32 v[168:169], v[168:169], v[56:57]
    v_pk_mul_f32 v[170:171], v[170:171], v[58:59]
    v_pk_mul_f32 v[172:173], v[172:173], v[60:61]
    v_pk_mul_f32 v[174:175], v[174:175], v[62:63]
    v_exp_f32 v160, v160
    v_exp_f32 v161, v161
    v_exp_f32 v162, v162
    v_exp_f32 v163, v163
    v_exp_f32 v164, v164
    v_exp_f32 v165, v165
    v_exp_f32 v166, v166
    v_exp_f32 v167, v167
    v_exp_f32 v168, v168
    v_exp_f32 v169, v169
    v_exp_f32 v170, v170
    v_exp_f32 v171, v171
    v_exp_f32 v172, v172
    v_exp_f32 v173, v173
    v_exp_f32 v174, v174
    v_exp_f32 v175, v175
    v_pk_add_f32 v[160:161], v[160:161], 1.0 op_sel_hi:[1,0]
    v_pk_add_f32 v[162:163], v[162:163], 1.0 op_sel_hi:[1,0]
    v_pk_add_f32 v[164:165], v[164:165], 1.0 op_sel_hi:[1,0]
    v_pk_add_f32 v[166:167], v[166:167], 1.0 op_sel_hi:[1,0]
    v_pk_add_f32 v[168:169], v[168:169], 1.0 op_sel_hi:[1,0]
    v_pk_add_f32 v[170:171], v[170:171], 1.0 op_sel_hi:[1,0]
    v_pk_add_f32 v[172:173], v[172:173], 1.0 op_sel_hi:[1,0]
    v_pk_add_f32 v[174:175], v[174:175], 1.0 op_sel_hi:[1,0]
    v_rcp_f32 v160, v160
    v_rcp_f32 v161, v161
    v_rcp_f32 v162, v162
    v_rcp_f32 v163, v163
    v_rcp_f32 v164, v164
    v_rcp_f32 v165, v165
    v_rcp_f32 v166, v166
    v_rcp_f32 v167, v167
    v_rcp_f32 v168, v168
    v_rcp_f32 v169, v169
    v_rcp_f32 v170, v170
    v_rcp_f32 v171, v171
    v_rcp_f32 v172, v172
    v_rcp_f32 v173, v173
    v_rcp_f32 v174, v174
    v_rcp_f32 v175, v175
    v_pk_mul_f32 v[48:49], v[48:49], v[160:161]
    v_pk_mul_f32 v[50:51], v[50:51], v[162:163]
    v_pk_mul_f32 v[52:53], v[52:53], v[164:165]
    v_pk_mul_f32 v[54:55], v[54:55], v[166:167]
    v_pk_mul_f32 v[56:57], v[56:57], v[168:169]
    v_pk_mul_f32 v[58:59], v[58:59], v[170:171]
    v_pk_mul_f32 v[60:61], v[60:61], v[172:173]
    v_pk_mul_f32 v[62:63], v[62:63], v[174:175]
    v_cvt_pk_bf16_f32 v104, v48, v49
    v_cvt_pk_bf16_f32 v105, v50, v51
    v_cvt_pk_bf16_f32 v106, v52, v53
    v_cvt_pk_bf16_f32 v107, v54, v55
    v_cvt_pk_bf16_f32 v108, v56, v57
    v_cvt_pk_bf16_f32 v109, v58, v59
    v_cvt_pk_bf16_f32 v110, v60, v61
    v_cvt_pk_bf16_f32 v111, v62, v63
    buffer_store_dwordx4 v[104:107], v242, s[44:47], s9 offen sc1
    buffer_store_dwordx4 v[108:111], v243, s[44:47], s9 offen sc1
    v_pk_mul_f32 v[160:161], v[64:65], v[64:65]
    v_pk_mul_f32 v[162:163], v[66:67], v[66:67]
    v_pk_mul_f32 v[164:165], v[68:69], v[68:69]
    v_pk_mul_f32 v[166:167], v[70:71], v[70:71]
    v_pk_mul_f32 v[168:169], v[72:73], v[72:73]
    v_pk_mul_f32 v[170:171], v[74:75], v[74:75]
    v_pk_mul_f32 v[172:173], v[76:77], v[76:77]
    v_pk_mul_f32 v[174:175], v[78:79], v[78:79]
    v_pk_fma_f32 v[160:161], v[160:161], s[10:11], v[88:89] op_sel_hi:[1,0,0]
    v_pk_fma_f32 v[162:163], v[162:163], s[10:11], v[88:89] op_sel_hi:[1,0,0]
    v_pk_fma_f32 v[164:165], v[164:165], s[10:11], v[88:89] op_sel_hi:[1,0,0]
    v_pk_fma_f32 v[166:167], v[166:167], s[10:11], v[88:89] op_sel_hi:[1,0,0]
    v_pk_fma_f32 v[168:169], v[168:169], s[10:11], v[88:89] op_sel_hi:[1,0,0]
    v_pk_fma_f32 v[170:171], v[170:171], s[10:11], v[88:89] op_sel_hi:[1,0,0]
    v_pk_fma_f32 v[172:173], v[172:173], s[10:11], v[88:89] op_sel_hi:[1,0,0]
    v_pk_fma_f32 v[174:175], v[174:175], s[10:11], v[88:89] op_sel_hi:[1,0,0]
    v_pk_mul_f32 v[160:161], v[160:161], v[64:65]
    v_pk_mul_f32 v[162:163], v[162:163], v[66:67]
    v_pk_mul_f32 v[164:165], v[164:165], v[68:69]
    v_pk_mul_f32 v[166:167], v[166:167], v[70:71]
    v_pk_mul_f32 v[168:169], v[168:169], v[72:73]
    v_pk_mul_f32 v[170:171], v[170:171], v[74:75]
    v_pk_mul_f32 v[172:173], v[172:173], v[76:77]
    v_pk_mul_f32 v[174:175], v[174:175], v[78:79]
    v_exp_f32 v160, v160
    v_exp_f32 v161, v161
    v_exp_f32 v162, v162
    v_exp_f32 v163, v163
    v_exp_f32 v164, v164
    v_exp_f32 v165, v165
    v_exp_f32 v166, v166
    v_exp_f32 v167, v167
    v_exp_f32 v168, v168
    v_exp_f32 v169, v169
    v_exp_f32 v170, v170
    v_exp_f32 v171, v171
    v_exp_f32 v172, v172
    v_exp_f32 v173, v173
    v_exp_f32 v174, v174
    v_exp_f32 v175, v175
    v_pk_add_f32 v[160:161], v[160:161], 1.0 op_sel_hi:[1,0]
    v_pk_add_f32 v[162:163], v[162:163], 1.0 op_sel_hi:[1,0]
    v_pk_add_f32 v[164:165], v[164:165], 1.0 op_sel_hi:[1,0]
    v_pk_add_f32 v[166:167], v[166:167], 1.0 op_sel_hi:[1,0]
    v_pk_add_f32 v[168:169], v[168:169], 1.0 op_sel_hi:[1,0]
    v_pk_add_f32 v[170:171], v[170:171], 1.0 op_sel_hi:[1,0]
    v_pk_add_f32 v[172:173], v[172:173], 1.0 op_sel_hi:[1,0]
    v_pk_add_f32 v[174:175], v[174:175], 1.0 op_sel_hi:[1,0]
    v_rcp_f32 v160, v160
    v_rcp_f32 v161, v161
    v_rcp_f32 v162, v162
    v_rcp_f32 v163, v163
    v_rcp_f32 v164, v164
    v_rcp_f32 v165, v165
    v_rcp_f32 v166, v166
    v_rcp_f32 v167, v167
    v_rcp_f32 v168, v168
    v_rcp_f32 v169, v169
    v_rcp_f32 v170, v170
    v_rcp_f32 v171, v171
    v_rcp_f32 v172, v172
    v_rcp_f32 v173, v173
    v_rcp_f32 v174, v174
    v_rcp_f32 v175, v175
    v_pk_mul_f32 v[64:65], v[64:65], v[160:161]
    v_pk_mul_f32 v[66:67], v[66:67], v[162:163]
    v_pk_mul_f32 v[68:69], v[68:69], v[164:165]
    v_pk_mul_f32 v[70:71], v[70:71], v[166:167]
    v_pk_mul_f32 v[72:73], v[72:73], v[168:169]
    v_pk_mul_f32 v[74:75], v[74:75], v[170:171]
    v_pk_mul_f32 v[76:77], v[76:77], v[172:173]
    v_pk_mul_f32 v[78:79], v[78:79], v[174:175]
    v_cvt_pk_bf16_f32 v112, v64, v65
    v_cvt_pk_bf16_f32 v113, v66, v67
    v_cvt_pk_bf16_f32 v114, v68, v69
    v_cvt_pk_bf16_f32 v115, v70, v71
    v_cvt_pk_bf16_f32 v116, v72, v73
    v_cvt_pk_bf16_f32 v117, v74, v75
    v_cvt_pk_bf16_f32 v118, v76, v77
    v_cvt_pk_bf16_f32 v119, v78, v79
    buffer_store_dwordx4 v[112:115], v244, s[44:47], s9 offen sc1
    buffer_store_dwordx4 v[116:119], v245, s[44:47], s9 offen sc1
    s_waitcnt vmcnt(6)
    s_barrier
    ds_read_b64_tr_b16 a[64:65], v10 offset:49152
    s_add_u32 m0, s73, 32768
    s_lshl_b32 s14, s94, 18
    ds_read_b64_tr_b16 a[66:67], v10 offset:51200
    ds_read_b64_tr_b16 a[72:73], v10 offset:53248
    ds_read_b64_tr_b16 a[74:75], v10 offset:55296
    ds_read_b64_tr_b16 a[68:69], v11 offset:49152
    buffer_load_dwordx4 v4, s[52:55], s14 offen offset:0 lds
    ds_read_b64_tr_b16 a[70:71], v11 offset:51200
    ds_read_b64_tr_b16 a[76:77], v11 offset:53248
    ds_read_b64_tr_b16 a[78:79], v11 offset:55296
    v_add_u32 v10, 65536, v10
    ds_read_b64_tr_b16 a[80:81], v10 offset:0
    ds_read_b64_tr_b16 a[82:83], v10 offset:2048
    buffer_load_dwordx4 v5, s[52:55], s14 offen offset:1024 lds
    ds_read_b64_tr_b16 a[88:89], v10 offset:4096
    ds_read_b64_tr_b16 a[90:91], v10 offset:6144
    v_add_u32 v11, 65536, v11
    ds_read_b64_tr_b16 a[84:85], v11 offset:0
    ds_read_b64_tr_b16 a[86:87], v11 offset:2048
    ds_read_b64_tr_b16 a[92:93], v11 offset:4096
    buffer_load_dwordx4 v6, s[52:55], s14 offen offset:2048 lds
    ds_read_b64_tr_b16 a[94:95], v11 offset:6144
    v_add_u32 v10, -65536, v10
    ds_read_b64_tr_b16 a[96:97], v10 offset:0
    ds_read_b64_tr_b16 a[98:99], v10 offset:2048
    ds_read_b64_tr_b16 a[104:105], v10 offset:4096
    ds_read_b64_tr_b16 a[106:107], v10 offset:6144
    buffer_load_dwordx4 v7, s[52:55], s14 offen offset:3072 lds
    v_add_u32 v11, -65536, v11
    ds_read_b64_tr_b16 a[100:101], v11 offset:0
    ds_read_b64_tr_b16 a[102:103], v11 offset:2048
    ds_read_b64_tr_b16 a[108:109], v11 offset:4096
    ds_read_b64_tr_b16 a[110:111], v11 offset:6144
    ds_read_b64_tr_b16 a[112:113], v10 offset:16384
    s_add_u32 m0, s73, 81920
    s_lshl_b32 s14, s95, 18
    ds_read_b64_tr_b16 a[114:115], v10 offset:18432
    ds_read_b64_tr_b16 a[120:121], v10 offset:20480
    ds_read_b64_tr_b16 a[122:123], v10 offset:22528
    ds_read_b64_tr_b16 a[116:117], v11 offset:16384
    buffer_load_dwordx4 v4, s[52:55], s14 offen offset:0 lds
    ds_read_b64_tr_b16 a[118:119], v11 offset:18432
    ds_read_b64_tr_b16 a[124:125], v11 offset:20480
    ds_read_b64_tr_b16 a[126:127], v11 offset:22528
    v_add_u32 v10, 131072, v10
    ds_read_b64_tr_b16 a[128:129], v10 offset:0
    ds_read_b64_tr_b16 a[130:131], v10 offset:2048
    buffer_load_dwordx4 v5, s[52:55], s14 offen offset:1024 lds
    ds_read_b64_tr_b16 a[136:137], v10 offset:4096
    ds_read_b64_tr_b16 a[138:139], v10 offset:6144
    v_add_u32 v11, 131072, v11
    ds_read_b64_tr_b16 a[132:133], v11 offset:0
    ds_read_b64_tr_b16 a[134:135], v11 offset:2048
    ds_read_b64_tr_b16 a[140:141], v11 offset:4096
    buffer_load_dwordx4 v6, s[52:55], s14 offen offset:2048 lds
    ds_read_b64_tr_b16 a[142:143], v11 offset:6144
    ds_read_b64_tr_b16 a[144:145], v10 offset:16384
    ds_read_b64_tr_b16 a[146:147], v10 offset:18432
    ds_read_b64_tr_b16 a[152:153], v10 offset:20480
    ds_read_b64_tr_b16 a[154:155], v10 offset:22528
    buffer_load_dwordx4 v7, s[52:55], s14 offen offset:3072 lds
    ds_read_b64_tr_b16 a[148:149], v11 offset:16384
    ds_read_b64_tr_b16 a[150:151], v11 offset:18432
    ds_read_b64_tr_b16 a[156:157], v11 offset:20480
    ds_read_b64_tr_b16 a[158:159], v11 offset:22528
    s_bitcmp1_b32 s3, 1
    s_cselect_b32 s18, s85, s84
    s_mul_i32 s18, s18, 139264
    s_cselect_b32 s19, s87, s86
    s_mul_i32 s19, s19, 139264
    s_cselect_b32 s20, s89, s88
    s_mul_i32 s20, s20, 139264
    s_cselect_b32 s21, s91, s90
    s_mul_i32 s21, s21, 139264
    s_cselect_b32 s22, s93, s92
    s_mul_i32 s22, s22, 139264
    s_cselect_b32 s23, s95, s94
    s_mul_i32 s23, s23, 139264
    s_cselect_b32 s24, s97, s96
    s_mul_i32 s24, s24, 139264
    s_cselect_b32 s25, s99, s98
    s_mul_i32 s25, s25, 139264
    s_cselect_b32 s26, s101, s100
    s_mul_i32 s26, s26, 139264
    s_waitcnt vmcnt(8) lgkmcnt(0)
    s_barrier
    buffer_store_dword v249, v17, s[44:47], 0 offen sc1
    s_add_u32 m0, s73, 0
    s_lshl_b32 s14, s96, 18
    buffer_load_dwordx4 v4, s[52:55], s14 offen offset:0 lds
    buffer_load_dwordx4 v5, s[52:55], s14 offen offset:1024 lds
    buffer_load_dwordx4 v6, s[52:55], s14 offen offset:2048 lds
    buffer_load_dwordx4 v7, s[52:55], s14 offen offset:3072 lds
    s_add_u32 m0, s73, 16384
    s_lshl_b32 s14, s97, 18
    buffer_load_dwordx4 v4, s[52:55], s14 offen offset:0 lds
    buffer_load_dwordx4 v5, s[52:55], s14 offen offset:1024 lds
    buffer_load_dwordx4 v6, s[52:55], s14 offen offset:2048 lds
    buffer_load_dwordx4 v7, s[52:55], s14 offen offset:3072 lds
    v_mov_b32 v16, 0
    buffer_atomic_add v16, v15, s[44:47], 0 offen sc0 sc1
    s_add_u32 m0, s73, 49152
    s_lshl_b32 s14, s98, 18
    buffer_load_dwordx4 v4, s[52:55], s14 offen offset:0 lds
    buffer_load_dwordx4 v5, s[52:55], s14 offen offset:1024 lds
    buffer_load_dwordx4 v6, s[52:55], s14 offen offset:2048 lds
    buffer_load_dwordx4 v7, s[52:55], s14 offen offset:3072 lds
    s_add_u32 m0, s73, 65536
    s_lshl_b32 s14, s99, 18
    buffer_load_dwordx4 v4, s[52:55], s14 offen offset:0 lds
    buffer_load_dwordx4 v5, s[52:55], s14 offen offset:1024 lds
    buffer_load_dwordx4 v6, s[52:55], s14 offen offset:2048 lds
    buffer_load_dwordx4 v7, s[52:55], s14 offen offset:3072 lds
L_DG:
    s_waitcnt vmcnt(8)
    v_cmp_ne_u32 vcc, v13, v16
    s_cbranch_vccnz L_rs_p2G
L_ok_p2G:
    s_barrier
    s_add_u32 m0, s73, 97536
    s_nop 0
    buffer_load_dwordx4 v23, s[44:47], s18 offen offset:768 sc1 lds
    s_add_u32 m0, s73, 99328
    s_nop 0
    buffer_load_dwordx4 v20, s[44:47], s18 offen offset:0 sc1 lds
    s_add_u32 m0, s73, 99840
    s_nop 0
    buffer_load_dwordx4 v20, s[44:47], s18 offen offset:512 sc1 lds
    s_add_u32 m0, s73, 100608
    s_nop 0
    buffer_load_dwordx4 v23, s[44:47], s19 offen offset:768 sc1 lds
    s_add_u32 m0, s73, 114688
    s_nop 0
    buffer_load_dwordx4 v20, s[44:47], s19 offen offset:0 sc1 lds
    s_add_u32 m0, s73, 115200
    s_nop 0
    buffer_load_dwordx4 v20, s[44:47], s19 offen offset:512 sc1 lds
    s_add_u32 m0, s73, 115968
    s_nop 0
    buffer_load_dwordx4 v23, s[44:47], s20 offen offset:768 sc1 lds
    s_add_u32 m0, s73, 117760
    s_nop 0
    buffer_load_dwordx4 v20, s[44:47], s20 offen offset:0 sc1 lds
    v_mov_b32 v195, s68
    v_mov_b32 v199, s68
    v_mov_b32 v202, s68
    v_mov_b32 v203, s68
    s_waitcnt vmcnt(4)
    s_barrier
    ds_read_b128 v[104:107], v14 offset:0
    ds_read_b128 v[108:111], v14 offset:4096
    ds_read_b128 v[112:115], v14 offset:8192
    ds_read_b128 v[116:119], v14 offset:12288
    s_waitcnt lgkmcnt(2)
    v_mfma_f32_16x16x32_bf16 v[32:35], v[104:107], a[0:3], 0
    s_add_u32 m0, s73, 130560
    v_mfma_f32_16x16x32_bf16 v[32:35], v[108:111], a[8:11], v[32:35]
    buffer_load_dwordx4 v20, s[44:47], s20 offen offset:512 sc1 lds
    s_waitcnt lgkmcnt(0)
    v_mfma_f32_16x16x32_bf16 v[32:35], v[112:115], a[16:19], v[32:35]
    ds_read_b128 v[120:123], v14 offset:1024
    v_mfma_f32_16x16x32_bf16 v[32:35], v[116:119], a[24:27], v[32:35]
    ds_read_b128 v[124:127], v14 offset:5120
    v_mfma_f32_16x16x32_bf16 v[36:39], v[116:119], a[28:31], 0
    ds_read_b128 v[128:131], v14 offset:9216
    v_mfma_f32_16x16x32_bf16 v[36:39], v[112:115], a[20:23], v[36:39]
    ds_read_b128 v[132:135], v14 offset:13312
    v_mfma_f32_16x16x32_bf16 v[36:39], v[108:111], a[12:15], v[36:39]
    s_add_u32 m0, s73, 131328
    v_mfma_f32_16x16x32_bf16 v[36:39], v[104:107], a[4:7], v[36:39]
    buffer_load_dwordx4 v23, s[44:47], s21 offen offset:768 sc1 lds
    s_waitcnt lgkmcnt(2)
    v_mfma_f32_16x16x32_bf16 v[44:47], v[120:123], a[4:7], 0
    s_add_u32 m0, s73, 133120
    v_mfma_f32_16x16x32_bf16 v[44:47], v[124:127], a[12:15], v[44:47]
    buffer_load_dwordx4 v20, s[44:47], s21 offen offset:0 sc1 lds
    s_waitcnt lgkmcnt(0)
    v_mfma_f32_16x16x32_bf16 v[44:47], v[128:131], a[20:23], v[44:47]
    ds_read_b128 v[104:107], v14 offset:2048
    v_mfma_f32_16x16x32_bf16 v[44:47], v[132:135], a[28:31], v[44:47]
    ds_read_b128 v[108:111], v14 offset:6144
    v_mfma_f32_16x16x32_bf16 v[40:43], v[132:135], a[24:27], 0
    ds_read_b128 v[112:115], v14 offset:10240
    v_mfma_f32_16x16x32_bf16 v[40:43], v[128:131], a[16:19], v[40:43]
    ds_read_b128 v[116:119], v14 offset:14336
    v_mfma_f32_16x16x32_bf16 v[40:43], v[124:127], a[8:11], v[40:43]
    s_add_u32 m0, s73, 133632
    v_mfma_f32_16x16x32_bf16 v[40:43], v[120:123], a[0:3], v[40:43]
    buffer_load_dwordx4 v20, s[44:47], s21 offen offset:512 sc1 lds
    s_waitcnt lgkmcnt(2)
    v_mfma_f32_16x16x32_bf16 v[48:51], v[104:107], a[0:3], 0
    s_add_u32 m0, s73, 146688
    v_mfma_f32_16x16x32_bf16 v[48:51], v[108:111], a[8:11], v[48:51]
    buffer_load_dwordx4 v23, s[44:47], s22 offen offset:768 sc1 lds
    s_waitcnt lgkmcnt(0)
    v_mfma_f32_16x16x32_bf16 v[48:51], v[112:115], a[16:19], v[48:51]
    ds_read_b128 v[120:123], v14 offset:3072
    v_mfma_f32_16x16x32_bf16 v[48:51], v[116:119], a[24:27], v[48:51]
    ds_read_b128 v[124:127], v14 offset:7168
    v_mfma_f32_16x16x32_bf16 v[52:55], v[116:119], a[28:31], 0
    ds_read_b128 v[128:131], v14 offset:11264
    v_mfma_f32_16x16x32_bf16 v[52:55], v[112:115], a[20:23], v[52:55]
    ds_read_b128 v[132:135], v14 offset:15360
    v_mfma_f32_16x16x32_bf16 v[52:55], v[108:111], a[12:15], v[52:55]
    s_add_u32 m0, s73, 148480
    v_mfma_f32_16x16x32_bf16 v[52:55], v[104:107], a[4:7], v[52:55]
    buffer_load_dwordx4 v20, s[44:47], s22 offen offset:0 sc1 lds
    s_waitcnt lgkmcnt(2)
    v_mfma_f32_16x16x32_bf16 v[36:39], v[120:123], a[36:39], v[36:39]
    s_add_u32 m0, s73, 148992
    v_mfma_f32_16x16x32_bf16 v[36:39], v[124:127], a[44:47], v[36:39]
    buffer_load_dwordx4 v20, s[44:47], s22 offen offset:512 sc1 lds
    s_waitcnt lgkmcnt(0)
    v_mfma_f32_16x16x32_bf16 v[36:39], v[128:131], a[52:55], v[36:39]
    s_waitcnt vmcnt(7)
    s_barrier
    v_mfma_f32_16x16x32_bf16 v[36:39], v[132:135], a[60:63], v[36:39]
    ds_read_b128 v[104:107], v14 offset:16384
    v_add_u32 v10, -131072, v10
    v_mfma_f32_16x16x32_bf16 v[32:35], v[132:135], a[56:59], v[32:35]
    ds_read_b128 v[108:111], v14 offset:20480
    v_mfma_f32_16x16x32_bf16 v[32:35], v[128:131], a[48:51], v[32:35]
    ds_read_b128 v[112:115], v14 offset:24576
    ds_read_b64_tr_b16 a[160:161], v10 offset:32768
    v_mfma_f32_16x16x32_bf16 v[32:35], v[124:127], a[40:43], v[32:35]
    ds_read_b128 v[116:119], v14 offset:28672
    s_add_u32 m0, s73, 149760
    v_mfma_f32_16x16x32_bf16 v[32:35], v[120:123], a[32:35], v[32:35]
    buffer_load_dwordx4 v23, s[44:47], s23 offen offset:768 sc1 lds
    ds_read_b64_tr_b16 a[162:163], v10 offset:34816
    s_waitcnt lgkmcnt(4)
    v_mfma_f32_16x16x32_bf16 v[40:43], v[104:107], a[32:35], v[40:43]
    s_add_u32 m0, s73, 98304
    ds_read_b64_tr_b16 a[168:169], v10 offset:36864
    v_mfma_f32_16x16x32_bf16 v[40:43], v[108:111], a[40:43], v[40:43]
    buffer_load_dwordx4 v20, s[44:47], s23 offen offset:0 sc1 lds
    ds_read_b64_tr_b16 a[170:171], v10 offset:38912
    s_waitcnt lgkmcnt(3)
    v_mfma_f32_16x16x32_bf16 v[40:43], v[112:115], a[48:51], v[40:43]
    ds_read_b128 v[120:123], v14 offset:17408
    v_mfma_f32_16x16x32_bf16 v[40:43], v[116:119], a[56:59], v[40:43]
    ds_read_b128 v[124:127], v14 offset:21504
    v_add_u32 v11, -131072, v11
    v_mfma_f32_16x16x32_bf16 v[44:47], v[116:119], a[60:63], v[44:47]
    ds_read_b128 v[128:131], v14 offset:25600
    v_mfma_f32_16x16x32_bf16 v[44:47], v[112:115], a[52:55], v[44:47]
    ds_read_b128 v[132:135], v14 offset:29696
    v_mfma_f32_16x16x32_bf16 v[44:47], v[108:111], a[44:47], v[44:47]
    s_add_u32 m0, s73, 98816
    ds_read_b64_tr_b16 a[164:165], v11 offset:32768
    v_mfma_f32_16x16x32_bf16 v[44:47], v[104:107], a[36:39], v[44:47]
    buffer_load_dwordx4 v20, s[44:47], s23 offen offset:512 sc1 lds
    ds_read_b64_tr_b16 a[166:167], v11 offset:34816
    s_waitcnt lgkmcnt(4)
    v_mfma_f32_16x16x32_bf16 v[52:55], v[120:123], a[36:39], v[52:55]
    s_add_u32 m0, s73, 99584
    ds_read_b64_tr_b16 a[172:173], v11 offset:36864
    v_mfma_f32_16x16x32_bf16 v[52:55], v[124:127], a[44:47], v[52:55]
    buffer_load_dwordx4 v23, s[44:47], s24 offen offset:768 sc1 lds
    ds_read_b64_tr_b16 a[174:175], v11 offset:38912
    s_waitcnt lgkmcnt(4)
    v_mfma_f32_16x16x32_bf16 v[52:55], v[128:131], a[52:55], v[52:55]
    ds_read_b128 v[104:107], v14 offset:18432
    v_mfma_f32_16x16x32_bf16 v[52:55], v[132:135], a[60:63], v[52:55]
    ds_read_b128 v[108:111], v14 offset:22528
    v_add_u32 v10, 65536, v10
    v_mfma_f32_16x16x32_bf16 v[48:51], v[132:135], a[56:59], v[48:51]
    ds_read_b128 v[112:115], v14 offset:26624
    v_mfma_f32_16x16x32_bf16 v[48:51], v[128:131], a[48:51], v[48:51]
    ds_read_b128 v[116:119], v14 offset:30720
    v_mfma_f32_16x16x32_bf16 v[48:51], v[124:127], a[40:43], v[48:51]
    s_add_u32 m0, s73, 101376
    ds_read_b64_tr_b16 a[176:177], v10 offset:16384
    v_mfma_f32_16x16x32_bf16 v[48:51], v[120:123], a[32:35], v[48:51]
    buffer_load_dwordx4 v20, s[44:47], s24 offen offset:0 sc1 lds
    ds_read_b64_tr_b16 a[178:179], v10 offset:18432
    s_waitcnt lgkmcnt(4)
    v_mfma_f32_16x16x32_bf16 v[32:35], v[104:107], a[64:67], v[32:35]
    ds_read_b64_tr_b16 a[184:185], v10 offset:20480
    v_mfma_f32_16x16x32_bf16 v[32:35], v[108:111], a[72:75], v[32:35]
    ds_read_b64_tr_b16 a[186:187], v10 offset:22528
    s_waitcnt lgkmcnt(4)
    v_mfma_f32_16x16x32_bf16 v[32:35], v[112:115], a[80:83], v[32:35]
    ds_read_b128 v[120:123], v14 offset:19456
    v_mfma_f32_16x16x32_bf16 v[32:35], v[116:119], a[88:91], v[32:35]
    ds_read_b128 v[124:127], v14 offset:23552
    v_add_u32 v11, 65536, v11
    v_mfma_f32_16x16x32_bf16 v[36:39], v[116:119], a[92:95], v[36:39]
    ds_read_b128 v[128:131], v14 offset:27648
    v_mfma_f32_16x16x32_bf16 v[36:39], v[112:115], a[84:87], v[36:39]
    ds_read_b128 v[132:135], v14 offset:31744
    v_mfma_f32_16x16x32_bf16 v[36:39], v[108:111], a[76:79], v[36:39]
    ds_read_b64_tr_b16 a[180:181], v11 offset:16384
    v_mfma_f32_16x16x32_bf16 v[36:39], v[104:107], a[68:71], v[36:39]
    ds_read_b64_tr_b16 a[182:183], v11 offset:18432
    s_waitcnt lgkmcnt(4)
    v_mfma_f32_16x16x32_bf16 v[44:47], v[120:123], a[68:71], v[44:47]
    ds_read_b64_tr_b16 a[188:189], v11 offset:20480
    v_mfma_f32_16x16x32_bf16 v[44:47], v[124:127], a[76:79], v[44:47]
    ds_read_b64_tr_b16 a[190:191], v11 offset:22528
    s_waitcnt lgkmcnt(4)
    v_mfma_f32_16x16x32_bf16 v[44:47], v[128:131], a[84:87], v[44:47]
    s_waitcnt vmcnt(8) lgkmcnt(0)
    s_barrier
    v_mfma_f32_16x16x32_bf16 v[44:47], v[132:135], a[92:95], v[44:47]
    ds_read_b128 v[104:107], v14 offset:32768
    s_lshl_b32 s14, s100, 18
    s_add_u32 m0, s73, 32768
    v_add_u32 v10, -65536, v10
    v_mfma_f32_16x16x32_bf16 v[40:43], v[132:135], a[88:91], v[40:43]
    ds_read_b128 v[108:111], v14 offset:36864
    buffer_load_dwordx4 v4, s[52:55], s14 offen offset:0 lds
    v_mfma_f32_16x16x32_bf16 v[40:43], v[128:131], a[80:83], v[40:43]
    ds_read_b128 v[112:115], v14 offset:40960
    ds_read_b64_tr_b16 a[192:193], v10 offset:0
    v_mfma_f32_16x16x32_bf16 v[40:43], v[124:127], a[72:75], v[40:43]
    ds_read_b128 v[116:119], v14 offset:45056
    v_mfma_f32_16x16x32_bf16 v[40:43], v[120:123], a[64:67], v[40:43]
    ds_read_b64_tr_b16 a[194:195], v10 offset:2048
    s_waitcnt lgkmcnt(4)
    v_mfma_f32_16x16x32_bf16 v[48:51], v[104:107], a[64:67], v[48:51]
    s_add_u32 m0, s73, 114176
    ds_read_b64_tr_b16 a[200:201], v10 offset:4096
    v_mfma_f32_16x16x32_bf16 v[48:51], v[108:111], a[72:75], v[48:51]
    buffer_load_dwordx4 v20, s[44:47], s24 offen offset:512 sc1 lds
    ds_read_b64_tr_b16 a[202:203], v10 offset:6144
    s_waitcnt lgkmcnt(3)
    v_mfma_f32_16x16x32_bf16 v[48:51], v[112:115], a[80:83], v[48:51]
    ds_read_b128 v[120:123], v14 offset:33792
    s_add_u32 m0, s73, 32768
    v_lshrrev_b32 v30, 2, v26
    v_mfma_f32_16x16x32_bf16 v[48:51], v[116:119], a[88:91], v[48:51]
    ds_read_b128 v[124:127], v14 offset:37888
    buffer_load_dwordx4 v5, s[52:55], s14 offen offset:1024 lds
    v_mfma_f32_16x16x32_bf16 v[52:55], v[116:119], a[92:95], v[52:55]
    ds_read_b128 v[128:131], v14 offset:41984
    v_add_u32 v11, -65536, v11
    v_mfma_f32_16x16x32_bf16 v[52:55], v[112:115], a[84:87], v[52:55]
    ds_read_b128 v[132:135], v14 offset:46080
L_pl_G_6:
    s_cbranch_execz L_wret
    v_mfma_f32_16x16x32_bf16 v[52:55], v[108:111], a[76:79], v[52:55]
    s_add_u32 m0, s73, 114944
    ds_read_b64_tr_b16 a[196:197], v11 offset:0
    v_mfma_f32_16x16x32_bf16 v[52:55], v[104:107], a[68:71], v[52:55]
    buffer_load_dwordx4 v23, s[44:47], s25 offen offset:768 sc1 lds
    ds_read_b64_tr_b16 a[198:199], v11 offset:2048
    s_waitcnt lgkmcnt(4)
    v_mfma_f32_16x16x32_bf16 v[36:39], v[120:123], a[100:103], v[36:39]
    s_add_u32 m0, s73, 116736
    ds_read_b64_tr_b16 a[204:205], v11 offset:4096
    v_mfma_f32_16x16x32_bf16 v[36:39], v[124:127], a[108:111], v[36:39]
    buffer_load_dwordx4 v20, s[44:47], s25 offen offset:0 sc1 lds
    ds_read_b64_tr_b16 a[206:207], v11 offset:6144
    s_waitcnt lgkmcnt(4)
    v_mfma_f32_16x16x32_bf16 v[36:39], v[128:131], a[116:119], v[36:39]
    ds_read_b128 v[104:107], v14 offset:34816
    s_add_u32 m0, s73, 32768
    v_lshrrev_b32 v31, 2, v18
    v_mfma_f32_16x16x32_bf16 v[36:39], v[132:135], a[124:127], v[36:39]
    ds_read_b128 v[108:111], v14 offset:38912
    buffer_load_dwordx4 v6, s[52:55], s14 offen offset:2048 lds
    v_mfma_f32_16x16x32_bf16 v[32:35], v[132:135], a[120:123], v[32:35]
    ds_read_b128 v[112:115], v14 offset:43008
    v_mfma_f32_16x16x32_bf16 v[32:35], v[128:131], a[112:115], v[32:35]
    ds_read_b128 v[116:119], v14 offset:47104
    v_mfma_f32_16x16x32_bf16 v[32:35], v[124:127], a[104:107], v[32:35]
    s_add_u32 m0, s73, 117248
    ds_read_b64_tr_b16 a[208:209], v10 offset:16384
    v_mfma_f32_16x16x32_bf16 v[32:35], v[120:123], a[96:99], v[32:35]
    buffer_load_dwordx4 v20, s[44:47], s25 offen offset:512 sc1 lds
    ds_read_b64_tr_b16 a[210:211], v10 offset:18432
    s_waitcnt lgkmcnt(4)
    v_mfma_f32_16x16x32_bf16 v[40:43], v[104:107], a[96:99], v[40:43]
    ds_read_b64_tr_b16 a[216:217], v10 offset:20480
    buffer_load_ushort v102, v30, s[60:63], 0 offen offset:0
    s_add_u32 m0, s73, 32768
    v_mfma_f32_16x16x32_bf16 v[40:43], v[108:111], a[104:107], v[40:43]
    ds_read_b64_tr_b16 a[218:219], v10 offset:22528
    buffer_load_dwordx4 v7, s[52:55], s14 offen offset:3072 lds
    s_waitcnt lgkmcnt(4)
    v_mfma_f32_16x16x32_bf16 v[40:43], v[112:115], a[112:115], v[40:43]
    ds_read_b128 v[120:123], v14 offset:35840
    v_mfma_f32_16x16x32_bf16 v[40:43], v[116:119], a[120:123], v[40:43]
    ds_read_b128 v[124:127], v14 offset:39936
    v_mfma_f32_16x16x32_bf16 v[44:47], v[116:119], a[124:127], v[44:47]
    ds_read_b128 v[128:131], v14 offset:44032
    v_mfma_f32_16x16x32_bf16 v[44:47], v[112:115], a[116:119], v[44:47]
    ds_read_b128 v[132:135], v14 offset:48128
    v_mfma_f32_16x16x32_bf16 v[44:47], v[108:111], a[108:111], v[44:47]
    ds_read_b64_tr_b16 a[212:213], v11 offset:16384
    buffer_load_ushort v103, v30, s[60:63], 0 offen offset:32
    v_mfma_f32_16x16x32_bf16 v[44:47], v[104:107], a[100:103], v[44:47]
    ds_read_b64_tr_b16 a[214:215], v11 offset:18432
    s_waitcnt lgkmcnt(4)
    v_mfma_f32_16x16x32_bf16 v[52:55], v[120:123], a[100:103], v[52:55]
    ds_read_b64_tr_b16 a[220:221], v11 offset:20480
    v_mfma_f32_16x16x32_bf16 v[52:55], v[124:127], a[108:111], v[52:55]
    ds_read_b64_tr_b16 a[222:223], v11 offset:22528
    s_waitcnt lgkmcnt(4)
    v_mfma_f32_16x16x32_bf16 v[52:55], v[128:131], a[116:119], v[52:55]
    s_waitcnt vmcnt(14) lgkmcnt(0)
    s_barrier
    v_mfma_f32_16x16x32_bf16 v[52:55], v[132:135], a[124:127], v[52:55]
    ds_read_b128 v[104:107], v14 offset:49152
    s_lshl_b32 s14, s101, 18
    ds_read_b64_tr_b16 a[224:225], v10 offset:49152
    s_add_u32 m0, s73, 81920
    v_mfma_f32_16x16x32_bf16 v[48:51], v[132:135], a[120:123], v[48:51]
    ds_read_b128 v[108:111], v14 offset:53248
    buffer_load_dwordx4 v4, s[52:55], s14 offen offset:0 lds
    v_mfma_f32_16x16x32_bf16 v[48:51], v[128:131], a[112:115], v[48:51]
    ds_read_b128 v[112:115], v14 offset:57344
    buffer_load_ushort v27, v31, s[60:63], 0 offen offset:0
    v_mfma_f32_16x16x32_bf16 v[48:51], v[124:127], a[104:107], v[48:51]
    ds_read_b128 v[116:119], v14 offset:61440
    v_mfma_f32_16x16x32_bf16 v[48:51], v[120:123], a[96:99], v[48:51]
    ds_read_b64_tr_b16 a[226:227], v10 offset:51200
    s_waitcnt lgkmcnt(3)
    v_mfma_f32_16x16x32_bf16 v[32:35], v[104:107], a[128:131], v[32:35]
    s_add_u32 m0, s73, 130304
    ds_read_b64_tr_b16 a[232:233], v10 offset:53248
    v_mfma_f32_16x16x32_bf16 v[32:35], v[108:111], a[136:139], v[32:35]
    buffer_load_dwordx4 v23, s[44:47], s26 offen offset:768 sc1 lds
    ds_read_b64_tr_b16 a[234:235], v10 offset:55296
    s_waitcnt lgkmcnt(3)
    v_mfma_f32_16x16x32_bf16 v[32:35], v[112:115], a[144:147], v[32:35]
    ds_read_b128 v[120:123], v14 offset:50176
    s_add_u32 m0, s73, 81920
    v_mfma_f32_16x16x32_bf16 v[32:35], v[116:119], a[152:155], v[32:35]
    ds_read_b128 v[124:127], v14 offset:54272
    buffer_load_dwordx4 v5, s[52:55], s14 offen offset:1024 lds
    v_mfma_f32_16x16x32_bf16 v[36:39], v[116:119], a[156:159], v[36:39]
    ds_read_b128 v[128:131], v14 offset:58368
    v_mfma_f32_16x16x32_bf16 v[36:39], v[112:115], a[148:151], v[36:39]
    ds_read_b128 v[132:135], v14 offset:62464
    v_mfma_f32_16x16x32_bf16 v[36:39], v[108:111], a[140:143], v[36:39]
    s_add_u32 m0, s73, 132096
    ds_read_b64_tr_b16 a[228:229], v11 offset:49152
    v_mfma_f32_16x16x32_bf16 v[36:39], v[104:107], a[132:135], v[36:39]
    buffer_load_dwordx4 v20, s[44:47], s26 offen offset:0 sc1 lds
    ds_read_b64_tr_b16 a[230:231], v11 offset:51200
    s_waitcnt lgkmcnt(4)
    v_mfma_f32_16x16x32_bf16 v[44:47], v[120:123], a[132:135], v[44:47]
    s_add_u32 m0, s73, 132608
    ds_read_b64_tr_b16 a[236:237], v11 offset:53248
    v_mfma_f32_16x16x32_bf16 v[44:47], v[124:127], a[140:143], v[44:47]
    buffer_load_dwordx4 v20, s[44:47], s26 offen offset:512 sc1 lds
    ds_read_b64_tr_b16 a[238:239], v11 offset:55296
    s_waitcnt lgkmcnt(4)
    v_mfma_f32_16x16x32_bf16 v[44:47], v[128:131], a[148:151], v[44:47]
    ds_read_b128 v[104:107], v14 offset:51200
    s_add_u32 m0, s73, 81920
    v_add_u32 v10, 65536, v10
    v_mfma_f32_16x16x32_bf16 v[44:47], v[132:135], a[156:159], v[44:47]
    ds_read_b128 v[108:111], v14 offset:55296
    buffer_load_dwordx4 v6, s[52:55], s14 offen offset:2048 lds
    v_mfma_f32_16x16x32_bf16 v[40:43], v[132:135], a[152:155], v[40:43]
    ds_read_b128 v[112:115], v14 offset:59392
    v_mfma_f32_16x16x32_bf16 v[40:43], v[128:131], a[144:147], v[40:43]
    ds_read_b128 v[116:119], v14 offset:63488
    v_mfma_f32_16x16x32_bf16 v[40:43], v[124:127], a[136:139], v[40:43]
    s_add_u32 m0, s73, 134144
    ds_read_b64_tr_b16 a[240:241], v10 offset:0
    v_mfma_f32_16x16x32_bf16 v[40:43], v[120:123], a[128:131], v[40:43]
    buffer_load_dwordx4 v21, s[44:47], s18 offen offset:0 sc1 lds
    ds_read_b64_tr_b16 a[242:243], v10 offset:2048
    s_waitcnt lgkmcnt(4)
    v_mfma_f32_16x16x32_bf16 v[48:51], v[104:107], a[128:131], v[48:51]
    ds_read_b64_tr_b16 a[248:249], v10 offset:4096
    s_add_u32 m0, s73, 81920
    v_mfma_f32_16x16x32_bf16 v[48:51], v[108:111], a[136:139], v[48:51]
    ds_read_b64_tr_b16 a[250:251], v10 offset:6144
    buffer_load_dwordx4 v7, s[52:55], s14 offen offset:3072 lds
    s_waitcnt lgkmcnt(4)
    v_mfma_f32_16x16x32_bf16 v[48:51], v[112:115], a[144:147], v[48:51]
    ds_read_b128 v[120:123], v14 offset:52224
    v_add_u32 v11, 65536, v11
    v_mfma_f32_16x16x32_bf16 v[48:51], v[116:119], a[152:155], v[48:51]
    ds_read_b128 v[124:127], v14 offset:56320
    v_mfma_f32_16x16x32_bf16 v[52:55], v[116:119], a[156:159], v[52:55]
    ds_read_b128 v[128:131], v14 offset:60416
    v_mfma_f32_16x16x32_bf16 v[52:55], v[112:115], a[148:151], v[52:55]
    ds_read_b128 v[132:135], v14 offset:64512
    v_mfma_f32_16x16x32_bf16 v[52:55], v[108:111], a[140:143], v[52:55]
    ds_read_b64_tr_b16 a[244:245], v11 offset:0
    v_mfma_f32_16x16x32_bf16 v[52:55], v[104:107], a[132:135], v[52:55]
    ds_read_b64_tr_b16 a[246:247], v11 offset:2048
    s_waitcnt lgkmcnt(4)
    v_mfma_f32_16x16x32_bf16 v[36:39], v[120:123], a[164:167], v[36:39]
    ds_read_b64_tr_b16 a[252:253], v11 offset:4096
    v_mfma_f32_16x16x32_bf16 v[36:39], v[124:127], a[172:175], v[36:39]
    ds_read_b64_tr_b16 a[254:255], v11 offset:6144
    s_waitcnt lgkmcnt(4)
    v_mfma_f32_16x16x32_bf16 v[36:39], v[128:131], a[180:183], v[36:39]
    s_waitcnt vmcnt(10) lgkmcnt(0)
    s_barrier
    v_mfma_f32_16x16x32_bf16 v[36:39], v[132:135], a[188:191], v[36:39]
    ds_read_b128 v[104:107], v14 offset:0
    v_mfma_f32_16x16x32_bf16 v[32:35], v[132:135], a[184:187], v[32:35]
    ds_read_b128 v[108:111], v14 offset:4096
    v_add_u32 v10, -65536, v10
    v_mfma_f32_16x16x32_bf16 v[32:35], v[128:131], a[176:179], v[32:35]
    ds_read_b128 v[112:115], v14 offset:8192
    v_mfma_f32_16x16x32_bf16 v[32:35], v[124:127], a[168:171], v[32:35]
    ds_read_b128 v[116:119], v14 offset:12288
    v_mfma_f32_16x16x32_bf16 v[32:35], v[120:123], a[160:163], v[32:35]
    ds_read_b64_tr_b16 v[220:221], v10 offset:32768
    s_waitcnt lgkmcnt(3)
    v_mfma_f32_16x16x32_bf16 v[40:43], v[104:107], a[160:163], v[40:43]
    s_add_u32 m0, s73, 146944
    v_mfma_f32_16x16x32_bf16 v[40:43], v[108:111], a[168:171], v[40:43]
    buffer_load_dwordx4 v21, s[44:47], s18 offen offset:512 sc1 lds
    ds_read_b64_tr_b16 v[222:223], v10 offset:34816
    s_waitcnt lgkmcnt(2)
    v_mfma_f32_16x16x32_bf16 v[40:43], v[112:115], a[176:179], v[40:43]
    ds_read_b128 v[120:123], v14 offset:1024
    v_mfma_f32_16x16x32_bf16 v[40:43], v[116:119], a[184:187], v[40:43]
    ds_read_b128 v[124:127], v14 offset:5120
    v_mfma_f32_16x16x32_bf16 v[44:47], v[116:119], a[188:191], v[44:47]
    ds_read_b128 v[128:131], v14 offset:9216
    v_mfma_f32_16x16x32_bf16 v[44:47], v[112:115], a[180:183], v[44:47]
    ds_read_b128 v[132:135], v14 offset:13312
    buffer_load_dwordx4 v[88:91], v252, s[56:59], 0 offen
    v_mfma_f32_16x16x32_bf16 v[44:47], v[108:111], a[172:175], v[44:47]
    s_add_u32 m0, s73, 148480
    ds_read_b64_tr_b16 v[228:229], v10 offset:36864
    v_mfma_f32_16x16x32_bf16 v[44:47], v[104:107], a[164:167], v[44:47]
    buffer_load_dwordx4 v21, s[44:47], s19 offen offset:0 sc1 lds
    s_waitcnt lgkmcnt(3)
    v_mfma_f32_16x16x32_bf16 v[52:55], v[120:123], a[164:167], v[52:55]
    s_add_u32 m0, s73, 148992
    ds_read_b64_tr_b16 v[230:231], v10 offset:38912
    v_mfma_f32_16x16x32_bf16 v[52:55], v[124:127], a[172:175], v[52:55]
    buffer_load_dwordx4 v21, s[44:47], s19 offen offset:512 sc1 lds
    s_waitcnt lgkmcnt(2)
    v_mfma_f32_16x16x32_bf16 v[52:55], v[128:131], a[180:183], v[52:55]
    ds_read_b128 v[104:107], v14 offset:2048
    v_mfma_f32_16x16x32_bf16 v[52:55], v[132:135], a[188:191], v[52:55]
    ds_read_b128 v[108:111], v14 offset:6144
    v_mfma_f32_16x16x32_bf16 v[48:51], v[132:135], a[184:187], v[48:51]
    ds_read_b128 v[112:115], v14 offset:10240
    v_add_u32 v11, -65536, v11
    v_mfma_f32_16x16x32_bf16 v[48:51], v[128:131], a[176:179], v[48:51]
    ds_read_b128 v[116:119], v14 offset:14336
    v_mfma_f32_16x16x32_bf16 v[48:51], v[124:127], a[168:171], v[48:51]
    s_add_u32 m0, s73, 150528
    v_mfma_f32_16x16x32_bf16 v[48:51], v[120:123], a[160:163], v[48:51]
    buffer_load_dwordx4 v21, s[44:47], s20 offen offset:0 sc1 lds
    ds_read_b64_tr_b16 v[224:225], v11 offset:32768
    s_waitcnt lgkmcnt(3)
    v_mfma_f32_16x16x32_bf16 v[32:35], v[104:107], a[192:195], v[32:35]
    buffer_load_dwordx4 v[92:95], v252, s[56:59], s40 offen
    v_mfma_f32_16x16x32_bf16 v[32:35], v[108:111], a[200:203], v[32:35]
    ds_read_b64_tr_b16 v[226:227], v11 offset:34816
    s_waitcnt vmcnt(13)
    s_waitcnt lgkmcnt(2)
    v_mfma_f32_16x16x32_bf16 v[32:35], v[112:115], a[208:211], v[32:35]
    ds_read_b128 v[120:123], v14 offset:3072
    v_mfma_f32_16x16x32_bf16 v[32:35], v[116:119], a[216:219], v[32:35]
    ds_read_b128 v[124:127], v14 offset:7168
    v_lshlrev_b32 v72, 16, v102
    v_mfma_f32_16x16x32_bf16 v[36:39], v[116:119], a[220:223], v[36:39]
    ds_read_b128 v[128:131], v14 offset:11264
    v_mfma_f32_16x16x32_bf16 v[36:39], v[112:115], a[212:215], v[36:39]
    ds_read_b128 v[132:135], v14 offset:15360
    v_mfma_f32_16x16x32_bf16 v[36:39], v[108:111], a[204:207], v[36:39]
    ds_read_b64_tr_b16 v[232:233], v11 offset:36864
    v_lshlrev_b32 v73, 16, v102
    v_mfma_f32_16x16x32_bf16 v[36:39], v[104:107], a[196:199], v[36:39]
    s_waitcnt lgkmcnt(3)
    v_mfma_f32_16x16x32_bf16 v[44:47], v[120:123], a[196:199], v[44:47]
    ds_read_b64_tr_b16 v[234:235], v11 offset:38912
    v_mfma_f32_16x16x32_bf16 v[44:47], v[124:127], a[204:207], v[44:47]
    v_lshlrev_b32 v74, 16, v102
    s_waitcnt lgkmcnt(2)
    v_mfma_f32_16x16x32_bf16 v[44:47], v[128:131], a[212:215], v[44:47]
    buffer_load_dwordx2 v[142:143], v253, s[56:59], 0 offen
    s_waitcnt vmcnt(7) lgkmcnt(0)
    s_barrier
    v_mfma_f32_16x16x32_bf16 v[44:47], v[132:135], a[220:223], v[44:47]
    ds_read_b128 v[104:107], v14 offset:16384
    v_lshlrev_b32 v75, 16, v102
    v_mfma_f32_16x16x32_bf16 v[40:43], v[132:135], a[216:219], v[40:43]
    ds_read_b128 v[108:111], v14 offset:20480
    v_add_u32 v10, 65536, v10
    v_mfma_f32_16x16x32_bf16 v[40:43], v[128:131], a[208:211], v[40:43]
    ds_read_b128 v[112:115], v14 offset:24576
    v_mfma_f32_16x16x32_bf16 v[40:43], v[124:127], a[200:203], v[40:43]
    ds_read_b128 v[116:119], v14 offset:28672
    v_lshlrev_b32 v76, 16, v103
    v_mfma_f32_16x16x32_bf16 v[40:43], v[120:123], a[192:195], v[40:43]
    ds_read_b64_tr_b16 v[236:237], v10 offset:16384
    s_waitcnt lgkmcnt(3)
    v_mfma_f32_16x16x32_bf16 v[48:51], v[104:107], a[192:195], v[48:51]
    s_add_u32 m0, s73, 97792
    v_lshlrev_b32 v77, 16, v103
    v_mfma_f32_16x16x32_bf16 v[48:51], v[108:111], a[200:203], v[48:51]
    buffer_load_dwordx4 v21, s[44:47], s20 offen offset:512 sc1 lds
    ds_read_b64_tr_b16 v[238:239], v10 offset:18432
    s_waitcnt lgkmcnt(2)
    v_mfma_f32_16x16x32_bf16 v[48:51], v[112:115], a[208:211], v[48:51]
    ds_read_b128 v[120:123], v14 offset:17408
    v_mfma_f32_16x16x32_bf16 v[48:51], v[116:119], a[216:219], v[48:51]
    ds_read_b128 v[124:127], v14 offset:21504
    v_mfma_f32_16x16x32_bf16 v[52:55], v[116:119], a[220:223], v[52:55]
    ds_read_b128 v[128:131], v14 offset:25600
    v_lshlrev_b32 v78, 16, v103
    v_mfma_f32_16x16x32_bf16 v[52:55], v[112:115], a[212:215], v[52:55]
    ds_read_b128 v[132:135], v14 offset:29696
    buffer_load_dwordx2 v[96:97], v26, s[44:47], s42 offen offset:0 sc1
    v_mfma_f32_16x16x32_bf16 v[52:55], v[108:111], a[204:207], v[52:55]
    ds_read_b64_tr_b16 v[244:245], v10 offset:20480
    s_add_u32 m0, s73, 99328
    v_lshlrev_b32 v79, 16, v103
    v_mfma_f32_16x16x32_bf16 v[52:55], v[104:107], a[196:199], v[52:55]
    buffer_load_dwordx4 v21, s[44:47], s21 offen offset:0 sc1 lds
    s_waitcnt lgkmcnt(3)
    v_mfma_f32_16x16x32_bf16 v[36:39], v[120:123], a[228:231], v[36:39]
    ds_read_b64_tr_b16 v[246:247], v10 offset:22528
    s_add_u32 m0, s73, 99840
    v_lshlrev_b32 v80, 16, v102
    v_mfma_f32_16x16x32_bf16 v[36:39], v[124:127], a[236:239], v[36:39]
    buffer_load_dwordx4 v21, s[44:47], s21 offen offset:512 sc1 lds
    s_waitcnt lgkmcnt(2)
    v_mfma_f32_16x16x32_bf16 v[36:39], v[128:131], a[244:247], v[36:39]
    ds_read_b128 v[104:107], v14 offset:18432
    v_mfma_f32_16x16x32_bf16 v[36:39], v[132:135], a[252:255], v[36:39]
    ds_read_b128 v[108:111], v14 offset:22528
    v_lshlrev_b32 v81, 16, v102
    v_mfma_f32_16x16x32_bf16 v[32:35], v[132:135], a[248:251], v[32:35]
    ds_read_b128 v[112:115], v14 offset:26624
    v_add_u32 v11, 65536, v11
    v_mfma_f32_16x16x32_bf16 v[32:35], v[128:131], a[240:243], v[32:35]
    ds_read_b128 v[116:119], v14 offset:30720
    v_mfma_f32_16x16x32_bf16 v[32:35], v[124:127], a[232:235], v[32:35]
    s_add_u32 m0, s73, 101376
    v_lshlrev_b32 v82, 16, v102
    v_mfma_f32_16x16x32_bf16 v[32:35], v[120:123], a[224:227], v[32:35]
    buffer_load_dwordx4 v21, s[44:47], s22 offen offset:0 sc1 lds
    ds_read_b64_tr_b16 v[240:241], v11 offset:16384
    s_waitcnt lgkmcnt(3)
    v_mfma_f32_16x16x32_bf16 v[40:43], v[104:107], a[224:227], v[40:43]
    buffer_load_dwordx2 v[98:99], v26, s[44:47], s42 offen offset:128 sc1
    v_lshlrev_b32 v83, 16, v102
    v_mfma_f32_16x16x32_bf16 v[40:43], v[108:111], a[232:235], v[40:43]
    ds_read_b64_tr_b16 v[242:243], v11 offset:18432
    s_waitcnt lgkmcnt(2)
    v_mfma_f32_16x16x32_bf16 v[40:43], v[112:115], a[240:243], v[40:43]
    ds_read_b128 v[120:123], v14 offset:19456
    v_mfma_f32_16x16x32_bf16 v[40:43], v[116:119], a[248:251], v[40:43]
    ds_read_b128 v[124:127], v14 offset:23552
    v_mfma_f32_16x16x32_bf16 v[44:47], v[116:119], a[252:255], v[44:47]
    ds_read_b128 v[128:131], v14 offset:27648
    v_lshlrev_b32 v84, 16, v103
    v_mfma_f32_16x16x32_bf16 v[44:47], v[112:115], a[244:247], v[44:47]
    ds_read_b128 v[132:135], v14 offset:31744
    v_mfma_f32_16x16x32_bf16 v[44:47], v[108:111], a[236:239], v[44:47]
    ds_read_b64_tr_b16 v[248:249], v11 offset:20480
    v_lshlrev_b32 v85, 16, v103
    v_mfma_f32_16x16x32_bf16 v[44:47], v[104:107], a[228:231], v[44:47]
    s_waitcnt lgkmcnt(3)
    v_mfma_f32_16x16x32_bf16 v[52:55], v[120:123], a[228:231], v[52:55]
    ds_read_b64_tr_b16 v[250:251], v11 offset:22528
    v_mfma_f32_16x16x32_bf16 v[52:55], v[124:127], a[236:239], v[52:55]
    v_lshlrev_b32 v86, 16, v103
    s_waitcnt lgkmcnt(2)
    v_mfma_f32_16x16x32_bf16 v[52:55], v[128:131], a[244:247], v[52:55]
    buffer_load_dwordx2 v[100:101], v18, s[44:47], s42 offen offset:0 sc1
    s_waitcnt lgkmcnt(0)
    s_barrier
    v_mfma_f32_16x16x32_bf16 v[52:55], v[132:135], a[252:255], v[52:55]
    ds_read_b128 v[104:107], v14 offset:32768
    v_mfma_f32_16x16x32_bf16 v[48:51], v[132:135], a[248:251], v[48:51]
    ds_read_b128 v[108:111], v14 offset:36864
    v_lshlrev_b32 v87, 16, v103
    v_mfma_f32_16x16x32_bf16 v[48:51], v[128:131], a[240:243], v[48:51]
    ds_read_b128 v[112:115], v14 offset:40960
    v_mfma_f32_16x16x32_bf16 v[48:51], v[124:127], a[232:235], v[48:51]
    ds_read_b128 v[116:119], v14 offset:45056
    v_lshlrev_b32 v27, 16, v27
    v_mfma_f32_16x16x32_bf16 v[48:51], v[120:123], a[224:227], v[48:51]
L_Dc:
L_pl_D_0:
    s_cbranch_execz L_wret
    s_waitcnt lgkmcnt(2)
    v_mfma_f32_16x16x32_bf16 v[32:35], v[104:107], v[220:223], v[32:35]
    s_add_u32 m0, s73, 114176
    v_mfma_f32_16x16x32_bf16 v[32:35], v[108:111], v[228:231], v[32:35]
    buffer_load_dwordx4 v21, s[44:47], s22 offen offset:512 sc1 lds
    s_waitcnt lgkmcnt(0)
    v_mfma_f32_16x16x32_bf16 v[32:35], v[112:115], v[236:239], v[32:35]
    ds_read_b128 v[120:123], v14 offset:33792
    v_mfma_f32_16x16x32_bf16 v[32:35], v[116:119], v[244:247], v[32:35]
    ds_read_b128 v[124:127], v14 offset:37888
    v_mfma_f32_16x16x32_bf16 v[36:39], v[116:119], v[248:251], v[36:39]
    ds_read_b128 v[128:131], v14 offset:41984
    buffer_load_dword v189, v188, s[44:47], 0 offen sc1
    v_mfma_f32_16x16x32_bf16 v[36:39], v[112:115], v[240:243], v[36:39]
    ds_read_b128 v[132:135], v14 offset:46080
    v_mfma_f32_16x16x32_bf16 v[36:39], v[108:111], v[232:235], v[36:39]
    s_add_u32 m0, s73, 115712
    v_mfma_f32_16x16x32_bf16 v[36:39], v[104:107], v[224:227], v[36:39]
    buffer_load_dwordx4 v21, s[44:47], s23 offen offset:0 sc1 lds
    s_waitcnt lgkmcnt(2)
    v_mfma_f32_16x16x32_bf16 v[44:47], v[120:123], v[224:227], v[44:47]
    s_add_u32 m0, s73, 116224
    v_mfma_f32_16x16x32_bf16 v[44:47], v[124:127], v[232:235], v[44:47]
    buffer_load_dwordx4 v21, s[44:47], s23 offen offset:512 sc1 lds
    s_waitcnt lgkmcnt(0)
    v_mfma_f32_16x16x32_bf16 v[44:47], v[128:131], v[240:243], v[44:47]
    ds_read_b128 v[104:107], v14 offset:34816
    v_mfma_f32_16x16x32_bf16 v[44:47], v[132:135], v[248:251], v[44:47]
    ds_read_b128 v[108:111], v14 offset:38912
    v_mfma_f32_16x16x32_bf16 v[40:43], v[132:135], v[244:247], v[40:43]
    ds_read_b128 v[112:115], v14 offset:43008
    v_mfma_f32_16x16x32_bf16 v[40:43], v[128:131], v[236:239], v[40:43]
    ds_read_b128 v[116:119], v14 offset:47104
    v_mfma_f32_16x16x32_bf16 v[40:43], v[124:127], v[228:231], v[40:43]
    s_add_u32 m0, s73, 117760
    v_mfma_f32_16x16x32_bf16 v[40:43], v[120:123], v[220:223], v[40:43]
    buffer_load_dwordx4 v21, s[44:47], s24 offen offset:0 sc1 lds
    s_waitcnt lgkmcnt(2)
    v_mfma_f32_16x16x32_bf16 v[48:51], v[104:107], v[220:223], v[48:51]
    v_mfma_f32_16x16x32_bf16 v[48:51], v[108:111], v[228:231], v[48:51]
    s_waitcnt lgkmcnt(0)
    v_mfma_f32_16x16x32_bf16 v[48:51], v[112:115], v[236:239], v[48:51]
    ds_read_b128 v[120:123], v14 offset:35840
    v_mfma_f32_16x16x32_bf16 v[48:51], v[116:119], v[244:247], v[48:51]
    ds_read_b128 v[124:127], v14 offset:39936
    v_mfma_f32_16x16x32_bf16 v[52:55], v[116:119], v[248:251], v[52:55]
    ds_read_b128 v[128:131], v14 offset:44032
    v_mfma_f32_16x16x32_bf16 v[52:55], v[112:115], v[240:243], v[52:55]
    ds_read_b128 v[132:135], v14 offset:48128
    v_mfma_f32_16x16x32_bf16 v[52:55], v[108:111], v[232:235], v[52:55]
    v_mfma_f32_16x16x32_bf16 v[52:55], v[104:107], v[224:227], v[52:55]
    s_waitcnt lgkmcnt(2)
    v_mfma_f32_16x16x32_bf16 v[60:63], v[120:123], a[4:7], 0
    v_mfma_f32_16x16x32_bf16 v[60:63], v[124:127], a[12:15], v[60:63]
    s_waitcnt lgkmcnt(0)
    v_mfma_f32_16x16x32_bf16 v[60:63], v[128:131], a[20:23], v[60:63]
    s_waitcnt vmcnt(14)
    s_barrier
    v_mfma_f32_16x16x32_bf16 v[60:63], v[132:135], a[28:31], v[60:63]
    ds_read_b128 v[104:107], v14 offset:49152
    v_mfma_f32_16x16x32_bf16 v[56:59], v[132:135], a[24:27], 0
    ds_read_b128 v[108:111], v14 offset:53248
    v_mfma_f32_16x16x32_bf16 v[56:59], v[128:131], a[16:19], v[56:59]
    ds_read_b128 v[112:115], v14 offset:57344
    v_cvt_pk_bf16_f32 v192, v32, v33
    v_mfma_f32_16x16x32_bf16 v[56:59], v[124:127], a[8:11], v[56:59]
    ds_read_b128 v[116:119], v14 offset:61440
    v_mfma_f32_16x16x32_bf16 v[56:59], v[120:123], a[0:3], v[56:59]
    s_waitcnt lgkmcnt(2)
    v_mfma_f32_16x16x32_bf16 v[64:67], v[104:107], a[0:3], 0
    s_add_u32 m0, s73, 130560
    v_mfma_f32_16x16x32_bf16 v[64:67], v[108:111], a[8:11], v[64:67]
    buffer_load_dwordx4 v21, s[44:47], s24 offen offset:512 sc1 lds
    s_waitcnt lgkmcnt(0)
    v_mfma_f32_16x16x32_bf16 v[64:67], v[112:115], a[16:19], v[64:67]
    ds_read_b128 v[120:123], v14 offset:50176
    v_cvt_pk_bf16_f32 v193, v34, v35
    v_mfma_f32_16x16x32_bf16 v[64:67], v[116:119], a[24:27], v[64:67]
    ds_read_b128 v[124:127], v14 offset:54272
    v_mfma_f32_16x16x32_bf16 v[68:71], v[116:119], a[28:31], 0
    ds_read_b128 v[128:131], v14 offset:58368
    v_mfma_f32_16x16x32_bf16 v[68:71], v[112:115], a[20:23], v[68:71]
    buffer_store_dwordx4 v[192:195], v136, s[44:47], s32 offen sc1
    ds_read_b128 v[132:135], v14 offset:62464
    v_mfma_f32_16x16x32_bf16 v[68:71], v[108:111], a[12:15], v[68:71]
    s_add_u32 m0, s73, 132096
    v_mfma_f32_16x16x32_bf16 v[68:71], v[104:107], a[4:7], v[68:71]
    buffer_load_dwordx4 v21, s[44:47], s25 offen offset:0 sc1 lds
    s_waitcnt lgkmcnt(2)
    v_mfma_f32_16x16x32_bf16 v[60:63], v[120:123], a[36:39], v[60:63]
    s_add_u32 m0, s73, 132608
    v_mfma_f32_16x16x32_bf16 v[60:63], v[124:127], a[44:47], v[60:63]
    buffer_load_dwordx4 v21, s[44:47], s25 offen offset:512 sc1 lds
    s_waitcnt lgkmcnt(0)
    v_mfma_f32_16x16x32_bf16 v[60:63], v[128:131], a[52:55], v[60:63]
    ds_read_b128 v[104:107], v14 offset:51200
    v_mfma_f32_16x16x32_bf16 v[60:63], v[132:135], a[60:63], v[60:63]
    ds_read_b128 v[108:111], v14 offset:55296
    v_mfma_f32_16x16x32_bf16 v[56:59], v[132:135], a[56:59], v[56:59]
    ds_read_b128 v[112:115], v14 offset:59392
    v_mfma_f32_16x16x32_bf16 v[56:59], v[128:131], a[48:51], v[56:59]
    ds_read_b128 v[116:119], v14 offset:63488
    v_mfma_f32_16x16x32_bf16 v[56:59], v[124:127], a[40:43], v[56:59]
    s_add_u32 m0, s73, 134144
    v_cvt_pk_bf16_f32 v196, v36, v37
    v_mfma_f32_16x16x32_bf16 v[56:59], v[120:123], a[32:35], v[56:59]
    buffer_load_dwordx4 v21, s[44:47], s26 offen offset:0 sc1 lds
    s_waitcnt lgkmcnt(2)
    v_mfma_f32_16x16x32_bf16 v[64:67], v[104:107], a[32:35], v[64:67]
    v_mfma_f32_16x16x32_bf16 v[64:67], v[108:111], a[40:43], v[64:67]
    s_waitcnt lgkmcnt(0)
    v_mfma_f32_16x16x32_bf16 v[64:67], v[112:115], a[48:51], v[64:67]
    ds_read_b128 v[120:123], v14 offset:52224
    v_cvt_pk_bf16_f32 v197, v38, v39
    v_mfma_f32_16x16x32_bf16 v[64:67], v[116:119], a[56:59], v[64:67]
    ds_read_b128 v[124:127], v14 offset:56320
    v_mfma_f32_16x16x32_bf16 v[68:71], v[116:119], a[60:63], v[68:71]
    ds_read_b128 v[128:131], v14 offset:60416
    v_mfma_f32_16x16x32_bf16 v[68:71], v[112:115], a[52:55], v[68:71]
    ds_read_b128 v[132:135], v14 offset:64512
    v_mfma_f32_16x16x32_bf16 v[68:71], v[108:111], a[44:47], v[68:71]
    buffer_store_dwordx4 v[196:199], v136, s[44:47], s33 offen sc1
    v_mfma_f32_16x16x32_bf16 v[68:71], v[104:107], a[36:39], v[68:71]
    s_waitcnt lgkmcnt(2)
    v_mfma_f32_16x16x32_bf16 v[60:63], v[120:123], a[68:71], v[60:63]
    v_mfma_f32_16x16x32_bf16 v[60:63], v[124:127], a[76:79], v[60:63]
    s_waitcnt lgkmcnt(0)
    v_mfma_f32_16x16x32_bf16 v[60:63], v[128:131], a[84:87], v[60:63]
    s_waitcnt vmcnt(13)
    s_barrier
    v_mfma_f32_16x16x32_bf16 v[60:63], v[132:135], a[92:95], v[60:63]
    ds_read_b128 v[104:107], v14 offset:0
    v_mfma_f32_16x16x32_bf16 v[56:59], v[132:135], a[88:91], v[56:59]
    ds_read_b128 v[108:111], v14 offset:4096
    v_mfma_f32_16x16x32_bf16 v[56:59], v[128:131], a[80:83], v[56:59]
    ds_read_b128 v[112:115], v14 offset:8192
    v_cvt_pk_bf16_f32 v192, v40, v41
    v_mfma_f32_16x16x32_bf16 v[56:59], v[124:127], a[72:75], v[56:59]
    ds_read_b128 v[116:119], v14 offset:12288
    v_mfma_f32_16x16x32_bf16 v[56:59], v[120:123], a[64:67], v[56:59]
    s_waitcnt lgkmcnt(2)
    v_mfma_f32_16x16x32_bf16 v[64:67], v[104:107], a[64:67], v[64:67]
    s_add_u32 m0, s73, 146944
    v_cvt_pk_bf16_f32 v193, v42, v43
    s_waitcnt vmcnt(11)
    v_mfma_f32_16x16x32_bf16 v[64:67], v[108:111], a[72:75], v[64:67]
    buffer_load_dwordx4 v21, s[44:47], s26 offen offset:512 sc1 lds
    s_waitcnt lgkmcnt(0)
    v_mfma_f32_16x16x32_bf16 v[64:67], v[112:115], a[80:83], v[64:67]
    ds_read_b128 v[120:123], v14 offset:1024
    v_mul_f32 v96, v96, v97
    v_mfma_f32_16x16x32_bf16 v[64:67], v[116:119], a[88:91], v[64:67]
    ds_read_b128 v[124:127], v14 offset:5120
    v_cvt_pk_bf16_f32 v194, v44, v45
    v_mfma_f32_16x16x32_bf16 v[68:71], v[116:119], a[92:95], v[68:71]
    ds_read_b128 v[128:131], v14 offset:9216
    v_mul_f32 v98, v98, v99
    v_mfma_f32_16x16x32_bf16 v[68:71], v[112:115], a[84:87], v[68:71]
    ds_read_b128 v[132:135], v14 offset:13312
    v_mul_f32 v100, v100, v101
    v_mfma_f32_16x16x32_bf16 v[68:71], v[108:111], a[76:79], v[68:71]
    buffer_store_dwordx4 v[192:195], v136, s[44:47], s30 offen offset:0 sc1
    s_add_u32 m0, s73, 148480
    v_permlane16_swap_b32 v88, v90
    v_mfma_f32_16x16x32_bf16 v[68:71], v[104:107], a[68:71], v[68:71]
    buffer_load_dwordx4 v22, s[44:47], s18 offen offset:0 sc1 lds
    s_waitcnt lgkmcnt(2)
    v_mfma_f32_16x16x32_bf16 v[60:63], v[120:123], a[100:103], v[60:63]
    s_add_u32 m0, s73, 148992
    v_permlane16_swap_b32 v89, v91
    v_permlane16_swap_b32 v92, v94
    v_mfma_f32_16x16x32_bf16 v[60:63], v[124:127], a[108:111], v[60:63]
    buffer_load_dwordx4 v22, s[44:47], s18 offen offset:512 sc1 lds
    s_waitcnt vmcnt(13)
    s_waitcnt lgkmcnt(0)
    v_mfma_f32_16x16x32_bf16 v[60:63], v[128:131], a[116:119], v[60:63]
    ds_read_b128 v[104:107], v14 offset:2048
    v_permlane16_swap_b32 v93, v95
    v_mfma_f32_16x16x32_bf16 v[60:63], v[132:135], a[124:127], v[60:63]
    ds_read_b128 v[108:111], v14 offset:6144
    v_cmp_ne_u32 vcc, s68, v189
    v_mfma_f32_16x16x32_bf16 v[56:59], v[132:135], a[120:123], v[56:59]
    ds_read_b128 v[112:115], v14 offset:10240
    v_and_b32 v145, 0xffff0000, v88
    v_mfma_f32_16x16x32_bf16 v[56:59], v[128:131], a[112:115], v[56:59]
    ds_read_b128 v[116:119], v14 offset:14336
    v_cvt_pk_bf16_f32 v196, v46, v47
    v_mfma_f32_16x16x32_bf16 v[56:59], v[124:127], a[104:107], v[56:59]
    s_add_u32 m0, s73, 150528
    s_cbranch_vccnz L_rs_p3
L_ok_p3:
    v_lshlrev_b32 v144, 16, v88
    v_mfma_f32_16x16x32_bf16 v[56:59], v[120:123], a[96:99], v[56:59]
    buffer_load_dwordx4 v22, s[44:47], s19 offen offset:0 sc1 lds
    s_waitcnt lgkmcnt(2)
    v_mfma_f32_16x16x32_bf16 v[64:67], v[104:107], a[96:99], v[64:67]
    s_add_u32 m0, s73, 81920
    v_cvt_pk_bf16_f32 v197, v48, v49
    v_and_b32 v147, 0xffff0000, v89
    v_mfma_f32_16x16x32_bf16 v[64:67], v[108:111], a[104:107], v[64:67]
    buffer_load_dwordx4 v184, s[44:47], s37 offen offset:0 sc1 lds
    s_waitcnt lgkmcnt(0)
    v_mfma_f32_16x16x32_bf16 v[64:67], v[112:115], a[112:115], v[64:67]
    ds_read_b128 v[120:123], v14 offset:3072
    buffer_load_dwordx4 v185, s[44:47], s37 offen offset:1024 sc1 lds
    v_mfma_f32_16x16x32_bf16 v[64:67], v[116:119], a[120:123], v[64:67]
    ds_read_b128 v[124:127], v14 offset:7168
    s_add_u32 m0, s73, 83968
    v_cvt_pk_bf16_f32 v198, v50, v51
    v_mfma_f32_16x16x32_bf16 v[68:71], v[116:119], a[124:127], v[68:71]
    ds_read_b128 v[128:131], v14 offset:11264
    buffer_load_dwordx4 v184, s[44:47], s16 offen offset:0 sc1 lds
    v_mfma_f32_16x16x32_bf16 v[68:71], v[112:115], a[116:119], v[68:71]
    ds_read_b128 v[132:135], v14 offset:15360
    buffer_load_dwordx4 v185, s[44:47], s16 offen offset:1024 sc1 lds
    v_mfma_f32_16x16x32_bf16 v[68:71], v[108:111], a[108:111], v[68:71]
    buffer_store_dwordx4 v[196:199], v136, s[44:47], s30 offen offset:1024 sc1
    v_lshlrev_b32 v146, 16, v89
    v_and_b32 v149, 0xffff0000, v92
    v_lshlrev_b32 v148, 16, v92
L_pl_D_1:
    s_cbranch_execz L_wret
    v_mfma_f32_16x16x32_bf16 v[68:71], v[104:107], a[100:103], v[68:71]
    s_waitcnt lgkmcnt(2)
    v_mfma_f32_16x16x32_bf16 v[60:63], v[120:123], a[132:135], v[60:63]
    v_and_b32 v151, 0xffff0000, v93
    v_mfma_f32_16x16x32_bf16 v[60:63], v[124:127], a[140:143], v[60:63]
    v_lshlrev_b32 v150, 16, v93
    s_waitcnt lgkmcnt(0)
    v_mfma_f32_16x16x32_bf16 v[60:63], v[128:131], a[148:151], v[60:63]
    s_waitcnt vmcnt(16)
    s_barrier
    v_mfma_f32_16x16x32_bf16 v[60:63], v[132:135], a[156:159], v[60:63]
    ds_read_b128 v[104:107], v14 offset:16384
    v_and_b32 v153, 0xffff0000, v90
    v_mfma_f32_16x16x32_bf16 v[56:59], v[132:135], a[152:155], v[56:59]
    ds_read_b128 v[108:111], v14 offset:20480
    v_lshlrev_b32 v152, 16, v90
    v_mfma_f32_16x16x32_bf16 v[56:59], v[128:131], a[144:147], v[56:59]
    ds_read_b128 v[112:115], v14 offset:24576
    v_cvt_pk_bf16_f32 v200, v52, v53
    v_mfma_f32_16x16x32_bf16 v[56:59], v[124:127], a[136:139], v[56:59]
    ds_read_b128 v[116:119], v14 offset:28672
    v_and_b32 v155, 0xffff0000, v91
    v_mfma_f32_16x16x32_bf16 v[56:59], v[120:123], a[128:131], v[56:59]
    s_waitcnt lgkmcnt(2)
    v_mfma_f32_16x16x32_bf16 v[64:67], v[104:107], a[128:131], v[64:67]
    s_add_u32 m0, s73, 97792
    v_lshlrev_b32 v154, 16, v91
    v_mfma_f32_16x16x32_bf16 v[64:67], v[108:111], a[136:139], v[64:67]
    buffer_load_dwordx4 v22, s[44:47], s19 offen offset:512 sc1 lds
    s_waitcnt lgkmcnt(0)
    v_mfma_f32_16x16x32_bf16 v[64:67], v[112:115], a[144:147], v[64:67]
    ds_read_b128 v[120:123], v14 offset:17408
    v_cvt_pk_bf16_f32 v201, v54, v55
    v_mfma_f32_16x16x32_bf16 v[64:67], v[116:119], a[152:155], v[64:67]
    ds_read_b128 v[124:127], v14 offset:21504
    v_and_b32 v157, 0xffff0000, v94
    v_mfma_f32_16x16x32_bf16 v[68:71], v[116:119], a[156:159], v[68:71]
    ds_read_b128 v[128:131], v14 offset:25600
    v_lshlrev_b32 v156, 16, v94
    v_mfma_f32_16x16x32_bf16 v[68:71], v[112:115], a[148:151], v[68:71]
    buffer_store_dwordx4 v[200:203], v136, s[44:47], s30 offen offset:2048 sc1
    ds_read_b128 v[132:135], v14 offset:29696
    v_and_b32 v159, 0xffff0000, v95
    v_mfma_f32_16x16x32_bf16 v[68:71], v[108:111], a[140:143], v[68:71]
    s_add_u32 m0, s73, 99328
    v_lshlrev_b32 v158, 16, v95
    v_mfma_f32_16x16x32_bf16 v[68:71], v[104:107], a[132:135], v[68:71]
    buffer_load_dwordx4 v22, s[44:47], s20 offen offset:0 sc1 lds
    s_waitcnt lgkmcnt(2)
    v_mfma_f32_16x16x32_bf16 v[60:63], v[120:123], a[164:167], v[60:63]
    s_add_u32 m0, s73, 99840
    v_and_b32 v161, 0xffff0000, v142
    v_mfma_f32_16x16x32_bf16 v[60:63], v[124:127], a[172:175], v[60:63]
    buffer_load_dwordx4 v22, s[44:47], s20 offen offset:512 sc1 lds
    s_waitcnt lgkmcnt(0)
    v_mfma_f32_16x16x32_bf16 v[60:63], v[128:131], a[180:183], v[60:63]
    ds_read_b128 v[104:107], v14 offset:18432
    v_lshlrev_b32 v160, 16, v142
    v_mfma_f32_16x16x32_bf16 v[60:63], v[132:135], a[188:191], v[60:63]
    ds_read_b128 v[108:111], v14 offset:22528
    v_mfma_f32_16x16x32_bf16 v[56:59], v[132:135], a[184:187], v[56:59]
    ds_read_b128 v[112:115], v14 offset:26624
    v_and_b32 v163, 0xffff0000, v143
    v_mfma_f32_16x16x32_bf16 v[56:59], v[128:131], a[176:179], v[56:59]
    ds_read_b128 v[116:119], v14 offset:30720
    v_lshlrev_b32 v162, 16, v143
    v_mfma_f32_16x16x32_bf16 v[56:59], v[124:127], a[168:171], v[56:59]
    s_add_u32 m0, s73, 101376
    v_mfma_f32_16x16x32_bf16 v[56:59], v[120:123], a[160:163], v[56:59]
    buffer_load_dwordx4 v22, s[44:47], s21 offen offset:0 sc1 lds
    s_waitcnt lgkmcnt(2)
    v_mfma_f32_16x16x32_bf16 v[64:67], v[104:107], a[160:163], v[64:67]
    v_fma_f32 v164, v144, v97, -v96
    v_mfma_f32_16x16x32_bf16 v[64:67], v[108:111], a[168:171], v[64:67]
    v_fma_f32 v165, v145, v97, -v96
    s_waitcnt lgkmcnt(0)
    v_mfma_f32_16x16x32_bf16 v[64:67], v[112:115], a[176:179], v[64:67]
    ds_read_b128 v[120:123], v14 offset:19456
    v_fma_f32 v166, v146, v97, -v96
    v_mfma_f32_16x16x32_bf16 v[64:67], v[116:119], a[184:187], v[64:67]
    ds_read_b128 v[124:127], v14 offset:23552
    v_mfma_f32_16x16x32_bf16 v[68:71], v[116:119], a[188:191], v[68:71]
    ds_read_b128 v[128:131], v14 offset:27648
    v_fma_f32 v167, v147, v97, -v96
    v_mfma_f32_16x16x32_bf16 v[68:71], v[112:115], a[180:183], v[68:71]
    ds_read_b128 v[132:135], v14 offset:31744
    v_mfma_f32_16x16x32_bf16 v[68:71], v[108:111], a[172:175], v[68:71]
    v_fma_f32 v168, v148, v99, -v98
    v_mfma_f32_16x16x32_bf16 v[68:71], v[104:107], a[164:167], v[68:71]
    v_fma_f32 v169, v149, v99, -v98
    s_waitcnt lgkmcnt(2)
    v_mfma_f32_16x16x32_bf16 v[60:63], v[120:123], a[196:199], v[60:63]
    v_mfma_f32_16x16x32_bf16 v[60:63], v[124:127], a[204:207], v[60:63]
    v_fma_f32 v170, v150, v99, -v98
    s_waitcnt lgkmcnt(0)
    v_mfma_f32_16x16x32_bf16 v[60:63], v[128:131], a[212:215], v[60:63]
    s_waitcnt vmcnt(16)
    s_barrier
    v_mfma_f32_16x16x32_bf16 v[60:63], v[132:135], a[220:223], v[60:63]
    ds_read_b128 v[104:107], v14 offset:32768
    v_fma_f32 v171, v151, v99, -v98
    v_mfma_f32_16x16x32_bf16 v[56:59], v[132:135], a[216:219], v[56:59]
    ds_read_b128 v[108:111], v14 offset:36864
    v_fma_f32 v172, v152, v97, -v96
    v_mfma_f32_16x16x32_bf16 v[56:59], v[128:131], a[208:211], v[56:59]
    ds_read_b128 v[112:115], v14 offset:40960
    v_mfma_f32_16x16x32_bf16 v[56:59], v[124:127], a[200:203], v[56:59]
    ds_read_b128 v[116:119], v14 offset:45056
    v_fma_f32 v173, v153, v97, -v96
    v_mfma_f32_16x16x32_bf16 v[56:59], v[120:123], a[192:195], v[56:59]
    s_waitcnt lgkmcnt(2)
    v_mfma_f32_16x16x32_bf16 v[64:67], v[104:107], a[192:195], v[64:67]
    s_add_u32 m0, s73, 114176
    v_fma_f32 v174, v154, v97, -v96
    v_mfma_f32_16x16x32_bf16 v[64:67], v[108:111], a[200:203], v[64:67]
    buffer_load_dwordx4 v22, s[44:47], s21 offen offset:512 sc1 lds
    s_waitcnt lgkmcnt(0)
    v_mfma_f32_16x16x32_bf16 v[64:67], v[112:115], a[208:211], v[64:67]
    ds_read_b128 v[120:123], v14 offset:33792
    v_fma_f32 v175, v155, v97, -v96
    v_mfma_f32_16x16x32_bf16 v[64:67], v[116:119], a[216:219], v[64:67]
    ds_read_b128 v[124:127], v14 offset:37888
    v_fma_f32 v176, v156, v99, -v98
    v_mfma_f32_16x16x32_bf16 v[68:71], v[116:119], a[220:223], v[68:71]
    ds_read_b128 v[128:131], v14 offset:41984
    v_mfma_f32_16x16x32_bf16 v[68:71], v[112:115], a[212:215], v[68:71]
    ds_read_b128 v[132:135], v14 offset:46080
    v_fma_f32 v177, v157, v99, -v98
    v_mfma_f32_16x16x32_bf16 v[68:71], v[108:111], a[204:207], v[68:71]
    s_add_u32 m0, s73, 115712
    v_fma_f32 v178, v158, v99, -v98
    v_mfma_f32_16x16x32_bf16 v[68:71], v[104:107], a[196:199], v[68:71]
    buffer_load_dwordx4 v22, s[44:47], s22 offen offset:0 sc1 lds
    s_waitcnt lgkmcnt(2)
    v_mfma_f32_16x16x32_bf16 v[60:63], v[120:123], a[228:231], v[60:63]
    s_add_u32 m0, s73, 116224
    v_fma_f32 v179, v159, v99, -v98
    v_mfma_f32_16x16x32_bf16 v[60:63], v[124:127], a[236:239], v[60:63]
    buffer_load_dwordx4 v22, s[44:47], s22 offen offset:512 sc1 lds
    s_waitcnt lgkmcnt(0)
    v_mfma_f32_16x16x32_bf16 v[60:63], v[128:131], a[244:247], v[60:63]
    ds_read_b128 v[104:107], v14 offset:34816
    v_fma_f32 v180, v160, v101, -v100
    v_mfma_f32_16x16x32_bf16 v[60:63], v[132:135], a[252:255], v[60:63]
    ds_read_b128 v[108:111], v14 offset:38912
    v_fma_f32 v181, v161, v101, -v100
    v_mfma_f32_16x16x32_bf16 v[56:59], v[132:135], a[248:251], v[56:59]
    ds_read_b128 v[112:115], v14 offset:43008
    v_mfma_f32_16x16x32_bf16 v[56:59], v[128:131], a[240:243], v[56:59]
    ds_read_b128 v[116:119], v14 offset:47104
    v_fma_f32 v182, v162, v101, -v100
    v_mfma_f32_16x16x32_bf16 v[56:59], v[124:127], a[232:235], v[56:59]
    s_add_u32 m0, s73, 117760
    v_fma_f32 v183, v163, v101, -v100
    v_mfma_f32_16x16x32_bf16 v[56:59], v[120:123], a[224:227], v[56:59]
    buffer_load_dwordx4 v22, s[44:47], s23 offen offset:0 sc1 lds
    s_waitcnt lgkmcnt(2)
    v_mfma_f32_16x16x32_bf16 v[64:67], v[104:107], a[224:227], v[64:67]
    v_mfma_f32_16x16x32_bf16 v[64:67], v[108:111], a[232:235], v[64:67]
    s_waitcnt lgkmcnt(0)
    v_mfma_f32_16x16x32_bf16 v[64:67], v[112:115], a[240:243], v[64:67]
    ds_read_b128 v[120:123], v14 offset:35840
    v_mfma_f32_16x16x32_bf16 v[64:67], v[116:119], a[248:251], v[64:67]
    ds_read_b128 v[124:127], v14 offset:39936
    v_mfma_f32_16x16x32_bf16 v[68:71], v[116:119], a[252:255], v[68:71]
    ds_read_b128 v[128:131], v14 offset:44032
    v_mfma_f32_16x16x32_bf16 v[68:71], v[112:115], a[244:247], v[68:71]
    ds_read_b128 v[132:135], v14 offset:48128
    v_mfma_f32_16x16x32_bf16 v[68:71], v[108:111], a[236:239], v[68:71]
    v_mfma_f32_16x16x32_bf16 v[68:71], v[104:107], a[228:231], v[68:71]
    s_waitcnt lgkmcnt(2)
    v_mfma_f32_16x16x32_bf16 v[60:63], v[120:123], v[224:227], v[60:63]
    v_mfma_f32_16x16x32_bf16 v[60:63], v[124:127], v[232:235], v[60:63]
    s_waitcnt lgkmcnt(0)
    v_mfma_f32_16x16x32_bf16 v[60:63], v[128:131], v[240:243], v[60:63]
    s_waitcnt vmcnt(10)
    s_barrier
    v_mfma_f32_16x16x32_bf16 v[60:63], v[132:135], v[248:251], v[60:63]
    ds_read_b128 v[104:107], v14 offset:49152
    v_mfma_f32_16x16x32_bf16 v[56:59], v[132:135], v[244:247], v[56:59]
    ds_read_b128 v[108:111], v14 offset:53248
    v_mfma_f32_16x16x32_bf16 v[56:59], v[128:131], v[236:239], v[56:59]
    ds_read_b128 v[112:115], v14 offset:57344
    v_mfma_f32_16x16x32_bf16 v[56:59], v[124:127], v[228:231], v[56:59]
    ds_read_b128 v[116:119], v14 offset:61440
    v_mfma_f32_16x16x32_bf16 v[56:59], v[120:123], v[220:223], v[56:59]
    s_waitcnt lgkmcnt(2)
    v_mfma_f32_16x16x32_bf16 v[64:67], v[104:107], v[220:223], v[64:67]
    s_add_u32 m0, s73, 130560
    v_xor_b32 v186, s41, v10
    v_add_u32 v186, s43, v186
    v_mfma_f32_16x16x32_bf16 v[64:67], v[108:111], v[228:231], v[64:67]
    buffer_load_dwordx4 v22, s[44:47], s23 offen offset:512 sc1 lds
    ds_read_b64_tr_b16 v[12:13], v10 offset:16384
    s_waitcnt lgkmcnt(1)
    v_mfma_f32_16x16x32_bf16 v[64:67], v[112:115], v[236:239], v[64:67]
    ds_read_b128 v[120:123], v14 offset:50176
    v_mfma_f32_16x16x32_bf16 v[64:67], v[116:119], v[244:247], v[64:67]
    ds_read_b128 v[124:127], v14 offset:54272
    v_mfma_f32_16x16x32_bf16 v[68:71], v[116:119], v[248:251], v[68:71]
    ds_read_b128 v[128:131], v14 offset:58368
    ds_read_b64_tr_b16 v[24:25], v11 offset:16384
    v_mfma_f32_16x16x32_bf16 v[68:71], v[112:115], v[240:243], v[68:71]
    ds_read_b128 v[132:135], v14 offset:62464
    ds_read_b64_tr_b16 v[28:29], v10 offset:20480
    v_mfma_f32_16x16x32_bf16 v[68:71], v[108:111], v[232:235], v[68:71]
    s_add_u32 m0, s73, 132096
    ds_read_b64_tr_b16 v[190:191], v11 offset:20480
    v_mfma_f32_16x16x32_bf16 v[68:71], v[104:107], v[224:227], v[68:71]
    buffer_load_dwordx4 v22, s[44:47], s24 offen offset:0 sc1 lds
    ds_read_b64_tr_b16 v[142:143], v186 offset:18432
    s_waitcnt lgkmcnt(6)
    v_mfma_f32_16x16x32_bf16 v[76:79], v[120:123], a[4:7], v[76:79]
    s_add_u32 m0, s73, 132608
    s_waitcnt lgkmcnt(0)
    v_mfma_f32_16x16x32_bf16 v[76:79], v[124:127], a[12:15], v[76:79]
    buffer_load_dwordx4 v22, s[44:47], s24 offen offset:512 sc1 lds
    v_mfma_f32_16x16x32_bf16 v[76:79], v[128:131], a[20:23], v[76:79]
    ds_read_b128 v[104:107], v14 offset:51200
    v_and_b32 v9, 0xffff0000, v12
    v_mfma_f32_16x16x32_bf16 v[76:79], v[132:135], a[28:31], v[76:79]
    ds_read_b128 v[108:111], v14 offset:55296
    v_mfma_f32_16x16x32_bf16 v[72:75], v[132:135], a[24:27], v[72:75]
    ds_read_b128 v[112:115], v14 offset:59392
    v_lshlrev_b32 v8, 16, v12
    v_mfma_f32_16x16x32_bf16 v[72:75], v[128:131], a[16:19], v[72:75]
    ds_read_b128 v[116:119], v14 offset:63488
    v_cvt_pk_bf16_f32 v192, v56, v57
    v_mfma_f32_16x16x32_bf16 v[72:75], v[124:127], a[8:11], v[72:75]
    s_add_u32 m0, s73, 134144
    v_mul_f32 v165, v165, v9
    v_mfma_f32_16x16x32_bf16 v[72:75], v[120:123], a[0:3], v[72:75]
    buffer_load_dwordx4 v22, s[44:47], s25 offen offset:0 sc1 lds
    s_waitcnt lgkmcnt(2)
    v_mfma_f32_16x16x32_bf16 v[80:83], v[104:107], a[0:3], v[80:83]
    v_cvt_pk_bf16_f32 v193, v58, v59
    v_mul_f32 v164, v164, v8
    v_mfma_f32_16x16x32_bf16 v[80:83], v[108:111], a[8:11], v[80:83]
    v_and_b32 v31, 0xffff0000, v13
    s_waitcnt lgkmcnt(0)
    v_mfma_f32_16x16x32_bf16 v[80:83], v[112:115], a[16:19], v[80:83]
    ds_read_b128 v[120:123], v14 offset:52224
    v_lshlrev_b32 v30, 16, v13
    v_mfma_f32_16x16x32_bf16 v[80:83], v[116:119], a[24:27], v[80:83]
    ds_read_b128 v[124:127], v14 offset:56320
    v_cvt_pk_bf16_f32 v194, v60, v61
    v_mfma_f32_16x16x32_bf16 v[84:87], v[116:119], a[28:31], v[84:87]
    ds_read_b128 v[128:131], v14 offset:60416
    v_mfma_f32_16x16x32_bf16 v[84:87], v[112:115], a[20:23], v[84:87]
    ds_read_b128 v[132:135], v14 offset:64512
    v_mul_f32 v167, v167, v31
    v_mfma_f32_16x16x32_bf16 v[84:87], v[108:111], a[12:15], v[84:87]
    buffer_store_dwordx4 v[192:195], v136, s[44:47], s15 offen offset:0 sc1
    v_mul_f32 v166, v166, v30
    v_mfma_f32_16x16x32_bf16 v[84:87], v[104:107], a[4:7], v[84:87]
    s_waitcnt lgkmcnt(2)
    v_mfma_f32_16x16x32_bf16 v[76:79], v[120:123], a[36:39], v[76:79]
    v_and_b32 v9, 0xffff0000, v24
    v_mfma_f32_16x16x32_bf16 v[76:79], v[124:127], a[44:47], v[76:79]
    v_cvt_pk_bf16_f32 v196, v62, v63
    s_waitcnt lgkmcnt(0)
    v_mfma_f32_16x16x32_bf16 v[76:79], v[128:131], a[52:55], v[76:79]
    s_waitcnt vmcnt(9)
    s_barrier
    v_lshlrev_b32 v8, 16, v24
    v_mfma_f32_16x16x32_bf16 v[76:79], v[132:135], a[60:63], v[76:79]
    ds_read_b128 v[104:107], v14 offset:0
    v_mul_f32 v169, v169, v9
    v_mfma_f32_16x16x32_bf16 v[72:75], v[132:135], a[56:59], v[72:75]
    ds_read_b128 v[108:111], v14 offset:4096
    v_cvt_pk_bf16_f32 v197, v64, v65
    v_mfma_f32_16x16x32_bf16 v[72:75], v[128:131], a[48:51], v[72:75]
    ds_read_b128 v[112:115], v14 offset:8192
    v_mul_f32 v168, v168, v8
    v_mfma_f32_16x16x32_bf16 v[72:75], v[124:127], a[40:43], v[72:75]
    ds_read_b128 v[116:119], v14 offset:12288
    v_mfma_f32_16x16x32_bf16 v[72:75], v[120:123], a[32:35], v[72:75]
    v_cvt_pk_bf16_f32 v198, v66, v67
    s_waitcnt lgkmcnt(2)
    v_mfma_f32_16x16x32_bf16 v[80:83], v[104:107], a[32:35], v[80:83]
    s_add_u32 m0, s73, 146944
    v_and_b32 v31, 0xffff0000, v25
    v_lshlrev_b32 v30, 16, v25
    v_mfma_f32_16x16x32_bf16 v[80:83], v[108:111], a[40:43], v[80:83]
    buffer_load_dwordx4 v22, s[44:47], s25 offen offset:512 sc1 lds
    s_waitcnt lgkmcnt(0)
    v_mfma_f32_16x16x32_bf16 v[80:83], v[112:115], a[48:51], v[80:83]
    buffer_store_dwordx4 v[196:199], v136, s[44:47], s15 offen offset:1024 sc1
    ds_read_b128 v[120:123], v14 offset:1024
    v_mfma_f32_16x16x32_bf16 v[80:83], v[116:119], a[56:59], v[80:83]
    ds_read_b128 v[124:127], v14 offset:5120
    v_mul_f32 v171, v171, v31
    v_mfma_f32_16x16x32_bf16 v[84:87], v[116:119], a[60:63], v[84:87]
    ds_read_b128 v[128:131], v14 offset:9216
    v_mul_f32 v170, v170, v30
    v_mfma_f32_16x16x32_bf16 v[84:87], v[112:115], a[52:55], v[84:87]
    ds_read_b128 v[132:135], v14 offset:13312
    v_mfma_f32_16x16x32_bf16 v[84:87], v[108:111], a[44:47], v[84:87]
    s_add_u32 m0, s73, 148480
    v_cvt_pk_bf16_f32 v200, v68, v69
    v_and_b32 v9, 0xffff0000, v28
    v_mfma_f32_16x16x32_bf16 v[84:87], v[104:107], a[36:39], v[84:87]
    buffer_load_dwordx4 v22, s[44:47], s26 offen offset:0 sc1 lds
    s_waitcnt lgkmcnt(2)
    v_mfma_f32_16x16x32_bf16 v[76:79], v[120:123], a[68:71], v[76:79]
    s_add_u32 m0, s73, 148992
    v_lshlrev_b32 v8, 16, v28
    v_mfma_f32_16x16x32_bf16 v[76:79], v[124:127], a[76:79], v[76:79]
    buffer_load_dwordx4 v22, s[44:47], s26 offen offset:512 sc1 lds
    s_waitcnt lgkmcnt(0)
    v_mfma_f32_16x16x32_bf16 v[76:79], v[128:131], a[84:87], v[76:79]
    ds_read_b128 v[104:107], v14 offset:2048
    v_cvt_pk_bf16_f32 v201, v70, v71
    v_mfma_f32_16x16x32_bf16 v[76:79], v[132:135], a[92:95], v[76:79]
    ds_read_b128 v[108:111], v14 offset:6144
    v_mul_f32 v173, v173, v9
    v_mfma_f32_16x16x32_bf16 v[72:75], v[132:135], a[88:91], v[72:75]
    ds_read_b128 v[112:115], v14 offset:10240
    v_mul_f32 v172, v172, v8
    v_mfma_f32_16x16x32_bf16 v[72:75], v[128:131], a[80:83], v[72:75]
    ds_read_b128 v[116:119], v14 offset:14336
    v_and_b32 v31, 0xffff0000, v29
    v_mfma_f32_16x16x32_bf16 v[72:75], v[124:127], a[72:75], v[72:75]
    buffer_store_dwordx4 v[200:203], v136, s[44:47], s15 offen offset:2048 sc1
    s_add_u32 m0, s73, 150528
    v_mfma_f32_16x16x32_bf16 v[72:75], v[120:123], a[64:67], v[72:75]
    buffer_load_dwordx4 v19, s[44:47], s18 offen offset:0 sc1 lds
    s_waitcnt lgkmcnt(2)
    v_mfma_f32_16x16x32_bf16 v[80:83], v[104:107], a[64:67], v[80:83]
    v_lshlrev_b32 v30, 16, v29
    v_mul_f32 v175, v175, v31
    v_mfma_f32_16x16x32_bf16 v[80:83], v[108:111], a[72:75], v[80:83]
    buffer_load_dwordx4 v[40:43], v136, s[44:47], s34 offen offset:0 sc1
    s_waitcnt lgkmcnt(0)
    v_mfma_f32_16x16x32_bf16 v[80:83], v[112:115], a[80:83], v[80:83]
    ds_read_b128 v[120:123], v14 offset:3072
    v_mfma_f32_16x16x32_bf16 v[80:83], v[116:119], a[88:91], v[80:83]
    ds_read_b128 v[124:127], v14 offset:7168
    v_mul_f32 v174, v174, v30
    v_mfma_f32_16x16x32_bf16 v[84:87], v[116:119], a[92:95], v[84:87]
    ds_read_b128 v[128:131], v14 offset:11264
    v_and_b32 v9, 0xffff0000, v190
    v_mfma_f32_16x16x32_bf16 v[84:87], v[112:115], a[84:87], v[84:87]
    ds_read_b128 v[132:135], v14 offset:15360
    buffer_load_dwordx4 v[44:47], v136, s[44:47], s34 offen offset:1024 sc1
    v_mfma_f32_16x16x32_bf16 v[84:87], v[108:111], a[76:79], v[84:87]
    v_lshlrev_b32 v8, 16, v190
    v_mfma_f32_16x16x32_bf16 v[84:87], v[104:107], a[68:71], v[84:87]
    s_waitcnt lgkmcnt(2)
    v_mfma_f32_16x16x32_bf16 v[76:79], v[120:123], a[100:103], v[76:79]
    buffer_load_dwordx4 v[48:51], v136, s[44:47], s34 offen offset:2048 sc1
    v_mul_f32 v177, v177, v9
    v_mfma_f32_16x16x32_bf16 v[76:79], v[124:127], a[108:111], v[76:79]
    s_waitcnt lgkmcnt(0)
    v_mfma_f32_16x16x32_bf16 v[76:79], v[128:131], a[116:119], v[76:79]
    s_waitcnt vmcnt(14)
    s_barrier
    v_mul_f32 v176, v176, v8
    v_mfma_f32_16x16x32_bf16 v[76:79], v[132:135], a[124:127], v[76:79]
    ds_read_b128 v[104:107], v14 offset:16384
    v_and_b32 v31, 0xffff0000, v191
    v_mfma_f32_16x16x32_bf16 v[72:75], v[132:135], a[120:123], v[72:75]
    ds_read_b128 v[108:111], v14 offset:20480
    buffer_load_dwordx4 v[204:207], v136, s[44:47], s35 offen offset:0 sc1
    v_mfma_f32_16x16x32_bf16 v[72:75], v[128:131], a[112:115], v[72:75]
    ds_read_b128 v[112:115], v14 offset:24576
    v_lshlrev_b32 v30, 16, v191
    v_mfma_f32_16x16x32_bf16 v[72:75], v[124:127], a[104:107], v[72:75]
    ds_read_b128 v[116:119], v14 offset:28672
    v_mul_f32 v179, v179, v31
    v_mfma_f32_16x16x32_bf16 v[72:75], v[120:123], a[96:99], v[72:75]
    buffer_load_dwordx4 v[208:211], v136, s[44:47], s35 offen offset:1024 sc1
    s_waitcnt lgkmcnt(2)
    v_mfma_f32_16x16x32_bf16 v[80:83], v[104:107], a[96:99], v[80:83]
    v_mfma_f32_16x16x32_bf16 v[80:83], v[108:111], a[104:107], v[80:83]
    v_mul_f32 v178, v178, v30
    s_waitcnt lgkmcnt(0)
    v_mfma_f32_16x16x32_bf16 v[80:83], v[112:115], a[112:115], v[80:83]
    ds_read_b128 v[120:123], v14 offset:17408
    buffer_load_dwordx4 v[212:215], v136, s[44:47], s35 offen offset:2048 sc1
    v_mfma_f32_16x16x32_bf16 v[80:83], v[116:119], a[120:123], v[80:83]
    ds_read_b128 v[124:127], v14 offset:21504
    v_and_b32 v9, 0xffff0000, v142
    v_mfma_f32_16x16x32_bf16 v[84:87], v[116:119], a[124:127], v[84:87]
    ds_read_b128 v[128:131], v14 offset:25600
    v_lshlrev_b32 v8, 16, v142
    v_mfma_f32_16x16x32_bf16 v[84:87], v[112:115], a[116:119], v[84:87]
    ds_read_b128 v[132:135], v14 offset:29696
    v_mfma_f32_16x16x32_bf16 v[84:87], v[108:111], a[108:111], v[84:87]
    buffer_load_dwordx4 v[216:219], v136, s[44:47], s35 offen offset:3072 sc1
    v_mul_f32 v181, v181, v9
    v_mfma_f32_16x16x32_bf16 v[84:87], v[104:107], a[100:103], v[84:87]
    s_waitcnt lgkmcnt(2)
    v_mfma_f32_16x16x32_bf16 v[76:79], v[120:123], a[132:135], v[76:79]
    v_mul_f32 v180, v180, v8
    v_mfma_f32_16x16x32_bf16 v[76:79], v[124:127], a[140:143], v[76:79]
    v_and_b32 v31, 0xffff0000, v143
    s_waitcnt lgkmcnt(0)
    v_mfma_f32_16x16x32_bf16 v[76:79], v[128:131], a[148:151], v[76:79]
    ds_read_b128 v[104:107], v14 offset:18432
    v_mfma_f32_16x16x32_bf16 v[76:79], v[132:135], a[156:159], v[76:79]
    ds_read_b128 v[108:111], v14 offset:22528
    v_lshlrev_b32 v30, 16, v143
    v_mfma_f32_16x16x32_bf16 v[72:75], v[132:135], a[152:155], v[72:75]
    ds_read_b128 v[112:115], v14 offset:26624
    v_mfma_f32_16x16x32_bf16 v[72:75], v[128:131], a[144:147], v[72:75]
    ds_read_b128 v[116:119], v14 offset:30720
    v_mul_f32 v183, v183, v31
    v_mfma_f32_16x16x32_bf16 v[72:75], v[124:127], a[136:139], v[72:75]
    v_mfma_f32_16x16x32_bf16 v[72:75], v[120:123], a[128:131], v[72:75]
    v_mul_f32 v182, v182, v30
    s_waitcnt lgkmcnt(2)
    v_mfma_f32_16x16x32_bf16 v[80:83], v[104:107], a[128:131], v[80:83]
    v_mfma_f32_16x16x32_bf16 v[80:83], v[108:111], a[136:139], v[80:83]
    s_waitcnt lgkmcnt(0)
    v_mfma_f32_16x16x32_bf16 v[80:83], v[112:115], a[144:147], v[80:83]
    ds_read_b128 v[120:123], v14 offset:19456
    v_mfma_f32_16x16x32_bf16 v[80:83], v[116:119], a[152:155], v[80:83]
    ds_read_b128 v[124:127], v14 offset:23552
    v_mfma_f32_16x16x32_bf16 v[84:87], v[116:119], a[156:159], v[84:87]
    ds_read_b128 v[128:131], v14 offset:27648
    v_mfma_f32_16x16x32_bf16 v[84:87], v[112:115], a[148:151], v[84:87]
    ds_read_b128 v[132:135], v14 offset:31744
    v_mfma_f32_16x16x32_bf16 v[84:87], v[108:111], a[140:143], v[84:87]
    v_mfma_f32_16x16x32_bf16 v[84:87], v[104:107], a[132:135], v[84:87]
    s_waitcnt lgkmcnt(2)
    v_mfma_f32_16x16x32_bf16 v[76:79], v[120:123], a[164:167], v[76:79]
    s_add_u32 m0, s73, 97792
    v_mfma_f32_16x16x32_bf16 v[76:79], v[124:127], a[172:175], v[76:79]
    buffer_load_dwordx4 v19, s[44:47], s18 offen offset:512 sc1 lds
    s_waitcnt lgkmcnt(0)
    v_mfma_f32_16x16x32_bf16 v[76:79], v[128:131], a[180:183], v[76:79]
    s_waitcnt vmcnt(15)
    s_barrier
    v_mfma_f32_16x16x32_bf16 v[76:79], v[132:135], a[188:191], v[76:79]
    ds_read_b128 v[104:107], v14 offset:32768
    v_mfma_f32_16x16x32_bf16 v[72:75], v[132:135], a[184:187], v[72:75]
    ds_read_b128 v[108:111], v14 offset:36864
    v_mfma_f32_16x16x32_bf16 v[72:75], v[128:131], a[176:179], v[72:75]
    ds_read_b128 v[112:115], v14 offset:40960
    v_mfma_f32_16x16x32_bf16 v[72:75], v[124:127], a[168:171], v[72:75]
    ds_read_b128 v[116:119], v14 offset:45056
    s_add_u32 m0, s73, 99328
    v_mfma_f32_16x16x32_bf16 v[72:75], v[120:123], a[160:163], v[72:75]
    buffer_load_dwordx4 v19, s[44:47], s19 offen offset:0 sc1 lds
    s_waitcnt lgkmcnt(2)
    v_mfma_f32_16x16x32_bf16 v[80:83], v[104:107], a[160:163], v[80:83]
    s_add_u32 m0, s73, 99840
    v_mfma_f32_16x16x32_bf16 v[80:83], v[108:111], a[168:171], v[80:83]
    buffer_load_dwordx4 v19, s[44:47], s19 offen offset:512 sc1 lds
    s_waitcnt lgkmcnt(0)
    v_mfma_f32_16x16x32_bf16 v[80:83], v[112:115], a[176:179], v[80:83]
    ds_read_b128 v[120:123], v14 offset:33792
    v_mfma_f32_16x16x32_bf16 v[80:83], v[116:119], a[184:187], v[80:83]
    ds_read_b128 v[124:127], v14 offset:37888
    v_mfma_f32_16x16x32_bf16 v[84:87], v[116:119], a[188:191], v[84:87]
    ds_read_b128 v[128:131], v14 offset:41984
    v_mfma_f32_16x16x32_bf16 v[84:87], v[112:115], a[180:183], v[84:87]
    ds_read_b128 v[132:135], v14 offset:46080
    v_mfma_f32_16x16x32_bf16 v[84:87], v[108:111], a[172:175], v[84:87]
    s_add_u32 m0, s73, 101376
    v_mfma_f32_16x16x32_bf16 v[84:87], v[104:107], a[164:167], v[84:87]
    buffer_load_dwordx4 v19, s[44:47], s20 offen offset:0 sc1 lds
    s_waitcnt lgkmcnt(2)
    v_mfma_f32_16x16x32_bf16 v[76:79], v[120:123], a[196:199], v[76:79]
    s_add_u32 m0, s73, 114176
    v_mov_b32 v141, 0
    v_mfma_f32_16x16x32_bf16 v[76:79], v[124:127], a[204:207], v[76:79]
    buffer_load_dwordx4 v19, s[44:47], s20 offen offset:512 sc1 lds
    s_waitcnt lgkmcnt(0)
    v_mfma_f32_16x16x32_bf16 v[76:79], v[128:131], a[212:215], v[76:79]
    ds_read_b128 v[104:107], v14 offset:34816
    v_mfma_f32_16x16x32_bf16 v[76:79], v[132:135], a[220:223], v[76:79]
    ds_read_b128 v[108:111], v14 offset:38912
    buffer_atomic_add v141, v139, s[44:47], s11 offen offset:2060 sc0 sc1
    v_mfma_f32_16x16x32_bf16 v[72:75], v[132:135], a[216:219], v[72:75]
    ds_read_b128 v[112:115], v14 offset:43008
    v_mfma_f32_16x16x32_bf16 v[72:75], v[128:131], a[208:211], v[72:75]
    ds_read_b128 v[116:119], v14 offset:47104
    v_mfma_f32_16x16x32_bf16 v[72:75], v[124:127], a[200:203], v[72:75]
    s_add_u32 m0, s73, 115712
    v_mfma_f32_16x16x32_bf16 v[72:75], v[120:123], a[192:195], v[72:75]
    buffer_load_dwordx4 v19, s[44:47], s21 offen offset:0 sc1 lds
    s_waitcnt lgkmcnt(2)
    v_mfma_f32_16x16x32_bf16 v[80:83], v[104:107], a[192:195], v[80:83]
    s_add_u32 m0, s73, 116224
    v_mfma_f32_16x16x32_bf16 v[80:83], v[108:111], a[200:203], v[80:83]
    buffer_load_dwordx4 v19, s[44:47], s21 offen offset:512 sc1 lds
    s_waitcnt lgkmcnt(0)
    v_mfma_f32_16x16x32_bf16 v[80:83], v[112:115], a[208:211], v[80:83]
    ds_read_b128 v[120:123], v14 offset:35840
    v_mfma_f32_16x16x32_bf16 v[80:83], v[116:119], a[216:219], v[80:83]
    ds_read_b128 v[124:127], v14 offset:39936
    v_mfma_f32_16x16x32_bf16 v[84:87], v[116:119], a[220:223], v[84:87]
    ds_read_b128 v[128:131], v14 offset:44032
    v_mfma_f32_16x16x32_bf16 v[84:87], v[112:115], a[212:215], v[84:87]
    ds_read_b128 v[132:135], v14 offset:48128
    v_mfma_f32_16x16x32_bf16 v[84:87], v[108:111], a[204:207], v[84:87]
    s_add_u32 m0, s73, 117760
    v_mfma_f32_16x16x32_bf16 v[84:87], v[104:107], a[196:199], v[84:87]
    buffer_load_dwordx4 v19, s[44:47], s22 offen offset:0 sc1 lds
    s_waitcnt lgkmcnt(2)
    v_mfma_f32_16x16x32_bf16 v[76:79], v[120:123], a[228:231], v[76:79]
    v_mfma_f32_16x16x32_bf16 v[76:79], v[124:127], a[236:239], v[76:79]
    s_waitcnt lgkmcnt(0)
    v_mfma_f32_16x16x32_bf16 v[76:79], v[128:131], a[244:247], v[76:79]
    s_waitcnt vmcnt(16)
    s_barrier
    v_mfma_f32_16x16x32_bf16 v[76:79], v[132:135], a[252:255], v[76:79]
    ds_read_b128 v[104:107], v14 offset:49152
    v_mfma_f32_16x16x32_bf16 v[72:75], v[132:135], a[248:251], v[72:75]
    ds_read_b128 v[108:111], v14 offset:53248
    v_mfma_f32_16x16x32_bf16 v[72:75], v[128:131], a[240:243], v[72:75]
    ds_read_b128 v[112:115], v14 offset:57344
    v_mfma_f32_16x16x32_bf16 v[72:75], v[124:127], a[232:235], v[72:75]
    ds_read_b128 v[116:119], v14 offset:61440
    v_mfma_f32_16x16x32_bf16 v[72:75], v[120:123], a[224:227], v[72:75]
    s_waitcnt lgkmcnt(2)
    v_mfma_f32_16x16x32_bf16 v[80:83], v[104:107], a[224:227], v[80:83]
    s_add_u32 m0, s73, 130560
    v_mfma_f32_16x16x32_bf16 v[80:83], v[108:111], a[232:235], v[80:83]
    buffer_load_dwordx4 v19, s[44:47], s22 offen offset:512 sc1 lds
    s_waitcnt lgkmcnt(0)
    v_mfma_f32_16x16x32_bf16 v[80:83], v[112:115], a[240:243], v[80:83]
    ds_read_b128 v[120:123], v14 offset:50176
    v_mfma_f32_16x16x32_bf16 v[80:83], v[116:119], a[248:251], v[80:83]
    ds_read_b128 v[124:127], v14 offset:54272
    v_mfma_f32_16x16x32_bf16 v[84:87], v[116:119], a[252:255], v[84:87]
    ds_read_b128 v[128:131], v14 offset:58368
    v_mfma_f32_16x16x32_bf16 v[84:87], v[112:115], a[244:247], v[84:87]
    ds_read_b128 v[132:135], v14 offset:62464
    v_mfma_f32_16x16x32_bf16 v[84:87], v[108:111], a[236:239], v[84:87]
    s_add_u32 m0, s73, 132096
    v_mfma_f32_16x16x32_bf16 v[84:87], v[104:107], a[228:231], v[84:87]
    buffer_load_dwordx4 v19, s[44:47], s23 offen offset:0 sc1 lds
    s_waitcnt lgkmcnt(2)
    v_mfma_f32_16x16x32_bf16 v[76:79], v[120:123], v[224:227], v[76:79]
    s_add_u32 m0, s73, 132608
    s_waitcnt vmcnt(15)
    v_bitop3_b32 v43, v43, v47, s68 bitop3:0x7e
    v_bitop3_b32 v43, v43, v51, s68 bitop3:0xf6
    v_cmp_ne_u32 vcc, 0, v43
    v_mfma_f32_16x16x32_bf16 v[76:79], v[124:127], v[232:235], v[76:79]
    buffer_load_dwordx4 v19, s[44:47], s23 offen offset:512 sc1 lds
    s_waitcnt lgkmcnt(0)
    v_mfma_f32_16x16x32_bf16 v[76:79], v[128:131], v[240:243], v[76:79]
    ds_read_b128 v[104:107], v14 offset:51200
    s_cbranch_vccnz L_xs_a
L_xo_a:
    v_and_b32 v89, 0xffff0000, v40
    v_mfma_f32_16x16x32_bf16 v[76:79], v[132:135], v[248:251], v[76:79]
    ds_read_b128 v[108:111], v14 offset:55296
    v_lshlrev_b32 v88, 16, v40
    v_mfma_f32_16x16x32_bf16 v[72:75], v[132:135], v[244:247], v[72:75]
    ds_read_b128 v[112:115], v14 offset:59392
    v_and_b32 v91, 0xffff0000, v41
    v_mfma_f32_16x16x32_bf16 v[72:75], v[128:131], v[236:239], v[72:75]
    ds_read_b128 v[116:119], v14 offset:63488
    v_lshlrev_b32 v90, 16, v41
    v_mfma_f32_16x16x32_bf16 v[72:75], v[124:127], v[228:231], v[72:75]
    s_add_u32 m0, s73, 134144
    v_and_b32 v93, 0xffff0000, v42
    v_lshlrev_b32 v92, 16, v42
    v_mfma_f32_16x16x32_bf16 v[72:75], v[120:123], v[220:223], v[72:75]
    buffer_load_dwordx4 v19, s[44:47], s24 offen offset:0 sc1 lds
    s_waitcnt lgkmcnt(2)
    v_mfma_f32_16x16x32_bf16 v[80:83], v[104:107], v[220:223], v[80:83]
    v_and_b32 v95, 0xffff0000, v44
    v_lshlrev_b32 v94, 16, v44
    v_mfma_f32_16x16x32_bf16 v[80:83], v[108:111], v[228:231], v[80:83]
    v_and_b32 v97, 0xffff0000, v45
L_pl_D_2:
    s_cbranch_execz L_wret
    s_waitcnt lgkmcnt(0)
    v_mfma_f32_16x16x32_bf16 v[80:83], v[112:115], v[236:239], v[80:83]
    ds_read_b128 v[120:123], v14 offset:52224
    v_lshlrev_b32 v96, 16, v45
    v_mfma_f32_16x16x32_bf16 v[80:83], v[116:119], v[244:247], v[80:83]
    ds_read_b128 v[124:127], v14 offset:56320
    v_and_b32 v99, 0xffff0000, v46
    v_lshlrev_b32 v98, 16, v46
    v_mfma_f32_16x16x32_bf16 v[84:87], v[116:119], v[248:251], v[84:87]
    ds_read_b128 v[128:131], v14 offset:60416
    s_waitcnt vmcnt(7)
    v_and_b32 v101, 0xffff0000, v48
    v_mfma_f32_16x16x32_bf16 v[84:87], v[112:115], v[240:243], v[84:87]
    ds_read_b128 v[132:135], v14 offset:64512
    v_lshlrev_b32 v100, 16, v48
    v_cmp_ne_u32 vcc, v140, v141
    v_mfma_f32_16x16x32_bf16 v[84:87], v[108:111], v[232:235], v[84:87]
    v_and_b32 v103, 0xffff0000, v49
    v_lshlrev_b32 v102, 16, v49
    v_mfma_f32_16x16x32_bf16 v[84:87], v[104:107], v[224:227], v[84:87]
    s_cbranch_vccnz L_as_b
L_ao_b:
    s_waitcnt lgkmcnt(2)
    v_mfma_f32_16x16x32_bf16 v[92:95], v[120:123], a[4:7], v[92:95]
    buffer_load_dwordx4 v[56:59], v136, s[44:47], s11 offen offset:0 sc1
    v_mfma_f32_16x16x32_bf16 v[92:95], v[124:127], a[12:15], v[92:95]
    s_waitcnt lgkmcnt(0)
    v_mfma_f32_16x16x32_bf16 v[92:95], v[128:131], a[20:23], v[92:95]
    buffer_load_dwordx4 v[60:63], v136, s[44:47], s11 offen offset:1024 sc1
    s_barrier
    v_mfma_f32_16x16x32_bf16 v[92:95], v[132:135], a[28:31], v[92:95]
    ds_read_b128 v[104:107], v14 offset:0
    buffer_load_dwordx4 v[64:67], v136, s[44:47], s11 offen offset:2048 sc1
    v_mfma_f32_16x16x32_bf16 v[88:91], v[132:135], a[24:27], v[88:91]
    ds_read_b128 v[108:111], v14 offset:4096
    v_cvt_pk_bf16_f32 v192, v72, v73
    v_mfma_f32_16x16x32_bf16 v[88:91], v[128:131], a[16:19], v[88:91]
    ds_read_b128 v[112:115], v14 offset:8192
    v_cvt_pk_bf16_f32 v193, v74, v75
    v_mfma_f32_16x16x32_bf16 v[88:91], v[124:127], a[8:11], v[88:91]
    ds_read_b128 v[116:119], v14 offset:12288
    v_cvt_pk_bf16_f32 v194, v76, v77
    v_mfma_f32_16x16x32_bf16 v[88:91], v[120:123], a[0:3], v[88:91]
    buffer_store_dwordx4 v[192:195], v136, s[44:47], s31 offen offset:0 sc1
    s_waitcnt lgkmcnt(2)
    v_mfma_f32_16x16x32_bf16 v[96:99], v[104:107], a[0:3], v[96:99]
    s_add_u32 m0, s73, 146944
    v_cvt_pk_bf16_f32 v196, v78, v79
    v_cvt_pk_bf16_f32 v197, v80, v81
    v_mfma_f32_16x16x32_bf16 v[96:99], v[108:111], a[8:11], v[96:99]
    buffer_load_dwordx4 v19, s[44:47], s24 offen offset:512 sc1 lds
    s_waitcnt lgkmcnt(0)
    v_mfma_f32_16x16x32_bf16 v[96:99], v[112:115], a[16:19], v[96:99]
    ds_read_b128 v[120:123], v14 offset:1024
    v_cvt_pk_bf16_f32 v198, v82, v83
    v_mfma_f32_16x16x32_bf16 v[96:99], v[116:119], a[24:27], v[96:99]
    buffer_store_dwordx4 v[196:199], v136, s[44:47], s31 offen offset:1024 sc1
    ds_read_b128 v[124:127], v14 offset:5120
    v_bitop3_b32 v207, v207, v211, s36 bitop3:0x7e
    v_bitop3_b32 v207, v207, v215, s36 bitop3:0xf6
    v_mfma_f32_16x16x32_bf16 v[100:103], v[116:119], a[28:31], v[100:103]
    ds_read_b128 v[128:131], v14 offset:9216
    v_cvt_pk_bf16_f32 v200, v84, v85
    v_mfma_f32_16x16x32_bf16 v[100:103], v[112:115], a[20:23], v[100:103]
    ds_read_b128 v[132:135], v14 offset:13312
    v_cvt_pk_bf16_f32 v201, v86, v87
    v_mfma_f32_16x16x32_bf16 v[100:103], v[108:111], a[12:15], v[100:103]
    buffer_store_dwordx4 v[200:203], v136, s[44:47], s31 offen offset:2048 sc1
    s_add_u32 m0, s73, 148480
    v_bitop3_b32 v207, v207, v219, s36 bitop3:0xf6
    v_cmp_ne_u32 vcc, 0, v207
    v_mfma_f32_16x16x32_bf16 v[100:103], v[104:107], a[4:7], v[100:103]
    buffer_load_dwordx4 v19, s[44:47], s25 offen offset:0 sc1 lds
    s_waitcnt lgkmcnt(2)
    v_mfma_f32_16x16x32_bf16 v[92:95], v[120:123], a[36:39], v[92:95]
    s_add_u32 m0, s73, 148992
    s_cbranch_vccnz L_xs_8
L_xo_8:
    v_mfma_f32_16x16x32_bf16 v[92:95], v[124:127], a[44:47], v[92:95]
    buffer_load_dwordx4 v19, s[44:47], s25 offen offset:512 sc1 lds
    s_waitcnt lgkmcnt(0)
    v_mfma_f32_16x16x32_bf16 v[92:95], v[128:131], a[52:55], v[92:95]
    ds_read_b128 v[104:107], v14 offset:2048
    v_and_b32 v33, 0xffff0000, v204
    v_mfma_f32_16x16x32_bf16 v[92:95], v[132:135], a[60:63], v[92:95]
    ds_read_b128 v[108:111], v14 offset:6144
    v_lshlrev_b32 v32, 16, v204
    v_mfma_f32_16x16x32_bf16 v[88:91], v[132:135], a[56:59], v[88:91]
    ds_read_b128 v[112:115], v14 offset:10240
    v_and_b32 v35, 0xffff0000, v205
    v_mfma_f32_16x16x32_bf16 v[88:91], v[128:131], a[48:51], v[88:91]
    ds_read_b128 v[116:119], v14 offset:14336
    v_mfma_f32_16x16x32_bf16 v[88:91], v[124:127], a[40:43], v[88:91]
    s_add_u32 m0, s73, 150528
    v_lshlrev_b32 v34, 16, v205
    v_mfma_f32_16x16x32_bf16 v[88:91], v[120:123], a[32:35], v[88:91]
    buffer_load_dwordx4 v19, s[44:47], s26 offen offset:0 sc1 lds
    s_waitcnt lgkmcnt(2)
    v_mfma_f32_16x16x32_bf16 v[96:99], v[104:107], a[32:35], v[96:99]
    v_add_f32 v32, v32, v27
    v_mfma_f32_16x16x32_bf16 v[96:99], v[108:111], a[40:43], v[96:99]
    v_add_f32 v33, v33, v27
    s_waitcnt lgkmcnt(0)
    v_mfma_f32_16x16x32_bf16 v[96:99], v[112:115], a[48:51], v[96:99]
    ds_read_b128 v[120:123], v14 offset:3072
    v_add_f32 v34, v34, v27
    v_mfma_f32_16x16x32_bf16 v[96:99], v[116:119], a[56:59], v[96:99]
    ds_read_b128 v[124:127], v14 offset:7168
    v_mfma_f32_16x16x32_bf16 v[100:103], v[116:119], a[60:63], v[100:103]
    ds_read_b128 v[128:131], v14 offset:11264
    v_add_f32 v35, v35, v27
    v_mfma_f32_16x16x32_bf16 v[100:103], v[112:115], a[52:55], v[100:103]
    ds_read_b128 v[132:135], v14 offset:15360
    v_and_b32 v37, 0xffff0000, v208
    v_mfma_f32_16x16x32_bf16 v[100:103], v[108:111], a[44:47], v[100:103]
    v_mfma_f32_16x16x32_bf16 v[100:103], v[104:107], a[36:39], v[100:103]
    v_lshlrev_b32 v36, 16, v208
    s_waitcnt lgkmcnt(2)
    v_mfma_f32_16x16x32_bf16 v[92:95], v[120:123], a[68:71], v[92:95]
    v_and_b32 v39, 0xffff0000, v209
    v_mfma_f32_16x16x32_bf16 v[92:95], v[124:127], a[76:79], v[92:95]
    s_waitcnt lgkmcnt(0)
    v_mfma_f32_16x16x32_bf16 v[92:95], v[128:131], a[84:87], v[92:95]
    s_waitcnt vmcnt(14)
    s_barrier
    v_lshlrev_b32 v38, 16, v209
    v_mfma_f32_16x16x32_bf16 v[92:95], v[132:135], a[92:95], v[92:95]
    ds_read_b128 v[104:107], v14 offset:16384
    v_add_f32 v32, v32, v36
    v_mfma_f32_16x16x32_bf16 v[88:91], v[132:135], a[88:91], v[88:91]
    ds_read_b128 v[108:111], v14 offset:20480
    v_mfma_f32_16x16x32_bf16 v[88:91], v[128:131], a[80:83], v[88:91]
    ds_read_b128 v[112:115], v14 offset:24576
    v_add_f32 v33, v33, v37
    v_mfma_f32_16x16x32_bf16 v[88:91], v[124:127], a[72:75], v[88:91]
    ds_read_b128 v[116:119], v14 offset:28672
    v_add_f32 v34, v34, v38
    v_mfma_f32_16x16x32_bf16 v[88:91], v[120:123], a[64:67], v[88:91]
    s_waitcnt lgkmcnt(2)
    v_mfma_f32_16x16x32_bf16 v[96:99], v[104:107], a[64:67], v[96:99]
    s_add_u32 m0, s73, 97792
    v_add_f32 v35, v35, v39
    v_mfma_f32_16x16x32_bf16 v[96:99], v[108:111], a[72:75], v[96:99]
    buffer_load_dwordx4 v19, s[44:47], s26 offen offset:512 sc1 lds
    s_waitcnt lgkmcnt(0)
    v_mfma_f32_16x16x32_bf16 v[96:99], v[112:115], a[80:83], v[96:99]
    ds_read_b128 v[120:123], v14 offset:17408
    v_and_b32 v37, 0xffff0000, v212
    v_mfma_f32_16x16x32_bf16 v[96:99], v[116:119], a[88:91], v[96:99]
    ds_read_b128 v[124:127], v14 offset:21504
    v_lshlrev_b32 v36, 16, v212
    v_mfma_f32_16x16x32_bf16 v[100:103], v[116:119], a[92:95], v[100:103]
    ds_read_b128 v[128:131], v14 offset:25600
    v_and_b32 v39, 0xffff0000, v213
    v_mfma_f32_16x16x32_bf16 v[100:103], v[112:115], a[84:87], v[100:103]
    ds_read_b128 v[132:135], v14 offset:29696
    v_mfma_f32_16x16x32_bf16 v[100:103], v[108:111], a[76:79], v[100:103]
    v_lshlrev_b32 v38, 16, v213
    v_mfma_f32_16x16x32_bf16 v[100:103], v[104:107], a[68:71], v[100:103]
    v_add_f32 v32, v32, v36
    s_waitcnt lgkmcnt(2)
    v_mfma_f32_16x16x32_bf16 v[92:95], v[120:123], a[100:103], v[92:95]
    v_mfma_f32_16x16x32_bf16 v[92:95], v[124:127], a[108:111], v[92:95]
    v_add_f32 v33, v33, v37
    s_waitcnt lgkmcnt(0)
    v_mfma_f32_16x16x32_bf16 v[92:95], v[128:131], a[116:119], v[92:95]
    ds_read_b128 v[104:107], v14 offset:18432
    v_add_f32 v34, v34, v38
    v_mfma_f32_16x16x32_bf16 v[92:95], v[132:135], a[124:127], v[92:95]
    ds_read_b128 v[108:111], v14 offset:22528
    v_add_f32 v35, v35, v39
    v_mfma_f32_16x16x32_bf16 v[88:91], v[132:135], a[120:123], v[88:91]
    ds_read_b128 v[112:115], v14 offset:26624
    v_and_b32 v37, 0xffff0000, v216
    v_mfma_f32_16x16x32_bf16 v[88:91], v[128:131], a[112:115], v[88:91]
    ds_read_b128 v[116:119], v14 offset:30720
    v_lshlrev_b32 v36, 16, v216
    v_mfma_f32_16x16x32_bf16 v[88:91], v[124:127], a[104:107], v[88:91]
    v_and_b32 v39, 0xffff0000, v217
    v_lshlrev_b32 v38, 16, v217
    v_mfma_f32_16x16x32_bf16 v[88:91], v[120:123], a[96:99], v[88:91]
    v_add_f32 v32, v32, v36
    s_waitcnt lgkmcnt(2)
    v_mfma_f32_16x16x32_bf16 v[96:99], v[104:107], a[96:99], v[96:99]
    v_add_f32 v33, v33, v37
    v_add_f32 v34, v34, v38
    v_mfma_f32_16x16x32_bf16 v[96:99], v[108:111], a[104:107], v[96:99]
    v_add_f32 v35, v35, v39
    s_waitcnt lgkmcnt(0)
    v_mfma_f32_16x16x32_bf16 v[96:99], v[112:115], a[112:115], v[96:99]
    ds_read_b128 v[120:123], v14 offset:19456
    v_mul_f32 v36, s38, v32
    v_mfma_f32_16x16x32_bf16 v[96:99], v[116:119], a[120:123], v[96:99]
    ds_read_b128 v[124:127], v14 offset:23552
    v_mul_f32 v37, s38, v33
    v_mfma_f32_16x16x32_bf16 v[100:103], v[116:119], a[124:127], v[100:103]
    ds_read_b128 v[128:131], v14 offset:27648
    v_mul_f32 v38, s38, v34
    v_mfma_f32_16x16x32_bf16 v[100:103], v[112:115], a[116:119], v[100:103]
    ds_read_b128 v[132:135], v14 offset:31744
    v_mul_f32 v39, s38, v35
    v_mfma_f32_16x16x32_bf16 v[100:103], v[108:111], a[108:111], v[100:103]
    v_exp_f32 v36, v36
    v_mfma_f32_16x16x32_bf16 v[100:103], v[104:107], a[100:103], v[100:103]
    s_waitcnt lgkmcnt(2)
    v_mfma_f32_16x16x32_bf16 v[92:95], v[120:123], a[132:135], v[92:95]
    v_exp_f32 v37, v37
    v_mfma_f32_16x16x32_bf16 v[92:95], v[124:127], a[140:143], v[92:95]
    s_waitcnt lgkmcnt(0)
    v_mfma_f32_16x16x32_bf16 v[92:95], v[128:131], a[148:151], v[92:95]
    s_waitcnt vmcnt(11)
    s_barrier
    v_mfma_f32_16x16x32_bf16 v[92:95], v[132:135], a[156:159], v[92:95]
    ds_read_b128 v[104:107], v14 offset:32768
    v_mfma_f32_16x16x32_bf16 v[88:91], v[132:135], a[152:155], v[88:91]
    ds_read_b128 v[108:111], v14 offset:36864
    v_exp_f32 v38, v38
    v_mfma_f32_16x16x32_bf16 v[88:91], v[128:131], a[144:147], v[88:91]
    ds_read_b128 v[112:115], v14 offset:40960
    v_exp_f32 v39, v39
    v_mfma_f32_16x16x32_bf16 v[88:91], v[124:127], a[136:139], v[88:91]
    ds_read_b128 v[116:119], v14 offset:45056
    v_mul_f32 v180, v180, v32
    v_mfma_f32_16x16x32_bf16 v[88:91], v[120:123], a[128:131], v[88:91]
    v_mul_f32 v181, v181, v33
    s_waitcnt lgkmcnt(2)
    v_mfma_f32_16x16x32_bf16 v[96:99], v[104:107], a[128:131], v[96:99]
    v_mul_f32 v182, v182, v34
    v_mul_f32 v183, v183, v35
    v_mfma_f32_16x16x32_bf16 v[96:99], v[108:111], a[136:139], v[96:99]
    v_add_f32 v36, 1.0, v36
    s_waitcnt lgkmcnt(0)
    v_mfma_f32_16x16x32_bf16 v[96:99], v[112:115], a[144:147], v[96:99]
    ds_read_b128 v[120:123], v14 offset:33792
    v_add_f32 v37, 1.0, v37
    v_mfma_f32_16x16x32_bf16 v[96:99], v[116:119], a[152:155], v[96:99]
    ds_read_b128 v[124:127], v14 offset:37888
    v_add_f32 v38, 1.0, v38
    v_mfma_f32_16x16x32_bf16 v[100:103], v[116:119], a[156:159], v[100:103]
    ds_read_b128 v[128:131], v14 offset:41984
    v_add_f32 v39, 1.0, v39
    v_mfma_f32_16x16x32_bf16 v[100:103], v[112:115], a[148:151], v[100:103]
    ds_read_b128 v[132:135], v14 offset:46080
    v_rcp_f32 v36, v36
    v_mfma_f32_16x16x32_bf16 v[100:103], v[108:111], a[140:143], v[100:103]
    v_rcp_f32 v37, v37
    v_mfma_f32_16x16x32_bf16 v[100:103], v[104:107], a[132:135], v[100:103]
    v_rcp_f32 v38, v38
    s_waitcnt lgkmcnt(2)
    v_mfma_f32_16x16x32_bf16 v[92:95], v[120:123], a[164:167], v[92:95]
    s_waitcnt vmcnt(8)
    v_bitop3_b32 v59, v59, v63, s68 bitop3:0x7e
    v_rcp_f32 v39, v39
    v_mfma_f32_16x16x32_bf16 v[92:95], v[124:127], a[172:175], v[92:95]
    buffer_load_dwordx4 v[72:75], v136, s[44:47], s12 offen offset:0 sc1
    s_waitcnt lgkmcnt(0)
    v_mfma_f32_16x16x32_bf16 v[92:95], v[128:131], a[180:183], v[92:95]
    ds_read_b128 v[104:107], v14 offset:34816
    v_bitop3_b32 v59, v59, v67, s68 bitop3:0xf6
    v_mfma_f32_16x16x32_bf16 v[92:95], v[132:135], a[188:191], v[92:95]
    ds_read_b128 v[108:111], v14 offset:38912
    v_cmp_ne_u32 vcc, 0, v59
    v_mfma_f32_16x16x32_bf16 v[88:91], v[132:135], a[184:187], v[88:91]
    ds_read_b128 v[112:115], v14 offset:43008
    buffer_load_dwordx4 v[76:79], v136, s[44:47], s12 offen offset:1024 sc1
    v_mfma_f32_16x16x32_bf16 v[88:91], v[128:131], a[176:179], v[88:91]
    ds_read_b128 v[116:119], v14 offset:47104
    s_cbranch_vccnz L_xs_b
L_xo_b:
    v_fma_f32 v180, v180, v36, v160
    v_mfma_f32_16x16x32_bf16 v[88:91], v[124:127], a[168:171], v[88:91]
    buffer_load_dwordx4 v[80:83], v136, s[44:47], s12 offen offset:2048 sc1
    v_and_b32 v41, 0xffff0000, v56
    v_mfma_f32_16x16x32_bf16 v[88:91], v[120:123], a[160:163], v[88:91]
    v_lshlrev_b32 v40, 16, v56
    s_waitcnt lgkmcnt(2)
    v_mfma_f32_16x16x32_bf16 v[96:99], v[104:107], a[160:163], v[96:99]
    v_and_b32 v43, 0xffff0000, v57
    v_fma_f32 v181, v181, v37, v161
    v_mfma_f32_16x16x32_bf16 v[96:99], v[108:111], a[168:171], v[96:99]
    v_lshlrev_b32 v42, 16, v57
    s_waitcnt lgkmcnt(0)
    v_mfma_f32_16x16x32_bf16 v[96:99], v[112:115], a[176:179], v[96:99]
    ds_read_b128 v[120:123], v14 offset:35840
    v_and_b32 v45, 0xffff0000, v58
    v_mfma_f32_16x16x32_bf16 v[96:99], v[116:119], a[184:187], v[96:99]
    ds_read_b128 v[124:127], v14 offset:39936
    v_fma_f32 v182, v182, v38, v162
    v_mfma_f32_16x16x32_bf16 v[100:103], v[116:119], a[188:191], v[100:103]
    ds_read_b128 v[128:131], v14 offset:44032
    v_lshlrev_b32 v44, 16, v58
    v_mfma_f32_16x16x32_bf16 v[100:103], v[112:115], a[180:183], v[100:103]
    ds_read_b128 v[132:135], v14 offset:48128
    v_and_b32 v47, 0xffff0000, v60
    v_mfma_f32_16x16x32_bf16 v[100:103], v[108:111], a[172:175], v[100:103]
    v_lshlrev_b32 v46, 16, v60
    v_fma_f32 v183, v183, v39, v163
    v_mfma_f32_16x16x32_bf16 v[100:103], v[104:107], a[164:167], v[100:103]
    v_and_b32 v49, 0xffff0000, v61
    s_waitcnt lgkmcnt(2)
    v_mfma_f32_16x16x32_bf16 v[92:95], v[120:123], a[196:199], v[92:95]
    v_lshlrev_b32 v48, 16, v61
    v_cvt_pk_bf16_f32 v142, v180, v181
    v_mfma_f32_16x16x32_bf16 v[92:95], v[124:127], a[204:207], v[92:95]
    v_and_b32 v51, 0xffff0000, v62
    s_waitcnt lgkmcnt(0)
    v_mfma_f32_16x16x32_bf16 v[92:95], v[128:131], a[212:215], v[92:95]
    s_waitcnt vmcnt(4)
    s_barrier
    v_lshlrev_b32 v50, 16, v62
    v_mfma_f32_16x16x32_bf16 v[92:95], v[132:135], a[220:223], v[92:95]
    ds_read_b128 v[104:107], v14 offset:49152
    v_cvt_pk_bf16_f32 v143, v182, v183
    v_mfma_f32_16x16x32_bf16 v[88:91], v[132:135], a[216:219], v[88:91]
    ds_read_b128 v[108:111], v14 offset:53248
    v_and_b32 v53, 0xffff0000, v64
    v_mfma_f32_16x16x32_bf16 v[88:91], v[128:131], a[208:211], v[88:91]
    ds_read_b128 v[112:115], v14 offset:57344
    v_lshlrev_b32 v52, 16, v64
    v_mfma_f32_16x16x32_bf16 v[88:91], v[124:127], a[200:203], v[88:91]
    ds_read_b128 v[116:119], v14 offset:61440
    v_and_b32 v55, 0xffff0000, v65
    v_mfma_f32_16x16x32_bf16 v[88:91], v[120:123], a[192:195], v[88:91]
    v_lshlrev_b32 v54, 16, v65
    s_waitcnt lgkmcnt(2)
    v_mfma_f32_16x16x32_bf16 v[96:99], v[104:107], a[192:195], v[96:99]
    v_mfma_f32_16x16x32_bf16 v[96:99], v[108:111], a[200:203], v[96:99]
    s_waitcnt lgkmcnt(0)
    v_mfma_f32_16x16x32_bf16 v[96:99], v[112:115], a[208:211], v[96:99]
    ds_read_b128 v[120:123], v14 offset:50176
    v_add_f32 v92, v92, v44
    v_add_f32 v93, v93, v45
    v_mfma_f32_16x16x32_bf16 v[96:99], v[116:119], a[216:219], v[96:99]
    ds_read_b128 v[124:127], v14 offset:54272
    v_add_f32 v94, v94, v46
    v_mfma_f32_16x16x32_bf16 v[100:103], v[116:119], a[220:223], v[100:103]
    ds_read_b128 v[128:131], v14 offset:58368
    v_add_f32 v95, v95, v47
    v_add_f32 v88, v88, v40
    v_mfma_f32_16x16x32_bf16 v[100:103], v[112:115], a[212:215], v[100:103]
    ds_read_b128 v[132:135], v14 offset:62464
    v_add_f32 v89, v89, v41
    v_mfma_f32_16x16x32_bf16 v[100:103], v[108:111], a[204:207], v[100:103]
    v_add_f32 v90, v90, v42
    v_add_f32 v91, v91, v43
    v_mfma_f32_16x16x32_bf16 v[100:103], v[104:107], a[196:199], v[100:103]
    s_waitcnt lgkmcnt(2)
    v_mfma_f32_16x16x32_bf16 v[92:95], v[120:123], a[228:231], v[92:95]
    v_mfma_f32_16x16x32_bf16 v[92:95], v[124:127], a[236:239], v[92:95]
    s_waitcnt lgkmcnt(0)
    v_mfma_f32_16x16x32_bf16 v[92:95], v[128:131], a[244:247], v[92:95]
    ds_read_b128 v[104:107], v14 offset:51200
    v_add_f32 v96, v96, v48
    v_add_f32 v97, v97, v49
    v_mfma_f32_16x16x32_bf16 v[92:95], v[132:135], a[252:255], v[92:95]
    ds_read_b128 v[108:111], v14 offset:55296
    v_add_f32 v98, v98, v50
    v_mfma_f32_16x16x32_bf16 v[88:91], v[132:135], a[248:251], v[88:91]
    ds_read_b128 v[112:115], v14 offset:59392
    v_add_f32 v99, v99, v51
    v_add_f32 v100, v100, v52
    v_mfma_f32_16x16x32_bf16 v[88:91], v[128:131], a[240:243], v[88:91]
    ds_read_b128 v[116:119], v14 offset:63488
    v_add_f32 v101, v101, v53
    v_mfma_f32_16x16x32_bf16 v[88:91], v[124:127], a[232:235], v[88:91]
    v_add_f32 v102, v102, v54
    v_add_f32 v103, v103, v55
    v_mfma_f32_16x16x32_bf16 v[88:91], v[120:123], a[224:227], v[88:91]
    s_waitcnt lgkmcnt(2)
    v_mfma_f32_16x16x32_bf16 v[96:99], v[104:107], a[224:227], v[96:99]
    v_mfma_f32_16x16x32_bf16 v[96:99], v[108:111], a[232:235], v[96:99]
    s_waitcnt lgkmcnt(0)
    v_mfma_f32_16x16x32_bf16 v[96:99], v[112:115], a[240:243], v[96:99]
    ds_read_b128 v[120:123], v14 offset:52224
    v_mfma_f32_16x16x32_bf16 v[96:99], v[116:119], a[248:251], v[96:99]
    ds_read_b128 v[124:127], v14 offset:56320
    v_mfma_f32_16x16x32_bf16 v[100:103], v[116:119], a[252:255], v[100:103]
    buffer_store_dwordx2 v[142:143], v253, s[64:67], 0 offen sc1
    ds_read_b128 v[128:131], v14 offset:60416
    v_mfma_f32_16x16x32_bf16 v[100:103], v[112:115], a[244:247], v[100:103]
    ds_read_b128 v[132:135], v14 offset:64512
    v_mfma_f32_16x16x32_bf16 v[100:103], v[108:111], a[236:239], v[100:103]
    v_mfma_f32_16x16x32_bf16 v[100:103], v[104:107], a[228:231], v[100:103]
    s_waitcnt lgkmcnt(2)
    v_mfma_f32_16x16x32_bf16 v[92:95], v[120:123], v[224:227], v[92:95]
    v_mfma_f32_16x16x32_bf16 v[92:95], v[124:127], v[232:235], v[92:95]
    s_waitcnt lgkmcnt(0)
    v_mfma_f32_16x16x32_bf16 v[92:95], v[128:131], v[240:243], v[92:95]
    s_waitcnt vmcnt(4)
    s_barrier
    v_mfma_f32_16x16x32_bf16 v[92:95], v[132:135], v[248:251], v[92:95]
    ds_read_b128 v[104:107], v14 offset:0
    v_mfma_f32_16x16x32_bf16 v[88:91], v[132:135], v[244:247], v[88:91]
    ds_read_b128 v[108:111], v14 offset:4096
    v_mfma_f32_16x16x32_bf16 v[88:91], v[128:131], v[236:239], v[88:91]
    ds_read_b128 v[112:115], v14 offset:8192
    v_mfma_f32_16x16x32_bf16 v[88:91], v[124:127], v[228:231], v[88:91]
    ds_read_b128 v[116:119], v14 offset:12288
    v_mfma_f32_16x16x32_bf16 v[88:91], v[120:123], v[220:223], v[88:91]
    s_waitcnt lgkmcnt(2)
    v_mfma_f32_16x16x32_bf16 v[96:99], v[104:107], v[220:223], v[96:99]
    v_mfma_f32_16x16x32_bf16 v[96:99], v[108:111], v[228:231], v[96:99]
    s_waitcnt lgkmcnt(0)
    v_mfma_f32_16x16x32_bf16 v[96:99], v[112:115], v[236:239], v[96:99]
    v_mfma_f32_16x16x32_bf16 v[96:99], v[116:119], v[244:247], v[96:99]
    v_mfma_f32_16x16x32_bf16 v[100:103], v[116:119], v[248:251], v[100:103]
    v_mfma_f32_16x16x32_bf16 v[100:103], v[112:115], v[240:243], v[100:103]
    v_mfma_f32_16x16x32_bf16 v[100:103], v[108:111], v[232:235], v[100:103]
    v_mfma_f32_16x16x32_bf16 v[100:103], v[104:107], v[224:227], v[100:103]
    s_waitcnt vmcnt(1)
    v_bitop3_b32 v75, v75, v79, s68 bitop3:0x7e
    v_bitop3_b32 v75, v75, v83, s68 bitop3:0xf6
    v_cmp_ne_u32 vcc, 0, v75
    s_cbranch_vccnz L_xs_z
L_xo_z:
    v_and_b32 v41, 0xffff0000, v72
    v_lshlrev_b32 v40, 16, v72
    v_and_b32 v43, 0xffff0000, v73
    v_lshlrev_b32 v42, 16, v73
    v_and_b32 v45, 0xffff0000, v74
    v_lshlrev_b32 v44, 16, v74
    v_and_b32 v47, 0xffff0000, v76
    v_lshlrev_b32 v46, 16, v76
    v_and_b32 v49, 0xffff0000, v77
    v_lshlrev_b32 v48, 16, v77
    v_and_b32 v51, 0xffff0000, v78
    v_lshlrev_b32 v50, 16, v78
    v_and_b32 v53, 0xffff0000, v80
    v_lshlrev_b32 v52, 16, v80
    v_and_b32 v55, 0xffff0000, v81
    v_lshlrev_b32 v54, 16, v81
    v_pk_add_f32 v[88:89], v[88:89], v[40:41]
    v_pk_add_f32 v[90:91], v[90:91], v[42:43]
    v_pk_add_f32 v[96:97], v[96:97], v[48:49]
    v_pk_add_f32 v[98:99], v[98:99], v[50:51]
    v_pk_mul_f32 v[56:57], v[88:89], s[38:39] op_sel_hi:[1,0]
    v_pk_mul_f32 v[58:59], v[90:91], s[38:39] op_sel_hi:[1,0]
    v_pk_mul_f32 v[64:65], v[96:97], s[38:39] op_sel_hi:[1,0]
    v_pk_mul_f32 v[66:67], v[98:99], s[38:39] op_sel_hi:[1,0]
    v_exp_f32 v56, v56
    v_exp_f32 v57, v57
    v_exp_f32 v58, v58
    v_exp_f32 v59, v59
    v_exp_f32 v64, v64
    v_exp_f32 v65, v65
    v_exp_f32 v66, v66
    v_exp_f32 v67, v67
    v_pk_mul_f32 v[164:165], v[164:165], v[88:89]
    v_pk_mul_f32 v[166:167], v[166:167], v[90:91]
    v_pk_mul_f32 v[172:173], v[172:173], v[96:97]
    v_pk_mul_f32 v[174:175], v[174:175], v[98:99]
    v_pk_add_f32 v[56:57], v[56:57], 1.0 op_sel_hi:[1,0]
    v_pk_add_f32 v[58:59], v[58:59], 1.0 op_sel_hi:[1,0]
    v_pk_add_f32 v[64:65], v[64:65], 1.0 op_sel_hi:[1,0]
    v_pk_add_f32 v[66:67], v[66:67], 1.0 op_sel_hi:[1,0]
    v_rcp_f32 v56, v56
    v_rcp_f32 v57, v57
    v_rcp_f32 v58, v58
    v_rcp_f32 v59, v59
    v_rcp_f32 v64, v64
    v_rcp_f32 v65, v65
    v_rcp_f32 v66, v66
    v_rcp_f32 v67, v67
    v_pk_fma_f32 v[164:165], v[164:165], v[56:57], v[144:145]
    v_pk_fma_f32 v[166:167], v[166:167], v[58:59], v[146:147]
    v_pk_fma_f32 v[172:173], v[172:173], v[64:65], v[152:153]
    v_pk_fma_f32 v[174:175], v[174:175], v[66:67], v[154:155]
    v_cvt_pk_bf16_f32 v88, v164, v165
    v_cvt_pk_bf16_f32 v90, v172, v173
    v_cvt_pk_bf16_f32 v89, v166, v167
    v_cvt_pk_bf16_f32 v91, v174, v175
    v_permlane16_swap_b32 v88, v90
    s_nop 0
    v_permlane16_swap_b32 v89, v91
    buffer_store_dwordx4 v[88:91], v252, s[64:67], 0 offen sc1
    v_pk_add_f32 v[92:93], v[92:93], v[44:45]
    v_pk_add_f32 v[94:95], v[94:95], v[46:47]
    v_pk_add_f32 v[100:101], v[100:101], v[52:53]
    v_pk_add_f32 v[102:103], v[102:103], v[54:55]
    v_pk_mul_f32 v[60:61], v[92:93], s[38:39] op_sel_hi:[1,0]
    v_pk_mul_f32 v[62:63], v[94:95], s[38:39] op_sel_hi:[1,0]
    v_pk_mul_f32 v[68:69], v[100:101], s[38:39] op_sel_hi:[1,0]
    v_pk_mul_f32 v[70:71], v[102:103], s[38:39] op_sel_hi:[1,0]
    v_exp_f32 v60, v60
    v_exp_f32 v61, v61
    v_exp_f32 v62, v62
    v_exp_f32 v63, v63
    v_exp_f32 v68, v68
    v_exp_f32 v69, v69
    v_exp_f32 v70, v70
    v_exp_f32 v71, v71
    v_pk_mul_f32 v[168:169], v[168:169], v[92:93]
    v_pk_mul_f32 v[170:171], v[170:171], v[94:95]
    v_pk_mul_f32 v[176:177], v[176:177], v[100:101]
    v_pk_mul_f32 v[178:179], v[178:179], v[102:103]
    v_pk_add_f32 v[60:61], v[60:61], 1.0 op_sel_hi:[1,0]
    v_pk_add_f32 v[62:63], v[62:63], 1.0 op_sel_hi:[1,0]
    v_pk_add_f32 v[68:69], v[68:69], 1.0 op_sel_hi:[1,0]
    v_pk_add_f32 v[70:71], v[70:71], 1.0 op_sel_hi:[1,0]
    v_rcp_f32 v60, v60
    v_rcp_f32 v61, v61
    v_rcp_f32 v62, v62
    v_rcp_f32 v63, v63
    v_rcp_f32 v68, v68
    v_rcp_f32 v69, v69
    v_rcp_f32 v70, v70
    v_rcp_f32 v71, v71
    v_pk_fma_f32 v[168:169], v[168:169], v[60:61], v[148:149]
    v_pk_fma_f32 v[170:171], v[170:171], v[62:63], v[150:151]
    v_pk_fma_f32 v[176:177], v[176:177], v[68:69], v[156:157]
    v_pk_fma_f32 v[178:179], v[178:179], v[70:71], v[158:159]
    v_cvt_pk_bf16_f32 v92, v168, v169
    v_cvt_pk_bf16_f32 v94, v176, v177
    v_cvt_pk_bf16_f32 v93, v170, v171
    v_cvt_pk_bf16_f32 v95, v178, v179
    v_permlane16_swap_b32 v92, v94
    s_nop 0
    v_permlane16_swap_b32 v93, v95
    buffer_store_dwordx4 v[92:95], v252, s[64:67], s40 offen sc1
    s_endpgm
L_segE:
.p2align 12
L_aux:
    s_bfe_u32 s101, s2, 0x20003
    s_mul_i32 s101, s101, 3
    s_mul_i32 s84, s101, 305844
    s_lshr_b32 s84, s84, 18
    s_add_u32 s84, s84, 0
    s_add_u32 s85, s84, 1
    s_cmp_eq_u32 s85, 14
    s_cselect_b32 s85, 0, s85
    s_add_u32 s86, s85, 1
    s_cmp_eq_u32 s86, 14
    s_cselect_b32 s86, 0, s86
    s_add_u32 s87, s86, 1
    s_cmp_eq_u32 s87, 14
    s_cselect_b32 s87, 0, s87
    s_add_u32 s88, s87, 1
    s_cmp_eq_u32 s88, 14
    s_cselect_b32 s88, 0, s88
    s_add_u32 s89, s88, 1
    s_cmp_eq_u32 s89, 14
    s_cselect_b32 s89, 0, s89
    s_add_u32 s90, s89, 1
    s_cmp_eq_u32 s90, 14
    s_cselect_b32 s90, 0, s90
    s_add_u32 s91, s90, 1
    s_cmp_eq_u32 s91, 14
    s_cselect_b32 s91, 0, s91
    s_add_u32 s92, s91, 1
    s_cmp_eq_u32 s92, 14
    s_cselect_b32 s92, 0, s92
    s_add_u32 s93, s92, 1
    s_cmp_eq_u32 s93, 14
    s_cselect_b32 s93, 0, s93
    s_add_u32 s94, s93, 1
    s_cmp_eq_u32 s94, 14
    s_cselect_b32 s94, 0, s94
    s_add_u32 s95, s94, 1
    s_cmp_eq_u32 s95, 14
    s_cselect_b32 s95, 0, s95
    s_add_u32 s96, s95, 1
    s_cmp_eq_u32 s96, 14
    s_cselect_b32 s96, 0, s96
    s_add_u32 s97, s96, 1
    s_cmp_eq_u32 s97, 14
    s_cselect_b32 s97, 0, s97
    s_mul_i32 s98, s101, 87384
    s_lshr_b32 s98, s98, 18
    s_add_u32 s98, s98, 14
    s_add_u32 s99, s98, 1
    s_cmp_eq_u32 s99, 18
    s_cselect_b32 s99, 14, s99
    s_add_u32 s100, s99, 1
    s_cmp_eq_u32 s100, 18
    s_cselect_b32 s100, 14, s100
    s_add_u32 s101, s100, 1
    s_cmp_eq_u32 s101, 18
    s_cselect_b32 s101, 14, s101
    s_lshl2_add_u32 s7, s5, s6
    s_add_u32 s7, s7, 188
    s_add_u32 s8, s5, 248
    s_cmp_eq_u32 s6, 27
    s_cselect_b32 s75, s8, s7
    s_mov_b32 s48, s24
    s_and_b32 s49, s25, 0xffff
    s_mov_b32 s50, 2359296
    s_mov_b32 s51, 0x20000
    v_lshlrev_b32 v240, 4, v2
    s_mul_i32 s74, s3, 16640
    s_add_u32 s74, s74, 73728
    s_sub_u32 s69, s75, 216
    s_lshl_b32 s70, s69, 4
    s_add_u32 s70, s70, s3
    s_lshl_b32 s12, s70, 12
    s_lshl_b32 s70, s70, 1
    s_mov_b32 s9, 144896
    s_mov_b32 s11, 8192
    v_mul_u32_u24 v48, 1216, v3
    v_mad_u32_u24 v48, v4, 12, v48
    v_add_u32 v48, s9, v48
    v_mov_b32 v47, 0x40000000
    v_lshlrev_b32 v3, 3, v3
    s_lshl_b32 s5, s68, 6
    s_add_u32 s5, s5, 12386304
    v_cmp_eq_u32 vcc, 0, v4
    s_nop 1
    v_cndmask_b32 v49, v47, v3, vcc
    v_lshrrev_b32 v5, 4, v0
    v_and_b32 v4, 3, v2
    v_lshlrev_b32 v4, 3, v4
    v_lshl_add_u32 v5, v5, 5, v4
    v_bfe_u32 v6, v2, 2, 2
    v_mul_u32_u24 v4, 1216, v6
    v_mul_u32_u24 v6, 1152, v6
    v_add3_u32 v50, v4, v5, s9
    v_add3_u32 v51, v6, v5, s11
    s_mul_i32 s4, s3, 2176
    v_add_u32 v55, s4, v51
    v_lshlrev_b32 v52, 4, v0
    s_add_u32 s7, s15, 4096
    s_add_u32 s8, s15, 8192
    s_cmp_eq_u32 s3, 0
    s_cselect_b32 s8, s8, 0x40000000
    v_add_u32 v53, 2359296, v52
    v_mov_b32 v54, 0
    v_add_u32 v4, 0, v52
    v_lshrrev_b32 v5, 7, v4
    v_mul_u32_u24 v6, 9363, v5
    v_lshrrev_b32 v6, 16, v6
    v_mad_i32_i24 v5, v6, -7, v5
    v_cmp_lt_u32 vcc, 2, v5
    s_nop 1
    v_addc_co_u32 v6, vcc, 0, v6, vcc
    v_lshl_add_u32 v93, v6, 7, v4
    v_add_u32 v4, 4096, v52
    v_lshrrev_b32 v5, 7, v4
    v_mul_u32_u24 v6, 9363, v5
    v_lshrrev_b32 v6, 16, v6
    v_mad_i32_i24 v5, v6, -7, v5
    v_cmp_lt_u32 vcc, 2, v5
    s_nop 1
    v_addc_co_u32 v6, vcc, 0, v6, vcc
    v_lshl_add_u32 v94, v6, 7, v4
    v_add_u32 v4, 8192, v52
    v_lshrrev_b32 v5, 7, v4
    v_mul_u32_u24 v6, 9363, v5
    v_lshrrev_b32 v6, 16, v6
    v_mad_i32_i24 v5, v6, -7, v5
    v_cmp_lt_u32 vcc, 2, v5
    s_nop 1
    v_addc_co_u32 v6, vcc, 0, v6, vcc
    v_lshl_add_u32 v95, v6, 7, v4
    s_mul_i32 s10, s68, 11264
    s_add_u32 s10, s10, 36585472
    s_cmp_eq_u32 s3, 0
    s_cselect_b32 s83, s10, 0x40000000
    s_add_u32 s7, s10, 2883584
    s_add_u32 s8, s83, 2883584
    s_mul_i32 s4, s3, 1028
    s_sub_u32 s4, 8204, s4
    v_add_u32 v90, s4, v53
    s_bfe_u32 s6, s68, 0x20001
    s_lshl_b32 s6, s6, 6
    s_lshr_b32 s9, s68, 3
    s_lshl1_add_u32 s6, s9, s6
    s_and_b32 s9, s68, 1
    s_add_u32 s6, s6, s9
    s_lshl_b32 s4, s6, 2
    s_add_u32 s4, s4, 12533760
    v_lshl_add_u32 v1, v0, 10, s4
    s_lshl_b32 s4, s68, 2
    s_add_u32 s4, s4, 12599296
    v_lshl_add_u32 v46, v0, 10, s4
    v_cmp_gt_u32 vcc, 8, v0
    s_nop 1
    v_cndmask_b32 v1, v47, v1, vcc
    v_cmp_gt_u32 vcc, 4, v0
    s_nop 1
    v_cndmask_b32 v46, v47, v46, vcc
    s_waitcnt vmcnt(9)
    v_and_b32 v21, 0xffff0000, v8
    v_lshlrev_b32 v20, 16, v8
    v_and_b32 v23, 0xffff0000, v9
    v_lshlrev_b32 v22, 16, v9
    v_and_b32 v25, 0xffff0000, v10
    v_lshlrev_b32 v24, 16, v10
    v_and_b32 v27, 0xffff0000, v12
    v_lshlrev_b32 v26, 16, v12
    v_and_b32 v29, 0xffff0000, v13
    v_lshlrev_b32 v28, 16, v13
    v_and_b32 v31, 0xffff0000, v14
    v_lshlrev_b32 v30, 16, v14
    v_and_b32 v33, 0xffff0000, v16
    v_lshlrev_b32 v32, 16, v16
    v_and_b32 v35, 0xffff0000, v17
    v_lshlrev_b32 v34, 16, v17
    v_and_b32 v37, 0xffff0000, v18
    v_lshlrev_b32 v36, 16, v18
    v_pk_add_f32 v[38:39], v[20:21], v[22:23]
    v_pk_add_f32 v[40:41], v[24:25], v[26:27]
    v_pk_add_f32 v[42:43], v[28:29], v[30:31]
    v_pk_add_f32 v[44:45], v[32:33], v[34:35]
    v_pk_add_f32 v[38:39], v[38:39], v[40:41]
    v_pk_add_f32 v[42:43], v[42:43], v[44:45]
    v_pk_add_f32 v[38:39], v[38:39], v[36:37]
    v_pk_add_f32 v[38:39], v[38:39], v[42:43]
    v_add_f32 v56, v38, v39
    s_nop 1
    v_add_f32_dpp v56, v56, v56 row_ror:8 row_mask:0xf bank_mask:0xf
    s_nop 1
    v_add_f32_dpp v56, v56, v56 row_ror:4 row_mask:0xf bank_mask:0xf
    s_nop 1
    v_add_f32_dpp v56, v56, v56 row_ror:2 row_mask:0xf bank_mask:0xf
    s_nop 1
    v_add_f32_dpp v56, v56, v56 row_ror:1 row_mask:0xf bank_mask:0xf
    v_mov_b32 v57, v56
    s_nop 1
    v_permlane16_swap_b32 v56, v57
    v_add_f32 v56, v56, v57
    v_mul_f32 v56, 0x3ae38e39, v56
    v_pk_add_f32 v[20:21], v[20:21], v[56:57] op_sel_hi:[1,0] neg_lo:[0,1] neg_hi:[0,1]
    v_pk_add_f32 v[22:23], v[22:23], v[56:57] op_sel_hi:[1,0] neg_lo:[0,1] neg_hi:[0,1]
    v_pk_add_f32 v[24:25], v[24:25], v[56:57] op_sel_hi:[1,0] neg_lo:[0,1] neg_hi:[0,1]
    v_pk_add_f32 v[26:27], v[26:27], v[56:57] op_sel_hi:[1,0] neg_lo:[0,1] neg_hi:[0,1]
    v_pk_add_f32 v[28:29], v[28:29], v[56:57] op_sel_hi:[1,0] neg_lo:[0,1] neg_hi:[0,1]
    v_pk_add_f32 v[30:31], v[30:31], v[56:57] op_sel_hi:[1,0] neg_lo:[0,1] neg_hi:[0,1]
    v_pk_add_f32 v[32:33], v[32:33], v[56:57] op_sel_hi:[1,0] neg_lo:[0,1] neg_hi:[0,1]
    v_pk_add_f32 v[34:35], v[34:35], v[56:57] op_sel_hi:[1,0] neg_lo:[0,1] neg_hi:[0,1]
    v_pk_add_f32 v[36:37], v[36:37], v[56:57] op_sel_hi:[1,0] neg_lo:[0,1] neg_hi:[0,1]
    v_pk_mul_f32 v[38:39], v[20:21], v[20:21]
    v_pk_mul_f32 v[40:41], v[22:23], v[22:23]
    v_pk_fma_f32 v[38:39], v[24:25], v[24:25], v[38:39]
    v_pk_fma_f32 v[40:41], v[26:27], v[26:27], v[40:41]
    v_pk_fma_f32 v[38:39], v[28:29], v[28:29], v[38:39]
    v_pk_fma_f32 v[40:41], v[30:31], v[30:31], v[40:41]
    v_pk_fma_f32 v[38:39], v[32:33], v[32:33], v[38:39]
    v_pk_fma_f32 v[40:41], v[34:35], v[34:35], v[40:41]
    v_pk_fma_f32 v[38:39], v[36:37], v[36:37], v[38:39]
    v_pk_add_f32 v[38:39], v[38:39], v[40:41]
    v_add_f32 v18, v38, v39
    s_nop 1
    v_add_f32_dpp v18, v18, v18 row_ror:8 row_mask:0xf bank_mask:0xf
    s_nop 1
    v_add_f32_dpp v18, v18, v18 row_ror:4 row_mask:0xf bank_mask:0xf
    s_nop 1
    v_add_f32_dpp v18, v18, v18 row_ror:2 row_mask:0xf bank_mask:0xf
    s_nop 1
    v_add_f32_dpp v18, v18, v18 row_ror:1 row_mask:0xf bank_mask:0xf
    v_mov_b32 v19, v18
    s_nop 1
    v_permlane16_swap_b32 v18, v19
    v_add_f32 v18, v18, v19
    v_mul_f32 v18, 0x3ae38e39, v18
    v_cvt_pk_bf16_f32 v38, v56, v18
    v_lshlrev_b32 v106, 16, v38
    v_and_b32 v38, 0xffff0000, v38
    v_add_f32 v38, 0x3727c5ac, v38
    v_sub_f32 v56, v56, v106
    v_cvt_pk_bf16_f32 v38, v38, v38
    v_lshlrev_b32 v38, 16, v38
    v_sqrt_f32 v38, v38
    s_nop 0
    v_cvt_pk_bf16_f32 v38, v38, v38
    v_lshlrev_b32 v38, 16, v38
    v_rcp_f32 v107, v38
    s_nop 0
    v_mul_f32 v56, v56, v107
    v_mul_f32 v18, v18, v107
    v_mul_f32 v18, v18, v107
    v_cvt_pk_bf16_f32 v38, v56, v18
    v_lshlrev_b32 v39, 16, v38
    v_and_b32 v38, 0xffff0000, v38
    v_add_f32 v38, 0x3727c5ac, v38
    v_sub_f32 v56, v56, v39
    v_cvt_pk_bf16_f32 v38, v38, v38
    v_lshlrev_b32 v38, 16, v38
    v_sqrt_f32 v38, v38
    s_nop 0
    v_cvt_pk_bf16_f32 v38, v38, v38
    v_lshlrev_b32 v38, 16, v38
    v_rcp_f32 v38, v38
    s_nop 0
    v_mul_f32 v18, v107, v38
    v_mul_f32 v56, v56, v38
    v_pk_fma_f32 v[20:21], v[20:21], v[18:19], v[56:57] op_sel_hi:[1,0,0]
    v_pk_fma_f32 v[22:23], v[22:23], v[18:19], v[56:57] op_sel_hi:[1,0,0]
    v_pk_fma_f32 v[24:25], v[24:25], v[18:19], v[56:57] op_sel_hi:[1,0,0]
    v_pk_fma_f32 v[26:27], v[26:27], v[18:19], v[56:57] op_sel_hi:[1,0,0]
    v_pk_fma_f32 v[28:29], v[28:29], v[18:19], v[56:57] op_sel_hi:[1,0,0]
    v_pk_fma_f32 v[30:31], v[30:31], v[18:19], v[56:57] op_sel_hi:[1,0,0]
    v_pk_fma_f32 v[32:33], v[32:33], v[18:19], v[56:57] op_sel_hi:[1,0,0]
    v_pk_fma_f32 v[34:35], v[34:35], v[18:19], v[56:57] op_sel_hi:[1,0,0]
    v_pk_fma_f32 v[36:37], v[36:37], v[18:19], v[56:57] op_sel_hi:[1,0,0]
    v_cvt_pk_bf16_f32 v8, v20, v21
    v_cvt_pk_bf16_f32 v9, v22, v23
    v_cvt_pk_bf16_f32 v10, v24, v25
    v_cvt_pk_bf16_f32 v11, v26, v27
    v_cvt_pk_bf16_f32 v12, v28, v29
    v_cvt_pk_bf16_f32 v13, v30, v31
    v_cvt_pk_bf16_f32 v14, v32, v33
    v_cvt_pk_bf16_f32 v15, v34, v35
    v_cvt_pk_bf16_f32 v16, v36, v37
    ds_write_b32 v48, v8 offset:0
    ds_write_b32 v48, v9 offset:4
    ds_write_b32 v48, v10 offset:8
    ds_write_b32 v48, v11 offset:384
    ds_write_b32 v48, v12 offset:388
    ds_write_b32 v48, v13 offset:392
    ds_write_b32 v48, v14 offset:768
    ds_write_b32 v48, v15 offset:772
    ds_write_b32 v48, v16 offset:776
    buffer_store_dwordx2 v[106:107], v49, s[44:47], s5 offen sc1
    s_waitcnt lgkmcnt(0)
    s_barrier
    ds_read_b64_tr_b16 v[20:21], v50 offset:0
    ds_read_b64_tr_b16 v[22:23], v50 offset:4864
    ds_read_b64_tr_b16 v[24:25], v50 offset:512
    ds_read_b64_tr_b16 v[26:27], v50 offset:5376
    ds_read_b64_tr_b16 v[28:29], v50 offset:1024
    ds_read_b64_tr_b16 v[30:31], v50 offset:5888
    s_waitcnt lgkmcnt(4)
    buffer_store_dwordx4 v[20:23], v93, s[44:47], s10 offen sc1
    s_waitcnt lgkmcnt(2)
    buffer_store_dwordx4 v[24:27], v94, s[44:47], s10 offen sc1
    s_waitcnt lgkmcnt(0)
    buffer_store_dwordx4 v[28:31], v95, s[44:47], s83 offen sc1
    buffer_load_dword v45, v54, s[64:67], 0 offen sc1
    s_waitcnt vmcnt(5)
    s_barrier
    ds_read_b64_tr_b16 v[60:61], v51 offset:0
    ds_read_b64_tr_b16 v[62:63], v51 offset:4608
    ds_read_b64_tr_b16 v[64:65], v51 offset:9216
    ds_read_b64_tr_b16 v[66:67], v51 offset:12672
    ds_read_b64_tr_b16 v[68:69], v51 offset:17280
    ds_read_b64_tr_b16 v[70:71], v51 offset:512
    ds_read_b64_tr_b16 v[72:73], v51 offset:5120
    ds_read_b64_tr_b16 v[74:75], v51 offset:9728
    ds_read_b64_tr_b16 v[76:77], v51 offset:13184
    ds_read_b64_tr_b16 v[78:79], v51 offset:17792
    v_alignbit_b32 v114, v99, v99, 16
    v_alignbit_b32 v115, v98, v98, 16
    s_waitcnt lgkmcnt(5)
    v_alignbit_b32 v108, v61, v60, 16
    v_alignbit_b32 v109, v62, v61, 16
    v_alignbit_b32 v110, v63, v62, 16
    v_alignbit_b32 v111, v64, v63, 16
    v_alignbit_b32 v112, v65, v64, 16
    v_dot2_f32_bf16 v116, v60, v114, 0
    ds_read_b64_tr_b16 v[80:81], v51 offset:1024
    v_dot2_f32_bf16 v117, v108, v114, 0
    v_dot2_f32_bf16 v118, v61, v114, 0
    v_dot2_f32_bf16 v119, v109, v114, 0
    v_dot2_f32_bf16 v120, v62, v114, 0
    ds_read_b64_tr_b16 v[82:83], v51 offset:5632
    v_dot2_f32_bf16 v121, v110, v114, 0
    v_dot2_f32_bf16 v122, v63, v114, 0
    v_dot2_f32_bf16 v123, v111, v114, 0
    v_dot2_f32_bf16 v116, v61, v115, v116
    v_dot2_f32_bf16 v117, v109, v115, v117
    ds_read_b64_tr_b16 v[84:85], v51 offset:10240
    v_dot2_f32_bf16 v118, v62, v115, v118
    v_dot2_f32_bf16 v119, v110, v115, v119
    v_dot2_f32_bf16 v120, v63, v115, v120
    v_dot2_f32_bf16 v121, v111, v115, v121
    v_dot2_f32_bf16 v122, v64, v115, v122
    ds_read_b64_tr_b16 v[86:87], v51 offset:13696
    v_dot2_f32_bf16 v123, v112, v115, v123
    v_and_b32 v133, 0xffff0000, v66
    v_lshlrev_b32 v132, 16, v66
    v_and_b32 v135, 0xffff0000, v67
    v_lshlrev_b32 v134, 16, v67
    ds_read_b64_tr_b16 v[88:89], v51 offset:18304
    v_and_b32 v137, 0xffff0000, v68
    v_lshlrev_b32 v136, 16, v68
    v_and_b32 v139, 0xffff0000, v69
    v_lshlrev_b32 v138, 16, v69
    v_pk_mul_f32 v[116:117], v[116:117], v[132:133]
    v_pk_mul_f32 v[118:119], v[118:119], v[134:135]
    v_pk_mul_f32 v[120:121], v[120:121], v[136:137]
    v_pk_mul_f32 v[122:123], v[122:123], v[138:139]
    v_cvt_pk_bf16_f32 v160, v123, v122
    v_cvt_pk_bf16_f32 v161, v121, v120
    v_cvt_pk_bf16_f32 v162, v119, v118
    v_cvt_pk_bf16_f32 v163, v117, v116
    buffer_store_dwordx4 v[160:163], v93, s[44:47], s7 offen sc1
    v_alignbit_b32 v114, v101, v101, 16
    v_alignbit_b32 v115, v100, v100, 16
    s_waitcnt lgkmcnt(5)
    v_alignbit_b32 v108, v71, v70, 16
    v_alignbit_b32 v109, v72, v71, 16
    v_alignbit_b32 v110, v73, v72, 16
    v_alignbit_b32 v111, v74, v73, 16
    v_alignbit_b32 v112, v75, v74, 16
    v_dot2_f32_bf16 v124, v70, v114, 0
    v_dot2_f32_bf16 v125, v108, v114, 0
    v_dot2_f32_bf16 v126, v71, v114, 0
    v_dot2_f32_bf16 v127, v109, v114, 0
    v_dot2_f32_bf16 v128, v72, v114, 0
    v_dot2_f32_bf16 v129, v110, v114, 0
    v_dot2_f32_bf16 v130, v73, v114, 0
    v_dot2_f32_bf16 v131, v111, v114, 0
    v_dot2_f32_bf16 v124, v71, v115, v124
    v_dot2_f32_bf16 v125, v109, v115, v125
    v_dot2_f32_bf16 v126, v72, v115, v126
    v_dot2_f32_bf16 v127, v110, v115, v127
    v_dot2_f32_bf16 v128, v73, v115, v128
    v_dot2_f32_bf16 v129, v111, v115, v129
    v_dot2_f32_bf16 v130, v74, v115, v130
    v_dot2_f32_bf16 v131, v112, v115, v131
    v_and_b32 v133, 0xffff0000, v76
    v_lshlrev_b32 v132, 16, v76
    v_and_b32 v135, 0xffff0000, v77
    v_lshlrev_b32 v134, 16, v77
    v_and_b32 v137, 0xffff0000, v78
    v_lshlrev_b32 v136, 16, v78
    v_and_b32 v139, 0xffff0000, v79
    v_lshlrev_b32 v138, 16, v79
    v_pk_mul_f32 v[124:125], v[124:125], v[132:133]
    v_pk_mul_f32 v[126:127], v[126:127], v[134:135]
    v_pk_mul_f32 v[128:129], v[128:129], v[136:137]
    v_pk_mul_f32 v[130:131], v[130:131], v[138:139]
    v_cvt_pk_bf16_f32 v164, v131, v130
    v_cvt_pk_bf16_f32 v165, v129, v128
    v_cvt_pk_bf16_f32 v166, v127, v126
    v_cvt_pk_bf16_f32 v167, v125, v124
    buffer_store_dwordx4 v[164:167], v94, s[44:47], s7 offen sc1
    v_alignbit_b32 v114, v103, v103, 16
    v_alignbit_b32 v115, v102, v102, 16
    s_waitcnt lgkmcnt(0)
    v_alignbit_b32 v108, v81, v80, 16
    v_alignbit_b32 v109, v82, v81, 16
    v_alignbit_b32 v110, v83, v82, 16
    v_alignbit_b32 v111, v84, v83, 16
    v_alignbit_b32 v112, v85, v84, 16
    v_dot2_f32_bf16 v116, v80, v114, 0
    v_dot2_f32_bf16 v117, v108, v114, 0
    v_dot2_f32_bf16 v118, v81, v114, 0
    v_dot2_f32_bf16 v119, v109, v114, 0
    v_dot2_f32_bf16 v120, v82, v114, 0
    v_dot2_f32_bf16 v121, v110, v114, 0
    v_dot2_f32_bf16 v122, v83, v114, 0
    v_dot2_f32_bf16 v123, v111, v114, 0
    v_dot2_f32_bf16 v116, v81, v115, v116
    v_dot2_f32_bf16 v117, v109, v115, v117
    v_dot2_f32_bf16 v118, v82, v115, v118
    v_dot2_f32_bf16 v119, v110, v115, v119
    v_dot2_f32_bf16 v120, v83, v115, v120
    v_dot2_f32_bf16 v121, v111, v115, v121
    v_dot2_f32_bf16 v122, v84, v115, v122
    v_dot2_f32_bf16 v123, v112, v115, v123
    v_and_b32 v133, 0xffff0000, v86
    v_lshlrev_b32 v132, 16, v86
    v_and_b32 v135, 0xffff0000, v87
    v_lshlrev_b32 v134, 16, v87
    v_and_b32 v137, 0xffff0000, v88
    v_lshlrev_b32 v136, 16, v88
    v_and_b32 v139, 0xffff0000, v89
    v_lshlrev_b32 v138, 16, v89
    v_pk_mul_f32 v[116:117], v[116:117], v[132:133]
    v_pk_mul_f32 v[118:119], v[118:119], v[134:135]
    v_pk_mul_f32 v[120:121], v[120:121], v[136:137]
    v_pk_mul_f32 v[122:123], v[122:123], v[138:139]
    v_cvt_pk_bf16_f32 v168, v123, v122
    v_cvt_pk_bf16_f32 v169, v121, v120
    v_cvt_pk_bf16_f32 v170, v119, v118
    v_cvt_pk_bf16_f32 v171, v117, v116
    buffer_store_dwordx4 v[168:171], v95, s[44:47], s8 offen sc1
    s_add_u32 m0, s74, 32
    s_add_u32 s13, s12, 0
    buffer_load_dwordx4 v240, s[48:51], s13 offen offset:0 lds
    buffer_load_dwordx4 v240, s[48:51], s13 offen offset:1024 lds
    buffer_load_dwordx4 v240, s[48:51], s13 offen offset:2048 lds
    buffer_load_dwordx4 v240, s[48:51], s13 offen offset:3072 lds
    s_add_u32 m0, s74, 8352
    s_add_u32 s13, s12, 16384
    buffer_load_dwordx4 v240, s[48:51], s13 offen offset:0 lds
    buffer_load_dwordx4 v240, s[48:51], s13 offen offset:1024 lds
    buffer_load_dwordx4 v240, s[48:51], s13 offen offset:2048 lds
    buffer_load_dwordx4 v240, s[48:51], s13 offen offset:3072 lds
    s_mov_b64 exec, 0
    s_call_b64 s[82:83], L_wc_X
    s_mov_b64 exec, -1
    s_waitcnt vmcnt(11)
    v_readfirstlane_b32 s68, v45
    s_nop 1
    s_cmp_eq_u32 s68, 0
    s_cbranch_scc1 L_nw_X
L_ng_X:
    s_barrier
    v_mov_b32 v3, s68
    buffer_store_dword v3, v1, s[44:47], 0 offen sc1
    s_waitcnt vmcnt(9)
    s_barrier
    buffer_store_dword v3, v46, s[44:47], 0 offen sc1
L_segX:
L_pl_X_0:
    s_cbranch_execz L_pl_X_4
    s_cmp_lt_u32 s75, 252
    s_cbranch_scc0 L_idle
    s_mov_b32 s56, s26
    s_and_b32 s57, s27, 0xffff
    s_mov_b32 s58, 1152
    s_mov_b32 s59, 0x20000
    v_mov_b32 v9, 0
    buffer_load_ushort v9, v9, s[56:59], s70 offen
    s_lshr_b32 s4, s2, 1
    s_and_b32 s4, s4, 3
    s_lshl2_add_u32 s4, s4, s3
    s_lshl_b32 s4, s4, 8
    s_add_u32 s4, s4, 12599296
    v_lshl_add_u32 v28, v2, 2, s4
    v_add_u32 v241, s74, v240
    v_cmp_eq_u32 vcc, 0, v2
    v_mov_b32 v196, 4136
    s_nop 0
    v_cndmask_b32 v196, v196, 30, vcc
    v_add_u32 v242, s74, v196
    v_bfe_u32 v196, v2, 3, 2
    v_mul_u32_u24 v196, 4160, v196
    v_and_b32 v197, 7, v2
    v_lshl_add_u32 v196, v197, 2, v196
    v_add_u32 v200, s74, v196
    v_mov_b32 v196, 0
    v_mov_b32 v197, 0
    v_mov_b32 v198, 0
    v_mov_b32 v199, 0
    ds_write_b32 v200, v196
    v_lshlrev_b32 v201, 4, v0
    ds_write_b128 v201, v[196:199]
    ds_write_b128 v201, v[196:199] offset:36864
    s_waitcnt vmcnt(7)
    ds_read_b128 v[212:215], v241 offset:32
    ds_read_b32 v216, v241 offset:48
    ds_read_b128 v[218:221], v241 offset:1056
    ds_read_b32 v222, v241 offset:1072
    ds_read_b128 v[224:227], v241 offset:2080
    ds_read_b32 v228, v241 offset:2096
    ds_read_b128 v[230:233], v241 offset:3104
    ds_read_b32 v234, v241 offset:3120
    v_lshrrev_b32 v202, 3, v2
    v_and_b32 v203, 7, v2
    v_lshrrev_b32 v204, 1, v202
    v_xor_b32 v203, v203, v204
    v_mul_u32_u24 v202, 11264, v202
    v_lshl_add_u32 v15, v203, 4, v202
    v_xor_b32 v16, 64, v15
    v_and_b32 v202, 15, v2
    v_add_u32 v202, 1, v202
    v_and_b32 v203, 1, v202
    v_mul_u32_u24 v203, 4160, v203
    v_lshrrev_b32 v202, 1, v202
    v_lshl_add_u32 v203, v202, 2, v203
    v_lshrrev_b32 v204, 4, v2
    v_lshl_add_u32 v203, v204, 4, v203
    v_add_u32 v236, s74, v203
    v_add_u32 v237, 1024, v236
    v_add_u32 v238, 1024, v237
    v_add_u32 v239, 1024, v238
    s_waitcnt lgkmcnt(0)
    s_waitcnt vmcnt(0)
    v_lshlrev_b32 v9, 16, v9
    v_lshlrev_b32 v208, 16, v212
    v_add_f32 v9, v9, v208
    v_cvt_pk_bf16_f32 v9, v9, v9
    ds_write_b16 v242, v9 offset:4160
    ds_write_b16 v242, v9 offset:2
    v_alignbit_b32 v212, v213, v212, 16
    v_alignbit_b32 v213, v214, v213, 16
    v_alignbit_b32 v214, v215, v214, 16
    v_alignbit_b32 v215, v216, v215, 16
    ds_write_b128 v241, v[212:215] offset:4192
    v_alignbit_b32 v218, v219, v218, 16
    v_alignbit_b32 v219, v220, v219, 16
    v_alignbit_b32 v220, v221, v220, 16
    v_alignbit_b32 v221, v222, v221, 16
    ds_write_b128 v241, v[218:221] offset:5216
    v_alignbit_b32 v224, v225, v224, 16
    v_alignbit_b32 v225, v226, v225, 16
    v_alignbit_b32 v226, v227, v226, 16
    v_alignbit_b32 v227, v228, v227, 16
    ds_write_b128 v241, v[224:227] offset:6240
    v_alignbit_b32 v230, v231, v230, 16
    v_alignbit_b32 v231, v232, v231, 16
    v_alignbit_b32 v232, v233, v232, 16
    v_alignbit_b32 v233, v234, v233, 16
    ds_write_b128 v241, v[230:233] offset:7264
    v_and_b32 v202, 15, v2
    v_lshlrev_b32 v202, 1, v202
    v_sub_u32 v202, v202, v204
    v_add_u32 v202, 17, v202
    v_bfe_u32 v203, v202, 1, 3
    v_xor_b32 v203, s3, v203
    v_lshlrev_b32 v203, 4, v203
    v_lshl_add_u32 v244, v202, 7, v203
    v_and_b32 v202, 15, v2
    v_lshlrev_b32 v202, 1, v202
    v_sub_u32 v202, v202, v204
    v_add_u32 v202, 13, v202
    v_bfe_u32 v203, v202, 1, 3
    v_xor_b32 v203, s3, v203
    v_lshlrev_b32 v203, 4, v203
    v_lshl_add_u32 v245, v202, 7, v203
    v_and_b32 v202, 15, v2
    v_lshlrev_b32 v202, 1, v202
    v_sub_u32 v202, v202, v204
    v_add_u32 v202, 9, v202
    v_bfe_u32 v203, v202, 1, 3
    v_xor_b32 v203, s3, v203
    v_lshlrev_b32 v203, 4, v203
    v_lshl_add_u32 v246, v202, 7, v203
    v_and_b32 v202, 15, v2
    v_lshlrev_b32 v202, 1, v202
    v_sub_u32 v202, v202, v204
    v_add_u32 v202, 5, v202
    v_bfe_u32 v203, v202, 1, 3
    v_xor_b32 v203, s3, v203
    v_lshlrev_b32 v203, 4, v203
    v_lshl_add_u32 v247, v202, 7, v203
    v_and_b32 v202, 15, v2
    v_lshlrev_b32 v202, 5, v202
    v_lshl_add_u32 v8, v204, 3, v202
    s_mul_i32 s7, s3, 589824
    s_lshl_b32 s8, s69, 8
    s_add_u32 s7, s7, s8
    s_add_u32 s10, s7, 2359296
    s_lshl_b32 s9, s3, 13
    s_add_u32 s9, s9, 4096
    s_lshl1_add_u32 s4, s69, 0
    s_mul_i32 s5, s4, 9363
    s_lshr_b32 s5, s5, 16
    s_mul_i32 s7, s5, 7
    s_sub_u32 s7, s4, s7
    s_cmp_gt_u32 s7, 2
    s_addc_u32 s4, s4, s5
    s_lshl_b32 s4, s4, 7
    s_mul_i32 s7, s3, 720896
    s_add_u32 s4, s4, s7
    s_add_u32 s10, s4, 39469056
    s_lshl1_add_u32 s4, s69, 1
    s_mul_i32 s5, s4, 9363
    s_lshr_b32 s5, s5, 16
    s_mul_i32 s7, s5, 7
    s_sub_u32 s7, s4, s7
    s_cmp_gt_u32 s7, 2
    s_addc_u32 s4, s4, s5
    s_lshl_b32 s4, s4, 7
    s_mul_i32 s7, s3, 720896
    s_add_u32 s4, s4, s7
    s_add_u32 s11, s4, 39469056
    ds_read2_b32 v[64:65], v236 offset0:0 offset1:1
    ds_read2_b32 v[66:67], v236 offset0:2 offset1:3
    ds_read2_b32 v[68:69], v236 offset0:128 offset1:129
    ds_read2_b32 v[70:71], v236 offset0:130 offset1:131
    ds_read2_b32 v[72:73], v237 offset0:0 offset1:1
    ds_read2_b32 v[74:75], v237 offset0:2 offset1:3
    ds_read2_b32 v[76:77], v237 offset0:128 offset1:129
    ds_read2_b32 v[78:79], v237 offset0:130 offset1:131
    ds_read2_b32 v[80:81], v238 offset0:0 offset1:1
    ds_read2_b32 v[82:83], v238 offset0:2 offset1:3
    ds_read2_b32 v[84:85], v238 offset0:128 offset1:129
    ds_read2_b32 v[86:87], v238 offset0:130 offset1:131
    ds_read2_b32 v[88:89], v239 offset0:0 offset1:1
    ds_read2_b32 v[90:91], v239 offset0:2 offset1:3
    ds_read2_b32 v[92:93], v239 offset0:128 offset1:129
    ds_read2_b32 v[94:95], v239 offset0:130 offset1:131
    v_mov_b32 v29, 0
    buffer_atomic_add v29, v28, s[44:47], 0 offen sc0 sc1
    s_waitcnt vmcnt(0)
    v_cmp_ne_u32 vcc, s68, v29
    s_cbranch_vccnz L_rs_p1X
L_ok_p1X:
    s_add_u32 m0, s9, 0
    s_add_u32 s13, s10, 0
    buffer_load_dwordx4 v15, s[44:47], s13 offen sc1 lds
    s_add_u32 m0, s9, 1024
    s_add_u32 s13, s10, 90112
    buffer_load_dwordx4 v16, s[44:47], s13 offen sc1 lds
    s_add_u32 m0, s9, 2048
    s_add_u32 s13, s10, 180224
L_pl_X_1:
    s_cbranch_execz L_pl_X_5
    buffer_load_dwordx4 v15, s[44:47], s13 offen sc1 lds
    s_add_u32 m0, s9, 3072
    s_add_u32 s13, s10, 270336
    buffer_load_dwordx4 v16, s[44:47], s13 offen sc1 lds
    s_add_u32 m0, s9, 4096
    s_add_u32 s13, s10, 360448
    buffer_load_dwordx4 v15, s[44:47], s13 offen sc1 lds
    s_add_u32 m0, s9, 5120
    s_add_u32 s13, s10, 450560
    buffer_load_dwordx4 v16, s[44:47], s13 offen sc1 lds
    s_add_u32 m0, s9, 6144
    s_add_u32 s13, s10, 540672
    buffer_load_dwordx4 v15, s[44:47], s13 offen sc1 lds
    s_add_u32 m0, s9, 7168
    s_add_u32 s13, s10, 630784
    buffer_load_dwordx4 v16, s[44:47], s13 offen sc1 lds
    s_mov_b64 exec, 0
    s_call_b64 s[82:83], L_wc_D
    s_mov_b64 exec, -1
    s_mov_b32 s60, s36
    s_and_b32 s61, s37, 0xffff
    s_mov_b32 s62, 4096
    s_mov_b32 s63, 0x20000
    v_and_b32 v24, 15, v2
    s_lshl_b32 s7, s71, 6
    v_add_u32 v24, s7, v24
    s_and_b32 s8, s3, 1
    s_lshl_b32 s4, s8, 5
    v_add_u32 v25, s4, v24
    v_lshlrev_b32 v26, 3, v25
    v_mul_u32_u24 v25, 1152, v25
    v_bfe_u32 v31, v2, 4, 1
    v_lshl_add_u32 v25, v31, 5, v25
    v_lshrrev_b32 v31, 5, v2
    v_lshl_add_u32 v25, v31, 4, v25
    s_bfe_u32 s7, s2, 0x20003
    s_mul_i32 s7, s7, 288
    s_bfe_u32 s5, s2, 0x10003
    s_mul_i32 s5, s5, 32
    s_lshl_b32 s4, s72, 6
    s_add_u32 s4, s4, s7
    s_add_u32 s4, s4, s5
    s_lshl_b32 s5, s5, 3
    s_sub_u32 s7, s7, s5
    v_add_u32 v252, s4, v25
    s_xor_b32 s8, s3, s72
    s_and_b32 s4, s72, 1
    s_lshl1_add_u32 s4, s4, s8
    v_lshl_add_u32 v24, s4, 4, v24
    s_add_u32 s7, s7, 256
    s_cmp_lt_u32 s8, 2
    s_cselect_b32 s7, s7, 0x40000000
    v_lshlrev_b32 v18, 3, v24
    v_mul_u32_u24 v24, 1152, v24
    v_lshrrev_b32 v31, 4, v2
    v_lshl_add_u32 v24, v31, 3, v24
    v_add_u32 v253, s7, v24
    v_lshrrev_b32 v24, 3, v2
    v_and_b32 v25, 7, v2
    v_bfe_u32 v31, v2, 4, 2
    v_lshlrev_b32 v31, 1, v31
    v_xor_b32 v25, v25, v31
    v_lshlrev_b32 v24, 12, v24
    v_lshl_add_u32 v24, v25, 4, v24
    s_mul_i32 s7, s72, 36
    s_bitcmp1_b32 s3, 0
    s_addc_u32 s7, s7, 0
    s_lshl_b32 s7, s7, 17
    s_lshl_b32 s8, s71, 7
    s_add_u32 s7, s7, s8
    v_add_u32 v4, s7, v24
    v_add_u32 v5, 31744, v4
    v_add_u32 v6, 31744, v5
    v_add_u32 v7, 31744, v6
    v_lshrrev_b32 v24, 2, v2
    v_lshlrev_b32 v24, 7, v24
    v_and_b32 v25, 3, v2
    v_lshl_add_u32 v24, v25, 3, v24
    s_and_b32 s7, s73, 8192
    v_add_u32 v24, s7, v24
    v_bfe_u32 v31, v2, 3, 2
    s_and_b32 s7, s3, 1
    s_lshl_b32 s7, s7, 1
    v_xor_b32 v31, s7, v31
    v_lshl_add_u32 v10, v31, 5, v24
    v_xor_b32 v11, 32, v10
    v_and_b32 v24, 15, v2
    v_lshrrev_b32 v25, 4, v2
    v_mul_u32_u24 v25, 17408, v25
    v_lshl_add_u32 v24, v24, 4, v25
    s_mul_i32 s7, s72, 36
    s_and_b32 s8, s3, 1
    s_add_u32 s7, s7, s8
    s_mul_i32 s7, s7, 69632
    s_bfe_u32 s8, s2, 0x20003
    s_lshl_b32 s8, s8, 12
    s_add_u32 s7, s7, s8
    s_add_u32 s7, s7, 12795904
    v_add_u32 v23, s7, v24
    s_xor_b32 s7, s72, 0
    v_lshl_add_u32 v19, s7, 10, v23
    s_xor_b32 s7, s72, 1
    v_lshl_add_u32 v20, s7, 10, v23
    s_xor_b32 s7, s72, 2
    v_lshl_add_u32 v21, s7, 10, v23
    s_xor_b32 s7, s72, 3
    v_lshl_add_u32 v22, s7, 10, v23
    v_lshlrev_b32 v14, 4, v2
    v_add_u32 v14, 98304, v14
    v_add_u32 v1, 0x10000, v14
    s_bitcmp1_b32 s3, 1
    s_cselect_b32 s18, s85, s84
    s_mul_i32 s18, s18, 139264
    s_cselect_b32 s19, s87, s86
    s_mul_i32 s19, s19, 139264
    s_cselect_b32 s20, s89, s88
    s_mul_i32 s20, s20, 139264
    s_cselect_b32 s21, s91, s90
    s_mul_i32 s21, s21, 139264
    s_cselect_b32 s22, s93, s92
    s_mul_i32 s22, s22, 139264
    s_cselect_b32 s23, s95, s94
    s_mul_i32 s23, s23, 139264
    s_cselect_b32 s24, s97, s96
    s_mul_i32 s24, s24, 139264
    s_cselect_b32 s25, s99, s98
    s_mul_i32 s25, s25, 139264
    s_cselect_b32 s26, s101, s100
    s_mul_i32 s26, s26, 139264
    v_add_u32 v10, 131072, v10
    v_add_u32 v11, 131072, v11
    s_waitcnt vmcnt(0) lgkmcnt(0)
    s_barrier
    ds_read_b128 v[96:99], v244 offset:2048
    ds_read_b128 v[100:103], v244 offset:6144
    ds_read_b128 v[104:107], v244 offset:10240
    ds_read_b128 v[108:111], v244 offset:14336
    ds_read_b128 v[112:115], v244 offset:18432
    ds_read_b128 v[116:119], v244 offset:22528
    ds_read_b128 v[120:123], v244 offset:26624
    ds_read_b128 v[124:127], v244 offset:30720
    s_waitcnt lgkmcnt(0)
    v_mfma_f32_16x16x32_bf16 v[32:35], v[64:67], v[96:99], 0
    s_lshl_b32 s14, s84, 18
    ds_read_b128 v[160:163], v245 offset:2048
    v_mfma_f32_16x16x32_bf16 v[36:39], v[68:71], v[96:99], 0
    s_add_u32 m0, s73, 147456
    v_mfma_f32_16x16x32_bf16 v[36:39], v[64:67], v[100:103], v[36:39]
    buffer_load_dwordx4 v4, s[52:55], s14 offen offset:0 lds
    ds_read2_b32 v[128:129], v236 offset0:16 offset1:17
    v_mfma_f32_16x16x32_bf16 v[40:43], v[64:67], v[104:107], 0
    ds_read2_b32 v[130:131], v236 offset0:18 offset1:19
    v_mfma_f32_16x16x32_bf16 v[40:43], v[68:71], v[100:103], v[40:43]
    v_mfma_f32_16x16x32_bf16 v[40:43], v[72:75], v[96:99], v[40:43]
    ds_read_b128 v[164:167], v245 offset:6144
    v_mfma_f32_16x16x32_bf16 v[44:47], v[76:79], v[96:99], 0
    ds_read2_b32 v[132:133], v236 offset0:144 offset1:145
    v_mfma_f32_16x16x32_bf16 v[44:47], v[72:75], v[100:103], v[44:47]
    v_mfma_f32_16x16x32_bf16 v[44:47], v[68:71], v[104:107], v[44:47]
    s_add_u32 m0, s73, 147456
    ds_read2_b32 v[134:135], v236 offset0:146 offset1:147
    v_mfma_f32_16x16x32_bf16 v[44:47], v[64:67], v[108:111], v[44:47]
    buffer_load_dwordx4 v5, s[52:55], s14 offen offset:1024 lds
    ds_read_b128 v[168:171], v245 offset:10240
    v_mfma_f32_16x16x32_bf16 v[48:51], v[64:67], v[112:115], 0
    ds_read2_b32 v[136:137], v237 offset0:16 offset1:17
    v_mfma_f32_16x16x32_bf16 v[48:51], v[68:71], v[108:111], v[48:51]
    v_mfma_f32_16x16x32_bf16 v[48:51], v[72:75], v[104:107], v[48:51]
    ds_read2_b32 v[138:139], v237 offset0:18 offset1:19
    v_mfma_f32_16x16x32_bf16 v[48:51], v[76:79], v[100:103], v[48:51]
    ds_read_b128 v[172:175], v245 offset:14336
    v_mfma_f32_16x16x32_bf16 v[48:51], v[80:83], v[96:99], v[48:51]
    v_mfma_f32_16x16x32_bf16 v[52:55], v[84:87], v[96:99], 0
    s_add_u32 m0, s73, 147456
    ds_read2_b32 v[140:141], v237 offset0:144 offset1:145
    v_mfma_f32_16x16x32_bf16 v[52:55], v[80:83], v[100:103], v[52:55]
    buffer_load_dwordx4 v6, s[52:55], s14 offen offset:2048 lds
    ds_read2_b32 v[142:143], v237 offset0:146 offset1:147
    v_mfma_f32_16x16x32_bf16 v[52:55], v[76:79], v[104:107], v[52:55]
    v_mfma_f32_16x16x32_bf16 v[52:55], v[72:75], v[108:111], v[52:55]
    ds_read_b128 v[176:179], v245 offset:18432
    v_mfma_f32_16x16x32_bf16 v[52:55], v[68:71], v[112:115], v[52:55]
    ds_read2_b32 v[144:145], v238 offset0:16 offset1:17
    v_mfma_f32_16x16x32_bf16 v[52:55], v[64:67], v[116:119], v[52:55]
    v_mfma_f32_16x16x32_bf16 v[56:59], v[64:67], v[120:123], 0
    ds_read2_b32 v[146:147], v238 offset0:18 offset1:19
    v_mfma_f32_16x16x32_bf16 v[56:59], v[68:71], v[116:119], v[56:59]
    s_add_u32 m0, s73, 147456
    ds_read_b128 v[180:183], v245 offset:22528
    v_mfma_f32_16x16x32_bf16 v[56:59], v[72:75], v[112:115], v[56:59]
    buffer_load_dwordx4 v7, s[52:55], s14 offen offset:3072 lds
    v_mfma_f32_16x16x32_bf16 v[56:59], v[76:79], v[108:111], v[56:59]
    ds_read2_b32 v[148:149], v238 offset0:144 offset1:145
    v_mfma_f32_16x16x32_bf16 v[56:59], v[80:83], v[104:107], v[56:59]
    ds_read2_b32 v[150:151], v238 offset0:146 offset1:147
    v_mfma_f32_16x16x32_bf16 v[56:59], v[84:87], v[100:103], v[56:59]
    ds_read_b128 v[184:187], v245 offset:26624
    v_mfma_f32_16x16x32_bf16 v[56:59], v[88:91], v[96:99], v[56:59]
    v_mfma_f32_16x16x32_bf16 v[60:63], v[92:95], v[96:99], 0
    ds_read2_b32 v[152:153], v239 offset0:16 offset1:17
    v_mfma_f32_16x16x32_bf16 v[60:63], v[88:91], v[100:103], v[60:63]
    ds_read2_b32 v[154:155], v239 offset0:18 offset1:19
    v_mfma_f32_16x16x32_bf16 v[60:63], v[84:87], v[104:107], v[60:63]
    v_mfma_f32_16x16x32_bf16 v[60:63], v[80:83], v[108:111], v[60:63]
    ds_read_b128 v[188:191], v245 offset:30720
    v_mfma_f32_16x16x32_bf16 v[60:63], v[76:79], v[112:115], v[60:63]
    ds_read2_b32 v[156:157], v239 offset0:144 offset1:145
    v_mfma_f32_16x16x32_bf16 v[60:63], v[72:75], v[116:119], v[60:63]
    v_mfma_f32_16x16x32_bf16 v[60:63], v[68:71], v[120:123], v[60:63]
    ds_read2_b32 v[158:159], v239 offset0:146 offset1:147
    v_mfma_f32_16x16x32_bf16 v[60:63], v[64:67], v[124:127], v[60:63]
    s_waitcnt lgkmcnt(12)
    v_mfma_f32_16x16x32_bf16 v[32:35], v[128:131], v[160:163], v[32:35]
    ds_read_b128 v[96:99], v246 offset:2048
    v_mfma_f32_16x16x32_bf16 v[36:39], v[132:135], v[160:163], v[36:39]
    v_mfma_f32_16x16x32_bf16 v[36:39], v[128:131], v[164:167], v[36:39]
    ds_read2_b32 v[64:65], v236 offset0:32 offset1:33
    v_mfma_f32_16x16x32_bf16 v[40:43], v[128:131], v[168:171], v[40:43]
    ds_read2_b32 v[66:67], v236 offset0:34 offset1:35
    v_mfma_f32_16x16x32_bf16 v[40:43], v[132:135], v[164:167], v[40:43]
    v_mfma_f32_16x16x32_bf16 v[40:43], v[136:139], v[160:163], v[40:43]
    ds_read_b128 v[100:103], v246 offset:6144
    v_mfma_f32_16x16x32_bf16 v[44:47], v[140:143], v[160:163], v[44:47]
    ds_read2_b32 v[68:69], v236 offset0:160 offset1:161
    v_mfma_f32_16x16x32_bf16 v[44:47], v[136:139], v[164:167], v[44:47]
    v_mfma_f32_16x16x32_bf16 v[44:47], v[132:135], v[168:171], v[44:47]
    ds_read2_b32 v[70:71], v236 offset0:162 offset1:163
    v_mfma_f32_16x16x32_bf16 v[44:47], v[128:131], v[172:175], v[44:47]
    ds_read_b128 v[104:107], v246 offset:10240
    s_waitcnt lgkmcnt(7)
    v_mfma_f32_16x16x32_bf16 v[48:51], v[128:131], v[176:179], v[48:51]
    s_lshl_b32 s14, s85, 18
    ds_read2_b32 v[72:73], v237 offset0:32 offset1:33
    v_mfma_f32_16x16x32_bf16 v[48:51], v[132:135], v[172:175], v[48:51]
    s_add_u32 m0, s73, 49152
    ds_read2_b32 v[74:75], v237 offset0:34 offset1:35
    v_mfma_f32_16x16x32_bf16 v[48:51], v[136:139], v[168:171], v[48:51]
    buffer_load_dwordx4 v4, s[52:55], s14 offen offset:0 lds
    v_mov_b32 v9, 8
    buffer_load_ushort v9, v9, s[56:59], s70 offen
    v_mfma_f32_16x16x32_bf16 v[48:51], v[140:143], v[164:167], v[48:51]
    ds_read_b128 v[108:111], v246 offset:14336
    v_mfma_f32_16x16x32_bf16 v[48:51], v[144:147], v[160:163], v[48:51]
    v_mfma_f32_16x16x32_bf16 v[52:55], v[148:151], v[160:163], v[52:55]
    ds_read2_b32 v[76:77], v237 offset0:160 offset1:161
    v_mfma_f32_16x16x32_bf16 v[52:55], v[144:147], v[164:167], v[52:55]
    ds_read2_b32 v[78:79], v237 offset0:162 offset1:163
    v_mfma_f32_16x16x32_bf16 v[52:55], v[140:143], v[168:171], v[52:55]
    v_mfma_f32_16x16x32_bf16 v[52:55], v[136:139], v[172:175], v[52:55]
    ds_read_b128 v[112:115], v246 offset:18432
    v_mfma_f32_16x16x32_bf16 v[52:55], v[132:135], v[176:179], v[52:55]
    s_add_u32 m0, s73, 49152
    ds_read2_b32 v[80:81], v238 offset0:32 offset1:33
    v_mfma_f32_16x16x32_bf16 v[52:55], v[128:131], v[180:183], v[52:55]
    buffer_load_dwordx4 v5, s[52:55], s14 offen offset:1024 lds
    v_mfma_f32_16x16x32_bf16 v[56:59], v[128:131], v[184:187], v[56:59]
    ds_read2_b32 v[82:83], v238 offset0:34 offset1:35
    v_mfma_f32_16x16x32_bf16 v[56:59], v[132:135], v[180:183], v[56:59]
    ds_read_b128 v[116:119], v246 offset:22528
    v_mfma_f32_16x16x32_bf16 v[56:59], v[136:139], v[176:179], v[56:59]
    v_mfma_f32_16x16x32_bf16 v[56:59], v[140:143], v[172:175], v[56:59]
    ds_read2_b32 v[84:85], v238 offset0:160 offset1:161
    v_mfma_f32_16x16x32_bf16 v[56:59], v[144:147], v[168:171], v[56:59]
    ds_read2_b32 v[86:87], v238 offset0:162 offset1:163
    v_mfma_f32_16x16x32_bf16 v[56:59], v[148:151], v[164:167], v[56:59]
    s_add_u32 m0, s73, 49152
    ds_read_b128 v[120:123], v246 offset:26624
    v_mfma_f32_16x16x32_bf16 v[56:59], v[152:155], v[160:163], v[56:59]
    buffer_load_dwordx4 v6, s[52:55], s14 offen offset:2048 lds
    v_mfma_f32_16x16x32_bf16 v[60:63], v[156:159], v[160:163], v[60:63]
    ds_read2_b32 v[88:89], v239 offset0:32 offset1:33
    v_mfma_f32_16x16x32_bf16 v[60:63], v[152:155], v[164:167], v[60:63]
    ds_read2_b32 v[90:91], v239 offset0:34 offset1:35
    v_mfma_f32_16x16x32_bf16 v[60:63], v[148:151], v[168:171], v[60:63]
    v_mfma_f32_16x16x32_bf16 v[60:63], v[144:147], v[172:175], v[60:63]
    ds_read_b128 v[124:127], v246 offset:30720
    v_mfma_f32_16x16x32_bf16 v[60:63], v[140:143], v[176:179], v[60:63]
    ds_read2_b32 v[92:93], v239 offset0:160 offset1:161
    v_mfma_f32_16x16x32_bf16 v[60:63], v[136:139], v[180:183], v[60:63]
    s_add_u32 m0, s73, 49152
    v_mfma_f32_16x16x32_bf16 v[60:63], v[132:135], v[184:187], v[60:63]
    buffer_load_dwordx4 v7, s[52:55], s14 offen offset:3072 lds
    ds_read2_b32 v[94:95], v239 offset0:162 offset1:163
    v_mfma_f32_16x16x32_bf16 v[60:63], v[128:131], v[188:191], v[60:63]
    s_waitcnt lgkmcnt(12)
    v_mfma_f32_16x16x32_bf16 v[32:35], v[64:67], v[96:99], v[32:35]
    ds_read_b128 v[160:163], v247 offset:2048
    v_mfma_f32_16x16x32_bf16 v[36:39], v[68:71], v[96:99], v[36:39]
    v_mfma_f32_16x16x32_bf16 v[36:39], v[64:67], v[100:103], v[36:39]
    ds_read2_b32 v[128:129], v236 offset0:48 offset1:49
    v_mfma_f32_16x16x32_bf16 v[40:43], v[64:67], v[104:107], v[40:43]
    ds_read2_b32 v[130:131], v236 offset0:50 offset1:51
    v_mfma_f32_16x16x32_bf16 v[40:43], v[68:71], v[100:103], v[40:43]
    v_mfma_f32_16x16x32_bf16 v[40:43], v[72:75], v[96:99], v[40:43]
    ds_read_b128 v[164:167], v247 offset:6144
    v_mfma_f32_16x16x32_bf16 v[44:47], v[76:79], v[96:99], v[44:47]
    ds_read2_b32 v[132:133], v236 offset0:176 offset1:177
    v_mfma_f32_16x16x32_bf16 v[44:47], v[72:75], v[100:103], v[44:47]
    v_mfma_f32_16x16x32_bf16 v[44:47], v[68:71], v[104:107], v[44:47]
    ds_read2_b32 v[134:135], v236 offset0:178 offset1:179
    v_mfma_f32_16x16x32_bf16 v[44:47], v[64:67], v[108:111], v[44:47]
    ds_read_b128 v[168:171], v247 offset:10240
    s_waitcnt lgkmcnt(7)
    v_mfma_f32_16x16x32_bf16 v[48:51], v[64:67], v[112:115], v[48:51]
    ds_read2_b32 v[136:137], v237 offset0:48 offset1:49
    v_mfma_f32_16x16x32_bf16 v[48:51], v[68:71], v[108:111], v[48:51]
    v_mfma_f32_16x16x32_bf16 v[48:51], v[72:75], v[104:107], v[48:51]
    ds_read2_b32 v[138:139], v237 offset0:50 offset1:51
    v_mfma_f32_16x16x32_bf16 v[48:51], v[76:79], v[100:103], v[48:51]
    ds_read_b128 v[172:175], v247 offset:14336
    v_mfma_f32_16x16x32_bf16 v[48:51], v[80:83], v[96:99], v[48:51]
    v_mfma_f32_16x16x32_bf16 v[52:55], v[84:87], v[96:99], v[52:55]
    ds_read2_b32 v[140:141], v237 offset0:176 offset1:177
    v_mfma_f32_16x16x32_bf16 v[52:55], v[80:83], v[100:103], v[52:55]
    ds_read2_b32 v[142:143], v237 offset0:178 offset1:179
    v_mfma_f32_16x16x32_bf16 v[52:55], v[76:79], v[104:107], v[52:55]
    v_mfma_f32_16x16x32_bf16 v[52:55], v[72:75], v[108:111], v[52:55]
    ds_read_b128 v[176:179], v247 offset:18432
    v_mfma_f32_16x16x32_bf16 v[52:55], v[68:71], v[112:115], v[52:55]
    ds_read2_b32 v[144:145], v238 offset0:48 offset1:49
    v_mfma_f32_16x16x32_bf16 v[52:55], v[64:67], v[116:119], v[52:55]
    v_mfma_f32_16x16x32_bf16 v[56:59], v[64:67], v[120:123], v[56:59]
    ds_read2_b32 v[146:147], v238 offset0:50 offset1:51
    v_mfma_f32_16x16x32_bf16 v[56:59], v[68:71], v[116:119], v[56:59]
    ds_read_b128 v[180:183], v247 offset:22528
    v_mfma_f32_16x16x32_bf16 v[56:59], v[72:75], v[112:115], v[56:59]
    v_mfma_f32_16x16x32_bf16 v[56:59], v[76:79], v[108:111], v[56:59]
    ds_read2_b32 v[148:149], v238 offset0:176 offset1:177
    v_mfma_f32_16x16x32_bf16 v[56:59], v[80:83], v[104:107], v[56:59]
    ds_read2_b32 v[150:151], v238 offset0:178 offset1:179
    v_mfma_f32_16x16x32_bf16 v[56:59], v[84:87], v[100:103], v[56:59]
    ds_read_b128 v[184:187], v247 offset:26624
    v_mfma_f32_16x16x32_bf16 v[56:59], v[88:91], v[96:99], v[56:59]
    v_mfma_f32_16x16x32_bf16 v[60:63], v[92:95], v[96:99], v[60:63]
    ds_read2_b32 v[152:153], v239 offset0:48 offset1:49
    v_mfma_f32_16x16x32_bf16 v[60:63], v[88:91], v[100:103], v[60:63]
    ds_read2_b32 v[154:155], v239 offset0:50 offset1:51
    v_mfma_f32_16x16x32_bf16 v[60:63], v[84:87], v[104:107], v[60:63]
    v_mfma_f32_16x16x32_bf16 v[60:63], v[80:83], v[108:111], v[60:63]
    ds_read_b128 v[188:191], v247 offset:30720
    v_mfma_f32_16x16x32_bf16 v[60:63], v[76:79], v[112:115], v[60:63]
    ds_read2_b32 v[156:157], v239 offset0:176 offset1:177
    v_mfma_f32_16x16x32_bf16 v[60:63], v[72:75], v[116:119], v[60:63]
    v_mfma_f32_16x16x32_bf16 v[60:63], v[68:71], v[120:123], v[60:63]
    ds_read2_b32 v[158:159], v239 offset0:178 offset1:179
    v_mfma_f32_16x16x32_bf16 v[60:63], v[64:67], v[124:127], v[60:63]
    s_waitcnt lgkmcnt(12)
    v_mfma_f32_16x16x32_bf16 v[32:35], v[128:131], v[160:163], v[32:35]
    ds_read_b128 v[96:99], v244 offset:0
    v_mfma_f32_16x16x32_bf16 v[36:39], v[132:135], v[160:163], v[36:39]
    v_mfma_f32_16x16x32_bf16 v[36:39], v[128:131], v[164:167], v[36:39]
    ds_read2_b32 v[64:65], v236 offset0:64 offset1:65
    v_mfma_f32_16x16x32_bf16 v[40:43], v[128:131], v[168:171], v[40:43]
    ds_read2_b32 v[66:67], v236 offset0:66 offset1:67
    v_mfma_f32_16x16x32_bf16 v[40:43], v[132:135], v[164:167], v[40:43]
    v_mfma_f32_16x16x32_bf16 v[40:43], v[136:139], v[160:163], v[40:43]
    ds_read_b128 v[100:103], v244 offset:4096
    v_mfma_f32_16x16x32_bf16 v[44:47], v[140:143], v[160:163], v[44:47]
    ds_read2_b32 v[68:69], v236 offset0:192 offset1:193
    v_mfma_f32_16x16x32_bf16 v[44:47], v[136:139], v[164:167], v[44:47]
    v_mfma_f32_16x16x32_bf16 v[44:47], v[132:135], v[168:171], v[44:47]
    ds_read2_b32 v[70:71], v236 offset0:194 offset1:195
    v_mfma_f32_16x16x32_bf16 v[44:47], v[128:131], v[172:175], v[44:47]
    ds_read_b128 v[104:107], v244 offset:8192
    s_waitcnt lgkmcnt(7)
    v_mfma_f32_16x16x32_bf16 v[48:51], v[128:131], v[176:179], v[48:51]
    ds_read2_b32 v[72:73], v237 offset0:64 offset1:65
    v_mfma_f32_16x16x32_bf16 v[48:51], v[132:135], v[172:175], v[48:51]
    ds_read2_b32 v[74:75], v237 offset0:66 offset1:67
    v_mfma_f32_16x16x32_bf16 v[48:51], v[136:139], v[168:171], v[48:51]
    ds_read_b128 v[108:111], v244 offset:12288
    v_mfma_f32_16x16x32_bf16 v[48:51], v[140:143], v[164:167], v[48:51]
    ds_read2_b32 v[76:77], v237 offset0:192 offset1:193
    v_mfma_f32_16x16x32_bf16 v[48:51], v[144:147], v[160:163], v[48:51]
    ds_read2_b32 v[78:79], v237 offset0:194 offset1:195
    s_waitcnt vmcnt(5)
    s_barrier
    v_mfma_f32_16x16x32_bf16 v[52:55], v[148:151], v[160:163], v[52:55]
    ds_read_b64_tr_b16 a[0:1], v10 offset:16384
    v_mfma_f32_16x16x32_bf16 v[52:55], v[144:147], v[164:167], v[52:55]
    ds_read_b128 v[112:115], v244 offset:16384
    v_mfma_f32_16x16x32_bf16 v[52:55], v[140:143], v[168:171], v[52:55]
    ds_read_b64_tr_b16 a[2:3], v10 offset:18432
    v_mfma_f32_16x16x32_bf16 v[52:55], v[136:139], v[172:175], v[52:55]
    ds_read_b64_tr_b16 a[8:9], v10 offset:20480
    v_mfma_f32_16x16x32_bf16 v[52:55], v[132:135], v[176:179], v[52:55]
    ds_read2_b32 v[80:81], v238 offset0:64 offset1:65
    v_mfma_f32_16x16x32_bf16 v[52:55], v[128:131], v[180:183], v[52:55]
    ds_read_b64_tr_b16 a[10:11], v10 offset:22528
    v_mfma_f32_16x16x32_bf16 v[56:59], v[128:131], v[184:187], v[56:59]
    ds_read_b64_tr_b16 a[4:5], v11 offset:16384
    v_mfma_f32_16x16x32_bf16 v[56:59], v[132:135], v[180:183], v[56:59]
    ds_read2_b32 v[82:83], v238 offset0:66 offset1:67
    v_mfma_f32_16x16x32_bf16 v[56:59], v[136:139], v[176:179], v[56:59]
    ds_read_b64_tr_b16 a[6:7], v11 offset:18432
    v_mfma_f32_16x16x32_bf16 v[56:59], v[140:143], v[172:175], v[56:59]
    ds_read_b64_tr_b16 a[12:13], v11 offset:20480
    v_mfma_f32_16x16x32_bf16 v[56:59], v[144:147], v[168:171], v[56:59]
    ds_read_b64_tr_b16 a[14:15], v11 offset:22528
    v_mfma_f32_16x16x32_bf16 v[56:59], v[148:151], v[164:167], v[56:59]
    ds_read_b128 v[116:119], v244 offset:20480
    v_mfma_f32_16x16x32_bf16 v[56:59], v[152:155], v[160:163], v[56:59]
    ds_read2_b32 v[84:85], v238 offset0:192 offset1:193
    v_mfma_f32_16x16x32_bf16 v[60:63], v[156:159], v[160:163], v[60:63]
    ds_read2_b32 v[86:87], v238 offset0:194 offset1:195
    s_waitcnt lgkmcnt(3)
    s_barrier
    v_mfma_f32_16x16x32_bf16 v[60:63], v[152:155], v[164:167], v[60:63]
    ds_read_b128 v[120:123], v244 offset:24576
    v_mfma_f32_16x16x32_bf16 v[60:63], v[148:151], v[168:171], v[60:63]
    ds_read2_b32 v[88:89], v239 offset0:64 offset1:65
    v_mfma_f32_16x16x32_bf16 v[60:63], v[144:147], v[172:175], v[60:63]
    ds_read2_b32 v[90:91], v239 offset0:66 offset1:67
    v_mfma_f32_16x16x32_bf16 v[60:63], v[140:143], v[176:179], v[60:63]
    s_lshl_b32 s14, s86, 18
    ds_read_b128 v[124:127], v244 offset:28672
    v_mfma_f32_16x16x32_bf16 v[60:63], v[136:139], v[180:183], v[60:63]
    s_add_u32 m0, s73, 147456
    ds_read2_b32 v[92:93], v239 offset0:192 offset1:193
    v_mfma_f32_16x16x32_bf16 v[60:63], v[132:135], v[184:187], v[60:63]
    buffer_load_dwordx4 v4, s[52:55], s14 offen offset:0 lds
    ds_read2_b32 v[94:95], v239 offset0:194 offset1:195
    v_mfma_f32_16x16x32_bf16 v[60:63], v[128:131], v[188:191], v[60:63]
    v_mfma_f32_16x16x32_bf16 v[32:35], v[64:67], v[96:99], v[32:35]
    ds_read_b128 v[160:163], v245 offset:0
    v_mfma_f32_16x16x32_bf16 v[36:39], v[68:71], v[96:99], v[36:39]
    ds_read2_b32 v[128:129], v236 offset0:80 offset1:81
    v_mfma_f32_16x16x32_bf16 v[36:39], v[64:67], v[100:103], v[36:39]
    ds_read2_b32 v[130:131], v236 offset0:82 offset1:83
    v_mfma_f32_16x16x32_bf16 v[40:43], v[64:67], v[104:107], v[40:43]
    ds_read_b128 v[164:167], v245 offset:4096
    v_mfma_f32_16x16x32_bf16 v[40:43], v[68:71], v[100:103], v[40:43]
    s_add_u32 m0, s73, 147456
    ds_read2_b32 v[132:133], v236 offset0:208 offset1:209
    v_mfma_f32_16x16x32_bf16 v[40:43], v[72:75], v[96:99], v[40:43]
    buffer_load_dwordx4 v5, s[52:55], s14 offen offset:1024 lds
    ds_read2_b32 v[134:135], v236 offset0:210 offset1:211
    v_mfma_f32_16x16x32_bf16 v[44:47], v[76:79], v[96:99], v[44:47]
    ds_read_b128 v[168:171], v245 offset:8192
    v_mfma_f32_16x16x32_bf16 v[44:47], v[72:75], v[100:103], v[44:47]
    ds_read2_b32 v[136:137], v237 offset0:80 offset1:81
    v_mfma_f32_16x16x32_bf16 v[44:47], v[68:71], v[104:107], v[44:47]
    ds_read2_b32 v[138:139], v237 offset0:82 offset1:83
    v_mfma_f32_16x16x32_bf16 v[44:47], v[64:67], v[108:111], v[44:47]
    ds_read_b128 v[172:175], v245 offset:12288
    s_waitcnt lgkmcnt(10)
    v_mfma_f32_16x16x32_bf16 v[48:51], v[64:67], v[112:115], v[48:51]
    ds_read2_b32 v[140:141], v237 offset0:208 offset1:209
    v_mfma_f32_16x16x32_bf16 v[48:51], v[68:71], v[108:111], v[48:51]
    s_add_u32 m0, s73, 147456
    ds_read2_b32 v[142:143], v237 offset0:210 offset1:211
    v_mfma_f32_16x16x32_bf16 v[48:51], v[72:75], v[104:107], v[48:51]
    buffer_load_dwordx4 v6, s[52:55], s14 offen offset:2048 lds
    ds_read_b128 v[176:179], v245 offset:16384
    v_mfma_f32_16x16x32_bf16 v[48:51], v[76:79], v[100:103], v[48:51]
    ds_read2_b32 v[144:145], v238 offset0:80 offset1:81
    v_mfma_f32_16x16x32_bf16 v[48:51], v[80:83], v[96:99], v[48:51]
    ds_read2_b32 v[146:147], v238 offset0:82 offset1:83
    v_mfma_f32_16x16x32_bf16 v[52:55], v[84:87], v[96:99], v[52:55]
    ds_read_b128 v[180:183], v245 offset:20480
    v_mfma_f32_16x16x32_bf16 v[52:55], v[80:83], v[100:103], v[52:55]
    ds_read2_b32 v[148:149], v238 offset0:208 offset1:209
    v_mfma_f32_16x16x32_bf16 v[52:55], v[76:79], v[104:107], v[52:55]
    ds_read2_b32 v[150:151], v238 offset0:210 offset1:211
    v_mfma_f32_16x16x32_bf16 v[52:55], v[72:75], v[108:111], v[52:55]
    ds_read_b128 v[184:187], v245 offset:24576
    v_mfma_f32_16x16x32_bf16 v[52:55], v[68:71], v[112:115], v[52:55]
    s_add_u32 m0, s73, 147456
    ds_read_b128 v[212:215], v241 offset:8352
    v_mfma_f32_16x16x32_bf16 v[52:55], v[64:67], v[116:119], v[52:55]
    buffer_load_dwordx4 v7, s[52:55], s14 offen offset:3072 lds
    ds_read2_b32 v[152:153], v239 offset0:80 offset1:81
    v_mfma_f32_16x16x32_bf16 v[56:59], v[64:67], v[120:123], v[56:59]
    ds_read_b32 v216, v241 offset:8368
    v_mfma_f32_16x16x32_bf16 v[56:59], v[68:71], v[116:119], v[56:59]
    ds_read2_b32 v[154:155], v239 offset0:82 offset1:83
    v_mfma_f32_16x16x32_bf16 v[56:59], v[72:75], v[112:115], v[56:59]
    ds_read_b128 v[218:221], v241 offset:9376
    v_mfma_f32_16x16x32_bf16 v[56:59], v[76:79], v[108:111], v[56:59]
    ds_read_b32 v222, v241 offset:9392
    v_mfma_f32_16x16x32_bf16 v[56:59], v[80:83], v[104:107], v[56:59]
    ds_read_b128 v[224:227], v241 offset:10400
    s_waitcnt vmcnt(4)
    s_barrier
    v_mfma_f32_16x16x32_bf16 v[56:59], v[84:87], v[100:103], v[56:59]
    ds_read_b32 v228, v241 offset:10416
    v_add_u32 v10, -131072, v10
    v_mfma_f32_16x16x32_bf16 v[56:59], v[88:91], v[96:99], v[56:59]
    ds_read_b64_tr_b16 a[16:17], v10 offset:49152
    v_mfma_f32_16x16x32_bf16 v[60:63], v[92:95], v[96:99], v[60:63]
    ds_read_b64_tr_b16 a[18:19], v10 offset:51200
    v_mfma_f32_16x16x32_bf16 v[60:63], v[88:91], v[100:103], v[60:63]
    ds_read_b64_tr_b16 a[24:25], v10 offset:53248
    v_mfma_f32_16x16x32_bf16 v[60:63], v[84:87], v[104:107], v[60:63]
    ds_read_b128 v[230:233], v241 offset:11424
    v_mfma_f32_16x16x32_bf16 v[60:63], v[80:83], v[108:111], v[60:63]
    ds_read_b64_tr_b16 a[26:27], v10 offset:55296
    ds_read_b128 v[188:191], v245 offset:28672
    v_mfma_f32_16x16x32_bf16 v[60:63], v[76:79], v[112:115], v[60:63]
    ds_read_b32 v234, v241 offset:11440
    v_add_u32 v11, -131072, v11
    v_mfma_f32_16x16x32_bf16 v[60:63], v[72:75], v[116:119], v[60:63]
    ds_read_b64_tr_b16 a[20:21], v11 offset:49152
    ds_read2_b32 v[156:157], v239 offset0:208 offset1:209
    v_mfma_f32_16x16x32_bf16 v[60:63], v[68:71], v[120:123], v[60:63]
    ds_read_b64_tr_b16 a[22:23], v11 offset:51200
    ds_read2_b32 v[158:159], v239 offset0:210 offset1:211
    v_mfma_f32_16x16x32_bf16 v[60:63], v[64:67], v[124:127], v[60:63]
    ds_read_b64_tr_b16 a[28:29], v11 offset:53248
    s_waitcnt lgkmcnt(15)
    v_mfma_f32_16x16x32_bf16 v[32:35], v[128:131], v[160:163], v[32:35]
    ds_read_b64_tr_b16 a[30:31], v11 offset:55296
    v_mfma_f32_16x16x32_bf16 v[36:39], v[132:135], v[160:163], v[36:39]
    ds_read_b128 v[96:99], v246 offset:0
    v_mfma_f32_16x16x32_bf16 v[36:39], v[128:131], v[164:167], v[36:39]
    ds_read2_b32 v[64:65], v236 offset0:96 offset1:97
    v_mfma_f32_16x16x32_bf16 v[40:43], v[128:131], v[168:171], v[40:43]
    ds_read2_b32 v[66:67], v236 offset0:98 offset1:99
    s_waitcnt lgkmcnt(3)
    s_barrier
    v_mfma_f32_16x16x32_bf16 v[40:43], v[132:135], v[164:167], v[40:43]
    v_mfma_f32_16x16x32_bf16 v[40:43], v[136:139], v[160:163], v[40:43]
    ds_read_b128 v[100:103], v246 offset:4096
    v_mfma_f32_16x16x32_bf16 v[44:47], v[140:143], v[160:163], v[44:47]
    ds_read2_b32 v[68:69], v236 offset0:224 offset1:225
    v_mfma_f32_16x16x32_bf16 v[44:47], v[136:139], v[164:167], v[44:47]
    s_lshl_b32 s14, s87, 18
    v_mfma_f32_16x16x32_bf16 v[44:47], v[132:135], v[168:171], v[44:47]
    ds_read2_b32 v[70:71], v236 offset0:226 offset1:227
    s_add_u32 m0, s73, 49152
    v_lshlrev_b32 v9, 16, v9
    v_mfma_f32_16x16x32_bf16 v[44:47], v[128:131], v[172:175], v[44:47]
    buffer_load_dwordx4 v4, s[52:55], s14 offen offset:0 lds
    ds_read_b128 v[104:107], v246 offset:8192
    v_mfma_f32_16x16x32_bf16 v[48:51], v[128:131], v[176:179], v[48:51]
    ds_read2_b32 v[72:73], v237 offset0:96 offset1:97
    v_lshlrev_b32 v208, 16, v212
    v_mfma_f32_16x16x32_bf16 v[48:51], v[132:135], v[172:175], v[48:51]
    v_mfma_f32_16x16x32_bf16 v[48:51], v[136:139], v[168:171], v[48:51]
    ds_read2_b32 v[74:75], v237 offset0:98 offset1:99
    v_add_f32 v9, v9, v208
    v_mfma_f32_16x16x32_bf16 v[48:51], v[140:143], v[164:167], v[48:51]
    ds_read_b128 v[108:111], v246 offset:12288
    v_cvt_pk_bf16_f32 v9, v9, v9
    v_mfma_f32_16x16x32_bf16 v[48:51], v[144:147], v[160:163], v[48:51]
    ds_write_b16 v242, v9 offset:12480
    v_mfma_f32_16x16x32_bf16 v[52:55], v[148:151], v[160:163], v[52:55]
    s_add_u32 m0, s73, 49152
    ds_read2_b32 v[76:77], v237 offset0:224 offset1:225
    v_mfma_f32_16x16x32_bf16 v[52:55], v[144:147], v[164:167], v[52:55]
    buffer_load_dwordx4 v5, s[52:55], s14 offen offset:1024 lds
    ds_read2_b32 v[78:79], v237 offset0:226 offset1:227
    v_mfma_f32_16x16x32_bf16 v[52:55], v[140:143], v[168:171], v[52:55]
    ds_write_b16 v242, v9 offset:8322
    v_mfma_f32_16x16x32_bf16 v[52:55], v[136:139], v[172:175], v[52:55]
    ds_read_b128 v[112:115], v246 offset:16384
    v_mfma_f32_16x16x32_bf16 v[52:55], v[132:135], v[176:179], v[52:55]
    ds_read2_b32 v[80:81], v238 offset0:96 offset1:97
    v_alignbit_b32 v212, v213, v212, 16
    v_mfma_f32_16x16x32_bf16 v[52:55], v[128:131], v[180:183], v[52:55]
L_pl_X_2:
    s_cbranch_execz L_pl_X_6
    v_alignbit_b32 v213, v214, v213, 16
    v_mfma_f32_16x16x32_bf16 v[56:59], v[128:131], v[184:187], v[56:59]
    ds_read2_b32 v[82:83], v238 offset0:98 offset1:99
    v_mfma_f32_16x16x32_bf16 v[56:59], v[132:135], v[180:183], v[56:59]
    ds_read_b128 v[116:119], v246 offset:20480
    s_add_u32 m0, s73, 49152
    v_alignbit_b32 v214, v215, v214, 16
    v_mfma_f32_16x16x32_bf16 v[56:59], v[136:139], v[176:179], v[56:59]
    buffer_load_dwordx4 v6, s[52:55], s14 offen offset:2048 lds
    v_mfma_f32_16x16x32_bf16 v[56:59], v[140:143], v[172:175], v[56:59]
    ds_read2_b32 v[84:85], v238 offset0:224 offset1:225
    v_alignbit_b32 v215, v216, v215, 16
    v_mfma_f32_16x16x32_bf16 v[56:59], v[144:147], v[168:171], v[56:59]
    ds_read2_b32 v[86:87], v238 offset0:226 offset1:227
    v_mfma_f32_16x16x32_bf16 v[56:59], v[148:151], v[164:167], v[56:59]
    ds_write_b128 v241, v[212:215] offset:12512
    v_mfma_f32_16x16x32_bf16 v[56:59], v[152:155], v[160:163], v[56:59]
    ds_read_b128 v[120:123], v246 offset:24576
    v_mfma_f32_16x16x32_bf16 v[60:63], v[156:159], v[160:163], v[60:63]
    ds_read2_b32 v[88:89], v239 offset0:96 offset1:97
    v_alignbit_b32 v218, v219, v218, 16
    v_mfma_f32_16x16x32_bf16 v[60:63], v[152:155], v[164:167], v[60:63]
    ds_read2_b32 v[90:91], v239 offset0:98 offset1:99
    s_add_u32 m0, s73, 49152
    v_alignbit_b32 v219, v220, v219, 16
    v_mfma_f32_16x16x32_bf16 v[60:63], v[148:151], v[168:171], v[60:63]
    buffer_load_dwordx4 v7, s[52:55], s14 offen offset:3072 lds
    v_mfma_f32_16x16x32_bf16 v[60:63], v[144:147], v[172:175], v[60:63]
    ds_read_b128 v[124:127], v246 offset:28672
    v_alignbit_b32 v220, v221, v220, 16
    v_mfma_f32_16x16x32_bf16 v[60:63], v[140:143], v[176:179], v[60:63]
    ds_read2_b32 v[92:93], v239 offset0:224 offset1:225
    v_mfma_f32_16x16x32_bf16 v[60:63], v[136:139], v[180:183], v[60:63]
    ds_read2_b32 v[94:95], v239 offset0:226 offset1:227
    v_alignbit_b32 v221, v222, v221, 16
    v_mfma_f32_16x16x32_bf16 v[60:63], v[132:135], v[184:187], v[60:63]
    ds_write_b128 v241, v[218:221] offset:13536
    v_mfma_f32_16x16x32_bf16 v[60:63], v[128:131], v[188:191], v[60:63]
    s_waitcnt lgkmcnt(15)
    v_mfma_f32_16x16x32_bf16 v[32:35], v[64:67], v[96:99], v[32:35]
    ds_read_b128 v[160:163], v247 offset:0
    v_mfma_f32_16x16x32_bf16 v[36:39], v[68:71], v[96:99], v[36:39]
    v_alignbit_b32 v224, v225, v224, 16
    v_mfma_f32_16x16x32_bf16 v[36:39], v[64:67], v[100:103], v[36:39]
    ds_read_b128 v[164:167], v247 offset:4096
    v_mfma_f32_16x16x32_bf16 v[40:43], v[64:67], v[104:107], v[40:43]
    ds_read_b128 v[168:171], v247 offset:8192
    v_mfma_f32_16x16x32_bf16 v[40:43], v[68:71], v[100:103], v[40:43]
    ds_read_b128 v[172:175], v247 offset:12288
    v_mfma_f32_16x16x32_bf16 v[40:43], v[72:75], v[96:99], v[40:43]
    v_alignbit_b32 v225, v226, v225, 16
    v_mfma_f32_16x16x32_bf16 v[44:47], v[76:79], v[96:99], v[44:47]
    ds_read_b128 v[176:179], v247 offset:16384
    v_mfma_f32_16x16x32_bf16 v[44:47], v[72:75], v[100:103], v[44:47]
    ds_read_b128 v[180:183], v247 offset:20480
    v_mfma_f32_16x16x32_bf16 v[44:47], v[68:71], v[104:107], v[44:47]
    ds_read_b128 v[184:187], v247 offset:24576
    v_mfma_f32_16x16x32_bf16 v[44:47], v[64:67], v[108:111], v[44:47]
    v_alignbit_b32 v226, v227, v226, 16
    s_waitcnt lgkmcnt(8)
    v_mfma_f32_16x16x32_bf16 v[48:51], v[64:67], v[112:115], v[48:51]
    ds_read_b128 v[188:191], v247 offset:28672
    v_mfma_f32_16x16x32_bf16 v[48:51], v[68:71], v[108:111], v[48:51]
    ds_read2_b32 v[128:129], v236 offset0:112 offset1:113
    v_mfma_f32_16x16x32_bf16 v[48:51], v[72:75], v[104:107], v[48:51]
    v_alignbit_b32 v227, v228, v227, 16
    v_mfma_f32_16x16x32_bf16 v[48:51], v[76:79], v[100:103], v[48:51]
    ds_read2_b32 v[130:131], v236 offset0:114 offset1:115
    v_mfma_f32_16x16x32_bf16 v[48:51], v[80:83], v[96:99], v[48:51]
    ds_read2_b32 v[132:133], v236 offset0:240 offset1:241
    v_mfma_f32_16x16x32_bf16 v[52:55], v[84:87], v[96:99], v[52:55]
    ds_read2_b32 v[134:135], v236 offset0:242 offset1:243
    v_mfma_f32_16x16x32_bf16 v[52:55], v[80:83], v[100:103], v[52:55]
    ds_write_b128 v241, v[224:227] offset:14560
    v_mfma_f32_16x16x32_bf16 v[52:55], v[76:79], v[104:107], v[52:55]
    ds_read2_b32 v[136:137], v237 offset0:112 offset1:113
    v_mfma_f32_16x16x32_bf16 v[52:55], v[72:75], v[108:111], v[52:55]
    s_add_u32 s6, s12, 4718592
    ds_read2_b32 v[138:139], v237 offset0:114 offset1:115
    v_mfma_f32_16x16x32_bf16 v[52:55], v[68:71], v[112:115], v[52:55]
    ds_read2_b32 v[140:141], v237 offset0:240 offset1:241
    v_alignbit_b32 v230, v231, v230, 16
    v_mfma_f32_16x16x32_bf16 v[52:55], v[64:67], v[116:119], v[52:55]
    ds_read2_b32 v[142:143], v237 offset0:242 offset1:243
    v_xor_b32 v244, 64, v244
    v_mfma_f32_16x16x32_bf16 v[56:59], v[64:67], v[120:123], v[56:59]
    ds_read2_b32 v[144:145], v238 offset0:112 offset1:113
    v_mfma_f32_16x16x32_bf16 v[56:59], v[68:71], v[116:119], v[56:59]
    ds_read2_b32 v[146:147], v238 offset0:114 offset1:115
    v_mfma_f32_16x16x32_bf16 v[56:59], v[72:75], v[112:115], v[56:59]
    ds_read2_b32 v[148:149], v238 offset0:240 offset1:241
    v_alignbit_b32 v231, v232, v231, 16
    v_mfma_f32_16x16x32_bf16 v[56:59], v[76:79], v[108:111], v[56:59]
    ds_read2_b32 v[150:151], v238 offset0:242 offset1:243
    v_xor_b32 v245, 64, v245
    v_mfma_f32_16x16x32_bf16 v[56:59], v[80:83], v[104:107], v[56:59]
    ds_read2_b32 v[152:153], v239 offset0:112 offset1:113
    v_mfma_f32_16x16x32_bf16 v[56:59], v[84:87], v[100:103], v[56:59]
    ds_read2_b32 v[154:155], v239 offset0:114 offset1:115
    v_mfma_f32_16x16x32_bf16 v[56:59], v[88:91], v[96:99], v[56:59]
    ds_read2_b32 v[156:157], v239 offset0:240 offset1:241
    v_alignbit_b32 v232, v233, v232, 16
    v_mfma_f32_16x16x32_bf16 v[60:63], v[92:95], v[96:99], v[60:63]
    ds_read2_b32 v[158:159], v239 offset0:242 offset1:243
    v_mfma_f32_16x16x32_bf16 v[60:63], v[88:91], v[100:103], v[60:63]
    v_xor_b32 v246, 64, v246
    v_add_u32 v236, 8320, v236
    v_mfma_f32_16x16x32_bf16 v[60:63], v[84:87], v[104:107], v[60:63]
    v_alignbit_b32 v233, v234, v233, 16
    v_mfma_f32_16x16x32_bf16 v[60:63], v[80:83], v[108:111], v[60:63]
    v_add_u32 v237, 8320, v237
    v_mfma_f32_16x16x32_bf16 v[60:63], v[76:79], v[112:115], v[60:63]
    v_mfma_f32_16x16x32_bf16 v[60:63], v[72:75], v[116:119], v[60:63]
    v_xor_b32 v247, 64, v247
    v_add_u32 v238, 8320, v238
    v_mfma_f32_16x16x32_bf16 v[60:63], v[68:71], v[120:123], v[60:63]
    ds_write_b128 v241, v[230:233] offset:15584
    v_mfma_f32_16x16x32_bf16 v[60:63], v[64:67], v[124:127], v[60:63]
    v_add_u32 v239, 8320, v239
    s_waitcnt lgkmcnt(1)
    v_mfma_f32_16x16x32_bf16 v[60:63], v[128:131], v[188:191], v[60:63]
    ds_read_b128 v[96:99], v244 offset:2048
    v_mfma_f32_16x16x32_bf16 v[60:63], v[132:135], v[184:187], v[60:63]
    ds_read2_b32 v[64:65], v236 offset0:0 offset1:1
    v_mfma_f32_16x16x32_bf16 v[60:63], v[136:139], v[180:183], v[60:63]
    ds_read2_b32 v[66:67], v236 offset0:2 offset1:3
    v_mfma_f32_16x16x32_bf16 v[60:63], v[140:143], v[176:179], v[60:63]
    ds_read_b128 v[100:103], v244 offset:6144
    v_mfma_f32_16x16x32_bf16 v[60:63], v[144:147], v[172:175], v[60:63]
    ds_read2_b32 v[68:69], v236 offset0:128 offset1:129
    v_mfma_f32_16x16x32_bf16 v[60:63], v[148:151], v[168:171], v[60:63]
    ds_read2_b32 v[70:71], v236 offset0:130 offset1:131
    v_mfma_f32_16x16x32_bf16 v[60:63], v[152:155], v[164:167], v[60:63]
    ds_read_b128 v[104:107], v244 offset:10240
    v_mfma_f32_16x16x32_bf16 v[60:63], v[156:159], v[160:163], v[60:63]
    s_waitcnt vmcnt(4)
    s_barrier
    s_add_u32 s13, s12, 32768
    v_mfma_f32_16x16x32_bf16 v[56:59], v[128:131], v[184:187], v[56:59]
    ds_read2_b32 v[72:73], v237 offset0:0 offset1:1
    v_add_u32 v10, 131072, v10
    v_mfma_f32_16x16x32_bf16 v[56:59], v[132:135], v[180:183], v[56:59]
    ds_read_b64_tr_b16 a[32:33], v10 offset:16384
    s_add_u32 m0, s74, 32
    v_mfma_f32_16x16x32_bf16 v[56:59], v[136:139], v[176:179], v[56:59]
    ds_read_b64_tr_b16 a[34:35], v10 offset:18432
    buffer_load_dwordx4 v240, s[48:51], s13 offen offset:0 lds
    ds_read2_b32 v[74:75], v237 offset0:2 offset1:3
    v_mfma_f32_16x16x32_bf16 v[56:59], v[140:143], v[172:175], v[56:59]
    ds_read_b64_tr_b16 a[40:41], v10 offset:20480
    ds_read_b128 v[108:111], v244 offset:14336
    v_mfma_f32_16x16x32_bf16 v[56:59], v[144:147], v[168:171], v[56:59]
    ds_read2_b32 v[76:77], v237 offset0:128 offset1:129
    v_mfma_f32_16x16x32_bf16 v[56:59], v[148:151], v[164:167], v[56:59]
    ds_read_b64_tr_b16 a[42:43], v10 offset:22528
    v_cvt_pk_bf16_f32 v206, v60, v61
    v_mfma_f32_16x16x32_bf16 v[56:59], v[152:155], v[160:163], v[56:59]
    ds_read2_b32 v[78:79], v237 offset0:130 offset1:131
    v_add_u32 v11, 131072, v11
    v_mfma_f32_16x16x32_bf16 v[52:55], v[128:131], v[180:183], v[52:55]
    ds_read_b64_tr_b16 a[36:37], v11 offset:16384
    ds_read_b128 v[112:115], v244 offset:18432
    v_mfma_f32_16x16x32_bf16 v[52:55], v[132:135], v[176:179], v[52:55]
    ds_read_b64_tr_b16 a[38:39], v11 offset:18432
    s_add_u32 m0, s74, 32
    v_cvt_pk_bf16_f32 v207, v62, v63
    v_mfma_f32_16x16x32_bf16 v[52:55], v[136:139], v[172:175], v[52:55]
    ds_read_b64_tr_b16 a[44:45], v11 offset:20480
    buffer_load_dwordx4 v240, s[48:51], s13 offen offset:1024 lds
    ds_read2_b32 v[80:81], v238 offset0:0 offset1:1
    v_mfma_f32_16x16x32_bf16 v[52:55], v[140:143], v[168:171], v[52:55]
    buffer_store_dwordx2 v[206:207], v8, s[44:47], s6 offen offset:3584 sc1
    ds_read_b64_tr_b16 a[46:47], v11 offset:22528
    v_mfma_f32_16x16x32_bf16 v[52:55], v[144:147], v[164:167], v[52:55]
    ds_read2_b32 v[82:83], v238 offset0:2 offset1:3
    v_mfma_f32_16x16x32_bf16 v[52:55], v[148:151], v[160:163], v[52:55]
    ds_read_b128 v[116:119], v244 offset:22528
    v_mfma_f32_16x16x32_bf16 v[48:51], v[128:131], v[176:179], v[48:51]
    ds_read2_b32 v[84:85], v238 offset0:128 offset1:129
    v_cvt_pk_bf16_f32 v204, v56, v57
    v_mfma_f32_16x16x32_bf16 v[48:51], v[132:135], v[172:175], v[48:51]
    ds_read2_b32 v[86:87], v238 offset0:130 offset1:131
    v_mfma_f32_16x16x32_bf16 v[48:51], v[136:139], v[168:171], v[48:51]
    ds_read_b128 v[120:123], v244 offset:26624
    v_mfma_f32_16x16x32_bf16 v[48:51], v[140:143], v[164:167], v[48:51]
    ds_read2_b32 v[88:89], v239 offset0:0 offset1:1
    s_add_u32 m0, s74, 32
    v_cvt_pk_bf16_f32 v205, v58, v59
    v_mfma_f32_16x16x32_bf16 v[48:51], v[144:147], v[160:163], v[48:51]
    buffer_load_dwordx4 v240, s[48:51], s13 offen offset:2048 lds
    ds_read2_b32 v[90:91], v239 offset0:2 offset1:3
    v_mfma_f32_16x16x32_bf16 v[44:47], v[128:131], v[172:175], v[44:47]
    buffer_store_dwordx2 v[204:205], v8, s[44:47], s6 offen offset:3072 sc1
    ds_read_b128 v[124:127], v244 offset:30720
    v_mfma_f32_16x16x32_bf16 v[44:47], v[132:135], v[168:171], v[44:47]
    ds_read2_b32 v[92:93], v239 offset0:128 offset1:129
    v_mfma_f32_16x16x32_bf16 v[44:47], v[136:139], v[164:167], v[44:47]
    ds_read2_b32 v[94:95], v239 offset0:130 offset1:131
    v_mfma_f32_16x16x32_bf16 v[44:47], v[140:143], v[160:163], v[44:47]
    v_cvt_pk_bf16_f32 v202, v52, v53
    v_mfma_f32_16x16x32_bf16 v[40:43], v[128:131], v[168:171], v[40:43]
    v_mfma_f32_16x16x32_bf16 v[40:43], v[132:135], v[164:167], v[40:43]
    v_mfma_f32_16x16x32_bf16 v[40:43], v[136:139], v[160:163], v[40:43]
    s_add_u32 m0, s74, 32
    v_cvt_pk_bf16_f32 v203, v54, v55
    v_mfma_f32_16x16x32_bf16 v[36:39], v[128:131], v[164:167], v[36:39]
    buffer_load_dwordx4 v240, s[48:51], s13 offen offset:3072 lds
    v_mfma_f32_16x16x32_bf16 v[36:39], v[132:135], v[160:163], v[36:39]
    buffer_store_dwordx2 v[202:203], v8, s[44:47], s6 offen offset:2560 sc1
    v_mfma_f32_16x16x32_bf16 v[32:35], v[128:131], v[160:163], v[32:35]
    s_waitcnt lgkmcnt(0)
    v_mfma_f32_16x16x32_bf16 v[60:63], v[64:67], v[124:127], 0
    ds_read_b128 v[160:163], v245 offset:2048
    v_mfma_f32_16x16x32_bf16 v[60:63], v[68:71], v[120:123], v[60:63]
    v_cvt_pk_bf16_f32 v200, v48, v49
    v_mfma_f32_16x16x32_bf16 v[60:63], v[72:75], v[116:119], v[60:63]
    ds_read2_b32 v[128:129], v236 offset0:16 offset1:17
    v_mfma_f32_16x16x32_bf16 v[60:63], v[76:79], v[112:115], v[60:63]
    ds_read2_b32 v[130:131], v236 offset0:18 offset1:19
    v_cvt_pk_bf16_f32 v201, v50, v51
    v_mfma_f32_16x16x32_bf16 v[60:63], v[80:83], v[108:111], v[60:63]
    v_mfma_f32_16x16x32_bf16 v[60:63], v[84:87], v[104:107], v[60:63]
    buffer_store_dwordx2 v[200:201], v8, s[44:47], s6 offen offset:2048 sc1
    ds_read_b128 v[164:167], v245 offset:6144
    v_mfma_f32_16x16x32_bf16 v[60:63], v[88:91], v[100:103], v[60:63]
    ds_read2_b32 v[132:133], v236 offset0:144 offset1:145
    v_mfma_f32_16x16x32_bf16 v[60:63], v[92:95], v[96:99], v[60:63]
    ds_read2_b32 v[134:135], v236 offset0:146 offset1:147
    v_cvt_pk_bf16_f32 v198, v44, v45
    v_mfma_f32_16x16x32_bf16 v[56:59], v[64:67], v[120:123], 0
    ds_read_b128 v[168:171], v245 offset:10240
    v_mfma_f32_16x16x32_bf16 v[56:59], v[68:71], v[116:119], v[56:59]
    ds_read2_b32 v[136:137], v237 offset0:16 offset1:17
    v_mfma_f32_16x16x32_bf16 v[56:59], v[72:75], v[112:115], v[56:59]
    ds_read2_b32 v[138:139], v237 offset0:18 offset1:19
    v_cvt_pk_bf16_f32 v199, v46, v47
    v_mfma_f32_16x16x32_bf16 v[56:59], v[76:79], v[108:111], v[56:59]
    ds_read_b128 v[172:175], v245 offset:14336
    v_mfma_f32_16x16x32_bf16 v[56:59], v[80:83], v[104:107], v[56:59]
    buffer_store_dwordx2 v[198:199], v8, s[44:47], s6 offen offset:1536 sc1
    ds_read2_b32 v[140:141], v237 offset0:144 offset1:145
    v_mfma_f32_16x16x32_bf16 v[56:59], v[84:87], v[100:103], v[56:59]
    ds_read2_b32 v[142:143], v237 offset0:146 offset1:147
    v_mfma_f32_16x16x32_bf16 v[56:59], v[88:91], v[96:99], v[56:59]
    ds_read_b128 v[176:179], v245 offset:18432
    v_cvt_pk_bf16_f32 v196, v40, v41
    v_mfma_f32_16x16x32_bf16 v[52:55], v[64:67], v[116:119], 0
    ds_read2_b32 v[144:145], v238 offset0:16 offset1:17
    v_mfma_f32_16x16x32_bf16 v[52:55], v[68:71], v[112:115], v[52:55]
    ds_read2_b32 v[146:147], v238 offset0:18 offset1:19
    v_cvt_pk_bf16_f32 v197, v42, v43
    v_mfma_f32_16x16x32_bf16 v[52:55], v[72:75], v[108:111], v[52:55]
    ds_read_b128 v[180:183], v245 offset:22528
    v_mfma_f32_16x16x32_bf16 v[52:55], v[76:79], v[104:107], v[52:55]
    buffer_store_dwordx2 v[196:197], v8, s[44:47], s6 offen offset:1024 sc1
    ds_read2_b32 v[148:149], v238 offset0:144 offset1:145
    v_mfma_f32_16x16x32_bf16 v[52:55], v[80:83], v[100:103], v[52:55]
    ds_read2_b32 v[150:151], v238 offset0:146 offset1:147
    v_mfma_f32_16x16x32_bf16 v[52:55], v[84:87], v[96:99], v[52:55]
    ds_read_b128 v[184:187], v245 offset:26624
    v_mfma_f32_16x16x32_bf16 v[48:51], v[64:67], v[112:115], 0
    s_waitcnt vmcnt(10)
    s_barrier
    v_cvt_pk_bf16_f32 v194, v36, v37
    v_mfma_f32_16x16x32_bf16 v[48:51], v[68:71], v[108:111], v[48:51]
    ds_read2_b32 v[152:153], v239 offset0:16 offset1:17
    v_add_u32 v10, -131072, v10
    v_mfma_f32_16x16x32_bf16 v[48:51], v[72:75], v[104:107], v[48:51]
    ds_read_b64_tr_b16 a[48:49], v10 offset:49152
    v_cvt_pk_bf16_f32 v195, v38, v39
    v_mfma_f32_16x16x32_bf16 v[48:51], v[76:79], v[100:103], v[48:51]
    buffer_store_dwordx2 v[194:195], v8, s[44:47], s6 offen offset:512 sc1
    ds_read2_b32 v[154:155], v239 offset0:18 offset1:19
    v_mfma_f32_16x16x32_bf16 v[48:51], v[80:83], v[96:99], v[48:51]
    ds_read_b64_tr_b16 a[50:51], v10 offset:51200
    v_mfma_f32_16x16x32_bf16 v[44:47], v[64:67], v[108:111], 0
    ds_read_b64_tr_b16 a[56:57], v10 offset:53248
    v_mfma_f32_16x16x32_bf16 v[44:47], v[68:71], v[104:107], v[44:47]
    ds_read_b64_tr_b16 a[58:59], v10 offset:55296
    v_cvt_pk_bf16_f32 v192, v32, v33
    v_mfma_f32_16x16x32_bf16 v[44:47], v[72:75], v[100:103], v[44:47]
    ds_read_b128 v[188:191], v245 offset:30720
    v_add_u32 v11, -131072, v11
    v_mfma_f32_16x16x32_bf16 v[44:47], v[76:79], v[96:99], v[44:47]
    ds_read_b64_tr_b16 a[52:53], v11 offset:49152
    v_cvt_pk_bf16_f32 v193, v34, v35
    v_mfma_f32_16x16x32_bf16 v[40:43], v[64:67], v[104:107], 0
    buffer_store_dwordx2 v[192:193], v8, s[44:47], s6 offen offset:0 sc1
    ds_read2_b32 v[156:157], v239 offset0:144 offset1:145
    v_mfma_f32_16x16x32_bf16 v[40:43], v[68:71], v[100:103], v[40:43]
    ds_read_b64_tr_b16 a[54:55], v11 offset:51200
    v_mfma_f32_16x16x32_bf16 v[40:43], v[72:75], v[96:99], v[40:43]
    ds_read_b64_tr_b16 a[60:61], v11 offset:53248
    v_mfma_f32_16x16x32_bf16 v[36:39], v[64:67], v[100:103], 0
    ds_read_b64_tr_b16 a[62:63], v11 offset:55296
    v_mfma_f32_16x16x32_bf16 v[36:39], v[68:71], v[96:99], v[36:39]
    ds_read2_b32 v[158:159], v239 offset0:146 offset1:147
    v_mfma_f32_16x16x32_bf16 v[32:35], v[64:67], v[96:99], 0
    s_waitcnt lgkmcnt(15)
    v_mfma_f32_16x16x32_bf16 v[32:35], v[128:131], v[160:163], v[32:35]
    ds_read_b128 v[96:99], v246 offset:2048
    v_mfma_f32_16x16x32_bf16 v[36:39], v[132:135], v[160:163], v[36:39]
    v_mfma_f32_16x16x32_bf16 v[36:39], v[128:131], v[164:167], v[36:39]
    ds_read2_b32 v[64:65], v236 offset0:32 offset1:33
    v_mfma_f32_16x16x32_bf16 v[40:43], v[128:131], v[168:171], v[40:43]
    ds_read2_b32 v[66:67], v236 offset0:34 offset1:35
    v_mfma_f32_16x16x32_bf16 v[40:43], v[132:135], v[164:167], v[40:43]
    v_mfma_f32_16x16x32_bf16 v[40:43], v[136:139], v[160:163], v[40:43]
    ds_read_b128 v[100:103], v246 offset:6144
    v_mfma_f32_16x16x32_bf16 v[44:47], v[140:143], v[160:163], v[44:47]
    ds_read2_b32 v[68:69], v236 offset0:160 offset1:161
    v_mfma_f32_16x16x32_bf16 v[44:47], v[136:139], v[164:167], v[44:47]
    v_mfma_f32_16x16x32_bf16 v[44:47], v[132:135], v[168:171], v[44:47]
    ds_read2_b32 v[70:71], v236 offset0:162 offset1:163
    v_mfma_f32_16x16x32_bf16 v[44:47], v[128:131], v[172:175], v[44:47]
    ds_read_b128 v[104:107], v246 offset:10240
    s_waitcnt lgkmcnt(7)
    v_mfma_f32_16x16x32_bf16 v[48:51], v[128:131], v[176:179], v[48:51]
    ds_read2_b32 v[72:73], v237 offset0:32 offset1:33
    v_mfma_f32_16x16x32_bf16 v[48:51], v[132:135], v[172:175], v[48:51]
    ds_read2_b32 v[74:75], v237 offset0:34 offset1:35
    v_mfma_f32_16x16x32_bf16 v[48:51], v[136:139], v[168:171], v[48:51]
    v_mov_b32 v9, 16
    buffer_load_ushort v9, v9, s[56:59], s70 offen
    v_mfma_f32_16x16x32_bf16 v[48:51], v[140:143], v[164:167], v[48:51]
    ds_read_b128 v[108:111], v246 offset:14336
    v_mfma_f32_16x16x32_bf16 v[48:51], v[144:147], v[160:163], v[48:51]
    v_mfma_f32_16x16x32_bf16 v[52:55], v[148:151], v[160:163], v[52:55]
    ds_read2_b32 v[76:77], v237 offset0:160 offset1:161
    v_mfma_f32_16x16x32_bf16 v[52:55], v[144:147], v[164:167], v[52:55]
    ds_read2_b32 v[78:79], v237 offset0:162 offset1:163
    v_mfma_f32_16x16x32_bf16 v[52:55], v[140:143], v[168:171], v[52:55]
    v_mfma_f32_16x16x32_bf16 v[52:55], v[136:139], v[172:175], v[52:55]
    s_lshl_b32 s14, s88, 18
    ds_read_b128 v[112:115], v246 offset:18432
    v_mfma_f32_16x16x32_bf16 v[52:55], v[132:135], v[176:179], v[52:55]
    s_add_u32 m0, s73, 147456
    ds_read2_b32 v[80:81], v238 offset0:32 offset1:33
    v_mfma_f32_16x16x32_bf16 v[52:55], v[128:131], v[180:183], v[52:55]
    buffer_load_dwordx4 v4, s[52:55], s14 offen offset:0 lds
    v_mfma_f32_16x16x32_bf16 v[56:59], v[128:131], v[184:187], v[56:59]
    ds_read2_b32 v[82:83], v238 offset0:34 offset1:35
    v_mfma_f32_16x16x32_bf16 v[56:59], v[132:135], v[180:183], v[56:59]
    ds_read_b128 v[116:119], v246 offset:22528
    v_mfma_f32_16x16x32_bf16 v[56:59], v[136:139], v[176:179], v[56:59]
    v_mfma_f32_16x16x32_bf16 v[56:59], v[140:143], v[172:175], v[56:59]
    ds_read2_b32 v[84:85], v238 offset0:160 offset1:161
    v_mfma_f32_16x16x32_bf16 v[56:59], v[144:147], v[168:171], v[56:59]
    ds_read2_b32 v[86:87], v238 offset0:162 offset1:163
    v_mfma_f32_16x16x32_bf16 v[56:59], v[148:151], v[164:167], v[56:59]
    s_add_u32 m0, s73, 147456
    ds_read_b128 v[120:123], v246 offset:26624
    v_mfma_f32_16x16x32_bf16 v[56:59], v[152:155], v[160:163], v[56:59]
    buffer_load_dwordx4 v5, s[52:55], s14 offen offset:1024 lds
    v_mfma_f32_16x16x32_bf16 v[60:63], v[156:159], v[160:163], v[60:63]
    ds_read2_b32 v[88:89], v239 offset0:32 offset1:33
    v_mfma_f32_16x16x32_bf16 v[60:63], v[152:155], v[164:167], v[60:63]
    ds_read2_b32 v[90:91], v239 offset0:34 offset1:35
    v_mfma_f32_16x16x32_bf16 v[60:63], v[148:151], v[168:171], v[60:63]
    v_mfma_f32_16x16x32_bf16 v[60:63], v[144:147], v[172:175], v[60:63]
    ds_read_b128 v[124:127], v246 offset:30720
    v_mfma_f32_16x16x32_bf16 v[60:63], v[140:143], v[176:179], v[60:63]
    ds_read2_b32 v[92:93], v239 offset0:160 offset1:161
    v_mfma_f32_16x16x32_bf16 v[60:63], v[136:139], v[180:183], v[60:63]
    s_add_u32 m0, s73, 147456
    v_mfma_f32_16x16x32_bf16 v[60:63], v[132:135], v[184:187], v[60:63]
    buffer_load_dwordx4 v6, s[52:55], s14 offen offset:2048 lds
    ds_read2_b32 v[94:95], v239 offset0:162 offset1:163
    v_mfma_f32_16x16x32_bf16 v[60:63], v[128:131], v[188:191], v[60:63]
    s_waitcnt lgkmcnt(12)
    v_mfma_f32_16x16x32_bf16 v[32:35], v[64:67], v[96:99], v[32:35]
    ds_read_b128 v[160:163], v247 offset:2048
    v_mfma_f32_16x16x32_bf16 v[36:39], v[68:71], v[96:99], v[36:39]
    v_mfma_f32_16x16x32_bf16 v[36:39], v[64:67], v[100:103], v[36:39]
    ds_read2_b32 v[128:129], v236 offset0:48 offset1:49
    v_mfma_f32_16x16x32_bf16 v[40:43], v[64:67], v[104:107], v[40:43]
    ds_read2_b32 v[130:131], v236 offset0:50 offset1:51
    v_mfma_f32_16x16x32_bf16 v[40:43], v[68:71], v[100:103], v[40:43]
    s_add_u32 m0, s73, 147456
    v_mfma_f32_16x16x32_bf16 v[40:43], v[72:75], v[96:99], v[40:43]
    buffer_load_dwordx4 v7, s[52:55], s14 offen offset:3072 lds
    ds_read_b128 v[164:167], v247 offset:6144
    v_mfma_f32_16x16x32_bf16 v[44:47], v[76:79], v[96:99], v[44:47]
    ds_read2_b32 v[132:133], v236 offset0:176 offset1:177
    v_mfma_f32_16x16x32_bf16 v[44:47], v[72:75], v[100:103], v[44:47]
    s_barrier
    v_mfma_f32_16x16x32_bf16 v[44:47], v[68:71], v[104:107], v[44:47]
    ds_read2_b32 v[134:135], v236 offset0:178 offset1:179
    v_mfma_f32_16x16x32_bf16 v[44:47], v[64:67], v[108:111], v[44:47]
    ds_read_b128 v[168:171], v247 offset:10240
    s_waitcnt lgkmcnt(7)
    v_mfma_f32_16x16x32_bf16 v[48:51], v[64:67], v[112:115], v[48:51]
    ds_read2_b32 v[136:137], v237 offset0:48 offset1:49
    v_mfma_f32_16x16x32_bf16 v[48:51], v[68:71], v[108:111], v[48:51]
    v_mfma_f32_16x16x32_bf16 v[48:51], v[72:75], v[104:107], v[48:51]
    ds_read2_b32 v[138:139], v237 offset0:50 offset1:51
    v_mfma_f32_16x16x32_bf16 v[48:51], v[76:79], v[100:103], v[48:51]
    ds_read_b128 v[172:175], v247 offset:14336
    v_mfma_f32_16x16x32_bf16 v[48:51], v[80:83], v[96:99], v[48:51]
    v_mfma_f32_16x16x32_bf16 v[52:55], v[84:87], v[96:99], v[52:55]
    ds_read2_b32 v[140:141], v237 offset0:176 offset1:177
    v_mfma_f32_16x16x32_bf16 v[52:55], v[80:83], v[100:103], v[52:55]
    ds_read2_b32 v[142:143], v237 offset0:178 offset1:179
    v_mfma_f32_16x16x32_bf16 v[52:55], v[76:79], v[104:107], v[52:55]
    v_mfma_f32_16x16x32_bf16 v[52:55], v[72:75], v[108:111], v[52:55]
    ds_read_b128 v[176:179], v247 offset:18432
    v_mfma_f32_16x16x32_bf16 v[52:55], v[68:71], v[112:115], v[52:55]
    ds_read2_b32 v[144:145], v238 offset0:48 offset1:49
    v_mfma_f32_16x16x32_bf16 v[52:55], v[64:67], v[116:119], v[52:55]
    v_mfma_f32_16x16x32_bf16 v[56:59], v[64:67], v[120:123], v[56:59]
    ds_read2_b32 v[146:147], v238 offset0:50 offset1:51
    v_mfma_f32_16x16x32_bf16 v[56:59], v[68:71], v[116:119], v[56:59]
    ds_read_b128 v[180:183], v247 offset:22528
    v_mfma_f32_16x16x32_bf16 v[56:59], v[72:75], v[112:115], v[56:59]
    v_mfma_f32_16x16x32_bf16 v[56:59], v[76:79], v[108:111], v[56:59]
    ds_read2_b32 v[148:149], v238 offset0:176 offset1:177
    v_mfma_f32_16x16x32_bf16 v[56:59], v[80:83], v[104:107], v[56:59]
    ds_read2_b32 v[150:151], v238 offset0:178 offset1:179
    v_mfma_f32_16x16x32_bf16 v[56:59], v[84:87], v[100:103], v[56:59]
    ds_read_b128 v[184:187], v247 offset:26624
    v_mfma_f32_16x16x32_bf16 v[56:59], v[88:91], v[96:99], v[56:59]
    v_mfma_f32_16x16x32_bf16 v[60:63], v[92:95], v[96:99], v[60:63]
    ds_read2_b32 v[152:153], v239 offset0:48 offset1:49
    v_mfma_f32_16x16x32_bf16 v[60:63], v[88:91], v[100:103], v[60:63]
    ds_read2_b32 v[154:155], v239 offset0:50 offset1:51
    v_mfma_f32_16x16x32_bf16 v[60:63], v[84:87], v[104:107], v[60:63]
    v_mfma_f32_16x16x32_bf16 v[60:63], v[80:83], v[108:111], v[60:63]
    ds_read_b128 v[188:191], v247 offset:30720
    v_mfma_f32_16x16x32_bf16 v[60:63], v[76:79], v[112:115], v[60:63]
    ds_read2_b32 v[156:157], v239 offset0:176 offset1:177
    v_mfma_f32_16x16x32_bf16 v[60:63], v[72:75], v[116:119], v[60:63]
    v_mfma_f32_16x16x32_bf16 v[60:63], v[68:71], v[120:123], v[60:63]
    ds_read2_b32 v[158:159], v239 offset0:178 offset1:179
    v_mfma_f32_16x16x32_bf16 v[60:63], v[64:67], v[124:127], v[60:63]
    s_waitcnt lgkmcnt(12)
    v_mfma_f32_16x16x32_bf16 v[32:35], v[128:131], v[160:163], v[32:35]
    ds_read_b128 v[96:99], v244 offset:0
    v_mfma_f32_16x16x32_bf16 v[36:39], v[132:135], v[160:163], v[36:39]
    v_mfma_f32_16x16x32_bf16 v[36:39], v[128:131], v[164:167], v[36:39]
    ds_read2_b32 v[64:65], v236 offset0:64 offset1:65
    v_mfma_f32_16x16x32_bf16 v[40:43], v[128:131], v[168:171], v[40:43]
    ds_read2_b32 v[66:67], v236 offset0:66 offset1:67
    v_mfma_f32_16x16x32_bf16 v[40:43], v[132:135], v[164:167], v[40:43]
    v_mfma_f32_16x16x32_bf16 v[40:43], v[136:139], v[160:163], v[40:43]
    ds_read_b128 v[100:103], v244 offset:4096
    v_mfma_f32_16x16x32_bf16 v[44:47], v[140:143], v[160:163], v[44:47]
    ds_read2_b32 v[68:69], v236 offset0:192 offset1:193
    v_mfma_f32_16x16x32_bf16 v[44:47], v[136:139], v[164:167], v[44:47]
    s_add_u32 m0, s9, 36864
    s_add_u32 s13, s11, 0
    v_mfma_f32_16x16x32_bf16 v[44:47], v[132:135], v[168:171], v[44:47]
    buffer_load_dwordx4 v15, s[44:47], s13 offen sc1 lds
    ds_read2_b32 v[70:71], v236 offset0:194 offset1:195
    v_mfma_f32_16x16x32_bf16 v[44:47], v[128:131], v[172:175], v[44:47]
    ds_read_b128 v[104:107], v244 offset:8192
    s_waitcnt lgkmcnt(7)
    v_mfma_f32_16x16x32_bf16 v[48:51], v[128:131], v[176:179], v[48:51]
    ds_read2_b32 v[72:73], v237 offset0:64 offset1:65
    v_mfma_f32_16x16x32_bf16 v[48:51], v[132:135], v[172:175], v[48:51]
    v_mfma_f32_16x16x32_bf16 v[48:51], v[136:139], v[168:171], v[48:51]
    ds_read2_b32 v[74:75], v237 offset0:66 offset1:67
    v_mfma_f32_16x16x32_bf16 v[48:51], v[140:143], v[164:167], v[48:51]
    ds_read_b128 v[108:111], v244 offset:12288
    v_mfma_f32_16x16x32_bf16 v[48:51], v[144:147], v[160:163], v[48:51]
    v_mfma_f32_16x16x32_bf16 v[52:55], v[148:151], v[160:163], v[52:55]
    ds_read2_b32 v[76:77], v237 offset0:192 offset1:193
    v_mfma_f32_16x16x32_bf16 v[52:55], v[144:147], v[164:167], v[52:55]
    ds_read2_b32 v[78:79], v237 offset0:194 offset1:195
    s_add_u32 m0, s9, 37888
    s_add_u32 s13, s11, 90112
    v_mfma_f32_16x16x32_bf16 v[52:55], v[140:143], v[168:171], v[52:55]
    buffer_load_dwordx4 v16, s[44:47], s13 offen sc1 lds
    v_mfma_f32_16x16x32_bf16 v[52:55], v[136:139], v[172:175], v[52:55]
    ds_read_b128 v[112:115], v244 offset:16384
    v_mfma_f32_16x16x32_bf16 v[52:55], v[132:135], v[176:179], v[52:55]
    ds_read2_b32 v[80:81], v238 offset0:64 offset1:65
    v_mfma_f32_16x16x32_bf16 v[52:55], v[128:131], v[180:183], v[52:55]
    v_mfma_f32_16x16x32_bf16 v[56:59], v[128:131], v[184:187], v[56:59]
    ds_read2_b32 v[82:83], v238 offset0:66 offset1:67
    v_mfma_f32_16x16x32_bf16 v[56:59], v[132:135], v[180:183], v[56:59]
    ds_read_b128 v[116:119], v244 offset:20480
    v_mfma_f32_16x16x32_bf16 v[56:59], v[136:139], v[176:179], v[56:59]
    v_mfma_f32_16x16x32_bf16 v[56:59], v[140:143], v[172:175], v[56:59]
    ds_read2_b32 v[84:85], v238 offset0:192 offset1:193
    v_mfma_f32_16x16x32_bf16 v[56:59], v[144:147], v[168:171], v[56:59]
    ds_read2_b32 v[86:87], v238 offset0:194 offset1:195
    s_add_u32 m0, s9, 38912
    s_add_u32 s13, s11, 180224
    v_mfma_f32_16x16x32_bf16 v[56:59], v[148:151], v[164:167], v[56:59]
    buffer_load_dwordx4 v15, s[44:47], s13 offen sc1 lds
    ds_read_b128 v[120:123], v244 offset:24576
    v_mfma_f32_16x16x32_bf16 v[56:59], v[152:155], v[160:163], v[56:59]
    v_mfma_f32_16x16x32_bf16 v[60:63], v[156:159], v[160:163], v[60:63]
    ds_read2_b32 v[88:89], v239 offset0:64 offset1:65
    v_mfma_f32_16x16x32_bf16 v[60:63], v[152:155], v[164:167], v[60:63]
    ds_read2_b32 v[90:91], v239 offset0:66 offset1:67
    v_mfma_f32_16x16x32_bf16 v[60:63], v[148:151], v[168:171], v[60:63]
    v_mfma_f32_16x16x32_bf16 v[60:63], v[144:147], v[172:175], v[60:63]
    ds_read_b128 v[124:127], v244 offset:28672
    v_mfma_f32_16x16x32_bf16 v[60:63], v[140:143], v[176:179], v[60:63]
    ds_read2_b32 v[92:93], v239 offset0:192 offset1:193
    v_mfma_f32_16x16x32_bf16 v[60:63], v[136:139], v[180:183], v[60:63]
    v_mfma_f32_16x16x32_bf16 v[60:63], v[132:135], v[184:187], v[60:63]
    ds_read2_b32 v[94:95], v239 offset0:194 offset1:195
    s_add_u32 m0, s9, 39936
    s_add_u32 s13, s11, 270336
    v_mfma_f32_16x16x32_bf16 v[60:63], v[128:131], v[188:191], v[60:63]
    buffer_load_dwordx4 v16, s[44:47], s13 offen sc1 lds
    s_waitcnt lgkmcnt(12)
    v_mfma_f32_16x16x32_bf16 v[32:35], v[64:67], v[96:99], v[32:35]
    ds_read_b128 v[160:163], v245 offset:0
    s_waitcnt vmcnt(4)
    s_barrier
    v_mfma_f32_16x16x32_bf16 v[36:39], v[68:71], v[96:99], v[36:39]
    ds_read2_b32 v[128:129], v236 offset0:80 offset1:81
    v_add_u32 v10, 131072, v10
    v_mfma_f32_16x16x32_bf16 v[36:39], v[64:67], v[100:103], v[36:39]
    ds_read_b64_tr_b16 a[64:65], v10 offset:16384
    v_mfma_f32_16x16x32_bf16 v[40:43], v[64:67], v[104:107], v[40:43]
    ds_read_b64_tr_b16 a[66:67], v10 offset:18432
    ds_read2_b32 v[130:131], v236 offset0:82 offset1:83
    v_mfma_f32_16x16x32_bf16 v[40:43], v[68:71], v[100:103], v[40:43]
    ds_read_b64_tr_b16 a[72:73], v10 offset:20480
    v_mfma_f32_16x16x32_bf16 v[40:43], v[72:75], v[96:99], v[40:43]
    ds_read_b64_tr_b16 a[74:75], v10 offset:22528
    ds_read_b128 v[164:167], v245 offset:4096
L_pl_X_3:
    s_cbranch_execz L_pl_X_7
    v_mfma_f32_16x16x32_bf16 v[44:47], v[76:79], v[96:99], v[44:47]
    ds_read2_b32 v[132:133], v236 offset0:208 offset1:209
    v_mfma_f32_16x16x32_bf16 v[44:47], v[72:75], v[100:103], v[44:47]
    v_add_u32 v11, 131072, v11
    s_add_u32 m0, s9, 40960
    s_add_u32 s13, s11, 360448
    v_mfma_f32_16x16x32_bf16 v[44:47], v[68:71], v[104:107], v[44:47]
    ds_read_b64_tr_b16 a[68:69], v11 offset:16384
    buffer_load_dwordx4 v15, s[44:47], s13 offen sc1 lds
    ds_read2_b32 v[134:135], v236 offset0:210 offset1:211
    v_mfma_f32_16x16x32_bf16 v[44:47], v[64:67], v[108:111], v[44:47]
    ds_read_b64_tr_b16 a[70:71], v11 offset:18432
    ds_read_b128 v[168:171], v245 offset:8192
    s_waitcnt lgkmcnt(13)
    v_mfma_f32_16x16x32_bf16 v[48:51], v[64:67], v[112:115], v[48:51]
    ds_read_b64_tr_b16 a[76:77], v11 offset:20480
    v_mfma_f32_16x16x32_bf16 v[48:51], v[68:71], v[108:111], v[48:51]
    ds_read_b64_tr_b16 a[78:79], v11 offset:22528
    v_mfma_f32_16x16x32_bf16 v[48:51], v[72:75], v[104:107], v[48:51]
    ds_read2_b32 v[136:137], v237 offset0:80 offset1:81
    v_mfma_f32_16x16x32_bf16 v[48:51], v[76:79], v[100:103], v[48:51]
    ds_read2_b32 v[138:139], v237 offset0:82 offset1:83
    v_mfma_f32_16x16x32_bf16 v[48:51], v[80:83], v[96:99], v[48:51]
    ds_read_b128 v[172:175], v245 offset:12288
    v_mfma_f32_16x16x32_bf16 v[52:55], v[84:87], v[96:99], v[52:55]
    ds_read2_b32 v[140:141], v237 offset0:208 offset1:209
    v_mfma_f32_16x16x32_bf16 v[52:55], v[80:83], v[100:103], v[52:55]
    ds_read2_b32 v[142:143], v237 offset0:210 offset1:211
    s_add_u32 m0, s9, 41984
    s_add_u32 s13, s11, 450560
    v_mfma_f32_16x16x32_bf16 v[52:55], v[76:79], v[104:107], v[52:55]
    buffer_load_dwordx4 v16, s[44:47], s13 offen sc1 lds
    ds_read_b128 v[176:179], v245 offset:16384
    v_mfma_f32_16x16x32_bf16 v[52:55], v[72:75], v[108:111], v[52:55]
    ds_read2_b32 v[144:145], v238 offset0:80 offset1:81
    v_mfma_f32_16x16x32_bf16 v[52:55], v[68:71], v[112:115], v[52:55]
    ds_read_b128 v[212:215], v241 offset:32
    v_mfma_f32_16x16x32_bf16 v[52:55], v[64:67], v[116:119], v[52:55]
    ds_read2_b32 v[146:147], v238 offset0:82 offset1:83
    v_mfma_f32_16x16x32_bf16 v[56:59], v[64:67], v[120:123], v[56:59]
    ds_read_b32 v216, v241 offset:48
    v_mfma_f32_16x16x32_bf16 v[56:59], v[68:71], v[116:119], v[56:59]
    ds_read_b128 v[180:183], v245 offset:20480
    v_mfma_f32_16x16x32_bf16 v[56:59], v[72:75], v[112:115], v[56:59]
    ds_read_b128 v[218:221], v241 offset:1056
    v_mfma_f32_16x16x32_bf16 v[56:59], v[76:79], v[108:111], v[56:59]
    ds_read2_b32 v[148:149], v238 offset0:208 offset1:209
    v_mfma_f32_16x16x32_bf16 v[56:59], v[80:83], v[104:107], v[56:59]
    ds_read2_b32 v[150:151], v238 offset0:210 offset1:211
    s_add_u32 m0, s9, 43008
    s_add_u32 s13, s11, 540672
    v_mfma_f32_16x16x32_bf16 v[56:59], v[84:87], v[100:103], v[56:59]
    buffer_load_dwordx4 v15, s[44:47], s13 offen sc1 lds
    ds_read_b32 v222, v241 offset:1072
    v_mfma_f32_16x16x32_bf16 v[56:59], v[88:91], v[96:99], v[56:59]
    ds_read_b128 v[184:187], v245 offset:24576
    v_mfma_f32_16x16x32_bf16 v[60:63], v[92:95], v[96:99], v[60:63]
    ds_read_b128 v[224:227], v241 offset:2080
    ds_read2_b32 v[152:153], v239 offset0:80 offset1:81
    v_mfma_f32_16x16x32_bf16 v[60:63], v[88:91], v[100:103], v[60:63]
    ds_read2_b32 v[154:155], v239 offset0:82 offset1:83
    v_mfma_f32_16x16x32_bf16 v[60:63], v[84:87], v[104:107], v[60:63]
    ds_read_b32 v228, v241 offset:2096
    v_mfma_f32_16x16x32_bf16 v[60:63], v[80:83], v[108:111], v[60:63]
    ds_read_b128 v[188:191], v245 offset:28672
    v_mfma_f32_16x16x32_bf16 v[60:63], v[76:79], v[112:115], v[60:63]
    ds_read_b128 v[230:233], v241 offset:3104
    ds_read2_b32 v[156:157], v239 offset0:208 offset1:209
    v_mfma_f32_16x16x32_bf16 v[60:63], v[72:75], v[116:119], v[60:63]
    ds_read2_b32 v[158:159], v239 offset0:210 offset1:211
    v_mfma_f32_16x16x32_bf16 v[60:63], v[68:71], v[120:123], v[60:63]
    ds_read_b32 v234, v241 offset:3120
    s_add_u32 m0, s9, 44032
    s_add_u32 s13, s11, 630784
    v_mfma_f32_16x16x32_bf16 v[60:63], v[64:67], v[124:127], v[60:63]
    buffer_load_dwordx4 v16, s[44:47], s13 offen sc1 lds
    s_waitcnt lgkmcnt(15)
    v_mfma_f32_16x16x32_bf16 v[32:35], v[128:131], v[160:163], v[32:35]
    ds_read_b128 v[96:99], v246 offset:0
    v_mfma_f32_16x16x32_bf16 v[36:39], v[132:135], v[160:163], v[36:39]
    v_mfma_f32_16x16x32_bf16 v[36:39], v[128:131], v[164:167], v[36:39]
    ds_read2_b32 v[64:65], v236 offset0:96 offset1:97
    v_mfma_f32_16x16x32_bf16 v[40:43], v[128:131], v[168:171], v[40:43]
    ds_read2_b32 v[66:67], v236 offset0:98 offset1:99
    v_mfma_f32_16x16x32_bf16 v[40:43], v[132:135], v[164:167], v[40:43]
    s_waitcnt lgkmcnt(3)
    v_mfma_f32_16x16x32_bf16 v[40:43], v[136:139], v[160:163], v[40:43]
    ds_read_b128 v[100:103], v246 offset:4096
    v_mfma_f32_16x16x32_bf16 v[44:47], v[140:143], v[160:163], v[44:47]
    ds_read2_b32 v[68:69], v236 offset0:224 offset1:225
    v_mfma_f32_16x16x32_bf16 v[44:47], v[136:139], v[164:167], v[44:47]
    v_mfma_f32_16x16x32_bf16 v[44:47], v[132:135], v[168:171], v[44:47]
    ds_read2_b32 v[70:71], v236 offset0:226 offset1:227
    v_lshlrev_b32 v9, 16, v9
    v_mfma_f32_16x16x32_bf16 v[44:47], v[128:131], v[172:175], v[44:47]
    ds_read_b128 v[104:107], v246 offset:8192
    v_mfma_f32_16x16x32_bf16 v[48:51], v[128:131], v[176:179], v[48:51]
    ds_read2_b32 v[72:73], v237 offset0:96 offset1:97
    v_lshlrev_b32 v208, 16, v212
    v_mfma_f32_16x16x32_bf16 v[48:51], v[132:135], v[172:175], v[48:51]
    v_mfma_f32_16x16x32_bf16 v[48:51], v[136:139], v[168:171], v[48:51]
    ds_read2_b32 v[74:75], v237 offset0:98 offset1:99
    v_add_f32 v9, v9, v208
    v_mfma_f32_16x16x32_bf16 v[48:51], v[140:143], v[164:167], v[48:51]
    ds_read_b128 v[108:111], v246 offset:12288
    v_cvt_pk_bf16_f32 v9, v9, v9
    v_mfma_f32_16x16x32_bf16 v[48:51], v[144:147], v[160:163], v[48:51]
    ds_read2_b32 v[76:77], v237 offset0:224 offset1:225
    s_barrier
    v_mfma_f32_16x16x32_bf16 v[52:55], v[148:151], v[160:163], v[52:55]
    ds_write_b16 v242, v9 offset:4160
    v_mfma_f32_16x16x32_bf16 v[52:55], v[144:147], v[164:167], v[52:55]
    ds_read2_b32 v[78:79], v237 offset0:226 offset1:227
    v_mfma_f32_16x16x32_bf16 v[52:55], v[140:143], v[168:171], v[52:55]
    ds_write_b16 v242, v9 offset:2
    v_mfma_f32_16x16x32_bf16 v[52:55], v[136:139], v[172:175], v[52:55]
    s_lshl_b32 s14, s89, 18
    ds_read_b128 v[112:115], v246 offset:16384
    v_mfma_f32_16x16x32_bf16 v[52:55], v[132:135], v[176:179], v[52:55]
    ds_read2_b32 v[80:81], v238 offset0:96 offset1:97
    s_add_u32 m0, s73, 147456
    v_alignbit_b32 v212, v213, v212, 16
    v_mfma_f32_16x16x32_bf16 v[52:55], v[128:131], v[180:183], v[52:55]
    buffer_load_dwordx4 v4, s[52:55], s14 offen offset:0 lds
    v_alignbit_b32 v213, v214, v213, 16
    v_mfma_f32_16x16x32_bf16 v[56:59], v[128:131], v[184:187], v[56:59]
    ds_read2_b32 v[82:83], v238 offset0:98 offset1:99
    v_mfma_f32_16x16x32_bf16 v[56:59], v[132:135], v[180:183], v[56:59]
    ds_read_b128 v[116:119], v246 offset:20480
    v_alignbit_b32 v214, v215, v214, 16
    v_mfma_f32_16x16x32_bf16 v[56:59], v[136:139], v[176:179], v[56:59]
    v_mfma_f32_16x16x32_bf16 v[56:59], v[140:143], v[172:175], v[56:59]
    ds_read2_b32 v[84:85], v238 offset0:224 offset1:225
    v_alignbit_b32 v215, v216, v215, 16
    v_mfma_f32_16x16x32_bf16 v[56:59], v[144:147], v[168:171], v[56:59]
    ds_write_b128 v241, v[212:215] offset:4192
    v_mfma_f32_16x16x32_bf16 v[56:59], v[148:151], v[164:167], v[56:59]
    s_add_u32 m0, s73, 147456
    ds_read2_b32 v[86:87], v238 offset0:226 offset1:227
    v_mfma_f32_16x16x32_bf16 v[56:59], v[152:155], v[160:163], v[56:59]
    buffer_load_dwordx4 v5, s[52:55], s14 offen offset:1024 lds
    ds_read_b128 v[120:123], v246 offset:24576
    v_mfma_f32_16x16x32_bf16 v[60:63], v[156:159], v[160:163], v[60:63]
    ds_read2_b32 v[88:89], v239 offset0:96 offset1:97
    v_alignbit_b32 v218, v219, v218, 16
    v_mfma_f32_16x16x32_bf16 v[60:63], v[152:155], v[164:167], v[60:63]
    ds_read2_b32 v[90:91], v239 offset0:98 offset1:99
    v_alignbit_b32 v219, v220, v219, 16
    v_mfma_f32_16x16x32_bf16 v[60:63], v[148:151], v[168:171], v[60:63]
    ds_read_b128 v[124:127], v246 offset:28672
    v_mfma_f32_16x16x32_bf16 v[60:63], v[144:147], v[172:175], v[60:63]
    v_alignbit_b32 v220, v221, v220, 16
    v_alignbit_b32 v221, v222, v221, 16
    v_mfma_f32_16x16x32_bf16 v[60:63], v[140:143], v[176:179], v[60:63]
    ds_write_b128 v241, v[218:221] offset:5216
    v_mfma_f32_16x16x32_bf16 v[60:63], v[136:139], v[180:183], v[60:63]
    s_add_u32 m0, s73, 147456
    ds_read2_b32 v[92:93], v239 offset0:224 offset1:225
    v_mfma_f32_16x16x32_bf16 v[60:63], v[132:135], v[184:187], v[60:63]
    buffer_load_dwordx4 v6, s[52:55], s14 offen offset:2048 lds
    ds_read2_b32 v[94:95], v239 offset0:226 offset1:227
    v_mfma_f32_16x16x32_bf16 v[60:63], v[128:131], v[188:191], v[60:63]
    s_waitcnt lgkmcnt(15)
    v_mfma_f32_16x16x32_bf16 v[32:35], v[64:67], v[96:99], v[32:35]
    ds_read_b128 v[160:163], v247 offset:0
    v_mfma_f32_16x16x32_bf16 v[36:39], v[68:71], v[96:99], v[36:39]
    v_alignbit_b32 v224, v225, v224, 16
    v_mfma_f32_16x16x32_bf16 v[36:39], v[64:67], v[100:103], v[36:39]
    ds_read_b128 v[164:167], v247 offset:4096
    v_mfma_f32_16x16x32_bf16 v[40:43], v[64:67], v[104:107], v[40:43]
    ds_read_b128 v[168:171], v247 offset:8192
    v_mfma_f32_16x16x32_bf16 v[40:43], v[68:71], v[100:103], v[40:43]
    s_add_u32 m0, s73, 147456
    ds_read_b128 v[172:175], v247 offset:12288
    v_mfma_f32_16x16x32_bf16 v[40:43], v[72:75], v[96:99], v[40:43]
    buffer_load_dwordx4 v7, s[52:55], s14 offen offset:3072 lds
    v_alignbit_b32 v225, v226, v225, 16
    v_mfma_f32_16x16x32_bf16 v[44:47], v[76:79], v[96:99], v[44:47]
    ds_read_b128 v[176:179], v247 offset:16384
    v_mfma_f32_16x16x32_bf16 v[44:47], v[72:75], v[100:103], v[44:47]
    ds_read_b128 v[180:183], v247 offset:20480
    v_mfma_f32_16x16x32_bf16 v[44:47], v[68:71], v[104:107], v[44:47]
    ds_read_b128 v[184:187], v247 offset:24576
    v_mfma_f32_16x16x32_bf16 v[44:47], v[64:67], v[108:111], v[44:47]
    v_alignbit_b32 v226, v227, v226, 16
    s_waitcnt lgkmcnt(7)
    v_mfma_f32_16x16x32_bf16 v[48:51], v[64:67], v[112:115], v[48:51]
    ds_read_b128 v[188:191], v247 offset:28672
    v_mfma_f32_16x16x32_bf16 v[48:51], v[68:71], v[108:111], v[48:51]
    ds_read2_b32 v[128:129], v236 offset0:112 offset1:113
    v_mfma_f32_16x16x32_bf16 v[48:51], v[72:75], v[104:107], v[48:51]
    v_alignbit_b32 v227, v228, v227, 16
    v_mfma_f32_16x16x32_bf16 v[48:51], v[76:79], v[100:103], v[48:51]
    ds_read2_b32 v[130:131], v236 offset0:114 offset1:115
    v_mfma_f32_16x16x32_bf16 v[48:51], v[80:83], v[96:99], v[48:51]
    ds_read2_b32 v[132:133], v236 offset0:240 offset1:241
    v_mfma_f32_16x16x32_bf16 v[52:55], v[84:87], v[96:99], v[52:55]
    ds_read2_b32 v[134:135], v236 offset0:242 offset1:243
    v_mfma_f32_16x16x32_bf16 v[52:55], v[80:83], v[100:103], v[52:55]
    ds_write_b128 v241, v[224:227] offset:6240
    v_mfma_f32_16x16x32_bf16 v[52:55], v[76:79], v[104:107], v[52:55]
    ds_read2_b32 v[136:137], v237 offset0:112 offset1:113
    ds_read2_b32 v[138:139], v237 offset0:114 offset1:115
    v_mfma_f32_16x16x32_bf16 v[52:55], v[72:75], v[108:111], v[52:55]
    s_add_u32 s6, s12, 4734976
    ds_read2_b32 v[140:141], v237 offset0:240 offset1:241
    v_mfma_f32_16x16x32_bf16 v[52:55], v[68:71], v[112:115], v[52:55]
    ds_read2_b32 v[142:143], v237 offset0:242 offset1:243
    v_alignbit_b32 v230, v231, v230, 16
    v_xor_b32 v244, 64, v244
    v_mfma_f32_16x16x32_bf16 v[52:55], v[64:67], v[116:119], v[52:55]
    ds_read2_b32 v[144:145], v238 offset0:112 offset1:113
    v_mfma_f32_16x16x32_bf16 v[56:59], v[64:67], v[120:123], v[56:59]
    ds_read2_b32 v[146:147], v238 offset0:114 offset1:115
    v_xor_b32 v245, 64, v245
    v_mfma_f32_16x16x32_bf16 v[56:59], v[68:71], v[116:119], v[56:59]
    ds_read2_b32 v[148:149], v238 offset0:240 offset1:241
    v_mfma_f32_16x16x32_bf16 v[56:59], v[72:75], v[112:115], v[56:59]
    v_alignbit_b32 v231, v232, v231, 16
    v_xor_b32 v246, 64, v246
    v_mfma_f32_16x16x32_bf16 v[56:59], v[76:79], v[108:111], v[56:59]
    ds_read2_b32 v[150:151], v238 offset0:242 offset1:243
    v_mfma_f32_16x16x32_bf16 v[56:59], v[80:83], v[104:107], v[56:59]
    ds_read2_b32 v[152:153], v239 offset0:112 offset1:113
    v_xor_b32 v247, 64, v247
    v_mfma_f32_16x16x32_bf16 v[56:59], v[84:87], v[100:103], v[56:59]
    ds_read2_b32 v[154:155], v239 offset0:114 offset1:115
    v_mfma_f32_16x16x32_bf16 v[56:59], v[88:91], v[96:99], v[56:59]
    ds_read2_b32 v[156:157], v239 offset0:240 offset1:241
    v_alignbit_b32 v232, v233, v232, 16
    v_mfma_f32_16x16x32_bf16 v[60:63], v[92:95], v[96:99], v[60:63]
    ds_read2_b32 v[158:159], v239 offset0:242 offset1:243
    v_add_u32 v244, 36864, v244
    v_mfma_f32_16x16x32_bf16 v[60:63], v[88:91], v[100:103], v[60:63]
    v_add_u32 v236, -8320, v236
    v_mfma_f32_16x16x32_bf16 v[60:63], v[84:87], v[104:107], v[60:63]
    v_alignbit_b32 v233, v234, v233, 16
    v_add_u32 v245, 36864, v245
    v_mfma_f32_16x16x32_bf16 v[60:63], v[80:83], v[108:111], v[60:63]
    v_add_u32 v237, -8320, v237
    v_mfma_f32_16x16x32_bf16 v[60:63], v[76:79], v[112:115], v[60:63]
    s_waitcnt vmcnt(4)
    s_barrier
    v_add_u32 v246, 36864, v246
    v_mfma_f32_16x16x32_bf16 v[60:63], v[72:75], v[116:119], v[60:63]
    v_add_u32 v238, -8320, v238
    v_add_u32 v239, -8320, v239
    v_mfma_f32_16x16x32_bf16 v[60:63], v[68:71], v[120:123], v[60:63]
    ds_write_b128 v241, v[230:233] offset:7264
    v_mfma_f32_16x16x32_bf16 v[60:63], v[64:67], v[124:127], v[60:63]
    v_add_u32 v247, 36864, v247
    s_waitcnt lgkmcnt(1)
    v_mfma_f32_16x16x32_bf16 v[60:63], v[128:131], v[188:191], v[60:63]
    ds_read_b128 v[96:99], v244 offset:2048
    v_mfma_f32_16x16x32_bf16 v[60:63], v[132:135], v[184:187], v[60:63]
    ds_read2_b32 v[64:65], v236 offset0:0 offset1:1
    v_mfma_f32_16x16x32_bf16 v[60:63], v[136:139], v[180:183], v[60:63]
    ds_read2_b32 v[66:67], v236 offset0:2 offset1:3
    v_mfma_f32_16x16x32_bf16 v[60:63], v[140:143], v[176:179], v[60:63]
    ds_read_b128 v[100:103], v244 offset:6144
    v_mfma_f32_16x16x32_bf16 v[60:63], v[144:147], v[172:175], v[60:63]
    ds_read2_b32 v[68:69], v236 offset0:128 offset1:129
    v_mfma_f32_16x16x32_bf16 v[60:63], v[148:151], v[168:171], v[60:63]
    ds_read2_b32 v[70:71], v236 offset0:130 offset1:131
    v_mfma_f32_16x16x32_bf16 v[60:63], v[152:155], v[164:167], v[60:63]
    ds_read_b128 v[104:107], v244 offset:10240
    v_mfma_f32_16x16x32_bf16 v[60:63], v[156:159], v[160:163], v[60:63]
    s_add_u32 s13, s12, 49152
    ds_read2_b32 v[72:73], v237 offset0:0 offset1:1
    v_mfma_f32_16x16x32_bf16 v[56:59], v[128:131], v[184:187], v[56:59]
    ds_read2_b32 v[74:75], v237 offset0:2 offset1:3
    v_mfma_f32_16x16x32_bf16 v[56:59], v[132:135], v[180:183], v[56:59]
    s_add_u32 m0, s74, 8352
    ds_read_b128 v[108:111], v244 offset:14336
    v_mfma_f32_16x16x32_bf16 v[56:59], v[136:139], v[176:179], v[56:59]
    buffer_load_dwordx4 v240, s[48:51], s13 offen offset:0 lds
    ds_read2_b32 v[76:77], v237 offset0:128 offset1:129
    v_mfma_f32_16x16x32_bf16 v[56:59], v[140:143], v[172:175], v[56:59]
    ds_read2_b32 v[78:79], v237 offset0:130 offset1:131
    v_mfma_f32_16x16x32_bf16 v[56:59], v[144:147], v[168:171], v[56:59]
    ds_read_b128 v[112:115], v244 offset:18432
    v_mfma_f32_16x16x32_bf16 v[56:59], v[148:151], v[164:167], v[56:59]
    ds_read2_b32 v[80:81], v238 offset0:0 offset1:1
    v_cvt_pk_bf16_f32 v206, v60, v61
    v_mfma_f32_16x16x32_bf16 v[56:59], v[152:155], v[160:163], v[56:59]
    ds_read2_b32 v[82:83], v238 offset0:2 offset1:3
    v_mfma_f32_16x16x32_bf16 v[52:55], v[128:131], v[180:183], v[52:55]
    ds_read_b128 v[116:119], v244 offset:22528
    v_mfma_f32_16x16x32_bf16 v[52:55], v[132:135], v[176:179], v[52:55]
    ds_read2_b32 v[84:85], v238 offset0:128 offset1:129
    s_add_u32 m0, s74, 8352
    v_cvt_pk_bf16_f32 v207, v62, v63
    v_mfma_f32_16x16x32_bf16 v[52:55], v[136:139], v[172:175], v[52:55]
    buffer_load_dwordx4 v240, s[48:51], s13 offen offset:1024 lds
    ds_read2_b32 v[86:87], v238 offset0:130 offset1:131
    v_mfma_f32_16x16x32_bf16 v[52:55], v[140:143], v[168:171], v[52:55]
    buffer_store_dwordx2 v[206:207], v8, s[44:47], s6 offen offset:3584 sc1
    ds_read_b128 v[120:123], v244 offset:26624
    v_mfma_f32_16x16x32_bf16 v[52:55], v[144:147], v[164:167], v[52:55]
    ds_read2_b32 v[88:89], v239 offset0:0 offset1:1
    v_mfma_f32_16x16x32_bf16 v[52:55], v[148:151], v[160:163], v[52:55]
    ds_read2_b32 v[90:91], v239 offset0:2 offset1:3
    v_mfma_f32_16x16x32_bf16 v[48:51], v[128:131], v[176:179], v[48:51]
    s_waitcnt vmcnt(3)
    s_barrier
    v_cvt_pk_bf16_f32 v204, v56, v57
    v_mfma_f32_16x16x32_bf16 v[48:51], v[132:135], v[172:175], v[48:51]
    ds_read_b128 v[124:127], v244 offset:30720
    v_mfma_f32_16x16x32_bf16 v[48:51], v[136:139], v[168:171], v[48:51]
    ds_read_b64_tr_b16 a[80:81], v10 offset:16384
    v_mfma_f32_16x16x32_bf16 v[48:51], v[140:143], v[164:167], v[48:51]
    ds_read_b64_tr_b16 a[82:83], v10 offset:18432
    s_add_u32 m0, s74, 8352
    v_cvt_pk_bf16_f32 v205, v58, v59
    v_mfma_f32_16x16x32_bf16 v[48:51], v[144:147], v[160:163], v[48:51]
    ds_read_b64_tr_b16 a[88:89], v10 offset:20480
    buffer_load_dwordx4 v240, s[48:51], s13 offen offset:2048 lds
    v_mfma_f32_16x16x32_bf16 v[44:47], v[128:131], v[172:175], v[44:47]
    buffer_store_dwordx2 v[204:205], v8, s[44:47], s6 offen offset:3072 sc1
    ds_read2_b32 v[92:93], v239 offset0:128 offset1:129
    v_mfma_f32_16x16x32_bf16 v[44:47], v[132:135], v[168:171], v[44:47]
    ds_read_b64_tr_b16 a[90:91], v10 offset:22528
    v_mfma_f32_16x16x32_bf16 v[44:47], v[136:139], v[164:167], v[44:47]
    ds_read_b64_tr_b16 a[84:85], v11 offset:16384
    ds_read2_b32 v[94:95], v239 offset0:130 offset1:131
    v_mfma_f32_16x16x32_bf16 v[44:47], v[140:143], v[160:163], v[44:47]
    v_cvt_pk_bf16_f32 v202, v52, v53
    v_mfma_f32_16x16x32_bf16 v[40:43], v[128:131], v[168:171], v[40:43]
    ds_read_b64_tr_b16 a[86:87], v11 offset:18432
    v_mfma_f32_16x16x32_bf16 v[40:43], v[132:135], v[164:167], v[40:43]
    ds_read_b64_tr_b16 a[92:93], v11 offset:20480
    v_mfma_f32_16x16x32_bf16 v[40:43], v[136:139], v[160:163], v[40:43]
    s_add_u32 m0, s74, 8352
    v_cvt_pk_bf16_f32 v203, v54, v55
    v_mfma_f32_16x16x32_bf16 v[36:39], v[128:131], v[164:167], v[36:39]
    ds_read_b64_tr_b16 a[94:95], v11 offset:22528
    buffer_load_dwordx4 v240, s[48:51], s13 offen offset:3072 lds
    v_mfma_f32_16x16x32_bf16 v[36:39], v[132:135], v[160:163], v[36:39]
    buffer_store_dwordx2 v[202:203], v8, s[44:47], s6 offen offset:2560 sc1
    v_mfma_f32_16x16x32_bf16 v[32:35], v[128:131], v[160:163], v[32:35]
    s_waitcnt lgkmcnt(3)
    v_mfma_f32_16x16x32_bf16 v[60:63], v[64:67], v[124:127], 0
    ds_read_b128 v[160:163], v245 offset:2048
    v_mfma_f32_16x16x32_bf16 v[60:63], v[68:71], v[120:123], v[60:63]
    v_cvt_pk_bf16_f32 v200, v48, v49
    v_mfma_f32_16x16x32_bf16 v[60:63], v[72:75], v[116:119], v[60:63]
    ds_read2_b32 v[128:129], v236 offset0:16 offset1:17
    v_mfma_f32_16x16x32_bf16 v[60:63], v[76:79], v[112:115], v[60:63]
    ds_read2_b32 v[130:131], v236 offset0:18 offset1:19
    v_cvt_pk_bf16_f32 v201, v50, v51
    v_mfma_f32_16x16x32_bf16 v[60:63], v[80:83], v[108:111], v[60:63]
    v_mfma_f32_16x16x32_bf16 v[60:63], v[84:87], v[104:107], v[60:63]
    buffer_store_dwordx2 v[200:201], v8, s[44:47], s6 offen offset:2048 sc1
    ds_read_b128 v[164:167], v245 offset:6144
    v_mfma_f32_16x16x32_bf16 v[60:63], v[88:91], v[100:103], v[60:63]
    ds_read2_b32 v[132:133], v236 offset0:144 offset1:145
    v_mfma_f32_16x16x32_bf16 v[60:63], v[92:95], v[96:99], v[60:63]
    v_cvt_pk_bf16_f32 v198, v44, v45
    v_mfma_f32_16x16x32_bf16 v[56:59], v[64:67], v[120:123], 0
    ds_read2_b32 v[134:135], v236 offset0:146 offset1:147
    v_mfma_f32_16x16x32_bf16 v[56:59], v[68:71], v[116:119], v[56:59]
    ds_read_b128 v[168:171], v245 offset:10240
    v_mfma_f32_16x16x32_bf16 v[56:59], v[72:75], v[112:115], v[56:59]
    ds_read2_b32 v[136:137], v237 offset0:16 offset1:17
    v_cvt_pk_bf16_f32 v199, v46, v47
    v_mfma_f32_16x16x32_bf16 v[56:59], v[76:79], v[108:111], v[56:59]
    v_mfma_f32_16x16x32_bf16 v[56:59], v[80:83], v[104:107], v[56:59]
    buffer_store_dwordx2 v[198:199], v8, s[44:47], s6 offen offset:1536 sc1
    ds_read2_b32 v[138:139], v237 offset0:18 offset1:19
    v_mfma_f32_16x16x32_bf16 v[56:59], v[84:87], v[100:103], v[56:59]
    ds_read_b128 v[172:175], v245 offset:14336
    v_mfma_f32_16x16x32_bf16 v[56:59], v[88:91], v[96:99], v[56:59]
    v_cvt_pk_bf16_f32 v196, v40, v41
    v_mfma_f32_16x16x32_bf16 v[52:55], v[64:67], v[116:119], 0
    ds_read2_b32 v[140:141], v237 offset0:144 offset1:145
    v_mfma_f32_16x16x32_bf16 v[52:55], v[68:71], v[112:115], v[52:55]
    ds_read2_b32 v[142:143], v237 offset0:146 offset1:147
    v_cvt_pk_bf16_f32 v197, v42, v43
    v_mfma_f32_16x16x32_bf16 v[52:55], v[72:75], v[108:111], v[52:55]
    v_mfma_f32_16x16x32_bf16 v[52:55], v[76:79], v[104:107], v[52:55]
    buffer_store_dwordx2 v[196:197], v8, s[44:47], s6 offen offset:1024 sc1
    ds_read_b128 v[176:179], v245 offset:18432
    v_mfma_f32_16x16x32_bf16 v[52:55], v[80:83], v[100:103], v[52:55]
    ds_read2_b32 v[144:145], v238 offset0:16 offset1:17
    v_mfma_f32_16x16x32_bf16 v[52:55], v[84:87], v[96:99], v[52:55]
    v_mfma_f32_16x16x32_bf16 v[48:51], v[64:67], v[112:115], 0
    ds_read2_b32 v[146:147], v238 offset0:18 offset1:19
    v_cvt_pk_bf16_f32 v194, v36, v37
    v_mfma_f32_16x16x32_bf16 v[48:51], v[68:71], v[108:111], v[48:51]
    ds_read_b128 v[180:183], v245 offset:22528
    v_mfma_f32_16x16x32_bf16 v[48:51], v[72:75], v[104:107], v[48:51]
    v_cvt_pk_bf16_f32 v195, v38, v39
    v_mfma_f32_16x16x32_bf16 v[48:51], v[76:79], v[100:103], v[48:51]
    ds_read2_b32 v[148:149], v238 offset0:144 offset1:145
    v_mfma_f32_16x16x32_bf16 v[48:51], v[80:83], v[96:99], v[48:51]
    buffer_store_dwordx2 v[194:195], v8, s[44:47], s6 offen offset:512 sc1
    ds_read2_b32 v[150:151], v238 offset0:146 offset1:147
    v_mfma_f32_16x16x32_bf16 v[44:47], v[64:67], v[108:111], 0
    ds_read_b128 v[184:187], v245 offset:26624
    v_mfma_f32_16x16x32_bf16 v[44:47], v[68:71], v[104:107], v[44:47]
    v_cvt_pk_bf16_f32 v192, v32, v33
    v_mfma_f32_16x16x32_bf16 v[44:47], v[72:75], v[100:103], v[44:47]
    ds_read2_b32 v[152:153], v239 offset0:16 offset1:17
    v_mfma_f32_16x16x32_bf16 v[44:47], v[76:79], v[96:99], v[44:47]
    ds_read2_b32 v[154:155], v239 offset0:18 offset1:19
    v_cvt_pk_bf16_f32 v193, v34, v35
    v_mfma_f32_16x16x32_bf16 v[40:43], v[64:67], v[104:107], 0
    v_mfma_f32_16x16x32_bf16 v[40:43], v[68:71], v[100:103], v[40:43]
    buffer_store_dwordx2 v[192:193], v8, s[44:47], s6 offen offset:0 sc1
    ds_read_b128 v[188:191], v245 offset:30720
    v_mfma_f32_16x16x32_bf16 v[40:43], v[72:75], v[96:99], v[40:43]
    ds_read2_b32 v[156:157], v239 offset0:144 offset1:145
    v_mfma_f32_16x16x32_bf16 v[36:39], v[64:67], v[100:103], 0
    v_mfma_f32_16x16x32_bf16 v[36:39], v[68:71], v[96:99], v[36:39]
    ds_read2_b32 v[158:159], v239 offset0:146 offset1:147
    v_mfma_f32_16x16x32_bf16 v[32:35], v[64:67], v[96:99], 0
    s_waitcnt lgkmcnt(12)
    v_mfma_f32_16x16x32_bf16 v[32:35], v[128:131], v[160:163], v[32:35]
    ds_read_b128 v[96:99], v246 offset:2048
    v_mfma_f32_16x16x32_bf16 v[36:39], v[132:135], v[160:163], v[36:39]
    v_mfma_f32_16x16x32_bf16 v[36:39], v[128:131], v[164:167], v[36:39]
    ds_read2_b32 v[64:65], v236 offset0:32 offset1:33
    v_mfma_f32_16x16x32_bf16 v[40:43], v[128:131], v[168:171], v[40:43]
    ds_read2_b32 v[66:67], v236 offset0:34 offset1:35
    s_barrier
    v_mfma_f32_16x16x32_bf16 v[40:43], v[132:135], v[164:167], v[40:43]
    v_mfma_f32_16x16x32_bf16 v[40:43], v[136:139], v[160:163], v[40:43]
    ds_read_b128 v[100:103], v246 offset:6144
    v_mfma_f32_16x16x32_bf16 v[44:47], v[140:143], v[160:163], v[44:47]
    ds_read2_b32 v[68:69], v236 offset0:160 offset1:161
    v_mfma_f32_16x16x32_bf16 v[44:47], v[136:139], v[164:167], v[44:47]
    v_mfma_f32_16x16x32_bf16 v[44:47], v[132:135], v[168:171], v[44:47]
    ds_read2_b32 v[70:71], v236 offset0:162 offset1:163
    v_mfma_f32_16x16x32_bf16 v[44:47], v[128:131], v[172:175], v[44:47]
    ds_read_b128 v[104:107], v246 offset:10240
    s_waitcnt lgkmcnt(7)
    v_mfma_f32_16x16x32_bf16 v[48:51], v[128:131], v[176:179], v[48:51]
    ds_read2_b32 v[72:73], v237 offset0:32 offset1:33
    v_mfma_f32_16x16x32_bf16 v[48:51], v[132:135], v[172:175], v[48:51]
    ds_read2_b32 v[74:75], v237 offset0:34 offset1:35
    v_mfma_f32_16x16x32_bf16 v[48:51], v[136:139], v[168:171], v[48:51]
    v_mov_b32 v9, 24
    buffer_load_ushort v9, v9, s[56:59], s70 offen
    v_mfma_f32_16x16x32_bf16 v[48:51], v[140:143], v[164:167], v[48:51]
    ds_read_b128 v[108:111], v246 offset:14336
    v_mfma_f32_16x16x32_bf16 v[48:51], v[144:147], v[160:163], v[48:51]
    s_lshl_b32 s14, s90, 18
    v_mfma_f32_16x16x32_bf16 v[52:55], v[148:151], v[160:163], v[52:55]
    s_add_u32 m0, s73, 147456
    ds_read2_b32 v[76:77], v237 offset0:160 offset1:161
    v_mfma_f32_16x16x32_bf16 v[52:55], v[144:147], v[164:167], v[52:55]
    buffer_load_dwordx4 v4, s[52:55], s14 offen offset:0 lds
    ds_read2_b32 v[78:79], v237 offset0:162 offset1:163
    v_mfma_f32_16x16x32_bf16 v[52:55], v[140:143], v[168:171], v[52:55]
    v_mfma_f32_16x16x32_bf16 v[52:55], v[136:139], v[172:175], v[52:55]
    ds_read_b128 v[112:115], v246 offset:18432
    v_mfma_f32_16x16x32_bf16 v[52:55], v[132:135], v[176:179], v[52:55]
    ds_read2_b32 v[80:81], v238 offset0:32 offset1:33
    v_mfma_f32_16x16x32_bf16 v[52:55], v[128:131], v[180:183], v[52:55]
    v_mfma_f32_16x16x32_bf16 v[56:59], v[128:131], v[184:187], v[56:59]
    ds_read2_b32 v[82:83], v238 offset0:34 offset1:35
    v_mfma_f32_16x16x32_bf16 v[56:59], v[132:135], v[180:183], v[56:59]
    s_add_u32 m0, s73, 147456
    ds_read_b128 v[116:119], v246 offset:22528
    v_mfma_f32_16x16x32_bf16 v[56:59], v[136:139], v[176:179], v[56:59]
    buffer_load_dwordx4 v5, s[52:55], s14 offen offset:1024 lds
    v_mfma_f32_16x16x32_bf16 v[56:59], v[140:143], v[172:175], v[56:59]
    ds_read2_b32 v[84:85], v238 offset0:160 offset1:161
    v_mfma_f32_16x16x32_bf16 v[56:59], v[144:147], v[168:171], v[56:59]
    ds_read2_b32 v[86:87], v238 offset0:162 offset1:163
    v_mfma_f32_16x16x32_bf16 v[56:59], v[148:151], v[164:167], v[56:59]
    ds_read_b128 v[120:123], v246 offset:26624
    v_mfma_f32_16x16x32_bf16 v[56:59], v[152:155], v[160:163], v[56:59]
    v_mfma_f32_16x16x32_bf16 v[60:63], v[156:159], v[160:163], v[60:63]
    ds_read2_b32 v[88:89], v239 offset0:32 offset1:33
    v_mfma_f32_16x16x32_bf16 v[60:63], v[152:155], v[164:167], v[60:63]
    s_add_u32 m0, s73, 147456
    ds_read2_b32 v[90:91], v239 offset0:34 offset1:35
    v_mfma_f32_16x16x32_bf16 v[60:63], v[148:151], v[168:171], v[60:63]
    buffer_load_dwordx4 v6, s[52:55], s14 offen offset:2048 lds
    v_mfma_f32_16x16x32_bf16 v[60:63], v[144:147], v[172:175], v[60:63]
    ds_read_b128 v[124:127], v246 offset:30720
    v_mfma_f32_16x16x32_bf16 v[60:63], v[140:143], v[176:179], v[60:63]
    ds_read2_b32 v[92:93], v239 offset0:160 offset1:161
    v_mfma_f32_16x16x32_bf16 v[60:63], v[136:139], v[180:183], v[60:63]
    v_mfma_f32_16x16x32_bf16 v[60:63], v[132:135], v[184:187], v[60:63]
    ds_read2_b32 v[94:95], v239 offset0:162 offset1:163
    v_mfma_f32_16x16x32_bf16 v[60:63], v[128:131], v[188:191], v[60:63]
    s_waitcnt lgkmcnt(12)
    v_mfma_f32_16x16x32_bf16 v[32:35], v[64:67], v[96:99], v[32:35]
    ds_read_b128 v[160:163], v247 offset:2048
    v_mfma_f32_16x16x32_bf16 v[36:39], v[68:71], v[96:99], v[36:39]
    s_add_u32 m0, s73, 147456
    v_mfma_f32_16x16x32_bf16 v[36:39], v[64:67], v[100:103], v[36:39]
    buffer_load_dwordx4 v7, s[52:55], s14 offen offset:3072 lds
    ds_read2_b32 v[128:129], v236 offset0:48 offset1:49
    v_mfma_f32_16x16x32_bf16 v[40:43], v[64:67], v[104:107], v[40:43]
    ds_read2_b32 v[130:131], v236 offset0:50 offset1:51
    v_mfma_f32_16x16x32_bf16 v[40:43], v[68:71], v[100:103], v[40:43]
    v_mfma_f32_16x16x32_bf16 v[40:43], v[72:75], v[96:99], v[40:43]
    ds_read_b128 v[164:167], v247 offset:6144
    v_mfma_f32_16x16x32_bf16 v[44:47], v[76:79], v[96:99], v[44:47]
    ds_read2_b32 v[132:133], v236 offset0:176 offset1:177
    v_mfma_f32_16x16x32_bf16 v[44:47], v[72:75], v[100:103], v[44:47]
    v_mfma_f32_16x16x32_bf16 v[44:47], v[68:71], v[104:107], v[44:47]
    ds_read2_b32 v[134:135], v236 offset0:178 offset1:179
    v_mfma_f32_16x16x32_bf16 v[44:47], v[64:67], v[108:111], v[44:47]
    ds_read_b128 v[168:171], v247 offset:10240
    s_waitcnt lgkmcnt(7)
    v_mfma_f32_16x16x32_bf16 v[48:51], v[64:67], v[112:115], v[48:51]
    ds_read2_b32 v[136:137], v237 offset0:48 offset1:49
    v_mfma_f32_16x16x32_bf16 v[48:51], v[68:71], v[108:111], v[48:51]
    v_mfma_f32_16x16x32_bf16 v[48:51], v[72:75], v[104:107], v[48:51]
    ds_read2_b32 v[138:139], v237 offset0:50 offset1:51
    v_mfma_f32_16x16x32_bf16 v[48:51], v[76:79], v[100:103], v[48:51]
    ds_read_b128 v[172:175], v247 offset:14336
    v_mfma_f32_16x16x32_bf16 v[48:51], v[80:83], v[96:99], v[48:51]
    v_mfma_f32_16x16x32_bf16 v[52:55], v[84:87], v[96:99], v[52:55]
    ds_read2_b32 v[140:141], v237 offset0:176 offset1:177
    v_mfma_f32_16x16x32_bf16 v[52:55], v[80:83], v[100:103], v[52:55]
    ds_read2_b32 v[142:143], v237 offset0:178 offset1:179
    v_mfma_f32_16x16x32_bf16 v[52:55], v[76:79], v[104:107], v[52:55]
    v_mfma_f32_16x16x32_bf16 v[52:55], v[72:75], v[108:111], v[52:55]
    ds_read_b128 v[176:179], v247 offset:18432
    v_mfma_f32_16x16x32_bf16 v[52:55], v[68:71], v[112:115], v[52:55]
L_pl_X_4:
    s_cbranch_execz L_wret
    ds_read2_b32 v[144:145], v238 offset0:48 offset1:49
    v_mfma_f32_16x16x32_bf16 v[52:55], v[64:67], v[116:119], v[52:55]
    v_mfma_f32_16x16x32_bf16 v[56:59], v[64:67], v[120:123], v[56:59]
    s_lshl_b32 s14, s91, 18
    ds_read2_b32 v[146:147], v238 offset0:50 offset1:51
    v_mfma_f32_16x16x32_bf16 v[56:59], v[68:71], v[116:119], v[56:59]
    s_add_u32 m0, s73, 0
    ds_read_b128 v[180:183], v247 offset:22528
    v_mfma_f32_16x16x32_bf16 v[56:59], v[72:75], v[112:115], v[56:59]
    buffer_load_dwordx4 v4, s[52:55], s14 offen offset:0 lds
    v_mfma_f32_16x16x32_bf16 v[56:59], v[76:79], v[108:111], v[56:59]
    ds_read2_b32 v[148:149], v238 offset0:176 offset1:177
    v_mfma_f32_16x16x32_bf16 v[56:59], v[80:83], v[104:107], v[56:59]
    ds_read2_b32 v[150:151], v238 offset0:178 offset1:179
    v_mfma_f32_16x16x32_bf16 v[56:59], v[84:87], v[100:103], v[56:59]
    ds_read_b128 v[184:187], v247 offset:26624
    v_mfma_f32_16x16x32_bf16 v[56:59], v[88:91], v[96:99], v[56:59]
    v_mfma_f32_16x16x32_bf16 v[60:63], v[92:95], v[96:99], v[60:63]
    ds_read2_b32 v[152:153], v239 offset0:48 offset1:49
    v_mfma_f32_16x16x32_bf16 v[60:63], v[88:91], v[100:103], v[60:63]
    s_add_u32 m0, s73, 0
    ds_read2_b32 v[154:155], v239 offset0:50 offset1:51
    v_mfma_f32_16x16x32_bf16 v[60:63], v[84:87], v[104:107], v[60:63]
    buffer_load_dwordx4 v5, s[52:55], s14 offen offset:1024 lds
    v_mfma_f32_16x16x32_bf16 v[60:63], v[80:83], v[108:111], v[60:63]
    ds_read_b128 v[188:191], v247 offset:30720
    v_mfma_f32_16x16x32_bf16 v[60:63], v[76:79], v[112:115], v[60:63]
    ds_read2_b32 v[156:157], v239 offset0:176 offset1:177
    v_mfma_f32_16x16x32_bf16 v[60:63], v[72:75], v[116:119], v[60:63]
    v_mfma_f32_16x16x32_bf16 v[60:63], v[68:71], v[120:123], v[60:63]
    ds_read2_b32 v[158:159], v239 offset0:178 offset1:179
    v_mfma_f32_16x16x32_bf16 v[60:63], v[64:67], v[124:127], v[60:63]
    s_waitcnt lgkmcnt(12)
    v_mfma_f32_16x16x32_bf16 v[32:35], v[128:131], v[160:163], v[32:35]
    ds_read_b128 v[96:99], v244 offset:0
    v_mfma_f32_16x16x32_bf16 v[36:39], v[132:135], v[160:163], v[36:39]
    s_add_u32 m0, s73, 0
    v_mfma_f32_16x16x32_bf16 v[36:39], v[128:131], v[164:167], v[36:39]
    buffer_load_dwordx4 v6, s[52:55], s14 offen offset:2048 lds
    ds_read2_b32 v[64:65], v236 offset0:64 offset1:65
    v_mfma_f32_16x16x32_bf16 v[40:43], v[128:131], v[168:171], v[40:43]
    ds_read2_b32 v[66:67], v236 offset0:66 offset1:67
    v_mfma_f32_16x16x32_bf16 v[40:43], v[132:135], v[164:167], v[40:43]
    v_mfma_f32_16x16x32_bf16 v[40:43], v[136:139], v[160:163], v[40:43]
    ds_read_b128 v[100:103], v244 offset:4096
    v_mfma_f32_16x16x32_bf16 v[44:47], v[140:143], v[160:163], v[44:47]
    ds_read2_b32 v[68:69], v236 offset0:192 offset1:193
    v_mfma_f32_16x16x32_bf16 v[44:47], v[136:139], v[164:167], v[44:47]
    v_mfma_f32_16x16x32_bf16 v[44:47], v[132:135], v[168:171], v[44:47]
    s_add_u32 m0, s73, 0
    ds_read2_b32 v[70:71], v236 offset0:194 offset1:195
    v_mfma_f32_16x16x32_bf16 v[44:47], v[128:131], v[172:175], v[44:47]
    buffer_load_dwordx4 v7, s[52:55], s14 offen offset:3072 lds
    ds_read_b128 v[104:107], v244 offset:8192
    s_waitcnt lgkmcnt(7)
    v_mfma_f32_16x16x32_bf16 v[48:51], v[128:131], v[176:179], v[48:51]
    ds_read2_b32 v[72:73], v237 offset0:64 offset1:65
    v_mfma_f32_16x16x32_bf16 v[48:51], v[132:135], v[172:175], v[48:51]
    v_mfma_f32_16x16x32_bf16 v[48:51], v[136:139], v[168:171], v[48:51]
    ds_read2_b32 v[74:75], v237 offset0:66 offset1:67
    v_mfma_f32_16x16x32_bf16 v[48:51], v[140:143], v[164:167], v[48:51]
    ds_read_b128 v[108:111], v244 offset:12288
    v_mfma_f32_16x16x32_bf16 v[48:51], v[144:147], v[160:163], v[48:51]
    v_mfma_f32_16x16x32_bf16 v[52:55], v[148:151], v[160:163], v[52:55]
    ds_read2_b32 v[76:77], v237 offset0:192 offset1:193
    v_mfma_f32_16x16x32_bf16 v[52:55], v[144:147], v[164:167], v[52:55]
    ds_read2_b32 v[78:79], v237 offset0:194 offset1:195
    v_mfma_f32_16x16x32_bf16 v[52:55], v[140:143], v[168:171], v[52:55]
    v_mfma_f32_16x16x32_bf16 v[52:55], v[136:139], v[172:175], v[52:55]
    ds_read_b128 v[112:115], v244 offset:16384
    v_mfma_f32_16x16x32_bf16 v[52:55], v[132:135], v[176:179], v[52:55]
    ds_read2_b32 v[80:81], v238 offset0:64 offset1:65
    v_mfma_f32_16x16x32_bf16 v[52:55], v[128:131], v[180:183], v[52:55]
    v_mfma_f32_16x16x32_bf16 v[56:59], v[128:131], v[184:187], v[56:59]
    ds_read2_b32 v[82:83], v238 offset0:66 offset1:67
    v_mfma_f32_16x16x32_bf16 v[56:59], v[132:135], v[180:183], v[56:59]
    ds_read_b128 v[116:119], v244 offset:20480
    v_mfma_f32_16x16x32_bf16 v[56:59], v[136:139], v[176:179], v[56:59]
    v_mfma_f32_16x16x32_bf16 v[56:59], v[140:143], v[172:175], v[56:59]
    ds_read2_b32 v[84:85], v238 offset0:192 offset1:193
    v_mfma_f32_16x16x32_bf16 v[56:59], v[144:147], v[168:171], v[56:59]
    ds_read2_b32 v[86:87], v238 offset0:194 offset1:195
    v_mfma_f32_16x16x32_bf16 v[56:59], v[148:151], v[164:167], v[56:59]
    ds_read_b128 v[120:123], v244 offset:24576
    v_mfma_f32_16x16x32_bf16 v[56:59], v[152:155], v[160:163], v[56:59]
    v_mfma_f32_16x16x32_bf16 v[60:63], v[156:159], v[160:163], v[60:63]
    s_lshl_b32 s14, s92, 18
    ds_read2_b32 v[88:89], v239 offset0:64 offset1:65
    v_mfma_f32_16x16x32_bf16 v[60:63], v[152:155], v[164:167], v[60:63]
    s_add_u32 m0, s73, 16384
    ds_read2_b32 v[90:91], v239 offset0:66 offset1:67
    v_mfma_f32_16x16x32_bf16 v[60:63], v[148:151], v[168:171], v[60:63]
    buffer_load_dwordx4 v4, s[52:55], s14 offen offset:0 lds
    v_mfma_f32_16x16x32_bf16 v[60:63], v[144:147], v[172:175], v[60:63]
    ds_read_b128 v[124:127], v244 offset:28672
    v_mfma_f32_16x16x32_bf16 v[60:63], v[140:143], v[176:179], v[60:63]
    ds_read2_b32 v[92:93], v239 offset0:192 offset1:193
    v_mfma_f32_16x16x32_bf16 v[60:63], v[136:139], v[180:183], v[60:63]
    v_mfma_f32_16x16x32_bf16 v[60:63], v[132:135], v[184:187], v[60:63]
    ds_read2_b32 v[94:95], v239 offset0:194 offset1:195
    v_mfma_f32_16x16x32_bf16 v[60:63], v[128:131], v[188:191], v[60:63]
    s_waitcnt lgkmcnt(12)
    v_mfma_f32_16x16x32_bf16 v[32:35], v[64:67], v[96:99], v[32:35]
    ds_read_b128 v[160:163], v245 offset:0
    v_mfma_f32_16x16x32_bf16 v[36:39], v[68:71], v[96:99], v[36:39]
    s_add_u32 m0, s73, 16384
    ds_read2_b32 v[128:129], v236 offset0:80 offset1:81
    v_mfma_f32_16x16x32_bf16 v[36:39], v[64:67], v[100:103], v[36:39]
    buffer_load_dwordx4 v5, s[52:55], s14 offen offset:1024 lds
    ds_read2_b32 v[130:131], v236 offset0:82 offset1:83
    v_mfma_f32_16x16x32_bf16 v[40:43], v[64:67], v[104:107], v[40:43]
    ds_read_b128 v[164:167], v245 offset:4096
    v_mfma_f32_16x16x32_bf16 v[40:43], v[68:71], v[100:103], v[40:43]
    ds_read2_b32 v[132:133], v236 offset0:208 offset1:209
    v_mfma_f32_16x16x32_bf16 v[40:43], v[72:75], v[96:99], v[40:43]
    ds_read2_b32 v[134:135], v236 offset0:210 offset1:211
    v_mfma_f32_16x16x32_bf16 v[44:47], v[76:79], v[96:99], v[44:47]
    ds_read_b128 v[168:171], v245 offset:8192
    v_mfma_f32_16x16x32_bf16 v[44:47], v[72:75], v[100:103], v[44:47]
    ds_read2_b32 v[136:137], v237 offset0:80 offset1:81
    v_mfma_f32_16x16x32_bf16 v[44:47], v[68:71], v[104:107], v[44:47]
    s_add_u32 m0, s73, 16384
    ds_read2_b32 v[138:139], v237 offset0:82 offset1:83
    v_mfma_f32_16x16x32_bf16 v[44:47], v[64:67], v[108:111], v[44:47]
    buffer_load_dwordx4 v6, s[52:55], s14 offen offset:2048 lds
    ds_read_b128 v[172:175], v245 offset:12288
    s_waitcnt lgkmcnt(10)
    v_mfma_f32_16x16x32_bf16 v[48:51], v[64:67], v[112:115], v[48:51]
    ds_read2_b32 v[140:141], v237 offset0:208 offset1:209
    v_mfma_f32_16x16x32_bf16 v[48:51], v[68:71], v[108:111], v[48:51]
    ds_read2_b32 v[142:143], v237 offset0:210 offset1:211
    v_mfma_f32_16x16x32_bf16 v[48:51], v[72:75], v[104:107], v[48:51]
    ds_read_b128 v[176:179], v245 offset:16384
    v_mfma_f32_16x16x32_bf16 v[48:51], v[76:79], v[100:103], v[48:51]
    ds_read2_b32 v[144:145], v238 offset0:80 offset1:81
    v_mfma_f32_16x16x32_bf16 v[48:51], v[80:83], v[96:99], v[48:51]
    ds_read2_b32 v[146:147], v238 offset0:82 offset1:83
    s_waitcnt vmcnt(7)
    s_barrier
    v_mfma_f32_16x16x32_bf16 v[52:55], v[84:87], v[96:99], v[52:55]
    ds_read_b64_tr_b16 a[96:97], v10 offset:16384
    s_add_u32 m0, s73, 16384
    v_mfma_f32_16x16x32_bf16 v[52:55], v[80:83], v[100:103], v[52:55]
    buffer_load_dwordx4 v7, s[52:55], s14 offen offset:3072 lds
    ds_read_b128 v[180:183], v245 offset:20480
    v_mfma_f32_16x16x32_bf16 v[52:55], v[76:79], v[104:107], v[52:55]
    ds_read_b64_tr_b16 a[98:99], v10 offset:18432
    v_mfma_f32_16x16x32_bf16 v[52:55], v[72:75], v[108:111], v[52:55]
    ds_read_b64_tr_b16 a[104:105], v10 offset:20480
    v_mfma_f32_16x16x32_bf16 v[52:55], v[68:71], v[112:115], v[52:55]
    ds_read_b128 v[212:215], v241 offset:8352
    v_mfma_f32_16x16x32_bf16 v[52:55], v[64:67], v[116:119], v[52:55]
    ds_read_b64_tr_b16 a[106:107], v10 offset:22528
    v_mfma_f32_16x16x32_bf16 v[56:59], v[64:67], v[120:123], v[56:59]
    ds_read_b64_tr_b16 a[100:101], v11 offset:16384
    v_mfma_f32_16x16x32_bf16 v[56:59], v[68:71], v[116:119], v[56:59]
    ds_read_b32 v216, v241 offset:8368
    v_mfma_f32_16x16x32_bf16 v[56:59], v[72:75], v[112:115], v[56:59]
    ds_read_b64_tr_b16 a[102:103], v11 offset:18432
    v_mfma_f32_16x16x32_bf16 v[56:59], v[76:79], v[108:111], v[56:59]
    ds_read_b64_tr_b16 a[108:109], v11 offset:20480
    ds_read2_b32 v[148:149], v238 offset0:208 offset1:209
    v_mfma_f32_16x16x32_bf16 v[56:59], v[80:83], v[104:107], v[56:59]
    ds_read_b64_tr_b16 a[110:111], v11 offset:22528
    ds_read2_b32 v[150:151], v238 offset0:210 offset1:211
    v_mfma_f32_16x16x32_bf16 v[56:59], v[84:87], v[100:103], v[56:59]
    ds_read_b128 v[218:221], v241 offset:9376
    ds_read_b128 v[184:187], v245 offset:24576
    v_mfma_f32_16x16x32_bf16 v[56:59], v[88:91], v[96:99], v[56:59]
    ds_read_b32 v222, v241 offset:9392
    v_mfma_f32_16x16x32_bf16 v[60:63], v[92:95], v[96:99], v[60:63]
    ds_read_b128 v[224:227], v241 offset:10400
    ds_read2_b32 v[152:153], v239 offset0:80 offset1:81
    v_mfma_f32_16x16x32_bf16 v[60:63], v[88:91], v[100:103], v[60:63]
    ds_read2_b32 v[154:155], v239 offset0:82 offset1:83
    v_mfma_f32_16x16x32_bf16 v[60:63], v[84:87], v[104:107], v[60:63]
    ds_read_b32 v228, v241 offset:10416
    v_mfma_f32_16x16x32_bf16 v[60:63], v[80:83], v[108:111], v[60:63]
    ds_read_b128 v[188:191], v245 offset:28672
    v_mfma_f32_16x16x32_bf16 v[60:63], v[76:79], v[112:115], v[60:63]
    ds_read_b128 v[230:233], v241 offset:11424
    s_waitcnt lgkmcnt(10)
    s_barrier
    v_mfma_f32_16x16x32_bf16 v[60:63], v[72:75], v[116:119], v[60:63]
    ds_read2_b32 v[156:157], v239 offset0:208 offset1:209
    v_mfma_f32_16x16x32_bf16 v[60:63], v[68:71], v[120:123], v[60:63]
    ds_read_b32 v234, v241 offset:11440
    ds_read2_b32 v[158:159], v239 offset0:210 offset1:211
    v_mfma_f32_16x16x32_bf16 v[60:63], v[64:67], v[124:127], v[60:63]
    v_mfma_f32_16x16x32_bf16 v[32:35], v[128:131], v[160:163], v[32:35]
    s_lshl_b32 s14, s93, 18
    ds_read_b128 v[96:99], v246 offset:0
    v_mfma_f32_16x16x32_bf16 v[36:39], v[132:135], v[160:163], v[36:39]
    s_add_u32 m0, s73, 147456
    ds_read2_b32 v[64:65], v236 offset0:96 offset1:97
    v_mfma_f32_16x16x32_bf16 v[36:39], v[128:131], v[164:167], v[36:39]
    buffer_load_dwordx4 v4, s[52:55], s14 offen offset:0 lds
    ds_read2_b32 v[66:67], v236 offset0:98 offset1:99
    v_mfma_f32_16x16x32_bf16 v[40:43], v[128:131], v[168:171], v[40:43]
    ds_read_b128 v[100:103], v246 offset:4096
    v_mfma_f32_16x16x32_bf16 v[40:43], v[132:135], v[164:167], v[40:43]
    s_waitcnt lgkmcnt(5)
    ds_read2_b32 v[68:69], v236 offset0:224 offset1:225
    v_mfma_f32_16x16x32_bf16 v[40:43], v[136:139], v[160:163], v[40:43]
    ds_read2_b32 v[70:71], v236 offset0:226 offset1:227
    v_mfma_f32_16x16x32_bf16 v[44:47], v[140:143], v[160:163], v[44:47]
    ds_read_b128 v[104:107], v246 offset:8192
    v_mfma_f32_16x16x32_bf16 v[44:47], v[136:139], v[164:167], v[44:47]
    ds_read2_b32 v[72:73], v237 offset0:96 offset1:97
    v_mfma_f32_16x16x32_bf16 v[44:47], v[132:135], v[168:171], v[44:47]
    ds_read2_b32 v[74:75], v237 offset0:98 offset1:99
    s_add_u32 m0, s73, 147456
    v_lshlrev_b32 v9, 16, v9
    v_mfma_f32_16x16x32_bf16 v[44:47], v[128:131], v[172:175], v[44:47]
    buffer_load_dwordx4 v5, s[52:55], s14 offen offset:1024 lds
    ds_read_b128 v[108:111], v246 offset:12288
    s_waitcnt lgkmcnt(10)
    v_mfma_f32_16x16x32_bf16 v[48:51], v[128:131], v[176:179], v[48:51]
    ds_read2_b32 v[76:77], v237 offset0:224 offset1:225
    v_lshlrev_b32 v208, 16, v212
    v_mfma_f32_16x16x32_bf16 v[48:51], v[132:135], v[172:175], v[48:51]
    ds_read2_b32 v[78:79], v237 offset0:226 offset1:227
    v_mfma_f32_16x16x32_bf16 v[48:51], v[136:139], v[168:171], v[48:51]
    ds_read_b128 v[112:115], v246 offset:16384
    v_add_f32 v9, v9, v208
    v_mfma_f32_16x16x32_bf16 v[48:51], v[140:143], v[164:167], v[48:51]
    ds_read2_b32 v[80:81], v238 offset0:96 offset1:97
    v_cvt_pk_bf16_f32 v9, v9, v9
    v_mfma_f32_16x16x32_bf16 v[48:51], v[144:147], v[160:163], v[48:51]
    ds_write_b16 v242, v9 offset:12480
    v_mfma_f32_16x16x32_bf16 v[52:55], v[148:151], v[160:163], v[52:55]
    s_add_u32 m0, s73, 147456
    ds_read2_b32 v[82:83], v238 offset0:98 offset1:99
    v_mfma_f32_16x16x32_bf16 v[52:55], v[144:147], v[164:167], v[52:55]
    buffer_load_dwordx4 v6, s[52:55], s14 offen offset:2048 lds
    ds_read_b128 v[116:119], v246 offset:20480
    v_mfma_f32_16x16x32_bf16 v[52:55], v[140:143], v[168:171], v[52:55]
    ds_write_b16 v242, v9 offset:8322
    v_mfma_f32_16x16x32_bf16 v[52:55], v[136:139], v[172:175], v[52:55]
    ds_read2_b32 v[84:85], v238 offset0:224 offset1:225
    v_mfma_f32_16x16x32_bf16 v[52:55], v[132:135], v[176:179], v[52:55]
    ds_read2_b32 v[86:87], v238 offset0:226 offset1:227
    v_alignbit_b32 v212, v213, v212, 16
    v_mfma_f32_16x16x32_bf16 v[52:55], v[128:131], v[180:183], v[52:55]
    v_alignbit_b32 v213, v214, v213, 16
    v_alignbit_b32 v214, v215, v214, 16
    v_mfma_f32_16x16x32_bf16 v[56:59], v[128:131], v[184:187], v[56:59]
    s_waitcnt vmcnt(7)
    s_barrier
    v_alignbit_b32 v215, v216, v215, 16
    v_mfma_f32_16x16x32_bf16 v[56:59], v[132:135], v[180:183], v[56:59]
    v_add_u32 v10, -131072, v10
    s_add_u32 m0, s73, 147456
    v_mfma_f32_16x16x32_bf16 v[56:59], v[136:139], v[176:179], v[56:59]
    ds_read_b64_tr_b16 a[112:113], v10 offset:0
    buffer_load_dwordx4 v7, s[52:55], s14 offen offset:3072 lds
    v_mfma_f32_16x16x32_bf16 v[56:59], v[140:143], v[172:175], v[56:59]
    ds_write_b128 v241, v[212:215] offset:12512
    v_mfma_f32_16x16x32_bf16 v[56:59], v[144:147], v[168:171], v[56:59]
    ds_read_b64_tr_b16 a[114:115], v10 offset:2048
    ds_read_b128 v[120:123], v246 offset:24576
    v_mfma_f32_16x16x32_bf16 v[56:59], v[148:151], v[164:167], v[56:59]
    ds_read_b64_tr_b16 a[120:121], v10 offset:4096
    ds_read2_b32 v[88:89], v239 offset0:96 offset1:97
    v_mfma_f32_16x16x32_bf16 v[56:59], v[152:155], v[160:163], v[56:59]
    ds_read_b64_tr_b16 a[122:123], v10 offset:6144
    v_alignbit_b32 v218, v219, v218, 16
    v_mfma_f32_16x16x32_bf16 v[60:63], v[156:159], v[160:163], v[60:63]
    ds_read2_b32 v[90:91], v239 offset0:98 offset1:99
    v_add_u32 v11, -131072, v11
    v_mfma_f32_16x16x32_bf16 v[60:63], v[152:155], v[164:167], v[60:63]
    ds_read_b64_tr_b16 a[116:117], v11 offset:0
    v_alignbit_b32 v219, v220, v219, 16
    v_mfma_f32_16x16x32_bf16 v[60:63], v[148:151], v[168:171], v[60:63]
    ds_read_b128 v[124:127], v246 offset:28672
    ds_read2_b32 v[92:93], v239 offset0:224 offset1:225
    v_mfma_f32_16x16x32_bf16 v[60:63], v[144:147], v[172:175], v[60:63]
    ds_read_b64_tr_b16 a[118:119], v11 offset:2048
    v_alignbit_b32 v220, v221, v220, 16
    v_mfma_f32_16x16x32_bf16 v[60:63], v[140:143], v[176:179], v[60:63]
    ds_read_b64_tr_b16 a[124:125], v11 offset:4096
    ds_read2_b32 v[94:95], v239 offset0:226 offset1:227
    v_mfma_f32_16x16x32_bf16 v[60:63], v[136:139], v[180:183], v[60:63]
    ds_read_b64_tr_b16 a[126:127], v11 offset:6144
    v_alignbit_b32 v221, v222, v221, 16
    v_mfma_f32_16x16x32_bf16 v[60:63], v[132:135], v[184:187], v[60:63]
    ds_write_b128 v241, v[218:221] offset:13536
    v_mfma_f32_16x16x32_bf16 v[60:63], v[128:131], v[188:191], v[60:63]
    s_waitcnt lgkmcnt(15)
    v_mfma_f32_16x16x32_bf16 v[32:35], v[64:67], v[96:99], v[32:35]
    ds_read_b128 v[160:163], v247 offset:0
    v_mfma_f32_16x16x32_bf16 v[36:39], v[68:71], v[96:99], v[36:39]
    v_alignbit_b32 v224, v225, v224, 16
    v_mfma_f32_16x16x32_bf16 v[36:39], v[64:67], v[100:103], v[36:39]
    ds_read_b128 v[164:167], v247 offset:4096
    v_mfma_f32_16x16x32_bf16 v[40:43], v[64:67], v[104:107], v[40:43]
    ds_read_b128 v[168:171], v247 offset:8192
    s_waitcnt lgkmcnt(4)
    s_barrier
    v_mfma_f32_16x16x32_bf16 v[40:43], v[68:71], v[100:103], v[40:43]
    ds_read_b128 v[172:175], v247 offset:12288
    v_mfma_f32_16x16x32_bf16 v[40:43], v[72:75], v[96:99], v[40:43]
    v_alignbit_b32 v225, v226, v225, 16
    v_mfma_f32_16x16x32_bf16 v[44:47], v[76:79], v[96:99], v[44:47]
    ds_read_b128 v[176:179], v247 offset:16384
    v_mfma_f32_16x16x32_bf16 v[44:47], v[72:75], v[100:103], v[44:47]
    s_lshl_b32 s14, s94, 18
    ds_read_b128 v[180:183], v247 offset:20480
    v_mfma_f32_16x16x32_bf16 v[44:47], v[68:71], v[104:107], v[44:47]
    s_add_u32 m0, s73, 0
    v_alignbit_b32 v226, v227, v226, 16
    v_mfma_f32_16x16x32_bf16 v[44:47], v[64:67], v[108:111], v[44:47]
    buffer_load_dwordx4 v4, s[52:55], s14 offen offset:0 lds
    ds_read_b128 v[184:187], v247 offset:24576
    v_mfma_f32_16x16x32_bf16 v[48:51], v[64:67], v[112:115], v[48:51]
    ds_read_b128 v[188:191], v247 offset:28672
    v_mfma_f32_16x16x32_bf16 v[48:51], v[68:71], v[108:111], v[48:51]
    ds_read2_b32 v[128:129], v236 offset0:112 offset1:113
    v_mfma_f32_16x16x32_bf16 v[48:51], v[72:75], v[104:107], v[48:51]
    v_alignbit_b32 v227, v228, v227, 16
    v_mfma_f32_16x16x32_bf16 v[48:51], v[76:79], v[100:103], v[48:51]
    ds_read2_b32 v[130:131], v236 offset0:114 offset1:115
    v_mfma_f32_16x16x32_bf16 v[48:51], v[80:83], v[96:99], v[48:51]
    ds_read2_b32 v[132:133], v236 offset0:240 offset1:241
    v_mfma_f32_16x16x32_bf16 v[52:55], v[84:87], v[96:99], v[52:55]
    s_add_u32 m0, s73, 0
    ds_read2_b32 v[134:135], v236 offset0:242 offset1:243
    v_mfma_f32_16x16x32_bf16 v[52:55], v[80:83], v[100:103], v[52:55]
    buffer_load_dwordx4 v5, s[52:55], s14 offen offset:1024 lds
    ds_read2_b32 v[136:137], v237 offset0:112 offset1:113
    v_mfma_f32_16x16x32_bf16 v[52:55], v[76:79], v[104:107], v[52:55]
    ds_write_b128 v241, v[224:227] offset:14560
    v_mfma_f32_16x16x32_bf16 v[52:55], v[72:75], v[108:111], v[52:55]
    ds_read2_b32 v[138:139], v237 offset0:114 offset1:115
    s_add_u32 s6, s12, 4751360
    ds_read2_b32 v[140:141], v237 offset0:240 offset1:241
    v_mfma_f32_16x16x32_bf16 v[52:55], v[68:71], v[112:115], v[52:55]
    ds_read2_b32 v[142:143], v237 offset0:242 offset1:243
    v_alignbit_b32 v230, v231, v230, 16
    v_mfma_f32_16x16x32_bf16 v[52:55], v[64:67], v[116:119], v[52:55]
    ds_read2_b32 v[144:145], v238 offset0:112 offset1:113
    v_xor_b32 v244, 64, v244
    v_mfma_f32_16x16x32_bf16 v[56:59], v[64:67], v[120:123], v[56:59]
    ds_read2_b32 v[146:147], v238 offset0:114 offset1:115
    v_mfma_f32_16x16x32_bf16 v[56:59], v[68:71], v[116:119], v[56:59]
    s_add_u32 m0, s73, 0
    ds_read2_b32 v[148:149], v238 offset0:240 offset1:241
    v_mfma_f32_16x16x32_bf16 v[56:59], v[72:75], v[112:115], v[56:59]
    buffer_load_dwordx4 v6, s[52:55], s14 offen offset:2048 lds
    v_alignbit_b32 v231, v232, v231, 16
    v_mfma_f32_16x16x32_bf16 v[56:59], v[76:79], v[108:111], v[56:59]
    ds_read2_b32 v[150:151], v238 offset0:242 offset1:243
    v_xor_b32 v245, 64, v245
    v_mfma_f32_16x16x32_bf16 v[56:59], v[80:83], v[104:107], v[56:59]
    ds_read2_b32 v[152:153], v239 offset0:112 offset1:113
    v_mfma_f32_16x16x32_bf16 v[56:59], v[84:87], v[100:103], v[56:59]
    ds_read2_b32 v[154:155], v239 offset0:114 offset1:115
    v_mfma_f32_16x16x32_bf16 v[56:59], v[88:91], v[96:99], v[56:59]
    ds_read2_b32 v[156:157], v239 offset0:240 offset1:241
    v_alignbit_b32 v232, v233, v232, 16
    v_mfma_f32_16x16x32_bf16 v[60:63], v[92:95], v[96:99], v[60:63]
    ds_read2_b32 v[158:159], v239 offset0:242 offset1:243
    s_waitcnt vmcnt(7)
    s_barrier
    v_mfma_f32_16x16x32_bf16 v[60:63], v[88:91], v[100:103], v[60:63]
    s_add_u32 m0, s73, 0
    v_xor_b32 v246, 64, v246
    v_add_u32 v236, 8320, v236
    v_mfma_f32_16x16x32_bf16 v[60:63], v[84:87], v[104:107], v[60:63]
    ds_read_b64_tr_b16 a[128:129], v10 offset:16384
    buffer_load_dwordx4 v7, s[52:55], s14 offen offset:3072 lds
    v_mfma_f32_16x16x32_bf16 v[60:63], v[80:83], v[108:111], v[60:63]
    ds_read_b64_tr_b16 a[130:131], v10 offset:18432
    v_alignbit_b32 v233, v234, v233, 16
    v_add_u32 v237, 8320, v237
    v_mfma_f32_16x16x32_bf16 v[60:63], v[76:79], v[112:115], v[60:63]
    ds_write_b128 v241, v[230:233] offset:15584
    v_mfma_f32_16x16x32_bf16 v[60:63], v[72:75], v[116:119], v[60:63]
    ds_read_b64_tr_b16 a[136:137], v10 offset:20480
    v_xor_b32 v247, 64, v247
    v_mfma_f32_16x16x32_bf16 v[60:63], v[68:71], v[120:123], v[60:63]
    ds_read_b64_tr_b16 a[138:139], v10 offset:22528
    v_add_u32 v238, 8320, v238
    v_mfma_f32_16x16x32_bf16 v[60:63], v[64:67], v[124:127], v[60:63]
    v_add_u32 v239, 8320, v239
    s_waitcnt lgkmcnt(5)
    v_mfma_f32_16x16x32_bf16 v[60:63], v[128:131], v[188:191], v[60:63]
    ds_read_b64_tr_b16 a[132:133], v11 offset:16384
    v_mfma_f32_16x16x32_bf16 v[60:63], v[132:135], v[184:187], v[60:63]
    ds_read_b64_tr_b16 a[134:135], v11 offset:18432
    v_mfma_f32_16x16x32_bf16 v[60:63], v[136:139], v[180:183], v[60:63]
    ds_read_b64_tr_b16 a[140:141], v11 offset:20480
    v_mfma_f32_16x16x32_bf16 v[60:63], v[140:143], v[176:179], v[60:63]
    ds_read_b128 v[96:99], v244 offset:2048
    v_mfma_f32_16x16x32_bf16 v[60:63], v[144:147], v[172:175], v[60:63]
    ds_read_b64_tr_b16 a[142:143], v11 offset:22528
    v_mfma_f32_16x16x32_bf16 v[60:63], v[148:151], v[168:171], v[60:63]
    ds_read2_b32 v[64:65], v236 offset0:0 offset1:1
    v_mfma_f32_16x16x32_bf16 v[60:63], v[152:155], v[164:167], v[60:63]
    ds_read2_b32 v[66:67], v236 offset0:2 offset1:3
    v_mfma_f32_16x16x32_bf16 v[60:63], v[156:159], v[160:163], v[60:63]
    ds_read_b128 v[100:103], v244 offset:6144
    v_mfma_f32_16x16x32_bf16 v[56:59], v[128:131], v[184:187], v[56:59]
    ds_read2_b32 v[68:69], v236 offset0:128 offset1:129
    v_mfma_f32_16x16x32_bf16 v[56:59], v[132:135], v[180:183], v[56:59]
    ds_read2_b32 v[70:71], v236 offset0:130 offset1:131
    v_mfma_f32_16x16x32_bf16 v[56:59], v[136:139], v[176:179], v[56:59]
    ds_read_b128 v[104:107], v244 offset:10240
    s_waitcnt lgkmcnt(6)
    s_barrier
    v_mfma_f32_16x16x32_bf16 v[56:59], v[140:143], v[172:175], v[56:59]
    ds_read2_b32 v[72:73], v237 offset0:0 offset1:1
    v_mfma_f32_16x16x32_bf16 v[56:59], v[144:147], v[168:171], v[56:59]
    ds_read2_b32 v[74:75], v237 offset0:2 offset1:3
    v_mfma_f32_16x16x32_bf16 v[56:59], v[148:151], v[164:167], v[56:59]
    ds_read_b128 v[108:111], v244 offset:14336
    v_cvt_pk_bf16_f32 v206, v60, v61
    v_mfma_f32_16x16x32_bf16 v[56:59], v[152:155], v[160:163], v[56:59]
    s_lshl_b32 s14, s95, 18
    ds_read2_b32 v[76:77], v237 offset0:128 offset1:129
    v_mfma_f32_16x16x32_bf16 v[52:55], v[128:131], v[180:183], v[52:55]
    s_add_u32 m0, s73, 16384
    ds_read2_b32 v[78:79], v237 offset0:130 offset1:131
    v_mfma_f32_16x16x32_bf16 v[52:55], v[132:135], v[176:179], v[52:55]
    buffer_load_dwordx4 v4, s[52:55], s14 offen offset:0 lds
    v_cvt_pk_bf16_f32 v207, v62, v63
    v_mfma_f32_16x16x32_bf16 v[52:55], v[136:139], v[172:175], v[52:55]
    ds_read_b128 v[112:115], v244 offset:18432
    v_mfma_f32_16x16x32_bf16 v[52:55], v[140:143], v[168:171], v[52:55]
    buffer_store_dwordx2 v[206:207], v8, s[44:47], s6 offen offset:3584 sc1
    ds_read2_b32 v[80:81], v238 offset0:0 offset1:1
    v_mfma_f32_16x16x32_bf16 v[52:55], v[144:147], v[164:167], v[52:55]
    ds_read2_b32 v[82:83], v238 offset0:2 offset1:3
    v_mfma_f32_16x16x32_bf16 v[52:55], v[148:151], v[160:163], v[52:55]
    ds_read_b128 v[116:119], v244 offset:22528
    v_mfma_f32_16x16x32_bf16 v[48:51], v[128:131], v[176:179], v[48:51]
    ds_read2_b32 v[84:85], v238 offset0:128 offset1:129
    v_cvt_pk_bf16_f32 v204, v56, v57
    v_mfma_f32_16x16x32_bf16 v[48:51], v[132:135], v[172:175], v[48:51]
    s_add_u32 m0, s73, 16384
    ds_read2_b32 v[86:87], v238 offset0:130 offset1:131
    v_mfma_f32_16x16x32_bf16 v[48:51], v[136:139], v[168:171], v[48:51]
    buffer_load_dwordx4 v5, s[52:55], s14 offen offset:1024 lds
    ds_read_b128 v[120:123], v244 offset:26624
    v_mfma_f32_16x16x32_bf16 v[48:51], v[140:143], v[164:167], v[48:51]
    ds_read2_b32 v[88:89], v239 offset0:0 offset1:1
    v_cvt_pk_bf16_f32 v205, v58, v59
    v_mfma_f32_16x16x32_bf16 v[48:51], v[144:147], v[160:163], v[48:51]
    ds_read2_b32 v[90:91], v239 offset0:2 offset1:3
    v_mfma_f32_16x16x32_bf16 v[44:47], v[128:131], v[172:175], v[44:47]
    buffer_store_dwordx2 v[204:205], v8, s[44:47], s6 offen offset:3072 sc1
    ds_read_b128 v[124:127], v244 offset:30720
    v_mfma_f32_16x16x32_bf16 v[44:47], v[132:135], v[168:171], v[44:47]
    ds_read2_b32 v[92:93], v239 offset0:128 offset1:129
    v_mfma_f32_16x16x32_bf16 v[44:47], v[136:139], v[164:167], v[44:47]
    ds_read2_b32 v[94:95], v239 offset0:130 offset1:131
    v_mfma_f32_16x16x32_bf16 v[44:47], v[140:143], v[160:163], v[44:47]
    s_add_u32 m0, s73, 16384
    v_cvt_pk_bf16_f32 v202, v52, v53
    v_mfma_f32_16x16x32_bf16 v[40:43], v[128:131], v[168:171], v[40:43]
    buffer_load_dwordx4 v6, s[52:55], s14 offen offset:2048 lds
    v_mfma_f32_16x16x32_bf16 v[40:43], v[132:135], v[164:167], v[40:43]
    v_mfma_f32_16x16x32_bf16 v[40:43], v[136:139], v[160:163], v[40:43]
    v_cvt_pk_bf16_f32 v203, v54, v55
    v_mfma_f32_16x16x32_bf16 v[36:39], v[128:131], v[164:167], v[36:39]
    v_mfma_f32_16x16x32_bf16 v[36:39], v[132:135], v[160:163], v[36:39]
    buffer_store_dwordx2 v[202:203], v8, s[44:47], s6 offen offset:2560 sc1
    v_mfma_f32_16x16x32_bf16 v[32:35], v[128:131], v[160:163], v[32:35]
    s_waitcnt lgkmcnt(0)
    v_mfma_f32_16x16x32_bf16 v[60:63], v[64:67], v[124:127], 0
    ds_read_b128 v[160:163], v245 offset:2048
    s_waitcnt vmcnt(10)
    s_barrier
    v_cvt_pk_bf16_f32 v200, v48, v49
    v_mfma_f32_16x16x32_bf16 v[60:63], v[68:71], v[120:123], v[60:63]
    v_add_u32 v10, 131072, v10
    s_add_u32 m0, s73, 16384
    v_mfma_f32_16x16x32_bf16 v[60:63], v[72:75], v[116:119], v[60:63]
    ds_read_b64_tr_b16 a[144:145], v10 offset:16384
    buffer_load_dwordx4 v7, s[52:55], s14 offen offset:3072 lds
    v_mfma_f32_16x16x32_bf16 v[60:63], v[76:79], v[112:115], v[60:63]
    ds_read_b64_tr_b16 a[146:147], v10 offset:18432
    v_cvt_pk_bf16_f32 v201, v50, v51
    v_mfma_f32_16x16x32_bf16 v[60:63], v[80:83], v[108:111], v[60:63]
    ds_read_b64_tr_b16 a[152:153], v10 offset:20480
    v_mfma_f32_16x16x32_bf16 v[60:63], v[84:87], v[104:107], v[60:63]
    buffer_store_dwordx2 v[200:201], v8, s[44:47], s6 offen offset:2048 sc1
    ds_read_b64_tr_b16 a[154:155], v10 offset:22528
    v_mfma_f32_16x16x32_bf16 v[60:63], v[88:91], v[100:103], v[60:63]
    ds_read2_b32 v[128:129], v236 offset0:16 offset1:17
    v_mfma_f32_16x16x32_bf16 v[60:63], v[92:95], v[96:99], v[60:63]
    v_add_u32 v11, 131072, v11
    v_cvt_pk_bf16_f32 v198, v44, v45
    v_mfma_f32_16x16x32_bf16 v[56:59], v[64:67], v[120:123], 0
    ds_read_b64_tr_b16 a[148:149], v11 offset:16384
    v_mfma_f32_16x16x32_bf16 v[56:59], v[68:71], v[116:119], v[56:59]
    ds_read_b64_tr_b16 a[150:151], v11 offset:18432
    v_mfma_f32_16x16x32_bf16 v[56:59], v[72:75], v[112:115], v[56:59]
    ds_read_b64_tr_b16 a[156:157], v11 offset:20480
    v_cvt_pk_bf16_f32 v199, v46, v47
    v_mfma_f32_16x16x32_bf16 v[56:59], v[76:79], v[108:111], v[56:59]
    ds_read_b64_tr_b16 a[158:159], v11 offset:22528
    v_mfma_f32_16x16x32_bf16 v[56:59], v[80:83], v[104:107], v[56:59]
    buffer_store_dwordx2 v[198:199], v8, s[44:47], s6 offen offset:1536 sc1
    ds_read2_b32 v[130:131], v236 offset0:18 offset1:19
    v_mfma_f32_16x16x32_bf16 v[56:59], v[84:87], v[100:103], v[56:59]
    ds_read_b128 v[164:167], v245 offset:6144
    v_mfma_f32_16x16x32_bf16 v[56:59], v[88:91], v[96:99], v[56:59]
    ds_read2_b32 v[132:133], v236 offset0:144 offset1:145
    v_cvt_pk_bf16_f32 v196, v40, v41
    v_mfma_f32_16x16x32_bf16 v[52:55], v[64:67], v[116:119], 0
    ds_read2_b32 v[134:135], v236 offset0:146 offset1:147
    v_mfma_f32_16x16x32_bf16 v[52:55], v[68:71], v[112:115], v[52:55]
    ds_read_b128 v[168:171], v245 offset:10240
    v_cvt_pk_bf16_f32 v197, v42, v43
    v_mfma_f32_16x16x32_bf16 v[52:55], v[72:75], v[108:111], v[52:55]
    ds_read2_b32 v[136:137], v237 offset0:16 offset1:17
    v_mfma_f32_16x16x32_bf16 v[52:55], v[76:79], v[104:107], v[52:55]
    buffer_store_dwordx2 v[196:197], v8, s[44:47], s6 offen offset:1024 sc1
    ds_read2_b32 v[138:139], v237 offset0:18 offset1:19
    s_waitcnt lgkmcnt(7)
    s_barrier
    v_mfma_f32_16x16x32_bf16 v[52:55], v[80:83], v[100:103], v[52:55]
    ds_read_b128 v[172:175], v245 offset:14336
    v_mfma_f32_16x16x32_bf16 v[52:55], v[84:87], v[96:99], v[52:55]
    ds_read2_b32 v[140:141], v237 offset0:144 offset1:145
    v_cvt_pk_bf16_f32 v194, v36, v37
    v_mfma_f32_16x16x32_bf16 v[48:51], v[64:67], v[112:115], 0
    s_lshl_b32 s14, s96, 18
    ds_read2_b32 v[142:143], v237 offset0:146 offset1:147
    v_mfma_f32_16x16x32_bf16 v[48:51], v[68:71], v[108:111], v[48:51]
    s_add_u32 m0, s73, 147456
    ds_read_b128 v[176:179], v245 offset:18432
    v_mfma_f32_16x16x32_bf16 v[48:51], v[72:75], v[104:107], v[48:51]
L_pl_X_5:
    s_cbranch_execz L_wret
    buffer_load_dwordx4 v4, s[52:55], s14 offen offset:0 lds
    v_cvt_pk_bf16_f32 v195, v38, v39
    v_mfma_f32_16x16x32_bf16 v[48:51], v[76:79], v[100:103], v[48:51]
    ds_read2_b32 v[144:145], v238 offset0:16 offset1:17
    v_mfma_f32_16x16x32_bf16 v[48:51], v[80:83], v[96:99], v[48:51]
    buffer_store_dwordx2 v[194:195], v8, s[44:47], s6 offen offset:512 sc1
    ds_read2_b32 v[146:147], v238 offset0:18 offset1:19
    v_mfma_f32_16x16x32_bf16 v[44:47], v[64:67], v[108:111], 0
    ds_read_b128 v[180:183], v245 offset:22528
    v_mfma_f32_16x16x32_bf16 v[44:47], v[68:71], v[104:107], v[44:47]
    ds_read2_b32 v[148:149], v238 offset0:144 offset1:145
    v_cvt_pk_bf16_f32 v192, v32, v33
    v_mfma_f32_16x16x32_bf16 v[44:47], v[72:75], v[100:103], v[44:47]
    ds_read2_b32 v[150:151], v238 offset0:146 offset1:147
    v_mfma_f32_16x16x32_bf16 v[44:47], v[76:79], v[96:99], v[44:47]
    ds_read_b128 v[184:187], v245 offset:26624
    s_add_u32 m0, s73, 147456
    v_cvt_pk_bf16_f32 v193, v34, v35
    v_mfma_f32_16x16x32_bf16 v[40:43], v[64:67], v[104:107], 0
    buffer_load_dwordx4 v5, s[52:55], s14 offen offset:1024 lds
    ds_read2_b32 v[152:153], v239 offset0:16 offset1:17
    v_mfma_f32_16x16x32_bf16 v[40:43], v[68:71], v[100:103], v[40:43]
    buffer_store_dwordx2 v[192:193], v8, s[44:47], s6 offen offset:0 sc1
    ds_read2_b32 v[154:155], v239 offset0:18 offset1:19
    v_mfma_f32_16x16x32_bf16 v[40:43], v[72:75], v[96:99], v[40:43]
    ds_read_b128 v[188:191], v245 offset:30720
    v_mfma_f32_16x16x32_bf16 v[36:39], v[64:67], v[100:103], 0
    ds_read2_b32 v[156:157], v239 offset0:144 offset1:145
    v_mfma_f32_16x16x32_bf16 v[36:39], v[68:71], v[96:99], v[36:39]
    ds_read2_b32 v[158:159], v239 offset0:146 offset1:147
    v_mfma_f32_16x16x32_bf16 v[32:35], v[64:67], v[96:99], 0
    s_waitcnt lgkmcnt(12)
    v_mfma_f32_16x16x32_bf16 v[32:35], v[128:131], v[160:163], v[32:35]
    ds_read_b128 v[96:99], v246 offset:2048
    v_mfma_f32_16x16x32_bf16 v[36:39], v[132:135], v[160:163], v[36:39]
    s_add_u32 m0, s73, 147456
    ds_read2_b32 v[64:65], v236 offset0:32 offset1:33
    v_mfma_f32_16x16x32_bf16 v[36:39], v[128:131], v[164:167], v[36:39]
    buffer_load_dwordx4 v6, s[52:55], s14 offen offset:2048 lds
    ds_read2_b32 v[66:67], v236 offset0:34 offset1:35
    v_mfma_f32_16x16x32_bf16 v[40:43], v[128:131], v[168:171], v[40:43]
    ds_read_b128 v[100:103], v246 offset:6144
    v_mfma_f32_16x16x32_bf16 v[40:43], v[132:135], v[164:167], v[40:43]
    ds_read2_b32 v[68:69], v236 offset0:160 offset1:161
    v_mfma_f32_16x16x32_bf16 v[40:43], v[136:139], v[160:163], v[40:43]
    ds_read2_b32 v[70:71], v236 offset0:162 offset1:163
    v_mfma_f32_16x16x32_bf16 v[44:47], v[140:143], v[160:163], v[44:47]
    ds_read_b128 v[104:107], v246 offset:10240
    v_mfma_f32_16x16x32_bf16 v[44:47], v[136:139], v[164:167], v[44:47]
    ds_read2_b32 v[72:73], v237 offset0:32 offset1:33
    s_waitcnt vmcnt(15)
    s_barrier
    v_mfma_f32_16x16x32_bf16 v[44:47], v[132:135], v[168:171], v[44:47]
    v_add_u32 v10, -131072, v10
    s_add_u32 m0, s73, 147456
    v_mfma_f32_16x16x32_bf16 v[44:47], v[128:131], v[172:175], v[44:47]
    ds_read_b64_tr_b16 a[160:161], v10 offset:0
    buffer_load_dwordx4 v7, s[52:55], s14 offen offset:3072 lds
    s_waitcnt lgkmcnt(9)
    v_mfma_f32_16x16x32_bf16 v[48:51], v[128:131], v[176:179], v[48:51]
    ds_read_b64_tr_b16 a[162:163], v10 offset:2048
    v_mfma_f32_16x16x32_bf16 v[48:51], v[132:135], v[172:175], v[48:51]
    ds_read_b64_tr_b16 a[168:169], v10 offset:4096
    v_mfma_f32_16x16x32_bf16 v[48:51], v[136:139], v[168:171], v[48:51]
    ds_read2_b32 v[74:75], v237 offset0:34 offset1:35
    v_mfma_f32_16x16x32_bf16 v[48:51], v[140:143], v[164:167], v[48:51]
    ds_read_b64_tr_b16 a[170:171], v10 offset:6144
    v_mfma_f32_16x16x32_bf16 v[48:51], v[144:147], v[160:163], v[48:51]
    ds_read_b128 v[108:111], v246 offset:14336
    v_add_u32 v11, -131072, v11
    v_mfma_f32_16x16x32_bf16 v[52:55], v[148:151], v[160:163], v[52:55]
    ds_read_b64_tr_b16 a[164:165], v11 offset:0
    v_mfma_f32_16x16x32_bf16 v[52:55], v[144:147], v[164:167], v[52:55]
    ds_read_b64_tr_b16 a[166:167], v11 offset:2048
    v_mfma_f32_16x16x32_bf16 v[52:55], v[140:143], v[168:171], v[52:55]
    ds_read_b64_tr_b16 a[172:173], v11 offset:4096
    v_mfma_f32_16x16x32_bf16 v[52:55], v[136:139], v[172:175], v[52:55]
    ds_read_b64_tr_b16 a[174:175], v11 offset:6144
    v_mfma_f32_16x16x32_bf16 v[52:55], v[132:135], v[176:179], v[52:55]
    ds_read2_b32 v[76:77], v237 offset0:160 offset1:161
    v_mfma_f32_16x16x32_bf16 v[52:55], v[128:131], v[180:183], v[52:55]
    ds_read2_b32 v[78:79], v237 offset0:162 offset1:163
    v_mfma_f32_16x16x32_bf16 v[56:59], v[128:131], v[184:187], v[56:59]
    ds_read_b128 v[112:115], v246 offset:18432
    v_mfma_f32_16x16x32_bf16 v[56:59], v[132:135], v[180:183], v[56:59]
    ds_read2_b32 v[80:81], v238 offset0:32 offset1:33
    v_mfma_f32_16x16x32_bf16 v[56:59], v[136:139], v[176:179], v[56:59]
    ds_read2_b32 v[82:83], v238 offset0:34 offset1:35
    v_mfma_f32_16x16x32_bf16 v[56:59], v[140:143], v[172:175], v[56:59]
    ds_read_b128 v[116:119], v246 offset:22528
    v_mfma_f32_16x16x32_bf16 v[56:59], v[144:147], v[168:171], v[56:59]
    ds_read2_b32 v[84:85], v238 offset0:160 offset1:161
    s_waitcnt lgkmcnt(7)
    s_barrier
    v_mfma_f32_16x16x32_bf16 v[56:59], v[148:151], v[164:167], v[56:59]
    ds_read2_b32 v[86:87], v238 offset0:162 offset1:163
    v_mfma_f32_16x16x32_bf16 v[56:59], v[152:155], v[160:163], v[56:59]
    ds_read_b128 v[120:123], v246 offset:26624
    v_mfma_f32_16x16x32_bf16 v[60:63], v[156:159], v[160:163], v[60:63]
    s_lshl_b32 s14, s97, 18
    ds_read2_b32 v[88:89], v239 offset0:32 offset1:33
    v_mfma_f32_16x16x32_bf16 v[60:63], v[152:155], v[164:167], v[60:63]
    s_add_u32 m0, s73, 0
    ds_read2_b32 v[90:91], v239 offset0:34 offset1:35
    v_mfma_f32_16x16x32_bf16 v[60:63], v[148:151], v[168:171], v[60:63]
    buffer_load_dwordx4 v4, s[52:55], s14 offen offset:0 lds
    v_mfma_f32_16x16x32_bf16 v[60:63], v[144:147], v[172:175], v[60:63]
    ds_read_b128 v[124:127], v246 offset:30720
    v_mfma_f32_16x16x32_bf16 v[60:63], v[140:143], v[176:179], v[60:63]
    ds_read2_b32 v[92:93], v239 offset0:160 offset1:161
    v_mfma_f32_16x16x32_bf16 v[60:63], v[136:139], v[180:183], v[60:63]
    v_mfma_f32_16x16x32_bf16 v[60:63], v[132:135], v[184:187], v[60:63]
    ds_read2_b32 v[94:95], v239 offset0:162 offset1:163
    v_mfma_f32_16x16x32_bf16 v[60:63], v[128:131], v[188:191], v[60:63]
    s_waitcnt lgkmcnt(12)
    v_mfma_f32_16x16x32_bf16 v[32:35], v[64:67], v[96:99], v[32:35]
    ds_read_b128 v[160:163], v247 offset:2048
    v_mfma_f32_16x16x32_bf16 v[36:39], v[68:71], v[96:99], v[36:39]
    s_add_u32 m0, s73, 0
    v_mfma_f32_16x16x32_bf16 v[36:39], v[64:67], v[100:103], v[36:39]
    buffer_load_dwordx4 v5, s[52:55], s14 offen offset:1024 lds
    ds_read2_b32 v[128:129], v236 offset0:48 offset1:49
    v_mfma_f32_16x16x32_bf16 v[40:43], v[64:67], v[104:107], v[40:43]
    ds_read2_b32 v[130:131], v236 offset0:50 offset1:51
    v_mfma_f32_16x16x32_bf16 v[40:43], v[68:71], v[100:103], v[40:43]
    v_mfma_f32_16x16x32_bf16 v[40:43], v[72:75], v[96:99], v[40:43]
    ds_read_b128 v[164:167], v247 offset:6144
    v_mfma_f32_16x16x32_bf16 v[44:47], v[76:79], v[96:99], v[44:47]
    ds_read2_b32 v[132:133], v236 offset0:176 offset1:177
    v_mfma_f32_16x16x32_bf16 v[44:47], v[72:75], v[100:103], v[44:47]
    v_mfma_f32_16x16x32_bf16 v[44:47], v[68:71], v[104:107], v[44:47]
    s_add_u32 m0, s73, 0
    ds_read2_b32 v[134:135], v236 offset0:178 offset1:179
    v_mfma_f32_16x16x32_bf16 v[44:47], v[64:67], v[108:111], v[44:47]
    buffer_load_dwordx4 v6, s[52:55], s14 offen offset:2048 lds
    ds_read_b128 v[168:171], v247 offset:10240
    s_waitcnt lgkmcnt(7)
    v_mfma_f32_16x16x32_bf16 v[48:51], v[64:67], v[112:115], v[48:51]
    ds_read2_b32 v[136:137], v237 offset0:48 offset1:49
    v_mfma_f32_16x16x32_bf16 v[48:51], v[68:71], v[108:111], v[48:51]
    ds_read2_b32 v[138:139], v237 offset0:50 offset1:51
    v_mfma_f32_16x16x32_bf16 v[48:51], v[72:75], v[104:107], v[48:51]
    ds_read_b128 v[172:175], v247 offset:14336
    v_mfma_f32_16x16x32_bf16 v[48:51], v[76:79], v[100:103], v[48:51]
    ds_read2_b32 v[140:141], v237 offset0:176 offset1:177
    v_mfma_f32_16x16x32_bf16 v[48:51], v[80:83], v[96:99], v[48:51]
    ds_read2_b32 v[142:143], v237 offset0:178 offset1:179
    s_waitcnt vmcnt(12)
    s_barrier
    v_mfma_f32_16x16x32_bf16 v[52:55], v[84:87], v[96:99], v[52:55]
    ds_read_b64_tr_b16 a[176:177], v10 offset:16384
    s_add_u32 m0, s73, 0
    v_mfma_f32_16x16x32_bf16 v[52:55], v[80:83], v[100:103], v[52:55]
    buffer_load_dwordx4 v7, s[52:55], s14 offen offset:3072 lds
    ds_read_b128 v[176:179], v247 offset:18432
    v_mfma_f32_16x16x32_bf16 v[52:55], v[76:79], v[104:107], v[52:55]
    ds_read_b64_tr_b16 a[178:179], v10 offset:18432
    v_mfma_f32_16x16x32_bf16 v[52:55], v[72:75], v[108:111], v[52:55]
    ds_read_b64_tr_b16 a[184:185], v10 offset:20480
    v_mfma_f32_16x16x32_bf16 v[52:55], v[68:71], v[112:115], v[52:55]
    ds_read2_b32 v[144:145], v238 offset0:48 offset1:49
    v_mfma_f32_16x16x32_bf16 v[52:55], v[64:67], v[116:119], v[52:55]
    ds_read_b64_tr_b16 a[186:187], v10 offset:22528
    v_mfma_f32_16x16x32_bf16 v[56:59], v[64:67], v[120:123], v[56:59]
    ds_read_b64_tr_b16 a[180:181], v11 offset:16384
    v_mfma_f32_16x16x32_bf16 v[56:59], v[68:71], v[116:119], v[56:59]
    ds_read2_b32 v[146:147], v238 offset0:50 offset1:51
    v_mfma_f32_16x16x32_bf16 v[56:59], v[72:75], v[112:115], v[56:59]
    ds_read_b64_tr_b16 a[182:183], v11 offset:18432
    v_mfma_f32_16x16x32_bf16 v[56:59], v[76:79], v[108:111], v[56:59]
    ds_read_b64_tr_b16 a[188:189], v11 offset:20480
    v_mfma_f32_16x16x32_bf16 v[56:59], v[80:83], v[104:107], v[56:59]
    ds_read_b64_tr_b16 a[190:191], v11 offset:22528
    v_mfma_f32_16x16x32_bf16 v[56:59], v[84:87], v[100:103], v[56:59]
    ds_read_b128 v[180:183], v247 offset:22528
    v_mfma_f32_16x16x32_bf16 v[56:59], v[88:91], v[96:99], v[56:59]
    ds_read2_b32 v[148:149], v238 offset0:176 offset1:177
    v_mfma_f32_16x16x32_bf16 v[60:63], v[92:95], v[96:99], v[60:63]
    ds_read2_b32 v[150:151], v238 offset0:178 offset1:179
    v_mfma_f32_16x16x32_bf16 v[60:63], v[88:91], v[100:103], v[60:63]
    ds_read_b128 v[184:187], v247 offset:26624
    v_mfma_f32_16x16x32_bf16 v[60:63], v[84:87], v[104:107], v[60:63]
    ds_read2_b32 v[152:153], v239 offset0:48 offset1:49
    v_mfma_f32_16x16x32_bf16 v[60:63], v[80:83], v[108:111], v[60:63]
    ds_read2_b32 v[154:155], v239 offset0:50 offset1:51
    v_mfma_f32_16x16x32_bf16 v[60:63], v[76:79], v[112:115], v[60:63]
    ds_read_b128 v[188:191], v247 offset:30720
    s_waitcnt lgkmcnt(7)
    s_barrier
    v_mfma_f32_16x16x32_bf16 v[60:63], v[72:75], v[116:119], v[60:63]
    ds_read2_b32 v[156:157], v239 offset0:176 offset1:177
    v_mfma_f32_16x16x32_bf16 v[60:63], v[68:71], v[120:123], v[60:63]
    ds_read2_b32 v[158:159], v239 offset0:178 offset1:179
    v_mfma_f32_16x16x32_bf16 v[60:63], v[64:67], v[124:127], v[60:63]
    v_mfma_f32_16x16x32_bf16 v[32:35], v[128:131], v[160:163], v[32:35]
    s_lshl_b32 s14, s98, 18
    ds_read_b128 v[96:99], v244 offset:0
    v_mfma_f32_16x16x32_bf16 v[36:39], v[132:135], v[160:163], v[36:39]
    s_add_u32 m0, s73, 16384
    v_mfma_f32_16x16x32_bf16 v[36:39], v[128:131], v[164:167], v[36:39]
    buffer_load_dwordx4 v4, s[52:55], s14 offen offset:0 lds
    ds_read2_b32 v[64:65], v236 offset0:64 offset1:65
    v_mfma_f32_16x16x32_bf16 v[40:43], v[128:131], v[168:171], v[40:43]
    ds_read2_b32 v[66:67], v236 offset0:66 offset1:67
    v_mfma_f32_16x16x32_bf16 v[40:43], v[132:135], v[164:167], v[40:43]
    v_mfma_f32_16x16x32_bf16 v[40:43], v[136:139], v[160:163], v[40:43]
    ds_read_b128 v[100:103], v244 offset:4096
    v_mfma_f32_16x16x32_bf16 v[44:47], v[140:143], v[160:163], v[44:47]
    ds_read2_b32 v[68:69], v236 offset0:192 offset1:193
    v_mfma_f32_16x16x32_bf16 v[44:47], v[136:139], v[164:167], v[44:47]
    ds_read2_b32 v[70:71], v236 offset0:194 offset1:195
    v_mfma_f32_16x16x32_bf16 v[44:47], v[132:135], v[168:171], v[44:47]
    s_add_u32 m0, s73, 16384
    ds_read_b128 v[104:107], v244 offset:8192
    v_mfma_f32_16x16x32_bf16 v[44:47], v[128:131], v[172:175], v[44:47]
    buffer_load_dwordx4 v5, s[52:55], s14 offen offset:1024 lds
    ds_read2_b32 v[72:73], v237 offset0:64 offset1:65
    s_waitcnt lgkmcnt(8)
    v_mfma_f32_16x16x32_bf16 v[48:51], v[128:131], v[176:179], v[48:51]
    ds_read2_b32 v[74:75], v237 offset0:66 offset1:67
    v_mfma_f32_16x16x32_bf16 v[48:51], v[132:135], v[172:175], v[48:51]
    ds_read_b128 v[108:111], v244 offset:12288
    v_mfma_f32_16x16x32_bf16 v[48:51], v[136:139], v[168:171], v[48:51]
    ds_read2_b32 v[76:77], v237 offset0:192 offset1:193
    v_mfma_f32_16x16x32_bf16 v[48:51], v[140:143], v[164:167], v[48:51]
    ds_read2_b32 v[78:79], v237 offset0:194 offset1:195
    v_mfma_f32_16x16x32_bf16 v[48:51], v[144:147], v[160:163], v[48:51]
    ds_read_b128 v[112:115], v244 offset:16384
    v_mfma_f32_16x16x32_bf16 v[52:55], v[148:151], v[160:163], v[52:55]
    s_add_u32 m0, s73, 16384
    ds_read2_b32 v[80:81], v238 offset0:64 offset1:65
    v_mfma_f32_16x16x32_bf16 v[52:55], v[144:147], v[164:167], v[52:55]
    buffer_load_dwordx4 v6, s[52:55], s14 offen offset:2048 lds
    ds_read2_b32 v[82:83], v238 offset0:66 offset1:67
    v_mfma_f32_16x16x32_bf16 v[52:55], v[140:143], v[168:171], v[52:55]
    ds_read_b128 v[116:119], v244 offset:20480
    v_mfma_f32_16x16x32_bf16 v[52:55], v[136:139], v[172:175], v[52:55]
    ds_read2_b32 v[84:85], v238 offset0:192 offset1:193
    v_mfma_f32_16x16x32_bf16 v[52:55], v[132:135], v[176:179], v[52:55]
    ds_read2_b32 v[86:87], v238 offset0:194 offset1:195
    v_mfma_f32_16x16x32_bf16 v[52:55], v[128:131], v[180:183], v[52:55]
    ds_read_b128 v[120:123], v244 offset:24576
    v_mfma_f32_16x16x32_bf16 v[56:59], v[128:131], v[184:187], v[56:59]
    ds_read2_b32 v[88:89], v239 offset0:64 offset1:65
    s_waitcnt vmcnt(7)
    s_barrier
    v_mfma_f32_16x16x32_bf16 v[56:59], v[132:135], v[180:183], v[56:59]
    v_add_u32 v10, 131072, v10
    s_add_u32 m0, s73, 16384
    v_mfma_f32_16x16x32_bf16 v[56:59], v[136:139], v[176:179], v[56:59]
    ds_read_b64_tr_b16 a[192:193], v10 offset:16384
    buffer_load_dwordx4 v7, s[52:55], s14 offen offset:3072 lds
    v_mfma_f32_16x16x32_bf16 v[56:59], v[140:143], v[172:175], v[56:59]
    ds_read2_b32 v[90:91], v239 offset0:66 offset1:67
    v_mfma_f32_16x16x32_bf16 v[56:59], v[144:147], v[168:171], v[56:59]
    ds_read_b64_tr_b16 a[194:195], v10 offset:18432
    v_mfma_f32_16x16x32_bf16 v[56:59], v[148:151], v[164:167], v[56:59]
    ds_read_b64_tr_b16 a[200:201], v10 offset:20480
    v_mfma_f32_16x16x32_bf16 v[56:59], v[152:155], v[160:163], v[56:59]
    ds_read_b64_tr_b16 a[202:203], v10 offset:22528
    v_mfma_f32_16x16x32_bf16 v[60:63], v[156:159], v[160:163], v[60:63]
    ds_read_b128 v[124:127], v244 offset:28672
    v_add_u32 v11, 131072, v11
    v_mfma_f32_16x16x32_bf16 v[60:63], v[152:155], v[164:167], v[60:63]
    ds_read_b64_tr_b16 a[196:197], v11 offset:16384
    v_mfma_f32_16x16x32_bf16 v[60:63], v[148:151], v[168:171], v[60:63]
    ds_read2_b32 v[92:93], v239 offset0:192 offset1:193
    v_mfma_f32_16x16x32_bf16 v[60:63], v[144:147], v[172:175], v[60:63]
    ds_read_b64_tr_b16 a[198:199], v11 offset:18432
    v_mfma_f32_16x16x32_bf16 v[60:63], v[140:143], v[176:179], v[60:63]
    ds_read_b64_tr_b16 a[204:205], v11 offset:20480
    v_mfma_f32_16x16x32_bf16 v[60:63], v[136:139], v[180:183], v[60:63]
    ds_read_b64_tr_b16 a[206:207], v11 offset:22528
    v_mfma_f32_16x16x32_bf16 v[60:63], v[132:135], v[184:187], v[60:63]
    ds_read2_b32 v[94:95], v239 offset0:194 offset1:195
    v_mfma_f32_16x16x32_bf16 v[60:63], v[128:131], v[188:191], v[60:63]
    s_waitcnt lgkmcnt(15)
    v_mfma_f32_16x16x32_bf16 v[32:35], v[64:67], v[96:99], v[32:35]
    ds_read_b128 v[160:163], v245 offset:0
    v_mfma_f32_16x16x32_bf16 v[36:39], v[68:71], v[96:99], v[36:39]
    v_mfma_f32_16x16x32_bf16 v[36:39], v[64:67], v[100:103], v[36:39]
    ds_read2_b32 v[128:129], v236 offset0:80 offset1:81
    v_mfma_f32_16x16x32_bf16 v[40:43], v[64:67], v[104:107], v[40:43]
    ds_read2_b32 v[130:131], v236 offset0:82 offset1:83
    s_waitcnt lgkmcnt(4)
    s_barrier
    v_mfma_f32_16x16x32_bf16 v[40:43], v[68:71], v[100:103], v[40:43]
    v_mfma_f32_16x16x32_bf16 v[40:43], v[72:75], v[96:99], v[40:43]
    ds_read_b128 v[164:167], v245 offset:4096
    v_mfma_f32_16x16x32_bf16 v[44:47], v[76:79], v[96:99], v[44:47]
    ds_read2_b32 v[132:133], v236 offset0:208 offset1:209
    v_mfma_f32_16x16x32_bf16 v[44:47], v[72:75], v[100:103], v[44:47]
    s_lshl_b32 s14, s99, 18
    v_mfma_f32_16x16x32_bf16 v[44:47], v[68:71], v[104:107], v[44:47]
    s_add_u32 m0, s73, 147456
    ds_read2_b32 v[134:135], v236 offset0:210 offset1:211
    v_mfma_f32_16x16x32_bf16 v[44:47], v[64:67], v[108:111], v[44:47]
    buffer_load_dwordx4 v4, s[52:55], s14 offen offset:0 lds
    ds_read_b128 v[168:171], v245 offset:8192
    s_waitcnt lgkmcnt(7)
    v_mfma_f32_16x16x32_bf16 v[48:51], v[64:67], v[112:115], v[48:51]
    ds_read2_b32 v[136:137], v237 offset0:80 offset1:81
    v_mfma_f32_16x16x32_bf16 v[48:51], v[68:71], v[108:111], v[48:51]
    v_mfma_f32_16x16x32_bf16 v[48:51], v[72:75], v[104:107], v[48:51]
    ds_read2_b32 v[138:139], v237 offset0:82 offset1:83
    v_mfma_f32_16x16x32_bf16 v[48:51], v[76:79], v[100:103], v[48:51]
    ds_read_b128 v[172:175], v245 offset:12288
    v_mfma_f32_16x16x32_bf16 v[48:51], v[80:83], v[96:99], v[48:51]
    v_mfma_f32_16x16x32_bf16 v[52:55], v[84:87], v[96:99], v[52:55]
    s_add_u32 m0, s73, 147456
    ds_read2_b32 v[140:141], v237 offset0:208 offset1:209
    v_mfma_f32_16x16x32_bf16 v[52:55], v[80:83], v[100:103], v[52:55]
    buffer_load_dwordx4 v5, s[52:55], s14 offen offset:1024 lds
    ds_read2_b32 v[142:143], v237 offset0:210 offset1:211
    v_mfma_f32_16x16x32_bf16 v[52:55], v[76:79], v[104:107], v[52:55]
    v_mfma_f32_16x16x32_bf16 v[52:55], v[72:75], v[108:111], v[52:55]
    ds_read_b128 v[176:179], v245 offset:16384
    v_mfma_f32_16x16x32_bf16 v[52:55], v[68:71], v[112:115], v[52:55]
    ds_read2_b32 v[144:145], v238 offset0:80 offset1:81
    v_mfma_f32_16x16x32_bf16 v[52:55], v[64:67], v[116:119], v[52:55]
    ds_read2_b32 v[146:147], v238 offset0:82 offset1:83
    v_mfma_f32_16x16x32_bf16 v[56:59], v[64:67], v[120:123], v[56:59]
    ds_read_b128 v[180:183], v245 offset:20480
    v_mfma_f32_16x16x32_bf16 v[56:59], v[68:71], v[116:119], v[56:59]
    s_add_u32 m0, s73, 147456
    ds_read2_b32 v[148:149], v238 offset0:208 offset1:209
    v_mfma_f32_16x16x32_bf16 v[56:59], v[72:75], v[112:115], v[56:59]
    buffer_load_dwordx4 v6, s[52:55], s14 offen offset:2048 lds
    ds_read2_b32 v[150:151], v238 offset0:210 offset1:211
    v_mfma_f32_16x16x32_bf16 v[56:59], v[76:79], v[108:111], v[56:59]
    ds_read_b128 v[184:187], v245 offset:24576
    v_mfma_f32_16x16x32_bf16 v[56:59], v[80:83], v[104:107], v[56:59]
    ds_read2_b32 v[152:153], v239 offset0:80 offset1:81
    v_mfma_f32_16x16x32_bf16 v[56:59], v[84:87], v[100:103], v[56:59]
    ds_read2_b32 v[154:155], v239 offset0:82 offset1:83
    v_mfma_f32_16x16x32_bf16 v[56:59], v[88:91], v[96:99], v[56:59]
    ds_read_b128 v[188:191], v245 offset:28672
    v_mfma_f32_16x16x32_bf16 v[60:63], v[92:95], v[96:99], v[60:63]
    ds_read2_b32 v[156:157], v239 offset0:208 offset1:209
    s_waitcnt vmcnt(7)
    s_barrier
    v_mfma_f32_16x16x32_bf16 v[60:63], v[88:91], v[100:103], v[60:63]
    v_add_u32 v10, -131072, v10
    s_add_u32 m0, s73, 147456
    v_mfma_f32_16x16x32_bf16 v[60:63], v[84:87], v[104:107], v[60:63]
    buffer_load_dwordx4 v7, s[52:55], s14 offen offset:3072 lds
    ds_read2_b32 v[158:159], v239 offset0:210 offset1:211
    v_mfma_f32_16x16x32_bf16 v[60:63], v[80:83], v[108:111], v[60:63]
    ds_read_b64_tr_b16 a[208:209], v10 offset:0
    v_mfma_f32_16x16x32_bf16 v[60:63], v[76:79], v[112:115], v[60:63]
    ds_read_b64_tr_b16 a[210:211], v10 offset:2048
    v_mfma_f32_16x16x32_bf16 v[60:63], v[72:75], v[116:119], v[60:63]
    ds_read_b64_tr_b16 a[216:217], v10 offset:4096
    v_mfma_f32_16x16x32_bf16 v[60:63], v[68:71], v[120:123], v[60:63]
    ds_read_b64_tr_b16 a[218:219], v10 offset:6144
    v_mfma_f32_16x16x32_bf16 v[60:63], v[64:67], v[124:127], v[60:63]
    v_add_u32 v11, -131072, v11
    s_waitcnt lgkmcnt(15)
    v_mfma_f32_16x16x32_bf16 v[32:35], v[128:131], v[160:163], v[32:35]
    ds_read_b128 v[96:99], v246 offset:0
    v_mfma_f32_16x16x32_bf16 v[36:39], v[132:135], v[160:163], v[36:39]
    ds_read_b64_tr_b16 a[212:213], v11 offset:0
    v_mfma_f32_16x16x32_bf16 v[36:39], v[128:131], v[164:167], v[36:39]
    ds_read_b64_tr_b16 a[214:215], v11 offset:2048
    v_mfma_f32_16x16x32_bf16 v[40:43], v[128:131], v[168:171], v[40:43]
    ds_read_b64_tr_b16 a[220:221], v11 offset:4096
    v_mfma_f32_16x16x32_bf16 v[40:43], v[132:135], v[164:167], v[40:43]
    ds_read_b64_tr_b16 a[222:223], v11 offset:6144
    v_mfma_f32_16x16x32_bf16 v[40:43], v[136:139], v[160:163], v[40:43]
    ds_read2_b32 v[64:65], v236 offset0:96 offset1:97
    v_mfma_f32_16x16x32_bf16 v[44:47], v[140:143], v[160:163], v[44:47]
    ds_read2_b32 v[66:67], v236 offset0:98 offset1:99
    v_mfma_f32_16x16x32_bf16 v[44:47], v[136:139], v[164:167], v[44:47]
    ds_read_b128 v[100:103], v246 offset:4096
    v_mfma_f32_16x16x32_bf16 v[44:47], v[132:135], v[168:171], v[44:47]
    ds_read2_b32 v[68:69], v236 offset0:224 offset1:225
    v_mfma_f32_16x16x32_bf16 v[44:47], v[128:131], v[172:175], v[44:47]
    ds_read2_b32 v[70:71], v236 offset0:226 offset1:227
    s_waitcnt lgkmcnt(14)
    v_mfma_f32_16x16x32_bf16 v[48:51], v[128:131], v[176:179], v[48:51]
    ds_read_b128 v[104:107], v246 offset:8192
    s_waitcnt lgkmcnt(6)
    s_barrier
    v_mfma_f32_16x16x32_bf16 v[48:51], v[132:135], v[172:175], v[48:51]
    ds_read2_b32 v[72:73], v237 offset0:96 offset1:97
    v_mfma_f32_16x16x32_bf16 v[48:51], v[136:139], v[168:171], v[48:51]
    ds_read2_b32 v[74:75], v237 offset0:98 offset1:99
    v_mfma_f32_16x16x32_bf16 v[48:51], v[140:143], v[164:167], v[48:51]
    ds_read_b128 v[108:111], v246 offset:12288
    v_mfma_f32_16x16x32_bf16 v[48:51], v[144:147], v[160:163], v[48:51]
    s_lshl_b32 s14, s100, 18
    v_mfma_f32_16x16x32_bf16 v[52:55], v[148:151], v[160:163], v[52:55]
    s_add_u32 m0, s73, 0
    ds_read2_b32 v[76:77], v237 offset0:224 offset1:225
    v_mfma_f32_16x16x32_bf16 v[52:55], v[144:147], v[164:167], v[52:55]
    buffer_load_dwordx4 v4, s[52:55], s14 offen offset:0 lds
    ds_read2_b32 v[78:79], v237 offset0:226 offset1:227
    v_mfma_f32_16x16x32_bf16 v[52:55], v[140:143], v[168:171], v[52:55]
    v_mfma_f32_16x16x32_bf16 v[52:55], v[136:139], v[172:175], v[52:55]
    ds_read_b128 v[112:115], v246 offset:16384
    v_mfma_f32_16x16x32_bf16 v[52:55], v[132:135], v[176:179], v[52:55]
    ds_read2_b32 v[80:81], v238 offset0:96 offset1:97
    v_mfma_f32_16x16x32_bf16 v[52:55], v[128:131], v[180:183], v[52:55]
    v_mfma_f32_16x16x32_bf16 v[56:59], v[128:131], v[184:187], v[56:59]
    ds_read2_b32 v[82:83], v238 offset0:98 offset1:99
    v_mfma_f32_16x16x32_bf16 v[56:59], v[132:135], v[180:183], v[56:59]
    s_add_u32 m0, s73, 0
    ds_read_b128 v[116:119], v246 offset:20480
    v_mfma_f32_16x16x32_bf16 v[56:59], v[136:139], v[176:179], v[56:59]
    buffer_load_dwordx4 v5, s[52:55], s14 offen offset:1024 lds
    v_mfma_f32_16x16x32_bf16 v[56:59], v[140:143], v[172:175], v[56:59]
    ds_read2_b32 v[84:85], v238 offset0:224 offset1:225
    v_mfma_f32_16x16x32_bf16 v[56:59], v[144:147], v[168:171], v[56:59]
    ds_read2_b32 v[86:87], v238 offset0:226 offset1:227
    v_mfma_f32_16x16x32_bf16 v[56:59], v[148:151], v[164:167], v[56:59]
    ds_read_b128 v[120:123], v246 offset:24576
    v_mfma_f32_16x16x32_bf16 v[56:59], v[152:155], v[160:163], v[56:59]
    v_mfma_f32_16x16x32_bf16 v[60:63], v[156:159], v[160:163], v[60:63]
    ds_read2_b32 v[88:89], v239 offset0:96 offset1:97
    v_mfma_f32_16x16x32_bf16 v[60:63], v[152:155], v[164:167], v[60:63]
    s_add_u32 m0, s73, 0
    ds_read2_b32 v[90:91], v239 offset0:98 offset1:99
    v_mfma_f32_16x16x32_bf16 v[60:63], v[148:151], v[168:171], v[60:63]
    buffer_load_dwordx4 v6, s[52:55], s14 offen offset:2048 lds
    v_mfma_f32_16x16x32_bf16 v[60:63], v[144:147], v[172:175], v[60:63]
    ds_read_b128 v[124:127], v246 offset:28672
    v_mfma_f32_16x16x32_bf16 v[60:63], v[140:143], v[176:179], v[60:63]
    ds_read2_b32 v[92:93], v239 offset0:224 offset1:225
    v_mfma_f32_16x16x32_bf16 v[60:63], v[136:139], v[180:183], v[60:63]
    v_mfma_f32_16x16x32_bf16 v[60:63], v[132:135], v[184:187], v[60:63]
    ds_read2_b32 v[94:95], v239 offset0:226 offset1:227
    v_mfma_f32_16x16x32_bf16 v[60:63], v[128:131], v[188:191], v[60:63]
    s_waitcnt lgkmcnt(12)
    v_mfma_f32_16x16x32_bf16 v[32:35], v[64:67], v[96:99], v[32:35]
    ds_read_b128 v[160:163], v247 offset:0
    s_waitcnt vmcnt(7)
    s_barrier
    v_mfma_f32_16x16x32_bf16 v[36:39], v[68:71], v[96:99], v[36:39]
    ds_read_b64_tr_b16 a[224:225], v10 offset:16384
    s_add_u32 m0, s73, 0
    s_bfe_u32 s4, s2, 0x20003
    v_mfma_f32_16x16x32_bf16 v[36:39], v[64:67], v[100:103], v[36:39]
    ds_read_b64_tr_b16 a[226:227], v10 offset:18432
    buffer_load_dwordx4 v7, s[52:55], s14 offen offset:3072 lds
    ds_read_b128 v[164:167], v247 offset:4096
    v_mfma_f32_16x16x32_bf16 v[40:43], v[64:67], v[104:107], v[40:43]
    s_lshl2_add_u32 s4, s72, s4
    ds_read_b128 v[168:171], v247 offset:8192
    v_mfma_f32_16x16x32_bf16 v[40:43], v[68:71], v[100:103], v[40:43]
    ds_read_b64_tr_b16 a[232:233], v10 offset:20480
    ds_read_b128 v[172:175], v247 offset:12288
    v_mfma_f32_16x16x32_bf16 v[40:43], v[72:75], v[96:99], v[40:43]
    ds_read_b64_tr_b16 a[234:235], v10 offset:22528
    s_lshl_b32 s4, s4, 3
    v_mfma_f32_16x16x32_bf16 v[44:47], v[76:79], v[96:99], v[44:47]
    ds_read_b128 v[176:179], v247 offset:16384
    v_mfma_f32_16x16x32_bf16 v[44:47], v[72:75], v[100:103], v[44:47]
    ds_read_b64_tr_b16 a[228:229], v11 offset:16384
    s_lshr_b32 s5, s2, 4
    ds_read_b128 v[180:183], v247 offset:20480
    v_mfma_f32_16x16x32_bf16 v[44:47], v[68:71], v[104:107], v[44:47]
    ds_read_b64_tr_b16 a[230:231], v11 offset:18432
    v_mfma_f32_16x16x32_bf16 v[44:47], v[64:67], v[108:111], v[44:47]
    s_and_b32 s5, s5, 6
    ds_read_b128 v[184:187], v247 offset:24576
    s_waitcnt lgkmcnt(13)
    v_mfma_f32_16x16x32_bf16 v[48:51], v[64:67], v[112:115], v[48:51]
    ds_read_b64_tr_b16 a[236:237], v11 offset:20480
    ds_read_b128 v[188:191], v247 offset:28672
    v_mfma_f32_16x16x32_bf16 v[48:51], v[68:71], v[108:111], v[48:51]
    ds_read_b64_tr_b16 a[238:239], v11 offset:22528
    s_add_u32 s4, s4, s5
    v_mfma_f32_16x16x32_bf16 v[48:51], v[72:75], v[104:107], v[48:51]
    ds_read2_b32 v[128:129], v236 offset0:112 offset1:113
    v_mfma_f32_16x16x32_bf16 v[48:51], v[76:79], v[100:103], v[48:51]
    s_and_b32 s5, s2, 1
    ds_read2_b32 v[130:131], v236 offset0:114 offset1:115
    v_mfma_f32_16x16x32_bf16 v[48:51], v[80:83], v[96:99], v[48:51]
    ds_read2_b32 v[132:133], v236 offset0:240 offset1:241
    v_mfma_f32_16x16x32_bf16 v[52:55], v[84:87], v[96:99], v[52:55]
    s_add_u32 s4, s4, s5
    ds_read2_b32 v[134:135], v236 offset0:242 offset1:243
    v_mfma_f32_16x16x32_bf16 v[52:55], v[80:83], v[100:103], v[52:55]
    ds_read2_b32 v[136:137], v237 offset0:112 offset1:113
    v_mfma_f32_16x16x32_bf16 v[52:55], v[76:79], v[104:107], v[52:55]
    s_lshl_b32 s4, s4, 7
    ds_read2_b32 v[138:139], v237 offset0:114 offset1:115
    s_add_u32 s6, s12, 4767744
    v_mfma_f32_16x16x32_bf16 v[52:55], v[72:75], v[108:111], v[52:55]
    s_waitcnt lgkmcnt(6)
    s_barrier
    ds_read2_b32 v[140:141], v237 offset0:240 offset1:241
    s_add_u32 s4, s4, 12566528
    v_mfma_f32_16x16x32_bf16 v[52:55], v[68:71], v[112:115], v[52:55]
    ds_read2_b32 v[142:143], v237 offset0:242 offset1:243
    v_mfma_f32_16x16x32_bf16 v[52:55], v[64:67], v[116:119], v[52:55]
    ds_read2_b32 v[144:145], v238 offset0:112 offset1:113
    v_lshl_add_u32 v28, v2, 2, s4
    v_mfma_f32_16x16x32_bf16 v[56:59], v[64:67], v[120:123], v[56:59]
    s_lshl_b32 s14, s101, 18
    ds_read2_b32 v[146:147], v238 offset0:114 offset1:115
    v_mfma_f32_16x16x32_bf16 v[56:59], v[68:71], v[116:119], v[56:59]
    s_add_u32 m0, s73, 16384
    s_cmp_eq_u32 s3, 0
    s_cselect_b32 s4, 18, 0
    v_mfma_f32_16x16x32_bf16 v[56:59], v[72:75], v[112:115], v[56:59]
    buffer_load_dwordx4 v4, s[52:55], s14 offen offset:0 lds
    ds_read2_b32 v[148:149], v238 offset0:240 offset1:241
    v_mfma_f32_16x16x32_bf16 v[56:59], v[76:79], v[108:111], v[56:59]
    ds_read2_b32 v[150:151], v238 offset0:242 offset1:243
    v_cmp_gt_u32 vcc, s4, v2
    v_mfma_f32_16x16x32_bf16 v[56:59], v[80:83], v[104:107], v[56:59]
    ds_read2_b32 v[152:153], v239 offset0:112 offset1:113
    v_mfma_f32_16x16x32_bf16 v[56:59], v[84:87], v[100:103], v[56:59]
    ds_read2_b32 v[154:155], v239 offset0:114 offset1:115
    v_mov_b32 v13, 0x40000000
    v_mfma_f32_16x16x32_bf16 v[56:59], v[88:91], v[96:99], v[56:59]
    ds_read2_b32 v[156:157], v239 offset0:240 offset1:241
    v_mfma_f32_16x16x32_bf16 v[60:63], v[92:95], v[96:99], v[60:63]
    ds_read2_b32 v[158:159], v239 offset0:242 offset1:243
    v_cndmask_b32 v28, v13, v28, vcc
    v_mfma_f32_16x16x32_bf16 v[60:63], v[88:91], v[100:103], v[60:63]
    s_add_u32 m0, s73, 16384
    v_mfma_f32_16x16x32_bf16 v[60:63], v[84:87], v[104:107], v[60:63]
    buffer_load_dwordx4 v5, s[52:55], s14 offen offset:1024 lds
    v_mov_b32 v13, s68
    v_mfma_f32_16x16x32_bf16 v[60:63], v[80:83], v[108:111], v[60:63]
    v_mfma_f32_16x16x32_bf16 v[60:63], v[76:79], v[112:115], v[60:63]
    v_cndmask_b32 v13, 0, v13, vcc
    v_mfma_f32_16x16x32_bf16 v[60:63], v[72:75], v[116:119], v[60:63]
    v_mfma_f32_16x16x32_bf16 v[60:63], v[68:71], v[120:123], v[60:63]
    v_mfma_f32_16x16x32_bf16 v[60:63], v[64:67], v[124:127], v[60:63]
    s_waitcnt lgkmcnt(0)
    v_mfma_f32_16x16x32_bf16 v[60:63], v[128:131], v[188:191], v[60:63]
    v_mfma_f32_16x16x32_bf16 v[60:63], v[132:135], v[184:187], v[60:63]
    s_add_u32 m0, s73, 16384
    v_mfma_f32_16x16x32_bf16 v[60:63], v[136:139], v[180:183], v[60:63]
    buffer_load_dwordx4 v6, s[52:55], s14 offen offset:2048 lds
    v_mfma_f32_16x16x32_bf16 v[60:63], v[140:143], v[176:179], v[60:63]
    v_mfma_f32_16x16x32_bf16 v[60:63], v[144:147], v[172:175], v[60:63]
    v_mfma_f32_16x16x32_bf16 v[60:63], v[148:151], v[168:171], v[60:63]
    v_mfma_f32_16x16x32_bf16 v[60:63], v[152:155], v[164:167], v[60:63]
L_pl_X_6:
    s_cbranch_execz L_wret
    v_mfma_f32_16x16x32_bf16 v[60:63], v[156:159], v[160:163], v[60:63]
    s_waitcnt vmcnt(7)
    s_barrier
    v_mfma_f32_16x16x32_bf16 v[56:59], v[128:131], v[184:187], v[56:59]
    v_add_u32 v10, 131072, v10
    s_add_u32 m0, s73, 16384
    v_mfma_f32_16x16x32_bf16 v[56:59], v[132:135], v[180:183], v[56:59]
    ds_read_b64_tr_b16 a[240:241], v10 offset:16384
    buffer_load_dwordx4 v7, s[52:55], s14 offen offset:3072 lds
    v_mfma_f32_16x16x32_bf16 v[56:59], v[136:139], v[176:179], v[56:59]
    ds_read_b64_tr_b16 a[242:243], v10 offset:18432
    v_mfma_f32_16x16x32_bf16 v[56:59], v[140:143], v[172:175], v[56:59]
    ds_read_b64_tr_b16 a[248:249], v10 offset:20480
    v_mfma_f32_16x16x32_bf16 v[56:59], v[144:147], v[168:171], v[56:59]
    v_mfma_f32_16x16x32_bf16 v[56:59], v[148:151], v[164:167], v[56:59]
    ds_read_b64_tr_b16 a[250:251], v10 offset:22528
    v_cvt_pk_bf16_f32 v206, v60, v61
    v_mfma_f32_16x16x32_bf16 v[56:59], v[152:155], v[160:163], v[56:59]
    v_add_u32 v11, 131072, v11
    v_mfma_f32_16x16x32_bf16 v[52:55], v[128:131], v[180:183], v[52:55]
    ds_read_b64_tr_b16 a[244:245], v11 offset:16384
    v_mfma_f32_16x16x32_bf16 v[52:55], v[132:135], v[176:179], v[52:55]
    ds_read_b64_tr_b16 a[246:247], v11 offset:18432
    v_cvt_pk_bf16_f32 v207, v62, v63
    v_mfma_f32_16x16x32_bf16 v[52:55], v[136:139], v[172:175], v[52:55]
    ds_read_b64_tr_b16 a[252:253], v11 offset:20480
    v_mfma_f32_16x16x32_bf16 v[52:55], v[140:143], v[168:171], v[52:55]
    buffer_store_dwordx2 v[206:207], v8, s[44:47], s6 offen offset:3584 sc1
    ds_read_b64_tr_b16 a[254:255], v11 offset:22528
    v_mfma_f32_16x16x32_bf16 v[52:55], v[144:147], v[164:167], v[52:55]
    v_mfma_f32_16x16x32_bf16 v[52:55], v[148:151], v[160:163], v[52:55]
    v_mfma_f32_16x16x32_bf16 v[48:51], v[128:131], v[176:179], v[48:51]
    v_cvt_pk_bf16_f32 v204, v56, v57
    v_mfma_f32_16x16x32_bf16 v[48:51], v[132:135], v[172:175], v[48:51]
    v_mfma_f32_16x16x32_bf16 v[48:51], v[136:139], v[168:171], v[48:51]
    v_mfma_f32_16x16x32_bf16 v[48:51], v[140:143], v[164:167], v[48:51]
    v_cvt_pk_bf16_f32 v205, v58, v59
    v_mfma_f32_16x16x32_bf16 v[48:51], v[144:147], v[160:163], v[48:51]
    v_mfma_f32_16x16x32_bf16 v[44:47], v[128:131], v[172:175], v[44:47]
    buffer_store_dwordx2 v[204:205], v8, s[44:47], s6 offen offset:3072 sc1
    v_mfma_f32_16x16x32_bf16 v[44:47], v[132:135], v[168:171], v[44:47]
    v_mfma_f32_16x16x32_bf16 v[44:47], v[136:139], v[164:167], v[44:47]
    v_mfma_f32_16x16x32_bf16 v[44:47], v[140:143], v[160:163], v[44:47]
    v_cvt_pk_bf16_f32 v202, v52, v53
    v_mfma_f32_16x16x32_bf16 v[40:43], v[128:131], v[168:171], v[40:43]
    v_mfma_f32_16x16x32_bf16 v[40:43], v[132:135], v[164:167], v[40:43]
    v_mfma_f32_16x16x32_bf16 v[40:43], v[136:139], v[160:163], v[40:43]
    v_cvt_pk_bf16_f32 v203, v54, v55
    v_mfma_f32_16x16x32_bf16 v[36:39], v[128:131], v[164:167], v[36:39]
    v_mfma_f32_16x16x32_bf16 v[36:39], v[132:135], v[160:163], v[36:39]
    buffer_store_dwordx2 v[202:203], v8, s[44:47], s6 offen offset:2560 sc1
    v_mfma_f32_16x16x32_bf16 v[32:35], v[128:131], v[160:163], v[32:35]
    v_mov_b32 v29, 0
    buffer_atomic_add v29, v28, s[44:47], 0 offen sc0 sc1
    v_cvt_pk_bf16_f32 v200, v48, v49
    v_cvt_pk_bf16_f32 v201, v50, v51
    buffer_store_dwordx2 v[200:201], v8, s[44:47], s6 offen offset:2048 sc1
    v_cvt_pk_bf16_f32 v198, v44, v45
    v_cvt_pk_bf16_f32 v199, v46, v47
    buffer_store_dwordx2 v[198:199], v8, s[44:47], s6 offen offset:1536 sc1
    v_cvt_pk_bf16_f32 v196, v40, v41
    v_cvt_pk_bf16_f32 v197, v42, v43
    buffer_store_dwordx2 v[196:197], v8, s[44:47], s6 offen offset:1024 sc1
    v_cvt_pk_bf16_f32 v194, v36, v37
    v_cvt_pk_bf16_f32 v195, v38, v39
    buffer_store_dwordx2 v[194:195], v8, s[44:47], s6 offen offset:512 sc1
    v_cvt_pk_bf16_f32 v192, v32, v33
    v_cvt_pk_bf16_f32 v193, v34, v35
    buffer_store_dwordx2 v[192:193], v8, s[44:47], s6 offen offset:0 sc1
    v_add_u32 v10, -131072, v10
    v_add_u32 v11, -131072, v11
    s_waitcnt lgkmcnt(0)
    s_barrier
L_DX:
    s_waitcnt vmcnt(0)
    v_cmp_ne_u32 vcc, v13, v29
    s_cbranch_vccnz L_rs_p2X
L_ok_p2X:
    s_barrier
    s_add_u32 m0, s73, 97536
    s_nop 0
    buffer_load_dwordx4 v23, s[44:47], s18 offen offset:768 sc1 lds
    s_add_u32 m0, s73, 99328
    s_nop 0
    buffer_load_dwordx4 v20, s[44:47], s18 offen offset:0 sc1 lds
    s_add_u32 m0, s73, 99840
    s_nop 0
    buffer_load_dwordx4 v20, s[44:47], s18 offen offset:512 sc1 lds
    s_add_u32 m0, s73, 100608
    s_nop 0
    buffer_load_dwordx4 v23, s[44:47], s19 offen offset:768 sc1 lds
    s_add_u32 m0, s73, 114688
    s_nop 0
    buffer_load_dwordx4 v20, s[44:47], s19 offen offset:0 sc1 lds
    s_add_u32 m0, s73, 115200
    s_nop 0
    buffer_load_dwordx4 v20, s[44:47], s19 offen offset:512 sc1 lds
    s_add_u32 m0, s73, 115968
    s_nop 0
    buffer_load_dwordx4 v23, s[44:47], s20 offen offset:768 sc1 lds
    s_add_u32 m0, s73, 117760
    s_nop 0
    buffer_load_dwordx4 v20, s[44:47], s20 offen offset:0 sc1 lds
    s_mov_b32 s56, s16
    s_and_b32 s57, s17, 0xffff
    s_mov_b32 s58, 2359296
    s_mov_b32 s59, 0x20000
    s_mov_b32 s40, 18432
    s_mov_b32 s42, 12386304
    s_mov_b32 s64, s38
    s_and_b32 s65, s39, 0xffff
    s_mov_b32 s66, 2359296
    s_mov_b32 s67, 0x20000
    v_lshlrev_b32 v136, 4, v2
    s_mul_i32 s7, s72, 36
    s_bitcmp1_b32 s3, 0
    s_addc_u32 s7, s7, 0
    s_lshl_b32 s7, s7, 17
    v_subrev_u32 v184, s7, v4
    v_subrev_u32 v185, s7, v5
    s_bfe_u32 s4, s2, 0x20003
    s_mul_i32 s4, s4, 9
    s_lshl1_add_u32 s7, s72, s4
    s_and_b32 s8, s3, 1
    s_add_u32 s7, s7, s8
    s_bfe_u32 s8, s2, 65539
    s_add_u32 s7, s7, s8
    s_lshl_b32 s8, s8, 3
    s_sub_u32 s4, s4, s8
    s_lshl_b32 s37, s7, 16
    s_add_u32 s37, s37, 4718592
    s_add_u32 s4, s4, 8
    s_lshl_b32 s16, s4, 16
    s_add_u32 s16, s16, 4718592
    s_sub_u32 s4, s4, s7
    s_lshl_b32 s4, s4, 7
    s_lshl_b32 s7, s7, 7
    s_add_u32 s7, s7, 12582912
    v_bfe_u32 v24, v2, 2, 1
    v_mul_i32_i24 v24, s4, v24
    v_and_b32 v25, 3, v2
    v_lshl_add_u32 v24, v25, 2, v24
    v_add_u32 v188, s7, v24
    s_lshl2_add_u32 s7, s2, s3
    s_mul_i32 s8, s7, 3072
    s_add_u32 s34, s8, 22953984
    s_add_u32 s11, s8, 26099712
    s_add_u32 s12, s8, 29245440
    s_lshl_b32 s35, s7, 12
    s_add_u32 s35, s35, 32391168
    s_xor_b32 s8, s7, 8
    s_mul_i32 s8, s8, 3072
    s_add_u32 s30, s8, 22953984
    s_xor_b32 s8, s7, 16
    s_mul_i32 s8, s8, 3072
    s_add_u32 s15, s8, 26099712
    s_xor_b32 s8, s7, 24
    s_mul_i32 s8, s8, 3072
    s_add_u32 s31, s8, 29245440
    s_andn2_b32 s7, s7, 24
    s_lshl3_add_u32 s7, s3, s7
    s_lshl2_add_u32 s8, s7, s72
    s_lshl_b32 s8, s8, 10
    s_add_u32 s32, s8, 32391168
    s_xor_b32 s8, s8, 4096
    s_add_u32 s33, s8, 32391168
    s_xor_b32 s8, s3, s72
    s_cmp_lt_u32 s8, 2
    s_cselect_b32 s35, s35, 0x40000000
    s_cselect_b32 s16, s16, 0x40000000
    s_cselect_b32 s36, s68, 0
    s_mov_b32 s38, 0xbfb8aa3b
    s_and_b32 s8, s8, 1
    s_mul_i32 s41, s8, 96
    s_and_b32 s43, s73, 4096
    v_lshlrev_b32 v24, 10, v2
    v_add_u32 v24, s35, v24
    s_add_u32 s7, s34, 2048
    v_mov_b32 v25, s36
    v_cmp_gt_u32 vcc, 4, v2
    s_nop 1
    v_cndmask_b32 v138, 0, v25, vcc
    v_mov_b32 v25, 0x40000000
    v_cndmask_b32 v137, v25, v24, vcc
    v_writelane_b32 v137, s7, 4
    v_writelane_b32 v138, s68, 4
    v_min_u32 v139, 1, v2
    v_lshlrev_b32 v139, 30, v139
    v_mov_b32 v140, 0
    v_writelane_b32 v140, s68, 0
    v_mov_b32 v195, s68
    v_mov_b32 v199, s68
    v_mov_b32 v202, s68
    v_mov_b32 v203, s68
    s_waitcnt vmcnt(4)
    s_barrier
    ds_read_b128 v[104:107], v14 offset:0
    ds_read_b128 v[108:111], v14 offset:4096
    ds_read_b128 v[112:115], v14 offset:8192
    ds_read_b128 v[116:119], v14 offset:12288
    s_waitcnt lgkmcnt(2)
    v_mfma_f32_16x16x32_bf16 v[32:35], v[104:107], a[0:3], 0
    s_add_u32 m0, s73, 130560
    s_sub_u32 s4, s75, 216
    s_lshl_b32 s7, s4, 7
    v_mfma_f32_16x16x32_bf16 v[32:35], v[108:111], a[8:11], v[32:35]
    buffer_load_dwordx4 v20, s[44:47], s20 offen offset:512 sc1 lds
    s_waitcnt lgkmcnt(0)
    v_mfma_f32_16x16x32_bf16 v[32:35], v[112:115], a[16:19], v[32:35]
    ds_read_b128 v[120:123], v14 offset:1024
    s_lshl2_add_u32 s7, s3, s7
    s_add_u32 s7, s7, 12582912
    v_mfma_f32_16x16x32_bf16 v[32:35], v[116:119], a[24:27], v[32:35]
    ds_read_b128 v[124:127], v14 offset:5120
    v_mfma_f32_16x16x32_bf16 v[36:39], v[116:119], a[28:31], 0
    ds_read_b128 v[128:131], v14 offset:9216
    s_cmp_lt_u32 s4, 36
    s_cselect_b32 s7, s7, 0x40000000
    v_mfma_f32_16x16x32_bf16 v[36:39], v[112:115], a[20:23], v[36:39]
    ds_read_b128 v[132:135], v14 offset:13312
    v_min_u32 v28, 1, v2
    v_mfma_f32_16x16x32_bf16 v[36:39], v[108:111], a[12:15], v[36:39]
    s_add_u32 m0, s73, 131328
    v_lshlrev_b32 v28, 30, v28
    v_mov_b32 v29, s68
    v_mfma_f32_16x16x32_bf16 v[36:39], v[104:107], a[4:7], v[36:39]
    buffer_load_dwordx4 v23, s[44:47], s21 offen offset:768 sc1 lds
    s_waitcnt lgkmcnt(2)
    v_mfma_f32_16x16x32_bf16 v[44:47], v[120:123], a[4:7], 0
    buffer_store_dword v29, v28, s[44:47], s7 offen sc1
    s_add_u32 m0, s73, 133120
    v_mfma_f32_16x16x32_bf16 v[44:47], v[124:127], a[12:15], v[44:47]
    buffer_load_dwordx4 v20, s[44:47], s21 offen offset:0 sc1 lds
    s_waitcnt lgkmcnt(0)
    v_mfma_f32_16x16x32_bf16 v[44:47], v[128:131], a[20:23], v[44:47]
    ds_read_b128 v[104:107], v14 offset:2048
    v_mfma_f32_16x16x32_bf16 v[44:47], v[132:135], a[28:31], v[44:47]
    ds_read_b128 v[108:111], v14 offset:6144
    v_mfma_f32_16x16x32_bf16 v[40:43], v[132:135], a[24:27], 0
    ds_read_b128 v[112:115], v14 offset:10240
    v_mfma_f32_16x16x32_bf16 v[40:43], v[128:131], a[16:19], v[40:43]
    ds_read_b128 v[116:119], v14 offset:14336
    v_mfma_f32_16x16x32_bf16 v[40:43], v[124:127], a[8:11], v[40:43]
    s_add_u32 m0, s73, 133632
    v_mfma_f32_16x16x32_bf16 v[40:43], v[120:123], a[0:3], v[40:43]
    buffer_load_dwordx4 v20, s[44:47], s21 offen offset:512 sc1 lds
    s_waitcnt lgkmcnt(2)
    v_mfma_f32_16x16x32_bf16 v[48:51], v[104:107], a[0:3], 0
    s_add_u32 m0, s73, 146688
    v_mfma_f32_16x16x32_bf16 v[48:51], v[108:111], a[8:11], v[48:51]
    buffer_load_dwordx4 v23, s[44:47], s22 offen offset:768 sc1 lds
    s_waitcnt lgkmcnt(0)
    v_mfma_f32_16x16x32_bf16 v[48:51], v[112:115], a[16:19], v[48:51]
    ds_read_b128 v[120:123], v14 offset:3072
    v_mfma_f32_16x16x32_bf16 v[48:51], v[116:119], a[24:27], v[48:51]
    ds_read_b128 v[124:127], v14 offset:7168
    v_mfma_f32_16x16x32_bf16 v[52:55], v[116:119], a[28:31], 0
    ds_read_b128 v[128:131], v14 offset:11264
    v_mfma_f32_16x16x32_bf16 v[52:55], v[112:115], a[20:23], v[52:55]
    ds_read_b128 v[132:135], v14 offset:15360
    v_mfma_f32_16x16x32_bf16 v[52:55], v[108:111], a[12:15], v[52:55]
    s_add_u32 m0, s73, 148480
    v_mfma_f32_16x16x32_bf16 v[52:55], v[104:107], a[4:7], v[52:55]
    buffer_load_dwordx4 v20, s[44:47], s22 offen offset:0 sc1 lds
    s_waitcnt lgkmcnt(2)
    v_mfma_f32_16x16x32_bf16 v[36:39], v[120:123], a[36:39], v[36:39]
    s_add_u32 m0, s73, 148992
    v_mfma_f32_16x16x32_bf16 v[36:39], v[124:127], a[44:47], v[36:39]
    buffer_load_dwordx4 v20, s[44:47], s22 offen offset:512 sc1 lds
    s_waitcnt lgkmcnt(0)
    v_mfma_f32_16x16x32_bf16 v[36:39], v[128:131], a[52:55], v[36:39]
    s_waitcnt vmcnt(8)
    s_barrier
    v_mfma_f32_16x16x32_bf16 v[36:39], v[132:135], a[60:63], v[36:39]
    ds_read_b128 v[104:107], v14 offset:16384
    v_mfma_f32_16x16x32_bf16 v[32:35], v[132:135], a[56:59], v[32:35]
    ds_read_b128 v[108:111], v14 offset:20480
    v_mfma_f32_16x16x32_bf16 v[32:35], v[128:131], a[48:51], v[32:35]
    ds_read_b128 v[112:115], v14 offset:24576
    v_mfma_f32_16x16x32_bf16 v[32:35], v[124:127], a[40:43], v[32:35]
    ds_read_b128 v[116:119], v14 offset:28672
    s_add_u32 m0, s73, 149760
    v_mfma_f32_16x16x32_bf16 v[32:35], v[120:123], a[32:35], v[32:35]
    buffer_load_dwordx4 v23, s[44:47], s23 offen offset:768 sc1 lds
    ds_read_b64_tr_b16 v[220:221], v10 offset:0
    s_waitcnt lgkmcnt(3)
    v_mfma_f32_16x16x32_bf16 v[40:43], v[104:107], a[32:35], v[40:43]
    s_add_u32 m0, s73, 98304
    ds_read_b64_tr_b16 v[222:223], v10 offset:2048
    v_mfma_f32_16x16x32_bf16 v[40:43], v[108:111], a[40:43], v[40:43]
    buffer_load_dwordx4 v20, s[44:47], s23 offen offset:0 sc1 lds
    s_waitcnt lgkmcnt(2)
    v_mfma_f32_16x16x32_bf16 v[40:43], v[112:115], a[48:51], v[40:43]
    ds_read_b128 v[120:123], v14 offset:17408
    v_mfma_f32_16x16x32_bf16 v[40:43], v[116:119], a[56:59], v[40:43]
    ds_read_b128 v[124:127], v14 offset:21504
    v_mfma_f32_16x16x32_bf16 v[44:47], v[116:119], a[60:63], v[44:47]
    ds_read_b128 v[128:131], v14 offset:25600
    v_mfma_f32_16x16x32_bf16 v[44:47], v[112:115], a[52:55], v[44:47]
    ds_read_b128 v[132:135], v14 offset:29696
    v_mfma_f32_16x16x32_bf16 v[44:47], v[108:111], a[44:47], v[44:47]
    s_add_u32 m0, s73, 98816
    ds_read_b64_tr_b16 v[228:229], v10 offset:4096
    v_mfma_f32_16x16x32_bf16 v[44:47], v[104:107], a[36:39], v[44:47]
    buffer_load_dwordx4 v20, s[44:47], s23 offen offset:512 sc1 lds
    s_waitcnt lgkmcnt(3)
    v_mfma_f32_16x16x32_bf16 v[52:55], v[120:123], a[36:39], v[52:55]
    s_add_u32 m0, s73, 99584
    ds_read_b64_tr_b16 v[230:231], v10 offset:6144
    v_mfma_f32_16x16x32_bf16 v[52:55], v[124:127], a[44:47], v[52:55]
    buffer_load_dwordx4 v23, s[44:47], s24 offen offset:768 sc1 lds
    s_waitcnt lgkmcnt(2)
    v_mfma_f32_16x16x32_bf16 v[52:55], v[128:131], a[52:55], v[52:55]
    ds_read_b128 v[104:107], v14 offset:18432
    v_mfma_f32_16x16x32_bf16 v[52:55], v[132:135], a[60:63], v[52:55]
    ds_read_b128 v[108:111], v14 offset:22528
    v_mfma_f32_16x16x32_bf16 v[48:51], v[132:135], a[56:59], v[48:51]
    ds_read_b128 v[112:115], v14 offset:26624
    v_mfma_f32_16x16x32_bf16 v[48:51], v[128:131], a[48:51], v[48:51]
    ds_read_b128 v[116:119], v14 offset:30720
    v_mfma_f32_16x16x32_bf16 v[48:51], v[124:127], a[40:43], v[48:51]
    s_add_u32 m0, s73, 101376
    ds_read_b64_tr_b16 v[224:225], v11 offset:0
    v_mfma_f32_16x16x32_bf16 v[48:51], v[120:123], a[32:35], v[48:51]
    buffer_load_dwordx4 v20, s[44:47], s24 offen offset:0 sc1 lds
    s_waitcnt lgkmcnt(3)
    v_mfma_f32_16x16x32_bf16 v[32:35], v[104:107], a[64:67], v[32:35]
    ds_read_b64_tr_b16 v[226:227], v11 offset:2048
    v_mfma_f32_16x16x32_bf16 v[32:35], v[108:111], a[72:75], v[32:35]
    s_waitcnt lgkmcnt(2)
    v_mfma_f32_16x16x32_bf16 v[32:35], v[112:115], a[80:83], v[32:35]
    ds_read_b128 v[120:123], v14 offset:19456
    v_mfma_f32_16x16x32_bf16 v[32:35], v[116:119], a[88:91], v[32:35]
    ds_read_b128 v[124:127], v14 offset:23552
    v_mfma_f32_16x16x32_bf16 v[36:39], v[116:119], a[92:95], v[36:39]
    ds_read_b128 v[128:131], v14 offset:27648
    v_mfma_f32_16x16x32_bf16 v[36:39], v[112:115], a[84:87], v[36:39]
    ds_read_b128 v[132:135], v14 offset:31744
    v_mfma_f32_16x16x32_bf16 v[36:39], v[108:111], a[76:79], v[36:39]
    ds_read_b64_tr_b16 v[232:233], v11 offset:4096
    v_mfma_f32_16x16x32_bf16 v[36:39], v[104:107], a[68:71], v[36:39]
    s_waitcnt lgkmcnt(3)
    v_mfma_f32_16x16x32_bf16 v[44:47], v[120:123], a[68:71], v[44:47]
    ds_read_b64_tr_b16 v[234:235], v11 offset:6144
    v_mfma_f32_16x16x32_bf16 v[44:47], v[124:127], a[76:79], v[44:47]
    s_waitcnt lgkmcnt(2)
    v_mfma_f32_16x16x32_bf16 v[44:47], v[128:131], a[84:87], v[44:47]
    s_waitcnt vmcnt(8) lgkmcnt(0)
    s_barrier
    v_mfma_f32_16x16x32_bf16 v[44:47], v[132:135], a[92:95], v[44:47]
    ds_read_b128 v[104:107], v14 offset:32768
    v_mfma_f32_16x16x32_bf16 v[40:43], v[132:135], a[88:91], v[40:43]
    ds_read_b128 v[108:111], v14 offset:36864
    v_mfma_f32_16x16x32_bf16 v[40:43], v[128:131], a[80:83], v[40:43]
    ds_read_b128 v[112:115], v14 offset:40960
    v_mfma_f32_16x16x32_bf16 v[40:43], v[124:127], a[72:75], v[40:43]
    ds_read_b128 v[116:119], v14 offset:45056
    v_mfma_f32_16x16x32_bf16 v[40:43], v[120:123], a[64:67], v[40:43]
    ds_read_b64_tr_b16 v[236:237], v10 offset:16384
    s_waitcnt lgkmcnt(3)
    v_mfma_f32_16x16x32_bf16 v[48:51], v[104:107], a[64:67], v[48:51]
    s_add_u32 m0, s73, 114176
    ds_read_b64_tr_b16 v[238:239], v10 offset:18432
    v_mfma_f32_16x16x32_bf16 v[48:51], v[108:111], a[72:75], v[48:51]
    buffer_load_dwordx4 v20, s[44:47], s24 offen offset:512 sc1 lds
    s_waitcnt lgkmcnt(2)
    v_mfma_f32_16x16x32_bf16 v[48:51], v[112:115], a[80:83], v[48:51]
    ds_read_b128 v[120:123], v14 offset:33792
    v_mfma_f32_16x16x32_bf16 v[48:51], v[116:119], a[88:91], v[48:51]
    ds_read_b128 v[124:127], v14 offset:37888
    v_lshrrev_b32 v30, 2, v26
    v_mfma_f32_16x16x32_bf16 v[52:55], v[116:119], a[92:95], v[52:55]
    ds_read_b128 v[128:131], v14 offset:41984
    v_mfma_f32_16x16x32_bf16 v[52:55], v[112:115], a[84:87], v[52:55]
    ds_read_b128 v[132:135], v14 offset:46080
    v_mfma_f32_16x16x32_bf16 v[52:55], v[108:111], a[76:79], v[52:55]
    s_add_u32 m0, s73, 114944
    ds_read_b64_tr_b16 v[244:245], v10 offset:20480
    v_mfma_f32_16x16x32_bf16 v[52:55], v[104:107], a[68:71], v[52:55]
    buffer_load_dwordx4 v23, s[44:47], s25 offen offset:768 sc1 lds
    s_waitcnt lgkmcnt(3)
    v_mfma_f32_16x16x32_bf16 v[36:39], v[120:123], a[100:103], v[36:39]
    s_add_u32 m0, s73, 116736
    ds_read_b64_tr_b16 v[246:247], v10 offset:22528
    v_mfma_f32_16x16x32_bf16 v[36:39], v[124:127], a[108:111], v[36:39]
    buffer_load_dwordx4 v20, s[44:47], s25 offen offset:0 sc1 lds
    s_waitcnt lgkmcnt(2)
    v_mfma_f32_16x16x32_bf16 v[36:39], v[128:131], a[116:119], v[36:39]
    ds_read_b128 v[104:107], v14 offset:34816
    v_lshrrev_b32 v31, 2, v18
    v_mfma_f32_16x16x32_bf16 v[36:39], v[132:135], a[124:127], v[36:39]
    ds_read_b128 v[108:111], v14 offset:38912
    v_mfma_f32_16x16x32_bf16 v[32:35], v[132:135], a[120:123], v[32:35]
    ds_read_b128 v[112:115], v14 offset:43008
    v_mfma_f32_16x16x32_bf16 v[32:35], v[128:131], a[112:115], v[32:35]
    ds_read_b128 v[116:119], v14 offset:47104
    v_mfma_f32_16x16x32_bf16 v[32:35], v[124:127], a[104:107], v[32:35]
    s_add_u32 m0, s73, 117248
    ds_read_b64_tr_b16 v[240:241], v11 offset:16384
    v_mfma_f32_16x16x32_bf16 v[32:35], v[120:123], a[96:99], v[32:35]
    buffer_load_dwordx4 v20, s[44:47], s25 offen offset:512 sc1 lds
    s_waitcnt lgkmcnt(3)
    v_mfma_f32_16x16x32_bf16 v[40:43], v[104:107], a[96:99], v[40:43]
    ds_read_b64_tr_b16 v[242:243], v11 offset:18432
    buffer_load_ushort v102, v30, s[60:63], 0 offen offset:0
    v_mfma_f32_16x16x32_bf16 v[40:43], v[108:111], a[104:107], v[40:43]
    s_waitcnt lgkmcnt(2)
    v_mfma_f32_16x16x32_bf16 v[40:43], v[112:115], a[112:115], v[40:43]
    ds_read_b128 v[120:123], v14 offset:35840
    v_mfma_f32_16x16x32_bf16 v[40:43], v[116:119], a[120:123], v[40:43]
    ds_read_b128 v[124:127], v14 offset:39936
    v_mfma_f32_16x16x32_bf16 v[44:47], v[116:119], a[124:127], v[44:47]
    ds_read_b128 v[128:131], v14 offset:44032
    v_mfma_f32_16x16x32_bf16 v[44:47], v[112:115], a[116:119], v[44:47]
    ds_read_b128 v[132:135], v14 offset:48128
    v_mfma_f32_16x16x32_bf16 v[44:47], v[108:111], a[108:111], v[44:47]
    ds_read_b64_tr_b16 v[248:249], v11 offset:20480
    buffer_load_ushort v103, v30, s[60:63], 0 offen offset:32
    v_mfma_f32_16x16x32_bf16 v[44:47], v[104:107], a[100:103], v[44:47]
    s_waitcnt lgkmcnt(3)
    v_mfma_f32_16x16x32_bf16 v[52:55], v[120:123], a[100:103], v[52:55]
    ds_read_b64_tr_b16 v[250:251], v11 offset:22528
    v_mfma_f32_16x16x32_bf16 v[52:55], v[124:127], a[108:111], v[52:55]
    s_waitcnt lgkmcnt(2)
    v_mfma_f32_16x16x32_bf16 v[52:55], v[128:131], a[116:119], v[52:55]
    s_waitcnt vmcnt(10) lgkmcnt(0)
    s_barrier
    v_mfma_f32_16x16x32_bf16 v[52:55], v[132:135], a[124:127], v[52:55]
    ds_read_b128 v[104:107], v14 offset:49152
    v_mfma_f32_16x16x32_bf16 v[48:51], v[132:135], a[120:123], v[48:51]
    ds_read_b128 v[108:111], v14 offset:53248
    buffer_load_ushort v27, v31, s[60:63], 0 offen offset:0
    v_mfma_f32_16x16x32_bf16 v[48:51], v[128:131], a[112:115], v[48:51]
    ds_read_b128 v[112:115], v14 offset:57344
    v_mfma_f32_16x16x32_bf16 v[48:51], v[124:127], a[104:107], v[48:51]
    ds_read_b128 v[116:119], v14 offset:61440
    v_mfma_f32_16x16x32_bf16 v[48:51], v[120:123], a[96:99], v[48:51]
    s_waitcnt lgkmcnt(2)
    v_mfma_f32_16x16x32_bf16 v[32:35], v[104:107], a[128:131], v[32:35]
    s_add_u32 m0, s73, 130304
    v_mfma_f32_16x16x32_bf16 v[32:35], v[108:111], a[136:139], v[32:35]
    buffer_load_dwordx4 v23, s[44:47], s26 offen offset:768 sc1 lds
    s_waitcnt lgkmcnt(0)
    v_mfma_f32_16x16x32_bf16 v[32:35], v[112:115], a[144:147], v[32:35]
    ds_read_b128 v[120:123], v14 offset:50176
    v_mfma_f32_16x16x32_bf16 v[32:35], v[116:119], a[152:155], v[32:35]
    ds_read_b128 v[124:127], v14 offset:54272
    v_mfma_f32_16x16x32_bf16 v[36:39], v[116:119], a[156:159], v[36:39]
    ds_read_b128 v[128:131], v14 offset:58368
    v_mfma_f32_16x16x32_bf16 v[36:39], v[112:115], a[148:151], v[36:39]
    ds_read_b128 v[132:135], v14 offset:62464
    v_mfma_f32_16x16x32_bf16 v[36:39], v[108:111], a[140:143], v[36:39]
    s_add_u32 m0, s73, 132096
    v_mfma_f32_16x16x32_bf16 v[36:39], v[104:107], a[132:135], v[36:39]
    buffer_load_dwordx4 v20, s[44:47], s26 offen offset:0 sc1 lds
    s_waitcnt lgkmcnt(2)
    v_mfma_f32_16x16x32_bf16 v[44:47], v[120:123], a[132:135], v[44:47]
    s_add_u32 m0, s73, 132608
    v_mfma_f32_16x16x32_bf16 v[44:47], v[124:127], a[140:143], v[44:47]
    buffer_load_dwordx4 v20, s[44:47], s26 offen offset:512 sc1 lds
    s_waitcnt lgkmcnt(0)
    v_mfma_f32_16x16x32_bf16 v[44:47], v[128:131], a[148:151], v[44:47]
    ds_read_b128 v[104:107], v14 offset:51200
    v_mfma_f32_16x16x32_bf16 v[44:47], v[132:135], a[156:159], v[44:47]
    ds_read_b128 v[108:111], v14 offset:55296
    v_mfma_f32_16x16x32_bf16 v[40:43], v[132:135], a[152:155], v[40:43]
    ds_read_b128 v[112:115], v14 offset:59392
    v_mfma_f32_16x16x32_bf16 v[40:43], v[128:131], a[144:147], v[40:43]
    ds_read_b128 v[116:119], v14 offset:63488
    v_mfma_f32_16x16x32_bf16 v[40:43], v[124:127], a[136:139], v[40:43]
    s_add_u32 m0, s73, 134144
    v_mfma_f32_16x16x32_bf16 v[40:43], v[120:123], a[128:131], v[40:43]
    buffer_load_dwordx4 v21, s[44:47], s18 offen offset:0 sc1 lds
    s_waitcnt lgkmcnt(2)
    v_mfma_f32_16x16x32_bf16 v[48:51], v[104:107], a[128:131], v[48:51]
    v_mfma_f32_16x16x32_bf16 v[48:51], v[108:111], a[136:139], v[48:51]
    s_waitcnt lgkmcnt(0)
    v_mfma_f32_16x16x32_bf16 v[48:51], v[112:115], a[144:147], v[48:51]
    ds_read_b128 v[120:123], v14 offset:52224
    v_mfma_f32_16x16x32_bf16 v[48:51], v[116:119], a[152:155], v[48:51]
    ds_read_b128 v[124:127], v14 offset:56320
    v_mfma_f32_16x16x32_bf16 v[52:55], v[116:119], a[156:159], v[52:55]
    ds_read_b128 v[128:131], v14 offset:60416
    v_mfma_f32_16x16x32_bf16 v[52:55], v[112:115], a[148:151], v[52:55]
    ds_read_b128 v[132:135], v14 offset:64512
    v_mfma_f32_16x16x32_bf16 v[52:55], v[108:111], a[140:143], v[52:55]
    v_mfma_f32_16x16x32_bf16 v[52:55], v[104:107], a[132:135], v[52:55]
    s_waitcnt lgkmcnt(2)
    v_mfma_f32_16x16x32_bf16 v[36:39], v[120:123], a[164:167], v[36:39]
    v_mfma_f32_16x16x32_bf16 v[36:39], v[124:127], a[172:175], v[36:39]
    s_waitcnt lgkmcnt(0)
    v_mfma_f32_16x16x32_bf16 v[36:39], v[128:131], a[180:183], v[36:39]
    s_waitcnt vmcnt(11)
    s_barrier
    v_mfma_f32_16x16x32_bf16 v[36:39], v[132:135], a[188:191], v[36:39]
    ds_read_b128 v[104:107], v14 offset:0
    v_mfma_f32_16x16x32_bf16 v[32:35], v[132:135], a[184:187], v[32:35]
    ds_read_b128 v[108:111], v14 offset:4096
    v_mfma_f32_16x16x32_bf16 v[32:35], v[128:131], a[176:179], v[32:35]
    ds_read_b128 v[112:115], v14 offset:8192
    v_mfma_f32_16x16x32_bf16 v[32:35], v[124:127], a[168:171], v[32:35]
    ds_read_b128 v[116:119], v14 offset:12288
    v_mfma_f32_16x16x32_bf16 v[32:35], v[120:123], a[160:163], v[32:35]
    s_waitcnt lgkmcnt(2)
    v_mfma_f32_16x16x32_bf16 v[40:43], v[104:107], a[160:163], v[40:43]
    s_add_u32 m0, s73, 146944
    v_mfma_f32_16x16x32_bf16 v[40:43], v[108:111], a[168:171], v[40:43]
    buffer_load_dwordx4 v21, s[44:47], s18 offen offset:512 sc1 lds
    s_waitcnt lgkmcnt(0)
    v_mfma_f32_16x16x32_bf16 v[40:43], v[112:115], a[176:179], v[40:43]
    ds_read_b128 v[120:123], v14 offset:1024
    v_mfma_f32_16x16x32_bf16 v[40:43], v[116:119], a[184:187], v[40:43]
    ds_read_b128 v[124:127], v14 offset:5120
    v_mfma_f32_16x16x32_bf16 v[44:47], v[116:119], a[188:191], v[44:47]
    ds_read_b128 v[128:131], v14 offset:9216
    v_mfma_f32_16x16x32_bf16 v[44:47], v[112:115], a[180:183], v[44:47]
    ds_read_b128 v[132:135], v14 offset:13312
    buffer_load_dwordx4 v[88:91], v252, s[56:59], 0 offen
    v_mfma_f32_16x16x32_bf16 v[44:47], v[108:111], a[172:175], v[44:47]
    s_add_u32 m0, s73, 148480
    v_mfma_f32_16x16x32_bf16 v[44:47], v[104:107], a[164:167], v[44:47]
    buffer_load_dwordx4 v21, s[44:47], s19 offen offset:0 sc1 lds
    s_waitcnt lgkmcnt(2)
    v_mfma_f32_16x16x32_bf16 v[52:55], v[120:123], a[164:167], v[52:55]
    s_add_u32 m0, s73, 148992
    v_mfma_f32_16x16x32_bf16 v[52:55], v[124:127], a[172:175], v[52:55]
    buffer_load_dwordx4 v21, s[44:47], s19 offen offset:512 sc1 lds
    s_waitcnt lgkmcnt(0)
    v_mfma_f32_16x16x32_bf16 v[52:55], v[128:131], a[180:183], v[52:55]
    ds_read_b128 v[104:107], v14 offset:2048
    v_mfma_f32_16x16x32_bf16 v[52:55], v[132:135], a[188:191], v[52:55]
    ds_read_b128 v[108:111], v14 offset:6144
    v_mfma_f32_16x16x32_bf16 v[48:51], v[132:135], a[184:187], v[48:51]
    ds_read_b128 v[112:115], v14 offset:10240
    v_mfma_f32_16x16x32_bf16 v[48:51], v[128:131], a[176:179], v[48:51]
    ds_read_b128 v[116:119], v14 offset:14336
    v_mfma_f32_16x16x32_bf16 v[48:51], v[124:127], a[168:171], v[48:51]
    s_add_u32 m0, s73, 150528
    v_mfma_f32_16x16x32_bf16 v[48:51], v[120:123], a[160:163], v[48:51]
    buffer_load_dwordx4 v21, s[44:47], s20 offen offset:0 sc1 lds
    s_waitcnt lgkmcnt(2)
    v_mfma_f32_16x16x32_bf16 v[32:35], v[104:107], a[192:195], v[32:35]
    buffer_load_dwordx4 v[92:95], v252, s[56:59], s40 offen
    v_mfma_f32_16x16x32_bf16 v[32:35], v[108:111], a[200:203], v[32:35]
    s_waitcnt vmcnt(10)
    s_waitcnt lgkmcnt(0)
    v_mfma_f32_16x16x32_bf16 v[32:35], v[112:115], a[208:211], v[32:35]
    ds_read_b128 v[120:123], v14 offset:3072
    v_mfma_f32_16x16x32_bf16 v[32:35], v[116:119], a[216:219], v[32:35]
    ds_read_b128 v[124:127], v14 offset:7168
    v_mfma_f32_16x16x32_bf16 v[36:39], v[116:119], a[220:223], v[36:39]
    ds_read_b128 v[128:131], v14 offset:11264
    v_lshlrev_b32 v72, 16, v102
    v_mfma_f32_16x16x32_bf16 v[36:39], v[112:115], a[212:215], v[36:39]
    ds_read_b128 v[132:135], v14 offset:15360
    v_mfma_f32_16x16x32_bf16 v[36:39], v[108:111], a[204:207], v[36:39]
    v_lshlrev_b32 v73, 16, v102
    v_mfma_f32_16x16x32_bf16 v[36:39], v[104:107], a[196:199], v[36:39]
    s_waitcnt lgkmcnt(2)
    v_mfma_f32_16x16x32_bf16 v[44:47], v[120:123], a[196:199], v[44:47]
    v_mfma_f32_16x16x32_bf16 v[44:47], v[124:127], a[204:207], v[44:47]
    v_lshlrev_b32 v74, 16, v102
    s_waitcnt lgkmcnt(0)
    v_mfma_f32_16x16x32_bf16 v[44:47], v[128:131], a[212:215], v[44:47]
    buffer_load_dwordx2 v[142:143], v253, s[56:59], 0 offen
    s_barrier
    v_mfma_f32_16x16x32_bf16 v[44:47], v[132:135], a[220:223], v[44:47]
    ds_read_b128 v[104:107], v14 offset:16384
    v_mfma_f32_16x16x32_bf16 v[40:43], v[132:135], a[216:219], v[40:43]
    ds_read_b128 v[108:111], v14 offset:20480
    v_lshlrev_b32 v75, 16, v102
    v_mfma_f32_16x16x32_bf16 v[40:43], v[128:131], a[208:211], v[40:43]
    ds_read_b128 v[112:115], v14 offset:24576
    v_mfma_f32_16x16x32_bf16 v[40:43], v[124:127], a[200:203], v[40:43]
    ds_read_b128 v[116:119], v14 offset:28672
    v_lshlrev_b32 v76, 16, v103
    v_mfma_f32_16x16x32_bf16 v[40:43], v[120:123], a[192:195], v[40:43]
    s_waitcnt lgkmcnt(2)
    v_mfma_f32_16x16x32_bf16 v[48:51], v[104:107], a[192:195], v[48:51]
    s_add_u32 m0, s73, 97792
    v_lshlrev_b32 v77, 16, v103
    v_mfma_f32_16x16x32_bf16 v[48:51], v[108:111], a[200:203], v[48:51]
    buffer_load_dwordx4 v21, s[44:47], s20 offen offset:512 sc1 lds
L_pl_X_7:
    s_cbranch_execz L_wret
    s_waitcnt lgkmcnt(0)
    v_mfma_f32_16x16x32_bf16 v[48:51], v[112:115], a[208:211], v[48:51]
    ds_read_b128 v[120:123], v14 offset:17408
    v_mfma_f32_16x16x32_bf16 v[48:51], v[116:119], a[216:219], v[48:51]
    ds_read_b128 v[124:127], v14 offset:21504
    v_mfma_f32_16x16x32_bf16 v[52:55], v[116:119], a[220:223], v[52:55]
    ds_read_b128 v[128:131], v14 offset:25600
    v_lshlrev_b32 v78, 16, v103
    v_mfma_f32_16x16x32_bf16 v[52:55], v[112:115], a[212:215], v[52:55]
    ds_read_b128 v[132:135], v14 offset:29696
    buffer_load_dwordx2 v[96:97], v26, s[44:47], s42 offen offset:0 sc1
    v_mfma_f32_16x16x32_bf16 v[52:55], v[108:111], a[204:207], v[52:55]
    s_add_u32 m0, s73, 99328
    v_lshlrev_b32 v79, 16, v103
    v_mfma_f32_16x16x32_bf16 v[52:55], v[104:107], a[196:199], v[52:55]
    buffer_load_dwordx4 v21, s[44:47], s21 offen offset:0 sc1 lds
    s_waitcnt lgkmcnt(2)
    v_mfma_f32_16x16x32_bf16 v[36:39], v[120:123], a[228:231], v[36:39]
    s_add_u32 m0, s73, 99840
    v_lshlrev_b32 v80, 16, v102
    v_mfma_f32_16x16x32_bf16 v[36:39], v[124:127], a[236:239], v[36:39]
    buffer_load_dwordx4 v21, s[44:47], s21 offen offset:512 sc1 lds
    s_waitcnt lgkmcnt(0)
    v_mfma_f32_16x16x32_bf16 v[36:39], v[128:131], a[244:247], v[36:39]
    ds_read_b128 v[104:107], v14 offset:18432
    v_mfma_f32_16x16x32_bf16 v[36:39], v[132:135], a[252:255], v[36:39]
    ds_read_b128 v[108:111], v14 offset:22528
    v_mfma_f32_16x16x32_bf16 v[32:35], v[132:135], a[248:251], v[32:35]
    ds_read_b128 v[112:115], v14 offset:26624
    v_lshlrev_b32 v81, 16, v102
    v_mfma_f32_16x16x32_bf16 v[32:35], v[128:131], a[240:243], v[32:35]
    ds_read_b128 v[116:119], v14 offset:30720
    v_mfma_f32_16x16x32_bf16 v[32:35], v[124:127], a[232:235], v[32:35]
    s_add_u32 m0, s73, 101376
    v_lshlrev_b32 v82, 16, v102
    v_mfma_f32_16x16x32_bf16 v[32:35], v[120:123], a[224:227], v[32:35]
    buffer_load_dwordx4 v21, s[44:47], s22 offen offset:0 sc1 lds
    s_waitcnt lgkmcnt(2)
    v_mfma_f32_16x16x32_bf16 v[40:43], v[104:107], a[224:227], v[40:43]
    buffer_load_dwordx2 v[98:99], v26, s[44:47], s42 offen offset:128 sc1
    v_mfma_f32_16x16x32_bf16 v[40:43], v[108:111], a[232:235], v[40:43]
    v_lshlrev_b32 v83, 16, v102
    s_waitcnt lgkmcnt(0)
    v_mfma_f32_16x16x32_bf16 v[40:43], v[112:115], a[240:243], v[40:43]
    ds_read_b128 v[120:123], v14 offset:19456
    v_mfma_f32_16x16x32_bf16 v[40:43], v[116:119], a[248:251], v[40:43]
    ds_read_b128 v[124:127], v14 offset:23552
    v_mfma_f32_16x16x32_bf16 v[44:47], v[116:119], a[252:255], v[44:47]
    ds_read_b128 v[128:131], v14 offset:27648
    v_lshlrev_b32 v84, 16, v103
    v_mfma_f32_16x16x32_bf16 v[44:47], v[112:115], a[244:247], v[44:47]
    ds_read_b128 v[132:135], v14 offset:31744
    v_mfma_f32_16x16x32_bf16 v[44:47], v[108:111], a[236:239], v[44:47]
    v_lshlrev_b32 v85, 16, v103
    v_mfma_f32_16x16x32_bf16 v[44:47], v[104:107], a[228:231], v[44:47]
    s_waitcnt lgkmcnt(2)
    v_mfma_f32_16x16x32_bf16 v[52:55], v[120:123], a[228:231], v[52:55]
    v_mfma_f32_16x16x32_bf16 v[52:55], v[124:127], a[236:239], v[52:55]
    v_lshlrev_b32 v86, 16, v103
    s_waitcnt lgkmcnt(0)
    v_mfma_f32_16x16x32_bf16 v[52:55], v[128:131], a[244:247], v[52:55]
    buffer_load_dwordx2 v[100:101], v18, s[44:47], s42 offen offset:0 sc1
    s_waitcnt vmcnt(14)
    s_barrier
    v_mfma_f32_16x16x32_bf16 v[52:55], v[132:135], a[252:255], v[52:55]
    ds_read_b128 v[104:107], v14 offset:32768
    v_lshlrev_b32 v87, 16, v103
    v_mfma_f32_16x16x32_bf16 v[48:51], v[132:135], a[248:251], v[48:51]
    ds_read_b128 v[108:111], v14 offset:36864
    v_add_u32 v10, 65536, v10
    v_mfma_f32_16x16x32_bf16 v[48:51], v[128:131], a[240:243], v[48:51]
    ds_read_b128 v[112:115], v14 offset:40960
    v_mfma_f32_16x16x32_bf16 v[48:51], v[124:127], a[232:235], v[48:51]
    ds_read_b128 v[116:119], v14 offset:45056
    v_add_u32 v11, 65536, v11
    v_mfma_f32_16x16x32_bf16 v[48:51], v[120:123], a[224:227], v[48:51]
    v_lshlrev_b32 v27, 16, v27
    s_branch L_Dc
L_idle:
    s_waitcnt vmcnt(0)
    s_barrier
    s_mov_b64 exec, 0
    s_call_b64 s[82:83], L_wc_D
    s_mov_b64 exec, -1
    s_mov_b32 s60, s36
    s_and_b32 s61, s37, 0xffff
    s_mov_b32 s62, 4096
    s_mov_b32 s63, 0x20000
    v_and_b32 v24, 15, v2
    s_lshl_b32 s7, s71, 6
    v_add_u32 v24, s7, v24
    s_and_b32 s8, s3, 1
    s_lshl_b32 s4, s8, 5
    v_add_u32 v25, s4, v24
    v_lshlrev_b32 v26, 3, v25
    v_mul_u32_u24 v25, 1152, v25
    v_bfe_u32 v31, v2, 4, 1
    v_lshl_add_u32 v25, v31, 5, v25
    v_lshrrev_b32 v31, 5, v2
    v_lshl_add_u32 v25, v31, 4, v25
    s_bfe_u32 s7, s2, 0x20003
    s_mul_i32 s7, s7, 288
    s_bfe_u32 s5, s2, 0x10003
    s_mul_i32 s5, s5, 32
    s_lshl_b32 s4, s72, 6
    s_add_u32 s4, s4, s7
    s_add_u32 s4, s4, s5
    s_lshl_b32 s5, s5, 3
    s_sub_u32 s7, s7, s5
    v_add_u32 v252, s4, v25
    s_xor_b32 s8, s3, s72
    s_and_b32 s4, s72, 1
    s_lshl1_add_u32 s4, s4, s8
    v_lshl_add_u32 v24, s4, 4, v24
    s_add_u32 s7, s7, 256
    s_cmp_lt_u32 s8, 2
    s_cselect_b32 s7, s7, 0x40000000
    v_lshlrev_b32 v18, 3, v24
    v_mul_u32_u24 v24, 1152, v24
    v_lshrrev_b32 v31, 4, v2
    v_lshl_add_u32 v24, v31, 3, v24
    v_add_u32 v253, s7, v24
    v_lshrrev_b32 v24, 3, v2
    v_and_b32 v25, 7, v2
    v_bfe_u32 v31, v2, 4, 2
    v_lshlrev_b32 v31, 1, v31
    v_xor_b32 v25, v25, v31
    v_lshlrev_b32 v24, 12, v24
    v_lshl_add_u32 v24, v25, 4, v24
    s_mul_i32 s7, s72, 36
    s_bitcmp1_b32 s3, 0
    s_addc_u32 s7, s7, 0
    s_lshl_b32 s7, s7, 17
    s_lshl_b32 s8, s71, 7
    s_add_u32 s7, s7, s8
    v_add_u32 v4, s7, v24
    v_add_u32 v5, 31744, v4
    v_add_u32 v6, 31744, v5
    v_add_u32 v7, 31744, v6
    v_lshrrev_b32 v24, 2, v2
    v_lshlrev_b32 v24, 7, v24
    v_and_b32 v25, 3, v2
    v_lshl_add_u32 v24, v25, 3, v24
    s_and_b32 s7, s73, 8192
    v_add_u32 v24, s7, v24
    v_bfe_u32 v31, v2, 3, 2
    s_and_b32 s7, s3, 1
    s_lshl_b32 s7, s7, 1
    v_xor_b32 v31, s7, v31
    v_lshl_add_u32 v10, v31, 5, v24
    v_xor_b32 v11, 32, v10
    v_and_b32 v24, 15, v2
    v_lshrrev_b32 v25, 4, v2
    v_mul_u32_u24 v25, 17408, v25
    v_lshl_add_u32 v24, v24, 4, v25
    s_mul_i32 s7, s72, 36
    s_and_b32 s8, s3, 1
    s_add_u32 s7, s7, s8
    s_mul_i32 s7, s7, 69632
    s_bfe_u32 s8, s2, 0x20003
    s_lshl_b32 s8, s8, 12
    s_add_u32 s7, s7, s8
    s_add_u32 s7, s7, 12795904
    v_add_u32 v23, s7, v24
    s_xor_b32 s7, s72, 0
    v_lshl_add_u32 v19, s7, 10, v23
    s_xor_b32 s7, s72, 1
    v_lshl_add_u32 v20, s7, 10, v23
    s_xor_b32 s7, s72, 2
    v_lshl_add_u32 v21, s7, 10, v23
    s_xor_b32 s7, s72, 3
    v_lshl_add_u32 v22, s7, 10, v23
    v_lshlrev_b32 v14, 4, v2
    v_add_u32 v14, 98304, v14
    v_add_u32 v1, 0x10000, v14
    s_bitcmp1_b32 s3, 1
    s_cselect_b32 s18, s85, s84
    s_mul_i32 s18, s18, 139264
    s_cselect_b32 s19, s87, s86
    s_mul_i32 s19, s19, 139264
    s_cselect_b32 s20, s89, s88
    s_mul_i32 s20, s20, 139264
    s_cselect_b32 s21, s91, s90
    s_mul_i32 s21, s21, 139264
    s_cselect_b32 s22, s93, s92
    s_mul_i32 s22, s22, 139264
    s_cselect_b32 s23, s95, s94
    s_mul_i32 s23, s23, 139264
    s_cselect_b32 s24, s97, s96
    s_mul_i32 s24, s24, 139264
    s_cselect_b32 s25, s99, s98
    s_mul_i32 s25, s25, 139264
    s_cselect_b32 s26, s101, s100
    s_mul_i32 s26, s26, 139264
    s_sub_u32 s4, s75, 252
    s_mul_i32 s4, s4, 1152
    s_mul_i32 s5, s3, 64
    s_add_u32 s4, s4, s5
    s_add_u32 s4, s4, 896
    s_lshl_b32 s4, s4, 12
    s_add_u32 s4, s4, 384
    v_lshlrev_b32 v24, 10, v2
    buffer_load_dword v255, v24, s[52:55], s4 offen
    s_add_u32 s4, s4, 65536
    buffer_load_dword v255, v24, s[52:55], s4 offen
    s_add_u32 s4, s4, 65536
    buffer_load_dword v255, v24, s[52:55], s4 offen
    s_add_u32 s4, s4, 65536
    buffer_load_dword v255, v24, s[52:55], s4 offen
    s_add_u32 s4, s4, 65536
    s_add_u32 m0, s73, 32768
    s_lshl_b32 s14, s84, 18
    buffer_load_dwordx4 v4, s[52:55], s14 offen offset:0 lds
    buffer_load_dwordx4 v5, s[52:55], s14 offen offset:1024 lds
    buffer_load_dwordx4 v6, s[52:55], s14 offen offset:2048 lds
    buffer_load_dwordx4 v7, s[52:55], s14 offen offset:3072 lds
    s_add_u32 m0, s73, 49152
    s_lshl_b32 s14, s85, 18
    buffer_load_dwordx4 v4, s[52:55], s14 offen offset:0 lds
    buffer_load_dwordx4 v5, s[52:55], s14 offen offset:1024 lds
    buffer_load_dwordx4 v6, s[52:55], s14 offen offset:2048 lds
    buffer_load_dwordx4 v7, s[52:55], s14 offen offset:3072 lds
    s_add_u32 m0, s73, 65536
    s_lshl_b32 s14, s86, 18
    buffer_load_dwordx4 v4, s[52:55], s14 offen offset:0 lds
    buffer_load_dwordx4 v5, s[52:55], s14 offen offset:1024 lds
    buffer_load_dwordx4 v6, s[52:55], s14 offen offset:2048 lds
    buffer_load_dwordx4 v7, s[52:55], s14 offen offset:3072 lds
    s_add_u32 m0, s73, 81920
    s_lshl_b32 s14, s87, 18
    buffer_load_dwordx4 v4, s[52:55], s14 offen offset:0 lds
    buffer_load_dwordx4 v5, s[52:55], s14 offen offset:1024 lds
    buffer_load_dwordx4 v6, s[52:55], s14 offen offset:2048 lds
    buffer_load_dwordx4 v7, s[52:55], s14 offen offset:3072 lds
    s_add_u32 m0, s73, 98304
    s_lshl_b32 s14, s88, 18
    buffer_load_dwordx4 v4, s[52:55], s14 offen offset:0 lds
    buffer_load_dwordx4 v5, s[52:55], s14 offen offset:1024 lds
    buffer_load_dwordx4 v6, s[52:55], s14 offen offset:2048 lds
    buffer_load_dwordx4 v7, s[52:55], s14 offen offset:3072 lds
    s_add_u32 m0, s73, 114688
    s_lshl_b32 s14, s89, 18
    buffer_load_dwordx4 v4, s[52:55], s14 offen offset:0 lds
    buffer_load_dwordx4 v5, s[52:55], s14 offen offset:1024 lds
    buffer_load_dwordx4 v6, s[52:55], s14 offen offset:2048 lds
    buffer_load_dwordx4 v7, s[52:55], s14 offen offset:3072 lds
    s_add_u32 m0, s73, 131072
    s_lshl_b32 s14, s90, 18
    buffer_load_dwordx4 v4, s[52:55], s14 offen offset:0 lds
    buffer_load_dwordx4 v5, s[52:55], s14 offen offset:1024 lds
    buffer_load_dwordx4 v6, s[52:55], s14 offen offset:2048 lds
    buffer_load_dwordx4 v7, s[52:55], s14 offen offset:3072 lds
    s_add_u32 m0, s73, 147456
    s_lshl_b32 s14, s91, 18
    buffer_load_dwordx4 v4, s[52:55], s14 offen offset:0 lds
    buffer_load_dwordx4 v5, s[52:55], s14 offen offset:1024 lds
    buffer_load_dwordx4 v6, s[52:55], s14 offen offset:2048 lds
    buffer_load_dwordx4 v7, s[52:55], s14 offen offset:3072 lds
    s_waitcnt vmcnt(28)
    s_barrier
    ds_read_b64_tr_b16 a[0:1], v10 offset:32768
    ds_read_b64_tr_b16 a[2:3], v10 offset:34816
    ds_read_b64_tr_b16 a[8:9], v10 offset:36864
    ds_read_b64_tr_b16 a[10:11], v10 offset:38912
    ds_read_b64_tr_b16 a[4:5], v11 offset:32768
    ds_read_b64_tr_b16 a[6:7], v11 offset:34816
    ds_read_b64_tr_b16 a[12:13], v11 offset:36864
    ds_read_b64_tr_b16 a[14:15], v11 offset:38912
    s_waitcnt vmcnt(24) lgkmcnt(0)
    s_barrier
    ds_read_b64_tr_b16 a[16:17], v10 offset:49152
    s_add_u32 m0, s73, 32768
    s_lshl_b32 s14, s92, 18
    ds_read_b64_tr_b16 a[18:19], v10 offset:51200
    buffer_load_dwordx4 v4, s[52:55], s14 offen offset:0 lds
    ds_read_b64_tr_b16 a[24:25], v10 offset:53248
    ds_read_b64_tr_b16 a[26:27], v10 offset:55296
    buffer_load_dwordx4 v5, s[52:55], s14 offen offset:1024 lds
    ds_read_b64_tr_b16 a[20:21], v11 offset:49152
    buffer_load_dwordx4 v6, s[52:55], s14 offen offset:2048 lds
    ds_read_b64_tr_b16 a[22:23], v11 offset:51200
    ds_read_b64_tr_b16 a[28:29], v11 offset:53248
    buffer_load_dwordx4 v7, s[52:55], s14 offen offset:3072 lds
    ds_read_b64_tr_b16 a[30:31], v11 offset:55296
    s_waitcnt vmcnt(24) lgkmcnt(0)
    s_barrier
    v_add_u32 v10, 65536, v10
    ds_read_b64_tr_b16 a[32:33], v10 offset:0
    s_add_u32 m0, s73, 49152
    s_lshl_b32 s14, s93, 18
    ds_read_b64_tr_b16 a[34:35], v10 offset:2048
    buffer_load_dwordx4 v4, s[52:55], s14 offen offset:0 lds
    ds_read_b64_tr_b16 a[40:41], v10 offset:4096
    ds_read_b64_tr_b16 a[42:43], v10 offset:6144
    buffer_load_dwordx4 v5, s[52:55], s14 offen offset:1024 lds
    v_add_u32 v11, 65536, v11
    ds_read_b64_tr_b16 a[36:37], v11 offset:0
    buffer_load_dwordx4 v6, s[52:55], s14 offen offset:2048 lds
    ds_read_b64_tr_b16 a[38:39], v11 offset:2048
    ds_read_b64_tr_b16 a[44:45], v11 offset:4096
    buffer_load_dwordx4 v7, s[52:55], s14 offen offset:3072 lds
    ds_read_b64_tr_b16 a[46:47], v11 offset:6144
    s_waitcnt vmcnt(24) lgkmcnt(0)
    s_barrier
    ds_read_b64_tr_b16 a[48:49], v10 offset:16384
    s_add_u32 m0, s73, 65536
    s_lshl_b32 s14, s94, 18
    ds_read_b64_tr_b16 a[50:51], v10 offset:18432
    buffer_load_dwordx4 v4, s[52:55], s14 offen offset:0 lds
    ds_read_b64_tr_b16 a[56:57], v10 offset:20480
    ds_read_b64_tr_b16 a[58:59], v10 offset:22528
    buffer_load_dwordx4 v5, s[52:55], s14 offen offset:1024 lds
    ds_read_b64_tr_b16 a[52:53], v11 offset:16384
    buffer_load_dwordx4 v6, s[52:55], s14 offen offset:2048 lds
    ds_read_b64_tr_b16 a[54:55], v11 offset:18432
    ds_read_b64_tr_b16 a[60:61], v11 offset:20480
    buffer_load_dwordx4 v7, s[52:55], s14 offen offset:3072 lds
    ds_read_b64_tr_b16 a[62:63], v11 offset:22528
    s_waitcnt vmcnt(24) lgkmcnt(0)
    s_barrier
    ds_read_b64_tr_b16 a[64:65], v10 offset:32768
    s_add_u32 m0, s73, 81920
    s_lshl_b32 s14, s95, 18
    ds_read_b64_tr_b16 a[66:67], v10 offset:34816
    buffer_load_dwordx4 v4, s[52:55], s14 offen offset:0 lds
    ds_read_b64_tr_b16 a[72:73], v10 offset:36864
    ds_read_b64_tr_b16 a[74:75], v10 offset:38912
    buffer_load_dwordx4 v5, s[52:55], s14 offen offset:1024 lds
    ds_read_b64_tr_b16 a[68:69], v11 offset:32768
    buffer_load_dwordx4 v6, s[52:55], s14 offen offset:2048 lds
    ds_read_b64_tr_b16 a[70:71], v11 offset:34816
    ds_read_b64_tr_b16 a[76:77], v11 offset:36864
    buffer_load_dwordx4 v7, s[52:55], s14 offen offset:3072 lds
    ds_read_b64_tr_b16 a[78:79], v11 offset:38912
    s_waitcnt vmcnt(24) lgkmcnt(0)
    s_barrier
    ds_read_b64_tr_b16 a[80:81], v10 offset:49152
    s_add_u32 m0, s73, 98304
    s_lshl_b32 s14, s96, 18
    ds_read_b64_tr_b16 a[82:83], v10 offset:51200
    buffer_load_dwordx4 v4, s[52:55], s14 offen offset:0 lds
    ds_read_b64_tr_b16 a[88:89], v10 offset:53248
    ds_read_b64_tr_b16 a[90:91], v10 offset:55296
    buffer_load_dwordx4 v5, s[52:55], s14 offen offset:1024 lds
    ds_read_b64_tr_b16 a[84:85], v11 offset:49152
    buffer_load_dwordx4 v6, s[52:55], s14 offen offset:2048 lds
    ds_read_b64_tr_b16 a[86:87], v11 offset:51200
    ds_read_b64_tr_b16 a[92:93], v11 offset:53248
    buffer_load_dwordx4 v7, s[52:55], s14 offen offset:3072 lds
    ds_read_b64_tr_b16 a[94:95], v11 offset:55296
    s_waitcnt vmcnt(24) lgkmcnt(0)
    s_barrier
    v_add_u32 v10, 65536, v10
    ds_read_b64_tr_b16 a[96:97], v10 offset:0
    s_add_u32 m0, s73, 114688
    s_lshl_b32 s14, s97, 18
    ds_read_b64_tr_b16 a[98:99], v10 offset:2048
    buffer_load_dwordx4 v4, s[52:55], s14 offen offset:0 lds
    ds_read_b64_tr_b16 a[104:105], v10 offset:4096
    ds_read_b64_tr_b16 a[106:107], v10 offset:6144
    buffer_load_dwordx4 v5, s[52:55], s14 offen offset:1024 lds
    v_add_u32 v11, 65536, v11
    ds_read_b64_tr_b16 a[100:101], v11 offset:0
    buffer_load_dwordx4 v6, s[52:55], s14 offen offset:2048 lds
    ds_read_b64_tr_b16 a[102:103], v11 offset:2048
    ds_read_b64_tr_b16 a[108:109], v11 offset:4096
    buffer_load_dwordx4 v7, s[52:55], s14 offen offset:3072 lds
    ds_read_b64_tr_b16 a[110:111], v11 offset:6144
    s_waitcnt vmcnt(24) lgkmcnt(0)
    s_barrier
    ds_read_b64_tr_b16 a[112:113], v10 offset:16384
    s_add_u32 m0, s73, 131072
    s_lshl_b32 s14, s98, 18
    ds_read_b64_tr_b16 a[114:115], v10 offset:18432
    buffer_load_dwordx4 v4, s[52:55], s14 offen offset:0 lds
    ds_read_b64_tr_b16 a[120:121], v10 offset:20480
    ds_read_b64_tr_b16 a[122:123], v10 offset:22528
    buffer_load_dwordx4 v5, s[52:55], s14 offen offset:1024 lds
    ds_read_b64_tr_b16 a[116:117], v11 offset:16384
    buffer_load_dwordx4 v6, s[52:55], s14 offen offset:2048 lds
    ds_read_b64_tr_b16 a[118:119], v11 offset:18432
    ds_read_b64_tr_b16 a[124:125], v11 offset:20480
    buffer_load_dwordx4 v7, s[52:55], s14 offen offset:3072 lds
    ds_read_b64_tr_b16 a[126:127], v11 offset:22528
    s_waitcnt vmcnt(24) lgkmcnt(0)
    s_barrier
    v_add_u32 v10, -131072, v10
    ds_read_b64_tr_b16 a[128:129], v10 offset:32768
    s_add_u32 m0, s73, 147456
    s_lshl_b32 s14, s99, 18
    ds_read_b64_tr_b16 a[130:131], v10 offset:34816
    buffer_load_dwordx4 v4, s[52:55], s14 offen offset:0 lds
    ds_read_b64_tr_b16 a[136:137], v10 offset:36864
    ds_read_b64_tr_b16 a[138:139], v10 offset:38912
    buffer_load_dwordx4 v5, s[52:55], s14 offen offset:1024 lds
    v_add_u32 v11, -131072, v11
    ds_read_b64_tr_b16 a[132:133], v11 offset:32768
    buffer_load_dwordx4 v6, s[52:55], s14 offen offset:2048 lds
    ds_read_b64_tr_b16 a[134:135], v11 offset:34816
    ds_read_b64_tr_b16 a[140:141], v11 offset:36864
    buffer_load_dwordx4 v7, s[52:55], s14 offen offset:3072 lds
    ds_read_b64_tr_b16 a[142:143], v11 offset:38912
    s_waitcnt vmcnt(24) lgkmcnt(0)
    s_barrier
    ds_read_b64_tr_b16 a[144:145], v10 offset:49152
    s_add_u32 m0, s73, 0
    s_lshl_b32 s14, s100, 18
    ds_read_b64_tr_b16 a[146:147], v10 offset:51200
    buffer_load_dwordx4 v4, s[52:55], s14 offen offset:0 lds
    ds_read_b64_tr_b16 a[152:153], v10 offset:53248
    ds_read_b64_tr_b16 a[154:155], v10 offset:55296
    buffer_load_dwordx4 v5, s[52:55], s14 offen offset:1024 lds
    ds_read_b64_tr_b16 a[148:149], v11 offset:49152
    buffer_load_dwordx4 v6, s[52:55], s14 offen offset:2048 lds
    ds_read_b64_tr_b16 a[150:151], v11 offset:51200
    ds_read_b64_tr_b16 a[156:157], v11 offset:53248
    buffer_load_dwordx4 v7, s[52:55], s14 offen offset:3072 lds
    ds_read_b64_tr_b16 a[158:159], v11 offset:55296
    s_waitcnt vmcnt(24) lgkmcnt(0)
    s_barrier
    v_add_u32 v10, 65536, v10
    ds_read_b64_tr_b16 a[160:161], v10 offset:0
    s_add_u32 m0, s73, 16384
    s_lshl_b32 s14, s101, 18
    ds_read_b64_tr_b16 a[162:163], v10 offset:2048
    buffer_load_dwordx4 v4, s[52:55], s14 offen offset:0 lds
    ds_read_b64_tr_b16 a[168:169], v10 offset:4096
    ds_read_b64_tr_b16 a[170:171], v10 offset:6144
    buffer_load_dwordx4 v5, s[52:55], s14 offen offset:1024 lds
    v_add_u32 v11, 65536, v11
    ds_read_b64_tr_b16 a[164:165], v11 offset:0
    buffer_load_dwordx4 v6, s[52:55], s14 offen offset:2048 lds
    ds_read_b64_tr_b16 a[166:167], v11 offset:2048
    ds_read_b64_tr_b16 a[172:173], v11 offset:4096
    buffer_load_dwordx4 v7, s[52:55], s14 offen offset:3072 lds
    ds_read_b64_tr_b16 a[174:175], v11 offset:6144
    s_waitcnt vmcnt(24) lgkmcnt(0)
    s_barrier
    ds_read_b64_tr_b16 a[176:177], v10 offset:16384
    ds_read_b64_tr_b16 a[178:179], v10 offset:18432
    ds_read_b64_tr_b16 a[184:185], v10 offset:20480
    ds_read_b64_tr_b16 a[186:187], v10 offset:22528
    ds_read_b64_tr_b16 a[180:181], v11 offset:16384
    ds_read_b64_tr_b16 a[182:183], v11 offset:18432
    ds_read_b64_tr_b16 a[188:189], v11 offset:20480
    ds_read_b64_tr_b16 a[190:191], v11 offset:22528
    s_waitcnt vmcnt(20) lgkmcnt(0)
    s_barrier
    ds_read_b64_tr_b16 a[192:193], v10 offset:32768
    ds_read_b64_tr_b16 a[194:195], v10 offset:34816
    ds_read_b64_tr_b16 a[200:201], v10 offset:36864
    ds_read_b64_tr_b16 a[202:203], v10 offset:38912
    ds_read_b64_tr_b16 a[196:197], v11 offset:32768
    ds_read_b64_tr_b16 a[198:199], v11 offset:34816
    ds_read_b64_tr_b16 a[204:205], v11 offset:36864
    ds_read_b64_tr_b16 a[206:207], v11 offset:38912
    s_waitcnt vmcnt(16) lgkmcnt(0)
    s_barrier
    ds_read_b64_tr_b16 a[208:209], v10 offset:49152
    ds_read_b64_tr_b16 a[210:211], v10 offset:51200
    ds_read_b64_tr_b16 a[216:217], v10 offset:53248
    ds_read_b64_tr_b16 a[218:219], v10 offset:55296
    ds_read_b64_tr_b16 a[212:213], v11 offset:49152
    ds_read_b64_tr_b16 a[214:215], v11 offset:51200
    ds_read_b64_tr_b16 a[220:221], v11 offset:53248
    ds_read_b64_tr_b16 a[222:223], v11 offset:55296
    s_waitcnt vmcnt(12) lgkmcnt(0)
    s_barrier
    v_add_u32 v10, 65536, v10
    ds_read_b64_tr_b16 a[224:225], v10 offset:0
    ds_read_b64_tr_b16 a[226:227], v10 offset:2048
    ds_read_b64_tr_b16 a[232:233], v10 offset:4096
    ds_read_b64_tr_b16 a[234:235], v10 offset:6144
    v_add_u32 v11, 65536, v11
    ds_read_b64_tr_b16 a[228:229], v11 offset:0
    ds_read_b64_tr_b16 a[230:231], v11 offset:2048
    ds_read_b64_tr_b16 a[236:237], v11 offset:4096
    ds_read_b64_tr_b16 a[238:239], v11 offset:6144
    s_waitcnt vmcnt(8) lgkmcnt(0)
    s_barrier
    ds_read_b64_tr_b16 a[240:241], v10 offset:16384
    ds_read_b64_tr_b16 a[242:243], v10 offset:18432
    ds_read_b64_tr_b16 a[248:249], v10 offset:20480
    ds_read_b64_tr_b16 a[250:251], v10 offset:22528
    ds_read_b64_tr_b16 a[244:245], v11 offset:16384
    ds_read_b64_tr_b16 a[246:247], v11 offset:18432
    ds_read_b64_tr_b16 a[252:253], v11 offset:20480
    ds_read_b64_tr_b16 a[254:255], v11 offset:22528
    s_waitcnt lgkmcnt(0)
    s_barrier
    v_add_u32 v10, -131072, v10
    v_add_u32 v11, -131072, v11
    s_mov_b64 exec, 0
    s_call_b64 s[82:83], L_wc_D
    s_mov_b64 exec, -1
    s_bfe_u32 s4, s2, 0x20003
    s_lshl2_add_u32 s4, s72, s4
    s_lshl_b32 s4, s4, 3
    s_lshr_b32 s5, s2, 4
    s_and_b32 s5, s5, 6
    s_add_u32 s4, s4, s5
    s_and_b32 s5, s2, 1
    s_add_u32 s4, s4, s5
    s_lshl_b32 s4, s4, 7
    s_add_u32 s4, s4, 12566528
    v_lshl_add_u32 v28, v2, 2, s4
    s_cmp_eq_u32 s3, 0
    s_cselect_b32 s4, 18, 0
    v_cmp_gt_u32 vcc, s4, v2
    v_mov_b32 v13, 0x40000000
    s_nop 0
    v_cndmask_b32 v28, v13, v28, vcc
    v_mov_b32 v13, s68
    v_cndmask_b32 v13, 0, v13, vcc
    s_mov_b32 s5, 0
L_iw:
    s_sleep 16
    v_mov_b32 v29, 0
    buffer_atomic_add v29, v28, s[44:47], 0 offen sc0 sc1
    s_waitcnt vmcnt(0)
    v_cmp_eq_u32 vcc, 0, v13
    s_nop 1
    s_mov_b64 s[6:7], vcc
    v_cmp_ne_u32 vcc, v13, v29
    s_nop 1
    s_andn2_b64 s[8:9], exec, vcc
    s_andn2_b64 s[8:9], s[8:9], s[6:7]
    s_cbranch_scc1 L_ix
    s_cmp_eq_u64 s[6:7], exec
    s_cbranch_scc1 L_ix
    s_add_u32 s5, s5, 1
    s_cmp_lt_u32 s5, 100000
    s_cbranch_scc1 L_iw
L_ix:
    v_mov_b32 v29, 0
    buffer_atomic_add v29, v28, s[44:47], 0 offen sc0 sc1
    s_branch L_DX
L_end:
.section .rodata,"a"
.p2align 6
.amdhsa_kernel recurrent_scan__ssm_conv_h3__mixer_token_mlp__prompt_kernel
  .amdhsa_next_free_vgpr 512
  .amdhsa_next_free_sgpr 102
  .amdhsa_accum_offset 256
  .amdhsa_group_segment_fixed_size 0
  .amdhsa_kernarg_size 112
  .amdhsa_user_sgpr_count 2
  .amdhsa_user_sgpr_kernarg_segment_ptr 1
  .amdhsa_system_sgpr_workgroup_id_x 1
  .amdhsa_float_denorm_mode_32 3
.end_amdhsa_kernel
```

```asm
; @launch grid=(256,1,1) block=(256,1,1) lds=163840
.amdgcn_target "amdgcn-amd-amdhsa--gfx950"
.text
.globl recurrent_scan__ssm_conv_h3__mixer_token_mlp__prompt_kernel
.p2align 8
.type recurrent_scan__ssm_conv_h3__mixer_token_mlp__prompt_kernel,@function
recurrent_scan__ssm_conv_h3__mixer_token_mlp__prompt_kernel:
    s_cmp_lt_u32 s2, 256
    s_cbranch_scc0 L_exit
    s_load_dwordx2 s[56:57], s[0:1], 0
    s_load_dwordx2 s[48:49], s[0:1], 8
    s_load_dwordx2 s[52:53], s[0:1], 16
    s_load_dwordx2 s[60:61], s[0:1], 24
    s_load_dwordx16 s[16:31], s[0:1], 0
    s_load_dwordx8 s[32:39], s[0:1], 64
    s_load_dwordx4 s[40:43], s[0:1], 96
    s_memrealtime s[12:13]
    v_lshrrev_b32 v1, 6, v0
    v_and_b32 v2, 63, v0
    s_getpc_b64 s[6:7]
L_pc:
    s_lshr_b32 s4, s2, 1
    s_and_b32 s4, s4, 124
    v_add_u32 v22, s4, v1
    v_lshl_add_u32 v22, v2, 7, v22
    v_lshlrev_b32 v22, 7, v22
    v_min_u32 v22, L_end-L_pc-4, v22
    s_mov_b64 exec, 31
    global_load_dword v255, v22, s[6:7]
    s_mov_b64 exec, -1
    v_readfirstlane_b32 s3, v1
    s_and_b32 s4, s2, 7
    s_lshr_b32 s5, s2, 3
    s_lshl_b32 s4, s4, 5
    s_add_u32 s68, s4, s5
    v_lshrrev_b32 v3, 5, v0
    v_and_b32 v4, 31, v0
    v_mul_u32_u24 v5, 1152, v3
    v_mad_u32_u24 v5, v4, 12, v5
    s_mul_i32 s15, s68, 9216
    s_mul_i32 s4, s3, 3072
    s_add_u32 s5, s4, s15
    s_sub_u32 s5, s5, 3456
    v_lshlrev_b32 v6, 4, v2
    v_add_u32 v7, s5, v6
    v_add_u32 v58, 1024, v7
    s_add_u32 s4, s4, 114688
    s_lshl_b32 s5, s3, 11
    s_add_u32 s11, s5, s15
    s_add_u32 s5, s5, 127360
    s_cmp_lt_u32 s2, 216
    s_cselect_b32 s9, 0, 106496
    s_sub_u32 s4, s4, s9
    s_sub_u32 s5, s5, s9
    s_mov_b32 m0, s4
    s_mov_b32 s58, 2359296
    s_mov_b32 s59, 0x20000
    s_mov_b32 s50, 2359296
    s_mov_b32 s51, 0x20000
    s_mov_b32 s54, 2359296
    s_mov_b32 s55, 0x20000
    s_mov_b32 s62, 4608
    s_mov_b32 s63, 0x20000
    v_lshlrev_b32 v59, 3, v0
    s_movk_i32 s10, 4096
    v_lshlrev_b32 v91, 3, v2
    v_or_b32 v22, s2, v0
    v_lshlrev_b32 v22, 8, v22
    s_mov_b32 s66, 256
    s_mov_b32 s67, 0x20000
    s_waitcnt lgkmcnt(0)
    buffer_load_dwordx3 v[8:10], v5, s[56:59], s15 offen offset:0
    buffer_load_dwordx3 v[12:14], v5, s[56:59], s15 offen offset:384
    buffer_load_dwordx3 v[16:18], v5, s[56:59], s15 offen offset:768
    s_mov_b32 s64, s40
    s_and_b32 s65, s41, 0xffff
    s_or_b32 s12, s12, 1
    v_mov_b32 v23, s12
    buffer_store_dword v23, v22, s[64:67], 0 offen sc1
    buffer_load_dwordx4 v7, s[48:51], 0 offen lds
    s_add_u32 m0, s4, 1024
    s_cmp_eq_u32 s3, 3
    buffer_load_dwordx4 v58, s[48:51], 0 offen lds
    buffer_load_dwordx4 v58, s[48:51], 0 offen offset:1024 lds
    s_cbranch_scc1 L_xld
L_nox:
    s_mov_b32 m0, s5
    buffer_load_dwordx2 v[98:99], v59, s[60:63], 0 offen
    buffer_load_dwordx4 v6, s[52:55], s11 offen lds
    buffer_load_dwordx4 v6, s[52:55], s11 offen offset:1024 lds
    buffer_load_dwordx2 v[100:101], v59, s[60:63], 0 offen offset:2048
    buffer_load_dwordx2 v[102:103], v59, s[60:63], s10 offen
    s_mov_b32 s44, s42
    s_and_b32 s45, s43, 0xffff
    s_mov_b32 s46, 42352640
    s_mov_b32 s47, 0x20000
    s_and_b32 s5, s2, 7
    s_lshr_b32 s6, s2, 3
    s_lshr_b32 s7, s6, 2
    s_lshr_b32 s8, s3, 1
    s_lshl1_add_u32 s9, s7, s8
    s_cmp_ge_u32 s9, 10
    s_addc_u32 s14, s9, 0
    s_cmp_ge_u32 s9, 3
    s_addc_u32 s14, s14, 0
    s_lshl3_add_u32 s8, s8, 3
    s_cmp_eq_u32 s7, 7
    s_cselect_b32 s14, s8, s14
    s_and_b32 s4, s5, 1
    s_lshl4_add_u32 s71, s4, s14
    s_lshr_b32 s13, s5, 1
    s_mov_b32 s72, s13
    s_lshl_b32 s73, s3, 12
    s_mov_b32 s52, s34
    s_and_b32 s53, s35, 0xffff
    s_mov_b32 s54, 18874368
    s_mov_b32 s55, 0x20000
    s_cmp_lt_u32 s6, 27
    s_cbranch_scc0 L_aux
    s_branch L_org
L_exit:
    s_endpgm
L_xld:
    s_mov_b64 exec, 0xffffff
    buffer_load_dwordx4 v58, s[48:51], 0 offen offset:2048 lds
    s_mov_b64 exec, -1
    s_mov_b32 m0, s5
    s_nop 0
    buffer_load_dwordx4 v6, s[52:55], s11 offen offset:2048 lds
    s_branch L_nox
L_nw_G:
    s_mov_b32 s5, 0
L_nl_G:
    buffer_load_dword v45, v54, s[64:67], 0 offen sc1
    s_waitcnt vmcnt(0)
    v_readfirstlane_b32 s68, v45
    s_nop 1
    s_cmp_lg_u32 s68, 0
    s_cbranch_scc1 L_ng_G
    s_add_u32 s5, s5, 1
    s_cmp_lt_u32 s5, 100000
    s_cbranch_scc1 L_nl_G
    s_branch L_ng_G
L_rs_p1G:
    s_mov_b32 s5, 0
L_rt_p1G:
    s_mov_b64 exec, vcc
    v_mov_b32 v29, 0
    buffer_atomic_add v29, v28, s[44:47], 0 offen sc0 sc1
    s_waitcnt vmcnt(0)
    v_cmp_ne_u32 vcc, v12, v29
    s_cbranch_vccz L_rx_p1G
    s_add_u32 s5, s5, 1
    s_cmp_lt_u32 s5, 100000
    s_cbranch_scc1 L_rt_p1G
L_rx_p1G:
    s_mov_b64 exec, -1
    s_branch L_ok_p1G
L_rs_p5:
    s_mov_b32 s5, 0
L_rt_p5:
    s_mov_b64 exec, vcc
    buffer_load_dword v29, v28, s[44:47], 0 offen sc1
    s_waitcnt vmcnt(0)
    v_cmp_ne_u32 vcc, s68, v29
    s_cbranch_vccz L_rx_p5
    s_add_u32 s5, s5, 1
    s_cmp_lt_u32 s5, 100000
    s_cbranch_scc1 L_rt_p5
L_rx_p5:
    s_mov_b64 exec, -1
    s_branch L_ok_p5
L_nw_X:
    s_mov_b32 s5, 0
L_nl_X:
    buffer_load_dword v45, v54, s[64:67], 0 offen sc1
    s_waitcnt vmcnt(0)
    v_readfirstlane_b32 s68, v45
    s_nop 1
    s_cmp_lg_u32 s68, 0
    s_cbranch_scc1 L_ng_X
    s_add_u32 s5, s5, 1
    s_cmp_lt_u32 s5, 100000
    s_cbranch_scc1 L_nl_X
    s_branch L_ng_X
L_rs_p1X:
    s_mov_b32 s5, 0
L_rt_p1X:
    s_mov_b64 exec, vcc
    v_mov_b32 v29, 0
    buffer_atomic_add v29, v28, s[44:47], 0 offen sc0 sc1
    s_waitcnt vmcnt(0)
    v_cmp_ne_u32 vcc, s68, v29
    s_cbranch_vccz L_rx_p1X
    s_add_u32 s5, s5, 1
    s_cmp_lt_u32 s5, 100000
    s_cbranch_scc1 L_rt_p1X
L_rx_p1X:
    s_mov_b64 exec, -1
    s_branch L_ok_p1X
L_rs_p2G:
    s_mov_b32 s5, 0
L_rt_p2G:
    s_mov_b64 exec, vcc
    v_mov_b32 v16, 0
    buffer_atomic_add v16, v15, s[44:47], 0 offen sc0 sc1
    s_waitcnt vmcnt(0)
    v_cmp_ne_u32 vcc, v13, v16
    s_cbranch_vccz L_rx_p2G
    s_add_u32 s5, s5, 1
    s_cmp_lt_u32 s5, 100000
    s_cbranch_scc1 L_rt_p2G
L_rx_p2G:
    s_mov_b64 exec, -1
    s_branch L_ok_p2G
L_xs_a:
    s_mov_b32 s5, 0
L_xt_a:
    v_mov_b32 v187, 0
    buffer_atomic_add v187, v137, s[44:47], 0 offen offset:12 sc0 sc1
    s_waitcnt vmcnt(0)
    v_cmp_ne_u32 vcc, v138, v187
    s_cbranch_vccz L_xr_a
    s_add_u32 s5, s5, 1
    s_cmp_lt_u32 s5, 100000
    s_cbranch_scc1 L_xt_a
L_xr_a:
    buffer_load_dwordx4 v[40:43], v136, s[44:47], s34 offen offset:0 sc1
    buffer_load_dwordx4 v[44:47], v136, s[44:47], s34 offen offset:1024 sc1
    buffer_load_dwordx4 v[48:51], v136, s[44:47], s34 offen offset:2048 sc1
    s_waitcnt vmcnt(0)
    v_bitop3_b32 v43, v43, v47, s68 bitop3:0x7e
    v_bitop3_b32 v43, v43, v51, s68 bitop3:0xf6
    v_cmp_ne_u32 vcc, 0, v43
    s_cbranch_vccz L_xo_a
    s_add_u32 s5, s5, 1
    s_cmp_lt_u32 s5, 100000
    s_cbranch_scc1 L_xt_a
    s_branch L_xo_a
L_as_b:
    s_mov_b32 s5, 0
L_at_b:
    v_mov_b32 v141, 0
    buffer_atomic_add v141, v139, s[44:47], s11 offen offset:2060 sc0 sc1
    s_waitcnt vmcnt(0)
    v_cmp_ne_u32 vcc, v140, v141
    s_cbranch_vccz L_ao_b
    s_add_u32 s5, s5, 1
    s_cmp_lt_u32 s5, 100000
    s_cbranch_scc1 L_at_b
    s_branch L_ao_b
L_xs_b:
    s_mov_b32 s5, 0
L_xt_b:
    buffer_load_dwordx4 v[56:59], v136, s[44:47], s11 offen offset:0 sc1
    buffer_load_dwordx4 v[60:63], v136, s[44:47], s11 offen offset:1024 sc1
    buffer_load_dwordx4 v[64:67], v136, s[44:47], s11 offen offset:2048 sc1
    s_waitcnt vmcnt(0)
    v_bitop3_b32 v59, v59, v63, s68 bitop3:0x7e
    v_bitop3_b32 v59, v59, v67, s68 bitop3:0xf6
    v_cmp_ne_u32 vcc, 0, v59
    s_cbranch_vccz L_xo_b
    s_add_u32 s5, s5, 1
    s_cmp_lt_u32 s5, 100000
    s_cbranch_scc1 L_xt_b
    s_branch L_xo_b
L_xs_z:
    s_mov_b32 s5, 0
L_xt_z:
    buffer_load_dwordx4 v[72:75], v136, s[44:47], s12 offen offset:0 sc1
    buffer_load_dwordx4 v[76:79], v136, s[44:47], s12 offen offset:1024 sc1
    buffer_load_dwordx4 v[80:83], v136, s[44:47], s12 offen offset:2048 sc1
    s_waitcnt vmcnt(0)
    v_bitop3_b32 v75, v75, v79, s68 bitop3:0x7e
    v_bitop3_b32 v75, v75, v83, s68 bitop3:0xf6
    v_cmp_ne_u32 vcc, 0, v75
    s_cbranch_vccz L_xo_z
    s_add_u32 s5, s5, 1
    s_cmp_lt_u32 s5, 100000
    s_cbranch_scc1 L_xt_z
    s_branch L_xo_z
L_rs_p3:
    s_mov_b32 s5, 0
L_rt_p3:
    s_mov_b64 exec, vcc
    buffer_load_dword v189, v188, s[44:47], 0 offen sc1
    s_waitcnt vmcnt(0)
    v_cmp_ne_u32 vcc, s68, v189
    s_cbranch_vccz L_rx_p3
    s_add_u32 s5, s5, 1
    s_cmp_lt_u32 s5, 100000
    s_cbranch_scc1 L_rt_p3
L_rx_p3:
    s_mov_b64 exec, -1
    s_branch L_ok_p3
L_xs_8:
    s_mov_b32 s5, 0
L_xt_8:
    v_mov_b32 v187, 0
    buffer_atomic_add v187, v137, s[44:47], 0 offen offset:12 sc0 sc1
    s_waitcnt vmcnt(0)
    v_cmp_ne_u32 vcc, v138, v187
    s_cbranch_vccz L_xr_8
    s_add_u32 s5, s5, 1
    s_cmp_lt_u32 s5, 100000
    s_cbranch_scc1 L_xt_8
L_xr_8:
    buffer_load_dwordx4 v[204:207], v136, s[44:47], s35 offen offset:0 sc1
    buffer_load_dwordx4 v[208:211], v136, s[44:47], s35 offen offset:1024 sc1
    buffer_load_dwordx4 v[212:215], v136, s[44:47], s35 offen offset:2048 sc1
    buffer_load_dwordx4 v[216:219], v136, s[44:47], s35 offen offset:3072 sc1
    s_waitcnt vmcnt(0)
    v_bitop3_b32 v207, v207, v211, s36 bitop3:0x7e
    v_bitop3_b32 v207, v207, v215, s36 bitop3:0xf6
    v_bitop3_b32 v207, v207, v219, s36 bitop3:0xf6
    v_cmp_ne_u32 vcc, 0, v207
    s_cbranch_vccz L_xo_8
    s_add_u32 s5, s5, 1
    s_cmp_lt_u32 s5, 100000
    s_cbranch_scc1 L_xt_8
    s_branch L_xo_8
L_rs_p2X:
    s_mov_b32 s5, 0
L_rt_p2X:
    s_mov_b64 exec, vcc
    v_mov_b32 v29, 0
    buffer_atomic_add v29, v28, s[44:47], 0 offen sc0 sc1
    s_waitcnt vmcnt(0)
    v_cmp_ne_u32 vcc, v13, v29
    s_cbranch_vccz L_rx_p2X
    s_add_u32 s5, s5, 1
    s_cmp_lt_u32 s5, 100000
    s_cbranch_scc1 L_rt_p2X
L_rx_p2X:
    s_mov_b64 exec, -1
    s_branch L_ok_p2X
L_wc_G:
    s_cmp_eq_u32 s3, 0
    s_cbranch_scc1 L_pl_G_0
    s_cmp_eq_u32 s3, 1
    s_cbranch_scc1 L_pl_G_1
    s_cmp_eq_u32 s3, 2
    s_cbranch_scc1 L_pl_G_2
    s_branch L_pl_G_3
L_wc_X:
    s_cmp_eq_u32 s3, 0
    s_cbranch_scc1 L_pl_X_0
    s_cmp_eq_u32 s3, 1
    s_cbranch_scc1 L_pl_X_1
    s_cmp_eq_u32 s3, 2
    s_cbranch_scc1 L_pl_X_2
    s_branch L_pl_X_3
L_wc_D:
    s_cmp_eq_u32 s3, 0
    s_cbranch_scc1 L_pl_D_0
    s_cmp_eq_u32 s3, 1
    s_cbranch_scc1 L_pl_D_1
    s_cmp_eq_u32 s3, 2
    s_cbranch_scc1 L_pl_D_2
    s_branch L_wret
L_wret:
    s_setpc_b64 s[82:83]
.p2align 12
L_org:
    s_mul_i32 s7, s6, 21846
    s_lshr_b32 s7, s7, 16
    s_mul_i32 s8, s7, 3
    s_sub_u32 s12, s6, s8
    s_mul_i32 s8, s13, 9
    s_add_u32 s69, s8, s7
    s_lshl1_add_u32 s70, s12, s4
    s_mul_i32 s8, s69, 6
    s_add_u32 s75, s8, s70
    s_mov_b32 s48, s30
    s_and_b32 s49, s31, 0xffff
    s_mov_b32 s50, 18874368
    s_mov_b32 s51, 0x20000
    s_add_u32 s12, s12, s7
    s_mul_i32 s8, s12, 21846
    s_lshr_b32 s8, s8, 16
    s_mul_i32 s8, s8, 3
    s_sub_u32 s12, s12, s8
    s_mul_i32 s4, s4, 16
    s_mul_i32 s7, s12, 65538
    s_lshr_b32 s7, s7, 16
    s_mul_i32 s7, s7, 1
    s_add_u32 s5, s4, 0
    s_add_u32 s18, s7, s5
    s_add_u32 s8, s5, 3
    s_add_u32 s19, s18, 1
    s_cmp_eq_u32 s19, s8
    s_cselect_b32 s19, s5, s19
    s_add_u32 s20, s19, 1
    s_cmp_eq_u32 s20, s8
    s_cselect_b32 s20, s5, s20
    s_mul_i32 s7, s12, 65538
    s_lshr_b32 s7, s7, 16
    s_mul_i32 s7, s7, 1
    s_add_u32 s5, s4, 3
    s_add_u32 s21, s7, s5
    s_add_u32 s8, s5, 3
    s_add_u32 s22, s21, 1
    s_cmp_eq_u32 s22, s8
    s_cselect_b32 s22, s5, s22
    s_add_u32 s23, s22, 1
    s_cmp_eq_u32 s23, s8
    s_cselect_b32 s23, s5, s23
    s_mul_i32 s7, s12, 87384
    s_lshr_b32 s7, s7, 16
    s_mul_i32 s7, s7, 1
    s_add_u32 s5, s4, 6
    s_add_u32 s24, s7, s5
    s_add_u32 s8, s5, 4
    s_add_u32 s25, s24, 1
    s_cmp_eq_u32 s25, s8
    s_cselect_b32 s25, s5, s25
    s_add_u32 s26, s25, 1
    s_cmp_eq_u32 s26, s8
    s_cselect_b32 s26, s5, s26
    s_add_u32 s27, s26, 1
    s_cmp_eq_u32 s27, s8
    s_cselect_b32 s27, s5, s27
    s_mul_i32 s7, s12, 131076
    s_lshr_b32 s7, s7, 16
    s_mul_i32 s7, s7, 1
    s_add_u32 s5, s4, 10
    s_add_u32 s76, s7, s5
    s_add_u32 s8, s5, 6
    s_add_u32 s77, s76, 1
    s_cmp_eq_u32 s77, s8
    s_cselect_b32 s77, s5, s77
    s_add_u32 s78, s77, 1
    s_cmp_eq_u32 s78, s8
    s_cselect_b32 s78, s5, s78
    s_add_u32 s79, s78, 1
    s_cmp_eq_u32 s79, s8
    s_cselect_b32 s79, s5, s79
    s_add_u32 s80, s79, 1
    s_cmp_eq_u32 s80, s8
    s_cselect_b32 s80, s5, s80
    s_add_u32 s81, s80, 1
    s_cmp_eq_u32 s81, s8
    s_cselect_b32 s81, s5, s81
    v_lshrrev_b32 v24, 4, v2
    v_and_b32 v25, 15, v2
    v_lshlrev_b32 v26, 1, v24
    v_xor_b32 v25, v25, v26
    v_mul_u32_u24 v24, 9216, v24
    v_lshl_add_u32 v24, v25, 4, v24
    s_mul_i32 s7, s3, 147456
    s_lshl_b32 s8, s69, 8
    s_add_u32 s7, s7, s8
    v_add_u32 v148, s7, v24
    v_add_u32 v149, 35840, v148
    v_xor_b32 v24, 128, v148
    v_add_u32 v150, 71680, v24
    v_add_u32 v151, 35840, v150
    s_mov_b32 s9, 144896
    s_mov_b32 s11, 114688
    v_mul_u32_u24 v48, 1216, v3
    v_mad_u32_u24 v48, v4, 12, v48
    v_add_u32 v48, s9, v48
    v_mov_b32 v47, 0x40000000
    v_lshlrev_b32 v3, 3, v3
    s_lshl_b32 s5, s68, 6
    s_add_u32 s5, s5, 12386304
    v_cmp_eq_u32 vcc, 0, v4
    s_nop 1
    v_cndmask_b32 v49, v47, v3, vcc
    v_lshrrev_b32 v5, 4, v0
    v_and_b32 v4, 3, v2
    v_lshlrev_b32 v4, 3, v4
    v_lshl_add_u32 v5, v5, 5, v4
    v_bfe_u32 v6, v2, 2, 2
    v_mul_u32_u24 v4, 1216, v6
    v_mul_u32_u24 v6, 1152, v6
    v_add3_u32 v50, v4, v5, s9
    v_add3_u32 v51, v6, v5, s11
    s_mul_i32 s4, s3, 2176
    v_add_u32 v55, s4, v51
    v_lshlrev_b32 v52, 4, v0
    s_add_u32 s7, s15, 4096
    s_add_u32 s8, s15, 8192
    s_cmp_eq_u32 s3, 0
    s_cselect_b32 s8, s8, 0x40000000
    v_add_u32 v53, 2359296, v52
    v_mov_b32 v54, 0
    v_add_u32 v4, 0, v52
    v_lshrrev_b32 v5, 7, v4
    v_mul_u32_u24 v6, 9363, v5
    v_lshrrev_b32 v6, 16, v6
    v_mad_i32_i24 v5, v6, -7, v5
    v_cmp_lt_u32 vcc, 2, v5
    s_nop 1
    v_addc_co_u32 v6, vcc, 0, v6, vcc
    v_lshl_add_u32 v93, v6, 7, v4
    v_add_u32 v4, 4096, v52
    v_lshrrev_b32 v5, 7, v4
    v_mul_u32_u24 v6, 9363, v5
    v_lshrrev_b32 v6, 16, v6
    v_mad_i32_i24 v5, v6, -7, v5
    v_cmp_lt_u32 vcc, 2, v5
    s_nop 1
    v_addc_co_u32 v6, vcc, 0, v6, vcc
    v_lshl_add_u32 v94, v6, 7, v4
    v_add_u32 v4, 8192, v52
    v_lshrrev_b32 v5, 7, v4
    v_mul_u32_u24 v6, 9363, v5
    v_lshrrev_b32 v6, 16, v6
    v_mad_i32_i24 v5, v6, -7, v5
    v_cmp_lt_u32 vcc, 2, v5
    s_nop 1
    v_addc_co_u32 v6, vcc, 0, v6, vcc
    v_lshl_add_u32 v95, v6, 7, v4
    s_mul_i32 s10, s68, 11264
    s_add_u32 s10, s10, 36585472
    s_cmp_eq_u32 s3, 0
    s_cselect_b32 s83, s10, 0x40000000
    s_add_u32 s7, s10, 2883584
    s_add_u32 s8, s83, 2883584
    s_mul_i32 s4, s3, 1028
    s_sub_u32 s4, 8204, s4
    v_add_u32 v90, s4, v53
    s_bfe_u32 s6, s68, 0x20001
    s_lshl_b32 s6, s6, 6
    s_lshr_b32 s9, s68, 3
    s_lshl1_add_u32 s6, s9, s6
    s_and_b32 s9, s68, 1
    s_add_u32 s6, s6, s9
    s_lshl_b32 s4, s6, 2
    s_add_u32 s4, s4, 12533760
    v_lshl_add_u32 v1, v0, 10, s4
    s_lshl_b32 s4, s68, 2
    s_add_u32 s4, s4, 12599296
    v_lshl_add_u32 v46, v0, 10, s4
    v_cmp_gt_u32 vcc, 8, v0
    s_nop 1
    v_cndmask_b32 v1, v47, v1, vcc
    v_cmp_gt_u32 vcc, 4, v0
    s_nop 1
    v_cndmask_b32 v46, v47, v46, vcc
    s_waitcnt vmcnt(9)
    v_and_b32 v21, 0xffff0000, v8
    s_add_u32 m0, s73, 81920
    s_mul_i32 s14, s18, 589824
    buffer_load_dwordx4 v148, s[48:51], s14 offen offset:0 lds
    v_lshlrev_b32 v20, 16, v8
    v_and_b32 v23, 0xffff0000, v9
    v_lshlrev_b32 v22, 16, v9
    v_and_b32 v25, 0xffff0000, v10
    v_lshlrev_b32 v24, 16, v10
    v_and_b32 v27, 0xffff0000, v12
    v_lshlrev_b32 v26, 16, v12
    v_and_b32 v29, 0xffff0000, v13
    v_lshlrev_b32 v28, 16, v13
    v_and_b32 v31, 0xffff0000, v14
    v_lshlrev_b32 v30, 16, v14
    v_and_b32 v33, 0xffff0000, v16
    v_lshlrev_b32 v32, 16, v16
    v_and_b32 v35, 0xffff0000, v17
    v_lshlrev_b32 v34, 16, v17
    v_and_b32 v37, 0xffff0000, v18
    v_lshlrev_b32 v36, 16, v18
    v_pk_add_f32 v[38:39], v[20:21], v[22:23]
    v_pk_add_f32 v[40:41], v[24:25], v[26:27]
    v_pk_add_f32 v[42:43], v[28:29], v[30:31]
    v_pk_add_f32 v[44:45], v[32:33], v[34:35]
    v_pk_add_f32 v[38:39], v[38:39], v[40:41]
    v_pk_add_f32 v[42:43], v[42:43], v[44:45]
    v_pk_add_f32 v[38:39], v[38:39], v[36:37]
    v_pk_add_f32 v[38:39], v[38:39], v[42:43]
    v_add_f32 v56, v38, v39
    buffer_load_dwordx4 v149, s[48:51], s14 offen offset:1024 lds
    s_nop 0
    v_add_f32_dpp v56, v56, v56 row_ror:8 row_mask:0xf bank_mask:0xf
    s_nop 1
    v_add_f32_dpp v56, v56, v56 row_ror:4 row_mask:0xf bank_mask:0xf
    s_nop 1
    v_add_f32_dpp v56, v56, v56 row_ror:2 row_mask:0xf bank_mask:0xf
    s_nop 1
    v_add_f32_dpp v56, v56, v56 row_ror:1 row_mask:0xf bank_mask:0xf
    v_mov_b32 v57, v56
    s_nop 1
    v_permlane16_swap_b32 v56, v57
    v_add_f32 v56, v56, v57
    v_mul_f32 v56, 0x3ae38e39, v56
    v_pk_add_f32 v[20:21], v[20:21], v[56:57] op_sel_hi:[1,0] neg_lo:[0,1] neg_hi:[0,1]
    v_pk_add_f32 v[22:23], v[22:23], v[56:57] op_sel_hi:[1,0] neg_lo:[0,1] neg_hi:[0,1]
    v_pk_add_f32 v[24:25], v[24:25], v[56:57] op_sel_hi:[1,0] neg_lo:[0,1] neg_hi:[0,1]
    v_pk_add_f32 v[26:27], v[26:27], v[56:57] op_sel_hi:[1,0] neg_lo:[0,1] neg_hi:[0,1]
    v_pk_add_f32 v[28:29], v[28:29], v[56:57] op_sel_hi:[1,0] neg_lo:[0,1] neg_hi:[0,1]
    v_pk_add_f32 v[30:31], v[30:31], v[56:57] op_sel_hi:[1,0] neg_lo:[0,1] neg_hi:[0,1]
    v_pk_add_f32 v[32:33], v[32:33], v[56:57] op_sel_hi:[1,0] neg_lo:[0,1] neg_hi:[0,1]
    v_pk_add_f32 v[34:35], v[34:35], v[56:57] op_sel_hi:[1,0] neg_lo:[0,1] neg_hi:[0,1]
    v_pk_add_f32 v[36:37], v[36:37], v[56:57] op_sel_hi:[1,0] neg_lo:[0,1] neg_hi:[0,1]
    v_pk_mul_f32 v[38:39], v[20:21], v[20:21]
    v_pk_mul_f32 v[40:41], v[22:23], v[22:23]
    v_pk_fma_f32 v[38:39], v[24:25], v[24:25], v[38:39]
    v_pk_fma_f32 v[40:41], v[26:27], v[26:27], v[40:41]
    v_pk_fma_f32 v[38:39], v[28:29], v[28:29], v[38:39]
    v_pk_fma_f32 v[40:41], v[30:31], v[30:31], v[40:41]
    v_pk_fma_f32 v[38:39], v[32:33], v[32:33], v[38:39]
    v_pk_fma_f32 v[40:41], v[34:35], v[34:35], v[40:41]
    v_pk_fma_f32 v[38:39], v[36:37], v[36:37], v[38:39]
    buffer_load_dwordx4 v150, s[48:51], s14 offen offset:2048 lds
    v_pk_add_f32 v[38:39], v[38:39], v[40:41]
    v_add_f32 v18, v38, v39
    s_nop 1
    v_add_f32_dpp v18, v18, v18 row_ror:8 row_mask:0xf bank_mask:0xf
    s_nop 1
    v_add_f32_dpp v18, v18, v18 row_ror:4 row_mask:0xf bank_mask:0xf
    s_nop 1
    v_add_f32_dpp v18, v18, v18 row_ror:2 row_mask:0xf bank_mask:0xf
    s_nop 1
    v_add_f32_dpp v18, v18, v18 row_ror:1 row_mask:0xf bank_mask:0xf
    v_mov_b32 v19, v18
    s_nop 1
    v_permlane16_swap_b32 v18, v19
    v_add_f32 v18, v18, v19
    v_mul_f32 v18, 0x3ae38e39, v18
    v_cvt_pk_bf16_f32 v38, v56, v18
    v_lshlrev_b32 v106, 16, v38
    v_and_b32 v38, 0xffff0000, v38
    v_add_f32 v38, 0x3727c5ac, v38
    v_sub_f32 v56, v56, v106
    v_cvt_pk_bf16_f32 v38, v38, v38
    v_lshlrev_b32 v38, 16, v38
    v_sqrt_f32 v38, v38
    s_nop 0
    v_cvt_pk_bf16_f32 v38, v38, v38
    v_lshlrev_b32 v38, 16, v38
    v_rcp_f32 v107, v38
    s_nop 0
    v_mul_f32 v56, v56, v107
    v_mul_f32 v18, v18, v107
    v_mul_f32 v18, v18, v107
    v_cvt_pk_bf16_f32 v38, v56, v18
    v_lshlrev_b32 v39, 16, v38
    buffer_load_dwordx4 v151, s[48:51], s14 offen offset:3072 lds
    v_and_b32 v38, 0xffff0000, v38
    v_add_f32 v38, 0x3727c5ac, v38
    v_sub_f32 v56, v56, v39
    v_cvt_pk_bf16_f32 v38, v38, v38
    v_lshlrev_b32 v38, 16, v38
    v_sqrt_f32 v38, v38
    s_nop 0
    v_cvt_pk_bf16_f32 v38, v38, v38
    v_lshlrev_b32 v38, 16, v38
    v_rcp_f32 v38, v38
    s_nop 0
    v_mul_f32 v18, v107, v38
    v_mul_f32 v56, v56, v38
    v_pk_fma_f32 v[20:21], v[20:21], v[18:19], v[56:57] op_sel_hi:[1,0,0]
    v_pk_fma_f32 v[22:23], v[22:23], v[18:19], v[56:57] op_sel_hi:[1,0,0]
    v_pk_fma_f32 v[24:25], v[24:25], v[18:19], v[56:57] op_sel_hi:[1,0,0]
    v_pk_fma_f32 v[26:27], v[26:27], v[18:19], v[56:57] op_sel_hi:[1,0,0]
    v_pk_fma_f32 v[28:29], v[28:29], v[18:19], v[56:57] op_sel_hi:[1,0,0]
    v_pk_fma_f32 v[30:31], v[30:31], v[18:19], v[56:57] op_sel_hi:[1,0,0]
    v_pk_fma_f32 v[32:33], v[32:33], v[18:19], v[56:57] op_sel_hi:[1,0,0]
    v_pk_fma_f32 v[34:35], v[34:35], v[18:19], v[56:57] op_sel_hi:[1,0,0]
    v_pk_fma_f32 v[36:37], v[36:37], v[18:19], v[56:57] op_sel_hi:[1,0,0]
    v_cvt_pk_bf16_f32 v8, v20, v21
    v_cvt_pk_bf16_f32 v9, v22, v23
    v_cvt_pk_bf16_f32 v10, v24, v25
    v_cvt_pk_bf16_f32 v11, v26, v27
    v_cvt_pk_bf16_f32 v12, v28, v29
    v_cvt_pk_bf16_f32 v13, v30, v31
    v_cvt_pk_bf16_f32 v14, v32, v33
    v_cvt_pk_bf16_f32 v15, v34, v35
    v_cvt_pk_bf16_f32 v16, v36, v37
    ds_write_b32 v48, v8 offset:0
    ds_write_b32 v48, v9 offset:4
    ds_write_b32 v48, v10 offset:8
    ds_write_b32 v48, v11 offset:384
    ds_write_b32 v48, v12 offset:388
    ds_write_b32 v48, v13 offset:392
    ds_write_b32 v48, v14 offset:768
    ds_write_b32 v48, v15 offset:772
    ds_write_b32 v48, v16 offset:776
    buffer_store_dwordx2 v[106:107], v49, s[44:47], s5 offen sc1
    s_waitcnt lgkmcnt(0)
    s_barrier
    ds_read_b64_tr_b16 v[20:21], v50 offset:0
    ds_read_b64_tr_b16 v[22:23], v50 offset:4864
    ds_read_b64_tr_b16 v[24:25], v50 offset:512
    ds_read_b64_tr_b16 v[26:27], v50 offset:5376
    ds_read_b64_tr_b16 v[28:29], v50 offset:1024
    ds_read_b64_tr_b16 v[30:31], v50 offset:5888
    s_waitcnt lgkmcnt(4)
    buffer_store_dwordx4 v[20:23], v93, s[44:47], s10 offen sc1
    s_waitcnt lgkmcnt(2)
    buffer_store_dwordx4 v[24:27], v94, s[44:47], s10 offen sc1
    s_waitcnt lgkmcnt(0)
    buffer_store_dwordx4 v[28:31], v95, s[44:47], s83 offen sc1
    buffer_load_dword v45, v54, s[64:67], 0 offen sc1
    s_waitcnt vmcnt(9)
    s_barrier
    ds_read_b64_tr_b16 v[60:61], v51 offset:0
    ds_read_b64_tr_b16 v[62:63], v51 offset:4608
    ds_read_b64_tr_b16 v[64:65], v51 offset:9216
    ds_read_b64_tr_b16 v[66:67], v51 offset:12672
    ds_read_b64_tr_b16 v[68:69], v51 offset:17280
    ds_read_b64_tr_b16 v[70:71], v51 offset:512
    ds_read_b64_tr_b16 v[72:73], v51 offset:5120
    ds_read_b64_tr_b16 v[74:75], v51 offset:9728
    ds_read_b64_tr_b16 v[76:77], v51 offset:13184
    ds_read_b64_tr_b16 v[78:79], v51 offset:17792
    v_alignbit_b32 v114, v99, v99, 16
    v_alignbit_b32 v115, v98, v98, 16
    s_waitcnt lgkmcnt(5)
    v_alignbit_b32 v108, v61, v60, 16
    v_alignbit_b32 v109, v62, v61, 16
    v_alignbit_b32 v110, v63, v62, 16
    v_alignbit_b32 v111, v64, v63, 16
    v_alignbit_b32 v112, v65, v64, 16
    v_dot2_f32_bf16 v116, v60, v114, 0
    ds_read_b64_tr_b16 v[80:81], v51 offset:1024
    v_dot2_f32_bf16 v117, v108, v114, 0
    v_dot2_f32_bf16 v118, v61, v114, 0
    v_dot2_f32_bf16 v119, v109, v114, 0
    v_dot2_f32_bf16 v120, v62, v114, 0
    ds_read_b64_tr_b16 v[82:83], v51 offset:5632
    v_dot2_f32_bf16 v121, v110, v114, 0
    v_dot2_f32_bf16 v122, v63, v114, 0
    v_dot2_f32_bf16 v123, v111, v114, 0
    v_dot2_f32_bf16 v116, v61, v115, v116
    v_dot2_f32_bf16 v117, v109, v115, v117
    ds_read_b64_tr_b16 v[84:85], v51 offset:10240
    v_dot2_f32_bf16 v118, v62, v115, v118
    v_dot2_f32_bf16 v119, v110, v115, v119
    v_dot2_f32_bf16 v120, v63, v115, v120
    v_dot2_f32_bf16 v121, v111, v115, v121
    v_dot2_f32_bf16 v122, v64, v115, v122
    ds_read_b64_tr_b16 v[86:87], v51 offset:13696
    v_dot2_f32_bf16 v123, v112, v115, v123
    v_and_b32 v133, 0xffff0000, v66
    v_lshlrev_b32 v132, 16, v66
    v_and_b32 v135, 0xffff0000, v67
    v_lshlrev_b32 v134, 16, v67
    ds_read_b64_tr_b16 v[88:89], v51 offset:18304
    v_and_b32 v137, 0xffff0000, v68
    v_lshlrev_b32 v136, 16, v68
    v_and_b32 v139, 0xffff0000, v69
    v_lshlrev_b32 v138, 16, v69
    v_pk_mul_f32 v[116:117], v[116:117], v[132:133]
    v_pk_mul_f32 v[118:119], v[118:119], v[134:135]
    v_pk_mul_f32 v[120:121], v[120:121], v[136:137]
    v_pk_mul_f32 v[122:123], v[122:123], v[138:139]
    v_cvt_pk_bf16_f32 v160, v123, v122
    v_cvt_pk_bf16_f32 v161, v121, v120
    v_cvt_pk_bf16_f32 v162, v119, v118
    v_cvt_pk_bf16_f32 v163, v117, v116
    buffer_store_dwordx4 v[160:163], v93, s[44:47], s7 offen sc1
    v_alignbit_b32 v114, v101, v101, 16
    v_alignbit_b32 v115, v100, v100, 16
    s_waitcnt lgkmcnt(5)
    v_alignbit_b32 v108, v71, v70, 16
    v_alignbit_b32 v109, v72, v71, 16
    v_alignbit_b32 v110, v73, v72, 16
    v_alignbit_b32 v111, v74, v73, 16
    v_alignbit_b32 v112, v75, v74, 16
    v_dot2_f32_bf16 v124, v70, v114, 0
    v_dot2_f32_bf16 v125, v108, v114, 0
    v_dot2_f32_bf16 v126, v71, v114, 0
    v_dot2_f32_bf16 v127, v109, v114, 0
    v_dot2_f32_bf16 v128, v72, v114, 0
    v_dot2_f32_bf16 v129, v110, v114, 0
    v_dot2_f32_bf16 v130, v73, v114, 0
    v_dot2_f32_bf16 v131, v111, v114, 0
    v_dot2_f32_bf16 v124, v71, v115, v124
    v_dot2_f32_bf16 v125, v109, v115, v125
    v_dot2_f32_bf16 v126, v72, v115, v126
    v_dot2_f32_bf16 v127, v110, v115, v127
    v_dot2_f32_bf16 v128, v73, v115, v128
    v_dot2_f32_bf16 v129, v111, v115, v129
    v_dot2_f32_bf16 v130, v74, v115, v130
    v_dot2_f32_bf16 v131, v112, v115, v131
    v_and_b32 v133, 0xffff0000, v76
    v_lshlrev_b32 v132, 16, v76
    v_and_b32 v135, 0xffff0000, v77
    v_lshlrev_b32 v134, 16, v77
    v_and_b32 v137, 0xffff0000, v78
    v_lshlrev_b32 v136, 16, v78
    v_and_b32 v139, 0xffff0000, v79
    v_lshlrev_b32 v138, 16, v79
    v_pk_mul_f32 v[124:125], v[124:125], v[132:133]
    v_pk_mul_f32 v[126:127], v[126:127], v[134:135]
    v_pk_mul_f32 v[128:129], v[128:129], v[136:137]
    v_pk_mul_f32 v[130:131], v[130:131], v[138:139]
    v_cvt_pk_bf16_f32 v164, v131, v130
    v_cvt_pk_bf16_f32 v165, v129, v128
    v_cvt_pk_bf16_f32 v166, v127, v126
    v_cvt_pk_bf16_f32 v167, v125, v124
    buffer_store_dwordx4 v[164:167], v94, s[44:47], s7 offen sc1
    v_alignbit_b32 v114, v103, v103, 16
    v_alignbit_b32 v115, v102, v102, 16
    s_waitcnt lgkmcnt(0)
    v_alignbit_b32 v108, v81, v80, 16
    v_alignbit_b32 v109, v82, v81, 16
    v_alignbit_b32 v110, v83, v82, 16
    v_alignbit_b32 v111, v84, v83, 16
    v_alignbit_b32 v112, v85, v84, 16
    v_dot2_f32_bf16 v116, v80, v114, 0
    v_dot2_f32_bf16 v117, v108, v114, 0
    v_dot2_f32_bf16 v118, v81, v114, 0
    v_dot2_f32_bf16 v119, v109, v114, 0
    v_dot2_f32_bf16 v120, v82, v114, 0
    v_dot2_f32_bf16 v121, v110, v114, 0
    v_dot2_f32_bf16 v122, v83, v114, 0
    v_dot2_f32_bf16 v123, v111, v114, 0
    v_dot2_f32_bf16 v116, v81, v115, v116
    v_dot2_f32_bf16 v117, v109, v115, v117
    v_dot2_f32_bf16 v118, v82, v115, v118
    v_dot2_f32_bf16 v119, v110, v115, v119
    v_dot2_f32_bf16 v120, v83, v115, v120
    v_dot2_f32_bf16 v121, v111, v115, v121
    v_dot2_f32_bf16 v122, v84, v115, v122
    v_dot2_f32_bf16 v123, v112, v115, v123
    v_and_b32 v133, 0xffff0000, v86
    v_lshlrev_b32 v132, 16, v86
    v_and_b32 v135, 0xffff0000, v87
    v_lshlrev_b32 v134, 16, v87
    v_and_b32 v137, 0xffff0000, v88
    v_lshlrev_b32 v136, 16, v88
    v_and_b32 v139, 0xffff0000, v89
    v_lshlrev_b32 v138, 16, v89
    v_pk_mul_f32 v[116:117], v[116:117], v[132:133]
    v_pk_mul_f32 v[118:119], v[118:119], v[134:135]
    v_pk_mul_f32 v[120:121], v[120:121], v[136:137]
    v_pk_mul_f32 v[122:123], v[122:123], v[138:139]
    v_cvt_pk_bf16_f32 v168, v123, v122
    v_cvt_pk_bf16_f32 v169, v121, v120
    v_cvt_pk_bf16_f32 v170, v119, v118
    v_cvt_pk_bf16_f32 v171, v117, v116
    buffer_store_dwordx4 v[168:171], v95, s[44:47], s8 offen sc1
    s_add_u32 m0, s73, 98304
    s_mul_i32 s14, s19, 589824
    buffer_load_dwordx4 v148, s[48:51], s14 offen offset:0 lds
    buffer_load_dwordx4 v149, s[48:51], s14 offen offset:1024 lds
    buffer_load_dwordx4 v150, s[48:51], s14 offen offset:2048 lds
    buffer_load_dwordx4 v151, s[48:51], s14 offen offset:3072 lds
    s_add_u32 m0, s73, 0
    s_mul_i32 s14, s20, 589824
    buffer_load_dwordx4 v148, s[48:51], s14 offen offset:0 lds
    buffer_load_dwordx4 v149, s[48:51], s14 offen offset:1024 lds
    buffer_load_dwordx4 v150, s[48:51], s14 offen offset:2048 lds
    buffer_load_dwordx4 v151, s[48:51], s14 offen offset:3072 lds
    s_add_u32 m0, s73, 16384
    s_mul_i32 s14, s21, 589824
    buffer_load_dwordx4 v148, s[48:51], s14 offen offset:0 lds
    buffer_load_dwordx4 v149, s[48:51], s14 offen offset:1024 lds
    s_waitcnt vmcnt(13)
    v_readfirstlane_b32 s68, v45
    s_nop 1
    s_cmp_eq_u32 s68, 0
    s_cbranch_scc1 L_nw_G
L_ng_G:
    s_barrier
    v_mov_b32 v3, s68
    buffer_store_dword v3, v1, s[44:47], 0 offen sc1
    s_mov_b64 exec, 0
    s_call_b64 s[82:83], L_wc_G
    s_mov_b64 exec, -1
    s_waitcnt vmcnt(11)
    s_barrier
    buffer_store_dword v3, v46, s[44:47], 0 offen sc1
L_segG:
L_pl_G_0:
    s_cbranch_execz L_pl_G_4
    buffer_load_dwordx4 v150, s[48:51], s14 offen offset:2048 lds
    buffer_load_dwordx4 v151, s[48:51], s14 offen offset:3072 lds
    s_add_u32 m0, s73, 32768
    s_mul_i32 s14, s22, 589824
    buffer_load_dwordx4 v148, s[48:51], s14 offen offset:0 lds
    buffer_load_dwordx4 v149, s[48:51], s14 offen offset:1024 lds
    buffer_load_dwordx4 v150, s[48:51], s14 offen offset:2048 lds
    buffer_load_dwordx4 v151, s[48:51], s14 offen offset:3072 lds
    s_add_u32 m0, s73, 49152
    s_mul_i32 s14, s23, 589824
    buffer_load_dwordx4 v148, s[48:51], s14 offen offset:0 lds
    buffer_load_dwordx4 v149, s[48:51], s14 offen offset:1024 lds
    buffer_load_dwordx4 v150, s[48:51], s14 offen offset:2048 lds
    buffer_load_dwordx4 v151, s[48:51], s14 offen offset:3072 lds
    s_add_u32 m0, s73, 65536
    s_mul_i32 s14, s24, 589824
    buffer_load_dwordx4 v148, s[48:51], s14 offen offset:0 lds
    buffer_load_dwordx4 v149, s[48:51], s14 offen offset:1024 lds
    buffer_load_dwordx4 v150, s[48:51], s14 offen offset:2048 lds
    buffer_load_dwordx4 v151, s[48:51], s14 offen offset:3072 lds
    v_bfe_u32 v140, v2, 2, 2
    v_lshrrev_b32 v141, 4, v2
    v_lshl_add_u32 v142, v141, 3, v140
    v_lshlrev_b32 v142, 8, v142
    v_and_b32 v143, 3, v2
    v_lshl_add_u32 v142, v143, 3, v142
    v_and_b32 v141, 1, v141
    v_lshl_add_u32 v140, v141, 2, v140
    s_lshl_b32 s7, s3, 1
    v_xor_b32 v140, s7, v140
    v_lshl_add_u32 v152, v140, 5, v142
    v_xor_b32 v153, 32, v152
    v_add_u32 v154, 0x10000, v152
    v_add_u32 v155, 0x10000, v153
    v_and_b32 v24, 15, v2
    v_lshrrev_b32 v25, 4, v2
    v_mul_u32_u24 v26, 17408, v25
    v_lshl_add_u32 v26, v24, 4, v26
    v_mul_u32_u24 v25, 1536, v25
    v_lshl_add_u32 v25, v24, 4, v25
    v_add_u32 v159, 81920, v25
    v_add_u32 v250, 36864, v159
    s_mul_i32 s7, s3, 18432
    s_xor_b32 s8, s70, 1
    s_mul_i32 s8, s8, 1536
    s_add_u32 s7, s7, s8
    v_lshlrev_b32 v246, 4, v2
    v_add_u32 v156, s7, v246
    v_lshrrev_b32 v25, 5, v2
    v_mul_u32_u24 v25, 7680, v25
    v_add_u32 v157, v156, v25
    v_add_u32 v158, 7680, v156
    s_mul_i32 s74, s3, 3072
    s_add_u32 s74, s74, 81920
    v_mov_b32 v245, v26
    s_mov_b64 exec, 0
    s_call_b64 s[82:83], L_wc_D
    s_mov_b64 exec, -1
    s_mov_b32 s56, s32
    s_and_b32 s57, s33, 0xffff
    s_mov_b32 s58, 9216
    s_mov_b32 s59, 0x20000
    s_mov_b32 s60, s36
    s_and_b32 s61, s37, 0xffff
    s_mov_b32 s62, 4096
    s_mov_b32 s63, 0x20000
    s_and_b32 s4, s70, 1
    s_lshl1_add_u32 s4, s3, s4
    s_lshl_b32 s4, s4, 7
    s_bfe_u32 s5, s2, 0x10003
    s_lshl1_add_u32 s5, s72, s5
    s_lshr_b32 s5, s5, 0
    s_lshl_b32 s5, s5, 10
    s_add_u32 s4, s4, s5
    s_add_u32 s4, s4, 12533760
    v_lshl_add_u32 v28, v2, 2, s4
    v_cmp_gt_u32 vcc, 32, v2
    v_mov_b32 v12, 0x40000000
    s_nop 0
    v_cndmask_b32 v28, v12, v28, vcc
    v_mov_b32 v12, s68
    v_cndmask_b32 v12, 0, v12, vcc
    v_lshrrev_b32 v24, 4, v2
    v_lshlrev_b32 v25, 3, v24
    s_lshl_b32 s7, s69, 8
    s_lshl_b32 s8, s3, 6
    s_add_u32 s7, s7, s8
    buffer_load_dwordx2 v[144:145], v25, s[56:59], s7 offen
    buffer_load_dwordx2 v[146:147], v25, s[56:59], s7 offen offset:32
    s_waitcnt vmcnt(24)
    s_barrier
    ds_read_b64_tr_b16 a[0:1], v154 offset:16384
    ds_read_b64_tr_b16 a[2:3], v154 offset:17408
    ds_read_b64_tr_b16 a[4:5], v155 offset:16384
    ds_read_b64_tr_b16 a[6:7], v155 offset:17408
    ds_read_b64_tr_b16 a[8:9], v154 offset:24576
    ds_read_b64_tr_b16 a[10:11], v154 offset:25600
    ds_read_b64_tr_b16 a[12:13], v155 offset:24576
    ds_read_b64_tr_b16 a[14:15], v155 offset:25600
    ds_read_b64_tr_b16 a[16:17], v154 offset:32768
    ds_read_b64_tr_b16 a[18:19], v154 offset:33792
    ds_read_b64_tr_b16 a[20:21], v155 offset:32768
    ds_read_b64_tr_b16 a[22:23], v155 offset:33792
    ds_read_b64_tr_b16 a[24:25], v154 offset:40960
    ds_read_b64_tr_b16 a[26:27], v154 offset:41984
    ds_read_b64_tr_b16 a[28:29], v155 offset:40960
    ds_read_b64_tr_b16 a[30:31], v155 offset:41984
    s_waitcnt vmcnt(20)
    s_barrier
    ds_read_b64_tr_b16 a[32:33], v152 offset:0
    ds_read_b64_tr_b16 a[34:35], v152 offset:1024
    ds_read_b64_tr_b16 a[36:37], v153 offset:0
    ds_read_b64_tr_b16 a[38:39], v153 offset:1024
    ds_read_b64_tr_b16 a[40:41], v152 offset:8192
    ds_read_b64_tr_b16 a[42:43], v152 offset:9216
    ds_read_b64_tr_b16 a[44:45], v153 offset:8192
    ds_read_b64_tr_b16 a[46:47], v153 offset:9216
    s_waitcnt vmcnt(14)
    s_barrier
    ds_read_b64_tr_b16 a[48:49], v152 offset:16384
    ds_read_b64_tr_b16 a[50:51], v152 offset:17408
    ds_read_b64_tr_b16 a[52:53], v153 offset:16384
    ds_read_b64_tr_b16 a[54:55], v153 offset:17408
    ds_read_b64_tr_b16 a[56:57], v152 offset:24576
    ds_read_b64_tr_b16 a[58:59], v152 offset:25600
    ds_read_b64_tr_b16 a[60:61], v153 offset:24576
    ds_read_b64_tr_b16 a[62:63], v153 offset:25600
    v_mov_b32 v29, 0
    buffer_atomic_add v29, v28, s[44:47], 0 offen sc0 sc1
    s_waitcnt vmcnt(11)
    s_barrier
    ds_read_b64_tr_b16 a[64:65], v152 offset:32768
    ds_read_b64_tr_b16 a[66:67], v152 offset:33792
    ds_read_b64_tr_b16 a[68:69], v153 offset:32768
    ds_read_b64_tr_b16 a[70:71], v153 offset:33792
    ds_read_b64_tr_b16 a[72:73], v152 offset:40960
    ds_read_b64_tr_b16 a[74:75], v152 offset:41984
    ds_read_b64_tr_b16 a[76:77], v153 offset:40960
    ds_read_b64_tr_b16 a[78:79], v153 offset:41984
L_pl_G_1:
    s_cbranch_execz L_pl_G_5
    s_waitcnt lgkmcnt(0)
    s_barrier
    s_xor_b32 s8, s70, 1
    s_mul_i32 s8, s8, 1536
    s_mul_i32 s7, s3, 22528
    s_add_u32 s7, s7, 36585472
    v_add_u32 v24, 0, v246
    v_cmp_lt_u32 vcc, 1535, v24
    s_nop 1
    v_cndmask_b32 v25, 0, 1, vcc
    v_mul_u32_u24 v30, 1536, v25
    v_sub_u32 v24, v24, v30
    v_add_u32 v24, s8, v24
    v_lshrrev_b32 v30, 7, v24
    v_mul_u32_u24 v31, 9363, v30
    v_lshrrev_b32 v31, 16, v31
    v_mad_i32_i24 v30, v31, -7, v30
    v_cmp_lt_u32 vcc, 2, v30
    s_nop 1
    v_addc_co_u32 v31, vcc, 0, v31, vcc
    v_lshl_add_u32 v24, v31, 7, v24
    v_mul_u32_u24 v25, 11264, v25
    v_add3_u32 v24, v24, v25, s7
    v_subrev_u32 v156, 0, v24
    v_add_u32 v24, 1024, v246
    v_cmp_lt_u32 vcc, 1535, v24
    s_nop 1
    v_cndmask_b32 v25, 0, 1, vcc
    v_mul_u32_u24 v30, 1536, v25
    v_sub_u32 v24, v24, v30
    v_add_u32 v24, s8, v24
    v_lshrrev_b32 v30, 7, v24
    v_mul_u32_u24 v31, 9363, v30
    v_lshrrev_b32 v31, 16, v31
    v_mad_i32_i24 v30, v31, -7, v30
    v_cmp_lt_u32 vcc, 2, v30
    s_nop 1
    v_addc_co_u32 v31, vcc, 0, v31, vcc
    v_lshl_add_u32 v24, v31, 7, v24
    v_mul_u32_u24 v25, 11264, v25
    v_add3_u32 v24, v24, v25, s7
    v_subrev_u32 v157, 1024, v24
    v_add_u32 v24, 2048, v246
    v_cmp_lt_u32 vcc, 1535, v24
    s_nop 1
    v_cndmask_b32 v25, 0, 1, vcc
    v_mul_u32_u24 v30, 1536, v25
    v_sub_u32 v24, v24, v30
    v_add_u32 v24, s8, v24
    v_lshrrev_b32 v30, 7, v24
    v_mul_u32_u24 v31, 9363, v30
    v_lshrrev_b32 v31, 16, v31
    v_mad_i32_i24 v30, v31, -7, v30
    v_cmp_lt_u32 vcc, 2, v30
    s_nop 1
    v_addc_co_u32 v31, vcc, 0, v31, vcc
    v_lshl_add_u32 v24, v31, 7, v24
    v_mul_u32_u24 v25, 11264, v25
    v_add3_u32 v24, v24, v25, s7
    v_subrev_u32 v158, 2048, v24
    s_xor_b32 s8, s70, 0
    s_mul_i32 s8, s8, 1536
    s_mul_i32 s7, s3, 22528
    s_add_u32 s7, s7, 36585472
    v_add_u32 v24, 0, v246
    v_cmp_lt_u32 vcc, 1535, v24
    s_nop 1
    v_cndmask_b32 v25, 0, 1, vcc
    v_mul_u32_u24 v30, 1536, v25
    v_sub_u32 v24, v24, v30
    v_add_u32 v24, s8, v24
    v_lshrrev_b32 v30, 7, v24
    v_mul_u32_u24 v31, 9363, v30
    v_lshrrev_b32 v31, 16, v31
    v_mad_i32_i24 v30, v31, -7, v30
    v_cmp_lt_u32 vcc, 2, v30
    s_nop 1
    v_addc_co_u32 v31, vcc, 0, v31, vcc
    v_lshl_add_u32 v24, v31, 7, v24
    v_mul_u32_u24 v25, 11264, v25
    v_add3_u32 v24, v24, v25, s7
    v_subrev_u32 v8, 0, v24
    v_add_u32 v24, 1024, v246
    v_cmp_lt_u32 vcc, 1535, v24
    s_nop 1
    v_cndmask_b32 v25, 0, 1, vcc
    v_mul_u32_u24 v30, 1536, v25
    v_sub_u32 v24, v24, v30
    v_add_u32 v24, s8, v24
    v_lshrrev_b32 v30, 7, v24
    v_mul_u32_u24 v31, 9363, v30
    v_lshrrev_b32 v31, 16, v31
    v_mad_i32_i24 v30, v31, -7, v30
    v_cmp_lt_u32 vcc, 2, v30
    s_nop 1
    v_addc_co_u32 v31, vcc, 0, v31, vcc
    v_lshl_add_u32 v24, v31, 7, v24
    v_mul_u32_u24 v25, 11264, v25
    v_add3_u32 v24, v24, v25, s7
    v_subrev_u32 v9, 1024, v24
    v_add_u32 v24, 2048, v246
    v_cmp_lt_u32 vcc, 1535, v24
    s_nop 1
    v_cndmask_b32 v25, 0, 1, vcc
    v_mul_u32_u24 v30, 1536, v25
    v_sub_u32 v24, v24, v30
    v_add_u32 v24, s8, v24
    v_lshrrev_b32 v30, 7, v24
    v_mul_u32_u24 v31, 9363, v30
    v_lshrrev_b32 v31, 16, v31
    v_mad_i32_i24 v30, v31, -7, v30
    v_cmp_lt_u32 vcc, 2, v30
    s_nop 1
    v_addc_co_u32 v31, vcc, 0, v31, vcc
    v_lshl_add_u32 v24, v31, 7, v24
    v_mul_u32_u24 v25, 11264, v25
    v_add3_u32 v24, v24, v25, s7
    v_subrev_u32 v3, 2048, v24
    s_waitcnt vmcnt(0)
    v_cmp_ne_u32 vcc, v12, v29
    s_cbranch_vccnz L_rs_p1G
L_ok_p1G:
    s_add_u32 m0, s74, 0
    s_mul_i32 s13, s18, 90112
    buffer_load_dwordx4 v156, s[44:47], s13 offen offset:0 sc1 lds
    buffer_load_dwordx4 v157, s[44:47], s13 offen offset:1024 sc1 lds
    buffer_load_dwordx4 v158, s[44:47], s13 offen offset:2048 sc1 lds
    s_add_u32 m0, s74, 12288
    s_mul_i32 s13, s19, 90112
    buffer_load_dwordx4 v156, s[44:47], s13 offen offset:0 sc1 lds
    buffer_load_dwordx4 v157, s[44:47], s13 offen offset:1024 sc1 lds
    buffer_load_dwordx4 v158, s[44:47], s13 offen offset:2048 sc1 lds
    s_add_u32 m0, s74, 24576
    s_mul_i32 s13, s20, 90112
    buffer_load_dwordx4 v156, s[44:47], s13 offen offset:0 sc1 lds
    buffer_load_dwordx4 v157, s[44:47], s13 offen offset:1024 sc1 lds
    buffer_load_dwordx4 v158, s[44:47], s13 offen offset:2048 sc1 lds
    s_add_u32 m0, s74, 36864
    s_mul_i32 s13, s21, 90112
    buffer_load_dwordx4 v156, s[44:47], s13 offen offset:0 sc1 lds
    buffer_load_dwordx4 v157, s[44:47], s13 offen offset:1024 sc1 lds
    buffer_load_dwordx4 v158, s[44:47], s13 offen offset:2048 sc1 lds
    s_waitcnt vmcnt(9) lgkmcnt(0)
    s_barrier
    ds_read_b128 v[80:83], v159 offset:0
    ds_read_b128 v[84:87], v159 offset:6144
    ds_read_b128 v[88:91], v159 offset:256
    ds_read_b128 v[92:95], v159 offset:6400
    ds_read_b128 v[96:99], v159 offset:512
    ds_read_b128 v[100:103], v159 offset:6656
    s_waitcnt lgkmcnt(0)
    v_mfma_f32_16x16x32_bf16 v[192:195], a[0:3], v[80:83], 0
    v_mfma_f32_16x16x32_bf16 v[192:195], a[8:11], v[84:87], v[192:195]
    ds_read_b128 v[104:107], v159 offset:768
    v_mfma_f32_16x16x32_bf16 v[196:199], a[12:15], v[84:87], 0
    ds_read_b128 v[108:111], v159 offset:6912
    v_mfma_f32_16x16x32_bf16 v[196:199], a[4:7], v[80:83], v[196:199]
    ds_read_b128 v[112:115], v159 offset:1024
    v_mfma_f32_16x16x32_bf16 v[204:207], a[4:7], v[88:91], 0
    ds_read_b128 v[116:119], v159 offset:7168
    v_mfma_f32_16x16x32_bf16 v[204:207], a[12:15], v[92:95], v[204:207]
    ds_read_b128 v[120:123], v159 offset:1280
    v_mfma_f32_16x16x32_bf16 v[200:203], a[8:11], v[92:95], 0
    ds_read_b128 v[124:127], v159 offset:7424
    v_and_b32 v24, 15, v2
    s_lshl_b32 s7, s71, 6
    v_add_u32 v24, s7, v24
    s_and_b32 s8, s3, 1
    s_lshl_b32 s4, s8, 5
    v_add_u32 v25, s4, v24
    v_lshlrev_b32 v26, 3, v25
    v_mul_u32_u24 v25, 1152, v25
    v_bfe_u32 v31, v2, 4, 1
    v_lshl_add_u32 v25, v31, 5, v25
    v_lshrrev_b32 v31, 5, v2
    v_lshl_add_u32 v25, v31, 4, v25
    s_bfe_u32 s7, s2, 0x20003
    s_mul_i32 s7, s7, 288
    s_bfe_u32 s5, s2, 0x10003
    s_mul_i32 s5, s5, 32
    s_lshl_b32 s4, s72, 6
    s_add_u32 s4, s4, s7
    s_add_u32 s4, s4, s5
    s_lshl_b32 s5, s5, 3
    s_sub_u32 s7, s7, s5
    v_add_u32 v252, s4, v25
    s_xor_b32 s8, s3, s72
    s_and_b32 s4, s72, 1
    s_lshl1_add_u32 s4, s4, s8
    v_lshl_add_u32 v24, s4, 4, v24
    s_add_u32 s7, s7, 256
    s_cmp_lt_u32 s8, 2
    s_cselect_b32 s7, s7, 0x40000000
    v_lshlrev_b32 v18, 3, v24
    v_mul_u32_u24 v24, 1152, v24
    v_mfma_f32_16x16x32_bf16 v[200:203], a[0:3], v[88:91], v[200:203]
    v_mfma_f32_16x16x32_bf16 v[208:211], a[0:3], v[96:99], 0
    v_mfma_f32_16x16x32_bf16 v[208:211], a[8:11], v[100:103], v[208:211]
    v_mfma_f32_16x16x32_bf16 v[212:215], a[12:15], v[100:103], 0
    v_mfma_f32_16x16x32_bf16 v[212:215], a[4:7], v[96:99], v[212:215]
    s_waitcnt lgkmcnt(0)
    v_mfma_f32_16x16x32_bf16 v[220:223], a[4:7], v[104:107], 0
    s_waitcnt vmcnt(6)
    s_barrier
    v_mfma_f32_16x16x32_bf16 v[220:223], a[12:15], v[108:111], v[220:223]
    ds_read_b128 v[80:83], v159 offset:12288
    s_add_u32 m0, s74, 49152
    s_mul_i32 s13, s22, 90112
    v_mfma_f32_16x16x32_bf16 v[216:219], a[8:11], v[108:111], 0
    ds_read_b128 v[84:87], v159 offset:18432
    buffer_load_dwordx4 v156, s[44:47], s13 offen offset:0 sc1 lds
    v_mfma_f32_16x16x32_bf16 v[216:219], a[0:3], v[104:107], v[216:219]
    ds_read_b128 v[88:91], v159 offset:12544
    v_mfma_f32_16x16x32_bf16 v[224:227], a[0:3], v[112:115], 0
    ds_read_b128 v[92:95], v159 offset:18688
    buffer_load_dwordx4 v157, s[44:47], s13 offen offset:1024 sc1 lds
    v_mfma_f32_16x16x32_bf16 v[224:227], a[8:11], v[116:119], v[224:227]
    ds_read_b128 v[96:99], v159 offset:12800
    v_mfma_f32_16x16x32_bf16 v[228:231], a[12:15], v[116:119], 0
    ds_read_b128 v[100:103], v159 offset:18944
    buffer_load_dwordx4 v158, s[44:47], s13 offen offset:2048 sc1 lds
    v_lshrrev_b32 v31, 4, v2
    v_lshl_add_u32 v24, v31, 3, v24
    v_add_u32 v253, s7, v24
    v_lshrrev_b32 v24, 3, v2
    v_and_b32 v25, 7, v2
    v_bfe_u32 v31, v2, 4, 2
    v_lshlrev_b32 v31, 1, v31
    v_xor_b32 v25, v25, v31
    v_lshlrev_b32 v24, 12, v24
    v_lshl_add_u32 v24, v25, 4, v24
    s_mul_i32 s7, s72, 36
    s_bitcmp1_b32 s3, 0
    s_addc_u32 s7, s7, 0
    s_lshl_b32 s7, s7, 17
    s_lshl_b32 s8, s71, 7
    s_add_u32 s7, s7, s8
    v_add_u32 v4, s7, v24
    v_add_u32 v5, 31744, v4
    v_add_u32 v6, 31744, v5
    v_add_u32 v7, 31744, v6
    v_lshrrev_b32 v24, 2, v2
    v_lshlrev_b32 v24, 7, v24
    v_and_b32 v25, 3, v2
    v_lshl_add_u32 v24, v25, 3, v24
    s_and_b32 s7, s73, 8192
    v_add_u32 v24, s7, v24
    v_bfe_u32 v31, v2, 3, 2
    s_and_b32 s7, s3, 1
    s_lshl_b32 s7, s7, 1
    v_xor_b32 v31, s7, v31
    v_mfma_f32_16x16x32_bf16 v[228:231], a[4:7], v[112:115], v[228:231]
    ds_read_b64_tr_b16 a[80:81], v152 offset:49152
    v_mfma_f32_16x16x32_bf16 v[236:239], a[4:7], v[120:123], 0
    ds_read_b64_tr_b16 a[82:83], v152 offset:50176
    s_add_u32 m0, s74, 61440
    s_mul_i32 s13, s23, 90112
    v_mfma_f32_16x16x32_bf16 v[236:239], a[12:15], v[124:127], v[236:239]
    v_mfma_f32_16x16x32_bf16 v[232:235], a[8:11], v[124:127], 0
    ds_read_b64_tr_b16 a[84:85], v153 offset:49152
    buffer_load_dwordx4 v156, s[44:47], s13 offen offset:0 sc1 lds
    v_mfma_f32_16x16x32_bf16 v[232:235], a[0:3], v[120:123], v[232:235]
    ds_read_b64_tr_b16 a[86:87], v153 offset:50176
    s_waitcnt lgkmcnt(4)
    v_mfma_f32_16x16x32_bf16 v[192:195], a[16:19], v[80:83], v[192:195]
    buffer_load_dwordx4 v157, s[44:47], s13 offen offset:1024 sc1 lds
    v_mfma_f32_16x16x32_bf16 v[192:195], a[24:27], v[84:87], v[192:195]
    ds_read_b128 v[104:107], v159 offset:13056
    buffer_load_dwordx4 v158, s[44:47], s13 offen offset:2048 sc1 lds
    v_mfma_f32_16x16x32_bf16 v[196:199], a[28:31], v[84:87], v[196:199]
    ds_read_b128 v[108:111], v159 offset:19200
    v_mfma_f32_16x16x32_bf16 v[196:199], a[20:23], v[80:83], v[196:199]
    ds_read_b128 v[112:115], v159 offset:13312
    s_add_u32 m0, s73, 0
    s_mul_i32 s14, s25, 589824
    v_mfma_f32_16x16x32_bf16 v[204:207], a[20:23], v[88:91], v[204:207]
    ds_read_b128 v[116:119], v159 offset:19456
    v_mfma_f32_16x16x32_bf16 v[204:207], a[28:31], v[92:95], v[204:207]
    ds_read_b128 v[120:123], v159 offset:13568
    buffer_load_dwordx4 v148, s[48:51], s14 offen offset:0 lds
    v_mfma_f32_16x16x32_bf16 v[200:203], a[24:27], v[92:95], v[200:203]
    ds_read_b128 v[124:127], v159 offset:19712
    buffer_load_dwordx4 v149, s[48:51], s14 offen offset:1024 lds
    v_lshl_add_u32 v10, v31, 5, v24
    v_xor_b32 v11, 32, v10
    s_bfe_u32 s101, s2, 0x20003
    s_mul_i32 s101, s101, 3
    s_mul_i32 s84, s101, 305844
    s_lshr_b32 s84, s84, 18
    s_add_u32 s84, s84, 0
    s_add_u32 s85, s84, 1
    s_cmp_eq_u32 s85, 14
    s_cselect_b32 s85, 0, s85
    s_add_u32 s86, s85, 1
    s_cmp_eq_u32 s86, 14
    s_cselect_b32 s86, 0, s86
    s_add_u32 s87, s86, 1
    s_cmp_eq_u32 s87, 14
    s_cselect_b32 s87, 0, s87
    s_add_u32 s88, s87, 1
    s_cmp_eq_u32 s88, 14
    s_cselect_b32 s88, 0, s88
    s_add_u32 s89, s88, 1
    s_cmp_eq_u32 s89, 14
    s_cselect_b32 s89, 0, s89
    s_add_u32 s90, s89, 1
    s_cmp_eq_u32 s90, 14
    s_cselect_b32 s90, 0, s90
    s_add_u32 s91, s90, 1
    s_cmp_eq_u32 s91, 14
    s_cselect_b32 s91, 0, s91
    s_add_u32 s92, s91, 1
    s_cmp_eq_u32 s92, 14
    s_cselect_b32 s92, 0, s92
    s_add_u32 s93, s92, 1
    s_cmp_eq_u32 s93, 14
    s_cselect_b32 s93, 0, s93
    s_add_u32 s94, s93, 1
    s_cmp_eq_u32 s94, 14
    s_cselect_b32 s94, 0, s94
    s_add_u32 s95, s94, 1
    s_cmp_eq_u32 s95, 14
    s_cselect_b32 s95, 0, s95
    s_add_u32 s96, s95, 1
    s_cmp_eq_u32 s96, 14
    s_cselect_b32 s96, 0, s96
    s_add_u32 s97, s96, 1
    s_cmp_eq_u32 s97, 14
    s_cselect_b32 s97, 0, s97
    s_mul_i32 s98, s101, 87384
    s_lshr_b32 s98, s98, 18
    s_add_u32 s98, s98, 14
    s_add_u32 s99, s98, 1
    s_cmp_eq_u32 s99, 18
    s_cselect_b32 s99, 14, s99
    s_add_u32 s100, s99, 1
    s_cmp_eq_u32 s100, 18
    s_cselect_b32 s100, 14, s100
    s_add_u32 s101, s100, 1
    s_cmp_eq_u32 s101, 18
    s_cselect_b32 s101, 14, s101
    s_mul_i32 s7, s70, 6
    s_add_u32 s7, s7, 0
    s_mul_i32 s8, s7, 7282
    s_lshr_b32 s8, s8, 16
    s_mul_i32 s5, s8, 9
    s_sub_u32 s7, s7, s5
    s_lshl_b32 s7, s7, 2
    v_mfma_f32_16x16x32_bf16 v[200:203], a[16:19], v[88:91], v[200:203]
    ds_read_b64_tr_b16 a[88:89], v152 offset:57344
    v_mfma_f32_16x16x32_bf16 v[208:211], a[16:19], v[96:99], v[208:211]
    ds_read_b64_tr_b16 a[90:91], v152 offset:58368
    buffer_load_dwordx4 v150, s[48:51], s14 offen offset:2048 lds
    v_mfma_f32_16x16x32_bf16 v[208:211], a[24:27], v[100:103], v[208:211]
    v_mfma_f32_16x16x32_bf16 v[212:215], a[28:31], v[100:103], v[212:215]
    ds_read_b64_tr_b16 a[92:93], v153 offset:57344
    buffer_load_dwordx4 v151, s[48:51], s14 offen offset:3072 lds
    v_mfma_f32_16x16x32_bf16 v[212:215], a[20:23], v[96:99], v[212:215]
    ds_read_b64_tr_b16 a[94:95], v153 offset:58368
    s_waitcnt lgkmcnt(4)
    v_mfma_f32_16x16x32_bf16 v[220:223], a[20:23], v[104:107], v[220:223]
    s_waitcnt vmcnt(13)
    s_barrier
    v_mfma_f32_16x16x32_bf16 v[220:223], a[28:31], v[108:111], v[220:223]
    ds_read_b128 v[80:83], v159 offset:24576
    s_add_u32 m0, s74, 0
    s_mul_i32 s13, s24, 90112
    v_mfma_f32_16x16x32_bf16 v[216:219], a[24:27], v[108:111], v[216:219]
    ds_read_b128 v[84:87], v159 offset:30720
    buffer_load_dwordx4 v156, s[44:47], s13 offen offset:0 sc1 lds
    v_mfma_f32_16x16x32_bf16 v[216:219], a[16:19], v[104:107], v[216:219]
    ds_read_b128 v[88:91], v159 offset:24832
    v_mfma_f32_16x16x32_bf16 v[224:227], a[16:19], v[112:115], v[224:227]
    ds_read_b128 v[92:95], v159 offset:30976
    buffer_load_dwordx4 v157, s[44:47], s13 offen offset:1024 sc1 lds
    v_mfma_f32_16x16x32_bf16 v[224:227], a[24:27], v[116:119], v[224:227]
    ds_read_b128 v[96:99], v159 offset:25088
    v_mfma_f32_16x16x32_bf16 v[228:231], a[28:31], v[116:119], v[228:231]
    ds_read_b128 v[100:103], v159 offset:31232
    buffer_load_dwordx4 v158, s[44:47], s13 offen offset:2048 sc1 lds
    s_mov_b32 s4, 0xeca86420
    s_bitcmp1_b32 s8, 0
    s_cselect_b32 s4, 0xca864203, s4
    s_cselect_b32 s5, 14, 3
    s_lshr_b64 s[4:5], s[4:5], s7
    s_and_b32 s4, s4, 15
    s_lshl4_add_u32 s4, s8, s4
    v_lshl_add_u32 v240, s4, 8, v245
    s_mul_i32 s7, s70, 6
    s_add_u32 s7, s7, 1
    s_mul_i32 s8, s7, 7282
    s_lshr_b32 s8, s8, 16
    s_mul_i32 s5, s8, 9
    s_sub_u32 s7, s7, s5
    s_lshl_b32 s7, s7, 2
    s_mov_b32 s4, 0xeca86420
    s_bitcmp1_b32 s8, 0
    s_cselect_b32 s4, 0xca864203, s4
    s_cselect_b32 s5, 14, 3
    s_lshr_b64 s[4:5], s[4:5], s7
    s_and_b32 s4, s4, 15
    s_lshl4_add_u32 s4, s8, s4
    v_lshl_add_u32 v241, s4, 8, v245
    s_mul_i32 s7, s70, 6
    s_add_u32 s7, s7, 2
    s_mul_i32 s8, s7, 7282
    s_lshr_b32 s8, s8, 16
    s_mul_i32 s5, s8, 9
    s_sub_u32 s7, s7, s5
    s_lshl_b32 s7, s7, 2
    v_mfma_f32_16x16x32_bf16 v[228:231], a[20:23], v[112:115], v[228:231]
    ds_read_b64_tr_b16 a[96:97], v154 offset:0
    v_mfma_f32_16x16x32_bf16 v[236:239], a[20:23], v[120:123], v[236:239]
    ds_read_b64_tr_b16 a[98:99], v154 offset:1024
    s_add_u32 m0, s74, 12288
    s_mul_i32 s13, s25, 90112
    v_mfma_f32_16x16x32_bf16 v[236:239], a[28:31], v[124:127], v[236:239]
    v_mfma_f32_16x16x32_bf16 v[232:235], a[24:27], v[124:127], v[232:235]
    ds_read_b64_tr_b16 a[100:101], v155 offset:0
    buffer_load_dwordx4 v156, s[44:47], s13 offen offset:0 sc1 lds
    v_mfma_f32_16x16x32_bf16 v[232:235], a[16:19], v[120:123], v[232:235]
    ds_read_b64_tr_b16 a[102:103], v155 offset:1024
    s_waitcnt lgkmcnt(4)
    v_mfma_f32_16x16x32_bf16 v[192:195], a[32:35], v[80:83], v[192:195]
    buffer_load_dwordx4 v157, s[44:47], s13 offen offset:1024 sc1 lds
    v_mfma_f32_16x16x32_bf16 v[192:195], a[40:43], v[84:87], v[192:195]
    ds_read_b128 v[104:107], v159 offset:25344
    buffer_load_dwordx4 v158, s[44:47], s13 offen offset:2048 sc1 lds
    v_mfma_f32_16x16x32_bf16 v[196:199], a[44:47], v[84:87], v[196:199]
    ds_read_b128 v[108:111], v159 offset:31488
    v_mfma_f32_16x16x32_bf16 v[196:199], a[36:39], v[80:83], v[196:199]
    ds_read_b128 v[112:115], v159 offset:25600
    s_add_u32 m0, s73, 16384
    s_mul_i32 s14, s26, 589824
    v_mfma_f32_16x16x32_bf16 v[204:207], a[36:39], v[88:91], v[204:207]
    ds_read_b128 v[116:119], v159 offset:31744
    v_mfma_f32_16x16x32_bf16 v[204:207], a[44:47], v[92:95], v[204:207]
    ds_read_b128 v[120:123], v159 offset:25856
    buffer_load_dwordx4 v148, s[48:51], s14 offen offset:0 lds
    v_mfma_f32_16x16x32_bf16 v[200:203], a[40:43], v[92:95], v[200:203]
    ds_read_b128 v[124:127], v159 offset:32000
    buffer_load_dwordx4 v149, s[48:51], s14 offen offset:1024 lds
    s_mov_b32 s4, 0xeca86420
    s_bitcmp1_b32 s8, 0
    s_cselect_b32 s4, 0xca864203, s4
    s_cselect_b32 s5, 14, 3
    s_lshr_b64 s[4:5], s[4:5], s7
    s_and_b32 s4, s4, 15
    s_lshl4_add_u32 s4, s8, s4
    v_lshl_add_u32 v242, s4, 8, v245
    s_mul_i32 s7, s70, 6
    s_add_u32 s7, s7, 3
    s_mul_i32 s8, s7, 7282
    s_lshr_b32 s8, s8, 16
    s_mul_i32 s5, s8, 9
    s_sub_u32 s7, s7, s5
    s_lshl_b32 s7, s7, 2
    s_mov_b32 s4, 0xeca86420
    s_bitcmp1_b32 s8, 0
    s_cselect_b32 s4, 0xca864203, s4
    s_cselect_b32 s5, 14, 3
    s_lshr_b64 s[4:5], s[4:5], s7
    s_and_b32 s4, s4, 15
    s_lshl4_add_u32 s4, s8, s4
    v_lshl_add_u32 v243, s4, 8, v245
    s_mul_i32 s7, s70, 6
    s_add_u32 s7, s7, 4
    s_mul_i32 s8, s7, 7282
    s_lshr_b32 s8, s8, 16
    s_mul_i32 s5, s8, 9
    s_sub_u32 s7, s7, s5
    v_mfma_f32_16x16x32_bf16 v[200:203], a[32:35], v[88:91], v[200:203]
    ds_read_b64_tr_b16 a[104:105], v154 offset:8192
    v_mfma_f32_16x16x32_bf16 v[208:211], a[32:35], v[96:99], v[208:211]
    ds_read_b64_tr_b16 a[106:107], v154 offset:9216
    buffer_load_dwordx4 v150, s[48:51], s14 offen offset:2048 lds
    v_mfma_f32_16x16x32_bf16 v[208:211], a[40:43], v[100:103], v[208:211]
    v_mfma_f32_16x16x32_bf16 v[212:215], a[44:47], v[100:103], v[212:215]
    ds_read_b64_tr_b16 a[108:109], v155 offset:8192
    buffer_load_dwordx4 v151, s[48:51], s14 offen offset:3072 lds
    v_mfma_f32_16x16x32_bf16 v[212:215], a[36:39], v[96:99], v[212:215]
    ds_read_b64_tr_b16 a[110:111], v155 offset:9216
    s_waitcnt lgkmcnt(4)
    v_mfma_f32_16x16x32_bf16 v[220:223], a[36:39], v[104:107], v[220:223]
    s_waitcnt vmcnt(20)
    s_barrier
    v_mfma_f32_16x16x32_bf16 v[220:223], a[44:47], v[108:111], v[220:223]
    ds_read_b128 v[80:83], v250 offset:0
    s_add_u32 m0, s74, 24576
    s_mul_i32 s13, s26, 90112
    v_mfma_f32_16x16x32_bf16 v[216:219], a[40:43], v[108:111], v[216:219]
    ds_read_b128 v[84:87], v250 offset:6144
    v_mfma_f32_16x16x32_bf16 v[216:219], a[32:35], v[104:107], v[216:219]
    ds_read_b128 v[88:91], v250 offset:256
    buffer_load_dwordx4 v156, s[44:47], s13 offen offset:0 sc1 lds
    v_mfma_f32_16x16x32_bf16 v[224:227], a[32:35], v[112:115], v[224:227]
    ds_read_b128 v[92:95], v250 offset:6400
    v_mfma_f32_16x16x32_bf16 v[224:227], a[40:43], v[116:119], v[224:227]
    ds_read_b128 v[96:99], v250 offset:512
    v_mfma_f32_16x16x32_bf16 v[228:231], a[44:47], v[116:119], v[228:231]
    ds_read_b128 v[100:103], v250 offset:6656
    buffer_load_dwordx4 v157, s[44:47], s13 offen offset:1024 sc1 lds
    s_lshl_b32 s7, s7, 2
    s_mov_b32 s4, 0xeca86420
    s_bitcmp1_b32 s8, 0
    s_cselect_b32 s4, 0xca864203, s4
    s_cselect_b32 s5, 14, 3
    s_lshr_b64 s[4:5], s[4:5], s7
    s_and_b32 s4, s4, 15
    s_lshl4_add_u32 s4, s8, s4
    v_lshl_add_u32 v244, s4, 8, v245
    s_mul_i32 s7, s70, 6
    s_add_u32 s7, s7, 5
    s_mul_i32 s8, s7, 7282
    s_lshr_b32 s8, s8, 16
    s_mul_i32 s5, s8, 9
    s_sub_u32 s7, s7, s5
    s_lshl_b32 s7, s7, 2
    s_mov_b32 s4, 0xeca86420
    s_bitcmp1_b32 s8, 0
    s_cselect_b32 s4, 0xca864203, s4
    s_cselect_b32 s5, 14, 3
    s_lshr_b64 s[4:5], s[4:5], s7
    s_and_b32 s4, s4, 15
    s_lshl4_add_u32 s4, s8, s4
    v_lshl_add_u32 v245, s4, 8, v245
    s_xor_b32 s7, s75, 1
    s_lshl2_add_u32 s7, s7, s3
    s_mul_i32 s9, s7, 6144
    s_add_u32 s9, s9, 7077888
    s_lshl_b32 s7, s7, 7
    s_add_u32 s6, s7, 22822912
    s_lshl2_add_u32 s7, s75, s3
    s_mul_i32 s10, s7, 6144
    v_mfma_f32_16x16x32_bf16 v[228:231], a[36:39], v[112:115], v[228:231]
    v_mfma_f32_16x16x32_bf16 v[236:239], a[36:39], v[120:123], v[236:239]
    v_mfma_f32_16x16x32_bf16 v[236:239], a[44:47], v[124:127], v[236:239]
    buffer_load_dwordx4 v158, s[44:47], s13 offen offset:2048 sc1 lds
    v_mfma_f32_16x16x32_bf16 v[232:235], a[40:43], v[124:127], v[232:235]
    v_mfma_f32_16x16x32_bf16 v[232:235], a[32:35], v[120:123], v[232:235]
    s_waitcnt lgkmcnt(0)
    v_mfma_f32_16x16x32_bf16 v[192:195], a[48:51], v[80:83], v[192:195]
    s_add_u32 m0, s73, 32768
    s_mul_i32 s14, s27, 589824
    v_mfma_f32_16x16x32_bf16 v[192:195], a[56:59], v[84:87], v[192:195]
    ds_read_b128 v[104:107], v250 offset:768
    v_mfma_f32_16x16x32_bf16 v[196:199], a[60:63], v[84:87], v[196:199]
    ds_read_b128 v[108:111], v250 offset:6912
    buffer_load_dwordx4 v148, s[48:51], s14 offen offset:0 lds
    v_mfma_f32_16x16x32_bf16 v[196:199], a[52:55], v[80:83], v[196:199]
    ds_read_b128 v[112:115], v250 offset:1024
    v_mfma_f32_16x16x32_bf16 v[204:207], a[52:55], v[88:91], v[204:207]
    ds_read_b128 v[116:119], v250 offset:7168
    buffer_load_dwordx4 v149, s[48:51], s14 offen offset:1024 lds
    v_mfma_f32_16x16x32_bf16 v[204:207], a[60:63], v[92:95], v[204:207]
    ds_read_b128 v[120:123], v250 offset:1280
    v_mfma_f32_16x16x32_bf16 v[200:203], a[56:59], v[92:95], v[200:203]
    ds_read_b128 v[124:127], v250 offset:7424
    s_add_u32 s10, s10, 7077888
    s_lshl_b32 s7, s7, 7
    s_add_u32 s7, s7, 22822912
    v_mov_b32 v28, s7
    v_add_u32 v247, 3072, v246
    v_cmp_eq_u32 vcc, 0, v2
    v_mov_b32 v248, 0x40000000
    s_nop 0
    v_cndmask_b32 v248, v248, 0, vcc
    v_mov_b32 v249, s68
    v_and_b32 v129, 0xffff0000, v144
    v_lshlrev_b32 v128, 16, v144
    v_and_b32 v131, 0xffff0000, v145
    v_lshlrev_b32 v130, 16, v145
    v_and_b32 v133, 0xffff0000, v146
    v_lshlrev_b32 v132, 16, v146
    v_and_b32 v135, 0xffff0000, v147
    v_lshlrev_b32 v134, 16, v147
    s_mul_i32 s4, s70, 43691
    s_lshr_b32 s4, s4, 16
    s_mul_i32 s5, s70, 21846
    s_lshr_b32 s5, s5, 16
    s_mul_i32 s5, s5, 3
    s_sub_u32 s5, s70, s5
    v_mfma_f32_16x16x32_bf16 v[200:203], a[48:51], v[88:91], v[200:203]
    buffer_load_dwordx4 v150, s[48:51], s14 offen offset:2048 lds
    v_mfma_f32_16x16x32_bf16 v[208:211], a[48:51], v[96:99], v[208:211]
    v_mfma_f32_16x16x32_bf16 v[208:211], a[56:59], v[100:103], v[208:211]
    buffer_load_dwordx4 v151, s[48:51], s14 offen offset:3072 lds
    v_mfma_f32_16x16x32_bf16 v[212:215], a[60:63], v[100:103], v[212:215]
    v_mfma_f32_16x16x32_bf16 v[212:215], a[52:55], v[96:99], v[212:215]
    s_waitcnt lgkmcnt(0)
    v_mfma_f32_16x16x32_bf16 v[220:223], a[52:55], v[104:107], v[220:223]
    s_waitcnt vmcnt(17)
    s_barrier
    v_mfma_f32_16x16x32_bf16 v[220:223], a[60:63], v[108:111], v[220:223]
    ds_read_b128 v[80:83], v250 offset:12288
    s_add_u32 m0, s74, 36864
    s_mul_i32 s13, s27, 90112
    v_mfma_f32_16x16x32_bf16 v[216:219], a[56:59], v[108:111], v[216:219]
    ds_read_b128 v[84:87], v250 offset:18432
    v_mfma_f32_16x16x32_bf16 v[216:219], a[48:51], v[104:107], v[216:219]
    ds_read_b128 v[88:91], v250 offset:12544
    buffer_load_dwordx4 v156, s[44:47], s13 offen offset:0 sc1 lds
    v_mfma_f32_16x16x32_bf16 v[224:227], a[48:51], v[112:115], v[224:227]
    ds_read_b128 v[92:95], v250 offset:18688
    v_mfma_f32_16x16x32_bf16 v[224:227], a[56:59], v[116:119], v[224:227]
    ds_read_b128 v[96:99], v250 offset:12800
    v_mfma_f32_16x16x32_bf16 v[228:231], a[60:63], v[116:119], v[228:231]
    ds_read_b128 v[100:103], v250 offset:18944
    buffer_load_dwordx4 v157, s[44:47], s13 offen offset:1024 sc1 lds
    s_lshl2_add_u32 s4, s72, s4
    s_lshl_b32 s4, s4, 10
    s_mul_i32 s7, s72, 9
    s_sub_u32 s7, s69, s7
    s_lshl3_add_u32 s4, s7, s4
    s_add_u32 s4, s4, 12566528
    s_cmp_eq_u32 s5, 1
    s_cselect_b32 s7, 16, 8
    s_cmp_lg_u32 s5, 0
    s_cselect_b32 s5, 4, 0
    v_lshlrev_b32 v17, 7, v0
    v_add_u32 v17, s4, v17
    v_cmp_gt_u32 vcc, 8, v0
    v_mov_b32 v24, s5
    s_nop 0
    v_cndmask_b32 v24, 0, v24, vcc
    v_add_u32 v17, v17, v24
    v_cmp_gt_u32 vcc, s7, v0
    v_mov_b32 v24, 0x40000000
    s_nop 0
    v_cndmask_b32 v17, v24, v17, vcc
    s_bfe_u32 s4, s2, 0x20003
    s_lshl2_add_u32 s4, s72, s4
    s_lshl_b32 s4, s4, 3
    s_lshr_b32 s5, s2, 4
    v_mfma_f32_16x16x32_bf16 v[228:231], a[52:55], v[112:115], v[228:231]
    ds_read_b64_tr_b16 a[112:113], v152 offset:0
    v_mfma_f32_16x16x32_bf16 v[236:239], a[52:55], v[120:123], v[236:239]
    ds_read_b64_tr_b16 a[114:115], v152 offset:1024
    v_mfma_f32_16x16x32_bf16 v[236:239], a[60:63], v[124:127], v[236:239]
    buffer_load_dwordx4 v158, s[44:47], s13 offen offset:2048 sc1 lds
    v_mfma_f32_16x16x32_bf16 v[232:235], a[56:59], v[124:127], v[232:235]
    ds_read_b64_tr_b16 a[116:117], v153 offset:0
    v_mfma_f32_16x16x32_bf16 v[232:235], a[48:51], v[120:123], v[232:235]
    ds_read_b64_tr_b16 a[118:119], v153 offset:1024
    s_waitcnt lgkmcnt(4)
    v_mfma_f32_16x16x32_bf16 v[192:195], a[64:67], v[80:83], v[192:195]
    s_add_u32 m0, s73, 49152
    s_mul_i32 s14, s76, 589824
    v_mfma_f32_16x16x32_bf16 v[192:195], a[72:75], v[84:87], v[192:195]
    ds_read_b128 v[104:107], v250 offset:13056
    v_mfma_f32_16x16x32_bf16 v[196:199], a[76:79], v[84:87], v[196:199]
    ds_read_b128 v[108:111], v250 offset:19200
    buffer_load_dwordx4 v148, s[48:51], s14 offen offset:0 lds
    v_mfma_f32_16x16x32_bf16 v[196:199], a[68:71], v[80:83], v[196:199]
L_pl_G_2:
    s_cbranch_execz L_pl_G_6
    ds_read_b128 v[112:115], v250 offset:13312
    v_mfma_f32_16x16x32_bf16 v[204:207], a[68:71], v[88:91], v[204:207]
    ds_read_b128 v[116:119], v250 offset:19456
    buffer_load_dwordx4 v149, s[48:51], s14 offen offset:1024 lds
    v_mfma_f32_16x16x32_bf16 v[204:207], a[76:79], v[92:95], v[204:207]
    ds_read_b128 v[120:123], v250 offset:13568
    v_mfma_f32_16x16x32_bf16 v[200:203], a[72:75], v[92:95], v[200:203]
    ds_read_b128 v[124:127], v250 offset:19712
    s_and_b32 s5, s5, 6
    s_add_u32 s4, s4, s5
    s_and_b32 s5, s2, 1
    s_add_u32 s4, s4, s5
    s_lshl_b32 s4, s4, 7
    s_add_u32 s4, s4, 12566528
    v_lshl_add_u32 v15, v2, 2, s4
    s_cmp_eq_u32 s3, 0
    s_cselect_b32 s4, 18, 0
    v_cmp_gt_u32 vcc, s4, v2
    v_mov_b32 v13, 0x40000000
    s_nop 0
    v_cndmask_b32 v15, v13, v15, vcc
    v_mov_b32 v13, s68
    v_cndmask_b32 v13, 0, v13, vcc
    v_and_b32 v24, 15, v2
    v_lshrrev_b32 v25, 4, v2
    v_mul_u32_u24 v25, 17408, v25
    v_lshl_add_u32 v24, v24, 4, v25
    s_mul_i32 s7, s72, 36
    s_and_b32 s8, s3, 1
    s_add_u32 s7, s7, s8
    v_mfma_f32_16x16x32_bf16 v[200:203], a[64:67], v[88:91], v[200:203]
    ds_read_b64_tr_b16 a[120:121], v152 offset:8192
    buffer_load_dwordx4 v150, s[48:51], s14 offen offset:2048 lds
    v_mfma_f32_16x16x32_bf16 v[208:211], a[64:67], v[96:99], v[208:211]
    ds_read_b64_tr_b16 a[122:123], v152 offset:9216
    v_mfma_f32_16x16x32_bf16 v[208:211], a[72:75], v[100:103], v[208:211]
    buffer_load_dwordx4 v151, s[48:51], s14 offen offset:3072 lds
    v_mfma_f32_16x16x32_bf16 v[212:215], a[76:79], v[100:103], v[212:215]
    ds_read_b64_tr_b16 a[124:125], v153 offset:8192
    v_mfma_f32_16x16x32_bf16 v[212:215], a[68:71], v[96:99], v[212:215]
    ds_read_b64_tr_b16 a[126:127], v153 offset:9216
    s_waitcnt lgkmcnt(4)
    v_mfma_f32_16x16x32_bf16 v[220:223], a[68:71], v[104:107], v[220:223]
    s_waitcnt vmcnt(14)
    s_barrier
    v_mfma_f32_16x16x32_bf16 v[220:223], a[76:79], v[108:111], v[220:223]
    ds_read_b128 v[80:83], v250 offset:24576
    s_add_u32 m0, s74, 49152
    s_mul_i32 s13, s76, 90112
    v_mfma_f32_16x16x32_bf16 v[216:219], a[72:75], v[108:111], v[216:219]
    ds_read_b128 v[84:87], v250 offset:30720
    v_mfma_f32_16x16x32_bf16 v[216:219], a[64:67], v[104:107], v[216:219]
    ds_read_b128 v[88:91], v250 offset:24832
    buffer_load_dwordx4 v156, s[44:47], s13 offen offset:0 sc1 lds
    v_mfma_f32_16x16x32_bf16 v[224:227], a[64:67], v[112:115], v[224:227]
    ds_read_b128 v[92:95], v250 offset:30976
    v_mfma_f32_16x16x32_bf16 v[224:227], a[72:75], v[116:119], v[224:227]
    ds_read_b128 v[96:99], v250 offset:25088
    v_mfma_f32_16x16x32_bf16 v[228:231], a[76:79], v[116:119], v[228:231]
    ds_read_b128 v[100:103], v250 offset:31232
    buffer_load_dwordx4 v157, s[44:47], s13 offen offset:1024 sc1 lds
    s_mul_i32 s7, s7, 69632
    s_bfe_u32 s8, s2, 0x20003
    s_lshl_b32 s8, s8, 12
    s_add_u32 s7, s7, s8
    s_add_u32 s7, s7, 12795904
    v_add_u32 v23, s7, v24
    s_xor_b32 s7, s72, 0
    v_lshl_add_u32 v19, s7, 10, v23
    s_xor_b32 s7, s72, 1
    v_lshl_add_u32 v20, s7, 10, v23
    s_xor_b32 s7, s72, 2
    v_lshl_add_u32 v21, s7, 10, v23
    s_xor_b32 s7, s72, 3
    v_lshl_add_u32 v22, s7, 10, v23
    v_lshlrev_b32 v14, 4, v2
    v_add_u32 v14, 98304, v14
    v_add_u32 v1, 0x10000, v14
    s_mov_b32 s56, s16
    v_mfma_f32_16x16x32_bf16 v[228:231], a[68:71], v[112:115], v[228:231]
    ds_read_b64_tr_b16 a[128:129], v152 offset:16384
    v_mfma_f32_16x16x32_bf16 v[236:239], a[68:71], v[120:123], v[236:239]
    ds_read_b64_tr_b16 a[130:131], v152 offset:17408
    v_mfma_f32_16x16x32_bf16 v[236:239], a[76:79], v[124:127], v[236:239]
    buffer_load_dwordx4 v158, s[44:47], s13 offen offset:2048 sc1 lds
    v_mfma_f32_16x16x32_bf16 v[232:235], a[72:75], v[124:127], v[232:235]
    ds_read_b64_tr_b16 a[132:133], v153 offset:16384
    v_mfma_f32_16x16x32_bf16 v[232:235], a[64:67], v[120:123], v[232:235]
    ds_read_b64_tr_b16 a[134:135], v153 offset:17408
    s_waitcnt lgkmcnt(4)
    v_mfma_f32_16x16x32_bf16 v[192:195], a[80:83], v[80:83], v[192:195]
    s_add_u32 m0, s73, 65536
    s_mul_i32 s14, s77, 589824
    v_mfma_f32_16x16x32_bf16 v[192:195], a[88:91], v[84:87], v[192:195]
    ds_read_b128 v[104:107], v250 offset:25344
    v_mfma_f32_16x16x32_bf16 v[196:199], a[92:95], v[84:87], v[196:199]
    ds_read_b128 v[108:111], v250 offset:31488
    buffer_load_dwordx4 v148, s[48:51], s14 offen offset:0 lds
    v_mfma_f32_16x16x32_bf16 v[196:199], a[84:87], v[80:83], v[196:199]
    ds_read_b128 v[112:115], v250 offset:25600
    v_mfma_f32_16x16x32_bf16 v[204:207], a[84:87], v[88:91], v[204:207]
    ds_read_b128 v[116:119], v250 offset:31744
    buffer_load_dwordx4 v149, s[48:51], s14 offen offset:1024 lds
    v_mfma_f32_16x16x32_bf16 v[204:207], a[92:95], v[92:95], v[204:207]
    ds_read_b128 v[120:123], v250 offset:25856
    v_mfma_f32_16x16x32_bf16 v[200:203], a[88:91], v[92:95], v[200:203]
    ds_read_b128 v[124:127], v250 offset:32000
    s_and_b32 s57, s17, 0xffff
    s_mov_b32 s58, 2359296
    s_mov_b32 s59, 0x20000
    s_mov_b32 s40, 18432
    s_mov_b32 s42, 12386304
    s_mov_b32 s64, s38
    s_and_b32 s65, s39, 0xffff
    s_mov_b32 s66, 2359296
    s_mov_b32 s67, 0x20000
    v_lshlrev_b32 v136, 4, v2
    s_mul_i32 s7, s72, 36
    s_bitcmp1_b32 s3, 0
    s_addc_u32 s7, s7, 0
    s_lshl_b32 s7, s7, 17
    v_subrev_u32 v184, s7, v4
    v_subrev_u32 v185, s7, v5
    s_bfe_u32 s4, s2, 0x20003
    s_mul_i32 s4, s4, 9
    v_mfma_f32_16x16x32_bf16 v[200:203], a[80:83], v[88:91], v[200:203]
    ds_read_b64_tr_b16 a[136:137], v152 offset:24576
    buffer_load_dwordx4 v150, s[48:51], s14 offen offset:2048 lds
    v_mfma_f32_16x16x32_bf16 v[208:211], a[80:83], v[96:99], v[208:211]
    ds_read_b64_tr_b16 a[138:139], v152 offset:25600
    v_mfma_f32_16x16x32_bf16 v[208:211], a[88:91], v[100:103], v[208:211]
    buffer_load_dwordx4 v151, s[48:51], s14 offen offset:3072 lds
    v_mfma_f32_16x16x32_bf16 v[212:215], a[92:95], v[100:103], v[212:215]
    ds_read_b64_tr_b16 a[140:141], v153 offset:24576
    v_mfma_f32_16x16x32_bf16 v[212:215], a[84:87], v[96:99], v[212:215]
    ds_read_b64_tr_b16 a[142:143], v153 offset:25600
    s_waitcnt lgkmcnt(4)
    v_mfma_f32_16x16x32_bf16 v[220:223], a[84:87], v[104:107], v[220:223]
    s_waitcnt vmcnt(14)
    s_barrier
    v_mfma_f32_16x16x32_bf16 v[220:223], a[92:95], v[108:111], v[220:223]
    ds_read_b128 v[80:83], v159 offset:0
    s_add_u32 m0, s74, 61440
    s_mul_i32 s13, s77, 90112
    v_mfma_f32_16x16x32_bf16 v[216:219], a[88:91], v[108:111], v[216:219]
    ds_read_b128 v[84:87], v159 offset:6144
    v_mfma_f32_16x16x32_bf16 v[216:219], a[80:83], v[104:107], v[216:219]
    ds_read_b128 v[88:91], v159 offset:256
    buffer_load_dwordx4 v156, s[44:47], s13 offen offset:0 sc1 lds
    v_mfma_f32_16x16x32_bf16 v[224:227], a[80:83], v[112:115], v[224:227]
    ds_read_b128 v[92:95], v159 offset:6400
    v_mfma_f32_16x16x32_bf16 v[224:227], a[88:91], v[116:119], v[224:227]
    ds_read_b128 v[96:99], v159 offset:512
    v_mfma_f32_16x16x32_bf16 v[228:231], a[92:95], v[116:119], v[228:231]
    ds_read_b128 v[100:103], v159 offset:6656
    buffer_load_dwordx4 v157, s[44:47], s13 offen offset:1024 sc1 lds
    s_lshl1_add_u32 s7, s72, s4
    s_and_b32 s8, s3, 1
    s_add_u32 s7, s7, s8
    s_bfe_u32 s8, s2, 65539
    s_add_u32 s7, s7, s8
    s_lshl_b32 s8, s8, 3
    s_sub_u32 s4, s4, s8
    s_lshl_b32 s37, s7, 16
    s_add_u32 s37, s37, 4718592
    s_add_u32 s4, s4, 8
    s_lshl_b32 s16, s4, 16
    s_add_u32 s16, s16, 4718592
    s_sub_u32 s4, s4, s7
    s_lshl_b32 s4, s4, 7
    s_lshl_b32 s7, s7, 7
    v_mfma_f32_16x16x32_bf16 v[228:231], a[84:87], v[112:115], v[228:231]
    ds_read_b64_tr_b16 a[144:145], v152 offset:32768
    v_mfma_f32_16x16x32_bf16 v[236:239], a[84:87], v[120:123], v[236:239]
    ds_read_b64_tr_b16 a[146:147], v152 offset:33792
    v_mfma_f32_16x16x32_bf16 v[236:239], a[92:95], v[124:127], v[236:239]
    buffer_load_dwordx4 v158, s[44:47], s13 offen offset:2048 sc1 lds
    v_mfma_f32_16x16x32_bf16 v[232:235], a[88:91], v[124:127], v[232:235]
    ds_read_b64_tr_b16 a[148:149], v153 offset:32768
    v_mfma_f32_16x16x32_bf16 v[232:235], a[80:83], v[120:123], v[232:235]
    ds_read_b64_tr_b16 a[150:151], v153 offset:33792
    s_waitcnt lgkmcnt(4)
    v_mfma_f32_16x16x32_bf16 v[192:195], a[96:99], v[80:83], v[192:195]
    s_add_u32 m0, s73, 0
    s_mul_i32 s14, s78, 589824
    v_mfma_f32_16x16x32_bf16 v[192:195], a[104:107], v[84:87], v[192:195]
    ds_read_b128 v[104:107], v159 offset:768
    v_mfma_f32_16x16x32_bf16 v[196:199], a[108:111], v[84:87], v[196:199]
    ds_read_b128 v[108:111], v159 offset:6912
    buffer_load_dwordx4 v148, s[48:51], s14 offen offset:0 lds
    v_mfma_f32_16x16x32_bf16 v[196:199], a[100:103], v[80:83], v[196:199]
    ds_read_b128 v[112:115], v159 offset:1024
    v_mfma_f32_16x16x32_bf16 v[204:207], a[100:103], v[88:91], v[204:207]
    ds_read_b128 v[116:119], v159 offset:7168
    buffer_load_dwordx4 v149, s[48:51], s14 offen offset:1024 lds
    v_mfma_f32_16x16x32_bf16 v[204:207], a[108:111], v[92:95], v[204:207]
    ds_read_b128 v[120:123], v159 offset:1280
    v_mfma_f32_16x16x32_bf16 v[200:203], a[104:107], v[92:95], v[200:203]
    ds_read_b128 v[124:127], v159 offset:7424
    s_add_u32 s7, s7, 12582912
    v_bfe_u32 v24, v2, 2, 1
    v_mul_i32_i24 v24, s4, v24
    v_and_b32 v25, 3, v2
    v_lshl_add_u32 v24, v25, 2, v24
    v_add_u32 v188, s7, v24
    s_lshl2_add_u32 s7, s2, s3
    s_mul_i32 s8, s7, 3072
    s_add_u32 s34, s8, 22953984
    s_add_u32 s11, s8, 26099712
    s_add_u32 s12, s8, 29245440
    s_lshl_b32 s35, s7, 12
    s_add_u32 s35, s35, 32391168
    s_xor_b32 s8, s7, 8
    s_mul_i32 s8, s8, 3072
    v_mfma_f32_16x16x32_bf16 v[200:203], a[96:99], v[88:91], v[200:203]
    ds_read_b64_tr_b16 a[152:153], v152 offset:40960
    buffer_load_dwordx4 v150, s[48:51], s14 offen offset:2048 lds
    v_mfma_f32_16x16x32_bf16 v[208:211], a[96:99], v[96:99], v[208:211]
    ds_read_b64_tr_b16 a[154:155], v152 offset:41984
    v_mfma_f32_16x16x32_bf16 v[208:211], a[104:107], v[100:103], v[208:211]
    buffer_load_dwordx4 v151, s[48:51], s14 offen offset:3072 lds
    v_mfma_f32_16x16x32_bf16 v[212:215], a[108:111], v[100:103], v[212:215]
    ds_read_b64_tr_b16 a[156:157], v153 offset:40960
    v_mfma_f32_16x16x32_bf16 v[212:215], a[100:103], v[96:99], v[212:215]
    ds_read_b64_tr_b16 a[158:159], v153 offset:41984
    s_waitcnt lgkmcnt(4)
    v_mfma_f32_16x16x32_bf16 v[220:223], a[100:103], v[104:107], v[220:223]
    s_waitcnt vmcnt(14)
    s_barrier
    v_mfma_f32_16x16x32_bf16 v[220:223], a[108:111], v[108:111], v[220:223]
    ds_read_b128 v[80:83], v159 offset:12288
    s_add_u32 m0, s74, 0
    s_mul_i32 s13, s78, 90112
    v_mfma_f32_16x16x32_bf16 v[216:219], a[104:107], v[108:111], v[216:219]
    ds_read_b128 v[84:87], v159 offset:18432
    v_mfma_f32_16x16x32_bf16 v[216:219], a[96:99], v[104:107], v[216:219]
    ds_read_b128 v[88:91], v159 offset:12544
    buffer_load_dwordx4 v156, s[44:47], s13 offen offset:0 sc1 lds
    v_mfma_f32_16x16x32_bf16 v[224:227], a[96:99], v[112:115], v[224:227]
    ds_read_b128 v[92:95], v159 offset:18688
    v_mfma_f32_16x16x32_bf16 v[224:227], a[104:107], v[116:119], v[224:227]
    ds_read_b128 v[96:99], v159 offset:12800
    v_mfma_f32_16x16x32_bf16 v[228:231], a[108:111], v[116:119], v[228:231]
    ds_read_b128 v[100:103], v159 offset:18944
    buffer_load_dwordx4 v157, s[44:47], s13 offen offset:1024 sc1 lds
    s_add_u32 s30, s8, 22953984
    s_xor_b32 s8, s7, 16
    s_mul_i32 s8, s8, 3072
    s_add_u32 s15, s8, 26099712
    s_xor_b32 s8, s7, 24
    s_mul_i32 s8, s8, 3072
    s_add_u32 s31, s8, 29245440
    s_andn2_b32 s7, s7, 24
    s_lshl3_add_u32 s7, s3, s7
    s_lshl2_add_u32 s8, s7, s72
    s_lshl_b32 s8, s8, 10
    s_add_u32 s32, s8, 32391168
    v_mfma_f32_16x16x32_bf16 v[228:231], a[100:103], v[112:115], v[228:231]
    ds_read_b64_tr_b16 a[160:161], v152 offset:49152
    v_mfma_f32_16x16x32_bf16 v[236:239], a[100:103], v[120:123], v[236:239]
    ds_read_b64_tr_b16 a[162:163], v152 offset:50176
    v_mfma_f32_16x16x32_bf16 v[236:239], a[108:111], v[124:127], v[236:239]
    buffer_load_dwordx4 v158, s[44:47], s13 offen offset:2048 sc1 lds
    v_mfma_f32_16x16x32_bf16 v[232:235], a[104:107], v[124:127], v[232:235]
    ds_read_b64_tr_b16 a[164:165], v153 offset:49152
    v_mfma_f32_16x16x32_bf16 v[232:235], a[96:99], v[120:123], v[232:235]
    ds_read_b64_tr_b16 a[166:167], v153 offset:50176
    s_waitcnt lgkmcnt(4)
    v_mfma_f32_16x16x32_bf16 v[192:195], a[112:115], v[80:83], v[192:195]
    s_add_u32 m0, s73, 16384
    s_mul_i32 s14, s79, 589824
    v_mfma_f32_16x16x32_bf16 v[192:195], a[120:123], v[84:87], v[192:195]
    ds_read_b128 v[104:107], v159 offset:13056
    v_mfma_f32_16x16x32_bf16 v[196:199], a[124:127], v[84:87], v[196:199]
    ds_read_b128 v[108:111], v159 offset:19200
    buffer_load_dwordx4 v148, s[48:51], s14 offen offset:0 lds
    v_mfma_f32_16x16x32_bf16 v[196:199], a[116:119], v[80:83], v[196:199]
    ds_read_b128 v[112:115], v159 offset:13312
    v_mfma_f32_16x16x32_bf16 v[204:207], a[116:119], v[88:91], v[204:207]
    ds_read_b128 v[116:119], v159 offset:19456
    buffer_load_dwordx4 v149, s[48:51], s14 offen offset:1024 lds
    v_mfma_f32_16x16x32_bf16 v[204:207], a[124:127], v[92:95], v[204:207]
    ds_read_b128 v[120:123], v159 offset:13568
    v_mfma_f32_16x16x32_bf16 v[200:203], a[120:123], v[92:95], v[200:203]
    ds_read_b128 v[124:127], v159 offset:19712
    s_xor_b32 s8, s8, 4096
    s_add_u32 s33, s8, 32391168
    s_xor_b32 s8, s3, s72
    s_cmp_lt_u32 s8, 2
    s_cselect_b32 s35, s35, 0x40000000
    s_cselect_b32 s16, s16, 0x40000000
    s_cselect_b32 s36, s68, 0
    s_mov_b32 s38, 0xbfb8aa3b
    s_and_b32 s8, s8, 1
    s_mul_i32 s41, s8, 96
    s_and_b32 s43, s73, 4096
    v_lshlrev_b32 v24, 10, v2
    v_add_u32 v24, s35, v24
    s_add_u32 s7, s34, 2048
    v_mov_b32 v25, s36
    v_mfma_f32_16x16x32_bf16 v[200:203], a[112:115], v[88:91], v[200:203]
    ds_read_b64_tr_b16 a[168:169], v152 offset:57344
    buffer_load_dwordx4 v150, s[48:51], s14 offen offset:2048 lds
    v_mfma_f32_16x16x32_bf16 v[208:211], a[112:115], v[96:99], v[208:211]
    ds_read_b64_tr_b16 a[170:171], v152 offset:58368
    v_mfma_f32_16x16x32_bf16 v[208:211], a[120:123], v[100:103], v[208:211]
    buffer_load_dwordx4 v151, s[48:51], s14 offen offset:3072 lds
    v_mfma_f32_16x16x32_bf16 v[212:215], a[124:127], v[100:103], v[212:215]
    ds_read_b64_tr_b16 a[172:173], v153 offset:57344
    v_mfma_f32_16x16x32_bf16 v[212:215], a[116:119], v[96:99], v[212:215]
    ds_read_b64_tr_b16 a[174:175], v153 offset:58368
    s_waitcnt lgkmcnt(4)
    v_mfma_f32_16x16x32_bf16 v[220:223], a[116:119], v[104:107], v[220:223]
    s_waitcnt vmcnt(14)
    s_barrier
    v_mfma_f32_16x16x32_bf16 v[220:223], a[124:127], v[108:111], v[220:223]
    ds_read_b128 v[80:83], v159 offset:24576
    s_add_u32 m0, s74, 12288
    s_mul_i32 s13, s79, 90112
    v_mfma_f32_16x16x32_bf16 v[216:219], a[120:123], v[108:111], v[216:219]
    ds_read_b128 v[84:87], v159 offset:30720
    v_mfma_f32_16x16x32_bf16 v[216:219], a[112:115], v[104:107], v[216:219]
    ds_read_b128 v[88:91], v159 offset:24832
    buffer_load_dwordx4 v156, s[44:47], s13 offen offset:0 sc1 lds
    v_mfma_f32_16x16x32_bf16 v[224:227], a[112:115], v[112:115], v[224:227]
    ds_read_b128 v[92:95], v159 offset:30976
    v_mfma_f32_16x16x32_bf16 v[224:227], a[120:123], v[116:119], v[224:227]
    ds_read_b128 v[96:99], v159 offset:25088
    v_mfma_f32_16x16x32_bf16 v[228:231], a[124:127], v[116:119], v[228:231]
    ds_read_b128 v[100:103], v159 offset:31232
    buffer_load_dwordx4 v157, s[44:47], s13 offen offset:1024 sc1 lds
    v_cmp_gt_u32 vcc, 4, v2
    s_nop 1
    v_cndmask_b32 v138, 0, v25, vcc
    v_mov_b32 v25, 0x40000000
    v_cndmask_b32 v137, v25, v24, vcc
    v_writelane_b32 v137, s7, 4
    v_writelane_b32 v138, s68, 4
    v_min_u32 v139, 1, v2
    v_lshlrev_b32 v139, 30, v139
    v_mov_b32 v140, 0
    v_writelane_b32 v140, s68, 0
    v_mfma_f32_16x16x32_bf16 v[228:231], a[116:119], v[112:115], v[228:231]
    ds_read_b64_tr_b16 a[176:177], v154 offset:0
    v_mfma_f32_16x16x32_bf16 v[236:239], a[116:119], v[120:123], v[236:239]
    ds_read_b64_tr_b16 a[178:179], v154 offset:1024
    v_mfma_f32_16x16x32_bf16 v[236:239], a[124:127], v[124:127], v[236:239]
    buffer_load_dwordx4 v158, s[44:47], s13 offen offset:2048 sc1 lds
    v_mfma_f32_16x16x32_bf16 v[232:235], a[120:123], v[124:127], v[232:235]
    ds_read_b64_tr_b16 a[180:181], v155 offset:0
    v_mfma_f32_16x16x32_bf16 v[232:235], a[112:115], v[120:123], v[232:235]
    ds_read_b64_tr_b16 a[182:183], v155 offset:1024
    s_waitcnt lgkmcnt(4)
    v_mfma_f32_16x16x32_bf16 v[192:195], a[128:131], v[80:83], v[192:195]
    s_add_u32 m0, s73, 32768
    s_mul_i32 s14, s80, 589824
    v_mfma_f32_16x16x32_bf16 v[192:195], a[136:139], v[84:87], v[192:195]
    ds_read_b128 v[104:107], v159 offset:25344
    v_mfma_f32_16x16x32_bf16 v[196:199], a[140:143], v[84:87], v[196:199]
    ds_read_b128 v[108:111], v159 offset:31488
    buffer_load_dwordx4 v148, s[48:51], s14 offen offset:0 lds
    v_mfma_f32_16x16x32_bf16 v[196:199], a[132:135], v[80:83], v[196:199]
    ds_read_b128 v[112:115], v159 offset:25600
    v_mfma_f32_16x16x32_bf16 v[204:207], a[132:135], v[88:91], v[204:207]
    ds_read_b128 v[116:119], v159 offset:31744
    buffer_load_dwordx4 v149, s[48:51], s14 offen offset:1024 lds
    v_mfma_f32_16x16x32_bf16 v[204:207], a[140:143], v[92:95], v[204:207]
    ds_read_b128 v[120:123], v159 offset:25856
    v_mfma_f32_16x16x32_bf16 v[200:203], a[136:139], v[92:95], v[200:203]
    ds_read_b128 v[124:127], v159 offset:32000
    v_mfma_f32_16x16x32_bf16 v[200:203], a[128:131], v[88:91], v[200:203]
    ds_read_b64_tr_b16 a[184:185], v154 offset:8192
    buffer_load_dwordx4 v150, s[48:51], s14 offen offset:2048 lds
    v_mfma_f32_16x16x32_bf16 v[208:211], a[128:131], v[96:99], v[208:211]
    ds_read_b64_tr_b16 a[186:187], v154 offset:9216
    v_mfma_f32_16x16x32_bf16 v[208:211], a[136:139], v[100:103], v[208:211]
    buffer_load_dwordx4 v151, s[48:51], s14 offen offset:3072 lds
    v_mfma_f32_16x16x32_bf16 v[212:215], a[140:143], v[100:103], v[212:215]
    ds_read_b64_tr_b16 a[188:189], v155 offset:8192
    v_mfma_f32_16x16x32_bf16 v[212:215], a[132:135], v[96:99], v[212:215]
    ds_read_b64_tr_b16 a[190:191], v155 offset:9216
    s_waitcnt lgkmcnt(4)
    v_mfma_f32_16x16x32_bf16 v[220:223], a[132:135], v[104:107], v[220:223]
    s_waitcnt vmcnt(14)
    s_barrier
    v_mfma_f32_16x16x32_bf16 v[220:223], a[140:143], v[108:111], v[220:223]
    ds_read_b128 v[80:83], v250 offset:0
    s_add_u32 m0, s74, 24576
    s_mul_i32 s13, s80, 90112
    v_mfma_f32_16x16x32_bf16 v[216:219], a[136:139], v[108:111], v[216:219]
    ds_read_b128 v[84:87], v250 offset:6144
    v_mfma_f32_16x16x32_bf16 v[216:219], a[128:131], v[104:107], v[216:219]
    ds_read_b128 v[88:91], v250 offset:256
    buffer_load_dwordx4 v156, s[44:47], s13 offen offset:0 sc1 lds
    v_mfma_f32_16x16x32_bf16 v[224:227], a[128:131], v[112:115], v[224:227]
    ds_read_b128 v[92:95], v250 offset:6400
    v_mfma_f32_16x16x32_bf16 v[224:227], a[136:139], v[116:119], v[224:227]
    ds_read_b128 v[96:99], v250 offset:512
    v_mfma_f32_16x16x32_bf16 v[228:231], a[140:143], v[116:119], v[228:231]
    ds_read_b128 v[100:103], v250 offset:6656
    buffer_load_dwordx4 v157, s[44:47], s13 offen offset:1024 sc1 lds
    v_mfma_f32_16x16x32_bf16 v[228:231], a[132:135], v[112:115], v[228:231]
    ds_read_b64_tr_b16 a[192:193], v152 offset:0
    v_mfma_f32_16x16x32_bf16 v[236:239], a[132:135], v[120:123], v[236:239]
    ds_read_b64_tr_b16 a[194:195], v152 offset:1024
    v_mfma_f32_16x16x32_bf16 v[236:239], a[140:143], v[124:127], v[236:239]
    buffer_load_dwordx4 v158, s[44:47], s13 offen offset:2048 sc1 lds
    v_mfma_f32_16x16x32_bf16 v[232:235], a[136:139], v[124:127], v[232:235]
    ds_read_b64_tr_b16 a[196:197], v153 offset:0
    v_mfma_f32_16x16x32_bf16 v[232:235], a[128:131], v[120:123], v[232:235]
    ds_read_b64_tr_b16 a[198:199], v153 offset:1024
    s_waitcnt lgkmcnt(4)
    v_mfma_f32_16x16x32_bf16 v[192:195], a[144:147], v[80:83], v[192:195]
    s_add_u32 m0, s73, 49152
    s_mul_i32 s14, s81, 589824
    v_mfma_f32_16x16x32_bf16 v[192:195], a[152:155], v[84:87], v[192:195]
    ds_read_b128 v[104:107], v250 offset:768
    v_mfma_f32_16x16x32_bf16 v[196:199], a[156:159], v[84:87], v[196:199]
    ds_read_b128 v[108:111], v250 offset:6912
    buffer_load_dwordx4 v148, s[48:51], s14 offen offset:0 lds
    v_mfma_f32_16x16x32_bf16 v[196:199], a[148:151], v[80:83], v[196:199]
    ds_read_b128 v[112:115], v250 offset:1024
    v_mfma_f32_16x16x32_bf16 v[204:207], a[148:151], v[88:91], v[204:207]
    ds_read_b128 v[116:119], v250 offset:7168
    buffer_load_dwordx4 v149, s[48:51], s14 offen offset:1024 lds
    v_mfma_f32_16x16x32_bf16 v[204:207], a[156:159], v[92:95], v[204:207]
    ds_read_b128 v[120:123], v250 offset:1280
    v_mfma_f32_16x16x32_bf16 v[200:203], a[152:155], v[92:95], v[200:203]
    ds_read_b128 v[124:127], v250 offset:7424
    v_mfma_f32_16x16x32_bf16 v[200:203], a[144:147], v[88:91], v[200:203]
    ds_read_b64_tr_b16 a[200:201], v152 offset:8192
    buffer_load_dwordx4 v150, s[48:51], s14 offen offset:2048 lds
    v_mfma_f32_16x16x32_bf16 v[208:211], a[144:147], v[96:99], v[208:211]
    ds_read_b64_tr_b16 a[202:203], v152 offset:9216
    v_mfma_f32_16x16x32_bf16 v[208:211], a[152:155], v[100:103], v[208:211]
    buffer_load_dwordx4 v151, s[48:51], s14 offen offset:3072 lds
    v_mfma_f32_16x16x32_bf16 v[212:215], a[156:159], v[100:103], v[212:215]
    ds_read_b64_tr_b16 a[204:205], v153 offset:8192
    v_mfma_f32_16x16x32_bf16 v[212:215], a[148:151], v[96:99], v[212:215]
    ds_read_b64_tr_b16 a[206:207], v153 offset:9216
    s_waitcnt lgkmcnt(4)
    v_mfma_f32_16x16x32_bf16 v[220:223], a[148:151], v[104:107], v[220:223]
    s_waitcnt vmcnt(14)
    s_barrier
    v_mfma_f32_16x16x32_bf16 v[220:223], a[156:159], v[108:111], v[220:223]
    ds_read_b128 v[80:83], v250 offset:12288
    s_add_u32 m0, s74, 36864
    s_mul_i32 s13, s81, 90112
    v_mfma_f32_16x16x32_bf16 v[216:219], a[152:155], v[108:111], v[216:219]
    ds_read_b128 v[84:87], v250 offset:18432
    v_mfma_f32_16x16x32_bf16 v[216:219], a[144:147], v[104:107], v[216:219]
    ds_read_b128 v[88:91], v250 offset:12544
    buffer_load_dwordx4 v156, s[44:47], s13 offen offset:0 sc1 lds
    v_mfma_f32_16x16x32_bf16 v[224:227], a[144:147], v[112:115], v[224:227]
    ds_read_b128 v[92:95], v250 offset:18688
    v_mfma_f32_16x16x32_bf16 v[224:227], a[152:155], v[116:119], v[224:227]
    ds_read_b128 v[96:99], v250 offset:12800
    v_mfma_f32_16x16x32_bf16 v[228:231], a[156:159], v[116:119], v[228:231]
    ds_read_b128 v[100:103], v250 offset:18944
    buffer_load_dwordx4 v157, s[44:47], s13 offen offset:1024 sc1 lds
    v_mfma_f32_16x16x32_bf16 v[228:231], a[148:151], v[112:115], v[228:231]
    ds_read_b64_tr_b16 a[208:209], v152 offset:16384
    v_mfma_f32_16x16x32_bf16 v[236:239], a[148:151], v[120:123], v[236:239]
    ds_read_b64_tr_b16 a[210:211], v152 offset:17408
    v_mfma_f32_16x16x32_bf16 v[236:239], a[156:159], v[124:127], v[236:239]
    buffer_load_dwordx4 v158, s[44:47], s13 offen offset:2048 sc1 lds
    v_mfma_f32_16x16x32_bf16 v[232:235], a[152:155], v[124:127], v[232:235]
    ds_read_b64_tr_b16 a[212:213], v153 offset:16384
    v_mfma_f32_16x16x32_bf16 v[232:235], a[144:147], v[120:123], v[232:235]
    ds_read_b64_tr_b16 a[214:215], v153 offset:17408
    s_waitcnt lgkmcnt(4)
    v_mfma_f32_16x16x32_bf16 v[192:195], a[160:163], v[80:83], v[192:195]
    s_add_u32 m0, s73, 65536
    s_lshl_b32 s14, s84, 18
    v_mfma_f32_16x16x32_bf16 v[192:195], a[168:171], v[84:87], v[192:195]
    ds_read_b128 v[104:107], v250 offset:13056
    v_mfma_f32_16x16x32_bf16 v[196:199], a[172:175], v[84:87], v[196:199]
    ds_read_b128 v[108:111], v250 offset:19200
    buffer_load_dwordx4 v4, s[52:55], s14 offen offset:0 lds
    v_mfma_f32_16x16x32_bf16 v[196:199], a[164:167], v[80:83], v[196:199]
    ds_read_b128 v[112:115], v250 offset:13312
    v_mfma_f32_16x16x32_bf16 v[204:207], a[164:167], v[88:91], v[204:207]
    ds_read_b128 v[116:119], v250 offset:19456
    buffer_load_dwordx4 v5, s[52:55], s14 offen offset:1024 lds
    v_mfma_f32_16x16x32_bf16 v[204:207], a[172:175], v[92:95], v[204:207]
    ds_read_b128 v[120:123], v250 offset:13568
    v_mfma_f32_16x16x32_bf16 v[200:203], a[168:171], v[92:95], v[200:203]
    ds_read_b128 v[124:127], v250 offset:19712
    v_mfma_f32_16x16x32_bf16 v[200:203], a[160:163], v[88:91], v[200:203]
    ds_read_b64_tr_b16 a[216:217], v152 offset:24576
    buffer_load_dwordx4 v6, s[52:55], s14 offen offset:2048 lds
    v_mfma_f32_16x16x32_bf16 v[208:211], a[160:163], v[96:99], v[208:211]
    ds_read_b64_tr_b16 a[218:219], v152 offset:25600
    v_mfma_f32_16x16x32_bf16 v[208:211], a[168:171], v[100:103], v[208:211]
    buffer_load_dwordx4 v7, s[52:55], s14 offen offset:3072 lds
    v_mfma_f32_16x16x32_bf16 v[212:215], a[172:175], v[100:103], v[212:215]
    ds_read_b64_tr_b16 a[220:221], v153 offset:24576
    v_mfma_f32_16x16x32_bf16 v[212:215], a[164:167], v[96:99], v[212:215]
    ds_read_b64_tr_b16 a[222:223], v153 offset:25600
    s_waitcnt lgkmcnt(4)
    v_mfma_f32_16x16x32_bf16 v[220:223], a[164:167], v[104:107], v[220:223]
    s_waitcnt vmcnt(14)
    s_barrier
    v_mfma_f32_16x16x32_bf16 v[220:223], a[172:175], v[108:111], v[220:223]
    ds_read_b128 v[80:83], v250 offset:24576
    v_mfma_f32_16x16x32_bf16 v[216:219], a[168:171], v[108:111], v[216:219]
    ds_read_b128 v[84:87], v250 offset:30720
    v_mfma_f32_16x16x32_bf16 v[216:219], a[160:163], v[104:107], v[216:219]
    ds_read_b128 v[88:91], v250 offset:24832
    v_mfma_f32_16x16x32_bf16 v[224:227], a[160:163], v[112:115], v[224:227]
    ds_read_b128 v[92:95], v250 offset:30976
    v_mfma_f32_16x16x32_bf16 v[224:227], a[168:171], v[116:119], v[224:227]
    ds_read_b128 v[96:99], v250 offset:25088
    v_mfma_f32_16x16x32_bf16 v[228:231], a[172:175], v[116:119], v[228:231]
    ds_read_b128 v[100:103], v250 offset:31232
    v_mfma_f32_16x16x32_bf16 v[228:231], a[164:167], v[112:115], v[228:231]
    ds_read_b64_tr_b16 a[224:225], v152 offset:32768
    v_mfma_f32_16x16x32_bf16 v[236:239], a[164:167], v[120:123], v[236:239]
    ds_read_b64_tr_b16 a[226:227], v152 offset:33792
    v_mfma_f32_16x16x32_bf16 v[236:239], a[172:175], v[124:127], v[236:239]
    v_mfma_f32_16x16x32_bf16 v[232:235], a[168:171], v[124:127], v[232:235]
    ds_read_b64_tr_b16 a[228:229], v153 offset:32768
    v_mfma_f32_16x16x32_bf16 v[232:235], a[160:163], v[120:123], v[232:235]
    ds_read_b64_tr_b16 a[230:231], v153 offset:33792
    s_waitcnt lgkmcnt(4)
    v_mfma_f32_16x16x32_bf16 v[192:195], a[176:179], v[80:83], v[192:195]
    v_mfma_f32_16x16x32_bf16 v[192:195], a[184:187], v[84:87], v[192:195]
    ds_read_b128 v[104:107], v250 offset:25344
    v_mfma_f32_16x16x32_bf16 v[196:199], a[188:191], v[84:87], v[196:199]
    ds_read_b128 v[108:111], v250 offset:31488
    v_mfma_f32_16x16x32_bf16 v[196:199], a[180:183], v[80:83], v[196:199]
    ds_read_b128 v[112:115], v250 offset:25600
    v_mfma_f32_16x16x32_bf16 v[204:207], a[180:183], v[88:91], v[204:207]
    ds_read_b128 v[116:119], v250 offset:31744
    v_mfma_f32_16x16x32_bf16 v[204:207], a[188:191], v[92:95], v[204:207]
    ds_read_b128 v[120:123], v250 offset:25856
    v_mfma_f32_16x16x32_bf16 v[200:203], a[184:187], v[92:95], v[200:203]
    ds_read_b128 v[124:127], v250 offset:32000
    v_mfma_f32_16x16x32_bf16 v[200:203], a[176:179], v[88:91], v[200:203]
    ds_read_b64_tr_b16 a[232:233], v152 offset:40960
    v_mfma_f32_16x16x32_bf16 v[208:211], a[176:179], v[96:99], v[208:211]
    ds_read_b64_tr_b16 a[234:235], v152 offset:41984
    v_mfma_f32_16x16x32_bf16 v[208:211], a[184:187], v[100:103], v[208:211]
    v_mfma_f32_16x16x32_bf16 v[212:215], a[188:191], v[100:103], v[212:215]
    ds_read_b64_tr_b16 a[236:237], v153 offset:40960
    v_mfma_f32_16x16x32_bf16 v[212:215], a[180:183], v[96:99], v[212:215]
    ds_read_b64_tr_b16 a[238:239], v153 offset:41984
    s_waitcnt lgkmcnt(4)
    v_mfma_f32_16x16x32_bf16 v[220:223], a[180:183], v[104:107], v[220:223]
    s_waitcnt vmcnt(7)
    s_barrier
    v_mfma_f32_16x16x32_bf16 v[220:223], a[188:191], v[108:111], v[220:223]
    ds_read_b128 v[80:83], v159 offset:0
    v_mfma_f32_16x16x32_bf16 v[216:219], a[184:187], v[108:111], v[216:219]
    ds_read_b128 v[84:87], v159 offset:6144
    v_mfma_f32_16x16x32_bf16 v[216:219], a[176:179], v[104:107], v[216:219]
    ds_read_b128 v[88:91], v159 offset:256
    v_mfma_f32_16x16x32_bf16 v[224:227], a[176:179], v[112:115], v[224:227]
    ds_read_b128 v[92:95], v159 offset:6400
    v_mfma_f32_16x16x32_bf16 v[224:227], a[184:187], v[116:119], v[224:227]
    ds_read_b128 v[96:99], v159 offset:512
    v_mfma_f32_16x16x32_bf16 v[228:231], a[188:191], v[116:119], v[228:231]
    ds_read_b128 v[100:103], v159 offset:6656
    v_mfma_f32_16x16x32_bf16 v[228:231], a[180:183], v[112:115], v[228:231]
    ds_read_b64_tr_b16 a[240:241], v152 offset:49152
    v_mfma_f32_16x16x32_bf16 v[236:239], a[180:183], v[120:123], v[236:239]
    ds_read_b64_tr_b16 a[242:243], v152 offset:50176
L_pl_G_3:
    s_cbranch_execz L_wret
    v_mfma_f32_16x16x32_bf16 v[236:239], a[188:191], v[124:127], v[236:239]
    v_mfma_f32_16x16x32_bf16 v[232:235], a[184:187], v[124:127], v[232:235]
    ds_read_b64_tr_b16 a[244:245], v153 offset:49152
    v_mfma_f32_16x16x32_bf16 v[232:235], a[176:179], v[120:123], v[232:235]
    ds_read_b64_tr_b16 a[246:247], v153 offset:50176
    s_waitcnt lgkmcnt(4)
    v_mfma_f32_16x16x32_bf16 v[192:195], a[192:195], v[80:83], v[192:195]
    v_mfma_f32_16x16x32_bf16 v[192:195], a[200:203], v[84:87], v[192:195]
    ds_read_b128 v[104:107], v159 offset:768
    v_mfma_f32_16x16x32_bf16 v[196:199], a[204:207], v[84:87], v[196:199]
    ds_read_b128 v[108:111], v159 offset:6912
    v_mfma_f32_16x16x32_bf16 v[196:199], a[196:199], v[80:83], v[196:199]
    ds_read_b128 v[112:115], v159 offset:1024
    v_mfma_f32_16x16x32_bf16 v[204:207], a[196:199], v[88:91], v[204:207]
    ds_read_b128 v[116:119], v159 offset:7168
    v_mfma_f32_16x16x32_bf16 v[204:207], a[204:207], v[92:95], v[204:207]
    ds_read_b128 v[120:123], v159 offset:1280
    v_mfma_f32_16x16x32_bf16 v[200:203], a[200:203], v[92:95], v[200:203]
    ds_read_b128 v[124:127], v159 offset:7424
    v_mfma_f32_16x16x32_bf16 v[200:203], a[192:195], v[88:91], v[200:203]
    ds_read_b64_tr_b16 a[248:249], v152 offset:57344
    v_mfma_f32_16x16x32_bf16 v[208:211], a[192:195], v[96:99], v[208:211]
    ds_read_b64_tr_b16 a[250:251], v152 offset:58368
    v_mfma_f32_16x16x32_bf16 v[208:211], a[200:203], v[100:103], v[208:211]
    v_mfma_f32_16x16x32_bf16 v[212:215], a[204:207], v[100:103], v[212:215]
    ds_read_b64_tr_b16 a[252:253], v153 offset:57344
    v_mfma_f32_16x16x32_bf16 v[212:215], a[196:199], v[96:99], v[212:215]
    ds_read_b64_tr_b16 a[254:255], v153 offset:58368
    s_waitcnt lgkmcnt(4)
    v_mfma_f32_16x16x32_bf16 v[220:223], a[196:199], v[104:107], v[220:223]
    s_barrier
    v_mfma_f32_16x16x32_bf16 v[220:223], a[204:207], v[108:111], v[220:223]
    ds_read_b128 v[80:83], v159 offset:12288
    s_add_u32 m0, s74, 49152
    s_mul_i32 s13, s18, 90112
    v_mfma_f32_16x16x32_bf16 v[216:219], a[200:203], v[108:111], v[216:219]
    ds_read_b128 v[84:87], v159 offset:18432
    v_mfma_f32_16x16x32_bf16 v[216:219], a[192:195], v[104:107], v[216:219]
    ds_read_b128 v[88:91], v159 offset:12544
    buffer_load_dwordx4 v8, s[44:47], s13 offen offset:0 sc1 lds
    v_mfma_f32_16x16x32_bf16 v[224:227], a[192:195], v[112:115], v[224:227]
    ds_read_b128 v[92:95], v159 offset:18688
    v_mfma_f32_16x16x32_bf16 v[224:227], a[200:203], v[116:119], v[224:227]
    ds_read_b128 v[96:99], v159 offset:12800
    v_mfma_f32_16x16x32_bf16 v[228:231], a[204:207], v[116:119], v[228:231]
    ds_read_b128 v[100:103], v159 offset:18944
    buffer_load_dwordx4 v9, s[44:47], s13 offen offset:1024 sc1 lds
    v_mfma_f32_16x16x32_bf16 v[228:231], a[196:199], v[112:115], v[228:231]
    v_mfma_f32_16x16x32_bf16 v[236:239], a[196:199], v[120:123], v[236:239]
    v_mfma_f32_16x16x32_bf16 v[236:239], a[204:207], v[124:127], v[236:239]
    buffer_load_dwordx4 v3, s[44:47], s13 offen offset:2048 sc1 lds
    v_mfma_f32_16x16x32_bf16 v[232:235], a[200:203], v[124:127], v[232:235]
    v_mfma_f32_16x16x32_bf16 v[232:235], a[192:195], v[120:123], v[232:235]
    s_waitcnt lgkmcnt(0)
    v_mfma_f32_16x16x32_bf16 v[192:195], a[208:211], v[80:83], v[192:195]
    s_add_u32 m0, s74, 61440
    s_mul_i32 s13, s19, 90112
    v_mfma_f32_16x16x32_bf16 v[192:195], a[216:219], v[84:87], v[192:195]
    ds_read_b128 v[104:107], v159 offset:13056
    v_mfma_f32_16x16x32_bf16 v[196:199], a[220:223], v[84:87], v[196:199]
    ds_read_b128 v[108:111], v159 offset:19200
    v_mfma_f32_16x16x32_bf16 v[196:199], a[212:215], v[80:83], v[196:199]
    ds_read_b128 v[112:115], v159 offset:13312
    buffer_load_dwordx4 v8, s[44:47], s13 offen offset:0 sc1 lds
    v_mfma_f32_16x16x32_bf16 v[204:207], a[212:215], v[88:91], v[204:207]
    ds_read_b128 v[116:119], v159 offset:19456
    v_mfma_f32_16x16x32_bf16 v[204:207], a[220:223], v[92:95], v[204:207]
    ds_read_b128 v[120:123], v159 offset:13568
    v_mfma_f32_16x16x32_bf16 v[200:203], a[216:219], v[92:95], v[200:203]
    ds_read_b128 v[124:127], v159 offset:19712
    buffer_load_dwordx4 v9, s[44:47], s13 offen offset:1024 sc1 lds
    v_mfma_f32_16x16x32_bf16 v[200:203], a[208:211], v[88:91], v[200:203]
    v_mfma_f32_16x16x32_bf16 v[208:211], a[208:211], v[96:99], v[208:211]
    v_mfma_f32_16x16x32_bf16 v[208:211], a[216:219], v[100:103], v[208:211]
    buffer_load_dwordx4 v3, s[44:47], s13 offen offset:2048 sc1 lds
    v_mfma_f32_16x16x32_bf16 v[212:215], a[220:223], v[100:103], v[212:215]
    v_mfma_f32_16x16x32_bf16 v[212:215], a[212:215], v[96:99], v[212:215]
    s_waitcnt lgkmcnt(0)
    v_mfma_f32_16x16x32_bf16 v[220:223], a[212:215], v[104:107], v[220:223]
    s_barrier
    v_mfma_f32_16x16x32_bf16 v[220:223], a[220:223], v[108:111], v[220:223]
    ds_read_b128 v[80:83], v159 offset:24576
    s_add_u32 m0, s74, 0
    s_mul_i32 s13, s20, 90112
    v_mfma_f32_16x16x32_bf16 v[216:219], a[216:219], v[108:111], v[216:219]
    ds_read_b128 v[84:87], v159 offset:30720
    v_mfma_f32_16x16x32_bf16 v[216:219], a[208:211], v[104:107], v[216:219]
    ds_read_b128 v[88:91], v159 offset:24832
    buffer_load_dwordx4 v8, s[44:47], s13 offen offset:0 sc1 lds
    v_mfma_f32_16x16x32_bf16 v[224:227], a[208:211], v[112:115], v[224:227]
    ds_read_b128 v[92:95], v159 offset:30976
    v_mfma_f32_16x16x32_bf16 v[224:227], a[216:219], v[116:119], v[224:227]
    ds_read_b128 v[96:99], v159 offset:25088
    v_mfma_f32_16x16x32_bf16 v[228:231], a[220:223], v[116:119], v[228:231]
    ds_read_b128 v[100:103], v159 offset:31232
    buffer_load_dwordx4 v9, s[44:47], s13 offen offset:1024 sc1 lds
    v_mfma_f32_16x16x32_bf16 v[228:231], a[212:215], v[112:115], v[228:231]
    v_mfma_f32_16x16x32_bf16 v[236:239], a[212:215], v[120:123], v[236:239]
    v_mfma_f32_16x16x32_bf16 v[236:239], a[220:223], v[124:127], v[236:239]
    buffer_load_dwordx4 v3, s[44:47], s13 offen offset:2048 sc1 lds
    v_mfma_f32_16x16x32_bf16 v[232:235], a[216:219], v[124:127], v[232:235]
    v_mfma_f32_16x16x32_bf16 v[232:235], a[208:211], v[120:123], v[232:235]
    s_waitcnt lgkmcnt(0)
    v_mfma_f32_16x16x32_bf16 v[192:195], a[224:227], v[80:83], v[192:195]
    s_add_u32 m0, s74, 12288
    s_mul_i32 s13, s21, 90112
    v_mfma_f32_16x16x32_bf16 v[192:195], a[232:235], v[84:87], v[192:195]
    ds_read_b128 v[104:107], v159 offset:25344
    v_mfma_f32_16x16x32_bf16 v[196:199], a[236:239], v[84:87], v[196:199]
    ds_read_b128 v[108:111], v159 offset:31488
    v_mfma_f32_16x16x32_bf16 v[196:199], a[228:231], v[80:83], v[196:199]
    ds_read_b128 v[112:115], v159 offset:25600
    buffer_load_dwordx4 v8, s[44:47], s13 offen offset:0 sc1 lds
    v_mfma_f32_16x16x32_bf16 v[204:207], a[228:231], v[88:91], v[204:207]
    ds_read_b128 v[116:119], v159 offset:31744
    v_mfma_f32_16x16x32_bf16 v[204:207], a[236:239], v[92:95], v[204:207]
    ds_read_b128 v[120:123], v159 offset:25856
    v_mfma_f32_16x16x32_bf16 v[200:203], a[232:235], v[92:95], v[200:203]
    ds_read_b128 v[124:127], v159 offset:32000
    buffer_load_dwordx4 v9, s[44:47], s13 offen offset:1024 sc1 lds
    v_mfma_f32_16x16x32_bf16 v[200:203], a[224:227], v[88:91], v[200:203]
    v_mfma_f32_16x16x32_bf16 v[208:211], a[224:227], v[96:99], v[208:211]
    v_mfma_f32_16x16x32_bf16 v[208:211], a[232:235], v[100:103], v[208:211]
    buffer_load_dwordx4 v3, s[44:47], s13 offen offset:2048 sc1 lds
    v_mfma_f32_16x16x32_bf16 v[212:215], a[236:239], v[100:103], v[212:215]
    v_mfma_f32_16x16x32_bf16 v[212:215], a[228:231], v[96:99], v[212:215]
    s_waitcnt lgkmcnt(0)
    v_mfma_f32_16x16x32_bf16 v[220:223], a[228:231], v[104:107], v[220:223]
    s_waitcnt vmcnt(16)
    s_barrier
    v_mfma_f32_16x16x32_bf16 v[220:223], a[236:239], v[108:111], v[220:223]
    ds_read_b128 v[80:83], v250 offset:0
    s_add_u32 m0, s74, 24576
    s_mul_i32 s13, s22, 90112
    v_mfma_f32_16x16x32_bf16 v[216:219], a[232:235], v[108:111], v[216:219]
    ds_read_b128 v[84:87], v250 offset:6144
    v_mfma_f32_16x16x32_bf16 v[216:219], a[224:227], v[104:107], v[216:219]
    ds_read_b128 v[88:91], v250 offset:256
    buffer_load_dwordx4 v8, s[44:47], s13 offen offset:0 sc1 lds
    v_mfma_f32_16x16x32_bf16 v[224:227], a[224:227], v[112:115], v[224:227]
    ds_read_b128 v[92:95], v250 offset:6400
    v_mfma_f32_16x16x32_bf16 v[224:227], a[232:235], v[116:119], v[224:227]
    ds_read_b128 v[96:99], v250 offset:512
    v_mfma_f32_16x16x32_bf16 v[228:231], a[236:239], v[116:119], v[228:231]
    ds_read_b128 v[100:103], v250 offset:6656
    buffer_load_dwordx4 v9, s[44:47], s13 offen offset:1024 sc1 lds
    v_mfma_f32_16x16x32_bf16 v[228:231], a[228:231], v[112:115], v[228:231]
    v_mfma_f32_16x16x32_bf16 v[236:239], a[228:231], v[120:123], v[236:239]
    v_mfma_f32_16x16x32_bf16 v[236:239], a[236:239], v[124:127], v[236:239]
    buffer_load_dwordx4 v3, s[44:47], s13 offen offset:2048 sc1 lds
    v_mfma_f32_16x16x32_bf16 v[232:235], a[232:235], v[124:127], v[232:235]
    v_mfma_f32_16x16x32_bf16 v[232:235], a[224:227], v[120:123], v[232:235]
    s_waitcnt lgkmcnt(0)
    v_mfma_f32_16x16x32_bf16 v[192:195], a[240:243], v[80:83], v[192:195]
    s_add_u32 m0, s73, 0
    s_lshl_b32 s14, s85, 18
    v_mfma_f32_16x16x32_bf16 v[192:195], a[248:251], v[84:87], v[192:195]
    ds_read_b128 v[104:107], v250 offset:768
    v_mfma_f32_16x16x32_bf16 v[196:199], a[252:255], v[84:87], v[196:199]
    ds_read_b128 v[108:111], v250 offset:6912
    buffer_load_dwordx4 v4, s[52:55], s14 offen offset:0 lds
    v_mfma_f32_16x16x32_bf16 v[196:199], a[244:247], v[80:83], v[196:199]
    ds_read_b128 v[112:115], v250 offset:1024
    v_mfma_f32_16x16x32_bf16 v[204:207], a[244:247], v[88:91], v[204:207]
    ds_read_b128 v[116:119], v250 offset:7168
    buffer_load_dwordx4 v5, s[52:55], s14 offen offset:1024 lds
    v_mfma_f32_16x16x32_bf16 v[204:207], a[252:255], v[92:95], v[204:207]
    ds_read_b128 v[120:123], v250 offset:1280
    v_mfma_f32_16x16x32_bf16 v[200:203], a[248:251], v[92:95], v[200:203]
    ds_read_b128 v[124:127], v250 offset:7424
    v_mfma_f32_16x16x32_bf16 v[200:203], a[240:243], v[88:91], v[200:203]
    buffer_load_dwordx4 v6, s[52:55], s14 offen offset:2048 lds
    v_mfma_f32_16x16x32_bf16 v[208:211], a[240:243], v[96:99], v[208:211]
    v_mfma_f32_16x16x32_bf16 v[208:211], a[248:251], v[100:103], v[208:211]
    buffer_load_dwordx4 v7, s[52:55], s14 offen offset:3072 lds
    v_mfma_f32_16x16x32_bf16 v[212:215], a[252:255], v[100:103], v[212:215]
    v_mfma_f32_16x16x32_bf16 v[212:215], a[244:247], v[96:99], v[212:215]
    s_waitcnt lgkmcnt(0)
    v_mfma_f32_16x16x32_bf16 v[220:223], a[244:247], v[104:107], v[220:223]
    s_waitcnt vmcnt(16)
    s_barrier
    v_mfma_f32_16x16x32_bf16 v[220:223], a[252:255], v[108:111], v[220:223]
    ds_read_b128 v[80:83], v250 offset:12288
    v_mfma_f32_16x16x32_bf16 v[216:219], a[248:251], v[108:111], v[216:219]
    ds_read_b128 v[84:87], v250 offset:18432
    v_mfma_f32_16x16x32_bf16 v[216:219], a[240:243], v[104:107], v[216:219]
    ds_read_b128 v[88:91], v250 offset:12544
    v_mfma_f32_16x16x32_bf16 v[224:227], a[240:243], v[112:115], v[224:227]
    ds_read_b128 v[92:95], v250 offset:18688
    v_cvt_pk_bf16_f32 v192, v192, v193
    v_mfma_f32_16x16x32_bf16 v[224:227], a[248:251], v[116:119], v[224:227]
    ds_read_b128 v[96:99], v250 offset:12800
    v_mfma_f32_16x16x32_bf16 v[228:231], a[252:255], v[116:119], v[228:231]
    ds_read_b128 v[100:103], v250 offset:18944
    v_cvt_pk_bf16_f32 v193, v194, v195
    v_mfma_f32_16x16x32_bf16 v[228:231], a[244:247], v[112:115], v[228:231]
    v_mfma_f32_16x16x32_bf16 v[236:239], a[244:247], v[120:123], v[236:239]
    v_cvt_pk_bf16_f32 v194, v196, v197
    v_mfma_f32_16x16x32_bf16 v[236:239], a[252:255], v[124:127], v[236:239]
    v_cvt_pk_bf16_f32 v195, v198, v199
    v_mfma_f32_16x16x32_bf16 v[232:235], a[248:251], v[124:127], v[232:235]
    v_mfma_f32_16x16x32_bf16 v[232:235], a[240:243], v[120:123], v[232:235]
    buffer_store_dwordx4 v[192:195], v246, s[44:47], s9 offen offset:0 sc1
    s_waitcnt lgkmcnt(0)
    v_mfma_f32_16x16x32_bf16 v[32:35], a[0:3], v[80:83], v[128:131]
    v_mfma_f32_16x16x32_bf16 v[32:35], a[8:11], v[84:87], v[32:35]
    ds_read_b128 v[104:107], v250 offset:13056
    v_mfma_f32_16x16x32_bf16 v[36:39], a[12:15], v[84:87], v[132:135]
    ds_read_b128 v[108:111], v250 offset:19200
    v_mfma_f32_16x16x32_bf16 v[36:39], a[4:7], v[80:83], v[36:39]
    ds_read_b128 v[112:115], v250 offset:13312
    v_mfma_f32_16x16x32_bf16 v[44:47], a[4:7], v[88:91], v[132:135]
    ds_read_b128 v[116:119], v250 offset:19456
    v_cvt_pk_bf16_f32 v200, v200, v201
    v_mfma_f32_16x16x32_bf16 v[44:47], a[12:15], v[92:95], v[44:47]
    ds_read_b128 v[120:123], v250 offset:13568
    v_mfma_f32_16x16x32_bf16 v[40:43], a[8:11], v[92:95], v[128:131]
    ds_read_b128 v[124:127], v250 offset:19712
    v_cvt_pk_bf16_f32 v201, v202, v203
    v_mfma_f32_16x16x32_bf16 v[40:43], a[0:3], v[88:91], v[40:43]
    v_mfma_f32_16x16x32_bf16 v[48:51], a[0:3], v[96:99], v[128:131]
    v_cvt_pk_bf16_f32 v202, v204, v205
    v_mfma_f32_16x16x32_bf16 v[48:51], a[8:11], v[100:103], v[48:51]
    v_cvt_pk_bf16_f32 v203, v206, v207
    v_mfma_f32_16x16x32_bf16 v[52:55], a[12:15], v[100:103], v[132:135]
    v_mfma_f32_16x16x32_bf16 v[52:55], a[4:7], v[96:99], v[52:55]
    buffer_store_dwordx4 v[200:203], v246, s[44:47], s9 offen offset:1024 sc1
    s_waitcnt lgkmcnt(0)
    v_mfma_f32_16x16x32_bf16 v[60:63], a[4:7], v[104:107], v[132:135]
    s_waitcnt vmcnt(15)
    s_barrier
    v_mfma_f32_16x16x32_bf16 v[60:63], a[12:15], v[108:111], v[60:63]
    ds_read_b128 v[80:83], v250 offset:24576
    v_cvt_pk_bf16_f32 v208, v208, v209
    v_mfma_f32_16x16x32_bf16 v[56:59], a[8:11], v[108:111], v[128:131]
    ds_read_b128 v[84:87], v250 offset:30720
    v_mfma_f32_16x16x32_bf16 v[56:59], a[0:3], v[104:107], v[56:59]
    ds_read_b128 v[88:91], v250 offset:24832
    v_cvt_pk_bf16_f32 v209, v210, v211
    v_mfma_f32_16x16x32_bf16 v[64:67], a[0:3], v[112:115], v[128:131]
    ds_read_b128 v[92:95], v250 offset:30976
    v_mfma_f32_16x16x32_bf16 v[64:67], a[8:11], v[116:119], v[64:67]
    ds_read_b128 v[96:99], v250 offset:25088
    v_mfma_f32_16x16x32_bf16 v[68:71], a[12:15], v[116:119], v[132:135]
    ds_read_b128 v[100:103], v250 offset:31232
    v_cvt_pk_bf16_f32 v210, v212, v213
    v_mfma_f32_16x16x32_bf16 v[68:71], a[4:7], v[112:115], v[68:71]
    v_mfma_f32_16x16x32_bf16 v[76:79], a[4:7], v[120:123], v[132:135]
    v_cvt_pk_bf16_f32 v211, v214, v215
    v_mfma_f32_16x16x32_bf16 v[76:79], a[12:15], v[124:127], v[76:79]
    v_mfma_f32_16x16x32_bf16 v[72:75], a[8:11], v[124:127], v[128:131]
    buffer_store_dwordx4 v[208:211], v246, s[44:47], s9 offen offset:2048 sc1
    v_mfma_f32_16x16x32_bf16 v[72:75], a[0:3], v[120:123], v[72:75]
    s_waitcnt lgkmcnt(0)
    v_mfma_f32_16x16x32_bf16 v[32:35], a[16:19], v[80:83], v[32:35]
    v_mfma_f32_16x16x32_bf16 v[32:35], a[24:27], v[84:87], v[32:35]
    ds_read_b128 v[104:107], v250 offset:25344
    v_cvt_pk_bf16_f32 v216, v216, v217
    v_mfma_f32_16x16x32_bf16 v[36:39], a[28:31], v[84:87], v[36:39]
    ds_read_b128 v[108:111], v250 offset:31488
    v_mfma_f32_16x16x32_bf16 v[36:39], a[20:23], v[80:83], v[36:39]
    ds_read_b128 v[112:115], v250 offset:25600
    v_cvt_pk_bf16_f32 v217, v218, v219
    v_mfma_f32_16x16x32_bf16 v[44:47], a[20:23], v[88:91], v[44:47]
    ds_read_b128 v[116:119], v250 offset:31744
    v_mfma_f32_16x16x32_bf16 v[44:47], a[28:31], v[92:95], v[44:47]
    ds_read_b128 v[120:123], v250 offset:25856
    v_mfma_f32_16x16x32_bf16 v[40:43], a[24:27], v[92:95], v[40:43]
    ds_read_b128 v[124:127], v250 offset:32000
    v_cvt_pk_bf16_f32 v218, v220, v221
    v_mfma_f32_16x16x32_bf16 v[40:43], a[16:19], v[88:91], v[40:43]
    v_mfma_f32_16x16x32_bf16 v[48:51], a[16:19], v[96:99], v[48:51]
    v_cvt_pk_bf16_f32 v219, v222, v223
    v_mfma_f32_16x16x32_bf16 v[48:51], a[24:27], v[100:103], v[48:51]
    v_mfma_f32_16x16x32_bf16 v[52:55], a[28:31], v[100:103], v[52:55]
    buffer_store_dwordx4 v[216:219], v247, s[44:47], s9 offen offset:0 sc1
    v_mfma_f32_16x16x32_bf16 v[52:55], a[20:23], v[96:99], v[52:55]
    s_waitcnt lgkmcnt(0)
    v_mfma_f32_16x16x32_bf16 v[60:63], a[20:23], v[104:107], v[60:63]
    s_waitcnt vmcnt(14)
    s_barrier
    v_cvt_pk_bf16_f32 v224, v224, v225
    v_mfma_f32_16x16x32_bf16 v[60:63], a[28:31], v[108:111], v[60:63]
    ds_read_b128 v[80:83], v159 offset:0
    s_add_u32 m0, s74, 36864
    s_mul_i32 s13, s23, 90112
    v_mfma_f32_16x16x32_bf16 v[56:59], a[24:27], v[108:111], v[56:59]
    ds_read_b128 v[84:87], v159 offset:6144
    v_mfma_f32_16x16x32_bf16 v[56:59], a[16:19], v[104:107], v[56:59]
    ds_read_b128 v[88:91], v159 offset:256
    buffer_load_dwordx4 v8, s[44:47], s13 offen offset:0 sc1 lds
    v_mfma_f32_16x16x32_bf16 v[64:67], a[16:19], v[112:115], v[64:67]
    ds_read_b128 v[92:95], v159 offset:6400
    v_cvt_pk_bf16_f32 v225, v226, v227
    v_mfma_f32_16x16x32_bf16 v[64:67], a[24:27], v[116:119], v[64:67]
    ds_read_b128 v[96:99], v159 offset:512
    v_cvt_pk_bf16_f32 v226, v228, v229
    v_mfma_f32_16x16x32_bf16 v[68:71], a[28:31], v[116:119], v[68:71]
    ds_read_b128 v[100:103], v159 offset:6656
    buffer_load_dwordx4 v9, s[44:47], s13 offen offset:1024 sc1 lds
    v_mfma_f32_16x16x32_bf16 v[68:71], a[20:23], v[112:115], v[68:71]
    v_add_u32 v10, 65536, v10
    v_mfma_f32_16x16x32_bf16 v[76:79], a[20:23], v[120:123], v[76:79]
    ds_read_b64_tr_b16 a[0:1], v10 offset:0
    v_cvt_pk_bf16_f32 v227, v230, v231
    v_mfma_f32_16x16x32_bf16 v[76:79], a[28:31], v[124:127], v[76:79]
    ds_read_b64_tr_b16 a[2:3], v10 offset:2048
    buffer_load_dwordx4 v3, s[44:47], s13 offen offset:2048 sc1 lds
    v_mfma_f32_16x16x32_bf16 v[72:75], a[24:27], v[124:127], v[72:75]
    buffer_store_dwordx4 v[224:227], v247, s[44:47], s9 offen offset:1024 sc1
    ds_read_b64_tr_b16 a[8:9], v10 offset:4096
    v_mfma_f32_16x16x32_bf16 v[72:75], a[16:19], v[120:123], v[72:75]
    ds_read_b64_tr_b16 a[10:11], v10 offset:6144
    s_waitcnt lgkmcnt(4)
    v_mfma_f32_16x16x32_bf16 v[32:35], a[32:35], v[80:83], v[32:35]
    s_add_u32 m0, s74, 49152
    s_mul_i32 s13, s24, 90112
    v_mfma_f32_16x16x32_bf16 v[32:35], a[40:43], v[84:87], v[32:35]
    ds_read_b128 v[104:107], v159 offset:768
    v_cvt_pk_bf16_f32 v232, v232, v233
    v_mfma_f32_16x16x32_bf16 v[36:39], a[44:47], v[84:87], v[36:39]
    ds_read_b128 v[108:111], v159 offset:6912
    v_mfma_f32_16x16x32_bf16 v[36:39], a[36:39], v[80:83], v[36:39]
    ds_read_b128 v[112:115], v159 offset:1024
    buffer_load_dwordx4 v8, s[44:47], s13 offen offset:0 sc1 lds
    v_mfma_f32_16x16x32_bf16 v[44:47], a[36:39], v[88:91], v[44:47]
    ds_read_b128 v[116:119], v159 offset:7168
    v_cvt_pk_bf16_f32 v233, v234, v235
    v_mfma_f32_16x16x32_bf16 v[44:47], a[44:47], v[92:95], v[44:47]
    ds_read_b128 v[120:123], v159 offset:1280
    v_cvt_pk_bf16_f32 v234, v236, v237
    v_mfma_f32_16x16x32_bf16 v[40:43], a[40:43], v[92:95], v[40:43]
    ds_read_b128 v[124:127], v159 offset:7424
    buffer_load_dwordx4 v9, s[44:47], s13 offen offset:1024 sc1 lds
    v_mfma_f32_16x16x32_bf16 v[40:43], a[32:35], v[88:91], v[40:43]
    v_add_u32 v11, 65536, v11
    v_mfma_f32_16x16x32_bf16 v[48:51], a[32:35], v[96:99], v[48:51]
    ds_read_b64_tr_b16 a[4:5], v11 offset:0
    v_cvt_pk_bf16_f32 v235, v238, v239
    v_mfma_f32_16x16x32_bf16 v[48:51], a[40:43], v[100:103], v[48:51]
    ds_read_b64_tr_b16 a[6:7], v11 offset:2048
    buffer_load_dwordx4 v3, s[44:47], s13 offen offset:2048 sc1 lds
    v_mfma_f32_16x16x32_bf16 v[52:55], a[44:47], v[100:103], v[52:55]
    buffer_store_dwordx4 v[232:235], v247, s[44:47], s9 offen offset:2048 sc1
    ds_read_b64_tr_b16 a[12:13], v11 offset:4096
    v_mfma_f32_16x16x32_bf16 v[52:55], a[36:39], v[96:99], v[52:55]
    ds_read_b64_tr_b16 a[14:15], v11 offset:6144
    s_waitcnt lgkmcnt(4)
    v_mfma_f32_16x16x32_bf16 v[60:63], a[36:39], v[104:107], v[60:63]
    s_waitcnt vmcnt(19)
    s_barrier
    v_mfma_f32_16x16x32_bf16 v[60:63], a[44:47], v[108:111], v[60:63]
    ds_read_b128 v[80:83], v159 offset:12288
    s_add_u32 m0, s74, 61440
    s_mul_i32 s13, s25, 90112
    v_mfma_f32_16x16x32_bf16 v[56:59], a[40:43], v[108:111], v[56:59]
    ds_read_b128 v[84:87], v159 offset:18432
    v_mfma_f32_16x16x32_bf16 v[56:59], a[32:35], v[104:107], v[56:59]
    ds_read_b128 v[88:91], v159 offset:12544
    buffer_load_dwordx4 v8, s[44:47], s13 offen offset:0 sc1 lds
    v_mfma_f32_16x16x32_bf16 v[64:67], a[32:35], v[112:115], v[64:67]
    ds_read_b128 v[92:95], v159 offset:18688
    v_mfma_f32_16x16x32_bf16 v[64:67], a[40:43], v[116:119], v[64:67]
    ds_read_b128 v[96:99], v159 offset:12800
    v_mfma_f32_16x16x32_bf16 v[68:71], a[44:47], v[116:119], v[68:71]
    ds_read_b128 v[100:103], v159 offset:18944
    buffer_load_dwordx4 v9, s[44:47], s13 offen offset:1024 sc1 lds
    v_mfma_f32_16x16x32_bf16 v[68:71], a[36:39], v[112:115], v[68:71]
    v_mfma_f32_16x16x32_bf16 v[76:79], a[36:39], v[120:123], v[76:79]
    v_mfma_f32_16x16x32_bf16 v[76:79], a[44:47], v[124:127], v[76:79]
    buffer_load_dwordx4 v3, s[44:47], s13 offen offset:2048 sc1 lds
    v_mfma_f32_16x16x32_bf16 v[72:75], a[40:43], v[124:127], v[72:75]
    v_mfma_f32_16x16x32_bf16 v[72:75], a[32:35], v[120:123], v[72:75]
    s_waitcnt lgkmcnt(0)
    v_mfma_f32_16x16x32_bf16 v[32:35], a[48:51], v[80:83], v[32:35]
    s_add_u32 m0, s74, 0
    s_mul_i32 s13, s26, 90112
    v_bfe_u32 v24, v2, 2, 2
    v_mfma_f32_16x16x32_bf16 v[32:35], a[56:59], v[84:87], v[32:35]
    ds_read_b128 v[104:107], v159 offset:13056
    v_mfma_f32_16x16x32_bf16 v[36:39], a[60:63], v[84:87], v[36:39]
    ds_read_b128 v[108:111], v159 offset:19200
    v_lshrrev_b32 v25, 4, v2
    v_mfma_f32_16x16x32_bf16 v[36:39], a[52:55], v[80:83], v[36:39]
    ds_read_b128 v[112:115], v159 offset:13312
    buffer_load_dwordx4 v8, s[44:47], s13 offen offset:0 sc1 lds
    v_mfma_f32_16x16x32_bf16 v[44:47], a[52:55], v[88:91], v[44:47]
    ds_read_b128 v[116:119], v159 offset:19456
    v_cmp_eq_u32 vcc, v24, v25
    v_mfma_f32_16x16x32_bf16 v[44:47], a[60:63], v[92:95], v[44:47]
    ds_read_b128 v[120:123], v159 offset:13568
    v_and_b32 v24, 1, v2
    v_mfma_f32_16x16x32_bf16 v[40:43], a[56:59], v[92:95], v[40:43]
    ds_read_b128 v[124:127], v159 offset:19712
    buffer_load_dwordx4 v9, s[44:47], s13 offen offset:1024 sc1 lds
    v_mfma_f32_16x16x32_bf16 v[40:43], a[48:51], v[88:91], v[40:43]
    v_lshlrev_b32 v24, 4, v24
    v_mfma_f32_16x16x32_bf16 v[48:51], a[48:51], v[96:99], v[48:51]
    v_mov_b32 v25, 0x3f80
    v_mfma_f32_16x16x32_bf16 v[48:51], a[56:59], v[100:103], v[48:51]
    buffer_load_dwordx4 v3, s[44:47], s13 offen offset:2048 sc1 lds
    v_lshlrev_b32 v24, v24, v25
    v_mfma_f32_16x16x32_bf16 v[52:55], a[60:63], v[100:103], v[52:55]
    v_mfma_f32_16x16x32_bf16 v[52:55], a[52:55], v[96:99], v[52:55]
    v_cndmask_b32 v24, 0, v24, vcc
    s_waitcnt lgkmcnt(0)
    v_mfma_f32_16x16x32_bf16 v[60:63], a[52:55], v[104:107], v[60:63]
    s_waitcnt vmcnt(18)
    s_barrier
    v_and_b32 v25, 2, v2
    v_mfma_f32_16x16x32_bf16 v[60:63], a[60:63], v[108:111], v[60:63]
    ds_read_b128 v[80:83], v159 offset:24576
    s_add_u32 m0, s74, 12288
    s_mul_i32 s13, s27, 90112
    v_mfma_f32_16x16x32_bf16 v[56:59], a[56:59], v[108:111], v[56:59]
    ds_read_b128 v[84:87], v159 offset:30720
    v_cmp_eq_u32 vcc, 0, v25
    v_mfma_f32_16x16x32_bf16 v[56:59], a[48:51], v[104:107], v[56:59]
    ds_read_b128 v[88:91], v159 offset:24832
    buffer_load_dwordx4 v8, s[44:47], s13 offen offset:0 sc1 lds
    v_mfma_f32_16x16x32_bf16 v[64:67], a[48:51], v[112:115], v[64:67]
    ds_read_b128 v[92:95], v159 offset:30976
    v_cndmask_b32 v130, 0, v24, vcc
    v_mfma_f32_16x16x32_bf16 v[64:67], a[56:59], v[116:119], v[64:67]
    ds_read_b128 v[96:99], v159 offset:25088
    v_cndmask_b32 v131, v24, 0, vcc
    v_mfma_f32_16x16x32_bf16 v[68:71], a[60:63], v[116:119], v[68:71]
    ds_read_b128 v[100:103], v159 offset:31232
    buffer_load_dwordx4 v9, s[44:47], s13 offen offset:1024 sc1 lds
    v_mfma_f32_16x16x32_bf16 v[68:71], a[52:55], v[112:115], v[68:71]
    v_add_u32 v10, -65536, v10
    v_mov_b32 v128, 0
    v_mfma_f32_16x16x32_bf16 v[76:79], a[52:55], v[120:123], v[76:79]
    ds_read_b64_tr_b16 a[16:17], v10 offset:0
    v_mov_b32 v129, 0
    v_mfma_f32_16x16x32_bf16 v[76:79], a[60:63], v[124:127], v[76:79]
    ds_read_b64_tr_b16 a[18:19], v10 offset:2048
    buffer_load_dwordx4 v3, s[44:47], s13 offen offset:2048 sc1 lds
    v_mov_b32 v132, 0
    v_mfma_f32_16x16x32_bf16 v[72:75], a[56:59], v[124:127], v[72:75]
    ds_read_b64_tr_b16 a[24:25], v10 offset:4096
    v_mov_b32 v133, 0
    v_mfma_f32_16x16x32_bf16 v[72:75], a[48:51], v[120:123], v[72:75]
    ds_read_b64_tr_b16 a[26:27], v10 offset:6144
    s_waitcnt lgkmcnt(4)
    v_mfma_f32_16x16x32_bf16 v[32:35], a[64:67], v[80:83], v[32:35]
    s_add_u32 m0, s73, 16384
    s_lshl_b32 s14, s86, 18
    v_mfma_f32_16x16x32_bf16 v[32:35], a[72:75], v[84:87], v[32:35]
    ds_read_b128 v[104:107], v159 offset:25344
    v_mfma_f32_16x16x32_bf16 v[36:39], a[76:79], v[84:87], v[36:39]
    ds_read_b128 v[108:111], v159 offset:31488
    buffer_load_dwordx4 v4, s[52:55], s14 offen offset:0 lds
    v_mfma_f32_16x16x32_bf16 v[36:39], a[68:71], v[80:83], v[36:39]
    ds_read_b128 v[112:115], v159 offset:25600
    v_mfma_f32_16x16x32_bf16 v[44:47], a[68:71], v[88:91], v[44:47]
    ds_read_b128 v[116:119], v159 offset:31744
    buffer_load_dwordx4 v5, s[52:55], s14 offen offset:1024 lds
    v_mfma_f32_16x16x32_bf16 v[44:47], a[76:79], v[92:95], v[44:47]
    ds_read_b128 v[120:123], v159 offset:25856
    v_mfma_f32_16x16x32_bf16 v[40:43], a[72:75], v[92:95], v[40:43]
    ds_read_b128 v[124:127], v159 offset:32000
    v_mfma_f32_16x16x32_bf16 v[40:43], a[64:67], v[88:91], v[40:43]
    buffer_load_dwordx4 v6, s[52:55], s14 offen offset:2048 lds
    v_add_u32 v11, -65536, v11
    v_mfma_f32_16x16x32_bf16 v[48:51], a[64:67], v[96:99], v[48:51]
    ds_read_b64_tr_b16 a[20:21], v11 offset:0
    v_mfma_f32_16x16x32_bf16 v[48:51], a[72:75], v[100:103], v[48:51]
    ds_read_b64_tr_b16 a[22:23], v11 offset:2048
    buffer_load_dwordx4 v7, s[52:55], s14 offen offset:3072 lds
    v_mfma_f32_16x16x32_bf16 v[52:55], a[76:79], v[100:103], v[52:55]
    ds_read_b64_tr_b16 a[28:29], v11 offset:4096
    v_mfma_f32_16x16x32_bf16 v[52:55], a[68:71], v[96:99], v[52:55]
    ds_read_b64_tr_b16 a[30:31], v11 offset:6144
    s_waitcnt lgkmcnt(4)
    v_mfma_f32_16x16x32_bf16 v[60:63], a[68:71], v[104:107], v[60:63]
    s_waitcnt vmcnt(18)
    s_barrier
    v_mfma_f32_16x16x32_bf16 v[60:63], a[76:79], v[108:111], v[60:63]
    ds_read_b128 v[80:83], v250 offset:0
    v_mfma_f32_16x16x32_bf16 v[56:59], a[72:75], v[108:111], v[56:59]
    ds_read_b128 v[84:87], v250 offset:6144
    v_mfma_f32_16x16x32_bf16 v[56:59], a[64:67], v[104:107], v[56:59]
    ds_read_b128 v[88:91], v250 offset:256
    v_mfma_f32_16x16x32_bf16 v[64:67], a[64:67], v[112:115], v[64:67]
    ds_read_b128 v[92:95], v250 offset:6400
    v_mfma_f32_16x16x32_bf16 v[64:67], a[72:75], v[116:119], v[64:67]
    ds_read_b128 v[96:99], v250 offset:512
    v_mfma_f32_16x16x32_bf16 v[68:71], a[76:79], v[116:119], v[68:71]
    ds_read_b128 v[100:103], v250 offset:6656
    v_mfma_f32_16x16x32_bf16 v[68:71], a[68:71], v[112:115], v[68:71]
    v_mfma_f32_16x16x32_bf16 v[76:79], a[68:71], v[120:123], v[76:79]
    v_mfma_f32_16x16x32_bf16 v[76:79], a[76:79], v[124:127], v[76:79]
    v_mfma_f32_16x16x32_bf16 v[72:75], a[72:75], v[124:127], v[72:75]
    v_mfma_f32_16x16x32_bf16 v[72:75], a[64:67], v[120:123], v[72:75]
    s_waitcnt lgkmcnt(0)
    v_mfma_f32_16x16x32_bf16 v[32:35], a[80:83], v[80:83], v[32:35]
    v_mfma_f32_16x16x32_bf16 v[32:35], a[88:91], v[84:87], v[32:35]
    ds_read_b128 v[104:107], v250 offset:768
    v_mfma_f32_16x16x32_bf16 v[36:39], a[92:95], v[84:87], v[36:39]
    ds_read_b128 v[108:111], v250 offset:6912
    v_mfma_f32_16x16x32_bf16 v[36:39], a[84:87], v[80:83], v[36:39]
    ds_read_b128 v[112:115], v250 offset:1024
    v_mfma_f32_16x16x32_bf16 v[44:47], a[84:87], v[88:91], v[44:47]
    ds_read_b128 v[116:119], v250 offset:7168
    v_mfma_f32_16x16x32_bf16 v[44:47], a[92:95], v[92:95], v[44:47]
    ds_read_b128 v[120:123], v250 offset:1280
    v_mfma_f32_16x16x32_bf16 v[40:43], a[88:91], v[92:95], v[40:43]
    ds_read_b128 v[124:127], v250 offset:7424
    v_mfma_f32_16x16x32_bf16 v[40:43], a[80:83], v[88:91], v[40:43]
    s_waitcnt vmcnt(13)
    buffer_store_dword v249, v248, s[44:47], s6 offen sc1
    v_mfma_f32_16x16x32_bf16 v[48:51], a[80:83], v[96:99], v[48:51]
    v_mfma_f32_16x16x32_bf16 v[48:51], a[88:91], v[100:103], v[48:51]
    v_mfma_f32_16x16x32_bf16 v[52:55], a[92:95], v[100:103], v[52:55]
    v_mfma_f32_16x16x32_bf16 v[52:55], a[84:87], v[96:99], v[52:55]
    s_waitcnt lgkmcnt(0)
    v_mfma_f32_16x16x32_bf16 v[60:63], a[84:87], v[104:107], v[60:63]
    s_barrier
    v_mfma_f32_16x16x32_bf16 v[60:63], a[92:95], v[108:111], v[60:63]
    ds_read_b128 v[80:83], v250 offset:12288
    v_mfma_f32_16x16x32_bf16 v[56:59], a[88:91], v[108:111], v[56:59]
    ds_read_b128 v[84:87], v250 offset:18432
    v_mfma_f32_16x16x32_bf16 v[56:59], a[80:83], v[104:107], v[56:59]
    ds_read_b128 v[88:91], v250 offset:12544
    v_mfma_f32_16x16x32_bf16 v[64:67], a[80:83], v[112:115], v[64:67]
    ds_read_b128 v[92:95], v250 offset:18688
    v_mfma_f32_16x16x32_bf16 v[64:67], a[88:91], v[116:119], v[64:67]
    ds_read_b128 v[96:99], v250 offset:12800
    v_mfma_f32_16x16x32_bf16 v[68:71], a[92:95], v[116:119], v[68:71]
    ds_read_b128 v[100:103], v250 offset:18944
    v_mfma_f32_16x16x32_bf16 v[68:71], a[84:87], v[112:115], v[68:71]
    v_mfma_f32_16x16x32_bf16 v[76:79], a[84:87], v[120:123], v[76:79]
    v_mfma_f32_16x16x32_bf16 v[76:79], a[92:95], v[124:127], v[76:79]
    v_mfma_f32_16x16x32_bf16 v[72:75], a[88:91], v[124:127], v[72:75]
    v_mfma_f32_16x16x32_bf16 v[72:75], a[80:83], v[120:123], v[72:75]
    s_waitcnt lgkmcnt(0)
    v_mfma_f32_16x16x32_bf16 v[32:35], a[96:99], v[80:83], v[32:35]
    v_mfma_f32_16x16x32_bf16 v[32:35], a[104:107], v[84:87], v[32:35]
    ds_read_b128 v[104:107], v250 offset:13056
L_pl_G_4:
    s_cbranch_execz L_wret
    v_mfma_f32_16x16x32_bf16 v[36:39], a[108:111], v[84:87], v[36:39]
    ds_read_b128 v[108:111], v250 offset:19200
    v_mfma_f32_16x16x32_bf16 v[36:39], a[100:103], v[80:83], v[36:39]
    ds_read_b128 v[112:115], v250 offset:13312
    v_mfma_f32_16x16x32_bf16 v[44:47], a[100:103], v[88:91], v[44:47]
    ds_read_b128 v[116:119], v250 offset:19456
    v_mfma_f32_16x16x32_bf16 v[44:47], a[108:111], v[92:95], v[44:47]
    ds_read_b128 v[120:123], v250 offset:13568
    v_mfma_f32_16x16x32_bf16 v[40:43], a[104:107], v[92:95], v[40:43]
    ds_read_b128 v[124:127], v250 offset:19712
    v_mfma_f32_16x16x32_bf16 v[40:43], a[96:99], v[88:91], v[40:43]
    v_mfma_f32_16x16x32_bf16 v[48:51], a[96:99], v[96:99], v[48:51]
    v_mfma_f32_16x16x32_bf16 v[48:51], a[104:107], v[100:103], v[48:51]
    v_mfma_f32_16x16x32_bf16 v[52:55], a[108:111], v[100:103], v[52:55]
    v_mfma_f32_16x16x32_bf16 v[52:55], a[100:103], v[96:99], v[52:55]
    s_waitcnt lgkmcnt(0)
    v_mfma_f32_16x16x32_bf16 v[60:63], a[100:103], v[104:107], v[60:63]
    s_waitcnt vmcnt(11)
    s_barrier
    v_mfma_f32_16x16x32_bf16 v[60:63], a[108:111], v[108:111], v[60:63]
    ds_read_b128 v[80:83], v250 offset:24576
    s_add_u32 m0, s74, 24576
    s_mul_i32 s13, s76, 90112
    v_mfma_f32_16x16x32_bf16 v[56:59], a[104:107], v[108:111], v[56:59]
    ds_read_b128 v[84:87], v250 offset:30720
    v_mfma_f32_16x16x32_bf16 v[56:59], a[96:99], v[104:107], v[56:59]
    ds_read_b128 v[88:91], v250 offset:24832
    buffer_load_dwordx4 v8, s[44:47], s13 offen offset:0 sc1 lds
    v_mfma_f32_16x16x32_bf16 v[64:67], a[96:99], v[112:115], v[64:67]
    ds_read_b128 v[92:95], v250 offset:30976
    v_mfma_f32_16x16x32_bf16 v[64:67], a[104:107], v[116:119], v[64:67]
    ds_read_b128 v[96:99], v250 offset:25088
    v_mfma_f32_16x16x32_bf16 v[68:71], a[108:111], v[116:119], v[68:71]
    ds_read_b128 v[100:103], v250 offset:31232
    buffer_load_dwordx4 v9, s[44:47], s13 offen offset:1024 sc1 lds
    v_mfma_f32_16x16x32_bf16 v[68:71], a[100:103], v[112:115], v[68:71]
    v_mfma_f32_16x16x32_bf16 v[76:79], a[100:103], v[120:123], v[76:79]
    v_mfma_f32_16x16x32_bf16 v[76:79], a[108:111], v[124:127], v[76:79]
    buffer_load_dwordx4 v3, s[44:47], s13 offen offset:2048 sc1 lds
    v_mfma_f32_16x16x32_bf16 v[72:75], a[104:107], v[124:127], v[72:75]
    v_mfma_f32_16x16x32_bf16 v[72:75], a[96:99], v[120:123], v[72:75]
    s_waitcnt lgkmcnt(0)
    v_mfma_f32_16x16x32_bf16 v[32:35], a[112:115], v[80:83], v[32:35]
    s_add_u32 m0, s74, 36864
    s_mul_i32 s13, s77, 90112
    v_mfma_f32_16x16x32_bf16 v[32:35], a[120:123], v[84:87], v[32:35]
    ds_read_b128 v[104:107], v250 offset:25344
    v_mfma_f32_16x16x32_bf16 v[36:39], a[124:127], v[84:87], v[36:39]
    ds_read_b128 v[108:111], v250 offset:31488
    v_mfma_f32_16x16x32_bf16 v[36:39], a[116:119], v[80:83], v[36:39]
    ds_read_b128 v[112:115], v250 offset:25600
    buffer_load_dwordx4 v8, s[44:47], s13 offen offset:0 sc1 lds
    v_mfma_f32_16x16x32_bf16 v[44:47], a[116:119], v[88:91], v[44:47]
    ds_read_b128 v[116:119], v250 offset:31744
    v_mfma_f32_16x16x32_bf16 v[44:47], a[124:127], v[92:95], v[44:47]
    ds_read_b128 v[120:123], v250 offset:25856
    v_mfma_f32_16x16x32_bf16 v[40:43], a[120:123], v[92:95], v[40:43]
    ds_read_b128 v[124:127], v250 offset:32000
    buffer_load_dwordx4 v9, s[44:47], s13 offen offset:1024 sc1 lds
    v_mfma_f32_16x16x32_bf16 v[40:43], a[112:115], v[88:91], v[40:43]
    v_mfma_f32_16x16x32_bf16 v[48:51], a[112:115], v[96:99], v[48:51]
    v_mfma_f32_16x16x32_bf16 v[48:51], a[120:123], v[100:103], v[48:51]
    buffer_load_dwordx4 v3, s[44:47], s13 offen offset:2048 sc1 lds
    v_mfma_f32_16x16x32_bf16 v[52:55], a[124:127], v[100:103], v[52:55]
    v_mfma_f32_16x16x32_bf16 v[52:55], a[116:119], v[96:99], v[52:55]
    s_waitcnt lgkmcnt(0)
    v_mfma_f32_16x16x32_bf16 v[60:63], a[116:119], v[104:107], v[60:63]
    s_waitcnt vmcnt(14)
    s_barrier
    v_mfma_f32_16x16x32_bf16 v[60:63], a[124:127], v[108:111], v[60:63]
    ds_read_b128 v[80:83], v159 offset:0
    s_add_u32 m0, s74, 49152
    s_mul_i32 s13, s78, 90112
    v_mfma_f32_16x16x32_bf16 v[56:59], a[120:123], v[108:111], v[56:59]
    ds_read_b128 v[84:87], v159 offset:6144
    v_mfma_f32_16x16x32_bf16 v[56:59], a[112:115], v[104:107], v[56:59]
    ds_read_b128 v[88:91], v159 offset:256
    buffer_load_dwordx4 v8, s[44:47], s13 offen offset:0 sc1 lds
    v_mfma_f32_16x16x32_bf16 v[64:67], a[112:115], v[112:115], v[64:67]
    ds_read_b128 v[92:95], v159 offset:6400
    v_mfma_f32_16x16x32_bf16 v[64:67], a[120:123], v[116:119], v[64:67]
    ds_read_b128 v[96:99], v159 offset:512
    v_mfma_f32_16x16x32_bf16 v[68:71], a[124:127], v[116:119], v[68:71]
    ds_read_b128 v[100:103], v159 offset:6656
    buffer_load_dwordx4 v9, s[44:47], s13 offen offset:1024 sc1 lds
    v_mfma_f32_16x16x32_bf16 v[68:71], a[116:119], v[112:115], v[68:71]
    v_mfma_f32_16x16x32_bf16 v[76:79], a[116:119], v[120:123], v[76:79]
    v_mfma_f32_16x16x32_bf16 v[76:79], a[124:127], v[124:127], v[76:79]
    buffer_load_dwordx4 v3, s[44:47], s13 offen offset:2048 sc1 lds
    v_mfma_f32_16x16x32_bf16 v[72:75], a[120:123], v[124:127], v[72:75]
    v_mfma_f32_16x16x32_bf16 v[72:75], a[112:115], v[120:123], v[72:75]
    s_waitcnt lgkmcnt(0)
    v_mfma_f32_16x16x32_bf16 v[32:35], a[128:131], v[80:83], v[32:35]
    s_add_u32 m0, s74, 61440
    s_mul_i32 s13, s79, 90112
    v_mfma_f32_16x16x32_bf16 v[32:35], a[136:139], v[84:87], v[32:35]
    ds_read_b128 v[104:107], v159 offset:768
    v_mfma_f32_16x16x32_bf16 v[36:39], a[140:143], v[84:87], v[36:39]
    ds_read_b128 v[108:111], v159 offset:6912
    v_mfma_f32_16x16x32_bf16 v[36:39], a[132:135], v[80:83], v[36:39]
    ds_read_b128 v[112:115], v159 offset:1024
    buffer_load_dwordx4 v8, s[44:47], s13 offen offset:0 sc1 lds
    v_mfma_f32_16x16x32_bf16 v[44:47], a[132:135], v[88:91], v[44:47]
    ds_read_b128 v[116:119], v159 offset:7168
    v_mfma_f32_16x16x32_bf16 v[44:47], a[140:143], v[92:95], v[44:47]
    ds_read_b128 v[120:123], v159 offset:1280
    v_mfma_f32_16x16x32_bf16 v[40:43], a[136:139], v[92:95], v[40:43]
    ds_read_b128 v[124:127], v159 offset:7424
    buffer_load_dwordx4 v9, s[44:47], s13 offen offset:1024 sc1 lds
    v_mfma_f32_16x16x32_bf16 v[40:43], a[128:131], v[88:91], v[40:43]
    v_mfma_f32_16x16x32_bf16 v[48:51], a[128:131], v[96:99], v[48:51]
    v_mfma_f32_16x16x32_bf16 v[48:51], a[136:139], v[100:103], v[48:51]
    buffer_load_dwordx4 v3, s[44:47], s13 offen offset:2048 sc1 lds
    v_mfma_f32_16x16x32_bf16 v[52:55], a[140:143], v[100:103], v[52:55]
    v_mfma_f32_16x16x32_bf16 v[52:55], a[132:135], v[96:99], v[52:55]
    s_waitcnt lgkmcnt(0)
    v_mfma_f32_16x16x32_bf16 v[60:63], a[132:135], v[104:107], v[60:63]
    s_waitcnt vmcnt(13)
    s_barrier
    v_mfma_f32_16x16x32_bf16 v[60:63], a[140:143], v[108:111], v[60:63]
    ds_read_b128 v[80:83], v159 offset:12288
    s_add_u32 m0, s74, 0
    s_mul_i32 s13, s80, 90112
    v_mfma_f32_16x16x32_bf16 v[56:59], a[136:139], v[108:111], v[56:59]
    ds_read_b128 v[84:87], v159 offset:18432
    v_mfma_f32_16x16x32_bf16 v[56:59], a[128:131], v[104:107], v[56:59]
    ds_read_b128 v[88:91], v159 offset:12544
    buffer_load_dwordx4 v8, s[44:47], s13 offen offset:0 sc1 lds
    v_mfma_f32_16x16x32_bf16 v[64:67], a[128:131], v[112:115], v[64:67]
    ds_read_b128 v[92:95], v159 offset:18688
    v_mfma_f32_16x16x32_bf16 v[64:67], a[136:139], v[116:119], v[64:67]
    ds_read_b128 v[96:99], v159 offset:12800
    buffer_load_dword v29, v28, s[44:47], 0 offen sc1
    v_mfma_f32_16x16x32_bf16 v[68:71], a[140:143], v[116:119], v[68:71]
    ds_read_b128 v[100:103], v159 offset:18944
    buffer_load_dwordx4 v9, s[44:47], s13 offen offset:1024 sc1 lds
    v_mfma_f32_16x16x32_bf16 v[68:71], a[132:135], v[112:115], v[68:71]
    ds_read_b64_tr_b16 a[32:33], v10 offset:16384
    v_mfma_f32_16x16x32_bf16 v[76:79], a[132:135], v[120:123], v[76:79]
    ds_read_b64_tr_b16 a[34:35], v10 offset:18432
    v_mfma_f32_16x16x32_bf16 v[76:79], a[140:143], v[124:127], v[76:79]
    buffer_load_dwordx4 v3, s[44:47], s13 offen offset:2048 sc1 lds
    v_mfma_f32_16x16x32_bf16 v[72:75], a[136:139], v[124:127], v[72:75]
    ds_read_b64_tr_b16 a[40:41], v10 offset:20480
    v_mfma_f32_16x16x32_bf16 v[72:75], a[128:131], v[120:123], v[72:75]
    ds_read_b64_tr_b16 a[42:43], v10 offset:22528
    s_waitcnt lgkmcnt(4)
    v_mfma_f32_16x16x32_bf16 v[32:35], a[144:147], v[80:83], v[32:35]
    s_add_u32 m0, s73, 32768
    s_lshl_b32 s14, s87, 18
    v_mfma_f32_16x16x32_bf16 v[32:35], a[152:155], v[84:87], v[32:35]
    ds_read_b128 v[104:107], v159 offset:13056
    v_mfma_f32_16x16x32_bf16 v[36:39], a[156:159], v[84:87], v[36:39]
    ds_read_b128 v[108:111], v159 offset:19200
    buffer_load_dwordx4 v4, s[52:55], s14 offen offset:0 lds
    v_mfma_f32_16x16x32_bf16 v[36:39], a[148:151], v[80:83], v[36:39]
    ds_read_b128 v[112:115], v159 offset:13312
    v_mfma_f32_16x16x32_bf16 v[44:47], a[148:151], v[88:91], v[44:47]
    ds_read_b128 v[116:119], v159 offset:19456
    buffer_load_dwordx4 v5, s[52:55], s14 offen offset:1024 lds
    v_mfma_f32_16x16x32_bf16 v[44:47], a[156:159], v[92:95], v[44:47]
    ds_read_b128 v[120:123], v159 offset:13568
    v_mfma_f32_16x16x32_bf16 v[40:43], a[152:155], v[92:95], v[40:43]
    ds_read_b128 v[124:127], v159 offset:19712
    v_mfma_f32_16x16x32_bf16 v[40:43], a[144:147], v[88:91], v[40:43]
    ds_read_b64_tr_b16 a[36:37], v11 offset:16384
    buffer_load_dwordx4 v6, s[52:55], s14 offen offset:2048 lds
    v_mfma_f32_16x16x32_bf16 v[48:51], a[144:147], v[96:99], v[48:51]
    ds_read_b64_tr_b16 a[38:39], v11 offset:18432
    v_mfma_f32_16x16x32_bf16 v[48:51], a[152:155], v[100:103], v[48:51]
    buffer_load_dwordx4 v7, s[52:55], s14 offen offset:3072 lds
    v_mfma_f32_16x16x32_bf16 v[52:55], a[156:159], v[100:103], v[52:55]
    ds_read_b64_tr_b16 a[44:45], v11 offset:20480
    v_mfma_f32_16x16x32_bf16 v[52:55], a[148:151], v[96:99], v[52:55]
    ds_read_b64_tr_b16 a[46:47], v11 offset:22528
    s_waitcnt lgkmcnt(4)
    v_mfma_f32_16x16x32_bf16 v[60:63], a[148:151], v[104:107], v[60:63]
    s_waitcnt vmcnt(17)
    s_barrier
    v_mfma_f32_16x16x32_bf16 v[60:63], a[156:159], v[108:111], v[60:63]
    ds_read_b128 v[80:83], v159 offset:24576
    v_mfma_f32_16x16x32_bf16 v[56:59], a[152:155], v[108:111], v[56:59]
    ds_read_b128 v[84:87], v159 offset:30720
    v_mfma_f32_16x16x32_bf16 v[56:59], a[144:147], v[104:107], v[56:59]
    ds_read_b128 v[88:91], v159 offset:24832
    v_mfma_f32_16x16x32_bf16 v[64:67], a[144:147], v[112:115], v[64:67]
    ds_read_b128 v[92:95], v159 offset:30976
    v_mfma_f32_16x16x32_bf16 v[64:67], a[152:155], v[116:119], v[64:67]
    ds_read_b128 v[96:99], v159 offset:25088
    v_mfma_f32_16x16x32_bf16 v[68:71], a[156:159], v[116:119], v[68:71]
    ds_read_b128 v[100:103], v159 offset:31232
    v_mfma_f32_16x16x32_bf16 v[68:71], a[148:151], v[112:115], v[68:71]
    v_mfma_f32_16x16x32_bf16 v[76:79], a[148:151], v[120:123], v[76:79]
    v_mfma_f32_16x16x32_bf16 v[76:79], a[156:159], v[124:127], v[76:79]
    v_mfma_f32_16x16x32_bf16 v[72:75], a[152:155], v[124:127], v[72:75]
    v_mfma_f32_16x16x32_bf16 v[72:75], a[144:147], v[120:123], v[72:75]
    s_waitcnt lgkmcnt(0)
    v_mfma_f32_16x16x32_bf16 v[32:35], a[160:163], v[80:83], v[32:35]
    v_mfma_f32_16x16x32_bf16 v[32:35], a[168:171], v[84:87], v[32:35]
    ds_read_b128 v[104:107], v159 offset:25344
    v_mfma_f32_16x16x32_bf16 v[36:39], a[172:175], v[84:87], v[36:39]
    ds_read_b128 v[108:111], v159 offset:31488
    v_mfma_f32_16x16x32_bf16 v[36:39], a[164:167], v[80:83], v[36:39]
    ds_read_b128 v[112:115], v159 offset:25600
    v_mfma_f32_16x16x32_bf16 v[44:47], a[164:167], v[88:91], v[44:47]
    ds_read_b128 v[116:119], v159 offset:31744
    v_mfma_f32_16x16x32_bf16 v[44:47], a[172:175], v[92:95], v[44:47]
    ds_read_b128 v[120:123], v159 offset:25856
    v_mfma_f32_16x16x32_bf16 v[40:43], a[168:171], v[92:95], v[40:43]
    ds_read_b128 v[124:127], v159 offset:32000
    v_mfma_f32_16x16x32_bf16 v[40:43], a[160:163], v[88:91], v[40:43]
    v_mfma_f32_16x16x32_bf16 v[48:51], a[160:163], v[96:99], v[48:51]
    v_mfma_f32_16x16x32_bf16 v[48:51], a[168:171], v[100:103], v[48:51]
    v_mfma_f32_16x16x32_bf16 v[52:55], a[172:175], v[100:103], v[52:55]
    v_mfma_f32_16x16x32_bf16 v[52:55], a[164:167], v[96:99], v[52:55]
    s_waitcnt lgkmcnt(0)
    v_mfma_f32_16x16x32_bf16 v[60:63], a[164:167], v[104:107], v[60:63]
    s_waitcnt vmcnt(14)
    s_barrier
    v_mfma_f32_16x16x32_bf16 v[60:63], a[172:175], v[108:111], v[60:63]
    ds_read_b128 v[80:83], v250 offset:0
    s_waitcnt vmcnt(6)
    v_mfma_f32_16x16x32_bf16 v[56:59], a[168:171], v[108:111], v[56:59]
    ds_read_b128 v[84:87], v250 offset:6144
    v_cmp_ne_u32 vcc, s68, v29
    v_mfma_f32_16x16x32_bf16 v[56:59], a[160:163], v[104:107], v[56:59]
    ds_read_b128 v[88:91], v250 offset:256
    v_mfma_f32_16x16x32_bf16 v[64:67], a[160:163], v[112:115], v[64:67]
    ds_read_b128 v[92:95], v250 offset:6400
    v_mfma_f32_16x16x32_bf16 v[64:67], a[168:171], v[116:119], v[64:67]
    ds_read_b128 v[96:99], v250 offset:512
    s_cbranch_vccnz L_rs_p5
L_ok_p5:
    v_mfma_f32_16x16x32_bf16 v[68:71], a[172:175], v[116:119], v[68:71]
    ds_read_b128 v[100:103], v250 offset:6656
    buffer_load_dwordx4 v[160:163], v246, s[44:47], s10 offen offset:0 sc1
    v_mfma_f32_16x16x32_bf16 v[68:71], a[164:167], v[112:115], v[68:71]
    v_mfma_f32_16x16x32_bf16 v[76:79], a[164:167], v[120:123], v[76:79]
    v_mfma_f32_16x16x32_bf16 v[76:79], a[172:175], v[124:127], v[76:79]
    buffer_load_dwordx4 v[164:167], v246, s[44:47], s10 offen offset:1024 sc1
    v_mfma_f32_16x16x32_bf16 v[72:75], a[168:171], v[124:127], v[72:75]
    buffer_load_dwordx4 v[168:171], v246, s[44:47], s10 offen offset:2048 sc1
    v_mfma_f32_16x16x32_bf16 v[72:75], a[160:163], v[120:123], v[72:75]
    s_waitcnt lgkmcnt(0)
    v_mfma_f32_16x16x32_bf16 v[32:35], a[176:179], v[80:83], v[32:35]
    v_mfma_f32_16x16x32_bf16 v[32:35], a[184:187], v[84:87], v[32:35]
    ds_read_b128 v[104:107], v250 offset:768
    v_mfma_f32_16x16x32_bf16 v[36:39], a[188:191], v[84:87], v[36:39]
    ds_read_b128 v[108:111], v250 offset:6912
    buffer_load_dwordx4 v[172:175], v247, s[44:47], s10 offen offset:0 sc1
    v_mfma_f32_16x16x32_bf16 v[36:39], a[180:183], v[80:83], v[36:39]
    ds_read_b128 v[112:115], v250 offset:1024
    v_mfma_f32_16x16x32_bf16 v[44:47], a[180:183], v[88:91], v[44:47]
    ds_read_b128 v[116:119], v250 offset:7168
    v_mfma_f32_16x16x32_bf16 v[44:47], a[188:191], v[92:95], v[44:47]
    ds_read_b128 v[120:123], v250 offset:1280
    buffer_load_dwordx4 v[176:179], v247, s[44:47], s10 offen offset:1024 sc1
    v_mfma_f32_16x16x32_bf16 v[40:43], a[184:187], v[92:95], v[40:43]
    ds_read_b128 v[124:127], v250 offset:7424
    v_mfma_f32_16x16x32_bf16 v[40:43], a[176:179], v[88:91], v[40:43]
    v_mfma_f32_16x16x32_bf16 v[48:51], a[176:179], v[96:99], v[48:51]
    v_mfma_f32_16x16x32_bf16 v[48:51], a[184:187], v[100:103], v[48:51]
    v_mfma_f32_16x16x32_bf16 v[52:55], a[188:191], v[100:103], v[52:55]
    buffer_load_dwordx4 v[180:183], v247, s[44:47], s10 offen offset:2048 sc1
    v_mfma_f32_16x16x32_bf16 v[52:55], a[180:183], v[96:99], v[52:55]
    s_waitcnt lgkmcnt(0)
    v_mfma_f32_16x16x32_bf16 v[60:63], a[180:183], v[104:107], v[60:63]
    s_barrier
    v_mfma_f32_16x16x32_bf16 v[60:63], a[188:191], v[108:111], v[60:63]
    ds_read_b128 v[80:83], v250 offset:12288
    s_add_u32 m0, s74, 12288
    s_mul_i32 s13, s81, 90112
    v_mfma_f32_16x16x32_bf16 v[56:59], a[184:187], v[108:111], v[56:59]
    ds_read_b128 v[84:87], v250 offset:18432
    v_mfma_f32_16x16x32_bf16 v[56:59], a[176:179], v[104:107], v[56:59]
    ds_read_b128 v[88:91], v250 offset:12544
    buffer_load_dwordx4 v8, s[44:47], s13 offen offset:0 sc1 lds
    v_mfma_f32_16x16x32_bf16 v[64:67], a[176:179], v[112:115], v[64:67]
    ds_read_b128 v[92:95], v250 offset:18688
    v_mfma_f32_16x16x32_bf16 v[64:67], a[184:187], v[116:119], v[64:67]
    ds_read_b128 v[96:99], v250 offset:12800
    v_mfma_f32_16x16x32_bf16 v[68:71], a[188:191], v[116:119], v[68:71]
    ds_read_b128 v[100:103], v250 offset:18944
    buffer_load_dwordx4 v9, s[44:47], s13 offen offset:1024 sc1 lds
    v_mfma_f32_16x16x32_bf16 v[68:71], a[180:183], v[112:115], v[68:71]
    v_mfma_f32_16x16x32_bf16 v[76:79], a[180:183], v[120:123], v[76:79]
    v_mfma_f32_16x16x32_bf16 v[76:79], a[188:191], v[124:127], v[76:79]
    buffer_load_dwordx4 v3, s[44:47], s13 offen offset:2048 sc1 lds
    v_mfma_f32_16x16x32_bf16 v[72:75], a[184:187], v[124:127], v[72:75]
    v_mfma_f32_16x16x32_bf16 v[72:75], a[176:179], v[120:123], v[72:75]
    s_waitcnt lgkmcnt(0)
    v_mfma_f32_16x16x32_bf16 v[32:35], a[192:195], v[80:83], v[32:35]
    s_add_u32 m0, s73, 49152
    s_lshl_b32 s14, s88, 18
    v_mfma_f32_16x16x32_bf16 v[32:35], a[200:203], v[84:87], v[32:35]
    ds_read_b128 v[104:107], v250 offset:13056
    v_mfma_f32_16x16x32_bf16 v[36:39], a[204:207], v[84:87], v[36:39]
    ds_read_b128 v[108:111], v250 offset:19200
    buffer_load_dwordx4 v4, s[52:55], s14 offen offset:0 lds
    v_mfma_f32_16x16x32_bf16 v[36:39], a[196:199], v[80:83], v[36:39]
    ds_read_b128 v[112:115], v250 offset:13312
    v_mfma_f32_16x16x32_bf16 v[44:47], a[196:199], v[88:91], v[44:47]
    ds_read_b128 v[116:119], v250 offset:19456
    buffer_load_dwordx4 v5, s[52:55], s14 offen offset:1024 lds
    v_mfma_f32_16x16x32_bf16 v[44:47], a[204:207], v[92:95], v[44:47]
    ds_read_b128 v[120:123], v250 offset:13568
    v_mfma_f32_16x16x32_bf16 v[40:43], a[200:203], v[92:95], v[40:43]
    ds_read_b128 v[124:127], v250 offset:19712
    v_mfma_f32_16x16x32_bf16 v[40:43], a[192:195], v[88:91], v[40:43]
    buffer_load_dwordx4 v6, s[52:55], s14 offen offset:2048 lds
    v_mfma_f32_16x16x32_bf16 v[48:51], a[192:195], v[96:99], v[48:51]
    v_mfma_f32_16x16x32_bf16 v[48:51], a[200:203], v[100:103], v[48:51]
    buffer_load_dwordx4 v7, s[52:55], s14 offen offset:3072 lds
    v_mfma_f32_16x16x32_bf16 v[52:55], a[204:207], v[100:103], v[52:55]
    v_mfma_f32_16x16x32_bf16 v[52:55], a[196:199], v[96:99], v[52:55]
    s_waitcnt lgkmcnt(0)
    v_mfma_f32_16x16x32_bf16 v[60:63], a[196:199], v[104:107], v[60:63]
    s_barrier
    v_mfma_f32_16x16x32_bf16 v[60:63], a[204:207], v[108:111], v[60:63]
    ds_read_b128 v[80:83], v250 offset:24576
    v_mfma_f32_16x16x32_bf16 v[56:59], a[200:203], v[108:111], v[56:59]
    ds_read_b128 v[84:87], v250 offset:30720
    v_mfma_f32_16x16x32_bf16 v[56:59], a[192:195], v[104:107], v[56:59]
    ds_read_b128 v[88:91], v250 offset:24832
    v_mfma_f32_16x16x32_bf16 v[64:67], a[192:195], v[112:115], v[64:67]
    ds_read_b128 v[92:95], v250 offset:30976
    v_mfma_f32_16x16x32_bf16 v[64:67], a[200:203], v[116:119], v[64:67]
    ds_read_b128 v[96:99], v250 offset:25088
    v_mfma_f32_16x16x32_bf16 v[68:71], a[204:207], v[116:119], v[68:71]
    ds_read_b128 v[100:103], v250 offset:31232
    v_mfma_f32_16x16x32_bf16 v[68:71], a[196:199], v[112:115], v[68:71]
    v_mfma_f32_16x16x32_bf16 v[76:79], a[196:199], v[120:123], v[76:79]
    v_mfma_f32_16x16x32_bf16 v[76:79], a[204:207], v[124:127], v[76:79]
    v_mfma_f32_16x16x32_bf16 v[72:75], a[200:203], v[124:127], v[72:75]
    v_mfma_f32_16x16x32_bf16 v[72:75], a[192:195], v[120:123], v[72:75]
    s_waitcnt lgkmcnt(0)
    v_mfma_f32_16x16x32_bf16 v[32:35], a[208:211], v[80:83], v[32:35]
    s_add_u32 m0, s73, 65536
    s_lshl_b32 s14, s89, 18
    v_mfma_f32_16x16x32_bf16 v[32:35], a[216:219], v[84:87], v[32:35]
    ds_read_b128 v[104:107], v250 offset:25344
    v_mfma_f32_16x16x32_bf16 v[36:39], a[220:223], v[84:87], v[36:39]
    ds_read_b128 v[108:111], v250 offset:31488
    buffer_load_dwordx4 v4, s[52:55], s14 offen offset:0 lds
    v_mfma_f32_16x16x32_bf16 v[36:39], a[212:215], v[80:83], v[36:39]
    ds_read_b128 v[112:115], v250 offset:25600
    v_mfma_f32_16x16x32_bf16 v[44:47], a[212:215], v[88:91], v[44:47]
    ds_read_b128 v[116:119], v250 offset:31744
    buffer_load_dwordx4 v5, s[52:55], s14 offen offset:1024 lds
    v_mfma_f32_16x16x32_bf16 v[44:47], a[220:223], v[92:95], v[44:47]
    ds_read_b128 v[120:123], v250 offset:25856
    v_mfma_f32_16x16x32_bf16 v[40:43], a[216:219], v[92:95], v[40:43]
    ds_read_b128 v[124:127], v250 offset:32000
    v_mfma_f32_16x16x32_bf16 v[40:43], a[208:211], v[88:91], v[40:43]
    buffer_load_dwordx4 v6, s[52:55], s14 offen offset:2048 lds
    v_mfma_f32_16x16x32_bf16 v[48:51], a[208:211], v[96:99], v[48:51]
    v_mfma_f32_16x16x32_bf16 v[48:51], a[216:219], v[100:103], v[48:51]
    buffer_load_dwordx4 v7, s[52:55], s14 offen offset:3072 lds
    v_mfma_f32_16x16x32_bf16 v[52:55], a[220:223], v[100:103], v[52:55]
    v_mfma_f32_16x16x32_bf16 v[52:55], a[212:215], v[96:99], v[52:55]
    s_waitcnt lgkmcnt(0)
    v_mfma_f32_16x16x32_bf16 v[60:63], a[212:215], v[104:107], v[60:63]
    s_waitcnt vmcnt(17)
    s_barrier
    v_mfma_f32_16x16x32_bf16 v[60:63], a[220:223], v[108:111], v[60:63]
    ds_read_b128 v[80:83], v159 offset:0
    v_mfma_f32_16x16x32_bf16 v[56:59], a[216:219], v[108:111], v[56:59]
    ds_read_b128 v[84:87], v159 offset:6144
    v_mfma_f32_16x16x32_bf16 v[56:59], a[208:211], v[104:107], v[56:59]
    ds_read_b128 v[88:91], v159 offset:256
    v_mfma_f32_16x16x32_bf16 v[64:67], a[208:211], v[112:115], v[64:67]
    ds_read_b128 v[92:95], v159 offset:6400
    v_mfma_f32_16x16x32_bf16 v[64:67], a[216:219], v[116:119], v[64:67]
    ds_read_b128 v[96:99], v159 offset:512
    v_mfma_f32_16x16x32_bf16 v[68:71], a[220:223], v[116:119], v[68:71]
    ds_read_b128 v[100:103], v159 offset:6656
    v_mfma_f32_16x16x32_bf16 v[68:71], a[212:215], v[112:115], v[68:71]
    ds_read_b64_tr_b16 a[48:49], v10 offset:32768
    v_mfma_f32_16x16x32_bf16 v[76:79], a[212:215], v[120:123], v[76:79]
    ds_read_b64_tr_b16 a[50:51], v10 offset:34816
    v_mfma_f32_16x16x32_bf16 v[76:79], a[220:223], v[124:127], v[76:79]
    v_mfma_f32_16x16x32_bf16 v[72:75], a[216:219], v[124:127], v[72:75]
    ds_read_b64_tr_b16 a[56:57], v10 offset:36864
    v_mfma_f32_16x16x32_bf16 v[72:75], a[208:211], v[120:123], v[72:75]
    ds_read_b64_tr_b16 a[58:59], v10 offset:38912
    s_waitcnt lgkmcnt(4)
    v_mfma_f32_16x16x32_bf16 v[32:35], a[224:227], v[80:83], v[32:35]
    s_add_u32 m0, s73, 0
    s_lshl_b32 s14, s90, 18
    v_mfma_f32_16x16x32_bf16 v[32:35], a[232:235], v[84:87], v[32:35]
    ds_read_b128 v[104:107], v159 offset:768
    v_mfma_f32_16x16x32_bf16 v[36:39], a[236:239], v[84:87], v[36:39]
    ds_read_b128 v[108:111], v159 offset:6912
    buffer_load_dwordx4 v4, s[52:55], s14 offen offset:0 lds
    v_mfma_f32_16x16x32_bf16 v[36:39], a[228:231], v[80:83], v[36:39]
    ds_read_b128 v[112:115], v159 offset:1024
    v_mfma_f32_16x16x32_bf16 v[44:47], a[228:231], v[88:91], v[44:47]
    ds_read_b128 v[116:119], v159 offset:7168
    buffer_load_dwordx4 v5, s[52:55], s14 offen offset:1024 lds
    v_mfma_f32_16x16x32_bf16 v[44:47], a[236:239], v[92:95], v[44:47]
    ds_read_b128 v[120:123], v159 offset:1280
    v_mfma_f32_16x16x32_bf16 v[40:43], a[232:235], v[92:95], v[40:43]
    ds_read_b128 v[124:127], v159 offset:7424
    v_mfma_f32_16x16x32_bf16 v[40:43], a[224:227], v[88:91], v[40:43]
    ds_read_b64_tr_b16 a[52:53], v11 offset:32768
    buffer_load_dwordx4 v6, s[52:55], s14 offen offset:2048 lds
    v_mfma_f32_16x16x32_bf16 v[48:51], a[224:227], v[96:99], v[48:51]
    ds_read_b64_tr_b16 a[54:55], v11 offset:34816
    v_mfma_f32_16x16x32_bf16 v[48:51], a[232:235], v[100:103], v[48:51]
    buffer_load_dwordx4 v7, s[52:55], s14 offen offset:3072 lds
    v_mfma_f32_16x16x32_bf16 v[52:55], a[236:239], v[100:103], v[52:55]
    ds_read_b64_tr_b16 a[60:61], v11 offset:36864
    v_mfma_f32_16x16x32_bf16 v[52:55], a[228:231], v[96:99], v[52:55]
    ds_read_b64_tr_b16 a[62:63], v11 offset:38912
    s_waitcnt lgkmcnt(4)
    v_mfma_f32_16x16x32_bf16 v[60:63], a[228:231], v[104:107], v[60:63]
    s_waitcnt vmcnt(12)
    s_barrier
    v_mfma_f32_16x16x32_bf16 v[60:63], a[236:239], v[108:111], v[60:63]
    ds_read_b128 v[80:83], v159 offset:12288
    v_mfma_f32_16x16x32_bf16 v[56:59], a[232:235], v[108:111], v[56:59]
    ds_read_b128 v[84:87], v159 offset:18432
    v_mfma_f32_16x16x32_bf16 v[56:59], a[224:227], v[104:107], v[56:59]
    ds_read_b128 v[88:91], v159 offset:12544
    v_mfma_f32_16x16x32_bf16 v[64:67], a[224:227], v[112:115], v[64:67]
    ds_read_b128 v[92:95], v159 offset:18688
    v_mfma_f32_16x16x32_bf16 v[64:67], a[232:235], v[116:119], v[64:67]
    ds_read_b128 v[96:99], v159 offset:12800
    v_mfma_f32_16x16x32_bf16 v[68:71], a[236:239], v[116:119], v[68:71]
    ds_read_b128 v[100:103], v159 offset:18944
    v_mfma_f32_16x16x32_bf16 v[68:71], a[228:231], v[112:115], v[68:71]
    v_mfma_f32_16x16x32_bf16 v[76:79], a[228:231], v[120:123], v[76:79]
    v_mfma_f32_16x16x32_bf16 v[76:79], a[236:239], v[124:127], v[76:79]
    v_mfma_f32_16x16x32_bf16 v[72:75], a[232:235], v[124:127], v[72:75]
    v_mfma_f32_16x16x32_bf16 v[72:75], a[224:227], v[120:123], v[72:75]
    s_waitcnt lgkmcnt(0)
    v_mfma_f32_16x16x32_bf16 v[32:35], a[240:243], v[80:83], v[32:35]
    s_add_u32 m0, s73, 16384
    s_lshl_b32 s14, s91, 18
    v_mfma_f32_16x16x32_bf16 v[32:35], a[248:251], v[84:87], v[32:35]
    ds_read_b128 v[104:107], v159 offset:13056
    v_mfma_f32_16x16x32_bf16 v[32:35], v[130:133], v[160:163], v[32:35]
    ds_read_b128 v[108:111], v159 offset:19200
    buffer_load_dwordx4 v4, s[52:55], s14 offen offset:0 lds
    v_mfma_f32_16x16x32_bf16 v[36:39], a[252:255], v[84:87], v[36:39]
    ds_read_b128 v[112:115], v159 offset:13312
    v_mfma_f32_16x16x32_bf16 v[36:39], a[244:247], v[80:83], v[36:39]
    ds_read_b128 v[116:119], v159 offset:19456
    buffer_load_dwordx4 v5, s[52:55], s14 offen offset:1024 lds
    v_mfma_f32_16x16x32_bf16 v[36:39], v[128:131], v[160:163], v[36:39]
    ds_read_b128 v[120:123], v159 offset:13568
    v_mfma_f32_16x16x32_bf16 v[44:47], a[244:247], v[88:91], v[44:47]
    ds_read_b128 v[124:127], v159 offset:19712
    v_mfma_f32_16x16x32_bf16 v[44:47], a[252:255], v[92:95], v[44:47]
    buffer_load_dwordx4 v6, s[52:55], s14 offen offset:2048 lds
    v_mfma_f32_16x16x32_bf16 v[44:47], v[128:131], v[164:167], v[44:47]
    v_mfma_f32_16x16x32_bf16 v[40:43], a[248:251], v[92:95], v[40:43]
    buffer_load_dwordx4 v7, s[52:55], s14 offen offset:3072 lds
    v_mfma_f32_16x16x32_bf16 v[40:43], a[240:243], v[88:91], v[40:43]
    v_mfma_f32_16x16x32_bf16 v[40:43], v[130:133], v[164:167], v[40:43]
    v_mfma_f32_16x16x32_bf16 v[48:51], a[240:243], v[96:99], v[48:51]
    v_mfma_f32_16x16x32_bf16 v[48:51], a[248:251], v[100:103], v[48:51]
    v_mfma_f32_16x16x32_bf16 v[48:51], v[130:133], v[168:171], v[48:51]
    v_mfma_f32_16x16x32_bf16 v[52:55], a[252:255], v[100:103], v[52:55]
    v_mfma_f32_16x16x32_bf16 v[52:55], a[244:247], v[96:99], v[52:55]
    v_mfma_f32_16x16x32_bf16 v[52:55], v[128:131], v[168:171], v[52:55]
    s_waitcnt lgkmcnt(0)
    v_mfma_f32_16x16x32_bf16 v[60:63], a[244:247], v[104:107], v[60:63]
    s_barrier
    v_mfma_f32_16x16x32_bf16 v[60:63], a[252:255], v[108:111], v[60:63]
    s_add_u32 m0, s73, 131072
    s_lshl_b32 s14, s92, 18
    v_mfma_f32_16x16x32_bf16 v[60:63], v[128:131], v[172:175], v[60:63]
    buffer_load_dwordx4 v4, s[52:55], s14 offen offset:0 lds
    v_mfma_f32_16x16x32_bf16 v[56:59], a[248:251], v[108:111], v[56:59]
    buffer_load_dwordx4 v5, s[52:55], s14 offen offset:1024 lds
    v_mfma_f32_16x16x32_bf16 v[56:59], a[240:243], v[104:107], v[56:59]
    buffer_load_dwordx4 v6, s[52:55], s14 offen offset:2048 lds
    v_mfma_f32_16x16x32_bf16 v[56:59], v[130:133], v[172:175], v[56:59]
    buffer_load_dwordx4 v7, s[52:55], s14 offen offset:3072 lds
    v_mfma_f32_16x16x32_bf16 v[64:67], a[240:243], v[112:115], v[64:67]
    s_add_u32 m0, s73, 147456
    s_lshl_b32 s14, s93, 18
    v_mfma_f32_16x16x32_bf16 v[64:67], a[248:251], v[116:119], v[64:67]
    buffer_load_dwordx4 v4, s[52:55], s14 offen offset:0 lds
    v_mfma_f32_16x16x32_bf16 v[64:67], v[130:133], v[176:179], v[64:67]
    buffer_load_dwordx4 v5, s[52:55], s14 offen offset:1024 lds
    v_mfma_f32_16x16x32_bf16 v[68:71], a[252:255], v[116:119], v[68:71]
    buffer_load_dwordx4 v6, s[52:55], s14 offen offset:2048 lds
    v_mfma_f32_16x16x32_bf16 v[68:71], a[244:247], v[112:115], v[68:71]
    buffer_load_dwordx4 v7, s[52:55], s14 offen offset:3072 lds
    v_mfma_f32_16x16x32_bf16 v[68:71], v[128:131], v[176:179], v[68:71]
    v_mfma_f32_16x16x32_bf16 v[76:79], a[244:247], v[120:123], v[76:79]
    v_mfma_f32_16x16x32_bf16 v[76:79], a[252:255], v[124:127], v[76:79]
    v_mfma_f32_16x16x32_bf16 v[76:79], v[128:131], v[180:183], v[76:79]
    v_mfma_f32_16x16x32_bf16 v[72:75], a[248:251], v[124:127], v[72:75]
    v_mfma_f32_16x16x32_bf16 v[72:75], a[240:243], v[120:123], v[72:75]
    v_mfma_f32_16x16x32_bf16 v[72:75], v[130:133], v[180:183], v[72:75]
    s_waitcnt lgkmcnt(0)
    v_mov_b32 v88, 0xc0135761
    s_mov_b32 s10, 0xbdd2d3e8
    s_lshl_b32 s9, s69, 2
    s_add_u32 s9, s9, s3
    s_mul_i32 s9, s9, 69632
    s_add_u32 s9, s9, 12795904
    v_pk_mul_f32 v[160:161], v[32:33], v[32:33]
    v_pk_mul_f32 v[162:163], v[34:35], v[34:35]
    v_pk_mul_f32 v[164:165], v[36:37], v[36:37]
    v_pk_mul_f32 v[166:167], v[38:39], v[38:39]
    v_pk_mul_f32 v[168:169], v[40:41], v[40:41]
    v_pk_mul_f32 v[170:171], v[42:43], v[42:43]
    v_pk_mul_f32 v[172:173], v[44:45], v[44:45]
    v_pk_mul_f32 v[174:175], v[46:47], v[46:47]
    v_pk_fma_f32 v[160:161], v[160:161], s[10:11], v[88:89] op_sel_hi:[1,0,0]
    v_pk_fma_f32 v[162:163], v[162:163], s[10:11], v[88:89] op_sel_hi:[1,0,0]
    v_pk_fma_f32 v[164:165], v[164:165], s[10:11], v[88:89] op_sel_hi:[1,0,0]
    v_pk_fma_f32 v[166:167], v[166:167], s[10:11], v[88:89] op_sel_hi:[1,0,0]
    v_pk_fma_f32 v[168:169], v[168:169], s[10:11], v[88:89] op_sel_hi:[1,0,0]
    v_pk_fma_f32 v[170:171], v[170:171], s[10:11], v[88:89] op_sel_hi:[1,0,0]
    v_pk_fma_f32 v[172:173], v[172:173], s[10:11], v[88:89] op_sel_hi:[1,0,0]
    v_pk_fma_f32 v[174:175], v[174:175], s[10:11], v[88:89] op_sel_hi:[1,0,0]
    v_pk_mul_f32 v[160:161], v[160:161], v[32:33]
    v_pk_mul_f32 v[162:163], v[162:163], v[34:35]
    v_pk_mul_f32 v[164:165], v[164:165], v[36:37]
    v_pk_mul_f32 v[166:167], v[166:167], v[38:39]
    v_pk_mul_f32 v[168:169], v[168:169], v[40:41]
    v_pk_mul_f32 v[170:171], v[170:171], v[42:43]
    v_pk_mul_f32 v[172:173], v[172:173], v[44:45]
    v_pk_mul_f32 v[174:175], v[174:175], v[46:47]
    v_exp_f32 v160, v160
    v_exp_f32 v161, v161
    v_exp_f32 v162, v162
    v_exp_f32 v163, v163
    v_exp_f32 v164, v164
    v_exp_f32 v165, v165
    v_exp_f32 v166, v166
    v_exp_f32 v167, v167
    v_exp_f32 v168, v168
    v_exp_f32 v169, v169
    v_exp_f32 v170, v170
    v_exp_f32 v171, v171
    v_exp_f32 v172, v172
    v_exp_f32 v173, v173
    v_exp_f32 v174, v174
    v_exp_f32 v175, v175
    v_pk_add_f32 v[160:161], v[160:161], 1.0 op_sel_hi:[1,0]
L_pl_G_5:
    s_cbranch_execz L_wret
    v_pk_add_f32 v[162:163], v[162:163], 1.0 op_sel_hi:[1,0]
    v_pk_add_f32 v[164:165], v[164:165], 1.0 op_sel_hi:[1,0]
    v_pk_add_f32 v[166:167], v[166:167], 1.0 op_sel_hi:[1,0]
    v_pk_add_f32 v[168:169], v[168:169], 1.0 op_sel_hi:[1,0]
    v_pk_add_f32 v[170:171], v[170:171], 1.0 op_sel_hi:[1,0]
    v_pk_add_f32 v[172:173], v[172:173], 1.0 op_sel_hi:[1,0]
    v_pk_add_f32 v[174:175], v[174:175], 1.0 op_sel_hi:[1,0]
    v_rcp_f32 v160, v160
    v_rcp_f32 v161, v161
    v_rcp_f32 v162, v162
    v_rcp_f32 v163, v163
    v_rcp_f32 v164, v164
    v_rcp_f32 v165, v165
    v_rcp_f32 v166, v166
    v_rcp_f32 v167, v167
    v_rcp_f32 v168, v168
    v_rcp_f32 v169, v169
    v_rcp_f32 v170, v170
    v_rcp_f32 v171, v171
    v_rcp_f32 v172, v172
    v_rcp_f32 v173, v173
    v_rcp_f32 v174, v174
    v_rcp_f32 v175, v175
    v_pk_mul_f32 v[32:33], v[32:33], v[160:161]
    v_pk_mul_f32 v[34:35], v[34:35], v[162:163]
    v_pk_mul_f32 v[36:37], v[36:37], v[164:165]
    v_pk_mul_f32 v[38:39], v[38:39], v[166:167]
    v_pk_mul_f32 v[40:41], v[40:41], v[168:169]
    v_pk_mul_f32 v[42:43], v[42:43], v[170:171]
    v_pk_mul_f32 v[44:45], v[44:45], v[172:173]
    v_pk_mul_f32 v[46:47], v[46:47], v[174:175]
    v_cvt_pk_bf16_f32 v96, v32, v33
    v_cvt_pk_bf16_f32 v97, v34, v35
    v_cvt_pk_bf16_f32 v98, v36, v37
    v_cvt_pk_bf16_f32 v99, v38, v39
    v_cvt_pk_bf16_f32 v100, v40, v41
    v_cvt_pk_bf16_f32 v101, v42, v43
    v_cvt_pk_bf16_f32 v102, v44, v45
    v_cvt_pk_bf16_f32 v103, v46, v47
    buffer_store_dwordx4 v[96:99], v240, s[44:47], s9 offen sc1
    buffer_store_dwordx4 v[100:103], v241, s[44:47], s9 offen sc1
    v_pk_mul_f32 v[160:161], v[48:49], v[48:49]
    v_pk_mul_f32 v[162:163], v[50:51], v[50:51]
    v_pk_mul_f32 v[164:165], v[52:53], v[52:53]
    v_pk_mul_f32 v[166:167], v[54:55], v[54:55]
    v_pk_mul_f32 v[168:169], v[56:57], v[56:57]
    v_pk_mul_f32 v[170:171], v[58:59], v[58:59]
    v_pk_mul_f32 v[172:173], v[60:61], v[60:61]
    v_pk_mul_f32 v[174:175], v[62:63], v[62:63]
    v_pk_fma_f32 v[160:161], v[160:161], s[10:11], v[88:89] op_sel_hi:[1,0,0]
    v_pk_fma_f32 v[162:163], v[162:163], s[10:11], v[88:89] op_sel_hi:[1,0,0]
    v_pk_fma_f32 v[164:165], v[164:165], s[10:11], v[88:89] op_sel_hi:[1,0,0]
    v_pk_fma_f32 v[166:167], v[166:167], s[10:11], v[88:89] op_sel_hi:[1,0,0]
    v_pk_fma_f32 v[168:169], v[168:169], s[10:11], v[88:89] op_sel_hi:[1,0,0]
    v_pk_fma_f32 v[170:171], v[170:171], s[10:11], v[88:89] op_sel_hi:[1,0,0]
    v_pk_fma_f32 v[172:173], v[172:173], s[10:11], v[88:89] op_sel_hi:[1,0,0]
    v_pk_fma_f32 v[174:175], v[174:175], s[10:11], v[88:89] op_sel_hi:[1,0,0]
    v_pk_mul_f32 v[160:161], v[160:161], v[48:49]
    v_pk_mul_f32 v[162:163], v[162:163], v[50:51]
    v_pk_mul_f32 v[164:165], v[164:165], v[52:53]
    v_pk_mul_f32 v[166:167], v[166:167], v[54:55]
    v_pk_mul_f32 v[168:169], v[168:169], v[56:57]
    v_pk_mul_f32 v[170:171], v[170:171], v[58:59]
    v_pk_mul_f32 v[172:173], v[172:173], v[60:61]
    v_pk_mul_f32 v[174:175], v[174:175], v[62:63]
    v_exp_f32 v160, v160
    v_exp_f32 v161, v161
    v_exp_f32 v162, v162
    v_exp_f32 v163, v163
    v_exp_f32 v164, v164
    v_exp_f32 v165, v165
    v_exp_f32 v166, v166
    v_exp_f32 v167, v167
    v_exp_f32 v168, v168
    v_exp_f32 v169, v169
    v_exp_f32 v170, v170
    v_exp_f32 v171, v171
    v_exp_f32 v172, v172
    v_exp_f32 v173, v173
    v_exp_f32 v174, v174
    v_exp_f32 v175, v175
    v_pk_add_f32 v[160:161], v[160:161], 1.0 op_sel_hi:[1,0]
    v_pk_add_f32 v[162:163], v[162:163], 1.0 op_sel_hi:[1,0]
    v_pk_add_f32 v[164:165], v[164:165], 1.0 op_sel_hi:[1,0]
    v_pk_add_f32 v[166:167], v[166:167], 1.0 op_sel_hi:[1,0]
    v_pk_add_f32 v[168:169], v[168:169], 1.0 op_sel_hi:[1,0]
    v_pk_add_f32 v[170:171], v[170:171], 1.0 op_sel_hi:[1,0]
    v_pk_add_f32 v[172:173], v[172:173], 1.0 op_sel_hi:[1,0]
    v_pk_add_f32 v[174:175], v[174:175], 1.0 op_sel_hi:[1,0]
    v_rcp_f32 v160, v160
    v_rcp_f32 v161, v161
    v_rcp_f32 v162, v162
    v_rcp_f32 v163, v163
    v_rcp_f32 v164, v164
    v_rcp_f32 v165, v165
    v_rcp_f32 v166, v166
    v_rcp_f32 v167, v167
    v_rcp_f32 v168, v168
    v_rcp_f32 v169, v169
    v_rcp_f32 v170, v170
    v_rcp_f32 v171, v171
    v_rcp_f32 v172, v172
    v_rcp_f32 v173, v173
    v_rcp_f32 v174, v174
    v_rcp_f32 v175, v175
    v_pk_mul_f32 v[48:49], v[48:49], v[160:161]
    v_pk_mul_f32 v[50:51], v[50:51], v[162:163]
    v_pk_mul_f32 v[52:53], v[52:53], v[164:165]
    v_pk_mul_f32 v[54:55], v[54:55], v[166:167]
    v_pk_mul_f32 v[56:57], v[56:57], v[168:169]
    v_pk_mul_f32 v[58:59], v[58:59], v[170:171]
    v_pk_mul_f32 v[60:61], v[60:61], v[172:173]
    v_pk_mul_f32 v[62:63], v[62:63], v[174:175]
    v_cvt_pk_bf16_f32 v104, v48, v49
    v_cvt_pk_bf16_f32 v105, v50, v51
    v_cvt_pk_bf16_f32 v106, v52, v53
    v_cvt_pk_bf16_f32 v107, v54, v55
    v_cvt_pk_bf16_f32 v108, v56, v57
    v_cvt_pk_bf16_f32 v109, v58, v59
    v_cvt_pk_bf16_f32 v110, v60, v61
    v_cvt_pk_bf16_f32 v111, v62, v63
    buffer_store_dwordx4 v[104:107], v242, s[44:47], s9 offen sc1
    buffer_store_dwordx4 v[108:111], v243, s[44:47], s9 offen sc1
    v_pk_mul_f32 v[160:161], v[64:65], v[64:65]
    v_pk_mul_f32 v[162:163], v[66:67], v[66:67]
    v_pk_mul_f32 v[164:165], v[68:69], v[68:69]
    v_pk_mul_f32 v[166:167], v[70:71], v[70:71]
    v_pk_mul_f32 v[168:169], v[72:73], v[72:73]
    v_pk_mul_f32 v[170:171], v[74:75], v[74:75]
    v_pk_mul_f32 v[172:173], v[76:77], v[76:77]
    v_pk_mul_f32 v[174:175], v[78:79], v[78:79]
    v_pk_fma_f32 v[160:161], v[160:161], s[10:11], v[88:89] op_sel_hi:[1,0,0]
    v_pk_fma_f32 v[162:163], v[162:163], s[10:11], v[88:89] op_sel_hi:[1,0,0]
    v_pk_fma_f32 v[164:165], v[164:165], s[10:11], v[88:89] op_sel_hi:[1,0,0]
    v_pk_fma_f32 v[166:167], v[166:167], s[10:11], v[88:89] op_sel_hi:[1,0,0]
    v_pk_fma_f32 v[168:169], v[168:169], s[10:11], v[88:89] op_sel_hi:[1,0,0]
    v_pk_fma_f32 v[170:171], v[170:171], s[10:11], v[88:89] op_sel_hi:[1,0,0]
    v_pk_fma_f32 v[172:173], v[172:173], s[10:11], v[88:89] op_sel_hi:[1,0,0]
    v_pk_fma_f32 v[174:175], v[174:175], s[10:11], v[88:89] op_sel_hi:[1,0,0]
    v_pk_mul_f32 v[160:161], v[160:161], v[64:65]
    v_pk_mul_f32 v[162:163], v[162:163], v[66:67]
    v_pk_mul_f32 v[164:165], v[164:165], v[68:69]
    v_pk_mul_f32 v[166:167], v[166:167], v[70:71]
    v_pk_mul_f32 v[168:169], v[168:169], v[72:73]
    v_pk_mul_f32 v[170:171], v[170:171], v[74:75]
    v_pk_mul_f32 v[172:173], v[172:173], v[76:77]
    v_pk_mul_f32 v[174:175], v[174:175], v[78:79]
    v_exp_f32 v160, v160
    v_exp_f32 v161, v161
    v_exp_f32 v162, v162
    v_exp_f32 v163, v163
    v_exp_f32 v164, v164
    v_exp_f32 v165, v165
    v_exp_f32 v166, v166
    v_exp_f32 v167, v167
    v_exp_f32 v168, v168
    v_exp_f32 v169, v169
    v_exp_f32 v170, v170
    v_exp_f32 v171, v171
    v_exp_f32 v172, v172
    v_exp_f32 v173, v173
    v_exp_f32 v174, v174
    v_exp_f32 v175, v175
    v_pk_add_f32 v[160:161], v[160:161], 1.0 op_sel_hi:[1,0]
    v_pk_add_f32 v[162:163], v[162:163], 1.0 op_sel_hi:[1,0]
    v_pk_add_f32 v[164:165], v[164:165], 1.0 op_sel_hi:[1,0]
    v_pk_add_f32 v[166:167], v[166:167], 1.0 op_sel_hi:[1,0]
    v_pk_add_f32 v[168:169], v[168:169], 1.0 op_sel_hi:[1,0]
    v_pk_add_f32 v[170:171], v[170:171], 1.0 op_sel_hi:[1,0]
    v_pk_add_f32 v[172:173], v[172:173], 1.0 op_sel_hi:[1,0]
    v_pk_add_f32 v[174:175], v[174:175], 1.0 op_sel_hi:[1,0]
    v_rcp_f32 v160, v160
    v_rcp_f32 v161, v161
    v_rcp_f32 v162, v162
    v_rcp_f32 v163, v163
    v_rcp_f32 v164, v164
    v_rcp_f32 v165, v165
    v_rcp_f32 v166, v166
    v_rcp_f32 v167, v167
    v_rcp_f32 v168, v168
    v_rcp_f32 v169, v169
    v_rcp_f32 v170, v170
    v_rcp_f32 v171, v171
    v_rcp_f32 v172, v172
    v_rcp_f32 v173, v173
    v_rcp_f32 v174, v174
    v_rcp_f32 v175, v175
    v_pk_mul_f32 v[64:65], v[64:65], v[160:161]
    v_pk_mul_f32 v[66:67], v[66:67], v[162:163]
    v_pk_mul_f32 v[68:69], v[68:69], v[164:165]
    v_pk_mul_f32 v[70:71], v[70:71], v[166:167]
    v_pk_mul_f32 v[72:73], v[72:73], v[168:169]
    v_pk_mul_f32 v[74:75], v[74:75], v[170:171]
    v_pk_mul_f32 v[76:77], v[76:77], v[172:173]
    v_pk_mul_f32 v[78:79], v[78:79], v[174:175]
    v_cvt_pk_bf16_f32 v112, v64, v65
    v_cvt_pk_bf16_f32 v113, v66, v67
    v_cvt_pk_bf16_f32 v114, v68, v69
    v_cvt_pk_bf16_f32 v115, v70, v71
    v_cvt_pk_bf16_f32 v116, v72, v73
    v_cvt_pk_bf16_f32 v117, v74, v75
    v_cvt_pk_bf16_f32 v118, v76, v77
    v_cvt_pk_bf16_f32 v119, v78, v79
    buffer_store_dwordx4 v[112:115], v244, s[44:47], s9 offen sc1
    buffer_store_dwordx4 v[116:119], v245, s[44:47], s9 offen sc1
    s_waitcnt vmcnt(6)
    s_barrier
    ds_read_b64_tr_b16 a[64:65], v10 offset:49152
    s_add_u32 m0, s73, 32768
    s_lshl_b32 s14, s94, 18
    ds_read_b64_tr_b16 a[66:67], v10 offset:51200
    ds_read_b64_tr_b16 a[72:73], v10 offset:53248
    ds_read_b64_tr_b16 a[74:75], v10 offset:55296
    ds_read_b64_tr_b16 a[68:69], v11 offset:49152
    buffer_load_dwordx4 v4, s[52:55], s14 offen offset:0 lds
    ds_read_b64_tr_b16 a[70:71], v11 offset:51200
    ds_read_b64_tr_b16 a[76:77], v11 offset:53248
    ds_read_b64_tr_b16 a[78:79], v11 offset:55296
    v_add_u32 v10, 65536, v10
    ds_read_b64_tr_b16 a[80:81], v10 offset:0
    ds_read_b64_tr_b16 a[82:83], v10 offset:2048
    buffer_load_dwordx4 v5, s[52:55], s14 offen offset:1024 lds
    ds_read_b64_tr_b16 a[88:89], v10 offset:4096
    ds_read_b64_tr_b16 a[90:91], v10 offset:6144
    v_add_u32 v11, 65536, v11
    ds_read_b64_tr_b16 a[84:85], v11 offset:0
    ds_read_b64_tr_b16 a[86:87], v11 offset:2048
    ds_read_b64_tr_b16 a[92:93], v11 offset:4096
    buffer_load_dwordx4 v6, s[52:55], s14 offen offset:2048 lds
    ds_read_b64_tr_b16 a[94:95], v11 offset:6144
    v_add_u32 v10, -65536, v10
    ds_read_b64_tr_b16 a[96:97], v10 offset:0
    ds_read_b64_tr_b16 a[98:99], v10 offset:2048
    ds_read_b64_tr_b16 a[104:105], v10 offset:4096
    ds_read_b64_tr_b16 a[106:107], v10 offset:6144
    buffer_load_dwordx4 v7, s[52:55], s14 offen offset:3072 lds
    v_add_u32 v11, -65536, v11
    ds_read_b64_tr_b16 a[100:101], v11 offset:0
    ds_read_b64_tr_b16 a[102:103], v11 offset:2048
    ds_read_b64_tr_b16 a[108:109], v11 offset:4096
    ds_read_b64_tr_b16 a[110:111], v11 offset:6144
    ds_read_b64_tr_b16 a[112:113], v10 offset:16384
    s_add_u32 m0, s73, 81920
    s_lshl_b32 s14, s95, 18
    ds_read_b64_tr_b16 a[114:115], v10 offset:18432
    ds_read_b64_tr_b16 a[120:121], v10 offset:20480
    ds_read_b64_tr_b16 a[122:123], v10 offset:22528
    ds_read_b64_tr_b16 a[116:117], v11 offset:16384
    buffer_load_dwordx4 v4, s[52:55], s14 offen offset:0 lds
    ds_read_b64_tr_b16 a[118:119], v11 offset:18432
    ds_read_b64_tr_b16 a[124:125], v11 offset:20480
    ds_read_b64_tr_b16 a[126:127], v11 offset:22528
    v_add_u32 v10, 131072, v10
    ds_read_b64_tr_b16 a[128:129], v10 offset:0
    ds_read_b64_tr_b16 a[130:131], v10 offset:2048
    buffer_load_dwordx4 v5, s[52:55], s14 offen offset:1024 lds
    ds_read_b64_tr_b16 a[136:137], v10 offset:4096
    ds_read_b64_tr_b16 a[138:139], v10 offset:6144
    v_add_u32 v11, 131072, v11
    ds_read_b64_tr_b16 a[132:133], v11 offset:0
    ds_read_b64_tr_b16 a[134:135], v11 offset:2048
    ds_read_b64_tr_b16 a[140:141], v11 offset:4096
    buffer_load_dwordx4 v6, s[52:55], s14 offen offset:2048 lds
    ds_read_b64_tr_b16 a[142:143], v11 offset:6144
    ds_read_b64_tr_b16 a[144:145], v10 offset:16384
    ds_read_b64_tr_b16 a[146:147], v10 offset:18432
    ds_read_b64_tr_b16 a[152:153], v10 offset:20480
    ds_read_b64_tr_b16 a[154:155], v10 offset:22528
    buffer_load_dwordx4 v7, s[52:55], s14 offen offset:3072 lds
    ds_read_b64_tr_b16 a[148:149], v11 offset:16384
    ds_read_b64_tr_b16 a[150:151], v11 offset:18432
    ds_read_b64_tr_b16 a[156:157], v11 offset:20480
    ds_read_b64_tr_b16 a[158:159], v11 offset:22528
    s_bitcmp1_b32 s3, 1
    s_cselect_b32 s18, s85, s84
    s_mul_i32 s18, s18, 139264
    s_cselect_b32 s19, s87, s86
    s_mul_i32 s19, s19, 139264
    s_cselect_b32 s20, s89, s88
    s_mul_i32 s20, s20, 139264
    s_cselect_b32 s21, s91, s90
    s_mul_i32 s21, s21, 139264
    s_cselect_b32 s22, s93, s92
    s_mul_i32 s22, s22, 139264
    s_cselect_b32 s23, s95, s94
    s_mul_i32 s23, s23, 139264
    s_cselect_b32 s24, s97, s96
    s_mul_i32 s24, s24, 139264
    s_cselect_b32 s25, s99, s98
    s_mul_i32 s25, s25, 139264
    s_cselect_b32 s26, s101, s100
    s_mul_i32 s26, s26, 139264
    s_waitcnt vmcnt(8) lgkmcnt(0)
    s_barrier
    buffer_store_dword v249, v17, s[44:47], 0 offen sc1
    s_add_u32 m0, s73, 0
    s_lshl_b32 s14, s96, 18
    buffer_load_dwordx4 v4, s[52:55], s14 offen offset:0 lds
    buffer_load_dwordx4 v5, s[52:55], s14 offen offset:1024 lds
    buffer_load_dwordx4 v6, s[52:55], s14 offen offset:2048 lds
    buffer_load_dwordx4 v7, s[52:55], s14 offen offset:3072 lds
    s_add_u32 m0, s73, 16384
    s_lshl_b32 s14, s97, 18
    buffer_load_dwordx4 v4, s[52:55], s14 offen offset:0 lds
    buffer_load_dwordx4 v5, s[52:55], s14 offen offset:1024 lds
    buffer_load_dwordx4 v6, s[52:55], s14 offen offset:2048 lds
    buffer_load_dwordx4 v7, s[52:55], s14 offen offset:3072 lds
    v_mov_b32 v16, 0
    buffer_atomic_add v16, v15, s[44:47], 0 offen sc0 sc1
    s_add_u32 m0, s73, 49152
    s_lshl_b32 s14, s98, 18
    buffer_load_dwordx4 v4, s[52:55], s14 offen offset:0 lds
    buffer_load_dwordx4 v5, s[52:55], s14 offen offset:1024 lds
    buffer_load_dwordx4 v6, s[52:55], s14 offen offset:2048 lds
    buffer_load_dwordx4 v7, s[52:55], s14 offen offset:3072 lds
    s_add_u32 m0, s73, 65536
    s_lshl_b32 s14, s99, 18
    buffer_load_dwordx4 v4, s[52:55], s14 offen offset:0 lds
    buffer_load_dwordx4 v5, s[52:55], s14 offen offset:1024 lds
    buffer_load_dwordx4 v6, s[52:55], s14 offen offset:2048 lds
    buffer_load_dwordx4 v7, s[52:55], s14 offen offset:3072 lds
L_DG:
    s_waitcnt vmcnt(8)
    v_cmp_ne_u32 vcc, v13, v16
    s_cbranch_vccnz L_rs_p2G
L_ok_p2G:
    s_barrier
    s_add_u32 m0, s73, 97536
    s_nop 0
    buffer_load_dwordx4 v23, s[44:47], s18 offen offset:768 sc1 lds
    s_add_u32 m0, s73, 99328
    s_nop 0
    buffer_load_dwordx4 v20, s[44:47], s18 offen offset:0 sc1 lds
    s_add_u32 m0, s73, 99840
    s_nop 0
    buffer_load_dwordx4 v20, s[44:47], s18 offen offset:512 sc1 lds
    s_add_u32 m0, s73, 100608
    s_nop 0
    buffer_load_dwordx4 v23, s[44:47], s19 offen offset:768 sc1 lds
    s_add_u32 m0, s73, 114688
    s_nop 0
    buffer_load_dwordx4 v20, s[44:47], s19 offen offset:0 sc1 lds
    s_add_u32 m0, s73, 115200
    s_nop 0
    buffer_load_dwordx4 v20, s[44:47], s19 offen offset:512 sc1 lds
    s_add_u32 m0, s73, 115968
    s_nop 0
    buffer_load_dwordx4 v23, s[44:47], s20 offen offset:768 sc1 lds
    s_add_u32 m0, s73, 117760
    s_nop 0
    buffer_load_dwordx4 v20, s[44:47], s20 offen offset:0 sc1 lds
    s_add_u32 m0, s73, 130560
    s_nop 0
    buffer_load_dwordx4 v20, s[44:47], s20 offen offset:512 sc1 lds
    s_add_u32 m0, s73, 131328
    s_nop 0
    buffer_load_dwordx4 v23, s[44:47], s21 offen offset:768 sc1 lds
    v_mov_b32 v195, s68
    v_mov_b32 v199, s68
    v_mov_b32 v202, s68
    v_mov_b32 v203, s68
    s_waitcnt vmcnt(6)
    s_barrier
    ds_read_b128 v[104:107], v14 offset:0
    ds_read_b128 v[108:111], v14 offset:4096
    ds_read_b128 v[112:115], v14 offset:8192
    ds_read_b128 v[116:119], v14 offset:12288
    s_waitcnt lgkmcnt(2)
    v_mfma_f32_16x16x32_bf16 v[32:35], v[104:107], a[0:3], 0
    s_add_u32 m0, s73, 133120
    v_mfma_f32_16x16x32_bf16 v[32:35], v[108:111], a[8:11], v[32:35]
    buffer_load_dwordx4 v20, s[44:47], s21 offen offset:0 sc1 lds
    s_waitcnt lgkmcnt(0)
    v_mfma_f32_16x16x32_bf16 v[32:35], v[112:115], a[16:19], v[32:35]
    ds_read_b128 v[120:123], v14 offset:1024
    v_mfma_f32_16x16x32_bf16 v[32:35], v[116:119], a[24:27], v[32:35]
    ds_read_b128 v[124:127], v14 offset:5120
    v_mfma_f32_16x16x32_bf16 v[36:39], v[116:119], a[28:31], 0
    ds_read_b128 v[128:131], v14 offset:9216
    v_mfma_f32_16x16x32_bf16 v[36:39], v[112:115], a[20:23], v[36:39]
    ds_read_b128 v[132:135], v14 offset:13312
    v_mfma_f32_16x16x32_bf16 v[36:39], v[108:111], a[12:15], v[36:39]
    s_add_u32 m0, s73, 133632
    v_mfma_f32_16x16x32_bf16 v[36:39], v[104:107], a[4:7], v[36:39]
    buffer_load_dwordx4 v20, s[44:47], s21 offen offset:512 sc1 lds
    s_waitcnt lgkmcnt(2)
    v_mfma_f32_16x16x32_bf16 v[44:47], v[120:123], a[4:7], 0
    s_add_u32 m0, s73, 146688
    v_mfma_f32_16x16x32_bf16 v[44:47], v[124:127], a[12:15], v[44:47]
    buffer_load_dwordx4 v23, s[44:47], s22 offen offset:768 sc1 lds
    s_waitcnt lgkmcnt(0)
    v_mfma_f32_16x16x32_bf16 v[44:47], v[128:131], a[20:23], v[44:47]
    ds_read_b128 v[104:107], v14 offset:2048
    v_mfma_f32_16x16x32_bf16 v[44:47], v[132:135], a[28:31], v[44:47]
    ds_read_b128 v[108:111], v14 offset:6144
    v_mfma_f32_16x16x32_bf16 v[40:43], v[132:135], a[24:27], 0
    ds_read_b128 v[112:115], v14 offset:10240
    v_mfma_f32_16x16x32_bf16 v[40:43], v[128:131], a[16:19], v[40:43]
    ds_read_b128 v[116:119], v14 offset:14336
    v_mfma_f32_16x16x32_bf16 v[40:43], v[124:127], a[8:11], v[40:43]
    s_add_u32 m0, s73, 148480
    v_mfma_f32_16x16x32_bf16 v[40:43], v[120:123], a[0:3], v[40:43]
    buffer_load_dwordx4 v20, s[44:47], s22 offen offset:0 sc1 lds
    s_waitcnt lgkmcnt(2)
    v_mfma_f32_16x16x32_bf16 v[48:51], v[104:107], a[0:3], 0
    s_add_u32 m0, s73, 148992
    v_mfma_f32_16x16x32_bf16 v[48:51], v[108:111], a[8:11], v[48:51]
    buffer_load_dwordx4 v20, s[44:47], s22 offen offset:512 sc1 lds
    s_waitcnt lgkmcnt(0)
    v_mfma_f32_16x16x32_bf16 v[48:51], v[112:115], a[16:19], v[48:51]
    ds_read_b128 v[120:123], v14 offset:3072
    v_mfma_f32_16x16x32_bf16 v[48:51], v[116:119], a[24:27], v[48:51]
    ds_read_b128 v[124:127], v14 offset:7168
    v_mfma_f32_16x16x32_bf16 v[52:55], v[116:119], a[28:31], 0
    ds_read_b128 v[128:131], v14 offset:11264
    v_mfma_f32_16x16x32_bf16 v[52:55], v[112:115], a[20:23], v[52:55]
    ds_read_b128 v[132:135], v14 offset:15360
    v_mfma_f32_16x16x32_bf16 v[52:55], v[108:111], a[12:15], v[52:55]
    s_add_u32 m0, s73, 149760
    v_mfma_f32_16x16x32_bf16 v[52:55], v[104:107], a[4:7], v[52:55]
    buffer_load_dwordx4 v23, s[44:47], s23 offen offset:768 sc1 lds
    s_waitcnt lgkmcnt(2)
    v_mfma_f32_16x16x32_bf16 v[36:39], v[120:123], a[36:39], v[36:39]
    v_mfma_f32_16x16x32_bf16 v[36:39], v[124:127], a[44:47], v[36:39]
    s_waitcnt lgkmcnt(0)
    v_mfma_f32_16x16x32_bf16 v[36:39], v[128:131], a[52:55], v[36:39]
    s_waitcnt vmcnt(8)
    s_barrier
    v_mfma_f32_16x16x32_bf16 v[36:39], v[132:135], a[60:63], v[36:39]
    ds_read_b128 v[104:107], v14 offset:16384
    v_add_u32 v10, -131072, v10
    v_mfma_f32_16x16x32_bf16 v[32:35], v[132:135], a[56:59], v[32:35]
    ds_read_b128 v[108:111], v14 offset:20480
    v_mfma_f32_16x16x32_bf16 v[32:35], v[128:131], a[48:51], v[32:35]
    ds_read_b128 v[112:115], v14 offset:24576
    ds_read_b64_tr_b16 a[160:161], v10 offset:32768
    v_mfma_f32_16x16x32_bf16 v[32:35], v[124:127], a[40:43], v[32:35]
    ds_read_b128 v[116:119], v14 offset:28672
    v_mfma_f32_16x16x32_bf16 v[32:35], v[120:123], a[32:35], v[32:35]
    ds_read_b64_tr_b16 a[162:163], v10 offset:34816
    s_waitcnt lgkmcnt(4)
    v_mfma_f32_16x16x32_bf16 v[40:43], v[104:107], a[32:35], v[40:43]
    s_add_u32 m0, s73, 98304
    ds_read_b64_tr_b16 a[168:169], v10 offset:36864
    v_mfma_f32_16x16x32_bf16 v[40:43], v[108:111], a[40:43], v[40:43]
    buffer_load_dwordx4 v20, s[44:47], s23 offen offset:0 sc1 lds
    ds_read_b64_tr_b16 a[170:171], v10 offset:38912
    s_waitcnt lgkmcnt(3)
    v_mfma_f32_16x16x32_bf16 v[40:43], v[112:115], a[48:51], v[40:43]
    ds_read_b128 v[120:123], v14 offset:17408
    v_mfma_f32_16x16x32_bf16 v[40:43], v[116:119], a[56:59], v[40:43]
    ds_read_b128 v[124:127], v14 offset:21504
    v_add_u32 v11, -131072, v11
    v_mfma_f32_16x16x32_bf16 v[44:47], v[116:119], a[60:63], v[44:47]
    ds_read_b128 v[128:131], v14 offset:25600
    v_mfma_f32_16x16x32_bf16 v[44:47], v[112:115], a[52:55], v[44:47]
    ds_read_b128 v[132:135], v14 offset:29696
    v_mfma_f32_16x16x32_bf16 v[44:47], v[108:111], a[44:47], v[44:47]
    s_add_u32 m0, s73, 98816
    ds_read_b64_tr_b16 a[164:165], v11 offset:32768
    v_mfma_f32_16x16x32_bf16 v[44:47], v[104:107], a[36:39], v[44:47]
    buffer_load_dwordx4 v20, s[44:47], s23 offen offset:512 sc1 lds
    ds_read_b64_tr_b16 a[166:167], v11 offset:34816
    s_waitcnt lgkmcnt(4)
    v_mfma_f32_16x16x32_bf16 v[52:55], v[120:123], a[36:39], v[52:55]
    s_add_u32 m0, s73, 99584
    ds_read_b64_tr_b16 a[172:173], v11 offset:36864
    v_mfma_f32_16x16x32_bf16 v[52:55], v[124:127], a[44:47], v[52:55]
    buffer_load_dwordx4 v23, s[44:47], s24 offen offset:768 sc1 lds
    ds_read_b64_tr_b16 a[174:175], v11 offset:38912
    s_waitcnt lgkmcnt(4)
    v_mfma_f32_16x16x32_bf16 v[52:55], v[128:131], a[52:55], v[52:55]
    ds_read_b128 v[104:107], v14 offset:18432
    v_mfma_f32_16x16x32_bf16 v[52:55], v[132:135], a[60:63], v[52:55]
    ds_read_b128 v[108:111], v14 offset:22528
    v_add_u32 v10, 65536, v10
    v_mfma_f32_16x16x32_bf16 v[48:51], v[132:135], a[56:59], v[48:51]
    ds_read_b128 v[112:115], v14 offset:26624
    v_mfma_f32_16x16x32_bf16 v[48:51], v[128:131], a[48:51], v[48:51]
    ds_read_b128 v[116:119], v14 offset:30720
    v_mfma_f32_16x16x32_bf16 v[48:51], v[124:127], a[40:43], v[48:51]
    s_add_u32 m0, s73, 101376
    ds_read_b64_tr_b16 a[176:177], v10 offset:16384
    v_mfma_f32_16x16x32_bf16 v[48:51], v[120:123], a[32:35], v[48:51]
    buffer_load_dwordx4 v20, s[44:47], s24 offen offset:0 sc1 lds
    ds_read_b64_tr_b16 a[178:179], v10 offset:18432
    s_waitcnt lgkmcnt(4)
    v_mfma_f32_16x16x32_bf16 v[32:35], v[104:107], a[64:67], v[32:35]
    ds_read_b64_tr_b16 a[184:185], v10 offset:20480
    v_mfma_f32_16x16x32_bf16 v[32:35], v[108:111], a[72:75], v[32:35]
    ds_read_b64_tr_b16 a[186:187], v10 offset:22528
    s_waitcnt lgkmcnt(4)
    v_mfma_f32_16x16x32_bf16 v[32:35], v[112:115], a[80:83], v[32:35]
    ds_read_b128 v[120:123], v14 offset:19456
    v_mfma_f32_16x16x32_bf16 v[32:35], v[116:119], a[88:91], v[32:35]
    ds_read_b128 v[124:127], v14 offset:23552
    v_add_u32 v11, 65536, v11
    v_mfma_f32_16x16x32_bf16 v[36:39], v[116:119], a[92:95], v[36:39]
    ds_read_b128 v[128:131], v14 offset:27648
    v_mfma_f32_16x16x32_bf16 v[36:39], v[112:115], a[84:87], v[36:39]
    ds_read_b128 v[132:135], v14 offset:31744
    v_mfma_f32_16x16x32_bf16 v[36:39], v[108:111], a[76:79], v[36:39]
    ds_read_b64_tr_b16 a[180:181], v11 offset:16384
    v_mfma_f32_16x16x32_bf16 v[36:39], v[104:107], a[68:71], v[36:39]
    ds_read_b64_tr_b16 a[182:183], v11 offset:18432
    s_waitcnt lgkmcnt(4)
    v_mfma_f32_16x16x32_bf16 v[44:47], v[120:123], a[68:71], v[44:47]
    ds_read_b64_tr_b16 a[188:189], v11 offset:20480
    v_mfma_f32_16x16x32_bf16 v[44:47], v[124:127], a[76:79], v[44:47]
    ds_read_b64_tr_b16 a[190:191], v11 offset:22528
    s_waitcnt lgkmcnt(4)
    v_mfma_f32_16x16x32_bf16 v[44:47], v[128:131], a[84:87], v[44:47]
    s_waitcnt vmcnt(8) lgkmcnt(0)
    s_barrier
    v_mfma_f32_16x16x32_bf16 v[44:47], v[132:135], a[92:95], v[44:47]
    ds_read_b128 v[104:107], v14 offset:32768
    s_lshl_b32 s14, s100, 18
    s_add_u32 m0, s73, 32768
    v_add_u32 v10, -65536, v10
    v_mfma_f32_16x16x32_bf16 v[40:43], v[132:135], a[88:91], v[40:43]
    ds_read_b128 v[108:111], v14 offset:36864
    buffer_load_dwordx4 v4, s[52:55], s14 offen offset:0 lds
    v_mfma_f32_16x16x32_bf16 v[40:43], v[128:131], a[80:83], v[40:43]
    ds_read_b128 v[112:115], v14 offset:40960
    ds_read_b64_tr_b16 a[192:193], v10 offset:0
    v_mfma_f32_16x16x32_bf16 v[40:43], v[124:127], a[72:75], v[40:43]
    ds_read_b128 v[116:119], v14 offset:45056
    v_mfma_f32_16x16x32_bf16 v[40:43], v[120:123], a[64:67], v[40:43]
    ds_read_b64_tr_b16 a[194:195], v10 offset:2048
    s_waitcnt lgkmcnt(4)
    v_mfma_f32_16x16x32_bf16 v[48:51], v[104:107], a[64:67], v[48:51]
    s_add_u32 m0, s73, 114176
    ds_read_b64_tr_b16 a[200:201], v10 offset:4096
    v_mfma_f32_16x16x32_bf16 v[48:51], v[108:111], a[72:75], v[48:51]
    buffer_load_dwordx4 v20, s[44:47], s24 offen offset:512 sc1 lds
    ds_read_b64_tr_b16 a[202:203], v10 offset:6144
    s_waitcnt lgkmcnt(3)
    v_mfma_f32_16x16x32_bf16 v[48:51], v[112:115], a[80:83], v[48:51]
    ds_read_b128 v[120:123], v14 offset:33792
    s_add_u32 m0, s73, 32768
    v_lshrrev_b32 v30, 2, v26
    v_mfma_f32_16x16x32_bf16 v[48:51], v[116:119], a[88:91], v[48:51]
    ds_read_b128 v[124:127], v14 offset:37888
    buffer_load_dwordx4 v5, s[52:55], s14 offen offset:1024 lds
    v_mfma_f32_16x16x32_bf16 v[52:55], v[116:119], a[92:95], v[52:55]
    ds_read_b128 v[128:131], v14 offset:41984
    v_add_u32 v11, -65536, v11
    v_mfma_f32_16x16x32_bf16 v[52:55], v[112:115], a[84:87], v[52:55]
    ds_read_b128 v[132:135], v14 offset:46080
    v_mfma_f32_16x16x32_bf16 v[52:55], v[108:111], a[76:79], v[52:55]
    s_add_u32 m0, s73, 114944
    ds_read_b64_tr_b16 a[196:197], v11 offset:0
    v_mfma_f32_16x16x32_bf16 v[52:55], v[104:107], a[68:71], v[52:55]
    buffer_load_dwordx4 v23, s[44:47], s25 offen offset:768 sc1 lds
    ds_read_b64_tr_b16 a[198:199], v11 offset:2048
    s_waitcnt lgkmcnt(4)
    v_mfma_f32_16x16x32_bf16 v[36:39], v[120:123], a[100:103], v[36:39]
    s_add_u32 m0, s73, 116736
    ds_read_b64_tr_b16 a[204:205], v11 offset:4096
    v_mfma_f32_16x16x32_bf16 v[36:39], v[124:127], a[108:111], v[36:39]
    buffer_load_dwordx4 v20, s[44:47], s25 offen offset:0 sc1 lds
    ds_read_b64_tr_b16 a[206:207], v11 offset:6144
    s_waitcnt lgkmcnt(4)
    v_mfma_f32_16x16x32_bf16 v[36:39], v[128:131], a[116:119], v[36:39]
    ds_read_b128 v[104:107], v14 offset:34816
    s_add_u32 m0, s73, 32768
    v_lshrrev_b32 v31, 2, v18
    v_mfma_f32_16x16x32_bf16 v[36:39], v[132:135], a[124:127], v[36:39]
    ds_read_b128 v[108:111], v14 offset:38912
    buffer_load_dwordx4 v6, s[52:55], s14 offen offset:2048 lds
    v_mfma_f32_16x16x32_bf16 v[32:35], v[132:135], a[120:123], v[32:35]
    ds_read_b128 v[112:115], v14 offset:43008
    v_mfma_f32_16x16x32_bf16 v[32:35], v[128:131], a[112:115], v[32:35]
    ds_read_b128 v[116:119], v14 offset:47104
    v_mfma_f32_16x16x32_bf16 v[32:35], v[124:127], a[104:107], v[32:35]
    s_add_u32 m0, s73, 117248
    ds_read_b64_tr_b16 a[208:209], v10 offset:16384
    v_mfma_f32_16x16x32_bf16 v[32:35], v[120:123], a[96:99], v[32:35]
    buffer_load_dwordx4 v20, s[44:47], s25 offen offset:512 sc1 lds
    ds_read_b64_tr_b16 a[210:211], v10 offset:18432
    s_waitcnt lgkmcnt(4)
    v_mfma_f32_16x16x32_bf16 v[40:43], v[104:107], a[96:99], v[40:43]
    ds_read_b64_tr_b16 a[216:217], v10 offset:20480
    buffer_load_ushort v102, v30, s[60:63], 0 offen offset:0
    s_add_u32 m0, s73, 32768
    v_mfma_f32_16x16x32_bf16 v[40:43], v[108:111], a[104:107], v[40:43]
    ds_read_b64_tr_b16 a[218:219], v10 offset:22528
    buffer_load_dwordx4 v7, s[52:55], s14 offen offset:3072 lds
    s_waitcnt lgkmcnt(4)
L_pl_G_6:
    s_cbranch_execz L_wret
    v_mfma_f32_16x16x32_bf16 v[40:43], v[112:115], a[112:115], v[40:43]
    ds_read_b128 v[120:123], v14 offset:35840
    v_mfma_f32_16x16x32_bf16 v[40:43], v[116:119], a[120:123], v[40:43]
    ds_read_b128 v[124:127], v14 offset:39936
    v_mfma_f32_16x16x32_bf16 v[44:47], v[116:119], a[124:127], v[44:47]
    ds_read_b128 v[128:131], v14 offset:44032
    v_mfma_f32_16x16x32_bf16 v[44:47], v[112:115], a[116:119], v[44:47]
    ds_read_b128 v[132:135], v14 offset:48128
    v_mfma_f32_16x16x32_bf16 v[44:47], v[108:111], a[108:111], v[44:47]
    ds_read_b64_tr_b16 a[212:213], v11 offset:16384
    buffer_load_ushort v103, v30, s[60:63], 0 offen offset:32
    v_mfma_f32_16x16x32_bf16 v[44:47], v[104:107], a[100:103], v[44:47]
    ds_read_b64_tr_b16 a[214:215], v11 offset:18432
    s_waitcnt lgkmcnt(4)
    v_mfma_f32_16x16x32_bf16 v[52:55], v[120:123], a[100:103], v[52:55]
    ds_read_b64_tr_b16 a[220:221], v11 offset:20480
    v_mfma_f32_16x16x32_bf16 v[52:55], v[124:127], a[108:111], v[52:55]
    ds_read_b64_tr_b16 a[222:223], v11 offset:22528
    s_waitcnt lgkmcnt(4)
    v_mfma_f32_16x16x32_bf16 v[52:55], v[128:131], a[116:119], v[52:55]
    s_waitcnt vmcnt(14) lgkmcnt(0)
    s_barrier
    v_mfma_f32_16x16x32_bf16 v[52:55], v[132:135], a[124:127], v[52:55]
    ds_read_b128 v[104:107], v14 offset:49152
    s_lshl_b32 s14, s101, 18
    ds_read_b64_tr_b16 a[224:225], v10 offset:49152
    s_add_u32 m0, s73, 81920
    v_mfma_f32_16x16x32_bf16 v[48:51], v[132:135], a[120:123], v[48:51]
    ds_read_b128 v[108:111], v14 offset:53248
    buffer_load_dwordx4 v4, s[52:55], s14 offen offset:0 lds
    v_mfma_f32_16x16x32_bf16 v[48:51], v[128:131], a[112:115], v[48:51]
    ds_read_b128 v[112:115], v14 offset:57344
    buffer_load_ushort v27, v31, s[60:63], 0 offen offset:0
    v_mfma_f32_16x16x32_bf16 v[48:51], v[124:127], a[104:107], v[48:51]
    ds_read_b128 v[116:119], v14 offset:61440
    v_mfma_f32_16x16x32_bf16 v[48:51], v[120:123], a[96:99], v[48:51]
    ds_read_b64_tr_b16 a[226:227], v10 offset:51200
    s_waitcnt lgkmcnt(3)
    v_mfma_f32_16x16x32_bf16 v[32:35], v[104:107], a[128:131], v[32:35]
    s_add_u32 m0, s73, 130304
    ds_read_b64_tr_b16 a[232:233], v10 offset:53248
    v_mfma_f32_16x16x32_bf16 v[32:35], v[108:111], a[136:139], v[32:35]
    buffer_load_dwordx4 v23, s[44:47], s26 offen offset:768 sc1 lds
    ds_read_b64_tr_b16 a[234:235], v10 offset:55296
    s_waitcnt lgkmcnt(3)
    v_mfma_f32_16x16x32_bf16 v[32:35], v[112:115], a[144:147], v[32:35]
    ds_read_b128 v[120:123], v14 offset:50176
    s_add_u32 m0, s73, 81920
    v_mfma_f32_16x16x32_bf16 v[32:35], v[116:119], a[152:155], v[32:35]
    ds_read_b128 v[124:127], v14 offset:54272
    buffer_load_dwordx4 v5, s[52:55], s14 offen offset:1024 lds
    v_mfma_f32_16x16x32_bf16 v[36:39], v[116:119], a[156:159], v[36:39]
    ds_read_b128 v[128:131], v14 offset:58368
    v_mfma_f32_16x16x32_bf16 v[36:39], v[112:115], a[148:151], v[36:39]
    ds_read_b128 v[132:135], v14 offset:62464
    v_mfma_f32_16x16x32_bf16 v[36:39], v[108:111], a[140:143], v[36:39]
    s_add_u32 m0, s73, 132096
    ds_read_b64_tr_b16 a[228:229], v11 offset:49152
    v_mfma_f32_16x16x32_bf16 v[36:39], v[104:107], a[132:135], v[36:39]
    buffer_load_dwordx4 v20, s[44:47], s26 offen offset:0 sc1 lds
    ds_read_b64_tr_b16 a[230:231], v11 offset:51200
    s_waitcnt lgkmcnt(4)
    v_mfma_f32_16x16x32_bf16 v[44:47], v[120:123], a[132:135], v[44:47]
    s_add_u32 m0, s73, 132608
    ds_read_b64_tr_b16 a[236:237], v11 offset:53248
    v_mfma_f32_16x16x32_bf16 v[44:47], v[124:127], a[140:143], v[44:47]
    buffer_load_dwordx4 v20, s[44:47], s26 offen offset:512 sc1 lds
    ds_read_b64_tr_b16 a[238:239], v11 offset:55296
    s_waitcnt lgkmcnt(4)
    v_mfma_f32_16x16x32_bf16 v[44:47], v[128:131], a[148:151], v[44:47]
    ds_read_b128 v[104:107], v14 offset:51200
    s_add_u32 m0, s73, 81920
    v_add_u32 v10, 65536, v10
    v_mfma_f32_16x16x32_bf16 v[44:47], v[132:135], a[156:159], v[44:47]
    ds_read_b128 v[108:111], v14 offset:55296
    buffer_load_dwordx4 v6, s[52:55], s14 offen offset:2048 lds
    v_mfma_f32_16x16x32_bf16 v[40:43], v[132:135], a[152:155], v[40:43]
    ds_read_b128 v[112:115], v14 offset:59392
    v_mfma_f32_16x16x32_bf16 v[40:43], v[128:131], a[144:147], v[40:43]
    ds_read_b128 v[116:119], v14 offset:63488
    v_mfma_f32_16x16x32_bf16 v[40:43], v[124:127], a[136:139], v[40:43]
    s_add_u32 m0, s73, 134144
    ds_read_b64_tr_b16 a[240:241], v10 offset:0
    v_mfma_f32_16x16x32_bf16 v[40:43], v[120:123], a[128:131], v[40:43]
    buffer_load_dwordx4 v21, s[44:47], s18 offen offset:0 sc1 lds
    ds_read_b64_tr_b16 a[242:243], v10 offset:2048
    s_waitcnt lgkmcnt(4)
    v_mfma_f32_16x16x32_bf16 v[48:51], v[104:107], a[128:131], v[48:51]
    ds_read_b64_tr_b16 a[248:249], v10 offset:4096
    s_add_u32 m0, s73, 81920
    v_mfma_f32_16x16x32_bf16 v[48:51], v[108:111], a[136:139], v[48:51]
    ds_read_b64_tr_b16 a[250:251], v10 offset:6144
    buffer_load_dwordx4 v7, s[52:55], s14 offen offset:3072 lds
    s_waitcnt lgkmcnt(4)
    v_mfma_f32_16x16x32_bf16 v[48:51], v[112:115], a[144:147], v[48:51]
    ds_read_b128 v[120:123], v14 offset:52224
    v_add_u32 v11, 65536, v11
    v_mfma_f32_16x16x32_bf16 v[48:51], v[116:119], a[152:155], v[48:51]
    ds_read_b128 v[124:127], v14 offset:56320
    v_mfma_f32_16x16x32_bf16 v[52:55], v[116:119], a[156:159], v[52:55]
    ds_read_b128 v[128:131], v14 offset:60416
    v_mfma_f32_16x16x32_bf16 v[52:55], v[112:115], a[148:151], v[52:55]
    ds_read_b128 v[132:135], v14 offset:64512
    v_mfma_f32_16x16x32_bf16 v[52:55], v[108:111], a[140:143], v[52:55]
    ds_read_b64_tr_b16 a[244:245], v11 offset:0
    v_mfma_f32_16x16x32_bf16 v[52:55], v[104:107], a[132:135], v[52:55]
    ds_read_b64_tr_b16 a[246:247], v11 offset:2048
    s_waitcnt lgkmcnt(4)
    v_mfma_f32_16x16x32_bf16 v[36:39], v[120:123], a[164:167], v[36:39]
    ds_read_b64_tr_b16 a[252:253], v11 offset:4096
    v_mfma_f32_16x16x32_bf16 v[36:39], v[124:127], a[172:175], v[36:39]
    ds_read_b64_tr_b16 a[254:255], v11 offset:6144
    s_waitcnt lgkmcnt(4)
    v_mfma_f32_16x16x32_bf16 v[36:39], v[128:131], a[180:183], v[36:39]
    s_waitcnt vmcnt(10) lgkmcnt(0)
    s_barrier
    v_mfma_f32_16x16x32_bf16 v[36:39], v[132:135], a[188:191], v[36:39]
    ds_read_b128 v[104:107], v14 offset:0
    v_mfma_f32_16x16x32_bf16 v[32:35], v[132:135], a[184:187], v[32:35]
    ds_read_b128 v[108:111], v14 offset:4096
    v_add_u32 v10, -65536, v10
    v_mfma_f32_16x16x32_bf16 v[32:35], v[128:131], a[176:179], v[32:35]
    ds_read_b128 v[112:115], v14 offset:8192
    v_mfma_f32_16x16x32_bf16 v[32:35], v[124:127], a[168:171], v[32:35]
    ds_read_b128 v[116:119], v14 offset:12288
    v_mfma_f32_16x16x32_bf16 v[32:35], v[120:123], a[160:163], v[32:35]
    ds_read_b64_tr_b16 v[220:221], v10 offset:32768
    s_waitcnt lgkmcnt(3)
    v_mfma_f32_16x16x32_bf16 v[40:43], v[104:107], a[160:163], v[40:43]
    s_add_u32 m0, s73, 146944
    v_mfma_f32_16x16x32_bf16 v[40:43], v[108:111], a[168:171], v[40:43]
    buffer_load_dwordx4 v21, s[44:47], s18 offen offset:512 sc1 lds
    ds_read_b64_tr_b16 v[222:223], v10 offset:34816
    s_waitcnt lgkmcnt(2)
    v_mfma_f32_16x16x32_bf16 v[40:43], v[112:115], a[176:179], v[40:43]
    ds_read_b128 v[120:123], v14 offset:1024
    v_mfma_f32_16x16x32_bf16 v[40:43], v[116:119], a[184:187], v[40:43]
    ds_read_b128 v[124:127], v14 offset:5120
    v_mfma_f32_16x16x32_bf16 v[44:47], v[116:119], a[188:191], v[44:47]
    ds_read_b128 v[128:131], v14 offset:9216
    v_mfma_f32_16x16x32_bf16 v[44:47], v[112:115], a[180:183], v[44:47]
    ds_read_b128 v[132:135], v14 offset:13312
    buffer_load_dwordx4 v[88:91], v252, s[56:59], 0 offen
    v_mfma_f32_16x16x32_bf16 v[44:47], v[108:111], a[172:175], v[44:47]
    s_add_u32 m0, s73, 148480
    ds_read_b64_tr_b16 v[228:229], v10 offset:36864
    v_mfma_f32_16x16x32_bf16 v[44:47], v[104:107], a[164:167], v[44:47]
    buffer_load_dwordx4 v21, s[44:47], s19 offen offset:0 sc1 lds
    s_waitcnt lgkmcnt(3)
    v_mfma_f32_16x16x32_bf16 v[52:55], v[120:123], a[164:167], v[52:55]
    s_add_u32 m0, s73, 148992
    ds_read_b64_tr_b16 v[230:231], v10 offset:38912
    v_mfma_f32_16x16x32_bf16 v[52:55], v[124:127], a[172:175], v[52:55]
    buffer_load_dwordx4 v21, s[44:47], s19 offen offset:512 sc1 lds
    s_waitcnt lgkmcnt(2)
    v_mfma_f32_16x16x32_bf16 v[52:55], v[128:131], a[180:183], v[52:55]
    ds_read_b128 v[104:107], v14 offset:2048
    v_mfma_f32_16x16x32_bf16 v[52:55], v[132:135], a[188:191], v[52:55]
    ds_read_b128 v[108:111], v14 offset:6144
    v_mfma_f32_16x16x32_bf16 v[48:51], v[132:135], a[184:187], v[48:51]
    ds_read_b128 v[112:115], v14 offset:10240
    v_add_u32 v11, -65536, v11
    v_mfma_f32_16x16x32_bf16 v[48:51], v[128:131], a[176:179], v[48:51]
    ds_read_b128 v[116:119], v14 offset:14336
    v_mfma_f32_16x16x32_bf16 v[48:51], v[124:127], a[168:171], v[48:51]
    s_add_u32 m0, s73, 150528
    v_mfma_f32_16x16x32_bf16 v[48:51], v[120:123], a[160:163], v[48:51]
    buffer_load_dwordx4 v21, s[44:47], s20 offen offset:0 sc1 lds
    ds_read_b64_tr_b16 v[224:225], v11 offset:32768
    s_waitcnt lgkmcnt(3)
    v_mfma_f32_16x16x32_bf16 v[32:35], v[104:107], a[192:195], v[32:35]
    buffer_load_dwordx4 v[92:95], v252, s[56:59], s40 offen
    v_mfma_f32_16x16x32_bf16 v[32:35], v[108:111], a[200:203], v[32:35]
    ds_read_b64_tr_b16 v[226:227], v11 offset:34816
    s_waitcnt vmcnt(13)
    s_waitcnt lgkmcnt(2)
    v_mfma_f32_16x16x32_bf16 v[32:35], v[112:115], a[208:211], v[32:35]
    ds_read_b128 v[120:123], v14 offset:3072
    v_mfma_f32_16x16x32_bf16 v[32:35], v[116:119], a[216:219], v[32:35]
    ds_read_b128 v[124:127], v14 offset:7168
    v_lshlrev_b32 v72, 16, v102
    v_mfma_f32_16x16x32_bf16 v[36:39], v[116:119], a[220:223], v[36:39]
    ds_read_b128 v[128:131], v14 offset:11264
    v_mfma_f32_16x16x32_bf16 v[36:39], v[112:115], a[212:215], v[36:39]
    ds_read_b128 v[132:135], v14 offset:15360
    v_mfma_f32_16x16x32_bf16 v[36:39], v[108:111], a[204:207], v[36:39]
    ds_read_b64_tr_b16 v[232:233], v11 offset:36864
    v_lshlrev_b32 v73, 16, v102
    v_mfma_f32_16x16x32_bf16 v[36:39], v[104:107], a[196:199], v[36:39]
    s_waitcnt lgkmcnt(3)
    v_mfma_f32_16x16x32_bf16 v[44:47], v[120:123], a[196:199], v[44:47]
    ds_read_b64_tr_b16 v[234:235], v11 offset:38912
    v_mfma_f32_16x16x32_bf16 v[44:47], v[124:127], a[204:207], v[44:47]
    v_lshlrev_b32 v74, 16, v102
    s_waitcnt lgkmcnt(2)
    v_mfma_f32_16x16x32_bf16 v[44:47], v[128:131], a[212:215], v[44:47]
    buffer_load_dwordx2 v[142:143], v253, s[56:59], 0 offen
    s_waitcnt vmcnt(7) lgkmcnt(0)
    s_barrier
    v_mfma_f32_16x16x32_bf16 v[44:47], v[132:135], a[220:223], v[44:47]
    ds_read_b128 v[104:107], v14 offset:16384
    v_lshlrev_b32 v75, 16, v102
    v_mfma_f32_16x16x32_bf16 v[40:43], v[132:135], a[216:219], v[40:43]
    ds_read_b128 v[108:111], v14 offset:20480
    v_add_u32 v10, 65536, v10
    v_mfma_f32_16x16x32_bf16 v[40:43], v[128:131], a[208:211], v[40:43]
    ds_read_b128 v[112:115], v14 offset:24576
    v_mfma_f32_16x16x32_bf16 v[40:43], v[124:127], a[200:203], v[40:43]
    ds_read_b128 v[116:119], v14 offset:28672
    v_lshlrev_b32 v76, 16, v103
    v_mfma_f32_16x16x32_bf16 v[40:43], v[120:123], a[192:195], v[40:43]
    ds_read_b64_tr_b16 v[236:237], v10 offset:16384
    s_waitcnt lgkmcnt(3)
    v_mfma_f32_16x16x32_bf16 v[48:51], v[104:107], a[192:195], v[48:51]
    s_add_u32 m0, s73, 97792
    v_lshlrev_b32 v77, 16, v103
    v_mfma_f32_16x16x32_bf16 v[48:51], v[108:111], a[200:203], v[48:51]
    buffer_load_dwordx4 v21, s[44:47], s20 offen offset:512 sc1 lds
    ds_read_b64_tr_b16 v[238:239], v10 offset:18432
    s_waitcnt lgkmcnt(2)
    v_mfma_f32_16x16x32_bf16 v[48:51], v[112:115], a[208:211], v[48:51]
    ds_read_b128 v[120:123], v14 offset:17408
    v_mfma_f32_16x16x32_bf16 v[48:51], v[116:119], a[216:219], v[48:51]
    ds_read_b128 v[124:127], v14 offset:21504
    v_mfma_f32_16x16x32_bf16 v[52:55], v[116:119], a[220:223], v[52:55]
    ds_read_b128 v[128:131], v14 offset:25600
    v_lshlrev_b32 v78, 16, v103
    v_mfma_f32_16x16x32_bf16 v[52:55], v[112:115], a[212:215], v[52:55]
    ds_read_b128 v[132:135], v14 offset:29696
    buffer_load_dwordx2 v[96:97], v26, s[44:47], s42 offen offset:0 sc1
    v_mfma_f32_16x16x32_bf16 v[52:55], v[108:111], a[204:207], v[52:55]
    ds_read_b64_tr_b16 v[244:245], v10 offset:20480
    s_add_u32 m0, s73, 99328
    v_lshlrev_b32 v79, 16, v103
    v_mfma_f32_16x16x32_bf16 v[52:55], v[104:107], a[196:199], v[52:55]
    buffer_load_dwordx4 v21, s[44:47], s21 offen offset:0 sc1 lds
    s_waitcnt lgkmcnt(3)
    v_mfma_f32_16x16x32_bf16 v[36:39], v[120:123], a[228:231], v[36:39]
    ds_read_b64_tr_b16 v[246:247], v10 offset:22528
    s_add_u32 m0, s73, 99840
    v_lshlrev_b32 v80, 16, v102
    v_mfma_f32_16x16x32_bf16 v[36:39], v[124:127], a[236:239], v[36:39]
    buffer_load_dwordx4 v21, s[44:47], s21 offen offset:512 sc1 lds
    s_waitcnt lgkmcnt(2)
    v_mfma_f32_16x16x32_bf16 v[36:39], v[128:131], a[244:247], v[36:39]
    ds_read_b128 v[104:107], v14 offset:18432
    v_mfma_f32_16x16x32_bf16 v[36:39], v[132:135], a[252:255], v[36:39]
    ds_read_b128 v[108:111], v14 offset:22528
    v_lshlrev_b32 v81, 16, v102
    v_mfma_f32_16x16x32_bf16 v[32:35], v[132:135], a[248:251], v[32:35]
    ds_read_b128 v[112:115], v14 offset:26624
    v_add_u32 v11, 65536, v11
    v_mfma_f32_16x16x32_bf16 v[32:35], v[128:131], a[240:243], v[32:35]
    ds_read_b128 v[116:119], v14 offset:30720
    v_mfma_f32_16x16x32_bf16 v[32:35], v[124:127], a[232:235], v[32:35]
    s_add_u32 m0, s73, 101376
    v_lshlrev_b32 v82, 16, v102
    v_mfma_f32_16x16x32_bf16 v[32:35], v[120:123], a[224:227], v[32:35]
    buffer_load_dwordx4 v21, s[44:47], s22 offen offset:0 sc1 lds
    ds_read_b64_tr_b16 v[240:241], v11 offset:16384
    s_waitcnt lgkmcnt(3)
    v_mfma_f32_16x16x32_bf16 v[40:43], v[104:107], a[224:227], v[40:43]
    buffer_load_dwordx2 v[98:99], v26, s[44:47], s42 offen offset:128 sc1
    v_lshlrev_b32 v83, 16, v102
    v_mfma_f32_16x16x32_bf16 v[40:43], v[108:111], a[232:235], v[40:43]
    ds_read_b64_tr_b16 v[242:243], v11 offset:18432
    s_waitcnt lgkmcnt(2)
    v_mfma_f32_16x16x32_bf16 v[40:43], v[112:115], a[240:243], v[40:43]
    ds_read_b128 v[120:123], v14 offset:19456
    v_mfma_f32_16x16x32_bf16 v[40:43], v[116:119], a[248:251], v[40:43]
    ds_read_b128 v[124:127], v14 offset:23552
    v_mfma_f32_16x16x32_bf16 v[44:47], v[116:119], a[252:255], v[44:47]
    ds_read_b128 v[128:131], v14 offset:27648
    v_lshlrev_b32 v84, 16, v103
    v_mfma_f32_16x16x32_bf16 v[44:47], v[112:115], a[244:247], v[44:47]
    ds_read_b128 v[132:135], v14 offset:31744
    v_mfma_f32_16x16x32_bf16 v[44:47], v[108:111], a[236:239], v[44:47]
    ds_read_b64_tr_b16 v[248:249], v11 offset:20480
    v_lshlrev_b32 v85, 16, v103
    v_mfma_f32_16x16x32_bf16 v[44:47], v[104:107], a[228:231], v[44:47]
    s_waitcnt lgkmcnt(3)
    v_mfma_f32_16x16x32_bf16 v[52:55], v[120:123], a[228:231], v[52:55]
    ds_read_b64_tr_b16 v[250:251], v11 offset:22528
    v_mfma_f32_16x16x32_bf16 v[52:55], v[124:127], a[236:239], v[52:55]
    v_lshlrev_b32 v86, 16, v103
    s_waitcnt lgkmcnt(2)
    v_mfma_f32_16x16x32_bf16 v[52:55], v[128:131], a[244:247], v[52:55]
    buffer_load_dwordx2 v[100:101], v18, s[44:47], s42 offen offset:0 sc1
    s_waitcnt lgkmcnt(0)
    s_barrier
    v_mfma_f32_16x16x32_bf16 v[52:55], v[132:135], a[252:255], v[52:55]
    ds_read_b128 v[104:107], v14 offset:32768
    v_mfma_f32_16x16x32_bf16 v[48:51], v[132:135], a[248:251], v[48:51]
    ds_read_b128 v[108:111], v14 offset:36864
    v_lshlrev_b32 v87, 16, v103
    v_mfma_f32_16x16x32_bf16 v[48:51], v[128:131], a[240:243], v[48:51]
    ds_read_b128 v[112:115], v14 offset:40960
    v_mfma_f32_16x16x32_bf16 v[48:51], v[124:127], a[232:235], v[48:51]
    ds_read_b128 v[116:119], v14 offset:45056
    v_lshlrev_b32 v27, 16, v27
    v_mfma_f32_16x16x32_bf16 v[48:51], v[120:123], a[224:227], v[48:51]
L_Dc:
L_pl_D_0:
    s_cbranch_execz L_wret
    s_waitcnt lgkmcnt(2)
    v_mfma_f32_16x16x32_bf16 v[32:35], v[104:107], v[220:223], v[32:35]
    s_add_u32 m0, s73, 114176
    v_mfma_f32_16x16x32_bf16 v[32:35], v[108:111], v[228:231], v[32:35]
    buffer_load_dwordx4 v21, s[44:47], s22 offen offset:512 sc1 lds
    s_waitcnt lgkmcnt(0)
    v_mfma_f32_16x16x32_bf16 v[32:35], v[112:115], v[236:239], v[32:35]
    ds_read_b128 v[120:123], v14 offset:33792
    v_mfma_f32_16x16x32_bf16 v[32:35], v[116:119], v[244:247], v[32:35]
    ds_read_b128 v[124:127], v14 offset:37888
    v_mfma_f32_16x16x32_bf16 v[36:39], v[116:119], v[248:251], v[36:39]
    ds_read_b128 v[128:131], v14 offset:41984
    buffer_load_dword v189, v188, s[44:47], 0 offen sc1
    v_mfma_f32_16x16x32_bf16 v[36:39], v[112:115], v[240:243], v[36:39]
    ds_read_b128 v[132:135], v14 offset:46080
    v_mfma_f32_16x16x32_bf16 v[36:39], v[108:111], v[232:235], v[36:39]
    s_add_u32 m0, s73, 115712
    v_mfma_f32_16x16x32_bf16 v[36:39], v[104:107], v[224:227], v[36:39]
    buffer_load_dwordx4 v21, s[44:47], s23 offen offset:0 sc1 lds
    s_waitcnt lgkmcnt(2)
    v_mfma_f32_16x16x32_bf16 v[44:47], v[120:123], v[224:227], v[44:47]
    s_add_u32 m0, s73, 116224
    v_mfma_f32_16x16x32_bf16 v[44:47], v[124:127], v[232:235], v[44:47]
    buffer_load_dwordx4 v21, s[44:47], s23 offen offset:512 sc1 lds
    s_waitcnt lgkmcnt(0)
    v_mfma_f32_16x16x32_bf16 v[44:47], v[128:131], v[240:243], v[44:47]
    ds_read_b128 v[104:107], v14 offset:34816
    v_mfma_f32_16x16x32_bf16 v[44:47], v[132:135], v[248:251], v[44:47]
    ds_read_b128 v[108:111], v14 offset:38912
    v_mfma_f32_16x16x32_bf16 v[40:43], v[132:135], v[244:247], v[40:43]
    ds_read_b128 v[112:115], v14 offset:43008
    v_mfma_f32_16x16x32_bf16 v[40:43], v[128:131], v[236:239], v[40:43]
    ds_read_b128 v[116:119], v14 offset:47104
    v_mfma_f32_16x16x32_bf16 v[40:43], v[124:127], v[228:231], v[40:43]
    s_add_u32 m0, s73, 117760
    v_mfma_f32_16x16x32_bf16 v[40:43], v[120:123], v[220:223], v[40:43]
    buffer_load_dwordx4 v21, s[44:47], s24 offen offset:0 sc1 lds
    s_waitcnt lgkmcnt(2)
    v_mfma_f32_16x16x32_bf16 v[48:51], v[104:107], v[220:223], v[48:51]
    v_mfma_f32_16x16x32_bf16 v[48:51], v[108:111], v[228:231], v[48:51]
    s_waitcnt lgkmcnt(0)
    v_mfma_f32_16x16x32_bf16 v[48:51], v[112:115], v[236:239], v[48:51]
    ds_read_b128 v[120:123], v14 offset:35840
    v_mfma_f32_16x16x32_bf16 v[48:51], v[116:119], v[244:247], v[48:51]
    ds_read_b128 v[124:127], v14 offset:39936
    v_mfma_f32_16x16x32_bf16 v[52:55], v[116:119], v[248:251], v[52:55]
    ds_read_b128 v[128:131], v14 offset:44032
    v_mfma_f32_16x16x32_bf16 v[52:55], v[112:115], v[240:243], v[52:55]
    ds_read_b128 v[132:135], v14 offset:48128
    v_mfma_f32_16x16x32_bf16 v[52:55], v[108:111], v[232:235], v[52:55]
    v_mfma_f32_16x16x32_bf16 v[52:55], v[104:107], v[224:227], v[52:55]
    s_waitcnt lgkmcnt(2)
    v_mfma_f32_16x16x32_bf16 v[60:63], v[120:123], a[4:7], 0
    v_mfma_f32_16x16x32_bf16 v[60:63], v[124:127], a[12:15], v[60:63]
    s_waitcnt lgkmcnt(0)
    v_mfma_f32_16x16x32_bf16 v[60:63], v[128:131], a[20:23], v[60:63]
    s_waitcnt vmcnt(14)
    s_barrier
    v_mfma_f32_16x16x32_bf16 v[60:63], v[132:135], a[28:31], v[60:63]
    ds_read_b128 v[104:107], v14 offset:49152
    v_mfma_f32_16x16x32_bf16 v[56:59], v[132:135], a[24:27], 0
    ds_read_b128 v[108:111], v14 offset:53248
    v_mfma_f32_16x16x32_bf16 v[56:59], v[128:131], a[16:19], v[56:59]
    ds_read_b128 v[112:115], v14 offset:57344
    v_cvt_pk_bf16_f32 v192, v32, v33
    v_mfma_f32_16x16x32_bf16 v[56:59], v[124:127], a[8:11], v[56:59]
    ds_read_b128 v[116:119], v14 offset:61440
    v_mfma_f32_16x16x32_bf16 v[56:59], v[120:123], a[0:3], v[56:59]
    s_waitcnt lgkmcnt(2)
    v_mfma_f32_16x16x32_bf16 v[64:67], v[104:107], a[0:3], 0
    s_add_u32 m0, s73, 130560
    v_mfma_f32_16x16x32_bf16 v[64:67], v[108:111], a[8:11], v[64:67]
    buffer_load_dwordx4 v21, s[44:47], s24 offen offset:512 sc1 lds
    s_waitcnt lgkmcnt(0)
    v_mfma_f32_16x16x32_bf16 v[64:67], v[112:115], a[16:19], v[64:67]
    ds_read_b128 v[120:123], v14 offset:50176
    v_cvt_pk_bf16_f32 v193, v34, v35
    v_mfma_f32_16x16x32_bf16 v[64:67], v[116:119], a[24:27], v[64:67]
    ds_read_b128 v[124:127], v14 offset:54272
    v_mfma_f32_16x16x32_bf16 v[68:71], v[116:119], a[28:31], 0
    ds_read_b128 v[128:131], v14 offset:58368
    v_mfma_f32_16x16x32_bf16 v[68:71], v[112:115], a[20:23], v[68:71]
    buffer_store_dwordx4 v[192:195], v136, s[44:47], s32 offen sc1
    ds_read_b128 v[132:135], v14 offset:62464
    v_mfma_f32_16x16x32_bf16 v[68:71], v[108:111], a[12:15], v[68:71]
    s_add_u32 m0, s73, 132096
    v_mfma_f32_16x16x32_bf16 v[68:71], v[104:107], a[4:7], v[68:71]
    buffer_load_dwordx4 v21, s[44:47], s25 offen offset:0 sc1 lds
    s_waitcnt lgkmcnt(2)
    v_mfma_f32_16x16x32_bf16 v[60:63], v[120:123], a[36:39], v[60:63]
    s_add_u32 m0, s73, 132608
    v_mfma_f32_16x16x32_bf16 v[60:63], v[124:127], a[44:47], v[60:63]
    buffer_load_dwordx4 v21, s[44:47], s25 offen offset:512 sc1 lds
    s_waitcnt lgkmcnt(0)
    v_mfma_f32_16x16x32_bf16 v[60:63], v[128:131], a[52:55], v[60:63]
    ds_read_b128 v[104:107], v14 offset:51200
    v_mfma_f32_16x16x32_bf16 v[60:63], v[132:135], a[60:63], v[60:63]
    ds_read_b128 v[108:111], v14 offset:55296
    v_mfma_f32_16x16x32_bf16 v[56:59], v[132:135], a[56:59], v[56:59]
    ds_read_b128 v[112:115], v14 offset:59392
    v_mfma_f32_16x16x32_bf16 v[56:59], v[128:131], a[48:51], v[56:59]
    ds_read_b128 v[116:119], v14 offset:63488
    v_mfma_f32_16x16x32_bf16 v[56:59], v[124:127], a[40:43], v[56:59]
    s_add_u32 m0, s73, 134144
    v_cvt_pk_bf16_f32 v196, v36, v37
    v_mfma_f32_16x16x32_bf16 v[56:59], v[120:123], a[32:35], v[56:59]
    buffer_load_dwordx4 v21, s[44:47], s26 offen offset:0 sc1 lds
    s_waitcnt lgkmcnt(2)
    v_mfma_f32_16x16x32_bf16 v[64:67], v[104:107], a[32:35], v[64:67]
    v_mfma_f32_16x16x32_bf16 v[64:67], v[108:111], a[40:43], v[64:67]
    s_waitcnt lgkmcnt(0)
    v_mfma_f32_16x16x32_bf16 v[64:67], v[112:115], a[48:51], v[64:67]
    ds_read_b128 v[120:123], v14 offset:52224
    v_cvt_pk_bf16_f32 v197, v38, v39
    v_mfma_f32_16x16x32_bf16 v[64:67], v[116:119], a[56:59], v[64:67]
    ds_read_b128 v[124:127], v14 offset:56320
    v_mfma_f32_16x16x32_bf16 v[68:71], v[116:119], a[60:63], v[68:71]
    ds_read_b128 v[128:131], v14 offset:60416
    v_mfma_f32_16x16x32_bf16 v[68:71], v[112:115], a[52:55], v[68:71]
    ds_read_b128 v[132:135], v14 offset:64512
    v_mfma_f32_16x16x32_bf16 v[68:71], v[108:111], a[44:47], v[68:71]
    buffer_store_dwordx4 v[196:199], v136, s[44:47], s33 offen sc1
    v_mfma_f32_16x16x32_bf16 v[68:71], v[104:107], a[36:39], v[68:71]
    s_waitcnt lgkmcnt(2)
    v_mfma_f32_16x16x32_bf16 v[60:63], v[120:123], a[68:71], v[60:63]
    v_mfma_f32_16x16x32_bf16 v[60:63], v[124:127], a[76:79], v[60:63]
    s_waitcnt lgkmcnt(0)
    v_mfma_f32_16x16x32_bf16 v[60:63], v[128:131], a[84:87], v[60:63]
    s_waitcnt vmcnt(13)
    s_barrier
    v_mfma_f32_16x16x32_bf16 v[60:63], v[132:135], a[92:95], v[60:63]
    ds_read_b128 v[104:107], v14 offset:0
    v_mfma_f32_16x16x32_bf16 v[56:59], v[132:135], a[88:91], v[56:59]
    ds_read_b128 v[108:111], v14 offset:4096
    v_mfma_f32_16x16x32_bf16 v[56:59], v[128:131], a[80:83], v[56:59]
    ds_read_b128 v[112:115], v14 offset:8192
    v_cvt_pk_bf16_f32 v192, v40, v41
    v_mfma_f32_16x16x32_bf16 v[56:59], v[124:127], a[72:75], v[56:59]
    ds_read_b128 v[116:119], v14 offset:12288
    v_mfma_f32_16x16x32_bf16 v[56:59], v[120:123], a[64:67], v[56:59]
    s_waitcnt lgkmcnt(2)
    v_mfma_f32_16x16x32_bf16 v[64:67], v[104:107], a[64:67], v[64:67]
    s_add_u32 m0, s73, 146944
    v_cvt_pk_bf16_f32 v193, v42, v43
    s_waitcnt vmcnt(11)
    v_mfma_f32_16x16x32_bf16 v[64:67], v[108:111], a[72:75], v[64:67]
    buffer_load_dwordx4 v21, s[44:47], s26 offen offset:512 sc1 lds
    s_waitcnt lgkmcnt(0)
    v_mfma_f32_16x16x32_bf16 v[64:67], v[112:115], a[80:83], v[64:67]
    ds_read_b128 v[120:123], v14 offset:1024
    v_mul_f32 v96, v96, v97
    v_mfma_f32_16x16x32_bf16 v[64:67], v[116:119], a[88:91], v[64:67]
    ds_read_b128 v[124:127], v14 offset:5120
    v_cvt_pk_bf16_f32 v194, v44, v45
    v_mfma_f32_16x16x32_bf16 v[68:71], v[116:119], a[92:95], v[68:71]
    ds_read_b128 v[128:131], v14 offset:9216
    v_mul_f32 v98, v98, v99
    v_mfma_f32_16x16x32_bf16 v[68:71], v[112:115], a[84:87], v[68:71]
    ds_read_b128 v[132:135], v14 offset:13312
    v_mul_f32 v100, v100, v101
    v_mfma_f32_16x16x32_bf16 v[68:71], v[108:111], a[76:79], v[68:71]
    buffer_store_dwordx4 v[192:195], v136, s[44:47], s30 offen offset:0 sc1
    s_add_u32 m0, s73, 148480
    v_permlane16_swap_b32 v88, v90
    v_mfma_f32_16x16x32_bf16 v[68:71], v[104:107], a[68:71], v[68:71]
    buffer_load_dwordx4 v22, s[44:47], s18 offen offset:0 sc1 lds
    s_waitcnt lgkmcnt(2)
    v_mfma_f32_16x16x32_bf16 v[60:63], v[120:123], a[100:103], v[60:63]
    s_add_u32 m0, s73, 148992
    v_permlane16_swap_b32 v89, v91
    v_permlane16_swap_b32 v92, v94
    v_mfma_f32_16x16x32_bf16 v[60:63], v[124:127], a[108:111], v[60:63]
    buffer_load_dwordx4 v22, s[44:47], s18 offen offset:512 sc1 lds
    s_waitcnt vmcnt(13)
    s_waitcnt lgkmcnt(0)
    v_mfma_f32_16x16x32_bf16 v[60:63], v[128:131], a[116:119], v[60:63]
    ds_read_b128 v[104:107], v14 offset:2048
    v_permlane16_swap_b32 v93, v95
    v_mfma_f32_16x16x32_bf16 v[60:63], v[132:135], a[124:127], v[60:63]
    ds_read_b128 v[108:111], v14 offset:6144
    v_cmp_ne_u32 vcc, s68, v189
    v_mfma_f32_16x16x32_bf16 v[56:59], v[132:135], a[120:123], v[56:59]
    ds_read_b128 v[112:115], v14 offset:10240
    v_and_b32 v145, 0xffff0000, v88
    v_mfma_f32_16x16x32_bf16 v[56:59], v[128:131], a[112:115], v[56:59]
    ds_read_b128 v[116:119], v14 offset:14336
    v_cvt_pk_bf16_f32 v196, v46, v47
    v_mfma_f32_16x16x32_bf16 v[56:59], v[124:127], a[104:107], v[56:59]
    s_add_u32 m0, s73, 150528
    s_cbranch_vccnz L_rs_p3
L_ok_p3:
    v_lshlrev_b32 v144, 16, v88
    v_mfma_f32_16x16x32_bf16 v[56:59], v[120:123], a[96:99], v[56:59]
    buffer_load_dwordx4 v22, s[44:47], s19 offen offset:0 sc1 lds
    s_waitcnt lgkmcnt(2)
    v_mfma_f32_16x16x32_bf16 v[64:67], v[104:107], a[96:99], v[64:67]
    s_add_u32 m0, s73, 81920
    v_cvt_pk_bf16_f32 v197, v48, v49
    v_and_b32 v147, 0xffff0000, v89
    v_mfma_f32_16x16x32_bf16 v[64:67], v[108:111], a[104:107], v[64:67]
    buffer_load_dwordx4 v184, s[44:47], s37 offen offset:0 sc1 lds
    s_waitcnt lgkmcnt(0)
    v_mfma_f32_16x16x32_bf16 v[64:67], v[112:115], a[112:115], v[64:67]
    ds_read_b128 v[120:123], v14 offset:3072
    buffer_load_dwordx4 v185, s[44:47], s37 offen offset:1024 sc1 lds
    v_mfma_f32_16x16x32_bf16 v[64:67], v[116:119], a[120:123], v[64:67]
    ds_read_b128 v[124:127], v14 offset:7168
    s_add_u32 m0, s73, 83968
    v_cvt_pk_bf16_f32 v198, v50, v51
    v_mfma_f32_16x16x32_bf16 v[68:71], v[116:119], a[124:127], v[68:71]
    ds_read_b128 v[128:131], v14 offset:11264
    buffer_load_dwordx4 v184, s[44:47], s16 offen offset:0 sc1 lds
    v_mfma_f32_16x16x32_bf16 v[68:71], v[112:115], a[116:119], v[68:71]
    ds_read_b128 v[132:135], v14 offset:15360
    buffer_load_dwordx4 v185, s[44:47], s16 offen offset:1024 sc1 lds
    v_mfma_f32_16x16x32_bf16 v[68:71], v[108:111], a[108:111], v[68:71]
    buffer_store_dwordx4 v[196:199], v136, s[44:47], s30 offen offset:1024 sc1
    v_lshlrev_b32 v146, 16, v89
    v_and_b32 v149, 0xffff0000, v92
    v_lshlrev_b32 v148, 16, v92
    v_mfma_f32_16x16x32_bf16 v[68:71], v[104:107], a[100:103], v[68:71]
    s_waitcnt lgkmcnt(2)
    v_mfma_f32_16x16x32_bf16 v[60:63], v[120:123], a[132:135], v[60:63]
    v_and_b32 v151, 0xffff0000, v93
    v_mfma_f32_16x16x32_bf16 v[60:63], v[124:127], a[140:143], v[60:63]
    v_lshlrev_b32 v150, 16, v93
    s_waitcnt lgkmcnt(0)
    v_mfma_f32_16x16x32_bf16 v[60:63], v[128:131], a[148:151], v[60:63]
    s_waitcnt vmcnt(16)
    s_barrier
    v_mfma_f32_16x16x32_bf16 v[60:63], v[132:135], a[156:159], v[60:63]
    ds_read_b128 v[104:107], v14 offset:16384
    v_and_b32 v153, 0xffff0000, v90
    v_mfma_f32_16x16x32_bf16 v[56:59], v[132:135], a[152:155], v[56:59]
    ds_read_b128 v[108:111], v14 offset:20480
    v_lshlrev_b32 v152, 16, v90
    v_mfma_f32_16x16x32_bf16 v[56:59], v[128:131], a[144:147], v[56:59]
    ds_read_b128 v[112:115], v14 offset:24576
    v_cvt_pk_bf16_f32 v200, v52, v53
    v_mfma_f32_16x16x32_bf16 v[56:59], v[124:127], a[136:139], v[56:59]
    ds_read_b128 v[116:119], v14 offset:28672
    v_and_b32 v155, 0xffff0000, v91
    v_mfma_f32_16x16x32_bf16 v[56:59], v[120:123], a[128:131], v[56:59]
    s_waitcnt lgkmcnt(2)
    v_mfma_f32_16x16x32_bf16 v[64:67], v[104:107], a[128:131], v[64:67]
    s_add_u32 m0, s73, 97792
    v_lshlrev_b32 v154, 16, v91
    v_mfma_f32_16x16x32_bf16 v[64:67], v[108:111], a[136:139], v[64:67]
    buffer_load_dwordx4 v22, s[44:47], s19 offen offset:512 sc1 lds
    s_waitcnt lgkmcnt(0)
    v_mfma_f32_16x16x32_bf16 v[64:67], v[112:115], a[144:147], v[64:67]
    ds_read_b128 v[120:123], v14 offset:17408
    v_cvt_pk_bf16_f32 v201, v54, v55
    v_mfma_f32_16x16x32_bf16 v[64:67], v[116:119], a[152:155], v[64:67]
    ds_read_b128 v[124:127], v14 offset:21504
    v_and_b32 v157, 0xffff0000, v94
    v_mfma_f32_16x16x32_bf16 v[68:71], v[116:119], a[156:159], v[68:71]
    ds_read_b128 v[128:131], v14 offset:25600
    v_lshlrev_b32 v156, 16, v94
    v_mfma_f32_16x16x32_bf16 v[68:71], v[112:115], a[148:151], v[68:71]
    buffer_store_dwordx4 v[200:203], v136, s[44:47], s30 offen offset:2048 sc1
    ds_read_b128 v[132:135], v14 offset:29696
    v_and_b32 v159, 0xffff0000, v95
L_pl_D_1:
    s_cbranch_execz L_wret
    v_mfma_f32_16x16x32_bf16 v[68:71], v[108:111], a[140:143], v[68:71]
    s_add_u32 m0, s73, 99328
    v_lshlrev_b32 v158, 16, v95
    v_mfma_f32_16x16x32_bf16 v[68:71], v[104:107], a[132:135], v[68:71]
    buffer_load_dwordx4 v22, s[44:47], s20 offen offset:0 sc1 lds
    s_waitcnt lgkmcnt(2)
    v_mfma_f32_16x16x32_bf16 v[60:63], v[120:123], a[164:167], v[60:63]
    s_add_u32 m0, s73, 99840
    v_and_b32 v161, 0xffff0000, v142
    v_mfma_f32_16x16x32_bf16 v[60:63], v[124:127], a[172:175], v[60:63]
    buffer_load_dwordx4 v22, s[44:47], s20 offen offset:512 sc1 lds
    s_waitcnt lgkmcnt(0)
    v_mfma_f32_16x16x32_bf16 v[60:63], v[128:131], a[180:183], v[60:63]
    ds_read_b128 v[104:107], v14 offset:18432
    v_lshlrev_b32 v160, 16, v142
    v_mfma_f32_16x16x32_bf16 v[60:63], v[132:135], a[188:191], v[60:63]
    ds_read_b128 v[108:111], v14 offset:22528
    v_mfma_f32_16x16x32_bf16 v[56:59], v[132:135], a[184:187], v[56:59]
    ds_read_b128 v[112:115], v14 offset:26624
    v_and_b32 v163, 0xffff0000, v143
    v_mfma_f32_16x16x32_bf16 v[56:59], v[128:131], a[176:179], v[56:59]
    ds_read_b128 v[116:119], v14 offset:30720
    v_lshlrev_b32 v162, 16, v143
    v_mfma_f32_16x16x32_bf16 v[56:59], v[124:127], a[168:171], v[56:59]
    s_add_u32 m0, s73, 101376
    v_mfma_f32_16x16x32_bf16 v[56:59], v[120:123], a[160:163], v[56:59]
    buffer_load_dwordx4 v22, s[44:47], s21 offen offset:0 sc1 lds
    s_waitcnt lgkmcnt(2)
    v_mfma_f32_16x16x32_bf16 v[64:67], v[104:107], a[160:163], v[64:67]
    v_fma_f32 v164, v144, v97, -v96
    v_mfma_f32_16x16x32_bf16 v[64:67], v[108:111], a[168:171], v[64:67]
    v_fma_f32 v165, v145, v97, -v96
    s_waitcnt lgkmcnt(0)
    v_mfma_f32_16x16x32_bf16 v[64:67], v[112:115], a[176:179], v[64:67]
    ds_read_b128 v[120:123], v14 offset:19456
    v_fma_f32 v166, v146, v97, -v96
    v_mfma_f32_16x16x32_bf16 v[64:67], v[116:119], a[184:187], v[64:67]
    ds_read_b128 v[124:127], v14 offset:23552
    v_mfma_f32_16x16x32_bf16 v[68:71], v[116:119], a[188:191], v[68:71]
    ds_read_b128 v[128:131], v14 offset:27648
    v_fma_f32 v167, v147, v97, -v96
    v_mfma_f32_16x16x32_bf16 v[68:71], v[112:115], a[180:183], v[68:71]
    ds_read_b128 v[132:135], v14 offset:31744
    v_mfma_f32_16x16x32_bf16 v[68:71], v[108:111], a[172:175], v[68:71]
    v_fma_f32 v168, v148, v99, -v98
    v_mfma_f32_16x16x32_bf16 v[68:71], v[104:107], a[164:167], v[68:71]
    v_fma_f32 v169, v149, v99, -v98
    s_waitcnt lgkmcnt(2)
    v_mfma_f32_16x16x32_bf16 v[60:63], v[120:123], a[196:199], v[60:63]
    v_mfma_f32_16x16x32_bf16 v[60:63], v[124:127], a[204:207], v[60:63]
    v_fma_f32 v170, v150, v99, -v98
    s_waitcnt lgkmcnt(0)
    v_mfma_f32_16x16x32_bf16 v[60:63], v[128:131], a[212:215], v[60:63]
    s_waitcnt vmcnt(16)
    s_barrier
    v_mfma_f32_16x16x32_bf16 v[60:63], v[132:135], a[220:223], v[60:63]
    ds_read_b128 v[104:107], v14 offset:32768
    v_fma_f32 v171, v151, v99, -v98
    v_mfma_f32_16x16x32_bf16 v[56:59], v[132:135], a[216:219], v[56:59]
    ds_read_b128 v[108:111], v14 offset:36864
    v_fma_f32 v172, v152, v97, -v96
    v_mfma_f32_16x16x32_bf16 v[56:59], v[128:131], a[208:211], v[56:59]
    ds_read_b128 v[112:115], v14 offset:40960
    v_mfma_f32_16x16x32_bf16 v[56:59], v[124:127], a[200:203], v[56:59]
    ds_read_b128 v[116:119], v14 offset:45056
    v_fma_f32 v173, v153, v97, -v96
    v_mfma_f32_16x16x32_bf16 v[56:59], v[120:123], a[192:195], v[56:59]
    s_waitcnt lgkmcnt(2)
    v_mfma_f32_16x16x32_bf16 v[64:67], v[104:107], a[192:195], v[64:67]
    s_add_u32 m0, s73, 114176
    v_fma_f32 v174, v154, v97, -v96
    v_mfma_f32_16x16x32_bf16 v[64:67], v[108:111], a[200:203], v[64:67]
    buffer_load_dwordx4 v22, s[44:47], s21 offen offset:512 sc1 lds
    s_waitcnt lgkmcnt(0)
    v_mfma_f32_16x16x32_bf16 v[64:67], v[112:115], a[208:211], v[64:67]
    ds_read_b128 v[120:123], v14 offset:33792
    v_fma_f32 v175, v155, v97, -v96
    v_mfma_f32_16x16x32_bf16 v[64:67], v[116:119], a[216:219], v[64:67]
    ds_read_b128 v[124:127], v14 offset:37888
    v_fma_f32 v176, v156, v99, -v98
    v_mfma_f32_16x16x32_bf16 v[68:71], v[116:119], a[220:223], v[68:71]
    ds_read_b128 v[128:131], v14 offset:41984
    v_mfma_f32_16x16x32_bf16 v[68:71], v[112:115], a[212:215], v[68:71]
    ds_read_b128 v[132:135], v14 offset:46080
    v_fma_f32 v177, v157, v99, -v98
    v_mfma_f32_16x16x32_bf16 v[68:71], v[108:111], a[204:207], v[68:71]
    s_add_u32 m0, s73, 115712
    v_fma_f32 v178, v158, v99, -v98
    v_mfma_f32_16x16x32_bf16 v[68:71], v[104:107], a[196:199], v[68:71]
    buffer_load_dwordx4 v22, s[44:47], s22 offen offset:0 sc1 lds
    s_waitcnt lgkmcnt(2)
    v_mfma_f32_16x16x32_bf16 v[60:63], v[120:123], a[228:231], v[60:63]
    s_add_u32 m0, s73, 116224
    v_fma_f32 v179, v159, v99, -v98
    v_mfma_f32_16x16x32_bf16 v[60:63], v[124:127], a[236:239], v[60:63]
    buffer_load_dwordx4 v22, s[44:47], s22 offen offset:512 sc1 lds
    s_waitcnt lgkmcnt(0)
    v_mfma_f32_16x16x32_bf16 v[60:63], v[128:131], a[244:247], v[60:63]
    ds_read_b128 v[104:107], v14 offset:34816
    v_fma_f32 v180, v160, v101, -v100
    v_mfma_f32_16x16x32_bf16 v[60:63], v[132:135], a[252:255], v[60:63]
    ds_read_b128 v[108:111], v14 offset:38912
    v_fma_f32 v181, v161, v101, -v100
    v_mfma_f32_16x16x32_bf16 v[56:59], v[132:135], a[248:251], v[56:59]
    ds_read_b128 v[112:115], v14 offset:43008
    v_mfma_f32_16x16x32_bf16 v[56:59], v[128:131], a[240:243], v[56:59]
    ds_read_b128 v[116:119], v14 offset:47104
    v_fma_f32 v182, v162, v101, -v100
    v_mfma_f32_16x16x32_bf16 v[56:59], v[124:127], a[232:235], v[56:59]
    s_add_u32 m0, s73, 117760
    v_fma_f32 v183, v163, v101, -v100
    v_mfma_f32_16x16x32_bf16 v[56:59], v[120:123], a[224:227], v[56:59]
    buffer_load_dwordx4 v22, s[44:47], s23 offen offset:0 sc1 lds
    s_waitcnt lgkmcnt(2)
    v_mfma_f32_16x16x32_bf16 v[64:67], v[104:107], a[224:227], v[64:67]
    v_mfma_f32_16x16x32_bf16 v[64:67], v[108:111], a[232:235], v[64:67]
    s_waitcnt lgkmcnt(0)
    v_mfma_f32_16x16x32_bf16 v[64:67], v[112:115], a[240:243], v[64:67]
    ds_read_b128 v[120:123], v14 offset:35840
    v_mfma_f32_16x16x32_bf16 v[64:67], v[116:119], a[248:251], v[64:67]
    ds_read_b128 v[124:127], v14 offset:39936
    v_mfma_f32_16x16x32_bf16 v[68:71], v[116:119], a[252:255], v[68:71]
    ds_read_b128 v[128:131], v14 offset:44032
    v_mfma_f32_16x16x32_bf16 v[68:71], v[112:115], a[244:247], v[68:71]
    ds_read_b128 v[132:135], v14 offset:48128
    v_mfma_f32_16x16x32_bf16 v[68:71], v[108:111], a[236:239], v[68:71]
    v_mfma_f32_16x16x32_bf16 v[68:71], v[104:107], a[228:231], v[68:71]
    s_waitcnt lgkmcnt(2)
    v_mfma_f32_16x16x32_bf16 v[60:63], v[120:123], v[224:227], v[60:63]
    v_mfma_f32_16x16x32_bf16 v[60:63], v[124:127], v[232:235], v[60:63]
    s_waitcnt lgkmcnt(0)
    v_mfma_f32_16x16x32_bf16 v[60:63], v[128:131], v[240:243], v[60:63]
    s_waitcnt vmcnt(10)
    s_barrier
    v_mfma_f32_16x16x32_bf16 v[60:63], v[132:135], v[248:251], v[60:63]
    ds_read_b128 v[104:107], v14 offset:49152
    v_mfma_f32_16x16x32_bf16 v[56:59], v[132:135], v[244:247], v[56:59]
    ds_read_b128 v[108:111], v14 offset:53248
    v_mfma_f32_16x16x32_bf16 v[56:59], v[128:131], v[236:239], v[56:59]
    ds_read_b128 v[112:115], v14 offset:57344
    v_mfma_f32_16x16x32_bf16 v[56:59], v[124:127], v[228:231], v[56:59]
    ds_read_b128 v[116:119], v14 offset:61440
    v_mfma_f32_16x16x32_bf16 v[56:59], v[120:123], v[220:223], v[56:59]
    s_waitcnt lgkmcnt(2)
    v_mfma_f32_16x16x32_bf16 v[64:67], v[104:107], v[220:223], v[64:67]
    s_add_u32 m0, s73, 130560
    v_xor_b32 v186, s41, v10
    v_add_u32 v186, s43, v186
    v_mfma_f32_16x16x32_bf16 v[64:67], v[108:111], v[228:231], v[64:67]
    buffer_load_dwordx4 v22, s[44:47], s23 offen offset:512 sc1 lds
    ds_read_b64_tr_b16 v[12:13], v10 offset:16384
    s_waitcnt lgkmcnt(1)
    v_mfma_f32_16x16x32_bf16 v[64:67], v[112:115], v[236:239], v[64:67]
    ds_read_b128 v[120:123], v14 offset:50176
    v_mfma_f32_16x16x32_bf16 v[64:67], v[116:119], v[244:247], v[64:67]
    ds_read_b128 v[124:127], v14 offset:54272
    v_mfma_f32_16x16x32_bf16 v[68:71], v[116:119], v[248:251], v[68:71]
    ds_read_b128 v[128:131], v14 offset:58368
    ds_read_b64_tr_b16 v[24:25], v11 offset:16384
    v_mfma_f32_16x16x32_bf16 v[68:71], v[112:115], v[240:243], v[68:71]
    ds_read_b128 v[132:135], v14 offset:62464
    ds_read_b64_tr_b16 v[28:29], v10 offset:20480
    v_mfma_f32_16x16x32_bf16 v[68:71], v[108:111], v[232:235], v[68:71]
    s_add_u32 m0, s73, 132096
    ds_read_b64_tr_b16 v[190:191], v11 offset:20480
    v_mfma_f32_16x16x32_bf16 v[68:71], v[104:107], v[224:227], v[68:71]
    buffer_load_dwordx4 v22, s[44:47], s24 offen offset:0 sc1 lds
    ds_read_b64_tr_b16 v[142:143], v186 offset:18432
    s_waitcnt lgkmcnt(6)
    v_mfma_f32_16x16x32_bf16 v[76:79], v[120:123], a[4:7], v[76:79]
    s_add_u32 m0, s73, 132608
    s_waitcnt lgkmcnt(0)
    v_mfma_f32_16x16x32_bf16 v[76:79], v[124:127], a[12:15], v[76:79]
    buffer_load_dwordx4 v22, s[44:47], s24 offen offset:512 sc1 lds
    v_mfma_f32_16x16x32_bf16 v[76:79], v[128:131], a[20:23], v[76:79]
    ds_read_b128 v[104:107], v14 offset:51200
    v_and_b32 v9, 0xffff0000, v12
    v_mfma_f32_16x16x32_bf16 v[76:79], v[132:135], a[28:31], v[76:79]
    ds_read_b128 v[108:111], v14 offset:55296
    v_mfma_f32_16x16x32_bf16 v[72:75], v[132:135], a[24:27], v[72:75]
    ds_read_b128 v[112:115], v14 offset:59392
    v_lshlrev_b32 v8, 16, v12
    v_mfma_f32_16x16x32_bf16 v[72:75], v[128:131], a[16:19], v[72:75]
    ds_read_b128 v[116:119], v14 offset:63488
    v_cvt_pk_bf16_f32 v192, v56, v57
    v_mfma_f32_16x16x32_bf16 v[72:75], v[124:127], a[8:11], v[72:75]
    s_add_u32 m0, s73, 134144
    v_mul_f32 v165, v165, v9
    v_mfma_f32_16x16x32_bf16 v[72:75], v[120:123], a[0:3], v[72:75]
    buffer_load_dwordx4 v22, s[44:47], s25 offen offset:0 sc1 lds
    s_waitcnt lgkmcnt(2)
    v_mfma_f32_16x16x32_bf16 v[80:83], v[104:107], a[0:3], v[80:83]
    v_cvt_pk_bf16_f32 v193, v58, v59
    v_mul_f32 v164, v164, v8
    v_mfma_f32_16x16x32_bf16 v[80:83], v[108:111], a[8:11], v[80:83]
    v_and_b32 v31, 0xffff0000, v13
    s_waitcnt lgkmcnt(0)
    v_mfma_f32_16x16x32_bf16 v[80:83], v[112:115], a[16:19], v[80:83]
    ds_read_b128 v[120:123], v14 offset:52224
    v_lshlrev_b32 v30, 16, v13
    v_mfma_f32_16x16x32_bf16 v[80:83], v[116:119], a[24:27], v[80:83]
    ds_read_b128 v[124:127], v14 offset:56320
    v_cvt_pk_bf16_f32 v194, v60, v61
    v_mfma_f32_16x16x32_bf16 v[84:87], v[116:119], a[28:31], v[84:87]
    ds_read_b128 v[128:131], v14 offset:60416
    v_mfma_f32_16x16x32_bf16 v[84:87], v[112:115], a[20:23], v[84:87]
    ds_read_b128 v[132:135], v14 offset:64512
    v_mul_f32 v167, v167, v31
    v_mfma_f32_16x16x32_bf16 v[84:87], v[108:111], a[12:15], v[84:87]
    buffer_store_dwordx4 v[192:195], v136, s[44:47], s15 offen offset:0 sc1
    v_mul_f32 v166, v166, v30
    v_mfma_f32_16x16x32_bf16 v[84:87], v[104:107], a[4:7], v[84:87]
    s_waitcnt lgkmcnt(2)
    v_mfma_f32_16x16x32_bf16 v[76:79], v[120:123], a[36:39], v[76:79]
    v_and_b32 v9, 0xffff0000, v24
    v_mfma_f32_16x16x32_bf16 v[76:79], v[124:127], a[44:47], v[76:79]
    v_cvt_pk_bf16_f32 v196, v62, v63
    s_waitcnt lgkmcnt(0)
    v_mfma_f32_16x16x32_bf16 v[76:79], v[128:131], a[52:55], v[76:79]
    s_waitcnt vmcnt(9)
    s_barrier
    v_lshlrev_b32 v8, 16, v24
    v_mfma_f32_16x16x32_bf16 v[76:79], v[132:135], a[60:63], v[76:79]
    ds_read_b128 v[104:107], v14 offset:0
    v_mul_f32 v169, v169, v9
    v_mfma_f32_16x16x32_bf16 v[72:75], v[132:135], a[56:59], v[72:75]
    ds_read_b128 v[108:111], v14 offset:4096
    v_cvt_pk_bf16_f32 v197, v64, v65
    v_mfma_f32_16x16x32_bf16 v[72:75], v[128:131], a[48:51], v[72:75]
    ds_read_b128 v[112:115], v14 offset:8192
    v_mul_f32 v168, v168, v8
    v_mfma_f32_16x16x32_bf16 v[72:75], v[124:127], a[40:43], v[72:75]
    ds_read_b128 v[116:119], v14 offset:12288
    v_mfma_f32_16x16x32_bf16 v[72:75], v[120:123], a[32:35], v[72:75]
    v_cvt_pk_bf16_f32 v198, v66, v67
    s_waitcnt lgkmcnt(2)
    v_mfma_f32_16x16x32_bf16 v[80:83], v[104:107], a[32:35], v[80:83]
    s_add_u32 m0, s73, 146944
    v_and_b32 v31, 0xffff0000, v25
    v_lshlrev_b32 v30, 16, v25
    v_mfma_f32_16x16x32_bf16 v[80:83], v[108:111], a[40:43], v[80:83]
    buffer_load_dwordx4 v22, s[44:47], s25 offen offset:512 sc1 lds
    s_waitcnt lgkmcnt(0)
    v_mfma_f32_16x16x32_bf16 v[80:83], v[112:115], a[48:51], v[80:83]
    buffer_store_dwordx4 v[196:199], v136, s[44:47], s15 offen offset:1024 sc1
    ds_read_b128 v[120:123], v14 offset:1024
    v_mfma_f32_16x16x32_bf16 v[80:83], v[116:119], a[56:59], v[80:83]
    ds_read_b128 v[124:127], v14 offset:5120
    v_mul_f32 v171, v171, v31
    v_mfma_f32_16x16x32_bf16 v[84:87], v[116:119], a[60:63], v[84:87]
    ds_read_b128 v[128:131], v14 offset:9216
    v_mul_f32 v170, v170, v30
    v_mfma_f32_16x16x32_bf16 v[84:87], v[112:115], a[52:55], v[84:87]
    ds_read_b128 v[132:135], v14 offset:13312
    v_mfma_f32_16x16x32_bf16 v[84:87], v[108:111], a[44:47], v[84:87]
    s_add_u32 m0, s73, 148480
    v_cvt_pk_bf16_f32 v200, v68, v69
    v_and_b32 v9, 0xffff0000, v28
    v_mfma_f32_16x16x32_bf16 v[84:87], v[104:107], a[36:39], v[84:87]
    buffer_load_dwordx4 v22, s[44:47], s26 offen offset:0 sc1 lds
    s_waitcnt lgkmcnt(2)
    v_mfma_f32_16x16x32_bf16 v[76:79], v[120:123], a[68:71], v[76:79]
    s_add_u32 m0, s73, 148992
    v_lshlrev_b32 v8, 16, v28
    v_mfma_f32_16x16x32_bf16 v[76:79], v[124:127], a[76:79], v[76:79]
    buffer_load_dwordx4 v22, s[44:47], s26 offen offset:512 sc1 lds
    s_waitcnt lgkmcnt(0)
    v_mfma_f32_16x16x32_bf16 v[76:79], v[128:131], a[84:87], v[76:79]
    ds_read_b128 v[104:107], v14 offset:2048
    v_cvt_pk_bf16_f32 v201, v70, v71
    v_mfma_f32_16x16x32_bf16 v[76:79], v[132:135], a[92:95], v[76:79]
    ds_read_b128 v[108:111], v14 offset:6144
    v_mul_f32 v173, v173, v9
    v_mfma_f32_16x16x32_bf16 v[72:75], v[132:135], a[88:91], v[72:75]
    ds_read_b128 v[112:115], v14 offset:10240
    v_mul_f32 v172, v172, v8
    v_mfma_f32_16x16x32_bf16 v[72:75], v[128:131], a[80:83], v[72:75]
    ds_read_b128 v[116:119], v14 offset:14336
    v_and_b32 v31, 0xffff0000, v29
    v_mfma_f32_16x16x32_bf16 v[72:75], v[124:127], a[72:75], v[72:75]
    buffer_store_dwordx4 v[200:203], v136, s[44:47], s15 offen offset:2048 sc1
    s_add_u32 m0, s73, 150528
    v_mfma_f32_16x16x32_bf16 v[72:75], v[120:123], a[64:67], v[72:75]
    buffer_load_dwordx4 v19, s[44:47], s18 offen offset:0 sc1 lds
    s_waitcnt lgkmcnt(2)
    v_mfma_f32_16x16x32_bf16 v[80:83], v[104:107], a[64:67], v[80:83]
    v_lshlrev_b32 v30, 16, v29
    v_mul_f32 v175, v175, v31
    v_mfma_f32_16x16x32_bf16 v[80:83], v[108:111], a[72:75], v[80:83]
    buffer_load_dwordx4 v[40:43], v136, s[44:47], s34 offen offset:0 sc1
    s_waitcnt lgkmcnt(0)
    v_mfma_f32_16x16x32_bf16 v[80:83], v[112:115], a[80:83], v[80:83]
    ds_read_b128 v[120:123], v14 offset:3072
    v_mfma_f32_16x16x32_bf16 v[80:83], v[116:119], a[88:91], v[80:83]
    ds_read_b128 v[124:127], v14 offset:7168
    v_mul_f32 v174, v174, v30
    v_mfma_f32_16x16x32_bf16 v[84:87], v[116:119], a[92:95], v[84:87]
    ds_read_b128 v[128:131], v14 offset:11264
    v_and_b32 v9, 0xffff0000, v190
    v_mfma_f32_16x16x32_bf16 v[84:87], v[112:115], a[84:87], v[84:87]
    ds_read_b128 v[132:135], v14 offset:15360
    buffer_load_dwordx4 v[44:47], v136, s[44:47], s34 offen offset:1024 sc1
    v_mfma_f32_16x16x32_bf16 v[84:87], v[108:111], a[76:79], v[84:87]
    v_lshlrev_b32 v8, 16, v190
    v_mfma_f32_16x16x32_bf16 v[84:87], v[104:107], a[68:71], v[84:87]
    s_waitcnt lgkmcnt(2)
    v_mfma_f32_16x16x32_bf16 v[76:79], v[120:123], a[100:103], v[76:79]
    buffer_load_dwordx4 v[48:51], v136, s[44:47], s34 offen offset:2048 sc1
    v_mul_f32 v177, v177, v9
    v_mfma_f32_16x16x32_bf16 v[76:79], v[124:127], a[108:111], v[76:79]
    s_waitcnt lgkmcnt(0)
    v_mfma_f32_16x16x32_bf16 v[76:79], v[128:131], a[116:119], v[76:79]
    s_waitcnt vmcnt(14)
    s_barrier
    v_mul_f32 v176, v176, v8
    v_mfma_f32_16x16x32_bf16 v[76:79], v[132:135], a[124:127], v[76:79]
    ds_read_b128 v[104:107], v14 offset:16384
    v_and_b32 v31, 0xffff0000, v191
    v_mfma_f32_16x16x32_bf16 v[72:75], v[132:135], a[120:123], v[72:75]
    ds_read_b128 v[108:111], v14 offset:20480
    buffer_load_dwordx4 v[204:207], v136, s[44:47], s35 offen offset:0 sc1
    v_mfma_f32_16x16x32_bf16 v[72:75], v[128:131], a[112:115], v[72:75]
    ds_read_b128 v[112:115], v14 offset:24576
    v_lshlrev_b32 v30, 16, v191
    v_mfma_f32_16x16x32_bf16 v[72:75], v[124:127], a[104:107], v[72:75]
    ds_read_b128 v[116:119], v14 offset:28672
    v_mul_f32 v179, v179, v31
    v_mfma_f32_16x16x32_bf16 v[72:75], v[120:123], a[96:99], v[72:75]
    buffer_load_dwordx4 v[208:211], v136, s[44:47], s35 offen offset:1024 sc1
    s_waitcnt lgkmcnt(2)
    v_mfma_f32_16x16x32_bf16 v[80:83], v[104:107], a[96:99], v[80:83]
    v_mfma_f32_16x16x32_bf16 v[80:83], v[108:111], a[104:107], v[80:83]
    v_mul_f32 v178, v178, v30
    s_waitcnt lgkmcnt(0)
    v_mfma_f32_16x16x32_bf16 v[80:83], v[112:115], a[112:115], v[80:83]
    ds_read_b128 v[120:123], v14 offset:17408
    buffer_load_dwordx4 v[212:215], v136, s[44:47], s35 offen offset:2048 sc1
    v_mfma_f32_16x16x32_bf16 v[80:83], v[116:119], a[120:123], v[80:83]
    ds_read_b128 v[124:127], v14 offset:21504
    v_and_b32 v9, 0xffff0000, v142
    v_mfma_f32_16x16x32_bf16 v[84:87], v[116:119], a[124:127], v[84:87]
    ds_read_b128 v[128:131], v14 offset:25600
    v_lshlrev_b32 v8, 16, v142
    v_mfma_f32_16x16x32_bf16 v[84:87], v[112:115], a[116:119], v[84:87]
    ds_read_b128 v[132:135], v14 offset:29696
    v_mfma_f32_16x16x32_bf16 v[84:87], v[108:111], a[108:111], v[84:87]
    buffer_load_dwordx4 v[216:219], v136, s[44:47], s35 offen offset:3072 sc1
    v_mul_f32 v181, v181, v9
    v_mfma_f32_16x16x32_bf16 v[84:87], v[104:107], a[100:103], v[84:87]
    s_waitcnt lgkmcnt(2)
    v_mfma_f32_16x16x32_bf16 v[76:79], v[120:123], a[132:135], v[76:79]
    v_mul_f32 v180, v180, v8
    v_mfma_f32_16x16x32_bf16 v[76:79], v[124:127], a[140:143], v[76:79]
    v_and_b32 v31, 0xffff0000, v143
    s_waitcnt lgkmcnt(0)
    v_mfma_f32_16x16x32_bf16 v[76:79], v[128:131], a[148:151], v[76:79]
    ds_read_b128 v[104:107], v14 offset:18432
    v_mfma_f32_16x16x32_bf16 v[76:79], v[132:135], a[156:159], v[76:79]
    ds_read_b128 v[108:111], v14 offset:22528
    v_lshlrev_b32 v30, 16, v143
    v_mfma_f32_16x16x32_bf16 v[72:75], v[132:135], a[152:155], v[72:75]
    ds_read_b128 v[112:115], v14 offset:26624
    v_mfma_f32_16x16x32_bf16 v[72:75], v[128:131], a[144:147], v[72:75]
    ds_read_b128 v[116:119], v14 offset:30720
    v_mul_f32 v183, v183, v31
    v_mfma_f32_16x16x32_bf16 v[72:75], v[124:127], a[136:139], v[72:75]
    v_mfma_f32_16x16x32_bf16 v[72:75], v[120:123], a[128:131], v[72:75]
    v_mul_f32 v182, v182, v30
    s_waitcnt lgkmcnt(2)
    v_mfma_f32_16x16x32_bf16 v[80:83], v[104:107], a[128:131], v[80:83]
    v_mfma_f32_16x16x32_bf16 v[80:83], v[108:111], a[136:139], v[80:83]
    s_waitcnt lgkmcnt(0)
    v_mfma_f32_16x16x32_bf16 v[80:83], v[112:115], a[144:147], v[80:83]
    ds_read_b128 v[120:123], v14 offset:19456
    v_mfma_f32_16x16x32_bf16 v[80:83], v[116:119], a[152:155], v[80:83]
    ds_read_b128 v[124:127], v14 offset:23552
    v_mfma_f32_16x16x32_bf16 v[84:87], v[116:119], a[156:159], v[84:87]
    ds_read_b128 v[128:131], v14 offset:27648
    v_mfma_f32_16x16x32_bf16 v[84:87], v[112:115], a[148:151], v[84:87]
    ds_read_b128 v[132:135], v14 offset:31744
    v_mfma_f32_16x16x32_bf16 v[84:87], v[108:111], a[140:143], v[84:87]
    v_mfma_f32_16x16x32_bf16 v[84:87], v[104:107], a[132:135], v[84:87]
    s_waitcnt lgkmcnt(2)
    v_mfma_f32_16x16x32_bf16 v[76:79], v[120:123], a[164:167], v[76:79]
    s_add_u32 m0, s73, 97792
    v_mfma_f32_16x16x32_bf16 v[76:79], v[124:127], a[172:175], v[76:79]
    buffer_load_dwordx4 v19, s[44:47], s18 offen offset:512 sc1 lds
    s_waitcnt lgkmcnt(0)
    v_mfma_f32_16x16x32_bf16 v[76:79], v[128:131], a[180:183], v[76:79]
    s_waitcnt vmcnt(15)
    s_barrier
    v_mfma_f32_16x16x32_bf16 v[76:79], v[132:135], a[188:191], v[76:79]
    ds_read_b128 v[104:107], v14 offset:32768
    v_mfma_f32_16x16x32_bf16 v[72:75], v[132:135], a[184:187], v[72:75]
    ds_read_b128 v[108:111], v14 offset:36864
    v_mfma_f32_16x16x32_bf16 v[72:75], v[128:131], a[176:179], v[72:75]
    ds_read_b128 v[112:115], v14 offset:40960
    v_mfma_f32_16x16x32_bf16 v[72:75], v[124:127], a[168:171], v[72:75]
    ds_read_b128 v[116:119], v14 offset:45056
    s_add_u32 m0, s73, 99328
    v_mfma_f32_16x16x32_bf16 v[72:75], v[120:123], a[160:163], v[72:75]
    buffer_load_dwordx4 v19, s[44:47], s19 offen offset:0 sc1 lds
    s_waitcnt lgkmcnt(2)
    v_mfma_f32_16x16x32_bf16 v[80:83], v[104:107], a[160:163], v[80:83]
    s_add_u32 m0, s73, 99840
    v_mfma_f32_16x16x32_bf16 v[80:83], v[108:111], a[168:171], v[80:83]
    buffer_load_dwordx4 v19, s[44:47], s19 offen offset:512 sc1 lds
    s_waitcnt lgkmcnt(0)
    v_mfma_f32_16x16x32_bf16 v[80:83], v[112:115], a[176:179], v[80:83]
    ds_read_b128 v[120:123], v14 offset:33792
    v_mfma_f32_16x16x32_bf16 v[80:83], v[116:119], a[184:187], v[80:83]
    ds_read_b128 v[124:127], v14 offset:37888
    v_mfma_f32_16x16x32_bf16 v[84:87], v[116:119], a[188:191], v[84:87]
    ds_read_b128 v[128:131], v14 offset:41984
    v_mfma_f32_16x16x32_bf16 v[84:87], v[112:115], a[180:183], v[84:87]
    ds_read_b128 v[132:135], v14 offset:46080
    v_mfma_f32_16x16x32_bf16 v[84:87], v[108:111], a[172:175], v[84:87]
    s_add_u32 m0, s73, 101376
    v_mfma_f32_16x16x32_bf16 v[84:87], v[104:107], a[164:167], v[84:87]
    buffer_load_dwordx4 v19, s[44:47], s20 offen offset:0 sc1 lds
    s_waitcnt lgkmcnt(2)
    v_mfma_f32_16x16x32_bf16 v[76:79], v[120:123], a[196:199], v[76:79]
    s_add_u32 m0, s73, 114176
    v_mov_b32 v141, 0
    v_mfma_f32_16x16x32_bf16 v[76:79], v[124:127], a[204:207], v[76:79]
    buffer_load_dwordx4 v19, s[44:47], s20 offen offset:512 sc1 lds
    s_waitcnt lgkmcnt(0)
    v_mfma_f32_16x16x32_bf16 v[76:79], v[128:131], a[212:215], v[76:79]
    ds_read_b128 v[104:107], v14 offset:34816
    v_mfma_f32_16x16x32_bf16 v[76:79], v[132:135], a[220:223], v[76:79]
    ds_read_b128 v[108:111], v14 offset:38912
    buffer_atomic_add v141, v139, s[44:47], s11 offen offset:2060 sc0 sc1
    v_mfma_f32_16x16x32_bf16 v[72:75], v[132:135], a[216:219], v[72:75]
    ds_read_b128 v[112:115], v14 offset:43008
    v_mfma_f32_16x16x32_bf16 v[72:75], v[128:131], a[208:211], v[72:75]
    ds_read_b128 v[116:119], v14 offset:47104
    v_mfma_f32_16x16x32_bf16 v[72:75], v[124:127], a[200:203], v[72:75]
    s_add_u32 m0, s73, 115712
    v_mfma_f32_16x16x32_bf16 v[72:75], v[120:123], a[192:195], v[72:75]
    buffer_load_dwordx4 v19, s[44:47], s21 offen offset:0 sc1 lds
    s_waitcnt lgkmcnt(2)
    v_mfma_f32_16x16x32_bf16 v[80:83], v[104:107], a[192:195], v[80:83]
    s_add_u32 m0, s73, 116224
    v_mfma_f32_16x16x32_bf16 v[80:83], v[108:111], a[200:203], v[80:83]
    buffer_load_dwordx4 v19, s[44:47], s21 offen offset:512 sc1 lds
    s_waitcnt lgkmcnt(0)
    v_mfma_f32_16x16x32_bf16 v[80:83], v[112:115], a[208:211], v[80:83]
    ds_read_b128 v[120:123], v14 offset:35840
    v_mfma_f32_16x16x32_bf16 v[80:83], v[116:119], a[216:219], v[80:83]
    ds_read_b128 v[124:127], v14 offset:39936
    v_mfma_f32_16x16x32_bf16 v[84:87], v[116:119], a[220:223], v[84:87]
    ds_read_b128 v[128:131], v14 offset:44032
    v_mfma_f32_16x16x32_bf16 v[84:87], v[112:115], a[212:215], v[84:87]
    ds_read_b128 v[132:135], v14 offset:48128
    v_mfma_f32_16x16x32_bf16 v[84:87], v[108:111], a[204:207], v[84:87]
    s_add_u32 m0, s73, 117760
    v_mfma_f32_16x16x32_bf16 v[84:87], v[104:107], a[196:199], v[84:87]
    buffer_load_dwordx4 v19, s[44:47], s22 offen offset:0 sc1 lds
    s_waitcnt lgkmcnt(2)
    v_mfma_f32_16x16x32_bf16 v[76:79], v[120:123], a[228:231], v[76:79]
    v_mfma_f32_16x16x32_bf16 v[76:79], v[124:127], a[236:239], v[76:79]
    s_waitcnt lgkmcnt(0)
    v_mfma_f32_16x16x32_bf16 v[76:79], v[128:131], a[244:247], v[76:79]
    s_waitcnt vmcnt(16)
    s_barrier
    v_mfma_f32_16x16x32_bf16 v[76:79], v[132:135], a[252:255], v[76:79]
    ds_read_b128 v[104:107], v14 offset:49152
    v_mfma_f32_16x16x32_bf16 v[72:75], v[132:135], a[248:251], v[72:75]
    ds_read_b128 v[108:111], v14 offset:53248
    v_mfma_f32_16x16x32_bf16 v[72:75], v[128:131], a[240:243], v[72:75]
    ds_read_b128 v[112:115], v14 offset:57344
    v_mfma_f32_16x16x32_bf16 v[72:75], v[124:127], a[232:235], v[72:75]
    ds_read_b128 v[116:119], v14 offset:61440
    v_mfma_f32_16x16x32_bf16 v[72:75], v[120:123], a[224:227], v[72:75]
    s_waitcnt lgkmcnt(2)
    v_mfma_f32_16x16x32_bf16 v[80:83], v[104:107], a[224:227], v[80:83]
    s_add_u32 m0, s73, 130560
    v_mfma_f32_16x16x32_bf16 v[80:83], v[108:111], a[232:235], v[80:83]
    buffer_load_dwordx4 v19, s[44:47], s22 offen offset:512 sc1 lds
    s_waitcnt lgkmcnt(0)
    v_mfma_f32_16x16x32_bf16 v[80:83], v[112:115], a[240:243], v[80:83]
    ds_read_b128 v[120:123], v14 offset:50176
    v_mfma_f32_16x16x32_bf16 v[80:83], v[116:119], a[248:251], v[80:83]
    ds_read_b128 v[124:127], v14 offset:54272
    v_mfma_f32_16x16x32_bf16 v[84:87], v[116:119], a[252:255], v[84:87]
    ds_read_b128 v[128:131], v14 offset:58368
    v_mfma_f32_16x16x32_bf16 v[84:87], v[112:115], a[244:247], v[84:87]
    ds_read_b128 v[132:135], v14 offset:62464
    v_mfma_f32_16x16x32_bf16 v[84:87], v[108:111], a[236:239], v[84:87]
    s_add_u32 m0, s73, 132096
    v_mfma_f32_16x16x32_bf16 v[84:87], v[104:107], a[228:231], v[84:87]
    buffer_load_dwordx4 v19, s[44:47], s23 offen offset:0 sc1 lds
    s_waitcnt lgkmcnt(2)
    v_mfma_f32_16x16x32_bf16 v[76:79], v[120:123], v[224:227], v[76:79]
    s_add_u32 m0, s73, 132608
    s_waitcnt vmcnt(15)
    v_bitop3_b32 v43, v43, v47, s68 bitop3:0x7e
    v_bitop3_b32 v43, v43, v51, s68 bitop3:0xf6
    v_cmp_ne_u32 vcc, 0, v43
    v_mfma_f32_16x16x32_bf16 v[76:79], v[124:127], v[232:235], v[76:79]
    buffer_load_dwordx4 v19, s[44:47], s23 offen offset:512 sc1 lds
    s_waitcnt lgkmcnt(0)
    v_mfma_f32_16x16x32_bf16 v[76:79], v[128:131], v[240:243], v[76:79]
    ds_read_b128 v[104:107], v14 offset:51200
    s_cbranch_vccnz L_xs_a
L_xo_a:
    v_and_b32 v89, 0xffff0000, v40
    v_mfma_f32_16x16x32_bf16 v[76:79], v[132:135], v[248:251], v[76:79]
    ds_read_b128 v[108:111], v14 offset:55296
    v_lshlrev_b32 v88, 16, v40
    v_mfma_f32_16x16x32_bf16 v[72:75], v[132:135], v[244:247], v[72:75]
    ds_read_b128 v[112:115], v14 offset:59392
    v_and_b32 v91, 0xffff0000, v41
    v_mfma_f32_16x16x32_bf16 v[72:75], v[128:131], v[236:239], v[72:75]
    ds_read_b128 v[116:119], v14 offset:63488
    v_lshlrev_b32 v90, 16, v41
    v_mfma_f32_16x16x32_bf16 v[72:75], v[124:127], v[228:231], v[72:75]
    s_add_u32 m0, s73, 134144
    v_and_b32 v93, 0xffff0000, v42
    v_lshlrev_b32 v92, 16, v42
    v_mfma_f32_16x16x32_bf16 v[72:75], v[120:123], v[220:223], v[72:75]
    buffer_load_dwordx4 v19, s[44:47], s24 offen offset:0 sc1 lds
    s_waitcnt lgkmcnt(2)
    v_mfma_f32_16x16x32_bf16 v[80:83], v[104:107], v[220:223], v[80:83]
    v_and_b32 v95, 0xffff0000, v44
    v_lshlrev_b32 v94, 16, v44
    v_mfma_f32_16x16x32_bf16 v[80:83], v[108:111], v[228:231], v[80:83]
    v_and_b32 v97, 0xffff0000, v45
    s_waitcnt lgkmcnt(0)
    v_mfma_f32_16x16x32_bf16 v[80:83], v[112:115], v[236:239], v[80:83]
    ds_read_b128 v[120:123], v14 offset:52224
    v_lshlrev_b32 v96, 16, v45
    v_mfma_f32_16x16x32_bf16 v[80:83], v[116:119], v[244:247], v[80:83]
    ds_read_b128 v[124:127], v14 offset:56320
    v_and_b32 v99, 0xffff0000, v46
    v_lshlrev_b32 v98, 16, v46
    v_mfma_f32_16x16x32_bf16 v[84:87], v[116:119], v[248:251], v[84:87]
    ds_read_b128 v[128:131], v14 offset:60416
    s_waitcnt vmcnt(7)
    v_and_b32 v101, 0xffff0000, v48
    v_mfma_f32_16x16x32_bf16 v[84:87], v[112:115], v[240:243], v[84:87]
    ds_read_b128 v[132:135], v14 offset:64512
    v_lshlrev_b32 v100, 16, v48
    v_cmp_ne_u32 vcc, v140, v141
    v_mfma_f32_16x16x32_bf16 v[84:87], v[108:111], v[232:235], v[84:87]
    v_and_b32 v103, 0xffff0000, v49
    v_lshlrev_b32 v102, 16, v49
    v_mfma_f32_16x16x32_bf16 v[84:87], v[104:107], v[224:227], v[84:87]
    s_cbranch_vccnz L_as_b
L_ao_b:
    s_waitcnt lgkmcnt(2)
    v_mfma_f32_16x16x32_bf16 v[92:95], v[120:123], a[4:7], v[92:95]
    buffer_load_dwordx4 v[56:59], v136, s[44:47], s11 offen offset:0 sc1
    v_mfma_f32_16x16x32_bf16 v[92:95], v[124:127], a[12:15], v[92:95]
    s_waitcnt lgkmcnt(0)
    v_mfma_f32_16x16x32_bf16 v[92:95], v[128:131], a[20:23], v[92:95]
    buffer_load_dwordx4 v[60:63], v136, s[44:47], s11 offen offset:1024 sc1
    s_barrier
    v_mfma_f32_16x16x32_bf16 v[92:95], v[132:135], a[28:31], v[92:95]
    ds_read_b128 v[104:107], v14 offset:0
    buffer_load_dwordx4 v[64:67], v136, s[44:47], s11 offen offset:2048 sc1
    v_mfma_f32_16x16x32_bf16 v[88:91], v[132:135], a[24:27], v[88:91]
    ds_read_b128 v[108:111], v14 offset:4096
    v_cvt_pk_bf16_f32 v192, v72, v73
    v_mfma_f32_16x16x32_bf16 v[88:91], v[128:131], a[16:19], v[88:91]
    ds_read_b128 v[112:115], v14 offset:8192
    v_cvt_pk_bf16_f32 v193, v74, v75
    v_mfma_f32_16x16x32_bf16 v[88:91], v[124:127], a[8:11], v[88:91]
    ds_read_b128 v[116:119], v14 offset:12288
    v_cvt_pk_bf16_f32 v194, v76, v77
    v_mfma_f32_16x16x32_bf16 v[88:91], v[120:123], a[0:3], v[88:91]
    buffer_store_dwordx4 v[192:195], v136, s[44:47], s31 offen offset:0 sc1
L_pl_D_2:
    s_cbranch_execz L_wret
    s_waitcnt lgkmcnt(2)
    v_mfma_f32_16x16x32_bf16 v[96:99], v[104:107], a[0:3], v[96:99]
    s_add_u32 m0, s73, 146944
    v_cvt_pk_bf16_f32 v196, v78, v79
    v_cvt_pk_bf16_f32 v197, v80, v81
    v_mfma_f32_16x16x32_bf16 v[96:99], v[108:111], a[8:11], v[96:99]
    buffer_load_dwordx4 v19, s[44:47], s24 offen offset:512 sc1 lds
    s_waitcnt lgkmcnt(0)
    v_mfma_f32_16x16x32_bf16 v[96:99], v[112:115], a[16:19], v[96:99]
    ds_read_b128 v[120:123], v14 offset:1024
    v_cvt_pk_bf16_f32 v198, v82, v83
    v_mfma_f32_16x16x32_bf16 v[96:99], v[116:119], a[24:27], v[96:99]
    buffer_store_dwordx4 v[196:199], v136, s[44:47], s31 offen offset:1024 sc1
    ds_read_b128 v[124:127], v14 offset:5120
    v_bitop3_b32 v207, v207, v211, s36 bitop3:0x7e
    v_bitop3_b32 v207, v207, v215, s36 bitop3:0xf6
    v_mfma_f32_16x16x32_bf16 v[100:103], v[116:119], a[28:31], v[100:103]
    ds_read_b128 v[128:131], v14 offset:9216
    v_cvt_pk_bf16_f32 v200, v84, v85
    v_mfma_f32_16x16x32_bf16 v[100:103], v[112:115], a[20:23], v[100:103]
    ds_read_b128 v[132:135], v14 offset:13312
    v_cvt_pk_bf16_f32 v201, v86, v87
    v_mfma_f32_16x16x32_bf16 v[100:103], v[108:111], a[12:15], v[100:103]
    buffer_store_dwordx4 v[200:203], v136, s[44:47], s31 offen offset:2048 sc1
    s_add_u32 m0, s73, 148480
    v_bitop3_b32 v207, v207, v219, s36 bitop3:0xf6
    v_cmp_ne_u32 vcc, 0, v207
    v_mfma_f32_16x16x32_bf16 v[100:103], v[104:107], a[4:7], v[100:103]
    buffer_load_dwordx4 v19, s[44:47], s25 offen offset:0 sc1 lds
    s_waitcnt lgkmcnt(2)
    v_mfma_f32_16x16x32_bf16 v[92:95], v[120:123], a[36:39], v[92:95]
    s_add_u32 m0, s73, 148992
    s_cbranch_vccnz L_xs_8
L_xo_8:
    v_mfma_f32_16x16x32_bf16 v[92:95], v[124:127], a[44:47], v[92:95]
    buffer_load_dwordx4 v19, s[44:47], s25 offen offset:512 sc1 lds
    s_waitcnt lgkmcnt(0)
    v_mfma_f32_16x16x32_bf16 v[92:95], v[128:131], a[52:55], v[92:95]
    ds_read_b128 v[104:107], v14 offset:2048
    v_and_b32 v33, 0xffff0000, v204
    v_mfma_f32_16x16x32_bf16 v[92:95], v[132:135], a[60:63], v[92:95]
    ds_read_b128 v[108:111], v14 offset:6144
    v_lshlrev_b32 v32, 16, v204
    v_mfma_f32_16x16x32_bf16 v[88:91], v[132:135], a[56:59], v[88:91]
    ds_read_b128 v[112:115], v14 offset:10240
    v_and_b32 v35, 0xffff0000, v205
    v_mfma_f32_16x16x32_bf16 v[88:91], v[128:131], a[48:51], v[88:91]
    ds_read_b128 v[116:119], v14 offset:14336
    v_mfma_f32_16x16x32_bf16 v[88:91], v[124:127], a[40:43], v[88:91]
    s_add_u32 m0, s73, 150528
    v_lshlrev_b32 v34, 16, v205
    v_mfma_f32_16x16x32_bf16 v[88:91], v[120:123], a[32:35], v[88:91]
    buffer_load_dwordx4 v19, s[44:47], s26 offen offset:0 sc1 lds
    s_waitcnt lgkmcnt(2)
    v_mfma_f32_16x16x32_bf16 v[96:99], v[104:107], a[32:35], v[96:99]
    v_add_f32 v32, v32, v27
    v_mfma_f32_16x16x32_bf16 v[96:99], v[108:111], a[40:43], v[96:99]
    v_add_f32 v33, v33, v27
    s_waitcnt lgkmcnt(0)
    v_mfma_f32_16x16x32_bf16 v[96:99], v[112:115], a[48:51], v[96:99]
    ds_read_b128 v[120:123], v14 offset:3072
    v_add_f32 v34, v34, v27
    v_mfma_f32_16x16x32_bf16 v[96:99], v[116:119], a[56:59], v[96:99]
    ds_read_b128 v[124:127], v14 offset:7168
    v_mfma_f32_16x16x32_bf16 v[100:103], v[116:119], a[60:63], v[100:103]
    ds_read_b128 v[128:131], v14 offset:11264
    v_add_f32 v35, v35, v27
    v_mfma_f32_16x16x32_bf16 v[100:103], v[112:115], a[52:55], v[100:103]
    ds_read_b128 v[132:135], v14 offset:15360
    v_and_b32 v37, 0xffff0000, v208
    v_mfma_f32_16x16x32_bf16 v[100:103], v[108:111], a[44:47], v[100:103]
    v_mfma_f32_16x16x32_bf16 v[100:103], v[104:107], a[36:39], v[100:103]
    v_lshlrev_b32 v36, 16, v208
    s_waitcnt lgkmcnt(2)
    v_mfma_f32_16x16x32_bf16 v[92:95], v[120:123], a[68:71], v[92:95]
    v_and_b32 v39, 0xffff0000, v209
    v_mfma_f32_16x16x32_bf16 v[92:95], v[124:127], a[76:79], v[92:95]
    s_waitcnt lgkmcnt(0)
    v_mfma_f32_16x16x32_bf16 v[92:95], v[128:131], a[84:87], v[92:95]
    s_waitcnt vmcnt(14)
    s_barrier
    v_lshlrev_b32 v38, 16, v209
    v_mfma_f32_16x16x32_bf16 v[92:95], v[132:135], a[92:95], v[92:95]
    ds_read_b128 v[104:107], v14 offset:16384
    v_add_f32 v32, v32, v36
    v_mfma_f32_16x16x32_bf16 v[88:91], v[132:135], a[88:91], v[88:91]
    ds_read_b128 v[108:111], v14 offset:20480
    v_mfma_f32_16x16x32_bf16 v[88:91], v[128:131], a[80:83], v[88:91]
    ds_read_b128 v[112:115], v14 offset:24576
    v_add_f32 v33, v33, v37
    v_mfma_f32_16x16x32_bf16 v[88:91], v[124:127], a[72:75], v[88:91]
    ds_read_b128 v[116:119], v14 offset:28672
    v_add_f32 v34, v34, v38
    v_mfma_f32_16x16x32_bf16 v[88:91], v[120:123], a[64:67], v[88:91]
    s_waitcnt lgkmcnt(2)
    v_mfma_f32_16x16x32_bf16 v[96:99], v[104:107], a[64:67], v[96:99]
    s_add_u32 m0, s73, 97792
    v_add_f32 v35, v35, v39
    v_mfma_f32_16x16x32_bf16 v[96:99], v[108:111], a[72:75], v[96:99]
    buffer_load_dwordx4 v19, s[44:47], s26 offen offset:512 sc1 lds
    s_waitcnt lgkmcnt(0)
    v_mfma_f32_16x16x32_bf16 v[96:99], v[112:115], a[80:83], v[96:99]
    ds_read_b128 v[120:123], v14 offset:17408
    v_and_b32 v37, 0xffff0000, v212
    v_mfma_f32_16x16x32_bf16 v[96:99], v[116:119], a[88:91], v[96:99]
    ds_read_b128 v[124:127], v14 offset:21504
    v_lshlrev_b32 v36, 16, v212
    v_mfma_f32_16x16x32_bf16 v[100:103], v[116:119], a[92:95], v[100:103]
    ds_read_b128 v[128:131], v14 offset:25600
    v_and_b32 v39, 0xffff0000, v213
    v_mfma_f32_16x16x32_bf16 v[100:103], v[112:115], a[84:87], v[100:103]
    ds_read_b128 v[132:135], v14 offset:29696
    v_mfma_f32_16x16x32_bf16 v[100:103], v[108:111], a[76:79], v[100:103]
    v_lshlrev_b32 v38, 16, v213
    v_mfma_f32_16x16x32_bf16 v[100:103], v[104:107], a[68:71], v[100:103]
    v_add_f32 v32, v32, v36
    s_waitcnt lgkmcnt(2)
    v_mfma_f32_16x16x32_bf16 v[92:95], v[120:123], a[100:103], v[92:95]
    v_mfma_f32_16x16x32_bf16 v[92:95], v[124:127], a[108:111], v[92:95]
    v_add_f32 v33, v33, v37
    s_waitcnt lgkmcnt(0)
    v_mfma_f32_16x16x32_bf16 v[92:95], v[128:131], a[116:119], v[92:95]
    ds_read_b128 v[104:107], v14 offset:18432
    v_add_f32 v34, v34, v38
    v_mfma_f32_16x16x32_bf16 v[92:95], v[132:135], a[124:127], v[92:95]
    ds_read_b128 v[108:111], v14 offset:22528
    v_add_f32 v35, v35, v39
    v_mfma_f32_16x16x32_bf16 v[88:91], v[132:135], a[120:123], v[88:91]
    ds_read_b128 v[112:115], v14 offset:26624
    v_and_b32 v37, 0xffff0000, v216
    v_mfma_f32_16x16x32_bf16 v[88:91], v[128:131], a[112:115], v[88:91]
    ds_read_b128 v[116:119], v14 offset:30720
    v_lshlrev_b32 v36, 16, v216
    v_mfma_f32_16x16x32_bf16 v[88:91], v[124:127], a[104:107], v[88:91]
    v_and_b32 v39, 0xffff0000, v217
    v_lshlrev_b32 v38, 16, v217
    v_mfma_f32_16x16x32_bf16 v[88:91], v[120:123], a[96:99], v[88:91]
    v_add_f32 v32, v32, v36
    s_waitcnt lgkmcnt(2)
    v_mfma_f32_16x16x32_bf16 v[96:99], v[104:107], a[96:99], v[96:99]
    v_add_f32 v33, v33, v37
    v_add_f32 v34, v34, v38
    v_mfma_f32_16x16x32_bf16 v[96:99], v[108:111], a[104:107], v[96:99]
    v_add_f32 v35, v35, v39
    s_waitcnt lgkmcnt(0)
    v_mfma_f32_16x16x32_bf16 v[96:99], v[112:115], a[112:115], v[96:99]
    ds_read_b128 v[120:123], v14 offset:19456
    v_mul_f32 v36, s38, v32
    v_mfma_f32_16x16x32_bf16 v[96:99], v[116:119], a[120:123], v[96:99]
    ds_read_b128 v[124:127], v14 offset:23552
    v_mul_f32 v37, s38, v33
    v_mfma_f32_16x16x32_bf16 v[100:103], v[116:119], a[124:127], v[100:103]
    ds_read_b128 v[128:131], v14 offset:27648
    v_mul_f32 v38, s38, v34
    v_mfma_f32_16x16x32_bf16 v[100:103], v[112:115], a[116:119], v[100:103]
    ds_read_b128 v[132:135], v14 offset:31744
    v_mul_f32 v39, s38, v35
    v_mfma_f32_16x16x32_bf16 v[100:103], v[108:111], a[108:111], v[100:103]
    v_exp_f32 v36, v36
    v_mfma_f32_16x16x32_bf16 v[100:103], v[104:107], a[100:103], v[100:103]
    s_waitcnt lgkmcnt(2)
    v_mfma_f32_16x16x32_bf16 v[92:95], v[120:123], a[132:135], v[92:95]
    v_exp_f32 v37, v37
    v_mfma_f32_16x16x32_bf16 v[92:95], v[124:127], a[140:143], v[92:95]
    s_waitcnt lgkmcnt(0)
    v_mfma_f32_16x16x32_bf16 v[92:95], v[128:131], a[148:151], v[92:95]
    s_waitcnt vmcnt(11)
    s_barrier
    v_mfma_f32_16x16x32_bf16 v[92:95], v[132:135], a[156:159], v[92:95]
    ds_read_b128 v[104:107], v14 offset:32768
    v_mfma_f32_16x16x32_bf16 v[88:91], v[132:135], a[152:155], v[88:91]
    ds_read_b128 v[108:111], v14 offset:36864
    v_exp_f32 v38, v38
    v_mfma_f32_16x16x32_bf16 v[88:91], v[128:131], a[144:147], v[88:91]
    ds_read_b128 v[112:115], v14 offset:40960
    v_exp_f32 v39, v39
    v_mfma_f32_16x16x32_bf16 v[88:91], v[124:127], a[136:139], v[88:91]
    ds_read_b128 v[116:119], v14 offset:45056
    v_mul_f32 v180, v180, v32
    v_mfma_f32_16x16x32_bf16 v[88:91], v[120:123], a[128:131], v[88:91]
    v_mul_f32 v181, v181, v33
    s_waitcnt lgkmcnt(2)
    v_mfma_f32_16x16x32_bf16 v[96:99], v[104:107], a[128:131], v[96:99]
    v_mul_f32 v182, v182, v34
    v_mul_f32 v183, v183, v35
    v_mfma_f32_16x16x32_bf16 v[96:99], v[108:111], a[136:139], v[96:99]
    v_add_f32 v36, 1.0, v36
    s_waitcnt lgkmcnt(0)
    v_mfma_f32_16x16x32_bf16 v[96:99], v[112:115], a[144:147], v[96:99]
    ds_read_b128 v[120:123], v14 offset:33792
    v_add_f32 v37, 1.0, v37
    v_mfma_f32_16x16x32_bf16 v[96:99], v[116:119], a[152:155], v[96:99]
    ds_read_b128 v[124:127], v14 offset:37888
    v_add_f32 v38, 1.0, v38
    v_mfma_f32_16x16x32_bf16 v[100:103], v[116:119], a[156:159], v[100:103]
    ds_read_b128 v[128:131], v14 offset:41984
    v_add_f32 v39, 1.0, v39
    v_mfma_f32_16x16x32_bf16 v[100:103], v[112:115], a[148:151], v[100:103]
    ds_read_b128 v[132:135], v14 offset:46080
    v_rcp_f32 v36, v36
    v_mfma_f32_16x16x32_bf16 v[100:103], v[108:111], a[140:143], v[100:103]
    v_rcp_f32 v37, v37
    v_mfma_f32_16x16x32_bf16 v[100:103], v[104:107], a[132:135], v[100:103]
    v_rcp_f32 v38, v38
    s_waitcnt lgkmcnt(2)
    v_mfma_f32_16x16x32_bf16 v[92:95], v[120:123], a[164:167], v[92:95]
    s_waitcnt vmcnt(8)
    v_bitop3_b32 v59, v59, v63, s68 bitop3:0x7e
    v_rcp_f32 v39, v39
    v_mfma_f32_16x16x32_bf16 v[92:95], v[124:127], a[172:175], v[92:95]
    buffer_load_dwordx4 v[72:75], v136, s[44:47], s12 offen offset:0 sc1
    s_waitcnt lgkmcnt(0)
    v_mfma_f32_16x16x32_bf16 v[92:95], v[128:131], a[180:183], v[92:95]
    ds_read_b128 v[104:107], v14 offset:34816
    v_bitop3_b32 v59, v59, v67, s68 bitop3:0xf6
    v_mfma_f32_16x16x32_bf16 v[92:95], v[132:135], a[188:191], v[92:95]
    ds_read_b128 v[108:111], v14 offset:38912
    v_cmp_ne_u32 vcc, 0, v59
    v_mfma_f32_16x16x32_bf16 v[88:91], v[132:135], a[184:187], v[88:91]
    ds_read_b128 v[112:115], v14 offset:43008
    buffer_load_dwordx4 v[76:79], v136, s[44:47], s12 offen offset:1024 sc1
    v_mfma_f32_16x16x32_bf16 v[88:91], v[128:131], a[176:179], v[88:91]
    ds_read_b128 v[116:119], v14 offset:47104
    s_cbranch_vccnz L_xs_b
L_xo_b:
    v_fma_f32 v180, v180, v36, v160
    v_mfma_f32_16x16x32_bf16 v[88:91], v[124:127], a[168:171], v[88:91]
    buffer_load_dwordx4 v[80:83], v136, s[44:47], s12 offen offset:2048 sc1
    v_and_b32 v41, 0xffff0000, v56
    v_mfma_f32_16x16x32_bf16 v[88:91], v[120:123], a[160:163], v[88:91]
    v_lshlrev_b32 v40, 16, v56
    s_waitcnt lgkmcnt(2)
    v_mfma_f32_16x16x32_bf16 v[96:99], v[104:107], a[160:163], v[96:99]
    v_and_b32 v43, 0xffff0000, v57
    v_fma_f32 v181, v181, v37, v161
    v_mfma_f32_16x16x32_bf16 v[96:99], v[108:111], a[168:171], v[96:99]
    v_lshlrev_b32 v42, 16, v57
    s_waitcnt lgkmcnt(0)
    v_mfma_f32_16x16x32_bf16 v[96:99], v[112:115], a[176:179], v[96:99]
    ds_read_b128 v[120:123], v14 offset:35840
    v_and_b32 v45, 0xffff0000, v58
    v_mfma_f32_16x16x32_bf16 v[96:99], v[116:119], a[184:187], v[96:99]
    ds_read_b128 v[124:127], v14 offset:39936
    v_fma_f32 v182, v182, v38, v162
    v_mfma_f32_16x16x32_bf16 v[100:103], v[116:119], a[188:191], v[100:103]
    ds_read_b128 v[128:131], v14 offset:44032
    v_lshlrev_b32 v44, 16, v58
    v_mfma_f32_16x16x32_bf16 v[100:103], v[112:115], a[180:183], v[100:103]
    ds_read_b128 v[132:135], v14 offset:48128
    v_and_b32 v47, 0xffff0000, v60
    v_mfma_f32_16x16x32_bf16 v[100:103], v[108:111], a[172:175], v[100:103]
    v_lshlrev_b32 v46, 16, v60
    v_fma_f32 v183, v183, v39, v163
    v_mfma_f32_16x16x32_bf16 v[100:103], v[104:107], a[164:167], v[100:103]
    v_and_b32 v49, 0xffff0000, v61
    s_waitcnt lgkmcnt(2)
    v_mfma_f32_16x16x32_bf16 v[92:95], v[120:123], a[196:199], v[92:95]
    v_lshlrev_b32 v48, 16, v61
    v_cvt_pk_bf16_f32 v142, v180, v181
    v_mfma_f32_16x16x32_bf16 v[92:95], v[124:127], a[204:207], v[92:95]
    v_and_b32 v51, 0xffff0000, v62
    s_waitcnt lgkmcnt(0)
    v_mfma_f32_16x16x32_bf16 v[92:95], v[128:131], a[212:215], v[92:95]
    s_waitcnt vmcnt(4)
    s_barrier
    v_lshlrev_b32 v50, 16, v62
    v_mfma_f32_16x16x32_bf16 v[92:95], v[132:135], a[220:223], v[92:95]
    ds_read_b128 v[104:107], v14 offset:49152
    v_cvt_pk_bf16_f32 v143, v182, v183
    v_mfma_f32_16x16x32_bf16 v[88:91], v[132:135], a[216:219], v[88:91]
    ds_read_b128 v[108:111], v14 offset:53248
    v_and_b32 v53, 0xffff0000, v64
    v_mfma_f32_16x16x32_bf16 v[88:91], v[128:131], a[208:211], v[88:91]
    ds_read_b128 v[112:115], v14 offset:57344
    v_lshlrev_b32 v52, 16, v64
    v_mfma_f32_16x16x32_bf16 v[88:91], v[124:127], a[200:203], v[88:91]
    ds_read_b128 v[116:119], v14 offset:61440
    v_and_b32 v55, 0xffff0000, v65
    v_mfma_f32_16x16x32_bf16 v[88:91], v[120:123], a[192:195], v[88:91]
    v_lshlrev_b32 v54, 16, v65
    s_waitcnt lgkmcnt(2)
    v_mfma_f32_16x16x32_bf16 v[96:99], v[104:107], a[192:195], v[96:99]
    v_mfma_f32_16x16x32_bf16 v[96:99], v[108:111], a[200:203], v[96:99]
    s_waitcnt lgkmcnt(0)
    v_mfma_f32_16x16x32_bf16 v[96:99], v[112:115], a[208:211], v[96:99]
    ds_read_b128 v[120:123], v14 offset:50176
    v_add_f32 v92, v92, v44
    v_add_f32 v93, v93, v45
    v_mfma_f32_16x16x32_bf16 v[96:99], v[116:119], a[216:219], v[96:99]
    ds_read_b128 v[124:127], v14 offset:54272
    v_add_f32 v94, v94, v46
    v_mfma_f32_16x16x32_bf16 v[100:103], v[116:119], a[220:223], v[100:103]
    ds_read_b128 v[128:131], v14 offset:58368
    v_add_f32 v95, v95, v47
    v_add_f32 v88, v88, v40
    v_mfma_f32_16x16x32_bf16 v[100:103], v[112:115], a[212:215], v[100:103]
    ds_read_b128 v[132:135], v14 offset:62464
    v_add_f32 v89, v89, v41
    v_mfma_f32_16x16x32_bf16 v[100:103], v[108:111], a[204:207], v[100:103]
    v_add_f32 v90, v90, v42
    v_add_f32 v91, v91, v43
    v_mfma_f32_16x16x32_bf16 v[100:103], v[104:107], a[196:199], v[100:103]
    s_waitcnt lgkmcnt(2)
    v_mfma_f32_16x16x32_bf16 v[92:95], v[120:123], a[228:231], v[92:95]
    v_mfma_f32_16x16x32_bf16 v[92:95], v[124:127], a[236:239], v[92:95]
    s_waitcnt lgkmcnt(0)
    v_mfma_f32_16x16x32_bf16 v[92:95], v[128:131], a[244:247], v[92:95]
    ds_read_b128 v[104:107], v14 offset:51200
    v_add_f32 v96, v96, v48
    v_add_f32 v97, v97, v49
    v_mfma_f32_16x16x32_bf16 v[92:95], v[132:135], a[252:255], v[92:95]
    ds_read_b128 v[108:111], v14 offset:55296
    v_add_f32 v98, v98, v50
    v_mfma_f32_16x16x32_bf16 v[88:91], v[132:135], a[248:251], v[88:91]
    ds_read_b128 v[112:115], v14 offset:59392
    v_add_f32 v99, v99, v51
    v_add_f32 v100, v100, v52
    v_mfma_f32_16x16x32_bf16 v[88:91], v[128:131], a[240:243], v[88:91]
    ds_read_b128 v[116:119], v14 offset:63488
    v_add_f32 v101, v101, v53
    v_mfma_f32_16x16x32_bf16 v[88:91], v[124:127], a[232:235], v[88:91]
    v_add_f32 v102, v102, v54
    v_add_f32 v103, v103, v55
    v_mfma_f32_16x16x32_bf16 v[88:91], v[120:123], a[224:227], v[88:91]
    s_waitcnt lgkmcnt(2)
    v_mfma_f32_16x16x32_bf16 v[96:99], v[104:107], a[224:227], v[96:99]
    v_mfma_f32_16x16x32_bf16 v[96:99], v[108:111], a[232:235], v[96:99]
    s_waitcnt lgkmcnt(0)
    v_mfma_f32_16x16x32_bf16 v[96:99], v[112:115], a[240:243], v[96:99]
    ds_read_b128 v[120:123], v14 offset:52224
    v_mfma_f32_16x16x32_bf16 v[96:99], v[116:119], a[248:251], v[96:99]
    ds_read_b128 v[124:127], v14 offset:56320
    v_mfma_f32_16x16x32_bf16 v[100:103], v[116:119], a[252:255], v[100:103]
    buffer_store_dwordx2 v[142:143], v253, s[64:67], 0 offen sc1
    ds_read_b128 v[128:131], v14 offset:60416
    v_mfma_f32_16x16x32_bf16 v[100:103], v[112:115], a[244:247], v[100:103]
    ds_read_b128 v[132:135], v14 offset:64512
    v_mfma_f32_16x16x32_bf16 v[100:103], v[108:111], a[236:239], v[100:103]
    v_mfma_f32_16x16x32_bf16 v[100:103], v[104:107], a[228:231], v[100:103]
    s_waitcnt lgkmcnt(2)
    v_mfma_f32_16x16x32_bf16 v[92:95], v[120:123], v[224:227], v[92:95]
    v_mfma_f32_16x16x32_bf16 v[92:95], v[124:127], v[232:235], v[92:95]
    s_waitcnt lgkmcnt(0)
    v_mfma_f32_16x16x32_bf16 v[92:95], v[128:131], v[240:243], v[92:95]
    s_waitcnt vmcnt(4)
    s_barrier
    v_mfma_f32_16x16x32_bf16 v[92:95], v[132:135], v[248:251], v[92:95]
    ds_read_b128 v[104:107], v14 offset:0
    v_mfma_f32_16x16x32_bf16 v[88:91], v[132:135], v[244:247], v[88:91]
    ds_read_b128 v[108:111], v14 offset:4096
    v_mfma_f32_16x16x32_bf16 v[88:91], v[128:131], v[236:239], v[88:91]
    ds_read_b128 v[112:115], v14 offset:8192
    v_mfma_f32_16x16x32_bf16 v[88:91], v[124:127], v[228:231], v[88:91]
    ds_read_b128 v[116:119], v14 offset:12288
    v_mfma_f32_16x16x32_bf16 v[88:91], v[120:123], v[220:223], v[88:91]
    s_waitcnt lgkmcnt(2)
    v_mfma_f32_16x16x32_bf16 v[96:99], v[104:107], v[220:223], v[96:99]
    v_mfma_f32_16x16x32_bf16 v[96:99], v[108:111], v[228:231], v[96:99]
    s_waitcnt lgkmcnt(0)
    v_mfma_f32_16x16x32_bf16 v[96:99], v[112:115], v[236:239], v[96:99]
    v_mfma_f32_16x16x32_bf16 v[96:99], v[116:119], v[244:247], v[96:99]
    v_mfma_f32_16x16x32_bf16 v[100:103], v[116:119], v[248:251], v[100:103]
    v_mfma_f32_16x16x32_bf16 v[100:103], v[112:115], v[240:243], v[100:103]
    v_mfma_f32_16x16x32_bf16 v[100:103], v[108:111], v[232:235], v[100:103]
    v_mfma_f32_16x16x32_bf16 v[100:103], v[104:107], v[224:227], v[100:103]
    s_waitcnt vmcnt(1)
    v_bitop3_b32 v75, v75, v79, s68 bitop3:0x7e
    v_bitop3_b32 v75, v75, v83, s68 bitop3:0xf6
    v_cmp_ne_u32 vcc, 0, v75
    s_cbranch_vccnz L_xs_z
L_xo_z:
    v_and_b32 v41, 0xffff0000, v72
    v_lshlrev_b32 v40, 16, v72
    v_and_b32 v43, 0xffff0000, v73
    v_lshlrev_b32 v42, 16, v73
    v_and_b32 v45, 0xffff0000, v74
    v_lshlrev_b32 v44, 16, v74
    v_and_b32 v47, 0xffff0000, v76
    v_lshlrev_b32 v46, 16, v76
    v_and_b32 v49, 0xffff0000, v77
    v_lshlrev_b32 v48, 16, v77
    v_and_b32 v51, 0xffff0000, v78
    v_lshlrev_b32 v50, 16, v78
    v_and_b32 v53, 0xffff0000, v80
    v_lshlrev_b32 v52, 16, v80
    v_and_b32 v55, 0xffff0000, v81
    v_lshlrev_b32 v54, 16, v81
    v_pk_add_f32 v[88:89], v[88:89], v[40:41]
    v_pk_add_f32 v[90:91], v[90:91], v[42:43]
    v_pk_add_f32 v[96:97], v[96:97], v[48:49]
    v_pk_add_f32 v[98:99], v[98:99], v[50:51]
    v_pk_mul_f32 v[56:57], v[88:89], s[38:39] op_sel_hi:[1,0]
    v_pk_mul_f32 v[58:59], v[90:91], s[38:39] op_sel_hi:[1,0]
    v_pk_mul_f32 v[64:65], v[96:97], s[38:39] op_sel_hi:[1,0]
    v_pk_mul_f32 v[66:67], v[98:99], s[38:39] op_sel_hi:[1,0]
    v_exp_f32 v56, v56
    v_exp_f32 v57, v57
    v_exp_f32 v58, v58
    v_exp_f32 v59, v59
    v_exp_f32 v64, v64
    v_exp_f32 v65, v65
    v_exp_f32 v66, v66
    v_exp_f32 v67, v67
    v_pk_mul_f32 v[164:165], v[164:165], v[88:89]
    v_pk_mul_f32 v[166:167], v[166:167], v[90:91]
    v_pk_mul_f32 v[172:173], v[172:173], v[96:97]
    v_pk_mul_f32 v[174:175], v[174:175], v[98:99]
    v_pk_add_f32 v[56:57], v[56:57], 1.0 op_sel_hi:[1,0]
    v_pk_add_f32 v[58:59], v[58:59], 1.0 op_sel_hi:[1,0]
    v_pk_add_f32 v[64:65], v[64:65], 1.0 op_sel_hi:[1,0]
    v_pk_add_f32 v[66:67], v[66:67], 1.0 op_sel_hi:[1,0]
    v_rcp_f32 v56, v56
    v_rcp_f32 v57, v57
    v_rcp_f32 v58, v58
    v_rcp_f32 v59, v59
    v_rcp_f32 v64, v64
    v_rcp_f32 v65, v65
    v_rcp_f32 v66, v66
    v_rcp_f32 v67, v67
    v_pk_fma_f32 v[164:165], v[164:165], v[56:57], v[144:145]
    v_pk_fma_f32 v[166:167], v[166:167], v[58:59], v[146:147]
    v_pk_fma_f32 v[172:173], v[172:173], v[64:65], v[152:153]
    v_pk_fma_f32 v[174:175], v[174:175], v[66:67], v[154:155]
    v_cvt_pk_bf16_f32 v88, v164, v165
    v_cvt_pk_bf16_f32 v90, v172, v173
    v_cvt_pk_bf16_f32 v89, v166, v167
    v_cvt_pk_bf16_f32 v91, v174, v175
    v_permlane16_swap_b32 v88, v90
    s_nop 0
    v_permlane16_swap_b32 v89, v91
    buffer_store_dwordx4 v[88:91], v252, s[64:67], 0 offen sc1
    v_pk_add_f32 v[92:93], v[92:93], v[44:45]
    v_pk_add_f32 v[94:95], v[94:95], v[46:47]
    v_pk_add_f32 v[100:101], v[100:101], v[52:53]
    v_pk_add_f32 v[102:103], v[102:103], v[54:55]
    v_pk_mul_f32 v[60:61], v[92:93], s[38:39] op_sel_hi:[1,0]
    v_pk_mul_f32 v[62:63], v[94:95], s[38:39] op_sel_hi:[1,0]
    v_pk_mul_f32 v[68:69], v[100:101], s[38:39] op_sel_hi:[1,0]
    v_pk_mul_f32 v[70:71], v[102:103], s[38:39] op_sel_hi:[1,0]
    v_exp_f32 v60, v60
    v_exp_f32 v61, v61
    v_exp_f32 v62, v62
    v_exp_f32 v63, v63
    v_exp_f32 v68, v68
    v_exp_f32 v69, v69
    v_exp_f32 v70, v70
    v_exp_f32 v71, v71
    v_pk_mul_f32 v[168:169], v[168:169], v[92:93]
    v_pk_mul_f32 v[170:171], v[170:171], v[94:95]
    v_pk_mul_f32 v[176:177], v[176:177], v[100:101]
    v_pk_mul_f32 v[178:179], v[178:179], v[102:103]
    v_pk_add_f32 v[60:61], v[60:61], 1.0 op_sel_hi:[1,0]
    v_pk_add_f32 v[62:63], v[62:63], 1.0 op_sel_hi:[1,0]
    v_pk_add_f32 v[68:69], v[68:69], 1.0 op_sel_hi:[1,0]
    v_pk_add_f32 v[70:71], v[70:71], 1.0 op_sel_hi:[1,0]
    v_rcp_f32 v60, v60
    v_rcp_f32 v61, v61
    v_rcp_f32 v62, v62
    v_rcp_f32 v63, v63
    v_rcp_f32 v68, v68
    v_rcp_f32 v69, v69
    v_rcp_f32 v70, v70
    v_rcp_f32 v71, v71
    v_pk_fma_f32 v[168:169], v[168:169], v[60:61], v[148:149]
    v_pk_fma_f32 v[170:171], v[170:171], v[62:63], v[150:151]
    v_pk_fma_f32 v[176:177], v[176:177], v[68:69], v[156:157]
    v_pk_fma_f32 v[178:179], v[178:179], v[70:71], v[158:159]
    v_cvt_pk_bf16_f32 v92, v168, v169
    v_cvt_pk_bf16_f32 v94, v176, v177
    v_cvt_pk_bf16_f32 v93, v170, v171
    v_cvt_pk_bf16_f32 v95, v178, v179
    v_permlane16_swap_b32 v92, v94
    s_nop 0
    v_permlane16_swap_b32 v93, v95
    buffer_store_dwordx4 v[92:95], v252, s[64:67], s40 offen sc1
    s_endpgm
L_segE:
.p2align 12
L_aux:
    s_bfe_u32 s101, s2, 0x20003
    s_mul_i32 s101, s101, 3
    s_mul_i32 s84, s101, 305844
    s_lshr_b32 s84, s84, 18
    s_add_u32 s84, s84, 0
    s_add_u32 s85, s84, 1
    s_cmp_eq_u32 s85, 14
    s_cselect_b32 s85, 0, s85
    s_add_u32 s86, s85, 1
    s_cmp_eq_u32 s86, 14
    s_cselect_b32 s86, 0, s86
    s_add_u32 s87, s86, 1
    s_cmp_eq_u32 s87, 14
    s_cselect_b32 s87, 0, s87
    s_add_u32 s88, s87, 1
    s_cmp_eq_u32 s88, 14
    s_cselect_b32 s88, 0, s88
    s_add_u32 s89, s88, 1
    s_cmp_eq_u32 s89, 14
    s_cselect_b32 s89, 0, s89
    s_add_u32 s90, s89, 1
    s_cmp_eq_u32 s90, 14
    s_cselect_b32 s90, 0, s90
    s_add_u32 s91, s90, 1
    s_cmp_eq_u32 s91, 14
    s_cselect_b32 s91, 0, s91
    s_add_u32 s92, s91, 1
    s_cmp_eq_u32 s92, 14
    s_cselect_b32 s92, 0, s92
    s_add_u32 s93, s92, 1
    s_cmp_eq_u32 s93, 14
    s_cselect_b32 s93, 0, s93
    s_add_u32 s94, s93, 1
    s_cmp_eq_u32 s94, 14
    s_cselect_b32 s94, 0, s94
    s_add_u32 s95, s94, 1
    s_cmp_eq_u32 s95, 14
    s_cselect_b32 s95, 0, s95
    s_add_u32 s96, s95, 1
    s_cmp_eq_u32 s96, 14
    s_cselect_b32 s96, 0, s96
    s_add_u32 s97, s96, 1
    s_cmp_eq_u32 s97, 14
    s_cselect_b32 s97, 0, s97
    s_mul_i32 s98, s101, 87384
    s_lshr_b32 s98, s98, 18
    s_add_u32 s98, s98, 14
    s_add_u32 s99, s98, 1
    s_cmp_eq_u32 s99, 18
    s_cselect_b32 s99, 14, s99
    s_add_u32 s100, s99, 1
    s_cmp_eq_u32 s100, 18
    s_cselect_b32 s100, 14, s100
    s_add_u32 s101, s100, 1
    s_cmp_eq_u32 s101, 18
    s_cselect_b32 s101, 14, s101
    s_lshl2_add_u32 s7, s5, s6
    s_add_u32 s7, s7, 188
    s_add_u32 s8, s5, 248
    s_cmp_eq_u32 s6, 27
    s_cselect_b32 s75, s8, s7
    s_mov_b32 s48, s24
    s_and_b32 s49, s25, 0xffff
    s_mov_b32 s50, 2359296
    s_mov_b32 s51, 0x20000
    v_lshlrev_b32 v240, 4, v2
    s_mul_i32 s74, s3, 16640
    s_add_u32 s74, s74, 73728
    s_sub_u32 s69, s75, 216
    s_lshl_b32 s70, s69, 4
    s_add_u32 s70, s70, s3
    s_lshl_b32 s12, s70, 12
    s_lshl_b32 s70, s70, 1
    s_mov_b32 s9, 144896
    s_mov_b32 s11, 8192
    v_mul_u32_u24 v48, 1216, v3
    v_mad_u32_u24 v48, v4, 12, v48
    v_add_u32 v48, s9, v48
    v_mov_b32 v47, 0x40000000
    v_lshlrev_b32 v3, 3, v3
    s_lshl_b32 s5, s68, 6
    s_add_u32 s5, s5, 12386304
    v_cmp_eq_u32 vcc, 0, v4
    s_nop 1
    v_cndmask_b32 v49, v47, v3, vcc
    v_lshrrev_b32 v5, 4, v0
    v_and_b32 v4, 3, v2
    v_lshlrev_b32 v4, 3, v4
    v_lshl_add_u32 v5, v5, 5, v4
    v_bfe_u32 v6, v2, 2, 2
    v_mul_u32_u24 v4, 1216, v6
    v_mul_u32_u24 v6, 1152, v6
    v_add3_u32 v50, v4, v5, s9
    v_add3_u32 v51, v6, v5, s11
    s_mul_i32 s4, s3, 2176
    v_add_u32 v55, s4, v51
    v_lshlrev_b32 v52, 4, v0
    s_add_u32 s7, s15, 4096
    s_add_u32 s8, s15, 8192
    s_cmp_eq_u32 s3, 0
    s_cselect_b32 s8, s8, 0x40000000
    v_add_u32 v53, 2359296, v52
    v_mov_b32 v54, 0
    v_add_u32 v4, 0, v52
    v_lshrrev_b32 v5, 7, v4
    v_mul_u32_u24 v6, 9363, v5
    v_lshrrev_b32 v6, 16, v6
    v_mad_i32_i24 v5, v6, -7, v5
    v_cmp_lt_u32 vcc, 2, v5
    s_nop 1
    v_addc_co_u32 v6, vcc, 0, v6, vcc
    v_lshl_add_u32 v93, v6, 7, v4
    v_add_u32 v4, 4096, v52
    v_lshrrev_b32 v5, 7, v4
    v_mul_u32_u24 v6, 9363, v5
    v_lshrrev_b32 v6, 16, v6
    v_mad_i32_i24 v5, v6, -7, v5
    v_cmp_lt_u32 vcc, 2, v5
    s_nop 1
    v_addc_co_u32 v6, vcc, 0, v6, vcc
    v_lshl_add_u32 v94, v6, 7, v4
    v_add_u32 v4, 8192, v52
    v_lshrrev_b32 v5, 7, v4
    v_mul_u32_u24 v6, 9363, v5
    v_lshrrev_b32 v6, 16, v6
    v_mad_i32_i24 v5, v6, -7, v5
    v_cmp_lt_u32 vcc, 2, v5
    s_nop 1
    v_addc_co_u32 v6, vcc, 0, v6, vcc
    v_lshl_add_u32 v95, v6, 7, v4
    s_mul_i32 s10, s68, 11264
    s_add_u32 s10, s10, 36585472
    s_cmp_eq_u32 s3, 0
    s_cselect_b32 s83, s10, 0x40000000
    s_add_u32 s7, s10, 2883584
    s_add_u32 s8, s83, 2883584
    s_mul_i32 s4, s3, 1028
    s_sub_u32 s4, 8204, s4
    v_add_u32 v90, s4, v53
    s_bfe_u32 s6, s68, 0x20001
    s_lshl_b32 s6, s6, 6
    s_lshr_b32 s9, s68, 3
    s_lshl1_add_u32 s6, s9, s6
    s_and_b32 s9, s68, 1
    s_add_u32 s6, s6, s9
    s_lshl_b32 s4, s6, 2
    s_add_u32 s4, s4, 12533760
    v_lshl_add_u32 v1, v0, 10, s4
    s_lshl_b32 s4, s68, 2
    s_add_u32 s4, s4, 12599296
    v_lshl_add_u32 v46, v0, 10, s4
    v_cmp_gt_u32 vcc, 8, v0
    s_nop 1
    v_cndmask_b32 v1, v47, v1, vcc
    v_cmp_gt_u32 vcc, 4, v0
    s_nop 1
    v_cndmask_b32 v46, v47, v46, vcc
    s_waitcnt vmcnt(9)
    v_and_b32 v21, 0xffff0000, v8
    v_lshlrev_b32 v20, 16, v8
    v_and_b32 v23, 0xffff0000, v9
    v_lshlrev_b32 v22, 16, v9
    v_and_b32 v25, 0xffff0000, v10
    v_lshlrev_b32 v24, 16, v10
    v_and_b32 v27, 0xffff0000, v12
    v_lshlrev_b32 v26, 16, v12
    v_and_b32 v29, 0xffff0000, v13
    v_lshlrev_b32 v28, 16, v13
    v_and_b32 v31, 0xffff0000, v14
    v_lshlrev_b32 v30, 16, v14
    v_and_b32 v33, 0xffff0000, v16
    v_lshlrev_b32 v32, 16, v16
    v_and_b32 v35, 0xffff0000, v17
    v_lshlrev_b32 v34, 16, v17
    v_and_b32 v37, 0xffff0000, v18
    v_lshlrev_b32 v36, 16, v18
    v_pk_add_f32 v[38:39], v[20:21], v[22:23]
    v_pk_add_f32 v[40:41], v[24:25], v[26:27]
    v_pk_add_f32 v[42:43], v[28:29], v[30:31]
    v_pk_add_f32 v[44:45], v[32:33], v[34:35]
    v_pk_add_f32 v[38:39], v[38:39], v[40:41]
    v_pk_add_f32 v[42:43], v[42:43], v[44:45]
    v_pk_add_f32 v[38:39], v[38:39], v[36:37]
    v_pk_add_f32 v[38:39], v[38:39], v[42:43]
    v_add_f32 v56, v38, v39
    s_nop 1
    v_add_f32_dpp v56, v56, v56 row_ror:8 row_mask:0xf bank_mask:0xf
    s_nop 1
    v_add_f32_dpp v56, v56, v56 row_ror:4 row_mask:0xf bank_mask:0xf
    s_nop 1
    v_add_f32_dpp v56, v56, v56 row_ror:2 row_mask:0xf bank_mask:0xf
    s_nop 1
    v_add_f32_dpp v56, v56, v56 row_ror:1 row_mask:0xf bank_mask:0xf
    v_mov_b32 v57, v56
    s_nop 1
    v_permlane16_swap_b32 v56, v57
    v_add_f32 v56, v56, v57
    v_mul_f32 v56, 0x3ae38e39, v56
    v_pk_add_f32 v[20:21], v[20:21], v[56:57] op_sel_hi:[1,0] neg_lo:[0,1] neg_hi:[0,1]
    v_pk_add_f32 v[22:23], v[22:23], v[56:57] op_sel_hi:[1,0] neg_lo:[0,1] neg_hi:[0,1]
    v_pk_add_f32 v[24:25], v[24:25], v[56:57] op_sel_hi:[1,0] neg_lo:[0,1] neg_hi:[0,1]
    v_pk_add_f32 v[26:27], v[26:27], v[56:57] op_sel_hi:[1,0] neg_lo:[0,1] neg_hi:[0,1]
    v_pk_add_f32 v[28:29], v[28:29], v[56:57] op_sel_hi:[1,0] neg_lo:[0,1] neg_hi:[0,1]
    v_pk_add_f32 v[30:31], v[30:31], v[56:57] op_sel_hi:[1,0] neg_lo:[0,1] neg_hi:[0,1]
    v_pk_add_f32 v[32:33], v[32:33], v[56:57] op_sel_hi:[1,0] neg_lo:[0,1] neg_hi:[0,1]
    v_pk_add_f32 v[34:35], v[34:35], v[56:57] op_sel_hi:[1,0] neg_lo:[0,1] neg_hi:[0,1]
    v_pk_add_f32 v[36:37], v[36:37], v[56:57] op_sel_hi:[1,0] neg_lo:[0,1] neg_hi:[0,1]
    v_pk_mul_f32 v[38:39], v[20:21], v[20:21]
    v_pk_mul_f32 v[40:41], v[22:23], v[22:23]
    v_pk_fma_f32 v[38:39], v[24:25], v[24:25], v[38:39]
    v_pk_fma_f32 v[40:41], v[26:27], v[26:27], v[40:41]
    v_pk_fma_f32 v[38:39], v[28:29], v[28:29], v[38:39]
    v_pk_fma_f32 v[40:41], v[30:31], v[30:31], v[40:41]
    v_pk_fma_f32 v[38:39], v[32:33], v[32:33], v[38:39]
    v_pk_fma_f32 v[40:41], v[34:35], v[34:35], v[40:41]
    v_pk_fma_f32 v[38:39], v[36:37], v[36:37], v[38:39]
    v_pk_add_f32 v[38:39], v[38:39], v[40:41]
    v_add_f32 v18, v38, v39
    s_nop 1
    v_add_f32_dpp v18, v18, v18 row_ror:8 row_mask:0xf bank_mask:0xf
    s_nop 1
    v_add_f32_dpp v18, v18, v18 row_ror:4 row_mask:0xf bank_mask:0xf
    s_nop 1
    v_add_f32_dpp v18, v18, v18 row_ror:2 row_mask:0xf bank_mask:0xf
    s_nop 1
    v_add_f32_dpp v18, v18, v18 row_ror:1 row_mask:0xf bank_mask:0xf
    v_mov_b32 v19, v18
    s_nop 1
    v_permlane16_swap_b32 v18, v19
    v_add_f32 v18, v18, v19
    v_mul_f32 v18, 0x3ae38e39, v18
    v_cvt_pk_bf16_f32 v38, v56, v18
    v_lshlrev_b32 v106, 16, v38
    v_and_b32 v38, 0xffff0000, v38
    v_add_f32 v38, 0x3727c5ac, v38
    v_sub_f32 v56, v56, v106
    v_cvt_pk_bf16_f32 v38, v38, v38
    v_lshlrev_b32 v38, 16, v38
    v_sqrt_f32 v38, v38
    s_nop 0
    v_cvt_pk_bf16_f32 v38, v38, v38
    v_lshlrev_b32 v38, 16, v38
    v_rcp_f32 v107, v38
    s_nop 0
    v_mul_f32 v56, v56, v107
    v_mul_f32 v18, v18, v107
    v_mul_f32 v18, v18, v107
    v_cvt_pk_bf16_f32 v38, v56, v18
    v_lshlrev_b32 v39, 16, v38
    v_and_b32 v38, 0xffff0000, v38
    v_add_f32 v38, 0x3727c5ac, v38
    v_sub_f32 v56, v56, v39
    v_cvt_pk_bf16_f32 v38, v38, v38
    v_lshlrev_b32 v38, 16, v38
    v_sqrt_f32 v38, v38
    s_nop 0
    v_cvt_pk_bf16_f32 v38, v38, v38
    v_lshlrev_b32 v38, 16, v38
    v_rcp_f32 v38, v38
    s_nop 0
    v_mul_f32 v18, v107, v38
    v_mul_f32 v56, v56, v38
    v_pk_fma_f32 v[20:21], v[20:21], v[18:19], v[56:57] op_sel_hi:[1,0,0]
    v_pk_fma_f32 v[22:23], v[22:23], v[18:19], v[56:57] op_sel_hi:[1,0,0]
    v_pk_fma_f32 v[24:25], v[24:25], v[18:19], v[56:57] op_sel_hi:[1,0,0]
    v_pk_fma_f32 v[26:27], v[26:27], v[18:19], v[56:57] op_sel_hi:[1,0,0]
    v_pk_fma_f32 v[28:29], v[28:29], v[18:19], v[56:57] op_sel_hi:[1,0,0]
    v_pk_fma_f32 v[30:31], v[30:31], v[18:19], v[56:57] op_sel_hi:[1,0,0]
    v_pk_fma_f32 v[32:33], v[32:33], v[18:19], v[56:57] op_sel_hi:[1,0,0]
    v_pk_fma_f32 v[34:35], v[34:35], v[18:19], v[56:57] op_sel_hi:[1,0,0]
    v_pk_fma_f32 v[36:37], v[36:37], v[18:19], v[56:57] op_sel_hi:[1,0,0]
    v_cvt_pk_bf16_f32 v8, v20, v21
    v_cvt_pk_bf16_f32 v9, v22, v23
    v_cvt_pk_bf16_f32 v10, v24, v25
    v_cvt_pk_bf16_f32 v11, v26, v27
    v_cvt_pk_bf16_f32 v12, v28, v29
    v_cvt_pk_bf16_f32 v13, v30, v31
    v_cvt_pk_bf16_f32 v14, v32, v33
    v_cvt_pk_bf16_f32 v15, v34, v35
    v_cvt_pk_bf16_f32 v16, v36, v37
    ds_write_b32 v48, v8 offset:0
    ds_write_b32 v48, v9 offset:4
    ds_write_b32 v48, v10 offset:8
    ds_write_b32 v48, v11 offset:384
    ds_write_b32 v48, v12 offset:388
    ds_write_b32 v48, v13 offset:392
    ds_write_b32 v48, v14 offset:768
    ds_write_b32 v48, v15 offset:772
    ds_write_b32 v48, v16 offset:776
    buffer_store_dwordx2 v[106:107], v49, s[44:47], s5 offen sc1
    s_waitcnt lgkmcnt(0)
    s_barrier
    ds_read_b64_tr_b16 v[20:21], v50 offset:0
    ds_read_b64_tr_b16 v[22:23], v50 offset:4864
    ds_read_b64_tr_b16 v[24:25], v50 offset:512
    ds_read_b64_tr_b16 v[26:27], v50 offset:5376
    ds_read_b64_tr_b16 v[28:29], v50 offset:1024
    ds_read_b64_tr_b16 v[30:31], v50 offset:5888
    s_waitcnt lgkmcnt(4)
    buffer_store_dwordx4 v[20:23], v93, s[44:47], s10 offen sc1
    s_waitcnt lgkmcnt(2)
    buffer_store_dwordx4 v[24:27], v94, s[44:47], s10 offen sc1
    s_waitcnt lgkmcnt(0)
    buffer_store_dwordx4 v[28:31], v95, s[44:47], s83 offen sc1
    buffer_load_dword v45, v54, s[64:67], 0 offen sc1
    s_waitcnt vmcnt(5)
    s_barrier
    ds_read_b64_tr_b16 v[60:61], v51 offset:0
    ds_read_b64_tr_b16 v[62:63], v51 offset:4608
    ds_read_b64_tr_b16 v[64:65], v51 offset:9216
    ds_read_b64_tr_b16 v[66:67], v51 offset:12672
    ds_read_b64_tr_b16 v[68:69], v51 offset:17280
    ds_read_b64_tr_b16 v[70:71], v51 offset:512
    ds_read_b64_tr_b16 v[72:73], v51 offset:5120
    ds_read_b64_tr_b16 v[74:75], v51 offset:9728
    ds_read_b64_tr_b16 v[76:77], v51 offset:13184
    ds_read_b64_tr_b16 v[78:79], v51 offset:17792
    v_alignbit_b32 v114, v99, v99, 16
    v_alignbit_b32 v115, v98, v98, 16
    s_waitcnt lgkmcnt(5)
    v_alignbit_b32 v108, v61, v60, 16
    v_alignbit_b32 v109, v62, v61, 16
    v_alignbit_b32 v110, v63, v62, 16
    v_alignbit_b32 v111, v64, v63, 16
    v_alignbit_b32 v112, v65, v64, 16
    v_dot2_f32_bf16 v116, v60, v114, 0
    ds_read_b64_tr_b16 v[80:81], v51 offset:1024
    v_dot2_f32_bf16 v117, v108, v114, 0
    v_dot2_f32_bf16 v118, v61, v114, 0
    v_dot2_f32_bf16 v119, v109, v114, 0
    v_dot2_f32_bf16 v120, v62, v114, 0
    ds_read_b64_tr_b16 v[82:83], v51 offset:5632
    v_dot2_f32_bf16 v121, v110, v114, 0
    v_dot2_f32_bf16 v122, v63, v114, 0
    v_dot2_f32_bf16 v123, v111, v114, 0
    v_dot2_f32_bf16 v116, v61, v115, v116
    v_dot2_f32_bf16 v117, v109, v115, v117
    ds_read_b64_tr_b16 v[84:85], v51 offset:10240
    v_dot2_f32_bf16 v118, v62, v115, v118
    v_dot2_f32_bf16 v119, v110, v115, v119
    v_dot2_f32_bf16 v120, v63, v115, v120
    v_dot2_f32_bf16 v121, v111, v115, v121
    v_dot2_f32_bf16 v122, v64, v115, v122
    ds_read_b64_tr_b16 v[86:87], v51 offset:13696
    v_dot2_f32_bf16 v123, v112, v115, v123
    v_and_b32 v133, 0xffff0000, v66
    v_lshlrev_b32 v132, 16, v66
    v_and_b32 v135, 0xffff0000, v67
    v_lshlrev_b32 v134, 16, v67
    ds_read_b64_tr_b16 v[88:89], v51 offset:18304
    v_and_b32 v137, 0xffff0000, v68
    v_lshlrev_b32 v136, 16, v68
    v_and_b32 v139, 0xffff0000, v69
    v_lshlrev_b32 v138, 16, v69
    v_pk_mul_f32 v[116:117], v[116:117], v[132:133]
    v_pk_mul_f32 v[118:119], v[118:119], v[134:135]
    v_pk_mul_f32 v[120:121], v[120:121], v[136:137]
    v_pk_mul_f32 v[122:123], v[122:123], v[138:139]
    v_cvt_pk_bf16_f32 v160, v123, v122
    v_cvt_pk_bf16_f32 v161, v121, v120
    v_cvt_pk_bf16_f32 v162, v119, v118
    v_cvt_pk_bf16_f32 v163, v117, v116
    buffer_store_dwordx4 v[160:163], v93, s[44:47], s7 offen sc1
    v_alignbit_b32 v114, v101, v101, 16
    v_alignbit_b32 v115, v100, v100, 16
    s_waitcnt lgkmcnt(5)
    v_alignbit_b32 v108, v71, v70, 16
    v_alignbit_b32 v109, v72, v71, 16
    v_alignbit_b32 v110, v73, v72, 16
    v_alignbit_b32 v111, v74, v73, 16
    v_alignbit_b32 v112, v75, v74, 16
    v_dot2_f32_bf16 v124, v70, v114, 0
    v_dot2_f32_bf16 v125, v108, v114, 0
    v_dot2_f32_bf16 v126, v71, v114, 0
    v_dot2_f32_bf16 v127, v109, v114, 0
    v_dot2_f32_bf16 v128, v72, v114, 0
    v_dot2_f32_bf16 v129, v110, v114, 0
    v_dot2_f32_bf16 v130, v73, v114, 0
    v_dot2_f32_bf16 v131, v111, v114, 0
    v_dot2_f32_bf16 v124, v71, v115, v124
    v_dot2_f32_bf16 v125, v109, v115, v125
    v_dot2_f32_bf16 v126, v72, v115, v126
    v_dot2_f32_bf16 v127, v110, v115, v127
    v_dot2_f32_bf16 v128, v73, v115, v128
    v_dot2_f32_bf16 v129, v111, v115, v129
    v_dot2_f32_bf16 v130, v74, v115, v130
    v_dot2_f32_bf16 v131, v112, v115, v131
    v_and_b32 v133, 0xffff0000, v76
    v_lshlrev_b32 v132, 16, v76
    v_and_b32 v135, 0xffff0000, v77
    v_lshlrev_b32 v134, 16, v77
    v_and_b32 v137, 0xffff0000, v78
    v_lshlrev_b32 v136, 16, v78
    v_and_b32 v139, 0xffff0000, v79
    v_lshlrev_b32 v138, 16, v79
    v_pk_mul_f32 v[124:125], v[124:125], v[132:133]
    v_pk_mul_f32 v[126:127], v[126:127], v[134:135]
    v_pk_mul_f32 v[128:129], v[128:129], v[136:137]
    v_pk_mul_f32 v[130:131], v[130:131], v[138:139]
    v_cvt_pk_bf16_f32 v164, v131, v130
    v_cvt_pk_bf16_f32 v165, v129, v128
    v_cvt_pk_bf16_f32 v166, v127, v126
    v_cvt_pk_bf16_f32 v167, v125, v124
    buffer_store_dwordx4 v[164:167], v94, s[44:47], s7 offen sc1
    v_alignbit_b32 v114, v103, v103, 16
    v_alignbit_b32 v115, v102, v102, 16
    s_waitcnt lgkmcnt(0)
    v_alignbit_b32 v108, v81, v80, 16
    v_alignbit_b32 v109, v82, v81, 16
    v_alignbit_b32 v110, v83, v82, 16
    v_alignbit_b32 v111, v84, v83, 16
    v_alignbit_b32 v112, v85, v84, 16
    v_dot2_f32_bf16 v116, v80, v114, 0
    v_dot2_f32_bf16 v117, v108, v114, 0
    v_dot2_f32_bf16 v118, v81, v114, 0
    v_dot2_f32_bf16 v119, v109, v114, 0
    v_dot2_f32_bf16 v120, v82, v114, 0
    v_dot2_f32_bf16 v121, v110, v114, 0
    v_dot2_f32_bf16 v122, v83, v114, 0
    v_dot2_f32_bf16 v123, v111, v114, 0
    v_dot2_f32_bf16 v116, v81, v115, v116
    v_dot2_f32_bf16 v117, v109, v115, v117
    v_dot2_f32_bf16 v118, v82, v115, v118
    v_dot2_f32_bf16 v119, v110, v115, v119
    v_dot2_f32_bf16 v120, v83, v115, v120
    v_dot2_f32_bf16 v121, v111, v115, v121
    v_dot2_f32_bf16 v122, v84, v115, v122
    v_dot2_f32_bf16 v123, v112, v115, v123
    v_and_b32 v133, 0xffff0000, v86
    v_lshlrev_b32 v132, 16, v86
    v_and_b32 v135, 0xffff0000, v87
    v_lshlrev_b32 v134, 16, v87
    v_and_b32 v137, 0xffff0000, v88
    v_lshlrev_b32 v136, 16, v88
    v_and_b32 v139, 0xffff0000, v89
    v_lshlrev_b32 v138, 16, v89
    v_pk_mul_f32 v[116:117], v[116:117], v[132:133]
    v_pk_mul_f32 v[118:119], v[118:119], v[134:135]
    v_pk_mul_f32 v[120:121], v[120:121], v[136:137]
    v_pk_mul_f32 v[122:123], v[122:123], v[138:139]
    v_cvt_pk_bf16_f32 v168, v123, v122
    v_cvt_pk_bf16_f32 v169, v121, v120
    v_cvt_pk_bf16_f32 v170, v119, v118
    v_cvt_pk_bf16_f32 v171, v117, v116
    buffer_store_dwordx4 v[168:171], v95, s[44:47], s8 offen sc1
    s_add_u32 m0, s74, 32
    s_add_u32 s13, s12, 0
    buffer_load_dwordx4 v240, s[48:51], s13 offen offset:0 lds
    buffer_load_dwordx4 v240, s[48:51], s13 offen offset:1024 lds
    buffer_load_dwordx4 v240, s[48:51], s13 offen offset:2048 lds
    buffer_load_dwordx4 v240, s[48:51], s13 offen offset:3072 lds
    s_add_u32 m0, s74, 8352
    s_add_u32 s13, s12, 16384
    buffer_load_dwordx4 v240, s[48:51], s13 offen offset:0 lds
    buffer_load_dwordx4 v240, s[48:51], s13 offen offset:1024 lds
    buffer_load_dwordx4 v240, s[48:51], s13 offen offset:2048 lds
    buffer_load_dwordx4 v240, s[48:51], s13 offen offset:3072 lds
    s_mov_b64 exec, 0
    s_call_b64 s[82:83], L_wc_X
    s_mov_b64 exec, -1
    s_waitcnt vmcnt(11)
    v_readfirstlane_b32 s68, v45
    s_nop 1
    s_cmp_eq_u32 s68, 0
    s_cbranch_scc1 L_nw_X
L_ng_X:
    s_barrier
    v_mov_b32 v3, s68
    buffer_store_dword v3, v1, s[44:47], 0 offen sc1
    s_waitcnt vmcnt(9)
    s_barrier
    buffer_store_dword v3, v46, s[44:47], 0 offen sc1
L_segX:
L_pl_X_0:
    s_cbranch_execz L_pl_X_4
    s_cmp_lt_u32 s75, 252
    s_cbranch_scc0 L_idle
    s_mov_b32 s56, s26
    s_and_b32 s57, s27, 0xffff
    s_mov_b32 s58, 1152
    s_mov_b32 s59, 0x20000
    v_mov_b32 v9, 0
    buffer_load_ushort v9, v9, s[56:59], s70 offen
    s_lshr_b32 s4, s2, 1
    s_and_b32 s4, s4, 3
    s_lshl2_add_u32 s4, s4, s3
    s_lshl_b32 s4, s4, 8
    s_add_u32 s4, s4, 12599296
    v_lshl_add_u32 v28, v2, 2, s4
    v_add_u32 v241, s74, v240
    v_cmp_eq_u32 vcc, 0, v2
    v_mov_b32 v196, 4136
    s_nop 0
    v_cndmask_b32 v196, v196, 30, vcc
    v_add_u32 v242, s74, v196
    v_bfe_u32 v196, v2, 3, 2
    v_mul_u32_u24 v196, 4160, v196
    v_and_b32 v197, 7, v2
    v_lshl_add_u32 v196, v197, 2, v196
    v_add_u32 v200, s74, v196
    v_mov_b32 v196, 0
    v_mov_b32 v197, 0
    v_mov_b32 v198, 0
    v_mov_b32 v199, 0
    ds_write_b32 v200, v196
    v_lshlrev_b32 v201, 4, v0
    ds_write_b128 v201, v[196:199]
    ds_write_b128 v201, v[196:199] offset:36864
    s_waitcnt vmcnt(7)
    ds_read_b128 v[212:215], v241 offset:32
    ds_read_b32 v216, v241 offset:48
    ds_read_b128 v[218:221], v241 offset:1056
    ds_read_b32 v222, v241 offset:1072
    ds_read_b128 v[224:227], v241 offset:2080
    ds_read_b32 v228, v241 offset:2096
    ds_read_b128 v[230:233], v241 offset:3104
    ds_read_b32 v234, v241 offset:3120
    v_lshrrev_b32 v202, 3, v2
    v_and_b32 v203, 7, v2
    v_lshrrev_b32 v204, 1, v202
    v_xor_b32 v203, v203, v204
    v_mul_u32_u24 v202, 11264, v202
    v_lshl_add_u32 v15, v203, 4, v202
    v_xor_b32 v16, 64, v15
    v_and_b32 v202, 15, v2
    v_add_u32 v202, 1, v202
    v_and_b32 v203, 1, v202
    v_mul_u32_u24 v203, 4160, v203
    v_lshrrev_b32 v202, 1, v202
    v_lshl_add_u32 v203, v202, 2, v203
    v_lshrrev_b32 v204, 4, v2
    v_lshl_add_u32 v203, v204, 4, v203
    v_add_u32 v236, s74, v203
    v_add_u32 v237, 1024, v236
    v_add_u32 v238, 1024, v237
    v_add_u32 v239, 1024, v238
    s_waitcnt lgkmcnt(0)
    s_waitcnt vmcnt(0)
    v_lshlrev_b32 v9, 16, v9
    v_lshlrev_b32 v208, 16, v212
    v_add_f32 v9, v9, v208
    v_cvt_pk_bf16_f32 v9, v9, v9
    ds_write_b16 v242, v9 offset:4160
    ds_write_b16 v242, v9 offset:2
    v_alignbit_b32 v212, v213, v212, 16
    v_alignbit_b32 v213, v214, v213, 16
    v_alignbit_b32 v214, v215, v214, 16
    v_alignbit_b32 v215, v216, v215, 16
    ds_write_b128 v241, v[212:215] offset:4192
    v_alignbit_b32 v218, v219, v218, 16
    v_alignbit_b32 v219, v220, v219, 16
    v_alignbit_b32 v220, v221, v220, 16
    v_alignbit_b32 v221, v222, v221, 16
    ds_write_b128 v241, v[218:221] offset:5216
    v_alignbit_b32 v224, v225, v224, 16
    v_alignbit_b32 v225, v226, v225, 16
    v_alignbit_b32 v226, v227, v226, 16
    v_alignbit_b32 v227, v228, v227, 16
    ds_write_b128 v241, v[224:227] offset:6240
    v_alignbit_b32 v230, v231, v230, 16
    v_alignbit_b32 v231, v232, v231, 16
    v_alignbit_b32 v232, v233, v232, 16
    v_alignbit_b32 v233, v234, v233, 16
    ds_write_b128 v241, v[230:233] offset:7264
    v_and_b32 v202, 15, v2
    v_lshlrev_b32 v202, 1, v202
    v_sub_u32 v202, v202, v204
    v_add_u32 v202, 17, v202
    v_bfe_u32 v203, v202, 1, 3
    v_xor_b32 v203, s3, v203
    v_lshlrev_b32 v203, 4, v203
    v_lshl_add_u32 v244, v202, 7, v203
    v_and_b32 v202, 15, v2
    v_lshlrev_b32 v202, 1, v202
    v_sub_u32 v202, v202, v204
    v_add_u32 v202, 13, v202
    v_bfe_u32 v203, v202, 1, 3
    v_xor_b32 v203, s3, v203
    v_lshlrev_b32 v203, 4, v203
    v_lshl_add_u32 v245, v202, 7, v203
    v_and_b32 v202, 15, v2
    v_lshlrev_b32 v202, 1, v202
    v_sub_u32 v202, v202, v204
    v_add_u32 v202, 9, v202
    v_bfe_u32 v203, v202, 1, 3
    v_xor_b32 v203, s3, v203
    v_lshlrev_b32 v203, 4, v203
    v_lshl_add_u32 v246, v202, 7, v203
    v_and_b32 v202, 15, v2
    v_lshlrev_b32 v202, 1, v202
    v_sub_u32 v202, v202, v204
    v_add_u32 v202, 5, v202
    v_bfe_u32 v203, v202, 1, 3
    v_xor_b32 v203, s3, v203
    v_lshlrev_b32 v203, 4, v203
    v_lshl_add_u32 v247, v202, 7, v203
    v_and_b32 v202, 15, v2
    v_lshlrev_b32 v202, 5, v202
    v_lshl_add_u32 v8, v204, 3, v202
    s_mul_i32 s7, s3, 589824
    s_lshl_b32 s8, s69, 8
    s_add_u32 s7, s7, s8
    s_add_u32 s10, s7, 2359296
    s_lshl_b32 s9, s3, 13
    s_add_u32 s9, s9, 4096
    s_lshl1_add_u32 s4, s69, 0
    s_mul_i32 s5, s4, 9363
    s_lshr_b32 s5, s5, 16
    s_mul_i32 s7, s5, 7
    s_sub_u32 s7, s4, s7
    s_cmp_gt_u32 s7, 2
    s_addc_u32 s4, s4, s5
    s_lshl_b32 s4, s4, 7
    s_mul_i32 s7, s3, 720896
    s_add_u32 s4, s4, s7
    s_add_u32 s10, s4, 39469056
    s_lshl1_add_u32 s4, s69, 1
    s_mul_i32 s5, s4, 9363
    s_lshr_b32 s5, s5, 16
    s_mul_i32 s7, s5, 7
    s_sub_u32 s7, s4, s7
    s_cmp_gt_u32 s7, 2
    s_addc_u32 s4, s4, s5
    s_lshl_b32 s4, s4, 7
    s_mul_i32 s7, s3, 720896
    s_add_u32 s4, s4, s7
    s_add_u32 s11, s4, 39469056
    ds_read2_b32 v[64:65], v236 offset0:0 offset1:1
    ds_read2_b32 v[66:67], v236 offset0:2 offset1:3
    ds_read2_b32 v[68:69], v236 offset0:128 offset1:129
    ds_read2_b32 v[70:71], v236 offset0:130 offset1:131
    ds_read2_b32 v[72:73], v237 offset0:0 offset1:1
    ds_read2_b32 v[74:75], v237 offset0:2 offset1:3
    ds_read2_b32 v[76:77], v237 offset0:128 offset1:129
    ds_read2_b32 v[78:79], v237 offset0:130 offset1:131
    ds_read2_b32 v[80:81], v238 offset0:0 offset1:1
    ds_read2_b32 v[82:83], v238 offset0:2 offset1:3
    ds_read2_b32 v[84:85], v238 offset0:128 offset1:129
    ds_read2_b32 v[86:87], v238 offset0:130 offset1:131
    ds_read2_b32 v[88:89], v239 offset0:0 offset1:1
    ds_read2_b32 v[90:91], v239 offset0:2 offset1:3
    ds_read2_b32 v[92:93], v239 offset0:128 offset1:129
    ds_read2_b32 v[94:95], v239 offset0:130 offset1:131
    v_mov_b32 v29, 0
    buffer_atomic_add v29, v28, s[44:47], 0 offen sc0 sc1
    s_waitcnt vmcnt(0)
    v_cmp_ne_u32 vcc, s68, v29
    s_cbranch_vccnz L_rs_p1X
L_ok_p1X:
    s_add_u32 m0, s9, 0
    s_add_u32 s13, s10, 0
    buffer_load_dwordx4 v15, s[44:47], s13 offen sc1 lds
    s_add_u32 m0, s9, 1024
    s_add_u32 s13, s10, 90112
    buffer_load_dwordx4 v16, s[44:47], s13 offen sc1 lds
    s_add_u32 m0, s9, 2048
    s_add_u32 s13, s10, 180224
L_pl_X_1:
    s_cbranch_execz L_pl_X_5
    buffer_load_dwordx4 v15, s[44:47], s13 offen sc1 lds
    s_add_u32 m0, s9, 3072
    s_add_u32 s13, s10, 270336
    buffer_load_dwordx4 v16, s[44:47], s13 offen sc1 lds
    s_add_u32 m0, s9, 4096
    s_add_u32 s13, s10, 360448
    buffer_load_dwordx4 v15, s[44:47], s13 offen sc1 lds
    s_add_u32 m0, s9, 5120
    s_add_u32 s13, s10, 450560
    buffer_load_dwordx4 v16, s[44:47], s13 offen sc1 lds
    s_add_u32 m0, s9, 6144
    s_add_u32 s13, s10, 540672
    buffer_load_dwordx4 v15, s[44:47], s13 offen sc1 lds
    s_add_u32 m0, s9, 7168
    s_add_u32 s13, s10, 630784
    buffer_load_dwordx4 v16, s[44:47], s13 offen sc1 lds
    s_mov_b64 exec, 0
    s_call_b64 s[82:83], L_wc_D
    s_mov_b64 exec, -1
    s_mov_b32 s60, s36
    s_and_b32 s61, s37, 0xffff
    s_mov_b32 s62, 4096
    s_mov_b32 s63, 0x20000
    v_and_b32 v24, 15, v2
    s_lshl_b32 s7, s71, 6
    v_add_u32 v24, s7, v24
    s_and_b32 s8, s3, 1
    s_lshl_b32 s4, s8, 5
    v_add_u32 v25, s4, v24
    v_lshlrev_b32 v26, 3, v25
    v_mul_u32_u24 v25, 1152, v25
    v_bfe_u32 v31, v2, 4, 1
    v_lshl_add_u32 v25, v31, 5, v25
    v_lshrrev_b32 v31, 5, v2
    v_lshl_add_u32 v25, v31, 4, v25
    s_bfe_u32 s7, s2, 0x20003
    s_mul_i32 s7, s7, 288
    s_bfe_u32 s5, s2, 0x10003
    s_mul_i32 s5, s5, 32
    s_lshl_b32 s4, s72, 6
    s_add_u32 s4, s4, s7
    s_add_u32 s4, s4, s5
    s_lshl_b32 s5, s5, 3
    s_sub_u32 s7, s7, s5
    v_add_u32 v252, s4, v25
    s_xor_b32 s8, s3, s72
    s_and_b32 s4, s72, 1
    s_lshl1_add_u32 s4, s4, s8
    v_lshl_add_u32 v24, s4, 4, v24
    s_add_u32 s7, s7, 256
    s_cmp_lt_u32 s8, 2
    s_cselect_b32 s7, s7, 0x40000000
    v_lshlrev_b32 v18, 3, v24
    v_mul_u32_u24 v24, 1152, v24
    v_lshrrev_b32 v31, 4, v2
    v_lshl_add_u32 v24, v31, 3, v24
    v_add_u32 v253, s7, v24
    v_lshrrev_b32 v24, 3, v2
    v_and_b32 v25, 7, v2
    v_bfe_u32 v31, v2, 4, 2
    v_lshlrev_b32 v31, 1, v31
    v_xor_b32 v25, v25, v31
    v_lshlrev_b32 v24, 12, v24
    v_lshl_add_u32 v24, v25, 4, v24
    s_mul_i32 s7, s72, 36
    s_bitcmp1_b32 s3, 0
    s_addc_u32 s7, s7, 0
    s_lshl_b32 s7, s7, 17
    s_lshl_b32 s8, s71, 7
    s_add_u32 s7, s7, s8
    v_add_u32 v4, s7, v24
    v_add_u32 v5, 31744, v4
    v_add_u32 v6, 31744, v5
    v_add_u32 v7, 31744, v6
    v_lshrrev_b32 v24, 2, v2
    v_lshlrev_b32 v24, 7, v24
    v_and_b32 v25, 3, v2
    v_lshl_add_u32 v24, v25, 3, v24
    s_and_b32 s7, s73, 8192
    v_add_u32 v24, s7, v24
    v_bfe_u32 v31, v2, 3, 2
    s_and_b32 s7, s3, 1
    s_lshl_b32 s7, s7, 1
    v_xor_b32 v31, s7, v31
    v_lshl_add_u32 v10, v31, 5, v24
    v_xor_b32 v11, 32, v10
    v_and_b32 v24, 15, v2
    v_lshrrev_b32 v25, 4, v2
    v_mul_u32_u24 v25, 17408, v25
    v_lshl_add_u32 v24, v24, 4, v25
    s_mul_i32 s7, s72, 36
    s_and_b32 s8, s3, 1
    s_add_u32 s7, s7, s8
    s_mul_i32 s7, s7, 69632
    s_bfe_u32 s8, s2, 0x20003
    s_lshl_b32 s8, s8, 12
    s_add_u32 s7, s7, s8
    s_add_u32 s7, s7, 12795904
    v_add_u32 v23, s7, v24
    s_xor_b32 s7, s72, 0
    v_lshl_add_u32 v19, s7, 10, v23
    s_xor_b32 s7, s72, 1
    v_lshl_add_u32 v20, s7, 10, v23
    s_xor_b32 s7, s72, 2
    v_lshl_add_u32 v21, s7, 10, v23
    s_xor_b32 s7, s72, 3
    v_lshl_add_u32 v22, s7, 10, v23
    v_lshlrev_b32 v14, 4, v2
    v_add_u32 v14, 98304, v14
    v_add_u32 v1, 0x10000, v14
    s_bitcmp1_b32 s3, 1
    s_cselect_b32 s18, s85, s84
    s_mul_i32 s18, s18, 139264
    s_cselect_b32 s19, s87, s86
    s_mul_i32 s19, s19, 139264
    s_cselect_b32 s20, s89, s88
    s_mul_i32 s20, s20, 139264
    s_cselect_b32 s21, s91, s90
    s_mul_i32 s21, s21, 139264
    s_cselect_b32 s22, s93, s92
    s_mul_i32 s22, s22, 139264
    s_cselect_b32 s23, s95, s94
    s_mul_i32 s23, s23, 139264
    s_cselect_b32 s24, s97, s96
    s_mul_i32 s24, s24, 139264
    s_cselect_b32 s25, s99, s98
    s_mul_i32 s25, s25, 139264
    s_cselect_b32 s26, s101, s100
    s_mul_i32 s26, s26, 139264
    v_add_u32 v10, 131072, v10
    v_add_u32 v11, 131072, v11
    s_waitcnt vmcnt(0) lgkmcnt(0)
    s_barrier
    ds_read_b128 v[96:99], v244 offset:2048
    ds_read_b128 v[100:103], v244 offset:6144
    ds_read_b128 v[104:107], v244 offset:10240
    ds_read_b128 v[108:111], v244 offset:14336
    ds_read_b128 v[112:115], v244 offset:18432
    ds_read_b128 v[116:119], v244 offset:22528
    ds_read_b128 v[120:123], v244 offset:26624
    ds_read_b128 v[124:127], v244 offset:30720
    s_waitcnt lgkmcnt(0)
    v_mfma_f32_16x16x32_bf16 v[32:35], v[64:67], v[96:99], 0
    s_lshl_b32 s14, s84, 18
    ds_read_b128 v[160:163], v245 offset:2048
    v_mfma_f32_16x16x32_bf16 v[36:39], v[68:71], v[96:99], 0
    s_add_u32 m0, s73, 147456
    v_mfma_f32_16x16x32_bf16 v[36:39], v[64:67], v[100:103], v[36:39]
    buffer_load_dwordx4 v4, s[52:55], s14 offen offset:0 lds
    ds_read2_b32 v[128:129], v236 offset0:16 offset1:17
    v_mfma_f32_16x16x32_bf16 v[40:43], v[64:67], v[104:107], 0
    ds_read2_b32 v[130:131], v236 offset0:18 offset1:19
    v_mfma_f32_16x16x32_bf16 v[40:43], v[68:71], v[100:103], v[40:43]
    v_mfma_f32_16x16x32_bf16 v[40:43], v[72:75], v[96:99], v[40:43]
    ds_read_b128 v[164:167], v245 offset:6144
    v_mfma_f32_16x16x32_bf16 v[44:47], v[76:79], v[96:99], 0
    ds_read2_b32 v[132:133], v236 offset0:144 offset1:145
    v_mfma_f32_16x16x32_bf16 v[44:47], v[72:75], v[100:103], v[44:47]
    v_mfma_f32_16x16x32_bf16 v[44:47], v[68:71], v[104:107], v[44:47]
    s_add_u32 m0, s73, 147456
    ds_read2_b32 v[134:135], v236 offset0:146 offset1:147
    v_mfma_f32_16x16x32_bf16 v[44:47], v[64:67], v[108:111], v[44:47]
    buffer_load_dwordx4 v5, s[52:55], s14 offen offset:1024 lds
    ds_read_b128 v[168:171], v245 offset:10240
    v_mfma_f32_16x16x32_bf16 v[48:51], v[64:67], v[112:115], 0
    ds_read2_b32 v[136:137], v237 offset0:16 offset1:17
    v_mfma_f32_16x16x32_bf16 v[48:51], v[68:71], v[108:111], v[48:51]
    v_mfma_f32_16x16x32_bf16 v[48:51], v[72:75], v[104:107], v[48:51]
    ds_read2_b32 v[138:139], v237 offset0:18 offset1:19
    v_mfma_f32_16x16x32_bf16 v[48:51], v[76:79], v[100:103], v[48:51]
    ds_read_b128 v[172:175], v245 offset:14336
    v_mfma_f32_16x16x32_bf16 v[48:51], v[80:83], v[96:99], v[48:51]
    v_mfma_f32_16x16x32_bf16 v[52:55], v[84:87], v[96:99], 0
    s_add_u32 m0, s73, 147456
    ds_read2_b32 v[140:141], v237 offset0:144 offset1:145
    v_mfma_f32_16x16x32_bf16 v[52:55], v[80:83], v[100:103], v[52:55]
    buffer_load_dwordx4 v6, s[52:55], s14 offen offset:2048 lds
    ds_read2_b32 v[142:143], v237 offset0:146 offset1:147
    v_mfma_f32_16x16x32_bf16 v[52:55], v[76:79], v[104:107], v[52:55]
    v_mfma_f32_16x16x32_bf16 v[52:55], v[72:75], v[108:111], v[52:55]
    ds_read_b128 v[176:179], v245 offset:18432
    v_mfma_f32_16x16x32_bf16 v[52:55], v[68:71], v[112:115], v[52:55]
    ds_read2_b32 v[144:145], v238 offset0:16 offset1:17
    v_mfma_f32_16x16x32_bf16 v[52:55], v[64:67], v[116:119], v[52:55]
    v_mfma_f32_16x16x32_bf16 v[56:59], v[64:67], v[120:123], 0
    ds_read2_b32 v[146:147], v238 offset0:18 offset1:19
    v_mfma_f32_16x16x32_bf16 v[56:59], v[68:71], v[116:119], v[56:59]
    s_add_u32 m0, s73, 147456
    ds_read_b128 v[180:183], v245 offset:22528
    v_mfma_f32_16x16x32_bf16 v[56:59], v[72:75], v[112:115], v[56:59]
    buffer_load_dwordx4 v7, s[52:55], s14 offen offset:3072 lds
    v_mfma_f32_16x16x32_bf16 v[56:59], v[76:79], v[108:111], v[56:59]
    ds_read2_b32 v[148:149], v238 offset0:144 offset1:145
    v_mfma_f32_16x16x32_bf16 v[56:59], v[80:83], v[104:107], v[56:59]
    ds_read2_b32 v[150:151], v238 offset0:146 offset1:147
    v_mfma_f32_16x16x32_bf16 v[56:59], v[84:87], v[100:103], v[56:59]
    ds_read_b128 v[184:187], v245 offset:26624
    v_mfma_f32_16x16x32_bf16 v[56:59], v[88:91], v[96:99], v[56:59]
    v_mfma_f32_16x16x32_bf16 v[60:63], v[92:95], v[96:99], 0
    ds_read2_b32 v[152:153], v239 offset0:16 offset1:17
    v_mfma_f32_16x16x32_bf16 v[60:63], v[88:91], v[100:103], v[60:63]
    ds_read2_b32 v[154:155], v239 offset0:18 offset1:19
    v_mfma_f32_16x16x32_bf16 v[60:63], v[84:87], v[104:107], v[60:63]
    v_mfma_f32_16x16x32_bf16 v[60:63], v[80:83], v[108:111], v[60:63]
    ds_read_b128 v[188:191], v245 offset:30720
    v_mfma_f32_16x16x32_bf16 v[60:63], v[76:79], v[112:115], v[60:63]
    ds_read2_b32 v[156:157], v239 offset0:144 offset1:145
    v_mfma_f32_16x16x32_bf16 v[60:63], v[72:75], v[116:119], v[60:63]
    v_mfma_f32_16x16x32_bf16 v[60:63], v[68:71], v[120:123], v[60:63]
    ds_read2_b32 v[158:159], v239 offset0:146 offset1:147
    v_mfma_f32_16x16x32_bf16 v[60:63], v[64:67], v[124:127], v[60:63]
    s_waitcnt lgkmcnt(12)
    v_mfma_f32_16x16x32_bf16 v[32:35], v[128:131], v[160:163], v[32:35]
    ds_read_b128 v[96:99], v246 offset:2048
    v_mfma_f32_16x16x32_bf16 v[36:39], v[132:135], v[160:163], v[36:39]
    v_mfma_f32_16x16x32_bf16 v[36:39], v[128:131], v[164:167], v[36:39]
    ds_read2_b32 v[64:65], v236 offset0:32 offset1:33
    v_mfma_f32_16x16x32_bf16 v[40:43], v[128:131], v[168:171], v[40:43]
    ds_read2_b32 v[66:67], v236 offset0:34 offset1:35
    v_mfma_f32_16x16x32_bf16 v[40:43], v[132:135], v[164:167], v[40:43]
    v_mfma_f32_16x16x32_bf16 v[40:43], v[136:139], v[160:163], v[40:43]
    ds_read_b128 v[100:103], v246 offset:6144
    v_mfma_f32_16x16x32_bf16 v[44:47], v[140:143], v[160:163], v[44:47]
    ds_read2_b32 v[68:69], v236 offset0:160 offset1:161
    v_mfma_f32_16x16x32_bf16 v[44:47], v[136:139], v[164:167], v[44:47]
    v_mfma_f32_16x16x32_bf16 v[44:47], v[132:135], v[168:171], v[44:47]
    ds_read2_b32 v[70:71], v236 offset0:162 offset1:163
    v_mfma_f32_16x16x32_bf16 v[44:47], v[128:131], v[172:175], v[44:47]
    ds_read_b128 v[104:107], v246 offset:10240
    s_waitcnt lgkmcnt(7)
    v_mfma_f32_16x16x32_bf16 v[48:51], v[128:131], v[176:179], v[48:51]
    s_lshl_b32 s14, s85, 18
    ds_read2_b32 v[72:73], v237 offset0:32 offset1:33
    v_mfma_f32_16x16x32_bf16 v[48:51], v[132:135], v[172:175], v[48:51]
    s_add_u32 m0, s73, 49152
    ds_read2_b32 v[74:75], v237 offset0:34 offset1:35
    v_mfma_f32_16x16x32_bf16 v[48:51], v[136:139], v[168:171], v[48:51]
    buffer_load_dwordx4 v4, s[52:55], s14 offen offset:0 lds
    v_mov_b32 v9, 8
    buffer_load_ushort v9, v9, s[56:59], s70 offen
    v_mfma_f32_16x16x32_bf16 v[48:51], v[140:143], v[164:167], v[48:51]
    ds_read_b128 v[108:111], v246 offset:14336
    v_mfma_f32_16x16x32_bf16 v[48:51], v[144:147], v[160:163], v[48:51]
    v_mfma_f32_16x16x32_bf16 v[52:55], v[148:151], v[160:163], v[52:55]
    ds_read2_b32 v[76:77], v237 offset0:160 offset1:161
    v_mfma_f32_16x16x32_bf16 v[52:55], v[144:147], v[164:167], v[52:55]
    ds_read2_b32 v[78:79], v237 offset0:162 offset1:163
    v_mfma_f32_16x16x32_bf16 v[52:55], v[140:143], v[168:171], v[52:55]
    v_mfma_f32_16x16x32_bf16 v[52:55], v[136:139], v[172:175], v[52:55]
    ds_read_b128 v[112:115], v246 offset:18432
    v_mfma_f32_16x16x32_bf16 v[52:55], v[132:135], v[176:179], v[52:55]
    s_add_u32 m0, s73, 49152
    ds_read2_b32 v[80:81], v238 offset0:32 offset1:33
    v_mfma_f32_16x16x32_bf16 v[52:55], v[128:131], v[180:183], v[52:55]
    buffer_load_dwordx4 v5, s[52:55], s14 offen offset:1024 lds
    v_mfma_f32_16x16x32_bf16 v[56:59], v[128:131], v[184:187], v[56:59]
    ds_read2_b32 v[82:83], v238 offset0:34 offset1:35
    v_mfma_f32_16x16x32_bf16 v[56:59], v[132:135], v[180:183], v[56:59]
    ds_read_b128 v[116:119], v246 offset:22528
    v_mfma_f32_16x16x32_bf16 v[56:59], v[136:139], v[176:179], v[56:59]
    v_mfma_f32_16x16x32_bf16 v[56:59], v[140:143], v[172:175], v[56:59]
    ds_read2_b32 v[84:85], v238 offset0:160 offset1:161
    v_mfma_f32_16x16x32_bf16 v[56:59], v[144:147], v[168:171], v[56:59]
    ds_read2_b32 v[86:87], v238 offset0:162 offset1:163
    v_mfma_f32_16x16x32_bf16 v[56:59], v[148:151], v[164:167], v[56:59]
    s_add_u32 m0, s73, 49152
    ds_read_b128 v[120:123], v246 offset:26624
    v_mfma_f32_16x16x32_bf16 v[56:59], v[152:155], v[160:163], v[56:59]
    buffer_load_dwordx4 v6, s[52:55], s14 offen offset:2048 lds
    v_mfma_f32_16x16x32_bf16 v[60:63], v[156:159], v[160:163], v[60:63]
    ds_read2_b32 v[88:89], v239 offset0:32 offset1:33
    v_mfma_f32_16x16x32_bf16 v[60:63], v[152:155], v[164:167], v[60:63]
    ds_read2_b32 v[90:91], v239 offset0:34 offset1:35
    v_mfma_f32_16x16x32_bf16 v[60:63], v[148:151], v[168:171], v[60:63]
    v_mfma_f32_16x16x32_bf16 v[60:63], v[144:147], v[172:175], v[60:63]
    ds_read_b128 v[124:127], v246 offset:30720
    v_mfma_f32_16x16x32_bf16 v[60:63], v[140:143], v[176:179], v[60:63]
    ds_read2_b32 v[92:93], v239 offset0:160 offset1:161
    v_mfma_f32_16x16x32_bf16 v[60:63], v[136:139], v[180:183], v[60:63]
    s_add_u32 m0, s73, 49152
    v_mfma_f32_16x16x32_bf16 v[60:63], v[132:135], v[184:187], v[60:63]
    buffer_load_dwordx4 v7, s[52:55], s14 offen offset:3072 lds
    ds_read2_b32 v[94:95], v239 offset0:162 offset1:163
    v_mfma_f32_16x16x32_bf16 v[60:63], v[128:131], v[188:191], v[60:63]
    s_waitcnt lgkmcnt(12)
    v_mfma_f32_16x16x32_bf16 v[32:35], v[64:67], v[96:99], v[32:35]
    ds_read_b128 v[160:163], v247 offset:2048
    v_mfma_f32_16x16x32_bf16 v[36:39], v[68:71], v[96:99], v[36:39]
    v_mfma_f32_16x16x32_bf16 v[36:39], v[64:67], v[100:103], v[36:39]
    ds_read2_b32 v[128:129], v236 offset0:48 offset1:49
    v_mfma_f32_16x16x32_bf16 v[40:43], v[64:67], v[104:107], v[40:43]
    ds_read2_b32 v[130:131], v236 offset0:50 offset1:51
    v_mfma_f32_16x16x32_bf16 v[40:43], v[68:71], v[100:103], v[40:43]
    v_mfma_f32_16x16x32_bf16 v[40:43], v[72:75], v[96:99], v[40:43]
    ds_read_b128 v[164:167], v247 offset:6144
    v_mfma_f32_16x16x32_bf16 v[44:47], v[76:79], v[96:99], v[44:47]
    ds_read2_b32 v[132:133], v236 offset0:176 offset1:177
    v_mfma_f32_16x16x32_bf16 v[44:47], v[72:75], v[100:103], v[44:47]
    v_mfma_f32_16x16x32_bf16 v[44:47], v[68:71], v[104:107], v[44:47]
    ds_read2_b32 v[134:135], v236 offset0:178 offset1:179
    v_mfma_f32_16x16x32_bf16 v[44:47], v[64:67], v[108:111], v[44:47]
    ds_read_b128 v[168:171], v247 offset:10240
    s_waitcnt lgkmcnt(7)
    v_mfma_f32_16x16x32_bf16 v[48:51], v[64:67], v[112:115], v[48:51]
    ds_read2_b32 v[136:137], v237 offset0:48 offset1:49
    v_mfma_f32_16x16x32_bf16 v[48:51], v[68:71], v[108:111], v[48:51]
    v_mfma_f32_16x16x32_bf16 v[48:51], v[72:75], v[104:107], v[48:51]
    ds_read2_b32 v[138:139], v237 offset0:50 offset1:51
    v_mfma_f32_16x16x32_bf16 v[48:51], v[76:79], v[100:103], v[48:51]
    ds_read_b128 v[172:175], v247 offset:14336
    v_mfma_f32_16x16x32_bf16 v[48:51], v[80:83], v[96:99], v[48:51]
    v_mfma_f32_16x16x32_bf16 v[52:55], v[84:87], v[96:99], v[52:55]
    ds_read2_b32 v[140:141], v237 offset0:176 offset1:177
    v_mfma_f32_16x16x32_bf16 v[52:55], v[80:83], v[100:103], v[52:55]
    ds_read2_b32 v[142:143], v237 offset0:178 offset1:179
    v_mfma_f32_16x16x32_bf16 v[52:55], v[76:79], v[104:107], v[52:55]
    v_mfma_f32_16x16x32_bf16 v[52:55], v[72:75], v[108:111], v[52:55]
    ds_read_b128 v[176:179], v247 offset:18432
    v_mfma_f32_16x16x32_bf16 v[52:55], v[68:71], v[112:115], v[52:55]
    ds_read2_b32 v[144:145], v238 offset0:48 offset1:49
    v_mfma_f32_16x16x32_bf16 v[52:55], v[64:67], v[116:119], v[52:55]
    v_mfma_f32_16x16x32_bf16 v[56:59], v[64:67], v[120:123], v[56:59]
    ds_read2_b32 v[146:147], v238 offset0:50 offset1:51
    v_mfma_f32_16x16x32_bf16 v[56:59], v[68:71], v[116:119], v[56:59]
    ds_read_b128 v[180:183], v247 offset:22528
    v_mfma_f32_16x16x32_bf16 v[56:59], v[72:75], v[112:115], v[56:59]
    v_mfma_f32_16x16x32_bf16 v[56:59], v[76:79], v[108:111], v[56:59]
    ds_read2_b32 v[148:149], v238 offset0:176 offset1:177
    v_mfma_f32_16x16x32_bf16 v[56:59], v[80:83], v[104:107], v[56:59]
    ds_read2_b32 v[150:151], v238 offset0:178 offset1:179
    v_mfma_f32_16x16x32_bf16 v[56:59], v[84:87], v[100:103], v[56:59]
    ds_read_b128 v[184:187], v247 offset:26624
    v_mfma_f32_16x16x32_bf16 v[56:59], v[88:91], v[96:99], v[56:59]
    v_mfma_f32_16x16x32_bf16 v[60:63], v[92:95], v[96:99], v[60:63]
    ds_read2_b32 v[152:153], v239 offset0:48 offset1:49
    v_mfma_f32_16x16x32_bf16 v[60:63], v[88:91], v[100:103], v[60:63]
    ds_read2_b32 v[154:155], v239 offset0:50 offset1:51
    v_mfma_f32_16x16x32_bf16 v[60:63], v[84:87], v[104:107], v[60:63]
    v_mfma_f32_16x16x32_bf16 v[60:63], v[80:83], v[108:111], v[60:63]
    ds_read_b128 v[188:191], v247 offset:30720
    v_mfma_f32_16x16x32_bf16 v[60:63], v[76:79], v[112:115], v[60:63]
    ds_read2_b32 v[156:157], v239 offset0:176 offset1:177
    v_mfma_f32_16x16x32_bf16 v[60:63], v[72:75], v[116:119], v[60:63]
    v_mfma_f32_16x16x32_bf16 v[60:63], v[68:71], v[120:123], v[60:63]
    ds_read2_b32 v[158:159], v239 offset0:178 offset1:179
    v_mfma_f32_16x16x32_bf16 v[60:63], v[64:67], v[124:127], v[60:63]
    s_waitcnt lgkmcnt(12)
    v_mfma_f32_16x16x32_bf16 v[32:35], v[128:131], v[160:163], v[32:35]
    ds_read_b128 v[96:99], v244 offset:0
    v_mfma_f32_16x16x32_bf16 v[36:39], v[132:135], v[160:163], v[36:39]
    v_mfma_f32_16x16x32_bf16 v[36:39], v[128:131], v[164:167], v[36:39]
    ds_read2_b32 v[64:65], v236 offset0:64 offset1:65
    v_mfma_f32_16x16x32_bf16 v[40:43], v[128:131], v[168:171], v[40:43]
    ds_read2_b32 v[66:67], v236 offset0:66 offset1:67
    v_mfma_f32_16x16x32_bf16 v[40:43], v[132:135], v[164:167], v[40:43]
    v_mfma_f32_16x16x32_bf16 v[40:43], v[136:139], v[160:163], v[40:43]
    ds_read_b128 v[100:103], v244 offset:4096
    v_mfma_f32_16x16x32_bf16 v[44:47], v[140:143], v[160:163], v[44:47]
    ds_read2_b32 v[68:69], v236 offset0:192 offset1:193
    v_mfma_f32_16x16x32_bf16 v[44:47], v[136:139], v[164:167], v[44:47]
    v_mfma_f32_16x16x32_bf16 v[44:47], v[132:135], v[168:171], v[44:47]
    ds_read2_b32 v[70:71], v236 offset0:194 offset1:195
    v_mfma_f32_16x16x32_bf16 v[44:47], v[128:131], v[172:175], v[44:47]
    ds_read_b128 v[104:107], v244 offset:8192
    s_waitcnt lgkmcnt(7)
    v_mfma_f32_16x16x32_bf16 v[48:51], v[128:131], v[176:179], v[48:51]
    ds_read2_b32 v[72:73], v237 offset0:64 offset1:65
    v_mfma_f32_16x16x32_bf16 v[48:51], v[132:135], v[172:175], v[48:51]
    ds_read2_b32 v[74:75], v237 offset0:66 offset1:67
    v_mfma_f32_16x16x32_bf16 v[48:51], v[136:139], v[168:171], v[48:51]
    ds_read_b128 v[108:111], v244 offset:12288
    v_mfma_f32_16x16x32_bf16 v[48:51], v[140:143], v[164:167], v[48:51]
    ds_read2_b32 v[76:77], v237 offset0:192 offset1:193
    v_mfma_f32_16x16x32_bf16 v[48:51], v[144:147], v[160:163], v[48:51]
    ds_read2_b32 v[78:79], v237 offset0:194 offset1:195
    s_waitcnt vmcnt(5)
    s_barrier
    v_mfma_f32_16x16x32_bf16 v[52:55], v[148:151], v[160:163], v[52:55]
    ds_read_b64_tr_b16 a[0:1], v10 offset:16384
    v_mfma_f32_16x16x32_bf16 v[52:55], v[144:147], v[164:167], v[52:55]
    ds_read_b128 v[112:115], v244 offset:16384
    v_mfma_f32_16x16x32_bf16 v[52:55], v[140:143], v[168:171], v[52:55]
    ds_read_b64_tr_b16 a[2:3], v10 offset:18432
    v_mfma_f32_16x16x32_bf16 v[52:55], v[136:139], v[172:175], v[52:55]
    ds_read_b64_tr_b16 a[8:9], v10 offset:20480
    v_mfma_f32_16x16x32_bf16 v[52:55], v[132:135], v[176:179], v[52:55]
    ds_read2_b32 v[80:81], v238 offset0:64 offset1:65
    v_mfma_f32_16x16x32_bf16 v[52:55], v[128:131], v[180:183], v[52:55]
    ds_read_b64_tr_b16 a[10:11], v10 offset:22528
    v_mfma_f32_16x16x32_bf16 v[56:59], v[128:131], v[184:187], v[56:59]
    ds_read_b64_tr_b16 a[4:5], v11 offset:16384
    v_mfma_f32_16x16x32_bf16 v[56:59], v[132:135], v[180:183], v[56:59]
    ds_read2_b32 v[82:83], v238 offset0:66 offset1:67
    v_mfma_f32_16x16x32_bf16 v[56:59], v[136:139], v[176:179], v[56:59]
    ds_read_b64_tr_b16 a[6:7], v11 offset:18432
    v_mfma_f32_16x16x32_bf16 v[56:59], v[140:143], v[172:175], v[56:59]
    ds_read_b64_tr_b16 a[12:13], v11 offset:20480
    v_mfma_f32_16x16x32_bf16 v[56:59], v[144:147], v[168:171], v[56:59]
    ds_read_b64_tr_b16 a[14:15], v11 offset:22528
    v_mfma_f32_16x16x32_bf16 v[56:59], v[148:151], v[164:167], v[56:59]
    ds_read_b128 v[116:119], v244 offset:20480
    v_mfma_f32_16x16x32_bf16 v[56:59], v[152:155], v[160:163], v[56:59]
    ds_read2_b32 v[84:85], v238 offset0:192 offset1:193
    v_mfma_f32_16x16x32_bf16 v[60:63], v[156:159], v[160:163], v[60:63]
    ds_read2_b32 v[86:87], v238 offset0:194 offset1:195
    s_waitcnt lgkmcnt(3)
    s_barrier
    v_mfma_f32_16x16x32_bf16 v[60:63], v[152:155], v[164:167], v[60:63]
    ds_read_b128 v[120:123], v244 offset:24576
    v_mfma_f32_16x16x32_bf16 v[60:63], v[148:151], v[168:171], v[60:63]
    ds_read2_b32 v[88:89], v239 offset0:64 offset1:65
    v_mfma_f32_16x16x32_bf16 v[60:63], v[144:147], v[172:175], v[60:63]
    ds_read2_b32 v[90:91], v239 offset0:66 offset1:67
    v_mfma_f32_16x16x32_bf16 v[60:63], v[140:143], v[176:179], v[60:63]
    s_lshl_b32 s14, s86, 18
    ds_read_b128 v[124:127], v244 offset:28672
    v_mfma_f32_16x16x32_bf16 v[60:63], v[136:139], v[180:183], v[60:63]
    s_add_u32 m0, s73, 147456
    ds_read2_b32 v[92:93], v239 offset0:192 offset1:193
    v_mfma_f32_16x16x32_bf16 v[60:63], v[132:135], v[184:187], v[60:63]
    buffer_load_dwordx4 v4, s[52:55], s14 offen offset:0 lds
    ds_read2_b32 v[94:95], v239 offset0:194 offset1:195
    v_mfma_f32_16x16x32_bf16 v[60:63], v[128:131], v[188:191], v[60:63]
    v_mfma_f32_16x16x32_bf16 v[32:35], v[64:67], v[96:99], v[32:35]
    ds_read_b128 v[160:163], v245 offset:0
    v_mfma_f32_16x16x32_bf16 v[36:39], v[68:71], v[96:99], v[36:39]
    ds_read2_b32 v[128:129], v236 offset0:80 offset1:81
    v_mfma_f32_16x16x32_bf16 v[36:39], v[64:67], v[100:103], v[36:39]
    ds_read2_b32 v[130:131], v236 offset0:82 offset1:83
    v_mfma_f32_16x16x32_bf16 v[40:43], v[64:67], v[104:107], v[40:43]
    ds_read_b128 v[164:167], v245 offset:4096
    v_mfma_f32_16x16x32_bf16 v[40:43], v[68:71], v[100:103], v[40:43]
    s_add_u32 m0, s73, 147456
    ds_read2_b32 v[132:133], v236 offset0:208 offset1:209
    v_mfma_f32_16x16x32_bf16 v[40:43], v[72:75], v[96:99], v[40:43]
    buffer_load_dwordx4 v5, s[52:55], s14 offen offset:1024 lds
    ds_read2_b32 v[134:135], v236 offset0:210 offset1:211
    v_mfma_f32_16x16x32_bf16 v[44:47], v[76:79], v[96:99], v[44:47]
    ds_read_b128 v[168:171], v245 offset:8192
    v_mfma_f32_16x16x32_bf16 v[44:47], v[72:75], v[100:103], v[44:47]
    ds_read2_b32 v[136:137], v237 offset0:80 offset1:81
    v_mfma_f32_16x16x32_bf16 v[44:47], v[68:71], v[104:107], v[44:47]
    ds_read2_b32 v[138:139], v237 offset0:82 offset1:83
    v_mfma_f32_16x16x32_bf16 v[44:47], v[64:67], v[108:111], v[44:47]
    ds_read_b128 v[172:175], v245 offset:12288
    s_waitcnt lgkmcnt(10)
    v_mfma_f32_16x16x32_bf16 v[48:51], v[64:67], v[112:115], v[48:51]
    ds_read2_b32 v[140:141], v237 offset0:208 offset1:209
    v_mfma_f32_16x16x32_bf16 v[48:51], v[68:71], v[108:111], v[48:51]
    s_add_u32 m0, s73, 147456
    ds_read2_b32 v[142:143], v237 offset0:210 offset1:211
    v_mfma_f32_16x16x32_bf16 v[48:51], v[72:75], v[104:107], v[48:51]
    buffer_load_dwordx4 v6, s[52:55], s14 offen offset:2048 lds
    ds_read_b128 v[176:179], v245 offset:16384
    v_mfma_f32_16x16x32_bf16 v[48:51], v[76:79], v[100:103], v[48:51]
    ds_read2_b32 v[144:145], v238 offset0:80 offset1:81
    v_mfma_f32_16x16x32_bf16 v[48:51], v[80:83], v[96:99], v[48:51]
    ds_read2_b32 v[146:147], v238 offset0:82 offset1:83
    v_mfma_f32_16x16x32_bf16 v[52:55], v[84:87], v[96:99], v[52:55]
    ds_read_b128 v[180:183], v245 offset:20480
    v_mfma_f32_16x16x32_bf16 v[52:55], v[80:83], v[100:103], v[52:55]
    ds_read2_b32 v[148:149], v238 offset0:208 offset1:209
    v_mfma_f32_16x16x32_bf16 v[52:55], v[76:79], v[104:107], v[52:55]
    ds_read2_b32 v[150:151], v238 offset0:210 offset1:211
    v_mfma_f32_16x16x32_bf16 v[52:55], v[72:75], v[108:111], v[52:55]
    ds_read_b128 v[184:187], v245 offset:24576
    v_mfma_f32_16x16x32_bf16 v[52:55], v[68:71], v[112:115], v[52:55]
    s_add_u32 m0, s73, 147456
    ds_read_b128 v[212:215], v241 offset:8352
    v_mfma_f32_16x16x32_bf16 v[52:55], v[64:67], v[116:119], v[52:55]
    buffer_load_dwordx4 v7, s[52:55], s14 offen offset:3072 lds
    ds_read2_b32 v[152:153], v239 offset0:80 offset1:81
    v_mfma_f32_16x16x32_bf16 v[56:59], v[64:67], v[120:123], v[56:59]
    ds_read_b32 v216, v241 offset:8368
    v_mfma_f32_16x16x32_bf16 v[56:59], v[68:71], v[116:119], v[56:59]
    ds_read2_b32 v[154:155], v239 offset0:82 offset1:83
    v_mfma_f32_16x16x32_bf16 v[56:59], v[72:75], v[112:115], v[56:59]
    ds_read_b128 v[218:221], v241 offset:9376
    v_mfma_f32_16x16x32_bf16 v[56:59], v[76:79], v[108:111], v[56:59]
    ds_read_b32 v222, v241 offset:9392
    v_mfma_f32_16x16x32_bf16 v[56:59], v[80:83], v[104:107], v[56:59]
    ds_read_b128 v[224:227], v241 offset:10400
    s_waitcnt vmcnt(4)
    s_barrier
    v_mfma_f32_16x16x32_bf16 v[56:59], v[84:87], v[100:103], v[56:59]
    ds_read_b32 v228, v241 offset:10416
    v_add_u32 v10, -131072, v10
    v_mfma_f32_16x16x32_bf16 v[56:59], v[88:91], v[96:99], v[56:59]
    ds_read_b64_tr_b16 a[16:17], v10 offset:49152
    v_mfma_f32_16x16x32_bf16 v[60:63], v[92:95], v[96:99], v[60:63]
    ds_read_b64_tr_b16 a[18:19], v10 offset:51200
    v_mfma_f32_16x16x32_bf16 v[60:63], v[88:91], v[100:103], v[60:63]
    ds_read_b64_tr_b16 a[24:25], v10 offset:53248
    v_mfma_f32_16x16x32_bf16 v[60:63], v[84:87], v[104:107], v[60:63]
    ds_read_b128 v[230:233], v241 offset:11424
    v_mfma_f32_16x16x32_bf16 v[60:63], v[80:83], v[108:111], v[60:63]
    ds_read_b64_tr_b16 a[26:27], v10 offset:55296
    ds_read_b128 v[188:191], v245 offset:28672
    v_mfma_f32_16x16x32_bf16 v[60:63], v[76:79], v[112:115], v[60:63]
    ds_read_b32 v234, v241 offset:11440
    v_add_u32 v11, -131072, v11
    v_mfma_f32_16x16x32_bf16 v[60:63], v[72:75], v[116:119], v[60:63]
    ds_read_b64_tr_b16 a[20:21], v11 offset:49152
    ds_read2_b32 v[156:157], v239 offset0:208 offset1:209
    v_mfma_f32_16x16x32_bf16 v[60:63], v[68:71], v[120:123], v[60:63]
    ds_read_b64_tr_b16 a[22:23], v11 offset:51200
    ds_read2_b32 v[158:159], v239 offset0:210 offset1:211
    v_mfma_f32_16x16x32_bf16 v[60:63], v[64:67], v[124:127], v[60:63]
    ds_read_b64_tr_b16 a[28:29], v11 offset:53248
    s_waitcnt lgkmcnt(15)
    v_mfma_f32_16x16x32_bf16 v[32:35], v[128:131], v[160:163], v[32:35]
    ds_read_b64_tr_b16 a[30:31], v11 offset:55296
    v_mfma_f32_16x16x32_bf16 v[36:39], v[132:135], v[160:163], v[36:39]
    ds_read_b128 v[96:99], v246 offset:0
    v_mfma_f32_16x16x32_bf16 v[36:39], v[128:131], v[164:167], v[36:39]
    ds_read2_b32 v[64:65], v236 offset0:96 offset1:97
    v_mfma_f32_16x16x32_bf16 v[40:43], v[128:131], v[168:171], v[40:43]
    ds_read2_b32 v[66:67], v236 offset0:98 offset1:99
    s_waitcnt lgkmcnt(3)
    s_barrier
    v_mfma_f32_16x16x32_bf16 v[40:43], v[132:135], v[164:167], v[40:43]
    v_mfma_f32_16x16x32_bf16 v[40:43], v[136:139], v[160:163], v[40:43]
    ds_read_b128 v[100:103], v246 offset:4096
    v_mfma_f32_16x16x32_bf16 v[44:47], v[140:143], v[160:163], v[44:47]
    ds_read2_b32 v[68:69], v236 offset0:224 offset1:225
    v_mfma_f32_16x16x32_bf16 v[44:47], v[136:139], v[164:167], v[44:47]
    s_lshl_b32 s14, s87, 18
    v_mfma_f32_16x16x32_bf16 v[44:47], v[132:135], v[168:171], v[44:47]
    ds_read2_b32 v[70:71], v236 offset0:226 offset1:227
    s_add_u32 m0, s73, 49152
    v_lshlrev_b32 v9, 16, v9
    v_mfma_f32_16x16x32_bf16 v[44:47], v[128:131], v[172:175], v[44:47]
    buffer_load_dwordx4 v4, s[52:55], s14 offen offset:0 lds
    ds_read_b128 v[104:107], v246 offset:8192
    v_mfma_f32_16x16x32_bf16 v[48:51], v[128:131], v[176:179], v[48:51]
    ds_read2_b32 v[72:73], v237 offset0:96 offset1:97
    v_lshlrev_b32 v208, 16, v212
    v_mfma_f32_16x16x32_bf16 v[48:51], v[132:135], v[172:175], v[48:51]
    v_mfma_f32_16x16x32_bf16 v[48:51], v[136:139], v[168:171], v[48:51]
    ds_read2_b32 v[74:75], v237 offset0:98 offset1:99
    v_add_f32 v9, v9, v208
    v_mfma_f32_16x16x32_bf16 v[48:51], v[140:143], v[164:167], v[48:51]
    ds_read_b128 v[108:111], v246 offset:12288
    v_cvt_pk_bf16_f32 v9, v9, v9
    v_mfma_f32_16x16x32_bf16 v[48:51], v[144:147], v[160:163], v[48:51]
    ds_write_b16 v242, v9 offset:12480
    v_mfma_f32_16x16x32_bf16 v[52:55], v[148:151], v[160:163], v[52:55]
    s_add_u32 m0, s73, 49152
    ds_read2_b32 v[76:77], v237 offset0:224 offset1:225
    v_mfma_f32_16x16x32_bf16 v[52:55], v[144:147], v[164:167], v[52:55]
    buffer_load_dwordx4 v5, s[52:55], s14 offen offset:1024 lds
    ds_read2_b32 v[78:79], v237 offset0:226 offset1:227
    v_mfma_f32_16x16x32_bf16 v[52:55], v[140:143], v[168:171], v[52:55]
    ds_write_b16 v242, v9 offset:8322
    v_mfma_f32_16x16x32_bf16 v[52:55], v[136:139], v[172:175], v[52:55]
    ds_read_b128 v[112:115], v246 offset:16384
    v_mfma_f32_16x16x32_bf16 v[52:55], v[132:135], v[176:179], v[52:55]
    ds_read2_b32 v[80:81], v238 offset0:96 offset1:97
    v_alignbit_b32 v212, v213, v212, 16
    v_mfma_f32_16x16x32_bf16 v[52:55], v[128:131], v[180:183], v[52:55]
L_pl_X_2:
    s_cbranch_execz L_pl_X_6
    v_alignbit_b32 v213, v214, v213, 16
    v_mfma_f32_16x16x32_bf16 v[56:59], v[128:131], v[184:187], v[56:59]
    ds_read2_b32 v[82:83], v238 offset0:98 offset1:99
    v_mfma_f32_16x16x32_bf16 v[56:59], v[132:135], v[180:183], v[56:59]
    ds_read_b128 v[116:119], v246 offset:20480
    s_add_u32 m0, s73, 49152
    v_alignbit_b32 v214, v215, v214, 16
    v_mfma_f32_16x16x32_bf16 v[56:59], v[136:139], v[176:179], v[56:59]
    buffer_load_dwordx4 v6, s[52:55], s14 offen offset:2048 lds
    v_mfma_f32_16x16x32_bf16 v[56:59], v[140:143], v[172:175], v[56:59]
    ds_read2_b32 v[84:85], v238 offset0:224 offset1:225
    v_alignbit_b32 v215, v216, v215, 16
    v_mfma_f32_16x16x32_bf16 v[56:59], v[144:147], v[168:171], v[56:59]
    ds_read2_b32 v[86:87], v238 offset0:226 offset1:227
    v_mfma_f32_16x16x32_bf16 v[56:59], v[148:151], v[164:167], v[56:59]
    ds_write_b128 v241, v[212:215] offset:12512
    v_mfma_f32_16x16x32_bf16 v[56:59], v[152:155], v[160:163], v[56:59]
    ds_read_b128 v[120:123], v246 offset:24576
    v_mfma_f32_16x16x32_bf16 v[60:63], v[156:159], v[160:163], v[60:63]
    ds_read2_b32 v[88:89], v239 offset0:96 offset1:97
    v_alignbit_b32 v218, v219, v218, 16
    v_mfma_f32_16x16x32_bf16 v[60:63], v[152:155], v[164:167], v[60:63]
    ds_read2_b32 v[90:91], v239 offset0:98 offset1:99
    s_add_u32 m0, s73, 49152
    v_alignbit_b32 v219, v220, v219, 16
    v_mfma_f32_16x16x32_bf16 v[60:63], v[148:151], v[168:171], v[60:63]
    buffer_load_dwordx4 v7, s[52:55], s14 offen offset:3072 lds
    v_mfma_f32_16x16x32_bf16 v[60:63], v[144:147], v[172:175], v[60:63]
    ds_read_b128 v[124:127], v246 offset:28672
    v_alignbit_b32 v220, v221, v220, 16
    v_mfma_f32_16x16x32_bf16 v[60:63], v[140:143], v[176:179], v[60:63]
    ds_read2_b32 v[92:93], v239 offset0:224 offset1:225
    v_mfma_f32_16x16x32_bf16 v[60:63], v[136:139], v[180:183], v[60:63]
    ds_read2_b32 v[94:95], v239 offset0:226 offset1:227
    v_alignbit_b32 v221, v222, v221, 16
    v_mfma_f32_16x16x32_bf16 v[60:63], v[132:135], v[184:187], v[60:63]
    ds_write_b128 v241, v[218:221] offset:13536
    v_mfma_f32_16x16x32_bf16 v[60:63], v[128:131], v[188:191], v[60:63]
    s_waitcnt lgkmcnt(15)
    v_mfma_f32_16x16x32_bf16 v[32:35], v[64:67], v[96:99], v[32:35]
    ds_read_b128 v[160:163], v247 offset:0
    v_mfma_f32_16x16x32_bf16 v[36:39], v[68:71], v[96:99], v[36:39]
    v_alignbit_b32 v224, v225, v224, 16
    v_mfma_f32_16x16x32_bf16 v[36:39], v[64:67], v[100:103], v[36:39]
    ds_read_b128 v[164:167], v247 offset:4096
    v_mfma_f32_16x16x32_bf16 v[40:43], v[64:67], v[104:107], v[40:43]
    ds_read_b128 v[168:171], v247 offset:8192
    v_mfma_f32_16x16x32_bf16 v[40:43], v[68:71], v[100:103], v[40:43]
    ds_read_b128 v[172:175], v247 offset:12288
    v_mfma_f32_16x16x32_bf16 v[40:43], v[72:75], v[96:99], v[40:43]
    v_alignbit_b32 v225, v226, v225, 16
    v_mfma_f32_16x16x32_bf16 v[44:47], v[76:79], v[96:99], v[44:47]
    ds_read_b128 v[176:179], v247 offset:16384
    v_mfma_f32_16x16x32_bf16 v[44:47], v[72:75], v[100:103], v[44:47]
    ds_read_b128 v[180:183], v247 offset:20480
    v_mfma_f32_16x16x32_bf16 v[44:47], v[68:71], v[104:107], v[44:47]
    ds_read_b128 v[184:187], v247 offset:24576
    v_mfma_f32_16x16x32_bf16 v[44:47], v[64:67], v[108:111], v[44:47]
    v_alignbit_b32 v226, v227, v226, 16
    s_waitcnt lgkmcnt(8)
    v_mfma_f32_16x16x32_bf16 v[48:51], v[64:67], v[112:115], v[48:51]
    ds_read_b128 v[188:191], v247 offset:28672
    v_mfma_f32_16x16x32_bf16 v[48:51], v[68:71], v[108:111], v[48:51]
    ds_read2_b32 v[128:129], v236 offset0:112 offset1:113
    v_mfma_f32_16x16x32_bf16 v[48:51], v[72:75], v[104:107], v[48:51]
    v_alignbit_b32 v227, v228, v227, 16
    v_mfma_f32_16x16x32_bf16 v[48:51], v[76:79], v[100:103], v[48:51]
    ds_read2_b32 v[130:131], v236 offset0:114 offset1:115
    v_mfma_f32_16x16x32_bf16 v[48:51], v[80:83], v[96:99], v[48:51]
    ds_read2_b32 v[132:133], v236 offset0:240 offset1:241
    v_mfma_f32_16x16x32_bf16 v[52:55], v[84:87], v[96:99], v[52:55]
    ds_read2_b32 v[134:135], v236 offset0:242 offset1:243
    v_mfma_f32_16x16x32_bf16 v[52:55], v[80:83], v[100:103], v[52:55]
    ds_write_b128 v241, v[224:227] offset:14560
    v_mfma_f32_16x16x32_bf16 v[52:55], v[76:79], v[104:107], v[52:55]
    ds_read2_b32 v[136:137], v237 offset0:112 offset1:113
    v_mfma_f32_16x16x32_bf16 v[52:55], v[72:75], v[108:111], v[52:55]
    s_add_u32 s6, s12, 4718592
    ds_read2_b32 v[138:139], v237 offset0:114 offset1:115
    v_mfma_f32_16x16x32_bf16 v[52:55], v[68:71], v[112:115], v[52:55]
    ds_read2_b32 v[140:141], v237 offset0:240 offset1:241
    v_alignbit_b32 v230, v231, v230, 16
    v_mfma_f32_16x16x32_bf16 v[52:55], v[64:67], v[116:119], v[52:55]
    ds_read2_b32 v[142:143], v237 offset0:242 offset1:243
    v_xor_b32 v244, 64, v244
    v_mfma_f32_16x16x32_bf16 v[56:59], v[64:67], v[120:123], v[56:59]
    ds_read2_b32 v[144:145], v238 offset0:112 offset1:113
    v_mfma_f32_16x16x32_bf16 v[56:59], v[68:71], v[116:119], v[56:59]
    ds_read2_b32 v[146:147], v238 offset0:114 offset1:115
    v_mfma_f32_16x16x32_bf16 v[56:59], v[72:75], v[112:115], v[56:59]
    ds_read2_b32 v[148:149], v238 offset0:240 offset1:241
    v_alignbit_b32 v231, v232, v231, 16
    v_mfma_f32_16x16x32_bf16 v[56:59], v[76:79], v[108:111], v[56:59]
    ds_read2_b32 v[150:151], v238 offset0:242 offset1:243
    v_xor_b32 v245, 64, v245
    v_mfma_f32_16x16x32_bf16 v[56:59], v[80:83], v[104:107], v[56:59]
    ds_read2_b32 v[152:153], v239 offset0:112 offset1:113
    v_mfma_f32_16x16x32_bf16 v[56:59], v[84:87], v[100:103], v[56:59]
    ds_read2_b32 v[154:155], v239 offset0:114 offset1:115
    v_mfma_f32_16x16x32_bf16 v[56:59], v[88:91], v[96:99], v[56:59]
    ds_read2_b32 v[156:157], v239 offset0:240 offset1:241
    v_alignbit_b32 v232, v233, v232, 16
    v_mfma_f32_16x16x32_bf16 v[60:63], v[92:95], v[96:99], v[60:63]
    ds_read2_b32 v[158:159], v239 offset0:242 offset1:243
    v_mfma_f32_16x16x32_bf16 v[60:63], v[88:91], v[100:103], v[60:63]
    v_xor_b32 v246, 64, v246
    v_add_u32 v236, 8320, v236
    v_mfma_f32_16x16x32_bf16 v[60:63], v[84:87], v[104:107], v[60:63]
    v_alignbit_b32 v233, v234, v233, 16
    v_mfma_f32_16x16x32_bf16 v[60:63], v[80:83], v[108:111], v[60:63]
    v_add_u32 v237, 8320, v237
    v_mfma_f32_16x16x32_bf16 v[60:63], v[76:79], v[112:115], v[60:63]
    v_mfma_f32_16x16x32_bf16 v[60:63], v[72:75], v[116:119], v[60:63]
    v_xor_b32 v247, 64, v247
    v_add_u32 v238, 8320, v238
    v_mfma_f32_16x16x32_bf16 v[60:63], v[68:71], v[120:123], v[60:63]
    ds_write_b128 v241, v[230:233] offset:15584
    v_mfma_f32_16x16x32_bf16 v[60:63], v[64:67], v[124:127], v[60:63]
    v_add_u32 v239, 8320, v239
    s_waitcnt lgkmcnt(1)
    v_mfma_f32_16x16x32_bf16 v[60:63], v[128:131], v[188:191], v[60:63]
    ds_read_b128 v[96:99], v244 offset:2048
    v_mfma_f32_16x16x32_bf16 v[60:63], v[132:135], v[184:187], v[60:63]
    ds_read2_b32 v[64:65], v236 offset0:0 offset1:1
    v_mfma_f32_16x16x32_bf16 v[60:63], v[136:139], v[180:183], v[60:63]
    ds_read2_b32 v[66:67], v236 offset0:2 offset1:3
    v_mfma_f32_16x16x32_bf16 v[60:63], v[140:143], v[176:179], v[60:63]
    ds_read_b128 v[100:103], v244 offset:6144
    v_mfma_f32_16x16x32_bf16 v[60:63], v[144:147], v[172:175], v[60:63]
    ds_read2_b32 v[68:69], v236 offset0:128 offset1:129
    v_mfma_f32_16x16x32_bf16 v[60:63], v[148:151], v[168:171], v[60:63]
    ds_read2_b32 v[70:71], v236 offset0:130 offset1:131
    v_mfma_f32_16x16x32_bf16 v[60:63], v[152:155], v[164:167], v[60:63]
    ds_read_b128 v[104:107], v244 offset:10240
    v_mfma_f32_16x16x32_bf16 v[60:63], v[156:159], v[160:163], v[60:63]
    s_waitcnt vmcnt(4)
    s_barrier
    s_add_u32 s13, s12, 32768
    v_mfma_f32_16x16x32_bf16 v[56:59], v[128:131], v[184:187], v[56:59]
    ds_read2_b32 v[72:73], v237 offset0:0 offset1:1
    v_add_u32 v10, 131072, v10
    v_mfma_f32_16x16x32_bf16 v[56:59], v[132:135], v[180:183], v[56:59]
    ds_read_b64_tr_b16 a[32:33], v10 offset:16384
    s_add_u32 m0, s74, 32
    v_mfma_f32_16x16x32_bf16 v[56:59], v[136:139], v[176:179], v[56:59]
    ds_read_b64_tr_b16 a[34:35], v10 offset:18432
    buffer_load_dwordx4 v240, s[48:51], s13 offen offset:0 lds
    ds_read2_b32 v[74:75], v237 offset0:2 offset1:3
    v_mfma_f32_16x16x32_bf16 v[56:59], v[140:143], v[172:175], v[56:59]
    ds_read_b64_tr_b16 a[40:41], v10 offset:20480
    ds_read_b128 v[108:111], v244 offset:14336
    v_mfma_f32_16x16x32_bf16 v[56:59], v[144:147], v[168:171], v[56:59]
    ds_read2_b32 v[76:77], v237 offset0:128 offset1:129
    v_mfma_f32_16x16x32_bf16 v[56:59], v[148:151], v[164:167], v[56:59]
    ds_read_b64_tr_b16 a[42:43], v10 offset:22528
    v_cvt_pk_bf16_f32 v206, v60, v61
    v_mfma_f32_16x16x32_bf16 v[56:59], v[152:155], v[160:163], v[56:59]
    ds_read2_b32 v[78:79], v237 offset0:130 offset1:131
    v_add_u32 v11, 131072, v11
    v_mfma_f32_16x16x32_bf16 v[52:55], v[128:131], v[180:183], v[52:55]
    ds_read_b64_tr_b16 a[36:37], v11 offset:16384
    ds_read_b128 v[112:115], v244 offset:18432
    v_mfma_f32_16x16x32_bf16 v[52:55], v[132:135], v[176:179], v[52:55]
    ds_read_b64_tr_b16 a[38:39], v11 offset:18432
    s_add_u32 m0, s74, 32
    v_cvt_pk_bf16_f32 v207, v62, v63
    v_mfma_f32_16x16x32_bf16 v[52:55], v[136:139], v[172:175], v[52:55]
    ds_read_b64_tr_b16 a[44:45], v11 offset:20480
    buffer_load_dwordx4 v240, s[48:51], s13 offen offset:1024 lds
    ds_read2_b32 v[80:81], v238 offset0:0 offset1:1
    v_mfma_f32_16x16x32_bf16 v[52:55], v[140:143], v[168:171], v[52:55]
    buffer_store_dwordx2 v[206:207], v8, s[44:47], s6 offen offset:3584 sc1
    ds_read_b64_tr_b16 a[46:47], v11 offset:22528
    v_mfma_f32_16x16x32_bf16 v[52:55], v[144:147], v[164:167], v[52:55]
    ds_read2_b32 v[82:83], v238 offset0:2 offset1:3
    v_mfma_f32_16x16x32_bf16 v[52:55], v[148:151], v[160:163], v[52:55]
    ds_read_b128 v[116:119], v244 offset:22528
    v_mfma_f32_16x16x32_bf16 v[48:51], v[128:131], v[176:179], v[48:51]
    ds_read2_b32 v[84:85], v238 offset0:128 offset1:129
    v_cvt_pk_bf16_f32 v204, v56, v57
    v_mfma_f32_16x16x32_bf16 v[48:51], v[132:135], v[172:175], v[48:51]
    ds_read2_b32 v[86:87], v238 offset0:130 offset1:131
    v_mfma_f32_16x16x32_bf16 v[48:51], v[136:139], v[168:171], v[48:51]
    ds_read_b128 v[120:123], v244 offset:26624
    v_mfma_f32_16x16x32_bf16 v[48:51], v[140:143], v[164:167], v[48:51]
    ds_read2_b32 v[88:89], v239 offset0:0 offset1:1
    s_add_u32 m0, s74, 32
    v_cvt_pk_bf16_f32 v205, v58, v59
    v_mfma_f32_16x16x32_bf16 v[48:51], v[144:147], v[160:163], v[48:51]
    buffer_load_dwordx4 v240, s[48:51], s13 offen offset:2048 lds
    ds_read2_b32 v[90:91], v239 offset0:2 offset1:3
    v_mfma_f32_16x16x32_bf16 v[44:47], v[128:131], v[172:175], v[44:47]
    buffer_store_dwordx2 v[204:205], v8, s[44:47], s6 offen offset:3072 sc1
    ds_read_b128 v[124:127], v244 offset:30720
    v_mfma_f32_16x16x32_bf16 v[44:47], v[132:135], v[168:171], v[44:47]
    ds_read2_b32 v[92:93], v239 offset0:128 offset1:129
    v_mfma_f32_16x16x32_bf16 v[44:47], v[136:139], v[164:167], v[44:47]
    ds_read2_b32 v[94:95], v239 offset0:130 offset1:131
    v_mfma_f32_16x16x32_bf16 v[44:47], v[140:143], v[160:163], v[44:47]
    v_cvt_pk_bf16_f32 v202, v52, v53
    v_mfma_f32_16x16x32_bf16 v[40:43], v[128:131], v[168:171], v[40:43]
    v_mfma_f32_16x16x32_bf16 v[40:43], v[132:135], v[164:167], v[40:43]
    v_mfma_f32_16x16x32_bf16 v[40:43], v[136:139], v[160:163], v[40:43]
    s_add_u32 m0, s74, 32
    v_cvt_pk_bf16_f32 v203, v54, v55
    v_mfma_f32_16x16x32_bf16 v[36:39], v[128:131], v[164:167], v[36:39]
    buffer_load_dwordx4 v240, s[48:51], s13 offen offset:3072 lds
    v_mfma_f32_16x16x32_bf16 v[36:39], v[132:135], v[160:163], v[36:39]
    buffer_store_dwordx2 v[202:203], v8, s[44:47], s6 offen offset:2560 sc1
    v_mfma_f32_16x16x32_bf16 v[32:35], v[128:131], v[160:163], v[32:35]
    s_waitcnt lgkmcnt(0)
    v_mfma_f32_16x16x32_bf16 v[60:63], v[64:67], v[124:127], 0
    ds_read_b128 v[160:163], v245 offset:2048
    v_mfma_f32_16x16x32_bf16 v[60:63], v[68:71], v[120:123], v[60:63]
    v_cvt_pk_bf16_f32 v200, v48, v49
    v_mfma_f32_16x16x32_bf16 v[60:63], v[72:75], v[116:119], v[60:63]
    ds_read2_b32 v[128:129], v236 offset0:16 offset1:17
    v_mfma_f32_16x16x32_bf16 v[60:63], v[76:79], v[112:115], v[60:63]
    ds_read2_b32 v[130:131], v236 offset0:18 offset1:19
    v_cvt_pk_bf16_f32 v201, v50, v51
    v_mfma_f32_16x16x32_bf16 v[60:63], v[80:83], v[108:111], v[60:63]
    v_mfma_f32_16x16x32_bf16 v[60:63], v[84:87], v[104:107], v[60:63]
    buffer_store_dwordx2 v[200:201], v8, s[44:47], s6 offen offset:2048 sc1
    ds_read_b128 v[164:167], v245 offset:6144
    v_mfma_f32_16x16x32_bf16 v[60:63], v[88:91], v[100:103], v[60:63]
    ds_read2_b32 v[132:133], v236 offset0:144 offset1:145
    v_mfma_f32_16x16x32_bf16 v[60:63], v[92:95], v[96:99], v[60:63]
    ds_read2_b32 v[134:135], v236 offset0:146 offset1:147
    v_cvt_pk_bf16_f32 v198, v44, v45
    v_mfma_f32_16x16x32_bf16 v[56:59], v[64:67], v[120:123], 0
    ds_read_b128 v[168:171], v245 offset:10240
    v_mfma_f32_16x16x32_bf16 v[56:59], v[68:71], v[116:119], v[56:59]
    ds_read2_b32 v[136:137], v237 offset0:16 offset1:17
    v_mfma_f32_16x16x32_bf16 v[56:59], v[72:75], v[112:115], v[56:59]
    ds_read2_b32 v[138:139], v237 offset0:18 offset1:19
    v_cvt_pk_bf16_f32 v199, v46, v47
    v_mfma_f32_16x16x32_bf16 v[56:59], v[76:79], v[108:111], v[56:59]
    ds_read_b128 v[172:175], v245 offset:14336
    v_mfma_f32_16x16x32_bf16 v[56:59], v[80:83], v[104:107], v[56:59]
    buffer_store_dwordx2 v[198:199], v8, s[44:47], s6 offen offset:1536 sc1
    ds_read2_b32 v[140:141], v237 offset0:144 offset1:145
    v_mfma_f32_16x16x32_bf16 v[56:59], v[84:87], v[100:103], v[56:59]
    ds_read2_b32 v[142:143], v237 offset0:146 offset1:147
    v_mfma_f32_16x16x32_bf16 v[56:59], v[88:91], v[96:99], v[56:59]
    ds_read_b128 v[176:179], v245 offset:18432
    v_cvt_pk_bf16_f32 v196, v40, v41
    v_mfma_f32_16x16x32_bf16 v[52:55], v[64:67], v[116:119], 0
    ds_read2_b32 v[144:145], v238 offset0:16 offset1:17
    v_mfma_f32_16x16x32_bf16 v[52:55], v[68:71], v[112:115], v[52:55]
    ds_read2_b32 v[146:147], v238 offset0:18 offset1:19
    v_cvt_pk_bf16_f32 v197, v42, v43
    v_mfma_f32_16x16x32_bf16 v[52:55], v[72:75], v[108:111], v[52:55]
    ds_read_b128 v[180:183], v245 offset:22528
    v_mfma_f32_16x16x32_bf16 v[52:55], v[76:79], v[104:107], v[52:55]
    buffer_store_dwordx2 v[196:197], v8, s[44:47], s6 offen offset:1024 sc1
    ds_read2_b32 v[148:149], v238 offset0:144 offset1:145
    v_mfma_f32_16x16x32_bf16 v[52:55], v[80:83], v[100:103], v[52:55]
    ds_read2_b32 v[150:151], v238 offset0:146 offset1:147
    v_mfma_f32_16x16x32_bf16 v[52:55], v[84:87], v[96:99], v[52:55]
    ds_read_b128 v[184:187], v245 offset:26624
    v_mfma_f32_16x16x32_bf16 v[48:51], v[64:67], v[112:115], 0
    s_waitcnt vmcnt(10)
    s_barrier
    v_cvt_pk_bf16_f32 v194, v36, v37
    v_mfma_f32_16x16x32_bf16 v[48:51], v[68:71], v[108:111], v[48:51]
    ds_read2_b32 v[152:153], v239 offset0:16 offset1:17
    v_add_u32 v10, -131072, v10
    v_mfma_f32_16x16x32_bf16 v[48:51], v[72:75], v[104:107], v[48:51]
    ds_read_b64_tr_b16 a[48:49], v10 offset:49152
    v_cvt_pk_bf16_f32 v195, v38, v39
    v_mfma_f32_16x16x32_bf16 v[48:51], v[76:79], v[100:103], v[48:51]
    buffer_store_dwordx2 v[194:195], v8, s[44:47], s6 offen offset:512 sc1
    ds_read2_b32 v[154:155], v239 offset0:18 offset1:19
    v_mfma_f32_16x16x32_bf16 v[48:51], v[80:83], v[96:99], v[48:51]
    ds_read_b64_tr_b16 a[50:51], v10 offset:51200
    v_mfma_f32_16x16x32_bf16 v[44:47], v[64:67], v[108:111], 0
    ds_read_b64_tr_b16 a[56:57], v10 offset:53248
    v_mfma_f32_16x16x32_bf16 v[44:47], v[68:71], v[104:107], v[44:47]
    ds_read_b64_tr_b16 a[58:59], v10 offset:55296
    v_cvt_pk_bf16_f32 v192, v32, v33
    v_mfma_f32_16x16x32_bf16 v[44:47], v[72:75], v[100:103], v[44:47]
    ds_read_b128 v[188:191], v245 offset:30720
    v_add_u32 v11, -131072, v11
    v_mfma_f32_16x16x32_bf16 v[44:47], v[76:79], v[96:99], v[44:47]
    ds_read_b64_tr_b16 a[52:53], v11 offset:49152
    v_cvt_pk_bf16_f32 v193, v34, v35
    v_mfma_f32_16x16x32_bf16 v[40:43], v[64:67], v[104:107], 0
    buffer_store_dwordx2 v[192:193], v8, s[44:47], s6 offen offset:0 sc1
    ds_read2_b32 v[156:157], v239 offset0:144 offset1:145
    v_mfma_f32_16x16x32_bf16 v[40:43], v[68:71], v[100:103], v[40:43]
    ds_read_b64_tr_b16 a[54:55], v11 offset:51200
    v_mfma_f32_16x16x32_bf16 v[40:43], v[72:75], v[96:99], v[40:43]
    ds_read_b64_tr_b16 a[60:61], v11 offset:53248
    v_mfma_f32_16x16x32_bf16 v[36:39], v[64:67], v[100:103], 0
    ds_read_b64_tr_b16 a[62:63], v11 offset:55296
    v_mfma_f32_16x16x32_bf16 v[36:39], v[68:71], v[96:99], v[36:39]
    ds_read2_b32 v[158:159], v239 offset0:146 offset1:147
    v_mfma_f32_16x16x32_bf16 v[32:35], v[64:67], v[96:99], 0
    s_waitcnt lgkmcnt(15)
    v_mfma_f32_16x16x32_bf16 v[32:35], v[128:131], v[160:163], v[32:35]
    ds_read_b128 v[96:99], v246 offset:2048
    v_mfma_f32_16x16x32_bf16 v[36:39], v[132:135], v[160:163], v[36:39]
    v_mfma_f32_16x16x32_bf16 v[36:39], v[128:131], v[164:167], v[36:39]
    ds_read2_b32 v[64:65], v236 offset0:32 offset1:33
    v_mfma_f32_16x16x32_bf16 v[40:43], v[128:131], v[168:171], v[40:43]
    ds_read2_b32 v[66:67], v236 offset0:34 offset1:35
    v_mfma_f32_16x16x32_bf16 v[40:43], v[132:135], v[164:167], v[40:43]
    v_mfma_f32_16x16x32_bf16 v[40:43], v[136:139], v[160:163], v[40:43]
    ds_read_b128 v[100:103], v246 offset:6144
    v_mfma_f32_16x16x32_bf16 v[44:47], v[140:143], v[160:163], v[44:47]
    ds_read2_b32 v[68:69], v236 offset0:160 offset1:161
    v_mfma_f32_16x16x32_bf16 v[44:47], v[136:139], v[164:167], v[44:47]
    v_mfma_f32_16x16x32_bf16 v[44:47], v[132:135], v[168:171], v[44:47]
    ds_read2_b32 v[70:71], v236 offset0:162 offset1:163
    v_mfma_f32_16x16x32_bf16 v[44:47], v[128:131], v[172:175], v[44:47]
    ds_read_b128 v[104:107], v246 offset:10240
    s_waitcnt lgkmcnt(7)
    v_mfma_f32_16x16x32_bf16 v[48:51], v[128:131], v[176:179], v[48:51]
    ds_read2_b32 v[72:73], v237 offset0:32 offset1:33
    v_mfma_f32_16x16x32_bf16 v[48:51], v[132:135], v[172:175], v[48:51]
    ds_read2_b32 v[74:75], v237 offset0:34 offset1:35
    v_mfma_f32_16x16x32_bf16 v[48:51], v[136:139], v[168:171], v[48:51]
    v_mov_b32 v9, 16
    buffer_load_ushort v9, v9, s[56:59], s70 offen
    v_mfma_f32_16x16x32_bf16 v[48:51], v[140:143], v[164:167], v[48:51]
    ds_read_b128 v[108:111], v246 offset:14336
    v_mfma_f32_16x16x32_bf16 v[48:51], v[144:147], v[160:163], v[48:51]
    v_mfma_f32_16x16x32_bf16 v[52:55], v[148:151], v[160:163], v[52:55]
    ds_read2_b32 v[76:77], v237 offset0:160 offset1:161
    v_mfma_f32_16x16x32_bf16 v[52:55], v[144:147], v[164:167], v[52:55]
    ds_read2_b32 v[78:79], v237 offset0:162 offset1:163
    v_mfma_f32_16x16x32_bf16 v[52:55], v[140:143], v[168:171], v[52:55]
    v_mfma_f32_16x16x32_bf16 v[52:55], v[136:139], v[172:175], v[52:55]
    s_lshl_b32 s14, s88, 18
    ds_read_b128 v[112:115], v246 offset:18432
    v_mfma_f32_16x16x32_bf16 v[52:55], v[132:135], v[176:179], v[52:55]
    s_add_u32 m0, s73, 147456
    ds_read2_b32 v[80:81], v238 offset0:32 offset1:33
    v_mfma_f32_16x16x32_bf16 v[52:55], v[128:131], v[180:183], v[52:55]
    buffer_load_dwordx4 v4, s[52:55], s14 offen offset:0 lds
    v_mfma_f32_16x16x32_bf16 v[56:59], v[128:131], v[184:187], v[56:59]
    ds_read2_b32 v[82:83], v238 offset0:34 offset1:35
    v_mfma_f32_16x16x32_bf16 v[56:59], v[132:135], v[180:183], v[56:59]
    ds_read_b128 v[116:119], v246 offset:22528
    v_mfma_f32_16x16x32_bf16 v[56:59], v[136:139], v[176:179], v[56:59]
    v_mfma_f32_16x16x32_bf16 v[56:59], v[140:143], v[172:175], v[56:59]
    ds_read2_b32 v[84:85], v238 offset0:160 offset1:161
    v_mfma_f32_16x16x32_bf16 v[56:59], v[144:147], v[168:171], v[56:59]
    ds_read2_b32 v[86:87], v238 offset0:162 offset1:163
    v_mfma_f32_16x16x32_bf16 v[56:59], v[148:151], v[164:167], v[56:59]
    s_add_u32 m0, s73, 147456
    ds_read_b128 v[120:123], v246 offset:26624
    v_mfma_f32_16x16x32_bf16 v[56:59], v[152:155], v[160:163], v[56:59]
    buffer_load_dwordx4 v5, s[52:55], s14 offen offset:1024 lds
    v_mfma_f32_16x16x32_bf16 v[60:63], v[156:159], v[160:163], v[60:63]
    ds_read2_b32 v[88:89], v239 offset0:32 offset1:33
    v_mfma_f32_16x16x32_bf16 v[60:63], v[152:155], v[164:167], v[60:63]
    ds_read2_b32 v[90:91], v239 offset0:34 offset1:35
    v_mfma_f32_16x16x32_bf16 v[60:63], v[148:151], v[168:171], v[60:63]
    v_mfma_f32_16x16x32_bf16 v[60:63], v[144:147], v[172:175], v[60:63]
    ds_read_b128 v[124:127], v246 offset:30720
    v_mfma_f32_16x16x32_bf16 v[60:63], v[140:143], v[176:179], v[60:63]
    ds_read2_b32 v[92:93], v239 offset0:160 offset1:161
    v_mfma_f32_16x16x32_bf16 v[60:63], v[136:139], v[180:183], v[60:63]
    s_add_u32 m0, s73, 147456
    v_mfma_f32_16x16x32_bf16 v[60:63], v[132:135], v[184:187], v[60:63]
    buffer_load_dwordx4 v6, s[52:55], s14 offen offset:2048 lds
    ds_read2_b32 v[94:95], v239 offset0:162 offset1:163
    v_mfma_f32_16x16x32_bf16 v[60:63], v[128:131], v[188:191], v[60:63]
    s_waitcnt lgkmcnt(12)
    v_mfma_f32_16x16x32_bf16 v[32:35], v[64:67], v[96:99], v[32:35]
    ds_read_b128 v[160:163], v247 offset:2048
    v_mfma_f32_16x16x32_bf16 v[36:39], v[68:71], v[96:99], v[36:39]
    v_mfma_f32_16x16x32_bf16 v[36:39], v[64:67], v[100:103], v[36:39]
    ds_read2_b32 v[128:129], v236 offset0:48 offset1:49
    v_mfma_f32_16x16x32_bf16 v[40:43], v[64:67], v[104:107], v[40:43]
    ds_read2_b32 v[130:131], v236 offset0:50 offset1:51
    v_mfma_f32_16x16x32_bf16 v[40:43], v[68:71], v[100:103], v[40:43]
    s_add_u32 m0, s73, 147456
    v_mfma_f32_16x16x32_bf16 v[40:43], v[72:75], v[96:99], v[40:43]
    buffer_load_dwordx4 v7, s[52:55], s14 offen offset:3072 lds
    ds_read_b128 v[164:167], v247 offset:6144
    v_mfma_f32_16x16x32_bf16 v[44:47], v[76:79], v[96:99], v[44:47]
    ds_read2_b32 v[132:133], v236 offset0:176 offset1:177
    v_mfma_f32_16x16x32_bf16 v[44:47], v[72:75], v[100:103], v[44:47]
    s_barrier
    v_mfma_f32_16x16x32_bf16 v[44:47], v[68:71], v[104:107], v[44:47]
    ds_read2_b32 v[134:135], v236 offset0:178 offset1:179
    v_mfma_f32_16x16x32_bf16 v[44:47], v[64:67], v[108:111], v[44:47]
    ds_read_b128 v[168:171], v247 offset:10240
    s_waitcnt lgkmcnt(7)
    v_mfma_f32_16x16x32_bf16 v[48:51], v[64:67], v[112:115], v[48:51]
    ds_read2_b32 v[136:137], v237 offset0:48 offset1:49
    v_mfma_f32_16x16x32_bf16 v[48:51], v[68:71], v[108:111], v[48:51]
    v_mfma_f32_16x16x32_bf16 v[48:51], v[72:75], v[104:107], v[48:51]
    ds_read2_b32 v[138:139], v237 offset0:50 offset1:51
    v_mfma_f32_16x16x32_bf16 v[48:51], v[76:79], v[100:103], v[48:51]
    ds_read_b128 v[172:175], v247 offset:14336
    v_mfma_f32_16x16x32_bf16 v[48:51], v[80:83], v[96:99], v[48:51]
    v_mfma_f32_16x16x32_bf16 v[52:55], v[84:87], v[96:99], v[52:55]
    ds_read2_b32 v[140:141], v237 offset0:176 offset1:177
    v_mfma_f32_16x16x32_bf16 v[52:55], v[80:83], v[100:103], v[52:55]
    ds_read2_b32 v[142:143], v237 offset0:178 offset1:179
    v_mfma_f32_16x16x32_bf16 v[52:55], v[76:79], v[104:107], v[52:55]
    v_mfma_f32_16x16x32_bf16 v[52:55], v[72:75], v[108:111], v[52:55]
    ds_read_b128 v[176:179], v247 offset:18432
    v_mfma_f32_16x16x32_bf16 v[52:55], v[68:71], v[112:115], v[52:55]
    ds_read2_b32 v[144:145], v238 offset0:48 offset1:49
    v_mfma_f32_16x16x32_bf16 v[52:55], v[64:67], v[116:119], v[52:55]
    v_mfma_f32_16x16x32_bf16 v[56:59], v[64:67], v[120:123], v[56:59]
    ds_read2_b32 v[146:147], v238 offset0:50 offset1:51
    v_mfma_f32_16x16x32_bf16 v[56:59], v[68:71], v[116:119], v[56:59]
    ds_read_b128 v[180:183], v247 offset:22528
    v_mfma_f32_16x16x32_bf16 v[56:59], v[72:75], v[112:115], v[56:59]
    v_mfma_f32_16x16x32_bf16 v[56:59], v[76:79], v[108:111], v[56:59]
    ds_read2_b32 v[148:149], v238 offset0:176 offset1:177
    v_mfma_f32_16x16x32_bf16 v[56:59], v[80:83], v[104:107], v[56:59]
    ds_read2_b32 v[150:151], v238 offset0:178 offset1:179
    v_mfma_f32_16x16x32_bf16 v[56:59], v[84:87], v[100:103], v[56:59]
    ds_read_b128 v[184:187], v247 offset:26624
    v_mfma_f32_16x16x32_bf16 v[56:59], v[88:91], v[96:99], v[56:59]
    v_mfma_f32_16x16x32_bf16 v[60:63], v[92:95], v[96:99], v[60:63]
    ds_read2_b32 v[152:153], v239 offset0:48 offset1:49
    v_mfma_f32_16x16x32_bf16 v[60:63], v[88:91], v[100:103], v[60:63]
    ds_read2_b32 v[154:155], v239 offset0:50 offset1:51
    v_mfma_f32_16x16x32_bf16 v[60:63], v[84:87], v[104:107], v[60:63]
    v_mfma_f32_16x16x32_bf16 v[60:63], v[80:83], v[108:111], v[60:63]
    ds_read_b128 v[188:191], v247 offset:30720
    v_mfma_f32_16x16x32_bf16 v[60:63], v[76:79], v[112:115], v[60:63]
    ds_read2_b32 v[156:157], v239 offset0:176 offset1:177
    v_mfma_f32_16x16x32_bf16 v[60:63], v[72:75], v[116:119], v[60:63]
    v_mfma_f32_16x16x32_bf16 v[60:63], v[68:71], v[120:123], v[60:63]
    ds_read2_b32 v[158:159], v239 offset0:178 offset1:179
    v_mfma_f32_16x16x32_bf16 v[60:63], v[64:67], v[124:127], v[60:63]
    s_waitcnt lgkmcnt(12)
    v_mfma_f32_16x16x32_bf16 v[32:35], v[128:131], v[160:163], v[32:35]
    ds_read_b128 v[96:99], v244 offset:0
    v_mfma_f32_16x16x32_bf16 v[36:39], v[132:135], v[160:163], v[36:39]
    v_mfma_f32_16x16x32_bf16 v[36:39], v[128:131], v[164:167], v[36:39]
    ds_read2_b32 v[64:65], v236 offset0:64 offset1:65
    v_mfma_f32_16x16x32_bf16 v[40:43], v[128:131], v[168:171], v[40:43]
    ds_read2_b32 v[66:67], v236 offset0:66 offset1:67
    v_mfma_f32_16x16x32_bf16 v[40:43], v[132:135], v[164:167], v[40:43]
    v_mfma_f32_16x16x32_bf16 v[40:43], v[136:139], v[160:163], v[40:43]
    ds_read_b128 v[100:103], v244 offset:4096
    v_mfma_f32_16x16x32_bf16 v[44:47], v[140:143], v[160:163], v[44:47]
    ds_read2_b32 v[68:69], v236 offset0:192 offset1:193
    v_mfma_f32_16x16x32_bf16 v[44:47], v[136:139], v[164:167], v[44:47]
    s_add_u32 m0, s9, 36864
    s_add_u32 s13, s11, 0
    v_mfma_f32_16x16x32_bf16 v[44:47], v[132:135], v[168:171], v[44:47]
    buffer_load_dwordx4 v15, s[44:47], s13 offen sc1 lds
    ds_read2_b32 v[70:71], v236 offset0:194 offset1:195
    v_mfma_f32_16x16x32_bf16 v[44:47], v[128:131], v[172:175], v[44:47]
    ds_read_b128 v[104:107], v244 offset:8192
    s_waitcnt lgkmcnt(7)
    v_mfma_f32_16x16x32_bf16 v[48:51], v[128:131], v[176:179], v[48:51]
    ds_read2_b32 v[72:73], v237 offset0:64 offset1:65
    v_mfma_f32_16x16x32_bf16 v[48:51], v[132:135], v[172:175], v[48:51]
    v_mfma_f32_16x16x32_bf16 v[48:51], v[136:139], v[168:171], v[48:51]
    ds_read2_b32 v[74:75], v237 offset0:66 offset1:67
    v_mfma_f32_16x16x32_bf16 v[48:51], v[140:143], v[164:167], v[48:51]
    ds_read_b128 v[108:111], v244 offset:12288
    v_mfma_f32_16x16x32_bf16 v[48:51], v[144:147], v[160:163], v[48:51]
    v_mfma_f32_16x16x32_bf16 v[52:55], v[148:151], v[160:163], v[52:55]
    ds_read2_b32 v[76:77], v237 offset0:192 offset1:193
    v_mfma_f32_16x16x32_bf16 v[52:55], v[144:147], v[164:167], v[52:55]
    ds_read2_b32 v[78:79], v237 offset0:194 offset1:195
    s_add_u32 m0, s9, 37888
    s_add_u32 s13, s11, 90112
    v_mfma_f32_16x16x32_bf16 v[52:55], v[140:143], v[168:171], v[52:55]
    buffer_load_dwordx4 v16, s[44:47], s13 offen sc1 lds
    v_mfma_f32_16x16x32_bf16 v[52:55], v[136:139], v[172:175], v[52:55]
    ds_read_b128 v[112:115], v244 offset:16384
    v_mfma_f32_16x16x32_bf16 v[52:55], v[132:135], v[176:179], v[52:55]
    ds_read2_b32 v[80:81], v238 offset0:64 offset1:65
    v_mfma_f32_16x16x32_bf16 v[52:55], v[128:131], v[180:183], v[52:55]
    v_mfma_f32_16x16x32_bf16 v[56:59], v[128:131], v[184:187], v[56:59]
    ds_read2_b32 v[82:83], v238 offset0:66 offset1:67
    v_mfma_f32_16x16x32_bf16 v[56:59], v[132:135], v[180:183], v[56:59]
    ds_read_b128 v[116:119], v244 offset:20480
    v_mfma_f32_16x16x32_bf16 v[56:59], v[136:139], v[176:179], v[56:59]
    v_mfma_f32_16x16x32_bf16 v[56:59], v[140:143], v[172:175], v[56:59]
    ds_read2_b32 v[84:85], v238 offset0:192 offset1:193
    v_mfma_f32_16x16x32_bf16 v[56:59], v[144:147], v[168:171], v[56:59]
    ds_read2_b32 v[86:87], v238 offset0:194 offset1:195
    s_add_u32 m0, s9, 38912
    s_add_u32 s13, s11, 180224
    v_mfma_f32_16x16x32_bf16 v[56:59], v[148:151], v[164:167], v[56:59]
    buffer_load_dwordx4 v15, s[44:47], s13 offen sc1 lds
    ds_read_b128 v[120:123], v244 offset:24576
    v_mfma_f32_16x16x32_bf16 v[56:59], v[152:155], v[160:163], v[56:59]
    v_mfma_f32_16x16x32_bf16 v[60:63], v[156:159], v[160:163], v[60:63]
    ds_read2_b32 v[88:89], v239 offset0:64 offset1:65
    v_mfma_f32_16x16x32_bf16 v[60:63], v[152:155], v[164:167], v[60:63]
    ds_read2_b32 v[90:91], v239 offset0:66 offset1:67
    v_mfma_f32_16x16x32_bf16 v[60:63], v[148:151], v[168:171], v[60:63]
    v_mfma_f32_16x16x32_bf16 v[60:63], v[144:147], v[172:175], v[60:63]
    ds_read_b128 v[124:127], v244 offset:28672
    v_mfma_f32_16x16x32_bf16 v[60:63], v[140:143], v[176:179], v[60:63]
    ds_read2_b32 v[92:93], v239 offset0:192 offset1:193
    v_mfma_f32_16x16x32_bf16 v[60:63], v[136:139], v[180:183], v[60:63]
    v_mfma_f32_16x16x32_bf16 v[60:63], v[132:135], v[184:187], v[60:63]
    ds_read2_b32 v[94:95], v239 offset0:194 offset1:195
    s_add_u32 m0, s9, 39936
    s_add_u32 s13, s11, 270336
    v_mfma_f32_16x16x32_bf16 v[60:63], v[128:131], v[188:191], v[60:63]
    buffer_load_dwordx4 v16, s[44:47], s13 offen sc1 lds
    s_waitcnt lgkmcnt(12)
    v_mfma_f32_16x16x32_bf16 v[32:35], v[64:67], v[96:99], v[32:35]
    ds_read_b128 v[160:163], v245 offset:0
    s_waitcnt vmcnt(4)
    s_barrier
    v_mfma_f32_16x16x32_bf16 v[36:39], v[68:71], v[96:99], v[36:39]
    ds_read2_b32 v[128:129], v236 offset0:80 offset1:81
    v_add_u32 v10, 131072, v10
    v_mfma_f32_16x16x32_bf16 v[36:39], v[64:67], v[100:103], v[36:39]
    ds_read_b64_tr_b16 a[64:65], v10 offset:16384
    v_mfma_f32_16x16x32_bf16 v[40:43], v[64:67], v[104:107], v[40:43]
    ds_read_b64_tr_b16 a[66:67], v10 offset:18432
    ds_read2_b32 v[130:131], v236 offset0:82 offset1:83
    v_mfma_f32_16x16x32_bf16 v[40:43], v[68:71], v[100:103], v[40:43]
    ds_read_b64_tr_b16 a[72:73], v10 offset:20480
    v_mfma_f32_16x16x32_bf16 v[40:43], v[72:75], v[96:99], v[40:43]
    ds_read_b64_tr_b16 a[74:75], v10 offset:22528
    ds_read_b128 v[164:167], v245 offset:4096
L_pl_X_3:
    s_cbranch_execz L_pl_X_7
    v_mfma_f32_16x16x32_bf16 v[44:47], v[76:79], v[96:99], v[44:47]
    ds_read2_b32 v[132:133], v236 offset0:208 offset1:209
    v_mfma_f32_16x16x32_bf16 v[44:47], v[72:75], v[100:103], v[44:47]
    v_add_u32 v11, 131072, v11
    s_add_u32 m0, s9, 40960
    s_add_u32 s13, s11, 360448
    v_mfma_f32_16x16x32_bf16 v[44:47], v[68:71], v[104:107], v[44:47]
    ds_read_b64_tr_b16 a[68:69], v11 offset:16384
    buffer_load_dwordx4 v15, s[44:47], s13 offen sc1 lds
    ds_read2_b32 v[134:135], v236 offset0:210 offset1:211
    v_mfma_f32_16x16x32_bf16 v[44:47], v[64:67], v[108:111], v[44:47]
    ds_read_b64_tr_b16 a[70:71], v11 offset:18432
    ds_read_b128 v[168:171], v245 offset:8192
    s_waitcnt lgkmcnt(13)
    v_mfma_f32_16x16x32_bf16 v[48:51], v[64:67], v[112:115], v[48:51]
    ds_read_b64_tr_b16 a[76:77], v11 offset:20480
    v_mfma_f32_16x16x32_bf16 v[48:51], v[68:71], v[108:111], v[48:51]
    ds_read_b64_tr_b16 a[78:79], v11 offset:22528
    v_mfma_f32_16x16x32_bf16 v[48:51], v[72:75], v[104:107], v[48:51]
    ds_read2_b32 v[136:137], v237 offset0:80 offset1:81
    v_mfma_f32_16x16x32_bf16 v[48:51], v[76:79], v[100:103], v[48:51]
    ds_read2_b32 v[138:139], v237 offset0:82 offset1:83
    v_mfma_f32_16x16x32_bf16 v[48:51], v[80:83], v[96:99], v[48:51]
    ds_read_b128 v[172:175], v245 offset:12288
    v_mfma_f32_16x16x32_bf16 v[52:55], v[84:87], v[96:99], v[52:55]
    ds_read2_b32 v[140:141], v237 offset0:208 offset1:209
    v_mfma_f32_16x16x32_bf16 v[52:55], v[80:83], v[100:103], v[52:55]
    ds_read2_b32 v[142:143], v237 offset0:210 offset1:211
    s_add_u32 m0, s9, 41984
    s_add_u32 s13, s11, 450560
    v_mfma_f32_16x16x32_bf16 v[52:55], v[76:79], v[104:107], v[52:55]
    buffer_load_dwordx4 v16, s[44:47], s13 offen sc1 lds
    ds_read_b128 v[176:179], v245 offset:16384
    v_mfma_f32_16x16x32_bf16 v[52:55], v[72:75], v[108:111], v[52:55]
    ds_read2_b32 v[144:145], v238 offset0:80 offset1:81
    v_mfma_f32_16x16x32_bf16 v[52:55], v[68:71], v[112:115], v[52:55]
    ds_read_b128 v[212:215], v241 offset:32
    v_mfma_f32_16x16x32_bf16 v[52:55], v[64:67], v[116:119], v[52:55]
    ds_read2_b32 v[146:147], v238 offset0:82 offset1:83
    v_mfma_f32_16x16x32_bf16 v[56:59], v[64:67], v[120:123], v[56:59]
    ds_read_b32 v216, v241 offset:48
    v_mfma_f32_16x16x32_bf16 v[56:59], v[68:71], v[116:119], v[56:59]
    ds_read_b128 v[180:183], v245 offset:20480
    v_mfma_f32_16x16x32_bf16 v[56:59], v[72:75], v[112:115], v[56:59]
    ds_read_b128 v[218:221], v241 offset:1056
    v_mfma_f32_16x16x32_bf16 v[56:59], v[76:79], v[108:111], v[56:59]
    ds_read2_b32 v[148:149], v238 offset0:208 offset1:209
    v_mfma_f32_16x16x32_bf16 v[56:59], v[80:83], v[104:107], v[56:59]
    ds_read2_b32 v[150:151], v238 offset0:210 offset1:211
    s_add_u32 m0, s9, 43008
    s_add_u32 s13, s11, 540672
    v_mfma_f32_16x16x32_bf16 v[56:59], v[84:87], v[100:103], v[56:59]
    buffer_load_dwordx4 v15, s[44:47], s13 offen sc1 lds
    ds_read_b32 v222, v241 offset:1072
    v_mfma_f32_16x16x32_bf16 v[56:59], v[88:91], v[96:99], v[56:59]
    ds_read_b128 v[184:187], v245 offset:24576
    v_mfma_f32_16x16x32_bf16 v[60:63], v[92:95], v[96:99], v[60:63]
    ds_read_b128 v[224:227], v241 offset:2080
    ds_read2_b32 v[152:153], v239 offset0:80 offset1:81
    v_mfma_f32_16x16x32_bf16 v[60:63], v[88:91], v[100:103], v[60:63]
    ds_read2_b32 v[154:155], v239 offset0:82 offset1:83
    v_mfma_f32_16x16x32_bf16 v[60:63], v[84:87], v[104:107], v[60:63]
    ds_read_b32 v228, v241 offset:2096
    v_mfma_f32_16x16x32_bf16 v[60:63], v[80:83], v[108:111], v[60:63]
    ds_read_b128 v[188:191], v245 offset:28672
    v_mfma_f32_16x16x32_bf16 v[60:63], v[76:79], v[112:115], v[60:63]
    ds_read_b128 v[230:233], v241 offset:3104
    ds_read2_b32 v[156:157], v239 offset0:208 offset1:209
    v_mfma_f32_16x16x32_bf16 v[60:63], v[72:75], v[116:119], v[60:63]
    ds_read2_b32 v[158:159], v239 offset0:210 offset1:211
    v_mfma_f32_16x16x32_bf16 v[60:63], v[68:71], v[120:123], v[60:63]
    ds_read_b32 v234, v241 offset:3120
    s_add_u32 m0, s9, 44032
    s_add_u32 s13, s11, 630784
    v_mfma_f32_16x16x32_bf16 v[60:63], v[64:67], v[124:127], v[60:63]
    buffer_load_dwordx4 v16, s[44:47], s13 offen sc1 lds
    s_waitcnt lgkmcnt(15)
    v_mfma_f32_16x16x32_bf16 v[32:35], v[128:131], v[160:163], v[32:35]
    ds_read_b128 v[96:99], v246 offset:0
    v_mfma_f32_16x16x32_bf16 v[36:39], v[132:135], v[160:163], v[36:39]
    v_mfma_f32_16x16x32_bf16 v[36:39], v[128:131], v[164:167], v[36:39]
    ds_read2_b32 v[64:65], v236 offset0:96 offset1:97
    v_mfma_f32_16x16x32_bf16 v[40:43], v[128:131], v[168:171], v[40:43]
    ds_read2_b32 v[66:67], v236 offset0:98 offset1:99
    v_mfma_f32_16x16x32_bf16 v[40:43], v[132:135], v[164:167], v[40:43]
    s_waitcnt lgkmcnt(3)
    v_mfma_f32_16x16x32_bf16 v[40:43], v[136:139], v[160:163], v[40:43]
    ds_read_b128 v[100:103], v246 offset:4096
    v_mfma_f32_16x16x32_bf16 v[44:47], v[140:143], v[160:163], v[44:47]
    ds_read2_b32 v[68:69], v236 offset0:224 offset1:225
    v_mfma_f32_16x16x32_bf16 v[44:47], v[136:139], v[164:167], v[44:47]
    v_mfma_f32_16x16x32_bf16 v[44:47], v[132:135], v[168:171], v[44:47]
    ds_read2_b32 v[70:71], v236 offset0:226 offset1:227
    v_lshlrev_b32 v9, 16, v9
    v_mfma_f32_16x16x32_bf16 v[44:47], v[128:131], v[172:175], v[44:47]
    ds_read_b128 v[104:107], v246 offset:8192
    v_mfma_f32_16x16x32_bf16 v[48:51], v[128:131], v[176:179], v[48:51]
    ds_read2_b32 v[72:73], v237 offset0:96 offset1:97
    v_lshlrev_b32 v208, 16, v212
    v_mfma_f32_16x16x32_bf16 v[48:51], v[132:135], v[172:175], v[48:51]
    v_mfma_f32_16x16x32_bf16 v[48:51], v[136:139], v[168:171], v[48:51]
    ds_read2_b32 v[74:75], v237 offset0:98 offset1:99
    v_add_f32 v9, v9, v208
    v_mfma_f32_16x16x32_bf16 v[48:51], v[140:143], v[164:167], v[48:51]
    ds_read_b128 v[108:111], v246 offset:12288
    v_cvt_pk_bf16_f32 v9, v9, v9
    v_mfma_f32_16x16x32_bf16 v[48:51], v[144:147], v[160:163], v[48:51]
    ds_read2_b32 v[76:77], v237 offset0:224 offset1:225
    s_barrier
    v_mfma_f32_16x16x32_bf16 v[52:55], v[148:151], v[160:163], v[52:55]
    ds_write_b16 v242, v9 offset:4160
    v_mfma_f32_16x16x32_bf16 v[52:55], v[144:147], v[164:167], v[52:55]
    ds_read2_b32 v[78:79], v237 offset0:226 offset1:227
    v_mfma_f32_16x16x32_bf16 v[52:55], v[140:143], v[168:171], v[52:55]
    ds_write_b16 v242, v9 offset:2
    v_mfma_f32_16x16x32_bf16 v[52:55], v[136:139], v[172:175], v[52:55]
    s_lshl_b32 s14, s89, 18
    ds_read_b128 v[112:115], v246 offset:16384
    v_mfma_f32_16x16x32_bf16 v[52:55], v[132:135], v[176:179], v[52:55]
    ds_read2_b32 v[80:81], v238 offset0:96 offset1:97
    s_add_u32 m0, s73, 147456
    v_alignbit_b32 v212, v213, v212, 16
    v_mfma_f32_16x16x32_bf16 v[52:55], v[128:131], v[180:183], v[52:55]
    buffer_load_dwordx4 v4, s[52:55], s14 offen offset:0 lds
    v_alignbit_b32 v213, v214, v213, 16
    v_mfma_f32_16x16x32_bf16 v[56:59], v[128:131], v[184:187], v[56:59]
    ds_read2_b32 v[82:83], v238 offset0:98 offset1:99
    v_mfma_f32_16x16x32_bf16 v[56:59], v[132:135], v[180:183], v[56:59]
    ds_read_b128 v[116:119], v246 offset:20480
    v_alignbit_b32 v214, v215, v214, 16
    v_mfma_f32_16x16x32_bf16 v[56:59], v[136:139], v[176:179], v[56:59]
    v_mfma_f32_16x16x32_bf16 v[56:59], v[140:143], v[172:175], v[56:59]
    ds_read2_b32 v[84:85], v238 offset0:224 offset1:225
    v_alignbit_b32 v215, v216, v215, 16
    v_mfma_f32_16x16x32_bf16 v[56:59], v[144:147], v[168:171], v[56:59]
    ds_write_b128 v241, v[212:215] offset:4192
    v_mfma_f32_16x16x32_bf16 v[56:59], v[148:151], v[164:167], v[56:59]
    s_add_u32 m0, s73, 147456
    ds_read2_b32 v[86:87], v238 offset0:226 offset1:227
    v_mfma_f32_16x16x32_bf16 v[56:59], v[152:155], v[160:163], v[56:59]
    buffer_load_dwordx4 v5, s[52:55], s14 offen offset:1024 lds
    ds_read_b128 v[120:123], v246 offset:24576
    v_mfma_f32_16x16x32_bf16 v[60:63], v[156:159], v[160:163], v[60:63]
    ds_read2_b32 v[88:89], v239 offset0:96 offset1:97
    v_alignbit_b32 v218, v219, v218, 16
    v_mfma_f32_16x16x32_bf16 v[60:63], v[152:155], v[164:167], v[60:63]
    ds_read2_b32 v[90:91], v239 offset0:98 offset1:99
    v_alignbit_b32 v219, v220, v219, 16
    v_mfma_f32_16x16x32_bf16 v[60:63], v[148:151], v[168:171], v[60:63]
    ds_read_b128 v[124:127], v246 offset:28672
    v_mfma_f32_16x16x32_bf16 v[60:63], v[144:147], v[172:175], v[60:63]
    v_alignbit_b32 v220, v221, v220, 16
    v_alignbit_b32 v221, v222, v221, 16
    v_mfma_f32_16x16x32_bf16 v[60:63], v[140:143], v[176:179], v[60:63]
    ds_write_b128 v241, v[218:221] offset:5216
    v_mfma_f32_16x16x32_bf16 v[60:63], v[136:139], v[180:183], v[60:63]
    s_add_u32 m0, s73, 147456
    ds_read2_b32 v[92:93], v239 offset0:224 offset1:225
    v_mfma_f32_16x16x32_bf16 v[60:63], v[132:135], v[184:187], v[60:63]
    buffer_load_dwordx4 v6, s[52:55], s14 offen offset:2048 lds
    ds_read2_b32 v[94:95], v239 offset0:226 offset1:227
    v_mfma_f32_16x16x32_bf16 v[60:63], v[128:131], v[188:191], v[60:63]
    s_waitcnt lgkmcnt(15)
    v_mfma_f32_16x16x32_bf16 v[32:35], v[64:67], v[96:99], v[32:35]
    ds_read_b128 v[160:163], v247 offset:0
    v_mfma_f32_16x16x32_bf16 v[36:39], v[68:71], v[96:99], v[36:39]
    v_alignbit_b32 v224, v225, v224, 16
    v_mfma_f32_16x16x32_bf16 v[36:39], v[64:67], v[100:103], v[36:39]
    ds_read_b128 v[164:167], v247 offset:4096
    v_mfma_f32_16x16x32_bf16 v[40:43], v[64:67], v[104:107], v[40:43]
    ds_read_b128 v[168:171], v247 offset:8192
    v_mfma_f32_16x16x32_bf16 v[40:43], v[68:71], v[100:103], v[40:43]
    s_add_u32 m0, s73, 147456
    ds_read_b128 v[172:175], v247 offset:12288
    v_mfma_f32_16x16x32_bf16 v[40:43], v[72:75], v[96:99], v[40:43]
    buffer_load_dwordx4 v7, s[52:55], s14 offen offset:3072 lds
    v_alignbit_b32 v225, v226, v225, 16
    v_mfma_f32_16x16x32_bf16 v[44:47], v[76:79], v[96:99], v[44:47]
    ds_read_b128 v[176:179], v247 offset:16384
    v_mfma_f32_16x16x32_bf16 v[44:47], v[72:75], v[100:103], v[44:47]
    ds_read_b128 v[180:183], v247 offset:20480
    v_mfma_f32_16x16x32_bf16 v[44:47], v[68:71], v[104:107], v[44:47]
    ds_read_b128 v[184:187], v247 offset:24576
    v_mfma_f32_16x16x32_bf16 v[44:47], v[64:67], v[108:111], v[44:47]
    v_alignbit_b32 v226, v227, v226, 16
    s_waitcnt lgkmcnt(7)
    v_mfma_f32_16x16x32_bf16 v[48:51], v[64:67], v[112:115], v[48:51]
    ds_read_b128 v[188:191], v247 offset:28672
    v_mfma_f32_16x16x32_bf16 v[48:51], v[68:71], v[108:111], v[48:51]
    ds_read2_b32 v[128:129], v236 offset0:112 offset1:113
    v_mfma_f32_16x16x32_bf16 v[48:51], v[72:75], v[104:107], v[48:51]
    v_alignbit_b32 v227, v228, v227, 16
    v_mfma_f32_16x16x32_bf16 v[48:51], v[76:79], v[100:103], v[48:51]
    ds_read2_b32 v[130:131], v236 offset0:114 offset1:115
    v_mfma_f32_16x16x32_bf16 v[48:51], v[80:83], v[96:99], v[48:51]
    ds_read2_b32 v[132:133], v236 offset0:240 offset1:241
    v_mfma_f32_16x16x32_bf16 v[52:55], v[84:87], v[96:99], v[52:55]
    ds_read2_b32 v[134:135], v236 offset0:242 offset1:243
    v_mfma_f32_16x16x32_bf16 v[52:55], v[80:83], v[100:103], v[52:55]
    ds_write_b128 v241, v[224:227] offset:6240
    v_mfma_f32_16x16x32_bf16 v[52:55], v[76:79], v[104:107], v[52:55]
    ds_read2_b32 v[136:137], v237 offset0:112 offset1:113
    ds_read2_b32 v[138:139], v237 offset0:114 offset1:115
    v_mfma_f32_16x16x32_bf16 v[52:55], v[72:75], v[108:111], v[52:55]
    s_add_u32 s6, s12, 4734976
    ds_read2_b32 v[140:141], v237 offset0:240 offset1:241
    v_mfma_f32_16x16x32_bf16 v[52:55], v[68:71], v[112:115], v[52:55]
    ds_read2_b32 v[142:143], v237 offset0:242 offset1:243
    v_alignbit_b32 v230, v231, v230, 16
    v_xor_b32 v244, 64, v244
    v_mfma_f32_16x16x32_bf16 v[52:55], v[64:67], v[116:119], v[52:55]
    ds_read2_b32 v[144:145], v238 offset0:112 offset1:113
    v_mfma_f32_16x16x32_bf16 v[56:59], v[64:67], v[120:123], v[56:59]
    ds_read2_b32 v[146:147], v238 offset0:114 offset1:115
    v_xor_b32 v245, 64, v245
    v_mfma_f32_16x16x32_bf16 v[56:59], v[68:71], v[116:119], v[56:59]
    ds_read2_b32 v[148:149], v238 offset0:240 offset1:241
    v_mfma_f32_16x16x32_bf16 v[56:59], v[72:75], v[112:115], v[56:59]
    v_alignbit_b32 v231, v232, v231, 16
    v_xor_b32 v246, 64, v246
    v_mfma_f32_16x16x32_bf16 v[56:59], v[76:79], v[108:111], v[56:59]
    ds_read2_b32 v[150:151], v238 offset0:242 offset1:243
    v_mfma_f32_16x16x32_bf16 v[56:59], v[80:83], v[104:107], v[56:59]
    ds_read2_b32 v[152:153], v239 offset0:112 offset1:113
    v_xor_b32 v247, 64, v247
    v_mfma_f32_16x16x32_bf16 v[56:59], v[84:87], v[100:103], v[56:59]
    ds_read2_b32 v[154:155], v239 offset0:114 offset1:115
    v_mfma_f32_16x16x32_bf16 v[56:59], v[88:91], v[96:99], v[56:59]
    ds_read2_b32 v[156:157], v239 offset0:240 offset1:241
    v_alignbit_b32 v232, v233, v232, 16
    v_mfma_f32_16x16x32_bf16 v[60:63], v[92:95], v[96:99], v[60:63]
    ds_read2_b32 v[158:159], v239 offset0:242 offset1:243
    v_add_u32 v244, 36864, v244
    v_mfma_f32_16x16x32_bf16 v[60:63], v[88:91], v[100:103], v[60:63]
    v_add_u32 v236, -8320, v236
    v_mfma_f32_16x16x32_bf16 v[60:63], v[84:87], v[104:107], v[60:63]
    v_alignbit_b32 v233, v234, v233, 16
    v_add_u32 v245, 36864, v245
    v_mfma_f32_16x16x32_bf16 v[60:63], v[80:83], v[108:111], v[60:63]
    v_add_u32 v237, -8320, v237
    v_mfma_f32_16x16x32_bf16 v[60:63], v[76:79], v[112:115], v[60:63]
    s_waitcnt vmcnt(4)
    s_barrier
    v_add_u32 v246, 36864, v246
    v_mfma_f32_16x16x32_bf16 v[60:63], v[72:75], v[116:119], v[60:63]
    v_add_u32 v238, -8320, v238
    v_add_u32 v239, -8320, v239
    v_mfma_f32_16x16x32_bf16 v[60:63], v[68:71], v[120:123], v[60:63]
    ds_write_b128 v241, v[230:233] offset:7264
    v_mfma_f32_16x16x32_bf16 v[60:63], v[64:67], v[124:127], v[60:63]
    v_add_u32 v247, 36864, v247
    s_waitcnt lgkmcnt(1)
    v_mfma_f32_16x16x32_bf16 v[60:63], v[128:131], v[188:191], v[60:63]
    ds_read_b128 v[96:99], v244 offset:2048
    v_mfma_f32_16x16x32_bf16 v[60:63], v[132:135], v[184:187], v[60:63]
    ds_read2_b32 v[64:65], v236 offset0:0 offset1:1
    v_mfma_f32_16x16x32_bf16 v[60:63], v[136:139], v[180:183], v[60:63]
    ds_read2_b32 v[66:67], v236 offset0:2 offset1:3
    v_mfma_f32_16x16x32_bf16 v[60:63], v[140:143], v[176:179], v[60:63]
    ds_read_b128 v[100:103], v244 offset:6144
    v_mfma_f32_16x16x32_bf16 v[60:63], v[144:147], v[172:175], v[60:63]
    ds_read2_b32 v[68:69], v236 offset0:128 offset1:129
    v_mfma_f32_16x16x32_bf16 v[60:63], v[148:151], v[168:171], v[60:63]
    ds_read2_b32 v[70:71], v236 offset0:130 offset1:131
    v_mfma_f32_16x16x32_bf16 v[60:63], v[152:155], v[164:167], v[60:63]
    ds_read_b128 v[104:107], v244 offset:10240
    v_mfma_f32_16x16x32_bf16 v[60:63], v[156:159], v[160:163], v[60:63]
    s_add_u32 s13, s12, 49152
    ds_read2_b32 v[72:73], v237 offset0:0 offset1:1
    v_mfma_f32_16x16x32_bf16 v[56:59], v[128:131], v[184:187], v[56:59]
    ds_read2_b32 v[74:75], v237 offset0:2 offset1:3
    v_mfma_f32_16x16x32_bf16 v[56:59], v[132:135], v[180:183], v[56:59]
    s_add_u32 m0, s74, 8352
    ds_read_b128 v[108:111], v244 offset:14336
    v_mfma_f32_16x16x32_bf16 v[56:59], v[136:139], v[176:179], v[56:59]
    buffer_load_dwordx4 v240, s[48:51], s13 offen offset:0 lds
    ds_read2_b32 v[76:77], v237 offset0:128 offset1:129
    v_mfma_f32_16x16x32_bf16 v[56:59], v[140:143], v[172:175], v[56:59]
    ds_read2_b32 v[78:79], v237 offset0:130 offset1:131
    v_mfma_f32_16x16x32_bf16 v[56:59], v[144:147], v[168:171], v[56:59]
    ds_read_b128 v[112:115], v244 offset:18432
    v_mfma_f32_16x16x32_bf16 v[56:59], v[148:151], v[164:167], v[56:59]
    ds_read2_b32 v[80:81], v238 offset0:0 offset1:1
    v_cvt_pk_bf16_f32 v206, v60, v61
    v_mfma_f32_16x16x32_bf16 v[56:59], v[152:155], v[160:163], v[56:59]
    ds_read2_b32 v[82:83], v238 offset0:2 offset1:3
    v_mfma_f32_16x16x32_bf16 v[52:55], v[128:131], v[180:183], v[52:55]
    ds_read_b128 v[116:119], v244 offset:22528
    v_mfma_f32_16x16x32_bf16 v[52:55], v[132:135], v[176:179], v[52:55]
    ds_read2_b32 v[84:85], v238 offset0:128 offset1:129
    s_add_u32 m0, s74, 8352
    v_cvt_pk_bf16_f32 v207, v62, v63
    v_mfma_f32_16x16x32_bf16 v[52:55], v[136:139], v[172:175], v[52:55]
    buffer_load_dwordx4 v240, s[48:51], s13 offen offset:1024 lds
    ds_read2_b32 v[86:87], v238 offset0:130 offset1:131
    v_mfma_f32_16x16x32_bf16 v[52:55], v[140:143], v[168:171], v[52:55]
    buffer_store_dwordx2 v[206:207], v8, s[44:47], s6 offen offset:3584 sc1
    ds_read_b128 v[120:123], v244 offset:26624
    v_mfma_f32_16x16x32_bf16 v[52:55], v[144:147], v[164:167], v[52:55]
    ds_read2_b32 v[88:89], v239 offset0:0 offset1:1
    v_mfma_f32_16x16x32_bf16 v[52:55], v[148:151], v[160:163], v[52:55]
    ds_read2_b32 v[90:91], v239 offset0:2 offset1:3
    v_mfma_f32_16x16x32_bf16 v[48:51], v[128:131], v[176:179], v[48:51]
    s_waitcnt vmcnt(3)
    s_barrier
    v_cvt_pk_bf16_f32 v204, v56, v57
    v_mfma_f32_16x16x32_bf16 v[48:51], v[132:135], v[172:175], v[48:51]
    ds_read_b128 v[124:127], v244 offset:30720
    v_mfma_f32_16x16x32_bf16 v[48:51], v[136:139], v[168:171], v[48:51]
    ds_read_b64_tr_b16 a[80:81], v10 offset:16384
    v_mfma_f32_16x16x32_bf16 v[48:51], v[140:143], v[164:167], v[48:51]
    ds_read_b64_tr_b16 a[82:83], v10 offset:18432
    s_add_u32 m0, s74, 8352
    v_cvt_pk_bf16_f32 v205, v58, v59
    v_mfma_f32_16x16x32_bf16 v[48:51], v[144:147], v[160:163], v[48:51]
    ds_read_b64_tr_b16 a[88:89], v10 offset:20480
    buffer_load_dwordx4 v240, s[48:51], s13 offen offset:2048 lds
    v_mfma_f32_16x16x32_bf16 v[44:47], v[128:131], v[172:175], v[44:47]
    buffer_store_dwordx2 v[204:205], v8, s[44:47], s6 offen offset:3072 sc1
    ds_read2_b32 v[92:93], v239 offset0:128 offset1:129
    v_mfma_f32_16x16x32_bf16 v[44:47], v[132:135], v[168:171], v[44:47]
    ds_read_b64_tr_b16 a[90:91], v10 offset:22528
    v_mfma_f32_16x16x32_bf16 v[44:47], v[136:139], v[164:167], v[44:47]
    ds_read_b64_tr_b16 a[84:85], v11 offset:16384
    ds_read2_b32 v[94:95], v239 offset0:130 offset1:131
    v_mfma_f32_16x16x32_bf16 v[44:47], v[140:143], v[160:163], v[44:47]
    v_cvt_pk_bf16_f32 v202, v52, v53
    v_mfma_f32_16x16x32_bf16 v[40:43], v[128:131], v[168:171], v[40:43]
    ds_read_b64_tr_b16 a[86:87], v11 offset:18432
    v_mfma_f32_16x16x32_bf16 v[40:43], v[132:135], v[164:167], v[40:43]
    ds_read_b64_tr_b16 a[92:93], v11 offset:20480
    v_mfma_f32_16x16x32_bf16 v[40:43], v[136:139], v[160:163], v[40:43]
    s_add_u32 m0, s74, 8352
    v_cvt_pk_bf16_f32 v203, v54, v55
    v_mfma_f32_16x16x32_bf16 v[36:39], v[128:131], v[164:167], v[36:39]
    ds_read_b64_tr_b16 a[94:95], v11 offset:22528
    buffer_load_dwordx4 v240, s[48:51], s13 offen offset:3072 lds
    v_mfma_f32_16x16x32_bf16 v[36:39], v[132:135], v[160:163], v[36:39]
    buffer_store_dwordx2 v[202:203], v8, s[44:47], s6 offen offset:2560 sc1
    v_mfma_f32_16x16x32_bf16 v[32:35], v[128:131], v[160:163], v[32:35]
    s_waitcnt lgkmcnt(3)
    v_mfma_f32_16x16x32_bf16 v[60:63], v[64:67], v[124:127], 0
    ds_read_b128 v[160:163], v245 offset:2048
    v_mfma_f32_16x16x32_bf16 v[60:63], v[68:71], v[120:123], v[60:63]
    v_cvt_pk_bf16_f32 v200, v48, v49
    v_mfma_f32_16x16x32_bf16 v[60:63], v[72:75], v[116:119], v[60:63]
    ds_read2_b32 v[128:129], v236 offset0:16 offset1:17
    v_mfma_f32_16x16x32_bf16 v[60:63], v[76:79], v[112:115], v[60:63]
    ds_read2_b32 v[130:131], v236 offset0:18 offset1:19
    v_cvt_pk_bf16_f32 v201, v50, v51
    v_mfma_f32_16x16x32_bf16 v[60:63], v[80:83], v[108:111], v[60:63]
    v_mfma_f32_16x16x32_bf16 v[60:63], v[84:87], v[104:107], v[60:63]
    buffer_store_dwordx2 v[200:201], v8, s[44:47], s6 offen offset:2048 sc1
    ds_read_b128 v[164:167], v245 offset:6144
    v_mfma_f32_16x16x32_bf16 v[60:63], v[88:91], v[100:103], v[60:63]
    ds_read2_b32 v[132:133], v236 offset0:144 offset1:145
    v_mfma_f32_16x16x32_bf16 v[60:63], v[92:95], v[96:99], v[60:63]
    v_cvt_pk_bf16_f32 v198, v44, v45
    v_mfma_f32_16x16x32_bf16 v[56:59], v[64:67], v[120:123], 0
    ds_read2_b32 v[134:135], v236 offset0:146 offset1:147
    v_mfma_f32_16x16x32_bf16 v[56:59], v[68:71], v[116:119], v[56:59]
    ds_read_b128 v[168:171], v245 offset:10240
    v_mfma_f32_16x16x32_bf16 v[56:59], v[72:75], v[112:115], v[56:59]
    ds_read2_b32 v[136:137], v237 offset0:16 offset1:17
    v_cvt_pk_bf16_f32 v199, v46, v47
    v_mfma_f32_16x16x32_bf16 v[56:59], v[76:79], v[108:111], v[56:59]
    v_mfma_f32_16x16x32_bf16 v[56:59], v[80:83], v[104:107], v[56:59]
    buffer_store_dwordx2 v[198:199], v8, s[44:47], s6 offen offset:1536 sc1
    ds_read2_b32 v[138:139], v237 offset0:18 offset1:19
    v_mfma_f32_16x16x32_bf16 v[56:59], v[84:87], v[100:103], v[56:59]
    ds_read_b128 v[172:175], v245 offset:14336
    v_mfma_f32_16x16x32_bf16 v[56:59], v[88:91], v[96:99], v[56:59]
    v_cvt_pk_bf16_f32 v196, v40, v41
    v_mfma_f32_16x16x32_bf16 v[52:55], v[64:67], v[116:119], 0
    ds_read2_b32 v[140:141], v237 offset0:144 offset1:145
    v_mfma_f32_16x16x32_bf16 v[52:55], v[68:71], v[112:115], v[52:55]
    ds_read2_b32 v[142:143], v237 offset0:146 offset1:147
    v_cvt_pk_bf16_f32 v197, v42, v43
    v_mfma_f32_16x16x32_bf16 v[52:55], v[72:75], v[108:111], v[52:55]
    v_mfma_f32_16x16x32_bf16 v[52:55], v[76:79], v[104:107], v[52:55]
    buffer_store_dwordx2 v[196:197], v8, s[44:47], s6 offen offset:1024 sc1
    ds_read_b128 v[176:179], v245 offset:18432
    v_mfma_f32_16x16x32_bf16 v[52:55], v[80:83], v[100:103], v[52:55]
    ds_read2_b32 v[144:145], v238 offset0:16 offset1:17
    v_mfma_f32_16x16x32_bf16 v[52:55], v[84:87], v[96:99], v[52:55]
    v_mfma_f32_16x16x32_bf16 v[48:51], v[64:67], v[112:115], 0
    ds_read2_b32 v[146:147], v238 offset0:18 offset1:19
    v_cvt_pk_bf16_f32 v194, v36, v37
    v_mfma_f32_16x16x32_bf16 v[48:51], v[68:71], v[108:111], v[48:51]
    ds_read_b128 v[180:183], v245 offset:22528
    v_mfma_f32_16x16x32_bf16 v[48:51], v[72:75], v[104:107], v[48:51]
    v_cvt_pk_bf16_f32 v195, v38, v39
    v_mfma_f32_16x16x32_bf16 v[48:51], v[76:79], v[100:103], v[48:51]
    ds_read2_b32 v[148:149], v238 offset0:144 offset1:145
    v_mfma_f32_16x16x32_bf16 v[48:51], v[80:83], v[96:99], v[48:51]
    buffer_store_dwordx2 v[194:195], v8, s[44:47], s6 offen offset:512 sc1
    ds_read2_b32 v[150:151], v238 offset0:146 offset1:147
    v_mfma_f32_16x16x32_bf16 v[44:47], v[64:67], v[108:111], 0
    ds_read_b128 v[184:187], v245 offset:26624
    v_mfma_f32_16x16x32_bf16 v[44:47], v[68:71], v[104:107], v[44:47]
    v_cvt_pk_bf16_f32 v192, v32, v33
    v_mfma_f32_16x16x32_bf16 v[44:47], v[72:75], v[100:103], v[44:47]
    ds_read2_b32 v[152:153], v239 offset0:16 offset1:17
    v_mfma_f32_16x16x32_bf16 v[44:47], v[76:79], v[96:99], v[44:47]
    ds_read2_b32 v[154:155], v239 offset0:18 offset1:19
    v_cvt_pk_bf16_f32 v193, v34, v35
    v_mfma_f32_16x16x32_bf16 v[40:43], v[64:67], v[104:107], 0
    v_mfma_f32_16x16x32_bf16 v[40:43], v[68:71], v[100:103], v[40:43]
    buffer_store_dwordx2 v[192:193], v8, s[44:47], s6 offen offset:0 sc1
    ds_read_b128 v[188:191], v245 offset:30720
    v_mfma_f32_16x16x32_bf16 v[40:43], v[72:75], v[96:99], v[40:43]
    ds_read2_b32 v[156:157], v239 offset0:144 offset1:145
    v_mfma_f32_16x16x32_bf16 v[36:39], v[64:67], v[100:103], 0
    v_mfma_f32_16x16x32_bf16 v[36:39], v[68:71], v[96:99], v[36:39]
    ds_read2_b32 v[158:159], v239 offset0:146 offset1:147
    v_mfma_f32_16x16x32_bf16 v[32:35], v[64:67], v[96:99], 0
    s_waitcnt lgkmcnt(12)
    v_mfma_f32_16x16x32_bf16 v[32:35], v[128:131], v[160:163], v[32:35]
    ds_read_b128 v[96:99], v246 offset:2048
    v_mfma_f32_16x16x32_bf16 v[36:39], v[132:135], v[160:163], v[36:39]
    v_mfma_f32_16x16x32_bf16 v[36:39], v[128:131], v[164:167], v[36:39]
    ds_read2_b32 v[64:65], v236 offset0:32 offset1:33
    v_mfma_f32_16x16x32_bf16 v[40:43], v[128:131], v[168:171], v[40:43]
    ds_read2_b32 v[66:67], v236 offset0:34 offset1:35
    s_barrier
    v_mfma_f32_16x16x32_bf16 v[40:43], v[132:135], v[164:167], v[40:43]
    v_mfma_f32_16x16x32_bf16 v[40:43], v[136:139], v[160:163], v[40:43]
    ds_read_b128 v[100:103], v246 offset:6144
    v_mfma_f32_16x16x32_bf16 v[44:47], v[140:143], v[160:163], v[44:47]
    ds_read2_b32 v[68:69], v236 offset0:160 offset1:161
    v_mfma_f32_16x16x32_bf16 v[44:47], v[136:139], v[164:167], v[44:47]
    v_mfma_f32_16x16x32_bf16 v[44:47], v[132:135], v[168:171], v[44:47]
    ds_read2_b32 v[70:71], v236 offset0:162 offset1:163
    v_mfma_f32_16x16x32_bf16 v[44:47], v[128:131], v[172:175], v[44:47]
    ds_read_b128 v[104:107], v246 offset:10240
    s_waitcnt lgkmcnt(7)
    v_mfma_f32_16x16x32_bf16 v[48:51], v[128:131], v[176:179], v[48:51]
    ds_read2_b32 v[72:73], v237 offset0:32 offset1:33
    v_mfma_f32_16x16x32_bf16 v[48:51], v[132:135], v[172:175], v[48:51]
    ds_read2_b32 v[74:75], v237 offset0:34 offset1:35
    v_mfma_f32_16x16x32_bf16 v[48:51], v[136:139], v[168:171], v[48:51]
    v_mov_b32 v9, 24
    buffer_load_ushort v9, v9, s[56:59], s70 offen
    v_mfma_f32_16x16x32_bf16 v[48:51], v[140:143], v[164:167], v[48:51]
    ds_read_b128 v[108:111], v246 offset:14336
    v_mfma_f32_16x16x32_bf16 v[48:51], v[144:147], v[160:163], v[48:51]
    s_lshl_b32 s14, s90, 18
    v_mfma_f32_16x16x32_bf16 v[52:55], v[148:151], v[160:163], v[52:55]
    s_add_u32 m0, s73, 147456
    ds_read2_b32 v[76:77], v237 offset0:160 offset1:161
    v_mfma_f32_16x16x32_bf16 v[52:55], v[144:147], v[164:167], v[52:55]
    buffer_load_dwordx4 v4, s[52:55], s14 offen offset:0 lds
    ds_read2_b32 v[78:79], v237 offset0:162 offset1:163
    v_mfma_f32_16x16x32_bf16 v[52:55], v[140:143], v[168:171], v[52:55]
    v_mfma_f32_16x16x32_bf16 v[52:55], v[136:139], v[172:175], v[52:55]
    ds_read_b128 v[112:115], v246 offset:18432
    v_mfma_f32_16x16x32_bf16 v[52:55], v[132:135], v[176:179], v[52:55]
    ds_read2_b32 v[80:81], v238 offset0:32 offset1:33
    v_mfma_f32_16x16x32_bf16 v[52:55], v[128:131], v[180:183], v[52:55]
    v_mfma_f32_16x16x32_bf16 v[56:59], v[128:131], v[184:187], v[56:59]
    ds_read2_b32 v[82:83], v238 offset0:34 offset1:35
    v_mfma_f32_16x16x32_bf16 v[56:59], v[132:135], v[180:183], v[56:59]
    s_add_u32 m0, s73, 147456
    ds_read_b128 v[116:119], v246 offset:22528
    v_mfma_f32_16x16x32_bf16 v[56:59], v[136:139], v[176:179], v[56:59]
    buffer_load_dwordx4 v5, s[52:55], s14 offen offset:1024 lds
    v_mfma_f32_16x16x32_bf16 v[56:59], v[140:143], v[172:175], v[56:59]
    ds_read2_b32 v[84:85], v238 offset0:160 offset1:161
    v_mfma_f32_16x16x32_bf16 v[56:59], v[144:147], v[168:171], v[56:59]
    ds_read2_b32 v[86:87], v238 offset0:162 offset1:163
    v_mfma_f32_16x16x32_bf16 v[56:59], v[148:151], v[164:167], v[56:59]
    ds_read_b128 v[120:123], v246 offset:26624
    v_mfma_f32_16x16x32_bf16 v[56:59], v[152:155], v[160:163], v[56:59]
    v_mfma_f32_16x16x32_bf16 v[60:63], v[156:159], v[160:163], v[60:63]
    ds_read2_b32 v[88:89], v239 offset0:32 offset1:33
    v_mfma_f32_16x16x32_bf16 v[60:63], v[152:155], v[164:167], v[60:63]
    s_add_u32 m0, s73, 147456
    ds_read2_b32 v[90:91], v239 offset0:34 offset1:35
    v_mfma_f32_16x16x32_bf16 v[60:63], v[148:151], v[168:171], v[60:63]
    buffer_load_dwordx4 v6, s[52:55], s14 offen offset:2048 lds
    v_mfma_f32_16x16x32_bf16 v[60:63], v[144:147], v[172:175], v[60:63]
    ds_read_b128 v[124:127], v246 offset:30720
    v_mfma_f32_16x16x32_bf16 v[60:63], v[140:143], v[176:179], v[60:63]
    ds_read2_b32 v[92:93], v239 offset0:160 offset1:161
    v_mfma_f32_16x16x32_bf16 v[60:63], v[136:139], v[180:183], v[60:63]
    v_mfma_f32_16x16x32_bf16 v[60:63], v[132:135], v[184:187], v[60:63]
    ds_read2_b32 v[94:95], v239 offset0:162 offset1:163
    v_mfma_f32_16x16x32_bf16 v[60:63], v[128:131], v[188:191], v[60:63]
    s_waitcnt lgkmcnt(12)
    v_mfma_f32_16x16x32_bf16 v[32:35], v[64:67], v[96:99], v[32:35]
    ds_read_b128 v[160:163], v247 offset:2048
    v_mfma_f32_16x16x32_bf16 v[36:39], v[68:71], v[96:99], v[36:39]
    s_add_u32 m0, s73, 147456
    v_mfma_f32_16x16x32_bf16 v[36:39], v[64:67], v[100:103], v[36:39]
    buffer_load_dwordx4 v7, s[52:55], s14 offen offset:3072 lds
    ds_read2_b32 v[128:129], v236 offset0:48 offset1:49
    v_mfma_f32_16x16x32_bf16 v[40:43], v[64:67], v[104:107], v[40:43]
    ds_read2_b32 v[130:131], v236 offset0:50 offset1:51
    v_mfma_f32_16x16x32_bf16 v[40:43], v[68:71], v[100:103], v[40:43]
    v_mfma_f32_16x16x32_bf16 v[40:43], v[72:75], v[96:99], v[40:43]
    ds_read_b128 v[164:167], v247 offset:6144
    v_mfma_f32_16x16x32_bf16 v[44:47], v[76:79], v[96:99], v[44:47]
    ds_read2_b32 v[132:133], v236 offset0:176 offset1:177
    v_mfma_f32_16x16x32_bf16 v[44:47], v[72:75], v[100:103], v[44:47]
    v_mfma_f32_16x16x32_bf16 v[44:47], v[68:71], v[104:107], v[44:47]
    ds_read2_b32 v[134:135], v236 offset0:178 offset1:179
    v_mfma_f32_16x16x32_bf16 v[44:47], v[64:67], v[108:111], v[44:47]
    ds_read_b128 v[168:171], v247 offset:10240
    s_waitcnt lgkmcnt(7)
    v_mfma_f32_16x16x32_bf16 v[48:51], v[64:67], v[112:115], v[48:51]
    ds_read2_b32 v[136:137], v237 offset0:48 offset1:49
    v_mfma_f32_16x16x32_bf16 v[48:51], v[68:71], v[108:111], v[48:51]
    v_mfma_f32_16x16x32_bf16 v[48:51], v[72:75], v[104:107], v[48:51]
    ds_read2_b32 v[138:139], v237 offset0:50 offset1:51
    v_mfma_f32_16x16x32_bf16 v[48:51], v[76:79], v[100:103], v[48:51]
    ds_read_b128 v[172:175], v247 offset:14336
    v_mfma_f32_16x16x32_bf16 v[48:51], v[80:83], v[96:99], v[48:51]
    v_mfma_f32_16x16x32_bf16 v[52:55], v[84:87], v[96:99], v[52:55]
    ds_read2_b32 v[140:141], v237 offset0:176 offset1:177
    v_mfma_f32_16x16x32_bf16 v[52:55], v[80:83], v[100:103], v[52:55]
    ds_read2_b32 v[142:143], v237 offset0:178 offset1:179
    v_mfma_f32_16x16x32_bf16 v[52:55], v[76:79], v[104:107], v[52:55]
    v_mfma_f32_16x16x32_bf16 v[52:55], v[72:75], v[108:111], v[52:55]
    ds_read_b128 v[176:179], v247 offset:18432
    v_mfma_f32_16x16x32_bf16 v[52:55], v[68:71], v[112:115], v[52:55]
L_pl_X_4:
    s_cbranch_execz L_wret
    ds_read2_b32 v[144:145], v238 offset0:48 offset1:49
    v_mfma_f32_16x16x32_bf16 v[52:55], v[64:67], v[116:119], v[52:55]
    v_mfma_f32_16x16x32_bf16 v[56:59], v[64:67], v[120:123], v[56:59]
    s_lshl_b32 s14, s91, 18
    ds_read2_b32 v[146:147], v238 offset0:50 offset1:51
    v_mfma_f32_16x16x32_bf16 v[56:59], v[68:71], v[116:119], v[56:59]
    s_add_u32 m0, s73, 0
    ds_read_b128 v[180:183], v247 offset:22528
    v_mfma_f32_16x16x32_bf16 v[56:59], v[72:75], v[112:115], v[56:59]
    buffer_load_dwordx4 v4, s[52:55], s14 offen offset:0 lds
    v_mfma_f32_16x16x32_bf16 v[56:59], v[76:79], v[108:111], v[56:59]
    ds_read2_b32 v[148:149], v238 offset0:176 offset1:177
    v_mfma_f32_16x16x32_bf16 v[56:59], v[80:83], v[104:107], v[56:59]
    ds_read2_b32 v[150:151], v238 offset0:178 offset1:179
    v_mfma_f32_16x16x32_bf16 v[56:59], v[84:87], v[100:103], v[56:59]
    ds_read_b128 v[184:187], v247 offset:26624
    v_mfma_f32_16x16x32_bf16 v[56:59], v[88:91], v[96:99], v[56:59]
    v_mfma_f32_16x16x32_bf16 v[60:63], v[92:95], v[96:99], v[60:63]
    ds_read2_b32 v[152:153], v239 offset0:48 offset1:49
    v_mfma_f32_16x16x32_bf16 v[60:63], v[88:91], v[100:103], v[60:63]
    s_add_u32 m0, s73, 0
    ds_read2_b32 v[154:155], v239 offset0:50 offset1:51
    v_mfma_f32_16x16x32_bf16 v[60:63], v[84:87], v[104:107], v[60:63]
    buffer_load_dwordx4 v5, s[52:55], s14 offen offset:1024 lds
    v_mfma_f32_16x16x32_bf16 v[60:63], v[80:83], v[108:111], v[60:63]
    ds_read_b128 v[188:191], v247 offset:30720
    v_mfma_f32_16x16x32_bf16 v[60:63], v[76:79], v[112:115], v[60:63]
    ds_read2_b32 v[156:157], v239 offset0:176 offset1:177
    v_mfma_f32_16x16x32_bf16 v[60:63], v[72:75], v[116:119], v[60:63]
    v_mfma_f32_16x16x32_bf16 v[60:63], v[68:71], v[120:123], v[60:63]
    ds_read2_b32 v[158:159], v239 offset0:178 offset1:179
    v_mfma_f32_16x16x32_bf16 v[60:63], v[64:67], v[124:127], v[60:63]
    s_waitcnt lgkmcnt(12)
    v_mfma_f32_16x16x32_bf16 v[32:35], v[128:131], v[160:163], v[32:35]
    ds_read_b128 v[96:99], v244 offset:0
    v_mfma_f32_16x16x32_bf16 v[36:39], v[132:135], v[160:163], v[36:39]
    s_add_u32 m0, s73, 0
    v_mfma_f32_16x16x32_bf16 v[36:39], v[128:131], v[164:167], v[36:39]
    buffer_load_dwordx4 v6, s[52:55], s14 offen offset:2048 lds
    ds_read2_b32 v[64:65], v236 offset0:64 offset1:65
    v_mfma_f32_16x16x32_bf16 v[40:43], v[128:131], v[168:171], v[40:43]
    ds_read2_b32 v[66:67], v236 offset0:66 offset1:67
    v_mfma_f32_16x16x32_bf16 v[40:43], v[132:135], v[164:167], v[40:43]
    v_mfma_f32_16x16x32_bf16 v[40:43], v[136:139], v[160:163], v[40:43]
    ds_read_b128 v[100:103], v244 offset:4096
    v_mfma_f32_16x16x32_bf16 v[44:47], v[140:143], v[160:163], v[44:47]
    ds_read2_b32 v[68:69], v236 offset0:192 offset1:193
    v_mfma_f32_16x16x32_bf16 v[44:47], v[136:139], v[164:167], v[44:47]
    v_mfma_f32_16x16x32_bf16 v[44:47], v[132:135], v[168:171], v[44:47]
    s_add_u32 m0, s73, 0
    ds_read2_b32 v[70:71], v236 offset0:194 offset1:195
    v_mfma_f32_16x16x32_bf16 v[44:47], v[128:131], v[172:175], v[44:47]
    buffer_load_dwordx4 v7, s[52:55], s14 offen offset:3072 lds
    ds_read_b128 v[104:107], v244 offset:8192
    s_waitcnt lgkmcnt(7)
    v_mfma_f32_16x16x32_bf16 v[48:51], v[128:131], v[176:179], v[48:51]
    ds_read2_b32 v[72:73], v237 offset0:64 offset1:65
    v_mfma_f32_16x16x32_bf16 v[48:51], v[132:135], v[172:175], v[48:51]
    v_mfma_f32_16x16x32_bf16 v[48:51], v[136:139], v[168:171], v[48:51]
    ds_read2_b32 v[74:75], v237 offset0:66 offset1:67
    v_mfma_f32_16x16x32_bf16 v[48:51], v[140:143], v[164:167], v[48:51]
    ds_read_b128 v[108:111], v244 offset:12288
    v_mfma_f32_16x16x32_bf16 v[48:51], v[144:147], v[160:163], v[48:51]
    v_mfma_f32_16x16x32_bf16 v[52:55], v[148:151], v[160:163], v[52:55]
    ds_read2_b32 v[76:77], v237 offset0:192 offset1:193
    v_mfma_f32_16x16x32_bf16 v[52:55], v[144:147], v[164:167], v[52:55]
    ds_read2_b32 v[78:79], v237 offset0:194 offset1:195
    v_mfma_f32_16x16x32_bf16 v[52:55], v[140:143], v[168:171], v[52:55]
    v_mfma_f32_16x16x32_bf16 v[52:55], v[136:139], v[172:175], v[52:55]
    ds_read_b128 v[112:115], v244 offset:16384
    v_mfma_f32_16x16x32_bf16 v[52:55], v[132:135], v[176:179], v[52:55]
    ds_read2_b32 v[80:81], v238 offset0:64 offset1:65
    v_mfma_f32_16x16x32_bf16 v[52:55], v[128:131], v[180:183], v[52:55]
    v_mfma_f32_16x16x32_bf16 v[56:59], v[128:131], v[184:187], v[56:59]
    ds_read2_b32 v[82:83], v238 offset0:66 offset1:67
    v_mfma_f32_16x16x32_bf16 v[56:59], v[132:135], v[180:183], v[56:59]
    ds_read_b128 v[116:119], v244 offset:20480
    v_mfma_f32_16x16x32_bf16 v[56:59], v[136:139], v[176:179], v[56:59]
    v_mfma_f32_16x16x32_bf16 v[56:59], v[140:143], v[172:175], v[56:59]
    ds_read2_b32 v[84:85], v238 offset0:192 offset1:193
    v_mfma_f32_16x16x32_bf16 v[56:59], v[144:147], v[168:171], v[56:59]
    ds_read2_b32 v[86:87], v238 offset0:194 offset1:195
    v_mfma_f32_16x16x32_bf16 v[56:59], v[148:151], v[164:167], v[56:59]
    ds_read_b128 v[120:123], v244 offset:24576
    v_mfma_f32_16x16x32_bf16 v[56:59], v[152:155], v[160:163], v[56:59]
    v_mfma_f32_16x16x32_bf16 v[60:63], v[156:159], v[160:163], v[60:63]
    s_lshl_b32 s14, s92, 18
    ds_read2_b32 v[88:89], v239 offset0:64 offset1:65
    v_mfma_f32_16x16x32_bf16 v[60:63], v[152:155], v[164:167], v[60:63]
    s_add_u32 m0, s73, 16384
    ds_read2_b32 v[90:91], v239 offset0:66 offset1:67
    v_mfma_f32_16x16x32_bf16 v[60:63], v[148:151], v[168:171], v[60:63]
    buffer_load_dwordx4 v4, s[52:55], s14 offen offset:0 lds
    v_mfma_f32_16x16x32_bf16 v[60:63], v[144:147], v[172:175], v[60:63]
    ds_read_b128 v[124:127], v244 offset:28672
    v_mfma_f32_16x16x32_bf16 v[60:63], v[140:143], v[176:179], v[60:63]
    ds_read2_b32 v[92:93], v239 offset0:192 offset1:193
    v_mfma_f32_16x16x32_bf16 v[60:63], v[136:139], v[180:183], v[60:63]
    v_mfma_f32_16x16x32_bf16 v[60:63], v[132:135], v[184:187], v[60:63]
    ds_read2_b32 v[94:95], v239 offset0:194 offset1:195
    v_mfma_f32_16x16x32_bf16 v[60:63], v[128:131], v[188:191], v[60:63]
    s_waitcnt lgkmcnt(12)
    v_mfma_f32_16x16x32_bf16 v[32:35], v[64:67], v[96:99], v[32:35]
    ds_read_b128 v[160:163], v245 offset:0
    v_mfma_f32_16x16x32_bf16 v[36:39], v[68:71], v[96:99], v[36:39]
    s_add_u32 m0, s73, 16384
    ds_read2_b32 v[128:129], v236 offset0:80 offset1:81
    v_mfma_f32_16x16x32_bf16 v[36:39], v[64:67], v[100:103], v[36:39]
    buffer_load_dwordx4 v5, s[52:55], s14 offen offset:1024 lds
    ds_read2_b32 v[130:131], v236 offset0:82 offset1:83
    v_mfma_f32_16x16x32_bf16 v[40:43], v[64:67], v[104:107], v[40:43]
    ds_read_b128 v[164:167], v245 offset:4096
    v_mfma_f32_16x16x32_bf16 v[40:43], v[68:71], v[100:103], v[40:43]
    ds_read2_b32 v[132:133], v236 offset0:208 offset1:209
    v_mfma_f32_16x16x32_bf16 v[40:43], v[72:75], v[96:99], v[40:43]
    ds_read2_b32 v[134:135], v236 offset0:210 offset1:211
    v_mfma_f32_16x16x32_bf16 v[44:47], v[76:79], v[96:99], v[44:47]
    ds_read_b128 v[168:171], v245 offset:8192
    v_mfma_f32_16x16x32_bf16 v[44:47], v[72:75], v[100:103], v[44:47]
    ds_read2_b32 v[136:137], v237 offset0:80 offset1:81
    v_mfma_f32_16x16x32_bf16 v[44:47], v[68:71], v[104:107], v[44:47]
    s_add_u32 m0, s73, 16384
    ds_read2_b32 v[138:139], v237 offset0:82 offset1:83
    v_mfma_f32_16x16x32_bf16 v[44:47], v[64:67], v[108:111], v[44:47]
    buffer_load_dwordx4 v6, s[52:55], s14 offen offset:2048 lds
    ds_read_b128 v[172:175], v245 offset:12288
    s_waitcnt lgkmcnt(10)
    v_mfma_f32_16x16x32_bf16 v[48:51], v[64:67], v[112:115], v[48:51]
    ds_read2_b32 v[140:141], v237 offset0:208 offset1:209
    v_mfma_f32_16x16x32_bf16 v[48:51], v[68:71], v[108:111], v[48:51]
    ds_read2_b32 v[142:143], v237 offset0:210 offset1:211
    v_mfma_f32_16x16x32_bf16 v[48:51], v[72:75], v[104:107], v[48:51]
    ds_read_b128 v[176:179], v245 offset:16384
    v_mfma_f32_16x16x32_bf16 v[48:51], v[76:79], v[100:103], v[48:51]
    ds_read2_b32 v[144:145], v238 offset0:80 offset1:81
    v_mfma_f32_16x16x32_bf16 v[48:51], v[80:83], v[96:99], v[48:51]
    ds_read2_b32 v[146:147], v238 offset0:82 offset1:83
    s_waitcnt vmcnt(7)
    s_barrier
    v_mfma_f32_16x16x32_bf16 v[52:55], v[84:87], v[96:99], v[52:55]
    ds_read_b64_tr_b16 a[96:97], v10 offset:16384
    s_add_u32 m0, s73, 16384
    v_mfma_f32_16x16x32_bf16 v[52:55], v[80:83], v[100:103], v[52:55]
    buffer_load_dwordx4 v7, s[52:55], s14 offen offset:3072 lds
    ds_read_b128 v[180:183], v245 offset:20480
    v_mfma_f32_16x16x32_bf16 v[52:55], v[76:79], v[104:107], v[52:55]
    ds_read_b64_tr_b16 a[98:99], v10 offset:18432
    v_mfma_f32_16x16x32_bf16 v[52:55], v[72:75], v[108:111], v[52:55]
    ds_read_b64_tr_b16 a[104:105], v10 offset:20480
    v_mfma_f32_16x16x32_bf16 v[52:55], v[68:71], v[112:115], v[52:55]
    ds_read_b128 v[212:215], v241 offset:8352
    v_mfma_f32_16x16x32_bf16 v[52:55], v[64:67], v[116:119], v[52:55]
    ds_read_b64_tr_b16 a[106:107], v10 offset:22528
    v_mfma_f32_16x16x32_bf16 v[56:59], v[64:67], v[120:123], v[56:59]
    ds_read_b64_tr_b16 a[100:101], v11 offset:16384
    v_mfma_f32_16x16x32_bf16 v[56:59], v[68:71], v[116:119], v[56:59]
    ds_read_b32 v216, v241 offset:8368
    v_mfma_f32_16x16x32_bf16 v[56:59], v[72:75], v[112:115], v[56:59]
    ds_read_b64_tr_b16 a[102:103], v11 offset:18432
    v_mfma_f32_16x16x32_bf16 v[56:59], v[76:79], v[108:111], v[56:59]
    ds_read_b64_tr_b16 a[108:109], v11 offset:20480
    ds_read2_b32 v[148:149], v238 offset0:208 offset1:209
    v_mfma_f32_16x16x32_bf16 v[56:59], v[80:83], v[104:107], v[56:59]
    ds_read_b64_tr_b16 a[110:111], v11 offset:22528
    ds_read2_b32 v[150:151], v238 offset0:210 offset1:211
    v_mfma_f32_16x16x32_bf16 v[56:59], v[84:87], v[100:103], v[56:59]
    ds_read_b128 v[218:221], v241 offset:9376
    ds_read_b128 v[184:187], v245 offset:24576
    v_mfma_f32_16x16x32_bf16 v[56:59], v[88:91], v[96:99], v[56:59]
    ds_read_b32 v222, v241 offset:9392
    v_mfma_f32_16x16x32_bf16 v[60:63], v[92:95], v[96:99], v[60:63]
    ds_read_b128 v[224:227], v241 offset:10400
    ds_read2_b32 v[152:153], v239 offset0:80 offset1:81
    v_mfma_f32_16x16x32_bf16 v[60:63], v[88:91], v[100:103], v[60:63]
    ds_read2_b32 v[154:155], v239 offset0:82 offset1:83
    v_mfma_f32_16x16x32_bf16 v[60:63], v[84:87], v[104:107], v[60:63]
    ds_read_b32 v228, v241 offset:10416
    v_mfma_f32_16x16x32_bf16 v[60:63], v[80:83], v[108:111], v[60:63]
    ds_read_b128 v[188:191], v245 offset:28672
    v_mfma_f32_16x16x32_bf16 v[60:63], v[76:79], v[112:115], v[60:63]
    ds_read_b128 v[230:233], v241 offset:11424
    s_waitcnt lgkmcnt(10)
    s_barrier
    v_mfma_f32_16x16x32_bf16 v[60:63], v[72:75], v[116:119], v[60:63]
    ds_read2_b32 v[156:157], v239 offset0:208 offset1:209
    v_mfma_f32_16x16x32_bf16 v[60:63], v[68:71], v[120:123], v[60:63]
    ds_read_b32 v234, v241 offset:11440
    ds_read2_b32 v[158:159], v239 offset0:210 offset1:211
    v_mfma_f32_16x16x32_bf16 v[60:63], v[64:67], v[124:127], v[60:63]
    v_mfma_f32_16x16x32_bf16 v[32:35], v[128:131], v[160:163], v[32:35]
    s_lshl_b32 s14, s93, 18
    ds_read_b128 v[96:99], v246 offset:0
    v_mfma_f32_16x16x32_bf16 v[36:39], v[132:135], v[160:163], v[36:39]
    s_add_u32 m0, s73, 147456
    ds_read2_b32 v[64:65], v236 offset0:96 offset1:97
    v_mfma_f32_16x16x32_bf16 v[36:39], v[128:131], v[164:167], v[36:39]
    buffer_load_dwordx4 v4, s[52:55], s14 offen offset:0 lds
    ds_read2_b32 v[66:67], v236 offset0:98 offset1:99
    v_mfma_f32_16x16x32_bf16 v[40:43], v[128:131], v[168:171], v[40:43]
    ds_read_b128 v[100:103], v246 offset:4096
    v_mfma_f32_16x16x32_bf16 v[40:43], v[132:135], v[164:167], v[40:43]
    s_waitcnt lgkmcnt(5)
    ds_read2_b32 v[68:69], v236 offset0:224 offset1:225
    v_mfma_f32_16x16x32_bf16 v[40:43], v[136:139], v[160:163], v[40:43]
    ds_read2_b32 v[70:71], v236 offset0:226 offset1:227
    v_mfma_f32_16x16x32_bf16 v[44:47], v[140:143], v[160:163], v[44:47]
    ds_read_b128 v[104:107], v246 offset:8192
    v_mfma_f32_16x16x32_bf16 v[44:47], v[136:139], v[164:167], v[44:47]
    ds_read2_b32 v[72:73], v237 offset0:96 offset1:97
    v_mfma_f32_16x16x32_bf16 v[44:47], v[132:135], v[168:171], v[44:47]
    ds_read2_b32 v[74:75], v237 offset0:98 offset1:99
    s_add_u32 m0, s73, 147456
    v_lshlrev_b32 v9, 16, v9
    v_mfma_f32_16x16x32_bf16 v[44:47], v[128:131], v[172:175], v[44:47]
    buffer_load_dwordx4 v5, s[52:55], s14 offen offset:1024 lds
    ds_read_b128 v[108:111], v246 offset:12288
    s_waitcnt lgkmcnt(10)
    v_mfma_f32_16x16x32_bf16 v[48:51], v[128:131], v[176:179], v[48:51]
    ds_read2_b32 v[76:77], v237 offset0:224 offset1:225
    v_lshlrev_b32 v208, 16, v212
    v_mfma_f32_16x16x32_bf16 v[48:51], v[132:135], v[172:175], v[48:51]
    ds_read2_b32 v[78:79], v237 offset0:226 offset1:227
    v_mfma_f32_16x16x32_bf16 v[48:51], v[136:139], v[168:171], v[48:51]
    ds_read_b128 v[112:115], v246 offset:16384
    v_add_f32 v9, v9, v208
    v_mfma_f32_16x16x32_bf16 v[48:51], v[140:143], v[164:167], v[48:51]
    ds_read2_b32 v[80:81], v238 offset0:96 offset1:97
    v_cvt_pk_bf16_f32 v9, v9, v9
    v_mfma_f32_16x16x32_bf16 v[48:51], v[144:147], v[160:163], v[48:51]
    ds_write_b16 v242, v9 offset:12480
    v_mfma_f32_16x16x32_bf16 v[52:55], v[148:151], v[160:163], v[52:55]
    s_add_u32 m0, s73, 147456
    ds_read2_b32 v[82:83], v238 offset0:98 offset1:99
    v_mfma_f32_16x16x32_bf16 v[52:55], v[144:147], v[164:167], v[52:55]
    buffer_load_dwordx4 v6, s[52:55], s14 offen offset:2048 lds
    ds_read_b128 v[116:119], v246 offset:20480
    v_mfma_f32_16x16x32_bf16 v[52:55], v[140:143], v[168:171], v[52:55]
    ds_write_b16 v242, v9 offset:8322
    v_mfma_f32_16x16x32_bf16 v[52:55], v[136:139], v[172:175], v[52:55]
    ds_read2_b32 v[84:85], v238 offset0:224 offset1:225
    v_mfma_f32_16x16x32_bf16 v[52:55], v[132:135], v[176:179], v[52:55]
    ds_read2_b32 v[86:87], v238 offset0:226 offset1:227
    v_alignbit_b32 v212, v213, v212, 16
    v_mfma_f32_16x16x32_bf16 v[52:55], v[128:131], v[180:183], v[52:55]
    v_alignbit_b32 v213, v214, v213, 16
    v_alignbit_b32 v214, v215, v214, 16
    v_mfma_f32_16x16x32_bf16 v[56:59], v[128:131], v[184:187], v[56:59]
    s_waitcnt vmcnt(7)
    s_barrier
    v_alignbit_b32 v215, v216, v215, 16
    v_mfma_f32_16x16x32_bf16 v[56:59], v[132:135], v[180:183], v[56:59]
    v_add_u32 v10, -131072, v10
    s_add_u32 m0, s73, 147456
    v_mfma_f32_16x16x32_bf16 v[56:59], v[136:139], v[176:179], v[56:59]
    ds_read_b64_tr_b16 a[112:113], v10 offset:0
    buffer_load_dwordx4 v7, s[52:55], s14 offen offset:3072 lds
    v_mfma_f32_16x16x32_bf16 v[56:59], v[140:143], v[172:175], v[56:59]
    ds_write_b128 v241, v[212:215] offset:12512
    v_mfma_f32_16x16x32_bf16 v[56:59], v[144:147], v[168:171], v[56:59]
    ds_read_b64_tr_b16 a[114:115], v10 offset:2048
    ds_read_b128 v[120:123], v246 offset:24576
    v_mfma_f32_16x16x32_bf16 v[56:59], v[148:151], v[164:167], v[56:59]
    ds_read_b64_tr_b16 a[120:121], v10 offset:4096
    ds_read2_b32 v[88:89], v239 offset0:96 offset1:97
    v_mfma_f32_16x16x32_bf16 v[56:59], v[152:155], v[160:163], v[56:59]
    ds_read_b64_tr_b16 a[122:123], v10 offset:6144
    v_alignbit_b32 v218, v219, v218, 16
    v_mfma_f32_16x16x32_bf16 v[60:63], v[156:159], v[160:163], v[60:63]
    ds_read2_b32 v[90:91], v239 offset0:98 offset1:99
    v_add_u32 v11, -131072, v11
    v_mfma_f32_16x16x32_bf16 v[60:63], v[152:155], v[164:167], v[60:63]
    ds_read_b64_tr_b16 a[116:117], v11 offset:0
    v_alignbit_b32 v219, v220, v219, 16
    v_mfma_f32_16x16x32_bf16 v[60:63], v[148:151], v[168:171], v[60:63]
    ds_read_b128 v[124:127], v246 offset:28672
    ds_read2_b32 v[92:93], v239 offset0:224 offset1:225
    v_mfma_f32_16x16x32_bf16 v[60:63], v[144:147], v[172:175], v[60:63]
    ds_read_b64_tr_b16 a[118:119], v11 offset:2048
    v_alignbit_b32 v220, v221, v220, 16
    v_mfma_f32_16x16x32_bf16 v[60:63], v[140:143], v[176:179], v[60:63]
    ds_read_b64_tr_b16 a[124:125], v11 offset:4096
    ds_read2_b32 v[94:95], v239 offset0:226 offset1:227
    v_mfma_f32_16x16x32_bf16 v[60:63], v[136:139], v[180:183], v[60:63]
    ds_read_b64_tr_b16 a[126:127], v11 offset:6144
    v_alignbit_b32 v221, v222, v221, 16
    v_mfma_f32_16x16x32_bf16 v[60:63], v[132:135], v[184:187], v[60:63]
    ds_write_b128 v241, v[218:221] offset:13536
    v_mfma_f32_16x16x32_bf16 v[60:63], v[128:131], v[188:191], v[60:63]
    s_waitcnt lgkmcnt(15)
    v_mfma_f32_16x16x32_bf16 v[32:35], v[64:67], v[96:99], v[32:35]
    ds_read_b128 v[160:163], v247 offset:0
    v_mfma_f32_16x16x32_bf16 v[36:39], v[68:71], v[96:99], v[36:39]
    v_alignbit_b32 v224, v225, v224, 16
    v_mfma_f32_16x16x32_bf16 v[36:39], v[64:67], v[100:103], v[36:39]
    ds_read_b128 v[164:167], v247 offset:4096
    v_mfma_f32_16x16x32_bf16 v[40:43], v[64:67], v[104:107], v[40:43]
    ds_read_b128 v[168:171], v247 offset:8192
    s_waitcnt lgkmcnt(4)
    s_barrier
    v_mfma_f32_16x16x32_bf16 v[40:43], v[68:71], v[100:103], v[40:43]
    ds_read_b128 v[172:175], v247 offset:12288
    v_mfma_f32_16x16x32_bf16 v[40:43], v[72:75], v[96:99], v[40:43]
    v_alignbit_b32 v225, v226, v225, 16
    v_mfma_f32_16x16x32_bf16 v[44:47], v[76:79], v[96:99], v[44:47]
    ds_read_b128 v[176:179], v247 offset:16384
    v_mfma_f32_16x16x32_bf16 v[44:47], v[72:75], v[100:103], v[44:47]
    s_lshl_b32 s14, s94, 18
    ds_read_b128 v[180:183], v247 offset:20480
    v_mfma_f32_16x16x32_bf16 v[44:47], v[68:71], v[104:107], v[44:47]
    s_add_u32 m0, s73, 0
    v_alignbit_b32 v226, v227, v226, 16
    v_mfma_f32_16x16x32_bf16 v[44:47], v[64:67], v[108:111], v[44:47]
    buffer_load_dwordx4 v4, s[52:55], s14 offen offset:0 lds
    ds_read_b128 v[184:187], v247 offset:24576
    v_mfma_f32_16x16x32_bf16 v[48:51], v[64:67], v[112:115], v[48:51]
    ds_read_b128 v[188:191], v247 offset:28672
    v_mfma_f32_16x16x32_bf16 v[48:51], v[68:71], v[108:111], v[48:51]
    ds_read2_b32 v[128:129], v236 offset0:112 offset1:113
    v_mfma_f32_16x16x32_bf16 v[48:51], v[72:75], v[104:107], v[48:51]
    v_alignbit_b32 v227, v228, v227, 16
    v_mfma_f32_16x16x32_bf16 v[48:51], v[76:79], v[100:103], v[48:51]
    ds_read2_b32 v[130:131], v236 offset0:114 offset1:115
    v_mfma_f32_16x16x32_bf16 v[48:51], v[80:83], v[96:99], v[48:51]
    ds_read2_b32 v[132:133], v236 offset0:240 offset1:241
    v_mfma_f32_16x16x32_bf16 v[52:55], v[84:87], v[96:99], v[52:55]
    s_add_u32 m0, s73, 0
    ds_read2_b32 v[134:135], v236 offset0:242 offset1:243
    v_mfma_f32_16x16x32_bf16 v[52:55], v[80:83], v[100:103], v[52:55]
    buffer_load_dwordx4 v5, s[52:55], s14 offen offset:1024 lds
    ds_read2_b32 v[136:137], v237 offset0:112 offset1:113
    v_mfma_f32_16x16x32_bf16 v[52:55], v[76:79], v[104:107], v[52:55]
    ds_write_b128 v241, v[224:227] offset:14560
    v_mfma_f32_16x16x32_bf16 v[52:55], v[72:75], v[108:111], v[52:55]
    ds_read2_b32 v[138:139], v237 offset0:114 offset1:115
    s_add_u32 s6, s12, 4751360
    ds_read2_b32 v[140:141], v237 offset0:240 offset1:241
    v_mfma_f32_16x16x32_bf16 v[52:55], v[68:71], v[112:115], v[52:55]
    ds_read2_b32 v[142:143], v237 offset0:242 offset1:243
    v_alignbit_b32 v230, v231, v230, 16
    v_mfma_f32_16x16x32_bf16 v[52:55], v[64:67], v[116:119], v[52:55]
    ds_read2_b32 v[144:145], v238 offset0:112 offset1:113
    v_xor_b32 v244, 64, v244
    v_mfma_f32_16x16x32_bf16 v[56:59], v[64:67], v[120:123], v[56:59]
    ds_read2_b32 v[146:147], v238 offset0:114 offset1:115
    v_mfma_f32_16x16x32_bf16 v[56:59], v[68:71], v[116:119], v[56:59]
    s_add_u32 m0, s73, 0
    ds_read2_b32 v[148:149], v238 offset0:240 offset1:241
    v_mfma_f32_16x16x32_bf16 v[56:59], v[72:75], v[112:115], v[56:59]
    buffer_load_dwordx4 v6, s[52:55], s14 offen offset:2048 lds
    v_alignbit_b32 v231, v232, v231, 16
    v_mfma_f32_16x16x32_bf16 v[56:59], v[76:79], v[108:111], v[56:59]
    ds_read2_b32 v[150:151], v238 offset0:242 offset1:243
    v_xor_b32 v245, 64, v245
    v_mfma_f32_16x16x32_bf16 v[56:59], v[80:83], v[104:107], v[56:59]
    ds_read2_b32 v[152:153], v239 offset0:112 offset1:113
    v_mfma_f32_16x16x32_bf16 v[56:59], v[84:87], v[100:103], v[56:59]
    ds_read2_b32 v[154:155], v239 offset0:114 offset1:115
    v_mfma_f32_16x16x32_bf16 v[56:59], v[88:91], v[96:99], v[56:59]
    ds_read2_b32 v[156:157], v239 offset0:240 offset1:241
    v_alignbit_b32 v232, v233, v232, 16
    v_mfma_f32_16x16x32_bf16 v[60:63], v[92:95], v[96:99], v[60:63]
    ds_read2_b32 v[158:159], v239 offset0:242 offset1:243
    s_waitcnt vmcnt(7)
    s_barrier
    v_mfma_f32_16x16x32_bf16 v[60:63], v[88:91], v[100:103], v[60:63]
    s_add_u32 m0, s73, 0
    v_xor_b32 v246, 64, v246
    v_add_u32 v236, 8320, v236
    v_mfma_f32_16x16x32_bf16 v[60:63], v[84:87], v[104:107], v[60:63]
    ds_read_b64_tr_b16 a[128:129], v10 offset:16384
    buffer_load_dwordx4 v7, s[52:55], s14 offen offset:3072 lds
    v_mfma_f32_16x16x32_bf16 v[60:63], v[80:83], v[108:111], v[60:63]
    ds_read_b64_tr_b16 a[130:131], v10 offset:18432
    v_alignbit_b32 v233, v234, v233, 16
    v_add_u32 v237, 8320, v237
    v_mfma_f32_16x16x32_bf16 v[60:63], v[76:79], v[112:115], v[60:63]
    ds_write_b128 v241, v[230:233] offset:15584
    v_mfma_f32_16x16x32_bf16 v[60:63], v[72:75], v[116:119], v[60:63]
    ds_read_b64_tr_b16 a[136:137], v10 offset:20480
    v_xor_b32 v247, 64, v247
    v_mfma_f32_16x16x32_bf16 v[60:63], v[68:71], v[120:123], v[60:63]
    ds_read_b64_tr_b16 a[138:139], v10 offset:22528
    v_add_u32 v238, 8320, v238
    v_mfma_f32_16x16x32_bf16 v[60:63], v[64:67], v[124:127], v[60:63]
    v_add_u32 v239, 8320, v239
    s_waitcnt lgkmcnt(5)
    v_mfma_f32_16x16x32_bf16 v[60:63], v[128:131], v[188:191], v[60:63]
    ds_read_b64_tr_b16 a[132:133], v11 offset:16384
    v_mfma_f32_16x16x32_bf16 v[60:63], v[132:135], v[184:187], v[60:63]
    ds_read_b64_tr_b16 a[134:135], v11 offset:18432
    v_mfma_f32_16x16x32_bf16 v[60:63], v[136:139], v[180:183], v[60:63]
    ds_read_b64_tr_b16 a[140:141], v11 offset:20480
    v_mfma_f32_16x16x32_bf16 v[60:63], v[140:143], v[176:179], v[60:63]
    ds_read_b128 v[96:99], v244 offset:2048
    v_mfma_f32_16x16x32_bf16 v[60:63], v[144:147], v[172:175], v[60:63]
    ds_read_b64_tr_b16 a[142:143], v11 offset:22528
    v_mfma_f32_16x16x32_bf16 v[60:63], v[148:151], v[168:171], v[60:63]
    ds_read2_b32 v[64:65], v236 offset0:0 offset1:1
    v_mfma_f32_16x16x32_bf16 v[60:63], v[152:155], v[164:167], v[60:63]
    ds_read2_b32 v[66:67], v236 offset0:2 offset1:3
    v_mfma_f32_16x16x32_bf16 v[60:63], v[156:159], v[160:163], v[60:63]
    ds_read_b128 v[100:103], v244 offset:6144
    v_mfma_f32_16x16x32_bf16 v[56:59], v[128:131], v[184:187], v[56:59]
    ds_read2_b32 v[68:69], v236 offset0:128 offset1:129
    v_mfma_f32_16x16x32_bf16 v[56:59], v[132:135], v[180:183], v[56:59]
    ds_read2_b32 v[70:71], v236 offset0:130 offset1:131
    v_mfma_f32_16x16x32_bf16 v[56:59], v[136:139], v[176:179], v[56:59]
    ds_read_b128 v[104:107], v244 offset:10240
    s_waitcnt lgkmcnt(6)
    s_barrier
    v_mfma_f32_16x16x32_bf16 v[56:59], v[140:143], v[172:175], v[56:59]
    ds_read2_b32 v[72:73], v237 offset0:0 offset1:1
    v_mfma_f32_16x16x32_bf16 v[56:59], v[144:147], v[168:171], v[56:59]
    ds_read2_b32 v[74:75], v237 offset0:2 offset1:3
    v_mfma_f32_16x16x32_bf16 v[56:59], v[148:151], v[164:167], v[56:59]
    ds_read_b128 v[108:111], v244 offset:14336
    v_cvt_pk_bf16_f32 v206, v60, v61
    v_mfma_f32_16x16x32_bf16 v[56:59], v[152:155], v[160:163], v[56:59]
    s_lshl_b32 s14, s95, 18
    ds_read2_b32 v[76:77], v237 offset0:128 offset1:129
    v_mfma_f32_16x16x32_bf16 v[52:55], v[128:131], v[180:183], v[52:55]
    s_add_u32 m0, s73, 16384
    ds_read2_b32 v[78:79], v237 offset0:130 offset1:131
    v_mfma_f32_16x16x32_bf16 v[52:55], v[132:135], v[176:179], v[52:55]
    buffer_load_dwordx4 v4, s[52:55], s14 offen offset:0 lds
    v_cvt_pk_bf16_f32 v207, v62, v63
    v_mfma_f32_16x16x32_bf16 v[52:55], v[136:139], v[172:175], v[52:55]
    ds_read_b128 v[112:115], v244 offset:18432
    v_mfma_f32_16x16x32_bf16 v[52:55], v[140:143], v[168:171], v[52:55]
    buffer_store_dwordx2 v[206:207], v8, s[44:47], s6 offen offset:3584 sc1
    ds_read2_b32 v[80:81], v238 offset0:0 offset1:1
    v_mfma_f32_16x16x32_bf16 v[52:55], v[144:147], v[164:167], v[52:55]
    ds_read2_b32 v[82:83], v238 offset0:2 offset1:3
    v_mfma_f32_16x16x32_bf16 v[52:55], v[148:151], v[160:163], v[52:55]
    ds_read_b128 v[116:119], v244 offset:22528
    v_mfma_f32_16x16x32_bf16 v[48:51], v[128:131], v[176:179], v[48:51]
    ds_read2_b32 v[84:85], v238 offset0:128 offset1:129
    v_cvt_pk_bf16_f32 v204, v56, v57
    v_mfma_f32_16x16x32_bf16 v[48:51], v[132:135], v[172:175], v[48:51]
    s_add_u32 m0, s73, 16384
    ds_read2_b32 v[86:87], v238 offset0:130 offset1:131
    v_mfma_f32_16x16x32_bf16 v[48:51], v[136:139], v[168:171], v[48:51]
    buffer_load_dwordx4 v5, s[52:55], s14 offen offset:1024 lds
    ds_read_b128 v[120:123], v244 offset:26624
    v_mfma_f32_16x16x32_bf16 v[48:51], v[140:143], v[164:167], v[48:51]
    ds_read2_b32 v[88:89], v239 offset0:0 offset1:1
    v_cvt_pk_bf16_f32 v205, v58, v59
    v_mfma_f32_16x16x32_bf16 v[48:51], v[144:147], v[160:163], v[48:51]
    ds_read2_b32 v[90:91], v239 offset0:2 offset1:3
    v_mfma_f32_16x16x32_bf16 v[44:47], v[128:131], v[172:175], v[44:47]
    buffer_store_dwordx2 v[204:205], v8, s[44:47], s6 offen offset:3072 sc1
    ds_read_b128 v[124:127], v244 offset:30720
    v_mfma_f32_16x16x32_bf16 v[44:47], v[132:135], v[168:171], v[44:47]
    ds_read2_b32 v[92:93], v239 offset0:128 offset1:129
    v_mfma_f32_16x16x32_bf16 v[44:47], v[136:139], v[164:167], v[44:47]
    ds_read2_b32 v[94:95], v239 offset0:130 offset1:131
    v_mfma_f32_16x16x32_bf16 v[44:47], v[140:143], v[160:163], v[44:47]
    s_add_u32 m0, s73, 16384
    v_cvt_pk_bf16_f32 v202, v52, v53
    v_mfma_f32_16x16x32_bf16 v[40:43], v[128:131], v[168:171], v[40:43]
    buffer_load_dwordx4 v6, s[52:55], s14 offen offset:2048 lds
    v_mfma_f32_16x16x32_bf16 v[40:43], v[132:135], v[164:167], v[40:43]
    v_mfma_f32_16x16x32_bf16 v[40:43], v[136:139], v[160:163], v[40:43]
    v_cvt_pk_bf16_f32 v203, v54, v55
    v_mfma_f32_16x16x32_bf16 v[36:39], v[128:131], v[164:167], v[36:39]
    v_mfma_f32_16x16x32_bf16 v[36:39], v[132:135], v[160:163], v[36:39]
    buffer_store_dwordx2 v[202:203], v8, s[44:47], s6 offen offset:2560 sc1
    v_mfma_f32_16x16x32_bf16 v[32:35], v[128:131], v[160:163], v[32:35]
    s_waitcnt lgkmcnt(0)
    v_mfma_f32_16x16x32_bf16 v[60:63], v[64:67], v[124:127], 0
    ds_read_b128 v[160:163], v245 offset:2048
    s_waitcnt vmcnt(10)
    s_barrier
    v_cvt_pk_bf16_f32 v200, v48, v49
    v_mfma_f32_16x16x32_bf16 v[60:63], v[68:71], v[120:123], v[60:63]
    v_add_u32 v10, 131072, v10
    s_add_u32 m0, s73, 16384
    v_mfma_f32_16x16x32_bf16 v[60:63], v[72:75], v[116:119], v[60:63]
    ds_read_b64_tr_b16 a[144:145], v10 offset:16384
    buffer_load_dwordx4 v7, s[52:55], s14 offen offset:3072 lds
    v_mfma_f32_16x16x32_bf16 v[60:63], v[76:79], v[112:115], v[60:63]
    ds_read_b64_tr_b16 a[146:147], v10 offset:18432
    v_cvt_pk_bf16_f32 v201, v50, v51
    v_mfma_f32_16x16x32_bf16 v[60:63], v[80:83], v[108:111], v[60:63]
    ds_read_b64_tr_b16 a[152:153], v10 offset:20480
    v_mfma_f32_16x16x32_bf16 v[60:63], v[84:87], v[104:107], v[60:63]
    buffer_store_dwordx2 v[200:201], v8, s[44:47], s6 offen offset:2048 sc1
    ds_read_b64_tr_b16 a[154:155], v10 offset:22528
    v_mfma_f32_16x16x32_bf16 v[60:63], v[88:91], v[100:103], v[60:63]
    ds_read2_b32 v[128:129], v236 offset0:16 offset1:17
    v_mfma_f32_16x16x32_bf16 v[60:63], v[92:95], v[96:99], v[60:63]
    v_add_u32 v11, 131072, v11
    v_cvt_pk_bf16_f32 v198, v44, v45
    v_mfma_f32_16x16x32_bf16 v[56:59], v[64:67], v[120:123], 0
    ds_read_b64_tr_b16 a[148:149], v11 offset:16384
    v_mfma_f32_16x16x32_bf16 v[56:59], v[68:71], v[116:119], v[56:59]
    ds_read_b64_tr_b16 a[150:151], v11 offset:18432
    v_mfma_f32_16x16x32_bf16 v[56:59], v[72:75], v[112:115], v[56:59]
    ds_read_b64_tr_b16 a[156:157], v11 offset:20480
    v_cvt_pk_bf16_f32 v199, v46, v47
    v_mfma_f32_16x16x32_bf16 v[56:59], v[76:79], v[108:111], v[56:59]
    ds_read_b64_tr_b16 a[158:159], v11 offset:22528
    v_mfma_f32_16x16x32_bf16 v[56:59], v[80:83], v[104:107], v[56:59]
    buffer_store_dwordx2 v[198:199], v8, s[44:47], s6 offen offset:1536 sc1
    ds_read2_b32 v[130:131], v236 offset0:18 offset1:19
    v_mfma_f32_16x16x32_bf16 v[56:59], v[84:87], v[100:103], v[56:59]
    ds_read_b128 v[164:167], v245 offset:6144
    v_mfma_f32_16x16x32_bf16 v[56:59], v[88:91], v[96:99], v[56:59]
    ds_read2_b32 v[132:133], v236 offset0:144 offset1:145
    v_cvt_pk_bf16_f32 v196, v40, v41
    v_mfma_f32_16x16x32_bf16 v[52:55], v[64:67], v[116:119], 0
    ds_read2_b32 v[134:135], v236 offset0:146 offset1:147
    v_mfma_f32_16x16x32_bf16 v[52:55], v[68:71], v[112:115], v[52:55]
    ds_read_b128 v[168:171], v245 offset:10240
    v_cvt_pk_bf16_f32 v197, v42, v43
    v_mfma_f32_16x16x32_bf16 v[52:55], v[72:75], v[108:111], v[52:55]
    ds_read2_b32 v[136:137], v237 offset0:16 offset1:17
    v_mfma_f32_16x16x32_bf16 v[52:55], v[76:79], v[104:107], v[52:55]
    buffer_store_dwordx2 v[196:197], v8, s[44:47], s6 offen offset:1024 sc1
    ds_read2_b32 v[138:139], v237 offset0:18 offset1:19
    s_waitcnt lgkmcnt(7)
    s_barrier
    v_mfma_f32_16x16x32_bf16 v[52:55], v[80:83], v[100:103], v[52:55]
    ds_read_b128 v[172:175], v245 offset:14336
    v_mfma_f32_16x16x32_bf16 v[52:55], v[84:87], v[96:99], v[52:55]
    ds_read2_b32 v[140:141], v237 offset0:144 offset1:145
    v_cvt_pk_bf16_f32 v194, v36, v37
    v_mfma_f32_16x16x32_bf16 v[48:51], v[64:67], v[112:115], 0
    s_lshl_b32 s14, s96, 18
    ds_read2_b32 v[142:143], v237 offset0:146 offset1:147
    v_mfma_f32_16x16x32_bf16 v[48:51], v[68:71], v[108:111], v[48:51]
    s_add_u32 m0, s73, 147456
    ds_read_b128 v[176:179], v245 offset:18432
    v_mfma_f32_16x16x32_bf16 v[48:51], v[72:75], v[104:107], v[48:51]
L_pl_X_5:
    s_cbranch_execz L_wret
    buffer_load_dwordx4 v4, s[52:55], s14 offen offset:0 lds
    v_cvt_pk_bf16_f32 v195, v38, v39
    v_mfma_f32_16x16x32_bf16 v[48:51], v[76:79], v[100:103], v[48:51]
    ds_read2_b32 v[144:145], v238 offset0:16 offset1:17
    v_mfma_f32_16x16x32_bf16 v[48:51], v[80:83], v[96:99], v[48:51]
    buffer_store_dwordx2 v[194:195], v8, s[44:47], s6 offen offset:512 sc1
    ds_read2_b32 v[146:147], v238 offset0:18 offset1:19
    v_mfma_f32_16x16x32_bf16 v[44:47], v[64:67], v[108:111], 0
    ds_read_b128 v[180:183], v245 offset:22528
    v_mfma_f32_16x16x32_bf16 v[44:47], v[68:71], v[104:107], v[44:47]
    ds_read2_b32 v[148:149], v238 offset0:144 offset1:145
    v_cvt_pk_bf16_f32 v192, v32, v33
    v_mfma_f32_16x16x32_bf16 v[44:47], v[72:75], v[100:103], v[44:47]
    ds_read2_b32 v[150:151], v238 offset0:146 offset1:147
    v_mfma_f32_16x16x32_bf16 v[44:47], v[76:79], v[96:99], v[44:47]
    ds_read_b128 v[184:187], v245 offset:26624
    s_add_u32 m0, s73, 147456
    v_cvt_pk_bf16_f32 v193, v34, v35
    v_mfma_f32_16x16x32_bf16 v[40:43], v[64:67], v[104:107], 0
    buffer_load_dwordx4 v5, s[52:55], s14 offen offset:1024 lds
    ds_read2_b32 v[152:153], v239 offset0:16 offset1:17
    v_mfma_f32_16x16x32_bf16 v[40:43], v[68:71], v[100:103], v[40:43]
    buffer_store_dwordx2 v[192:193], v8, s[44:47], s6 offen offset:0 sc1
    ds_read2_b32 v[154:155], v239 offset0:18 offset1:19
    v_mfma_f32_16x16x32_bf16 v[40:43], v[72:75], v[96:99], v[40:43]
    ds_read_b128 v[188:191], v245 offset:30720
    v_mfma_f32_16x16x32_bf16 v[36:39], v[64:67], v[100:103], 0
    ds_read2_b32 v[156:157], v239 offset0:144 offset1:145
    v_mfma_f32_16x16x32_bf16 v[36:39], v[68:71], v[96:99], v[36:39]
    ds_read2_b32 v[158:159], v239 offset0:146 offset1:147
    v_mfma_f32_16x16x32_bf16 v[32:35], v[64:67], v[96:99], 0
    s_waitcnt lgkmcnt(12)
    v_mfma_f32_16x16x32_bf16 v[32:35], v[128:131], v[160:163], v[32:35]
    ds_read_b128 v[96:99], v246 offset:2048
    v_mfma_f32_16x16x32_bf16 v[36:39], v[132:135], v[160:163], v[36:39]
    s_add_u32 m0, s73, 147456
    ds_read2_b32 v[64:65], v236 offset0:32 offset1:33
    v_mfma_f32_16x16x32_bf16 v[36:39], v[128:131], v[164:167], v[36:39]
    buffer_load_dwordx4 v6, s[52:55], s14 offen offset:2048 lds
    ds_read2_b32 v[66:67], v236 offset0:34 offset1:35
    v_mfma_f32_16x16x32_bf16 v[40:43], v[128:131], v[168:171], v[40:43]
    ds_read_b128 v[100:103], v246 offset:6144
    v_mfma_f32_16x16x32_bf16 v[40:43], v[132:135], v[164:167], v[40:43]
    ds_read2_b32 v[68:69], v236 offset0:160 offset1:161
    v_mfma_f32_16x16x32_bf16 v[40:43], v[136:139], v[160:163], v[40:43]
    ds_read2_b32 v[70:71], v236 offset0:162 offset1:163
    v_mfma_f32_16x16x32_bf16 v[44:47], v[140:143], v[160:163], v[44:47]
    ds_read_b128 v[104:107], v246 offset:10240
    v_mfma_f32_16x16x32_bf16 v[44:47], v[136:139], v[164:167], v[44:47]
    ds_read2_b32 v[72:73], v237 offset0:32 offset1:33
    s_waitcnt vmcnt(15)
    s_barrier
    v_mfma_f32_16x16x32_bf16 v[44:47], v[132:135], v[168:171], v[44:47]
    v_add_u32 v10, -131072, v10
    s_add_u32 m0, s73, 147456
    v_mfma_f32_16x16x32_bf16 v[44:47], v[128:131], v[172:175], v[44:47]
    ds_read_b64_tr_b16 a[160:161], v10 offset:0
    buffer_load_dwordx4 v7, s[52:55], s14 offen offset:3072 lds
    s_waitcnt lgkmcnt(9)
    v_mfma_f32_16x16x32_bf16 v[48:51], v[128:131], v[176:179], v[48:51]
    ds_read_b64_tr_b16 a[162:163], v10 offset:2048
    v_mfma_f32_16x16x32_bf16 v[48:51], v[132:135], v[172:175], v[48:51]
    ds_read_b64_tr_b16 a[168:169], v10 offset:4096
    v_mfma_f32_16x16x32_bf16 v[48:51], v[136:139], v[168:171], v[48:51]
    ds_read2_b32 v[74:75], v237 offset0:34 offset1:35
    v_mfma_f32_16x16x32_bf16 v[48:51], v[140:143], v[164:167], v[48:51]
    ds_read_b64_tr_b16 a[170:171], v10 offset:6144
    v_mfma_f32_16x16x32_bf16 v[48:51], v[144:147], v[160:163], v[48:51]
    ds_read_b128 v[108:111], v246 offset:14336
    v_add_u32 v11, -131072, v11
    v_mfma_f32_16x16x32_bf16 v[52:55], v[148:151], v[160:163], v[52:55]
    ds_read_b64_tr_b16 a[164:165], v11 offset:0
    v_mfma_f32_16x16x32_bf16 v[52:55], v[144:147], v[164:167], v[52:55]
    ds_read_b64_tr_b16 a[166:167], v11 offset:2048
    v_mfma_f32_16x16x32_bf16 v[52:55], v[140:143], v[168:171], v[52:55]
    ds_read_b64_tr_b16 a[172:173], v11 offset:4096
    v_mfma_f32_16x16x32_bf16 v[52:55], v[136:139], v[172:175], v[52:55]
    ds_read_b64_tr_b16 a[174:175], v11 offset:6144
    v_mfma_f32_16x16x32_bf16 v[52:55], v[132:135], v[176:179], v[52:55]
    ds_read2_b32 v[76:77], v237 offset0:160 offset1:161
    v_mfma_f32_16x16x32_bf16 v[52:55], v[128:131], v[180:183], v[52:55]
    ds_read2_b32 v[78:79], v237 offset0:162 offset1:163
    v_mfma_f32_16x16x32_bf16 v[56:59], v[128:131], v[184:187], v[56:59]
    ds_read_b128 v[112:115], v246 offset:18432
    v_mfma_f32_16x16x32_bf16 v[56:59], v[132:135], v[180:183], v[56:59]
    ds_read2_b32 v[80:81], v238 offset0:32 offset1:33
    v_mfma_f32_16x16x32_bf16 v[56:59], v[136:139], v[176:179], v[56:59]
    ds_read2_b32 v[82:83], v238 offset0:34 offset1:35
    v_mfma_f32_16x16x32_bf16 v[56:59], v[140:143], v[172:175], v[56:59]
    ds_read_b128 v[116:119], v246 offset:22528
    v_mfma_f32_16x16x32_bf16 v[56:59], v[144:147], v[168:171], v[56:59]
    ds_read2_b32 v[84:85], v238 offset0:160 offset1:161
    s_waitcnt lgkmcnt(7)
    s_barrier
    v_mfma_f32_16x16x32_bf16 v[56:59], v[148:151], v[164:167], v[56:59]
    ds_read2_b32 v[86:87], v238 offset0:162 offset1:163
    v_mfma_f32_16x16x32_bf16 v[56:59], v[152:155], v[160:163], v[56:59]
    ds_read_b128 v[120:123], v246 offset:26624
    v_mfma_f32_16x16x32_bf16 v[60:63], v[156:159], v[160:163], v[60:63]
    s_lshl_b32 s14, s97, 18
    ds_read2_b32 v[88:89], v239 offset0:32 offset1:33
    v_mfma_f32_16x16x32_bf16 v[60:63], v[152:155], v[164:167], v[60:63]
    s_add_u32 m0, s73, 0
    ds_read2_b32 v[90:91], v239 offset0:34 offset1:35
    v_mfma_f32_16x16x32_bf16 v[60:63], v[148:151], v[168:171], v[60:63]
    buffer_load_dwordx4 v4, s[52:55], s14 offen offset:0 lds
    v_mfma_f32_16x16x32_bf16 v[60:63], v[144:147], v[172:175], v[60:63]
    ds_read_b128 v[124:127], v246 offset:30720
    v_mfma_f32_16x16x32_bf16 v[60:63], v[140:143], v[176:179], v[60:63]
    ds_read2_b32 v[92:93], v239 offset0:160 offset1:161
    v_mfma_f32_16x16x32_bf16 v[60:63], v[136:139], v[180:183], v[60:63]
    v_mfma_f32_16x16x32_bf16 v[60:63], v[132:135], v[184:187], v[60:63]
    ds_read2_b32 v[94:95], v239 offset0:162 offset1:163
    v_mfma_f32_16x16x32_bf16 v[60:63], v[128:131], v[188:191], v[60:63]
    s_waitcnt lgkmcnt(12)
    v_mfma_f32_16x16x32_bf16 v[32:35], v[64:67], v[96:99], v[32:35]
    ds_read_b128 v[160:163], v247 offset:2048
    v_mfma_f32_16x16x32_bf16 v[36:39], v[68:71], v[96:99], v[36:39]
    s_add_u32 m0, s73, 0
    v_mfma_f32_16x16x32_bf16 v[36:39], v[64:67], v[100:103], v[36:39]
    buffer_load_dwordx4 v5, s[52:55], s14 offen offset:1024 lds
    ds_read2_b32 v[128:129], v236 offset0:48 offset1:49
    v_mfma_f32_16x16x32_bf16 v[40:43], v[64:67], v[104:107], v[40:43]
    ds_read2_b32 v[130:131], v236 offset0:50 offset1:51
    v_mfma_f32_16x16x32_bf16 v[40:43], v[68:71], v[100:103], v[40:43]
    v_mfma_f32_16x16x32_bf16 v[40:43], v[72:75], v[96:99], v[40:43]
    ds_read_b128 v[164:167], v247 offset:6144
    v_mfma_f32_16x16x32_bf16 v[44:47], v[76:79], v[96:99], v[44:47]
    ds_read2_b32 v[132:133], v236 offset0:176 offset1:177
    v_mfma_f32_16x16x32_bf16 v[44:47], v[72:75], v[100:103], v[44:47]
    v_mfma_f32_16x16x32_bf16 v[44:47], v[68:71], v[104:107], v[44:47]
    s_add_u32 m0, s73, 0
    ds_read2_b32 v[134:135], v236 offset0:178 offset1:179
    v_mfma_f32_16x16x32_bf16 v[44:47], v[64:67], v[108:111], v[44:47]
    buffer_load_dwordx4 v6, s[52:55], s14 offen offset:2048 lds
    ds_read_b128 v[168:171], v247 offset:10240
    s_waitcnt lgkmcnt(7)
    v_mfma_f32_16x16x32_bf16 v[48:51], v[64:67], v[112:115], v[48:51]
    ds_read2_b32 v[136:137], v237 offset0:48 offset1:49
    v_mfma_f32_16x16x32_bf16 v[48:51], v[68:71], v[108:111], v[48:51]
    ds_read2_b32 v[138:139], v237 offset0:50 offset1:51
    v_mfma_f32_16x16x32_bf16 v[48:51], v[72:75], v[104:107], v[48:51]
    ds_read_b128 v[172:175], v247 offset:14336
    v_mfma_f32_16x16x32_bf16 v[48:51], v[76:79], v[100:103], v[48:51]
    ds_read2_b32 v[140:141], v237 offset0:176 offset1:177
    v_mfma_f32_16x16x32_bf16 v[48:51], v[80:83], v[96:99], v[48:51]
    ds_read2_b32 v[142:143], v237 offset0:178 offset1:179
    s_waitcnt vmcnt(12)
    s_barrier
    v_mfma_f32_16x16x32_bf16 v[52:55], v[84:87], v[96:99], v[52:55]
    ds_read_b64_tr_b16 a[176:177], v10 offset:16384
    s_add_u32 m0, s73, 0
    v_mfma_f32_16x16x32_bf16 v[52:55], v[80:83], v[100:103], v[52:55]
    buffer_load_dwordx4 v7, s[52:55], s14 offen offset:3072 lds
    ds_read_b128 v[176:179], v247 offset:18432
    v_mfma_f32_16x16x32_bf16 v[52:55], v[76:79], v[104:107], v[52:55]
    ds_read_b64_tr_b16 a[178:179], v10 offset:18432
    v_mfma_f32_16x16x32_bf16 v[52:55], v[72:75], v[108:111], v[52:55]
    ds_read_b64_tr_b16 a[184:185], v10 offset:20480
    v_mfma_f32_16x16x32_bf16 v[52:55], v[68:71], v[112:115], v[52:55]
    ds_read2_b32 v[144:145], v238 offset0:48 offset1:49
    v_mfma_f32_16x16x32_bf16 v[52:55], v[64:67], v[116:119], v[52:55]
    ds_read_b64_tr_b16 a[186:187], v10 offset:22528
    v_mfma_f32_16x16x32_bf16 v[56:59], v[64:67], v[120:123], v[56:59]
    ds_read_b64_tr_b16 a[180:181], v11 offset:16384
    v_mfma_f32_16x16x32_bf16 v[56:59], v[68:71], v[116:119], v[56:59]
    ds_read2_b32 v[146:147], v238 offset0:50 offset1:51
    v_mfma_f32_16x16x32_bf16 v[56:59], v[72:75], v[112:115], v[56:59]
    ds_read_b64_tr_b16 a[182:183], v11 offset:18432
    v_mfma_f32_16x16x32_bf16 v[56:59], v[76:79], v[108:111], v[56:59]
    ds_read_b64_tr_b16 a[188:189], v11 offset:20480
    v_mfma_f32_16x16x32_bf16 v[56:59], v[80:83], v[104:107], v[56:59]
    ds_read_b64_tr_b16 a[190:191], v11 offset:22528
    v_mfma_f32_16x16x32_bf16 v[56:59], v[84:87], v[100:103], v[56:59]
    ds_read_b128 v[180:183], v247 offset:22528
    v_mfma_f32_16x16x32_bf16 v[56:59], v[88:91], v[96:99], v[56:59]
    ds_read2_b32 v[148:149], v238 offset0:176 offset1:177
    v_mfma_f32_16x16x32_bf16 v[60:63], v[92:95], v[96:99], v[60:63]
    ds_read2_b32 v[150:151], v238 offset0:178 offset1:179
    v_mfma_f32_16x16x32_bf16 v[60:63], v[88:91], v[100:103], v[60:63]
    ds_read_b128 v[184:187], v247 offset:26624
    v_mfma_f32_16x16x32_bf16 v[60:63], v[84:87], v[104:107], v[60:63]
    ds_read2_b32 v[152:153], v239 offset0:48 offset1:49
    v_mfma_f32_16x16x32_bf16 v[60:63], v[80:83], v[108:111], v[60:63]
    ds_read2_b32 v[154:155], v239 offset0:50 offset1:51
    v_mfma_f32_16x16x32_bf16 v[60:63], v[76:79], v[112:115], v[60:63]
    ds_read_b128 v[188:191], v247 offset:30720
    s_waitcnt lgkmcnt(7)
    s_barrier
    v_mfma_f32_16x16x32_bf16 v[60:63], v[72:75], v[116:119], v[60:63]
    ds_read2_b32 v[156:157], v239 offset0:176 offset1:177
    v_mfma_f32_16x16x32_bf16 v[60:63], v[68:71], v[120:123], v[60:63]
    ds_read2_b32 v[158:159], v239 offset0:178 offset1:179
    v_mfma_f32_16x16x32_bf16 v[60:63], v[64:67], v[124:127], v[60:63]
    v_mfma_f32_16x16x32_bf16 v[32:35], v[128:131], v[160:163], v[32:35]
    s_lshl_b32 s14, s98, 18
    ds_read_b128 v[96:99], v244 offset:0
    v_mfma_f32_16x16x32_bf16 v[36:39], v[132:135], v[160:163], v[36:39]
    s_add_u32 m0, s73, 16384
    v_mfma_f32_16x16x32_bf16 v[36:39], v[128:131], v[164:167], v[36:39]
    buffer_load_dwordx4 v4, s[52:55], s14 offen offset:0 lds
    ds_read2_b32 v[64:65], v236 offset0:64 offset1:65
    v_mfma_f32_16x16x32_bf16 v[40:43], v[128:131], v[168:171], v[40:43]
    ds_read2_b32 v[66:67], v236 offset0:66 offset1:67
    v_mfma_f32_16x16x32_bf16 v[40:43], v[132:135], v[164:167], v[40:43]
    v_mfma_f32_16x16x32_bf16 v[40:43], v[136:139], v[160:163], v[40:43]
    ds_read_b128 v[100:103], v244 offset:4096
    v_mfma_f32_16x16x32_bf16 v[44:47], v[140:143], v[160:163], v[44:47]
    ds_read2_b32 v[68:69], v236 offset0:192 offset1:193
    v_mfma_f32_16x16x32_bf16 v[44:47], v[136:139], v[164:167], v[44:47]
    ds_read2_b32 v[70:71], v236 offset0:194 offset1:195
    v_mfma_f32_16x16x32_bf16 v[44:47], v[132:135], v[168:171], v[44:47]
    s_add_u32 m0, s73, 16384
    ds_read_b128 v[104:107], v244 offset:8192
    v_mfma_f32_16x16x32_bf16 v[44:47], v[128:131], v[172:175], v[44:47]
    buffer_load_dwordx4 v5, s[52:55], s14 offen offset:1024 lds
    ds_read2_b32 v[72:73], v237 offset0:64 offset1:65
    s_waitcnt lgkmcnt(8)
    v_mfma_f32_16x16x32_bf16 v[48:51], v[128:131], v[176:179], v[48:51]
    ds_read2_b32 v[74:75], v237 offset0:66 offset1:67
    v_mfma_f32_16x16x32_bf16 v[48:51], v[132:135], v[172:175], v[48:51]
    ds_read_b128 v[108:111], v244 offset:12288
    v_mfma_f32_16x16x32_bf16 v[48:51], v[136:139], v[168:171], v[48:51]
    ds_read2_b32 v[76:77], v237 offset0:192 offset1:193
    v_mfma_f32_16x16x32_bf16 v[48:51], v[140:143], v[164:167], v[48:51]
    ds_read2_b32 v[78:79], v237 offset0:194 offset1:195
    v_mfma_f32_16x16x32_bf16 v[48:51], v[144:147], v[160:163], v[48:51]
    ds_read_b128 v[112:115], v244 offset:16384
    v_mfma_f32_16x16x32_bf16 v[52:55], v[148:151], v[160:163], v[52:55]
    s_add_u32 m0, s73, 16384
    ds_read2_b32 v[80:81], v238 offset0:64 offset1:65
    v_mfma_f32_16x16x32_bf16 v[52:55], v[144:147], v[164:167], v[52:55]
    buffer_load_dwordx4 v6, s[52:55], s14 offen offset:2048 lds
    ds_read2_b32 v[82:83], v238 offset0:66 offset1:67
    v_mfma_f32_16x16x32_bf16 v[52:55], v[140:143], v[168:171], v[52:55]
    ds_read_b128 v[116:119], v244 offset:20480
    v_mfma_f32_16x16x32_bf16 v[52:55], v[136:139], v[172:175], v[52:55]
    ds_read2_b32 v[84:85], v238 offset0:192 offset1:193
    v_mfma_f32_16x16x32_bf16 v[52:55], v[132:135], v[176:179], v[52:55]
    ds_read2_b32 v[86:87], v238 offset0:194 offset1:195
    v_mfma_f32_16x16x32_bf16 v[52:55], v[128:131], v[180:183], v[52:55]
    ds_read_b128 v[120:123], v244 offset:24576
    v_mfma_f32_16x16x32_bf16 v[56:59], v[128:131], v[184:187], v[56:59]
    ds_read2_b32 v[88:89], v239 offset0:64 offset1:65
    s_waitcnt vmcnt(7)
    s_barrier
    v_mfma_f32_16x16x32_bf16 v[56:59], v[132:135], v[180:183], v[56:59]
    v_add_u32 v10, 131072, v10
    s_add_u32 m0, s73, 16384
    v_mfma_f32_16x16x32_bf16 v[56:59], v[136:139], v[176:179], v[56:59]
    ds_read_b64_tr_b16 a[192:193], v10 offset:16384
    buffer_load_dwordx4 v7, s[52:55], s14 offen offset:3072 lds
    v_mfma_f32_16x16x32_bf16 v[56:59], v[140:143], v[172:175], v[56:59]
    ds_read2_b32 v[90:91], v239 offset0:66 offset1:67
    v_mfma_f32_16x16x32_bf16 v[56:59], v[144:147], v[168:171], v[56:59]
    ds_read_b64_tr_b16 a[194:195], v10 offset:18432
    v_mfma_f32_16x16x32_bf16 v[56:59], v[148:151], v[164:167], v[56:59]
    ds_read_b64_tr_b16 a[200:201], v10 offset:20480
    v_mfma_f32_16x16x32_bf16 v[56:59], v[152:155], v[160:163], v[56:59]
    ds_read_b64_tr_b16 a[202:203], v10 offset:22528
    v_mfma_f32_16x16x32_bf16 v[60:63], v[156:159], v[160:163], v[60:63]
    ds_read_b128 v[124:127], v244 offset:28672
    v_add_u32 v11, 131072, v11
    v_mfma_f32_16x16x32_bf16 v[60:63], v[152:155], v[164:167], v[60:63]
    ds_read_b64_tr_b16 a[196:197], v11 offset:16384
    v_mfma_f32_16x16x32_bf16 v[60:63], v[148:151], v[168:171], v[60:63]
    ds_read2_b32 v[92:93], v239 offset0:192 offset1:193
    v_mfma_f32_16x16x32_bf16 v[60:63], v[144:147], v[172:175], v[60:63]
    ds_read_b64_tr_b16 a[198:199], v11 offset:18432
    v_mfma_f32_16x16x32_bf16 v[60:63], v[140:143], v[176:179], v[60:63]
    ds_read_b64_tr_b16 a[204:205], v11 offset:20480
    v_mfma_f32_16x16x32_bf16 v[60:63], v[136:139], v[180:183], v[60:63]
    ds_read_b64_tr_b16 a[206:207], v11 offset:22528
    v_mfma_f32_16x16x32_bf16 v[60:63], v[132:135], v[184:187], v[60:63]
    ds_read2_b32 v[94:95], v239 offset0:194 offset1:195
    v_mfma_f32_16x16x32_bf16 v[60:63], v[128:131], v[188:191], v[60:63]
    s_waitcnt lgkmcnt(15)
    v_mfma_f32_16x16x32_bf16 v[32:35], v[64:67], v[96:99], v[32:35]
    ds_read_b128 v[160:163], v245 offset:0
    v_mfma_f32_16x16x32_bf16 v[36:39], v[68:71], v[96:99], v[36:39]
    v_mfma_f32_16x16x32_bf16 v[36:39], v[64:67], v[100:103], v[36:39]
    ds_read2_b32 v[128:129], v236 offset0:80 offset1:81
    v_mfma_f32_16x16x32_bf16 v[40:43], v[64:67], v[104:107], v[40:43]
    ds_read2_b32 v[130:131], v236 offset0:82 offset1:83
    s_waitcnt lgkmcnt(4)
    s_barrier
    v_mfma_f32_16x16x32_bf16 v[40:43], v[68:71], v[100:103], v[40:43]
    v_mfma_f32_16x16x32_bf16 v[40:43], v[72:75], v[96:99], v[40:43]
    ds_read_b128 v[164:167], v245 offset:4096
    v_mfma_f32_16x16x32_bf16 v[44:47], v[76:79], v[96:99], v[44:47]
    ds_read2_b32 v[132:133], v236 offset0:208 offset1:209
    v_mfma_f32_16x16x32_bf16 v[44:47], v[72:75], v[100:103], v[44:47]
    s_lshl_b32 s14, s99, 18
    v_mfma_f32_16x16x32_bf16 v[44:47], v[68:71], v[104:107], v[44:47]
    s_add_u32 m0, s73, 147456
    ds_read2_b32 v[134:135], v236 offset0:210 offset1:211
    v_mfma_f32_16x16x32_bf16 v[44:47], v[64:67], v[108:111], v[44:47]
    buffer_load_dwordx4 v4, s[52:55], s14 offen offset:0 lds
    ds_read_b128 v[168:171], v245 offset:8192
    s_waitcnt lgkmcnt(7)
    v_mfma_f32_16x16x32_bf16 v[48:51], v[64:67], v[112:115], v[48:51]
    ds_read2_b32 v[136:137], v237 offset0:80 offset1:81
    v_mfma_f32_16x16x32_bf16 v[48:51], v[68:71], v[108:111], v[48:51]
    v_mfma_f32_16x16x32_bf16 v[48:51], v[72:75], v[104:107], v[48:51]
    ds_read2_b32 v[138:139], v237 offset0:82 offset1:83
    v_mfma_f32_16x16x32_bf16 v[48:51], v[76:79], v[100:103], v[48:51]
    ds_read_b128 v[172:175], v245 offset:12288
    v_mfma_f32_16x16x32_bf16 v[48:51], v[80:83], v[96:99], v[48:51]
    v_mfma_f32_16x16x32_bf16 v[52:55], v[84:87], v[96:99], v[52:55]
    s_add_u32 m0, s73, 147456
    ds_read2_b32 v[140:141], v237 offset0:208 offset1:209
    v_mfma_f32_16x16x32_bf16 v[52:55], v[80:83], v[100:103], v[52:55]
    buffer_load_dwordx4 v5, s[52:55], s14 offen offset:1024 lds
    ds_read2_b32 v[142:143], v237 offset0:210 offset1:211
    v_mfma_f32_16x16x32_bf16 v[52:55], v[76:79], v[104:107], v[52:55]
    v_mfma_f32_16x16x32_bf16 v[52:55], v[72:75], v[108:111], v[52:55]
    ds_read_b128 v[176:179], v245 offset:16384
    v_mfma_f32_16x16x32_bf16 v[52:55], v[68:71], v[112:115], v[52:55]
    ds_read2_b32 v[144:145], v238 offset0:80 offset1:81
    v_mfma_f32_16x16x32_bf16 v[52:55], v[64:67], v[116:119], v[52:55]
    ds_read2_b32 v[146:147], v238 offset0:82 offset1:83
    v_mfma_f32_16x16x32_bf16 v[56:59], v[64:67], v[120:123], v[56:59]
    ds_read_b128 v[180:183], v245 offset:20480
    v_mfma_f32_16x16x32_bf16 v[56:59], v[68:71], v[116:119], v[56:59]
    s_add_u32 m0, s73, 147456
    ds_read2_b32 v[148:149], v238 offset0:208 offset1:209
    v_mfma_f32_16x16x32_bf16 v[56:59], v[72:75], v[112:115], v[56:59]
    buffer_load_dwordx4 v6, s[52:55], s14 offen offset:2048 lds
    ds_read2_b32 v[150:151], v238 offset0:210 offset1:211
    v_mfma_f32_16x16x32_bf16 v[56:59], v[76:79], v[108:111], v[56:59]
    ds_read_b128 v[184:187], v245 offset:24576
    v_mfma_f32_16x16x32_bf16 v[56:59], v[80:83], v[104:107], v[56:59]
    ds_read2_b32 v[152:153], v239 offset0:80 offset1:81
    v_mfma_f32_16x16x32_bf16 v[56:59], v[84:87], v[100:103], v[56:59]
    ds_read2_b32 v[154:155], v239 offset0:82 offset1:83
    v_mfma_f32_16x16x32_bf16 v[56:59], v[88:91], v[96:99], v[56:59]
    ds_read_b128 v[188:191], v245 offset:28672
    v_mfma_f32_16x16x32_bf16 v[60:63], v[92:95], v[96:99], v[60:63]
    ds_read2_b32 v[156:157], v239 offset0:208 offset1:209
    s_waitcnt vmcnt(7)
    s_barrier
    v_mfma_f32_16x16x32_bf16 v[60:63], v[88:91], v[100:103], v[60:63]
    v_add_u32 v10, -131072, v10
    s_add_u32 m0, s73, 147456
    v_mfma_f32_16x16x32_bf16 v[60:63], v[84:87], v[104:107], v[60:63]
    buffer_load_dwordx4 v7, s[52:55], s14 offen offset:3072 lds
    ds_read2_b32 v[158:159], v239 offset0:210 offset1:211
    v_mfma_f32_16x16x32_bf16 v[60:63], v[80:83], v[108:111], v[60:63]
    ds_read_b64_tr_b16 a[208:209], v10 offset:0
    v_mfma_f32_16x16x32_bf16 v[60:63], v[76:79], v[112:115], v[60:63]
    ds_read_b64_tr_b16 a[210:211], v10 offset:2048
    v_mfma_f32_16x16x32_bf16 v[60:63], v[72:75], v[116:119], v[60:63]
    ds_read_b64_tr_b16 a[216:217], v10 offset:4096
    v_mfma_f32_16x16x32_bf16 v[60:63], v[68:71], v[120:123], v[60:63]
    ds_read_b64_tr_b16 a[218:219], v10 offset:6144
    v_mfma_f32_16x16x32_bf16 v[60:63], v[64:67], v[124:127], v[60:63]
    v_add_u32 v11, -131072, v11
    s_waitcnt lgkmcnt(15)
    v_mfma_f32_16x16x32_bf16 v[32:35], v[128:131], v[160:163], v[32:35]
    ds_read_b128 v[96:99], v246 offset:0
    v_mfma_f32_16x16x32_bf16 v[36:39], v[132:135], v[160:163], v[36:39]
    ds_read_b64_tr_b16 a[212:213], v11 offset:0
    v_mfma_f32_16x16x32_bf16 v[36:39], v[128:131], v[164:167], v[36:39]
    ds_read_b64_tr_b16 a[214:215], v11 offset:2048
    v_mfma_f32_16x16x32_bf16 v[40:43], v[128:131], v[168:171], v[40:43]
    ds_read_b64_tr_b16 a[220:221], v11 offset:4096
    v_mfma_f32_16x16x32_bf16 v[40:43], v[132:135], v[164:167], v[40:43]
    ds_read_b64_tr_b16 a[222:223], v11 offset:6144
    v_mfma_f32_16x16x32_bf16 v[40:43], v[136:139], v[160:163], v[40:43]
    ds_read2_b32 v[64:65], v236 offset0:96 offset1:97
    v_mfma_f32_16x16x32_bf16 v[44:47], v[140:143], v[160:163], v[44:47]
    ds_read2_b32 v[66:67], v236 offset0:98 offset1:99
    v_mfma_f32_16x16x32_bf16 v[44:47], v[136:139], v[164:167], v[44:47]
    ds_read_b128 v[100:103], v246 offset:4096
    v_mfma_f32_16x16x32_bf16 v[44:47], v[132:135], v[168:171], v[44:47]
    ds_read2_b32 v[68:69], v236 offset0:224 offset1:225
    v_mfma_f32_16x16x32_bf16 v[44:47], v[128:131], v[172:175], v[44:47]
    ds_read2_b32 v[70:71], v236 offset0:226 offset1:227
    s_waitcnt lgkmcnt(14)
    v_mfma_f32_16x16x32_bf16 v[48:51], v[128:131], v[176:179], v[48:51]
    ds_read_b128 v[104:107], v246 offset:8192
    s_waitcnt lgkmcnt(6)
    s_barrier
    v_mfma_f32_16x16x32_bf16 v[48:51], v[132:135], v[172:175], v[48:51]
    ds_read2_b32 v[72:73], v237 offset0:96 offset1:97
    v_mfma_f32_16x16x32_bf16 v[48:51], v[136:139], v[168:171], v[48:51]
    ds_read2_b32 v[74:75], v237 offset0:98 offset1:99
    v_mfma_f32_16x16x32_bf16 v[48:51], v[140:143], v[164:167], v[48:51]
    ds_read_b128 v[108:111], v246 offset:12288
    v_mfma_f32_16x16x32_bf16 v[48:51], v[144:147], v[160:163], v[48:51]
    s_lshl_b32 s14, s100, 18
    v_mfma_f32_16x16x32_bf16 v[52:55], v[148:151], v[160:163], v[52:55]
    s_add_u32 m0, s73, 0
    ds_read2_b32 v[76:77], v237 offset0:224 offset1:225
    v_mfma_f32_16x16x32_bf16 v[52:55], v[144:147], v[164:167], v[52:55]
    buffer_load_dwordx4 v4, s[52:55], s14 offen offset:0 lds
    ds_read2_b32 v[78:79], v237 offset0:226 offset1:227
    v_mfma_f32_16x16x32_bf16 v[52:55], v[140:143], v[168:171], v[52:55]
    v_mfma_f32_16x16x32_bf16 v[52:55], v[136:139], v[172:175], v[52:55]
    ds_read_b128 v[112:115], v246 offset:16384
    v_mfma_f32_16x16x32_bf16 v[52:55], v[132:135], v[176:179], v[52:55]
    ds_read2_b32 v[80:81], v238 offset0:96 offset1:97
    v_mfma_f32_16x16x32_bf16 v[52:55], v[128:131], v[180:183], v[52:55]
    v_mfma_f32_16x16x32_bf16 v[56:59], v[128:131], v[184:187], v[56:59]
    ds_read2_b32 v[82:83], v238 offset0:98 offset1:99
    v_mfma_f32_16x16x32_bf16 v[56:59], v[132:135], v[180:183], v[56:59]
    s_add_u32 m0, s73, 0
    ds_read_b128 v[116:119], v246 offset:20480
    v_mfma_f32_16x16x32_bf16 v[56:59], v[136:139], v[176:179], v[56:59]
    buffer_load_dwordx4 v5, s[52:55], s14 offen offset:1024 lds
    v_mfma_f32_16x16x32_bf16 v[56:59], v[140:143], v[172:175], v[56:59]
    ds_read2_b32 v[84:85], v238 offset0:224 offset1:225
    v_mfma_f32_16x16x32_bf16 v[56:59], v[144:147], v[168:171], v[56:59]
    ds_read2_b32 v[86:87], v238 offset0:226 offset1:227
    v_mfma_f32_16x16x32_bf16 v[56:59], v[148:151], v[164:167], v[56:59]
    ds_read_b128 v[120:123], v246 offset:24576
    v_mfma_f32_16x16x32_bf16 v[56:59], v[152:155], v[160:163], v[56:59]
    v_mfma_f32_16x16x32_bf16 v[60:63], v[156:159], v[160:163], v[60:63]
    ds_read2_b32 v[88:89], v239 offset0:96 offset1:97
    v_mfma_f32_16x16x32_bf16 v[60:63], v[152:155], v[164:167], v[60:63]
    s_add_u32 m0, s73, 0
    ds_read2_b32 v[90:91], v239 offset0:98 offset1:99
    v_mfma_f32_16x16x32_bf16 v[60:63], v[148:151], v[168:171], v[60:63]
    buffer_load_dwordx4 v6, s[52:55], s14 offen offset:2048 lds
    v_mfma_f32_16x16x32_bf16 v[60:63], v[144:147], v[172:175], v[60:63]
    ds_read_b128 v[124:127], v246 offset:28672
    v_mfma_f32_16x16x32_bf16 v[60:63], v[140:143], v[176:179], v[60:63]
    ds_read2_b32 v[92:93], v239 offset0:224 offset1:225
    v_mfma_f32_16x16x32_bf16 v[60:63], v[136:139], v[180:183], v[60:63]
    v_mfma_f32_16x16x32_bf16 v[60:63], v[132:135], v[184:187], v[60:63]
    ds_read2_b32 v[94:95], v239 offset0:226 offset1:227
    v_mfma_f32_16x16x32_bf16 v[60:63], v[128:131], v[188:191], v[60:63]
    s_waitcnt lgkmcnt(12)
    v_mfma_f32_16x16x32_bf16 v[32:35], v[64:67], v[96:99], v[32:35]
    ds_read_b128 v[160:163], v247 offset:0
    s_waitcnt vmcnt(7)
    s_barrier
    v_mfma_f32_16x16x32_bf16 v[36:39], v[68:71], v[96:99], v[36:39]
    ds_read_b64_tr_b16 a[224:225], v10 offset:16384
    s_add_u32 m0, s73, 0
    s_bfe_u32 s4, s2, 0x20003
    v_mfma_f32_16x16x32_bf16 v[36:39], v[64:67], v[100:103], v[36:39]
    ds_read_b64_tr_b16 a[226:227], v10 offset:18432
    buffer_load_dwordx4 v7, s[52:55], s14 offen offset:3072 lds
    ds_read_b128 v[164:167], v247 offset:4096
    v_mfma_f32_16x16x32_bf16 v[40:43], v[64:67], v[104:107], v[40:43]
    s_lshl2_add_u32 s4, s72, s4
    ds_read_b128 v[168:171], v247 offset:8192
    v_mfma_f32_16x16x32_bf16 v[40:43], v[68:71], v[100:103], v[40:43]
    ds_read_b64_tr_b16 a[232:233], v10 offset:20480
    ds_read_b128 v[172:175], v247 offset:12288
    v_mfma_f32_16x16x32_bf16 v[40:43], v[72:75], v[96:99], v[40:43]
    ds_read_b64_tr_b16 a[234:235], v10 offset:22528
    s_lshl_b32 s4, s4, 3
    v_mfma_f32_16x16x32_bf16 v[44:47], v[76:79], v[96:99], v[44:47]
    ds_read_b128 v[176:179], v247 offset:16384
    v_mfma_f32_16x16x32_bf16 v[44:47], v[72:75], v[100:103], v[44:47]
    ds_read_b64_tr_b16 a[228:229], v11 offset:16384
    s_lshr_b32 s5, s2, 4
    ds_read_b128 v[180:183], v247 offset:20480
    v_mfma_f32_16x16x32_bf16 v[44:47], v[68:71], v[104:107], v[44:47]
    ds_read_b64_tr_b16 a[230:231], v11 offset:18432
    v_mfma_f32_16x16x32_bf16 v[44:47], v[64:67], v[108:111], v[44:47]
    s_and_b32 s5, s5, 6
    ds_read_b128 v[184:187], v247 offset:24576
    s_waitcnt lgkmcnt(13)
    v_mfma_f32_16x16x32_bf16 v[48:51], v[64:67], v[112:115], v[48:51]
    ds_read_b64_tr_b16 a[236:237], v11 offset:20480
    ds_read_b128 v[188:191], v247 offset:28672
    v_mfma_f32_16x16x32_bf16 v[48:51], v[68:71], v[108:111], v[48:51]
    ds_read_b64_tr_b16 a[238:239], v11 offset:22528
    s_add_u32 s4, s4, s5
    v_mfma_f32_16x16x32_bf16 v[48:51], v[72:75], v[104:107], v[48:51]
    ds_read2_b32 v[128:129], v236 offset0:112 offset1:113
    v_mfma_f32_16x16x32_bf16 v[48:51], v[76:79], v[100:103], v[48:51]
    s_and_b32 s5, s2, 1
    ds_read2_b32 v[130:131], v236 offset0:114 offset1:115
    v_mfma_f32_16x16x32_bf16 v[48:51], v[80:83], v[96:99], v[48:51]
    ds_read2_b32 v[132:133], v236 offset0:240 offset1:241
    v_mfma_f32_16x16x32_bf16 v[52:55], v[84:87], v[96:99], v[52:55]
    s_add_u32 s4, s4, s5
    ds_read2_b32 v[134:135], v236 offset0:242 offset1:243
    v_mfma_f32_16x16x32_bf16 v[52:55], v[80:83], v[100:103], v[52:55]
    ds_read2_b32 v[136:137], v237 offset0:112 offset1:113
    v_mfma_f32_16x16x32_bf16 v[52:55], v[76:79], v[104:107], v[52:55]
    s_lshl_b32 s4, s4, 7
    ds_read2_b32 v[138:139], v237 offset0:114 offset1:115
    s_add_u32 s6, s12, 4767744
    v_mfma_f32_16x16x32_bf16 v[52:55], v[72:75], v[108:111], v[52:55]
    s_waitcnt lgkmcnt(6)
    s_barrier
    ds_read2_b32 v[140:141], v237 offset0:240 offset1:241
    s_add_u32 s4, s4, 12566528
    v_mfma_f32_16x16x32_bf16 v[52:55], v[68:71], v[112:115], v[52:55]
    ds_read2_b32 v[142:143], v237 offset0:242 offset1:243
    v_mfma_f32_16x16x32_bf16 v[52:55], v[64:67], v[116:119], v[52:55]
    ds_read2_b32 v[144:145], v238 offset0:112 offset1:113
    v_lshl_add_u32 v28, v2, 2, s4
    v_mfma_f32_16x16x32_bf16 v[56:59], v[64:67], v[120:123], v[56:59]
    s_lshl_b32 s14, s101, 18
    ds_read2_b32 v[146:147], v238 offset0:114 offset1:115
    v_mfma_f32_16x16x32_bf16 v[56:59], v[68:71], v[116:119], v[56:59]
    s_add_u32 m0, s73, 16384
    s_cmp_eq_u32 s3, 0
    s_cselect_b32 s4, 18, 0
    v_mfma_f32_16x16x32_bf16 v[56:59], v[72:75], v[112:115], v[56:59]
    buffer_load_dwordx4 v4, s[52:55], s14 offen offset:0 lds
    ds_read2_b32 v[148:149], v238 offset0:240 offset1:241
    v_mfma_f32_16x16x32_bf16 v[56:59], v[76:79], v[108:111], v[56:59]
    ds_read2_b32 v[150:151], v238 offset0:242 offset1:243
    v_cmp_gt_u32 vcc, s4, v2
    v_mfma_f32_16x16x32_bf16 v[56:59], v[80:83], v[104:107], v[56:59]
    ds_read2_b32 v[152:153], v239 offset0:112 offset1:113
    v_mfma_f32_16x16x32_bf16 v[56:59], v[84:87], v[100:103], v[56:59]
    ds_read2_b32 v[154:155], v239 offset0:114 offset1:115
    v_mov_b32 v13, 0x40000000
    v_mfma_f32_16x16x32_bf16 v[56:59], v[88:91], v[96:99], v[56:59]
    ds_read2_b32 v[156:157], v239 offset0:240 offset1:241
    v_mfma_f32_16x16x32_bf16 v[60:63], v[92:95], v[96:99], v[60:63]
    ds_read2_b32 v[158:159], v239 offset0:242 offset1:243
    v_cndmask_b32 v28, v13, v28, vcc
    v_mfma_f32_16x16x32_bf16 v[60:63], v[88:91], v[100:103], v[60:63]
    s_add_u32 m0, s73, 16384
    v_mfma_f32_16x16x32_bf16 v[60:63], v[84:87], v[104:107], v[60:63]
    buffer_load_dwordx4 v5, s[52:55], s14 offen offset:1024 lds
    v_mov_b32 v13, s68
    v_mfma_f32_16x16x32_bf16 v[60:63], v[80:83], v[108:111], v[60:63]
    v_mfma_f32_16x16x32_bf16 v[60:63], v[76:79], v[112:115], v[60:63]
    v_cndmask_b32 v13, 0, v13, vcc
    v_mfma_f32_16x16x32_bf16 v[60:63], v[72:75], v[116:119], v[60:63]
    v_mfma_f32_16x16x32_bf16 v[60:63], v[68:71], v[120:123], v[60:63]
    v_mfma_f32_16x16x32_bf16 v[60:63], v[64:67], v[124:127], v[60:63]
    s_waitcnt lgkmcnt(0)
    v_mfma_f32_16x16x32_bf16 v[60:63], v[128:131], v[188:191], v[60:63]
    v_mfma_f32_16x16x32_bf16 v[60:63], v[132:135], v[184:187], v[60:63]
    s_add_u32 m0, s73, 16384
    v_mfma_f32_16x16x32_bf16 v[60:63], v[136:139], v[180:183], v[60:63]
    buffer_load_dwordx4 v6, s[52:55], s14 offen offset:2048 lds
    v_mfma_f32_16x16x32_bf16 v[60:63], v[140:143], v[176:179], v[60:63]
    v_mfma_f32_16x16x32_bf16 v[60:63], v[144:147], v[172:175], v[60:63]
    v_mfma_f32_16x16x32_bf16 v[60:63], v[148:151], v[168:171], v[60:63]
    v_mfma_f32_16x16x32_bf16 v[60:63], v[152:155], v[164:167], v[60:63]
L_pl_X_6:
    s_cbranch_execz L_wret
    v_mfma_f32_16x16x32_bf16 v[60:63], v[156:159], v[160:163], v[60:63]
    s_waitcnt vmcnt(7)
    s_barrier
    v_mfma_f32_16x16x32_bf16 v[56:59], v[128:131], v[184:187], v[56:59]
    v_add_u32 v10, 131072, v10
    s_add_u32 m0, s73, 16384
    v_mfma_f32_16x16x32_bf16 v[56:59], v[132:135], v[180:183], v[56:59]
    ds_read_b64_tr_b16 a[240:241], v10 offset:16384
    buffer_load_dwordx4 v7, s[52:55], s14 offen offset:3072 lds
    v_mfma_f32_16x16x32_bf16 v[56:59], v[136:139], v[176:179], v[56:59]
    ds_read_b64_tr_b16 a[242:243], v10 offset:18432
    v_mfma_f32_16x16x32_bf16 v[56:59], v[140:143], v[172:175], v[56:59]
    ds_read_b64_tr_b16 a[248:249], v10 offset:20480
    v_mfma_f32_16x16x32_bf16 v[56:59], v[144:147], v[168:171], v[56:59]
    v_mfma_f32_16x16x32_bf16 v[56:59], v[148:151], v[164:167], v[56:59]
    ds_read_b64_tr_b16 a[250:251], v10 offset:22528
    v_cvt_pk_bf16_f32 v206, v60, v61
    v_mfma_f32_16x16x32_bf16 v[56:59], v[152:155], v[160:163], v[56:59]
    v_add_u32 v11, 131072, v11
    v_mfma_f32_16x16x32_bf16 v[52:55], v[128:131], v[180:183], v[52:55]
    ds_read_b64_tr_b16 a[244:245], v11 offset:16384
    v_mfma_f32_16x16x32_bf16 v[52:55], v[132:135], v[176:179], v[52:55]
    ds_read_b64_tr_b16 a[246:247], v11 offset:18432
    v_cvt_pk_bf16_f32 v207, v62, v63
    v_mfma_f32_16x16x32_bf16 v[52:55], v[136:139], v[172:175], v[52:55]
    ds_read_b64_tr_b16 a[252:253], v11 offset:20480
    v_mfma_f32_16x16x32_bf16 v[52:55], v[140:143], v[168:171], v[52:55]
    buffer_store_dwordx2 v[206:207], v8, s[44:47], s6 offen offset:3584 sc1
    ds_read_b64_tr_b16 a[254:255], v11 offset:22528
    v_mfma_f32_16x16x32_bf16 v[52:55], v[144:147], v[164:167], v[52:55]
    v_mfma_f32_16x16x32_bf16 v[52:55], v[148:151], v[160:163], v[52:55]
    v_mfma_f32_16x16x32_bf16 v[48:51], v[128:131], v[176:179], v[48:51]
    v_cvt_pk_bf16_f32 v204, v56, v57
    v_mfma_f32_16x16x32_bf16 v[48:51], v[132:135], v[172:175], v[48:51]
    v_mfma_f32_16x16x32_bf16 v[48:51], v[136:139], v[168:171], v[48:51]
    v_mfma_f32_16x16x32_bf16 v[48:51], v[140:143], v[164:167], v[48:51]
    v_cvt_pk_bf16_f32 v205, v58, v59
    v_mfma_f32_16x16x32_bf16 v[48:51], v[144:147], v[160:163], v[48:51]
    v_mfma_f32_16x16x32_bf16 v[44:47], v[128:131], v[172:175], v[44:47]
    buffer_store_dwordx2 v[204:205], v8, s[44:47], s6 offen offset:3072 sc1
    v_mfma_f32_16x16x32_bf16 v[44:47], v[132:135], v[168:171], v[44:47]
    v_mfma_f32_16x16x32_bf16 v[44:47], v[136:139], v[164:167], v[44:47]
    v_mfma_f32_16x16x32_bf16 v[44:47], v[140:143], v[160:163], v[44:47]
    v_cvt_pk_bf16_f32 v202, v52, v53
    v_mfma_f32_16x16x32_bf16 v[40:43], v[128:131], v[168:171], v[40:43]
    v_mfma_f32_16x16x32_bf16 v[40:43], v[132:135], v[164:167], v[40:43]
    v_mfma_f32_16x16x32_bf16 v[40:43], v[136:139], v[160:163], v[40:43]
    v_cvt_pk_bf16_f32 v203, v54, v55
    v_mfma_f32_16x16x32_bf16 v[36:39], v[128:131], v[164:167], v[36:39]
    v_mfma_f32_16x16x32_bf16 v[36:39], v[132:135], v[160:163], v[36:39]
    buffer_store_dwordx2 v[202:203], v8, s[44:47], s6 offen offset:2560 sc1
    v_mfma_f32_16x16x32_bf16 v[32:35], v[128:131], v[160:163], v[32:35]
    v_mov_b32 v29, 0
    buffer_atomic_add v29, v28, s[44:47], 0 offen sc0 sc1
    v_cvt_pk_bf16_f32 v200, v48, v49
    v_cvt_pk_bf16_f32 v201, v50, v51
    buffer_store_dwordx2 v[200:201], v8, s[44:47], s6 offen offset:2048 sc1
    v_cvt_pk_bf16_f32 v198, v44, v45
    v_cvt_pk_bf16_f32 v199, v46, v47
    buffer_store_dwordx2 v[198:199], v8, s[44:47], s6 offen offset:1536 sc1
    v_cvt_pk_bf16_f32 v196, v40, v41
    v_cvt_pk_bf16_f32 v197, v42, v43
    buffer_store_dwordx2 v[196:197], v8, s[44:47], s6 offen offset:1024 sc1
    v_cvt_pk_bf16_f32 v194, v36, v37
    v_cvt_pk_bf16_f32 v195, v38, v39
    buffer_store_dwordx2 v[194:195], v8, s[44:47], s6 offen offset:512 sc1
    v_cvt_pk_bf16_f32 v192, v32, v33
    v_cvt_pk_bf16_f32 v193, v34, v35
    buffer_store_dwordx2 v[192:193], v8, s[44:47], s6 offen offset:0 sc1
    v_add_u32 v10, -131072, v10
    v_add_u32 v11, -131072, v11
    s_waitcnt lgkmcnt(0)
    s_barrier
L_DX:
    s_waitcnt vmcnt(0)
    v_cmp_ne_u32 vcc, v13, v29
    s_cbranch_vccnz L_rs_p2X
L_ok_p2X:
    s_barrier
    s_add_u32 m0, s73, 97536
    s_nop 0
    buffer_load_dwordx4 v23, s[44:47], s18 offen offset:768 sc1 lds
    s_add_u32 m0, s73, 99328
    s_nop 0
    buffer_load_dwordx4 v20, s[44:47], s18 offen offset:0 sc1 lds
    s_add_u32 m0, s73, 99840
    s_nop 0
    buffer_load_dwordx4 v20, s[44:47], s18 offen offset:512 sc1 lds
    s_add_u32 m0, s73, 100608
    s_nop 0
    buffer_load_dwordx4 v23, s[44:47], s19 offen offset:768 sc1 lds
    s_add_u32 m0, s73, 114688
    s_nop 0
    buffer_load_dwordx4 v20, s[44:47], s19 offen offset:0 sc1 lds
    s_add_u32 m0, s73, 115200
    s_nop 0
    buffer_load_dwordx4 v20, s[44:47], s19 offen offset:512 sc1 lds
    s_add_u32 m0, s73, 115968
    s_nop 0
    buffer_load_dwordx4 v23, s[44:47], s20 offen offset:768 sc1 lds
    s_add_u32 m0, s73, 117760
    s_nop 0
    buffer_load_dwordx4 v20, s[44:47], s20 offen offset:0 sc1 lds
    s_add_u32 m0, s73, 130560
    s_nop 0
    buffer_load_dwordx4 v20, s[44:47], s20 offen offset:512 sc1 lds
    s_add_u32 m0, s73, 131328
    s_nop 0
    buffer_load_dwordx4 v23, s[44:47], s21 offen offset:768 sc1 lds
    s_mov_b32 s56, s16
    s_and_b32 s57, s17, 0xffff
    s_mov_b32 s58, 2359296
    s_mov_b32 s59, 0x20000
    s_mov_b32 s40, 18432
    s_mov_b32 s42, 12386304
    s_mov_b32 s64, s38
    s_and_b32 s65, s39, 0xffff
    s_mov_b32 s66, 2359296
    s_mov_b32 s67, 0x20000
    v_lshlrev_b32 v136, 4, v2
    s_mul_i32 s7, s72, 36
    s_bitcmp1_b32 s3, 0
    s_addc_u32 s7, s7, 0
    s_lshl_b32 s7, s7, 17
    v_subrev_u32 v184, s7, v4
    v_subrev_u32 v185, s7, v5
    s_bfe_u32 s4, s2, 0x20003
    s_mul_i32 s4, s4, 9
    s_lshl1_add_u32 s7, s72, s4
    s_and_b32 s8, s3, 1
    s_add_u32 s7, s7, s8
    s_bfe_u32 s8, s2, 65539
    s_add_u32 s7, s7, s8
    s_lshl_b32 s8, s8, 3
    s_sub_u32 s4, s4, s8
    s_lshl_b32 s37, s7, 16
    s_add_u32 s37, s37, 4718592
    s_add_u32 s4, s4, 8
    s_lshl_b32 s16, s4, 16
    s_add_u32 s16, s16, 4718592
    s_sub_u32 s4, s4, s7
    s_lshl_b32 s4, s4, 7
    s_lshl_b32 s7, s7, 7
    s_add_u32 s7, s7, 12582912
    v_bfe_u32 v24, v2, 2, 1
    v_mul_i32_i24 v24, s4, v24
    v_and_b32 v25, 3, v2
    v_lshl_add_u32 v24, v25, 2, v24
    v_add_u32 v188, s7, v24
    s_lshl2_add_u32 s7, s2, s3
    s_mul_i32 s8, s7, 3072
    s_add_u32 s34, s8, 22953984
    s_add_u32 s11, s8, 26099712
    s_add_u32 s12, s8, 29245440
    s_lshl_b32 s35, s7, 12
    s_add_u32 s35, s35, 32391168
    s_xor_b32 s8, s7, 8
    s_mul_i32 s8, s8, 3072
    s_add_u32 s30, s8, 22953984
    s_xor_b32 s8, s7, 16
    s_mul_i32 s8, s8, 3072
    s_add_u32 s15, s8, 26099712
    s_xor_b32 s8, s7, 24
    s_mul_i32 s8, s8, 3072
    s_add_u32 s31, s8, 29245440
    s_andn2_b32 s7, s7, 24
    s_lshl3_add_u32 s7, s3, s7
    s_lshl2_add_u32 s8, s7, s72
    s_lshl_b32 s8, s8, 10
    s_add_u32 s32, s8, 32391168
    s_xor_b32 s8, s8, 4096
    s_add_u32 s33, s8, 32391168
    s_xor_b32 s8, s3, s72
    s_cmp_lt_u32 s8, 2
    s_cselect_b32 s35, s35, 0x40000000
    s_cselect_b32 s16, s16, 0x40000000
    s_cselect_b32 s36, s68, 0
    s_mov_b32 s38, 0xbfb8aa3b
    s_and_b32 s8, s8, 1
    s_mul_i32 s41, s8, 96
    s_and_b32 s43, s73, 4096
    v_lshlrev_b32 v24, 10, v2
    v_add_u32 v24, s35, v24
    s_add_u32 s7, s34, 2048
    v_mov_b32 v25, s36
    v_cmp_gt_u32 vcc, 4, v2
    s_nop 1
    v_cndmask_b32 v138, 0, v25, vcc
    v_mov_b32 v25, 0x40000000
    v_cndmask_b32 v137, v25, v24, vcc
    v_writelane_b32 v137, s7, 4
    v_writelane_b32 v138, s68, 4
    v_min_u32 v139, 1, v2
    v_lshlrev_b32 v139, 30, v139
    v_mov_b32 v140, 0
    v_writelane_b32 v140, s68, 0
    v_mov_b32 v195, s68
    v_mov_b32 v199, s68
    v_mov_b32 v202, s68
    v_mov_b32 v203, s68
    s_waitcnt vmcnt(6)
    s_barrier
    ds_read_b128 v[104:107], v14 offset:0
    ds_read_b128 v[108:111], v14 offset:4096
    ds_read_b128 v[112:115], v14 offset:8192
    ds_read_b128 v[116:119], v14 offset:12288
    s_waitcnt lgkmcnt(2)
    v_mfma_f32_16x16x32_bf16 v[32:35], v[104:107], a[0:3], 0
    s_add_u32 m0, s73, 133120
    s_sub_u32 s4, s75, 216
    s_lshl_b32 s7, s4, 7
    v_mfma_f32_16x16x32_bf16 v[32:35], v[108:111], a[8:11], v[32:35]
    buffer_load_dwordx4 v20, s[44:47], s21 offen offset:0 sc1 lds
    s_waitcnt lgkmcnt(0)
    v_mfma_f32_16x16x32_bf16 v[32:35], v[112:115], a[16:19], v[32:35]
    ds_read_b128 v[120:123], v14 offset:1024
    s_lshl2_add_u32 s7, s3, s7
    s_add_u32 s7, s7, 12582912
    v_mfma_f32_16x16x32_bf16 v[32:35], v[116:119], a[24:27], v[32:35]
    ds_read_b128 v[124:127], v14 offset:5120
    v_mfma_f32_16x16x32_bf16 v[36:39], v[116:119], a[28:31], 0
    ds_read_b128 v[128:131], v14 offset:9216
    s_cmp_lt_u32 s4, 36
    s_cselect_b32 s7, s7, 0x40000000
    v_mfma_f32_16x16x32_bf16 v[36:39], v[112:115], a[20:23], v[36:39]
    ds_read_b128 v[132:135], v14 offset:13312
    v_min_u32 v28, 1, v2
    v_mfma_f32_16x16x32_bf16 v[36:39], v[108:111], a[12:15], v[36:39]
    s_add_u32 m0, s73, 133632
    v_lshlrev_b32 v28, 30, v28
    v_mov_b32 v29, s68
    v_mfma_f32_16x16x32_bf16 v[36:39], v[104:107], a[4:7], v[36:39]
    buffer_load_dwordx4 v20, s[44:47], s21 offen offset:512 sc1 lds
    s_waitcnt lgkmcnt(2)
    v_mfma_f32_16x16x32_bf16 v[44:47], v[120:123], a[4:7], 0
    buffer_store_dword v29, v28, s[44:47], s7 offen sc1
    s_add_u32 m0, s73, 146688
    v_mfma_f32_16x16x32_bf16 v[44:47], v[124:127], a[12:15], v[44:47]
    buffer_load_dwordx4 v23, s[44:47], s22 offen offset:768 sc1 lds
    s_waitcnt lgkmcnt(0)
    v_mfma_f32_16x16x32_bf16 v[44:47], v[128:131], a[20:23], v[44:47]
    ds_read_b128 v[104:107], v14 offset:2048
    v_mfma_f32_16x16x32_bf16 v[44:47], v[132:135], a[28:31], v[44:47]
    ds_read_b128 v[108:111], v14 offset:6144
    v_mfma_f32_16x16x32_bf16 v[40:43], v[132:135], a[24:27], 0
    ds_read_b128 v[112:115], v14 offset:10240
    v_mfma_f32_16x16x32_bf16 v[40:43], v[128:131], a[16:19], v[40:43]
    ds_read_b128 v[116:119], v14 offset:14336
    v_mfma_f32_16x16x32_bf16 v[40:43], v[124:127], a[8:11], v[40:43]
    s_add_u32 m0, s73, 148480
    v_mfma_f32_16x16x32_bf16 v[40:43], v[120:123], a[0:3], v[40:43]
    buffer_load_dwordx4 v20, s[44:47], s22 offen offset:0 sc1 lds
    s_waitcnt lgkmcnt(2)
    v_mfma_f32_16x16x32_bf16 v[48:51], v[104:107], a[0:3], 0
    s_add_u32 m0, s73, 148992
    v_mfma_f32_16x16x32_bf16 v[48:51], v[108:111], a[8:11], v[48:51]
    buffer_load_dwordx4 v20, s[44:47], s22 offen offset:512 sc1 lds
    s_waitcnt lgkmcnt(0)
    v_mfma_f32_16x16x32_bf16 v[48:51], v[112:115], a[16:19], v[48:51]
    ds_read_b128 v[120:123], v14 offset:3072
    v_mfma_f32_16x16x32_bf16 v[48:51], v[116:119], a[24:27], v[48:51]
    ds_read_b128 v[124:127], v14 offset:7168
    v_mfma_f32_16x16x32_bf16 v[52:55], v[116:119], a[28:31], 0
    ds_read_b128 v[128:131], v14 offset:11264
    v_mfma_f32_16x16x32_bf16 v[52:55], v[112:115], a[20:23], v[52:55]
    ds_read_b128 v[132:135], v14 offset:15360
    v_mfma_f32_16x16x32_bf16 v[52:55], v[108:111], a[12:15], v[52:55]
    s_add_u32 m0, s73, 149760
    v_mfma_f32_16x16x32_bf16 v[52:55], v[104:107], a[4:7], v[52:55]
    buffer_load_dwordx4 v23, s[44:47], s23 offen offset:768 sc1 lds
    s_waitcnt lgkmcnt(2)
    v_mfma_f32_16x16x32_bf16 v[36:39], v[120:123], a[36:39], v[36:39]
    v_mfma_f32_16x16x32_bf16 v[36:39], v[124:127], a[44:47], v[36:39]
    s_waitcnt lgkmcnt(0)
    v_mfma_f32_16x16x32_bf16 v[36:39], v[128:131], a[52:55], v[36:39]
    s_waitcnt vmcnt(9)
    s_barrier
    v_mfma_f32_16x16x32_bf16 v[36:39], v[132:135], a[60:63], v[36:39]
    ds_read_b128 v[104:107], v14 offset:16384
    v_mfma_f32_16x16x32_bf16 v[32:35], v[132:135], a[56:59], v[32:35]
    ds_read_b128 v[108:111], v14 offset:20480
    v_mfma_f32_16x16x32_bf16 v[32:35], v[128:131], a[48:51], v[32:35]
    ds_read_b128 v[112:115], v14 offset:24576
    v_mfma_f32_16x16x32_bf16 v[32:35], v[124:127], a[40:43], v[32:35]
    ds_read_b128 v[116:119], v14 offset:28672
    v_mfma_f32_16x16x32_bf16 v[32:35], v[120:123], a[32:35], v[32:35]
    ds_read_b64_tr_b16 v[220:221], v10 offset:0
    s_waitcnt lgkmcnt(3)
    v_mfma_f32_16x16x32_bf16 v[40:43], v[104:107], a[32:35], v[40:43]
    s_add_u32 m0, s73, 98304
    ds_read_b64_tr_b16 v[222:223], v10 offset:2048
    v_mfma_f32_16x16x32_bf16 v[40:43], v[108:111], a[40:43], v[40:43]
    buffer_load_dwordx4 v20, s[44:47], s23 offen offset:0 sc1 lds
    s_waitcnt lgkmcnt(2)
    v_mfma_f32_16x16x32_bf16 v[40:43], v[112:115], a[48:51], v[40:43]
    ds_read_b128 v[120:123], v14 offset:17408
    v_mfma_f32_16x16x32_bf16 v[40:43], v[116:119], a[56:59], v[40:43]
    ds_read_b128 v[124:127], v14 offset:21504
    v_mfma_f32_16x16x32_bf16 v[44:47], v[116:119], a[60:63], v[44:47]
    ds_read_b128 v[128:131], v14 offset:25600
    v_mfma_f32_16x16x32_bf16 v[44:47], v[112:115], a[52:55], v[44:47]
    ds_read_b128 v[132:135], v14 offset:29696
    v_mfma_f32_16x16x32_bf16 v[44:47], v[108:111], a[44:47], v[44:47]
    s_add_u32 m0, s73, 98816
    ds_read_b64_tr_b16 v[228:229], v10 offset:4096
    v_mfma_f32_16x16x32_bf16 v[44:47], v[104:107], a[36:39], v[44:47]
    buffer_load_dwordx4 v20, s[44:47], s23 offen offset:512 sc1 lds
    s_waitcnt lgkmcnt(3)
    v_mfma_f32_16x16x32_bf16 v[52:55], v[120:123], a[36:39], v[52:55]
    s_add_u32 m0, s73, 99584
    ds_read_b64_tr_b16 v[230:231], v10 offset:6144
    v_mfma_f32_16x16x32_bf16 v[52:55], v[124:127], a[44:47], v[52:55]
    buffer_load_dwordx4 v23, s[44:47], s24 offen offset:768 sc1 lds
    s_waitcnt lgkmcnt(2)
    v_mfma_f32_16x16x32_bf16 v[52:55], v[128:131], a[52:55], v[52:55]
    ds_read_b128 v[104:107], v14 offset:18432
    v_mfma_f32_16x16x32_bf16 v[52:55], v[132:135], a[60:63], v[52:55]
    ds_read_b128 v[108:111], v14 offset:22528
    v_mfma_f32_16x16x32_bf16 v[48:51], v[132:135], a[56:59], v[48:51]
    ds_read_b128 v[112:115], v14 offset:26624
    v_mfma_f32_16x16x32_bf16 v[48:51], v[128:131], a[48:51], v[48:51]
    ds_read_b128 v[116:119], v14 offset:30720
    v_mfma_f32_16x16x32_bf16 v[48:51], v[124:127], a[40:43], v[48:51]
    s_add_u32 m0, s73, 101376
    ds_read_b64_tr_b16 v[224:225], v11 offset:0
    v_mfma_f32_16x16x32_bf16 v[48:51], v[120:123], a[32:35], v[48:51]
    buffer_load_dwordx4 v20, s[44:47], s24 offen offset:0 sc1 lds
    s_waitcnt lgkmcnt(3)
    v_mfma_f32_16x16x32_bf16 v[32:35], v[104:107], a[64:67], v[32:35]
    ds_read_b64_tr_b16 v[226:227], v11 offset:2048
    v_mfma_f32_16x16x32_bf16 v[32:35], v[108:111], a[72:75], v[32:35]
    s_waitcnt lgkmcnt(2)
    v_mfma_f32_16x16x32_bf16 v[32:35], v[112:115], a[80:83], v[32:35]
    ds_read_b128 v[120:123], v14 offset:19456
    v_mfma_f32_16x16x32_bf16 v[32:35], v[116:119], a[88:91], v[32:35]
    ds_read_b128 v[124:127], v14 offset:23552
    v_mfma_f32_16x16x32_bf16 v[36:39], v[116:119], a[92:95], v[36:39]
    ds_read_b128 v[128:131], v14 offset:27648
    v_mfma_f32_16x16x32_bf16 v[36:39], v[112:115], a[84:87], v[36:39]
    ds_read_b128 v[132:135], v14 offset:31744
    v_mfma_f32_16x16x32_bf16 v[36:39], v[108:111], a[76:79], v[36:39]
    ds_read_b64_tr_b16 v[232:233], v11 offset:4096
    v_mfma_f32_16x16x32_bf16 v[36:39], v[104:107], a[68:71], v[36:39]
    s_waitcnt lgkmcnt(3)
    v_mfma_f32_16x16x32_bf16 v[44:47], v[120:123], a[68:71], v[44:47]
    ds_read_b64_tr_b16 v[234:235], v11 offset:6144
    v_mfma_f32_16x16x32_bf16 v[44:47], v[124:127], a[76:79], v[44:47]
    s_waitcnt lgkmcnt(2)
    v_mfma_f32_16x16x32_bf16 v[44:47], v[128:131], a[84:87], v[44:47]
    s_waitcnt vmcnt(9) lgkmcnt(0)
    s_barrier
    v_mfma_f32_16x16x32_bf16 v[44:47], v[132:135], a[92:95], v[44:47]
    ds_read_b128 v[104:107], v14 offset:32768
    v_mfma_f32_16x16x32_bf16 v[40:43], v[132:135], a[88:91], v[40:43]
    ds_read_b128 v[108:111], v14 offset:36864
    v_mfma_f32_16x16x32_bf16 v[40:43], v[128:131], a[80:83], v[40:43]
    ds_read_b128 v[112:115], v14 offset:40960
    v_mfma_f32_16x16x32_bf16 v[40:43], v[124:127], a[72:75], v[40:43]
    ds_read_b128 v[116:119], v14 offset:45056
    v_mfma_f32_16x16x32_bf16 v[40:43], v[120:123], a[64:67], v[40:43]
    ds_read_b64_tr_b16 v[236:237], v10 offset:16384
    s_waitcnt lgkmcnt(3)
    v_mfma_f32_16x16x32_bf16 v[48:51], v[104:107], a[64:67], v[48:51]
    s_add_u32 m0, s73, 114176
    ds_read_b64_tr_b16 v[238:239], v10 offset:18432
    v_mfma_f32_16x16x32_bf16 v[48:51], v[108:111], a[72:75], v[48:51]
    buffer_load_dwordx4 v20, s[44:47], s24 offen offset:512 sc1 lds
    s_waitcnt lgkmcnt(2)
    v_mfma_f32_16x16x32_bf16 v[48:51], v[112:115], a[80:83], v[48:51]
    ds_read_b128 v[120:123], v14 offset:33792
    v_mfma_f32_16x16x32_bf16 v[48:51], v[116:119], a[88:91], v[48:51]
    ds_read_b128 v[124:127], v14 offset:37888
    v_lshrrev_b32 v30, 2, v26
    v_mfma_f32_16x16x32_bf16 v[52:55], v[116:119], a[92:95], v[52:55]
    ds_read_b128 v[128:131], v14 offset:41984
    v_mfma_f32_16x16x32_bf16 v[52:55], v[112:115], a[84:87], v[52:55]
    ds_read_b128 v[132:135], v14 offset:46080
    v_mfma_f32_16x16x32_bf16 v[52:55], v[108:111], a[76:79], v[52:55]
    s_add_u32 m0, s73, 114944
    ds_read_b64_tr_b16 v[244:245], v10 offset:20480
    v_mfma_f32_16x16x32_bf16 v[52:55], v[104:107], a[68:71], v[52:55]
    buffer_load_dwordx4 v23, s[44:47], s25 offen offset:768 sc1 lds
    s_waitcnt lgkmcnt(3)
    v_mfma_f32_16x16x32_bf16 v[36:39], v[120:123], a[100:103], v[36:39]
    s_add_u32 m0, s73, 116736
    ds_read_b64_tr_b16 v[246:247], v10 offset:22528
    v_mfma_f32_16x16x32_bf16 v[36:39], v[124:127], a[108:111], v[36:39]
    buffer_load_dwordx4 v20, s[44:47], s25 offen offset:0 sc1 lds
    s_waitcnt lgkmcnt(2)
    v_mfma_f32_16x16x32_bf16 v[36:39], v[128:131], a[116:119], v[36:39]
    ds_read_b128 v[104:107], v14 offset:34816
    v_lshrrev_b32 v31, 2, v18
    v_mfma_f32_16x16x32_bf16 v[36:39], v[132:135], a[124:127], v[36:39]
    ds_read_b128 v[108:111], v14 offset:38912
    v_mfma_f32_16x16x32_bf16 v[32:35], v[132:135], a[120:123], v[32:35]
    ds_read_b128 v[112:115], v14 offset:43008
    v_mfma_f32_16x16x32_bf16 v[32:35], v[128:131], a[112:115], v[32:35]
    ds_read_b128 v[116:119], v14 offset:47104
    v_mfma_f32_16x16x32_bf16 v[32:35], v[124:127], a[104:107], v[32:35]
    s_add_u32 m0, s73, 117248
    ds_read_b64_tr_b16 v[240:241], v11 offset:16384
    v_mfma_f32_16x16x32_bf16 v[32:35], v[120:123], a[96:99], v[32:35]
    buffer_load_dwordx4 v20, s[44:47], s25 offen offset:512 sc1 lds
    s_waitcnt lgkmcnt(3)
    v_mfma_f32_16x16x32_bf16 v[40:43], v[104:107], a[96:99], v[40:43]
    ds_read_b64_tr_b16 v[242:243], v11 offset:18432
    buffer_load_ushort v102, v30, s[60:63], 0 offen offset:0
    v_mfma_f32_16x16x32_bf16 v[40:43], v[108:111], a[104:107], v[40:43]
    s_waitcnt lgkmcnt(2)
    v_mfma_f32_16x16x32_bf16 v[40:43], v[112:115], a[112:115], v[40:43]
    ds_read_b128 v[120:123], v14 offset:35840
    v_mfma_f32_16x16x32_bf16 v[40:43], v[116:119], a[120:123], v[40:43]
    ds_read_b128 v[124:127], v14 offset:39936
    v_mfma_f32_16x16x32_bf16 v[44:47], v[116:119], a[124:127], v[44:47]
    ds_read_b128 v[128:131], v14 offset:44032
    v_mfma_f32_16x16x32_bf16 v[44:47], v[112:115], a[116:119], v[44:47]
    ds_read_b128 v[132:135], v14 offset:48128
    v_mfma_f32_16x16x32_bf16 v[44:47], v[108:111], a[108:111], v[44:47]
    ds_read_b64_tr_b16 v[248:249], v11 offset:20480
    buffer_load_ushort v103, v30, s[60:63], 0 offen offset:32
    v_mfma_f32_16x16x32_bf16 v[44:47], v[104:107], a[100:103], v[44:47]
    s_waitcnt lgkmcnt(3)
    v_mfma_f32_16x16x32_bf16 v[52:55], v[120:123], a[100:103], v[52:55]
    ds_read_b64_tr_b16 v[250:251], v11 offset:22528
    v_mfma_f32_16x16x32_bf16 v[52:55], v[124:127], a[108:111], v[52:55]
    s_waitcnt lgkmcnt(2)
    v_mfma_f32_16x16x32_bf16 v[52:55], v[128:131], a[116:119], v[52:55]
    s_waitcnt vmcnt(10) lgkmcnt(0)
    s_barrier
    v_mfma_f32_16x16x32_bf16 v[52:55], v[132:135], a[124:127], v[52:55]
    ds_read_b128 v[104:107], v14 offset:49152
    v_mfma_f32_16x16x32_bf16 v[48:51], v[132:135], a[120:123], v[48:51]
    ds_read_b128 v[108:111], v14 offset:53248
    buffer_load_ushort v27, v31, s[60:63], 0 offen offset:0
    v_mfma_f32_16x16x32_bf16 v[48:51], v[128:131], a[112:115], v[48:51]
    ds_read_b128 v[112:115], v14 offset:57344
    v_mfma_f32_16x16x32_bf16 v[48:51], v[124:127], a[104:107], v[48:51]
    ds_read_b128 v[116:119], v14 offset:61440
    v_mfma_f32_16x16x32_bf16 v[48:51], v[120:123], a[96:99], v[48:51]
    s_waitcnt lgkmcnt(2)
    v_mfma_f32_16x16x32_bf16 v[32:35], v[104:107], a[128:131], v[32:35]
    s_add_u32 m0, s73, 130304
    v_mfma_f32_16x16x32_bf16 v[32:35], v[108:111], a[136:139], v[32:35]
    buffer_load_dwordx4 v23, s[44:47], s26 offen offset:768 sc1 lds
    s_waitcnt lgkmcnt(0)
    v_mfma_f32_16x16x32_bf16 v[32:35], v[112:115], a[144:147], v[32:35]
    ds_read_b128 v[120:123], v14 offset:50176
    v_mfma_f32_16x16x32_bf16 v[32:35], v[116:119], a[152:155], v[32:35]
    ds_read_b128 v[124:127], v14 offset:54272
    v_mfma_f32_16x16x32_bf16 v[36:39], v[116:119], a[156:159], v[36:39]
    ds_read_b128 v[128:131], v14 offset:58368
    v_mfma_f32_16x16x32_bf16 v[36:39], v[112:115], a[148:151], v[36:39]
    ds_read_b128 v[132:135], v14 offset:62464
    v_mfma_f32_16x16x32_bf16 v[36:39], v[108:111], a[140:143], v[36:39]
    s_add_u32 m0, s73, 132096
    v_mfma_f32_16x16x32_bf16 v[36:39], v[104:107], a[132:135], v[36:39]
    buffer_load_dwordx4 v20, s[44:47], s26 offen offset:0 sc1 lds
    s_waitcnt lgkmcnt(2)
    v_mfma_f32_16x16x32_bf16 v[44:47], v[120:123], a[132:135], v[44:47]
    s_add_u32 m0, s73, 132608
    v_mfma_f32_16x16x32_bf16 v[44:47], v[124:127], a[140:143], v[44:47]
    buffer_load_dwordx4 v20, s[44:47], s26 offen offset:512 sc1 lds
    s_waitcnt lgkmcnt(0)
    v_mfma_f32_16x16x32_bf16 v[44:47], v[128:131], a[148:151], v[44:47]
    ds_read_b128 v[104:107], v14 offset:51200
    v_mfma_f32_16x16x32_bf16 v[44:47], v[132:135], a[156:159], v[44:47]
    ds_read_b128 v[108:111], v14 offset:55296
    v_mfma_f32_16x16x32_bf16 v[40:43], v[132:135], a[152:155], v[40:43]
    ds_read_b128 v[112:115], v14 offset:59392
    v_mfma_f32_16x16x32_bf16 v[40:43], v[128:131], a[144:147], v[40:43]
    ds_read_b128 v[116:119], v14 offset:63488
    v_mfma_f32_16x16x32_bf16 v[40:43], v[124:127], a[136:139], v[40:43]
    s_add_u32 m0, s73, 134144
    v_mfma_f32_16x16x32_bf16 v[40:43], v[120:123], a[128:131], v[40:43]
    buffer_load_dwordx4 v21, s[44:47], s18 offen offset:0 sc1 lds
    s_waitcnt lgkmcnt(2)
    v_mfma_f32_16x16x32_bf16 v[48:51], v[104:107], a[128:131], v[48:51]
    v_mfma_f32_16x16x32_bf16 v[48:51], v[108:111], a[136:139], v[48:51]
    s_waitcnt lgkmcnt(0)
    v_mfma_f32_16x16x32_bf16 v[48:51], v[112:115], a[144:147], v[48:51]
    ds_read_b128 v[120:123], v14 offset:52224
    v_mfma_f32_16x16x32_bf16 v[48:51], v[116:119], a[152:155], v[48:51]
    ds_read_b128 v[124:127], v14 offset:56320
    v_mfma_f32_16x16x32_bf16 v[52:55], v[116:119], a[156:159], v[52:55]
    ds_read_b128 v[128:131], v14 offset:60416
    v_mfma_f32_16x16x32_bf16 v[52:55], v[112:115], a[148:151], v[52:55]
    ds_read_b128 v[132:135], v14 offset:64512
    v_mfma_f32_16x16x32_bf16 v[52:55], v[108:111], a[140:143], v[52:55]
    v_mfma_f32_16x16x32_bf16 v[52:55], v[104:107], a[132:135], v[52:55]
    s_waitcnt lgkmcnt(2)
    v_mfma_f32_16x16x32_bf16 v[36:39], v[120:123], a[164:167], v[36:39]
    v_mfma_f32_16x16x32_bf16 v[36:39], v[124:127], a[172:175], v[36:39]
    s_waitcnt lgkmcnt(0)
    v_mfma_f32_16x16x32_bf16 v[36:39], v[128:131], a[180:183], v[36:39]
    s_waitcnt vmcnt(11)
    s_barrier
    v_mfma_f32_16x16x32_bf16 v[36:39], v[132:135], a[188:191], v[36:39]
    ds_read_b128 v[104:107], v14 offset:0
    v_mfma_f32_16x16x32_bf16 v[32:35], v[132:135], a[184:187], v[32:35]
    ds_read_b128 v[108:111], v14 offset:4096
    v_mfma_f32_16x16x32_bf16 v[32:35], v[128:131], a[176:179], v[32:35]
    ds_read_b128 v[112:115], v14 offset:8192
    v_mfma_f32_16x16x32_bf16 v[32:35], v[124:127], a[168:171], v[32:35]
    ds_read_b128 v[116:119], v14 offset:12288
    v_mfma_f32_16x16x32_bf16 v[32:35], v[120:123], a[160:163], v[32:35]
    s_waitcnt lgkmcnt(2)
    v_mfma_f32_16x16x32_bf16 v[40:43], v[104:107], a[160:163], v[40:43]
    s_add_u32 m0, s73, 146944
    v_mfma_f32_16x16x32_bf16 v[40:43], v[108:111], a[168:171], v[40:43]
    buffer_load_dwordx4 v21, s[44:47], s18 offen offset:512 sc1 lds
    s_waitcnt lgkmcnt(0)
    v_mfma_f32_16x16x32_bf16 v[40:43], v[112:115], a[176:179], v[40:43]
    ds_read_b128 v[120:123], v14 offset:1024
    v_mfma_f32_16x16x32_bf16 v[40:43], v[116:119], a[184:187], v[40:43]
    ds_read_b128 v[124:127], v14 offset:5120
    v_mfma_f32_16x16x32_bf16 v[44:47], v[116:119], a[188:191], v[44:47]
    ds_read_b128 v[128:131], v14 offset:9216
    v_mfma_f32_16x16x32_bf16 v[44:47], v[112:115], a[180:183], v[44:47]
    ds_read_b128 v[132:135], v14 offset:13312
    buffer_load_dwordx4 v[88:91], v252, s[56:59], 0 offen
    v_mfma_f32_16x16x32_bf16 v[44:47], v[108:111], a[172:175], v[44:47]
    s_add_u32 m0, s73, 148480
    v_mfma_f32_16x16x32_bf16 v[44:47], v[104:107], a[164:167], v[44:47]
    buffer_load_dwordx4 v21, s[44:47], s19 offen offset:0 sc1 lds
    s_waitcnt lgkmcnt(2)
    v_mfma_f32_16x16x32_bf16 v[52:55], v[120:123], a[164:167], v[52:55]
    s_add_u32 m0, s73, 148992
    v_mfma_f32_16x16x32_bf16 v[52:55], v[124:127], a[172:175], v[52:55]
    buffer_load_dwordx4 v21, s[44:47], s19 offen offset:512 sc1 lds
    s_waitcnt lgkmcnt(0)
    v_mfma_f32_16x16x32_bf16 v[52:55], v[128:131], a[180:183], v[52:55]
    ds_read_b128 v[104:107], v14 offset:2048
    v_mfma_f32_16x16x32_bf16 v[52:55], v[132:135], a[188:191], v[52:55]
    ds_read_b128 v[108:111], v14 offset:6144
    v_mfma_f32_16x16x32_bf16 v[48:51], v[132:135], a[184:187], v[48:51]
    ds_read_b128 v[112:115], v14 offset:10240
    v_mfma_f32_16x16x32_bf16 v[48:51], v[128:131], a[176:179], v[48:51]
    ds_read_b128 v[116:119], v14 offset:14336
    v_mfma_f32_16x16x32_bf16 v[48:51], v[124:127], a[168:171], v[48:51]
    s_add_u32 m0, s73, 150528
    v_mfma_f32_16x16x32_bf16 v[48:51], v[120:123], a[160:163], v[48:51]
    buffer_load_dwordx4 v21, s[44:47], s20 offen offset:0 sc1 lds
    s_waitcnt lgkmcnt(2)
    v_mfma_f32_16x16x32_bf16 v[32:35], v[104:107], a[192:195], v[32:35]
    buffer_load_dwordx4 v[92:95], v252, s[56:59], s40 offen
    v_mfma_f32_16x16x32_bf16 v[32:35], v[108:111], a[200:203], v[32:35]
    s_waitcnt vmcnt(10)
    s_waitcnt lgkmcnt(0)
    v_mfma_f32_16x16x32_bf16 v[32:35], v[112:115], a[208:211], v[32:35]
    ds_read_b128 v[120:123], v14 offset:3072
    v_mfma_f32_16x16x32_bf16 v[32:35], v[116:119], a[216:219], v[32:35]
    ds_read_b128 v[124:127], v14 offset:7168
    v_mfma_f32_16x16x32_bf16 v[36:39], v[116:119], a[220:223], v[36:39]
    ds_read_b128 v[128:131], v14 offset:11264
    v_lshlrev_b32 v72, 16, v102
    v_mfma_f32_16x16x32_bf16 v[36:39], v[112:115], a[212:215], v[36:39]
    ds_read_b128 v[132:135], v14 offset:15360
    v_mfma_f32_16x16x32_bf16 v[36:39], v[108:111], a[204:207], v[36:39]
    v_lshlrev_b32 v73, 16, v102
    v_mfma_f32_16x16x32_bf16 v[36:39], v[104:107], a[196:199], v[36:39]
    s_waitcnt lgkmcnt(2)
    v_mfma_f32_16x16x32_bf16 v[44:47], v[120:123], a[196:199], v[44:47]
    v_mfma_f32_16x16x32_bf16 v[44:47], v[124:127], a[204:207], v[44:47]
    v_lshlrev_b32 v74, 16, v102
    s_waitcnt lgkmcnt(0)
    v_mfma_f32_16x16x32_bf16 v[44:47], v[128:131], a[212:215], v[44:47]
    buffer_load_dwordx2 v[142:143], v253, s[56:59], 0 offen
    s_barrier
    v_mfma_f32_16x16x32_bf16 v[44:47], v[132:135], a[220:223], v[44:47]
    ds_read_b128 v[104:107], v14 offset:16384
    v_mfma_f32_16x16x32_bf16 v[40:43], v[132:135], a[216:219], v[40:43]
    ds_read_b128 v[108:111], v14 offset:20480
    v_lshlrev_b32 v75, 16, v102
    v_mfma_f32_16x16x32_bf16 v[40:43], v[128:131], a[208:211], v[40:43]
    ds_read_b128 v[112:115], v14 offset:24576
    v_mfma_f32_16x16x32_bf16 v[40:43], v[124:127], a[200:203], v[40:43]
    ds_read_b128 v[116:119], v14 offset:28672
    v_lshlrev_b32 v76, 16, v103
    v_mfma_f32_16x16x32_bf16 v[40:43], v[120:123], a[192:195], v[40:43]
    s_waitcnt lgkmcnt(2)
    v_mfma_f32_16x16x32_bf16 v[48:51], v[104:107], a[192:195], v[48:51]
    s_add_u32 m0, s73, 97792
    v_lshlrev_b32 v77, 16, v103
    v_mfma_f32_16x16x32_bf16 v[48:51], v[108:111], a[200:203], v[48:51]
L_pl_X_7:
    s_cbranch_execz L_wret
    buffer_load_dwordx4 v21, s[44:47], s20 offen offset:512 sc1 lds
    s_waitcnt lgkmcnt(0)
    v_mfma_f32_16x16x32_bf16 v[48:51], v[112:115], a[208:211], v[48:51]
    ds_read_b128 v[120:123], v14 offset:17408
    v_mfma_f32_16x16x32_bf16 v[48:51], v[116:119], a[216:219], v[48:51]
    ds_read_b128 v[124:127], v14 offset:21504
    v_mfma_f32_16x16x32_bf16 v[52:55], v[116:119], a[220:223], v[52:55]
    ds_read_b128 v[128:131], v14 offset:25600
    v_lshlrev_b32 v78, 16, v103
    v_mfma_f32_16x16x32_bf16 v[52:55], v[112:115], a[212:215], v[52:55]
    ds_read_b128 v[132:135], v14 offset:29696
    buffer_load_dwordx2 v[96:97], v26, s[44:47], s42 offen offset:0 sc1
    v_mfma_f32_16x16x32_bf16 v[52:55], v[108:111], a[204:207], v[52:55]
    s_add_u32 m0, s73, 99328
    v_lshlrev_b32 v79, 16, v103
    v_mfma_f32_16x16x32_bf16 v[52:55], v[104:107], a[196:199], v[52:55]
    buffer_load_dwordx4 v21, s[44:47], s21 offen offset:0 sc1 lds
    s_waitcnt lgkmcnt(2)
    v_mfma_f32_16x16x32_bf16 v[36:39], v[120:123], a[228:231], v[36:39]
    s_add_u32 m0, s73, 99840
    v_lshlrev_b32 v80, 16, v102
    v_mfma_f32_16x16x32_bf16 v[36:39], v[124:127], a[236:239], v[36:39]
    buffer_load_dwordx4 v21, s[44:47], s21 offen offset:512 sc1 lds
    s_waitcnt lgkmcnt(0)
    v_mfma_f32_16x16x32_bf16 v[36:39], v[128:131], a[244:247], v[36:39]
    ds_read_b128 v[104:107], v14 offset:18432
    v_mfma_f32_16x16x32_bf16 v[36:39], v[132:135], a[252:255], v[36:39]
    ds_read_b128 v[108:111], v14 offset:22528
    v_mfma_f32_16x16x32_bf16 v[32:35], v[132:135], a[248:251], v[32:35]
    ds_read_b128 v[112:115], v14 offset:26624
    v_lshlrev_b32 v81, 16, v102
    v_mfma_f32_16x16x32_bf16 v[32:35], v[128:131], a[240:243], v[32:35]
    ds_read_b128 v[116:119], v14 offset:30720
    v_mfma_f32_16x16x32_bf16 v[32:35], v[124:127], a[232:235], v[32:35]
    s_add_u32 m0, s73, 101376
    v_lshlrev_b32 v82, 16, v102
    v_mfma_f32_16x16x32_bf16 v[32:35], v[120:123], a[224:227], v[32:35]
    buffer_load_dwordx4 v21, s[44:47], s22 offen offset:0 sc1 lds
    s_waitcnt lgkmcnt(2)
    v_mfma_f32_16x16x32_bf16 v[40:43], v[104:107], a[224:227], v[40:43]
    buffer_load_dwordx2 v[98:99], v26, s[44:47], s42 offen offset:128 sc1
    v_mfma_f32_16x16x32_bf16 v[40:43], v[108:111], a[232:235], v[40:43]
    v_lshlrev_b32 v83, 16, v102
    s_waitcnt lgkmcnt(0)
    v_mfma_f32_16x16x32_bf16 v[40:43], v[112:115], a[240:243], v[40:43]
    ds_read_b128 v[120:123], v14 offset:19456
    v_mfma_f32_16x16x32_bf16 v[40:43], v[116:119], a[248:251], v[40:43]
    ds_read_b128 v[124:127], v14 offset:23552
    v_mfma_f32_16x16x32_bf16 v[44:47], v[116:119], a[252:255], v[44:47]
    ds_read_b128 v[128:131], v14 offset:27648
    v_lshlrev_b32 v84, 16, v103
    v_mfma_f32_16x16x32_bf16 v[44:47], v[112:115], a[244:247], v[44:47]
    ds_read_b128 v[132:135], v14 offset:31744
    v_mfma_f32_16x16x32_bf16 v[44:47], v[108:111], a[236:239], v[44:47]
    v_lshlrev_b32 v85, 16, v103
    v_mfma_f32_16x16x32_bf16 v[44:47], v[104:107], a[228:231], v[44:47]
    s_waitcnt lgkmcnt(2)
    v_mfma_f32_16x16x32_bf16 v[52:55], v[120:123], a[228:231], v[52:55]
    v_mfma_f32_16x16x32_bf16 v[52:55], v[124:127], a[236:239], v[52:55]
    v_lshlrev_b32 v86, 16, v103
    s_waitcnt lgkmcnt(0)
    v_mfma_f32_16x16x32_bf16 v[52:55], v[128:131], a[244:247], v[52:55]
    buffer_load_dwordx2 v[100:101], v18, s[44:47], s42 offen offset:0 sc1
    s_waitcnt vmcnt(14)
    s_barrier
    v_mfma_f32_16x16x32_bf16 v[52:55], v[132:135], a[252:255], v[52:55]
    ds_read_b128 v[104:107], v14 offset:32768
    v_lshlrev_b32 v87, 16, v103
    v_mfma_f32_16x16x32_bf16 v[48:51], v[132:135], a[248:251], v[48:51]
    ds_read_b128 v[108:111], v14 offset:36864
    v_add_u32 v10, 65536, v10
    v_mfma_f32_16x16x32_bf16 v[48:51], v[128:131], a[240:243], v[48:51]
    ds_read_b128 v[112:115], v14 offset:40960
    v_mfma_f32_16x16x32_bf16 v[48:51], v[124:127], a[232:235], v[48:51]
    ds_read_b128 v[116:119], v14 offset:45056
    v_add_u32 v11, 65536, v11
    v_mfma_f32_16x16x32_bf16 v[48:51], v[120:123], a[224:227], v[48:51]
    v_lshlrev_b32 v27, 16, v27
    s_branch L_Dc
L_idle:
    s_waitcnt vmcnt(0)
    s_barrier
    s_mov_b64 exec, 0
    s_call_b64 s[82:83], L_wc_D
    s_mov_b64 exec, -1
    s_mov_b32 s60, s36
    s_and_b32 s61, s37, 0xffff
    s_mov_b32 s62, 4096
    s_mov_b32 s63, 0x20000
    v_and_b32 v24, 15, v2
    s_lshl_b32 s7, s71, 6
    v_add_u32 v24, s7, v24
    s_and_b32 s8, s3, 1
    s_lshl_b32 s4, s8, 5
    v_add_u32 v25, s4, v24
    v_lshlrev_b32 v26, 3, v25
    v_mul_u32_u24 v25, 1152, v25
    v_bfe_u32 v31, v2, 4, 1
    v_lshl_add_u32 v25, v31, 5, v25
    v_lshrrev_b32 v31, 5, v2
    v_lshl_add_u32 v25, v31, 4, v25
    s_bfe_u32 s7, s2, 0x20003
    s_mul_i32 s7, s7, 288
    s_bfe_u32 s5, s2, 0x10003
    s_mul_i32 s5, s5, 32
    s_lshl_b32 s4, s72, 6
    s_add_u32 s4, s4, s7
    s_add_u32 s4, s4, s5
    s_lshl_b32 s5, s5, 3
    s_sub_u32 s7, s7, s5
    v_add_u32 v252, s4, v25
    s_xor_b32 s8, s3, s72
    s_and_b32 s4, s72, 1
    s_lshl1_add_u32 s4, s4, s8
    v_lshl_add_u32 v24, s4, 4, v24
    s_add_u32 s7, s7, 256
    s_cmp_lt_u32 s8, 2
    s_cselect_b32 s7, s7, 0x40000000
    v_lshlrev_b32 v18, 3, v24
    v_mul_u32_u24 v24, 1152, v24
    v_lshrrev_b32 v31, 4, v2
    v_lshl_add_u32 v24, v31, 3, v24
    v_add_u32 v253, s7, v24
    v_lshrrev_b32 v24, 3, v2
    v_and_b32 v25, 7, v2
    v_bfe_u32 v31, v2, 4, 2
    v_lshlrev_b32 v31, 1, v31
    v_xor_b32 v25, v25, v31
    v_lshlrev_b32 v24, 12, v24
    v_lshl_add_u32 v24, v25, 4, v24
    s_mul_i32 s7, s72, 36
    s_bitcmp1_b32 s3, 0
    s_addc_u32 s7, s7, 0
    s_lshl_b32 s7, s7, 17
    s_lshl_b32 s8, s71, 7
    s_add_u32 s7, s7, s8
    v_add_u32 v4, s7, v24
    v_add_u32 v5, 31744, v4
    v_add_u32 v6, 31744, v5
    v_add_u32 v7, 31744, v6
    v_lshrrev_b32 v24, 2, v2
    v_lshlrev_b32 v24, 7, v24
    v_and_b32 v25, 3, v2
    v_lshl_add_u32 v24, v25, 3, v24
    s_and_b32 s7, s73, 8192
    v_add_u32 v24, s7, v24
    v_bfe_u32 v31, v2, 3, 2
    s_and_b32 s7, s3, 1
    s_lshl_b32 s7, s7, 1
    v_xor_b32 v31, s7, v31
    v_lshl_add_u32 v10, v31, 5, v24
    v_xor_b32 v11, 32, v10
    v_and_b32 v24, 15, v2
    v_lshrrev_b32 v25, 4, v2
    v_mul_u32_u24 v25, 17408, v25
    v_lshl_add_u32 v24, v24, 4, v25
    s_mul_i32 s7, s72, 36
    s_and_b32 s8, s3, 1
    s_add_u32 s7, s7, s8
    s_mul_i32 s7, s7, 69632
    s_bfe_u32 s8, s2, 0x20003
    s_lshl_b32 s8, s8, 12
    s_add_u32 s7, s7, s8
    s_add_u32 s7, s7, 12795904
    v_add_u32 v23, s7, v24
    s_xor_b32 s7, s72, 0
    v_lshl_add_u32 v19, s7, 10, v23
    s_xor_b32 s7, s72, 1
    v_lshl_add_u32 v20, s7, 10, v23
    s_xor_b32 s7, s72, 2
    v_lshl_add_u32 v21, s7, 10, v23
    s_xor_b32 s7, s72, 3
    v_lshl_add_u32 v22, s7, 10, v23
    v_lshlrev_b32 v14, 4, v2
    v_add_u32 v14, 98304, v14
    v_add_u32 v1, 0x10000, v14
    s_bitcmp1_b32 s3, 1
    s_cselect_b32 s18, s85, s84
    s_mul_i32 s18, s18, 139264
    s_cselect_b32 s19, s87, s86
    s_mul_i32 s19, s19, 139264
    s_cselect_b32 s20, s89, s88
    s_mul_i32 s20, s20, 139264
    s_cselect_b32 s21, s91, s90
    s_mul_i32 s21, s21, 139264
    s_cselect_b32 s22, s93, s92
    s_mul_i32 s22, s22, 139264
    s_cselect_b32 s23, s95, s94
    s_mul_i32 s23, s23, 139264
    s_cselect_b32 s24, s97, s96
    s_mul_i32 s24, s24, 139264
    s_cselect_b32 s25, s99, s98
    s_mul_i32 s25, s25, 139264
    s_cselect_b32 s26, s101, s100
    s_mul_i32 s26, s26, 139264
    s_sub_u32 s4, s75, 252
    s_mul_i32 s4, s4, 1152
    s_mul_i32 s5, s3, 64
    s_add_u32 s4, s4, s5
    s_add_u32 s4, s4, 896
    s_lshl_b32 s4, s4, 12
    s_add_u32 s4, s4, 384
    v_lshlrev_b32 v24, 10, v2
    buffer_load_dword v255, v24, s[52:55], s4 offen
    s_add_u32 s4, s4, 65536
    buffer_load_dword v255, v24, s[52:55], s4 offen
    s_add_u32 s4, s4, 65536
    buffer_load_dword v255, v24, s[52:55], s4 offen
    s_add_u32 s4, s4, 65536
    buffer_load_dword v255, v24, s[52:55], s4 offen
    s_add_u32 s4, s4, 65536
    s_add_u32 m0, s73, 32768
    s_lshl_b32 s14, s84, 18
    buffer_load_dwordx4 v4, s[52:55], s14 offen offset:0 lds
    buffer_load_dwordx4 v5, s[52:55], s14 offen offset:1024 lds
    buffer_load_dwordx4 v6, s[52:55], s14 offen offset:2048 lds
    buffer_load_dwordx4 v7, s[52:55], s14 offen offset:3072 lds
    s_add_u32 m0, s73, 49152
    s_lshl_b32 s14, s85, 18
    buffer_load_dwordx4 v4, s[52:55], s14 offen offset:0 lds
    buffer_load_dwordx4 v5, s[52:55], s14 offen offset:1024 lds
    buffer_load_dwordx4 v6, s[52:55], s14 offen offset:2048 lds
    buffer_load_dwordx4 v7, s[52:55], s14 offen offset:3072 lds
    s_add_u32 m0, s73, 65536
    s_lshl_b32 s14, s86, 18
    buffer_load_dwordx4 v4, s[52:55], s14 offen offset:0 lds
    buffer_load_dwordx4 v5, s[52:55], s14 offen offset:1024 lds
    buffer_load_dwordx4 v6, s[52:55], s14 offen offset:2048 lds
    buffer_load_dwordx4 v7, s[52:55], s14 offen offset:3072 lds
    s_add_u32 m0, s73, 81920
    s_lshl_b32 s14, s87, 18
    buffer_load_dwordx4 v4, s[52:55], s14 offen offset:0 lds
    buffer_load_dwordx4 v5, s[52:55], s14 offen offset:1024 lds
    buffer_load_dwordx4 v6, s[52:55], s14 offen offset:2048 lds
    buffer_load_dwordx4 v7, s[52:55], s14 offen offset:3072 lds
    s_add_u32 m0, s73, 98304
    s_lshl_b32 s14, s88, 18
    buffer_load_dwordx4 v4, s[52:55], s14 offen offset:0 lds
    buffer_load_dwordx4 v5, s[52:55], s14 offen offset:1024 lds
    buffer_load_dwordx4 v6, s[52:55], s14 offen offset:2048 lds
    buffer_load_dwordx4 v7, s[52:55], s14 offen offset:3072 lds
    s_add_u32 m0, s73, 114688
    s_lshl_b32 s14, s89, 18
    buffer_load_dwordx4 v4, s[52:55], s14 offen offset:0 lds
    buffer_load_dwordx4 v5, s[52:55], s14 offen offset:1024 lds
    buffer_load_dwordx4 v6, s[52:55], s14 offen offset:2048 lds
    buffer_load_dwordx4 v7, s[52:55], s14 offen offset:3072 lds
    s_add_u32 m0, s73, 131072
    s_lshl_b32 s14, s90, 18
    buffer_load_dwordx4 v4, s[52:55], s14 offen offset:0 lds
    buffer_load_dwordx4 v5, s[52:55], s14 offen offset:1024 lds
    buffer_load_dwordx4 v6, s[52:55], s14 offen offset:2048 lds
    buffer_load_dwordx4 v7, s[52:55], s14 offen offset:3072 lds
    s_add_u32 m0, s73, 147456
    s_lshl_b32 s14, s91, 18
    buffer_load_dwordx4 v4, s[52:55], s14 offen offset:0 lds
    buffer_load_dwordx4 v5, s[52:55], s14 offen offset:1024 lds
    buffer_load_dwordx4 v6, s[52:55], s14 offen offset:2048 lds
    buffer_load_dwordx4 v7, s[52:55], s14 offen offset:3072 lds
    s_waitcnt vmcnt(28)
    s_barrier
    ds_read_b64_tr_b16 a[0:1], v10 offset:32768
    ds_read_b64_tr_b16 a[2:3], v10 offset:34816
    ds_read_b64_tr_b16 a[8:9], v10 offset:36864
    ds_read_b64_tr_b16 a[10:11], v10 offset:38912
    ds_read_b64_tr_b16 a[4:5], v11 offset:32768
    ds_read_b64_tr_b16 a[6:7], v11 offset:34816
    ds_read_b64_tr_b16 a[12:13], v11 offset:36864
    ds_read_b64_tr_b16 a[14:15], v11 offset:38912
    s_waitcnt vmcnt(24) lgkmcnt(0)
    s_barrier
    ds_read_b64_tr_b16 a[16:17], v10 offset:49152
    s_add_u32 m0, s73, 32768
    s_lshl_b32 s14, s92, 18
    ds_read_b64_tr_b16 a[18:19], v10 offset:51200
    buffer_load_dwordx4 v4, s[52:55], s14 offen offset:0 lds
    ds_read_b64_tr_b16 a[24:25], v10 offset:53248
    ds_read_b64_tr_b16 a[26:27], v10 offset:55296
    buffer_load_dwordx4 v5, s[52:55], s14 offen offset:1024 lds
    ds_read_b64_tr_b16 a[20:21], v11 offset:49152
    buffer_load_dwordx4 v6, s[52:55], s14 offen offset:2048 lds
    ds_read_b64_tr_b16 a[22:23], v11 offset:51200
    ds_read_b64_tr_b16 a[28:29], v11 offset:53248
    buffer_load_dwordx4 v7, s[52:55], s14 offen offset:3072 lds
    ds_read_b64_tr_b16 a[30:31], v11 offset:55296
    s_waitcnt vmcnt(24) lgkmcnt(0)
    s_barrier
    v_add_u32 v10, 65536, v10
    ds_read_b64_tr_b16 a[32:33], v10 offset:0
    s_add_u32 m0, s73, 49152
    s_lshl_b32 s14, s93, 18
    ds_read_b64_tr_b16 a[34:35], v10 offset:2048
    buffer_load_dwordx4 v4, s[52:55], s14 offen offset:0 lds
    ds_read_b64_tr_b16 a[40:41], v10 offset:4096
    ds_read_b64_tr_b16 a[42:43], v10 offset:6144
    buffer_load_dwordx4 v5, s[52:55], s14 offen offset:1024 lds
    v_add_u32 v11, 65536, v11
    ds_read_b64_tr_b16 a[36:37], v11 offset:0
    buffer_load_dwordx4 v6, s[52:55], s14 offen offset:2048 lds
    ds_read_b64_tr_b16 a[38:39], v11 offset:2048
    ds_read_b64_tr_b16 a[44:45], v11 offset:4096
    buffer_load_dwordx4 v7, s[52:55], s14 offen offset:3072 lds
    ds_read_b64_tr_b16 a[46:47], v11 offset:6144
    s_waitcnt vmcnt(24) lgkmcnt(0)
    s_barrier
    ds_read_b64_tr_b16 a[48:49], v10 offset:16384
    s_add_u32 m0, s73, 65536
    s_lshl_b32 s14, s94, 18
    ds_read_b64_tr_b16 a[50:51], v10 offset:18432
    buffer_load_dwordx4 v4, s[52:55], s14 offen offset:0 lds
    ds_read_b64_tr_b16 a[56:57], v10 offset:20480
    ds_read_b64_tr_b16 a[58:59], v10 offset:22528
    buffer_load_dwordx4 v5, s[52:55], s14 offen offset:1024 lds
    ds_read_b64_tr_b16 a[52:53], v11 offset:16384
    buffer_load_dwordx4 v6, s[52:55], s14 offen offset:2048 lds
    ds_read_b64_tr_b16 a[54:55], v11 offset:18432
    ds_read_b64_tr_b16 a[60:61], v11 offset:20480
    buffer_load_dwordx4 v7, s[52:55], s14 offen offset:3072 lds
    ds_read_b64_tr_b16 a[62:63], v11 offset:22528
    s_waitcnt vmcnt(24) lgkmcnt(0)
    s_barrier
    ds_read_b64_tr_b16 a[64:65], v10 offset:32768
    s_add_u32 m0, s73, 81920
    s_lshl_b32 s14, s95, 18
    ds_read_b64_tr_b16 a[66:67], v10 offset:34816
    buffer_load_dwordx4 v4, s[52:55], s14 offen offset:0 lds
    ds_read_b64_tr_b16 a[72:73], v10 offset:36864
    ds_read_b64_tr_b16 a[74:75], v10 offset:38912
    buffer_load_dwordx4 v5, s[52:55], s14 offen offset:1024 lds
    ds_read_b64_tr_b16 a[68:69], v11 offset:32768
    buffer_load_dwordx4 v6, s[52:55], s14 offen offset:2048 lds
    ds_read_b64_tr_b16 a[70:71], v11 offset:34816
    ds_read_b64_tr_b16 a[76:77], v11 offset:36864
    buffer_load_dwordx4 v7, s[52:55], s14 offen offset:3072 lds
    ds_read_b64_tr_b16 a[78:79], v11 offset:38912
    s_waitcnt vmcnt(24) lgkmcnt(0)
    s_barrier
    ds_read_b64_tr_b16 a[80:81], v10 offset:49152
    s_add_u32 m0, s73, 98304
    s_lshl_b32 s14, s96, 18
    ds_read_b64_tr_b16 a[82:83], v10 offset:51200
    buffer_load_dwordx4 v4, s[52:55], s14 offen offset:0 lds
    ds_read_b64_tr_b16 a[88:89], v10 offset:53248
    ds_read_b64_tr_b16 a[90:91], v10 offset:55296
    buffer_load_dwordx4 v5, s[52:55], s14 offen offset:1024 lds
    ds_read_b64_tr_b16 a[84:85], v11 offset:49152
    buffer_load_dwordx4 v6, s[52:55], s14 offen offset:2048 lds
    ds_read_b64_tr_b16 a[86:87], v11 offset:51200
    ds_read_b64_tr_b16 a[92:93], v11 offset:53248
    buffer_load_dwordx4 v7, s[52:55], s14 offen offset:3072 lds
    ds_read_b64_tr_b16 a[94:95], v11 offset:55296
    s_waitcnt vmcnt(24) lgkmcnt(0)
    s_barrier
    v_add_u32 v10, 65536, v10
    ds_read_b64_tr_b16 a[96:97], v10 offset:0
    s_add_u32 m0, s73, 114688
    s_lshl_b32 s14, s97, 18
    ds_read_b64_tr_b16 a[98:99], v10 offset:2048
    buffer_load_dwordx4 v4, s[52:55], s14 offen offset:0 lds
    ds_read_b64_tr_b16 a[104:105], v10 offset:4096
    ds_read_b64_tr_b16 a[106:107], v10 offset:6144
    buffer_load_dwordx4 v5, s[52:55], s14 offen offset:1024 lds
    v_add_u32 v11, 65536, v11
    ds_read_b64_tr_b16 a[100:101], v11 offset:0
    buffer_load_dwordx4 v6, s[52:55], s14 offen offset:2048 lds
    ds_read_b64_tr_b16 a[102:103], v11 offset:2048
    ds_read_b64_tr_b16 a[108:109], v11 offset:4096
    buffer_load_dwordx4 v7, s[52:55], s14 offen offset:3072 lds
    ds_read_b64_tr_b16 a[110:111], v11 offset:6144
    s_waitcnt vmcnt(24) lgkmcnt(0)
    s_barrier
    ds_read_b64_tr_b16 a[112:113], v10 offset:16384
    s_add_u32 m0, s73, 131072
    s_lshl_b32 s14, s98, 18
    ds_read_b64_tr_b16 a[114:115], v10 offset:18432
    buffer_load_dwordx4 v4, s[52:55], s14 offen offset:0 lds
    ds_read_b64_tr_b16 a[120:121], v10 offset:20480
    ds_read_b64_tr_b16 a[122:123], v10 offset:22528
    buffer_load_dwordx4 v5, s[52:55], s14 offen offset:1024 lds
    ds_read_b64_tr_b16 a[116:117], v11 offset:16384
    buffer_load_dwordx4 v6, s[52:55], s14 offen offset:2048 lds
    ds_read_b64_tr_b16 a[118:119], v11 offset:18432
    ds_read_b64_tr_b16 a[124:125], v11 offset:20480
    buffer_load_dwordx4 v7, s[52:55], s14 offen offset:3072 lds
    ds_read_b64_tr_b16 a[126:127], v11 offset:22528
    s_waitcnt vmcnt(24) lgkmcnt(0)
    s_barrier
    v_add_u32 v10, -131072, v10
    ds_read_b64_tr_b16 a[128:129], v10 offset:32768
    s_add_u32 m0, s73, 147456
    s_lshl_b32 s14, s99, 18
    ds_read_b64_tr_b16 a[130:131], v10 offset:34816
    buffer_load_dwordx4 v4, s[52:55], s14 offen offset:0 lds
    ds_read_b64_tr_b16 a[136:137], v10 offset:36864
    ds_read_b64_tr_b16 a[138:139], v10 offset:38912
    buffer_load_dwordx4 v5, s[52:55], s14 offen offset:1024 lds
    v_add_u32 v11, -131072, v11
    ds_read_b64_tr_b16 a[132:133], v11 offset:32768
    buffer_load_dwordx4 v6, s[52:55], s14 offen offset:2048 lds
    ds_read_b64_tr_b16 a[134:135], v11 offset:34816
    ds_read_b64_tr_b16 a[140:141], v11 offset:36864
    buffer_load_dwordx4 v7, s[52:55], s14 offen offset:3072 lds
    ds_read_b64_tr_b16 a[142:143], v11 offset:38912
    s_waitcnt vmcnt(24) lgkmcnt(0)
    s_barrier
    ds_read_b64_tr_b16 a[144:145], v10 offset:49152
    s_add_u32 m0, s73, 0
    s_lshl_b32 s14, s100, 18
    ds_read_b64_tr_b16 a[146:147], v10 offset:51200
    buffer_load_dwordx4 v4, s[52:55], s14 offen offset:0 lds
    ds_read_b64_tr_b16 a[152:153], v10 offset:53248
    ds_read_b64_tr_b16 a[154:155], v10 offset:55296
    buffer_load_dwordx4 v5, s[52:55], s14 offen offset:1024 lds
    ds_read_b64_tr_b16 a[148:149], v11 offset:49152
    buffer_load_dwordx4 v6, s[52:55], s14 offen offset:2048 lds
    ds_read_b64_tr_b16 a[150:151], v11 offset:51200
    ds_read_b64_tr_b16 a[156:157], v11 offset:53248
    buffer_load_dwordx4 v7, s[52:55], s14 offen offset:3072 lds
    ds_read_b64_tr_b16 a[158:159], v11 offset:55296
    s_waitcnt vmcnt(24) lgkmcnt(0)
    s_barrier
    v_add_u32 v10, 65536, v10
    ds_read_b64_tr_b16 a[160:161], v10 offset:0
    s_add_u32 m0, s73, 16384
    s_lshl_b32 s14, s101, 18
    ds_read_b64_tr_b16 a[162:163], v10 offset:2048
    buffer_load_dwordx4 v4, s[52:55], s14 offen offset:0 lds
    ds_read_b64_tr_b16 a[168:169], v10 offset:4096
    ds_read_b64_tr_b16 a[170:171], v10 offset:6144
    buffer_load_dwordx4 v5, s[52:55], s14 offen offset:1024 lds
    v_add_u32 v11, 65536, v11
    ds_read_b64_tr_b16 a[164:165], v11 offset:0
    buffer_load_dwordx4 v6, s[52:55], s14 offen offset:2048 lds
    ds_read_b64_tr_b16 a[166:167], v11 offset:2048
    ds_read_b64_tr_b16 a[172:173], v11 offset:4096
    buffer_load_dwordx4 v7, s[52:55], s14 offen offset:3072 lds
    ds_read_b64_tr_b16 a[174:175], v11 offset:6144
    s_waitcnt vmcnt(24) lgkmcnt(0)
    s_barrier
    ds_read_b64_tr_b16 a[176:177], v10 offset:16384
    ds_read_b64_tr_b16 a[178:179], v10 offset:18432
    ds_read_b64_tr_b16 a[184:185], v10 offset:20480
    ds_read_b64_tr_b16 a[186:187], v10 offset:22528
    ds_read_b64_tr_b16 a[180:181], v11 offset:16384
    ds_read_b64_tr_b16 a[182:183], v11 offset:18432
    ds_read_b64_tr_b16 a[188:189], v11 offset:20480
    ds_read_b64_tr_b16 a[190:191], v11 offset:22528
    s_waitcnt vmcnt(20) lgkmcnt(0)
    s_barrier
    ds_read_b64_tr_b16 a[192:193], v10 offset:32768
    ds_read_b64_tr_b16 a[194:195], v10 offset:34816
    ds_read_b64_tr_b16 a[200:201], v10 offset:36864
    ds_read_b64_tr_b16 a[202:203], v10 offset:38912
    ds_read_b64_tr_b16 a[196:197], v11 offset:32768
    ds_read_b64_tr_b16 a[198:199], v11 offset:34816
    ds_read_b64_tr_b16 a[204:205], v11 offset:36864
    ds_read_b64_tr_b16 a[206:207], v11 offset:38912
    s_waitcnt vmcnt(16) lgkmcnt(0)
    s_barrier
    ds_read_b64_tr_b16 a[208:209], v10 offset:49152
    ds_read_b64_tr_b16 a[210:211], v10 offset:51200
    ds_read_b64_tr_b16 a[216:217], v10 offset:53248
    ds_read_b64_tr_b16 a[218:219], v10 offset:55296
    ds_read_b64_tr_b16 a[212:213], v11 offset:49152
    ds_read_b64_tr_b16 a[214:215], v11 offset:51200
    ds_read_b64_tr_b16 a[220:221], v11 offset:53248
    ds_read_b64_tr_b16 a[222:223], v11 offset:55296
    s_waitcnt vmcnt(12) lgkmcnt(0)
    s_barrier
    v_add_u32 v10, 65536, v10
    ds_read_b64_tr_b16 a[224:225], v10 offset:0
    ds_read_b64_tr_b16 a[226:227], v10 offset:2048
    ds_read_b64_tr_b16 a[232:233], v10 offset:4096
    ds_read_b64_tr_b16 a[234:235], v10 offset:6144
    v_add_u32 v11, 65536, v11
    ds_read_b64_tr_b16 a[228:229], v11 offset:0
    ds_read_b64_tr_b16 a[230:231], v11 offset:2048
    ds_read_b64_tr_b16 a[236:237], v11 offset:4096
    ds_read_b64_tr_b16 a[238:239], v11 offset:6144
    s_waitcnt vmcnt(8) lgkmcnt(0)
    s_barrier
    ds_read_b64_tr_b16 a[240:241], v10 offset:16384
    ds_read_b64_tr_b16 a[242:243], v10 offset:18432
    ds_read_b64_tr_b16 a[248:249], v10 offset:20480
    ds_read_b64_tr_b16 a[250:251], v10 offset:22528
    ds_read_b64_tr_b16 a[244:245], v11 offset:16384
    ds_read_b64_tr_b16 a[246:247], v11 offset:18432
    ds_read_b64_tr_b16 a[252:253], v11 offset:20480
    ds_read_b64_tr_b16 a[254:255], v11 offset:22528
    s_waitcnt lgkmcnt(0)
    s_barrier
    v_add_u32 v10, -131072, v10
    v_add_u32 v11, -131072, v11
    s_mov_b64 exec, 0
    s_call_b64 s[82:83], L_wc_D
    s_mov_b64 exec, -1
    s_bfe_u32 s4, s2, 0x20003
    s_lshl2_add_u32 s4, s72, s4
    s_lshl_b32 s4, s4, 3
    s_lshr_b32 s5, s2, 4
    s_and_b32 s5, s5, 6
    s_add_u32 s4, s4, s5
    s_and_b32 s5, s2, 1
    s_add_u32 s4, s4, s5
    s_lshl_b32 s4, s4, 7
    s_add_u32 s4, s4, 12566528
    v_lshl_add_u32 v28, v2, 2, s4
    s_cmp_eq_u32 s3, 0
    s_cselect_b32 s4, 18, 0
    v_cmp_gt_u32 vcc, s4, v2
    v_mov_b32 v13, 0x40000000
    s_nop 0
    v_cndmask_b32 v28, v13, v28, vcc
    v_mov_b32 v13, s68
    v_cndmask_b32 v13, 0, v13, vcc
    s_mov_b32 s5, 0
L_iw:
    s_sleep 16
    v_mov_b32 v29, 0
    buffer_atomic_add v29, v28, s[44:47], 0 offen sc0 sc1
    s_waitcnt vmcnt(0)
    v_cmp_eq_u32 vcc, 0, v13
    s_nop 1
    s_mov_b64 s[6:7], vcc
    v_cmp_ne_u32 vcc, v13, v29
    s_nop 1
    s_andn2_b64 s[8:9], exec, vcc
    s_andn2_b64 s[8:9], s[8:9], s[6:7]
    s_cbranch_scc1 L_ix
    s_cmp_eq_u64 s[6:7], exec
    s_cbranch_scc1 L_ix
    s_add_u32 s5, s5, 1
    s_cmp_lt_u32 s5, 100000
    s_cbranch_scc1 L_iw
L_ix:
    v_mov_b32 v29, 0
    buffer_atomic_add v29, v28, s[44:47], 0 offen sc0 sc1
    s_branch L_DX
L_end:
.section .rodata,"a"
.p2align 6
.amdhsa_kernel recurrent_scan__ssm_conv_h3__mixer_token_mlp__prompt_kernel
  .amdhsa_next_free_vgpr 512
  .amdhsa_next_free_sgpr 102
  .amdhsa_accum_offset 256
  .amdhsa_group_segment_fixed_size 0
  .amdhsa_kernarg_size 112
  .amdhsa_user_sgpr_count 2
  .amdhsa_user_sgpr_kernarg_segment_ptr 1
  .amdhsa_system_sgpr_workgroup_id_x 1
  .amdhsa_float_denorm_mode_32 3
.end_amdhsa_kernel
```

```asm
; @launch grid=(256,1,1) block=(256,1,1) lds=163840
.amdgcn_target "amdgcn-amd-amdhsa--gfx950"
.text
.globl recurrent_scan__ssm_conv_h3__mixer_token_mlp__prompt_kernel
.p2align 8
.type recurrent_scan__ssm_conv_h3__mixer_token_mlp__prompt_kernel,@function
recurrent_scan__ssm_conv_h3__mixer_token_mlp__prompt_kernel:
    s_cmp_lt_u32 s2, 256
    s_cbranch_scc0 L_exit
    s_load_dwordx2 s[56:57], s[0:1], 0
    s_load_dwordx2 s[48:49], s[0:1], 8
    s_load_dwordx2 s[52:53], s[0:1], 16
    s_load_dwordx2 s[60:61], s[0:1], 24
    s_load_dwordx16 s[16:31], s[0:1], 0
    s_load_dwordx8 s[32:39], s[0:1], 64
    s_load_dwordx4 s[40:43], s[0:1], 96
    s_memrealtime s[12:13]
    v_lshrrev_b32 v1, 6, v0
    v_and_b32 v2, 63, v0
    s_getpc_b64 s[6:7]
L_pc:
    s_lshr_b32 s4, s2, 1
    s_and_b32 s4, s4, 124
    v_add_u32 v22, s4, v1
    v_lshl_add_u32 v22, v2, 7, v22
    v_lshlrev_b32 v22, 7, v22
    v_min_u32 v22, L_end-L_pc-4, v22
    s_mov_b64 exec, 31
    global_load_dword v255, v22, s[6:7]
    s_mov_b64 exec, -1
    v_readfirstlane_b32 s3, v1
    s_and_b32 s4, s2, 7
    s_lshr_b32 s5, s2, 3
    s_lshl_b32 s4, s4, 5
    s_add_u32 s68, s4, s5
    v_lshrrev_b32 v3, 5, v0
    v_and_b32 v4, 31, v0
    v_mul_u32_u24 v5, 1152, v3
    v_mad_u32_u24 v5, v4, 12, v5
    s_mul_i32 s15, s68, 9216
    s_mul_i32 s4, s3, 3072
    s_add_u32 s5, s4, s15
    s_sub_u32 s5, s5, 3456
    v_lshlrev_b32 v6, 4, v2
    v_add_u32 v7, s5, v6
    v_add_u32 v58, 1024, v7
    s_add_u32 s4, s4, 114688
    s_lshl_b32 s5, s3, 11
    s_add_u32 s11, s5, s15
    s_add_u32 s5, s5, 127360
    s_cmp_lt_u32 s2, 216
    s_cselect_b32 s9, 0, 106496
    s_sub_u32 s4, s4, s9
    s_sub_u32 s5, s5, s9
    s_mov_b32 m0, s4
    s_mov_b32 s58, 2359296
    s_mov_b32 s59, 0x20000
    s_mov_b32 s50, 2359296
    s_mov_b32 s51, 0x20000
    s_mov_b32 s54, 2359296
    s_mov_b32 s55, 0x20000
    s_mov_b32 s62, 4608
    s_mov_b32 s63, 0x20000
    v_lshlrev_b32 v59, 3, v0
    s_movk_i32 s10, 4096
    v_lshlrev_b32 v91, 3, v2
    v_or_b32 v22, s2, v0
    v_lshlrev_b32 v22, 8, v22
    s_mov_b32 s66, 256
    s_mov_b32 s67, 0x20000
    s_waitcnt lgkmcnt(0)
    buffer_load_dwordx3 v[8:10], v5, s[56:59], s15 offen offset:0
    buffer_load_dwordx3 v[12:14], v5, s[56:59], s15 offen offset:384
    buffer_load_dwordx3 v[16:18], v5, s[56:59], s15 offen offset:768
    s_mov_b32 s64, s40
    s_and_b32 s65, s41, 0xffff
    s_or_b32 s12, s12, 1
    v_mov_b32 v23, s12
    buffer_store_dword v23, v22, s[64:67], 0 offen sc1
    buffer_load_dwordx4 v7, s[48:51], 0 offen lds
    s_add_u32 m0, s4, 1024
    s_cmp_eq_u32 s3, 3
    buffer_load_dwordx4 v58, s[48:51], 0 offen lds
    buffer_load_dwordx4 v58, s[48:51], 0 offen offset:1024 lds
    s_cbranch_scc1 L_xld
L_nox:
    s_mov_b32 m0, s5
    buffer_load_dwordx2 v[98:99], v59, s[60:63], 0 offen
    buffer_load_dwordx4 v6, s[52:55], s11 offen lds
    buffer_load_dwordx4 v6, s[52:55], s11 offen offset:1024 lds
    buffer_load_dwordx2 v[100:101], v59, s[60:63], 0 offen offset:2048
    buffer_load_dwordx2 v[102:103], v59, s[60:63], s10 offen
    s_mov_b32 s44, s42
    s_and_b32 s45, s43, 0xffff
    s_mov_b32 s46, 42352640
    s_mov_b32 s47, 0x20000
    s_and_b32 s5, s2, 7
    s_lshr_b32 s6, s2, 3
    s_lshr_b32 s7, s6, 2
    s_lshr_b32 s8, s3, 1
    s_lshl1_add_u32 s9, s7, s8
    s_cmp_ge_u32 s9, 10
    s_addc_u32 s14, s9, 0
    s_cmp_ge_u32 s9, 3
    s_addc_u32 s14, s14, 0
    s_lshl3_add_u32 s8, s8, 3
    s_cmp_eq_u32 s7, 7
    s_cselect_b32 s14, s8, s14
    s_and_b32 s4, s5, 1
    s_lshl4_add_u32 s71, s4, s14
    s_lshr_b32 s13, s5, 1
    s_mov_b32 s72, s13
    s_lshl_b32 s73, s3, 12
    s_mov_b32 s52, s34
    s_and_b32 s53, s35, 0xffff
    s_mov_b32 s54, 18874368
    s_mov_b32 s55, 0x20000
    s_cmp_lt_u32 s6, 27
    s_cbranch_scc0 L_aux
    s_branch L_org
L_exit:
    s_endpgm
L_xld:
    s_mov_b64 exec, 0xffffff
    buffer_load_dwordx4 v58, s[48:51], 0 offen offset:2048 lds
    s_mov_b64 exec, -1
    s_mov_b32 m0, s5
    s_nop 0
    buffer_load_dwordx4 v6, s[52:55], s11 offen offset:2048 lds
    s_branch L_nox
L_nw_G:
    s_mov_b32 s5, 0
L_nl_G:
    buffer_load_dword v45, v54, s[64:67], 0 offen sc1
    s_waitcnt vmcnt(0)
    v_readfirstlane_b32 s68, v45
    s_nop 1
    s_cmp_lg_u32 s68, 0
    s_cbranch_scc1 L_ng_G
    s_add_u32 s5, s5, 1
    s_cmp_lt_u32 s5, 100000
    s_cbranch_scc1 L_nl_G
    s_branch L_ng_G
L_rs_p1G:
    s_mov_b32 s5, 0
L_rt_p1G:
    s_mov_b64 exec, vcc
    v_mov_b32 v29, 0
    buffer_atomic_add v29, v28, s[44:47], 0 offen sc0 sc1
    s_waitcnt vmcnt(0)
    v_cmp_ne_u32 vcc, v12, v29
    s_cbranch_vccz L_rx_p1G
    s_add_u32 s5, s5, 1
    s_cmp_lt_u32 s5, 100000
    s_cbranch_scc1 L_rt_p1G
L_rx_p1G:
    s_mov_b64 exec, -1
    s_branch L_ok_p1G
L_rs_p5:
    s_mov_b32 s5, 0
L_rt_p5:
    s_mov_b64 exec, vcc
    buffer_load_dword v29, v28, s[44:47], 0 offen sc1
    s_waitcnt vmcnt(0)
    v_cmp_ne_u32 vcc, s68, v29
    s_cbranch_vccz L_rx_p5
    s_add_u32 s5, s5, 1
    s_cmp_lt_u32 s5, 100000
    s_cbranch_scc1 L_rt_p5
L_rx_p5:
    s_mov_b64 exec, -1
    s_branch L_ok_p5
L_nw_X:
    s_mov_b32 s5, 0
L_nl_X:
    buffer_load_dword v45, v54, s[64:67], 0 offen sc1
    s_waitcnt vmcnt(0)
    v_readfirstlane_b32 s68, v45
    s_nop 1
    s_cmp_lg_u32 s68, 0
    s_cbranch_scc1 L_ng_X
    s_add_u32 s5, s5, 1
    s_cmp_lt_u32 s5, 100000
    s_cbranch_scc1 L_nl_X
    s_branch L_ng_X
L_rs_p1X:
    s_mov_b32 s5, 0
L_rt_p1X:
    s_mov_b64 exec, vcc
    v_mov_b32 v29, 0
    buffer_atomic_add v29, v28, s[44:47], 0 offen sc0 sc1
    s_waitcnt vmcnt(0)
    v_cmp_ne_u32 vcc, s68, v29
    s_cbranch_vccz L_rx_p1X
    s_add_u32 s5, s5, 1
    s_cmp_lt_u32 s5, 100000
    s_cbranch_scc1 L_rt_p1X
L_rx_p1X:
    s_mov_b64 exec, -1
    s_branch L_ok_p1X
L_rs_p2G:
    s_mov_b32 s5, 0
L_rt_p2G:
    s_mov_b64 exec, vcc
    v_mov_b32 v16, 0
    buffer_atomic_add v16, v15, s[44:47], 0 offen sc0 sc1
    s_waitcnt vmcnt(0)
    v_cmp_ne_u32 vcc, v13, v16
    s_cbranch_vccz L_rx_p2G
    s_add_u32 s5, s5, 1
    s_cmp_lt_u32 s5, 100000
    s_cbranch_scc1 L_rt_p2G
L_rx_p2G:
    s_mov_b64 exec, -1
    s_branch L_ok_p2G
L_xs_a:
    s_mov_b32 s5, 0
L_xt_a:
    v_mov_b32 v187, 0
    buffer_atomic_add v187, v137, s[44:47], 0 offen offset:12 sc0 sc1
    s_waitcnt vmcnt(0)
    v_cmp_ne_u32 vcc, v138, v187
    s_cbranch_vccz L_xr_a
    s_add_u32 s5, s5, 1
    s_cmp_lt_u32 s5, 100000
    s_cbranch_scc1 L_xt_a
L_xr_a:
    buffer_load_dwordx4 v[40:43], v136, s[44:47], s34 offen offset:0 sc1
    buffer_load_dwordx4 v[44:47], v136, s[44:47], s34 offen offset:1024 sc1
    buffer_load_dwordx4 v[48:51], v136, s[44:47], s34 offen offset:2048 sc1
    s_waitcnt vmcnt(0)
    v_bitop3_b32 v43, v43, v47, s68 bitop3:0x7e
    v_bitop3_b32 v43, v43, v51, s68 bitop3:0xf6
    v_cmp_ne_u32 vcc, 0, v43
    s_cbranch_vccz L_xo_a
    s_add_u32 s5, s5, 1
    s_cmp_lt_u32 s5, 100000
    s_cbranch_scc1 L_xt_a
    s_branch L_xo_a
L_as_b:
    s_mov_b32 s5, 0
L_at_b:
    v_mov_b32 v141, 0
    buffer_atomic_add v141, v139, s[44:47], s11 offen offset:2060 sc0 sc1
    s_waitcnt vmcnt(0)
    v_cmp_ne_u32 vcc, v140, v141
    s_cbranch_vccz L_ao_b
    s_add_u32 s5, s5, 1
    s_cmp_lt_u32 s5, 100000
    s_cbranch_scc1 L_at_b
    s_branch L_ao_b
L_xs_b:
    s_mov_b32 s5, 0
L_xt_b:
    buffer_load_dwordx4 v[56:59], v136, s[44:47], s11 offen offset:0 sc1
    buffer_load_dwordx4 v[60:63], v136, s[44:47], s11 offen offset:1024 sc1
    buffer_load_dwordx4 v[64:67], v136, s[44:47], s11 offen offset:2048 sc1
    s_waitcnt vmcnt(0)
    v_bitop3_b32 v59, v59, v63, s68 bitop3:0x7e
    v_bitop3_b32 v59, v59, v67, s68 bitop3:0xf6
    v_cmp_ne_u32 vcc, 0, v59
    s_cbranch_vccz L_xo_b
    s_add_u32 s5, s5, 1
    s_cmp_lt_u32 s5, 100000
    s_cbranch_scc1 L_xt_b
    s_branch L_xo_b
L_xs_z:
    s_mov_b32 s5, 0
L_xt_z:
    buffer_load_dwordx4 v[72:75], v136, s[44:47], s12 offen offset:0 sc1
    buffer_load_dwordx4 v[76:79], v136, s[44:47], s12 offen offset:1024 sc1
    buffer_load_dwordx4 v[80:83], v136, s[44:47], s12 offen offset:2048 sc1
    s_waitcnt vmcnt(0)
    v_bitop3_b32 v75, v75, v79, s68 bitop3:0x7e
    v_bitop3_b32 v75, v75, v83, s68 bitop3:0xf6
    v_cmp_ne_u32 vcc, 0, v75
    s_cbranch_vccz L_xo_z
    s_add_u32 s5, s5, 1
    s_cmp_lt_u32 s5, 100000
    s_cbranch_scc1 L_xt_z
    s_branch L_xo_z
L_rs_p3:
    s_mov_b32 s5, 0
L_rt_p3:
    s_mov_b64 exec, vcc
    buffer_load_dword v189, v188, s[44:47], 0 offen sc1
    s_waitcnt vmcnt(0)
    v_cmp_ne_u32 vcc, s68, v189
    s_cbranch_vccz L_rx_p3
    s_add_u32 s5, s5, 1
    s_cmp_lt_u32 s5, 100000
    s_cbranch_scc1 L_rt_p3
L_rx_p3:
    s_mov_b64 exec, -1
    s_branch L_ok_p3
L_xs_8:
    s_mov_b32 s5, 0
L_xt_8:
    v_mov_b32 v187, 0
    buffer_atomic_add v187, v137, s[44:47], 0 offen offset:12 sc0 sc1
    s_waitcnt vmcnt(0)
    v_cmp_ne_u32 vcc, v138, v187
    s_cbranch_vccz L_xr_8
    s_add_u32 s5, s5, 1
    s_cmp_lt_u32 s5, 100000
    s_cbranch_scc1 L_xt_8
L_xr_8:
    buffer_load_dwordx4 v[204:207], v136, s[44:47], s35 offen offset:0 sc1
    buffer_load_dwordx4 v[208:211], v136, s[44:47], s35 offen offset:1024 sc1
    buffer_load_dwordx4 v[212:215], v136, s[44:47], s35 offen offset:2048 sc1
    buffer_load_dwordx4 v[216:219], v136, s[44:47], s35 offen offset:3072 sc1
    s_waitcnt vmcnt(0)
    v_bitop3_b32 v207, v207, v211, s36 bitop3:0x7e
    v_bitop3_b32 v207, v207, v215, s36 bitop3:0xf6
    v_bitop3_b32 v207, v207, v219, s36 bitop3:0xf6
    v_cmp_ne_u32 vcc, 0, v207
    s_cbranch_vccz L_xo_8
    s_add_u32 s5, s5, 1
    s_cmp_lt_u32 s5, 100000
    s_cbranch_scc1 L_xt_8
    s_branch L_xo_8
L_rs_p2X:
    s_mov_b32 s5, 0
L_rt_p2X:
    s_mov_b64 exec, vcc
    v_mov_b32 v29, 0
    buffer_atomic_add v29, v28, s[44:47], 0 offen sc0 sc1
    s_waitcnt vmcnt(0)
    v_cmp_ne_u32 vcc, v13, v29
    s_cbranch_vccz L_rx_p2X
    s_add_u32 s5, s5, 1
    s_cmp_lt_u32 s5, 100000
    s_cbranch_scc1 L_rt_p2X
L_rx_p2X:
    s_mov_b64 exec, -1
    s_branch L_ok_p2X
L_wc_G:
    s_cmp_eq_u32 s3, 0
    s_cbranch_scc1 L_pl_G_0
    s_cmp_eq_u32 s3, 1
    s_cbranch_scc1 L_pl_G_1
    s_cmp_eq_u32 s3, 2
    s_cbranch_scc1 L_pl_G_2
    s_branch L_pl_G_3
L_wc_X:
    s_cmp_eq_u32 s3, 0
    s_cbranch_scc1 L_pl_X_0
    s_cmp_eq_u32 s3, 1
    s_cbranch_scc1 L_pl_X_1
    s_cmp_eq_u32 s3, 2
    s_cbranch_scc1 L_pl_X_2
    s_branch L_pl_X_3
L_wc_D:
    s_cmp_eq_u32 s3, 0
    s_cbranch_scc1 L_pl_D_0
    s_cmp_eq_u32 s3, 1
    s_cbranch_scc1 L_pl_D_1
    s_cmp_eq_u32 s3, 2
    s_cbranch_scc1 L_pl_D_2
    s_branch L_wret
L_wret:
    s_setpc_b64 s[82:83]
.p2align 12
L_org:
    s_mul_i32 s7, s6, 21846
    s_lshr_b32 s7, s7, 16
    s_mul_i32 s8, s7, 3
    s_sub_u32 s12, s6, s8
    s_mul_i32 s8, s13, 9
    s_add_u32 s69, s8, s7
    s_lshl1_add_u32 s70, s12, s4
    s_mul_i32 s8, s69, 6
    s_add_u32 s75, s8, s70
    s_mov_b32 s48, s30
    s_and_b32 s49, s31, 0xffff
    s_mov_b32 s50, 18874368
    s_mov_b32 s51, 0x20000
    s_add_u32 s12, s12, s7
    s_mul_i32 s8, s12, 21846
    s_lshr_b32 s8, s8, 16
    s_mul_i32 s8, s8, 3
    s_sub_u32 s12, s12, s8
    s_mul_i32 s4, s4, 16
    s_mul_i32 s7, s12, 65538
    s_lshr_b32 s7, s7, 16
    s_mul_i32 s7, s7, 1
    s_add_u32 s5, s4, 0
    s_add_u32 s18, s7, s5
    s_add_u32 s8, s5, 3
    s_add_u32 s19, s18, 1
    s_cmp_eq_u32 s19, s8
    s_cselect_b32 s19, s5, s19
    s_add_u32 s20, s19, 1
    s_cmp_eq_u32 s20, s8
    s_cselect_b32 s20, s5, s20
    s_mul_i32 s7, s12, 65538
    s_lshr_b32 s7, s7, 16
    s_mul_i32 s7, s7, 1
    s_add_u32 s5, s4, 3
    s_add_u32 s21, s7, s5
    s_add_u32 s8, s5, 3
    s_add_u32 s22, s21, 1
    s_cmp_eq_u32 s22, s8
    s_cselect_b32 s22, s5, s22
    s_add_u32 s23, s22, 1
    s_cmp_eq_u32 s23, s8
    s_cselect_b32 s23, s5, s23
    s_mul_i32 s7, s12, 87384
    s_lshr_b32 s7, s7, 16
    s_mul_i32 s7, s7, 1
    s_add_u32 s5, s4, 6
    s_add_u32 s24, s7, s5
    s_add_u32 s8, s5, 4
    s_add_u32 s25, s24, 1
    s_cmp_eq_u32 s25, s8
    s_cselect_b32 s25, s5, s25
    s_add_u32 s26, s25, 1
    s_cmp_eq_u32 s26, s8
    s_cselect_b32 s26, s5, s26
    s_add_u32 s27, s26, 1
    s_cmp_eq_u32 s27, s8
    s_cselect_b32 s27, s5, s27
    s_mul_i32 s7, s12, 131076
    s_lshr_b32 s7, s7, 16
    s_mul_i32 s7, s7, 1
    s_add_u32 s5, s4, 10
    s_add_u32 s76, s7, s5
    s_add_u32 s8, s5, 6
    s_add_u32 s77, s76, 1
    s_cmp_eq_u32 s77, s8
    s_cselect_b32 s77, s5, s77
    s_add_u32 s78, s77, 1
    s_cmp_eq_u32 s78, s8
    s_cselect_b32 s78, s5, s78
    s_add_u32 s79, s78, 1
    s_cmp_eq_u32 s79, s8
    s_cselect_b32 s79, s5, s79
    s_add_u32 s80, s79, 1
    s_cmp_eq_u32 s80, s8
    s_cselect_b32 s80, s5, s80
    s_add_u32 s81, s80, 1
    s_cmp_eq_u32 s81, s8
    s_cselect_b32 s81, s5, s81
    v_lshrrev_b32 v24, 4, v2
    v_and_b32 v25, 15, v2
    v_lshlrev_b32 v26, 1, v24
    v_xor_b32 v25, v25, v26
    v_mul_u32_u24 v24, 9216, v24
    v_lshl_add_u32 v24, v25, 4, v24
    s_mul_i32 s7, s3, 147456
    s_lshl_b32 s8, s69, 8
    s_add_u32 s7, s7, s8
    v_add_u32 v148, s7, v24
    v_add_u32 v149, 35840, v148
    v_xor_b32 v24, 128, v148
    v_add_u32 v150, 71680, v24
    v_add_u32 v151, 35840, v150
    s_mov_b32 s9, 144896
    s_mov_b32 s11, 114688
    v_mul_u32_u24 v48, 1216, v3
    v_mad_u32_u24 v48, v4, 12, v48
    v_add_u32 v48, s9, v48
    v_mov_b32 v47, 0x40000000
    v_lshlrev_b32 v3, 3, v3
    s_lshl_b32 s5, s68, 6
    s_add_u32 s5, s5, 12386304
    v_cmp_eq_u32 vcc, 0, v4
    s_nop 1
    v_cndmask_b32 v49, v47, v3, vcc
    v_lshrrev_b32 v5, 4, v0
    v_and_b32 v4, 3, v2
    v_lshlrev_b32 v4, 3, v4
    v_lshl_add_u32 v5, v5, 5, v4
    v_bfe_u32 v6, v2, 2, 2
    v_mul_u32_u24 v4, 1216, v6
    v_mul_u32_u24 v6, 1152, v6
    v_add3_u32 v50, v4, v5, s9
    v_add3_u32 v51, v6, v5, s11
    s_mul_i32 s4, s3, 2176
    v_add_u32 v55, s4, v51
    v_lshlrev_b32 v52, 4, v0
    s_add_u32 s7, s15, 4096
    s_add_u32 s8, s15, 8192
    s_cmp_eq_u32 s3, 0
    s_cselect_b32 s8, s8, 0x40000000
    v_add_u32 v53, 2359296, v52
    v_mov_b32 v54, 0
    v_add_u32 v4, 0, v52
    v_lshrrev_b32 v5, 7, v4
    v_mul_u32_u24 v6, 9363, v5
    v_lshrrev_b32 v6, 16, v6
    v_mad_i32_i24 v5, v6, -7, v5
    v_cmp_lt_u32 vcc, 2, v5
    s_nop 1
    v_addc_co_u32 v6, vcc, 0, v6, vcc
    v_lshl_add_u32 v93, v6, 7, v4
    v_add_u32 v4, 4096, v52
    v_lshrrev_b32 v5, 7, v4
    v_mul_u32_u24 v6, 9363, v5
    v_lshrrev_b32 v6, 16, v6
    v_mad_i32_i24 v5, v6, -7, v5
    v_cmp_lt_u32 vcc, 2, v5
    s_nop 1
    v_addc_co_u32 v6, vcc, 0, v6, vcc
    v_lshl_add_u32 v94, v6, 7, v4
    v_add_u32 v4, 8192, v52
    v_lshrrev_b32 v5, 7, v4
    v_mul_u32_u24 v6, 9363, v5
    v_lshrrev_b32 v6, 16, v6
    v_mad_i32_i24 v5, v6, -7, v5
    v_cmp_lt_u32 vcc, 2, v5
    s_nop 1
    v_addc_co_u32 v6, vcc, 0, v6, vcc
    v_lshl_add_u32 v95, v6, 7, v4
    s_mul_i32 s10, s68, 11264
    s_add_u32 s10, s10, 36585472
    s_cmp_eq_u32 s3, 0
    s_cselect_b32 s83, s10, 0x40000000
    s_add_u32 s7, s10, 2883584
    s_add_u32 s8, s83, 2883584
    s_mul_i32 s4, s3, 1028
    s_sub_u32 s4, 8204, s4
    v_add_u32 v90, s4, v53
    s_bfe_u32 s6, s68, 0x20001
    s_lshl_b32 s6, s6, 6
    s_lshr_b32 s9, s68, 3
    s_lshl1_add_u32 s6, s9, s6
    s_and_b32 s9, s68, 1
    s_add_u32 s6, s6, s9
    s_lshl_b32 s4, s6, 2
    s_add_u32 s4, s4, 12533760
    v_lshl_add_u32 v1, v0, 10, s4
    s_lshl_b32 s4, s68, 2
    s_add_u32 s4, s4, 12599296
    v_lshl_add_u32 v46, v0, 10, s4
    v_cmp_gt_u32 vcc, 8, v0
    s_nop 1
    v_cndmask_b32 v1, v47, v1, vcc
    v_cmp_gt_u32 vcc, 4, v0
    s_nop 1
    v_cndmask_b32 v46, v47, v46, vcc
    s_waitcnt vmcnt(9)
    v_and_b32 v21, 0xffff0000, v8
    s_add_u32 m0, s73, 81920
    s_mul_i32 s14, s18, 589824
    buffer_load_dwordx4 v148, s[48:51], s14 offen offset:0 lds
    v_lshlrev_b32 v20, 16, v8
    v_and_b32 v23, 0xffff0000, v9
    v_lshlrev_b32 v22, 16, v9
    v_and_b32 v25, 0xffff0000, v10
    v_lshlrev_b32 v24, 16, v10
    v_and_b32 v27, 0xffff0000, v12
    v_lshlrev_b32 v26, 16, v12
    v_and_b32 v29, 0xffff0000, v13
    v_lshlrev_b32 v28, 16, v13
    v_and_b32 v31, 0xffff0000, v14
    v_lshlrev_b32 v30, 16, v14
    v_and_b32 v33, 0xffff0000, v16
    v_lshlrev_b32 v32, 16, v16
    v_and_b32 v35, 0xffff0000, v17
    v_lshlrev_b32 v34, 16, v17
    v_and_b32 v37, 0xffff0000, v18
    v_lshlrev_b32 v36, 16, v18
    v_pk_add_f32 v[38:39], v[20:21], v[22:23]
    v_pk_add_f32 v[40:41], v[24:25], v[26:27]
    v_pk_add_f32 v[42:43], v[28:29], v[30:31]
    v_pk_add_f32 v[44:45], v[32:33], v[34:35]
    v_pk_add_f32 v[38:39], v[38:39], v[40:41]
    v_pk_add_f32 v[42:43], v[42:43], v[44:45]
    v_pk_add_f32 v[38:39], v[38:39], v[36:37]
    v_pk_add_f32 v[38:39], v[38:39], v[42:43]
    v_add_f32 v56, v38, v39
    buffer_load_dwordx4 v149, s[48:51], s14 offen offset:1024 lds
    s_nop 0
    v_add_f32_dpp v56, v56, v56 row_ror:8 row_mask:0xf bank_mask:0xf
    s_nop 1
    v_add_f32_dpp v56, v56, v56 row_ror:4 row_mask:0xf bank_mask:0xf
    s_nop 1
    v_add_f32_dpp v56, v56, v56 row_ror:2 row_mask:0xf bank_mask:0xf
    s_nop 1
    v_add_f32_dpp v56, v56, v56 row_ror:1 row_mask:0xf bank_mask:0xf
    v_mov_b32 v57, v56
    s_nop 1
    v_permlane16_swap_b32 v56, v57
    v_add_f32 v56, v56, v57
    v_mul_f32 v56, 0x3ae38e39, v56
    v_pk_add_f32 v[20:21], v[20:21], v[56:57] op_sel_hi:[1,0] neg_lo:[0,1] neg_hi:[0,1]
    v_pk_add_f32 v[22:23], v[22:23], v[56:57] op_sel_hi:[1,0] neg_lo:[0,1] neg_hi:[0,1]
    v_pk_add_f32 v[24:25], v[24:25], v[56:57] op_sel_hi:[1,0] neg_lo:[0,1] neg_hi:[0,1]
    v_pk_add_f32 v[26:27], v[26:27], v[56:57] op_sel_hi:[1,0] neg_lo:[0,1] neg_hi:[0,1]
    v_pk_add_f32 v[28:29], v[28:29], v[56:57] op_sel_hi:[1,0] neg_lo:[0,1] neg_hi:[0,1]
    v_pk_add_f32 v[30:31], v[30:31], v[56:57] op_sel_hi:[1,0] neg_lo:[0,1] neg_hi:[0,1]
    v_pk_add_f32 v[32:33], v[32:33], v[56:57] op_sel_hi:[1,0] neg_lo:[0,1] neg_hi:[0,1]
    v_pk_add_f32 v[34:35], v[34:35], v[56:57] op_sel_hi:[1,0] neg_lo:[0,1] neg_hi:[0,1]
    v_pk_add_f32 v[36:37], v[36:37], v[56:57] op_sel_hi:[1,0] neg_lo:[0,1] neg_hi:[0,1]
    v_pk_mul_f32 v[38:39], v[20:21], v[20:21]
    v_pk_mul_f32 v[40:41], v[22:23], v[22:23]
    v_pk_fma_f32 v[38:39], v[24:25], v[24:25], v[38:39]
    v_pk_fma_f32 v[40:41], v[26:27], v[26:27], v[40:41]
    v_pk_fma_f32 v[38:39], v[28:29], v[28:29], v[38:39]
    v_pk_fma_f32 v[40:41], v[30:31], v[30:31], v[40:41]
    v_pk_fma_f32 v[38:39], v[32:33], v[32:33], v[38:39]
    v_pk_fma_f32 v[40:41], v[34:35], v[34:35], v[40:41]
    v_pk_fma_f32 v[38:39], v[36:37], v[36:37], v[38:39]
    buffer_load_dwordx4 v150, s[48:51], s14 offen offset:2048 lds
    v_pk_add_f32 v[38:39], v[38:39], v[40:41]
    v_add_f32 v18, v38, v39
    s_nop 1
    v_add_f32_dpp v18, v18, v18 row_ror:8 row_mask:0xf bank_mask:0xf
    s_nop 1
    v_add_f32_dpp v18, v18, v18 row_ror:4 row_mask:0xf bank_mask:0xf
    s_nop 1
    v_add_f32_dpp v18, v18, v18 row_ror:2 row_mask:0xf bank_mask:0xf
    s_nop 1
    v_add_f32_dpp v18, v18, v18 row_ror:1 row_mask:0xf bank_mask:0xf
    v_mov_b32 v19, v18
    s_nop 1
    v_permlane16_swap_b32 v18, v19
    v_add_f32 v18, v18, v19
    v_mul_f32 v18, 0x3ae38e39, v18
    v_cvt_pk_bf16_f32 v38, v56, v18
    v_lshlrev_b32 v106, 16, v38
    v_and_b32 v38, 0xffff0000, v38
    v_add_f32 v38, 0x3727c5ac, v38
    v_sub_f32 v56, v56, v106
    v_cvt_pk_bf16_f32 v38, v38, v38
    v_lshlrev_b32 v38, 16, v38
    v_sqrt_f32 v38, v38
    s_nop 0
    v_cvt_pk_bf16_f32 v38, v38, v38
    v_lshlrev_b32 v38, 16, v38
    v_rcp_f32 v107, v38
    s_nop 0
    v_mul_f32 v56, v56, v107
    v_mul_f32 v18, v18, v107
    v_mul_f32 v18, v18, v107
    v_cvt_pk_bf16_f32 v38, v56, v18
    v_lshlrev_b32 v39, 16, v38
    buffer_load_dwordx4 v151, s[48:51], s14 offen offset:3072 lds
    v_and_b32 v38, 0xffff0000, v38
    v_add_f32 v38, 0x3727c5ac, v38
    v_sub_f32 v56, v56, v39
    v_cvt_pk_bf16_f32 v38, v38, v38
    v_lshlrev_b32 v38, 16, v38
    v_sqrt_f32 v38, v38
    s_nop 0
    v_cvt_pk_bf16_f32 v38, v38, v38
    v_lshlrev_b32 v38, 16, v38
    v_rcp_f32 v38, v38
    s_nop 0
    v_mul_f32 v18, v107, v38
    v_mul_f32 v56, v56, v38
    v_pk_fma_f32 v[20:21], v[20:21], v[18:19], v[56:57] op_sel_hi:[1,0,0]
    v_pk_fma_f32 v[22:23], v[22:23], v[18:19], v[56:57] op_sel_hi:[1,0,0]
    v_pk_fma_f32 v[24:25], v[24:25], v[18:19], v[56:57] op_sel_hi:[1,0,0]
    v_pk_fma_f32 v[26:27], v[26:27], v[18:19], v[56:57] op_sel_hi:[1,0,0]
    v_pk_fma_f32 v[28:29], v[28:29], v[18:19], v[56:57] op_sel_hi:[1,0,0]
    v_pk_fma_f32 v[30:31], v[30:31], v[18:19], v[56:57] op_sel_hi:[1,0,0]
    v_pk_fma_f32 v[32:33], v[32:33], v[18:19], v[56:57] op_sel_hi:[1,0,0]
    v_pk_fma_f32 v[34:35], v[34:35], v[18:19], v[56:57] op_sel_hi:[1,0,0]
    v_pk_fma_f32 v[36:37], v[36:37], v[18:19], v[56:57] op_sel_hi:[1,0,0]
    v_cvt_pk_bf16_f32 v8, v20, v21
    v_cvt_pk_bf16_f32 v9, v22, v23
    v_cvt_pk_bf16_f32 v10, v24, v25
    v_cvt_pk_bf16_f32 v11, v26, v27
    v_cvt_pk_bf16_f32 v12, v28, v29
    v_cvt_pk_bf16_f32 v13, v30, v31
    v_cvt_pk_bf16_f32 v14, v32, v33
    v_cvt_pk_bf16_f32 v15, v34, v35
    v_cvt_pk_bf16_f32 v16, v36, v37
    ds_write_b32 v48, v8 offset:0
    ds_write_b32 v48, v9 offset:4
    ds_write_b32 v48, v10 offset:8
    ds_write_b32 v48, v11 offset:384
    ds_write_b32 v48, v12 offset:388
    ds_write_b32 v48, v13 offset:392
    ds_write_b32 v48, v14 offset:768
    ds_write_b32 v48, v15 offset:772
    ds_write_b32 v48, v16 offset:776
    buffer_store_dwordx2 v[106:107], v49, s[44:47], s5 offen sc1
    s_waitcnt lgkmcnt(0)
    s_barrier
    ds_read_b64_tr_b16 v[20:21], v50 offset:0
    ds_read_b64_tr_b16 v[22:23], v50 offset:4864
    ds_read_b64_tr_b16 v[24:25], v50 offset:512
    ds_read_b64_tr_b16 v[26:27], v50 offset:5376
    ds_read_b64_tr_b16 v[28:29], v50 offset:1024
    ds_read_b64_tr_b16 v[30:31], v50 offset:5888
    s_waitcnt lgkmcnt(4)
    buffer_store_dwordx4 v[20:23], v93, s[44:47], s10 offen sc1
    s_waitcnt lgkmcnt(2)
    buffer_store_dwordx4 v[24:27], v94, s[44:47], s10 offen sc1
    s_waitcnt lgkmcnt(0)
    buffer_store_dwordx4 v[28:31], v95, s[44:47], s83 offen sc1
    buffer_load_dword v45, v54, s[64:67], 0 offen sc1
    s_waitcnt vmcnt(9)
    s_barrier
    ds_read_b64_tr_b16 v[60:61], v51 offset:0
    ds_read_b64_tr_b16 v[62:63], v51 offset:4608
    ds_read_b64_tr_b16 v[64:65], v51 offset:9216
    ds_read_b64_tr_b16 v[66:67], v51 offset:12672
    ds_read_b64_tr_b16 v[68:69], v51 offset:17280
    ds_read_b64_tr_b16 v[70:71], v51 offset:512
    ds_read_b64_tr_b16 v[72:73], v51 offset:5120
    ds_read_b64_tr_b16 v[74:75], v51 offset:9728
    ds_read_b64_tr_b16 v[76:77], v51 offset:13184
    ds_read_b64_tr_b16 v[78:79], v51 offset:17792
    v_alignbit_b32 v114, v99, v99, 16
    v_alignbit_b32 v115, v98, v98, 16
    s_waitcnt lgkmcnt(5)
    v_alignbit_b32 v108, v61, v60, 16
    v_alignbit_b32 v109, v62, v61, 16
    v_alignbit_b32 v110, v63, v62, 16
    v_alignbit_b32 v111, v64, v63, 16
    v_alignbit_b32 v112, v65, v64, 16
    v_dot2_f32_bf16 v116, v60, v114, 0
    ds_read_b64_tr_b16 v[80:81], v51 offset:1024
    v_dot2_f32_bf16 v117, v108, v114, 0
    v_dot2_f32_bf16 v118, v61, v114, 0
    v_dot2_f32_bf16 v119, v109, v114, 0
    v_dot2_f32_bf16 v120, v62, v114, 0
    ds_read_b64_tr_b16 v[82:83], v51 offset:5632
    v_dot2_f32_bf16 v121, v110, v114, 0
    v_dot2_f32_bf16 v122, v63, v114, 0
    v_dot2_f32_bf16 v123, v111, v114, 0
    v_dot2_f32_bf16 v116, v61, v115, v116
    v_dot2_f32_bf16 v117, v109, v115, v117
    ds_read_b64_tr_b16 v[84:85], v51 offset:10240
    v_dot2_f32_bf16 v118, v62, v115, v118
    v_dot2_f32_bf16 v119, v110, v115, v119
    v_dot2_f32_bf16 v120, v63, v115, v120
    v_dot2_f32_bf16 v121, v111, v115, v121
    v_dot2_f32_bf16 v122, v64, v115, v122
    ds_read_b64_tr_b16 v[86:87], v51 offset:13696
    v_dot2_f32_bf16 v123, v112, v115, v123
    v_and_b32 v133, 0xffff0000, v66
    v_lshlrev_b32 v132, 16, v66
    v_and_b32 v135, 0xffff0000, v67
    v_lshlrev_b32 v134, 16, v67
    ds_read_b64_tr_b16 v[88:89], v51 offset:18304
    v_and_b32 v137, 0xffff0000, v68
    v_lshlrev_b32 v136, 16, v68
    v_and_b32 v139, 0xffff0000, v69
    v_lshlrev_b32 v138, 16, v69
    v_pk_mul_f32 v[116:117], v[116:117], v[132:133]
    v_pk_mul_f32 v[118:119], v[118:119], v[134:135]
    v_pk_mul_f32 v[120:121], v[120:121], v[136:137]
    v_pk_mul_f32 v[122:123], v[122:123], v[138:139]
    v_cvt_pk_bf16_f32 v160, v123, v122
    v_cvt_pk_bf16_f32 v161, v121, v120
    v_cvt_pk_bf16_f32 v162, v119, v118
    v_cvt_pk_bf16_f32 v163, v117, v116
    buffer_store_dwordx4 v[160:163], v93, s[44:47], s7 offen sc1
    v_alignbit_b32 v114, v101, v101, 16
    v_alignbit_b32 v115, v100, v100, 16
    s_waitcnt lgkmcnt(5)
    v_alignbit_b32 v108, v71, v70, 16
    v_alignbit_b32 v109, v72, v71, 16
    v_alignbit_b32 v110, v73, v72, 16
    v_alignbit_b32 v111, v74, v73, 16
    v_alignbit_b32 v112, v75, v74, 16
    v_dot2_f32_bf16 v124, v70, v114, 0
    v_dot2_f32_bf16 v125, v108, v114, 0
    v_dot2_f32_bf16 v126, v71, v114, 0
    v_dot2_f32_bf16 v127, v109, v114, 0
    v_dot2_f32_bf16 v128, v72, v114, 0
    v_dot2_f32_bf16 v129, v110, v114, 0
    v_dot2_f32_bf16 v130, v73, v114, 0
    v_dot2_f32_bf16 v131, v111, v114, 0
    v_dot2_f32_bf16 v124, v71, v115, v124
    v_dot2_f32_bf16 v125, v109, v115, v125
    v_dot2_f32_bf16 v126, v72, v115, v126
    v_dot2_f32_bf16 v127, v110, v115, v127
    v_dot2_f32_bf16 v128, v73, v115, v128
    v_dot2_f32_bf16 v129, v111, v115, v129
    v_dot2_f32_bf16 v130, v74, v115, v130
    v_dot2_f32_bf16 v131, v112, v115, v131
    v_and_b32 v133, 0xffff0000, v76
    v_lshlrev_b32 v132, 16, v76
    v_and_b32 v135, 0xffff0000, v77
    v_lshlrev_b32 v134, 16, v77
    v_and_b32 v137, 0xffff0000, v78
    v_lshlrev_b32 v136, 16, v78
    v_and_b32 v139, 0xffff0000, v79
    v_lshlrev_b32 v138, 16, v79
    v_pk_mul_f32 v[124:125], v[124:125], v[132:133]
    v_pk_mul_f32 v[126:127], v[126:127], v[134:135]
    v_pk_mul_f32 v[128:129], v[128:129], v[136:137]
    v_pk_mul_f32 v[130:131], v[130:131], v[138:139]
    v_cvt_pk_bf16_f32 v164, v131, v130
    v_cvt_pk_bf16_f32 v165, v129, v128
    v_cvt_pk_bf16_f32 v166, v127, v126
    v_cvt_pk_bf16_f32 v167, v125, v124
    buffer_store_dwordx4 v[164:167], v94, s[44:47], s7 offen sc1
    v_alignbit_b32 v114, v103, v103, 16
    v_alignbit_b32 v115, v102, v102, 16
    s_waitcnt lgkmcnt(0)
    v_alignbit_b32 v108, v81, v80, 16
    v_alignbit_b32 v109, v82, v81, 16
    v_alignbit_b32 v110, v83, v82, 16
    v_alignbit_b32 v111, v84, v83, 16
    v_alignbit_b32 v112, v85, v84, 16
    v_dot2_f32_bf16 v116, v80, v114, 0
    v_dot2_f32_bf16 v117, v108, v114, 0
    v_dot2_f32_bf16 v118, v81, v114, 0
    v_dot2_f32_bf16 v119, v109, v114, 0
    v_dot2_f32_bf16 v120, v82, v114, 0
    v_dot2_f32_bf16 v121, v110, v114, 0
    v_dot2_f32_bf16 v122, v83, v114, 0
    v_dot2_f32_bf16 v123, v111, v114, 0
    v_dot2_f32_bf16 v116, v81, v115, v116
    v_dot2_f32_bf16 v117, v109, v115, v117
    v_dot2_f32_bf16 v118, v82, v115, v118
    v_dot2_f32_bf16 v119, v110, v115, v119
    v_dot2_f32_bf16 v120, v83, v115, v120
    v_dot2_f32_bf16 v121, v111, v115, v121
    v_dot2_f32_bf16 v122, v84, v115, v122
    v_dot2_f32_bf16 v123, v112, v115, v123
    v_and_b32 v133, 0xffff0000, v86
    v_lshlrev_b32 v132, 16, v86
    v_and_b32 v135, 0xffff0000, v87
    v_lshlrev_b32 v134, 16, v87
    v_and_b32 v137, 0xffff0000, v88
    v_lshlrev_b32 v136, 16, v88
    v_and_b32 v139, 0xffff0000, v89
    v_lshlrev_b32 v138, 16, v89
    v_pk_mul_f32 v[116:117], v[116:117], v[132:133]
    v_pk_mul_f32 v[118:119], v[118:119], v[134:135]
    v_pk_mul_f32 v[120:121], v[120:121], v[136:137]
    v_pk_mul_f32 v[122:123], v[122:123], v[138:139]
    v_cvt_pk_bf16_f32 v168, v123, v122
    v_cvt_pk_bf16_f32 v169, v121, v120
    v_cvt_pk_bf16_f32 v170, v119, v118
    v_cvt_pk_bf16_f32 v171, v117, v116
    buffer_store_dwordx4 v[168:171], v95, s[44:47], s8 offen sc1
    s_add_u32 m0, s73, 98304
    s_mul_i32 s14, s19, 589824
    buffer_load_dwordx4 v148, s[48:51], s14 offen offset:0 lds
    buffer_load_dwordx4 v149, s[48:51], s14 offen offset:1024 lds
    buffer_load_dwordx4 v150, s[48:51], s14 offen offset:2048 lds
    buffer_load_dwordx4 v151, s[48:51], s14 offen offset:3072 lds
    s_add_u32 m0, s73, 0
    s_mul_i32 s14, s20, 589824
    buffer_load_dwordx4 v148, s[48:51], s14 offen offset:0 lds
    buffer_load_dwordx4 v149, s[48:51], s14 offen offset:1024 lds
    buffer_load_dwordx4 v150, s[48:51], s14 offen offset:2048 lds
    buffer_load_dwordx4 v151, s[48:51], s14 offen offset:3072 lds
    s_add_u32 m0, s73, 16384
    s_mul_i32 s14, s21, 589824
    buffer_load_dwordx4 v148, s[48:51], s14 offen offset:0 lds
    buffer_load_dwordx4 v149, s[48:51], s14 offen offset:1024 lds
    s_waitcnt vmcnt(13)
    v_readfirstlane_b32 s68, v45
    s_nop 1
    s_cmp_eq_u32 s68, 0
    s_cbranch_scc1 L_nw_G
L_ng_G:
    s_barrier
    v_mov_b32 v3, s68
    buffer_store_dword v3, v1, s[44:47], 0 offen sc1
    s_mov_b64 exec, 0
    s_call_b64 s[82:83], L_wc_G
    s_mov_b64 exec, -1
    s_waitcnt vmcnt(11)
    s_barrier
    buffer_store_dword v3, v46, s[44:47], 0 offen sc1
L_segG:
L_pl_G_0:
    s_cbranch_execz L_pl_G_4
    buffer_load_dwordx4 v150, s[48:51], s14 offen offset:2048 lds
    buffer_load_dwordx4 v151, s[48:51], s14 offen offset:3072 lds
    s_add_u32 m0, s73, 32768
    s_mul_i32 s14, s22, 589824
    buffer_load_dwordx4 v148, s[48:51], s14 offen offset:0 lds
    buffer_load_dwordx4 v149, s[48:51], s14 offen offset:1024 lds
    buffer_load_dwordx4 v150, s[48:51], s14 offen offset:2048 lds
    buffer_load_dwordx4 v151, s[48:51], s14 offen offset:3072 lds
    s_add_u32 m0, s73, 49152
    s_mul_i32 s14, s23, 589824
    buffer_load_dwordx4 v148, s[48:51], s14 offen offset:0 lds
    buffer_load_dwordx4 v149, s[48:51], s14 offen offset:1024 lds
    buffer_load_dwordx4 v150, s[48:51], s14 offen offset:2048 lds
    buffer_load_dwordx4 v151, s[48:51], s14 offen offset:3072 lds
    s_add_u32 m0, s73, 65536
    s_mul_i32 s14, s24, 589824
    buffer_load_dwordx4 v148, s[48:51], s14 offen offset:0 lds
    buffer_load_dwordx4 v149, s[48:51], s14 offen offset:1024 lds
    buffer_load_dwordx4 v150, s[48:51], s14 offen offset:2048 lds
    buffer_load_dwordx4 v151, s[48:51], s14 offen offset:3072 lds
    v_bfe_u32 v140, v2, 2, 2
    v_lshrrev_b32 v141, 4, v2
    v_lshl_add_u32 v142, v141, 3, v140
    v_lshlrev_b32 v142, 8, v142
    v_and_b32 v143, 3, v2
    v_lshl_add_u32 v142, v143, 3, v142
    v_and_b32 v141, 1, v141
    v_lshl_add_u32 v140, v141, 2, v140
    s_lshl_b32 s7, s3, 1
    v_xor_b32 v140, s7, v140
    v_lshl_add_u32 v152, v140, 5, v142
    v_xor_b32 v153, 32, v152
    v_add_u32 v154, 0x10000, v152
    v_add_u32 v155, 0x10000, v153
    v_and_b32 v24, 15, v2
    v_lshrrev_b32 v25, 4, v2
    v_mul_u32_u24 v26, 17408, v25
    v_lshl_add_u32 v26, v24, 4, v26
    v_mul_u32_u24 v25, 1536, v25
    v_lshl_add_u32 v25, v24, 4, v25
    v_add_u32 v159, 81920, v25
    v_add_u32 v250, 36864, v159
    s_mul_i32 s7, s3, 18432
    s_xor_b32 s8, s70, 1
    s_mul_i32 s8, s8, 1536
    s_add_u32 s7, s7, s8
    v_lshlrev_b32 v246, 4, v2
    v_add_u32 v156, s7, v246
    v_lshrrev_b32 v25, 5, v2
    v_mul_u32_u24 v25, 7680, v25
    v_add_u32 v157, v156, v25
    v_add_u32 v158, 7680, v156
    s_mul_i32 s74, s3, 3072
    s_add_u32 s74, s74, 81920
    v_mov_b32 v245, v26
    s_mov_b64 exec, 0
    s_call_b64 s[82:83], L_wc_D
    s_mov_b64 exec, -1
    s_mov_b32 s56, s32
    s_and_b32 s57, s33, 0xffff
    s_mov_b32 s58, 9216
    s_mov_b32 s59, 0x20000
    s_mov_b32 s60, s36
    s_and_b32 s61, s37, 0xffff
    s_mov_b32 s62, 4096
    s_mov_b32 s63, 0x20000
    s_and_b32 s4, s70, 1
    s_lshl1_add_u32 s4, s3, s4
    s_lshl_b32 s4, s4, 7
    s_bfe_u32 s5, s2, 0x10003
    s_lshl1_add_u32 s5, s72, s5
    s_lshr_b32 s5, s5, 0
    s_lshl_b32 s5, s5, 10
    s_add_u32 s4, s4, s5
    s_add_u32 s4, s4, 12533760
    v_lshl_add_u32 v28, v2, 2, s4
    v_cmp_gt_u32 vcc, 32, v2
    v_mov_b32 v12, 0x40000000
    s_nop 0
    v_cndmask_b32 v28, v12, v28, vcc
    v_mov_b32 v12, s68
    v_cndmask_b32 v12, 0, v12, vcc
    v_lshrrev_b32 v24, 4, v2
    v_lshlrev_b32 v25, 3, v24
    s_lshl_b32 s7, s69, 8
    s_lshl_b32 s8, s3, 6
    s_add_u32 s7, s7, s8
    buffer_load_dwordx2 v[144:145], v25, s[56:59], s7 offen
    buffer_load_dwordx2 v[146:147], v25, s[56:59], s7 offen offset:32
    s_waitcnt vmcnt(24)
    s_barrier
    ds_read_b64_tr_b16 a[0:1], v154 offset:16384
    ds_read_b64_tr_b16 a[2:3], v154 offset:17408
    ds_read_b64_tr_b16 a[4:5], v155 offset:16384
    ds_read_b64_tr_b16 a[6:7], v155 offset:17408
    ds_read_b64_tr_b16 a[8:9], v154 offset:24576
    ds_read_b64_tr_b16 a[10:11], v154 offset:25600
    ds_read_b64_tr_b16 a[12:13], v155 offset:24576
    ds_read_b64_tr_b16 a[14:15], v155 offset:25600
    ds_read_b64_tr_b16 a[16:17], v154 offset:32768
    ds_read_b64_tr_b16 a[18:19], v154 offset:33792
    ds_read_b64_tr_b16 a[20:21], v155 offset:32768
    ds_read_b64_tr_b16 a[22:23], v155 offset:33792
    ds_read_b64_tr_b16 a[24:25], v154 offset:40960
    ds_read_b64_tr_b16 a[26:27], v154 offset:41984
    ds_read_b64_tr_b16 a[28:29], v155 offset:40960
    ds_read_b64_tr_b16 a[30:31], v155 offset:41984
    s_waitcnt vmcnt(20)
    s_barrier
    ds_read_b64_tr_b16 a[32:33], v152 offset:0
    ds_read_b64_tr_b16 a[34:35], v152 offset:1024
    ds_read_b64_tr_b16 a[36:37], v153 offset:0
    ds_read_b64_tr_b16 a[38:39], v153 offset:1024
    ds_read_b64_tr_b16 a[40:41], v152 offset:8192
    ds_read_b64_tr_b16 a[42:43], v152 offset:9216
    ds_read_b64_tr_b16 a[44:45], v153 offset:8192
    ds_read_b64_tr_b16 a[46:47], v153 offset:9216
    s_waitcnt vmcnt(14)
    s_barrier
    ds_read_b64_tr_b16 a[48:49], v152 offset:16384
    ds_read_b64_tr_b16 a[50:51], v152 offset:17408
    ds_read_b64_tr_b16 a[52:53], v153 offset:16384
    ds_read_b64_tr_b16 a[54:55], v153 offset:17408
    ds_read_b64_tr_b16 a[56:57], v152 offset:24576
    ds_read_b64_tr_b16 a[58:59], v152 offset:25600
    ds_read_b64_tr_b16 a[60:61], v153 offset:24576
    ds_read_b64_tr_b16 a[62:63], v153 offset:25600
    v_mov_b32 v29, 0
    buffer_atomic_add v29, v28, s[44:47], 0 offen sc0 sc1
    s_waitcnt vmcnt(11)
    s_barrier
    ds_read_b64_tr_b16 a[64:65], v152 offset:32768
    ds_read_b64_tr_b16 a[66:67], v152 offset:33792
    ds_read_b64_tr_b16 a[68:69], v153 offset:32768
    ds_read_b64_tr_b16 a[70:71], v153 offset:33792
    ds_read_b64_tr_b16 a[72:73], v152 offset:40960
    ds_read_b64_tr_b16 a[74:75], v152 offset:41984
    ds_read_b64_tr_b16 a[76:77], v153 offset:40960
    ds_read_b64_tr_b16 a[78:79], v153 offset:41984
L_pl_G_1:
    s_cbranch_execz L_pl_G_5
    s_waitcnt lgkmcnt(0)
    s_barrier
    s_xor_b32 s8, s70, 1
    s_mul_i32 s8, s8, 1536
    s_mul_i32 s7, s3, 22528
    s_add_u32 s7, s7, 36585472
    v_add_u32 v24, 0, v246
    v_cmp_lt_u32 vcc, 1535, v24
    s_nop 1
    v_cndmask_b32 v25, 0, 1, vcc
    v_mul_u32_u24 v30, 1536, v25
    v_sub_u32 v24, v24, v30
    v_add_u32 v24, s8, v24
    v_lshrrev_b32 v30, 7, v24
    v_mul_u32_u24 v31, 9363, v30
    v_lshrrev_b32 v31, 16, v31
    v_mad_i32_i24 v30, v31, -7, v30
    v_cmp_lt_u32 vcc, 2, v30
    s_nop 1
    v_addc_co_u32 v31, vcc, 0, v31, vcc
    v_lshl_add_u32 v24, v31, 7, v24
    v_mul_u32_u24 v25, 11264, v25
    v_add3_u32 v24, v24, v25, s7
    v_subrev_u32 v156, 0, v24
    v_add_u32 v24, 1024, v246
    v_cmp_lt_u32 vcc, 1535, v24
    s_nop 1
    v_cndmask_b32 v25, 0, 1, vcc
    v_mul_u32_u24 v30, 1536, v25
    v_sub_u32 v24, v24, v30
    v_add_u32 v24, s8, v24
    v_lshrrev_b32 v30, 7, v24
    v_mul_u32_u24 v31, 9363, v30
    v_lshrrev_b32 v31, 16, v31
    v_mad_i32_i24 v30, v31, -7, v30
    v_cmp_lt_u32 vcc, 2, v30
    s_nop 1
    v_addc_co_u32 v31, vcc, 0, v31, vcc
    v_lshl_add_u32 v24, v31, 7, v24
    v_mul_u32_u24 v25, 11264, v25
    v_add3_u32 v24, v24, v25, s7
    v_subrev_u32 v157, 1024, v24
    v_add_u32 v24, 2048, v246
    v_cmp_lt_u32 vcc, 1535, v24
    s_nop 1
    v_cndmask_b32 v25, 0, 1, vcc
    v_mul_u32_u24 v30, 1536, v25
    v_sub_u32 v24, v24, v30
    v_add_u32 v24, s8, v24
    v_lshrrev_b32 v30, 7, v24
    v_mul_u32_u24 v31, 9363, v30
    v_lshrrev_b32 v31, 16, v31
    v_mad_i32_i24 v30, v31, -7, v30
    v_cmp_lt_u32 vcc, 2, v30
    s_nop 1
    v_addc_co_u32 v31, vcc, 0, v31, vcc
    v_lshl_add_u32 v24, v31, 7, v24
    v_mul_u32_u24 v25, 11264, v25
    v_add3_u32 v24, v24, v25, s7
    v_subrev_u32 v158, 2048, v24
    s_xor_b32 s8, s70, 0
    s_mul_i32 s8, s8, 1536
    s_mul_i32 s7, s3, 22528
    s_add_u32 s7, s7, 36585472
    v_add_u32 v24, 0, v246
    v_cmp_lt_u32 vcc, 1535, v24
    s_nop 1
    v_cndmask_b32 v25, 0, 1, vcc
    v_mul_u32_u24 v30, 1536, v25
    v_sub_u32 v24, v24, v30
    v_add_u32 v24, s8, v24
    v_lshrrev_b32 v30, 7, v24
    v_mul_u32_u24 v31, 9363, v30
    v_lshrrev_b32 v31, 16, v31
    v_mad_i32_i24 v30, v31, -7, v30
    v_cmp_lt_u32 vcc, 2, v30
    s_nop 1
    v_addc_co_u32 v31, vcc, 0, v31, vcc
    v_lshl_add_u32 v24, v31, 7, v24
    v_mul_u32_u24 v25, 11264, v25
    v_add3_u32 v24, v24, v25, s7
    v_subrev_u32 v8, 0, v24
    v_add_u32 v24, 1024, v246
    v_cmp_lt_u32 vcc, 1535, v24
    s_nop 1
    v_cndmask_b32 v25, 0, 1, vcc
    v_mul_u32_u24 v30, 1536, v25
    v_sub_u32 v24, v24, v30
    v_add_u32 v24, s8, v24
    v_lshrrev_b32 v30, 7, v24
    v_mul_u32_u24 v31, 9363, v30
    v_lshrrev_b32 v31, 16, v31
    v_mad_i32_i24 v30, v31, -7, v30
    v_cmp_lt_u32 vcc, 2, v30
    s_nop 1
    v_addc_co_u32 v31, vcc, 0, v31, vcc
    v_lshl_add_u32 v24, v31, 7, v24
    v_mul_u32_u24 v25, 11264, v25
    v_add3_u32 v24, v24, v25, s7
    v_subrev_u32 v9, 1024, v24
    v_add_u32 v24, 2048, v246
    v_cmp_lt_u32 vcc, 1535, v24
    s_nop 1
    v_cndmask_b32 v25, 0, 1, vcc
    v_mul_u32_u24 v30, 1536, v25
    v_sub_u32 v24, v24, v30
    v_add_u32 v24, s8, v24
    v_lshrrev_b32 v30, 7, v24
    v_mul_u32_u24 v31, 9363, v30
    v_lshrrev_b32 v31, 16, v31
    v_mad_i32_i24 v30, v31, -7, v30
    v_cmp_lt_u32 vcc, 2, v30
    s_nop 1
    v_addc_co_u32 v31, vcc, 0, v31, vcc
    v_lshl_add_u32 v24, v31, 7, v24
    v_mul_u32_u24 v25, 11264, v25
    v_add3_u32 v24, v24, v25, s7
    v_subrev_u32 v3, 2048, v24
    s_waitcnt vmcnt(0)
    v_cmp_ne_u32 vcc, v12, v29
    s_cbranch_vccnz L_rs_p1G
L_ok_p1G:
    s_add_u32 m0, s74, 0
    s_mul_i32 s13, s18, 90112
    buffer_load_dwordx4 v156, s[44:47], s13 offen offset:0 sc1 lds
    buffer_load_dwordx4 v157, s[44:47], s13 offen offset:1024 sc1 lds
    buffer_load_dwordx4 v158, s[44:47], s13 offen offset:2048 sc1 lds
    s_add_u32 m0, s74, 12288
    s_mul_i32 s13, s19, 90112
    buffer_load_dwordx4 v156, s[44:47], s13 offen offset:0 sc1 lds
    buffer_load_dwordx4 v157, s[44:47], s13 offen offset:1024 sc1 lds
    buffer_load_dwordx4 v158, s[44:47], s13 offen offset:2048 sc1 lds
    s_add_u32 m0, s74, 24576
    s_mul_i32 s13, s20, 90112
    buffer_load_dwordx4 v156, s[44:47], s13 offen offset:0 sc1 lds
    buffer_load_dwordx4 v157, s[44:47], s13 offen offset:1024 sc1 lds
    buffer_load_dwordx4 v158, s[44:47], s13 offen offset:2048 sc1 lds
    s_add_u32 m0, s74, 36864
    s_mul_i32 s13, s21, 90112
    buffer_load_dwordx4 v156, s[44:47], s13 offen offset:0 sc1 lds
    buffer_load_dwordx4 v157, s[44:47], s13 offen offset:1024 sc1 lds
    buffer_load_dwordx4 v158, s[44:47], s13 offen offset:2048 sc1 lds
    s_waitcnt vmcnt(9) lgkmcnt(0)
    s_barrier
    ds_read_b128 v[80:83], v159 offset:0
    ds_read_b128 v[84:87], v159 offset:6144
    ds_read_b128 v[88:91], v159 offset:256
    ds_read_b128 v[92:95], v159 offset:6400
    ds_read_b128 v[96:99], v159 offset:512
    ds_read_b128 v[100:103], v159 offset:6656
    s_waitcnt lgkmcnt(0)
    v_mfma_f32_16x16x32_bf16 v[192:195], a[0:3], v[80:83], 0
    v_mfma_f32_16x16x32_bf16 v[192:195], a[8:11], v[84:87], v[192:195]
    ds_read_b128 v[104:107], v159 offset:768
    v_mfma_f32_16x16x32_bf16 v[196:199], a[12:15], v[84:87], 0
    ds_read_b128 v[108:111], v159 offset:6912
    v_mfma_f32_16x16x32_bf16 v[196:199], a[4:7], v[80:83], v[196:199]
    ds_read_b128 v[112:115], v159 offset:1024
    v_mfma_f32_16x16x32_bf16 v[204:207], a[4:7], v[88:91], 0
    ds_read_b128 v[116:119], v159 offset:7168
    v_mfma_f32_16x16x32_bf16 v[204:207], a[12:15], v[92:95], v[204:207]
    ds_read_b128 v[120:123], v159 offset:1280
    v_mfma_f32_16x16x32_bf16 v[200:203], a[8:11], v[92:95], 0
    ds_read_b128 v[124:127], v159 offset:7424
    v_and_b32 v24, 15, v2
    s_lshl_b32 s7, s71, 6
    v_add_u32 v24, s7, v24
    s_and_b32 s8, s3, 1
    s_lshl_b32 s4, s8, 5
    v_add_u32 v25, s4, v24
    v_lshlrev_b32 v26, 3, v25
    v_mul_u32_u24 v25, 1152, v25
    v_bfe_u32 v31, v2, 4, 1
    v_lshl_add_u32 v25, v31, 5, v25
    v_lshrrev_b32 v31, 5, v2
    v_lshl_add_u32 v25, v31, 4, v25
    s_bfe_u32 s7, s2, 0x20003
    s_mul_i32 s7, s7, 288
    s_bfe_u32 s5, s2, 0x10003
    s_mul_i32 s5, s5, 32
    s_lshl_b32 s4, s72, 6
    s_add_u32 s4, s4, s7
    s_add_u32 s4, s4, s5
    s_lshl_b32 s5, s5, 3
    s_sub_u32 s7, s7, s5
    v_add_u32 v252, s4, v25
    s_xor_b32 s8, s3, s72
    s_and_b32 s4, s72, 1
    s_lshl1_add_u32 s4, s4, s8
    v_lshl_add_u32 v24, s4, 4, v24
    s_add_u32 s7, s7, 256
    s_cmp_lt_u32 s8, 2
    s_cselect_b32 s7, s7, 0x40000000
    v_lshlrev_b32 v18, 3, v24
    v_mul_u32_u24 v24, 1152, v24
    v_mfma_f32_16x16x32_bf16 v[200:203], a[0:3], v[88:91], v[200:203]
    v_mfma_f32_16x16x32_bf16 v[208:211], a[0:3], v[96:99], 0
    v_mfma_f32_16x16x32_bf16 v[208:211], a[8:11], v[100:103], v[208:211]
    v_mfma_f32_16x16x32_bf16 v[212:215], a[12:15], v[100:103], 0
    v_mfma_f32_16x16x32_bf16 v[212:215], a[4:7], v[96:99], v[212:215]
    s_waitcnt lgkmcnt(0)
    v_mfma_f32_16x16x32_bf16 v[220:223], a[4:7], v[104:107], 0
    s_waitcnt vmcnt(6)
    s_barrier
    v_mfma_f32_16x16x32_bf16 v[220:223], a[12:15], v[108:111], v[220:223]
    ds_read_b128 v[80:83], v159 offset:12288
    s_add_u32 m0, s74, 49152
    s_mul_i32 s13, s22, 90112
    v_mfma_f32_16x16x32_bf16 v[216:219], a[8:11], v[108:111], 0
    ds_read_b128 v[84:87], v159 offset:18432
    buffer_load_dwordx4 v156, s[44:47], s13 offen offset:0 sc1 lds
    v_mfma_f32_16x16x32_bf16 v[216:219], a[0:3], v[104:107], v[216:219]
    ds_read_b128 v[88:91], v159 offset:12544
    v_mfma_f32_16x16x32_bf16 v[224:227], a[0:3], v[112:115], 0
    ds_read_b128 v[92:95], v159 offset:18688
    buffer_load_dwordx4 v157, s[44:47], s13 offen offset:1024 sc1 lds
    v_mfma_f32_16x16x32_bf16 v[224:227], a[8:11], v[116:119], v[224:227]
    ds_read_b128 v[96:99], v159 offset:12800
    v_mfma_f32_16x16x32_bf16 v[228:231], a[12:15], v[116:119], 0
    ds_read_b128 v[100:103], v159 offset:18944
    buffer_load_dwordx4 v158, s[44:47], s13 offen offset:2048 sc1 lds
    v_lshrrev_b32 v31, 4, v2
    v_lshl_add_u32 v24, v31, 3, v24
    v_add_u32 v253, s7, v24
    v_lshrrev_b32 v24, 3, v2
    v_and_b32 v25, 7, v2
    v_bfe_u32 v31, v2, 4, 2
    v_lshlrev_b32 v31, 1, v31
    v_xor_b32 v25, v25, v31
    v_lshlrev_b32 v24, 12, v24
    v_lshl_add_u32 v24, v25, 4, v24
    s_mul_i32 s7, s72, 36
    s_bitcmp1_b32 s3, 0
    s_addc_u32 s7, s7, 0
    s_lshl_b32 s7, s7, 17
    s_lshl_b32 s8, s71, 7
    s_add_u32 s7, s7, s8
    v_add_u32 v4, s7, v24
    v_add_u32 v5, 31744, v4
    v_add_u32 v6, 31744, v5
    v_add_u32 v7, 31744, v6
    v_lshrrev_b32 v24, 2, v2
    v_lshlrev_b32 v24, 7, v24
    v_and_b32 v25, 3, v2
    v_lshl_add_u32 v24, v25, 3, v24
    s_and_b32 s7, s73, 8192
    v_add_u32 v24, s7, v24
    v_bfe_u32 v31, v2, 3, 2
    s_and_b32 s7, s3, 1
    s_lshl_b32 s7, s7, 1
    v_xor_b32 v31, s7, v31
    v_mfma_f32_16x16x32_bf16 v[228:231], a[4:7], v[112:115], v[228:231]
    ds_read_b64_tr_b16 a[80:81], v152 offset:49152
    v_mfma_f32_16x16x32_bf16 v[236:239], a[4:7], v[120:123], 0
    ds_read_b64_tr_b16 a[82:83], v152 offset:50176
    s_add_u32 m0, s74, 61440
    s_mul_i32 s13, s23, 90112
    v_mfma_f32_16x16x32_bf16 v[236:239], a[12:15], v[124:127], v[236:239]
    v_mfma_f32_16x16x32_bf16 v[232:235], a[8:11], v[124:127], 0
    ds_read_b64_tr_b16 a[84:85], v153 offset:49152
    buffer_load_dwordx4 v156, s[44:47], s13 offen offset:0 sc1 lds
    v_mfma_f32_16x16x32_bf16 v[232:235], a[0:3], v[120:123], v[232:235]
    ds_read_b64_tr_b16 a[86:87], v153 offset:50176
    s_waitcnt lgkmcnt(4)
    v_mfma_f32_16x16x32_bf16 v[192:195], a[16:19], v[80:83], v[192:195]
    buffer_load_dwordx4 v157, s[44:47], s13 offen offset:1024 sc1 lds
    v_mfma_f32_16x16x32_bf16 v[192:195], a[24:27], v[84:87], v[192:195]
    ds_read_b128 v[104:107], v159 offset:13056
    buffer_load_dwordx4 v158, s[44:47], s13 offen offset:2048 sc1 lds
    v_mfma_f32_16x16x32_bf16 v[196:199], a[28:31], v[84:87], v[196:199]
    ds_read_b128 v[108:111], v159 offset:19200
    v_mfma_f32_16x16x32_bf16 v[196:199], a[20:23], v[80:83], v[196:199]
    ds_read_b128 v[112:115], v159 offset:13312
    s_add_u32 m0, s73, 0
    s_mul_i32 s14, s25, 589824
    v_mfma_f32_16x16x32_bf16 v[204:207], a[20:23], v[88:91], v[204:207]
    ds_read_b128 v[116:119], v159 offset:19456
    v_mfma_f32_16x16x32_bf16 v[204:207], a[28:31], v[92:95], v[204:207]
    ds_read_b128 v[120:123], v159 offset:13568
    buffer_load_dwordx4 v148, s[48:51], s14 offen offset:0 lds
    v_mfma_f32_16x16x32_bf16 v[200:203], a[24:27], v[92:95], v[200:203]
    ds_read_b128 v[124:127], v159 offset:19712
    buffer_load_dwordx4 v149, s[48:51], s14 offen offset:1024 lds
    v_lshl_add_u32 v10, v31, 5, v24
    v_xor_b32 v11, 32, v10
    s_bfe_u32 s101, s2, 0x20003
    s_mul_i32 s101, s101, 3
    s_mul_i32 s84, s101, 305844
    s_lshr_b32 s84, s84, 18
    s_add_u32 s84, s84, 0
    s_add_u32 s85, s84, 1
    s_cmp_eq_u32 s85, 14
    s_cselect_b32 s85, 0, s85
    s_add_u32 s86, s85, 1
    s_cmp_eq_u32 s86, 14
    s_cselect_b32 s86, 0, s86
    s_add_u32 s87, s86, 1
    s_cmp_eq_u32 s87, 14
    s_cselect_b32 s87, 0, s87
    s_add_u32 s88, s87, 1
    s_cmp_eq_u32 s88, 14
    s_cselect_b32 s88, 0, s88
    s_add_u32 s89, s88, 1
    s_cmp_eq_u32 s89, 14
    s_cselect_b32 s89, 0, s89
    s_add_u32 s90, s89, 1
    s_cmp_eq_u32 s90, 14
    s_cselect_b32 s90, 0, s90
    s_add_u32 s91, s90, 1
    s_cmp_eq_u32 s91, 14
    s_cselect_b32 s91, 0, s91
    s_add_u32 s92, s91, 1
    s_cmp_eq_u32 s92, 14
    s_cselect_b32 s92, 0, s92
    s_add_u32 s93, s92, 1
    s_cmp_eq_u32 s93, 14
    s_cselect_b32 s93, 0, s93
    s_add_u32 s94, s93, 1
    s_cmp_eq_u32 s94, 14
    s_cselect_b32 s94, 0, s94
    s_add_u32 s95, s94, 1
    s_cmp_eq_u32 s95, 14
    s_cselect_b32 s95, 0, s95
    s_add_u32 s96, s95, 1
    s_cmp_eq_u32 s96, 14
    s_cselect_b32 s96, 0, s96
    s_add_u32 s97, s96, 1
    s_cmp_eq_u32 s97, 14
    s_cselect_b32 s97, 0, s97
    s_mul_i32 s98, s101, 87384
    s_lshr_b32 s98, s98, 18
    s_add_u32 s98, s98, 14
    s_add_u32 s99, s98, 1
    s_cmp_eq_u32 s99, 18
    s_cselect_b32 s99, 14, s99
    s_add_u32 s100, s99, 1
    s_cmp_eq_u32 s100, 18
    s_cselect_b32 s100, 14, s100
    s_add_u32 s101, s100, 1
    s_cmp_eq_u32 s101, 18
    s_cselect_b32 s101, 14, s101
    s_mul_i32 s7, s70, 6
    s_add_u32 s7, s7, 0
    s_mul_i32 s8, s7, 7282
    s_lshr_b32 s8, s8, 16
    s_mul_i32 s5, s8, 9
    s_sub_u32 s7, s7, s5
    s_lshl_b32 s7, s7, 2
    v_mfma_f32_16x16x32_bf16 v[200:203], a[16:19], v[88:91], v[200:203]
    ds_read_b64_tr_b16 a[88:89], v152 offset:57344
    v_mfma_f32_16x16x32_bf16 v[208:211], a[16:19], v[96:99], v[208:211]
    ds_read_b64_tr_b16 a[90:91], v152 offset:58368
    buffer_load_dwordx4 v150, s[48:51], s14 offen offset:2048 lds
    v_mfma_f32_16x16x32_bf16 v[208:211], a[24:27], v[100:103], v[208:211]
    v_mfma_f32_16x16x32_bf16 v[212:215], a[28:31], v[100:103], v[212:215]
    ds_read_b64_tr_b16 a[92:93], v153 offset:57344
    buffer_load_dwordx4 v151, s[48:51], s14 offen offset:3072 lds
    v_mfma_f32_16x16x32_bf16 v[212:215], a[20:23], v[96:99], v[212:215]
    ds_read_b64_tr_b16 a[94:95], v153 offset:58368
    s_waitcnt lgkmcnt(4)
    v_mfma_f32_16x16x32_bf16 v[220:223], a[20:23], v[104:107], v[220:223]
    s_waitcnt vmcnt(13)
    s_barrier
    v_mfma_f32_16x16x32_bf16 v[220:223], a[28:31], v[108:111], v[220:223]
    ds_read_b128 v[80:83], v159 offset:24576
    s_add_u32 m0, s74, 0
    s_mul_i32 s13, s24, 90112
    v_mfma_f32_16x16x32_bf16 v[216:219], a[24:27], v[108:111], v[216:219]
    ds_read_b128 v[84:87], v159 offset:30720
    buffer_load_dwordx4 v156, s[44:47], s13 offen offset:0 sc1 lds
    v_mfma_f32_16x16x32_bf16 v[216:219], a[16:19], v[104:107], v[216:219]
    ds_read_b128 v[88:91], v159 offset:24832
    v_mfma_f32_16x16x32_bf16 v[224:227], a[16:19], v[112:115], v[224:227]
    ds_read_b128 v[92:95], v159 offset:30976
    buffer_load_dwordx4 v157, s[44:47], s13 offen offset:1024 sc1 lds
    v_mfma_f32_16x16x32_bf16 v[224:227], a[24:27], v[116:119], v[224:227]
    ds_read_b128 v[96:99], v159 offset:25088
    v_mfma_f32_16x16x32_bf16 v[228:231], a[28:31], v[116:119], v[228:231]
    ds_read_b128 v[100:103], v159 offset:31232
    buffer_load_dwordx4 v158, s[44:47], s13 offen offset:2048 sc1 lds
    s_mov_b32 s4, 0xeca86420
    s_bitcmp1_b32 s8, 0
    s_cselect_b32 s4, 0xca864203, s4
    s_cselect_b32 s5, 14, 3
    s_lshr_b64 s[4:5], s[4:5], s7
    s_and_b32 s4, s4, 15
    s_lshl4_add_u32 s4, s8, s4
    v_lshl_add_u32 v240, s4, 8, v245
    s_mul_i32 s7, s70, 6
    s_add_u32 s7, s7, 1
    s_mul_i32 s8, s7, 7282
    s_lshr_b32 s8, s8, 16
    s_mul_i32 s5, s8, 9
    s_sub_u32 s7, s7, s5
    s_lshl_b32 s7, s7, 2
    s_mov_b32 s4, 0xeca86420
    s_bitcmp1_b32 s8, 0
    s_cselect_b32 s4, 0xca864203, s4
    s_cselect_b32 s5, 14, 3
    s_lshr_b64 s[4:5], s[4:5], s7
    s_and_b32 s4, s4, 15
    s_lshl4_add_u32 s4, s8, s4
    v_lshl_add_u32 v241, s4, 8, v245
    s_mul_i32 s7, s70, 6
    s_add_u32 s7, s7, 2
    s_mul_i32 s8, s7, 7282
    s_lshr_b32 s8, s8, 16
    s_mul_i32 s5, s8, 9
    s_sub_u32 s7, s7, s5
    s_lshl_b32 s7, s7, 2
    v_mfma_f32_16x16x32_bf16 v[228:231], a[20:23], v[112:115], v[228:231]
    ds_read_b64_tr_b16 a[96:97], v154 offset:0
    v_mfma_f32_16x16x32_bf16 v[236:239], a[20:23], v[120:123], v[236:239]
    ds_read_b64_tr_b16 a[98:99], v154 offset:1024
    s_add_u32 m0, s74, 12288
    s_mul_i32 s13, s25, 90112
    v_mfma_f32_16x16x32_bf16 v[236:239], a[28:31], v[124:127], v[236:239]
    v_mfma_f32_16x16x32_bf16 v[232:235], a[24:27], v[124:127], v[232:235]
    ds_read_b64_tr_b16 a[100:101], v155 offset:0
    buffer_load_dwordx4 v156, s[44:47], s13 offen offset:0 sc1 lds
    v_mfma_f32_16x16x32_bf16 v[232:235], a[16:19], v[120:123], v[232:235]
    ds_read_b64_tr_b16 a[102:103], v155 offset:1024
    s_waitcnt lgkmcnt(4)
    v_mfma_f32_16x16x32_bf16 v[192:195], a[32:35], v[80:83], v[192:195]
    buffer_load_dwordx4 v157, s[44:47], s13 offen offset:1024 sc1 lds
    v_mfma_f32_16x16x32_bf16 v[192:195], a[40:43], v[84:87], v[192:195]
    ds_read_b128 v[104:107], v159 offset:25344
    buffer_load_dwordx4 v158, s[44:47], s13 offen offset:2048 sc1 lds
    v_mfma_f32_16x16x32_bf16 v[196:199], a[44:47], v[84:87], v[196:199]
    ds_read_b128 v[108:111], v159 offset:31488
    v_mfma_f32_16x16x32_bf16 v[196:199], a[36:39], v[80:83], v[196:199]
    ds_read_b128 v[112:115], v159 offset:25600
    s_add_u32 m0, s73, 16384
    s_mul_i32 s14, s26, 589824
    v_mfma_f32_16x16x32_bf16 v[204:207], a[36:39], v[88:91], v[204:207]
    ds_read_b128 v[116:119], v159 offset:31744
    v_mfma_f32_16x16x32_bf16 v[204:207], a[44:47], v[92:95], v[204:207]
    ds_read_b128 v[120:123], v159 offset:25856
    buffer_load_dwordx4 v148, s[48:51], s14 offen offset:0 lds
    v_mfma_f32_16x16x32_bf16 v[200:203], a[40:43], v[92:95], v[200:203]
    ds_read_b128 v[124:127], v159 offset:32000
    buffer_load_dwordx4 v149, s[48:51], s14 offen offset:1024 lds
    s_mov_b32 s4, 0xeca86420
    s_bitcmp1_b32 s8, 0
    s_cselect_b32 s4, 0xca864203, s4
    s_cselect_b32 s5, 14, 3
    s_lshr_b64 s[4:5], s[4:5], s7
    s_and_b32 s4, s4, 15
    s_lshl4_add_u32 s4, s8, s4
    v_lshl_add_u32 v242, s4, 8, v245
    s_mul_i32 s7, s70, 6
    s_add_u32 s7, s7, 3
    s_mul_i32 s8, s7, 7282
    s_lshr_b32 s8, s8, 16
    s_mul_i32 s5, s8, 9
    s_sub_u32 s7, s7, s5
    s_lshl_b32 s7, s7, 2
    s_mov_b32 s4, 0xeca86420
    s_bitcmp1_b32 s8, 0
    s_cselect_b32 s4, 0xca864203, s4
    s_cselect_b32 s5, 14, 3
    s_lshr_b64 s[4:5], s[4:5], s7
    s_and_b32 s4, s4, 15
    s_lshl4_add_u32 s4, s8, s4
    v_lshl_add_u32 v243, s4, 8, v245
    s_mul_i32 s7, s70, 6
    s_add_u32 s7, s7, 4
    s_mul_i32 s8, s7, 7282
    s_lshr_b32 s8, s8, 16
    s_mul_i32 s5, s8, 9
    s_sub_u32 s7, s7, s5
    v_mfma_f32_16x16x32_bf16 v[200:203], a[32:35], v[88:91], v[200:203]
    ds_read_b64_tr_b16 a[104:105], v154 offset:8192
    v_mfma_f32_16x16x32_bf16 v[208:211], a[32:35], v[96:99], v[208:211]
    ds_read_b64_tr_b16 a[106:107], v154 offset:9216
    buffer_load_dwordx4 v150, s[48:51], s14 offen offset:2048 lds
    v_mfma_f32_16x16x32_bf16 v[208:211], a[40:43], v[100:103], v[208:211]
    v_mfma_f32_16x16x32_bf16 v[212:215], a[44:47], v[100:103], v[212:215]
    ds_read_b64_tr_b16 a[108:109], v155 offset:8192
    buffer_load_dwordx4 v151, s[48:51], s14 offen offset:3072 lds
    v_mfma_f32_16x16x32_bf16 v[212:215], a[36:39], v[96:99], v[212:215]
    ds_read_b64_tr_b16 a[110:111], v155 offset:9216
    s_waitcnt lgkmcnt(4)
    v_mfma_f32_16x16x32_bf16 v[220:223], a[36:39], v[104:107], v[220:223]
    s_waitcnt vmcnt(20)
    s_barrier
    v_mfma_f32_16x16x32_bf16 v[220:223], a[44:47], v[108:111], v[220:223]
    ds_read_b128 v[80:83], v250 offset:0
    s_add_u32 m0, s74, 24576
    s_mul_i32 s13, s26, 90112
    v_mfma_f32_16x16x32_bf16 v[216:219], a[40:43], v[108:111], v[216:219]
    ds_read_b128 v[84:87], v250 offset:6144
    v_mfma_f32_16x16x32_bf16 v[216:219], a[32:35], v[104:107], v[216:219]
    ds_read_b128 v[88:91], v250 offset:256
    buffer_load_dwordx4 v156, s[44:47], s13 offen offset:0 sc1 lds
    v_mfma_f32_16x16x32_bf16 v[224:227], a[32:35], v[112:115], v[224:227]
    ds_read_b128 v[92:95], v250 offset:6400
    v_mfma_f32_16x16x32_bf16 v[224:227], a[40:43], v[116:119], v[224:227]
    ds_read_b128 v[96:99], v250 offset:512
    v_mfma_f32_16x16x32_bf16 v[228:231], a[44:47], v[116:119], v[228:231]
    ds_read_b128 v[100:103], v250 offset:6656
    buffer_load_dwordx4 v157, s[44:47], s13 offen offset:1024 sc1 lds
    s_lshl_b32 s7, s7, 2
    s_mov_b32 s4, 0xeca86420
    s_bitcmp1_b32 s8, 0
    s_cselect_b32 s4, 0xca864203, s4
    s_cselect_b32 s5, 14, 3
    s_lshr_b64 s[4:5], s[4:5], s7
    s_and_b32 s4, s4, 15
    s_lshl4_add_u32 s4, s8, s4
    v_lshl_add_u32 v244, s4, 8, v245
    s_mul_i32 s7, s70, 6
    s_add_u32 s7, s7, 5
    s_mul_i32 s8, s7, 7282
    s_lshr_b32 s8, s8, 16
    s_mul_i32 s5, s8, 9
    s_sub_u32 s7, s7, s5
    s_lshl_b32 s7, s7, 2
    s_mov_b32 s4, 0xeca86420
    s_bitcmp1_b32 s8, 0
    s_cselect_b32 s4, 0xca864203, s4
    s_cselect_b32 s5, 14, 3
    s_lshr_b64 s[4:5], s[4:5], s7
    s_and_b32 s4, s4, 15
    s_lshl4_add_u32 s4, s8, s4
    v_lshl_add_u32 v245, s4, 8, v245
    s_xor_b32 s7, s75, 1
    s_lshl2_add_u32 s7, s7, s3
    s_mul_i32 s9, s7, 6144
    s_add_u32 s9, s9, 7077888
    s_lshl_b32 s7, s7, 7
    s_add_u32 s6, s7, 22822912
    s_lshl2_add_u32 s7, s75, s3
    s_mul_i32 s10, s7, 6144
    v_mfma_f32_16x16x32_bf16 v[228:231], a[36:39], v[112:115], v[228:231]
    v_mfma_f32_16x16x32_bf16 v[236:239], a[36:39], v[120:123], v[236:239]
    v_mfma_f32_16x16x32_bf16 v[236:239], a[44:47], v[124:127], v[236:239]
    buffer_load_dwordx4 v158, s[44:47], s13 offen offset:2048 sc1 lds
    v_mfma_f32_16x16x32_bf16 v[232:235], a[40:43], v[124:127], v[232:235]
    v_mfma_f32_16x16x32_bf16 v[232:235], a[32:35], v[120:123], v[232:235]
    s_waitcnt lgkmcnt(0)
    v_mfma_f32_16x16x32_bf16 v[192:195], a[48:51], v[80:83], v[192:195]
    s_add_u32 m0, s73, 32768
    s_mul_i32 s14, s27, 589824
    v_mfma_f32_16x16x32_bf16 v[192:195], a[56:59], v[84:87], v[192:195]
    ds_read_b128 v[104:107], v250 offset:768
    v_mfma_f32_16x16x32_bf16 v[196:199], a[60:63], v[84:87], v[196:199]
    ds_read_b128 v[108:111], v250 offset:6912
    buffer_load_dwordx4 v148, s[48:51], s14 offen offset:0 lds
    v_mfma_f32_16x16x32_bf16 v[196:199], a[52:55], v[80:83], v[196:199]
    ds_read_b128 v[112:115], v250 offset:1024
    v_mfma_f32_16x16x32_bf16 v[204:207], a[52:55], v[88:91], v[204:207]
    ds_read_b128 v[116:119], v250 offset:7168
    buffer_load_dwordx4 v149, s[48:51], s14 offen offset:1024 lds
    v_mfma_f32_16x16x32_bf16 v[204:207], a[60:63], v[92:95], v[204:207]
    ds_read_b128 v[120:123], v250 offset:1280
    v_mfma_f32_16x16x32_bf16 v[200:203], a[56:59], v[92:95], v[200:203]
    ds_read_b128 v[124:127], v250 offset:7424
    s_add_u32 s10, s10, 7077888
    s_lshl_b32 s7, s7, 7
    s_add_u32 s7, s7, 22822912
    v_mov_b32 v28, s7
    v_add_u32 v247, 3072, v246
    v_cmp_eq_u32 vcc, 0, v2
    v_mov_b32 v248, 0x40000000
    s_nop 0
    v_cndmask_b32 v248, v248, 0, vcc
    v_mov_b32 v249, s68
    v_and_b32 v129, 0xffff0000, v144
    v_lshlrev_b32 v128, 16, v144
    v_and_b32 v131, 0xffff0000, v145
    v_lshlrev_b32 v130, 16, v145
    v_and_b32 v133, 0xffff0000, v146
    v_lshlrev_b32 v132, 16, v146
    v_and_b32 v135, 0xffff0000, v147
    v_lshlrev_b32 v134, 16, v147
    s_mul_i32 s4, s70, 43691
    s_lshr_b32 s4, s4, 16
    s_mul_i32 s5, s70, 21846
    s_lshr_b32 s5, s5, 16
    s_mul_i32 s5, s5, 3
    s_sub_u32 s5, s70, s5
    v_mfma_f32_16x16x32_bf16 v[200:203], a[48:51], v[88:91], v[200:203]
    buffer_load_dwordx4 v150, s[48:51], s14 offen offset:2048 lds
    v_mfma_f32_16x16x32_bf16 v[208:211], a[48:51], v[96:99], v[208:211]
    v_mfma_f32_16x16x32_bf16 v[208:211], a[56:59], v[100:103], v[208:211]
    buffer_load_dwordx4 v151, s[48:51], s14 offen offset:3072 lds
    v_mfma_f32_16x16x32_bf16 v[212:215], a[60:63], v[100:103], v[212:215]
    v_mfma_f32_16x16x32_bf16 v[212:215], a[52:55], v[96:99], v[212:215]
    s_waitcnt lgkmcnt(0)
    v_mfma_f32_16x16x32_bf16 v[220:223], a[52:55], v[104:107], v[220:223]
    s_waitcnt vmcnt(17)
    s_barrier
    v_mfma_f32_16x16x32_bf16 v[220:223], a[60:63], v[108:111], v[220:223]
    ds_read_b128 v[80:83], v250 offset:12288
    s_add_u32 m0, s74, 36864
    s_mul_i32 s13, s27, 90112
    v_mfma_f32_16x16x32_bf16 v[216:219], a[56:59], v[108:111], v[216:219]
    ds_read_b128 v[84:87], v250 offset:18432
    v_mfma_f32_16x16x32_bf16 v[216:219], a[48:51], v[104:107], v[216:219]
    ds_read_b128 v[88:91], v250 offset:12544
    buffer_load_dwordx4 v156, s[44:47], s13 offen offset:0 sc1 lds
    v_mfma_f32_16x16x32_bf16 v[224:227], a[48:51], v[112:115], v[224:227]
    ds_read_b128 v[92:95], v250 offset:18688
    v_mfma_f32_16x16x32_bf16 v[224:227], a[56:59], v[116:119], v[224:227]
    ds_read_b128 v[96:99], v250 offset:12800
    v_mfma_f32_16x16x32_bf16 v[228:231], a[60:63], v[116:119], v[228:231]
    ds_read_b128 v[100:103], v250 offset:18944
    buffer_load_dwordx4 v157, s[44:47], s13 offen offset:1024 sc1 lds
    s_lshl2_add_u32 s4, s72, s4
    s_lshl_b32 s4, s4, 10
    s_mul_i32 s7, s72, 9
    s_sub_u32 s7, s69, s7
    s_lshl3_add_u32 s4, s7, s4
    s_add_u32 s4, s4, 12566528
    s_cmp_eq_u32 s5, 1
    s_cselect_b32 s7, 16, 8
    s_cmp_lg_u32 s5, 0
    s_cselect_b32 s5, 4, 0
    v_lshlrev_b32 v17, 7, v0
    v_add_u32 v17, s4, v17
    v_cmp_gt_u32 vcc, 8, v0
    v_mov_b32 v24, s5
    s_nop 0
    v_cndmask_b32 v24, 0, v24, vcc
    v_add_u32 v17, v17, v24
    v_cmp_gt_u32 vcc, s7, v0
    v_mov_b32 v24, 0x40000000
    s_nop 0
    v_cndmask_b32 v17, v24, v17, vcc
    s_bfe_u32 s4, s2, 0x20003
    s_lshl2_add_u32 s4, s72, s4
    s_lshl_b32 s4, s4, 3
    s_lshr_b32 s5, s2, 4
    v_mfma_f32_16x16x32_bf16 v[228:231], a[52:55], v[112:115], v[228:231]
    ds_read_b64_tr_b16 a[112:113], v152 offset:0
    v_mfma_f32_16x16x32_bf16 v[236:239], a[52:55], v[120:123], v[236:239]
    ds_read_b64_tr_b16 a[114:115], v152 offset:1024
    v_mfma_f32_16x16x32_bf16 v[236:239], a[60:63], v[124:127], v[236:239]
    buffer_load_dwordx4 v158, s[44:47], s13 offen offset:2048 sc1 lds
    v_mfma_f32_16x16x32_bf16 v[232:235], a[56:59], v[124:127], v[232:235]
    ds_read_b64_tr_b16 a[116:117], v153 offset:0
    v_mfma_f32_16x16x32_bf16 v[232:235], a[48:51], v[120:123], v[232:235]
    ds_read_b64_tr_b16 a[118:119], v153 offset:1024
    s_waitcnt lgkmcnt(4)
    v_mfma_f32_16x16x32_bf16 v[192:195], a[64:67], v[80:83], v[192:195]
    s_add_u32 m0, s73, 49152
    s_mul_i32 s14, s76, 589824
    v_mfma_f32_16x16x32_bf16 v[192:195], a[72:75], v[84:87], v[192:195]
    ds_read_b128 v[104:107], v250 offset:13056
    v_mfma_f32_16x16x32_bf16 v[196:199], a[76:79], v[84:87], v[196:199]
    ds_read_b128 v[108:111], v250 offset:19200
    buffer_load_dwordx4 v148, s[48:51], s14 offen offset:0 lds
    v_mfma_f32_16x16x32_bf16 v[196:199], a[68:71], v[80:83], v[196:199]
L_pl_G_2:
    s_cbranch_execz L_pl_G_6
    ds_read_b128 v[112:115], v250 offset:13312
    v_mfma_f32_16x16x32_bf16 v[204:207], a[68:71], v[88:91], v[204:207]
    ds_read_b128 v[116:119], v250 offset:19456
    buffer_load_dwordx4 v149, s[48:51], s14 offen offset:1024 lds
    v_mfma_f32_16x16x32_bf16 v[204:207], a[76:79], v[92:95], v[204:207]
    ds_read_b128 v[120:123], v250 offset:13568
    v_mfma_f32_16x16x32_bf16 v[200:203], a[72:75], v[92:95], v[200:203]
    ds_read_b128 v[124:127], v250 offset:19712
    s_and_b32 s5, s5, 6
    s_add_u32 s4, s4, s5
    s_and_b32 s5, s2, 1
    s_add_u32 s4, s4, s5
    s_lshl_b32 s4, s4, 7
    s_add_u32 s4, s4, 12566528
    v_lshl_add_u32 v15, v2, 2, s4
    s_cmp_eq_u32 s3, 0
    s_cselect_b32 s4, 18, 0
    v_cmp_gt_u32 vcc, s4, v2
    v_mov_b32 v13, 0x40000000
    s_nop 0
    v_cndmask_b32 v15, v13, v15, vcc
    v_mov_b32 v13, s68
    v_cndmask_b32 v13, 0, v13, vcc
    v_and_b32 v24, 15, v2
    v_lshrrev_b32 v25, 4, v2
    v_mul_u32_u24 v25, 17408, v25
    v_lshl_add_u32 v24, v24, 4, v25
    s_mul_i32 s7, s72, 36
    s_and_b32 s8, s3, 1
    s_add_u32 s7, s7, s8
    v_mfma_f32_16x16x32_bf16 v[200:203], a[64:67], v[88:91], v[200:203]
    ds_read_b64_tr_b16 a[120:121], v152 offset:8192
    buffer_load_dwordx4 v150, s[48:51], s14 offen offset:2048 lds
    v_mfma_f32_16x16x32_bf16 v[208:211], a[64:67], v[96:99], v[208:211]
    ds_read_b64_tr_b16 a[122:123], v152 offset:9216
    v_mfma_f32_16x16x32_bf16 v[208:211], a[72:75], v[100:103], v[208:211]
    buffer_load_dwordx4 v151, s[48:51], s14 offen offset:3072 lds
    v_mfma_f32_16x16x32_bf16 v[212:215], a[76:79], v[100:103], v[212:215]
    ds_read_b64_tr_b16 a[124:125], v153 offset:8192
    v_mfma_f32_16x16x32_bf16 v[212:215], a[68:71], v[96:99], v[212:215]
    ds_read_b64_tr_b16 a[126:127], v153 offset:9216
    s_waitcnt lgkmcnt(4)
    v_mfma_f32_16x16x32_bf16 v[220:223], a[68:71], v[104:107], v[220:223]
    s_waitcnt vmcnt(14)
    s_barrier
    v_mfma_f32_16x16x32_bf16 v[220:223], a[76:79], v[108:111], v[220:223]
    ds_read_b128 v[80:83], v250 offset:24576
    s_add_u32 m0, s74, 49152
    s_mul_i32 s13, s76, 90112
    v_mfma_f32_16x16x32_bf16 v[216:219], a[72:75], v[108:111], v[216:219]
    ds_read_b128 v[84:87], v250 offset:30720
    v_mfma_f32_16x16x32_bf16 v[216:219], a[64:67], v[104:107], v[216:219]
    ds_read_b128 v[88:91], v250 offset:24832
    buffer_load_dwordx4 v156, s[44:47], s13 offen offset:0 sc1 lds
    v_mfma_f32_16x16x32_bf16 v[224:227], a[64:67], v[112:115], v[224:227]
    ds_read_b128 v[92:95], v250 offset:30976
    v_mfma_f32_16x16x32_bf16 v[224:227], a[72:75], v[116:119], v[224:227]
    ds_read_b128 v[96:99], v250 offset:25088
    v_mfma_f32_16x16x32_bf16 v[228:231], a[76:79], v[116:119], v[228:231]
    ds_read_b128 v[100:103], v250 offset:31232
    buffer_load_dwordx4 v157, s[44:47], s13 offen offset:1024 sc1 lds
    s_mul_i32 s7, s7, 69632
    s_bfe_u32 s8, s2, 0x20003
    s_lshl_b32 s8, s8, 12
    s_add_u32 s7, s7, s8
    s_add_u32 s7, s7, 12795904
    v_add_u32 v23, s7, v24
    s_xor_b32 s7, s72, 0
    v_lshl_add_u32 v19, s7, 10, v23
    s_xor_b32 s7, s72, 1
    v_lshl_add_u32 v20, s7, 10, v23
    s_xor_b32 s7, s72, 2
    v_lshl_add_u32 v21, s7, 10, v23
    s_xor_b32 s7, s72, 3
    v_lshl_add_u32 v22, s7, 10, v23
    v_lshlrev_b32 v14, 4, v2
    v_add_u32 v14, 98304, v14
    v_add_u32 v1, 0x10000, v14
    s_mov_b32 s56, s16
    v_mfma_f32_16x16x32_bf16 v[228:231], a[68:71], v[112:115], v[228:231]
    ds_read_b64_tr_b16 a[128:129], v152 offset:16384
    v_mfma_f32_16x16x32_bf16 v[236:239], a[68:71], v[120:123], v[236:239]
    ds_read_b64_tr_b16 a[130:131], v152 offset:17408
    v_mfma_f32_16x16x32_bf16 v[236:239], a[76:79], v[124:127], v[236:239]
    buffer_load_dwordx4 v158, s[44:47], s13 offen offset:2048 sc1 lds
    v_mfma_f32_16x16x32_bf16 v[232:235], a[72:75], v[124:127], v[232:235]
    ds_read_b64_tr_b16 a[132:133], v153 offset:16384
    v_mfma_f32_16x16x32_bf16 v[232:235], a[64:67], v[120:123], v[232:235]
    ds_read_b64_tr_b16 a[134:135], v153 offset:17408
    s_waitcnt lgkmcnt(4)
    v_mfma_f32_16x16x32_bf16 v[192:195], a[80:83], v[80:83], v[192:195]
    s_add_u32 m0, s73, 65536
    s_mul_i32 s14, s77, 589824
    v_mfma_f32_16x16x32_bf16 v[192:195], a[88:91], v[84:87], v[192:195]
    ds_read_b128 v[104:107], v250 offset:25344
    v_mfma_f32_16x16x32_bf16 v[196:199], a[92:95], v[84:87], v[196:199]
    ds_read_b128 v[108:111], v250 offset:31488
    buffer_load_dwordx4 v148, s[48:51], s14 offen offset:0 lds
    v_mfma_f32_16x16x32_bf16 v[196:199], a[84:87], v[80:83], v[196:199]
    ds_read_b128 v[112:115], v250 offset:25600
    v_mfma_f32_16x16x32_bf16 v[204:207], a[84:87], v[88:91], v[204:207]
    ds_read_b128 v[116:119], v250 offset:31744
    buffer_load_dwordx4 v149, s[48:51], s14 offen offset:1024 lds
    v_mfma_f32_16x16x32_bf16 v[204:207], a[92:95], v[92:95], v[204:207]
    ds_read_b128 v[120:123], v250 offset:25856
    v_mfma_f32_16x16x32_bf16 v[200:203], a[88:91], v[92:95], v[200:203]
    ds_read_b128 v[124:127], v250 offset:32000
    s_and_b32 s57, s17, 0xffff
    s_mov_b32 s58, 2359296
    s_mov_b32 s59, 0x20000
    s_mov_b32 s40, 18432
    s_mov_b32 s42, 12386304
    s_mov_b32 s64, s38
    s_and_b32 s65, s39, 0xffff
    s_mov_b32 s66, 2359296
    s_mov_b32 s67, 0x20000
    v_lshlrev_b32 v136, 4, v2
    s_mul_i32 s7, s72, 36
    s_bitcmp1_b32 s3, 0
    s_addc_u32 s7, s7, 0
    s_lshl_b32 s7, s7, 17
    v_subrev_u32 v184, s7, v4
    v_subrev_u32 v185, s7, v5
    s_bfe_u32 s4, s2, 0x20003
    s_mul_i32 s4, s4, 9
    v_mfma_f32_16x16x32_bf16 v[200:203], a[80:83], v[88:91], v[200:203]
    ds_read_b64_tr_b16 a[136:137], v152 offset:24576
    buffer_load_dwordx4 v150, s[48:51], s14 offen offset:2048 lds
    v_mfma_f32_16x16x32_bf16 v[208:211], a[80:83], v[96:99], v[208:211]
    ds_read_b64_tr_b16 a[138:139], v152 offset:25600
    v_mfma_f32_16x16x32_bf16 v[208:211], a[88:91], v[100:103], v[208:211]
    buffer_load_dwordx4 v151, s[48:51], s14 offen offset:3072 lds
    v_mfma_f32_16x16x32_bf16 v[212:215], a[92:95], v[100:103], v[212:215]
    ds_read_b64_tr_b16 a[140:141], v153 offset:24576
    v_mfma_f32_16x16x32_bf16 v[212:215], a[84:87], v[96:99], v[212:215]
    ds_read_b64_tr_b16 a[142:143], v153 offset:25600
    s_waitcnt lgkmcnt(4)
    v_mfma_f32_16x16x32_bf16 v[220:223], a[84:87], v[104:107], v[220:223]
    s_waitcnt vmcnt(14)
    s_barrier
    v_mfma_f32_16x16x32_bf16 v[220:223], a[92:95], v[108:111], v[220:223]
    ds_read_b128 v[80:83], v159 offset:0
    s_add_u32 m0, s74, 61440
    s_mul_i32 s13, s77, 90112
    v_mfma_f32_16x16x32_bf16 v[216:219], a[88:91], v[108:111], v[216:219]
    ds_read_b128 v[84:87], v159 offset:6144
    v_mfma_f32_16x16x32_bf16 v[216:219], a[80:83], v[104:107], v[216:219]
    ds_read_b128 v[88:91], v159 offset:256
    buffer_load_dwordx4 v156, s[44:47], s13 offen offset:0 sc1 lds
    v_mfma_f32_16x16x32_bf16 v[224:227], a[80:83], v[112:115], v[224:227]
    ds_read_b128 v[92:95], v159 offset:6400
    v_mfma_f32_16x16x32_bf16 v[224:227], a[88:91], v[116:119], v[224:227]
    ds_read_b128 v[96:99], v159 offset:512
    v_mfma_f32_16x16x32_bf16 v[228:231], a[92:95], v[116:119], v[228:231]
    ds_read_b128 v[100:103], v159 offset:6656
    buffer_load_dwordx4 v157, s[44:47], s13 offen offset:1024 sc1 lds
    s_lshl1_add_u32 s7, s72, s4
    s_and_b32 s8, s3, 1
    s_add_u32 s7, s7, s8
    s_bfe_u32 s8, s2, 65539
    s_add_u32 s7, s7, s8
    s_lshl_b32 s8, s8, 3
    s_sub_u32 s4, s4, s8
    s_lshl_b32 s37, s7, 16
    s_add_u32 s37, s37, 4718592
    s_add_u32 s4, s4, 8
    s_lshl_b32 s16, s4, 16
    s_add_u32 s16, s16, 4718592
    s_sub_u32 s4, s4, s7
    s_lshl_b32 s4, s4, 7
    s_lshl_b32 s7, s7, 7
    v_mfma_f32_16x16x32_bf16 v[228:231], a[84:87], v[112:115], v[228:231]
    ds_read_b64_tr_b16 a[144:145], v152 offset:32768
    v_mfma_f32_16x16x32_bf16 v[236:239], a[84:87], v[120:123], v[236:239]
    ds_read_b64_tr_b16 a[146:147], v152 offset:33792
    v_mfma_f32_16x16x32_bf16 v[236:239], a[92:95], v[124:127], v[236:239]
    buffer_load_dwordx4 v158, s[44:47], s13 offen offset:2048 sc1 lds
    v_mfma_f32_16x16x32_bf16 v[232:235], a[88:91], v[124:127], v[232:235]
    ds_read_b64_tr_b16 a[148:149], v153 offset:32768
    v_mfma_f32_16x16x32_bf16 v[232:235], a[80:83], v[120:123], v[232:235]
    ds_read_b64_tr_b16 a[150:151], v153 offset:33792
    s_waitcnt lgkmcnt(4)
    v_mfma_f32_16x16x32_bf16 v[192:195], a[96:99], v[80:83], v[192:195]
    s_add_u32 m0, s73, 0
    s_mul_i32 s14, s78, 589824
    v_mfma_f32_16x16x32_bf16 v[192:195], a[104:107], v[84:87], v[192:195]
    ds_read_b128 v[104:107], v159 offset:768
    v_mfma_f32_16x16x32_bf16 v[196:199], a[108:111], v[84:87], v[196:199]
    ds_read_b128 v[108:111], v159 offset:6912
    buffer_load_dwordx4 v148, s[48:51], s14 offen offset:0 lds
    v_mfma_f32_16x16x32_bf16 v[196:199], a[100:103], v[80:83], v[196:199]
    ds_read_b128 v[112:115], v159 offset:1024
    v_mfma_f32_16x16x32_bf16 v[204:207], a[100:103], v[88:91], v[204:207]
    ds_read_b128 v[116:119], v159 offset:7168
    buffer_load_dwordx4 v149, s[48:51], s14 offen offset:1024 lds
    v_mfma_f32_16x16x32_bf16 v[204:207], a[108:111], v[92:95], v[204:207]
    ds_read_b128 v[120:123], v159 offset:1280
    v_mfma_f32_16x16x32_bf16 v[200:203], a[104:107], v[92:95], v[200:203]
    ds_read_b128 v[124:127], v159 offset:7424
    s_add_u32 s7, s7, 12582912
    v_bfe_u32 v24, v2, 2, 1
    v_mul_i32_i24 v24, s4, v24
    v_and_b32 v25, 3, v2
    v_lshl_add_u32 v24, v25, 2, v24
    v_add_u32 v188, s7, v24
    s_lshl2_add_u32 s7, s2, s3
    s_mul_i32 s8, s7, 3072
    s_add_u32 s34, s8, 22953984
    s_add_u32 s11, s8, 26099712
    s_add_u32 s12, s8, 29245440
    s_lshl_b32 s35, s7, 12
    s_add_u32 s35, s35, 32391168
    s_xor_b32 s8, s7, 8
    s_mul_i32 s8, s8, 3072
    v_mfma_f32_16x16x32_bf16 v[200:203], a[96:99], v[88:91], v[200:203]
    ds_read_b64_tr_b16 a[152:153], v152 offset:40960
    buffer_load_dwordx4 v150, s[48:51], s14 offen offset:2048 lds
    v_mfma_f32_16x16x32_bf16 v[208:211], a[96:99], v[96:99], v[208:211]
    ds_read_b64_tr_b16 a[154:155], v152 offset:41984
    v_mfma_f32_16x16x32_bf16 v[208:211], a[104:107], v[100:103], v[208:211]
    buffer_load_dwordx4 v151, s[48:51], s14 offen offset:3072 lds
    v_mfma_f32_16x16x32_bf16 v[212:215], a[108:111], v[100:103], v[212:215]
    ds_read_b64_tr_b16 a[156:157], v153 offset:40960
    v_mfma_f32_16x16x32_bf16 v[212:215], a[100:103], v[96:99], v[212:215]
    ds_read_b64_tr_b16 a[158:159], v153 offset:41984
    s_waitcnt lgkmcnt(4)
    v_mfma_f32_16x16x32_bf16 v[220:223], a[100:103], v[104:107], v[220:223]
    s_waitcnt vmcnt(14)
    s_barrier
    v_mfma_f32_16x16x32_bf16 v[220:223], a[108:111], v[108:111], v[220:223]
    ds_read_b128 v[80:83], v159 offset:12288
    s_add_u32 m0, s74, 0
    s_mul_i32 s13, s78, 90112
    v_mfma_f32_16x16x32_bf16 v[216:219], a[104:107], v[108:111], v[216:219]
    ds_read_b128 v[84:87], v159 offset:18432
    v_mfma_f32_16x16x32_bf16 v[216:219], a[96:99], v[104:107], v[216:219]
    ds_read_b128 v[88:91], v159 offset:12544
    buffer_load_dwordx4 v156, s[44:47], s13 offen offset:0 sc1 lds
    v_mfma_f32_16x16x32_bf16 v[224:227], a[96:99], v[112:115], v[224:227]
    ds_read_b128 v[92:95], v159 offset:18688
    v_mfma_f32_16x16x32_bf16 v[224:227], a[104:107], v[116:119], v[224:227]
    ds_read_b128 v[96:99], v159 offset:12800
    v_mfma_f32_16x16x32_bf16 v[228:231], a[108:111], v[116:119], v[228:231]
    ds_read_b128 v[100:103], v159 offset:18944
    buffer_load_dwordx4 v157, s[44:47], s13 offen offset:1024 sc1 lds
    s_add_u32 s30, s8, 22953984
    s_xor_b32 s8, s7, 16
    s_mul_i32 s8, s8, 3072
    s_add_u32 s15, s8, 26099712
    s_xor_b32 s8, s7, 24
    s_mul_i32 s8, s8, 3072
    s_add_u32 s31, s8, 29245440
    s_andn2_b32 s7, s7, 24
    s_lshl3_add_u32 s7, s3, s7
    s_lshl2_add_u32 s8, s7, s72
    s_lshl_b32 s8, s8, 10
    s_add_u32 s32, s8, 32391168
    v_mfma_f32_16x16x32_bf16 v[228:231], a[100:103], v[112:115], v[228:231]
    ds_read_b64_tr_b16 a[160:161], v152 offset:49152
    v_mfma_f32_16x16x32_bf16 v[236:239], a[100:103], v[120:123], v[236:239]
    ds_read_b64_tr_b16 a[162:163], v152 offset:50176
    v_mfma_f32_16x16x32_bf16 v[236:239], a[108:111], v[124:127], v[236:239]
    buffer_load_dwordx4 v158, s[44:47], s13 offen offset:2048 sc1 lds
    v_mfma_f32_16x16x32_bf16 v[232:235], a[104:107], v[124:127], v[232:235]
    ds_read_b64_tr_b16 a[164:165], v153 offset:49152
    v_mfma_f32_16x16x32_bf16 v[232:235], a[96:99], v[120:123], v[232:235]
    ds_read_b64_tr_b16 a[166:167], v153 offset:50176
    s_waitcnt lgkmcnt(4)
    v_mfma_f32_16x16x32_bf16 v[192:195], a[112:115], v[80:83], v[192:195]
    s_add_u32 m0, s73, 16384
    s_mul_i32 s14, s79, 589824
    v_mfma_f32_16x16x32_bf16 v[192:195], a[120:123], v[84:87], v[192:195]
    ds_read_b128 v[104:107], v159 offset:13056
    v_mfma_f32_16x16x32_bf16 v[196:199], a[124:127], v[84:87], v[196:199]
    ds_read_b128 v[108:111], v159 offset:19200
    buffer_load_dwordx4 v148, s[48:51], s14 offen offset:0 lds
    v_mfma_f32_16x16x32_bf16 v[196:199], a[116:119], v[80:83], v[196:199]
    ds_read_b128 v[112:115], v159 offset:13312
    v_mfma_f32_16x16x32_bf16 v[204:207], a[116:119], v[88:91], v[204:207]
    ds_read_b128 v[116:119], v159 offset:19456
    buffer_load_dwordx4 v149, s[48:51], s14 offen offset:1024 lds
    v_mfma_f32_16x16x32_bf16 v[204:207], a[124:127], v[92:95], v[204:207]
    ds_read_b128 v[120:123], v159 offset:13568
    v_mfma_f32_16x16x32_bf16 v[200:203], a[120:123], v[92:95], v[200:203]
    ds_read_b128 v[124:127], v159 offset:19712
    s_xor_b32 s8, s8, 4096
    s_add_u32 s33, s8, 32391168
    s_xor_b32 s8, s3, s72
    s_cmp_lt_u32 s8, 2
    s_cselect_b32 s35, s35, 0x40000000
    s_cselect_b32 s16, s16, 0x40000000
    s_cselect_b32 s36, s68, 0
    s_mov_b32 s38, 0xbfb8aa3b
    s_and_b32 s8, s8, 1
    s_mul_i32 s41, s8, 96
    s_and_b32 s43, s73, 4096
    v_lshlrev_b32 v24, 10, v2
    v_add_u32 v24, s35, v24
    s_add_u32 s7, s34, 2048
    v_mov_b32 v25, s36
    v_mfma_f32_16x16x32_bf16 v[200:203], a[112:115], v[88:91], v[200:203]
    ds_read_b64_tr_b16 a[168:169], v152 offset:57344
    buffer_load_dwordx4 v150, s[48:51], s14 offen offset:2048 lds
    v_mfma_f32_16x16x32_bf16 v[208:211], a[112:115], v[96:99], v[208:211]
    ds_read_b64_tr_b16 a[170:171], v152 offset:58368
    v_mfma_f32_16x16x32_bf16 v[208:211], a[120:123], v[100:103], v[208:211]
    buffer_load_dwordx4 v151, s[48:51], s14 offen offset:3072 lds
    v_mfma_f32_16x16x32_bf16 v[212:215], a[124:127], v[100:103], v[212:215]
    ds_read_b64_tr_b16 a[172:173], v153 offset:57344
    v_mfma_f32_16x16x32_bf16 v[212:215], a[116:119], v[96:99], v[212:215]
    ds_read_b64_tr_b16 a[174:175], v153 offset:58368
    s_waitcnt lgkmcnt(4)
    v_mfma_f32_16x16x32_bf16 v[220:223], a[116:119], v[104:107], v[220:223]
    s_waitcnt vmcnt(14)
    s_barrier
    v_mfma_f32_16x16x32_bf16 v[220:223], a[124:127], v[108:111], v[220:223]
    ds_read_b128 v[80:83], v159 offset:24576
    s_add_u32 m0, s74, 12288
    s_mul_i32 s13, s79, 90112
    v_mfma_f32_16x16x32_bf16 v[216:219], a[120:123], v[108:111], v[216:219]
    ds_read_b128 v[84:87], v159 offset:30720
    v_mfma_f32_16x16x32_bf16 v[216:219], a[112:115], v[104:107], v[216:219]
    ds_read_b128 v[88:91], v159 offset:24832
    buffer_load_dwordx4 v156, s[44:47], s13 offen offset:0 sc1 lds
    v_mfma_f32_16x16x32_bf16 v[224:227], a[112:115], v[112:115], v[224:227]
    ds_read_b128 v[92:95], v159 offset:30976
    v_mfma_f32_16x16x32_bf16 v[224:227], a[120:123], v[116:119], v[224:227]
    ds_read_b128 v[96:99], v159 offset:25088
    v_mfma_f32_16x16x32_bf16 v[228:231], a[124:127], v[116:119], v[228:231]
    ds_read_b128 v[100:103], v159 offset:31232
    buffer_load_dwordx4 v157, s[44:47], s13 offen offset:1024 sc1 lds
    v_cmp_gt_u32 vcc, 4, v2
    s_nop 1
    v_cndmask_b32 v138, 0, v25, vcc
    v_mov_b32 v25, 0x40000000
    v_cndmask_b32 v137, v25, v24, vcc
    v_writelane_b32 v137, s7, 4
    v_writelane_b32 v138, s68, 4
    v_min_u32 v139, 1, v2
    v_lshlrev_b32 v139, 30, v139
    v_mov_b32 v140, 0
    v_writelane_b32 v140, s68, 0
    v_mfma_f32_16x16x32_bf16 v[228:231], a[116:119], v[112:115], v[228:231]
    ds_read_b64_tr_b16 a[176:177], v154 offset:0
    v_mfma_f32_16x16x32_bf16 v[236:239], a[116:119], v[120:123], v[236:239]
    ds_read_b64_tr_b16 a[178:179], v154 offset:1024
    v_mfma_f32_16x16x32_bf16 v[236:239], a[124:127], v[124:127], v[236:239]
    buffer_load_dwordx4 v158, s[44:47], s13 offen offset:2048 sc1 lds
    v_mfma_f32_16x16x32_bf16 v[232:235], a[120:123], v[124:127], v[232:235]
    ds_read_b64_tr_b16 a[180:181], v155 offset:0
    v_mfma_f32_16x16x32_bf16 v[232:235], a[112:115], v[120:123], v[232:235]
    ds_read_b64_tr_b16 a[182:183], v155 offset:1024
    s_waitcnt lgkmcnt(4)
    v_mfma_f32_16x16x32_bf16 v[192:195], a[128:131], v[80:83], v[192:195]
    s_add_u32 m0, s73, 32768
    s_mul_i32 s14, s80, 589824
    v_mfma_f32_16x16x32_bf16 v[192:195], a[136:139], v[84:87], v[192:195]
    ds_read_b128 v[104:107], v159 offset:25344
    v_mfma_f32_16x16x32_bf16 v[196:199], a[140:143], v[84:87], v[196:199]
    ds_read_b128 v[108:111], v159 offset:31488
    buffer_load_dwordx4 v148, s[48:51], s14 offen offset:0 lds
    v_mfma_f32_16x16x32_bf16 v[196:199], a[132:135], v[80:83], v[196:199]
    ds_read_b128 v[112:115], v159 offset:25600
    v_mfma_f32_16x16x32_bf16 v[204:207], a[132:135], v[88:91], v[204:207]
    ds_read_b128 v[116:119], v159 offset:31744
    buffer_load_dwordx4 v149, s[48:51], s14 offen offset:1024 lds
    v_mfma_f32_16x16x32_bf16 v[204:207], a[140:143], v[92:95], v[204:207]
    ds_read_b128 v[120:123], v159 offset:25856
    v_mfma_f32_16x16x32_bf16 v[200:203], a[136:139], v[92:95], v[200:203]
    ds_read_b128 v[124:127], v159 offset:32000
    v_mfma_f32_16x16x32_bf16 v[200:203], a[128:131], v[88:91], v[200:203]
    ds_read_b64_tr_b16 a[184:185], v154 offset:8192
    buffer_load_dwordx4 v150, s[48:51], s14 offen offset:2048 lds
    v_mfma_f32_16x16x32_bf16 v[208:211], a[128:131], v[96:99], v[208:211]
    ds_read_b64_tr_b16 a[186:187], v154 offset:9216
    v_mfma_f32_16x16x32_bf16 v[208:211], a[136:139], v[100:103], v[208:211]
    buffer_load_dwordx4 v151, s[48:51], s14 offen offset:3072 lds
    v_mfma_f32_16x16x32_bf16 v[212:215], a[140:143], v[100:103], v[212:215]
    ds_read_b64_tr_b16 a[188:189], v155 offset:8192
    v_mfma_f32_16x16x32_bf16 v[212:215], a[132:135], v[96:99], v[212:215]
    ds_read_b64_tr_b16 a[190:191], v155 offset:9216
    s_waitcnt lgkmcnt(4)
    v_mfma_f32_16x16x32_bf16 v[220:223], a[132:135], v[104:107], v[220:223]
    s_waitcnt vmcnt(14)
    s_barrier
    v_mfma_f32_16x16x32_bf16 v[220:223], a[140:143], v[108:111], v[220:223]
    ds_read_b128 v[80:83], v250 offset:0
    s_add_u32 m0, s74, 24576
    s_mul_i32 s13, s80, 90112
    v_mfma_f32_16x16x32_bf16 v[216:219], a[136:139], v[108:111], v[216:219]
    ds_read_b128 v[84:87], v250 offset:6144
    v_mfma_f32_16x16x32_bf16 v[216:219], a[128:131], v[104:107], v[216:219]
    ds_read_b128 v[88:91], v250 offset:256
    buffer_load_dwordx4 v156, s[44:47], s13 offen offset:0 sc1 lds
    v_mfma_f32_16x16x32_bf16 v[224:227], a[128:131], v[112:115], v[224:227]
    ds_read_b128 v[92:95], v250 offset:6400
    v_mfma_f32_16x16x32_bf16 v[224:227], a[136:139], v[116:119], v[224:227]
    ds_read_b128 v[96:99], v250 offset:512
    v_mfma_f32_16x16x32_bf16 v[228:231], a[140:143], v[116:119], v[228:231]
    ds_read_b128 v[100:103], v250 offset:6656
    buffer_load_dwordx4 v157, s[44:47], s13 offen offset:1024 sc1 lds
    v_mfma_f32_16x16x32_bf16 v[228:231], a[132:135], v[112:115], v[228:231]
    ds_read_b64_tr_b16 a[192:193], v152 offset:0
    v_mfma_f32_16x16x32_bf16 v[236:239], a[132:135], v[120:123], v[236:239]
    ds_read_b64_tr_b16 a[194:195], v152 offset:1024
    v_mfma_f32_16x16x32_bf16 v[236:239], a[140:143], v[124:127], v[236:239]
    buffer_load_dwordx4 v158, s[44:47], s13 offen offset:2048 sc1 lds
    v_mfma_f32_16x16x32_bf16 v[232:235], a[136:139], v[124:127], v[232:235]
    ds_read_b64_tr_b16 a[196:197], v153 offset:0
    v_mfma_f32_16x16x32_bf16 v[232:235], a[128:131], v[120:123], v[232:235]
    ds_read_b64_tr_b16 a[198:199], v153 offset:1024
    s_waitcnt lgkmcnt(4)
    v_mfma_f32_16x16x32_bf16 v[192:195], a[144:147], v[80:83], v[192:195]
    s_add_u32 m0, s73, 49152
    s_mul_i32 s14, s81, 589824
    v_mfma_f32_16x16x32_bf16 v[192:195], a[152:155], v[84:87], v[192:195]
    ds_read_b128 v[104:107], v250 offset:768
    v_mfma_f32_16x16x32_bf16 v[196:199], a[156:159], v[84:87], v[196:199]
    ds_read_b128 v[108:111], v250 offset:6912
    buffer_load_dwordx4 v148, s[48:51], s14 offen offset:0 lds
    v_mfma_f32_16x16x32_bf16 v[196:199], a[148:151], v[80:83], v[196:199]
    ds_read_b128 v[112:115], v250 offset:1024
    v_mfma_f32_16x16x32_bf16 v[204:207], a[148:151], v[88:91], v[204:207]
    ds_read_b128 v[116:119], v250 offset:7168
    buffer_load_dwordx4 v149, s[48:51], s14 offen offset:1024 lds
    v_mfma_f32_16x16x32_bf16 v[204:207], a[156:159], v[92:95], v[204:207]
    ds_read_b128 v[120:123], v250 offset:1280
    v_mfma_f32_16x16x32_bf16 v[200:203], a[152:155], v[92:95], v[200:203]
    ds_read_b128 v[124:127], v250 offset:7424
    v_mfma_f32_16x16x32_bf16 v[200:203], a[144:147], v[88:91], v[200:203]
    ds_read_b64_tr_b16 a[200:201], v152 offset:8192
    buffer_load_dwordx4 v150, s[48:51], s14 offen offset:2048 lds
    v_mfma_f32_16x16x32_bf16 v[208:211], a[144:147], v[96:99], v[208:211]
    ds_read_b64_tr_b16 a[202:203], v152 offset:9216
    v_mfma_f32_16x16x32_bf16 v[208:211], a[152:155], v[100:103], v[208:211]
    buffer_load_dwordx4 v151, s[48:51], s14 offen offset:3072 lds
    v_mfma_f32_16x16x32_bf16 v[212:215], a[156:159], v[100:103], v[212:215]
    ds_read_b64_tr_b16 a[204:205], v153 offset:8192
    v_mfma_f32_16x16x32_bf16 v[212:215], a[148:151], v[96:99], v[212:215]
    ds_read_b64_tr_b16 a[206:207], v153 offset:9216
    s_waitcnt lgkmcnt(4)
    v_mfma_f32_16x16x32_bf16 v[220:223], a[148:151], v[104:107], v[220:223]
    s_waitcnt vmcnt(14)
    s_barrier
    v_mfma_f32_16x16x32_bf16 v[220:223], a[156:159], v[108:111], v[220:223]
    ds_read_b128 v[80:83], v250 offset:12288
    s_add_u32 m0, s74, 36864
    s_mul_i32 s13, s81, 90112
    v_mfma_f32_16x16x32_bf16 v[216:219], a[152:155], v[108:111], v[216:219]
    ds_read_b128 v[84:87], v250 offset:18432
    v_mfma_f32_16x16x32_bf16 v[216:219], a[144:147], v[104:107], v[216:219]
    ds_read_b128 v[88:91], v250 offset:12544
    buffer_load_dwordx4 v156, s[44:47], s13 offen offset:0 sc1 lds
    v_mfma_f32_16x16x32_bf16 v[224:227], a[144:147], v[112:115], v[224:227]
    ds_read_b128 v[92:95], v250 offset:18688
    v_mfma_f32_16x16x32_bf16 v[224:227], a[152:155], v[116:119], v[224:227]
    ds_read_b128 v[96:99], v250 offset:12800
    v_mfma_f32_16x16x32_bf16 v[228:231], a[156:159], v[116:119], v[228:231]
    ds_read_b128 v[100:103], v250 offset:18944
    buffer_load_dwordx4 v157, s[44:47], s13 offen offset:1024 sc1 lds
    v_mfma_f32_16x16x32_bf16 v[228:231], a[148:151], v[112:115], v[228:231]
    ds_read_b64_tr_b16 a[208:209], v152 offset:16384
    v_mfma_f32_16x16x32_bf16 v[236:239], a[148:151], v[120:123], v[236:239]
    ds_read_b64_tr_b16 a[210:211], v152 offset:17408
    v_mfma_f32_16x16x32_bf16 v[236:239], a[156:159], v[124:127], v[236:239]
    buffer_load_dwordx4 v158, s[44:47], s13 offen offset:2048 sc1 lds
    v_mfma_f32_16x16x32_bf16 v[232:235], a[152:155], v[124:127], v[232:235]
    ds_read_b64_tr_b16 a[212:213], v153 offset:16384
    v_mfma_f32_16x16x32_bf16 v[232:235], a[144:147], v[120:123], v[232:235]
    ds_read_b64_tr_b16 a[214:215], v153 offset:17408
    s_waitcnt lgkmcnt(4)
    v_mfma_f32_16x16x32_bf16 v[192:195], a[160:163], v[80:83], v[192:195]
    s_add_u32 m0, s73, 65536
    s_lshl_b32 s14, s84, 18
    v_mfma_f32_16x16x32_bf16 v[192:195], a[168:171], v[84:87], v[192:195]
    ds_read_b128 v[104:107], v250 offset:13056
    v_mfma_f32_16x16x32_bf16 v[196:199], a[172:175], v[84:87], v[196:199]
    ds_read_b128 v[108:111], v250 offset:19200
    buffer_load_dwordx4 v4, s[52:55], s14 offen offset:0 lds
    v_mfma_f32_16x16x32_bf16 v[196:199], a[164:167], v[80:83], v[196:199]
    ds_read_b128 v[112:115], v250 offset:13312
    v_mfma_f32_16x16x32_bf16 v[204:207], a[164:167], v[88:91], v[204:207]
    ds_read_b128 v[116:119], v250 offset:19456
    buffer_load_dwordx4 v5, s[52:55], s14 offen offset:1024 lds
    v_mfma_f32_16x16x32_bf16 v[204:207], a[172:175], v[92:95], v[204:207]
    ds_read_b128 v[120:123], v250 offset:13568
    v_mfma_f32_16x16x32_bf16 v[200:203], a[168:171], v[92:95], v[200:203]
    ds_read_b128 v[124:127], v250 offset:19712
    v_mfma_f32_16x16x32_bf16 v[200:203], a[160:163], v[88:91], v[200:203]
    ds_read_b64_tr_b16 a[216:217], v152 offset:24576
    buffer_load_dwordx4 v6, s[52:55], s14 offen offset:2048 lds
    v_mfma_f32_16x16x32_bf16 v[208:211], a[160:163], v[96:99], v[208:211]
    ds_read_b64_tr_b16 a[218:219], v152 offset:25600
    v_mfma_f32_16x16x32_bf16 v[208:211], a[168:171], v[100:103], v[208:211]
    buffer_load_dwordx4 v7, s[52:55], s14 offen offset:3072 lds
    v_mfma_f32_16x16x32_bf16 v[212:215], a[172:175], v[100:103], v[212:215]
    ds_read_b64_tr_b16 a[220:221], v153 offset:24576
    v_mfma_f32_16x16x32_bf16 v[212:215], a[164:167], v[96:99], v[212:215]
    ds_read_b64_tr_b16 a[222:223], v153 offset:25600
    s_waitcnt lgkmcnt(4)
    v_mfma_f32_16x16x32_bf16 v[220:223], a[164:167], v[104:107], v[220:223]
    s_waitcnt vmcnt(14)
    s_barrier
    v_mfma_f32_16x16x32_bf16 v[220:223], a[172:175], v[108:111], v[220:223]
    ds_read_b128 v[80:83], v250 offset:24576
    v_mfma_f32_16x16x32_bf16 v[216:219], a[168:171], v[108:111], v[216:219]
    ds_read_b128 v[84:87], v250 offset:30720
    v_mfma_f32_16x16x32_bf16 v[216:219], a[160:163], v[104:107], v[216:219]
    ds_read_b128 v[88:91], v250 offset:24832
    v_mfma_f32_16x16x32_bf16 v[224:227], a[160:163], v[112:115], v[224:227]
    ds_read_b128 v[92:95], v250 offset:30976
    v_mfma_f32_16x16x32_bf16 v[224:227], a[168:171], v[116:119], v[224:227]
    ds_read_b128 v[96:99], v250 offset:25088
    v_mfma_f32_16x16x32_bf16 v[228:231], a[172:175], v[116:119], v[228:231]
    ds_read_b128 v[100:103], v250 offset:31232
    v_mfma_f32_16x16x32_bf16 v[228:231], a[164:167], v[112:115], v[228:231]
    ds_read_b64_tr_b16 a[224:225], v152 offset:32768
    v_mfma_f32_16x16x32_bf16 v[236:239], a[164:167], v[120:123], v[236:239]
    ds_read_b64_tr_b16 a[226:227], v152 offset:33792
    v_mfma_f32_16x16x32_bf16 v[236:239], a[172:175], v[124:127], v[236:239]
    v_mfma_f32_16x16x32_bf16 v[232:235], a[168:171], v[124:127], v[232:235]
    ds_read_b64_tr_b16 a[228:229], v153 offset:32768
    v_mfma_f32_16x16x32_bf16 v[232:235], a[160:163], v[120:123], v[232:235]
    ds_read_b64_tr_b16 a[230:231], v153 offset:33792
    s_waitcnt lgkmcnt(4)
    v_mfma_f32_16x16x32_bf16 v[192:195], a[176:179], v[80:83], v[192:195]
    v_mfma_f32_16x16x32_bf16 v[192:195], a[184:187], v[84:87], v[192:195]
    ds_read_b128 v[104:107], v250 offset:25344
    v_mfma_f32_16x16x32_bf16 v[196:199], a[188:191], v[84:87], v[196:199]
    ds_read_b128 v[108:111], v250 offset:31488
    v_mfma_f32_16x16x32_bf16 v[196:199], a[180:183], v[80:83], v[196:199]
    ds_read_b128 v[112:115], v250 offset:25600
    v_mfma_f32_16x16x32_bf16 v[204:207], a[180:183], v[88:91], v[204:207]
    ds_read_b128 v[116:119], v250 offset:31744
    v_mfma_f32_16x16x32_bf16 v[204:207], a[188:191], v[92:95], v[204:207]
    ds_read_b128 v[120:123], v250 offset:25856
    v_mfma_f32_16x16x32_bf16 v[200:203], a[184:187], v[92:95], v[200:203]
    ds_read_b128 v[124:127], v250 offset:32000
    v_mfma_f32_16x16x32_bf16 v[200:203], a[176:179], v[88:91], v[200:203]
    ds_read_b64_tr_b16 a[232:233], v152 offset:40960
    v_mfma_f32_16x16x32_bf16 v[208:211], a[176:179], v[96:99], v[208:211]
    ds_read_b64_tr_b16 a[234:235], v152 offset:41984
    v_mfma_f32_16x16x32_bf16 v[208:211], a[184:187], v[100:103], v[208:211]
    v_mfma_f32_16x16x32_bf16 v[212:215], a[188:191], v[100:103], v[212:215]
    ds_read_b64_tr_b16 a[236:237], v153 offset:40960
    v_mfma_f32_16x16x32_bf16 v[212:215], a[180:183], v[96:99], v[212:215]
    ds_read_b64_tr_b16 a[238:239], v153 offset:41984
    s_waitcnt lgkmcnt(4)
    v_mfma_f32_16x16x32_bf16 v[220:223], a[180:183], v[104:107], v[220:223]
    s_waitcnt vmcnt(7)
    s_barrier
    v_mfma_f32_16x16x32_bf16 v[220:223], a[188:191], v[108:111], v[220:223]
    ds_read_b128 v[80:83], v159 offset:0
    v_mfma_f32_16x16x32_bf16 v[216:219], a[184:187], v[108:111], v[216:219]
    ds_read_b128 v[84:87], v159 offset:6144
    v_mfma_f32_16x16x32_bf16 v[216:219], a[176:179], v[104:107], v[216:219]
    ds_read_b128 v[88:91], v159 offset:256
    v_mfma_f32_16x16x32_bf16 v[224:227], a[176:179], v[112:115], v[224:227]
    ds_read_b128 v[92:95], v159 offset:6400
    v_mfma_f32_16x16x32_bf16 v[224:227], a[184:187], v[116:119], v[224:227]
    ds_read_b128 v[96:99], v159 offset:512
    v_mfma_f32_16x16x32_bf16 v[228:231], a[188:191], v[116:119], v[228:231]
    ds_read_b128 v[100:103], v159 offset:6656
    v_mfma_f32_16x16x32_bf16 v[228:231], a[180:183], v[112:115], v[228:231]
    ds_read_b64_tr_b16 a[240:241], v152 offset:49152
    v_mfma_f32_16x16x32_bf16 v[236:239], a[180:183], v[120:123], v[236:239]
    ds_read_b64_tr_b16 a[242:243], v152 offset:50176
L_pl_G_3:
    s_cbranch_execz L_wret
    v_mfma_f32_16x16x32_bf16 v[236:239], a[188:191], v[124:127], v[236:239]
    v_mfma_f32_16x16x32_bf16 v[232:235], a[184:187], v[124:127], v[232:235]
    ds_read_b64_tr_b16 a[244:245], v153 offset:49152
    v_mfma_f32_16x16x32_bf16 v[232:235], a[176:179], v[120:123], v[232:235]
    ds_read_b64_tr_b16 a[246:247], v153 offset:50176
    s_waitcnt lgkmcnt(4)
    v_mfma_f32_16x16x32_bf16 v[192:195], a[192:195], v[80:83], v[192:195]
    v_mfma_f32_16x16x32_bf16 v[192:195], a[200:203], v[84:87], v[192:195]
    ds_read_b128 v[104:107], v159 offset:768
    v_mfma_f32_16x16x32_bf16 v[196:199], a[204:207], v[84:87], v[196:199]
    ds_read_b128 v[108:111], v159 offset:6912
    v_mfma_f32_16x16x32_bf16 v[196:199], a[196:199], v[80:83], v[196:199]
    ds_read_b128 v[112:115], v159 offset:1024
    v_mfma_f32_16x16x32_bf16 v[204:207], a[196:199], v[88:91], v[204:207]
    ds_read_b128 v[116:119], v159 offset:7168
    v_mfma_f32_16x16x32_bf16 v[204:207], a[204:207], v[92:95], v[204:207]
    ds_read_b128 v[120:123], v159 offset:1280
    v_mfma_f32_16x16x32_bf16 v[200:203], a[200:203], v[92:95], v[200:203]
    ds_read_b128 v[124:127], v159 offset:7424
    v_mfma_f32_16x16x32_bf16 v[200:203], a[192:195], v[88:91], v[200:203]
    ds_read_b64_tr_b16 a[248:249], v152 offset:57344
    v_mfma_f32_16x16x32_bf16 v[208:211], a[192:195], v[96:99], v[208:211]
    ds_read_b64_tr_b16 a[250:251], v152 offset:58368
    v_mfma_f32_16x16x32_bf16 v[208:211], a[200:203], v[100:103], v[208:211]
    v_mfma_f32_16x16x32_bf16 v[212:215], a[204:207], v[100:103], v[212:215]
    ds_read_b64_tr_b16 a[252:253], v153 offset:57344
    v_mfma_f32_16x16x32_bf16 v[212:215], a[196:199], v[96:99], v[212:215]
    ds_read_b64_tr_b16 a[254:255], v153 offset:58368
    s_waitcnt lgkmcnt(4)
    v_mfma_f32_16x16x32_bf16 v[220:223], a[196:199], v[104:107], v[220:223]
    s_barrier
    v_mfma_f32_16x16x32_bf16 v[220:223], a[204:207], v[108:111], v[220:223]
    ds_read_b128 v[80:83], v159 offset:12288
    s_add_u32 m0, s74, 49152
    s_mul_i32 s13, s18, 90112
    v_mfma_f32_16x16x32_bf16 v[216:219], a[200:203], v[108:111], v[216:219]
    ds_read_b128 v[84:87], v159 offset:18432
    v_mfma_f32_16x16x32_bf16 v[216:219], a[192:195], v[104:107], v[216:219]
    ds_read_b128 v[88:91], v159 offset:12544
    buffer_load_dwordx4 v8, s[44:47], s13 offen offset:0 sc1 lds
    v_mfma_f32_16x16x32_bf16 v[224:227], a[192:195], v[112:115], v[224:227]
    ds_read_b128 v[92:95], v159 offset:18688
    v_mfma_f32_16x16x32_bf16 v[224:227], a[200:203], v[116:119], v[224:227]
    ds_read_b128 v[96:99], v159 offset:12800
    v_mfma_f32_16x16x32_bf16 v[228:231], a[204:207], v[116:119], v[228:231]
    ds_read_b128 v[100:103], v159 offset:18944
    buffer_load_dwordx4 v9, s[44:47], s13 offen offset:1024 sc1 lds
    v_mfma_f32_16x16x32_bf16 v[228:231], a[196:199], v[112:115], v[228:231]
    v_mfma_f32_16x16x32_bf16 v[236:239], a[196:199], v[120:123], v[236:239]
    v_mfma_f32_16x16x32_bf16 v[236:239], a[204:207], v[124:127], v[236:239]
    buffer_load_dwordx4 v3, s[44:47], s13 offen offset:2048 sc1 lds
    v_mfma_f32_16x16x32_bf16 v[232:235], a[200:203], v[124:127], v[232:235]
    v_mfma_f32_16x16x32_bf16 v[232:235], a[192:195], v[120:123], v[232:235]
    s_waitcnt lgkmcnt(0)
    v_mfma_f32_16x16x32_bf16 v[192:195], a[208:211], v[80:83], v[192:195]
    s_add_u32 m0, s74, 61440
    s_mul_i32 s13, s19, 90112
    v_mfma_f32_16x16x32_bf16 v[192:195], a[216:219], v[84:87], v[192:195]
    ds_read_b128 v[104:107], v159 offset:13056
    v_mfma_f32_16x16x32_bf16 v[196:199], a[220:223], v[84:87], v[196:199]
    ds_read_b128 v[108:111], v159 offset:19200
    v_mfma_f32_16x16x32_bf16 v[196:199], a[212:215], v[80:83], v[196:199]
    ds_read_b128 v[112:115], v159 offset:13312
    buffer_load_dwordx4 v8, s[44:47], s13 offen offset:0 sc1 lds
    v_mfma_f32_16x16x32_bf16 v[204:207], a[212:215], v[88:91], v[204:207]
    ds_read_b128 v[116:119], v159 offset:19456
    v_mfma_f32_16x16x32_bf16 v[204:207], a[220:223], v[92:95], v[204:207]
    ds_read_b128 v[120:123], v159 offset:13568
    v_mfma_f32_16x16x32_bf16 v[200:203], a[216:219], v[92:95], v[200:203]
    ds_read_b128 v[124:127], v159 offset:19712
    buffer_load_dwordx4 v9, s[44:47], s13 offen offset:1024 sc1 lds
    v_mfma_f32_16x16x32_bf16 v[200:203], a[208:211], v[88:91], v[200:203]
    v_mfma_f32_16x16x32_bf16 v[208:211], a[208:211], v[96:99], v[208:211]
    v_mfma_f32_16x16x32_bf16 v[208:211], a[216:219], v[100:103], v[208:211]
    buffer_load_dwordx4 v3, s[44:47], s13 offen offset:2048 sc1 lds
    v_mfma_f32_16x16x32_bf16 v[212:215], a[220:223], v[100:103], v[212:215]
    v_mfma_f32_16x16x32_bf16 v[212:215], a[212:215], v[96:99], v[212:215]
    s_waitcnt lgkmcnt(0)
    v_mfma_f32_16x16x32_bf16 v[220:223], a[212:215], v[104:107], v[220:223]
    s_barrier
    v_mfma_f32_16x16x32_bf16 v[220:223], a[220:223], v[108:111], v[220:223]
    ds_read_b128 v[80:83], v159 offset:24576
    s_add_u32 m0, s74, 0
    s_mul_i32 s13, s20, 90112
    v_mfma_f32_16x16x32_bf16 v[216:219], a[216:219], v[108:111], v[216:219]
    ds_read_b128 v[84:87], v159 offset:30720
    v_mfma_f32_16x16x32_bf16 v[216:219], a[208:211], v[104:107], v[216:219]
    ds_read_b128 v[88:91], v159 offset:24832
    buffer_load_dwordx4 v8, s[44:47], s13 offen offset:0 sc1 lds
    v_mfma_f32_16x16x32_bf16 v[224:227], a[208:211], v[112:115], v[224:227]
    ds_read_b128 v[92:95], v159 offset:30976
    v_mfma_f32_16x16x32_bf16 v[224:227], a[216:219], v[116:119], v[224:227]
    ds_read_b128 v[96:99], v159 offset:25088
    v_mfma_f32_16x16x32_bf16 v[228:231], a[220:223], v[116:119], v[228:231]
    ds_read_b128 v[100:103], v159 offset:31232
    buffer_load_dwordx4 v9, s[44:47], s13 offen offset:1024 sc1 lds
    v_mfma_f32_16x16x32_bf16 v[228:231], a[212:215], v[112:115], v[228:231]
    v_mfma_f32_16x16x32_bf16 v[236:239], a[212:215], v[120:123], v[236:239]
    v_mfma_f32_16x16x32_bf16 v[236:239], a[220:223], v[124:127], v[236:239]
    buffer_load_dwordx4 v3, s[44:47], s13 offen offset:2048 sc1 lds
    v_mfma_f32_16x16x32_bf16 v[232:235], a[216:219], v[124:127], v[232:235]
    v_mfma_f32_16x16x32_bf16 v[232:235], a[208:211], v[120:123], v[232:235]
    s_waitcnt lgkmcnt(0)
    v_mfma_f32_16x16x32_bf16 v[192:195], a[224:227], v[80:83], v[192:195]
    s_add_u32 m0, s74, 12288
    s_mul_i32 s13, s21, 90112
    v_mfma_f32_16x16x32_bf16 v[192:195], a[232:235], v[84:87], v[192:195]
    ds_read_b128 v[104:107], v159 offset:25344
    v_mfma_f32_16x16x32_bf16 v[196:199], a[236:239], v[84:87], v[196:199]
    ds_read_b128 v[108:111], v159 offset:31488
    v_mfma_f32_16x16x32_bf16 v[196:199], a[228:231], v[80:83], v[196:199]
    ds_read_b128 v[112:115], v159 offset:25600
    buffer_load_dwordx4 v8, s[44:47], s13 offen offset:0 sc1 lds
    v_mfma_f32_16x16x32_bf16 v[204:207], a[228:231], v[88:91], v[204:207]
    ds_read_b128 v[116:119], v159 offset:31744
    v_mfma_f32_16x16x32_bf16 v[204:207], a[236:239], v[92:95], v[204:207]
    ds_read_b128 v[120:123], v159 offset:25856
    v_mfma_f32_16x16x32_bf16 v[200:203], a[232:235], v[92:95], v[200:203]
    ds_read_b128 v[124:127], v159 offset:32000
    buffer_load_dwordx4 v9, s[44:47], s13 offen offset:1024 sc1 lds
    v_mfma_f32_16x16x32_bf16 v[200:203], a[224:227], v[88:91], v[200:203]
    v_mfma_f32_16x16x32_bf16 v[208:211], a[224:227], v[96:99], v[208:211]
    v_mfma_f32_16x16x32_bf16 v[208:211], a[232:235], v[100:103], v[208:211]
    buffer_load_dwordx4 v3, s[44:47], s13 offen offset:2048 sc1 lds
    v_mfma_f32_16x16x32_bf16 v[212:215], a[236:239], v[100:103], v[212:215]
    v_mfma_f32_16x16x32_bf16 v[212:215], a[228:231], v[96:99], v[212:215]
    s_waitcnt lgkmcnt(0)
    v_mfma_f32_16x16x32_bf16 v[220:223], a[228:231], v[104:107], v[220:223]
    s_waitcnt vmcnt(16)
    s_barrier
    v_mfma_f32_16x16x32_bf16 v[220:223], a[236:239], v[108:111], v[220:223]
    ds_read_b128 v[80:83], v250 offset:0
    s_add_u32 m0, s74, 24576
    s_mul_i32 s13, s22, 90112
    v_mfma_f32_16x16x32_bf16 v[216:219], a[232:235], v[108:111], v[216:219]
    ds_read_b128 v[84:87], v250 offset:6144
    v_mfma_f32_16x16x32_bf16 v[216:219], a[224:227], v[104:107], v[216:219]
    ds_read_b128 v[88:91], v250 offset:256
    buffer_load_dwordx4 v8, s[44:47], s13 offen offset:0 sc1 lds
    v_mfma_f32_16x16x32_bf16 v[224:227], a[224:227], v[112:115], v[224:227]
    ds_read_b128 v[92:95], v250 offset:6400
    v_mfma_f32_16x16x32_bf16 v[224:227], a[232:235], v[116:119], v[224:227]
    ds_read_b128 v[96:99], v250 offset:512
    v_mfma_f32_16x16x32_bf16 v[228:231], a[236:239], v[116:119], v[228:231]
    ds_read_b128 v[100:103], v250 offset:6656
    buffer_load_dwordx4 v9, s[44:47], s13 offen offset:1024 sc1 lds
    v_mfma_f32_16x16x32_bf16 v[228:231], a[228:231], v[112:115], v[228:231]
    v_mfma_f32_16x16x32_bf16 v[236:239], a[228:231], v[120:123], v[236:239]
    v_mfma_f32_16x16x32_bf16 v[236:239], a[236:239], v[124:127], v[236:239]
    buffer_load_dwordx4 v3, s[44:47], s13 offen offset:2048 sc1 lds
    v_mfma_f32_16x16x32_bf16 v[232:235], a[232:235], v[124:127], v[232:235]
    v_mfma_f32_16x16x32_bf16 v[232:235], a[224:227], v[120:123], v[232:235]
    s_waitcnt lgkmcnt(0)
    v_mfma_f32_16x16x32_bf16 v[192:195], a[240:243], v[80:83], v[192:195]
    s_add_u32 m0, s73, 0
    s_lshl_b32 s14, s85, 18
    v_mfma_f32_16x16x32_bf16 v[192:195], a[248:251], v[84:87], v[192:195]
    ds_read_b128 v[104:107], v250 offset:768
    v_mfma_f32_16x16x32_bf16 v[196:199], a[252:255], v[84:87], v[196:199]
    ds_read_b128 v[108:111], v250 offset:6912
    buffer_load_dwordx4 v4, s[52:55], s14 offen offset:0 lds
    v_mfma_f32_16x16x32_bf16 v[196:199], a[244:247], v[80:83], v[196:199]
    ds_read_b128 v[112:115], v250 offset:1024
    v_mfma_f32_16x16x32_bf16 v[204:207], a[244:247], v[88:91], v[204:207]
    ds_read_b128 v[116:119], v250 offset:7168
    buffer_load_dwordx4 v5, s[52:55], s14 offen offset:1024 lds
    v_mfma_f32_16x16x32_bf16 v[204:207], a[252:255], v[92:95], v[204:207]
    ds_read_b128 v[120:123], v250 offset:1280
    v_mfma_f32_16x16x32_bf16 v[200:203], a[248:251], v[92:95], v[200:203]
    ds_read_b128 v[124:127], v250 offset:7424
    v_mfma_f32_16x16x32_bf16 v[200:203], a[240:243], v[88:91], v[200:203]
    buffer_load_dwordx4 v6, s[52:55], s14 offen offset:2048 lds
    v_mfma_f32_16x16x32_bf16 v[208:211], a[240:243], v[96:99], v[208:211]
    v_mfma_f32_16x16x32_bf16 v[208:211], a[248:251], v[100:103], v[208:211]
    buffer_load_dwordx4 v7, s[52:55], s14 offen offset:3072 lds
    v_mfma_f32_16x16x32_bf16 v[212:215], a[252:255], v[100:103], v[212:215]
    v_mfma_f32_16x16x32_bf16 v[212:215], a[244:247], v[96:99], v[212:215]
    s_waitcnt lgkmcnt(0)
    v_mfma_f32_16x16x32_bf16 v[220:223], a[244:247], v[104:107], v[220:223]
    s_waitcnt vmcnt(16)
    s_barrier
    v_mfma_f32_16x16x32_bf16 v[220:223], a[252:255], v[108:111], v[220:223]
    ds_read_b128 v[80:83], v250 offset:12288
    v_mfma_f32_16x16x32_bf16 v[216:219], a[248:251], v[108:111], v[216:219]
    ds_read_b128 v[84:87], v250 offset:18432
    v_mfma_f32_16x16x32_bf16 v[216:219], a[240:243], v[104:107], v[216:219]
    ds_read_b128 v[88:91], v250 offset:12544
    v_mfma_f32_16x16x32_bf16 v[224:227], a[240:243], v[112:115], v[224:227]
    ds_read_b128 v[92:95], v250 offset:18688
    v_cvt_pk_bf16_f32 v192, v192, v193
    v_mfma_f32_16x16x32_bf16 v[224:227], a[248:251], v[116:119], v[224:227]
    ds_read_b128 v[96:99], v250 offset:12800
    v_mfma_f32_16x16x32_bf16 v[228:231], a[252:255], v[116:119], v[228:231]
    ds_read_b128 v[100:103], v250 offset:18944
    v_cvt_pk_bf16_f32 v193, v194, v195
    v_mfma_f32_16x16x32_bf16 v[228:231], a[244:247], v[112:115], v[228:231]
    v_mfma_f32_16x16x32_bf16 v[236:239], a[244:247], v[120:123], v[236:239]
    v_cvt_pk_bf16_f32 v194, v196, v197
    v_mfma_f32_16x16x32_bf16 v[236:239], a[252:255], v[124:127], v[236:239]
    v_cvt_pk_bf16_f32 v195, v198, v199
    v_mfma_f32_16x16x32_bf16 v[232:235], a[248:251], v[124:127], v[232:235]
    v_mfma_f32_16x16x32_bf16 v[232:235], a[240:243], v[120:123], v[232:235]
    buffer_store_dwordx4 v[192:195], v246, s[44:47], s9 offen offset:0 sc1
    s_waitcnt lgkmcnt(0)
    v_mfma_f32_16x16x32_bf16 v[32:35], a[0:3], v[80:83], v[128:131]
    v_mfma_f32_16x16x32_bf16 v[32:35], a[8:11], v[84:87], v[32:35]
    ds_read_b128 v[104:107], v250 offset:13056
    v_mfma_f32_16x16x32_bf16 v[36:39], a[12:15], v[84:87], v[132:135]
    ds_read_b128 v[108:111], v250 offset:19200
    v_mfma_f32_16x16x32_bf16 v[36:39], a[4:7], v[80:83], v[36:39]
    ds_read_b128 v[112:115], v250 offset:13312
    v_mfma_f32_16x16x32_bf16 v[44:47], a[4:7], v[88:91], v[132:135]
    ds_read_b128 v[116:119], v250 offset:19456
    v_cvt_pk_bf16_f32 v200, v200, v201
    v_mfma_f32_16x16x32_bf16 v[44:47], a[12:15], v[92:95], v[44:47]
    ds_read_b128 v[120:123], v250 offset:13568
    v_mfma_f32_16x16x32_bf16 v[40:43], a[8:11], v[92:95], v[128:131]
    ds_read_b128 v[124:127], v250 offset:19712
    v_cvt_pk_bf16_f32 v201, v202, v203
    v_mfma_f32_16x16x32_bf16 v[40:43], a[0:3], v[88:91], v[40:43]
    v_mfma_f32_16x16x32_bf16 v[48:51], a[0:3], v[96:99], v[128:131]
    v_cvt_pk_bf16_f32 v202, v204, v205
    v_mfma_f32_16x16x32_bf16 v[48:51], a[8:11], v[100:103], v[48:51]
    v_cvt_pk_bf16_f32 v203, v206, v207
    v_mfma_f32_16x16x32_bf16 v[52:55], a[12:15], v[100:103], v[132:135]
    v_mfma_f32_16x16x32_bf16 v[52:55], a[4:7], v[96:99], v[52:55]
    buffer_store_dwordx4 v[200:203], v246, s[44:47], s9 offen offset:1024 sc1
    s_waitcnt lgkmcnt(0)
    v_mfma_f32_16x16x32_bf16 v[60:63], a[4:7], v[104:107], v[132:135]
    s_waitcnt vmcnt(15)
    s_barrier
    v_mfma_f32_16x16x32_bf16 v[60:63], a[12:15], v[108:111], v[60:63]
    ds_read_b128 v[80:83], v250 offset:24576
    v_cvt_pk_bf16_f32 v208, v208, v209
    v_mfma_f32_16x16x32_bf16 v[56:59], a[8:11], v[108:111], v[128:131]
    ds_read_b128 v[84:87], v250 offset:30720
    v_mfma_f32_16x16x32_bf16 v[56:59], a[0:3], v[104:107], v[56:59]
    ds_read_b128 v[88:91], v250 offset:24832
    v_cvt_pk_bf16_f32 v209, v210, v211
    v_mfma_f32_16x16x32_bf16 v[64:67], a[0:3], v[112:115], v[128:131]
    ds_read_b128 v[92:95], v250 offset:30976
    v_mfma_f32_16x16x32_bf16 v[64:67], a[8:11], v[116:119], v[64:67]
    ds_read_b128 v[96:99], v250 offset:25088
    v_mfma_f32_16x16x32_bf16 v[68:71], a[12:15], v[116:119], v[132:135]
    ds_read_b128 v[100:103], v250 offset:31232
    v_cvt_pk_bf16_f32 v210, v212, v213
    v_mfma_f32_16x16x32_bf16 v[68:71], a[4:7], v[112:115], v[68:71]
    v_mfma_f32_16x16x32_bf16 v[76:79], a[4:7], v[120:123], v[132:135]
    v_cvt_pk_bf16_f32 v211, v214, v215
    v_mfma_f32_16x16x32_bf16 v[76:79], a[12:15], v[124:127], v[76:79]
    v_mfma_f32_16x16x32_bf16 v[72:75], a[8:11], v[124:127], v[128:131]
    buffer_store_dwordx4 v[208:211], v246, s[44:47], s9 offen offset:2048 sc1
    v_mfma_f32_16x16x32_bf16 v[72:75], a[0:3], v[120:123], v[72:75]
    s_waitcnt lgkmcnt(0)
    v_mfma_f32_16x16x32_bf16 v[32:35], a[16:19], v[80:83], v[32:35]
    v_mfma_f32_16x16x32_bf16 v[32:35], a[24:27], v[84:87], v[32:35]
    ds_read_b128 v[104:107], v250 offset:25344
    v_cvt_pk_bf16_f32 v216, v216, v217
    v_mfma_f32_16x16x32_bf16 v[36:39], a[28:31], v[84:87], v[36:39]
    ds_read_b128 v[108:111], v250 offset:31488
    v_mfma_f32_16x16x32_bf16 v[36:39], a[20:23], v[80:83], v[36:39]
    ds_read_b128 v[112:115], v250 offset:25600
    v_cvt_pk_bf16_f32 v217, v218, v219
    v_mfma_f32_16x16x32_bf16 v[44:47], a[20:23], v[88:91], v[44:47]
    ds_read_b128 v[116:119], v250 offset:31744
    v_mfma_f32_16x16x32_bf16 v[44:47], a[28:31], v[92:95], v[44:47]
    ds_read_b128 v[120:123], v250 offset:25856
    v_mfma_f32_16x16x32_bf16 v[40:43], a[24:27], v[92:95], v[40:43]
    ds_read_b128 v[124:127], v250 offset:32000
    v_cvt_pk_bf16_f32 v218, v220, v221
    v_mfma_f32_16x16x32_bf16 v[40:43], a[16:19], v[88:91], v[40:43]
    v_mfma_f32_16x16x32_bf16 v[48:51], a[16:19], v[96:99], v[48:51]
    v_cvt_pk_bf16_f32 v219, v222, v223
    v_mfma_f32_16x16x32_bf16 v[48:51], a[24:27], v[100:103], v[48:51]
    v_mfma_f32_16x16x32_bf16 v[52:55], a[28:31], v[100:103], v[52:55]
    buffer_store_dwordx4 v[216:219], v247, s[44:47], s9 offen offset:0 sc1
    v_mfma_f32_16x16x32_bf16 v[52:55], a[20:23], v[96:99], v[52:55]
    s_waitcnt lgkmcnt(0)
    v_mfma_f32_16x16x32_bf16 v[60:63], a[20:23], v[104:107], v[60:63]
    s_waitcnt vmcnt(14)
    s_barrier
    v_cvt_pk_bf16_f32 v224, v224, v225
    v_mfma_f32_16x16x32_bf16 v[60:63], a[28:31], v[108:111], v[60:63]
    ds_read_b128 v[80:83], v159 offset:0
    s_add_u32 m0, s74, 36864
    s_mul_i32 s13, s23, 90112
    v_mfma_f32_16x16x32_bf16 v[56:59], a[24:27], v[108:111], v[56:59]
    ds_read_b128 v[84:87], v159 offset:6144
    v_mfma_f32_16x16x32_bf16 v[56:59], a[16:19], v[104:107], v[56:59]
    ds_read_b128 v[88:91], v159 offset:256
    buffer_load_dwordx4 v8, s[44:47], s13 offen offset:0 sc1 lds
    v_mfma_f32_16x16x32_bf16 v[64:67], a[16:19], v[112:115], v[64:67]
    ds_read_b128 v[92:95], v159 offset:6400
    v_cvt_pk_bf16_f32 v225, v226, v227
    v_mfma_f32_16x16x32_bf16 v[64:67], a[24:27], v[116:119], v[64:67]
    ds_read_b128 v[96:99], v159 offset:512
    v_cvt_pk_bf16_f32 v226, v228, v229
    v_mfma_f32_16x16x32_bf16 v[68:71], a[28:31], v[116:119], v[68:71]
    ds_read_b128 v[100:103], v159 offset:6656
    buffer_load_dwordx4 v9, s[44:47], s13 offen offset:1024 sc1 lds
    v_mfma_f32_16x16x32_bf16 v[68:71], a[20:23], v[112:115], v[68:71]
    v_add_u32 v10, 65536, v10
    v_mfma_f32_16x16x32_bf16 v[76:79], a[20:23], v[120:123], v[76:79]
    ds_read_b64_tr_b16 a[0:1], v10 offset:0
    v_cvt_pk_bf16_f32 v227, v230, v231
    v_mfma_f32_16x16x32_bf16 v[76:79], a[28:31], v[124:127], v[76:79]
    ds_read_b64_tr_b16 a[2:3], v10 offset:2048
    buffer_load_dwordx4 v3, s[44:47], s13 offen offset:2048 sc1 lds
    v_mfma_f32_16x16x32_bf16 v[72:75], a[24:27], v[124:127], v[72:75]
    buffer_store_dwordx4 v[224:227], v247, s[44:47], s9 offen offset:1024 sc1
    ds_read_b64_tr_b16 a[8:9], v10 offset:4096
    v_mfma_f32_16x16x32_bf16 v[72:75], a[16:19], v[120:123], v[72:75]
    ds_read_b64_tr_b16 a[10:11], v10 offset:6144
    s_waitcnt lgkmcnt(4)
    v_mfma_f32_16x16x32_bf16 v[32:35], a[32:35], v[80:83], v[32:35]
    s_add_u32 m0, s74, 49152
    s_mul_i32 s13, s24, 90112
    v_mfma_f32_16x16x32_bf16 v[32:35], a[40:43], v[84:87], v[32:35]
    ds_read_b128 v[104:107], v159 offset:768
    v_cvt_pk_bf16_f32 v232, v232, v233
    v_mfma_f32_16x16x32_bf16 v[36:39], a[44:47], v[84:87], v[36:39]
    ds_read_b128 v[108:111], v159 offset:6912
    v_mfma_f32_16x16x32_bf16 v[36:39], a[36:39], v[80:83], v[36:39]
    ds_read_b128 v[112:115], v159 offset:1024
    buffer_load_dwordx4 v8, s[44:47], s13 offen offset:0 sc1 lds
    v_mfma_f32_16x16x32_bf16 v[44:47], a[36:39], v[88:91], v[44:47]
    ds_read_b128 v[116:119], v159 offset:7168
    v_cvt_pk_bf16_f32 v233, v234, v235
    v_mfma_f32_16x16x32_bf16 v[44:47], a[44:47], v[92:95], v[44:47]
    ds_read_b128 v[120:123], v159 offset:1280
    v_cvt_pk_bf16_f32 v234, v236, v237
    v_mfma_f32_16x16x32_bf16 v[40:43], a[40:43], v[92:95], v[40:43]
    ds_read_b128 v[124:127], v159 offset:7424
    buffer_load_dwordx4 v9, s[44:47], s13 offen offset:1024 sc1 lds
    v_mfma_f32_16x16x32_bf16 v[40:43], a[32:35], v[88:91], v[40:43]
    v_add_u32 v11, 65536, v11
    v_mfma_f32_16x16x32_bf16 v[48:51], a[32:35], v[96:99], v[48:51]
    ds_read_b64_tr_b16 a[4:5], v11 offset:0
    v_cvt_pk_bf16_f32 v235, v238, v239
    v_mfma_f32_16x16x32_bf16 v[48:51], a[40:43], v[100:103], v[48:51]
    ds_read_b64_tr_b16 a[6:7], v11 offset:2048
    buffer_load_dwordx4 v3, s[44:47], s13 offen offset:2048 sc1 lds
    v_mfma_f32_16x16x32_bf16 v[52:55], a[44:47], v[100:103], v[52:55]
    buffer_store_dwordx4 v[232:235], v247, s[44:47], s9 offen offset:2048 sc1
    ds_read_b64_tr_b16 a[12:13], v11 offset:4096
    v_mfma_f32_16x16x32_bf16 v[52:55], a[36:39], v[96:99], v[52:55]
    ds_read_b64_tr_b16 a[14:15], v11 offset:6144
    s_waitcnt lgkmcnt(4)
    v_mfma_f32_16x16x32_bf16 v[60:63], a[36:39], v[104:107], v[60:63]
    s_waitcnt vmcnt(19)
    s_barrier
    v_mfma_f32_16x16x32_bf16 v[60:63], a[44:47], v[108:111], v[60:63]
    ds_read_b128 v[80:83], v159 offset:12288
    s_add_u32 m0, s74, 61440
    s_mul_i32 s13, s25, 90112
    v_mfma_f32_16x16x32_bf16 v[56:59], a[40:43], v[108:111], v[56:59]
    ds_read_b128 v[84:87], v159 offset:18432
    v_mfma_f32_16x16x32_bf16 v[56:59], a[32:35], v[104:107], v[56:59]
    ds_read_b128 v[88:91], v159 offset:12544
    buffer_load_dwordx4 v8, s[44:47], s13 offen offset:0 sc1 lds
    v_mfma_f32_16x16x32_bf16 v[64:67], a[32:35], v[112:115], v[64:67]
    ds_read_b128 v[92:95], v159 offset:18688
    v_mfma_f32_16x16x32_bf16 v[64:67], a[40:43], v[116:119], v[64:67]
    ds_read_b128 v[96:99], v159 offset:12800
    v_mfma_f32_16x16x32_bf16 v[68:71], a[44:47], v[116:119], v[68:71]
    ds_read_b128 v[100:103], v159 offset:18944
    buffer_load_dwordx4 v9, s[44:47], s13 offen offset:1024 sc1 lds
    v_mfma_f32_16x16x32_bf16 v[68:71], a[36:39], v[112:115], v[68:71]
    v_mfma_f32_16x16x32_bf16 v[76:79], a[36:39], v[120:123], v[76:79]
    v_mfma_f32_16x16x32_bf16 v[76:79], a[44:47], v[124:127], v[76:79]
    buffer_load_dwordx4 v3, s[44:47], s13 offen offset:2048 sc1 lds
    v_mfma_f32_16x16x32_bf16 v[72:75], a[40:43], v[124:127], v[72:75]
    v_mfma_f32_16x16x32_bf16 v[72:75], a[32:35], v[120:123], v[72:75]
    s_waitcnt lgkmcnt(0)
    v_mfma_f32_16x16x32_bf16 v[32:35], a[48:51], v[80:83], v[32:35]
    s_add_u32 m0, s74, 0
    s_mul_i32 s13, s26, 90112
    v_bfe_u32 v24, v2, 2, 2
    v_mfma_f32_16x16x32_bf16 v[32:35], a[56:59], v[84:87], v[32:35]
    ds_read_b128 v[104:107], v159 offset:13056
    v_mfma_f32_16x16x32_bf16 v[36:39], a[60:63], v[84:87], v[36:39]
    ds_read_b128 v[108:111], v159 offset:19200
    v_lshrrev_b32 v25, 4, v2
    v_mfma_f32_16x16x32_bf16 v[36:39], a[52:55], v[80:83], v[36:39]
    ds_read_b128 v[112:115], v159 offset:13312
    buffer_load_dwordx4 v8, s[44:47], s13 offen offset:0 sc1 lds
    v_mfma_f32_16x16x32_bf16 v[44:47], a[52:55], v[88:91], v[44:47]
    ds_read_b128 v[116:119], v159 offset:19456
    v_cmp_eq_u32 vcc, v24, v25
    v_mfma_f32_16x16x32_bf16 v[44:47], a[60:63], v[92:95], v[44:47]
    ds_read_b128 v[120:123], v159 offset:13568
    v_and_b32 v24, 1, v2
    v_mfma_f32_16x16x32_bf16 v[40:43], a[56:59], v[92:95], v[40:43]
    ds_read_b128 v[124:127], v159 offset:19712
    buffer_load_dwordx4 v9, s[44:47], s13 offen offset:1024 sc1 lds
    v_mfma_f32_16x16x32_bf16 v[40:43], a[48:51], v[88:91], v[40:43]
    v_lshlrev_b32 v24, 4, v24
    v_mfma_f32_16x16x32_bf16 v[48:51], a[48:51], v[96:99], v[48:51]
    v_mov_b32 v25, 0x3f80
    v_mfma_f32_16x16x32_bf16 v[48:51], a[56:59], v[100:103], v[48:51]
    buffer_load_dwordx4 v3, s[44:47], s13 offen offset:2048 sc1 lds
    v_lshlrev_b32 v24, v24, v25
    v_mfma_f32_16x16x32_bf16 v[52:55], a[60:63], v[100:103], v[52:55]
    v_mfma_f32_16x16x32_bf16 v[52:55], a[52:55], v[96:99], v[52:55]
    v_cndmask_b32 v24, 0, v24, vcc
    s_waitcnt lgkmcnt(0)
    v_mfma_f32_16x16x32_bf16 v[60:63], a[52:55], v[104:107], v[60:63]
    s_waitcnt vmcnt(18)
    s_barrier
    v_and_b32 v25, 2, v2
    v_mfma_f32_16x16x32_bf16 v[60:63], a[60:63], v[108:111], v[60:63]
    ds_read_b128 v[80:83], v159 offset:24576
    s_add_u32 m0, s74, 12288
    s_mul_i32 s13, s27, 90112
    v_mfma_f32_16x16x32_bf16 v[56:59], a[56:59], v[108:111], v[56:59]
    ds_read_b128 v[84:87], v159 offset:30720
    v_cmp_eq_u32 vcc, 0, v25
    v_mfma_f32_16x16x32_bf16 v[56:59], a[48:51], v[104:107], v[56:59]
    ds_read_b128 v[88:91], v159 offset:24832
    buffer_load_dwordx4 v8, s[44:47], s13 offen offset:0 sc1 lds
    v_mfma_f32_16x16x32_bf16 v[64:67], a[48:51], v[112:115], v[64:67]
    ds_read_b128 v[92:95], v159 offset:30976
    v_cndmask_b32 v130, 0, v24, vcc
    v_mfma_f32_16x16x32_bf16 v[64:67], a[56:59], v[116:119], v[64:67]
    ds_read_b128 v[96:99], v159 offset:25088
    v_cndmask_b32 v131, v24, 0, vcc
    v_mfma_f32_16x16x32_bf16 v[68:71], a[60:63], v[116:119], v[68:71]
    ds_read_b128 v[100:103], v159 offset:31232
    buffer_load_dwordx4 v9, s[44:47], s13 offen offset:1024 sc1 lds
    v_mfma_f32_16x16x32_bf16 v[68:71], a[52:55], v[112:115], v[68:71]
    v_add_u32 v10, -65536, v10
    v_mov_b32 v128, 0
    v_mfma_f32_16x16x32_bf16 v[76:79], a[52:55], v[120:123], v[76:79]
    ds_read_b64_tr_b16 a[16:17], v10 offset:0
    v_mov_b32 v129, 0
    v_mfma_f32_16x16x32_bf16 v[76:79], a[60:63], v[124:127], v[76:79]
    ds_read_b64_tr_b16 a[18:19], v10 offset:2048
    buffer_load_dwordx4 v3, s[44:47], s13 offen offset:2048 sc1 lds
    v_mov_b32 v132, 0
    v_mfma_f32_16x16x32_bf16 v[72:75], a[56:59], v[124:127], v[72:75]
    ds_read_b64_tr_b16 a[24:25], v10 offset:4096
    v_mov_b32 v133, 0
    v_mfma_f32_16x16x32_bf16 v[72:75], a[48:51], v[120:123], v[72:75]
    ds_read_b64_tr_b16 a[26:27], v10 offset:6144
    s_waitcnt lgkmcnt(4)
    v_mfma_f32_16x16x32_bf16 v[32:35], a[64:67], v[80:83], v[32:35]
    s_add_u32 m0, s73, 16384
    s_lshl_b32 s14, s86, 18
    v_mfma_f32_16x16x32_bf16 v[32:35], a[72:75], v[84:87], v[32:35]
    ds_read_b128 v[104:107], v159 offset:25344
    v_mfma_f32_16x16x32_bf16 v[36:39], a[76:79], v[84:87], v[36:39]
    ds_read_b128 v[108:111], v159 offset:31488
    buffer_load_dwordx4 v4, s[52:55], s14 offen offset:0 lds
    v_mfma_f32_16x16x32_bf16 v[36:39], a[68:71], v[80:83], v[36:39]
    ds_read_b128 v[112:115], v159 offset:25600
    v_mfma_f32_16x16x32_bf16 v[44:47], a[68:71], v[88:91], v[44:47]
    ds_read_b128 v[116:119], v159 offset:31744
    buffer_load_dwordx4 v5, s[52:55], s14 offen offset:1024 lds
    v_mfma_f32_16x16x32_bf16 v[44:47], a[76:79], v[92:95], v[44:47]
    ds_read_b128 v[120:123], v159 offset:25856
    v_mfma_f32_16x16x32_bf16 v[40:43], a[72:75], v[92:95], v[40:43]
    ds_read_b128 v[124:127], v159 offset:32000
    v_mfma_f32_16x16x32_bf16 v[40:43], a[64:67], v[88:91], v[40:43]
    buffer_load_dwordx4 v6, s[52:55], s14 offen offset:2048 lds
    v_add_u32 v11, -65536, v11
    v_mfma_f32_16x16x32_bf16 v[48:51], a[64:67], v[96:99], v[48:51]
    ds_read_b64_tr_b16 a[20:21], v11 offset:0
    v_mfma_f32_16x16x32_bf16 v[48:51], a[72:75], v[100:103], v[48:51]
    ds_read_b64_tr_b16 a[22:23], v11 offset:2048
    buffer_load_dwordx4 v7, s[52:55], s14 offen offset:3072 lds
    v_mfma_f32_16x16x32_bf16 v[52:55], a[76:79], v[100:103], v[52:55]
    ds_read_b64_tr_b16 a[28:29], v11 offset:4096
    v_mfma_f32_16x16x32_bf16 v[52:55], a[68:71], v[96:99], v[52:55]
    ds_read_b64_tr_b16 a[30:31], v11 offset:6144
    s_waitcnt lgkmcnt(4)
    v_mfma_f32_16x16x32_bf16 v[60:63], a[68:71], v[104:107], v[60:63]
    s_waitcnt vmcnt(18)
    s_barrier
    v_mfma_f32_16x16x32_bf16 v[60:63], a[76:79], v[108:111], v[60:63]
    ds_read_b128 v[80:83], v250 offset:0
    v_mfma_f32_16x16x32_bf16 v[56:59], a[72:75], v[108:111], v[56:59]
    ds_read_b128 v[84:87], v250 offset:6144
    v_mfma_f32_16x16x32_bf16 v[56:59], a[64:67], v[104:107], v[56:59]
    ds_read_b128 v[88:91], v250 offset:256
    v_mfma_f32_16x16x32_bf16 v[64:67], a[64:67], v[112:115], v[64:67]
    ds_read_b128 v[92:95], v250 offset:6400
    v_mfma_f32_16x16x32_bf16 v[64:67], a[72:75], v[116:119], v[64:67]
    ds_read_b128 v[96:99], v250 offset:512
    v_mfma_f32_16x16x32_bf16 v[68:71], a[76:79], v[116:119], v[68:71]
    ds_read_b128 v[100:103], v250 offset:6656
    v_mfma_f32_16x16x32_bf16 v[68:71], a[68:71], v[112:115], v[68:71]
    v_mfma_f32_16x16x32_bf16 v[76:79], a[68:71], v[120:123], v[76:79]
    v_mfma_f32_16x16x32_bf16 v[76:79], a[76:79], v[124:127], v[76:79]
    v_mfma_f32_16x16x32_bf16 v[72:75], a[72:75], v[124:127], v[72:75]
    v_mfma_f32_16x16x32_bf16 v[72:75], a[64:67], v[120:123], v[72:75]
    s_waitcnt lgkmcnt(0)
    v_mfma_f32_16x16x32_bf16 v[32:35], a[80:83], v[80:83], v[32:35]
    v_mfma_f32_16x16x32_bf16 v[32:35], a[88:91], v[84:87], v[32:35]
    ds_read_b128 v[104:107], v250 offset:768
    v_mfma_f32_16x16x32_bf16 v[36:39], a[92:95], v[84:87], v[36:39]
    ds_read_b128 v[108:111], v250 offset:6912
    v_mfma_f32_16x16x32_bf16 v[36:39], a[84:87], v[80:83], v[36:39]
    ds_read_b128 v[112:115], v250 offset:1024
    v_mfma_f32_16x16x32_bf16 v[44:47], a[84:87], v[88:91], v[44:47]
    ds_read_b128 v[116:119], v250 offset:7168
    v_mfma_f32_16x16x32_bf16 v[44:47], a[92:95], v[92:95], v[44:47]
    ds_read_b128 v[120:123], v250 offset:1280
    v_mfma_f32_16x16x32_bf16 v[40:43], a[88:91], v[92:95], v[40:43]
    ds_read_b128 v[124:127], v250 offset:7424
    v_mfma_f32_16x16x32_bf16 v[40:43], a[80:83], v[88:91], v[40:43]
    s_waitcnt vmcnt(13)
    buffer_store_dword v249, v248, s[44:47], s6 offen sc1
    v_mfma_f32_16x16x32_bf16 v[48:51], a[80:83], v[96:99], v[48:51]
    v_mfma_f32_16x16x32_bf16 v[48:51], a[88:91], v[100:103], v[48:51]
    v_mfma_f32_16x16x32_bf16 v[52:55], a[92:95], v[100:103], v[52:55]
    v_mfma_f32_16x16x32_bf16 v[52:55], a[84:87], v[96:99], v[52:55]
    s_waitcnt lgkmcnt(0)
    v_mfma_f32_16x16x32_bf16 v[60:63], a[84:87], v[104:107], v[60:63]
    s_barrier
    v_mfma_f32_16x16x32_bf16 v[60:63], a[92:95], v[108:111], v[60:63]
    ds_read_b128 v[80:83], v250 offset:12288
    v_mfma_f32_16x16x32_bf16 v[56:59], a[88:91], v[108:111], v[56:59]
    ds_read_b128 v[84:87], v250 offset:18432
    v_mfma_f32_16x16x32_bf16 v[56:59], a[80:83], v[104:107], v[56:59]
    ds_read_b128 v[88:91], v250 offset:12544
    v_mfma_f32_16x16x32_bf16 v[64:67], a[80:83], v[112:115], v[64:67]
    ds_read_b128 v[92:95], v250 offset:18688
    v_mfma_f32_16x16x32_bf16 v[64:67], a[88:91], v[116:119], v[64:67]
    ds_read_b128 v[96:99], v250 offset:12800
    v_mfma_f32_16x16x32_bf16 v[68:71], a[92:95], v[116:119], v[68:71]
    ds_read_b128 v[100:103], v250 offset:18944
    v_mfma_f32_16x16x32_bf16 v[68:71], a[84:87], v[112:115], v[68:71]
    v_mfma_f32_16x16x32_bf16 v[76:79], a[84:87], v[120:123], v[76:79]
    v_mfma_f32_16x16x32_bf16 v[76:79], a[92:95], v[124:127], v[76:79]
    v_mfma_f32_16x16x32_bf16 v[72:75], a[88:91], v[124:127], v[72:75]
    v_mfma_f32_16x16x32_bf16 v[72:75], a[80:83], v[120:123], v[72:75]
    s_waitcnt lgkmcnt(0)
    v_mfma_f32_16x16x32_bf16 v[32:35], a[96:99], v[80:83], v[32:35]
    v_mfma_f32_16x16x32_bf16 v[32:35], a[104:107], v[84:87], v[32:35]
    ds_read_b128 v[104:107], v250 offset:13056
L_pl_G_4:
    s_cbranch_execz L_wret
    v_mfma_f32_16x16x32_bf16 v[36:39], a[108:111], v[84:87], v[36:39]
    ds_read_b128 v[108:111], v250 offset:19200
    v_mfma_f32_16x16x32_bf16 v[36:39], a[100:103], v[80:83], v[36:39]
    ds_read_b128 v[112:115], v250 offset:13312
    v_mfma_f32_16x16x32_bf16 v[44:47], a[100:103], v[88:91], v[44:47]
    ds_read_b128 v[116:119], v250 offset:19456
    v_mfma_f32_16x16x32_bf16 v[44:47], a[108:111], v[92:95], v[44:47]
    ds_read_b128 v[120:123], v250 offset:13568
    v_mfma_f32_16x16x32_bf16 v[40:43], a[104:107], v[92:95], v[40:43]
    ds_read_b128 v[124:127], v250 offset:19712
    v_mfma_f32_16x16x32_bf16 v[40:43], a[96:99], v[88:91], v[40:43]
    v_mfma_f32_16x16x32_bf16 v[48:51], a[96:99], v[96:99], v[48:51]
    v_mfma_f32_16x16x32_bf16 v[48:51], a[104:107], v[100:103], v[48:51]
    v_mfma_f32_16x16x32_bf16 v[52:55], a[108:111], v[100:103], v[52:55]
    v_mfma_f32_16x16x32_bf16 v[52:55], a[100:103], v[96:99], v[52:55]
    s_waitcnt lgkmcnt(0)
    v_mfma_f32_16x16x32_bf16 v[60:63], a[100:103], v[104:107], v[60:63]
    s_waitcnt vmcnt(11)
    s_barrier
    v_mfma_f32_16x16x32_bf16 v[60:63], a[108:111], v[108:111], v[60:63]
    ds_read_b128 v[80:83], v250 offset:24576
    s_add_u32 m0, s74, 24576
    s_mul_i32 s13, s76, 90112
    v_mfma_f32_16x16x32_bf16 v[56:59], a[104:107], v[108:111], v[56:59]
    ds_read_b128 v[84:87], v250 offset:30720
    v_mfma_f32_16x16x32_bf16 v[56:59], a[96:99], v[104:107], v[56:59]
    ds_read_b128 v[88:91], v250 offset:24832
    buffer_load_dwordx4 v8, s[44:47], s13 offen offset:0 sc1 lds
    v_mfma_f32_16x16x32_bf16 v[64:67], a[96:99], v[112:115], v[64:67]
    ds_read_b128 v[92:95], v250 offset:30976
    v_mfma_f32_16x16x32_bf16 v[64:67], a[104:107], v[116:119], v[64:67]
    ds_read_b128 v[96:99], v250 offset:25088
    v_mfma_f32_16x16x32_bf16 v[68:71], a[108:111], v[116:119], v[68:71]
    ds_read_b128 v[100:103], v250 offset:31232
    buffer_load_dwordx4 v9, s[44:47], s13 offen offset:1024 sc1 lds
    v_mfma_f32_16x16x32_bf16 v[68:71], a[100:103], v[112:115], v[68:71]
    v_mfma_f32_16x16x32_bf16 v[76:79], a[100:103], v[120:123], v[76:79]
    v_mfma_f32_16x16x32_bf16 v[76:79], a[108:111], v[124:127], v[76:79]
    buffer_load_dwordx4 v3, s[44:47], s13 offen offset:2048 sc1 lds
    v_mfma_f32_16x16x32_bf16 v[72:75], a[104:107], v[124:127], v[72:75]
    v_mfma_f32_16x16x32_bf16 v[72:75], a[96:99], v[120:123], v[72:75]
    s_waitcnt lgkmcnt(0)
    v_mfma_f32_16x16x32_bf16 v[32:35], a[112:115], v[80:83], v[32:35]
    s_add_u32 m0, s74, 36864
    s_mul_i32 s13, s77, 90112
    v_mfma_f32_16x16x32_bf16 v[32:35], a[120:123], v[84:87], v[32:35]
    ds_read_b128 v[104:107], v250 offset:25344
    v_mfma_f32_16x16x32_bf16 v[36:39], a[124:127], v[84:87], v[36:39]
    ds_read_b128 v[108:111], v250 offset:31488
    v_mfma_f32_16x16x32_bf16 v[36:39], a[116:119], v[80:83], v[36:39]
    ds_read_b128 v[112:115], v250 offset:25600
    buffer_load_dwordx4 v8, s[44:47], s13 offen offset:0 sc1 lds
    v_mfma_f32_16x16x32_bf16 v[44:47], a[116:119], v[88:91], v[44:47]
    ds_read_b128 v[116:119], v250 offset:31744
    v_mfma_f32_16x16x32_bf16 v[44:47], a[124:127], v[92:95], v[44:47]
    ds_read_b128 v[120:123], v250 offset:25856
    v_mfma_f32_16x16x32_bf16 v[40:43], a[120:123], v[92:95], v[40:43]
    ds_read_b128 v[124:127], v250 offset:32000
    buffer_load_dwordx4 v9, s[44:47], s13 offen offset:1024 sc1 lds
    v_mfma_f32_16x16x32_bf16 v[40:43], a[112:115], v[88:91], v[40:43]
    v_mfma_f32_16x16x32_bf16 v[48:51], a[112:115], v[96:99], v[48:51]
    v_mfma_f32_16x16x32_bf16 v[48:51], a[120:123], v[100:103], v[48:51]
    buffer_load_dwordx4 v3, s[44:47], s13 offen offset:2048 sc1 lds
    v_mfma_f32_16x16x32_bf16 v[52:55], a[124:127], v[100:103], v[52:55]
    v_mfma_f32_16x16x32_bf16 v[52:55], a[116:119], v[96:99], v[52:55]
    s_waitcnt lgkmcnt(0)
    v_mfma_f32_16x16x32_bf16 v[60:63], a[116:119], v[104:107], v[60:63]
    s_waitcnt vmcnt(14)
    s_barrier
    v_mfma_f32_16x16x32_bf16 v[60:63], a[124:127], v[108:111], v[60:63]
    ds_read_b128 v[80:83], v159 offset:0
    s_add_u32 m0, s74, 49152
    s_mul_i32 s13, s78, 90112
    v_mfma_f32_16x16x32_bf16 v[56:59], a[120:123], v[108:111], v[56:59]
    ds_read_b128 v[84:87], v159 offset:6144
    v_mfma_f32_16x16x32_bf16 v[56:59], a[112:115], v[104:107], v[56:59]
    ds_read_b128 v[88:91], v159 offset:256
    buffer_load_dwordx4 v8, s[44:47], s13 offen offset:0 sc1 lds
    v_mfma_f32_16x16x32_bf16 v[64:67], a[112:115], v[112:115], v[64:67]
    ds_read_b128 v[92:95], v159 offset:6400
    v_mfma_f32_16x16x32_bf16 v[64:67], a[120:123], v[116:119], v[64:67]
    ds_read_b128 v[96:99], v159 offset:512
    v_mfma_f32_16x16x32_bf16 v[68:71], a[124:127], v[116:119], v[68:71]
    ds_read_b128 v[100:103], v159 offset:6656
    buffer_load_dwordx4 v9, s[44:47], s13 offen offset:1024 sc1 lds
    v_mfma_f32_16x16x32_bf16 v[68:71], a[116:119], v[112:115], v[68:71]
    v_mfma_f32_16x16x32_bf16 v[76:79], a[116:119], v[120:123], v[76:79]
    v_mfma_f32_16x16x32_bf16 v[76:79], a[124:127], v[124:127], v[76:79]
    buffer_load_dwordx4 v3, s[44:47], s13 offen offset:2048 sc1 lds
    v_mfma_f32_16x16x32_bf16 v[72:75], a[120:123], v[124:127], v[72:75]
    v_mfma_f32_16x16x32_bf16 v[72:75], a[112:115], v[120:123], v[72:75]
    s_waitcnt lgkmcnt(0)
    v_mfma_f32_16x16x32_bf16 v[32:35], a[128:131], v[80:83], v[32:35]
    s_add_u32 m0, s74, 61440
    s_mul_i32 s13, s79, 90112
    v_mfma_f32_16x16x32_bf16 v[32:35], a[136:139], v[84:87], v[32:35]
    ds_read_b128 v[104:107], v159 offset:768
    v_mfma_f32_16x16x32_bf16 v[36:39], a[140:143], v[84:87], v[36:39]
    ds_read_b128 v[108:111], v159 offset:6912
    v_mfma_f32_16x16x32_bf16 v[36:39], a[132:135], v[80:83], v[36:39]
    ds_read_b128 v[112:115], v159 offset:1024
    buffer_load_dwordx4 v8, s[44:47], s13 offen offset:0 sc1 lds
    v_mfma_f32_16x16x32_bf16 v[44:47], a[132:135], v[88:91], v[44:47]
    ds_read_b128 v[116:119], v159 offset:7168
    v_mfma_f32_16x16x32_bf16 v[44:47], a[140:143], v[92:95], v[44:47]
    ds_read_b128 v[120:123], v159 offset:1280
    v_mfma_f32_16x16x32_bf16 v[40:43], a[136:139], v[92:95], v[40:43]
    ds_read_b128 v[124:127], v159 offset:7424
    buffer_load_dwordx4 v9, s[44:47], s13 offen offset:1024 sc1 lds
    v_mfma_f32_16x16x32_bf16 v[40:43], a[128:131], v[88:91], v[40:43]
    v_mfma_f32_16x16x32_bf16 v[48:51], a[128:131], v[96:99], v[48:51]
    v_mfma_f32_16x16x32_bf16 v[48:51], a[136:139], v[100:103], v[48:51]
    buffer_load_dwordx4 v3, s[44:47], s13 offen offset:2048 sc1 lds
    v_mfma_f32_16x16x32_bf16 v[52:55], a[140:143], v[100:103], v[52:55]
    v_mfma_f32_16x16x32_bf16 v[52:55], a[132:135], v[96:99], v[52:55]
    s_waitcnt lgkmcnt(0)
    v_mfma_f32_16x16x32_bf16 v[60:63], a[132:135], v[104:107], v[60:63]
    s_waitcnt vmcnt(13)
    s_barrier
    v_mfma_f32_16x16x32_bf16 v[60:63], a[140:143], v[108:111], v[60:63]
    ds_read_b128 v[80:83], v159 offset:12288
    s_add_u32 m0, s74, 0
    s_mul_i32 s13, s80, 90112
    v_mfma_f32_16x16x32_bf16 v[56:59], a[136:139], v[108:111], v[56:59]
    ds_read_b128 v[84:87], v159 offset:18432
    v_mfma_f32_16x16x32_bf16 v[56:59], a[128:131], v[104:107], v[56:59]
    ds_read_b128 v[88:91], v159 offset:12544
    buffer_load_dwordx4 v8, s[44:47], s13 offen offset:0 sc1 lds
    v_mfma_f32_16x16x32_bf16 v[64:67], a[128:131], v[112:115], v[64:67]
    ds_read_b128 v[92:95], v159 offset:18688
    v_mfma_f32_16x16x32_bf16 v[64:67], a[136:139], v[116:119], v[64:67]
    ds_read_b128 v[96:99], v159 offset:12800
    buffer_load_dword v29, v28, s[44:47], 0 offen sc1
    v_mfma_f32_16x16x32_bf16 v[68:71], a[140:143], v[116:119], v[68:71]
    ds_read_b128 v[100:103], v159 offset:18944
    buffer_load_dwordx4 v9, s[44:47], s13 offen offset:1024 sc1 lds
    v_mfma_f32_16x16x32_bf16 v[68:71], a[132:135], v[112:115], v[68:71]
    ds_read_b64_tr_b16 a[32:33], v10 offset:16384
    v_mfma_f32_16x16x32_bf16 v[76:79], a[132:135], v[120:123], v[76:79]
    ds_read_b64_tr_b16 a[34:35], v10 offset:18432
    v_mfma_f32_16x16x32_bf16 v[76:79], a[140:143], v[124:127], v[76:79]
    buffer_load_dwordx4 v3, s[44:47], s13 offen offset:2048 sc1 lds
    v_mfma_f32_16x16x32_bf16 v[72:75], a[136:139], v[124:127], v[72:75]
    ds_read_b64_tr_b16 a[40:41], v10 offset:20480
    v_mfma_f32_16x16x32_bf16 v[72:75], a[128:131], v[120:123], v[72:75]
    ds_read_b64_tr_b16 a[42:43], v10 offset:22528
    s_waitcnt lgkmcnt(4)
    v_mfma_f32_16x16x32_bf16 v[32:35], a[144:147], v[80:83], v[32:35]
    s_add_u32 m0, s73, 32768
    s_lshl_b32 s14, s87, 18
    v_mfma_f32_16x16x32_bf16 v[32:35], a[152:155], v[84:87], v[32:35]
    ds_read_b128 v[104:107], v159 offset:13056
    v_mfma_f32_16x16x32_bf16 v[36:39], a[156:159], v[84:87], v[36:39]
    ds_read_b128 v[108:111], v159 offset:19200
    buffer_load_dwordx4 v4, s[52:55], s14 offen offset:0 lds
    v_mfma_f32_16x16x32_bf16 v[36:39], a[148:151], v[80:83], v[36:39]
    ds_read_b128 v[112:115], v159 offset:13312
    v_mfma_f32_16x16x32_bf16 v[44:47], a[148:151], v[88:91], v[44:47]
    ds_read_b128 v[116:119], v159 offset:19456
    buffer_load_dwordx4 v5, s[52:55], s14 offen offset:1024 lds
    v_mfma_f32_16x16x32_bf16 v[44:47], a[156:159], v[92:95], v[44:47]
    ds_read_b128 v[120:123], v159 offset:13568
    v_mfma_f32_16x16x32_bf16 v[40:43], a[152:155], v[92:95], v[40:43]
    ds_read_b128 v[124:127], v159 offset:19712
    v_mfma_f32_16x16x32_bf16 v[40:43], a[144:147], v[88:91], v[40:43]
    ds_read_b64_tr_b16 a[36:37], v11 offset:16384
    buffer_load_dwordx4 v6, s[52:55], s14 offen offset:2048 lds
    v_mfma_f32_16x16x32_bf16 v[48:51], a[144:147], v[96:99], v[48:51]
    ds_read_b64_tr_b16 a[38:39], v11 offset:18432
    v_mfma_f32_16x16x32_bf16 v[48:51], a[152:155], v[100:103], v[48:51]
    buffer_load_dwordx4 v7, s[52:55], s14 offen offset:3072 lds
    v_mfma_f32_16x16x32_bf16 v[52:55], a[156:159], v[100:103], v[52:55]
    ds_read_b64_tr_b16 a[44:45], v11 offset:20480
    v_mfma_f32_16x16x32_bf16 v[52:55], a[148:151], v[96:99], v[52:55]
    ds_read_b64_tr_b16 a[46:47], v11 offset:22528
    s_waitcnt lgkmcnt(4)
    v_mfma_f32_16x16x32_bf16 v[60:63], a[148:151], v[104:107], v[60:63]
    s_waitcnt vmcnt(17)
    s_barrier
    v_mfma_f32_16x16x32_bf16 v[60:63], a[156:159], v[108:111], v[60:63]
    ds_read_b128 v[80:83], v159 offset:24576
    v_mfma_f32_16x16x32_bf16 v[56:59], a[152:155], v[108:111], v[56:59]
    ds_read_b128 v[84:87], v159 offset:30720
    v_mfma_f32_16x16x32_bf16 v[56:59], a[144:147], v[104:107], v[56:59]
    ds_read_b128 v[88:91], v159 offset:24832
    v_mfma_f32_16x16x32_bf16 v[64:67], a[144:147], v[112:115], v[64:67]
    ds_read_b128 v[92:95], v159 offset:30976
    v_mfma_f32_16x16x32_bf16 v[64:67], a[152:155], v[116:119], v[64:67]
    ds_read_b128 v[96:99], v159 offset:25088
    v_mfma_f32_16x16x32_bf16 v[68:71], a[156:159], v[116:119], v[68:71]
    ds_read_b128 v[100:103], v159 offset:31232
    v_mfma_f32_16x16x32_bf16 v[68:71], a[148:151], v[112:115], v[68:71]
    v_mfma_f32_16x16x32_bf16 v[76:79], a[148:151], v[120:123], v[76:79]
    v_mfma_f32_16x16x32_bf16 v[76:79], a[156:159], v[124:127], v[76:79]
    v_mfma_f32_16x16x32_bf16 v[72:75], a[152:155], v[124:127], v[72:75]
    v_mfma_f32_16x16x32_bf16 v[72:75], a[144:147], v[120:123], v[72:75]
    s_waitcnt lgkmcnt(0)
    v_mfma_f32_16x16x32_bf16 v[32:35], a[160:163], v[80:83], v[32:35]
    v_mfma_f32_16x16x32_bf16 v[32:35], a[168:171], v[84:87], v[32:35]
    ds_read_b128 v[104:107], v159 offset:25344
    v_mfma_f32_16x16x32_bf16 v[36:39], a[172:175], v[84:87], v[36:39]
    ds_read_b128 v[108:111], v159 offset:31488
    v_mfma_f32_16x16x32_bf16 v[36:39], a[164:167], v[80:83], v[36:39]
    ds_read_b128 v[112:115], v159 offset:25600
    v_mfma_f32_16x16x32_bf16 v[44:47], a[164:167], v[88:91], v[44:47]
    ds_read_b128 v[116:119], v159 offset:31744
    v_mfma_f32_16x16x32_bf16 v[44:47], a[172:175], v[92:95], v[44:47]
    ds_read_b128 v[120:123], v159 offset:25856
    v_mfma_f32_16x16x32_bf16 v[40:43], a[168:171], v[92:95], v[40:43]
    ds_read_b128 v[124:127], v159 offset:32000
    v_mfma_f32_16x16x32_bf16 v[40:43], a[160:163], v[88:91], v[40:43]
    v_mfma_f32_16x16x32_bf16 v[48:51], a[160:163], v[96:99], v[48:51]
    v_mfma_f32_16x16x32_bf16 v[48:51], a[168:171], v[100:103], v[48:51]
    v_mfma_f32_16x16x32_bf16 v[52:55], a[172:175], v[100:103], v[52:55]
    v_mfma_f32_16x16x32_bf16 v[52:55], a[164:167], v[96:99], v[52:55]
    s_waitcnt lgkmcnt(0)
    v_mfma_f32_16x16x32_bf16 v[60:63], a[164:167], v[104:107], v[60:63]
    s_waitcnt vmcnt(14)
    s_barrier
    v_mfma_f32_16x16x32_bf16 v[60:63], a[172:175], v[108:111], v[60:63]
    ds_read_b128 v[80:83], v250 offset:0
    s_waitcnt vmcnt(6)
    v_mfma_f32_16x16x32_bf16 v[56:59], a[168:171], v[108:111], v[56:59]
    ds_read_b128 v[84:87], v250 offset:6144
    v_cmp_ne_u32 vcc, s68, v29
    v_mfma_f32_16x16x32_bf16 v[56:59], a[160:163], v[104:107], v[56:59]
    ds_read_b128 v[88:91], v250 offset:256
    v_mfma_f32_16x16x32_bf16 v[64:67], a[160:163], v[112:115], v[64:67]
    ds_read_b128 v[92:95], v250 offset:6400
    v_mfma_f32_16x16x32_bf16 v[64:67], a[168:171], v[116:119], v[64:67]
    ds_read_b128 v[96:99], v250 offset:512
    s_cbranch_vccnz L_rs_p5
L_ok_p5:
    v_mfma_f32_16x16x32_bf16 v[68:71], a[172:175], v[116:119], v[68:71]
    ds_read_b128 v[100:103], v250 offset:6656
    buffer_load_dwordx4 v[160:163], v246, s[44:47], s10 offen offset:0 sc1
    v_mfma_f32_16x16x32_bf16 v[68:71], a[164:167], v[112:115], v[68:71]
    v_mfma_f32_16x16x32_bf16 v[76:79], a[164:167], v[120:123], v[76:79]
    v_mfma_f32_16x16x32_bf16 v[76:79], a[172:175], v[124:127], v[76:79]
    buffer_load_dwordx4 v[164:167], v246, s[44:47], s10 offen offset:1024 sc1
    v_mfma_f32_16x16x32_bf16 v[72:75], a[168:171], v[124:127], v[72:75]
    buffer_load_dwordx4 v[168:171], v246, s[44:47], s10 offen offset:2048 sc1
    v_mfma_f32_16x16x32_bf16 v[72:75], a[160:163], v[120:123], v[72:75]
    s_waitcnt lgkmcnt(0)
    v_mfma_f32_16x16x32_bf16 v[32:35], a[176:179], v[80:83], v[32:35]
    v_mfma_f32_16x16x32_bf16 v[32:35], a[184:187], v[84:87], v[32:35]
    ds_read_b128 v[104:107], v250 offset:768
    v_mfma_f32_16x16x32_bf16 v[36:39], a[188:191], v[84:87], v[36:39]
    ds_read_b128 v[108:111], v250 offset:6912
    buffer_load_dwordx4 v[172:175], v247, s[44:47], s10 offen offset:0 sc1
    v_mfma_f32_16x16x32_bf16 v[36:39], a[180:183], v[80:83], v[36:39]
    ds_read_b128 v[112:115], v250 offset:1024
    v_mfma_f32_16x16x32_bf16 v[44:47], a[180:183], v[88:91], v[44:47]
    ds_read_b128 v[116:119], v250 offset:7168
    v_mfma_f32_16x16x32_bf16 v[44:47], a[188:191], v[92:95], v[44:47]
    ds_read_b128 v[120:123], v250 offset:1280
    buffer_load_dwordx4 v[176:179], v247, s[44:47], s10 offen offset:1024 sc1
    v_mfma_f32_16x16x32_bf16 v[40:43], a[184:187], v[92:95], v[40:43]
    ds_read_b128 v[124:127], v250 offset:7424
    v_mfma_f32_16x16x32_bf16 v[40:43], a[176:179], v[88:91], v[40:43]
    v_mfma_f32_16x16x32_bf16 v[48:51], a[176:179], v[96:99], v[48:51]
    v_mfma_f32_16x16x32_bf16 v[48:51], a[184:187], v[100:103], v[48:51]
    v_mfma_f32_16x16x32_bf16 v[52:55], a[188:191], v[100:103], v[52:55]
    buffer_load_dwordx4 v[180:183], v247, s[44:47], s10 offen offset:2048 sc1
    v_mfma_f32_16x16x32_bf16 v[52:55], a[180:183], v[96:99], v[52:55]
    s_waitcnt lgkmcnt(0)
    v_mfma_f32_16x16x32_bf16 v[60:63], a[180:183], v[104:107], v[60:63]
    s_barrier
    v_mfma_f32_16x16x32_bf16 v[60:63], a[188:191], v[108:111], v[60:63]
    ds_read_b128 v[80:83], v250 offset:12288
    s_add_u32 m0, s74, 12288
    s_mul_i32 s13, s81, 90112
    v_mfma_f32_16x16x32_bf16 v[56:59], a[184:187], v[108:111], v[56:59]
    ds_read_b128 v[84:87], v250 offset:18432
    v_mfma_f32_16x16x32_bf16 v[56:59], a[176:179], v[104:107], v[56:59]
    ds_read_b128 v[88:91], v250 offset:12544
    buffer_load_dwordx4 v8, s[44:47], s13 offen offset:0 sc1 lds
    v_mfma_f32_16x16x32_bf16 v[64:67], a[176:179], v[112:115], v[64:67]
    ds_read_b128 v[92:95], v250 offset:18688
    v_mfma_f32_16x16x32_bf16 v[64:67], a[184:187], v[116:119], v[64:67]
    ds_read_b128 v[96:99], v250 offset:12800
    v_mfma_f32_16x16x32_bf16 v[68:71], a[188:191], v[116:119], v[68:71]
    ds_read_b128 v[100:103], v250 offset:18944
    buffer_load_dwordx4 v9, s[44:47], s13 offen offset:1024 sc1 lds
    v_mfma_f32_16x16x32_bf16 v[68:71], a[180:183], v[112:115], v[68:71]
    v_mfma_f32_16x16x32_bf16 v[76:79], a[180:183], v[120:123], v[76:79]
    v_mfma_f32_16x16x32_bf16 v[76:79], a[188:191], v[124:127], v[76:79]
    buffer_load_dwordx4 v3, s[44:47], s13 offen offset:2048 sc1 lds
    v_mfma_f32_16x16x32_bf16 v[72:75], a[184:187], v[124:127], v[72:75]
    v_mfma_f32_16x16x32_bf16 v[72:75], a[176:179], v[120:123], v[72:75]
    s_waitcnt lgkmcnt(0)
    v_mfma_f32_16x16x32_bf16 v[32:35], a[192:195], v[80:83], v[32:35]
    s_add_u32 m0, s73, 49152
    s_lshl_b32 s14, s88, 18
    v_mfma_f32_16x16x32_bf16 v[32:35], a[200:203], v[84:87], v[32:35]
    ds_read_b128 v[104:107], v250 offset:13056
    v_mfma_f32_16x16x32_bf16 v[36:39], a[204:207], v[84:87], v[36:39]
    ds_read_b128 v[108:111], v250 offset:19200
    buffer_load_dwordx4 v4, s[52:55], s14 offen offset:0 lds
    v_mfma_f32_16x16x32_bf16 v[36:39], a[196:199], v[80:83], v[36:39]
    ds_read_b128 v[112:115], v250 offset:13312
    v_mfma_f32_16x16x32_bf16 v[44:47], a[196:199], v[88:91], v[44:47]
    ds_read_b128 v[116:119], v250 offset:19456
    buffer_load_dwordx4 v5, s[52:55], s14 offen offset:1024 lds
    v_mfma_f32_16x16x32_bf16 v[44:47], a[204:207], v[92:95], v[44:47]
    ds_read_b128 v[120:123], v250 offset:13568
    v_mfma_f32_16x16x32_bf16 v[40:43], a[200:203], v[92:95], v[40:43]
    ds_read_b128 v[124:127], v250 offset:19712
    v_mfma_f32_16x16x32_bf16 v[40:43], a[192:195], v[88:91], v[40:43]
    buffer_load_dwordx4 v6, s[52:55], s14 offen offset:2048 lds
    v_mfma_f32_16x16x32_bf16 v[48:51], a[192:195], v[96:99], v[48:51]
    v_mfma_f32_16x16x32_bf16 v[48:51], a[200:203], v[100:103], v[48:51]
    buffer_load_dwordx4 v7, s[52:55], s14 offen offset:3072 lds
    v_mfma_f32_16x16x32_bf16 v[52:55], a[204:207], v[100:103], v[52:55]
    v_mfma_f32_16x16x32_bf16 v[52:55], a[196:199], v[96:99], v[52:55]
    s_waitcnt lgkmcnt(0)
    v_mfma_f32_16x16x32_bf16 v[60:63], a[196:199], v[104:107], v[60:63]
    s_barrier
    v_mfma_f32_16x16x32_bf16 v[60:63], a[204:207], v[108:111], v[60:63]
    ds_read_b128 v[80:83], v250 offset:24576
    v_mfma_f32_16x16x32_bf16 v[56:59], a[200:203], v[108:111], v[56:59]
    ds_read_b128 v[84:87], v250 offset:30720
    v_mfma_f32_16x16x32_bf16 v[56:59], a[192:195], v[104:107], v[56:59]
    ds_read_b128 v[88:91], v250 offset:24832
    v_mfma_f32_16x16x32_bf16 v[64:67], a[192:195], v[112:115], v[64:67]
    ds_read_b128 v[92:95], v250 offset:30976
    v_mfma_f32_16x16x32_bf16 v[64:67], a[200:203], v[116:119], v[64:67]
    ds_read_b128 v[96:99], v250 offset:25088
    v_mfma_f32_16x16x32_bf16 v[68:71], a[204:207], v[116:119], v[68:71]
    ds_read_b128 v[100:103], v250 offset:31232
    v_mfma_f32_16x16x32_bf16 v[68:71], a[196:199], v[112:115], v[68:71]
    v_mfma_f32_16x16x32_bf16 v[76:79], a[196:199], v[120:123], v[76:79]
    v_mfma_f32_16x16x32_bf16 v[76:79], a[204:207], v[124:127], v[76:79]
    v_mfma_f32_16x16x32_bf16 v[72:75], a[200:203], v[124:127], v[72:75]
    v_mfma_f32_16x16x32_bf16 v[72:75], a[192:195], v[120:123], v[72:75]
    s_waitcnt lgkmcnt(0)
    v_mfma_f32_16x16x32_bf16 v[32:35], a[208:211], v[80:83], v[32:35]
    s_add_u32 m0, s73, 65536
    s_lshl_b32 s14, s89, 18
    v_mfma_f32_16x16x32_bf16 v[32:35], a[216:219], v[84:87], v[32:35]
    ds_read_b128 v[104:107], v250 offset:25344
    v_mfma_f32_16x16x32_bf16 v[36:39], a[220:223], v[84:87], v[36:39]
    ds_read_b128 v[108:111], v250 offset:31488
    buffer_load_dwordx4 v4, s[52:55], s14 offen offset:0 lds
    v_mfma_f32_16x16x32_bf16 v[36:39], a[212:215], v[80:83], v[36:39]
    ds_read_b128 v[112:115], v250 offset:25600
    v_mfma_f32_16x16x32_bf16 v[44:47], a[212:215], v[88:91], v[44:47]
    ds_read_b128 v[116:119], v250 offset:31744
    buffer_load_dwordx4 v5, s[52:55], s14 offen offset:1024 lds
    v_mfma_f32_16x16x32_bf16 v[44:47], a[220:223], v[92:95], v[44:47]
    ds_read_b128 v[120:123], v250 offset:25856
    v_mfma_f32_16x16x32_bf16 v[40:43], a[216:219], v[92:95], v[40:43]
    ds_read_b128 v[124:127], v250 offset:32000
    v_mfma_f32_16x16x32_bf16 v[40:43], a[208:211], v[88:91], v[40:43]
    buffer_load_dwordx4 v6, s[52:55], s14 offen offset:2048 lds
    v_mfma_f32_16x16x32_bf16 v[48:51], a[208:211], v[96:99], v[48:51]
    v_mfma_f32_16x16x32_bf16 v[48:51], a[216:219], v[100:103], v[48:51]
    buffer_load_dwordx4 v7, s[52:55], s14 offen offset:3072 lds
    v_mfma_f32_16x16x32_bf16 v[52:55], a[220:223], v[100:103], v[52:55]
    v_mfma_f32_16x16x32_bf16 v[52:55], a[212:215], v[96:99], v[52:55]
    s_waitcnt lgkmcnt(0)
    v_mfma_f32_16x16x32_bf16 v[60:63], a[212:215], v[104:107], v[60:63]
    s_waitcnt vmcnt(17)
    s_barrier
    v_mfma_f32_16x16x32_bf16 v[60:63], a[220:223], v[108:111], v[60:63]
    ds_read_b128 v[80:83], v159 offset:0
    v_mfma_f32_16x16x32_bf16 v[56:59], a[216:219], v[108:111], v[56:59]
    ds_read_b128 v[84:87], v159 offset:6144
    v_mfma_f32_16x16x32_bf16 v[56:59], a[208:211], v[104:107], v[56:59]
    ds_read_b128 v[88:91], v159 offset:256
    v_mfma_f32_16x16x32_bf16 v[64:67], a[208:211], v[112:115], v[64:67]
    ds_read_b128 v[92:95], v159 offset:6400
    v_mfma_f32_16x16x32_bf16 v[64:67], a[216:219], v[116:119], v[64:67]
    ds_read_b128 v[96:99], v159 offset:512
    v_mfma_f32_16x16x32_bf16 v[68:71], a[220:223], v[116:119], v[68:71]
    ds_read_b128 v[100:103], v159 offset:6656
    v_mfma_f32_16x16x32_bf16 v[68:71], a[212:215], v[112:115], v[68:71]
    ds_read_b64_tr_b16 a[48:49], v10 offset:32768
    v_mfma_f32_16x16x32_bf16 v[76:79], a[212:215], v[120:123], v[76:79]
    ds_read_b64_tr_b16 a[50:51], v10 offset:34816
    v_mfma_f32_16x16x32_bf16 v[76:79], a[220:223], v[124:127], v[76:79]
    v_mfma_f32_16x16x32_bf16 v[72:75], a[216:219], v[124:127], v[72:75]
    ds_read_b64_tr_b16 a[56:57], v10 offset:36864
    v_mfma_f32_16x16x32_bf16 v[72:75], a[208:211], v[120:123], v[72:75]
    ds_read_b64_tr_b16 a[58:59], v10 offset:38912
    s_waitcnt lgkmcnt(4)
    v_mfma_f32_16x16x32_bf16 v[32:35], a[224:227], v[80:83], v[32:35]
    s_add_u32 m0, s73, 0
    s_lshl_b32 s14, s90, 18
    v_mfma_f32_16x16x32_bf16 v[32:35], a[232:235], v[84:87], v[32:35]
    ds_read_b128 v[104:107], v159 offset:768
    v_mfma_f32_16x16x32_bf16 v[36:39], a[236:239], v[84:87], v[36:39]
    ds_read_b128 v[108:111], v159 offset:6912
    buffer_load_dwordx4 v4, s[52:55], s14 offen offset:0 lds
    v_mfma_f32_16x16x32_bf16 v[36:39], a[228:231], v[80:83], v[36:39]
    ds_read_b128 v[112:115], v159 offset:1024
    v_mfma_f32_16x16x32_bf16 v[44:47], a[228:231], v[88:91], v[44:47]
    ds_read_b128 v[116:119], v159 offset:7168
    buffer_load_dwordx4 v5, s[52:55], s14 offen offset:1024 lds
    v_mfma_f32_16x16x32_bf16 v[44:47], a[236:239], v[92:95], v[44:47]
    ds_read_b128 v[120:123], v159 offset:1280
    v_mfma_f32_16x16x32_bf16 v[40:43], a[232:235], v[92:95], v[40:43]
    ds_read_b128 v[124:127], v159 offset:7424
    v_mfma_f32_16x16x32_bf16 v[40:43], a[224:227], v[88:91], v[40:43]
    ds_read_b64_tr_b16 a[52:53], v11 offset:32768
    buffer_load_dwordx4 v6, s[52:55], s14 offen offset:2048 lds
    v_mfma_f32_16x16x32_bf16 v[48:51], a[224:227], v[96:99], v[48:51]
    ds_read_b64_tr_b16 a[54:55], v11 offset:34816
    v_mfma_f32_16x16x32_bf16 v[48:51], a[232:235], v[100:103], v[48:51]
    buffer_load_dwordx4 v7, s[52:55], s14 offen offset:3072 lds
    v_mfma_f32_16x16x32_bf16 v[52:55], a[236:239], v[100:103], v[52:55]
    ds_read_b64_tr_b16 a[60:61], v11 offset:36864
    v_mfma_f32_16x16x32_bf16 v[52:55], a[228:231], v[96:99], v[52:55]
    ds_read_b64_tr_b16 a[62:63], v11 offset:38912
    s_waitcnt lgkmcnt(4)
    v_mfma_f32_16x16x32_bf16 v[60:63], a[228:231], v[104:107], v[60:63]
    s_waitcnt vmcnt(12)
    s_barrier
    v_mfma_f32_16x16x32_bf16 v[60:63], a[236:239], v[108:111], v[60:63]
    ds_read_b128 v[80:83], v159 offset:12288
    v_mfma_f32_16x16x32_bf16 v[56:59], a[232:235], v[108:111], v[56:59]
    ds_read_b128 v[84:87], v159 offset:18432
    v_mfma_f32_16x16x32_bf16 v[56:59], a[224:227], v[104:107], v[56:59]
    ds_read_b128 v[88:91], v159 offset:12544
    v_mfma_f32_16x16x32_bf16 v[64:67], a[224:227], v[112:115], v[64:67]
    ds_read_b128 v[92:95], v159 offset:18688
    v_mfma_f32_16x16x32_bf16 v[64:67], a[232:235], v[116:119], v[64:67]
    ds_read_b128 v[96:99], v159 offset:12800
    v_mfma_f32_16x16x32_bf16 v[68:71], a[236:239], v[116:119], v[68:71]
    ds_read_b128 v[100:103], v159 offset:18944
    v_mfma_f32_16x16x32_bf16 v[68:71], a[228:231], v[112:115], v[68:71]
    v_mfma_f32_16x16x32_bf16 v[76:79], a[228:231], v[120:123], v[76:79]
    v_mfma_f32_16x16x32_bf16 v[76:79], a[236:239], v[124:127], v[76:79]
    v_mfma_f32_16x16x32_bf16 v[72:75], a[232:235], v[124:127], v[72:75]
    v_mfma_f32_16x16x32_bf16 v[72:75], a[224:227], v[120:123], v[72:75]
    s_waitcnt lgkmcnt(0)
    v_mfma_f32_16x16x32_bf16 v[32:35], a[240:243], v[80:83], v[32:35]
    s_add_u32 m0, s73, 16384
    s_lshl_b32 s14, s91, 18
    v_mfma_f32_16x16x32_bf16 v[32:35], a[248:251], v[84:87], v[32:35]
    ds_read_b128 v[104:107], v159 offset:13056
    v_mfma_f32_16x16x32_bf16 v[32:35], v[130:133], v[160:163], v[32:35]
    ds_read_b128 v[108:111], v159 offset:19200
    buffer_load_dwordx4 v4, s[52:55], s14 offen offset:0 lds
    v_mfma_f32_16x16x32_bf16 v[36:39], a[252:255], v[84:87], v[36:39]
    ds_read_b128 v[112:115], v159 offset:13312
    v_mfma_f32_16x16x32_bf16 v[36:39], a[244:247], v[80:83], v[36:39]
    ds_read_b128 v[116:119], v159 offset:19456
    buffer_load_dwordx4 v5, s[52:55], s14 offen offset:1024 lds
    v_mfma_f32_16x16x32_bf16 v[36:39], v[128:131], v[160:163], v[36:39]
    ds_read_b128 v[120:123], v159 offset:13568
    v_mfma_f32_16x16x32_bf16 v[44:47], a[244:247], v[88:91], v[44:47]
    ds_read_b128 v[124:127], v159 offset:19712
    v_mfma_f32_16x16x32_bf16 v[44:47], a[252:255], v[92:95], v[44:47]
    buffer_load_dwordx4 v6, s[52:55], s14 offen offset:2048 lds
    v_mfma_f32_16x16x32_bf16 v[44:47], v[128:131], v[164:167], v[44:47]
    v_mfma_f32_16x16x32_bf16 v[40:43], a[248:251], v[92:95], v[40:43]
    buffer_load_dwordx4 v7, s[52:55], s14 offen offset:3072 lds
    v_mfma_f32_16x16x32_bf16 v[40:43], a[240:243], v[88:91], v[40:43]
    v_mfma_f32_16x16x32_bf16 v[40:43], v[130:133], v[164:167], v[40:43]
    v_mfma_f32_16x16x32_bf16 v[48:51], a[240:243], v[96:99], v[48:51]
    v_mfma_f32_16x16x32_bf16 v[48:51], a[248:251], v[100:103], v[48:51]
    v_mfma_f32_16x16x32_bf16 v[48:51], v[130:133], v[168:171], v[48:51]
    v_mfma_f32_16x16x32_bf16 v[52:55], a[252:255], v[100:103], v[52:55]
    v_mfma_f32_16x16x32_bf16 v[52:55], a[244:247], v[96:99], v[52:55]
    v_mfma_f32_16x16x32_bf16 v[52:55], v[128:131], v[168:171], v[52:55]
    s_waitcnt lgkmcnt(0)
    v_mfma_f32_16x16x32_bf16 v[60:63], a[244:247], v[104:107], v[60:63]
    s_barrier
    v_mfma_f32_16x16x32_bf16 v[60:63], a[252:255], v[108:111], v[60:63]
    s_add_u32 m0, s73, 131072
    s_lshl_b32 s14, s92, 18
    v_mfma_f32_16x16x32_bf16 v[60:63], v[128:131], v[172:175], v[60:63]
    buffer_load_dwordx4 v4, s[52:55], s14 offen offset:0 lds
    v_mfma_f32_16x16x32_bf16 v[56:59], a[248:251], v[108:111], v[56:59]
    buffer_load_dwordx4 v5, s[52:55], s14 offen offset:1024 lds
    v_mfma_f32_16x16x32_bf16 v[56:59], a[240:243], v[104:107], v[56:59]
    buffer_load_dwordx4 v6, s[52:55], s14 offen offset:2048 lds
    v_mfma_f32_16x16x32_bf16 v[56:59], v[130:133], v[172:175], v[56:59]
    buffer_load_dwordx4 v7, s[52:55], s14 offen offset:3072 lds
    v_mfma_f32_16x16x32_bf16 v[64:67], a[240:243], v[112:115], v[64:67]
    s_add_u32 m0, s73, 147456
    s_lshl_b32 s14, s93, 18
    v_mfma_f32_16x16x32_bf16 v[64:67], a[248:251], v[116:119], v[64:67]
    buffer_load_dwordx4 v4, s[52:55], s14 offen offset:0 lds
    v_mfma_f32_16x16x32_bf16 v[64:67], v[130:133], v[176:179], v[64:67]
    buffer_load_dwordx4 v5, s[52:55], s14 offen offset:1024 lds
    v_mfma_f32_16x16x32_bf16 v[68:71], a[252:255], v[116:119], v[68:71]
    buffer_load_dwordx4 v6, s[52:55], s14 offen offset:2048 lds
    v_mfma_f32_16x16x32_bf16 v[68:71], a[244:247], v[112:115], v[68:71]
    buffer_load_dwordx4 v7, s[52:55], s14 offen offset:3072 lds
    v_mfma_f32_16x16x32_bf16 v[68:71], v[128:131], v[176:179], v[68:71]
    v_mfma_f32_16x16x32_bf16 v[76:79], a[244:247], v[120:123], v[76:79]
    v_mfma_f32_16x16x32_bf16 v[76:79], a[252:255], v[124:127], v[76:79]
    v_mfma_f32_16x16x32_bf16 v[76:79], v[128:131], v[180:183], v[76:79]
    v_mfma_f32_16x16x32_bf16 v[72:75], a[248:251], v[124:127], v[72:75]
    v_mfma_f32_16x16x32_bf16 v[72:75], a[240:243], v[120:123], v[72:75]
    v_mfma_f32_16x16x32_bf16 v[72:75], v[130:133], v[180:183], v[72:75]
    s_waitcnt lgkmcnt(0)
    v_mov_b32 v88, 0xc0135761
    s_mov_b32 s10, 0xbdd2d3e8
    s_lshl_b32 s9, s69, 2
    s_add_u32 s9, s9, s3
    s_mul_i32 s9, s9, 69632
    s_add_u32 s9, s9, 12795904
    v_pk_mul_f32 v[160:161], v[32:33], v[32:33]
    v_pk_mul_f32 v[162:163], v[34:35], v[34:35]
    v_pk_mul_f32 v[164:165], v[36:37], v[36:37]
    v_pk_mul_f32 v[166:167], v[38:39], v[38:39]
    v_pk_mul_f32 v[168:169], v[40:41], v[40:41]
    v_pk_mul_f32 v[170:171], v[42:43], v[42:43]
    v_pk_mul_f32 v[172:173], v[44:45], v[44:45]
    v_pk_mul_f32 v[174:175], v[46:47], v[46:47]
    v_pk_fma_f32 v[160:161], v[160:161], s[10:11], v[88:89] op_sel_hi:[1,0,0]
    v_pk_fma_f32 v[162:163], v[162:163], s[10:11], v[88:89] op_sel_hi:[1,0,0]
    v_pk_fma_f32 v[164:165], v[164:165], s[10:11], v[88:89] op_sel_hi:[1,0,0]
    v_pk_fma_f32 v[166:167], v[166:167], s[10:11], v[88:89] op_sel_hi:[1,0,0]
    v_pk_fma_f32 v[168:169], v[168:169], s[10:11], v[88:89] op_sel_hi:[1,0,0]
    v_pk_fma_f32 v[170:171], v[170:171], s[10:11], v[88:89] op_sel_hi:[1,0,0]
    v_pk_fma_f32 v[172:173], v[172:173], s[10:11], v[88:89] op_sel_hi:[1,0,0]
    v_pk_fma_f32 v[174:175], v[174:175], s[10:11], v[88:89] op_sel_hi:[1,0,0]
    v_pk_mul_f32 v[160:161], v[160:161], v[32:33]
    v_pk_mul_f32 v[162:163], v[162:163], v[34:35]
    v_pk_mul_f32 v[164:165], v[164:165], v[36:37]
    v_pk_mul_f32 v[166:167], v[166:167], v[38:39]
    v_pk_mul_f32 v[168:169], v[168:169], v[40:41]
    v_pk_mul_f32 v[170:171], v[170:171], v[42:43]
    v_pk_mul_f32 v[172:173], v[172:173], v[44:45]
    v_pk_mul_f32 v[174:175], v[174:175], v[46:47]
    v_exp_f32 v160, v160
    v_exp_f32 v161, v161
    v_exp_f32 v162, v162
    v_exp_f32 v163, v163
    v_exp_f32 v164, v164
    v_exp_f32 v165, v165
    v_exp_f32 v166, v166
    v_exp_f32 v167, v167
    v_exp_f32 v168, v168
    v_exp_f32 v169, v169
    v_exp_f32 v170, v170
    v_exp_f32 v171, v171
    v_exp_f32 v172, v172
    v_exp_f32 v173, v173
    v_exp_f32 v174, v174
    v_exp_f32 v175, v175
    v_pk_add_f32 v[160:161], v[160:161], 1.0 op_sel_hi:[1,0]
L_pl_G_5:
    s_cbranch_execz L_wret
    v_pk_add_f32 v[162:163], v[162:163], 1.0 op_sel_hi:[1,0]
    v_pk_add_f32 v[164:165], v[164:165], 1.0 op_sel_hi:[1,0]
    v_pk_add_f32 v[166:167], v[166:167], 1.0 op_sel_hi:[1,0]
    v_pk_add_f32 v[168:169], v[168:169], 1.0 op_sel_hi:[1,0]
    v_pk_add_f32 v[170:171], v[170:171], 1.0 op_sel_hi:[1,0]
    v_pk_add_f32 v[172:173], v[172:173], 1.0 op_sel_hi:[1,0]
    v_pk_add_f32 v[174:175], v[174:175], 1.0 op_sel_hi:[1,0]
    v_rcp_f32 v160, v160
    v_rcp_f32 v161, v161
    v_rcp_f32 v162, v162
    v_rcp_f32 v163, v163
    v_rcp_f32 v164, v164
    v_rcp_f32 v165, v165
    v_rcp_f32 v166, v166
    v_rcp_f32 v167, v167
    v_rcp_f32 v168, v168
    v_rcp_f32 v169, v169
    v_rcp_f32 v170, v170
    v_rcp_f32 v171, v171
    v_rcp_f32 v172, v172
    v_rcp_f32 v173, v173
    v_rcp_f32 v174, v174
    v_rcp_f32 v175, v175
    v_pk_mul_f32 v[32:33], v[32:33], v[160:161]
    v_pk_mul_f32 v[34:35], v[34:35], v[162:163]
    v_pk_mul_f32 v[36:37], v[36:37], v[164:165]
    v_pk_mul_f32 v[38:39], v[38:39], v[166:167]
    v_pk_mul_f32 v[40:41], v[40:41], v[168:169]
    v_pk_mul_f32 v[42:43], v[42:43], v[170:171]
    v_pk_mul_f32 v[44:45], v[44:45], v[172:173]
    v_pk_mul_f32 v[46:47], v[46:47], v[174:175]
    v_cvt_pk_bf16_f32 v96, v32, v33
    v_cvt_pk_bf16_f32 v97, v34, v35
    v_cvt_pk_bf16_f32 v98, v36, v37
    v_cvt_pk_bf16_f32 v99, v38, v39
    v_cvt_pk_bf16_f32 v100, v40, v41
    v_cvt_pk_bf16_f32 v101, v42, v43
    v_cvt_pk_bf16_f32 v102, v44, v45
    v_cvt_pk_bf16_f32 v103, v46, v47
    buffer_store_dwordx4 v[96:99], v240, s[44:47], s9 offen sc1
    buffer_store_dwordx4 v[100:103], v241, s[44:47], s9 offen sc1
    v_pk_mul_f32 v[160:161], v[48:49], v[48:49]
    v_pk_mul_f32 v[162:163], v[50:51], v[50:51]
    v_pk_mul_f32 v[164:165], v[52:53], v[52:53]
    v_pk_mul_f32 v[166:167], v[54:55], v[54:55]
    v_pk_mul_f32 v[168:169], v[56:57], v[56:57]
    v_pk_mul_f32 v[170:171], v[58:59], v[58:59]
    v_pk_mul_f32 v[172:173], v[60:61], v[60:61]
    v_pk_mul_f32 v[174:175], v[62:63], v[62:63]
    v_pk_fma_f32 v[160:161], v[160:161], s[10:11], v[88:89] op_sel_hi:[1,0,0]
    v_pk_fma_f32 v[162:163], v[162:163], s[10:11], v[88:89] op_sel_hi:[1,0,0]
    v_pk_fma_f32 v[164:165], v[164:165], s[10:11], v[88:89] op_sel_hi:[1,0,0]
    v_pk_fma_f32 v[166:167], v[166:167], s[10:11], v[88:89] op_sel_hi:[1,0,0]
    v_pk_fma_f32 v[168:169], v[168:169], s[10:11], v[88:89] op_sel_hi:[1,0,0]
    v_pk_fma_f32 v[170:171], v[170:171], s[10:11], v[88:89] op_sel_hi:[1,0,0]
    v_pk_fma_f32 v[172:173], v[172:173], s[10:11], v[88:89] op_sel_hi:[1,0,0]
    v_pk_fma_f32 v[174:175], v[174:175], s[10:11], v[88:89] op_sel_hi:[1,0,0]
    v_pk_mul_f32 v[160:161], v[160:161], v[48:49]
    v_pk_mul_f32 v[162:163], v[162:163], v[50:51]
    v_pk_mul_f32 v[164:165], v[164:165], v[52:53]
    v_pk_mul_f32 v[166:167], v[166:167], v[54:55]
    v_pk_mul_f32 v[168:169], v[168:169], v[56:57]
    v_pk_mul_f32 v[170:171], v[170:171], v[58:59]
    v_pk_mul_f32 v[172:173], v[172:173], v[60:61]
    v_pk_mul_f32 v[174:175], v[174:175], v[62:63]
    v_exp_f32 v160, v160
    v_exp_f32 v161, v161
    v_exp_f32 v162, v162
    v_exp_f32 v163, v163
    v_exp_f32 v164, v164
    v_exp_f32 v165, v165
    v_exp_f32 v166, v166
    v_exp_f32 v167, v167
    v_exp_f32 v168, v168
    v_exp_f32 v169, v169
    v_exp_f32 v170, v170
    v_exp_f32 v171, v171
    v_exp_f32 v172, v172
    v_exp_f32 v173, v173
    v_exp_f32 v174, v174
    v_exp_f32 v175, v175
    v_pk_add_f32 v[160:161], v[160:161], 1.0 op_sel_hi:[1,0]
    v_pk_add_f32 v[162:163], v[162:163], 1.0 op_sel_hi:[1,0]
    v_pk_add_f32 v[164:165], v[164:165], 1.0 op_sel_hi:[1,0]
    v_pk_add_f32 v[166:167], v[166:167], 1.0 op_sel_hi:[1,0]
    v_pk_add_f32 v[168:169], v[168:169], 1.0 op_sel_hi:[1,0]
    v_pk_add_f32 v[170:171], v[170:171], 1.0 op_sel_hi:[1,0]
    v_pk_add_f32 v[172:173], v[172:173], 1.0 op_sel_hi:[1,0]
    v_pk_add_f32 v[174:175], v[174:175], 1.0 op_sel_hi:[1,0]
    v_rcp_f32 v160, v160
    v_rcp_f32 v161, v161
    v_rcp_f32 v162, v162
    v_rcp_f32 v163, v163
    v_rcp_f32 v164, v164
    v_rcp_f32 v165, v165
    v_rcp_f32 v166, v166
    v_rcp_f32 v167, v167
    v_rcp_f32 v168, v168
    v_rcp_f32 v169, v169
    v_rcp_f32 v170, v170
    v_rcp_f32 v171, v171
    v_rcp_f32 v172, v172
    v_rcp_f32 v173, v173
    v_rcp_f32 v174, v174
    v_rcp_f32 v175, v175
    v_pk_mul_f32 v[48:49], v[48:49], v[160:161]
    v_pk_mul_f32 v[50:51], v[50:51], v[162:163]
    v_pk_mul_f32 v[52:53], v[52:53], v[164:165]
    v_pk_mul_f32 v[54:55], v[54:55], v[166:167]
    v_pk_mul_f32 v[56:57], v[56:57], v[168:169]
    v_pk_mul_f32 v[58:59], v[58:59], v[170:171]
    v_pk_mul_f32 v[60:61], v[60:61], v[172:173]
    v_pk_mul_f32 v[62:63], v[62:63], v[174:175]
    v_cvt_pk_bf16_f32 v104, v48, v49
    v_cvt_pk_bf16_f32 v105, v50, v51
    v_cvt_pk_bf16_f32 v106, v52, v53
    v_cvt_pk_bf16_f32 v107, v54, v55
    v_cvt_pk_bf16_f32 v108, v56, v57
    v_cvt_pk_bf16_f32 v109, v58, v59
    v_cvt_pk_bf16_f32 v110, v60, v61
    v_cvt_pk_bf16_f32 v111, v62, v63
    buffer_store_dwordx4 v[104:107], v242, s[44:47], s9 offen sc1
    buffer_store_dwordx4 v[108:111], v243, s[44:47], s9 offen sc1
    v_pk_mul_f32 v[160:161], v[64:65], v[64:65]
    v_pk_mul_f32 v[162:163], v[66:67], v[66:67]
    v_pk_mul_f32 v[164:165], v[68:69], v[68:69]
    v_pk_mul_f32 v[166:167], v[70:71], v[70:71]
    v_pk_mul_f32 v[168:169], v[72:73], v[72:73]
    v_pk_mul_f32 v[170:171], v[74:75], v[74:75]
    v_pk_mul_f32 v[172:173], v[76:77], v[76:77]
    v_pk_mul_f32 v[174:175], v[78:79], v[78:79]
    v_pk_fma_f32 v[160:161], v[160:161], s[10:11], v[88:89] op_sel_hi:[1,0,0]
    v_pk_fma_f32 v[162:163], v[162:163], s[10:11], v[88:89] op_sel_hi:[1,0,0]
    v_pk_fma_f32 v[164:165], v[164:165], s[10:11], v[88:89] op_sel_hi:[1,0,0]
    v_pk_fma_f32 v[166:167], v[166:167], s[10:11], v[88:89] op_sel_hi:[1,0,0]
    v_pk_fma_f32 v[168:169], v[168:169], s[10:11], v[88:89] op_sel_hi:[1,0,0]
    v_pk_fma_f32 v[170:171], v[170:171], s[10:11], v[88:89] op_sel_hi:[1,0,0]
    v_pk_fma_f32 v[172:173], v[172:173], s[10:11], v[88:89] op_sel_hi:[1,0,0]
    v_pk_fma_f32 v[174:175], v[174:175], s[10:11], v[88:89] op_sel_hi:[1,0,0]
    v_pk_mul_f32 v[160:161], v[160:161], v[64:65]
    v_pk_mul_f32 v[162:163], v[162:163], v[66:67]
    v_pk_mul_f32 v[164:165], v[164:165], v[68:69]
    v_pk_mul_f32 v[166:167], v[166:167], v[70:71]
    v_pk_mul_f32 v[168:169], v[168:169], v[72:73]
    v_pk_mul_f32 v[170:171], v[170:171], v[74:75]
    v_pk_mul_f32 v[172:173], v[172:173], v[76:77]
    v_pk_mul_f32 v[174:175], v[174:175], v[78:79]
    v_exp_f32 v160, v160
    v_exp_f32 v161, v161
    v_exp_f32 v162, v162
    v_exp_f32 v163, v163
    v_exp_f32 v164, v164
    v_exp_f32 v165, v165
    v_exp_f32 v166, v166
    v_exp_f32 v167, v167
    v_exp_f32 v168, v168
    v_exp_f32 v169, v169
    v_exp_f32 v170, v170
    v_exp_f32 v171, v171
    v_exp_f32 v172, v172
    v_exp_f32 v173, v173
    v_exp_f32 v174, v174
    v_exp_f32 v175, v175
    v_pk_add_f32 v[160:161], v[160:161], 1.0 op_sel_hi:[1,0]
    v_pk_add_f32 v[162:163], v[162:163], 1.0 op_sel_hi:[1,0]
    v_pk_add_f32 v[164:165], v[164:165], 1.0 op_sel_hi:[1,0]
    v_pk_add_f32 v[166:167], v[166:167], 1.0 op_sel_hi:[1,0]
    v_pk_add_f32 v[168:169], v[168:169], 1.0 op_sel_hi:[1,0]
    v_pk_add_f32 v[170:171], v[170:171], 1.0 op_sel_hi:[1,0]
    v_pk_add_f32 v[172:173], v[172:173], 1.0 op_sel_hi:[1,0]
    v_pk_add_f32 v[174:175], v[174:175], 1.0 op_sel_hi:[1,0]
    v_rcp_f32 v160, v160
    v_rcp_f32 v161, v161
    v_rcp_f32 v162, v162
    v_rcp_f32 v163, v163
    v_rcp_f32 v164, v164
    v_rcp_f32 v165, v165
    v_rcp_f32 v166, v166
    v_rcp_f32 v167, v167
    v_rcp_f32 v168, v168
    v_rcp_f32 v169, v169
    v_rcp_f32 v170, v170
    v_rcp_f32 v171, v171
    v_rcp_f32 v172, v172
    v_rcp_f32 v173, v173
    v_rcp_f32 v174, v174
    v_rcp_f32 v175, v175
    v_pk_mul_f32 v[64:65], v[64:65], v[160:161]
    v_pk_mul_f32 v[66:67], v[66:67], v[162:163]
    v_pk_mul_f32 v[68:69], v[68:69], v[164:165]
    v_pk_mul_f32 v[70:71], v[70:71], v[166:167]
    v_pk_mul_f32 v[72:73], v[72:73], v[168:169]
    v_pk_mul_f32 v[74:75], v[74:75], v[170:171]
    v_pk_mul_f32 v[76:77], v[76:77], v[172:173]
    v_pk_mul_f32 v[78:79], v[78:79], v[174:175]
    v_cvt_pk_bf16_f32 v112, v64, v65
    v_cvt_pk_bf16_f32 v113, v66, v67
    v_cvt_pk_bf16_f32 v114, v68, v69
    v_cvt_pk_bf16_f32 v115, v70, v71
    v_cvt_pk_bf16_f32 v116, v72, v73
    v_cvt_pk_bf16_f32 v117, v74, v75
    v_cvt_pk_bf16_f32 v118, v76, v77
    v_cvt_pk_bf16_f32 v119, v78, v79
    buffer_store_dwordx4 v[112:115], v244, s[44:47], s9 offen sc1
    buffer_store_dwordx4 v[116:119], v245, s[44:47], s9 offen sc1
    s_waitcnt vmcnt(6)
    s_barrier
    ds_read_b64_tr_b16 a[64:65], v10 offset:49152
    s_add_u32 m0, s73, 32768
    s_lshl_b32 s14, s94, 18
    ds_read_b64_tr_b16 a[66:67], v10 offset:51200
    ds_read_b64_tr_b16 a[72:73], v10 offset:53248
    ds_read_b64_tr_b16 a[74:75], v10 offset:55296
    ds_read_b64_tr_b16 a[68:69], v11 offset:49152
    buffer_load_dwordx4 v4, s[52:55], s14 offen offset:0 lds
    ds_read_b64_tr_b16 a[70:71], v11 offset:51200
    ds_read_b64_tr_b16 a[76:77], v11 offset:53248
    ds_read_b64_tr_b16 a[78:79], v11 offset:55296
    v_add_u32 v10, 65536, v10
    ds_read_b64_tr_b16 a[80:81], v10 offset:0
    ds_read_b64_tr_b16 a[82:83], v10 offset:2048
    buffer_load_dwordx4 v5, s[52:55], s14 offen offset:1024 lds
    ds_read_b64_tr_b16 a[88:89], v10 offset:4096
    ds_read_b64_tr_b16 a[90:91], v10 offset:6144
    v_add_u32 v11, 65536, v11
    ds_read_b64_tr_b16 a[84:85], v11 offset:0
    ds_read_b64_tr_b16 a[86:87], v11 offset:2048
    ds_read_b64_tr_b16 a[92:93], v11 offset:4096
    buffer_load_dwordx4 v6, s[52:55], s14 offen offset:2048 lds
    ds_read_b64_tr_b16 a[94:95], v11 offset:6144
    v_add_u32 v10, -65536, v10
    ds_read_b64_tr_b16 a[96:97], v10 offset:0
    ds_read_b64_tr_b16 a[98:99], v10 offset:2048
    ds_read_b64_tr_b16 a[104:105], v10 offset:4096
    ds_read_b64_tr_b16 a[106:107], v10 offset:6144
    buffer_load_dwordx4 v7, s[52:55], s14 offen offset:3072 lds
    v_add_u32 v11, -65536, v11
    ds_read_b64_tr_b16 a[100:101], v11 offset:0
    ds_read_b64_tr_b16 a[102:103], v11 offset:2048
    ds_read_b64_tr_b16 a[108:109], v11 offset:4096
    ds_read_b64_tr_b16 a[110:111], v11 offset:6144
    ds_read_b64_tr_b16 a[112:113], v10 offset:16384
    s_add_u32 m0, s73, 81920
    s_lshl_b32 s14, s95, 18
    ds_read_b64_tr_b16 a[114:115], v10 offset:18432
    ds_read_b64_tr_b16 a[120:121], v10 offset:20480
    ds_read_b64_tr_b16 a[122:123], v10 offset:22528
    ds_read_b64_tr_b16 a[116:117], v11 offset:16384
    buffer_load_dwordx4 v4, s[52:55], s14 offen offset:0 lds
    ds_read_b64_tr_b16 a[118:119], v11 offset:18432
    ds_read_b64_tr_b16 a[124:125], v11 offset:20480
    ds_read_b64_tr_b16 a[126:127], v11 offset:22528
    v_add_u32 v10, 131072, v10
    ds_read_b64_tr_b16 a[128:129], v10 offset:0
    ds_read_b64_tr_b16 a[130:131], v10 offset:2048
    buffer_load_dwordx4 v5, s[52:55], s14 offen offset:1024 lds
    ds_read_b64_tr_b16 a[136:137], v10 offset:4096
    ds_read_b64_tr_b16 a[138:139], v10 offset:6144
    v_add_u32 v11, 131072, v11
    ds_read_b64_tr_b16 a[132:133], v11 offset:0
    ds_read_b64_tr_b16 a[134:135], v11 offset:2048
    ds_read_b64_tr_b16 a[140:141], v11 offset:4096
    buffer_load_dwordx4 v6, s[52:55], s14 offen offset:2048 lds
    ds_read_b64_tr_b16 a[142:143], v11 offset:6144
    ds_read_b64_tr_b16 a[144:145], v10 offset:16384
    ds_read_b64_tr_b16 a[146:147], v10 offset:18432
    ds_read_b64_tr_b16 a[152:153], v10 offset:20480
    ds_read_b64_tr_b16 a[154:155], v10 offset:22528
    buffer_load_dwordx4 v7, s[52:55], s14 offen offset:3072 lds
    ds_read_b64_tr_b16 a[148:149], v11 offset:16384
    ds_read_b64_tr_b16 a[150:151], v11 offset:18432
    ds_read_b64_tr_b16 a[156:157], v11 offset:20480
    ds_read_b64_tr_b16 a[158:159], v11 offset:22528
    s_bitcmp1_b32 s3, 1
    s_cselect_b32 s18, s85, s84
    s_mul_i32 s18, s18, 139264
    s_cselect_b32 s19, s87, s86
    s_mul_i32 s19, s19, 139264
    s_cselect_b32 s20, s89, s88
    s_mul_i32 s20, s20, 139264
    s_cselect_b32 s21, s91, s90
    s_mul_i32 s21, s21, 139264
    s_cselect_b32 s22, s93, s92
    s_mul_i32 s22, s22, 139264
    s_cselect_b32 s23, s95, s94
    s_mul_i32 s23, s23, 139264
    s_cselect_b32 s24, s97, s96
    s_mul_i32 s24, s24, 139264
    s_cselect_b32 s25, s99, s98
    s_mul_i32 s25, s25, 139264
    s_cselect_b32 s26, s101, s100
    s_mul_i32 s26, s26, 139264
    s_waitcnt vmcnt(8) lgkmcnt(0)
    s_barrier
    buffer_store_dword v249, v17, s[44:47], 0 offen sc1
    s_add_u32 m0, s73, 0
    s_lshl_b32 s14, s96, 18
    buffer_load_dwordx4 v4, s[52:55], s14 offen offset:0 lds
    buffer_load_dwordx4 v5, s[52:55], s14 offen offset:1024 lds
    buffer_load_dwordx4 v6, s[52:55], s14 offen offset:2048 lds
    buffer_load_dwordx4 v7, s[52:55], s14 offen offset:3072 lds
    s_add_u32 m0, s73, 16384
    s_lshl_b32 s14, s97, 18
    buffer_load_dwordx4 v4, s[52:55], s14 offen offset:0 lds
    buffer_load_dwordx4 v5, s[52:55], s14 offen offset:1024 lds
    buffer_load_dwordx4 v6, s[52:55], s14 offen offset:2048 lds
    buffer_load_dwordx4 v7, s[52:55], s14 offen offset:3072 lds
    v_mov_b32 v16, 0
    buffer_atomic_add v16, v15, s[44:47], 0 offen sc0 sc1
    s_add_u32 m0, s73, 49152
    s_lshl_b32 s14, s98, 18
    buffer_load_dwordx4 v4, s[52:55], s14 offen offset:0 lds
    buffer_load_dwordx4 v5, s[52:55], s14 offen offset:1024 lds
    buffer_load_dwordx4 v6, s[52:55], s14 offen offset:2048 lds
    buffer_load_dwordx4 v7, s[52:55], s14 offen offset:3072 lds
    s_add_u32 m0, s73, 65536
    s_lshl_b32 s14, s99, 18
    buffer_load_dwordx4 v4, s[52:55], s14 offen offset:0 lds
    buffer_load_dwordx4 v5, s[52:55], s14 offen offset:1024 lds
    buffer_load_dwordx4 v6, s[52:55], s14 offen offset:2048 lds
    buffer_load_dwordx4 v7, s[52:55], s14 offen offset:3072 lds
L_DG:
    s_waitcnt vmcnt(8)
    v_cmp_ne_u32 vcc, v13, v16
    s_cbranch_vccnz L_rs_p2G
L_ok_p2G:
    s_barrier
    s_add_u32 m0, s73, 97536
    s_nop 0
    buffer_load_dwordx4 v23, s[44:47], s18 offen offset:768 sc1 lds
    s_add_u32 m0, s73, 99328
    s_nop 0
    buffer_load_dwordx4 v20, s[44:47], s18 offen offset:0 sc1 lds
    s_add_u32 m0, s73, 99840
    s_nop 0
    buffer_load_dwordx4 v20, s[44:47], s18 offen offset:512 sc1 lds
    s_add_u32 m0, s73, 100608
    s_nop 0
    buffer_load_dwordx4 v23, s[44:47], s19 offen offset:768 sc1 lds
    s_add_u32 m0, s73, 114688
    s_nop 0
    buffer_load_dwordx4 v20, s[44:47], s19 offen offset:0 sc1 lds
    s_add_u32 m0, s73, 115200
    s_nop 0
    buffer_load_dwordx4 v20, s[44:47], s19 offen offset:512 sc1 lds
    s_add_u32 m0, s73, 115968
    s_nop 0
    buffer_load_dwordx4 v23, s[44:47], s20 offen offset:768 sc1 lds
    s_add_u32 m0, s73, 117760
    s_nop 0
    buffer_load_dwordx4 v20, s[44:47], s20 offen offset:0 sc1 lds
    s_add_u32 m0, s73, 130560
    s_nop 0
    buffer_load_dwordx4 v20, s[44:47], s20 offen offset:512 sc1 lds
    s_add_u32 m0, s73, 131328
    s_nop 0
    buffer_load_dwordx4 v23, s[44:47], s21 offen offset:768 sc1 lds
    v_mov_b32 v195, s68
    v_mov_b32 v199, s68
    v_mov_b32 v202, s68
    v_mov_b32 v203, s68
    s_waitcnt vmcnt(6)
    s_barrier
    ds_read_b128 v[104:107], v14 offset:0
    ds_read_b128 v[108:111], v14 offset:4096
    ds_read_b128 v[112:115], v14 offset:8192
    ds_read_b128 v[116:119], v14 offset:12288
    s_waitcnt lgkmcnt(2)
    v_mfma_f32_16x16x32_bf16 v[32:35], v[104:107], a[0:3], 0
    s_add_u32 m0, s73, 133120
    v_mfma_f32_16x16x32_bf16 v[32:35], v[108:111], a[8:11], v[32:35]
    buffer_load_dwordx4 v20, s[44:47], s21 offen offset:0 sc1 lds
    s_waitcnt lgkmcnt(0)
    v_mfma_f32_16x16x32_bf16 v[32:35], v[112:115], a[16:19], v[32:35]
    ds_read_b128 v[120:123], v14 offset:1024
    v_mfma_f32_16x16x32_bf16 v[32:35], v[116:119], a[24:27], v[32:35]
    ds_read_b128 v[124:127], v14 offset:5120
    v_mfma_f32_16x16x32_bf16 v[36:39], v[116:119], a[28:31], 0
    ds_read_b128 v[128:131], v14 offset:9216
    v_mfma_f32_16x16x32_bf16 v[36:39], v[112:115], a[20:23], v[36:39]
    ds_read_b128 v[132:135], v14 offset:13312
    v_mfma_f32_16x16x32_bf16 v[36:39], v[108:111], a[12:15], v[36:39]
    s_add_u32 m0, s73, 133632
    v_mfma_f32_16x16x32_bf16 v[36:39], v[104:107], a[4:7], v[36:39]
    buffer_load_dwordx4 v20, s[44:47], s21 offen offset:512 sc1 lds
    s_waitcnt lgkmcnt(2)
    v_mfma_f32_16x16x32_bf16 v[44:47], v[120:123], a[4:7], 0
    s_add_u32 m0, s73, 146688
    v_mfma_f32_16x16x32_bf16 v[44:47], v[124:127], a[12:15], v[44:47]
    buffer_load_dwordx4 v23, s[44:47], s22 offen offset:768 sc1 lds
    s_waitcnt lgkmcnt(0)
    v_mfma_f32_16x16x32_bf16 v[44:47], v[128:131], a[20:23], v[44:47]
    ds_read_b128 v[104:107], v14 offset:2048
    v_mfma_f32_16x16x32_bf16 v[44:47], v[132:135], a[28:31], v[44:47]
    ds_read_b128 v[108:111], v14 offset:6144
    v_mfma_f32_16x16x32_bf16 v[40:43], v[132:135], a[24:27], 0
    ds_read_b128 v[112:115], v14 offset:10240
    v_mfma_f32_16x16x32_bf16 v[40:43], v[128:131], a[16:19], v[40:43]
    ds_read_b128 v[116:119], v14 offset:14336
    v_mfma_f32_16x16x32_bf16 v[40:43], v[124:127], a[8:11], v[40:43]
    s_add_u32 m0, s73, 148480
    v_mfma_f32_16x16x32_bf16 v[40:43], v[120:123], a[0:3], v[40:43]
    buffer_load_dwordx4 v20, s[44:47], s22 offen offset:0 sc1 lds
    s_waitcnt lgkmcnt(2)
    v_mfma_f32_16x16x32_bf16 v[48:51], v[104:107], a[0:3], 0
    s_add_u32 m0, s73, 148992
    v_mfma_f32_16x16x32_bf16 v[48:51], v[108:111], a[8:11], v[48:51]
    buffer_load_dwordx4 v20, s[44:47], s22 offen offset:512 sc1 lds
    s_waitcnt lgkmcnt(0)
    v_mfma_f32_16x16x32_bf16 v[48:51], v[112:115], a[16:19], v[48:51]
    ds_read_b128 v[120:123], v14 offset:3072
    v_mfma_f32_16x16x32_bf16 v[48:51], v[116:119], a[24:27], v[48:51]
    ds_read_b128 v[124:127], v14 offset:7168
    v_mfma_f32_16x16x32_bf16 v[52:55], v[116:119], a[28:31], 0
    ds_read_b128 v[128:131], v14 offset:11264
    v_mfma_f32_16x16x32_bf16 v[52:55], v[112:115], a[20:23], v[52:55]
    ds_read_b128 v[132:135], v14 offset:15360
    v_mfma_f32_16x16x32_bf16 v[52:55], v[108:111], a[12:15], v[52:55]
    s_add_u32 m0, s73, 149760
    v_mfma_f32_16x16x32_bf16 v[52:55], v[104:107], a[4:7], v[52:55]
    buffer_load_dwordx4 v23, s[44:47], s23 offen offset:768 sc1 lds
    s_waitcnt lgkmcnt(2)
    v_mfma_f32_16x16x32_bf16 v[36:39], v[120:123], a[36:39], v[36:39]
    v_mfma_f32_16x16x32_bf16 v[36:39], v[124:127], a[44:47], v[36:39]
    s_waitcnt lgkmcnt(0)
    v_mfma_f32_16x16x32_bf16 v[36:39], v[128:131], a[52:55], v[36:39]
    s_waitcnt vmcnt(8)
    s_barrier
    v_mfma_f32_16x16x32_bf16 v[36:39], v[132:135], a[60:63], v[36:39]
    ds_read_b128 v[104:107], v14 offset:16384
    v_add_u32 v10, -131072, v10
    v_mfma_f32_16x16x32_bf16 v[32:35], v[132:135], a[56:59], v[32:35]
    ds_read_b128 v[108:111], v14 offset:20480
    v_mfma_f32_16x16x32_bf16 v[32:35], v[128:131], a[48:51], v[32:35]
    ds_read_b128 v[112:115], v14 offset:24576
    ds_read_b64_tr_b16 a[160:161], v10 offset:32768
    v_mfma_f32_16x16x32_bf16 v[32:35], v[124:127], a[40:43], v[32:35]
    ds_read_b128 v[116:119], v14 offset:28672
    v_mfma_f32_16x16x32_bf16 v[32:35], v[120:123], a[32:35], v[32:35]
    ds_read_b64_tr_b16 a[162:163], v10 offset:34816
    s_waitcnt lgkmcnt(4)
    v_mfma_f32_16x16x32_bf16 v[40:43], v[104:107], a[32:35], v[40:43]
    s_add_u32 m0, s73, 98304
    ds_read_b64_tr_b16 a[168:169], v10 offset:36864
    v_mfma_f32_16x16x32_bf16 v[40:43], v[108:111], a[40:43], v[40:43]
    buffer_load_dwordx4 v20, s[44:47], s23 offen offset:0 sc1 lds
    ds_read_b64_tr_b16 a[170:171], v10 offset:38912
    s_waitcnt lgkmcnt(3)
    v_mfma_f32_16x16x32_bf16 v[40:43], v[112:115], a[48:51], v[40:43]
    ds_read_b128 v[120:123], v14 offset:17408
    v_mfma_f32_16x16x32_bf16 v[40:43], v[116:119], a[56:59], v[40:43]
    ds_read_b128 v[124:127], v14 offset:21504
    v_add_u32 v11, -131072, v11
    v_mfma_f32_16x16x32_bf16 v[44:47], v[116:119], a[60:63], v[44:47]
    ds_read_b128 v[128:131], v14 offset:25600
    v_mfma_f32_16x16x32_bf16 v[44:47], v[112:115], a[52:55], v[44:47]
    ds_read_b128 v[132:135], v14 offset:29696
    v_mfma_f32_16x16x32_bf16 v[44:47], v[108:111], a[44:47], v[44:47]
    s_add_u32 m0, s73, 98816
    ds_read_b64_tr_b16 a[164:165], v11 offset:32768
    v_mfma_f32_16x16x32_bf16 v[44:47], v[104:107], a[36:39], v[44:47]
    buffer_load_dwordx4 v20, s[44:47], s23 offen offset:512 sc1 lds
    ds_read_b64_tr_b16 a[166:167], v11 offset:34816
    s_waitcnt lgkmcnt(4)
    v_mfma_f32_16x16x32_bf16 v[52:55], v[120:123], a[36:39], v[52:55]
    s_add_u32 m0, s73, 99584
    ds_read_b64_tr_b16 a[172:173], v11 offset:36864
    v_mfma_f32_16x16x32_bf16 v[52:55], v[124:127], a[44:47], v[52:55]
    buffer_load_dwordx4 v23, s[44:47], s24 offen offset:768 sc1 lds
    ds_read_b64_tr_b16 a[174:175], v11 offset:38912
    s_waitcnt lgkmcnt(4)
    v_mfma_f32_16x16x32_bf16 v[52:55], v[128:131], a[52:55], v[52:55]
    ds_read_b128 v[104:107], v14 offset:18432
    v_mfma_f32_16x16x32_bf16 v[52:55], v[132:135], a[60:63], v[52:55]
    ds_read_b128 v[108:111], v14 offset:22528
    v_add_u32 v10, 65536, v10
    v_mfma_f32_16x16x32_bf16 v[48:51], v[132:135], a[56:59], v[48:51]
    ds_read_b128 v[112:115], v14 offset:26624
    v_mfma_f32_16x16x32_bf16 v[48:51], v[128:131], a[48:51], v[48:51]
    ds_read_b128 v[116:119], v14 offset:30720
    v_mfma_f32_16x16x32_bf16 v[48:51], v[124:127], a[40:43], v[48:51]
    s_add_u32 m0, s73, 101376
    ds_read_b64_tr_b16 a[176:177], v10 offset:16384
    v_mfma_f32_16x16x32_bf16 v[48:51], v[120:123], a[32:35], v[48:51]
    buffer_load_dwordx4 v20, s[44:47], s24 offen offset:0 sc1 lds
    ds_read_b64_tr_b16 a[178:179], v10 offset:18432
    s_waitcnt lgkmcnt(4)
    v_mfma_f32_16x16x32_bf16 v[32:35], v[104:107], a[64:67], v[32:35]
    ds_read_b64_tr_b16 a[184:185], v10 offset:20480
    v_mfma_f32_16x16x32_bf16 v[32:35], v[108:111], a[72:75], v[32:35]
    ds_read_b64_tr_b16 a[186:187], v10 offset:22528
    s_waitcnt lgkmcnt(4)
    v_mfma_f32_16x16x32_bf16 v[32:35], v[112:115], a[80:83], v[32:35]
    ds_read_b128 v[120:123], v14 offset:19456
    v_mfma_f32_16x16x32_bf16 v[32:35], v[116:119], a[88:91], v[32:35]
    ds_read_b128 v[124:127], v14 offset:23552
    v_add_u32 v11, 65536, v11
    v_mfma_f32_16x16x32_bf16 v[36:39], v[116:119], a[92:95], v[36:39]
    ds_read_b128 v[128:131], v14 offset:27648
    v_mfma_f32_16x16x32_bf16 v[36:39], v[112:115], a[84:87], v[36:39]
    ds_read_b128 v[132:135], v14 offset:31744
    v_mfma_f32_16x16x32_bf16 v[36:39], v[108:111], a[76:79], v[36:39]
    ds_read_b64_tr_b16 a[180:181], v11 offset:16384
    v_mfma_f32_16x16x32_bf16 v[36:39], v[104:107], a[68:71], v[36:39]
    ds_read_b64_tr_b16 a[182:183], v11 offset:18432
    s_waitcnt lgkmcnt(4)
    v_mfma_f32_16x16x32_bf16 v[44:47], v[120:123], a[68:71], v[44:47]
    ds_read_b64_tr_b16 a[188:189], v11 offset:20480
    v_mfma_f32_16x16x32_bf16 v[44:47], v[124:127], a[76:79], v[44:47]
    ds_read_b64_tr_b16 a[190:191], v11 offset:22528
    s_waitcnt lgkmcnt(4)
    v_mfma_f32_16x16x32_bf16 v[44:47], v[128:131], a[84:87], v[44:47]
    s_waitcnt vmcnt(8) lgkmcnt(0)
    s_barrier
    v_mfma_f32_16x16x32_bf16 v[44:47], v[132:135], a[92:95], v[44:47]
    ds_read_b128 v[104:107], v14 offset:32768
    s_lshl_b32 s14, s100, 18
    s_add_u32 m0, s73, 32768
    v_add_u32 v10, -65536, v10
    v_mfma_f32_16x16x32_bf16 v[40:43], v[132:135], a[88:91], v[40:43]
    ds_read_b128 v[108:111], v14 offset:36864
    buffer_load_dwordx4 v4, s[52:55], s14 offen offset:0 lds
    v_mfma_f32_16x16x32_bf16 v[40:43], v[128:131], a[80:83], v[40:43]
    ds_read_b128 v[112:115], v14 offset:40960
    ds_read_b64_tr_b16 a[192:193], v10 offset:0
    v_mfma_f32_16x16x32_bf16 v[40:43], v[124:127], a[72:75], v[40:43]
    ds_read_b128 v[116:119], v14 offset:45056
    v_mfma_f32_16x16x32_bf16 v[40:43], v[120:123], a[64:67], v[40:43]
    ds_read_b64_tr_b16 a[194:195], v10 offset:2048
    s_waitcnt lgkmcnt(4)
    v_mfma_f32_16x16x32_bf16 v[48:51], v[104:107], a[64:67], v[48:51]
    s_add_u32 m0, s73, 114176
    ds_read_b64_tr_b16 a[200:201], v10 offset:4096
    v_mfma_f32_16x16x32_bf16 v[48:51], v[108:111], a[72:75], v[48:51]
    buffer_load_dwordx4 v20, s[44:47], s24 offen offset:512 sc1 lds
    ds_read_b64_tr_b16 a[202:203], v10 offset:6144
    s_waitcnt lgkmcnt(3)
    v_mfma_f32_16x16x32_bf16 v[48:51], v[112:115], a[80:83], v[48:51]
    ds_read_b128 v[120:123], v14 offset:33792
    s_add_u32 m0, s73, 32768
    v_lshrrev_b32 v30, 2, v26
    v_mfma_f32_16x16x32_bf16 v[48:51], v[116:119], a[88:91], v[48:51]
    ds_read_b128 v[124:127], v14 offset:37888
    buffer_load_dwordx4 v5, s[52:55], s14 offen offset:1024 lds
    v_mfma_f32_16x16x32_bf16 v[52:55], v[116:119], a[92:95], v[52:55]
    ds_read_b128 v[128:131], v14 offset:41984
    v_add_u32 v11, -65536, v11
    v_mfma_f32_16x16x32_bf16 v[52:55], v[112:115], a[84:87], v[52:55]
    ds_read_b128 v[132:135], v14 offset:46080
    v_mfma_f32_16x16x32_bf16 v[52:55], v[108:111], a[76:79], v[52:55]
    s_add_u32 m0, s73, 114944
    ds_read_b64_tr_b16 a[196:197], v11 offset:0
    v_mfma_f32_16x16x32_bf16 v[52:55], v[104:107], a[68:71], v[52:55]
    buffer_load_dwordx4 v23, s[44:47], s25 offen offset:768 sc1 lds
    ds_read_b64_tr_b16 a[198:199], v11 offset:2048
    s_waitcnt lgkmcnt(4)
    v_mfma_f32_16x16x32_bf16 v[36:39], v[120:123], a[100:103], v[36:39]
    s_add_u32 m0, s73, 116736
    ds_read_b64_tr_b16 a[204:205], v11 offset:4096
    v_mfma_f32_16x16x32_bf16 v[36:39], v[124:127], a[108:111], v[36:39]
    buffer_load_dwordx4 v20, s[44:47], s25 offen offset:0 sc1 lds
    ds_read_b64_tr_b16 a[206:207], v11 offset:6144
    s_waitcnt lgkmcnt(4)
    v_mfma_f32_16x16x32_bf16 v[36:39], v[128:131], a[116:119], v[36:39]
    ds_read_b128 v[104:107], v14 offset:34816
    s_add_u32 m0, s73, 32768
    v_lshrrev_b32 v31, 2, v18
    v_mfma_f32_16x16x32_bf16 v[36:39], v[132:135], a[124:127], v[36:39]
    ds_read_b128 v[108:111], v14 offset:38912
    buffer_load_dwordx4 v6, s[52:55], s14 offen offset:2048 lds
    v_mfma_f32_16x16x32_bf16 v[32:35], v[132:135], a[120:123], v[32:35]
    ds_read_b128 v[112:115], v14 offset:43008
    v_mfma_f32_16x16x32_bf16 v[32:35], v[128:131], a[112:115], v[32:35]
    ds_read_b128 v[116:119], v14 offset:47104
    v_mfma_f32_16x16x32_bf16 v[32:35], v[124:127], a[104:107], v[32:35]
    s_add_u32 m0, s73, 117248
    ds_read_b64_tr_b16 a[208:209], v10 offset:16384
    v_mfma_f32_16x16x32_bf16 v[32:35], v[120:123], a[96:99], v[32:35]
    buffer_load_dwordx4 v20, s[44:47], s25 offen offset:512 sc1 lds
    ds_read_b64_tr_b16 a[210:211], v10 offset:18432
    s_waitcnt lgkmcnt(4)
    v_mfma_f32_16x16x32_bf16 v[40:43], v[104:107], a[96:99], v[40:43]
    ds_read_b64_tr_b16 a[216:217], v10 offset:20480
    buffer_load_ushort v102, v30, s[60:63], 0 offen offset:0
    s_add_u32 m0, s73, 32768
    v_mfma_f32_16x16x32_bf16 v[40:43], v[108:111], a[104:107], v[40:43]
    ds_read_b64_tr_b16 a[218:219], v10 offset:22528
    buffer_load_dwordx4 v7, s[52:55], s14 offen offset:3072 lds
    s_waitcnt lgkmcnt(4)
L_pl_G_6:
    s_cbranch_execz L_wret
    v_mfma_f32_16x16x32_bf16 v[40:43], v[112:115], a[112:115], v[40:43]
    ds_read_b128 v[120:123], v14 offset:35840
    v_mfma_f32_16x16x32_bf16 v[40:43], v[116:119], a[120:123], v[40:43]
    ds_read_b128 v[124:127], v14 offset:39936
    v_mfma_f32_16x16x32_bf16 v[44:47], v[116:119], a[124:127], v[44:47]
    ds_read_b128 v[128:131], v14 offset:44032
    v_mfma_f32_16x16x32_bf16 v[44:47], v[112:115], a[116:119], v[44:47]
    ds_read_b128 v[132:135], v14 offset:48128
    v_mfma_f32_16x16x32_bf16 v[44:47], v[108:111], a[108:111], v[44:47]
    ds_read_b64_tr_b16 a[212:213], v11 offset:16384
    buffer_load_ushort v103, v30, s[60:63], 0 offen offset:32
    v_mfma_f32_16x16x32_bf16 v[44:47], v[104:107], a[100:103], v[44:47]
    ds_read_b64_tr_b16 a[214:215], v11 offset:18432
    s_waitcnt lgkmcnt(4)
    v_mfma_f32_16x16x32_bf16 v[52:55], v[120:123], a[100:103], v[52:55]
    ds_read_b64_tr_b16 a[220:221], v11 offset:20480
    v_mfma_f32_16x16x32_bf16 v[52:55], v[124:127], a[108:111], v[52:55]
    ds_read_b64_tr_b16 a[222:223], v11 offset:22528
    s_waitcnt lgkmcnt(4)
    v_mfma_f32_16x16x32_bf16 v[52:55], v[128:131], a[116:119], v[52:55]
    s_waitcnt vmcnt(14) lgkmcnt(0)
    s_barrier
    v_mfma_f32_16x16x32_bf16 v[52:55], v[132:135], a[124:127], v[52:55]
    ds_read_b128 v[104:107], v14 offset:49152
    s_lshl_b32 s14, s101, 18
    ds_read_b64_tr_b16 a[224:225], v10 offset:49152
    s_add_u32 m0, s73, 81920
    v_mfma_f32_16x16x32_bf16 v[48:51], v[132:135], a[120:123], v[48:51]
    ds_read_b128 v[108:111], v14 offset:53248
    buffer_load_dwordx4 v4, s[52:55], s14 offen offset:0 lds
    v_mfma_f32_16x16x32_bf16 v[48:51], v[128:131], a[112:115], v[48:51]
    ds_read_b128 v[112:115], v14 offset:57344
    buffer_load_ushort v27, v31, s[60:63], 0 offen offset:0
    v_mfma_f32_16x16x32_bf16 v[48:51], v[124:127], a[104:107], v[48:51]
    ds_read_b128 v[116:119], v14 offset:61440
    v_mfma_f32_16x16x32_bf16 v[48:51], v[120:123], a[96:99], v[48:51]
    ds_read_b64_tr_b16 a[226:227], v10 offset:51200
    s_waitcnt lgkmcnt(3)
    v_mfma_f32_16x16x32_bf16 v[32:35], v[104:107], a[128:131], v[32:35]
    s_add_u32 m0, s73, 130304
    ds_read_b64_tr_b16 a[232:233], v10 offset:53248
    v_mfma_f32_16x16x32_bf16 v[32:35], v[108:111], a[136:139], v[32:35]
    buffer_load_dwordx4 v23, s[44:47], s26 offen offset:768 sc1 lds
    ds_read_b64_tr_b16 a[234:235], v10 offset:55296
    s_waitcnt lgkmcnt(3)
    v_mfma_f32_16x16x32_bf16 v[32:35], v[112:115], a[144:147], v[32:35]
    ds_read_b128 v[120:123], v14 offset:50176
    s_add_u32 m0, s73, 81920
    v_mfma_f32_16x16x32_bf16 v[32:35], v[116:119], a[152:155], v[32:35]
    ds_read_b128 v[124:127], v14 offset:54272
    buffer_load_dwordx4 v5, s[52:55], s14 offen offset:1024 lds
    v_mfma_f32_16x16x32_bf16 v[36:39], v[116:119], a[156:159], v[36:39]
    ds_read_b128 v[128:131], v14 offset:58368
    v_mfma_f32_16x16x32_bf16 v[36:39], v[112:115], a[148:151], v[36:39]
    ds_read_b128 v[132:135], v14 offset:62464
    v_mfma_f32_16x16x32_bf16 v[36:39], v[108:111], a[140:143], v[36:39]
    s_add_u32 m0, s73, 132096
    ds_read_b64_tr_b16 a[228:229], v11 offset:49152
    v_mfma_f32_16x16x32_bf16 v[36:39], v[104:107], a[132:135], v[36:39]
    buffer_load_dwordx4 v20, s[44:47], s26 offen offset:0 sc1 lds
    ds_read_b64_tr_b16 a[230:231], v11 offset:51200
    s_waitcnt lgkmcnt(4)
    v_mfma_f32_16x16x32_bf16 v[44:47], v[120:123], a[132:135], v[44:47]
    s_add_u32 m0, s73, 132608
    ds_read_b64_tr_b16 a[236:237], v11 offset:53248
    v_mfma_f32_16x16x32_bf16 v[44:47], v[124:127], a[140:143], v[44:47]
    buffer_load_dwordx4 v20, s[44:47], s26 offen offset:512 sc1 lds
    ds_read_b64_tr_b16 a[238:239], v11 offset:55296
    s_waitcnt lgkmcnt(4)
    v_mfma_f32_16x16x32_bf16 v[44:47], v[128:131], a[148:151], v[44:47]
    ds_read_b128 v[104:107], v14 offset:51200
    s_add_u32 m0, s73, 81920
    v_add_u32 v10, 65536, v10
    v_mfma_f32_16x16x32_bf16 v[44:47], v[132:135], a[156:159], v[44:47]
    ds_read_b128 v[108:111], v14 offset:55296
    buffer_load_dwordx4 v6, s[52:55], s14 offen offset:2048 lds
    v_mfma_f32_16x16x32_bf16 v[40:43], v[132:135], a[152:155], v[40:43]
    ds_read_b128 v[112:115], v14 offset:59392
    v_mfma_f32_16x16x32_bf16 v[40:43], v[128:131], a[144:147], v[40:43]
    ds_read_b128 v[116:119], v14 offset:63488
    v_mfma_f32_16x16x32_bf16 v[40:43], v[124:127], a[136:139], v[40:43]
    s_add_u32 m0, s73, 134144
    ds_read_b64_tr_b16 a[240:241], v10 offset:0
    v_mfma_f32_16x16x32_bf16 v[40:43], v[120:123], a[128:131], v[40:43]
    buffer_load_dwordx4 v21, s[44:47], s18 offen offset:0 sc1 lds
    ds_read_b64_tr_b16 a[242:243], v10 offset:2048
    s_waitcnt lgkmcnt(4)
    v_mfma_f32_16x16x32_bf16 v[48:51], v[104:107], a[128:131], v[48:51]
    ds_read_b64_tr_b16 a[248:249], v10 offset:4096
    s_add_u32 m0, s73, 81920
    v_mfma_f32_16x16x32_bf16 v[48:51], v[108:111], a[136:139], v[48:51]
    ds_read_b64_tr_b16 a[250:251], v10 offset:6144
    buffer_load_dwordx4 v7, s[52:55], s14 offen offset:3072 lds
    s_waitcnt lgkmcnt(4)
    v_mfma_f32_16x16x32_bf16 v[48:51], v[112:115], a[144:147], v[48:51]
    ds_read_b128 v[120:123], v14 offset:52224
    v_add_u32 v11, 65536, v11
    v_mfma_f32_16x16x32_bf16 v[48:51], v[116:119], a[152:155], v[48:51]
    ds_read_b128 v[124:127], v14 offset:56320
    v_mfma_f32_16x16x32_bf16 v[52:55], v[116:119], a[156:159], v[52:55]
    ds_read_b128 v[128:131], v14 offset:60416
    v_mfma_f32_16x16x32_bf16 v[52:55], v[112:115], a[148:151], v[52:55]
    ds_read_b128 v[132:135], v14 offset:64512
    v_mfma_f32_16x16x32_bf16 v[52:55], v[108:111], a[140:143], v[52:55]
    ds_read_b64_tr_b16 a[244:245], v11 offset:0
    v_mfma_f32_16x16x32_bf16 v[52:55], v[104:107], a[132:135], v[52:55]
    ds_read_b64_tr_b16 a[246:247], v11 offset:2048
    s_waitcnt lgkmcnt(4)
    v_mfma_f32_16x16x32_bf16 v[36:39], v[120:123], a[164:167], v[36:39]
    ds_read_b64_tr_b16 a[252:253], v11 offset:4096
    v_mfma_f32_16x16x32_bf16 v[36:39], v[124:127], a[172:175], v[36:39]
    ds_read_b64_tr_b16 a[254:255], v11 offset:6144
    s_waitcnt lgkmcnt(4)
    v_mfma_f32_16x16x32_bf16 v[36:39], v[128:131], a[180:183], v[36:39]
    s_waitcnt vmcnt(10) lgkmcnt(0)
    s_barrier
    v_mfma_f32_16x16x32_bf16 v[36:39], v[132:135], a[188:191], v[36:39]
    ds_read_b128 v[104:107], v14 offset:0
    v_mfma_f32_16x16x32_bf16 v[32:35], v[132:135], a[184:187], v[32:35]
    ds_read_b128 v[108:111], v14 offset:4096
    v_add_u32 v10, -65536, v10
    v_mfma_f32_16x16x32_bf16 v[32:35], v[128:131], a[176:179], v[32:35]
    ds_read_b128 v[112:115], v14 offset:8192
    v_mfma_f32_16x16x32_bf16 v[32:35], v[124:127], a[168:171], v[32:35]
    ds_read_b128 v[116:119], v14 offset:12288
    v_mfma_f32_16x16x32_bf16 v[32:35], v[120:123], a[160:163], v[32:35]
    ds_read_b64_tr_b16 v[220:221], v10 offset:32768
    s_waitcnt lgkmcnt(3)
    v_mfma_f32_16x16x32_bf16 v[40:43], v[104:107], a[160:163], v[40:43]
    s_add_u32 m0, s73, 146944
    v_mfma_f32_16x16x32_bf16 v[40:43], v[108:111], a[168:171], v[40:43]
    buffer_load_dwordx4 v21, s[44:47], s18 offen offset:512 sc1 lds
    ds_read_b64_tr_b16 v[222:223], v10 offset:34816
    s_waitcnt lgkmcnt(2)
    v_mfma_f32_16x16x32_bf16 v[40:43], v[112:115], a[176:179], v[40:43]
    ds_read_b128 v[120:123], v14 offset:1024
    v_mfma_f32_16x16x32_bf16 v[40:43], v[116:119], a[184:187], v[40:43]
    ds_read_b128 v[124:127], v14 offset:5120
    v_mfma_f32_16x16x32_bf16 v[44:47], v[116:119], a[188:191], v[44:47]
    ds_read_b128 v[128:131], v14 offset:9216
    v_mfma_f32_16x16x32_bf16 v[44:47], v[112:115], a[180:183], v[44:47]
    ds_read_b128 v[132:135], v14 offset:13312
    buffer_load_dwordx4 v[88:91], v252, s[56:59], 0 offen
    v_mfma_f32_16x16x32_bf16 v[44:47], v[108:111], a[172:175], v[44:47]
    s_add_u32 m0, s73, 148480
    ds_read_b64_tr_b16 v[228:229], v10 offset:36864
    v_mfma_f32_16x16x32_bf16 v[44:47], v[104:107], a[164:167], v[44:47]
    buffer_load_dwordx4 v21, s[44:47], s19 offen offset:0 sc1 lds
    s_waitcnt lgkmcnt(3)
    v_mfma_f32_16x16x32_bf16 v[52:55], v[120:123], a[164:167], v[52:55]
    s_add_u32 m0, s73, 148992
    ds_read_b64_tr_b16 v[230:231], v10 offset:38912
    v_mfma_f32_16x16x32_bf16 v[52:55], v[124:127], a[172:175], v[52:55]
    buffer_load_dwordx4 v21, s[44:47], s19 offen offset:512 sc1 lds
    s_waitcnt lgkmcnt(2)
    v_mfma_f32_16x16x32_bf16 v[52:55], v[128:131], a[180:183], v[52:55]
    ds_read_b128 v[104:107], v14 offset:2048
    v_mfma_f32_16x16x32_bf16 v[52:55], v[132:135], a[188:191], v[52:55]
    ds_read_b128 v[108:111], v14 offset:6144
    v_mfma_f32_16x16x32_bf16 v[48:51], v[132:135], a[184:187], v[48:51]
    ds_read_b128 v[112:115], v14 offset:10240
    v_add_u32 v11, -65536, v11
    v_mfma_f32_16x16x32_bf16 v[48:51], v[128:131], a[176:179], v[48:51]
    ds_read_b128 v[116:119], v14 offset:14336
    v_mfma_f32_16x16x32_bf16 v[48:51], v[124:127], a[168:171], v[48:51]
    s_add_u32 m0, s73, 150528
    v_mfma_f32_16x16x32_bf16 v[48:51], v[120:123], a[160:163], v[48:51]
    buffer_load_dwordx4 v21, s[44:47], s20 offen offset:0 sc1 lds
    ds_read_b64_tr_b16 v[224:225], v11 offset:32768
    s_waitcnt lgkmcnt(3)
    v_mfma_f32_16x16x32_bf16 v[32:35], v[104:107], a[192:195], v[32:35]
    buffer_load_dwordx4 v[92:95], v252, s[56:59], s40 offen
    v_mfma_f32_16x16x32_bf16 v[32:35], v[108:111], a[200:203], v[32:35]
    ds_read_b64_tr_b16 v[226:227], v11 offset:34816
    s_waitcnt vmcnt(13)
    s_waitcnt lgkmcnt(2)
    v_mfma_f32_16x16x32_bf16 v[32:35], v[112:115], a[208:211], v[32:35]
    ds_read_b128 v[120:123], v14 offset:3072
    v_mfma_f32_16x16x32_bf16 v[32:35], v[116:119], a[216:219], v[32:35]
    ds_read_b128 v[124:127], v14 offset:7168
    v_lshlrev_b32 v72, 16, v102
    v_mfma_f32_16x16x32_bf16 v[36:39], v[116:119], a[220:223], v[36:39]
    ds_read_b128 v[128:131], v14 offset:11264
    v_mfma_f32_16x16x32_bf16 v[36:39], v[112:115], a[212:215], v[36:39]
    ds_read_b128 v[132:135], v14 offset:15360
    v_mfma_f32_16x16x32_bf16 v[36:39], v[108:111], a[204:207], v[36:39]
    ds_read_b64_tr_b16 v[232:233], v11 offset:36864
    v_lshlrev_b32 v73, 16, v102
    v_mfma_f32_16x16x32_bf16 v[36:39], v[104:107], a[196:199], v[36:39]
    s_waitcnt lgkmcnt(3)
    v_mfma_f32_16x16x32_bf16 v[44:47], v[120:123], a[196:199], v[44:47]
    ds_read_b64_tr_b16 v[234:235], v11 offset:38912
    v_mfma_f32_16x16x32_bf16 v[44:47], v[124:127], a[204:207], v[44:47]
    v_lshlrev_b32 v74, 16, v102
    s_waitcnt lgkmcnt(2)
    v_mfma_f32_16x16x32_bf16 v[44:47], v[128:131], a[212:215], v[44:47]
    buffer_load_dwordx2 v[142:143], v253, s[56:59], 0 offen
    s_waitcnt vmcnt(7) lgkmcnt(0)
    s_barrier
    v_mfma_f32_16x16x32_bf16 v[44:47], v[132:135], a[220:223], v[44:47]
    ds_read_b128 v[104:107], v14 offset:16384
    v_lshlrev_b32 v75, 16, v102
    v_mfma_f32_16x16x32_bf16 v[40:43], v[132:135], a[216:219], v[40:43]
    ds_read_b128 v[108:111], v14 offset:20480
    v_add_u32 v10, 65536, v10
    v_mfma_f32_16x16x32_bf16 v[40:43], v[128:131], a[208:211], v[40:43]
    ds_read_b128 v[112:115], v14 offset:24576
    v_mfma_f32_16x16x32_bf16 v[40:43], v[124:127], a[200:203], v[40:43]
    ds_read_b128 v[116:119], v14 offset:28672
    v_lshlrev_b32 v76, 16, v103
    v_mfma_f32_16x16x32_bf16 v[40:43], v[120:123], a[192:195], v[40:43]
    ds_read_b64_tr_b16 v[236:237], v10 offset:16384
    s_waitcnt lgkmcnt(3)
    v_mfma_f32_16x16x32_bf16 v[48:51], v[104:107], a[192:195], v[48:51]
    s_add_u32 m0, s73, 97792
    v_lshlrev_b32 v77, 16, v103
    v_mfma_f32_16x16x32_bf16 v[48:51], v[108:111], a[200:203], v[48:51]
    buffer_load_dwordx4 v21, s[44:47], s20 offen offset:512 sc1 lds
    ds_read_b64_tr_b16 v[238:239], v10 offset:18432
    s_waitcnt lgkmcnt(2)
    v_mfma_f32_16x16x32_bf16 v[48:51], v[112:115], a[208:211], v[48:51]
    ds_read_b128 v[120:123], v14 offset:17408
    v_mfma_f32_16x16x32_bf16 v[48:51], v[116:119], a[216:219], v[48:51]
    ds_read_b128 v[124:127], v14 offset:21504
    v_mfma_f32_16x16x32_bf16 v[52:55], v[116:119], a[220:223], v[52:55]
    ds_read_b128 v[128:131], v14 offset:25600
    v_lshlrev_b32 v78, 16, v103
    v_mfma_f32_16x16x32_bf16 v[52:55], v[112:115], a[212:215], v[52:55]
    ds_read_b128 v[132:135], v14 offset:29696
    buffer_load_dwordx2 v[96:97], v26, s[44:47], s42 offen offset:0 sc1
    v_mfma_f32_16x16x32_bf16 v[52:55], v[108:111], a[204:207], v[52:55]
    ds_read_b64_tr_b16 v[244:245], v10 offset:20480
    s_add_u32 m0, s73, 99328
    v_lshlrev_b32 v79, 16, v103
    v_mfma_f32_16x16x32_bf16 v[52:55], v[104:107], a[196:199], v[52:55]
    buffer_load_dwordx4 v21, s[44:47], s21 offen offset:0 sc1 lds
    s_waitcnt lgkmcnt(3)
    v_mfma_f32_16x16x32_bf16 v[36:39], v[120:123], a[228:231], v[36:39]
    ds_read_b64_tr_b16 v[246:247], v10 offset:22528
    s_add_u32 m0, s73, 99840
    v_lshlrev_b32 v80, 16, v102
    v_mfma_f32_16x16x32_bf16 v[36:39], v[124:127], a[236:239], v[36:39]
    buffer_load_dwordx4 v21, s[44:47], s21 offen offset:512 sc1 lds
    s_waitcnt lgkmcnt(2)
    v_mfma_f32_16x16x32_bf16 v[36:39], v[128:131], a[244:247], v[36:39]
    ds_read_b128 v[104:107], v14 offset:18432
    v_mfma_f32_16x16x32_bf16 v[36:39], v[132:135], a[252:255], v[36:39]
    ds_read_b128 v[108:111], v14 offset:22528
    v_lshlrev_b32 v81, 16, v102
    v_mfma_f32_16x16x32_bf16 v[32:35], v[132:135], a[248:251], v[32:35]
    ds_read_b128 v[112:115], v14 offset:26624
    v_add_u32 v11, 65536, v11
    v_mfma_f32_16x16x32_bf16 v[32:35], v[128:131], a[240:243], v[32:35]
    ds_read_b128 v[116:119], v14 offset:30720
    v_mfma_f32_16x16x32_bf16 v[32:35], v[124:127], a[232:235], v[32:35]
    s_add_u32 m0, s73, 101376
    v_lshlrev_b32 v82, 16, v102
    v_mfma_f32_16x16x32_bf16 v[32:35], v[120:123], a[224:227], v[32:35]
    buffer_load_dwordx4 v21, s[44:47], s22 offen offset:0 sc1 lds
    ds_read_b64_tr_b16 v[240:241], v11 offset:16384
    s_waitcnt lgkmcnt(3)
    v_mfma_f32_16x16x32_bf16 v[40:43], v[104:107], a[224:227], v[40:43]
    buffer_load_dwordx2 v[98:99], v26, s[44:47], s42 offen offset:128 sc1
    v_lshlrev_b32 v83, 16, v102
    v_mfma_f32_16x16x32_bf16 v[40:43], v[108:111], a[232:235], v[40:43]
    ds_read_b64_tr_b16 v[242:243], v11 offset:18432
    s_waitcnt lgkmcnt(2)
    v_mfma_f32_16x16x32_bf16 v[40:43], v[112:115], a[240:243], v[40:43]
    ds_read_b128 v[120:123], v14 offset:19456
    v_mfma_f32_16x16x32_bf16 v[40:43], v[116:119], a[248:251], v[40:43]
    ds_read_b128 v[124:127], v14 offset:23552
    v_mfma_f32_16x16x32_bf16 v[44:47], v[116:119], a[252:255], v[44:47]
    ds_read_b128 v[128:131], v14 offset:27648
    v_lshlrev_b32 v84, 16, v103
    v_mfma_f32_16x16x32_bf16 v[44:47], v[112:115], a[244:247], v[44:47]
    ds_read_b128 v[132:135], v14 offset:31744
    v_mfma_f32_16x16x32_bf16 v[44:47], v[108:111], a[236:239], v[44:47]
    ds_read_b64_tr_b16 v[248:249], v11 offset:20480
    v_lshlrev_b32 v85, 16, v103
    v_mfma_f32_16x16x32_bf16 v[44:47], v[104:107], a[228:231], v[44:47]
    s_waitcnt lgkmcnt(3)
    v_mfma_f32_16x16x32_bf16 v[52:55], v[120:123], a[228:231], v[52:55]
    ds_read_b64_tr_b16 v[250:251], v11 offset:22528
    v_mfma_f32_16x16x32_bf16 v[52:55], v[124:127], a[236:239], v[52:55]
    v_lshlrev_b32 v86, 16, v103
    s_waitcnt lgkmcnt(2)
    v_mfma_f32_16x16x32_bf16 v[52:55], v[128:131], a[244:247], v[52:55]
    buffer_load_dwordx2 v[100:101], v18, s[44:47], s42 offen offset:0 sc1
    s_waitcnt lgkmcnt(0)
    s_barrier
    v_mfma_f32_16x16x32_bf16 v[52:55], v[132:135], a[252:255], v[52:55]
    ds_read_b128 v[104:107], v14 offset:32768
    v_mfma_f32_16x16x32_bf16 v[48:51], v[132:135], a[248:251], v[48:51]
    ds_read_b128 v[108:111], v14 offset:36864
    v_lshlrev_b32 v87, 16, v103
    v_mfma_f32_16x16x32_bf16 v[48:51], v[128:131], a[240:243], v[48:51]
    ds_read_b128 v[112:115], v14 offset:40960
    v_mfma_f32_16x16x32_bf16 v[48:51], v[124:127], a[232:235], v[48:51]
    ds_read_b128 v[116:119], v14 offset:45056
    v_lshlrev_b32 v27, 16, v27
    v_mfma_f32_16x16x32_bf16 v[48:51], v[120:123], a[224:227], v[48:51]
L_Dc:
L_pl_D_0:
    s_cbranch_execz L_wret
    s_waitcnt lgkmcnt(2)
    v_mfma_f32_16x16x32_bf16 v[32:35], v[104:107], v[220:223], v[32:35]
    s_add_u32 m0, s73, 114176
    v_mfma_f32_16x16x32_bf16 v[32:35], v[108:111], v[228:231], v[32:35]
    buffer_load_dwordx4 v21, s[44:47], s22 offen offset:512 sc1 lds
    s_waitcnt lgkmcnt(0)
    v_mfma_f32_16x16x32_bf16 v[32:35], v[112:115], v[236:239], v[32:35]
    ds_read_b128 v[120:123], v14 offset:33792
    v_mfma_f32_16x16x32_bf16 v[32:35], v[116:119], v[244:247], v[32:35]
    ds_read_b128 v[124:127], v14 offset:37888
    v_mfma_f32_16x16x32_bf16 v[36:39], v[116:119], v[248:251], v[36:39]
    ds_read_b128 v[128:131], v14 offset:41984
    buffer_load_dword v189, v188, s[44:47], 0 offen sc1
    v_mfma_f32_16x16x32_bf16 v[36:39], v[112:115], v[240:243], v[36:39]
    ds_read_b128 v[132:135], v14 offset:46080
    v_mfma_f32_16x16x32_bf16 v[36:39], v[108:111], v[232:235], v[36:39]
    s_add_u32 m0, s73, 115712
    v_mfma_f32_16x16x32_bf16 v[36:39], v[104:107], v[224:227], v[36:39]
    buffer_load_dwordx4 v21, s[44:47], s23 offen offset:0 sc1 lds
    s_waitcnt lgkmcnt(2)
    v_mfma_f32_16x16x32_bf16 v[44:47], v[120:123], v[224:227], v[44:47]
    s_add_u32 m0, s73, 116224
    v_mfma_f32_16x16x32_bf16 v[44:47], v[124:127], v[232:235], v[44:47]
    buffer_load_dwordx4 v21, s[44:47], s23 offen offset:512 sc1 lds
    s_waitcnt lgkmcnt(0)
    v_mfma_f32_16x16x32_bf16 v[44:47], v[128:131], v[240:243], v[44:47]
    ds_read_b128 v[104:107], v14 offset:34816
    v_mfma_f32_16x16x32_bf16 v[44:47], v[132:135], v[248:251], v[44:47]
    ds_read_b128 v[108:111], v14 offset:38912
    v_mfma_f32_16x16x32_bf16 v[40:43], v[132:135], v[244:247], v[40:43]
    ds_read_b128 v[112:115], v14 offset:43008
    v_mfma_f32_16x16x32_bf16 v[40:43], v[128:131], v[236:239], v[40:43]
    ds_read_b128 v[116:119], v14 offset:47104
    v_mfma_f32_16x16x32_bf16 v[40:43], v[124:127], v[228:231], v[40:43]
    s_add_u32 m0, s73, 117760
    v_mfma_f32_16x16x32_bf16 v[40:43], v[120:123], v[220:223], v[40:43]
    buffer_load_dwordx4 v21, s[44:47], s24 offen offset:0 sc1 lds
    s_waitcnt lgkmcnt(2)
    v_mfma_f32_16x16x32_bf16 v[48:51], v[104:107], v[220:223], v[48:51]
    v_mfma_f32_16x16x32_bf16 v[48:51], v[108:111], v[228:231], v[48:51]
    s_waitcnt lgkmcnt(0)
    v_mfma_f32_16x16x32_bf16 v[48:51], v[112:115], v[236:239], v[48:51]
    ds_read_b128 v[120:123], v14 offset:35840
    v_mfma_f32_16x16x32_bf16 v[48:51], v[116:119], v[244:247], v[48:51]
    ds_read_b128 v[124:127], v14 offset:39936
    v_mfma_f32_16x16x32_bf16 v[52:55], v[116:119], v[248:251], v[52:55]
    ds_read_b128 v[128:131], v14 offset:44032
    v_mfma_f32_16x16x32_bf16 v[52:55], v[112:115], v[240:243], v[52:55]
    ds_read_b128 v[132:135], v14 offset:48128
    v_mfma_f32_16x16x32_bf16 v[52:55], v[108:111], v[232:235], v[52:55]
    v_mfma_f32_16x16x32_bf16 v[52:55], v[104:107], v[224:227], v[52:55]
    s_waitcnt lgkmcnt(2)
    v_mfma_f32_16x16x32_bf16 v[60:63], v[120:123], a[4:7], 0
    v_mfma_f32_16x16x32_bf16 v[60:63], v[124:127], a[12:15], v[60:63]
    s_waitcnt lgkmcnt(0)
    v_mfma_f32_16x16x32_bf16 v[60:63], v[128:131], a[20:23], v[60:63]
    s_waitcnt vmcnt(14)
    s_barrier
    v_mfma_f32_16x16x32_bf16 v[60:63], v[132:135], a[28:31], v[60:63]
    ds_read_b128 v[104:107], v14 offset:49152
    v_mfma_f32_16x16x32_bf16 v[56:59], v[132:135], a[24:27], 0
    ds_read_b128 v[108:111], v14 offset:53248
    v_mfma_f32_16x16x32_bf16 v[56:59], v[128:131], a[16:19], v[56:59]
    ds_read_b128 v[112:115], v14 offset:57344
    v_cvt_pk_bf16_f32 v192, v32, v33
    v_mfma_f32_16x16x32_bf16 v[56:59], v[124:127], a[8:11], v[56:59]
    ds_read_b128 v[116:119], v14 offset:61440
    v_mfma_f32_16x16x32_bf16 v[56:59], v[120:123], a[0:3], v[56:59]
    s_waitcnt lgkmcnt(2)
    v_mfma_f32_16x16x32_bf16 v[64:67], v[104:107], a[0:3], 0
    s_add_u32 m0, s73, 130560
    v_mfma_f32_16x16x32_bf16 v[64:67], v[108:111], a[8:11], v[64:67]
    buffer_load_dwordx4 v21, s[44:47], s24 offen offset:512 sc1 lds
    s_waitcnt lgkmcnt(0)
    v_mfma_f32_16x16x32_bf16 v[64:67], v[112:115], a[16:19], v[64:67]
    ds_read_b128 v[120:123], v14 offset:50176
    v_cvt_pk_bf16_f32 v193, v34, v35
    v_mfma_f32_16x16x32_bf16 v[64:67], v[116:119], a[24:27], v[64:67]
    ds_read_b128 v[124:127], v14 offset:54272
    v_mfma_f32_16x16x32_bf16 v[68:71], v[116:119], a[28:31], 0
    ds_read_b128 v[128:131], v14 offset:58368
    v_mfma_f32_16x16x32_bf16 v[68:71], v[112:115], a[20:23], v[68:71]
    buffer_store_dwordx4 v[192:195], v136, s[44:47], s32 offen sc1
    ds_read_b128 v[132:135], v14 offset:62464
    v_mfma_f32_16x16x32_bf16 v[68:71], v[108:111], a[12:15], v[68:71]
    s_add_u32 m0, s73, 132096
    v_mfma_f32_16x16x32_bf16 v[68:71], v[104:107], a[4:7], v[68:71]
    buffer_load_dwordx4 v21, s[44:47], s25 offen offset:0 sc1 lds
    s_waitcnt lgkmcnt(2)
    v_mfma_f32_16x16x32_bf16 v[60:63], v[120:123], a[36:39], v[60:63]
    s_add_u32 m0, s73, 132608
    v_mfma_f32_16x16x32_bf16 v[60:63], v[124:127], a[44:47], v[60:63]
    buffer_load_dwordx4 v21, s[44:47], s25 offen offset:512 sc1 lds
    s_waitcnt lgkmcnt(0)
    v_mfma_f32_16x16x32_bf16 v[60:63], v[128:131], a[52:55], v[60:63]
    ds_read_b128 v[104:107], v14 offset:51200
    v_mfma_f32_16x16x32_bf16 v[60:63], v[132:135], a[60:63], v[60:63]
    ds_read_b128 v[108:111], v14 offset:55296
    v_mfma_f32_16x16x32_bf16 v[56:59], v[132:135], a[56:59], v[56:59]
    ds_read_b128 v[112:115], v14 offset:59392
    v_mfma_f32_16x16x32_bf16 v[56:59], v[128:131], a[48:51], v[56:59]
    ds_read_b128 v[116:119], v14 offset:63488
    v_mfma_f32_16x16x32_bf16 v[56:59], v[124:127], a[40:43], v[56:59]
    s_add_u32 m0, s73, 134144
    v_cvt_pk_bf16_f32 v196, v36, v37
    v_mfma_f32_16x16x32_bf16 v[56:59], v[120:123], a[32:35], v[56:59]
    buffer_load_dwordx4 v21, s[44:47], s26 offen offset:0 sc1 lds
    s_waitcnt lgkmcnt(2)
    v_mfma_f32_16x16x32_bf16 v[64:67], v[104:107], a[32:35], v[64:67]
    v_mfma_f32_16x16x32_bf16 v[64:67], v[108:111], a[40:43], v[64:67]
    s_waitcnt lgkmcnt(0)
    v_mfma_f32_16x16x32_bf16 v[64:67], v[112:115], a[48:51], v[64:67]
    ds_read_b128 v[120:123], v14 offset:52224
    v_cvt_pk_bf16_f32 v197, v38, v39
    v_mfma_f32_16x16x32_bf16 v[64:67], v[116:119], a[56:59], v[64:67]
    ds_read_b128 v[124:127], v14 offset:56320
    v_mfma_f32_16x16x32_bf16 v[68:71], v[116:119], a[60:63], v[68:71]
    ds_read_b128 v[128:131], v14 offset:60416
    v_mfma_f32_16x16x32_bf16 v[68:71], v[112:115], a[52:55], v[68:71]
    ds_read_b128 v[132:135], v14 offset:64512
    v_mfma_f32_16x16x32_bf16 v[68:71], v[108:111], a[44:47], v[68:71]
    buffer_store_dwordx4 v[196:199], v136, s[44:47], s33 offen sc1
    v_mfma_f32_16x16x32_bf16 v[68:71], v[104:107], a[36:39], v[68:71]
    s_waitcnt lgkmcnt(2)
    v_mfma_f32_16x16x32_bf16 v[60:63], v[120:123], a[68:71], v[60:63]
    v_mfma_f32_16x16x32_bf16 v[60:63], v[124:127], a[76:79], v[60:63]
    s_waitcnt lgkmcnt(0)
    v_mfma_f32_16x16x32_bf16 v[60:63], v[128:131], a[84:87], v[60:63]
    s_waitcnt vmcnt(13)
    s_barrier
    v_mfma_f32_16x16x32_bf16 v[60:63], v[132:135], a[92:95], v[60:63]
    ds_read_b128 v[104:107], v14 offset:0
    v_mfma_f32_16x16x32_bf16 v[56:59], v[132:135], a[88:91], v[56:59]
    ds_read_b128 v[108:111], v14 offset:4096
    v_mfma_f32_16x16x32_bf16 v[56:59], v[128:131], a[80:83], v[56:59]
    ds_read_b128 v[112:115], v14 offset:8192
    v_cvt_pk_bf16_f32 v192, v40, v41
    v_mfma_f32_16x16x32_bf16 v[56:59], v[124:127], a[72:75], v[56:59]
    ds_read_b128 v[116:119], v14 offset:12288
    v_mfma_f32_16x16x32_bf16 v[56:59], v[120:123], a[64:67], v[56:59]
    s_waitcnt lgkmcnt(2)
    v_mfma_f32_16x16x32_bf16 v[64:67], v[104:107], a[64:67], v[64:67]
    s_add_u32 m0, s73, 146944
    v_cvt_pk_bf16_f32 v193, v42, v43
    s_waitcnt vmcnt(11)
    v_mfma_f32_16x16x32_bf16 v[64:67], v[108:111], a[72:75], v[64:67]
    buffer_load_dwordx4 v21, s[44:47], s26 offen offset:512 sc1 lds
    s_waitcnt lgkmcnt(0)
    v_mfma_f32_16x16x32_bf16 v[64:67], v[112:115], a[80:83], v[64:67]
    ds_read_b128 v[120:123], v14 offset:1024
    v_mul_f32 v96, v96, v97
    v_mfma_f32_16x16x32_bf16 v[64:67], v[116:119], a[88:91], v[64:67]
    ds_read_b128 v[124:127], v14 offset:5120
    v_cvt_pk_bf16_f32 v194, v44, v45
    v_mfma_f32_16x16x32_bf16 v[68:71], v[116:119], a[92:95], v[68:71]
    ds_read_b128 v[128:131], v14 offset:9216
    v_mul_f32 v98, v98, v99
    v_mfma_f32_16x16x32_bf16 v[68:71], v[112:115], a[84:87], v[68:71]
    ds_read_b128 v[132:135], v14 offset:13312
    v_mul_f32 v100, v100, v101
    v_mfma_f32_16x16x32_bf16 v[68:71], v[108:111], a[76:79], v[68:71]
    buffer_store_dwordx4 v[192:195], v136, s[44:47], s30 offen offset:0 sc1
    s_add_u32 m0, s73, 148480
    v_permlane16_swap_b32 v88, v90
    v_mfma_f32_16x16x32_bf16 v[68:71], v[104:107], a[68:71], v[68:71]
    buffer_load_dwordx4 v22, s[44:47], s18 offen offset:0 sc1 lds
    s_waitcnt lgkmcnt(2)
    v_mfma_f32_16x16x32_bf16 v[60:63], v[120:123], a[100:103], v[60:63]
    s_add_u32 m0, s73, 148992
    v_permlane16_swap_b32 v89, v91
    v_permlane16_swap_b32 v92, v94
    v_mfma_f32_16x16x32_bf16 v[60:63], v[124:127], a[108:111], v[60:63]
    buffer_load_dwordx4 v22, s[44:47], s18 offen offset:512 sc1 lds
    s_waitcnt vmcnt(13)
    s_waitcnt lgkmcnt(0)
    v_mfma_f32_16x16x32_bf16 v[60:63], v[128:131], a[116:119], v[60:63]
    ds_read_b128 v[104:107], v14 offset:2048
    v_permlane16_swap_b32 v93, v95
    v_mfma_f32_16x16x32_bf16 v[60:63], v[132:135], a[124:127], v[60:63]
    ds_read_b128 v[108:111], v14 offset:6144
    v_cmp_ne_u32 vcc, s68, v189
    v_mfma_f32_16x16x32_bf16 v[56:59], v[132:135], a[120:123], v[56:59]
    ds_read_b128 v[112:115], v14 offset:10240
    v_and_b32 v145, 0xffff0000, v88
    v_mfma_f32_16x16x32_bf16 v[56:59], v[128:131], a[112:115], v[56:59]
    ds_read_b128 v[116:119], v14 offset:14336
    v_cvt_pk_bf16_f32 v196, v46, v47
    v_mfma_f32_16x16x32_bf16 v[56:59], v[124:127], a[104:107], v[56:59]
    s_add_u32 m0, s73, 150528
    s_cbranch_vccnz L_rs_p3
L_ok_p3:
    v_lshlrev_b32 v144, 16, v88
    v_mfma_f32_16x16x32_bf16 v[56:59], v[120:123], a[96:99], v[56:59]
    buffer_load_dwordx4 v22, s[44:47], s19 offen offset:0 sc1 lds
    s_waitcnt lgkmcnt(2)
    v_mfma_f32_16x16x32_bf16 v[64:67], v[104:107], a[96:99], v[64:67]
    s_add_u32 m0, s73, 81920
    v_cvt_pk_bf16_f32 v197, v48, v49
    v_and_b32 v147, 0xffff0000, v89
    v_mfma_f32_16x16x32_bf16 v[64:67], v[108:111], a[104:107], v[64:67]
    buffer_load_dwordx4 v184, s[44:47], s37 offen offset:0 sc1 lds
    s_waitcnt lgkmcnt(0)
    v_mfma_f32_16x16x32_bf16 v[64:67], v[112:115], a[112:115], v[64:67]
    ds_read_b128 v[120:123], v14 offset:3072
    buffer_load_dwordx4 v185, s[44:47], s37 offen offset:1024 sc1 lds
    v_mfma_f32_16x16x32_bf16 v[64:67], v[116:119], a[120:123], v[64:67]
    ds_read_b128 v[124:127], v14 offset:7168
    s_add_u32 m0, s73, 83968
    v_cvt_pk_bf16_f32 v198, v50, v51
    v_mfma_f32_16x16x32_bf16 v[68:71], v[116:119], a[124:127], v[68:71]
    ds_read_b128 v[128:131], v14 offset:11264
    buffer_load_dwordx4 v184, s[44:47], s16 offen offset:0 sc1 lds
    v_mfma_f32_16x16x32_bf16 v[68:71], v[112:115], a[116:119], v[68:71]
    ds_read_b128 v[132:135], v14 offset:15360
    buffer_load_dwordx4 v185, s[44:47], s16 offen offset:1024 sc1 lds
    v_mfma_f32_16x16x32_bf16 v[68:71], v[108:111], a[108:111], v[68:71]
    buffer_store_dwordx4 v[196:199], v136, s[44:47], s30 offen offset:1024 sc1
    v_lshlrev_b32 v146, 16, v89
    v_and_b32 v149, 0xffff0000, v92
    v_lshlrev_b32 v148, 16, v92
    v_mfma_f32_16x16x32_bf16 v[68:71], v[104:107], a[100:103], v[68:71]
    s_waitcnt lgkmcnt(2)
    v_mfma_f32_16x16x32_bf16 v[60:63], v[120:123], a[132:135], v[60:63]
    v_and_b32 v151, 0xffff0000, v93
    v_mfma_f32_16x16x32_bf16 v[60:63], v[124:127], a[140:143], v[60:63]
    v_lshlrev_b32 v150, 16, v93
    s_waitcnt lgkmcnt(0)
    v_mfma_f32_16x16x32_bf16 v[60:63], v[128:131], a[148:151], v[60:63]
    s_waitcnt vmcnt(16)
    s_barrier
    v_mfma_f32_16x16x32_bf16 v[60:63], v[132:135], a[156:159], v[60:63]
    ds_read_b128 v[104:107], v14 offset:16384
    v_and_b32 v153, 0xffff0000, v90
    v_mfma_f32_16x16x32_bf16 v[56:59], v[132:135], a[152:155], v[56:59]
    ds_read_b128 v[108:111], v14 offset:20480
    v_lshlrev_b32 v152, 16, v90
    v_mfma_f32_16x16x32_bf16 v[56:59], v[128:131], a[144:147], v[56:59]
    ds_read_b128 v[112:115], v14 offset:24576
    v_cvt_pk_bf16_f32 v200, v52, v53
    v_mfma_f32_16x16x32_bf16 v[56:59], v[124:127], a[136:139], v[56:59]
    ds_read_b128 v[116:119], v14 offset:28672
    v_and_b32 v155, 0xffff0000, v91
    v_mfma_f32_16x16x32_bf16 v[56:59], v[120:123], a[128:131], v[56:59]
    s_waitcnt lgkmcnt(2)
    v_mfma_f32_16x16x32_bf16 v[64:67], v[104:107], a[128:131], v[64:67]
    s_add_u32 m0, s73, 97792
    v_lshlrev_b32 v154, 16, v91
    v_mfma_f32_16x16x32_bf16 v[64:67], v[108:111], a[136:139], v[64:67]
    buffer_load_dwordx4 v22, s[44:47], s19 offen offset:512 sc1 lds
    s_waitcnt lgkmcnt(0)
    v_mfma_f32_16x16x32_bf16 v[64:67], v[112:115], a[144:147], v[64:67]
    ds_read_b128 v[120:123], v14 offset:17408
    v_cvt_pk_bf16_f32 v201, v54, v55
    v_mfma_f32_16x16x32_bf16 v[64:67], v[116:119], a[152:155], v[64:67]
    ds_read_b128 v[124:127], v14 offset:21504
    v_and_b32 v157, 0xffff0000, v94
    v_mfma_f32_16x16x32_bf16 v[68:71], v[116:119], a[156:159], v[68:71]
    ds_read_b128 v[128:131], v14 offset:25600
    v_lshlrev_b32 v156, 16, v94
    v_mfma_f32_16x16x32_bf16 v[68:71], v[112:115], a[148:151], v[68:71]
    buffer_store_dwordx4 v[200:203], v136, s[44:47], s30 offen offset:2048 sc1
    ds_read_b128 v[132:135], v14 offset:29696
    v_and_b32 v159, 0xffff0000, v95
L_pl_D_1:
    s_cbranch_execz L_wret
    v_mfma_f32_16x16x32_bf16 v[68:71], v[108:111], a[140:143], v[68:71]
    s_add_u32 m0, s73, 99328
    v_lshlrev_b32 v158, 16, v95
    v_mfma_f32_16x16x32_bf16 v[68:71], v[104:107], a[132:135], v[68:71]
    buffer_load_dwordx4 v22, s[44:47], s20 offen offset:0 sc1 lds
    s_waitcnt lgkmcnt(2)
    v_mfma_f32_16x16x32_bf16 v[60:63], v[120:123], a[164:167], v[60:63]
    s_add_u32 m0, s73, 99840
    v_and_b32 v161, 0xffff0000, v142
    v_mfma_f32_16x16x32_bf16 v[60:63], v[124:127], a[172:175], v[60:63]
    buffer_load_dwordx4 v22, s[44:47], s20 offen offset:512 sc1 lds
    s_waitcnt lgkmcnt(0)
    v_mfma_f32_16x16x32_bf16 v[60:63], v[128:131], a[180:183], v[60:63]
    ds_read_b128 v[104:107], v14 offset:18432
    v_lshlrev_b32 v160, 16, v142
    v_mfma_f32_16x16x32_bf16 v[60:63], v[132:135], a[188:191], v[60:63]
    ds_read_b128 v[108:111], v14 offset:22528
    v_mfma_f32_16x16x32_bf16 v[56:59], v[132:135], a[184:187], v[56:59]
    ds_read_b128 v[112:115], v14 offset:26624
    v_and_b32 v163, 0xffff0000, v143
    v_mfma_f32_16x16x32_bf16 v[56:59], v[128:131], a[176:179], v[56:59]
    ds_read_b128 v[116:119], v14 offset:30720
    v_lshlrev_b32 v162, 16, v143
    v_mfma_f32_16x16x32_bf16 v[56:59], v[124:127], a[168:171], v[56:59]
    s_add_u32 m0, s73, 101376
    v_mfma_f32_16x16x32_bf16 v[56:59], v[120:123], a[160:163], v[56:59]
    buffer_load_dwordx4 v22, s[44:47], s21 offen offset:0 sc1 lds
    s_waitcnt lgkmcnt(2)
    v_mfma_f32_16x16x32_bf16 v[64:67], v[104:107], a[160:163], v[64:67]
    v_fma_f32 v164, v144, v97, -v96
    v_mfma_f32_16x16x32_bf16 v[64:67], v[108:111], a[168:171], v[64:67]
    v_fma_f32 v165, v145, v97, -v96
    s_waitcnt lgkmcnt(0)
    v_mfma_f32_16x16x32_bf16 v[64:67], v[112:115], a[176:179], v[64:67]
    ds_read_b128 v[120:123], v14 offset:19456
    v_fma_f32 v166, v146, v97, -v96
    v_mfma_f32_16x16x32_bf16 v[64:67], v[116:119], a[184:187], v[64:67]
    ds_read_b128 v[124:127], v14 offset:23552
    v_mfma_f32_16x16x32_bf16 v[68:71], v[116:119], a[188:191], v[68:71]
    ds_read_b128 v[128:131], v14 offset:27648
    v_fma_f32 v167, v147, v97, -v96
    v_mfma_f32_16x16x32_bf16 v[68:71], v[112:115], a[180:183], v[68:71]
    ds_read_b128 v[132:135], v14 offset:31744
    v_mfma_f32_16x16x32_bf16 v[68:71], v[108:111], a[172:175], v[68:71]
    v_fma_f32 v168, v148, v99, -v98
    v_mfma_f32_16x16x32_bf16 v[68:71], v[104:107], a[164:167], v[68:71]
    v_fma_f32 v169, v149, v99, -v98
    s_waitcnt lgkmcnt(2)
    v_mfma_f32_16x16x32_bf16 v[60:63], v[120:123], a[196:199], v[60:63]
    v_mfma_f32_16x16x32_bf16 v[60:63], v[124:127], a[204:207], v[60:63]
    v_fma_f32 v170, v150, v99, -v98
    s_waitcnt lgkmcnt(0)
    v_mfma_f32_16x16x32_bf16 v[60:63], v[128:131], a[212:215], v[60:63]
    s_waitcnt vmcnt(16)
    s_barrier
    v_mfma_f32_16x16x32_bf16 v[60:63], v[132:135], a[220:223], v[60:63]
    ds_read_b128 v[104:107], v14 offset:32768
    v_fma_f32 v171, v151, v99, -v98
    v_mfma_f32_16x16x32_bf16 v[56:59], v[132:135], a[216:219], v[56:59]
    ds_read_b128 v[108:111], v14 offset:36864
    v_fma_f32 v172, v152, v97, -v96
    v_mfma_f32_16x16x32_bf16 v[56:59], v[128:131], a[208:211], v[56:59]
    ds_read_b128 v[112:115], v14 offset:40960
    v_mfma_f32_16x16x32_bf16 v[56:59], v[124:127], a[200:203], v[56:59]
    ds_read_b128 v[116:119], v14 offset:45056
    v_fma_f32 v173, v153, v97, -v96
    v_mfma_f32_16x16x32_bf16 v[56:59], v[120:123], a[192:195], v[56:59]
    s_waitcnt lgkmcnt(2)
    v_mfma_f32_16x16x32_bf16 v[64:67], v[104:107], a[192:195], v[64:67]
    s_add_u32 m0, s73, 114176
    v_fma_f32 v174, v154, v97, -v96
    v_mfma_f32_16x16x32_bf16 v[64:67], v[108:111], a[200:203], v[64:67]
    buffer_load_dwordx4 v22, s[44:47], s21 offen offset:512 sc1 lds
    s_waitcnt lgkmcnt(0)
    v_mfma_f32_16x16x32_bf16 v[64:67], v[112:115], a[208:211], v[64:67]
    ds_read_b128 v[120:123], v14 offset:33792
    v_fma_f32 v175, v155, v97, -v96
    v_mfma_f32_16x16x32_bf16 v[64:67], v[116:119], a[216:219], v[64:67]
    ds_read_b128 v[124:127], v14 offset:37888
    v_fma_f32 v176, v156, v99, -v98
    v_mfma_f32_16x16x32_bf16 v[68:71], v[116:119], a[220:223], v[68:71]
    ds_read_b128 v[128:131], v14 offset:41984
    v_mfma_f32_16x16x32_bf16 v[68:71], v[112:115], a[212:215], v[68:71]
    ds_read_b128 v[132:135], v14 offset:46080
    v_fma_f32 v177, v157, v99, -v98
    v_mfma_f32_16x16x32_bf16 v[68:71], v[108:111], a[204:207], v[68:71]
    s_add_u32 m0, s73, 115712
    v_fma_f32 v178, v158, v99, -v98
    v_mfma_f32_16x16x32_bf16 v[68:71], v[104:107], a[196:199], v[68:71]
    buffer_load_dwordx4 v22, s[44:47], s22 offen offset:0 sc1 lds
    s_waitcnt lgkmcnt(2)
    v_mfma_f32_16x16x32_bf16 v[60:63], v[120:123], a[228:231], v[60:63]
    s_add_u32 m0, s73, 116224
    v_fma_f32 v179, v159, v99, -v98
    v_mfma_f32_16x16x32_bf16 v[60:63], v[124:127], a[236:239], v[60:63]
    buffer_load_dwordx4 v22, s[44:47], s22 offen offset:512 sc1 lds
    s_waitcnt lgkmcnt(0)
    v_mfma_f32_16x16x32_bf16 v[60:63], v[128:131], a[244:247], v[60:63]
    ds_read_b128 v[104:107], v14 offset:34816
    v_fma_f32 v180, v160, v101, -v100
    v_mfma_f32_16x16x32_bf16 v[60:63], v[132:135], a[252:255], v[60:63]
    ds_read_b128 v[108:111], v14 offset:38912
    v_fma_f32 v181, v161, v101, -v100
    v_mfma_f32_16x16x32_bf16 v[56:59], v[132:135], a[248:251], v[56:59]
    ds_read_b128 v[112:115], v14 offset:43008
    v_mfma_f32_16x16x32_bf16 v[56:59], v[128:131], a[240:243], v[56:59]
    ds_read_b128 v[116:119], v14 offset:47104
    v_fma_f32 v182, v162, v101, -v100
    v_mfma_f32_16x16x32_bf16 v[56:59], v[124:127], a[232:235], v[56:59]
    s_add_u32 m0, s73, 117760
    v_fma_f32 v183, v163, v101, -v100
    v_mfma_f32_16x16x32_bf16 v[56:59], v[120:123], a[224:227], v[56:59]
    buffer_load_dwordx4 v22, s[44:47], s23 offen offset:0 sc1 lds
    s_waitcnt lgkmcnt(2)
    v_mfma_f32_16x16x32_bf16 v[64:67], v[104:107], a[224:227], v[64:67]
    v_mfma_f32_16x16x32_bf16 v[64:67], v[108:111], a[232:235], v[64:67]
    s_waitcnt lgkmcnt(0)
    v_mfma_f32_16x16x32_bf16 v[64:67], v[112:115], a[240:243], v[64:67]
    ds_read_b128 v[120:123], v14 offset:35840
    v_mfma_f32_16x16x32_bf16 v[64:67], v[116:119], a[248:251], v[64:67]
    ds_read_b128 v[124:127], v14 offset:39936
    v_mfma_f32_16x16x32_bf16 v[68:71], v[116:119], a[252:255], v[68:71]
    ds_read_b128 v[128:131], v14 offset:44032
    v_mfma_f32_16x16x32_bf16 v[68:71], v[112:115], a[244:247], v[68:71]
    ds_read_b128 v[132:135], v14 offset:48128
    v_mfma_f32_16x16x32_bf16 v[68:71], v[108:111], a[236:239], v[68:71]
    v_mfma_f32_16x16x32_bf16 v[68:71], v[104:107], a[228:231], v[68:71]
    s_waitcnt lgkmcnt(2)
    v_mfma_f32_16x16x32_bf16 v[60:63], v[120:123], v[224:227], v[60:63]
    v_mfma_f32_16x16x32_bf16 v[60:63], v[124:127], v[232:235], v[60:63]
    s_waitcnt lgkmcnt(0)
    v_mfma_f32_16x16x32_bf16 v[60:63], v[128:131], v[240:243], v[60:63]
    s_waitcnt vmcnt(10)
    s_barrier
    v_mfma_f32_16x16x32_bf16 v[60:63], v[132:135], v[248:251], v[60:63]
    ds_read_b128 v[104:107], v14 offset:49152
    v_mfma_f32_16x16x32_bf16 v[56:59], v[132:135], v[244:247], v[56:59]
    ds_read_b128 v[108:111], v14 offset:53248
    v_mfma_f32_16x16x32_bf16 v[56:59], v[128:131], v[236:239], v[56:59]
    ds_read_b128 v[112:115], v14 offset:57344
    v_mfma_f32_16x16x32_bf16 v[56:59], v[124:127], v[228:231], v[56:59]
    ds_read_b128 v[116:119], v14 offset:61440
    v_mfma_f32_16x16x32_bf16 v[56:59], v[120:123], v[220:223], v[56:59]
    s_waitcnt lgkmcnt(2)
    v_mfma_f32_16x16x32_bf16 v[64:67], v[104:107], v[220:223], v[64:67]
    s_add_u32 m0, s73, 130560
    v_xor_b32 v186, s41, v10
    v_add_u32 v186, s43, v186
    v_mfma_f32_16x16x32_bf16 v[64:67], v[108:111], v[228:231], v[64:67]
    buffer_load_dwordx4 v22, s[44:47], s23 offen offset:512 sc1 lds
    ds_read_b64_tr_b16 v[12:13], v10 offset:16384
    s_waitcnt lgkmcnt(1)
    v_mfma_f32_16x16x32_bf16 v[64:67], v[112:115], v[236:239], v[64:67]
    ds_read_b128 v[120:123], v14 offset:50176
    v_mfma_f32_16x16x32_bf16 v[64:67], v[116:119], v[244:247], v[64:67]
    ds_read_b128 v[124:127], v14 offset:54272
    v_mfma_f32_16x16x32_bf16 v[68:71], v[116:119], v[248:251], v[68:71]
    ds_read_b128 v[128:131], v14 offset:58368
    ds_read_b64_tr_b16 v[24:25], v11 offset:16384
    v_mfma_f32_16x16x32_bf16 v[68:71], v[112:115], v[240:243], v[68:71]
    ds_read_b128 v[132:135], v14 offset:62464
    ds_read_b64_tr_b16 v[28:29], v10 offset:20480
    v_mfma_f32_16x16x32_bf16 v[68:71], v[108:111], v[232:235], v[68:71]
    s_add_u32 m0, s73, 132096
    ds_read_b64_tr_b16 v[190:191], v11 offset:20480
    v_mfma_f32_16x16x32_bf16 v[68:71], v[104:107], v[224:227], v[68:71]
    buffer_load_dwordx4 v22, s[44:47], s24 offen offset:0 sc1 lds
    ds_read_b64_tr_b16 v[142:143], v186 offset:18432
    s_waitcnt lgkmcnt(6)
    v_mfma_f32_16x16x32_bf16 v[76:79], v[120:123], a[4:7], v[76:79]
    s_add_u32 m0, s73, 132608
    s_waitcnt lgkmcnt(0)
    v_mfma_f32_16x16x32_bf16 v[76:79], v[124:127], a[12:15], v[76:79]
    buffer_load_dwordx4 v22, s[44:47], s24 offen offset:512 sc1 lds
    v_mfma_f32_16x16x32_bf16 v[76:79], v[128:131], a[20:23], v[76:79]
    ds_read_b128 v[104:107], v14 offset:51200
    v_and_b32 v9, 0xffff0000, v12
    v_mfma_f32_16x16x32_bf16 v[76:79], v[132:135], a[28:31], v[76:79]
    ds_read_b128 v[108:111], v14 offset:55296
    v_mfma_f32_16x16x32_bf16 v[72:75], v[132:135], a[24:27], v[72:75]
    ds_read_b128 v[112:115], v14 offset:59392
    v_lshlrev_b32 v8, 16, v12
    v_mfma_f32_16x16x32_bf16 v[72:75], v[128:131], a[16:19], v[72:75]
    ds_read_b128 v[116:119], v14 offset:63488
    v_cvt_pk_bf16_f32 v192, v56, v57
    v_mfma_f32_16x16x32_bf16 v[72:75], v[124:127], a[8:11], v[72:75]
    s_add_u32 m0, s73, 134144
    v_mul_f32 v165, v165, v9
    v_mfma_f32_16x16x32_bf16 v[72:75], v[120:123], a[0:3], v[72:75]
    buffer_load_dwordx4 v22, s[44:47], s25 offen offset:0 sc1 lds
    s_waitcnt lgkmcnt(2)
    v_mfma_f32_16x16x32_bf16 v[80:83], v[104:107], a[0:3], v[80:83]
    v_cvt_pk_bf16_f32 v193, v58, v59
    v_mul_f32 v164, v164, v8
    v_mfma_f32_16x16x32_bf16 v[80:83], v[108:111], a[8:11], v[80:83]
    v_and_b32 v31, 0xffff0000, v13
    s_waitcnt lgkmcnt(0)
    v_mfma_f32_16x16x32_bf16 v[80:83], v[112:115], a[16:19], v[80:83]
    ds_read_b128 v[120:123], v14 offset:52224
    v_lshlrev_b32 v30, 16, v13
    v_mfma_f32_16x16x32_bf16 v[80:83], v[116:119], a[24:27], v[80:83]
    ds_read_b128 v[124:127], v14 offset:56320
    v_cvt_pk_bf16_f32 v194, v60, v61
    v_mfma_f32_16x16x32_bf16 v[84:87], v[116:119], a[28:31], v[84:87]
    ds_read_b128 v[128:131], v14 offset:60416
    v_mfma_f32_16x16x32_bf16 v[84:87], v[112:115], a[20:23], v[84:87]
    ds_read_b128 v[132:135], v14 offset:64512
    v_mul_f32 v167, v167, v31
    v_mfma_f32_16x16x32_bf16 v[84:87], v[108:111], a[12:15], v[84:87]
    buffer_store_dwordx4 v[192:195], v136, s[44:47], s15 offen offset:0 sc1
    v_mul_f32 v166, v166, v30
    v_mfma_f32_16x16x32_bf16 v[84:87], v[104:107], a[4:7], v[84:87]
    s_waitcnt lgkmcnt(2)
    v_mfma_f32_16x16x32_bf16 v[76:79], v[120:123], a[36:39], v[76:79]
    v_and_b32 v9, 0xffff0000, v24
    v_mfma_f32_16x16x32_bf16 v[76:79], v[124:127], a[44:47], v[76:79]
    v_cvt_pk_bf16_f32 v196, v62, v63
    s_waitcnt lgkmcnt(0)
    v_mfma_f32_16x16x32_bf16 v[76:79], v[128:131], a[52:55], v[76:79]
    s_waitcnt vmcnt(9)
    s_barrier
    v_lshlrev_b32 v8, 16, v24
    v_mfma_f32_16x16x32_bf16 v[76:79], v[132:135], a[60:63], v[76:79]
    ds_read_b128 v[104:107], v14 offset:0
    v_mul_f32 v169, v169, v9
    v_mfma_f32_16x16x32_bf16 v[72:75], v[132:135], a[56:59], v[72:75]
    ds_read_b128 v[108:111], v14 offset:4096
    v_cvt_pk_bf16_f32 v197, v64, v65
    v_mfma_f32_16x16x32_bf16 v[72:75], v[128:131], a[48:51], v[72:75]
    ds_read_b128 v[112:115], v14 offset:8192
    v_mul_f32 v168, v168, v8
    v_mfma_f32_16x16x32_bf16 v[72:75], v[124:127], a[40:43], v[72:75]
    ds_read_b128 v[116:119], v14 offset:12288
    v_mfma_f32_16x16x32_bf16 v[72:75], v[120:123], a[32:35], v[72:75]
    v_cvt_pk_bf16_f32 v198, v66, v67
    s_waitcnt lgkmcnt(2)
    v_mfma_f32_16x16x32_bf16 v[80:83], v[104:107], a[32:35], v[80:83]
    s_add_u32 m0, s73, 146944
    v_and_b32 v31, 0xffff0000, v25
    v_lshlrev_b32 v30, 16, v25
    v_mfma_f32_16x16x32_bf16 v[80:83], v[108:111], a[40:43], v[80:83]
    buffer_load_dwordx4 v22, s[44:47], s25 offen offset:512 sc1 lds
    s_waitcnt lgkmcnt(0)
    v_mfma_f32_16x16x32_bf16 v[80:83], v[112:115], a[48:51], v[80:83]
    buffer_store_dwordx4 v[196:199], v136, s[44:47], s15 offen offset:1024 sc1
    ds_read_b128 v[120:123], v14 offset:1024
    v_mfma_f32_16x16x32_bf16 v[80:83], v[116:119], a[56:59], v[80:83]
    ds_read_b128 v[124:127], v14 offset:5120
    v_mul_f32 v171, v171, v31
    v_mfma_f32_16x16x32_bf16 v[84:87], v[116:119], a[60:63], v[84:87]
    ds_read_b128 v[128:131], v14 offset:9216
    v_mul_f32 v170, v170, v30
    v_mfma_f32_16x16x32_bf16 v[84:87], v[112:115], a[52:55], v[84:87]
    ds_read_b128 v[132:135], v14 offset:13312
    v_mfma_f32_16x16x32_bf16 v[84:87], v[108:111], a[44:47], v[84:87]
    s_add_u32 m0, s73, 148480
    v_cvt_pk_bf16_f32 v200, v68, v69
    v_and_b32 v9, 0xffff0000, v28
    v_mfma_f32_16x16x32_bf16 v[84:87], v[104:107], a[36:39], v[84:87]
    buffer_load_dwordx4 v22, s[44:47], s26 offen offset:0 sc1 lds
    s_waitcnt lgkmcnt(2)
    v_mfma_f32_16x16x32_bf16 v[76:79], v[120:123], a[68:71], v[76:79]
    s_add_u32 m0, s73, 148992
    v_lshlrev_b32 v8, 16, v28
    v_mfma_f32_16x16x32_bf16 v[76:79], v[124:127], a[76:79], v[76:79]
    buffer_load_dwordx4 v22, s[44:47], s26 offen offset:512 sc1 lds
    s_waitcnt lgkmcnt(0)
    v_mfma_f32_16x16x32_bf16 v[76:79], v[128:131], a[84:87], v[76:79]
    ds_read_b128 v[104:107], v14 offset:2048
    v_cvt_pk_bf16_f32 v201, v70, v71
    v_mfma_f32_16x16x32_bf16 v[76:79], v[132:135], a[92:95], v[76:79]
    ds_read_b128 v[108:111], v14 offset:6144
    v_mul_f32 v173, v173, v9
    v_mfma_f32_16x16x32_bf16 v[72:75], v[132:135], a[88:91], v[72:75]
    ds_read_b128 v[112:115], v14 offset:10240
    v_mul_f32 v172, v172, v8
    v_mfma_f32_16x16x32_bf16 v[72:75], v[128:131], a[80:83], v[72:75]
    ds_read_b128 v[116:119], v14 offset:14336
    v_and_b32 v31, 0xffff0000, v29
    v_mfma_f32_16x16x32_bf16 v[72:75], v[124:127], a[72:75], v[72:75]
    buffer_store_dwordx4 v[200:203], v136, s[44:47], s15 offen offset:2048 sc1
    s_add_u32 m0, s73, 150528
    v_mfma_f32_16x16x32_bf16 v[72:75], v[120:123], a[64:67], v[72:75]
    buffer_load_dwordx4 v19, s[44:47], s18 offen offset:0 sc1 lds
    s_waitcnt lgkmcnt(2)
    v_mfma_f32_16x16x32_bf16 v[80:83], v[104:107], a[64:67], v[80:83]
    v_lshlrev_b32 v30, 16, v29
    v_mul_f32 v175, v175, v31
    v_mfma_f32_16x16x32_bf16 v[80:83], v[108:111], a[72:75], v[80:83]
    buffer_load_dwordx4 v[40:43], v136, s[44:47], s34 offen offset:0 sc1
    s_waitcnt lgkmcnt(0)
    v_mfma_f32_16x16x32_bf16 v[80:83], v[112:115], a[80:83], v[80:83]
    ds_read_b128 v[120:123], v14 offset:3072
    v_mfma_f32_16x16x32_bf16 v[80:83], v[116:119], a[88:91], v[80:83]
    ds_read_b128 v[124:127], v14 offset:7168
    v_mul_f32 v174, v174, v30
    v_mfma_f32_16x16x32_bf16 v[84:87], v[116:119], a[92:95], v[84:87]
    ds_read_b128 v[128:131], v14 offset:11264
    v_and_b32 v9, 0xffff0000, v190
    v_mfma_f32_16x16x32_bf16 v[84:87], v[112:115], a[84:87], v[84:87]
    ds_read_b128 v[132:135], v14 offset:15360
    buffer_load_dwordx4 v[44:47], v136, s[44:47], s34 offen offset:1024 sc1
    v_mfma_f32_16x16x32_bf16 v[84:87], v[108:111], a[76:79], v[84:87]
    v_lshlrev_b32 v8, 16, v190
    v_mfma_f32_16x16x32_bf16 v[84:87], v[104:107], a[68:71], v[84:87]
    s_waitcnt lgkmcnt(2)
    v_mfma_f32_16x16x32_bf16 v[76:79], v[120:123], a[100:103], v[76:79]
    buffer_load_dwordx4 v[48:51], v136, s[44:47], s34 offen offset:2048 sc1
    v_mul_f32 v177, v177, v9
    v_mfma_f32_16x16x32_bf16 v[76:79], v[124:127], a[108:111], v[76:79]
    s_waitcnt lgkmcnt(0)
    v_mfma_f32_16x16x32_bf16 v[76:79], v[128:131], a[116:119], v[76:79]
    s_waitcnt vmcnt(14)
    s_barrier
    v_mul_f32 v176, v176, v8
    v_mfma_f32_16x16x32_bf16 v[76:79], v[132:135], a[124:127], v[76:79]
    ds_read_b128 v[104:107], v14 offset:16384
    v_and_b32 v31, 0xffff0000, v191
    v_mfma_f32_16x16x32_bf16 v[72:75], v[132:135], a[120:123], v[72:75]
    ds_read_b128 v[108:111], v14 offset:20480
    buffer_load_dwordx4 v[204:207], v136, s[44:47], s35 offen offset:0 sc1
    v_mfma_f32_16x16x32_bf16 v[72:75], v[128:131], a[112:115], v[72:75]
    ds_read_b128 v[112:115], v14 offset:24576
    v_lshlrev_b32 v30, 16, v191
    v_mfma_f32_16x16x32_bf16 v[72:75], v[124:127], a[104:107], v[72:75]
    ds_read_b128 v[116:119], v14 offset:28672
    v_mul_f32 v179, v179, v31
    v_mfma_f32_16x16x32_bf16 v[72:75], v[120:123], a[96:99], v[72:75]
    buffer_load_dwordx4 v[208:211], v136, s[44:47], s35 offen offset:1024 sc1
    s_waitcnt lgkmcnt(2)
    v_mfma_f32_16x16x32_bf16 v[80:83], v[104:107], a[96:99], v[80:83]
    v_mfma_f32_16x16x32_bf16 v[80:83], v[108:111], a[104:107], v[80:83]
    v_mul_f32 v178, v178, v30
    s_waitcnt lgkmcnt(0)
    v_mfma_f32_16x16x32_bf16 v[80:83], v[112:115], a[112:115], v[80:83]
    ds_read_b128 v[120:123], v14 offset:17408
    buffer_load_dwordx4 v[212:215], v136, s[44:47], s35 offen offset:2048 sc1
    v_mfma_f32_16x16x32_bf16 v[80:83], v[116:119], a[120:123], v[80:83]
    ds_read_b128 v[124:127], v14 offset:21504
    v_and_b32 v9, 0xffff0000, v142
    v_mfma_f32_16x16x32_bf16 v[84:87], v[116:119], a[124:127], v[84:87]
    ds_read_b128 v[128:131], v14 offset:25600
    v_lshlrev_b32 v8, 16, v142
    v_mfma_f32_16x16x32_bf16 v[84:87], v[112:115], a[116:119], v[84:87]
    ds_read_b128 v[132:135], v14 offset:29696
    v_mfma_f32_16x16x32_bf16 v[84:87], v[108:111], a[108:111], v[84:87]
    buffer_load_dwordx4 v[216:219], v136, s[44:47], s35 offen offset:3072 sc1
    v_mul_f32 v181, v181, v9
    v_mfma_f32_16x16x32_bf16 v[84:87], v[104:107], a[100:103], v[84:87]
    s_waitcnt lgkmcnt(2)
    v_mfma_f32_16x16x32_bf16 v[76:79], v[120:123], a[132:135], v[76:79]
    v_mul_f32 v180, v180, v8
    v_mfma_f32_16x16x32_bf16 v[76:79], v[124:127], a[140:143], v[76:79]
    v_and_b32 v31, 0xffff0000, v143
    s_waitcnt lgkmcnt(0)
    v_mfma_f32_16x16x32_bf16 v[76:79], v[128:131], a[148:151], v[76:79]
    ds_read_b128 v[104:107], v14 offset:18432
    v_mfma_f32_16x16x32_bf16 v[76:79], v[132:135], a[156:159], v[76:79]
    ds_read_b128 v[108:111], v14 offset:22528
    v_lshlrev_b32 v30, 16, v143
    v_mfma_f32_16x16x32_bf16 v[72:75], v[132:135], a[152:155], v[72:75]
    ds_read_b128 v[112:115], v14 offset:26624
    v_mfma_f32_16x16x32_bf16 v[72:75], v[128:131], a[144:147], v[72:75]
    ds_read_b128 v[116:119], v14 offset:30720
    v_mul_f32 v183, v183, v31
    v_mfma_f32_16x16x32_bf16 v[72:75], v[124:127], a[136:139], v[72:75]
    v_mfma_f32_16x16x32_bf16 v[72:75], v[120:123], a[128:131], v[72:75]
    v_mul_f32 v182, v182, v30
    s_waitcnt lgkmcnt(2)
    v_mfma_f32_16x16x32_bf16 v[80:83], v[104:107], a[128:131], v[80:83]
    v_mfma_f32_16x16x32_bf16 v[80:83], v[108:111], a[136:139], v[80:83]
    s_waitcnt lgkmcnt(0)
    v_mfma_f32_16x16x32_bf16 v[80:83], v[112:115], a[144:147], v[80:83]
    ds_read_b128 v[120:123], v14 offset:19456
    v_mfma_f32_16x16x32_bf16 v[80:83], v[116:119], a[152:155], v[80:83]
    ds_read_b128 v[124:127], v14 offset:23552
    v_mfma_f32_16x16x32_bf16 v[84:87], v[116:119], a[156:159], v[84:87]
    ds_read_b128 v[128:131], v14 offset:27648
    v_mfma_f32_16x16x32_bf16 v[84:87], v[112:115], a[148:151], v[84:87]
    ds_read_b128 v[132:135], v14 offset:31744
    v_mfma_f32_16x16x32_bf16 v[84:87], v[108:111], a[140:143], v[84:87]
    v_mfma_f32_16x16x32_bf16 v[84:87], v[104:107], a[132:135], v[84:87]
    s_waitcnt lgkmcnt(2)
    v_mfma_f32_16x16x32_bf16 v[76:79], v[120:123], a[164:167], v[76:79]
    s_add_u32 m0, s73, 97792
    v_mfma_f32_16x16x32_bf16 v[76:79], v[124:127], a[172:175], v[76:79]
    buffer_load_dwordx4 v19, s[44:47], s18 offen offset:512 sc1 lds
    s_waitcnt lgkmcnt(0)
    v_mfma_f32_16x16x32_bf16 v[76:79], v[128:131], a[180:183], v[76:79]
    s_waitcnt vmcnt(15)
    s_barrier
    v_mfma_f32_16x16x32_bf16 v[76:79], v[132:135], a[188:191], v[76:79]
    ds_read_b128 v[104:107], v14 offset:32768
    v_mfma_f32_16x16x32_bf16 v[72:75], v[132:135], a[184:187], v[72:75]
    ds_read_b128 v[108:111], v14 offset:36864
    v_mfma_f32_16x16x32_bf16 v[72:75], v[128:131], a[176:179], v[72:75]
    ds_read_b128 v[112:115], v14 offset:40960
    v_mfma_f32_16x16x32_bf16 v[72:75], v[124:127], a[168:171], v[72:75]
    ds_read_b128 v[116:119], v14 offset:45056
    s_add_u32 m0, s73, 99328
    v_mfma_f32_16x16x32_bf16 v[72:75], v[120:123], a[160:163], v[72:75]
    buffer_load_dwordx4 v19, s[44:47], s19 offen offset:0 sc1 lds
    s_waitcnt lgkmcnt(2)
    v_mfma_f32_16x16x32_bf16 v[80:83], v[104:107], a[160:163], v[80:83]
    s_add_u32 m0, s73, 99840
    v_mfma_f32_16x16x32_bf16 v[80:83], v[108:111], a[168:171], v[80:83]
    buffer_load_dwordx4 v19, s[44:47], s19 offen offset:512 sc1 lds
    s_waitcnt lgkmcnt(0)
    v_mfma_f32_16x16x32_bf16 v[80:83], v[112:115], a[176:179], v[80:83]
    ds_read_b128 v[120:123], v14 offset:33792
    v_mfma_f32_16x16x32_bf16 v[80:83], v[116:119], a[184:187], v[80:83]
    ds_read_b128 v[124:127], v14 offset:37888
    v_mfma_f32_16x16x32_bf16 v[84:87], v[116:119], a[188:191], v[84:87]
    ds_read_b128 v[128:131], v14 offset:41984
    v_mfma_f32_16x16x32_bf16 v[84:87], v[112:115], a[180:183], v[84:87]
    ds_read_b128 v[132:135], v14 offset:46080
    v_mfma_f32_16x16x32_bf16 v[84:87], v[108:111], a[172:175], v[84:87]
    s_add_u32 m0, s73, 101376
    v_mfma_f32_16x16x32_bf16 v[84:87], v[104:107], a[164:167], v[84:87]
    buffer_load_dwordx4 v19, s[44:47], s20 offen offset:0 sc1 lds
    s_waitcnt lgkmcnt(2)
    v_mfma_f32_16x16x32_bf16 v[76:79], v[120:123], a[196:199], v[76:79]
    s_add_u32 m0, s73, 114176
    v_mov_b32 v141, 0
    v_mfma_f32_16x16x32_bf16 v[76:79], v[124:127], a[204:207], v[76:79]
    buffer_load_dwordx4 v19, s[44:47], s20 offen offset:512 sc1 lds
    s_waitcnt lgkmcnt(0)
    v_mfma_f32_16x16x32_bf16 v[76:79], v[128:131], a[212:215], v[76:79]
    ds_read_b128 v[104:107], v14 offset:34816
    v_mfma_f32_16x16x32_bf16 v[76:79], v[132:135], a[220:223], v[76:79]
    ds_read_b128 v[108:111], v14 offset:38912
    buffer_atomic_add v141, v139, s[44:47], s11 offen offset:2060 sc0 sc1
    v_mfma_f32_16x16x32_bf16 v[72:75], v[132:135], a[216:219], v[72:75]
    ds_read_b128 v[112:115], v14 offset:43008
    v_mfma_f32_16x16x32_bf16 v[72:75], v[128:131], a[208:211], v[72:75]
    ds_read_b128 v[116:119], v14 offset:47104
    v_mfma_f32_16x16x32_bf16 v[72:75], v[124:127], a[200:203], v[72:75]
    s_add_u32 m0, s73, 115712
    v_mfma_f32_16x16x32_bf16 v[72:75], v[120:123], a[192:195], v[72:75]
    buffer_load_dwordx4 v19, s[44:47], s21 offen offset:0 sc1 lds
    s_waitcnt lgkmcnt(2)
    v_mfma_f32_16x16x32_bf16 v[80:83], v[104:107], a[192:195], v[80:83]
    s_add_u32 m0, s73, 116224
    v_mfma_f32_16x16x32_bf16 v[80:83], v[108:111], a[200:203], v[80:83]
    buffer_load_dwordx4 v19, s[44:47], s21 offen offset:512 sc1 lds
    s_waitcnt lgkmcnt(0)
    v_mfma_f32_16x16x32_bf16 v[80:83], v[112:115], a[208:211], v[80:83]
    ds_read_b128 v[120:123], v14 offset:35840
    v_mfma_f32_16x16x32_bf16 v[80:83], v[116:119], a[216:219], v[80:83]
    ds_read_b128 v[124:127], v14 offset:39936
    v_mfma_f32_16x16x32_bf16 v[84:87], v[116:119], a[220:223], v[84:87]
    ds_read_b128 v[128:131], v14 offset:44032
    v_mfma_f32_16x16x32_bf16 v[84:87], v[112:115], a[212:215], v[84:87]
    ds_read_b128 v[132:135], v14 offset:48128
    v_mfma_f32_16x16x32_bf16 v[84:87], v[108:111], a[204:207], v[84:87]
    s_add_u32 m0, s73, 117760
    v_mfma_f32_16x16x32_bf16 v[84:87], v[104:107], a[196:199], v[84:87]
    buffer_load_dwordx4 v19, s[44:47], s22 offen offset:0 sc1 lds
    s_waitcnt lgkmcnt(2)
    v_mfma_f32_16x16x32_bf16 v[76:79], v[120:123], a[228:231], v[76:79]
    v_mfma_f32_16x16x32_bf16 v[76:79], v[124:127], a[236:239], v[76:79]
    s_waitcnt lgkmcnt(0)
    v_mfma_f32_16x16x32_bf16 v[76:79], v[128:131], a[244:247], v[76:79]
    s_waitcnt vmcnt(16)
    s_barrier
    v_mfma_f32_16x16x32_bf16 v[76:79], v[132:135], a[252:255], v[76:79]
    ds_read_b128 v[104:107], v14 offset:49152
    v_mfma_f32_16x16x32_bf16 v[72:75], v[132:135], a[248:251], v[72:75]
    ds_read_b128 v[108:111], v14 offset:53248
    v_mfma_f32_16x16x32_bf16 v[72:75], v[128:131], a[240:243], v[72:75]
    ds_read_b128 v[112:115], v14 offset:57344
    v_mfma_f32_16x16x32_bf16 v[72:75], v[124:127], a[232:235], v[72:75]
    ds_read_b128 v[116:119], v14 offset:61440
    v_mfma_f32_16x16x32_bf16 v[72:75], v[120:123], a[224:227], v[72:75]
    s_waitcnt lgkmcnt(2)
    v_mfma_f32_16x16x32_bf16 v[80:83], v[104:107], a[224:227], v[80:83]
    s_add_u32 m0, s73, 130560
    v_mfma_f32_16x16x32_bf16 v[80:83], v[108:111], a[232:235], v[80:83]
    buffer_load_dwordx4 v19, s[44:47], s22 offen offset:512 sc1 lds
    s_waitcnt lgkmcnt(0)
    v_mfma_f32_16x16x32_bf16 v[80:83], v[112:115], a[240:243], v[80:83]
    ds_read_b128 v[120:123], v14 offset:50176
    v_mfma_f32_16x16x32_bf16 v[80:83], v[116:119], a[248:251], v[80:83]
    ds_read_b128 v[124:127], v14 offset:54272
    v_mfma_f32_16x16x32_bf16 v[84:87], v[116:119], a[252:255], v[84:87]
    ds_read_b128 v[128:131], v14 offset:58368
    v_mfma_f32_16x16x32_bf16 v[84:87], v[112:115], a[244:247], v[84:87]
    ds_read_b128 v[132:135], v14 offset:62464
    v_mfma_f32_16x16x32_bf16 v[84:87], v[108:111], a[236:239], v[84:87]
    s_add_u32 m0, s73, 132096
    v_mfma_f32_16x16x32_bf16 v[84:87], v[104:107], a[228:231], v[84:87]
    buffer_load_dwordx4 v19, s[44:47], s23 offen offset:0 sc1 lds
    s_waitcnt lgkmcnt(2)
    v_mfma_f32_16x16x32_bf16 v[76:79], v[120:123], v[224:227], v[76:79]
    s_add_u32 m0, s73, 132608
    s_waitcnt vmcnt(15)
    v_bitop3_b32 v43, v43, v47, s68 bitop3:0x7e
    v_bitop3_b32 v43, v43, v51, s68 bitop3:0xf6
    v_cmp_ne_u32 vcc, 0, v43
    v_mfma_f32_16x16x32_bf16 v[76:79], v[124:127], v[232:235], v[76:79]
    buffer_load_dwordx4 v19, s[44:47], s23 offen offset:512 sc1 lds
    s_waitcnt lgkmcnt(0)
    v_mfma_f32_16x16x32_bf16 v[76:79], v[128:131], v[240:243], v[76:79]
    ds_read_b128 v[104:107], v14 offset:51200
    s_cbranch_vccnz L_xs_a
L_xo_a:
    v_and_b32 v89, 0xffff0000, v40
    v_mfma_f32_16x16x32_bf16 v[76:79], v[132:135], v[248:251], v[76:79]
    ds_read_b128 v[108:111], v14 offset:55296
    v_lshlrev_b32 v88, 16, v40
    v_mfma_f32_16x16x32_bf16 v[72:75], v[132:135], v[244:247], v[72:75]
    ds_read_b128 v[112:115], v14 offset:59392
    v_and_b32 v91, 0xffff0000, v41
    v_mfma_f32_16x16x32_bf16 v[72:75], v[128:131], v[236:239], v[72:75]
    ds_read_b128 v[116:119], v14 offset:63488
    v_lshlrev_b32 v90, 16, v41
    v_mfma_f32_16x16x32_bf16 v[72:75], v[124:127], v[228:231], v[72:75]
    s_add_u32 m0, s73, 134144
    v_and_b32 v93, 0xffff0000, v42
    v_lshlrev_b32 v92, 16, v42
    v_mfma_f32_16x16x32_bf16 v[72:75], v[120:123], v[220:223], v[72:75]
    buffer_load_dwordx4 v19, s[44:47], s24 offen offset:0 sc1 lds
    s_waitcnt lgkmcnt(2)
    v_mfma_f32_16x16x32_bf16 v[80:83], v[104:107], v[220:223], v[80:83]
    v_and_b32 v95, 0xffff0000, v44
    v_lshlrev_b32 v94, 16, v44
    v_mfma_f32_16x16x32_bf16 v[80:83], v[108:111], v[228:231], v[80:83]
    v_and_b32 v97, 0xffff0000, v45
    s_waitcnt lgkmcnt(0)
    v_mfma_f32_16x16x32_bf16 v[80:83], v[112:115], v[236:239], v[80:83]
    ds_read_b128 v[120:123], v14 offset:52224
    v_lshlrev_b32 v96, 16, v45
    v_mfma_f32_16x16x32_bf16 v[80:83], v[116:119], v[244:247], v[80:83]
    ds_read_b128 v[124:127], v14 offset:56320
    v_and_b32 v99, 0xffff0000, v46
    v_lshlrev_b32 v98, 16, v46
    v_mfma_f32_16x16x32_bf16 v[84:87], v[116:119], v[248:251], v[84:87]
    ds_read_b128 v[128:131], v14 offset:60416
    s_waitcnt vmcnt(7)
    v_and_b32 v101, 0xffff0000, v48
    v_mfma_f32_16x16x32_bf16 v[84:87], v[112:115], v[240:243], v[84:87]
    ds_read_b128 v[132:135], v14 offset:64512
    v_lshlrev_b32 v100, 16, v48
    v_cmp_ne_u32 vcc, v140, v141
    v_mfma_f32_16x16x32_bf16 v[84:87], v[108:111], v[232:235], v[84:87]
    v_and_b32 v103, 0xffff0000, v49
    v_lshlrev_b32 v102, 16, v49
    v_mfma_f32_16x16x32_bf16 v[84:87], v[104:107], v[224:227], v[84:87]
    s_cbranch_vccnz L_as_b
L_ao_b:
    s_waitcnt lgkmcnt(2)
    v_mfma_f32_16x16x32_bf16 v[92:95], v[120:123], a[4:7], v[92:95]
    buffer_load_dwordx4 v[56:59], v136, s[44:47], s11 offen offset:0 sc1
    v_mfma_f32_16x16x32_bf16 v[92:95], v[124:127], a[12:15], v[92:95]
    s_waitcnt lgkmcnt(0)
    v_mfma_f32_16x16x32_bf16 v[92:95], v[128:131], a[20:23], v[92:95]
    buffer_load_dwordx4 v[60:63], v136, s[44:47], s11 offen offset:1024 sc1
    s_barrier
    v_mfma_f32_16x16x32_bf16 v[92:95], v[132:135], a[28:31], v[92:95]
    ds_read_b128 v[104:107], v14 offset:0
    buffer_load_dwordx4 v[64:67], v136, s[44:47], s11 offen offset:2048 sc1
    v_mfma_f32_16x16x32_bf16 v[88:91], v[132:135], a[24:27], v[88:91]
    ds_read_b128 v[108:111], v14 offset:4096
    v_cvt_pk_bf16_f32 v192, v72, v73
    v_mfma_f32_16x16x32_bf16 v[88:91], v[128:131], a[16:19], v[88:91]
    ds_read_b128 v[112:115], v14 offset:8192
    v_cvt_pk_bf16_f32 v193, v74, v75
    v_mfma_f32_16x16x32_bf16 v[88:91], v[124:127], a[8:11], v[88:91]
    ds_read_b128 v[116:119], v14 offset:12288
    v_cvt_pk_bf16_f32 v194, v76, v77
    v_mfma_f32_16x16x32_bf16 v[88:91], v[120:123], a[0:3], v[88:91]
    buffer_store_dwordx4 v[192:195], v136, s[44:47], s31 offen offset:0 sc1
L_pl_D_2:
    s_cbranch_execz L_wret
    s_waitcnt lgkmcnt(2)
    v_mfma_f32_16x16x32_bf16 v[96:99], v[104:107], a[0:3], v[96:99]
    s_add_u32 m0, s73, 146944
    v_cvt_pk_bf16_f32 v196, v78, v79
    v_cvt_pk_bf16_f32 v197, v80, v81
    v_mfma_f32_16x16x32_bf16 v[96:99], v[108:111], a[8:11], v[96:99]
    buffer_load_dwordx4 v19, s[44:47], s24 offen offset:512 sc1 lds
    s_waitcnt lgkmcnt(0)
    v_mfma_f32_16x16x32_bf16 v[96:99], v[112:115], a[16:19], v[96:99]
    ds_read_b128 v[120:123], v14 offset:1024
    v_cvt_pk_bf16_f32 v198, v82, v83
    v_mfma_f32_16x16x32_bf16 v[96:99], v[116:119], a[24:27], v[96:99]
    buffer_store_dwordx4 v[196:199], v136, s[44:47], s31 offen offset:1024 sc1
    ds_read_b128 v[124:127], v14 offset:5120
    v_bitop3_b32 v207, v207, v211, s36 bitop3:0x7e
    v_bitop3_b32 v207, v207, v215, s36 bitop3:0xf6
    v_mfma_f32_16x16x32_bf16 v[100:103], v[116:119], a[28:31], v[100:103]
    ds_read_b128 v[128:131], v14 offset:9216
    v_cvt_pk_bf16_f32 v200, v84, v85
    v_mfma_f32_16x16x32_bf16 v[100:103], v[112:115], a[20:23], v[100:103]
    ds_read_b128 v[132:135], v14 offset:13312
    v_cvt_pk_bf16_f32 v201, v86, v87
    v_mfma_f32_16x16x32_bf16 v[100:103], v[108:111], a[12:15], v[100:103]
    buffer_store_dwordx4 v[200:203], v136, s[44:47], s31 offen offset:2048 sc1
    s_add_u32 m0, s73, 148480
    v_bitop3_b32 v207, v207, v219, s36 bitop3:0xf6
    v_cmp_ne_u32 vcc, 0, v207
    v_mfma_f32_16x16x32_bf16 v[100:103], v[104:107], a[4:7], v[100:103]
    buffer_load_dwordx4 v19, s[44:47], s25 offen offset:0 sc1 lds
    s_waitcnt lgkmcnt(2)
    v_mfma_f32_16x16x32_bf16 v[92:95], v[120:123], a[36:39], v[92:95]
    s_add_u32 m0, s73, 148992
    s_cbranch_vccnz L_xs_8
L_xo_8:
    v_mfma_f32_16x16x32_bf16 v[92:95], v[124:127], a[44:47], v[92:95]
    buffer_load_dwordx4 v19, s[44:47], s25 offen offset:512 sc1 lds
    s_waitcnt lgkmcnt(0)
    v_mfma_f32_16x16x32_bf16 v[92:95], v[128:131], a[52:55], v[92:95]
    ds_read_b128 v[104:107], v14 offset:2048
    v_and_b32 v33, 0xffff0000, v204
    v_mfma_f32_16x16x32_bf16 v[92:95], v[132:135], a[60:63], v[92:95]
    ds_read_b128 v[108:111], v14 offset:6144
    v_lshlrev_b32 v32, 16, v204
    v_mfma_f32_16x16x32_bf16 v[88:91], v[132:135], a[56:59], v[88:91]
    ds_read_b128 v[112:115], v14 offset:10240
    v_and_b32 v35, 0xffff0000, v205
    v_mfma_f32_16x16x32_bf16 v[88:91], v[128:131], a[48:51], v[88:91]
    ds_read_b128 v[116:119], v14 offset:14336
    v_mfma_f32_16x16x32_bf16 v[88:91], v[124:127], a[40:43], v[88:91]
    s_add_u32 m0, s73, 150528
    v_lshlrev_b32 v34, 16, v205
    v_mfma_f32_16x16x32_bf16 v[88:91], v[120:123], a[32:35], v[88:91]
    buffer_load_dwordx4 v19, s[44:47], s26 offen offset:0 sc1 lds
    s_waitcnt lgkmcnt(2)
    v_mfma_f32_16x16x32_bf16 v[96:99], v[104:107], a[32:35], v[96:99]
    v_add_f32 v32, v32, v27
    v_mfma_f32_16x16x32_bf16 v[96:99], v[108:111], a[40:43], v[96:99]
    v_add_f32 v33, v33, v27
    s_waitcnt lgkmcnt(0)
    v_mfma_f32_16x16x32_bf16 v[96:99], v[112:115], a[48:51], v[96:99]
    ds_read_b128 v[120:123], v14 offset:3072
    v_add_f32 v34, v34, v27
    v_mfma_f32_16x16x32_bf16 v[96:99], v[116:119], a[56:59], v[96:99]
    ds_read_b128 v[124:127], v14 offset:7168
    v_mfma_f32_16x16x32_bf16 v[100:103], v[116:119], a[60:63], v[100:103]
    ds_read_b128 v[128:131], v14 offset:11264
    v_add_f32 v35, v35, v27
    v_mfma_f32_16x16x32_bf16 v[100:103], v[112:115], a[52:55], v[100:103]
    ds_read_b128 v[132:135], v14 offset:15360
    v_and_b32 v37, 0xffff0000, v208
    v_mfma_f32_16x16x32_bf16 v[100:103], v[108:111], a[44:47], v[100:103]
    v_mfma_f32_16x16x32_bf16 v[100:103], v[104:107], a[36:39], v[100:103]
    v_lshlrev_b32 v36, 16, v208
    s_waitcnt lgkmcnt(2)
    v_mfma_f32_16x16x32_bf16 v[92:95], v[120:123], a[68:71], v[92:95]
    v_and_b32 v39, 0xffff0000, v209
    v_mfma_f32_16x16x32_bf16 v[92:95], v[124:127], a[76:79], v[92:95]
    s_waitcnt lgkmcnt(0)
    v_mfma_f32_16x16x32_bf16 v[92:95], v[128:131], a[84:87], v[92:95]
    s_waitcnt vmcnt(14)
    s_barrier
    v_lshlrev_b32 v38, 16, v209
    v_mfma_f32_16x16x32_bf16 v[92:95], v[132:135], a[92:95], v[92:95]
    ds_read_b128 v[104:107], v14 offset:16384
    v_add_f32 v32, v32, v36
    v_mfma_f32_16x16x32_bf16 v[88:91], v[132:135], a[88:91], v[88:91]
    ds_read_b128 v[108:111], v14 offset:20480
    v_mfma_f32_16x16x32_bf16 v[88:91], v[128:131], a[80:83], v[88:91]
    ds_read_b128 v[112:115], v14 offset:24576
    v_add_f32 v33, v33, v37
    v_mfma_f32_16x16x32_bf16 v[88:91], v[124:127], a[72:75], v[88:91]
    ds_read_b128 v[116:119], v14 offset:28672
    v_add_f32 v34, v34, v38
    v_mfma_f32_16x16x32_bf16 v[88:91], v[120:123], a[64:67], v[88:91]
    s_waitcnt lgkmcnt(2)
    v_mfma_f32_16x16x32_bf16 v[96:99], v[104:107], a[64:67], v[96:99]
    s_add_u32 m0, s73, 97792
    v_add_f32 v35, v35, v39
    v_mfma_f32_16x16x32_bf16 v[96:99], v[108:111], a[72:75], v[96:99]
    buffer_load_dwordx4 v19, s[44:47], s26 offen offset:512 sc1 lds
    s_waitcnt lgkmcnt(0)
    v_mfma_f32_16x16x32_bf16 v[96:99], v[112:115], a[80:83], v[96:99]
    ds_read_b128 v[120:123], v14 offset:17408
    v_and_b32 v37, 0xffff0000, v212
    v_mfma_f32_16x16x32_bf16 v[96:99], v[116:119], a[88:91], v[96:99]
    ds_read_b128 v[124:127], v14 offset:21504
    v_lshlrev_b32 v36, 16, v212
    v_mfma_f32_16x16x32_bf16 v[100:103], v[116:119], a[92:95], v[100:103]
    ds_read_b128 v[128:131], v14 offset:25600
    v_and_b32 v39, 0xffff0000, v213
    v_mfma_f32_16x16x32_bf16 v[100:103], v[112:115], a[84:87], v[100:103]
    ds_read_b128 v[132:135], v14 offset:29696
    v_mfma_f32_16x16x32_bf16 v[100:103], v[108:111], a[76:79], v[100:103]
    v_lshlrev_b32 v38, 16, v213
    v_mfma_f32_16x16x32_bf16 v[100:103], v[104:107], a[68:71], v[100:103]
    v_add_f32 v32, v32, v36
    s_waitcnt lgkmcnt(2)
    v_mfma_f32_16x16x32_bf16 v[92:95], v[120:123], a[100:103], v[92:95]
    v_mfma_f32_16x16x32_bf16 v[92:95], v[124:127], a[108:111], v[92:95]
    v_add_f32 v33, v33, v37
    s_waitcnt lgkmcnt(0)
    v_mfma_f32_16x16x32_bf16 v[92:95], v[128:131], a[116:119], v[92:95]
    ds_read_b128 v[104:107], v14 offset:18432
    v_add_f32 v34, v34, v38
    v_mfma_f32_16x16x32_bf16 v[92:95], v[132:135], a[124:127], v[92:95]
    ds_read_b128 v[108:111], v14 offset:22528
    v_add_f32 v35, v35, v39
    v_mfma_f32_16x16x32_bf16 v[88:91], v[132:135], a[120:123], v[88:91]
    ds_read_b128 v[112:115], v14 offset:26624
    v_and_b32 v37, 0xffff0000, v216
    v_mfma_f32_16x16x32_bf16 v[88:91], v[128:131], a[112:115], v[88:91]
    ds_read_b128 v[116:119], v14 offset:30720
    v_lshlrev_b32 v36, 16, v216
    v_mfma_f32_16x16x32_bf16 v[88:91], v[124:127], a[104:107], v[88:91]
    v_and_b32 v39, 0xffff0000, v217
    v_lshlrev_b32 v38, 16, v217
    v_mfma_f32_16x16x32_bf16 v[88:91], v[120:123], a[96:99], v[88:91]
    v_add_f32 v32, v32, v36
    s_waitcnt lgkmcnt(2)
    v_mfma_f32_16x16x32_bf16 v[96:99], v[104:107], a[96:99], v[96:99]
    v_add_f32 v33, v33, v37
    v_add_f32 v34, v34, v38
    v_mfma_f32_16x16x32_bf16 v[96:99], v[108:111], a[104:107], v[96:99]
    v_add_f32 v35, v35, v39
    s_waitcnt lgkmcnt(0)
    v_mfma_f32_16x16x32_bf16 v[96:99], v[112:115], a[112:115], v[96:99]
    ds_read_b128 v[120:123], v14 offset:19456
    v_mul_f32 v36, s38, v32
    v_mfma_f32_16x16x32_bf16 v[96:99], v[116:119], a[120:123], v[96:99]
    ds_read_b128 v[124:127], v14 offset:23552
    v_mul_f32 v37, s38, v33
    v_mfma_f32_16x16x32_bf16 v[100:103], v[116:119], a[124:127], v[100:103]
    ds_read_b128 v[128:131], v14 offset:27648
    v_mul_f32 v38, s38, v34
    v_mfma_f32_16x16x32_bf16 v[100:103], v[112:115], a[116:119], v[100:103]
    ds_read_b128 v[132:135], v14 offset:31744
    v_mul_f32 v39, s38, v35
    v_mfma_f32_16x16x32_bf16 v[100:103], v[108:111], a[108:111], v[100:103]
    v_exp_f32 v36, v36
    v_mfma_f32_16x16x32_bf16 v[100:103], v[104:107], a[100:103], v[100:103]
    s_waitcnt lgkmcnt(2)
    v_mfma_f32_16x16x32_bf16 v[92:95], v[120:123], a[132:135], v[92:95]
    v_exp_f32 v37, v37
    v_mfma_f32_16x16x32_bf16 v[92:95], v[124:127], a[140:143], v[92:95]
    s_waitcnt lgkmcnt(0)
    v_mfma_f32_16x16x32_bf16 v[92:95], v[128:131], a[148:151], v[92:95]
    s_waitcnt vmcnt(11)
    s_barrier
    v_mfma_f32_16x16x32_bf16 v[92:95], v[132:135], a[156:159], v[92:95]
    ds_read_b128 v[104:107], v14 offset:32768
    v_mfma_f32_16x16x32_bf16 v[88:91], v[132:135], a[152:155], v[88:91]
    ds_read_b128 v[108:111], v14 offset:36864
    v_exp_f32 v38, v38
    v_mfma_f32_16x16x32_bf16 v[88:91], v[128:131], a[144:147], v[88:91]
    ds_read_b128 v[112:115], v14 offset:40960
    v_exp_f32 v39, v39
    v_mfma_f32_16x16x32_bf16 v[88:91], v[124:127], a[136:139], v[88:91]
    ds_read_b128 v[116:119], v14 offset:45056
    v_mul_f32 v180, v180, v32
    v_mfma_f32_16x16x32_bf16 v[88:91], v[120:123], a[128:131], v[88:91]
    v_mul_f32 v181, v181, v33
    s_waitcnt lgkmcnt(2)
    v_mfma_f32_16x16x32_bf16 v[96:99], v[104:107], a[128:131], v[96:99]
    v_mul_f32 v182, v182, v34
    v_mul_f32 v183, v183, v35
    v_mfma_f32_16x16x32_bf16 v[96:99], v[108:111], a[136:139], v[96:99]
    v_add_f32 v36, 1.0, v36
    s_waitcnt lgkmcnt(0)
    v_mfma_f32_16x16x32_bf16 v[96:99], v[112:115], a[144:147], v[96:99]
    ds_read_b128 v[120:123], v14 offset:33792
    v_add_f32 v37, 1.0, v37
    v_mfma_f32_16x16x32_bf16 v[96:99], v[116:119], a[152:155], v[96:99]
    ds_read_b128 v[124:127], v14 offset:37888
    v_add_f32 v38, 1.0, v38
    v_mfma_f32_16x16x32_bf16 v[100:103], v[116:119], a[156:159], v[100:103]
    ds_read_b128 v[128:131], v14 offset:41984
    v_add_f32 v39, 1.0, v39
    v_mfma_f32_16x16x32_bf16 v[100:103], v[112:115], a[148:151], v[100:103]
    ds_read_b128 v[132:135], v14 offset:46080
    v_rcp_f32 v36, v36
    v_mfma_f32_16x16x32_bf16 v[100:103], v[108:111], a[140:143], v[100:103]
    v_rcp_f32 v37, v37
    v_mfma_f32_16x16x32_bf16 v[100:103], v[104:107], a[132:135], v[100:103]
    v_rcp_f32 v38, v38
    s_waitcnt lgkmcnt(2)
    v_mfma_f32_16x16x32_bf16 v[92:95], v[120:123], a[164:167], v[92:95]
    s_waitcnt vmcnt(8)
    v_bitop3_b32 v59, v59, v63, s68 bitop3:0x7e
    v_rcp_f32 v39, v39
    v_mfma_f32_16x16x32_bf16 v[92:95], v[124:127], a[172:175], v[92:95]
    buffer_load_dwordx4 v[72:75], v136, s[44:47], s12 offen offset:0 sc1
    s_waitcnt lgkmcnt(0)
    v_mfma_f32_16x16x32_bf16 v[92:95], v[128:131], a[180:183], v[92:95]
    ds_read_b128 v[104:107], v14 offset:34816
    v_bitop3_b32 v59, v59, v67, s68 bitop3:0xf6
    v_mfma_f32_16x16x32_bf16 v[92:95], v[132:135], a[188:191], v[92:95]
    ds_read_b128 v[108:111], v14 offset:38912
    v_cmp_ne_u32 vcc, 0, v59
    v_mfma_f32_16x16x32_bf16 v[88:91], v[132:135], a[184:187], v[88:91]
    ds_read_b128 v[112:115], v14 offset:43008
    buffer_load_dwordx4 v[76:79], v136, s[44:47], s12 offen offset:1024 sc1
    v_mfma_f32_16x16x32_bf16 v[88:91], v[128:131], a[176:179], v[88:91]
    ds_read_b128 v[116:119], v14 offset:47104
    s_cbranch_vccnz L_xs_b
L_xo_b:
    v_fma_f32 v180, v180, v36, v160
    v_mfma_f32_16x16x32_bf16 v[88:91], v[124:127], a[168:171], v[88:91]
    buffer_load_dwordx4 v[80:83], v136, s[44:47], s12 offen offset:2048 sc1
    v_and_b32 v41, 0xffff0000, v56
    v_mfma_f32_16x16x32_bf16 v[88:91], v[120:123], a[160:163], v[88:91]
    v_lshlrev_b32 v40, 16, v56
    s_waitcnt lgkmcnt(2)
    v_mfma_f32_16x16x32_bf16 v[96:99], v[104:107], a[160:163], v[96:99]
    v_and_b32 v43, 0xffff0000, v57
    v_fma_f32 v181, v181, v37, v161
    v_mfma_f32_16x16x32_bf16 v[96:99], v[108:111], a[168:171], v[96:99]
    v_lshlrev_b32 v42, 16, v57
    s_waitcnt lgkmcnt(0)
    v_mfma_f32_16x16x32_bf16 v[96:99], v[112:115], a[176:179], v[96:99]
    ds_read_b128 v[120:123], v14 offset:35840
    v_and_b32 v45, 0xffff0000, v58
    v_mfma_f32_16x16x32_bf16 v[96:99], v[116:119], a[184:187], v[96:99]
    ds_read_b128 v[124:127], v14 offset:39936
    v_fma_f32 v182, v182, v38, v162
    v_mfma_f32_16x16x32_bf16 v[100:103], v[116:119], a[188:191], v[100:103]
    ds_read_b128 v[128:131], v14 offset:44032
    v_lshlrev_b32 v44, 16, v58
    v_mfma_f32_16x16x32_bf16 v[100:103], v[112:115], a[180:183], v[100:103]
    ds_read_b128 v[132:135], v14 offset:48128
    v_and_b32 v47, 0xffff0000, v60
    v_mfma_f32_16x16x32_bf16 v[100:103], v[108:111], a[172:175], v[100:103]
    v_lshlrev_b32 v46, 16, v60
    v_fma_f32 v183, v183, v39, v163
    v_mfma_f32_16x16x32_bf16 v[100:103], v[104:107], a[164:167], v[100:103]
    v_and_b32 v49, 0xffff0000, v61
    s_waitcnt lgkmcnt(2)
    v_mfma_f32_16x16x32_bf16 v[92:95], v[120:123], a[196:199], v[92:95]
    v_lshlrev_b32 v48, 16, v61
    v_cvt_pk_bf16_f32 v142, v180, v181
    v_mfma_f32_16x16x32_bf16 v[92:95], v[124:127], a[204:207], v[92:95]
    v_and_b32 v51, 0xffff0000, v62
    s_waitcnt lgkmcnt(0)
    v_mfma_f32_16x16x32_bf16 v[92:95], v[128:131], a[212:215], v[92:95]
    s_waitcnt vmcnt(4)
    s_barrier
    v_lshlrev_b32 v50, 16, v62
    v_mfma_f32_16x16x32_bf16 v[92:95], v[132:135], a[220:223], v[92:95]
    ds_read_b128 v[104:107], v14 offset:49152
    v_cvt_pk_bf16_f32 v143, v182, v183
    v_mfma_f32_16x16x32_bf16 v[88:91], v[132:135], a[216:219], v[88:91]
    ds_read_b128 v[108:111], v14 offset:53248
    v_and_b32 v53, 0xffff0000, v64
    v_mfma_f32_16x16x32_bf16 v[88:91], v[128:131], a[208:211], v[88:91]
    ds_read_b128 v[112:115], v14 offset:57344
    v_lshlrev_b32 v52, 16, v64
    v_mfma_f32_16x16x32_bf16 v[88:91], v[124:127], a[200:203], v[88:91]
    ds_read_b128 v[116:119], v14 offset:61440
    v_and_b32 v55, 0xffff0000, v65
    v_mfma_f32_16x16x32_bf16 v[88:91], v[120:123], a[192:195], v[88:91]
    v_lshlrev_b32 v54, 16, v65
    s_waitcnt lgkmcnt(2)
    v_mfma_f32_16x16x32_bf16 v[96:99], v[104:107], a[192:195], v[96:99]
    v_mfma_f32_16x16x32_bf16 v[96:99], v[108:111], a[200:203], v[96:99]
    s_waitcnt lgkmcnt(0)
    v_mfma_f32_16x16x32_bf16 v[96:99], v[112:115], a[208:211], v[96:99]
    ds_read_b128 v[120:123], v14 offset:50176
    v_add_f32 v92, v92, v44
    v_add_f32 v93, v93, v45
    v_mfma_f32_16x16x32_bf16 v[96:99], v[116:119], a[216:219], v[96:99]
    ds_read_b128 v[124:127], v14 offset:54272
    v_add_f32 v94, v94, v46
    v_mfma_f32_16x16x32_bf16 v[100:103], v[116:119], a[220:223], v[100:103]
    ds_read_b128 v[128:131], v14 offset:58368
    v_add_f32 v95, v95, v47
    v_add_f32 v88, v88, v40
    v_mfma_f32_16x16x32_bf16 v[100:103], v[112:115], a[212:215], v[100:103]
    ds_read_b128 v[132:135], v14 offset:62464
    v_add_f32 v89, v89, v41
    v_mfma_f32_16x16x32_bf16 v[100:103], v[108:111], a[204:207], v[100:103]
    v_add_f32 v90, v90, v42
    v_add_f32 v91, v91, v43
    v_mfma_f32_16x16x32_bf16 v[100:103], v[104:107], a[196:199], v[100:103]
    s_waitcnt lgkmcnt(2)
    v_mfma_f32_16x16x32_bf16 v[92:95], v[120:123], a[228:231], v[92:95]
    v_mfma_f32_16x16x32_bf16 v[92:95], v[124:127], a[236:239], v[92:95]
    s_waitcnt lgkmcnt(0)
    v_mfma_f32_16x16x32_bf16 v[92:95], v[128:131], a[244:247], v[92:95]
    ds_read_b128 v[104:107], v14 offset:51200
    v_add_f32 v96, v96, v48
    v_add_f32 v97, v97, v49
    v_mfma_f32_16x16x32_bf16 v[92:95], v[132:135], a[252:255], v[92:95]
    ds_read_b128 v[108:111], v14 offset:55296
    v_add_f32 v98, v98, v50
    v_mfma_f32_16x16x32_bf16 v[88:91], v[132:135], a[248:251], v[88:91]
    ds_read_b128 v[112:115], v14 offset:59392
    v_add_f32 v99, v99, v51
    v_add_f32 v100, v100, v52
    v_mfma_f32_16x16x32_bf16 v[88:91], v[128:131], a[240:243], v[88:91]
    ds_read_b128 v[116:119], v14 offset:63488
    v_add_f32 v101, v101, v53
    v_mfma_f32_16x16x32_bf16 v[88:91], v[124:127], a[232:235], v[88:91]
    v_add_f32 v102, v102, v54
    v_add_f32 v103, v103, v55
    v_mfma_f32_16x16x32_bf16 v[88:91], v[120:123], a[224:227], v[88:91]
    s_waitcnt lgkmcnt(2)
    v_mfma_f32_16x16x32_bf16 v[96:99], v[104:107], a[224:227], v[96:99]
    v_mfma_f32_16x16x32_bf16 v[96:99], v[108:111], a[232:235], v[96:99]
    s_waitcnt lgkmcnt(0)
    v_mfma_f32_16x16x32_bf16 v[96:99], v[112:115], a[240:243], v[96:99]
    ds_read_b128 v[120:123], v14 offset:52224
    v_mfma_f32_16x16x32_bf16 v[96:99], v[116:119], a[248:251], v[96:99]
    ds_read_b128 v[124:127], v14 offset:56320
    v_mfma_f32_16x16x32_bf16 v[100:103], v[116:119], a[252:255], v[100:103]
    buffer_store_dwordx2 v[142:143], v253, s[64:67], 0 offen sc1
    ds_read_b128 v[128:131], v14 offset:60416
    v_mfma_f32_16x16x32_bf16 v[100:103], v[112:115], a[244:247], v[100:103]
    ds_read_b128 v[132:135], v14 offset:64512
    v_mfma_f32_16x16x32_bf16 v[100:103], v[108:111], a[236:239], v[100:103]
    v_mfma_f32_16x16x32_bf16 v[100:103], v[104:107], a[228:231], v[100:103]
    s_waitcnt lgkmcnt(2)
    v_mfma_f32_16x16x32_bf16 v[92:95], v[120:123], v[224:227], v[92:95]
    v_mfma_f32_16x16x32_bf16 v[92:95], v[124:127], v[232:235], v[92:95]
    s_waitcnt lgkmcnt(0)
    v_mfma_f32_16x16x32_bf16 v[92:95], v[128:131], v[240:243], v[92:95]
    s_waitcnt vmcnt(4)
    s_barrier
    v_mfma_f32_16x16x32_bf16 v[92:95], v[132:135], v[248:251], v[92:95]
    ds_read_b128 v[104:107], v14 offset:0
    v_mfma_f32_16x16x32_bf16 v[88:91], v[132:135], v[244:247], v[88:91]
    ds_read_b128 v[108:111], v14 offset:4096
    v_mfma_f32_16x16x32_bf16 v[88:91], v[128:131], v[236:239], v[88:91]
    ds_read_b128 v[112:115], v14 offset:8192
    v_mfma_f32_16x16x32_bf16 v[88:91], v[124:127], v[228:231], v[88:91]
    ds_read_b128 v[116:119], v14 offset:12288
    v_mfma_f32_16x16x32_bf16 v[88:91], v[120:123], v[220:223], v[88:91]
    s_waitcnt lgkmcnt(2)
    v_mfma_f32_16x16x32_bf16 v[96:99], v[104:107], v[220:223], v[96:99]
    v_mfma_f32_16x16x32_bf16 v[96:99], v[108:111], v[228:231], v[96:99]
    s_waitcnt lgkmcnt(0)
    v_mfma_f32_16x16x32_bf16 v[96:99], v[112:115], v[236:239], v[96:99]
    v_mfma_f32_16x16x32_bf16 v[96:99], v[116:119], v[244:247], v[96:99]
    v_mfma_f32_16x16x32_bf16 v[100:103], v[116:119], v[248:251], v[100:103]
    v_mfma_f32_16x16x32_bf16 v[100:103], v[112:115], v[240:243], v[100:103]
    v_mfma_f32_16x16x32_bf16 v[100:103], v[108:111], v[232:235], v[100:103]
    v_mfma_f32_16x16x32_bf16 v[100:103], v[104:107], v[224:227], v[100:103]
    s_waitcnt vmcnt(1)
    v_bitop3_b32 v75, v75, v79, s68 bitop3:0x7e
    v_bitop3_b32 v75, v75, v83, s68 bitop3:0xf6
    v_cmp_ne_u32 vcc, 0, v75
    s_cbranch_vccnz L_xs_z
L_xo_z:
    v_and_b32 v41, 0xffff0000, v72
    v_lshlrev_b32 v40, 16, v72
    v_and_b32 v43, 0xffff0000, v73
    v_lshlrev_b32 v42, 16, v73
    v_and_b32 v45, 0xffff0000, v74
    v_lshlrev_b32 v44, 16, v74
    v_and_b32 v47, 0xffff0000, v76
    v_lshlrev_b32 v46, 16, v76
    v_and_b32 v49, 0xffff0000, v77
    v_lshlrev_b32 v48, 16, v77
    v_and_b32 v51, 0xffff0000, v78
    v_lshlrev_b32 v50, 16, v78
    v_and_b32 v53, 0xffff0000, v80
    v_lshlrev_b32 v52, 16, v80
    v_and_b32 v55, 0xffff0000, v81
    v_lshlrev_b32 v54, 16, v81
    v_pk_add_f32 v[88:89], v[88:89], v[40:41]
    v_pk_add_f32 v[90:91], v[90:91], v[42:43]
    v_pk_add_f32 v[96:97], v[96:97], v[48:49]
    v_pk_add_f32 v[98:99], v[98:99], v[50:51]
    v_pk_mul_f32 v[56:57], v[88:89], s[38:39] op_sel_hi:[1,0]
    v_pk_mul_f32 v[58:59], v[90:91], s[38:39] op_sel_hi:[1,0]
    v_pk_mul_f32 v[64:65], v[96:97], s[38:39] op_sel_hi:[1,0]
    v_pk_mul_f32 v[66:67], v[98:99], s[38:39] op_sel_hi:[1,0]
    v_exp_f32 v56, v56
    v_exp_f32 v57, v57
    v_exp_f32 v58, v58
    v_exp_f32 v59, v59
    v_exp_f32 v64, v64
    v_exp_f32 v65, v65
    v_exp_f32 v66, v66
    v_exp_f32 v67, v67
    v_pk_mul_f32 v[164:165], v[164:165], v[88:89]
    v_pk_mul_f32 v[166:167], v[166:167], v[90:91]
    v_pk_mul_f32 v[172:173], v[172:173], v[96:97]
    v_pk_mul_f32 v[174:175], v[174:175], v[98:99]
    v_pk_add_f32 v[56:57], v[56:57], 1.0 op_sel_hi:[1,0]
    v_pk_add_f32 v[58:59], v[58:59], 1.0 op_sel_hi:[1,0]
    v_pk_add_f32 v[64:65], v[64:65], 1.0 op_sel_hi:[1,0]
    v_pk_add_f32 v[66:67], v[66:67], 1.0 op_sel_hi:[1,0]
    v_rcp_f32 v56, v56
    v_rcp_f32 v57, v57
    v_rcp_f32 v58, v58
    v_rcp_f32 v59, v59
    v_rcp_f32 v64, v64
    v_rcp_f32 v65, v65
    v_rcp_f32 v66, v66
    v_rcp_f32 v67, v67
    v_pk_fma_f32 v[164:165], v[164:165], v[56:57], v[144:145]
    v_pk_fma_f32 v[166:167], v[166:167], v[58:59], v[146:147]
    v_pk_fma_f32 v[172:173], v[172:173], v[64:65], v[152:153]
    v_pk_fma_f32 v[174:175], v[174:175], v[66:67], v[154:155]
    v_cvt_pk_bf16_f32 v88, v164, v165
    v_cvt_pk_bf16_f32 v90, v172, v173
    v_cvt_pk_bf16_f32 v89, v166, v167
    v_cvt_pk_bf16_f32 v91, v174, v175
    v_permlane16_swap_b32 v88, v90
    s_nop 0
    v_permlane16_swap_b32 v89, v91
    buffer_store_dwordx4 v[88:91], v252, s[64:67], 0 offen sc1
    v_pk_add_f32 v[92:93], v[92:93], v[44:45]
    v_pk_add_f32 v[94:95], v[94:95], v[46:47]
    v_pk_add_f32 v[100:101], v[100:101], v[52:53]
    v_pk_add_f32 v[102:103], v[102:103], v[54:55]
    v_pk_mul_f32 v[60:61], v[92:93], s[38:39] op_sel_hi:[1,0]
    v_pk_mul_f32 v[62:63], v[94:95], s[38:39] op_sel_hi:[1,0]
    v_pk_mul_f32 v[68:69], v[100:101], s[38:39] op_sel_hi:[1,0]
    v_pk_mul_f32 v[70:71], v[102:103], s[38:39] op_sel_hi:[1,0]
    v_exp_f32 v60, v60
    v_exp_f32 v61, v61
    v_exp_f32 v62, v62
    v_exp_f32 v63, v63
    v_exp_f32 v68, v68
    v_exp_f32 v69, v69
    v_exp_f32 v70, v70
    v_exp_f32 v71, v71
    v_pk_mul_f32 v[168:169], v[168:169], v[92:93]
    v_pk_mul_f32 v[170:171], v[170:171], v[94:95]
    v_pk_mul_f32 v[176:177], v[176:177], v[100:101]
    v_pk_mul_f32 v[178:179], v[178:179], v[102:103]
    v_pk_add_f32 v[60:61], v[60:61], 1.0 op_sel_hi:[1,0]
    v_pk_add_f32 v[62:63], v[62:63], 1.0 op_sel_hi:[1,0]
    v_pk_add_f32 v[68:69], v[68:69], 1.0 op_sel_hi:[1,0]
    v_pk_add_f32 v[70:71], v[70:71], 1.0 op_sel_hi:[1,0]
    v_rcp_f32 v60, v60
    v_rcp_f32 v61, v61
    v_rcp_f32 v62, v62
    v_rcp_f32 v63, v63
    v_rcp_f32 v68, v68
    v_rcp_f32 v69, v69
    v_rcp_f32 v70, v70
    v_rcp_f32 v71, v71
    v_pk_fma_f32 v[168:169], v[168:169], v[60:61], v[148:149]
    v_pk_fma_f32 v[170:171], v[170:171], v[62:63], v[150:151]
    v_pk_fma_f32 v[176:177], v[176:177], v[68:69], v[156:157]
    v_pk_fma_f32 v[178:179], v[178:179], v[70:71], v[158:159]
    v_cvt_pk_bf16_f32 v92, v168, v169
    v_cvt_pk_bf16_f32 v94, v176, v177
    v_cvt_pk_bf16_f32 v93, v170, v171
    v_cvt_pk_bf16_f32 v95, v178, v179
    v_permlane16_swap_b32 v92, v94
    s_nop 0
    v_permlane16_swap_b32 v93, v95
    buffer_store_dwordx4 v[92:95], v252, s[64:67], s40 offen sc1
    s_endpgm
L_segE:
.p2align 12
L_aux:
    s_bfe_u32 s101, s2, 0x20003
    s_mul_i32 s101, s101, 3
    s_mul_i32 s84, s101, 305844
    s_lshr_b32 s84, s84, 18
    s_add_u32 s84, s84, 0
    s_add_u32 s85, s84, 1
    s_cmp_eq_u32 s85, 14
    s_cselect_b32 s85, 0, s85
    s_add_u32 s86, s85, 1
    s_cmp_eq_u32 s86, 14
    s_cselect_b32 s86, 0, s86
    s_add_u32 s87, s86, 1
    s_cmp_eq_u32 s87, 14
    s_cselect_b32 s87, 0, s87
    s_add_u32 s88, s87, 1
    s_cmp_eq_u32 s88, 14
    s_cselect_b32 s88, 0, s88
    s_add_u32 s89, s88, 1
    s_cmp_eq_u32 s89, 14
    s_cselect_b32 s89, 0, s89
    s_add_u32 s90, s89, 1
    s_cmp_eq_u32 s90, 14
    s_cselect_b32 s90, 0, s90
    s_add_u32 s91, s90, 1
    s_cmp_eq_u32 s91, 14
    s_cselect_b32 s91, 0, s91
    s_add_u32 s92, s91, 1
    s_cmp_eq_u32 s92, 14
    s_cselect_b32 s92, 0, s92
    s_add_u32 s93, s92, 1
    s_cmp_eq_u32 s93, 14
    s_cselect_b32 s93, 0, s93
    s_add_u32 s94, s93, 1
    s_cmp_eq_u32 s94, 14
    s_cselect_b32 s94, 0, s94
    s_add_u32 s95, s94, 1
    s_cmp_eq_u32 s95, 14
    s_cselect_b32 s95, 0, s95
    s_add_u32 s96, s95, 1
    s_cmp_eq_u32 s96, 14
    s_cselect_b32 s96, 0, s96
    s_add_u32 s97, s96, 1
    s_cmp_eq_u32 s97, 14
    s_cselect_b32 s97, 0, s97
    s_mul_i32 s98, s101, 87384
    s_lshr_b32 s98, s98, 18
    s_add_u32 s98, s98, 14
    s_add_u32 s99, s98, 1
    s_cmp_eq_u32 s99, 18
    s_cselect_b32 s99, 14, s99
    s_add_u32 s100, s99, 1
    s_cmp_eq_u32 s100, 18
    s_cselect_b32 s100, 14, s100
    s_add_u32 s101, s100, 1
    s_cmp_eq_u32 s101, 18
    s_cselect_b32 s101, 14, s101
    s_lshl2_add_u32 s7, s5, s6
    s_add_u32 s7, s7, 188
    s_add_u32 s8, s5, 248
    s_cmp_eq_u32 s6, 27
    s_cselect_b32 s75, s8, s7
    s_mov_b32 s48, s24
    s_and_b32 s49, s25, 0xffff
    s_mov_b32 s50, 2359296
    s_mov_b32 s51, 0x20000
    v_lshlrev_b32 v240, 4, v2
    s_mul_i32 s74, s3, 16640
    s_add_u32 s74, s74, 73728
    s_sub_u32 s69, s75, 216
    s_lshl_b32 s70, s69, 4
    s_add_u32 s70, s70, s3
    s_lshl_b32 s12, s70, 12
    s_lshl_b32 s70, s70, 1
    s_mov_b32 s9, 144896
    s_mov_b32 s11, 8192
    v_mul_u32_u24 v48, 1216, v3
    v_mad_u32_u24 v48, v4, 12, v48
    v_add_u32 v48, s9, v48
    v_mov_b32 v47, 0x40000000
    v_lshlrev_b32 v3, 3, v3
    s_lshl_b32 s5, s68, 6
    s_add_u32 s5, s5, 12386304
    v_cmp_eq_u32 vcc, 0, v4
    s_nop 1
    v_cndmask_b32 v49, v47, v3, vcc
    v_lshrrev_b32 v5, 4, v0
    v_and_b32 v4, 3, v2
    v_lshlrev_b32 v4, 3, v4
    v_lshl_add_u32 v5, v5, 5, v4
    v_bfe_u32 v6, v2, 2, 2
    v_mul_u32_u24 v4, 1216, v6
    v_mul_u32_u24 v6, 1152, v6
    v_add3_u32 v50, v4, v5, s9
    v_add3_u32 v51, v6, v5, s11
    s_mul_i32 s4, s3, 2176
    v_add_u32 v55, s4, v51
    v_lshlrev_b32 v52, 4, v0
    s_add_u32 s7, s15, 4096
    s_add_u32 s8, s15, 8192
    s_cmp_eq_u32 s3, 0
    s_cselect_b32 s8, s8, 0x40000000
    v_add_u32 v53, 2359296, v52
    v_mov_b32 v54, 0
    v_add_u32 v4, 0, v52
    v_lshrrev_b32 v5, 7, v4
    v_mul_u32_u24 v6, 9363, v5
    v_lshrrev_b32 v6, 16, v6
    v_mad_i32_i24 v5, v6, -7, v5
    v_cmp_lt_u32 vcc, 2, v5
    s_nop 1
    v_addc_co_u32 v6, vcc, 0, v6, vcc
    v_lshl_add_u32 v93, v6, 7, v4
    v_add_u32 v4, 4096, v52
    v_lshrrev_b32 v5, 7, v4
    v_mul_u32_u24 v6, 9363, v5
    v_lshrrev_b32 v6, 16, v6
    v_mad_i32_i24 v5, v6, -7, v5
    v_cmp_lt_u32 vcc, 2, v5
    s_nop 1
    v_addc_co_u32 v6, vcc, 0, v6, vcc
    v_lshl_add_u32 v94, v6, 7, v4
    v_add_u32 v4, 8192, v52
    v_lshrrev_b32 v5, 7, v4
    v_mul_u32_u24 v6, 9363, v5
    v_lshrrev_b32 v6, 16, v6
    v_mad_i32_i24 v5, v6, -7, v5
    v_cmp_lt_u32 vcc, 2, v5
    s_nop 1
    v_addc_co_u32 v6, vcc, 0, v6, vcc
    v_lshl_add_u32 v95, v6, 7, v4
    s_mul_i32 s10, s68, 11264
    s_add_u32 s10, s10, 36585472
    s_cmp_eq_u32 s3, 0
    s_cselect_b32 s83, s10, 0x40000000
    s_add_u32 s7, s10, 2883584
    s_add_u32 s8, s83, 2883584
    s_mul_i32 s4, s3, 1028
    s_sub_u32 s4, 8204, s4
    v_add_u32 v90, s4, v53
    s_bfe_u32 s6, s68, 0x20001
    s_lshl_b32 s6, s6, 6
    s_lshr_b32 s9, s68, 3
    s_lshl1_add_u32 s6, s9, s6
    s_and_b32 s9, s68, 1
    s_add_u32 s6, s6, s9
    s_lshl_b32 s4, s6, 2
    s_add_u32 s4, s4, 12533760
    v_lshl_add_u32 v1, v0, 10, s4
    s_lshl_b32 s4, s68, 2
    s_add_u32 s4, s4, 12599296
    v_lshl_add_u32 v46, v0, 10, s4
    v_cmp_gt_u32 vcc, 8, v0
    s_nop 1
    v_cndmask_b32 v1, v47, v1, vcc
    v_cmp_gt_u32 vcc, 4, v0
    s_nop 1
    v_cndmask_b32 v46, v47, v46, vcc
    s_waitcnt vmcnt(9)
    v_and_b32 v21, 0xffff0000, v8
    v_lshlrev_b32 v20, 16, v8
    v_and_b32 v23, 0xffff0000, v9
    v_lshlrev_b32 v22, 16, v9
    v_and_b32 v25, 0xffff0000, v10
    v_lshlrev_b32 v24, 16, v10
    v_and_b32 v27, 0xffff0000, v12
    v_lshlrev_b32 v26, 16, v12
    v_and_b32 v29, 0xffff0000, v13
    v_lshlrev_b32 v28, 16, v13
    v_and_b32 v31, 0xffff0000, v14
    v_lshlrev_b32 v30, 16, v14
    v_and_b32 v33, 0xffff0000, v16
    v_lshlrev_b32 v32, 16, v16
    v_and_b32 v35, 0xffff0000, v17
    v_lshlrev_b32 v34, 16, v17
    v_and_b32 v37, 0xffff0000, v18
    v_lshlrev_b32 v36, 16, v18
    v_pk_add_f32 v[38:39], v[20:21], v[22:23]
    v_pk_add_f32 v[40:41], v[24:25], v[26:27]
    v_pk_add_f32 v[42:43], v[28:29], v[30:31]
    v_pk_add_f32 v[44:45], v[32:33], v[34:35]
    v_pk_add_f32 v[38:39], v[38:39], v[40:41]
    v_pk_add_f32 v[42:43], v[42:43], v[44:45]
    v_pk_add_f32 v[38:39], v[38:39], v[36:37]
    v_pk_add_f32 v[38:39], v[38:39], v[42:43]
    v_add_f32 v56, v38, v39
    s_nop 1
    v_add_f32_dpp v56, v56, v56 row_ror:8 row_mask:0xf bank_mask:0xf
    s_nop 1
    v_add_f32_dpp v56, v56, v56 row_ror:4 row_mask:0xf bank_mask:0xf
    s_nop 1
    v_add_f32_dpp v56, v56, v56 row_ror:2 row_mask:0xf bank_mask:0xf
    s_nop 1
    v_add_f32_dpp v56, v56, v56 row_ror:1 row_mask:0xf bank_mask:0xf
    v_mov_b32 v57, v56
    s_nop 1
    v_permlane16_swap_b32 v56, v57
    v_add_f32 v56, v56, v57
    v_mul_f32 v56, 0x3ae38e39, v56
    v_pk_add_f32 v[20:21], v[20:21], v[56:57] op_sel_hi:[1,0] neg_lo:[0,1] neg_hi:[0,1]
    v_pk_add_f32 v[22:23], v[22:23], v[56:57] op_sel_hi:[1,0] neg_lo:[0,1] neg_hi:[0,1]
    v_pk_add_f32 v[24:25], v[24:25], v[56:57] op_sel_hi:[1,0] neg_lo:[0,1] neg_hi:[0,1]
    v_pk_add_f32 v[26:27], v[26:27], v[56:57] op_sel_hi:[1,0] neg_lo:[0,1] neg_hi:[0,1]
    v_pk_add_f32 v[28:29], v[28:29], v[56:57] op_sel_hi:[1,0] neg_lo:[0,1] neg_hi:[0,1]
    v_pk_add_f32 v[30:31], v[30:31], v[56:57] op_sel_hi:[1,0] neg_lo:[0,1] neg_hi:[0,1]
    v_pk_add_f32 v[32:33], v[32:33], v[56:57] op_sel_hi:[1,0] neg_lo:[0,1] neg_hi:[0,1]
    v_pk_add_f32 v[34:35], v[34:35], v[56:57] op_sel_hi:[1,0] neg_lo:[0,1] neg_hi:[0,1]
    v_pk_add_f32 v[36:37], v[36:37], v[56:57] op_sel_hi:[1,0] neg_lo:[0,1] neg_hi:[0,1]
    v_pk_mul_f32 v[38:39], v[20:21], v[20:21]
    v_pk_mul_f32 v[40:41], v[22:23], v[22:23]
    v_pk_fma_f32 v[38:39], v[24:25], v[24:25], v[38:39]
    v_pk_fma_f32 v[40:41], v[26:27], v[26:27], v[40:41]
    v_pk_fma_f32 v[38:39], v[28:29], v[28:29], v[38:39]
    v_pk_fma_f32 v[40:41], v[30:31], v[30:31], v[40:41]
    v_pk_fma_f32 v[38:39], v[32:33], v[32:33], v[38:39]
    v_pk_fma_f32 v[40:41], v[34:35], v[34:35], v[40:41]
    v_pk_fma_f32 v[38:39], v[36:37], v[36:37], v[38:39]
    v_pk_add_f32 v[38:39], v[38:39], v[40:41]
    v_add_f32 v18, v38, v39
    s_nop 1
    v_add_f32_dpp v18, v18, v18 row_ror:8 row_mask:0xf bank_mask:0xf
    s_nop 1
    v_add_f32_dpp v18, v18, v18 row_ror:4 row_mask:0xf bank_mask:0xf
    s_nop 1
    v_add_f32_dpp v18, v18, v18 row_ror:2 row_mask:0xf bank_mask:0xf
    s_nop 1
    v_add_f32_dpp v18, v18, v18 row_ror:1 row_mask:0xf bank_mask:0xf
    v_mov_b32 v19, v18
    s_nop 1
    v_permlane16_swap_b32 v18, v19
    v_add_f32 v18, v18, v19
    v_mul_f32 v18, 0x3ae38e39, v18
    v_cvt_pk_bf16_f32 v38, v56, v18
    v_lshlrev_b32 v106, 16, v38
    v_and_b32 v38, 0xffff0000, v38
    v_add_f32 v38, 0x3727c5ac, v38
    v_sub_f32 v56, v56, v106
    v_cvt_pk_bf16_f32 v38, v38, v38
    v_lshlrev_b32 v38, 16, v38
    v_sqrt_f32 v38, v38
    s_nop 0
    v_cvt_pk_bf16_f32 v38, v38, v38
    v_lshlrev_b32 v38, 16, v38
    v_rcp_f32 v107, v38
    s_nop 0
    v_mul_f32 v56, v56, v107
    v_mul_f32 v18, v18, v107
    v_mul_f32 v18, v18, v107
    v_cvt_pk_bf16_f32 v38, v56, v18
    v_lshlrev_b32 v39, 16, v38
    v_and_b32 v38, 0xffff0000, v38
    v_add_f32 v38, 0x3727c5ac, v38
    v_sub_f32 v56, v56, v39
    v_cvt_pk_bf16_f32 v38, v38, v38
    v_lshlrev_b32 v38, 16, v38
    v_sqrt_f32 v38, v38
    s_nop 0
    v_cvt_pk_bf16_f32 v38, v38, v38
    v_lshlrev_b32 v38, 16, v38
    v_rcp_f32 v38, v38
    s_nop 0
    v_mul_f32 v18, v107, v38
    v_mul_f32 v56, v56, v38
    v_pk_fma_f32 v[20:21], v[20:21], v[18:19], v[56:57] op_sel_hi:[1,0,0]
    v_pk_fma_f32 v[22:23], v[22:23], v[18:19], v[56:57] op_sel_hi:[1,0,0]
    v_pk_fma_f32 v[24:25], v[24:25], v[18:19], v[56:57] op_sel_hi:[1,0,0]
    v_pk_fma_f32 v[26:27], v[26:27], v[18:19], v[56:57] op_sel_hi:[1,0,0]
    v_pk_fma_f32 v[28:29], v[28:29], v[18:19], v[56:57] op_sel_hi:[1,0,0]
    v_pk_fma_f32 v[30:31], v[30:31], v[18:19], v[56:57] op_sel_hi:[1,0,0]
    v_pk_fma_f32 v[32:33], v[32:33], v[18:19], v[56:57] op_sel_hi:[1,0,0]
    v_pk_fma_f32 v[34:35], v[34:35], v[18:19], v[56:57] op_sel_hi:[1,0,0]
    v_pk_fma_f32 v[36:37], v[36:37], v[18:19], v[56:57] op_sel_hi:[1,0,0]
    v_cvt_pk_bf16_f32 v8, v20, v21
    v_cvt_pk_bf16_f32 v9, v22, v23
    v_cvt_pk_bf16_f32 v10, v24, v25
    v_cvt_pk_bf16_f32 v11, v26, v27
    v_cvt_pk_bf16_f32 v12, v28, v29
    v_cvt_pk_bf16_f32 v13, v30, v31
    v_cvt_pk_bf16_f32 v14, v32, v33
    v_cvt_pk_bf16_f32 v15, v34, v35
    v_cvt_pk_bf16_f32 v16, v36, v37
    ds_write_b32 v48, v8 offset:0
    ds_write_b32 v48, v9 offset:4
    ds_write_b32 v48, v10 offset:8
    ds_write_b32 v48, v11 offset:384
    ds_write_b32 v48, v12 offset:388
    ds_write_b32 v48, v13 offset:392
    ds_write_b32 v48, v14 offset:768
    ds_write_b32 v48, v15 offset:772
    ds_write_b32 v48, v16 offset:776
    buffer_store_dwordx2 v[106:107], v49, s[44:47], s5 offen sc1
    s_waitcnt lgkmcnt(0)
    s_barrier
    ds_read_b64_tr_b16 v[20:21], v50 offset:0
    ds_read_b64_tr_b16 v[22:23], v50 offset:4864
    ds_read_b64_tr_b16 v[24:25], v50 offset:512
    ds_read_b64_tr_b16 v[26:27], v50 offset:5376
    ds_read_b64_tr_b16 v[28:29], v50 offset:1024
    ds_read_b64_tr_b16 v[30:31], v50 offset:5888
    s_waitcnt lgkmcnt(4)
    buffer_store_dwordx4 v[20:23], v93, s[44:47], s10 offen sc1
    s_waitcnt lgkmcnt(2)
    buffer_store_dwordx4 v[24:27], v94, s[44:47], s10 offen sc1
    s_waitcnt lgkmcnt(0)
    buffer_store_dwordx4 v[28:31], v95, s[44:47], s83 offen sc1
    buffer_load_dword v45, v54, s[64:67], 0 offen sc1
    s_waitcnt vmcnt(5)
    s_barrier
    ds_read_b64_tr_b16 v[60:61], v51 offset:0
    ds_read_b64_tr_b16 v[62:63], v51 offset:4608
    ds_read_b64_tr_b16 v[64:65], v51 offset:9216
    ds_read_b64_tr_b16 v[66:67], v51 offset:12672
    ds_read_b64_tr_b16 v[68:69], v51 offset:17280
    ds_read_b64_tr_b16 v[70:71], v51 offset:512
    ds_read_b64_tr_b16 v[72:73], v51 offset:5120
    ds_read_b64_tr_b16 v[74:75], v51 offset:9728
    ds_read_b64_tr_b16 v[76:77], v51 offset:13184
    ds_read_b64_tr_b16 v[78:79], v51 offset:17792
    v_alignbit_b32 v114, v99, v99, 16
    v_alignbit_b32 v115, v98, v98, 16
    s_waitcnt lgkmcnt(5)
    v_alignbit_b32 v108, v61, v60, 16
    v_alignbit_b32 v109, v62, v61, 16
    v_alignbit_b32 v110, v63, v62, 16
    v_alignbit_b32 v111, v64, v63, 16
    v_alignbit_b32 v112, v65, v64, 16
    v_dot2_f32_bf16 v116, v60, v114, 0
    ds_read_b64_tr_b16 v[80:81], v51 offset:1024
    v_dot2_f32_bf16 v117, v108, v114, 0
    v_dot2_f32_bf16 v118, v61, v114, 0
    v_dot2_f32_bf16 v119, v109, v114, 0
    v_dot2_f32_bf16 v120, v62, v114, 0
    ds_read_b64_tr_b16 v[82:83], v51 offset:5632
    v_dot2_f32_bf16 v121, v110, v114, 0
    v_dot2_f32_bf16 v122, v63, v114, 0
    v_dot2_f32_bf16 v123, v111, v114, 0
    v_dot2_f32_bf16 v116, v61, v115, v116
    v_dot2_f32_bf16 v117, v109, v115, v117
    ds_read_b64_tr_b16 v[84:85], v51 offset:10240
    v_dot2_f32_bf16 v118, v62, v115, v118
    v_dot2_f32_bf16 v119, v110, v115, v119
    v_dot2_f32_bf16 v120, v63, v115, v120
    v_dot2_f32_bf16 v121, v111, v115, v121
    v_dot2_f32_bf16 v122, v64, v115, v122
    ds_read_b64_tr_b16 v[86:87], v51 offset:13696
    v_dot2_f32_bf16 v123, v112, v115, v123
    v_and_b32 v133, 0xffff0000, v66
    v_lshlrev_b32 v132, 16, v66
    v_and_b32 v135, 0xffff0000, v67
    v_lshlrev_b32 v134, 16, v67
    ds_read_b64_tr_b16 v[88:89], v51 offset:18304
    v_and_b32 v137, 0xffff0000, v68
    v_lshlrev_b32 v136, 16, v68
    v_and_b32 v139, 0xffff0000, v69
    v_lshlrev_b32 v138, 16, v69
    v_pk_mul_f32 v[116:117], v[116:117], v[132:133]
    v_pk_mul_f32 v[118:119], v[118:119], v[134:135]
    v_pk_mul_f32 v[120:121], v[120:121], v[136:137]
    v_pk_mul_f32 v[122:123], v[122:123], v[138:139]
    v_cvt_pk_bf16_f32 v160, v123, v122
    v_cvt_pk_bf16_f32 v161, v121, v120
    v_cvt_pk_bf16_f32 v162, v119, v118
    v_cvt_pk_bf16_f32 v163, v117, v116
    buffer_store_dwordx4 v[160:163], v93, s[44:47], s7 offen sc1
    v_alignbit_b32 v114, v101, v101, 16
    v_alignbit_b32 v115, v100, v100, 16
    s_waitcnt lgkmcnt(5)
    v_alignbit_b32 v108, v71, v70, 16
    v_alignbit_b32 v109, v72, v71, 16
    v_alignbit_b32 v110, v73, v72, 16
    v_alignbit_b32 v111, v74, v73, 16
    v_alignbit_b32 v112, v75, v74, 16
    v_dot2_f32_bf16 v124, v70, v114, 0
    v_dot2_f32_bf16 v125, v108, v114, 0
    v_dot2_f32_bf16 v126, v71, v114, 0
    v_dot2_f32_bf16 v127, v109, v114, 0
    v_dot2_f32_bf16 v128, v72, v114, 0
    v_dot2_f32_bf16 v129, v110, v114, 0
    v_dot2_f32_bf16 v130, v73, v114, 0
    v_dot2_f32_bf16 v131, v111, v114, 0
    v_dot2_f32_bf16 v124, v71, v115, v124
    v_dot2_f32_bf16 v125, v109, v115, v125
    v_dot2_f32_bf16 v126, v72, v115, v126
    v_dot2_f32_bf16 v127, v110, v115, v127
    v_dot2_f32_bf16 v128, v73, v115, v128
    v_dot2_f32_bf16 v129, v111, v115, v129
    v_dot2_f32_bf16 v130, v74, v115, v130
    v_dot2_f32_bf16 v131, v112, v115, v131
    v_and_b32 v133, 0xffff0000, v76
    v_lshlrev_b32 v132, 16, v76
    v_and_b32 v135, 0xffff0000, v77
    v_lshlrev_b32 v134, 16, v77
    v_and_b32 v137, 0xffff0000, v78
    v_lshlrev_b32 v136, 16, v78
    v_and_b32 v139, 0xffff0000, v79
    v_lshlrev_b32 v138, 16, v79
    v_pk_mul_f32 v[124:125], v[124:125], v[132:133]
    v_pk_mul_f32 v[126:127], v[126:127], v[134:135]
    v_pk_mul_f32 v[128:129], v[128:129], v[136:137]
    v_pk_mul_f32 v[130:131], v[130:131], v[138:139]
    v_cvt_pk_bf16_f32 v164, v131, v130
    v_cvt_pk_bf16_f32 v165, v129, v128
    v_cvt_pk_bf16_f32 v166, v127, v126
    v_cvt_pk_bf16_f32 v167, v125, v124
    buffer_store_dwordx4 v[164:167], v94, s[44:47], s7 offen sc1
    v_alignbit_b32 v114, v103, v103, 16
    v_alignbit_b32 v115, v102, v102, 16
    s_waitcnt lgkmcnt(0)
    v_alignbit_b32 v108, v81, v80, 16
    v_alignbit_b32 v109, v82, v81, 16
    v_alignbit_b32 v110, v83, v82, 16
    v_alignbit_b32 v111, v84, v83, 16
    v_alignbit_b32 v112, v85, v84, 16
    v_dot2_f32_bf16 v116, v80, v114, 0
    v_dot2_f32_bf16 v117, v108, v114, 0
    v_dot2_f32_bf16 v118, v81, v114, 0
    v_dot2_f32_bf16 v119, v109, v114, 0
    v_dot2_f32_bf16 v120, v82, v114, 0
    v_dot2_f32_bf16 v121, v110, v114, 0
    v_dot2_f32_bf16 v122, v83, v114, 0
    v_dot2_f32_bf16 v123, v111, v114, 0
    v_dot2_f32_bf16 v116, v81, v115, v116
    v_dot2_f32_bf16 v117, v109, v115, v117
    v_dot2_f32_bf16 v118, v82, v115, v118
    v_dot2_f32_bf16 v119, v110, v115, v119
    v_dot2_f32_bf16 v120, v83, v115, v120
    v_dot2_f32_bf16 v121, v111, v115, v121
    v_dot2_f32_bf16 v122, v84, v115, v122
    v_dot2_f32_bf16 v123, v112, v115, v123
    v_and_b32 v133, 0xffff0000, v86
    v_lshlrev_b32 v132, 16, v86
    v_and_b32 v135, 0xffff0000, v87
    v_lshlrev_b32 v134, 16, v87
    v_and_b32 v137, 0xffff0000, v88
    v_lshlrev_b32 v136, 16, v88
    v_and_b32 v139, 0xffff0000, v89
    v_lshlrev_b32 v138, 16, v89
    v_pk_mul_f32 v[116:117], v[116:117], v[132:133]
    v_pk_mul_f32 v[118:119], v[118:119], v[134:135]
    v_pk_mul_f32 v[120:121], v[120:121], v[136:137]
    v_pk_mul_f32 v[122:123], v[122:123], v[138:139]
    v_cvt_pk_bf16_f32 v168, v123, v122
    v_cvt_pk_bf16_f32 v169, v121, v120
    v_cvt_pk_bf16_f32 v170, v119, v118
    v_cvt_pk_bf16_f32 v171, v117, v116
    buffer_store_dwordx4 v[168:171], v95, s[44:47], s8 offen sc1
    s_add_u32 m0, s74, 32
    s_add_u32 s13, s12, 0
    buffer_load_dwordx4 v240, s[48:51], s13 offen offset:0 lds
    buffer_load_dwordx4 v240, s[48:51], s13 offen offset:1024 lds
    buffer_load_dwordx4 v240, s[48:51], s13 offen offset:2048 lds
    buffer_load_dwordx4 v240, s[48:51], s13 offen offset:3072 lds
    s_add_u32 m0, s74, 8352
    s_add_u32 s13, s12, 16384
    buffer_load_dwordx4 v240, s[48:51], s13 offen offset:0 lds
    buffer_load_dwordx4 v240, s[48:51], s13 offen offset:1024 lds
    buffer_load_dwordx4 v240, s[48:51], s13 offen offset:2048 lds
    buffer_load_dwordx4 v240, s[48:51], s13 offen offset:3072 lds
    s_mov_b64 exec, 0
    s_call_b64 s[82:83], L_wc_X
    s_mov_b64 exec, -1
    s_waitcnt vmcnt(11)
    v_readfirstlane_b32 s68, v45
    s_nop 1
    s_cmp_eq_u32 s68, 0
    s_cbranch_scc1 L_nw_X
L_ng_X:
    s_barrier
    v_mov_b32 v3, s68
    buffer_store_dword v3, v1, s[44:47], 0 offen sc1
    s_waitcnt vmcnt(9)
    s_barrier
    buffer_store_dword v3, v46, s[44:47], 0 offen sc1
L_segX:
L_pl_X_0:
    s_cbranch_execz L_pl_X_4
    s_cmp_lt_u32 s75, 252
    s_cbranch_scc0 L_idle
    s_mov_b32 s56, s26
    s_and_b32 s57, s27, 0xffff
    s_mov_b32 s58, 1152
    s_mov_b32 s59, 0x20000
    v_mov_b32 v9, 0
    buffer_load_ushort v9, v9, s[56:59], s70 offen
    s_lshr_b32 s4, s2, 1
    s_and_b32 s4, s4, 3
    s_lshl2_add_u32 s4, s4, s3
    s_lshl_b32 s4, s4, 8
    s_add_u32 s4, s4, 12599296
    v_lshl_add_u32 v28, v2, 2, s4
    v_add_u32 v241, s74, v240
    v_cmp_eq_u32 vcc, 0, v2
    v_mov_b32 v196, 4136
    s_nop 0
    v_cndmask_b32 v196, v196, 30, vcc
    v_add_u32 v242, s74, v196
    v_bfe_u32 v196, v2, 3, 2
    v_mul_u32_u24 v196, 4160, v196
    v_and_b32 v197, 7, v2
    v_lshl_add_u32 v196, v197, 2, v196
    v_add_u32 v200, s74, v196
    v_mov_b32 v196, 0
    v_mov_b32 v197, 0
    v_mov_b32 v198, 0
    v_mov_b32 v199, 0
    ds_write_b32 v200, v196
    v_lshlrev_b32 v201, 4, v0
    ds_write_b128 v201, v[196:199]
    ds_write_b128 v201, v[196:199] offset:36864
    s_waitcnt vmcnt(7)
    ds_read_b128 v[212:215], v241 offset:32
    ds_read_b32 v216, v241 offset:48
    ds_read_b128 v[218:221], v241 offset:1056
    ds_read_b32 v222, v241 offset:1072
    ds_read_b128 v[224:227], v241 offset:2080
    ds_read_b32 v228, v241 offset:2096
    ds_read_b128 v[230:233], v241 offset:3104
    ds_read_b32 v234, v241 offset:3120
    v_lshrrev_b32 v202, 3, v2
    v_and_b32 v203, 7, v2
    v_lshrrev_b32 v204, 1, v202
    v_xor_b32 v203, v203, v204
    v_mul_u32_u24 v202, 11264, v202
    v_lshl_add_u32 v15, v203, 4, v202
    v_xor_b32 v16, 64, v15
    v_and_b32 v202, 15, v2
    v_add_u32 v202, 1, v202
    v_and_b32 v203, 1, v202
    v_mul_u32_u24 v203, 4160, v203
    v_lshrrev_b32 v202, 1, v202
    v_lshl_add_u32 v203, v202, 2, v203
    v_lshrrev_b32 v204, 4, v2
    v_lshl_add_u32 v203, v204, 4, v203
    v_add_u32 v236, s74, v203
    v_add_u32 v237, 1024, v236
    v_add_u32 v238, 1024, v237
    v_add_u32 v239, 1024, v238
    s_waitcnt lgkmcnt(0)
    s_waitcnt vmcnt(0)
    v_lshlrev_b32 v9, 16, v9
    v_lshlrev_b32 v208, 16, v212
    v_add_f32 v9, v9, v208
    v_cvt_pk_bf16_f32 v9, v9, v9
    ds_write_b16 v242, v9 offset:4160
    ds_write_b16 v242, v9 offset:2
    v_alignbit_b32 v212, v213, v212, 16
    v_alignbit_b32 v213, v214, v213, 16
    v_alignbit_b32 v214, v215, v214, 16
    v_alignbit_b32 v215, v216, v215, 16
    ds_write_b128 v241, v[212:215] offset:4192
    v_alignbit_b32 v218, v219, v218, 16
    v_alignbit_b32 v219, v220, v219, 16
    v_alignbit_b32 v220, v221, v220, 16
    v_alignbit_b32 v221, v222, v221, 16
    ds_write_b128 v241, v[218:221] offset:5216
    v_alignbit_b32 v224, v225, v224, 16
    v_alignbit_b32 v225, v226, v225, 16
    v_alignbit_b32 v226, v227, v226, 16
    v_alignbit_b32 v227, v228, v227, 16
    ds_write_b128 v241, v[224:227] offset:6240
    v_alignbit_b32 v230, v231, v230, 16
    v_alignbit_b32 v231, v232, v231, 16
    v_alignbit_b32 v232, v233, v232, 16
    v_alignbit_b32 v233, v234, v233, 16
    ds_write_b128 v241, v[230:233] offset:7264
    v_and_b32 v202, 15, v2
    v_lshlrev_b32 v202, 1, v202
    v_sub_u32 v202, v202, v204
    v_add_u32 v202, 17, v202
    v_bfe_u32 v203, v202, 1, 3
    v_xor_b32 v203, s3, v203
    v_lshlrev_b32 v203, 4, v203
    v_lshl_add_u32 v244, v202, 7, v203
    v_and_b32 v202, 15, v2
    v_lshlrev_b32 v202, 1, v202
    v_sub_u32 v202, v202, v204
    v_add_u32 v202, 13, v202
    v_bfe_u32 v203, v202, 1, 3
    v_xor_b32 v203, s3, v203
    v_lshlrev_b32 v203, 4, v203
    v_lshl_add_u32 v245, v202, 7, v203
    v_and_b32 v202, 15, v2
    v_lshlrev_b32 v202, 1, v202
    v_sub_u32 v202, v202, v204
    v_add_u32 v202, 9, v202
    v_bfe_u32 v203, v202, 1, 3
    v_xor_b32 v203, s3, v203
    v_lshlrev_b32 v203, 4, v203
    v_lshl_add_u32 v246, v202, 7, v203
    v_and_b32 v202, 15, v2
    v_lshlrev_b32 v202, 1, v202
    v_sub_u32 v202, v202, v204
    v_add_u32 v202, 5, v202
    v_bfe_u32 v203, v202, 1, 3
    v_xor_b32 v203, s3, v203
    v_lshlrev_b32 v203, 4, v203
    v_lshl_add_u32 v247, v202, 7, v203
    v_and_b32 v202, 15, v2
    v_lshlrev_b32 v202, 5, v202
    v_lshl_add_u32 v8, v204, 3, v202
    s_mul_i32 s7, s3, 589824
    s_lshl_b32 s8, s69, 8
    s_add_u32 s7, s7, s8
    s_add_u32 s10, s7, 2359296
    s_lshl_b32 s9, s3, 13
    s_add_u32 s9, s9, 4096
    s_lshl1_add_u32 s4, s69, 0
    s_mul_i32 s5, s4, 9363
    s_lshr_b32 s5, s5, 16
    s_mul_i32 s7, s5, 7
    s_sub_u32 s7, s4, s7
    s_cmp_gt_u32 s7, 2
    s_addc_u32 s4, s4, s5
    s_lshl_b32 s4, s4, 7
    s_mul_i32 s7, s3, 720896
    s_add_u32 s4, s4, s7
    s_add_u32 s10, s4, 39469056
    s_lshl1_add_u32 s4, s69, 1
    s_mul_i32 s5, s4, 9363
    s_lshr_b32 s5, s5, 16
    s_mul_i32 s7, s5, 7
    s_sub_u32 s7, s4, s7
    s_cmp_gt_u32 s7, 2
    s_addc_u32 s4, s4, s5
    s_lshl_b32 s4, s4, 7
    s_mul_i32 s7, s3, 720896
    s_add_u32 s4, s4, s7
    s_add_u32 s11, s4, 39469056
    ds_read2_b32 v[64:65], v236 offset0:0 offset1:1
    ds_read2_b32 v[66:67], v236 offset0:2 offset1:3
    ds_read2_b32 v[68:69], v236 offset0:128 offset1:129
    ds_read2_b32 v[70:71], v236 offset0:130 offset1:131
    ds_read2_b32 v[72:73], v237 offset0:0 offset1:1
    ds_read2_b32 v[74:75], v237 offset0:2 offset1:3
    ds_read2_b32 v[76:77], v237 offset0:128 offset1:129
    ds_read2_b32 v[78:79], v237 offset0:130 offset1:131
    ds_read2_b32 v[80:81], v238 offset0:0 offset1:1
    ds_read2_b32 v[82:83], v238 offset0:2 offset1:3
    ds_read2_b32 v[84:85], v238 offset0:128 offset1:129
    ds_read2_b32 v[86:87], v238 offset0:130 offset1:131
    ds_read2_b32 v[88:89], v239 offset0:0 offset1:1
    ds_read2_b32 v[90:91], v239 offset0:2 offset1:3
    ds_read2_b32 v[92:93], v239 offset0:128 offset1:129
    ds_read2_b32 v[94:95], v239 offset0:130 offset1:131
    v_mov_b32 v29, 0
    buffer_atomic_add v29, v28, s[44:47], 0 offen sc0 sc1
    s_waitcnt vmcnt(0)
    v_cmp_ne_u32 vcc, s68, v29
    s_cbranch_vccnz L_rs_p1X
L_ok_p1X:
    s_add_u32 m0, s9, 0
    s_add_u32 s13, s10, 0
    buffer_load_dwordx4 v15, s[44:47], s13 offen sc1 lds
    s_add_u32 m0, s9, 1024
    s_add_u32 s13, s10, 90112
    buffer_load_dwordx4 v16, s[44:47], s13 offen sc1 lds
    s_add_u32 m0, s9, 2048
    s_add_u32 s13, s10, 180224
L_pl_X_1:
    s_cbranch_execz L_pl_X_5
    buffer_load_dwordx4 v15, s[44:47], s13 offen sc1 lds
    s_add_u32 m0, s9, 3072
    s_add_u32 s13, s10, 270336
    buffer_load_dwordx4 v16, s[44:47], s13 offen sc1 lds
    s_add_u32 m0, s9, 4096
    s_add_u32 s13, s10, 360448
    buffer_load_dwordx4 v15, s[44:47], s13 offen sc1 lds
    s_add_u32 m0, s9, 5120
    s_add_u32 s13, s10, 450560
    buffer_load_dwordx4 v16, s[44:47], s13 offen sc1 lds
    s_add_u32 m0, s9, 6144
    s_add_u32 s13, s10, 540672
    buffer_load_dwordx4 v15, s[44:47], s13 offen sc1 lds
    s_add_u32 m0, s9, 7168
    s_add_u32 s13, s10, 630784
    buffer_load_dwordx4 v16, s[44:47], s13 offen sc1 lds
    s_mov_b64 exec, 0
    s_call_b64 s[82:83], L_wc_D
    s_mov_b64 exec, -1
    s_mov_b32 s60, s36
    s_and_b32 s61, s37, 0xffff
    s_mov_b32 s62, 4096
    s_mov_b32 s63, 0x20000
    v_and_b32 v24, 15, v2
    s_lshl_b32 s7, s71, 6
    v_add_u32 v24, s7, v24
    s_and_b32 s8, s3, 1
    s_lshl_b32 s4, s8, 5
    v_add_u32 v25, s4, v24
    v_lshlrev_b32 v26, 3, v25
    v_mul_u32_u24 v25, 1152, v25
    v_bfe_u32 v31, v2, 4, 1
    v_lshl_add_u32 v25, v31, 5, v25
    v_lshrrev_b32 v31, 5, v2
    v_lshl_add_u32 v25, v31, 4, v25
    s_bfe_u32 s7, s2, 0x20003
    s_mul_i32 s7, s7, 288
    s_bfe_u32 s5, s2, 0x10003
    s_mul_i32 s5, s5, 32
    s_lshl_b32 s4, s72, 6
    s_add_u32 s4, s4, s7
    s_add_u32 s4, s4, s5
    s_lshl_b32 s5, s5, 3
    s_sub_u32 s7, s7, s5
    v_add_u32 v252, s4, v25
    s_xor_b32 s8, s3, s72
    s_and_b32 s4, s72, 1
    s_lshl1_add_u32 s4, s4, s8
    v_lshl_add_u32 v24, s4, 4, v24
    s_add_u32 s7, s7, 256
    s_cmp_lt_u32 s8, 2
    s_cselect_b32 s7, s7, 0x40000000
    v_lshlrev_b32 v18, 3, v24
    v_mul_u32_u24 v24, 1152, v24
    v_lshrrev_b32 v31, 4, v2
    v_lshl_add_u32 v24, v31, 3, v24
    v_add_u32 v253, s7, v24
    v_lshrrev_b32 v24, 3, v2
    v_and_b32 v25, 7, v2
    v_bfe_u32 v31, v2, 4, 2
    v_lshlrev_b32 v31, 1, v31
    v_xor_b32 v25, v25, v31
    v_lshlrev_b32 v24, 12, v24
    v_lshl_add_u32 v24, v25, 4, v24
    s_mul_i32 s7, s72, 36
    s_bitcmp1_b32 s3, 0
    s_addc_u32 s7, s7, 0
    s_lshl_b32 s7, s7, 17
    s_lshl_b32 s8, s71, 7
    s_add_u32 s7, s7, s8
    v_add_u32 v4, s7, v24
    v_add_u32 v5, 31744, v4
    v_add_u32 v6, 31744, v5
    v_add_u32 v7, 31744, v6
    v_lshrrev_b32 v24, 2, v2
    v_lshlrev_b32 v24, 7, v24
    v_and_b32 v25, 3, v2
    v_lshl_add_u32 v24, v25, 3, v24
    s_and_b32 s7, s73, 8192
    v_add_u32 v24, s7, v24
    v_bfe_u32 v31, v2, 3, 2
    s_and_b32 s7, s3, 1
    s_lshl_b32 s7, s7, 1
    v_xor_b32 v31, s7, v31
    v_lshl_add_u32 v10, v31, 5, v24
    v_xor_b32 v11, 32, v10
    v_and_b32 v24, 15, v2
    v_lshrrev_b32 v25, 4, v2
    v_mul_u32_u24 v25, 17408, v25
    v_lshl_add_u32 v24, v24, 4, v25
    s_mul_i32 s7, s72, 36
    s_and_b32 s8, s3, 1
    s_add_u32 s7, s7, s8
    s_mul_i32 s7, s7, 69632
    s_bfe_u32 s8, s2, 0x20003
    s_lshl_b32 s8, s8, 12
    s_add_u32 s7, s7, s8
    s_add_u32 s7, s7, 12795904
    v_add_u32 v23, s7, v24
    s_xor_b32 s7, s72, 0
    v_lshl_add_u32 v19, s7, 10, v23
    s_xor_b32 s7, s72, 1
    v_lshl_add_u32 v20, s7, 10, v23
    s_xor_b32 s7, s72, 2
    v_lshl_add_u32 v21, s7, 10, v23
    s_xor_b32 s7, s72, 3
    v_lshl_add_u32 v22, s7, 10, v23
    v_lshlrev_b32 v14, 4, v2
    v_add_u32 v14, 98304, v14
    v_add_u32 v1, 0x10000, v14
    s_bitcmp1_b32 s3, 1
    s_cselect_b32 s18, s85, s84
    s_mul_i32 s18, s18, 139264
    s_cselect_b32 s19, s87, s86
    s_mul_i32 s19, s19, 139264
    s_cselect_b32 s20, s89, s88
    s_mul_i32 s20, s20, 139264
    s_cselect_b32 s21, s91, s90
    s_mul_i32 s21, s21, 139264
    s_cselect_b32 s22, s93, s92
    s_mul_i32 s22, s22, 139264
    s_cselect_b32 s23, s95, s94
    s_mul_i32 s23, s23, 139264
    s_cselect_b32 s24, s97, s96
    s_mul_i32 s24, s24, 139264
    s_cselect_b32 s25, s99, s98
    s_mul_i32 s25, s25, 139264
    s_cselect_b32 s26, s101, s100
    s_mul_i32 s26, s26, 139264
    v_add_u32 v10, 131072, v10
    v_add_u32 v11, 131072, v11
    s_waitcnt vmcnt(0) lgkmcnt(0)
    s_barrier
    ds_read_b128 v[96:99], v244 offset:2048
    ds_read_b128 v[100:103], v244 offset:6144
    ds_read_b128 v[104:107], v244 offset:10240
    ds_read_b128 v[108:111], v244 offset:14336
    ds_read_b128 v[112:115], v244 offset:18432
    ds_read_b128 v[116:119], v244 offset:22528
    ds_read_b128 v[120:123], v244 offset:26624
    ds_read_b128 v[124:127], v244 offset:30720
    s_waitcnt lgkmcnt(0)
    v_mfma_f32_16x16x32_bf16 v[32:35], v[64:67], v[96:99], 0
    s_lshl_b32 s14, s84, 18
    ds_read_b128 v[160:163], v245 offset:2048
    v_mfma_f32_16x16x32_bf16 v[36:39], v[68:71], v[96:99], 0
    s_add_u32 m0, s73, 147456
    v_mfma_f32_16x16x32_bf16 v[36:39], v[64:67], v[100:103], v[36:39]
    buffer_load_dwordx4 v4, s[52:55], s14 offen offset:0 lds
    ds_read2_b32 v[128:129], v236 offset0:16 offset1:17
    v_mfma_f32_16x16x32_bf16 v[40:43], v[64:67], v[104:107], 0
    ds_read2_b32 v[130:131], v236 offset0:18 offset1:19
    v_mfma_f32_16x16x32_bf16 v[40:43], v[68:71], v[100:103], v[40:43]
    v_mfma_f32_16x16x32_bf16 v[40:43], v[72:75], v[96:99], v[40:43]
    ds_read_b128 v[164:167], v245 offset:6144
    v_mfma_f32_16x16x32_bf16 v[44:47], v[76:79], v[96:99], 0
    ds_read2_b32 v[132:133], v236 offset0:144 offset1:145
    v_mfma_f32_16x16x32_bf16 v[44:47], v[72:75], v[100:103], v[44:47]
    v_mfma_f32_16x16x32_bf16 v[44:47], v[68:71], v[104:107], v[44:47]
    s_add_u32 m0, s73, 147456
    ds_read2_b32 v[134:135], v236 offset0:146 offset1:147
    v_mfma_f32_16x16x32_bf16 v[44:47], v[64:67], v[108:111], v[44:47]
    buffer_load_dwordx4 v5, s[52:55], s14 offen offset:1024 lds
    ds_read_b128 v[168:171], v245 offset:10240
    v_mfma_f32_16x16x32_bf16 v[48:51], v[64:67], v[112:115], 0
    ds_read2_b32 v[136:137], v237 offset0:16 offset1:17
    v_mfma_f32_16x16x32_bf16 v[48:51], v[68:71], v[108:111], v[48:51]
    v_mfma_f32_16x16x32_bf16 v[48:51], v[72:75], v[104:107], v[48:51]
    ds_read2_b32 v[138:139], v237 offset0:18 offset1:19
    v_mfma_f32_16x16x32_bf16 v[48:51], v[76:79], v[100:103], v[48:51]
    ds_read_b128 v[172:175], v245 offset:14336
    v_mfma_f32_16x16x32_bf16 v[48:51], v[80:83], v[96:99], v[48:51]
    v_mfma_f32_16x16x32_bf16 v[52:55], v[84:87], v[96:99], 0
    s_add_u32 m0, s73, 147456
    ds_read2_b32 v[140:141], v237 offset0:144 offset1:145
    v_mfma_f32_16x16x32_bf16 v[52:55], v[80:83], v[100:103], v[52:55]
    buffer_load_dwordx4 v6, s[52:55], s14 offen offset:2048 lds
    ds_read2_b32 v[142:143], v237 offset0:146 offset1:147
    v_mfma_f32_16x16x32_bf16 v[52:55], v[76:79], v[104:107], v[52:55]
    v_mfma_f32_16x16x32_bf16 v[52:55], v[72:75], v[108:111], v[52:55]
    ds_read_b128 v[176:179], v245 offset:18432
    v_mfma_f32_16x16x32_bf16 v[52:55], v[68:71], v[112:115], v[52:55]
    ds_read2_b32 v[144:145], v238 offset0:16 offset1:17
    v_mfma_f32_16x16x32_bf16 v[52:55], v[64:67], v[116:119], v[52:55]
    v_mfma_f32_16x16x32_bf16 v[56:59], v[64:67], v[120:123], 0
    ds_read2_b32 v[146:147], v238 offset0:18 offset1:19
    v_mfma_f32_16x16x32_bf16 v[56:59], v[68:71], v[116:119], v[56:59]
    s_add_u32 m0, s73, 147456
    ds_read_b128 v[180:183], v245 offset:22528
    v_mfma_f32_16x16x32_bf16 v[56:59], v[72:75], v[112:115], v[56:59]
    buffer_load_dwordx4 v7, s[52:55], s14 offen offset:3072 lds
    v_mfma_f32_16x16x32_bf16 v[56:59], v[76:79], v[108:111], v[56:59]
    ds_read2_b32 v[148:149], v238 offset0:144 offset1:145
    v_mfma_f32_16x16x32_bf16 v[56:59], v[80:83], v[104:107], v[56:59]
    ds_read2_b32 v[150:151], v238 offset0:146 offset1:147
    v_mfma_f32_16x16x32_bf16 v[56:59], v[84:87], v[100:103], v[56:59]
    ds_read_b128 v[184:187], v245 offset:26624
    v_mfma_f32_16x16x32_bf16 v[56:59], v[88:91], v[96:99], v[56:59]
    v_mfma_f32_16x16x32_bf16 v[60:63], v[92:95], v[96:99], 0
    ds_read2_b32 v[152:153], v239 offset0:16 offset1:17
    v_mfma_f32_16x16x32_bf16 v[60:63], v[88:91], v[100:103], v[60:63]
    ds_read2_b32 v[154:155], v239 offset0:18 offset1:19
    v_mfma_f32_16x16x32_bf16 v[60:63], v[84:87], v[104:107], v[60:63]
    v_mfma_f32_16x16x32_bf16 v[60:63], v[80:83], v[108:111], v[60:63]
    ds_read_b128 v[188:191], v245 offset:30720
    v_mfma_f32_16x16x32_bf16 v[60:63], v[76:79], v[112:115], v[60:63]
    ds_read2_b32 v[156:157], v239 offset0:144 offset1:145
    v_mfma_f32_16x16x32_bf16 v[60:63], v[72:75], v[116:119], v[60:63]
    v_mfma_f32_16x16x32_bf16 v[60:63], v[68:71], v[120:123], v[60:63]
    ds_read2_b32 v[158:159], v239 offset0:146 offset1:147
    v_mfma_f32_16x16x32_bf16 v[60:63], v[64:67], v[124:127], v[60:63]
    s_waitcnt lgkmcnt(12)
    v_mfma_f32_16x16x32_bf16 v[32:35], v[128:131], v[160:163], v[32:35]
    ds_read_b128 v[96:99], v246 offset:2048
    v_mfma_f32_16x16x32_bf16 v[36:39], v[132:135], v[160:163], v[36:39]
    v_mfma_f32_16x16x32_bf16 v[36:39], v[128:131], v[164:167], v[36:39]
    ds_read2_b32 v[64:65], v236 offset0:32 offset1:33
    v_mfma_f32_16x16x32_bf16 v[40:43], v[128:131], v[168:171], v[40:43]
    ds_read2_b32 v[66:67], v236 offset0:34 offset1:35
    v_mfma_f32_16x16x32_bf16 v[40:43], v[132:135], v[164:167], v[40:43]
    v_mfma_f32_16x16x32_bf16 v[40:43], v[136:139], v[160:163], v[40:43]
    ds_read_b128 v[100:103], v246 offset:6144
    v_mfma_f32_16x16x32_bf16 v[44:47], v[140:143], v[160:163], v[44:47]
    ds_read2_b32 v[68:69], v236 offset0:160 offset1:161
    v_mfma_f32_16x16x32_bf16 v[44:47], v[136:139], v[164:167], v[44:47]
    v_mfma_f32_16x16x32_bf16 v[44:47], v[132:135], v[168:171], v[44:47]
    ds_read2_b32 v[70:71], v236 offset0:162 offset1:163
    v_mfma_f32_16x16x32_bf16 v[44:47], v[128:131], v[172:175], v[44:47]
    ds_read_b128 v[104:107], v246 offset:10240
    s_waitcnt lgkmcnt(7)
    v_mfma_f32_16x16x32_bf16 v[48:51], v[128:131], v[176:179], v[48:51]
    s_lshl_b32 s14, s85, 18
    ds_read2_b32 v[72:73], v237 offset0:32 offset1:33
    v_mfma_f32_16x16x32_bf16 v[48:51], v[132:135], v[172:175], v[48:51]
    s_add_u32 m0, s73, 49152
    ds_read2_b32 v[74:75], v237 offset0:34 offset1:35
    v_mfma_f32_16x16x32_bf16 v[48:51], v[136:139], v[168:171], v[48:51]
    buffer_load_dwordx4 v4, s[52:55], s14 offen offset:0 lds
    v_mov_b32 v9, 8
    buffer_load_ushort v9, v9, s[56:59], s70 offen
    v_mfma_f32_16x16x32_bf16 v[48:51], v[140:143], v[164:167], v[48:51]
    ds_read_b128 v[108:111], v246 offset:14336
    v_mfma_f32_16x16x32_bf16 v[48:51], v[144:147], v[160:163], v[48:51]
    v_mfma_f32_16x16x32_bf16 v[52:55], v[148:151], v[160:163], v[52:55]
    ds_read2_b32 v[76:77], v237 offset0:160 offset1:161
    v_mfma_f32_16x16x32_bf16 v[52:55], v[144:147], v[164:167], v[52:55]
    ds_read2_b32 v[78:79], v237 offset0:162 offset1:163
    v_mfma_f32_16x16x32_bf16 v[52:55], v[140:143], v[168:171], v[52:55]
    v_mfma_f32_16x16x32_bf16 v[52:55], v[136:139], v[172:175], v[52:55]
    ds_read_b128 v[112:115], v246 offset:18432
    v_mfma_f32_16x16x32_bf16 v[52:55], v[132:135], v[176:179], v[52:55]
    s_add_u32 m0, s73, 49152
    ds_read2_b32 v[80:81], v238 offset0:32 offset1:33
    v_mfma_f32_16x16x32_bf16 v[52:55], v[128:131], v[180:183], v[52:55]
    buffer_load_dwordx4 v5, s[52:55], s14 offen offset:1024 lds
    v_mfma_f32_16x16x32_bf16 v[56:59], v[128:131], v[184:187], v[56:59]
    ds_read2_b32 v[82:83], v238 offset0:34 offset1:35
    v_mfma_f32_16x16x32_bf16 v[56:59], v[132:135], v[180:183], v[56:59]
    ds_read_b128 v[116:119], v246 offset:22528
    v_mfma_f32_16x16x32_bf16 v[56:59], v[136:139], v[176:179], v[56:59]
    v_mfma_f32_16x16x32_bf16 v[56:59], v[140:143], v[172:175], v[56:59]
    ds_read2_b32 v[84:85], v238 offset0:160 offset1:161
    v_mfma_f32_16x16x32_bf16 v[56:59], v[144:147], v[168:171], v[56:59]
    ds_read2_b32 v[86:87], v238 offset0:162 offset1:163
    v_mfma_f32_16x16x32_bf16 v[56:59], v[148:151], v[164:167], v[56:59]
    s_add_u32 m0, s73, 49152
    ds_read_b128 v[120:123], v246 offset:26624
    v_mfma_f32_16x16x32_bf16 v[56:59], v[152:155], v[160:163], v[56:59]
    buffer_load_dwordx4 v6, s[52:55], s14 offen offset:2048 lds
    v_mfma_f32_16x16x32_bf16 v[60:63], v[156:159], v[160:163], v[60:63]
    ds_read2_b32 v[88:89], v239 offset0:32 offset1:33
    v_mfma_f32_16x16x32_bf16 v[60:63], v[152:155], v[164:167], v[60:63]
    ds_read2_b32 v[90:91], v239 offset0:34 offset1:35
    v_mfma_f32_16x16x32_bf16 v[60:63], v[148:151], v[168:171], v[60:63]
    v_mfma_f32_16x16x32_bf16 v[60:63], v[144:147], v[172:175], v[60:63]
    ds_read_b128 v[124:127], v246 offset:30720
    v_mfma_f32_16x16x32_bf16 v[60:63], v[140:143], v[176:179], v[60:63]
    ds_read2_b32 v[92:93], v239 offset0:160 offset1:161
    v_mfma_f32_16x16x32_bf16 v[60:63], v[136:139], v[180:183], v[60:63]
    s_add_u32 m0, s73, 49152
    v_mfma_f32_16x16x32_bf16 v[60:63], v[132:135], v[184:187], v[60:63]
    buffer_load_dwordx4 v7, s[52:55], s14 offen offset:3072 lds
    ds_read2_b32 v[94:95], v239 offset0:162 offset1:163
    v_mfma_f32_16x16x32_bf16 v[60:63], v[128:131], v[188:191], v[60:63]
    s_waitcnt lgkmcnt(12)
    v_mfma_f32_16x16x32_bf16 v[32:35], v[64:67], v[96:99], v[32:35]
    ds_read_b128 v[160:163], v247 offset:2048
    v_mfma_f32_16x16x32_bf16 v[36:39], v[68:71], v[96:99], v[36:39]
    v_mfma_f32_16x16x32_bf16 v[36:39], v[64:67], v[100:103], v[36:39]
    ds_read2_b32 v[128:129], v236 offset0:48 offset1:49
    v_mfma_f32_16x16x32_bf16 v[40:43], v[64:67], v[104:107], v[40:43]
    ds_read2_b32 v[130:131], v236 offset0:50 offset1:51
    v_mfma_f32_16x16x32_bf16 v[40:43], v[68:71], v[100:103], v[40:43]
    v_mfma_f32_16x16x32_bf16 v[40:43], v[72:75], v[96:99], v[40:43]
    ds_read_b128 v[164:167], v247 offset:6144
    v_mfma_f32_16x16x32_bf16 v[44:47], v[76:79], v[96:99], v[44:47]
    ds_read2_b32 v[132:133], v236 offset0:176 offset1:177
    v_mfma_f32_16x16x32_bf16 v[44:47], v[72:75], v[100:103], v[44:47]
    v_mfma_f32_16x16x32_bf16 v[44:47], v[68:71], v[104:107], v[44:47]
    ds_read2_b32 v[134:135], v236 offset0:178 offset1:179
    v_mfma_f32_16x16x32_bf16 v[44:47], v[64:67], v[108:111], v[44:47]
    ds_read_b128 v[168:171], v247 offset:10240
    s_waitcnt lgkmcnt(7)
    v_mfma_f32_16x16x32_bf16 v[48:51], v[64:67], v[112:115], v[48:51]
    ds_read2_b32 v[136:137], v237 offset0:48 offset1:49
    v_mfma_f32_16x16x32_bf16 v[48:51], v[68:71], v[108:111], v[48:51]
    v_mfma_f32_16x16x32_bf16 v[48:51], v[72:75], v[104:107], v[48:51]
    ds_read2_b32 v[138:139], v237 offset0:50 offset1:51
    v_mfma_f32_16x16x32_bf16 v[48:51], v[76:79], v[100:103], v[48:51]
    ds_read_b128 v[172:175], v247 offset:14336
    v_mfma_f32_16x16x32_bf16 v[48:51], v[80:83], v[96:99], v[48:51]
    v_mfma_f32_16x16x32_bf16 v[52:55], v[84:87], v[96:99], v[52:55]
    ds_read2_b32 v[140:141], v237 offset0:176 offset1:177
    v_mfma_f32_16x16x32_bf16 v[52:55], v[80:83], v[100:103], v[52:55]
    ds_read2_b32 v[142:143], v237 offset0:178 offset1:179
    v_mfma_f32_16x16x32_bf16 v[52:55], v[76:79], v[104:107], v[52:55]
    v_mfma_f32_16x16x32_bf16 v[52:55], v[72:75], v[108:111], v[52:55]
    ds_read_b128 v[176:179], v247 offset:18432
    v_mfma_f32_16x16x32_bf16 v[52:55], v[68:71], v[112:115], v[52:55]
    ds_read2_b32 v[144:145], v238 offset0:48 offset1:49
    v_mfma_f32_16x16x32_bf16 v[52:55], v[64:67], v[116:119], v[52:55]
    v_mfma_f32_16x16x32_bf16 v[56:59], v[64:67], v[120:123], v[56:59]
    ds_read2_b32 v[146:147], v238 offset0:50 offset1:51
    v_mfma_f32_16x16x32_bf16 v[56:59], v[68:71], v[116:119], v[56:59]
    ds_read_b128 v[180:183], v247 offset:22528
    v_mfma_f32_16x16x32_bf16 v[56:59], v[72:75], v[112:115], v[56:59]
    v_mfma_f32_16x16x32_bf16 v[56:59], v[76:79], v[108:111], v[56:59]
    ds_read2_b32 v[148:149], v238 offset0:176 offset1:177
    v_mfma_f32_16x16x32_bf16 v[56:59], v[80:83], v[104:107], v[56:59]
    ds_read2_b32 v[150:151], v238 offset0:178 offset1:179
    v_mfma_f32_16x16x32_bf16 v[56:59], v[84:87], v[100:103], v[56:59]
    ds_read_b128 v[184:187], v247 offset:26624
    v_mfma_f32_16x16x32_bf16 v[56:59], v[88:91], v[96:99], v[56:59]
    v_mfma_f32_16x16x32_bf16 v[60:63], v[92:95], v[96:99], v[60:63]
    ds_read2_b32 v[152:153], v239 offset0:48 offset1:49
    v_mfma_f32_16x16x32_bf16 v[60:63], v[88:91], v[100:103], v[60:63]
    ds_read2_b32 v[154:155], v239 offset0:50 offset1:51
    v_mfma_f32_16x16x32_bf16 v[60:63], v[84:87], v[104:107], v[60:63]
    v_mfma_f32_16x16x32_bf16 v[60:63], v[80:83], v[108:111], v[60:63]
    ds_read_b128 v[188:191], v247 offset:30720
    v_mfma_f32_16x16x32_bf16 v[60:63], v[76:79], v[112:115], v[60:63]
    ds_read2_b32 v[156:157], v239 offset0:176 offset1:177
    v_mfma_f32_16x16x32_bf16 v[60:63], v[72:75], v[116:119], v[60:63]
    v_mfma_f32_16x16x32_bf16 v[60:63], v[68:71], v[120:123], v[60:63]
    ds_read2_b32 v[158:159], v239 offset0:178 offset1:179
    v_mfma_f32_16x16x32_bf16 v[60:63], v[64:67], v[124:127], v[60:63]
    s_waitcnt lgkmcnt(12)
    v_mfma_f32_16x16x32_bf16 v[32:35], v[128:131], v[160:163], v[32:35]
    ds_read_b128 v[96:99], v244 offset:0
    v_mfma_f32_16x16x32_bf16 v[36:39], v[132:135], v[160:163], v[36:39]
    v_mfma_f32_16x16x32_bf16 v[36:39], v[128:131], v[164:167], v[36:39]
    ds_read2_b32 v[64:65], v236 offset0:64 offset1:65
    v_mfma_f32_16x16x32_bf16 v[40:43], v[128:131], v[168:171], v[40:43]
    ds_read2_b32 v[66:67], v236 offset0:66 offset1:67
    v_mfma_f32_16x16x32_bf16 v[40:43], v[132:135], v[164:167], v[40:43]
    v_mfma_f32_16x16x32_bf16 v[40:43], v[136:139], v[160:163], v[40:43]
    ds_read_b128 v[100:103], v244 offset:4096
    v_mfma_f32_16x16x32_bf16 v[44:47], v[140:143], v[160:163], v[44:47]
    ds_read2_b32 v[68:69], v236 offset0:192 offset1:193
    v_mfma_f32_16x16x32_bf16 v[44:47], v[136:139], v[164:167], v[44:47]
    v_mfma_f32_16x16x32_bf16 v[44:47], v[132:135], v[168:171], v[44:47]
    ds_read2_b32 v[70:71], v236 offset0:194 offset1:195
    v_mfma_f32_16x16x32_bf16 v[44:47], v[128:131], v[172:175], v[44:47]
    ds_read_b128 v[104:107], v244 offset:8192
    s_waitcnt lgkmcnt(7)
    v_mfma_f32_16x16x32_bf16 v[48:51], v[128:131], v[176:179], v[48:51]
    ds_read2_b32 v[72:73], v237 offset0:64 offset1:65
    v_mfma_f32_16x16x32_bf16 v[48:51], v[132:135], v[172:175], v[48:51]
    ds_read2_b32 v[74:75], v237 offset0:66 offset1:67
    v_mfma_f32_16x16x32_bf16 v[48:51], v[136:139], v[168:171], v[48:51]
    ds_read_b128 v[108:111], v244 offset:12288
    v_mfma_f32_16x16x32_bf16 v[48:51], v[140:143], v[164:167], v[48:51]
    ds_read2_b32 v[76:77], v237 offset0:192 offset1:193
    v_mfma_f32_16x16x32_bf16 v[48:51], v[144:147], v[160:163], v[48:51]
    ds_read2_b32 v[78:79], v237 offset0:194 offset1:195
    s_waitcnt vmcnt(5)
    s_barrier
    v_mfma_f32_16x16x32_bf16 v[52:55], v[148:151], v[160:163], v[52:55]
    ds_read_b64_tr_b16 a[0:1], v10 offset:16384
    v_mfma_f32_16x16x32_bf16 v[52:55], v[144:147], v[164:167], v[52:55]
    ds_read_b128 v[112:115], v244 offset:16384
    v_mfma_f32_16x16x32_bf16 v[52:55], v[140:143], v[168:171], v[52:55]
    ds_read_b64_tr_b16 a[2:3], v10 offset:18432
    v_mfma_f32_16x16x32_bf16 v[52:55], v[136:139], v[172:175], v[52:55]
    ds_read_b64_tr_b16 a[8:9], v10 offset:20480
    v_mfma_f32_16x16x32_bf16 v[52:55], v[132:135], v[176:179], v[52:55]
    ds_read2_b32 v[80:81], v238 offset0:64 offset1:65
    v_mfma_f32_16x16x32_bf16 v[52:55], v[128:131], v[180:183], v[52:55]
    ds_read_b64_tr_b16 a[10:11], v10 offset:22528
    v_mfma_f32_16x16x32_bf16 v[56:59], v[128:131], v[184:187], v[56:59]
    ds_read_b64_tr_b16 a[4:5], v11 offset:16384
    v_mfma_f32_16x16x32_bf16 v[56:59], v[132:135], v[180:183], v[56:59]
    ds_read2_b32 v[82:83], v238 offset0:66 offset1:67
    v_mfma_f32_16x16x32_bf16 v[56:59], v[136:139], v[176:179], v[56:59]
    ds_read_b64_tr_b16 a[6:7], v11 offset:18432
    v_mfma_f32_16x16x32_bf16 v[56:59], v[140:143], v[172:175], v[56:59]
    ds_read_b64_tr_b16 a[12:13], v11 offset:20480
    v_mfma_f32_16x16x32_bf16 v[56:59], v[144:147], v[168:171], v[56:59]
    ds_read_b64_tr_b16 a[14:15], v11 offset:22528
    v_mfma_f32_16x16x32_bf16 v[56:59], v[148:151], v[164:167], v[56:59]
    ds_read_b128 v[116:119], v244 offset:20480
    v_mfma_f32_16x16x32_bf16 v[56:59], v[152:155], v[160:163], v[56:59]
    ds_read2_b32 v[84:85], v238 offset0:192 offset1:193
    v_mfma_f32_16x16x32_bf16 v[60:63], v[156:159], v[160:163], v[60:63]
    ds_read2_b32 v[86:87], v238 offset0:194 offset1:195
    s_waitcnt lgkmcnt(3)
    s_barrier
    v_mfma_f32_16x16x32_bf16 v[60:63], v[152:155], v[164:167], v[60:63]
    ds_read_b128 v[120:123], v244 offset:24576
    v_mfma_f32_16x16x32_bf16 v[60:63], v[148:151], v[168:171], v[60:63]
    ds_read2_b32 v[88:89], v239 offset0:64 offset1:65
    v_mfma_f32_16x16x32_bf16 v[60:63], v[144:147], v[172:175], v[60:63]
    ds_read2_b32 v[90:91], v239 offset0:66 offset1:67
    v_mfma_f32_16x16x32_bf16 v[60:63], v[140:143], v[176:179], v[60:63]
    s_lshl_b32 s14, s86, 18
    ds_read_b128 v[124:127], v244 offset:28672
    v_mfma_f32_16x16x32_bf16 v[60:63], v[136:139], v[180:183], v[60:63]
    s_add_u32 m0, s73, 147456
    ds_read2_b32 v[92:93], v239 offset0:192 offset1:193
    v_mfma_f32_16x16x32_bf16 v[60:63], v[132:135], v[184:187], v[60:63]
    buffer_load_dwordx4 v4, s[52:55], s14 offen offset:0 lds
    ds_read2_b32 v[94:95], v239 offset0:194 offset1:195
    v_mfma_f32_16x16x32_bf16 v[60:63], v[128:131], v[188:191], v[60:63]
    v_mfma_f32_16x16x32_bf16 v[32:35], v[64:67], v[96:99], v[32:35]
    ds_read_b128 v[160:163], v245 offset:0
    v_mfma_f32_16x16x32_bf16 v[36:39], v[68:71], v[96:99], v[36:39]
    ds_read2_b32 v[128:129], v236 offset0:80 offset1:81
    v_mfma_f32_16x16x32_bf16 v[36:39], v[64:67], v[100:103], v[36:39]
    ds_read2_b32 v[130:131], v236 offset0:82 offset1:83
    v_mfma_f32_16x16x32_bf16 v[40:43], v[64:67], v[104:107], v[40:43]
    ds_read_b128 v[164:167], v245 offset:4096
    v_mfma_f32_16x16x32_bf16 v[40:43], v[68:71], v[100:103], v[40:43]
    s_add_u32 m0, s73, 147456
    ds_read2_b32 v[132:133], v236 offset0:208 offset1:209
    v_mfma_f32_16x16x32_bf16 v[40:43], v[72:75], v[96:99], v[40:43]
    buffer_load_dwordx4 v5, s[52:55], s14 offen offset:1024 lds
    ds_read2_b32 v[134:135], v236 offset0:210 offset1:211
    v_mfma_f32_16x16x32_bf16 v[44:47], v[76:79], v[96:99], v[44:47]
    ds_read_b128 v[168:171], v245 offset:8192
    v_mfma_f32_16x16x32_bf16 v[44:47], v[72:75], v[100:103], v[44:47]
    ds_read2_b32 v[136:137], v237 offset0:80 offset1:81
    v_mfma_f32_16x16x32_bf16 v[44:47], v[68:71], v[104:107], v[44:47]
    ds_read2_b32 v[138:139], v237 offset0:82 offset1:83
    v_mfma_f32_16x16x32_bf16 v[44:47], v[64:67], v[108:111], v[44:47]
    ds_read_b128 v[172:175], v245 offset:12288
    s_waitcnt lgkmcnt(10)
    v_mfma_f32_16x16x32_bf16 v[48:51], v[64:67], v[112:115], v[48:51]
    ds_read2_b32 v[140:141], v237 offset0:208 offset1:209
    v_mfma_f32_16x16x32_bf16 v[48:51], v[68:71], v[108:111], v[48:51]
    s_add_u32 m0, s73, 147456
    ds_read2_b32 v[142:143], v237 offset0:210 offset1:211
    v_mfma_f32_16x16x32_bf16 v[48:51], v[72:75], v[104:107], v[48:51]
    buffer_load_dwordx4 v6, s[52:55], s14 offen offset:2048 lds
    ds_read_b128 v[176:179], v245 offset:16384
    v_mfma_f32_16x16x32_bf16 v[48:51], v[76:79], v[100:103], v[48:51]
    ds_read2_b32 v[144:145], v238 offset0:80 offset1:81
    v_mfma_f32_16x16x32_bf16 v[48:51], v[80:83], v[96:99], v[48:51]
    ds_read2_b32 v[146:147], v238 offset0:82 offset1:83
    v_mfma_f32_16x16x32_bf16 v[52:55], v[84:87], v[96:99], v[52:55]
    ds_read_b128 v[180:183], v245 offset:20480
    v_mfma_f32_16x16x32_bf16 v[52:55], v[80:83], v[100:103], v[52:55]
    ds_read2_b32 v[148:149], v238 offset0:208 offset1:209
    v_mfma_f32_16x16x32_bf16 v[52:55], v[76:79], v[104:107], v[52:55]
    ds_read2_b32 v[150:151], v238 offset0:210 offset1:211
    v_mfma_f32_16x16x32_bf16 v[52:55], v[72:75], v[108:111], v[52:55]
    ds_read_b128 v[184:187], v245 offset:24576
    v_mfma_f32_16x16x32_bf16 v[52:55], v[68:71], v[112:115], v[52:55]
    s_add_u32 m0, s73, 147456
    ds_read_b128 v[212:215], v241 offset:8352
    v_mfma_f32_16x16x32_bf16 v[52:55], v[64:67], v[116:119], v[52:55]
    buffer_load_dwordx4 v7, s[52:55], s14 offen offset:3072 lds
    ds_read2_b32 v[152:153], v239 offset0:80 offset1:81
    v_mfma_f32_16x16x32_bf16 v[56:59], v[64:67], v[120:123], v[56:59]
    ds_read_b32 v216, v241 offset:8368
    v_mfma_f32_16x16x32_bf16 v[56:59], v[68:71], v[116:119], v[56:59]
    ds_read2_b32 v[154:155], v239 offset0:82 offset1:83
    v_mfma_f32_16x16x32_bf16 v[56:59], v[72:75], v[112:115], v[56:59]
    ds_read_b128 v[218:221], v241 offset:9376
    v_mfma_f32_16x16x32_bf16 v[56:59], v[76:79], v[108:111], v[56:59]
    ds_read_b32 v222, v241 offset:9392
    v_mfma_f32_16x16x32_bf16 v[56:59], v[80:83], v[104:107], v[56:59]
    ds_read_b128 v[224:227], v241 offset:10400
    s_waitcnt vmcnt(4)
    s_barrier
    v_mfma_f32_16x16x32_bf16 v[56:59], v[84:87], v[100:103], v[56:59]
    ds_read_b32 v228, v241 offset:10416
    v_add_u32 v10, -131072, v10
    v_mfma_f32_16x16x32_bf16 v[56:59], v[88:91], v[96:99], v[56:59]
    ds_read_b64_tr_b16 a[16:17], v10 offset:49152
    v_mfma_f32_16x16x32_bf16 v[60:63], v[92:95], v[96:99], v[60:63]
    ds_read_b64_tr_b16 a[18:19], v10 offset:51200
    v_mfma_f32_16x16x32_bf16 v[60:63], v[88:91], v[100:103], v[60:63]
    ds_read_b64_tr_b16 a[24:25], v10 offset:53248
    v_mfma_f32_16x16x32_bf16 v[60:63], v[84:87], v[104:107], v[60:63]
    ds_read_b128 v[230:233], v241 offset:11424
    v_mfma_f32_16x16x32_bf16 v[60:63], v[80:83], v[108:111], v[60:63]
    ds_read_b64_tr_b16 a[26:27], v10 offset:55296
    ds_read_b128 v[188:191], v245 offset:28672
    v_mfma_f32_16x16x32_bf16 v[60:63], v[76:79], v[112:115], v[60:63]
    ds_read_b32 v234, v241 offset:11440
    v_add_u32 v11, -131072, v11
    v_mfma_f32_16x16x32_bf16 v[60:63], v[72:75], v[116:119], v[60:63]
    ds_read_b64_tr_b16 a[20:21], v11 offset:49152
    ds_read2_b32 v[156:157], v239 offset0:208 offset1:209
    v_mfma_f32_16x16x32_bf16 v[60:63], v[68:71], v[120:123], v[60:63]
    ds_read_b64_tr_b16 a[22:23], v11 offset:51200
    ds_read2_b32 v[158:159], v239 offset0:210 offset1:211
    v_mfma_f32_16x16x32_bf16 v[60:63], v[64:67], v[124:127], v[60:63]
    ds_read_b64_tr_b16 a[28:29], v11 offset:53248
    s_waitcnt lgkmcnt(15)
    v_mfma_f32_16x16x32_bf16 v[32:35], v[128:131], v[160:163], v[32:35]
    ds_read_b64_tr_b16 a[30:31], v11 offset:55296
    v_mfma_f32_16x16x32_bf16 v[36:39], v[132:135], v[160:163], v[36:39]
    ds_read_b128 v[96:99], v246 offset:0
    v_mfma_f32_16x16x32_bf16 v[36:39], v[128:131], v[164:167], v[36:39]
    ds_read2_b32 v[64:65], v236 offset0:96 offset1:97
    v_mfma_f32_16x16x32_bf16 v[40:43], v[128:131], v[168:171], v[40:43]
    ds_read2_b32 v[66:67], v236 offset0:98 offset1:99
    s_waitcnt lgkmcnt(3)
    s_barrier
    v_mfma_f32_16x16x32_bf16 v[40:43], v[132:135], v[164:167], v[40:43]
    v_mfma_f32_16x16x32_bf16 v[40:43], v[136:139], v[160:163], v[40:43]
    ds_read_b128 v[100:103], v246 offset:4096
    v_mfma_f32_16x16x32_bf16 v[44:47], v[140:143], v[160:163], v[44:47]
    ds_read2_b32 v[68:69], v236 offset0:224 offset1:225
    v_mfma_f32_16x16x32_bf16 v[44:47], v[136:139], v[164:167], v[44:47]
    s_lshl_b32 s14, s87, 18
    v_mfma_f32_16x16x32_bf16 v[44:47], v[132:135], v[168:171], v[44:47]
    ds_read2_b32 v[70:71], v236 offset0:226 offset1:227
    s_add_u32 m0, s73, 49152
    v_lshlrev_b32 v9, 16, v9
    v_mfma_f32_16x16x32_bf16 v[44:47], v[128:131], v[172:175], v[44:47]
    buffer_load_dwordx4 v4, s[52:55], s14 offen offset:0 lds
    ds_read_b128 v[104:107], v246 offset:8192
    v_mfma_f32_16x16x32_bf16 v[48:51], v[128:131], v[176:179], v[48:51]
    ds_read2_b32 v[72:73], v237 offset0:96 offset1:97
    v_lshlrev_b32 v208, 16, v212
    v_mfma_f32_16x16x32_bf16 v[48:51], v[132:135], v[172:175], v[48:51]
    v_mfma_f32_16x16x32_bf16 v[48:51], v[136:139], v[168:171], v[48:51]
    ds_read2_b32 v[74:75], v237 offset0:98 offset1:99
    v_add_f32 v9, v9, v208
    v_mfma_f32_16x16x32_bf16 v[48:51], v[140:143], v[164:167], v[48:51]
    ds_read_b128 v[108:111], v246 offset:12288
    v_cvt_pk_bf16_f32 v9, v9, v9
    v_mfma_f32_16x16x32_bf16 v[48:51], v[144:147], v[160:163], v[48:51]
    ds_write_b16 v242, v9 offset:12480
    v_mfma_f32_16x16x32_bf16 v[52:55], v[148:151], v[160:163], v[52:55]
    s_add_u32 m0, s73, 49152
    ds_read2_b32 v[76:77], v237 offset0:224 offset1:225
    v_mfma_f32_16x16x32_bf16 v[52:55], v[144:147], v[164:167], v[52:55]
    buffer_load_dwordx4 v5, s[52:55], s14 offen offset:1024 lds
    ds_read2_b32 v[78:79], v237 offset0:226 offset1:227
    v_mfma_f32_16x16x32_bf16 v[52:55], v[140:143], v[168:171], v[52:55]
    ds_write_b16 v242, v9 offset:8322
    v_mfma_f32_16x16x32_bf16 v[52:55], v[136:139], v[172:175], v[52:55]
    ds_read_b128 v[112:115], v246 offset:16384
    v_mfma_f32_16x16x32_bf16 v[52:55], v[132:135], v[176:179], v[52:55]
    ds_read2_b32 v[80:81], v238 offset0:96 offset1:97
    v_alignbit_b32 v212, v213, v212, 16
    v_mfma_f32_16x16x32_bf16 v[52:55], v[128:131], v[180:183], v[52:55]
L_pl_X_2:
    s_cbranch_execz L_pl_X_6
    v_alignbit_b32 v213, v214, v213, 16
    v_mfma_f32_16x16x32_bf16 v[56:59], v[128:131], v[184:187], v[56:59]
    ds_read2_b32 v[82:83], v238 offset0:98 offset1:99
    v_mfma_f32_16x16x32_bf16 v[56:59], v[132:135], v[180:183], v[56:59]
    ds_read_b128 v[116:119], v246 offset:20480
    s_add_u32 m0, s73, 49152
    v_alignbit_b32 v214, v215, v214, 16
    v_mfma_f32_16x16x32_bf16 v[56:59], v[136:139], v[176:179], v[56:59]
    buffer_load_dwordx4 v6, s[52:55], s14 offen offset:2048 lds
    v_mfma_f32_16x16x32_bf16 v[56:59], v[140:143], v[172:175], v[56:59]
    ds_read2_b32 v[84:85], v238 offset0:224 offset1:225
    v_alignbit_b32 v215, v216, v215, 16
    v_mfma_f32_16x16x32_bf16 v[56:59], v[144:147], v[168:171], v[56:59]
    ds_read2_b32 v[86:87], v238 offset0:226 offset1:227
    v_mfma_f32_16x16x32_bf16 v[56:59], v[148:151], v[164:167], v[56:59]
    ds_write_b128 v241, v[212:215] offset:12512
    v_mfma_f32_16x16x32_bf16 v[56:59], v[152:155], v[160:163], v[56:59]
    ds_read_b128 v[120:123], v246 offset:24576
    v_mfma_f32_16x16x32_bf16 v[60:63], v[156:159], v[160:163], v[60:63]
    ds_read2_b32 v[88:89], v239 offset0:96 offset1:97
    v_alignbit_b32 v218, v219, v218, 16
    v_mfma_f32_16x16x32_bf16 v[60:63], v[152:155], v[164:167], v[60:63]
    ds_read2_b32 v[90:91], v239 offset0:98 offset1:99
    s_add_u32 m0, s73, 49152
    v_alignbit_b32 v219, v220, v219, 16
    v_mfma_f32_16x16x32_bf16 v[60:63], v[148:151], v[168:171], v[60:63]
    buffer_load_dwordx4 v7, s[52:55], s14 offen offset:3072 lds
    v_mfma_f32_16x16x32_bf16 v[60:63], v[144:147], v[172:175], v[60:63]
    ds_read_b128 v[124:127], v246 offset:28672
    v_alignbit_b32 v220, v221, v220, 16
    v_mfma_f32_16x16x32_bf16 v[60:63], v[140:143], v[176:179], v[60:63]
    ds_read2_b32 v[92:93], v239 offset0:224 offset1:225
    v_mfma_f32_16x16x32_bf16 v[60:63], v[136:139], v[180:183], v[60:63]
    ds_read2_b32 v[94:95], v239 offset0:226 offset1:227
    v_alignbit_b32 v221, v222, v221, 16
    v_mfma_f32_16x16x32_bf16 v[60:63], v[132:135], v[184:187], v[60:63]
    ds_write_b128 v241, v[218:221] offset:13536
    v_mfma_f32_16x16x32_bf16 v[60:63], v[128:131], v[188:191], v[60:63]
    s_waitcnt lgkmcnt(15)
    v_mfma_f32_16x16x32_bf16 v[32:35], v[64:67], v[96:99], v[32:35]
    ds_read_b128 v[160:163], v247 offset:0
    v_mfma_f32_16x16x32_bf16 v[36:39], v[68:71], v[96:99], v[36:39]
    v_alignbit_b32 v224, v225, v224, 16
    v_mfma_f32_16x16x32_bf16 v[36:39], v[64:67], v[100:103], v[36:39]
    ds_read_b128 v[164:167], v247 offset:4096
    v_mfma_f32_16x16x32_bf16 v[40:43], v[64:67], v[104:107], v[40:43]
    ds_read_b128 v[168:171], v247 offset:8192
    v_mfma_f32_16x16x32_bf16 v[40:43], v[68:71], v[100:103], v[40:43]
    ds_read_b128 v[172:175], v247 offset:12288
    v_mfma_f32_16x16x32_bf16 v[40:43], v[72:75], v[96:99], v[40:43]
    v_alignbit_b32 v225, v226, v225, 16
    v_mfma_f32_16x16x32_bf16 v[44:47], v[76:79], v[96:99], v[44:47]
    ds_read_b128 v[176:179], v247 offset:16384
    v_mfma_f32_16x16x32_bf16 v[44:47], v[72:75], v[100:103], v[44:47]
    ds_read_b128 v[180:183], v247 offset:20480
    v_mfma_f32_16x16x32_bf16 v[44:47], v[68:71], v[104:107], v[44:47]
    ds_read_b128 v[184:187], v247 offset:24576
    v_mfma_f32_16x16x32_bf16 v[44:47], v[64:67], v[108:111], v[44:47]
    v_alignbit_b32 v226, v227, v226, 16
    s_waitcnt lgkmcnt(8)
    v_mfma_f32_16x16x32_bf16 v[48:51], v[64:67], v[112:115], v[48:51]
    ds_read_b128 v[188:191], v247 offset:28672
    v_mfma_f32_16x16x32_bf16 v[48:51], v[68:71], v[108:111], v[48:51]
    ds_read2_b32 v[128:129], v236 offset0:112 offset1:113
    v_mfma_f32_16x16x32_bf16 v[48:51], v[72:75], v[104:107], v[48:51]
    v_alignbit_b32 v227, v228, v227, 16
    v_mfma_f32_16x16x32_bf16 v[48:51], v[76:79], v[100:103], v[48:51]
    ds_read2_b32 v[130:131], v236 offset0:114 offset1:115
    v_mfma_f32_16x16x32_bf16 v[48:51], v[80:83], v[96:99], v[48:51]
    ds_read2_b32 v[132:133], v236 offset0:240 offset1:241
    v_mfma_f32_16x16x32_bf16 v[52:55], v[84:87], v[96:99], v[52:55]
    ds_read2_b32 v[134:135], v236 offset0:242 offset1:243
    v_mfma_f32_16x16x32_bf16 v[52:55], v[80:83], v[100:103], v[52:55]
    ds_write_b128 v241, v[224:227] offset:14560
    v_mfma_f32_16x16x32_bf16 v[52:55], v[76:79], v[104:107], v[52:55]
    ds_read2_b32 v[136:137], v237 offset0:112 offset1:113
    v_mfma_f32_16x16x32_bf16 v[52:55], v[72:75], v[108:111], v[52:55]
    s_add_u32 s6, s12, 4718592
    ds_read2_b32 v[138:139], v237 offset0:114 offset1:115
    v_mfma_f32_16x16x32_bf16 v[52:55], v[68:71], v[112:115], v[52:55]
    ds_read2_b32 v[140:141], v237 offset0:240 offset1:241
    v_alignbit_b32 v230, v231, v230, 16
    v_mfma_f32_16x16x32_bf16 v[52:55], v[64:67], v[116:119], v[52:55]
    ds_read2_b32 v[142:143], v237 offset0:242 offset1:243
    v_xor_b32 v244, 64, v244
    v_mfma_f32_16x16x32_bf16 v[56:59], v[64:67], v[120:123], v[56:59]
    ds_read2_b32 v[144:145], v238 offset0:112 offset1:113
    v_mfma_f32_16x16x32_bf16 v[56:59], v[68:71], v[116:119], v[56:59]
    ds_read2_b32 v[146:147], v238 offset0:114 offset1:115
    v_mfma_f32_16x16x32_bf16 v[56:59], v[72:75], v[112:115], v[56:59]
    ds_read2_b32 v[148:149], v238 offset0:240 offset1:241
    v_alignbit_b32 v231, v232, v231, 16
    v_mfma_f32_16x16x32_bf16 v[56:59], v[76:79], v[108:111], v[56:59]
    ds_read2_b32 v[150:151], v238 offset0:242 offset1:243
    v_xor_b32 v245, 64, v245
    v_mfma_f32_16x16x32_bf16 v[56:59], v[80:83], v[104:107], v[56:59]
    ds_read2_b32 v[152:153], v239 offset0:112 offset1:113
    v_mfma_f32_16x16x32_bf16 v[56:59], v[84:87], v[100:103], v[56:59]
    ds_read2_b32 v[154:155], v239 offset0:114 offset1:115
    v_mfma_f32_16x16x32_bf16 v[56:59], v[88:91], v[96:99], v[56:59]
    ds_read2_b32 v[156:157], v239 offset0:240 offset1:241
    v_alignbit_b32 v232, v233, v232, 16
    v_mfma_f32_16x16x32_bf16 v[60:63], v[92:95], v[96:99], v[60:63]
    ds_read2_b32 v[158:159], v239 offset0:242 offset1:243
    v_mfma_f32_16x16x32_bf16 v[60:63], v[88:91], v[100:103], v[60:63]
    v_xor_b32 v246, 64, v246
    v_add_u32 v236, 8320, v236
    v_mfma_f32_16x16x32_bf16 v[60:63], v[84:87], v[104:107], v[60:63]
    v_alignbit_b32 v233, v234, v233, 16
    v_mfma_f32_16x16x32_bf16 v[60:63], v[80:83], v[108:111], v[60:63]
    v_add_u32 v237, 8320, v237
    v_mfma_f32_16x16x32_bf16 v[60:63], v[76:79], v[112:115], v[60:63]
    v_mfma_f32_16x16x32_bf16 v[60:63], v[72:75], v[116:119], v[60:63]
    v_xor_b32 v247, 64, v247
    v_add_u32 v238, 8320, v238
    v_mfma_f32_16x16x32_bf16 v[60:63], v[68:71], v[120:123], v[60:63]
    ds_write_b128 v241, v[230:233] offset:15584
    v_mfma_f32_16x16x32_bf16 v[60:63], v[64:67], v[124:127], v[60:63]
    v_add_u32 v239, 8320, v239
    s_waitcnt lgkmcnt(1)
    v_mfma_f32_16x16x32_bf16 v[60:63], v[128:131], v[188:191], v[60:63]
    ds_read_b128 v[96:99], v244 offset:2048
    v_mfma_f32_16x16x32_bf16 v[60:63], v[132:135], v[184:187], v[60:63]
    ds_read2_b32 v[64:65], v236 offset0:0 offset1:1
    v_mfma_f32_16x16x32_bf16 v[60:63], v[136:139], v[180:183], v[60:63]
    ds_read2_b32 v[66:67], v236 offset0:2 offset1:3
    v_mfma_f32_16x16x32_bf16 v[60:63], v[140:143], v[176:179], v[60:63]
    ds_read_b128 v[100:103], v244 offset:6144
    v_mfma_f32_16x16x32_bf16 v[60:63], v[144:147], v[172:175], v[60:63]
    ds_read2_b32 v[68:69], v236 offset0:128 offset1:129
    v_mfma_f32_16x16x32_bf16 v[60:63], v[148:151], v[168:171], v[60:63]
    ds_read2_b32 v[70:71], v236 offset0:130 offset1:131
    v_mfma_f32_16x16x32_bf16 v[60:63], v[152:155], v[164:167], v[60:63]
    ds_read_b128 v[104:107], v244 offset:10240
    v_mfma_f32_16x16x32_bf16 v[60:63], v[156:159], v[160:163], v[60:63]
    s_waitcnt vmcnt(4)
    s_barrier
    s_add_u32 s13, s12, 32768
    v_mfma_f32_16x16x32_bf16 v[56:59], v[128:131], v[184:187], v[56:59]
    ds_read2_b32 v[72:73], v237 offset0:0 offset1:1
    v_add_u32 v10, 131072, v10
    v_mfma_f32_16x16x32_bf16 v[56:59], v[132:135], v[180:183], v[56:59]
    ds_read_b64_tr_b16 a[32:33], v10 offset:16384
    s_add_u32 m0, s74, 32
    v_mfma_f32_16x16x32_bf16 v[56:59], v[136:139], v[176:179], v[56:59]
    ds_read_b64_tr_b16 a[34:35], v10 offset:18432
    buffer_load_dwordx4 v240, s[48:51], s13 offen offset:0 lds
    ds_read2_b32 v[74:75], v237 offset0:2 offset1:3
    v_mfma_f32_16x16x32_bf16 v[56:59], v[140:143], v[172:175], v[56:59]
    ds_read_b64_tr_b16 a[40:41], v10 offset:20480
    ds_read_b128 v[108:111], v244 offset:14336
    v_mfma_f32_16x16x32_bf16 v[56:59], v[144:147], v[168:171], v[56:59]
    ds_read2_b32 v[76:77], v237 offset0:128 offset1:129
    v_mfma_f32_16x16x32_bf16 v[56:59], v[148:151], v[164:167], v[56:59]
    ds_read_b64_tr_b16 a[42:43], v10 offset:22528
    v_cvt_pk_bf16_f32 v206, v60, v61
    v_mfma_f32_16x16x32_bf16 v[56:59], v[152:155], v[160:163], v[56:59]
    ds_read2_b32 v[78:79], v237 offset0:130 offset1:131
    v_add_u32 v11, 131072, v11
    v_mfma_f32_16x16x32_bf16 v[52:55], v[128:131], v[180:183], v[52:55]
    ds_read_b64_tr_b16 a[36:37], v11 offset:16384
    ds_read_b128 v[112:115], v244 offset:18432
    v_mfma_f32_16x16x32_bf16 v[52:55], v[132:135], v[176:179], v[52:55]
    ds_read_b64_tr_b16 a[38:39], v11 offset:18432
    s_add_u32 m0, s74, 32
    v_cvt_pk_bf16_f32 v207, v62, v63
    v_mfma_f32_16x16x32_bf16 v[52:55], v[136:139], v[172:175], v[52:55]
    ds_read_b64_tr_b16 a[44:45], v11 offset:20480
    buffer_load_dwordx4 v240, s[48:51], s13 offen offset:1024 lds
    ds_read2_b32 v[80:81], v238 offset0:0 offset1:1
    v_mfma_f32_16x16x32_bf16 v[52:55], v[140:143], v[168:171], v[52:55]
    buffer_store_dwordx2 v[206:207], v8, s[44:47], s6 offen offset:3584 sc1
    ds_read_b64_tr_b16 a[46:47], v11 offset:22528
    v_mfma_f32_16x16x32_bf16 v[52:55], v[144:147], v[164:167], v[52:55]
    ds_read2_b32 v[82:83], v238 offset0:2 offset1:3
    v_mfma_f32_16x16x32_bf16 v[52:55], v[148:151], v[160:163], v[52:55]
    ds_read_b128 v[116:119], v244 offset:22528
    v_mfma_f32_16x16x32_bf16 v[48:51], v[128:131], v[176:179], v[48:51]
    ds_read2_b32 v[84:85], v238 offset0:128 offset1:129
    v_cvt_pk_bf16_f32 v204, v56, v57
    v_mfma_f32_16x16x32_bf16 v[48:51], v[132:135], v[172:175], v[48:51]
    ds_read2_b32 v[86:87], v238 offset0:130 offset1:131
    v_mfma_f32_16x16x32_bf16 v[48:51], v[136:139], v[168:171], v[48:51]
    ds_read_b128 v[120:123], v244 offset:26624
    v_mfma_f32_16x16x32_bf16 v[48:51], v[140:143], v[164:167], v[48:51]
    ds_read2_b32 v[88:89], v239 offset0:0 offset1:1
    s_add_u32 m0, s74, 32
    v_cvt_pk_bf16_f32 v205, v58, v59
    v_mfma_f32_16x16x32_bf16 v[48:51], v[144:147], v[160:163], v[48:51]
    buffer_load_dwordx4 v240, s[48:51], s13 offen offset:2048 lds
    ds_read2_b32 v[90:91], v239 offset0:2 offset1:3
    v_mfma_f32_16x16x32_bf16 v[44:47], v[128:131], v[172:175], v[44:47]
    buffer_store_dwordx2 v[204:205], v8, s[44:47], s6 offen offset:3072 sc1
    ds_read_b128 v[124:127], v244 offset:30720
    v_mfma_f32_16x16x32_bf16 v[44:47], v[132:135], v[168:171], v[44:47]
    ds_read2_b32 v[92:93], v239 offset0:128 offset1:129
    v_mfma_f32_16x16x32_bf16 v[44:47], v[136:139], v[164:167], v[44:47]
    ds_read2_b32 v[94:95], v239 offset0:130 offset1:131
    v_mfma_f32_16x16x32_bf16 v[44:47], v[140:143], v[160:163], v[44:47]
    v_cvt_pk_bf16_f32 v202, v52, v53
    v_mfma_f32_16x16x32_bf16 v[40:43], v[128:131], v[168:171], v[40:43]
    v_mfma_f32_16x16x32_bf16 v[40:43], v[132:135], v[164:167], v[40:43]
    v_mfma_f32_16x16x32_bf16 v[40:43], v[136:139], v[160:163], v[40:43]
    s_add_u32 m0, s74, 32
    v_cvt_pk_bf16_f32 v203, v54, v55
    v_mfma_f32_16x16x32_bf16 v[36:39], v[128:131], v[164:167], v[36:39]
    buffer_load_dwordx4 v240, s[48:51], s13 offen offset:3072 lds
    v_mfma_f32_16x16x32_bf16 v[36:39], v[132:135], v[160:163], v[36:39]
    buffer_store_dwordx2 v[202:203], v8, s[44:47], s6 offen offset:2560 sc1
    v_mfma_f32_16x16x32_bf16 v[32:35], v[128:131], v[160:163], v[32:35]
    s_waitcnt lgkmcnt(0)
    v_mfma_f32_16x16x32_bf16 v[60:63], v[64:67], v[124:127], 0
    ds_read_b128 v[160:163], v245 offset:2048
    v_mfma_f32_16x16x32_bf16 v[60:63], v[68:71], v[120:123], v[60:63]
    v_cvt_pk_bf16_f32 v200, v48, v49
    v_mfma_f32_16x16x32_bf16 v[60:63], v[72:75], v[116:119], v[60:63]
    ds_read2_b32 v[128:129], v236 offset0:16 offset1:17
    v_mfma_f32_16x16x32_bf16 v[60:63], v[76:79], v[112:115], v[60:63]
    ds_read2_b32 v[130:131], v236 offset0:18 offset1:19
    v_cvt_pk_bf16_f32 v201, v50, v51
    v_mfma_f32_16x16x32_bf16 v[60:63], v[80:83], v[108:111], v[60:63]
    v_mfma_f32_16x16x32_bf16 v[60:63], v[84:87], v[104:107], v[60:63]
    buffer_store_dwordx2 v[200:201], v8, s[44:47], s6 offen offset:2048 sc1
    ds_read_b128 v[164:167], v245 offset:6144
    v_mfma_f32_16x16x32_bf16 v[60:63], v[88:91], v[100:103], v[60:63]
    ds_read2_b32 v[132:133], v236 offset0:144 offset1:145
    v_mfma_f32_16x16x32_bf16 v[60:63], v[92:95], v[96:99], v[60:63]
    ds_read2_b32 v[134:135], v236 offset0:146 offset1:147
    v_cvt_pk_bf16_f32 v198, v44, v45
    v_mfma_f32_16x16x32_bf16 v[56:59], v[64:67], v[120:123], 0
    ds_read_b128 v[168:171], v245 offset:10240
    v_mfma_f32_16x16x32_bf16 v[56:59], v[68:71], v[116:119], v[56:59]
    ds_read2_b32 v[136:137], v237 offset0:16 offset1:17
    v_mfma_f32_16x16x32_bf16 v[56:59], v[72:75], v[112:115], v[56:59]
    ds_read2_b32 v[138:139], v237 offset0:18 offset1:19
    v_cvt_pk_bf16_f32 v199, v46, v47
    v_mfma_f32_16x16x32_bf16 v[56:59], v[76:79], v[108:111], v[56:59]
    ds_read_b128 v[172:175], v245 offset:14336
    v_mfma_f32_16x16x32_bf16 v[56:59], v[80:83], v[104:107], v[56:59]
    buffer_store_dwordx2 v[198:199], v8, s[44:47], s6 offen offset:1536 sc1
    ds_read2_b32 v[140:141], v237 offset0:144 offset1:145
    v_mfma_f32_16x16x32_bf16 v[56:59], v[84:87], v[100:103], v[56:59]
    ds_read2_b32 v[142:143], v237 offset0:146 offset1:147
    v_mfma_f32_16x16x32_bf16 v[56:59], v[88:91], v[96:99], v[56:59]
    ds_read_b128 v[176:179], v245 offset:18432
    v_cvt_pk_bf16_f32 v196, v40, v41
    v_mfma_f32_16x16x32_bf16 v[52:55], v[64:67], v[116:119], 0
    ds_read2_b32 v[144:145], v238 offset0:16 offset1:17
    v_mfma_f32_16x16x32_bf16 v[52:55], v[68:71], v[112:115], v[52:55]
    ds_read2_b32 v[146:147], v238 offset0:18 offset1:19
    v_cvt_pk_bf16_f32 v197, v42, v43
    v_mfma_f32_16x16x32_bf16 v[52:55], v[72:75], v[108:111], v[52:55]
    ds_read_b128 v[180:183], v245 offset:22528
    v_mfma_f32_16x16x32_bf16 v[52:55], v[76:79], v[104:107], v[52:55]
    buffer_store_dwordx2 v[196:197], v8, s[44:47], s6 offen offset:1024 sc1
    ds_read2_b32 v[148:149], v238 offset0:144 offset1:145
    v_mfma_f32_16x16x32_bf16 v[52:55], v[80:83], v[100:103], v[52:55]
    ds_read2_b32 v[150:151], v238 offset0:146 offset1:147
    v_mfma_f32_16x16x32_bf16 v[52:55], v[84:87], v[96:99], v[52:55]
    ds_read_b128 v[184:187], v245 offset:26624
    v_mfma_f32_16x16x32_bf16 v[48:51], v[64:67], v[112:115], 0
    s_waitcnt vmcnt(10)
    s_barrier
    v_cvt_pk_bf16_f32 v194, v36, v37
    v_mfma_f32_16x16x32_bf16 v[48:51], v[68:71], v[108:111], v[48:51]
    ds_read2_b32 v[152:153], v239 offset0:16 offset1:17
    v_add_u32 v10, -131072, v10
    v_mfma_f32_16x16x32_bf16 v[48:51], v[72:75], v[104:107], v[48:51]
    ds_read_b64_tr_b16 a[48:49], v10 offset:49152
    v_cvt_pk_bf16_f32 v195, v38, v39
    v_mfma_f32_16x16x32_bf16 v[48:51], v[76:79], v[100:103], v[48:51]
    buffer_store_dwordx2 v[194:195], v8, s[44:47], s6 offen offset:512 sc1
    ds_read2_b32 v[154:155], v239 offset0:18 offset1:19
    v_mfma_f32_16x16x32_bf16 v[48:51], v[80:83], v[96:99], v[48:51]
    ds_read_b64_tr_b16 a[50:51], v10 offset:51200
    v_mfma_f32_16x16x32_bf16 v[44:47], v[64:67], v[108:111], 0
    ds_read_b64_tr_b16 a[56:57], v10 offset:53248
    v_mfma_f32_16x16x32_bf16 v[44:47], v[68:71], v[104:107], v[44:47]
    ds_read_b64_tr_b16 a[58:59], v10 offset:55296
    v_cvt_pk_bf16_f32 v192, v32, v33
    v_mfma_f32_16x16x32_bf16 v[44:47], v[72:75], v[100:103], v[44:47]
    ds_read_b128 v[188:191], v245 offset:30720
    v_add_u32 v11, -131072, v11
    v_mfma_f32_16x16x32_bf16 v[44:47], v[76:79], v[96:99], v[44:47]
    ds_read_b64_tr_b16 a[52:53], v11 offset:49152
    v_cvt_pk_bf16_f32 v193, v34, v35
    v_mfma_f32_16x16x32_bf16 v[40:43], v[64:67], v[104:107], 0
    buffer_store_dwordx2 v[192:193], v8, s[44:47], s6 offen offset:0 sc1
    ds_read2_b32 v[156:157], v239 offset0:144 offset1:145
    v_mfma_f32_16x16x32_bf16 v[40:43], v[68:71], v[100:103], v[40:43]
    ds_read_b64_tr_b16 a[54:55], v11 offset:51200
    v_mfma_f32_16x16x32_bf16 v[40:43], v[72:75], v[96:99], v[40:43]
    ds_read_b64_tr_b16 a[60:61], v11 offset:53248
    v_mfma_f32_16x16x32_bf16 v[36:39], v[64:67], v[100:103], 0
    ds_read_b64_tr_b16 a[62:63], v11 offset:55296
    v_mfma_f32_16x16x32_bf16 v[36:39], v[68:71], v[96:99], v[36:39]
    ds_read2_b32 v[158:159], v239 offset0:146 offset1:147
    v_mfma_f32_16x16x32_bf16 v[32:35], v[64:67], v[96:99], 0
    s_waitcnt lgkmcnt(15)
    v_mfma_f32_16x16x32_bf16 v[32:35], v[128:131], v[160:163], v[32:35]
    ds_read_b128 v[96:99], v246 offset:2048
    v_mfma_f32_16x16x32_bf16 v[36:39], v[132:135], v[160:163], v[36:39]
    v_mfma_f32_16x16x32_bf16 v[36:39], v[128:131], v[164:167], v[36:39]
    ds_read2_b32 v[64:65], v236 offset0:32 offset1:33
    v_mfma_f32_16x16x32_bf16 v[40:43], v[128:131], v[168:171], v[40:43]
    ds_read2_b32 v[66:67], v236 offset0:34 offset1:35
    v_mfma_f32_16x16x32_bf16 v[40:43], v[132:135], v[164:167], v[40:43]
    v_mfma_f32_16x16x32_bf16 v[40:43], v[136:139], v[160:163], v[40:43]
    ds_read_b128 v[100:103], v246 offset:6144
    v_mfma_f32_16x16x32_bf16 v[44:47], v[140:143], v[160:163], v[44:47]
    ds_read2_b32 v[68:69], v236 offset0:160 offset1:161
    v_mfma_f32_16x16x32_bf16 v[44:47], v[136:139], v[164:167], v[44:47]
    v_mfma_f32_16x16x32_bf16 v[44:47], v[132:135], v[168:171], v[44:47]
    ds_read2_b32 v[70:71], v236 offset0:162 offset1:163
    v_mfma_f32_16x16x32_bf16 v[44:47], v[128:131], v[172:175], v[44:47]
    ds_read_b128 v[104:107], v246 offset:10240
    s_waitcnt lgkmcnt(7)
    v_mfma_f32_16x16x32_bf16 v[48:51], v[128:131], v[176:179], v[48:51]
    ds_read2_b32 v[72:73], v237 offset0:32 offset1:33
    v_mfma_f32_16x16x32_bf16 v[48:51], v[132:135], v[172:175], v[48:51]
    ds_read2_b32 v[74:75], v237 offset0:34 offset1:35
    v_mfma_f32_16x16x32_bf16 v[48:51], v[136:139], v[168:171], v[48:51]
    v_mov_b32 v9, 16
    buffer_load_ushort v9, v9, s[56:59], s70 offen
    v_mfma_f32_16x16x32_bf16 v[48:51], v[140:143], v[164:167], v[48:51]
    ds_read_b128 v[108:111], v246 offset:14336
    v_mfma_f32_16x16x32_bf16 v[48:51], v[144:147], v[160:163], v[48:51]
    v_mfma_f32_16x16x32_bf16 v[52:55], v[148:151], v[160:163], v[52:55]
    ds_read2_b32 v[76:77], v237 offset0:160 offset1:161
    v_mfma_f32_16x16x32_bf16 v[52:55], v[144:147], v[164:167], v[52:55]
    ds_read2_b32 v[78:79], v237 offset0:162 offset1:163
    v_mfma_f32_16x16x32_bf16 v[52:55], v[140:143], v[168:171], v[52:55]
    v_mfma_f32_16x16x32_bf16 v[52:55], v[136:139], v[172:175], v[52:55]
    s_lshl_b32 s14, s88, 18
    ds_read_b128 v[112:115], v246 offset:18432
    v_mfma_f32_16x16x32_bf16 v[52:55], v[132:135], v[176:179], v[52:55]
    s_add_u32 m0, s73, 147456
    ds_read2_b32 v[80:81], v238 offset0:32 offset1:33
    v_mfma_f32_16x16x32_bf16 v[52:55], v[128:131], v[180:183], v[52:55]
    buffer_load_dwordx4 v4, s[52:55], s14 offen offset:0 lds
    v_mfma_f32_16x16x32_bf16 v[56:59], v[128:131], v[184:187], v[56:59]
    ds_read2_b32 v[82:83], v238 offset0:34 offset1:35
    v_mfma_f32_16x16x32_bf16 v[56:59], v[132:135], v[180:183], v[56:59]
    ds_read_b128 v[116:119], v246 offset:22528
    v_mfma_f32_16x16x32_bf16 v[56:59], v[136:139], v[176:179], v[56:59]
    v_mfma_f32_16x16x32_bf16 v[56:59], v[140:143], v[172:175], v[56:59]
    ds_read2_b32 v[84:85], v238 offset0:160 offset1:161
    v_mfma_f32_16x16x32_bf16 v[56:59], v[144:147], v[168:171], v[56:59]
    ds_read2_b32 v[86:87], v238 offset0:162 offset1:163
    v_mfma_f32_16x16x32_bf16 v[56:59], v[148:151], v[164:167], v[56:59]
    s_add_u32 m0, s73, 147456
    ds_read_b128 v[120:123], v246 offset:26624
    v_mfma_f32_16x16x32_bf16 v[56:59], v[152:155], v[160:163], v[56:59]
    buffer_load_dwordx4 v5, s[52:55], s14 offen offset:1024 lds
    v_mfma_f32_16x16x32_bf16 v[60:63], v[156:159], v[160:163], v[60:63]
    ds_read2_b32 v[88:89], v239 offset0:32 offset1:33
    v_mfma_f32_16x16x32_bf16 v[60:63], v[152:155], v[164:167], v[60:63]
    ds_read2_b32 v[90:91], v239 offset0:34 offset1:35
    v_mfma_f32_16x16x32_bf16 v[60:63], v[148:151], v[168:171], v[60:63]
    v_mfma_f32_16x16x32_bf16 v[60:63], v[144:147], v[172:175], v[60:63]
    ds_read_b128 v[124:127], v246 offset:30720
    v_mfma_f32_16x16x32_bf16 v[60:63], v[140:143], v[176:179], v[60:63]
    ds_read2_b32 v[92:93], v239 offset0:160 offset1:161
    v_mfma_f32_16x16x32_bf16 v[60:63], v[136:139], v[180:183], v[60:63]
    s_add_u32 m0, s73, 147456
    v_mfma_f32_16x16x32_bf16 v[60:63], v[132:135], v[184:187], v[60:63]
    buffer_load_dwordx4 v6, s[52:55], s14 offen offset:2048 lds
    ds_read2_b32 v[94:95], v239 offset0:162 offset1:163
    v_mfma_f32_16x16x32_bf16 v[60:63], v[128:131], v[188:191], v[60:63]
    s_waitcnt lgkmcnt(12)
    v_mfma_f32_16x16x32_bf16 v[32:35], v[64:67], v[96:99], v[32:35]
    ds_read_b128 v[160:163], v247 offset:2048
    v_mfma_f32_16x16x32_bf16 v[36:39], v[68:71], v[96:99], v[36:39]
    v_mfma_f32_16x16x32_bf16 v[36:39], v[64:67], v[100:103], v[36:39]
    ds_read2_b32 v[128:129], v236 offset0:48 offset1:49
    v_mfma_f32_16x16x32_bf16 v[40:43], v[64:67], v[104:107], v[40:43]
    ds_read2_b32 v[130:131], v236 offset0:50 offset1:51
    v_mfma_f32_16x16x32_bf16 v[40:43], v[68:71], v[100:103], v[40:43]
    s_add_u32 m0, s73, 147456
    v_mfma_f32_16x16x32_bf16 v[40:43], v[72:75], v[96:99], v[40:43]
    buffer_load_dwordx4 v7, s[52:55], s14 offen offset:3072 lds
    ds_read_b128 v[164:167], v247 offset:6144
    v_mfma_f32_16x16x32_bf16 v[44:47], v[76:79], v[96:99], v[44:47]
    ds_read2_b32 v[132:133], v236 offset0:176 offset1:177
    v_mfma_f32_16x16x32_bf16 v[44:47], v[72:75], v[100:103], v[44:47]
    s_barrier
    v_mfma_f32_16x16x32_bf16 v[44:47], v[68:71], v[104:107], v[44:47]
    ds_read2_b32 v[134:135], v236 offset0:178 offset1:179
    v_mfma_f32_16x16x32_bf16 v[44:47], v[64:67], v[108:111], v[44:47]
    ds_read_b128 v[168:171], v247 offset:10240
    s_waitcnt lgkmcnt(7)
    v_mfma_f32_16x16x32_bf16 v[48:51], v[64:67], v[112:115], v[48:51]
    ds_read2_b32 v[136:137], v237 offset0:48 offset1:49
    v_mfma_f32_16x16x32_bf16 v[48:51], v[68:71], v[108:111], v[48:51]
    v_mfma_f32_16x16x32_bf16 v[48:51], v[72:75], v[104:107], v[48:51]
    ds_read2_b32 v[138:139], v237 offset0:50 offset1:51
    v_mfma_f32_16x16x32_bf16 v[48:51], v[76:79], v[100:103], v[48:51]
    ds_read_b128 v[172:175], v247 offset:14336
    v_mfma_f32_16x16x32_bf16 v[48:51], v[80:83], v[96:99], v[48:51]
    v_mfma_f32_16x16x32_bf16 v[52:55], v[84:87], v[96:99], v[52:55]
    ds_read2_b32 v[140:141], v237 offset0:176 offset1:177
    v_mfma_f32_16x16x32_bf16 v[52:55], v[80:83], v[100:103], v[52:55]
    ds_read2_b32 v[142:143], v237 offset0:178 offset1:179
    v_mfma_f32_16x16x32_bf16 v[52:55], v[76:79], v[104:107], v[52:55]
    v_mfma_f32_16x16x32_bf16 v[52:55], v[72:75], v[108:111], v[52:55]
    ds_read_b128 v[176:179], v247 offset:18432
    v_mfma_f32_16x16x32_bf16 v[52:55], v[68:71], v[112:115], v[52:55]
    ds_read2_b32 v[144:145], v238 offset0:48 offset1:49
    v_mfma_f32_16x16x32_bf16 v[52:55], v[64:67], v[116:119], v[52:55]
    v_mfma_f32_16x16x32_bf16 v[56:59], v[64:67], v[120:123], v[56:59]
    ds_read2_b32 v[146:147], v238 offset0:50 offset1:51
    v_mfma_f32_16x16x32_bf16 v[56:59], v[68:71], v[116:119], v[56:59]
    ds_read_b128 v[180:183], v247 offset:22528
    v_mfma_f32_16x16x32_bf16 v[56:59], v[72:75], v[112:115], v[56:59]
    v_mfma_f32_16x16x32_bf16 v[56:59], v[76:79], v[108:111], v[56:59]
    ds_read2_b32 v[148:149], v238 offset0:176 offset1:177
    v_mfma_f32_16x16x32_bf16 v[56:59], v[80:83], v[104:107], v[56:59]
    ds_read2_b32 v[150:151], v238 offset0:178 offset1:179
    v_mfma_f32_16x16x32_bf16 v[56:59], v[84:87], v[100:103], v[56:59]
    ds_read_b128 v[184:187], v247 offset:26624
    v_mfma_f32_16x16x32_bf16 v[56:59], v[88:91], v[96:99], v[56:59]
    v_mfma_f32_16x16x32_bf16 v[60:63], v[92:95], v[96:99], v[60:63]
    ds_read2_b32 v[152:153], v239 offset0:48 offset1:49
    v_mfma_f32_16x16x32_bf16 v[60:63], v[88:91], v[100:103], v[60:63]
    ds_read2_b32 v[154:155], v239 offset0:50 offset1:51
    v_mfma_f32_16x16x32_bf16 v[60:63], v[84:87], v[104:107], v[60:63]
    v_mfma_f32_16x16x32_bf16 v[60:63], v[80:83], v[108:111], v[60:63]
    ds_read_b128 v[188:191], v247 offset:30720
    v_mfma_f32_16x16x32_bf16 v[60:63], v[76:79], v[112:115], v[60:63]
    ds_read2_b32 v[156:157], v239 offset0:176 offset1:177
    v_mfma_f32_16x16x32_bf16 v[60:63], v[72:75], v[116:119], v[60:63]
    v_mfma_f32_16x16x32_bf16 v[60:63], v[68:71], v[120:123], v[60:63]
    ds_read2_b32 v[158:159], v239 offset0:178 offset1:179
    v_mfma_f32_16x16x32_bf16 v[60:63], v[64:67], v[124:127], v[60:63]
    s_waitcnt lgkmcnt(12)
    v_mfma_f32_16x16x32_bf16 v[32:35], v[128:131], v[160:163], v[32:35]
    ds_read_b128 v[96:99], v244 offset:0
    v_mfma_f32_16x16x32_bf16 v[36:39], v[132:135], v[160:163], v[36:39]
    v_mfma_f32_16x16x32_bf16 v[36:39], v[128:131], v[164:167], v[36:39]
    ds_read2_b32 v[64:65], v236 offset0:64 offset1:65
    v_mfma_f32_16x16x32_bf16 v[40:43], v[128:131], v[168:171], v[40:43]
    ds_read2_b32 v[66:67], v236 offset0:66 offset1:67
    v_mfma_f32_16x16x32_bf16 v[40:43], v[132:135], v[164:167], v[40:43]
    v_mfma_f32_16x16x32_bf16 v[40:43], v[136:139], v[160:163], v[40:43]
    ds_read_b128 v[100:103], v244 offset:4096
    v_mfma_f32_16x16x32_bf16 v[44:47], v[140:143], v[160:163], v[44:47]
    ds_read2_b32 v[68:69], v236 offset0:192 offset1:193
    v_mfma_f32_16x16x32_bf16 v[44:47], v[136:139], v[164:167], v[44:47]
    s_add_u32 m0, s9, 36864
    s_add_u32 s13, s11, 0
    v_mfma_f32_16x16x32_bf16 v[44:47], v[132:135], v[168:171], v[44:47]
    buffer_load_dwordx4 v15, s[44:47], s13 offen sc1 lds
    ds_read2_b32 v[70:71], v236 offset0:194 offset1:195
    v_mfma_f32_16x16x32_bf16 v[44:47], v[128:131], v[172:175], v[44:47]
    ds_read_b128 v[104:107], v244 offset:8192
    s_waitcnt lgkmcnt(7)
    v_mfma_f32_16x16x32_bf16 v[48:51], v[128:131], v[176:179], v[48:51]
    ds_read2_b32 v[72:73], v237 offset0:64 offset1:65
    v_mfma_f32_16x16x32_bf16 v[48:51], v[132:135], v[172:175], v[48:51]
    v_mfma_f32_16x16x32_bf16 v[48:51], v[136:139], v[168:171], v[48:51]
    ds_read2_b32 v[74:75], v237 offset0:66 offset1:67
    v_mfma_f32_16x16x32_bf16 v[48:51], v[140:143], v[164:167], v[48:51]
    ds_read_b128 v[108:111], v244 offset:12288
    v_mfma_f32_16x16x32_bf16 v[48:51], v[144:147], v[160:163], v[48:51]
    v_mfma_f32_16x16x32_bf16 v[52:55], v[148:151], v[160:163], v[52:55]
    ds_read2_b32 v[76:77], v237 offset0:192 offset1:193
    v_mfma_f32_16x16x32_bf16 v[52:55], v[144:147], v[164:167], v[52:55]
    ds_read2_b32 v[78:79], v237 offset0:194 offset1:195
    s_add_u32 m0, s9, 37888
    s_add_u32 s13, s11, 90112
    v_mfma_f32_16x16x32_bf16 v[52:55], v[140:143], v[168:171], v[52:55]
    buffer_load_dwordx4 v16, s[44:47], s13 offen sc1 lds
    v_mfma_f32_16x16x32_bf16 v[52:55], v[136:139], v[172:175], v[52:55]
    ds_read_b128 v[112:115], v244 offset:16384
    v_mfma_f32_16x16x32_bf16 v[52:55], v[132:135], v[176:179], v[52:55]
    ds_read2_b32 v[80:81], v238 offset0:64 offset1:65
    v_mfma_f32_16x16x32_bf16 v[52:55], v[128:131], v[180:183], v[52:55]
    v_mfma_f32_16x16x32_bf16 v[56:59], v[128:131], v[184:187], v[56:59]
    ds_read2_b32 v[82:83], v238 offset0:66 offset1:67
    v_mfma_f32_16x16x32_bf16 v[56:59], v[132:135], v[180:183], v[56:59]
    ds_read_b128 v[116:119], v244 offset:20480
    v_mfma_f32_16x16x32_bf16 v[56:59], v[136:139], v[176:179], v[56:59]
    v_mfma_f32_16x16x32_bf16 v[56:59], v[140:143], v[172:175], v[56:59]
    ds_read2_b32 v[84:85], v238 offset0:192 offset1:193
    v_mfma_f32_16x16x32_bf16 v[56:59], v[144:147], v[168:171], v[56:59]
    ds_read2_b32 v[86:87], v238 offset0:194 offset1:195
    s_add_u32 m0, s9, 38912
    s_add_u32 s13, s11, 180224
    v_mfma_f32_16x16x32_bf16 v[56:59], v[148:151], v[164:167], v[56:59]
    buffer_load_dwordx4 v15, s[44:47], s13 offen sc1 lds
    ds_read_b128 v[120:123], v244 offset:24576
    v_mfma_f32_16x16x32_bf16 v[56:59], v[152:155], v[160:163], v[56:59]
    v_mfma_f32_16x16x32_bf16 v[60:63], v[156:159], v[160:163], v[60:63]
    ds_read2_b32 v[88:89], v239 offset0:64 offset1:65
    v_mfma_f32_16x16x32_bf16 v[60:63], v[152:155], v[164:167], v[60:63]
    ds_read2_b32 v[90:91], v239 offset0:66 offset1:67
    v_mfma_f32_16x16x32_bf16 v[60:63], v[148:151], v[168:171], v[60:63]
    v_mfma_f32_16x16x32_bf16 v[60:63], v[144:147], v[172:175], v[60:63]
    ds_read_b128 v[124:127], v244 offset:28672
    v_mfma_f32_16x16x32_bf16 v[60:63], v[140:143], v[176:179], v[60:63]
    ds_read2_b32 v[92:93], v239 offset0:192 offset1:193
    v_mfma_f32_16x16x32_bf16 v[60:63], v[136:139], v[180:183], v[60:63]
    v_mfma_f32_16x16x32_bf16 v[60:63], v[132:135], v[184:187], v[60:63]
    ds_read2_b32 v[94:95], v239 offset0:194 offset1:195
    s_add_u32 m0, s9, 39936
    s_add_u32 s13, s11, 270336
    v_mfma_f32_16x16x32_bf16 v[60:63], v[128:131], v[188:191], v[60:63]
    buffer_load_dwordx4 v16, s[44:47], s13 offen sc1 lds
    s_waitcnt lgkmcnt(12)
    v_mfma_f32_16x16x32_bf16 v[32:35], v[64:67], v[96:99], v[32:35]
    ds_read_b128 v[160:163], v245 offset:0
    s_waitcnt vmcnt(4)
    s_barrier
    v_mfma_f32_16x16x32_bf16 v[36:39], v[68:71], v[96:99], v[36:39]
    ds_read2_b32 v[128:129], v236 offset0:80 offset1:81
    v_add_u32 v10, 131072, v10
    v_mfma_f32_16x16x32_bf16 v[36:39], v[64:67], v[100:103], v[36:39]
    ds_read_b64_tr_b16 a[64:65], v10 offset:16384
    v_mfma_f32_16x16x32_bf16 v[40:43], v[64:67], v[104:107], v[40:43]
    ds_read_b64_tr_b16 a[66:67], v10 offset:18432
    ds_read2_b32 v[130:131], v236 offset0:82 offset1:83
    v_mfma_f32_16x16x32_bf16 v[40:43], v[68:71], v[100:103], v[40:43]
    ds_read_b64_tr_b16 a[72:73], v10 offset:20480
    v_mfma_f32_16x16x32_bf16 v[40:43], v[72:75], v[96:99], v[40:43]
    ds_read_b64_tr_b16 a[74:75], v10 offset:22528
    ds_read_b128 v[164:167], v245 offset:4096
L_pl_X_3:
    s_cbranch_execz L_pl_X_7
    v_mfma_f32_16x16x32_bf16 v[44:47], v[76:79], v[96:99], v[44:47]
    ds_read2_b32 v[132:133], v236 offset0:208 offset1:209
    v_mfma_f32_16x16x32_bf16 v[44:47], v[72:75], v[100:103], v[44:47]
    v_add_u32 v11, 131072, v11
    s_add_u32 m0, s9, 40960
    s_add_u32 s13, s11, 360448
    v_mfma_f32_16x16x32_bf16 v[44:47], v[68:71], v[104:107], v[44:47]
    ds_read_b64_tr_b16 a[68:69], v11 offset:16384
    buffer_load_dwordx4 v15, s[44:47], s13 offen sc1 lds
    ds_read2_b32 v[134:135], v236 offset0:210 offset1:211
    v_mfma_f32_16x16x32_bf16 v[44:47], v[64:67], v[108:111], v[44:47]
    ds_read_b64_tr_b16 a[70:71], v11 offset:18432
    ds_read_b128 v[168:171], v245 offset:8192
    s_waitcnt lgkmcnt(13)
    v_mfma_f32_16x16x32_bf16 v[48:51], v[64:67], v[112:115], v[48:51]
    ds_read_b64_tr_b16 a[76:77], v11 offset:20480
    v_mfma_f32_16x16x32_bf16 v[48:51], v[68:71], v[108:111], v[48:51]
    ds_read_b64_tr_b16 a[78:79], v11 offset:22528
    v_mfma_f32_16x16x32_bf16 v[48:51], v[72:75], v[104:107], v[48:51]
    ds_read2_b32 v[136:137], v237 offset0:80 offset1:81
    v_mfma_f32_16x16x32_bf16 v[48:51], v[76:79], v[100:103], v[48:51]
    ds_read2_b32 v[138:139], v237 offset0:82 offset1:83
    v_mfma_f32_16x16x32_bf16 v[48:51], v[80:83], v[96:99], v[48:51]
    ds_read_b128 v[172:175], v245 offset:12288
    v_mfma_f32_16x16x32_bf16 v[52:55], v[84:87], v[96:99], v[52:55]
    ds_read2_b32 v[140:141], v237 offset0:208 offset1:209
    v_mfma_f32_16x16x32_bf16 v[52:55], v[80:83], v[100:103], v[52:55]
    ds_read2_b32 v[142:143], v237 offset0:210 offset1:211
    s_add_u32 m0, s9, 41984
    s_add_u32 s13, s11, 450560
    v_mfma_f32_16x16x32_bf16 v[52:55], v[76:79], v[104:107], v[52:55]
    buffer_load_dwordx4 v16, s[44:47], s13 offen sc1 lds
    ds_read_b128 v[176:179], v245 offset:16384
    v_mfma_f32_16x16x32_bf16 v[52:55], v[72:75], v[108:111], v[52:55]
    ds_read2_b32 v[144:145], v238 offset0:80 offset1:81
    v_mfma_f32_16x16x32_bf16 v[52:55], v[68:71], v[112:115], v[52:55]
    ds_read_b128 v[212:215], v241 offset:32
    v_mfma_f32_16x16x32_bf16 v[52:55], v[64:67], v[116:119], v[52:55]
    ds_read2_b32 v[146:147], v238 offset0:82 offset1:83
    v_mfma_f32_16x16x32_bf16 v[56:59], v[64:67], v[120:123], v[56:59]
    ds_read_b32 v216, v241 offset:48
    v_mfma_f32_16x16x32_bf16 v[56:59], v[68:71], v[116:119], v[56:59]
    ds_read_b128 v[180:183], v245 offset:20480
    v_mfma_f32_16x16x32_bf16 v[56:59], v[72:75], v[112:115], v[56:59]
    ds_read_b128 v[218:221], v241 offset:1056
    v_mfma_f32_16x16x32_bf16 v[56:59], v[76:79], v[108:111], v[56:59]
    ds_read2_b32 v[148:149], v238 offset0:208 offset1:209
    v_mfma_f32_16x16x32_bf16 v[56:59], v[80:83], v[104:107], v[56:59]
    ds_read2_b32 v[150:151], v238 offset0:210 offset1:211
    s_add_u32 m0, s9, 43008
    s_add_u32 s13, s11, 540672
    v_mfma_f32_16x16x32_bf16 v[56:59], v[84:87], v[100:103], v[56:59]
    buffer_load_dwordx4 v15, s[44:47], s13 offen sc1 lds
    ds_read_b32 v222, v241 offset:1072
    v_mfma_f32_16x16x32_bf16 v[56:59], v[88:91], v[96:99], v[56:59]
    ds_read_b128 v[184:187], v245 offset:24576
    v_mfma_f32_16x16x32_bf16 v[60:63], v[92:95], v[96:99], v[60:63]
    ds_read_b128 v[224:227], v241 offset:2080
    ds_read2_b32 v[152:153], v239 offset0:80 offset1:81
    v_mfma_f32_16x16x32_bf16 v[60:63], v[88:91], v[100:103], v[60:63]
    ds_read2_b32 v[154:155], v239 offset0:82 offset1:83
    v_mfma_f32_16x16x32_bf16 v[60:63], v[84:87], v[104:107], v[60:63]
    ds_read_b32 v228, v241 offset:2096
    v_mfma_f32_16x16x32_bf16 v[60:63], v[80:83], v[108:111], v[60:63]
    ds_read_b128 v[188:191], v245 offset:28672
    v_mfma_f32_16x16x32_bf16 v[60:63], v[76:79], v[112:115], v[60:63]
    ds_read_b128 v[230:233], v241 offset:3104
    ds_read2_b32 v[156:157], v239 offset0:208 offset1:209
    v_mfma_f32_16x16x32_bf16 v[60:63], v[72:75], v[116:119], v[60:63]
    ds_read2_b32 v[158:159], v239 offset0:210 offset1:211
    v_mfma_f32_16x16x32_bf16 v[60:63], v[68:71], v[120:123], v[60:63]
    ds_read_b32 v234, v241 offset:3120
    s_add_u32 m0, s9, 44032
    s_add_u32 s13, s11, 630784
    v_mfma_f32_16x16x32_bf16 v[60:63], v[64:67], v[124:127], v[60:63]
    buffer_load_dwordx4 v16, s[44:47], s13 offen sc1 lds
    s_waitcnt lgkmcnt(15)
    v_mfma_f32_16x16x32_bf16 v[32:35], v[128:131], v[160:163], v[32:35]
    ds_read_b128 v[96:99], v246 offset:0
    v_mfma_f32_16x16x32_bf16 v[36:39], v[132:135], v[160:163], v[36:39]
    v_mfma_f32_16x16x32_bf16 v[36:39], v[128:131], v[164:167], v[36:39]
    ds_read2_b32 v[64:65], v236 offset0:96 offset1:97
    v_mfma_f32_16x16x32_bf16 v[40:43], v[128:131], v[168:171], v[40:43]
    ds_read2_b32 v[66:67], v236 offset0:98 offset1:99
    v_mfma_f32_16x16x32_bf16 v[40:43], v[132:135], v[164:167], v[40:43]
    s_waitcnt lgkmcnt(3)
    v_mfma_f32_16x16x32_bf16 v[40:43], v[136:139], v[160:163], v[40:43]
    ds_read_b128 v[100:103], v246 offset:4096
    v_mfma_f32_16x16x32_bf16 v[44:47], v[140:143], v[160:163], v[44:47]
    ds_read2_b32 v[68:69], v236 offset0:224 offset1:225
    v_mfma_f32_16x16x32_bf16 v[44:47], v[136:139], v[164:167], v[44:47]
    v_mfma_f32_16x16x32_bf16 v[44:47], v[132:135], v[168:171], v[44:47]
    ds_read2_b32 v[70:71], v236 offset0:226 offset1:227
    v_lshlrev_b32 v9, 16, v9
    v_mfma_f32_16x16x32_bf16 v[44:47], v[128:131], v[172:175], v[44:47]
    ds_read_b128 v[104:107], v246 offset:8192
    v_mfma_f32_16x16x32_bf16 v[48:51], v[128:131], v[176:179], v[48:51]
    ds_read2_b32 v[72:73], v237 offset0:96 offset1:97
    v_lshlrev_b32 v208, 16, v212
    v_mfma_f32_16x16x32_bf16 v[48:51], v[132:135], v[172:175], v[48:51]
    v_mfma_f32_16x16x32_bf16 v[48:51], v[136:139], v[168:171], v[48:51]
    ds_read2_b32 v[74:75], v237 offset0:98 offset1:99
    v_add_f32 v9, v9, v208
    v_mfma_f32_16x16x32_bf16 v[48:51], v[140:143], v[164:167], v[48:51]
    ds_read_b128 v[108:111], v246 offset:12288
    v_cvt_pk_bf16_f32 v9, v9, v9
    v_mfma_f32_16x16x32_bf16 v[48:51], v[144:147], v[160:163], v[48:51]
    ds_read2_b32 v[76:77], v237 offset0:224 offset1:225
    s_barrier
    v_mfma_f32_16x16x32_bf16 v[52:55], v[148:151], v[160:163], v[52:55]
    ds_write_b16 v242, v9 offset:4160
    v_mfma_f32_16x16x32_bf16 v[52:55], v[144:147], v[164:167], v[52:55]
    ds_read2_b32 v[78:79], v237 offset0:226 offset1:227
    v_mfma_f32_16x16x32_bf16 v[52:55], v[140:143], v[168:171], v[52:55]
    ds_write_b16 v242, v9 offset:2
    v_mfma_f32_16x16x32_bf16 v[52:55], v[136:139], v[172:175], v[52:55]
    s_lshl_b32 s14, s89, 18
    ds_read_b128 v[112:115], v246 offset:16384
    v_mfma_f32_16x16x32_bf16 v[52:55], v[132:135], v[176:179], v[52:55]
    ds_read2_b32 v[80:81], v238 offset0:96 offset1:97
    s_add_u32 m0, s73, 147456
    v_alignbit_b32 v212, v213, v212, 16
    v_mfma_f32_16x16x32_bf16 v[52:55], v[128:131], v[180:183], v[52:55]
    buffer_load_dwordx4 v4, s[52:55], s14 offen offset:0 lds
    v_alignbit_b32 v213, v214, v213, 16
    v_mfma_f32_16x16x32_bf16 v[56:59], v[128:131], v[184:187], v[56:59]
    ds_read2_b32 v[82:83], v238 offset0:98 offset1:99
    v_mfma_f32_16x16x32_bf16 v[56:59], v[132:135], v[180:183], v[56:59]
    ds_read_b128 v[116:119], v246 offset:20480
    v_alignbit_b32 v214, v215, v214, 16
    v_mfma_f32_16x16x32_bf16 v[56:59], v[136:139], v[176:179], v[56:59]
    v_mfma_f32_16x16x32_bf16 v[56:59], v[140:143], v[172:175], v[56:59]
    ds_read2_b32 v[84:85], v238 offset0:224 offset1:225
    v_alignbit_b32 v215, v216, v215, 16
    v_mfma_f32_16x16x32_bf16 v[56:59], v[144:147], v[168:171], v[56:59]
    ds_write_b128 v241, v[212:215] offset:4192
    v_mfma_f32_16x16x32_bf16 v[56:59], v[148:151], v[164:167], v[56:59]
    s_add_u32 m0, s73, 147456
    ds_read2_b32 v[86:87], v238 offset0:226 offset1:227
    v_mfma_f32_16x16x32_bf16 v[56:59], v[152:155], v[160:163], v[56:59]
    buffer_load_dwordx4 v5, s[52:55], s14 offen offset:1024 lds
    ds_read_b128 v[120:123], v246 offset:24576
    v_mfma_f32_16x16x32_bf16 v[60:63], v[156:159], v[160:163], v[60:63]
    ds_read2_b32 v[88:89], v239 offset0:96 offset1:97
    v_alignbit_b32 v218, v219, v218, 16
    v_mfma_f32_16x16x32_bf16 v[60:63], v[152:155], v[164:167], v[60:63]
    ds_read2_b32 v[90:91], v239 offset0:98 offset1:99
    v_alignbit_b32 v219, v220, v219, 16
    v_mfma_f32_16x16x32_bf16 v[60:63], v[148:151], v[168:171], v[60:63]
    ds_read_b128 v[124:127], v246 offset:28672
    v_mfma_f32_16x16x32_bf16 v[60:63], v[144:147], v[172:175], v[60:63]
    v_alignbit_b32 v220, v221, v220, 16
    v_alignbit_b32 v221, v222, v221, 16
    v_mfma_f32_16x16x32_bf16 v[60:63], v[140:143], v[176:179], v[60:63]
    ds_write_b128 v241, v[218:221] offset:5216
    v_mfma_f32_16x16x32_bf16 v[60:63], v[136:139], v[180:183], v[60:63]
    s_add_u32 m0, s73, 147456
    ds_read2_b32 v[92:93], v239 offset0:224 offset1:225
    v_mfma_f32_16x16x32_bf16 v[60:63], v[132:135], v[184:187], v[60:63]
    buffer_load_dwordx4 v6, s[52:55], s14 offen offset:2048 lds
    ds_read2_b32 v[94:95], v239 offset0:226 offset1:227
    v_mfma_f32_16x16x32_bf16 v[60:63], v[128:131], v[188:191], v[60:63]
    s_waitcnt lgkmcnt(15)
    v_mfma_f32_16x16x32_bf16 v[32:35], v[64:67], v[96:99], v[32:35]
    ds_read_b128 v[160:163], v247 offset:0
    v_mfma_f32_16x16x32_bf16 v[36:39], v[68:71], v[96:99], v[36:39]
    v_alignbit_b32 v224, v225, v224, 16
    v_mfma_f32_16x16x32_bf16 v[36:39], v[64:67], v[100:103], v[36:39]
    ds_read_b128 v[164:167], v247 offset:4096
    v_mfma_f32_16x16x32_bf16 v[40:43], v[64:67], v[104:107], v[40:43]
    ds_read_b128 v[168:171], v247 offset:8192
    v_mfma_f32_16x16x32_bf16 v[40:43], v[68:71], v[100:103], v[40:43]
    s_add_u32 m0, s73, 147456
    ds_read_b128 v[172:175], v247 offset:12288
    v_mfma_f32_16x16x32_bf16 v[40:43], v[72:75], v[96:99], v[40:43]
    buffer_load_dwordx4 v7, s[52:55], s14 offen offset:3072 lds
    v_alignbit_b32 v225, v226, v225, 16
    v_mfma_f32_16x16x32_bf16 v[44:47], v[76:79], v[96:99], v[44:47]
    ds_read_b128 v[176:179], v247 offset:16384
    v_mfma_f32_16x16x32_bf16 v[44:47], v[72:75], v[100:103], v[44:47]
    ds_read_b128 v[180:183], v247 offset:20480
    v_mfma_f32_16x16x32_bf16 v[44:47], v[68:71], v[104:107], v[44:47]
    ds_read_b128 v[184:187], v247 offset:24576
    v_mfma_f32_16x16x32_bf16 v[44:47], v[64:67], v[108:111], v[44:47]
    v_alignbit_b32 v226, v227, v226, 16
    s_waitcnt lgkmcnt(7)
    v_mfma_f32_16x16x32_bf16 v[48:51], v[64:67], v[112:115], v[48:51]
    ds_read_b128 v[188:191], v247 offset:28672
    v_mfma_f32_16x16x32_bf16 v[48:51], v[68:71], v[108:111], v[48:51]
    ds_read2_b32 v[128:129], v236 offset0:112 offset1:113
    v_mfma_f32_16x16x32_bf16 v[48:51], v[72:75], v[104:107], v[48:51]
    v_alignbit_b32 v227, v228, v227, 16
    v_mfma_f32_16x16x32_bf16 v[48:51], v[76:79], v[100:103], v[48:51]
    ds_read2_b32 v[130:131], v236 offset0:114 offset1:115
    v_mfma_f32_16x16x32_bf16 v[48:51], v[80:83], v[96:99], v[48:51]
    ds_read2_b32 v[132:133], v236 offset0:240 offset1:241
    v_mfma_f32_16x16x32_bf16 v[52:55], v[84:87], v[96:99], v[52:55]
    ds_read2_b32 v[134:135], v236 offset0:242 offset1:243
    v_mfma_f32_16x16x32_bf16 v[52:55], v[80:83], v[100:103], v[52:55]
    ds_write_b128 v241, v[224:227] offset:6240
    v_mfma_f32_16x16x32_bf16 v[52:55], v[76:79], v[104:107], v[52:55]
    ds_read2_b32 v[136:137], v237 offset0:112 offset1:113
    ds_read2_b32 v[138:139], v237 offset0:114 offset1:115
    v_mfma_f32_16x16x32_bf16 v[52:55], v[72:75], v[108:111], v[52:55]
    s_add_u32 s6, s12, 4734976
    ds_read2_b32 v[140:141], v237 offset0:240 offset1:241
    v_mfma_f32_16x16x32_bf16 v[52:55], v[68:71], v[112:115], v[52:55]
    ds_read2_b32 v[142:143], v237 offset0:242 offset1:243
    v_alignbit_b32 v230, v231, v230, 16
    v_xor_b32 v244, 64, v244
    v_mfma_f32_16x16x32_bf16 v[52:55], v[64:67], v[116:119], v[52:55]
    ds_read2_b32 v[144:145], v238 offset0:112 offset1:113
    v_mfma_f32_16x16x32_bf16 v[56:59], v[64:67], v[120:123], v[56:59]
    ds_read2_b32 v[146:147], v238 offset0:114 offset1:115
    v_xor_b32 v245, 64, v245
    v_mfma_f32_16x16x32_bf16 v[56:59], v[68:71], v[116:119], v[56:59]
    ds_read2_b32 v[148:149], v238 offset0:240 offset1:241
    v_mfma_f32_16x16x32_bf16 v[56:59], v[72:75], v[112:115], v[56:59]
    v_alignbit_b32 v231, v232, v231, 16
    v_xor_b32 v246, 64, v246
    v_mfma_f32_16x16x32_bf16 v[56:59], v[76:79], v[108:111], v[56:59]
    ds_read2_b32 v[150:151], v238 offset0:242 offset1:243
    v_mfma_f32_16x16x32_bf16 v[56:59], v[80:83], v[104:107], v[56:59]
    ds_read2_b32 v[152:153], v239 offset0:112 offset1:113
    v_xor_b32 v247, 64, v247
    v_mfma_f32_16x16x32_bf16 v[56:59], v[84:87], v[100:103], v[56:59]
    ds_read2_b32 v[154:155], v239 offset0:114 offset1:115
    v_mfma_f32_16x16x32_bf16 v[56:59], v[88:91], v[96:99], v[56:59]
    ds_read2_b32 v[156:157], v239 offset0:240 offset1:241
    v_alignbit_b32 v232, v233, v232, 16
    v_mfma_f32_16x16x32_bf16 v[60:63], v[92:95], v[96:99], v[60:63]
    ds_read2_b32 v[158:159], v239 offset0:242 offset1:243
    v_add_u32 v244, 36864, v244
    v_mfma_f32_16x16x32_bf16 v[60:63], v[88:91], v[100:103], v[60:63]
    v_add_u32 v236, -8320, v236
    v_mfma_f32_16x16x32_bf16 v[60:63], v[84:87], v[104:107], v[60:63]
    v_alignbit_b32 v233, v234, v233, 16
    v_add_u32 v245, 36864, v245
    v_mfma_f32_16x16x32_bf16 v[60:63], v[80:83], v[108:111], v[60:63]
    v_add_u32 v237, -8320, v237
    v_mfma_f32_16x16x32_bf16 v[60:63], v[76:79], v[112:115], v[60:63]
    s_waitcnt vmcnt(4)
    s_barrier
    v_add_u32 v246, 36864, v246
    v_mfma_f32_16x16x32_bf16 v[60:63], v[72:75], v[116:119], v[60:63]
    v_add_u32 v238, -8320, v238
    v_add_u32 v239, -8320, v239
    v_mfma_f32_16x16x32_bf16 v[60:63], v[68:71], v[120:123], v[60:63]
    ds_write_b128 v241, v[230:233] offset:7264
    v_mfma_f32_16x16x32_bf16 v[60:63], v[64:67], v[124:127], v[60:63]
    v_add_u32 v247, 36864, v247
    s_waitcnt lgkmcnt(1)
    v_mfma_f32_16x16x32_bf16 v[60:63], v[128:131], v[188:191], v[60:63]
    ds_read_b128 v[96:99], v244 offset:2048
    v_mfma_f32_16x16x32_bf16 v[60:63], v[132:135], v[184:187], v[60:63]
    ds_read2_b32 v[64:65], v236 offset0:0 offset1:1
    v_mfma_f32_16x16x32_bf16 v[60:63], v[136:139], v[180:183], v[60:63]
    ds_read2_b32 v[66:67], v236 offset0:2 offset1:3
    v_mfma_f32_16x16x32_bf16 v[60:63], v[140:143], v[176:179], v[60:63]
    ds_read_b128 v[100:103], v244 offset:6144
    v_mfma_f32_16x16x32_bf16 v[60:63], v[144:147], v[172:175], v[60:63]
    ds_read2_b32 v[68:69], v236 offset0:128 offset1:129
    v_mfma_f32_16x16x32_bf16 v[60:63], v[148:151], v[168:171], v[60:63]
    ds_read2_b32 v[70:71], v236 offset0:130 offset1:131
    v_mfma_f32_16x16x32_bf16 v[60:63], v[152:155], v[164:167], v[60:63]
    ds_read_b128 v[104:107], v244 offset:10240
    v_mfma_f32_16x16x32_bf16 v[60:63], v[156:159], v[160:163], v[60:63]
    s_add_u32 s13, s12, 49152
    ds_read2_b32 v[72:73], v237 offset0:0 offset1:1
    v_mfma_f32_16x16x32_bf16 v[56:59], v[128:131], v[184:187], v[56:59]
    ds_read2_b32 v[74:75], v237 offset0:2 offset1:3
    v_mfma_f32_16x16x32_bf16 v[56:59], v[132:135], v[180:183], v[56:59]
    s_add_u32 m0, s74, 8352
    ds_read_b128 v[108:111], v244 offset:14336
    v_mfma_f32_16x16x32_bf16 v[56:59], v[136:139], v[176:179], v[56:59]
    buffer_load_dwordx4 v240, s[48:51], s13 offen offset:0 lds
    ds_read2_b32 v[76:77], v237 offset0:128 offset1:129
    v_mfma_f32_16x16x32_bf16 v[56:59], v[140:143], v[172:175], v[56:59]
    ds_read2_b32 v[78:79], v237 offset0:130 offset1:131
    v_mfma_f32_16x16x32_bf16 v[56:59], v[144:147], v[168:171], v[56:59]
    ds_read_b128 v[112:115], v244 offset:18432
    v_mfma_f32_16x16x32_bf16 v[56:59], v[148:151], v[164:167], v[56:59]
    ds_read2_b32 v[80:81], v238 offset0:0 offset1:1
    v_cvt_pk_bf16_f32 v206, v60, v61
    v_mfma_f32_16x16x32_bf16 v[56:59], v[152:155], v[160:163], v[56:59]
    ds_read2_b32 v[82:83], v238 offset0:2 offset1:3
    v_mfma_f32_16x16x32_bf16 v[52:55], v[128:131], v[180:183], v[52:55]
    ds_read_b128 v[116:119], v244 offset:22528
    v_mfma_f32_16x16x32_bf16 v[52:55], v[132:135], v[176:179], v[52:55]
    ds_read2_b32 v[84:85], v238 offset0:128 offset1:129
    s_add_u32 m0, s74, 8352
    v_cvt_pk_bf16_f32 v207, v62, v63
    v_mfma_f32_16x16x32_bf16 v[52:55], v[136:139], v[172:175], v[52:55]
    buffer_load_dwordx4 v240, s[48:51], s13 offen offset:1024 lds
    ds_read2_b32 v[86:87], v238 offset0:130 offset1:131
    v_mfma_f32_16x16x32_bf16 v[52:55], v[140:143], v[168:171], v[52:55]
    buffer_store_dwordx2 v[206:207], v8, s[44:47], s6 offen offset:3584 sc1
    ds_read_b128 v[120:123], v244 offset:26624
    v_mfma_f32_16x16x32_bf16 v[52:55], v[144:147], v[164:167], v[52:55]
    ds_read2_b32 v[88:89], v239 offset0:0 offset1:1
    v_mfma_f32_16x16x32_bf16 v[52:55], v[148:151], v[160:163], v[52:55]
    ds_read2_b32 v[90:91], v239 offset0:2 offset1:3
    v_mfma_f32_16x16x32_bf16 v[48:51], v[128:131], v[176:179], v[48:51]
    s_waitcnt vmcnt(3)
    s_barrier
    v_cvt_pk_bf16_f32 v204, v56, v57
    v_mfma_f32_16x16x32_bf16 v[48:51], v[132:135], v[172:175], v[48:51]
    ds_read_b128 v[124:127], v244 offset:30720
    v_mfma_f32_16x16x32_bf16 v[48:51], v[136:139], v[168:171], v[48:51]
    ds_read_b64_tr_b16 a[80:81], v10 offset:16384
    v_mfma_f32_16x16x32_bf16 v[48:51], v[140:143], v[164:167], v[48:51]
    ds_read_b64_tr_b16 a[82:83], v10 offset:18432
    s_add_u32 m0, s74, 8352
    v_cvt_pk_bf16_f32 v205, v58, v59
    v_mfma_f32_16x16x32_bf16 v[48:51], v[144:147], v[160:163], v[48:51]
    ds_read_b64_tr_b16 a[88:89], v10 offset:20480
    buffer_load_dwordx4 v240, s[48:51], s13 offen offset:2048 lds
    v_mfma_f32_16x16x32_bf16 v[44:47], v[128:131], v[172:175], v[44:47]
    buffer_store_dwordx2 v[204:205], v8, s[44:47], s6 offen offset:3072 sc1
    ds_read2_b32 v[92:93], v239 offset0:128 offset1:129
    v_mfma_f32_16x16x32_bf16 v[44:47], v[132:135], v[168:171], v[44:47]
    ds_read_b64_tr_b16 a[90:91], v10 offset:22528
    v_mfma_f32_16x16x32_bf16 v[44:47], v[136:139], v[164:167], v[44:47]
    ds_read_b64_tr_b16 a[84:85], v11 offset:16384
    ds_read2_b32 v[94:95], v239 offset0:130 offset1:131
    v_mfma_f32_16x16x32_bf16 v[44:47], v[140:143], v[160:163], v[44:47]
    v_cvt_pk_bf16_f32 v202, v52, v53
    v_mfma_f32_16x16x32_bf16 v[40:43], v[128:131], v[168:171], v[40:43]
    ds_read_b64_tr_b16 a[86:87], v11 offset:18432
    v_mfma_f32_16x16x32_bf16 v[40:43], v[132:135], v[164:167], v[40:43]
    ds_read_b64_tr_b16 a[92:93], v11 offset:20480
    v_mfma_f32_16x16x32_bf16 v[40:43], v[136:139], v[160:163], v[40:43]
    s_add_u32 m0, s74, 8352
    v_cvt_pk_bf16_f32 v203, v54, v55
    v_mfma_f32_16x16x32_bf16 v[36:39], v[128:131], v[164:167], v[36:39]
    ds_read_b64_tr_b16 a[94:95], v11 offset:22528
    buffer_load_dwordx4 v240, s[48:51], s13 offen offset:3072 lds
    v_mfma_f32_16x16x32_bf16 v[36:39], v[132:135], v[160:163], v[36:39]
    buffer_store_dwordx2 v[202:203], v8, s[44:47], s6 offen offset:2560 sc1
    v_mfma_f32_16x16x32_bf16 v[32:35], v[128:131], v[160:163], v[32:35]
    s_waitcnt lgkmcnt(3)
    v_mfma_f32_16x16x32_bf16 v[60:63], v[64:67], v[124:127], 0
    ds_read_b128 v[160:163], v245 offset:2048
    v_mfma_f32_16x16x32_bf16 v[60:63], v[68:71], v[120:123], v[60:63]
    v_cvt_pk_bf16_f32 v200, v48, v49
    v_mfma_f32_16x16x32_bf16 v[60:63], v[72:75], v[116:119], v[60:63]
    ds_read2_b32 v[128:129], v236 offset0:16 offset1:17
    v_mfma_f32_16x16x32_bf16 v[60:63], v[76:79], v[112:115], v[60:63]
    ds_read2_b32 v[130:131], v236 offset0:18 offset1:19
    v_cvt_pk_bf16_f32 v201, v50, v51
    v_mfma_f32_16x16x32_bf16 v[60:63], v[80:83], v[108:111], v[60:63]
    v_mfma_f32_16x16x32_bf16 v[60:63], v[84:87], v[104:107], v[60:63]
    buffer_store_dwordx2 v[200:201], v8, s[44:47], s6 offen offset:2048 sc1
    ds_read_b128 v[164:167], v245 offset:6144
    v_mfma_f32_16x16x32_bf16 v[60:63], v[88:91], v[100:103], v[60:63]
    ds_read2_b32 v[132:133], v236 offset0:144 offset1:145
    v_mfma_f32_16x16x32_bf16 v[60:63], v[92:95], v[96:99], v[60:63]
    v_cvt_pk_bf16_f32 v198, v44, v45
    v_mfma_f32_16x16x32_bf16 v[56:59], v[64:67], v[120:123], 0
    ds_read2_b32 v[134:135], v236 offset0:146 offset1:147
    v_mfma_f32_16x16x32_bf16 v[56:59], v[68:71], v[116:119], v[56:59]
    ds_read_b128 v[168:171], v245 offset:10240
    v_mfma_f32_16x16x32_bf16 v[56:59], v[72:75], v[112:115], v[56:59]
    ds_read2_b32 v[136:137], v237 offset0:16 offset1:17
    v_cvt_pk_bf16_f32 v199, v46, v47
    v_mfma_f32_16x16x32_bf16 v[56:59], v[76:79], v[108:111], v[56:59]
    v_mfma_f32_16x16x32_bf16 v[56:59], v[80:83], v[104:107], v[56:59]
    buffer_store_dwordx2 v[198:199], v8, s[44:47], s6 offen offset:1536 sc1
    ds_read2_b32 v[138:139], v237 offset0:18 offset1:19
    v_mfma_f32_16x16x32_bf16 v[56:59], v[84:87], v[100:103], v[56:59]
    ds_read_b128 v[172:175], v245 offset:14336
    v_mfma_f32_16x16x32_bf16 v[56:59], v[88:91], v[96:99], v[56:59]
    v_cvt_pk_bf16_f32 v196, v40, v41
    v_mfma_f32_16x16x32_bf16 v[52:55], v[64:67], v[116:119], 0
    ds_read2_b32 v[140:141], v237 offset0:144 offset1:145
    v_mfma_f32_16x16x32_bf16 v[52:55], v[68:71], v[112:115], v[52:55]
    ds_read2_b32 v[142:143], v237 offset0:146 offset1:147
    v_cvt_pk_bf16_f32 v197, v42, v43
    v_mfma_f32_16x16x32_bf16 v[52:55], v[72:75], v[108:111], v[52:55]
    v_mfma_f32_16x16x32_bf16 v[52:55], v[76:79], v[104:107], v[52:55]
    buffer_store_dwordx2 v[196:197], v8, s[44:47], s6 offen offset:1024 sc1
    ds_read_b128 v[176:179], v245 offset:18432
    v_mfma_f32_16x16x32_bf16 v[52:55], v[80:83], v[100:103], v[52:55]
    ds_read2_b32 v[144:145], v238 offset0:16 offset1:17
    v_mfma_f32_16x16x32_bf16 v[52:55], v[84:87], v[96:99], v[52:55]
    v_mfma_f32_16x16x32_bf16 v[48:51], v[64:67], v[112:115], 0
    ds_read2_b32 v[146:147], v238 offset0:18 offset1:19
    v_cvt_pk_bf16_f32 v194, v36, v37
    v_mfma_f32_16x16x32_bf16 v[48:51], v[68:71], v[108:111], v[48:51]
    ds_read_b128 v[180:183], v245 offset:22528
    v_mfma_f32_16x16x32_bf16 v[48:51], v[72:75], v[104:107], v[48:51]
    v_cvt_pk_bf16_f32 v195, v38, v39
    v_mfma_f32_16x16x32_bf16 v[48:51], v[76:79], v[100:103], v[48:51]
    ds_read2_b32 v[148:149], v238 offset0:144 offset1:145
    v_mfma_f32_16x16x32_bf16 v[48:51], v[80:83], v[96:99], v[48:51]
    buffer_store_dwordx2 v[194:195], v8, s[44:47], s6 offen offset:512 sc1
    ds_read2_b32 v[150:151], v238 offset0:146 offset1:147
    v_mfma_f32_16x16x32_bf16 v[44:47], v[64:67], v[108:111], 0
    ds_read_b128 v[184:187], v245 offset:26624
    v_mfma_f32_16x16x32_bf16 v[44:47], v[68:71], v[104:107], v[44:47]
    v_cvt_pk_bf16_f32 v192, v32, v33
    v_mfma_f32_16x16x32_bf16 v[44:47], v[72:75], v[100:103], v[44:47]
    ds_read2_b32 v[152:153], v239 offset0:16 offset1:17
    v_mfma_f32_16x16x32_bf16 v[44:47], v[76:79], v[96:99], v[44:47]
    ds_read2_b32 v[154:155], v239 offset0:18 offset1:19
    v_cvt_pk_bf16_f32 v193, v34, v35
    v_mfma_f32_16x16x32_bf16 v[40:43], v[64:67], v[104:107], 0
    v_mfma_f32_16x16x32_bf16 v[40:43], v[68:71], v[100:103], v[40:43]
    buffer_store_dwordx2 v[192:193], v8, s[44:47], s6 offen offset:0 sc1
    ds_read_b128 v[188:191], v245 offset:30720
    v_mfma_f32_16x16x32_bf16 v[40:43], v[72:75], v[96:99], v[40:43]
    ds_read2_b32 v[156:157], v239 offset0:144 offset1:145
    v_mfma_f32_16x16x32_bf16 v[36:39], v[64:67], v[100:103], 0
    v_mfma_f32_16x16x32_bf16 v[36:39], v[68:71], v[96:99], v[36:39]
    ds_read2_b32 v[158:159], v239 offset0:146 offset1:147
    v_mfma_f32_16x16x32_bf16 v[32:35], v[64:67], v[96:99], 0
    s_waitcnt lgkmcnt(12)
    v_mfma_f32_16x16x32_bf16 v[32:35], v[128:131], v[160:163], v[32:35]
    ds_read_b128 v[96:99], v246 offset:2048
    v_mfma_f32_16x16x32_bf16 v[36:39], v[132:135], v[160:163], v[36:39]
    v_mfma_f32_16x16x32_bf16 v[36:39], v[128:131], v[164:167], v[36:39]
    ds_read2_b32 v[64:65], v236 offset0:32 offset1:33
    v_mfma_f32_16x16x32_bf16 v[40:43], v[128:131], v[168:171], v[40:43]
    ds_read2_b32 v[66:67], v236 offset0:34 offset1:35
    s_barrier
    v_mfma_f32_16x16x32_bf16 v[40:43], v[132:135], v[164:167], v[40:43]
    v_mfma_f32_16x16x32_bf16 v[40:43], v[136:139], v[160:163], v[40:43]
    ds_read_b128 v[100:103], v246 offset:6144
    v_mfma_f32_16x16x32_bf16 v[44:47], v[140:143], v[160:163], v[44:47]
    ds_read2_b32 v[68:69], v236 offset0:160 offset1:161
    v_mfma_f32_16x16x32_bf16 v[44:47], v[136:139], v[164:167], v[44:47]
    v_mfma_f32_16x16x32_bf16 v[44:47], v[132:135], v[168:171], v[44:47]
    ds_read2_b32 v[70:71], v236 offset0:162 offset1:163
    v_mfma_f32_16x16x32_bf16 v[44:47], v[128:131], v[172:175], v[44:47]
    ds_read_b128 v[104:107], v246 offset:10240
    s_waitcnt lgkmcnt(7)
    v_mfma_f32_16x16x32_bf16 v[48:51], v[128:131], v[176:179], v[48:51]
    ds_read2_b32 v[72:73], v237 offset0:32 offset1:33
    v_mfma_f32_16x16x32_bf16 v[48:51], v[132:135], v[172:175], v[48:51]
    ds_read2_b32 v[74:75], v237 offset0:34 offset1:35
    v_mfma_f32_16x16x32_bf16 v[48:51], v[136:139], v[168:171], v[48:51]
    v_mov_b32 v9, 24
    buffer_load_ushort v9, v9, s[56:59], s70 offen
    v_mfma_f32_16x16x32_bf16 v[48:51], v[140:143], v[164:167], v[48:51]
    ds_read_b128 v[108:111], v246 offset:14336
    v_mfma_f32_16x16x32_bf16 v[48:51], v[144:147], v[160:163], v[48:51]
    s_lshl_b32 s14, s90, 18
    v_mfma_f32_16x16x32_bf16 v[52:55], v[148:151], v[160:163], v[52:55]
    s_add_u32 m0, s73, 147456
    ds_read2_b32 v[76:77], v237 offset0:160 offset1:161
    v_mfma_f32_16x16x32_bf16 v[52:55], v[144:147], v[164:167], v[52:55]
    buffer_load_dwordx4 v4, s[52:55], s14 offen offset:0 lds
    ds_read2_b32 v[78:79], v237 offset0:162 offset1:163
    v_mfma_f32_16x16x32_bf16 v[52:55], v[140:143], v[168:171], v[52:55]
    v_mfma_f32_16x16x32_bf16 v[52:55], v[136:139], v[172:175], v[52:55]
    ds_read_b128 v[112:115], v246 offset:18432
    v_mfma_f32_16x16x32_bf16 v[52:55], v[132:135], v[176:179], v[52:55]
    ds_read2_b32 v[80:81], v238 offset0:32 offset1:33
    v_mfma_f32_16x16x32_bf16 v[52:55], v[128:131], v[180:183], v[52:55]
    v_mfma_f32_16x16x32_bf16 v[56:59], v[128:131], v[184:187], v[56:59]
    ds_read2_b32 v[82:83], v238 offset0:34 offset1:35
    v_mfma_f32_16x16x32_bf16 v[56:59], v[132:135], v[180:183], v[56:59]
    s_add_u32 m0, s73, 147456
    ds_read_b128 v[116:119], v246 offset:22528
    v_mfma_f32_16x16x32_bf16 v[56:59], v[136:139], v[176:179], v[56:59]
    buffer_load_dwordx4 v5, s[52:55], s14 offen offset:1024 lds
    v_mfma_f32_16x16x32_bf16 v[56:59], v[140:143], v[172:175], v[56:59]
    ds_read2_b32 v[84:85], v238 offset0:160 offset1:161
    v_mfma_f32_16x16x32_bf16 v[56:59], v[144:147], v[168:171], v[56:59]
    ds_read2_b32 v[86:87], v238 offset0:162 offset1:163
    v_mfma_f32_16x16x32_bf16 v[56:59], v[148:151], v[164:167], v[56:59]
    ds_read_b128 v[120:123], v246 offset:26624
    v_mfma_f32_16x16x32_bf16 v[56:59], v[152:155], v[160:163], v[56:59]
    v_mfma_f32_16x16x32_bf16 v[60:63], v[156:159], v[160:163], v[60:63]
    ds_read2_b32 v[88:89], v239 offset0:32 offset1:33
    v_mfma_f32_16x16x32_bf16 v[60:63], v[152:155], v[164:167], v[60:63]
    s_add_u32 m0, s73, 147456
    ds_read2_b32 v[90:91], v239 offset0:34 offset1:35
    v_mfma_f32_16x16x32_bf16 v[60:63], v[148:151], v[168:171], v[60:63]
    buffer_load_dwordx4 v6, s[52:55], s14 offen offset:2048 lds
    v_mfma_f32_16x16x32_bf16 v[60:63], v[144:147], v[172:175], v[60:63]
    ds_read_b128 v[124:127], v246 offset:30720
    v_mfma_f32_16x16x32_bf16 v[60:63], v[140:143], v[176:179], v[60:63]
    ds_read2_b32 v[92:93], v239 offset0:160 offset1:161
    v_mfma_f32_16x16x32_bf16 v[60:63], v[136:139], v[180:183], v[60:63]
    v_mfma_f32_16x16x32_bf16 v[60:63], v[132:135], v[184:187], v[60:63]
    ds_read2_b32 v[94:95], v239 offset0:162 offset1:163
    v_mfma_f32_16x16x32_bf16 v[60:63], v[128:131], v[188:191], v[60:63]
    s_waitcnt lgkmcnt(12)
    v_mfma_f32_16x16x32_bf16 v[32:35], v[64:67], v[96:99], v[32:35]
    ds_read_b128 v[160:163], v247 offset:2048
    v_mfma_f32_16x16x32_bf16 v[36:39], v[68:71], v[96:99], v[36:39]
    s_add_u32 m0, s73, 147456
    v_mfma_f32_16x16x32_bf16 v[36:39], v[64:67], v[100:103], v[36:39]
    buffer_load_dwordx4 v7, s[52:55], s14 offen offset:3072 lds
    ds_read2_b32 v[128:129], v236 offset0:48 offset1:49
    v_mfma_f32_16x16x32_bf16 v[40:43], v[64:67], v[104:107], v[40:43]
    ds_read2_b32 v[130:131], v236 offset0:50 offset1:51
    v_mfma_f32_16x16x32_bf16 v[40:43], v[68:71], v[100:103], v[40:43]
    v_mfma_f32_16x16x32_bf16 v[40:43], v[72:75], v[96:99], v[40:43]
    ds_read_b128 v[164:167], v247 offset:6144
    v_mfma_f32_16x16x32_bf16 v[44:47], v[76:79], v[96:99], v[44:47]
    ds_read2_b32 v[132:133], v236 offset0:176 offset1:177
    v_mfma_f32_16x16x32_bf16 v[44:47], v[72:75], v[100:103], v[44:47]
    v_mfma_f32_16x16x32_bf16 v[44:47], v[68:71], v[104:107], v[44:47]
    ds_read2_b32 v[134:135], v236 offset0:178 offset1:179
    v_mfma_f32_16x16x32_bf16 v[44:47], v[64:67], v[108:111], v[44:47]
    ds_read_b128 v[168:171], v247 offset:10240
    s_waitcnt lgkmcnt(7)
    v_mfma_f32_16x16x32_bf16 v[48:51], v[64:67], v[112:115], v[48:51]
    ds_read2_b32 v[136:137], v237 offset0:48 offset1:49
    v_mfma_f32_16x16x32_bf16 v[48:51], v[68:71], v[108:111], v[48:51]
    v_mfma_f32_16x16x32_bf16 v[48:51], v[72:75], v[104:107], v[48:51]
    ds_read2_b32 v[138:139], v237 offset0:50 offset1:51
    v_mfma_f32_16x16x32_bf16 v[48:51], v[76:79], v[100:103], v[48:51]
    ds_read_b128 v[172:175], v247 offset:14336
    v_mfma_f32_16x16x32_bf16 v[48:51], v[80:83], v[96:99], v[48:51]
    v_mfma_f32_16x16x32_bf16 v[52:55], v[84:87], v[96:99], v[52:55]
    ds_read2_b32 v[140:141], v237 offset0:176 offset1:177
    v_mfma_f32_16x16x32_bf16 v[52:55], v[80:83], v[100:103], v[52:55]
    ds_read2_b32 v[142:143], v237 offset0:178 offset1:179
    v_mfma_f32_16x16x32_bf16 v[52:55], v[76:79], v[104:107], v[52:55]
    v_mfma_f32_16x16x32_bf16 v[52:55], v[72:75], v[108:111], v[52:55]
    ds_read_b128 v[176:179], v247 offset:18432
    v_mfma_f32_16x16x32_bf16 v[52:55], v[68:71], v[112:115], v[52:55]
L_pl_X_4:
    s_cbranch_execz L_wret
    ds_read2_b32 v[144:145], v238 offset0:48 offset1:49
    v_mfma_f32_16x16x32_bf16 v[52:55], v[64:67], v[116:119], v[52:55]
    v_mfma_f32_16x16x32_bf16 v[56:59], v[64:67], v[120:123], v[56:59]
    s_lshl_b32 s14, s91, 18
    ds_read2_b32 v[146:147], v238 offset0:50 offset1:51
    v_mfma_f32_16x16x32_bf16 v[56:59], v[68:71], v[116:119], v[56:59]
    s_add_u32 m0, s73, 0
    ds_read_b128 v[180:183], v247 offset:22528
    v_mfma_f32_16x16x32_bf16 v[56:59], v[72:75], v[112:115], v[56:59]
    buffer_load_dwordx4 v4, s[52:55], s14 offen offset:0 lds
    v_mfma_f32_16x16x32_bf16 v[56:59], v[76:79], v[108:111], v[56:59]
    ds_read2_b32 v[148:149], v238 offset0:176 offset1:177
    v_mfma_f32_16x16x32_bf16 v[56:59], v[80:83], v[104:107], v[56:59]
    ds_read2_b32 v[150:151], v238 offset0:178 offset1:179
    v_mfma_f32_16x16x32_bf16 v[56:59], v[84:87], v[100:103], v[56:59]
    ds_read_b128 v[184:187], v247 offset:26624
    v_mfma_f32_16x16x32_bf16 v[56:59], v[88:91], v[96:99], v[56:59]
    v_mfma_f32_16x16x32_bf16 v[60:63], v[92:95], v[96:99], v[60:63]
    ds_read2_b32 v[152:153], v239 offset0:48 offset1:49
    v_mfma_f32_16x16x32_bf16 v[60:63], v[88:91], v[100:103], v[60:63]
    s_add_u32 m0, s73, 0
    ds_read2_b32 v[154:155], v239 offset0:50 offset1:51
    v_mfma_f32_16x16x32_bf16 v[60:63], v[84:87], v[104:107], v[60:63]
    buffer_load_dwordx4 v5, s[52:55], s14 offen offset:1024 lds
    v_mfma_f32_16x16x32_bf16 v[60:63], v[80:83], v[108:111], v[60:63]
    ds_read_b128 v[188:191], v247 offset:30720
    v_mfma_f32_16x16x32_bf16 v[60:63], v[76:79], v[112:115], v[60:63]
    ds_read2_b32 v[156:157], v239 offset0:176 offset1:177
    v_mfma_f32_16x16x32_bf16 v[60:63], v[72:75], v[116:119], v[60:63]
    v_mfma_f32_16x16x32_bf16 v[60:63], v[68:71], v[120:123], v[60:63]
    ds_read2_b32 v[158:159], v239 offset0:178 offset1:179
    v_mfma_f32_16x16x32_bf16 v[60:63], v[64:67], v[124:127], v[60:63]
    s_waitcnt lgkmcnt(12)
    v_mfma_f32_16x16x32_bf16 v[32:35], v[128:131], v[160:163], v[32:35]
    ds_read_b128 v[96:99], v244 offset:0
    v_mfma_f32_16x16x32_bf16 v[36:39], v[132:135], v[160:163], v[36:39]
    s_add_u32 m0, s73, 0
    v_mfma_f32_16x16x32_bf16 v[36:39], v[128:131], v[164:167], v[36:39]
    buffer_load_dwordx4 v6, s[52:55], s14 offen offset:2048 lds
    ds_read2_b32 v[64:65], v236 offset0:64 offset1:65
    v_mfma_f32_16x16x32_bf16 v[40:43], v[128:131], v[168:171], v[40:43]
    ds_read2_b32 v[66:67], v236 offset0:66 offset1:67
    v_mfma_f32_16x16x32_bf16 v[40:43], v[132:135], v[164:167], v[40:43]
    v_mfma_f32_16x16x32_bf16 v[40:43], v[136:139], v[160:163], v[40:43]
    ds_read_b128 v[100:103], v244 offset:4096
    v_mfma_f32_16x16x32_bf16 v[44:47], v[140:143], v[160:163], v[44:47]
    ds_read2_b32 v[68:69], v236 offset0:192 offset1:193
    v_mfma_f32_16x16x32_bf16 v[44:47], v[136:139], v[164:167], v[44:47]
    v_mfma_f32_16x16x32_bf16 v[44:47], v[132:135], v[168:171], v[44:47]
    s_add_u32 m0, s73, 0
    ds_read2_b32 v[70:71], v236 offset0:194 offset1:195
    v_mfma_f32_16x16x32_bf16 v[44:47], v[128:131], v[172:175], v[44:47]
    buffer_load_dwordx4 v7, s[52:55], s14 offen offset:3072 lds
    ds_read_b128 v[104:107], v244 offset:8192
    s_waitcnt lgkmcnt(7)
    v_mfma_f32_16x16x32_bf16 v[48:51], v[128:131], v[176:179], v[48:51]
    ds_read2_b32 v[72:73], v237 offset0:64 offset1:65
    v_mfma_f32_16x16x32_bf16 v[48:51], v[132:135], v[172:175], v[48:51]
    v_mfma_f32_16x16x32_bf16 v[48:51], v[136:139], v[168:171], v[48:51]
    ds_read2_b32 v[74:75], v237 offset0:66 offset1:67
    v_mfma_f32_16x16x32_bf16 v[48:51], v[140:143], v[164:167], v[48:51]
    ds_read_b128 v[108:111], v244 offset:12288
    v_mfma_f32_16x16x32_bf16 v[48:51], v[144:147], v[160:163], v[48:51]
    v_mfma_f32_16x16x32_bf16 v[52:55], v[148:151], v[160:163], v[52:55]
    ds_read2_b32 v[76:77], v237 offset0:192 offset1:193
    v_mfma_f32_16x16x32_bf16 v[52:55], v[144:147], v[164:167], v[52:55]
    ds_read2_b32 v[78:79], v237 offset0:194 offset1:195
    v_mfma_f32_16x16x32_bf16 v[52:55], v[140:143], v[168:171], v[52:55]
    v_mfma_f32_16x16x32_bf16 v[52:55], v[136:139], v[172:175], v[52:55]
    ds_read_b128 v[112:115], v244 offset:16384
    v_mfma_f32_16x16x32_bf16 v[52:55], v[132:135], v[176:179], v[52:55]
    ds_read2_b32 v[80:81], v238 offset0:64 offset1:65
    v_mfma_f32_16x16x32_bf16 v[52:55], v[128:131], v[180:183], v[52:55]
    v_mfma_f32_16x16x32_bf16 v[56:59], v[128:131], v[184:187], v[56:59]
    ds_read2_b32 v[82:83], v238 offset0:66 offset1:67
    v_mfma_f32_16x16x32_bf16 v[56:59], v[132:135], v[180:183], v[56:59]
    ds_read_b128 v[116:119], v244 offset:20480
    v_mfma_f32_16x16x32_bf16 v[56:59], v[136:139], v[176:179], v[56:59]
    v_mfma_f32_16x16x32_bf16 v[56:59], v[140:143], v[172:175], v[56:59]
    ds_read2_b32 v[84:85], v238 offset0:192 offset1:193
    v_mfma_f32_16x16x32_bf16 v[56:59], v[144:147], v[168:171], v[56:59]
    ds_read2_b32 v[86:87], v238 offset0:194 offset1:195
    v_mfma_f32_16x16x32_bf16 v[56:59], v[148:151], v[164:167], v[56:59]
    ds_read_b128 v[120:123], v244 offset:24576
    v_mfma_f32_16x16x32_bf16 v[56:59], v[152:155], v[160:163], v[56:59]
    v_mfma_f32_16x16x32_bf16 v[60:63], v[156:159], v[160:163], v[60:63]
    s_lshl_b32 s14, s92, 18
    ds_read2_b32 v[88:89], v239 offset0:64 offset1:65
    v_mfma_f32_16x16x32_bf16 v[60:63], v[152:155], v[164:167], v[60:63]
    s_add_u32 m0, s73, 16384
    ds_read2_b32 v[90:91], v239 offset0:66 offset1:67
    v_mfma_f32_16x16x32_bf16 v[60:63], v[148:151], v[168:171], v[60:63]
    buffer_load_dwordx4 v4, s[52:55], s14 offen offset:0 lds
    v_mfma_f32_16x16x32_bf16 v[60:63], v[144:147], v[172:175], v[60:63]
    ds_read_b128 v[124:127], v244 offset:28672
    v_mfma_f32_16x16x32_bf16 v[60:63], v[140:143], v[176:179], v[60:63]
    ds_read2_b32 v[92:93], v239 offset0:192 offset1:193
    v_mfma_f32_16x16x32_bf16 v[60:63], v[136:139], v[180:183], v[60:63]
    v_mfma_f32_16x16x32_bf16 v[60:63], v[132:135], v[184:187], v[60:63]
    ds_read2_b32 v[94:95], v239 offset0:194 offset1:195
    v_mfma_f32_16x16x32_bf16 v[60:63], v[128:131], v[188:191], v[60:63]
    s_waitcnt lgkmcnt(12)
    v_mfma_f32_16x16x32_bf16 v[32:35], v[64:67], v[96:99], v[32:35]
    ds_read_b128 v[160:163], v245 offset:0
    v_mfma_f32_16x16x32_bf16 v[36:39], v[68:71], v[96:99], v[36:39]
    s_add_u32 m0, s73, 16384
    ds_read2_b32 v[128:129], v236 offset0:80 offset1:81
    v_mfma_f32_16x16x32_bf16 v[36:39], v[64:67], v[100:103], v[36:39]
    buffer_load_dwordx4 v5, s[52:55], s14 offen offset:1024 lds
    ds_read2_b32 v[130:131], v236 offset0:82 offset1:83
    v_mfma_f32_16x16x32_bf16 v[40:43], v[64:67], v[104:107], v[40:43]
    ds_read_b128 v[164:167], v245 offset:4096
    v_mfma_f32_16x16x32_bf16 v[40:43], v[68:71], v[100:103], v[40:43]
    ds_read2_b32 v[132:133], v236 offset0:208 offset1:209
    v_mfma_f32_16x16x32_bf16 v[40:43], v[72:75], v[96:99], v[40:43]
    ds_read2_b32 v[134:135], v236 offset0:210 offset1:211
    v_mfma_f32_16x16x32_bf16 v[44:47], v[76:79], v[96:99], v[44:47]
    ds_read_b128 v[168:171], v245 offset:8192
    v_mfma_f32_16x16x32_bf16 v[44:47], v[72:75], v[100:103], v[44:47]
    ds_read2_b32 v[136:137], v237 offset0:80 offset1:81
    v_mfma_f32_16x16x32_bf16 v[44:47], v[68:71], v[104:107], v[44:47]
    s_add_u32 m0, s73, 16384
    ds_read2_b32 v[138:139], v237 offset0:82 offset1:83
    v_mfma_f32_16x16x32_bf16 v[44:47], v[64:67], v[108:111], v[44:47]
    buffer_load_dwordx4 v6, s[52:55], s14 offen offset:2048 lds
    ds_read_b128 v[172:175], v245 offset:12288
    s_waitcnt lgkmcnt(10)
    v_mfma_f32_16x16x32_bf16 v[48:51], v[64:67], v[112:115], v[48:51]
    ds_read2_b32 v[140:141], v237 offset0:208 offset1:209
    v_mfma_f32_16x16x32_bf16 v[48:51], v[68:71], v[108:111], v[48:51]
    ds_read2_b32 v[142:143], v237 offset0:210 offset1:211
    v_mfma_f32_16x16x32_bf16 v[48:51], v[72:75], v[104:107], v[48:51]
    ds_read_b128 v[176:179], v245 offset:16384
    v_mfma_f32_16x16x32_bf16 v[48:51], v[76:79], v[100:103], v[48:51]
    ds_read2_b32 v[144:145], v238 offset0:80 offset1:81
    v_mfma_f32_16x16x32_bf16 v[48:51], v[80:83], v[96:99], v[48:51]
    ds_read2_b32 v[146:147], v238 offset0:82 offset1:83
    s_waitcnt vmcnt(7)
    s_barrier
    v_mfma_f32_16x16x32_bf16 v[52:55], v[84:87], v[96:99], v[52:55]
    ds_read_b64_tr_b16 a[96:97], v10 offset:16384
    s_add_u32 m0, s73, 16384
    v_mfma_f32_16x16x32_bf16 v[52:55], v[80:83], v[100:103], v[52:55]
    buffer_load_dwordx4 v7, s[52:55], s14 offen offset:3072 lds
    ds_read_b128 v[180:183], v245 offset:20480
    v_mfma_f32_16x16x32_bf16 v[52:55], v[76:79], v[104:107], v[52:55]
    ds_read_b64_tr_b16 a[98:99], v10 offset:18432
    v_mfma_f32_16x16x32_bf16 v[52:55], v[72:75], v[108:111], v[52:55]
    ds_read_b64_tr_b16 a[104:105], v10 offset:20480
    v_mfma_f32_16x16x32_bf16 v[52:55], v[68:71], v[112:115], v[52:55]
    ds_read_b128 v[212:215], v241 offset:8352
    v_mfma_f32_16x16x32_bf16 v[52:55], v[64:67], v[116:119], v[52:55]
    ds_read_b64_tr_b16 a[106:107], v10 offset:22528
    v_mfma_f32_16x16x32_bf16 v[56:59], v[64:67], v[120:123], v[56:59]
    ds_read_b64_tr_b16 a[100:101], v11 offset:16384
    v_mfma_f32_16x16x32_bf16 v[56:59], v[68:71], v[116:119], v[56:59]
    ds_read_b32 v216, v241 offset:8368
    v_mfma_f32_16x16x32_bf16 v[56:59], v[72:75], v[112:115], v[56:59]
    ds_read_b64_tr_b16 a[102:103], v11 offset:18432
    v_mfma_f32_16x16x32_bf16 v[56:59], v[76:79], v[108:111], v[56:59]
    ds_read_b64_tr_b16 a[108:109], v11 offset:20480
    ds_read2_b32 v[148:149], v238 offset0:208 offset1:209
    v_mfma_f32_16x16x32_bf16 v[56:59], v[80:83], v[104:107], v[56:59]
    ds_read_b64_tr_b16 a[110:111], v11 offset:22528
    ds_read2_b32 v[150:151], v238 offset0:210 offset1:211
    v_mfma_f32_16x16x32_bf16 v[56:59], v[84:87], v[100:103], v[56:59]
    ds_read_b128 v[218:221], v241 offset:9376
    ds_read_b128 v[184:187], v245 offset:24576
    v_mfma_f32_16x16x32_bf16 v[56:59], v[88:91], v[96:99], v[56:59]
    ds_read_b32 v222, v241 offset:9392
    v_mfma_f32_16x16x32_bf16 v[60:63], v[92:95], v[96:99], v[60:63]
    ds_read_b128 v[224:227], v241 offset:10400
    ds_read2_b32 v[152:153], v239 offset0:80 offset1:81
    v_mfma_f32_16x16x32_bf16 v[60:63], v[88:91], v[100:103], v[60:63]
    ds_read2_b32 v[154:155], v239 offset0:82 offset1:83
    v_mfma_f32_16x16x32_bf16 v[60:63], v[84:87], v[104:107], v[60:63]
    ds_read_b32 v228, v241 offset:10416
    v_mfma_f32_16x16x32_bf16 v[60:63], v[80:83], v[108:111], v[60:63]
    ds_read_b128 v[188:191], v245 offset:28672
    v_mfma_f32_16x16x32_bf16 v[60:63], v[76:79], v[112:115], v[60:63]
    ds_read_b128 v[230:233], v241 offset:11424
    s_waitcnt lgkmcnt(10)
    s_barrier
    v_mfma_f32_16x16x32_bf16 v[60:63], v[72:75], v[116:119], v[60:63]
    ds_read2_b32 v[156:157], v239 offset0:208 offset1:209
    v_mfma_f32_16x16x32_bf16 v[60:63], v[68:71], v[120:123], v[60:63]
    ds_read_b32 v234, v241 offset:11440
    ds_read2_b32 v[158:159], v239 offset0:210 offset1:211
    v_mfma_f32_16x16x32_bf16 v[60:63], v[64:67], v[124:127], v[60:63]
    v_mfma_f32_16x16x32_bf16 v[32:35], v[128:131], v[160:163], v[32:35]
    s_lshl_b32 s14, s93, 18
    ds_read_b128 v[96:99], v246 offset:0
    v_mfma_f32_16x16x32_bf16 v[36:39], v[132:135], v[160:163], v[36:39]
    s_add_u32 m0, s73, 147456
    ds_read2_b32 v[64:65], v236 offset0:96 offset1:97
    v_mfma_f32_16x16x32_bf16 v[36:39], v[128:131], v[164:167], v[36:39]
    buffer_load_dwordx4 v4, s[52:55], s14 offen offset:0 lds
    ds_read2_b32 v[66:67], v236 offset0:98 offset1:99
    v_mfma_f32_16x16x32_bf16 v[40:43], v[128:131], v[168:171], v[40:43]
    ds_read_b128 v[100:103], v246 offset:4096
    v_mfma_f32_16x16x32_bf16 v[40:43], v[132:135], v[164:167], v[40:43]
    s_waitcnt lgkmcnt(5)
    ds_read2_b32 v[68:69], v236 offset0:224 offset1:225
    v_mfma_f32_16x16x32_bf16 v[40:43], v[136:139], v[160:163], v[40:43]
    ds_read2_b32 v[70:71], v236 offset0:226 offset1:227
    v_mfma_f32_16x16x32_bf16 v[44:47], v[140:143], v[160:163], v[44:47]
    ds_read_b128 v[104:107], v246 offset:8192
    v_mfma_f32_16x16x32_bf16 v[44:47], v[136:139], v[164:167], v[44:47]
    ds_read2_b32 v[72:73], v237 offset0:96 offset1:97
    v_mfma_f32_16x16x32_bf16 v[44:47], v[132:135], v[168:171], v[44:47]
    ds_read2_b32 v[74:75], v237 offset0:98 offset1:99
    s_add_u32 m0, s73, 147456
    v_lshlrev_b32 v9, 16, v9
    v_mfma_f32_16x16x32_bf16 v[44:47], v[128:131], v[172:175], v[44:47]
    buffer_load_dwordx4 v5, s[52:55], s14 offen offset:1024 lds
    ds_read_b128 v[108:111], v246 offset:12288
    s_waitcnt lgkmcnt(10)
    v_mfma_f32_16x16x32_bf16 v[48:51], v[128:131], v[176:179], v[48:51]
    ds_read2_b32 v[76:77], v237 offset0:224 offset1:225
    v_lshlrev_b32 v208, 16, v212
    v_mfma_f32_16x16x32_bf16 v[48:51], v[132:135], v[172:175], v[48:51]
    ds_read2_b32 v[78:79], v237 offset0:226 offset1:227
    v_mfma_f32_16x16x32_bf16 v[48:51], v[136:139], v[168:171], v[48:51]
    ds_read_b128 v[112:115], v246 offset:16384
    v_add_f32 v9, v9, v208
    v_mfma_f32_16x16x32_bf16 v[48:51], v[140:143], v[164:167], v[48:51]
    ds_read2_b32 v[80:81], v238 offset0:96 offset1:97
    v_cvt_pk_bf16_f32 v9, v9, v9
    v_mfma_f32_16x16x32_bf16 v[48:51], v[144:147], v[160:163], v[48:51]
    ds_write_b16 v242, v9 offset:12480
    v_mfma_f32_16x16x32_bf16 v[52:55], v[148:151], v[160:163], v[52:55]
    s_add_u32 m0, s73, 147456
    ds_read2_b32 v[82:83], v238 offset0:98 offset1:99
    v_mfma_f32_16x16x32_bf16 v[52:55], v[144:147], v[164:167], v[52:55]
    buffer_load_dwordx4 v6, s[52:55], s14 offen offset:2048 lds
    ds_read_b128 v[116:119], v246 offset:20480
    v_mfma_f32_16x16x32_bf16 v[52:55], v[140:143], v[168:171], v[52:55]
    ds_write_b16 v242, v9 offset:8322
    v_mfma_f32_16x16x32_bf16 v[52:55], v[136:139], v[172:175], v[52:55]
    ds_read2_b32 v[84:85], v238 offset0:224 offset1:225
    v_mfma_f32_16x16x32_bf16 v[52:55], v[132:135], v[176:179], v[52:55]
    ds_read2_b32 v[86:87], v238 offset0:226 offset1:227
    v_alignbit_b32 v212, v213, v212, 16
    v_mfma_f32_16x16x32_bf16 v[52:55], v[128:131], v[180:183], v[52:55]
    v_alignbit_b32 v213, v214, v213, 16
    v_alignbit_b32 v214, v215, v214, 16
    v_mfma_f32_16x16x32_bf16 v[56:59], v[128:131], v[184:187], v[56:59]
    s_waitcnt vmcnt(7)
    s_barrier
    v_alignbit_b32 v215, v216, v215, 16
    v_mfma_f32_16x16x32_bf16 v[56:59], v[132:135], v[180:183], v[56:59]
    v_add_u32 v10, -131072, v10
    s_add_u32 m0, s73, 147456
    v_mfma_f32_16x16x32_bf16 v[56:59], v[136:139], v[176:179], v[56:59]
    ds_read_b64_tr_b16 a[112:113], v10 offset:0
    buffer_load_dwordx4 v7, s[52:55], s14 offen offset:3072 lds
    v_mfma_f32_16x16x32_bf16 v[56:59], v[140:143], v[172:175], v[56:59]
    ds_write_b128 v241, v[212:215] offset:12512
    v_mfma_f32_16x16x32_bf16 v[56:59], v[144:147], v[168:171], v[56:59]
    ds_read_b64_tr_b16 a[114:115], v10 offset:2048
    ds_read_b128 v[120:123], v246 offset:24576
    v_mfma_f32_16x16x32_bf16 v[56:59], v[148:151], v[164:167], v[56:59]
    ds_read_b64_tr_b16 a[120:121], v10 offset:4096
    ds_read2_b32 v[88:89], v239 offset0:96 offset1:97
    v_mfma_f32_16x16x32_bf16 v[56:59], v[152:155], v[160:163], v[56:59]
    ds_read_b64_tr_b16 a[122:123], v10 offset:6144
    v_alignbit_b32 v218, v219, v218, 16
    v_mfma_f32_16x16x32_bf16 v[60:63], v[156:159], v[160:163], v[60:63]
    ds_read2_b32 v[90:91], v239 offset0:98 offset1:99
    v_add_u32 v11, -131072, v11
    v_mfma_f32_16x16x32_bf16 v[60:63], v[152:155], v[164:167], v[60:63]
    ds_read_b64_tr_b16 a[116:117], v11 offset:0
    v_alignbit_b32 v219, v220, v219, 16
    v_mfma_f32_16x16x32_bf16 v[60:63], v[148:151], v[168:171], v[60:63]
    ds_read_b128 v[124:127], v246 offset:28672
    ds_read2_b32 v[92:93], v239 offset0:224 offset1:225
    v_mfma_f32_16x16x32_bf16 v[60:63], v[144:147], v[172:175], v[60:63]
    ds_read_b64_tr_b16 a[118:119], v11 offset:2048
    v_alignbit_b32 v220, v221, v220, 16
    v_mfma_f32_16x16x32_bf16 v[60:63], v[140:143], v[176:179], v[60:63]
    ds_read_b64_tr_b16 a[124:125], v11 offset:4096
    ds_read2_b32 v[94:95], v239 offset0:226 offset1:227
    v_mfma_f32_16x16x32_bf16 v[60:63], v[136:139], v[180:183], v[60:63]
    ds_read_b64_tr_b16 a[126:127], v11 offset:6144
    v_alignbit_b32 v221, v222, v221, 16
    v_mfma_f32_16x16x32_bf16 v[60:63], v[132:135], v[184:187], v[60:63]
    ds_write_b128 v241, v[218:221] offset:13536
    v_mfma_f32_16x16x32_bf16 v[60:63], v[128:131], v[188:191], v[60:63]
    s_waitcnt lgkmcnt(15)
    v_mfma_f32_16x16x32_bf16 v[32:35], v[64:67], v[96:99], v[32:35]
    ds_read_b128 v[160:163], v247 offset:0
    v_mfma_f32_16x16x32_bf16 v[36:39], v[68:71], v[96:99], v[36:39]
    v_alignbit_b32 v224, v225, v224, 16
    v_mfma_f32_16x16x32_bf16 v[36:39], v[64:67], v[100:103], v[36:39]
    ds_read_b128 v[164:167], v247 offset:4096
    v_mfma_f32_16x16x32_bf16 v[40:43], v[64:67], v[104:107], v[40:43]
    ds_read_b128 v[168:171], v247 offset:8192
    s_waitcnt lgkmcnt(4)
    s_barrier
    v_mfma_f32_16x16x32_bf16 v[40:43], v[68:71], v[100:103], v[40:43]
    ds_read_b128 v[172:175], v247 offset:12288
    v_mfma_f32_16x16x32_bf16 v[40:43], v[72:75], v[96:99], v[40:43]
    v_alignbit_b32 v225, v226, v225, 16
    v_mfma_f32_16x16x32_bf16 v[44:47], v[76:79], v[96:99], v[44:47]
    ds_read_b128 v[176:179], v247 offset:16384
    v_mfma_f32_16x16x32_bf16 v[44:47], v[72:75], v[100:103], v[44:47]
    s_lshl_b32 s14, s94, 18
    ds_read_b128 v[180:183], v247 offset:20480
    v_mfma_f32_16x16x32_bf16 v[44:47], v[68:71], v[104:107], v[44:47]
    s_add_u32 m0, s73, 0
    v_alignbit_b32 v226, v227, v226, 16
    v_mfma_f32_16x16x32_bf16 v[44:47], v[64:67], v[108:111], v[44:47]
    buffer_load_dwordx4 v4, s[52:55], s14 offen offset:0 lds
    ds_read_b128 v[184:187], v247 offset:24576
    v_mfma_f32_16x16x32_bf16 v[48:51], v[64:67], v[112:115], v[48:51]
    ds_read_b128 v[188:191], v247 offset:28672
    v_mfma_f32_16x16x32_bf16 v[48:51], v[68:71], v[108:111], v[48:51]
    ds_read2_b32 v[128:129], v236 offset0:112 offset1:113
    v_mfma_f32_16x16x32_bf16 v[48:51], v[72:75], v[104:107], v[48:51]
    v_alignbit_b32 v227, v228, v227, 16
    v_mfma_f32_16x16x32_bf16 v[48:51], v[76:79], v[100:103], v[48:51]
    ds_read2_b32 v[130:131], v236 offset0:114 offset1:115
    v_mfma_f32_16x16x32_bf16 v[48:51], v[80:83], v[96:99], v[48:51]
    ds_read2_b32 v[132:133], v236 offset0:240 offset1:241
    v_mfma_f32_16x16x32_bf16 v[52:55], v[84:87], v[96:99], v[52:55]
    s_add_u32 m0, s73, 0
    ds_read2_b32 v[134:135], v236 offset0:242 offset1:243
    v_mfma_f32_16x16x32_bf16 v[52:55], v[80:83], v[100:103], v[52:55]
    buffer_load_dwordx4 v5, s[52:55], s14 offen offset:1024 lds
    ds_read2_b32 v[136:137], v237 offset0:112 offset1:113
    v_mfma_f32_16x16x32_bf16 v[52:55], v[76:79], v[104:107], v[52:55]
    ds_write_b128 v241, v[224:227] offset:14560
    v_mfma_f32_16x16x32_bf16 v[52:55], v[72:75], v[108:111], v[52:55]
    ds_read2_b32 v[138:139], v237 offset0:114 offset1:115
    s_add_u32 s6, s12, 4751360
    ds_read2_b32 v[140:141], v237 offset0:240 offset1:241
    v_mfma_f32_16x16x32_bf16 v[52:55], v[68:71], v[112:115], v[52:55]
    ds_read2_b32 v[142:143], v237 offset0:242 offset1:243
    v_alignbit_b32 v230, v231, v230, 16
    v_mfma_f32_16x16x32_bf16 v[52:55], v[64:67], v[116:119], v[52:55]
    ds_read2_b32 v[144:145], v238 offset0:112 offset1:113
    v_xor_b32 v244, 64, v244
    v_mfma_f32_16x16x32_bf16 v[56:59], v[64:67], v[120:123], v[56:59]
    ds_read2_b32 v[146:147], v238 offset0:114 offset1:115
    v_mfma_f32_16x16x32_bf16 v[56:59], v[68:71], v[116:119], v[56:59]
    s_add_u32 m0, s73, 0
    ds_read2_b32 v[148:149], v238 offset0:240 offset1:241
    v_mfma_f32_16x16x32_bf16 v[56:59], v[72:75], v[112:115], v[56:59]
    buffer_load_dwordx4 v6, s[52:55], s14 offen offset:2048 lds
    v_alignbit_b32 v231, v232, v231, 16
    v_mfma_f32_16x16x32_bf16 v[56:59], v[76:79], v[108:111], v[56:59]
    ds_read2_b32 v[150:151], v238 offset0:242 offset1:243
    v_xor_b32 v245, 64, v245
    v_mfma_f32_16x16x32_bf16 v[56:59], v[80:83], v[104:107], v[56:59]
    ds_read2_b32 v[152:153], v239 offset0:112 offset1:113
    v_mfma_f32_16x16x32_bf16 v[56:59], v[84:87], v[100:103], v[56:59]
    ds_read2_b32 v[154:155], v239 offset0:114 offset1:115
    v_mfma_f32_16x16x32_bf16 v[56:59], v[88:91], v[96:99], v[56:59]
    ds_read2_b32 v[156:157], v239 offset0:240 offset1:241
    v_alignbit_b32 v232, v233, v232, 16
    v_mfma_f32_16x16x32_bf16 v[60:63], v[92:95], v[96:99], v[60:63]
    ds_read2_b32 v[158:159], v239 offset0:242 offset1:243
    s_waitcnt vmcnt(7)
    s_barrier
    v_mfma_f32_16x16x32_bf16 v[60:63], v[88:91], v[100:103], v[60:63]
    s_add_u32 m0, s73, 0
    v_xor_b32 v246, 64, v246
    v_add_u32 v236, 8320, v236
    v_mfma_f32_16x16x32_bf16 v[60:63], v[84:87], v[104:107], v[60:63]
    ds_read_b64_tr_b16 a[128:129], v10 offset:16384
    buffer_load_dwordx4 v7, s[52:55], s14 offen offset:3072 lds
    v_mfma_f32_16x16x32_bf16 v[60:63], v[80:83], v[108:111], v[60:63]
    ds_read_b64_tr_b16 a[130:131], v10 offset:18432
    v_alignbit_b32 v233, v234, v233, 16
    v_add_u32 v237, 8320, v237
    v_mfma_f32_16x16x32_bf16 v[60:63], v[76:79], v[112:115], v[60:63]
    ds_write_b128 v241, v[230:233] offset:15584
    v_mfma_f32_16x16x32_bf16 v[60:63], v[72:75], v[116:119], v[60:63]
    ds_read_b64_tr_b16 a[136:137], v10 offset:20480
    v_xor_b32 v247, 64, v247
    v_mfma_f32_16x16x32_bf16 v[60:63], v[68:71], v[120:123], v[60:63]
    ds_read_b64_tr_b16 a[138:139], v10 offset:22528
    v_add_u32 v238, 8320, v238
    v_mfma_f32_16x16x32_bf16 v[60:63], v[64:67], v[124:127], v[60:63]
    v_add_u32 v239, 8320, v239
    s_waitcnt lgkmcnt(5)
    v_mfma_f32_16x16x32_bf16 v[60:63], v[128:131], v[188:191], v[60:63]
    ds_read_b64_tr_b16 a[132:133], v11 offset:16384
    v_mfma_f32_16x16x32_bf16 v[60:63], v[132:135], v[184:187], v[60:63]
    ds_read_b64_tr_b16 a[134:135], v11 offset:18432
    v_mfma_f32_16x16x32_bf16 v[60:63], v[136:139], v[180:183], v[60:63]
    ds_read_b64_tr_b16 a[140:141], v11 offset:20480
    v_mfma_f32_16x16x32_bf16 v[60:63], v[140:143], v[176:179], v[60:63]
    ds_read_b128 v[96:99], v244 offset:2048
    v_mfma_f32_16x16x32_bf16 v[60:63], v[144:147], v[172:175], v[60:63]
    ds_read_b64_tr_b16 a[142:143], v11 offset:22528
    v_mfma_f32_16x16x32_bf16 v[60:63], v[148:151], v[168:171], v[60:63]
    ds_read2_b32 v[64:65], v236 offset0:0 offset1:1
    v_mfma_f32_16x16x32_bf16 v[60:63], v[152:155], v[164:167], v[60:63]
    ds_read2_b32 v[66:67], v236 offset0:2 offset1:3
    v_mfma_f32_16x16x32_bf16 v[60:63], v[156:159], v[160:163], v[60:63]
    ds_read_b128 v[100:103], v244 offset:6144
    v_mfma_f32_16x16x32_bf16 v[56:59], v[128:131], v[184:187], v[56:59]
    ds_read2_b32 v[68:69], v236 offset0:128 offset1:129
    v_mfma_f32_16x16x32_bf16 v[56:59], v[132:135], v[180:183], v[56:59]
    ds_read2_b32 v[70:71], v236 offset0:130 offset1:131
    v_mfma_f32_16x16x32_bf16 v[56:59], v[136:139], v[176:179], v[56:59]
    ds_read_b128 v[104:107], v244 offset:10240
    s_waitcnt lgkmcnt(6)
    s_barrier
    v_mfma_f32_16x16x32_bf16 v[56:59], v[140:143], v[172:175], v[56:59]
    ds_read2_b32 v[72:73], v237 offset0:0 offset1:1
    v_mfma_f32_16x16x32_bf16 v[56:59], v[144:147], v[168:171], v[56:59]
    ds_read2_b32 v[74:75], v237 offset0:2 offset1:3
    v_mfma_f32_16x16x32_bf16 v[56:59], v[148:151], v[164:167], v[56:59]
    ds_read_b128 v[108:111], v244 offset:14336
    v_cvt_pk_bf16_f32 v206, v60, v61
    v_mfma_f32_16x16x32_bf16 v[56:59], v[152:155], v[160:163], v[56:59]
    s_lshl_b32 s14, s95, 18
    ds_read2_b32 v[76:77], v237 offset0:128 offset1:129
    v_mfma_f32_16x16x32_bf16 v[52:55], v[128:131], v[180:183], v[52:55]
    s_add_u32 m0, s73, 16384
    ds_read2_b32 v[78:79], v237 offset0:130 offset1:131
    v_mfma_f32_16x16x32_bf16 v[52:55], v[132:135], v[176:179], v[52:55]
    buffer_load_dwordx4 v4, s[52:55], s14 offen offset:0 lds
    v_cvt_pk_bf16_f32 v207, v62, v63
    v_mfma_f32_16x16x32_bf16 v[52:55], v[136:139], v[172:175], v[52:55]
    ds_read_b128 v[112:115], v244 offset:18432
    v_mfma_f32_16x16x32_bf16 v[52:55], v[140:143], v[168:171], v[52:55]
    buffer_store_dwordx2 v[206:207], v8, s[44:47], s6 offen offset:3584 sc1
    ds_read2_b32 v[80:81], v238 offset0:0 offset1:1
    v_mfma_f32_16x16x32_bf16 v[52:55], v[144:147], v[164:167], v[52:55]
    ds_read2_b32 v[82:83], v238 offset0:2 offset1:3
    v_mfma_f32_16x16x32_bf16 v[52:55], v[148:151], v[160:163], v[52:55]
    ds_read_b128 v[116:119], v244 offset:22528
    v_mfma_f32_16x16x32_bf16 v[48:51], v[128:131], v[176:179], v[48:51]
    ds_read2_b32 v[84:85], v238 offset0:128 offset1:129
    v_cvt_pk_bf16_f32 v204, v56, v57
    v_mfma_f32_16x16x32_bf16 v[48:51], v[132:135], v[172:175], v[48:51]
    s_add_u32 m0, s73, 16384
    ds_read2_b32 v[86:87], v238 offset0:130 offset1:131
    v_mfma_f32_16x16x32_bf16 v[48:51], v[136:139], v[168:171], v[48:51]
    buffer_load_dwordx4 v5, s[52:55], s14 offen offset:1024 lds
    ds_read_b128 v[120:123], v244 offset:26624
    v_mfma_f32_16x16x32_bf16 v[48:51], v[140:143], v[164:167], v[48:51]
    ds_read2_b32 v[88:89], v239 offset0:0 offset1:1
    v_cvt_pk_bf16_f32 v205, v58, v59
    v_mfma_f32_16x16x32_bf16 v[48:51], v[144:147], v[160:163], v[48:51]
    ds_read2_b32 v[90:91], v239 offset0:2 offset1:3
    v_mfma_f32_16x16x32_bf16 v[44:47], v[128:131], v[172:175], v[44:47]
    buffer_store_dwordx2 v[204:205], v8, s[44:47], s6 offen offset:3072 sc1
    ds_read_b128 v[124:127], v244 offset:30720
    v_mfma_f32_16x16x32_bf16 v[44:47], v[132:135], v[168:171], v[44:47]
    ds_read2_b32 v[92:93], v239 offset0:128 offset1:129
    v_mfma_f32_16x16x32_bf16 v[44:47], v[136:139], v[164:167], v[44:47]
    ds_read2_b32 v[94:95], v239 offset0:130 offset1:131
    v_mfma_f32_16x16x32_bf16 v[44:47], v[140:143], v[160:163], v[44:47]
    s_add_u32 m0, s73, 16384
    v_cvt_pk_bf16_f32 v202, v52, v53
    v_mfma_f32_16x16x32_bf16 v[40:43], v[128:131], v[168:171], v[40:43]
    buffer_load_dwordx4 v6, s[52:55], s14 offen offset:2048 lds
    v_mfma_f32_16x16x32_bf16 v[40:43], v[132:135], v[164:167], v[40:43]
    v_mfma_f32_16x16x32_bf16 v[40:43], v[136:139], v[160:163], v[40:43]
    v_cvt_pk_bf16_f32 v203, v54, v55
    v_mfma_f32_16x16x32_bf16 v[36:39], v[128:131], v[164:167], v[36:39]
    v_mfma_f32_16x16x32_bf16 v[36:39], v[132:135], v[160:163], v[36:39]
    buffer_store_dwordx2 v[202:203], v8, s[44:47], s6 offen offset:2560 sc1
    v_mfma_f32_16x16x32_bf16 v[32:35], v[128:131], v[160:163], v[32:35]
    s_waitcnt lgkmcnt(0)
    v_mfma_f32_16x16x32_bf16 v[60:63], v[64:67], v[124:127], 0
    ds_read_b128 v[160:163], v245 offset:2048
    s_waitcnt vmcnt(10)
    s_barrier
    v_cvt_pk_bf16_f32 v200, v48, v49
    v_mfma_f32_16x16x32_bf16 v[60:63], v[68:71], v[120:123], v[60:63]
    v_add_u32 v10, 131072, v10
    s_add_u32 m0, s73, 16384
    v_mfma_f32_16x16x32_bf16 v[60:63], v[72:75], v[116:119], v[60:63]
    ds_read_b64_tr_b16 a[144:145], v10 offset:16384
    buffer_load_dwordx4 v7, s[52:55], s14 offen offset:3072 lds
    v_mfma_f32_16x16x32_bf16 v[60:63], v[76:79], v[112:115], v[60:63]
    ds_read_b64_tr_b16 a[146:147], v10 offset:18432
    v_cvt_pk_bf16_f32 v201, v50, v51
    v_mfma_f32_16x16x32_bf16 v[60:63], v[80:83], v[108:111], v[60:63]
    ds_read_b64_tr_b16 a[152:153], v10 offset:20480
    v_mfma_f32_16x16x32_bf16 v[60:63], v[84:87], v[104:107], v[60:63]
    buffer_store_dwordx2 v[200:201], v8, s[44:47], s6 offen offset:2048 sc1
    ds_read_b64_tr_b16 a[154:155], v10 offset:22528
    v_mfma_f32_16x16x32_bf16 v[60:63], v[88:91], v[100:103], v[60:63]
    ds_read2_b32 v[128:129], v236 offset0:16 offset1:17
    v_mfma_f32_16x16x32_bf16 v[60:63], v[92:95], v[96:99], v[60:63]
    v_add_u32 v11, 131072, v11
    v_cvt_pk_bf16_f32 v198, v44, v45
    v_mfma_f32_16x16x32_bf16 v[56:59], v[64:67], v[120:123], 0
    ds_read_b64_tr_b16 a[148:149], v11 offset:16384
    v_mfma_f32_16x16x32_bf16 v[56:59], v[68:71], v[116:119], v[56:59]
    ds_read_b64_tr_b16 a[150:151], v11 offset:18432
    v_mfma_f32_16x16x32_bf16 v[56:59], v[72:75], v[112:115], v[56:59]
    ds_read_b64_tr_b16 a[156:157], v11 offset:20480
    v_cvt_pk_bf16_f32 v199, v46, v47
    v_mfma_f32_16x16x32_bf16 v[56:59], v[76:79], v[108:111], v[56:59]
    ds_read_b64_tr_b16 a[158:159], v11 offset:22528
    v_mfma_f32_16x16x32_bf16 v[56:59], v[80:83], v[104:107], v[56:59]
    buffer_store_dwordx2 v[198:199], v8, s[44:47], s6 offen offset:1536 sc1
    ds_read2_b32 v[130:131], v236 offset0:18 offset1:19
    v_mfma_f32_16x16x32_bf16 v[56:59], v[84:87], v[100:103], v[56:59]
    ds_read_b128 v[164:167], v245 offset:6144
    v_mfma_f32_16x16x32_bf16 v[56:59], v[88:91], v[96:99], v[56:59]
    ds_read2_b32 v[132:133], v236 offset0:144 offset1:145
    v_cvt_pk_bf16_f32 v196, v40, v41
    v_mfma_f32_16x16x32_bf16 v[52:55], v[64:67], v[116:119], 0
    ds_read2_b32 v[134:135], v236 offset0:146 offset1:147
    v_mfma_f32_16x16x32_bf16 v[52:55], v[68:71], v[112:115], v[52:55]
    ds_read_b128 v[168:171], v245 offset:10240
    v_cvt_pk_bf16_f32 v197, v42, v43
    v_mfma_f32_16x16x32_bf16 v[52:55], v[72:75], v[108:111], v[52:55]
    ds_read2_b32 v[136:137], v237 offset0:16 offset1:17
    v_mfma_f32_16x16x32_bf16 v[52:55], v[76:79], v[104:107], v[52:55]
    buffer_store_dwordx2 v[196:197], v8, s[44:47], s6 offen offset:1024 sc1
    ds_read2_b32 v[138:139], v237 offset0:18 offset1:19
    s_waitcnt lgkmcnt(7)
    s_barrier
    v_mfma_f32_16x16x32_bf16 v[52:55], v[80:83], v[100:103], v[52:55]
    ds_read_b128 v[172:175], v245 offset:14336
    v_mfma_f32_16x16x32_bf16 v[52:55], v[84:87], v[96:99], v[52:55]
    ds_read2_b32 v[140:141], v237 offset0:144 offset1:145
    v_cvt_pk_bf16_f32 v194, v36, v37
    v_mfma_f32_16x16x32_bf16 v[48:51], v[64:67], v[112:115], 0
    s_lshl_b32 s14, s96, 18
    ds_read2_b32 v[142:143], v237 offset0:146 offset1:147
    v_mfma_f32_16x16x32_bf16 v[48:51], v[68:71], v[108:111], v[48:51]
    s_add_u32 m0, s73, 147456
    ds_read_b128 v[176:179], v245 offset:18432
    v_mfma_f32_16x16x32_bf16 v[48:51], v[72:75], v[104:107], v[48:51]
L_pl_X_5:
    s_cbranch_execz L_wret
    buffer_load_dwordx4 v4, s[52:55], s14 offen offset:0 lds
    v_cvt_pk_bf16_f32 v195, v38, v39
    v_mfma_f32_16x16x32_bf16 v[48:51], v[76:79], v[100:103], v[48:51]
    ds_read2_b32 v[144:145], v238 offset0:16 offset1:17
    v_mfma_f32_16x16x32_bf16 v[48:51], v[80:83], v[96:99], v[48:51]
    buffer_store_dwordx2 v[194:195], v8, s[44:47], s6 offen offset:512 sc1
    ds_read2_b32 v[146:147], v238 offset0:18 offset1:19
    v_mfma_f32_16x16x32_bf16 v[44:47], v[64:67], v[108:111], 0
    ds_read_b128 v[180:183], v245 offset:22528
    v_mfma_f32_16x16x32_bf16 v[44:47], v[68:71], v[104:107], v[44:47]
    ds_read2_b32 v[148:149], v238 offset0:144 offset1:145
    v_cvt_pk_bf16_f32 v192, v32, v33
    v_mfma_f32_16x16x32_bf16 v[44:47], v[72:75], v[100:103], v[44:47]
    ds_read2_b32 v[150:151], v238 offset0:146 offset1:147
    v_mfma_f32_16x16x32_bf16 v[44:47], v[76:79], v[96:99], v[44:47]
    ds_read_b128 v[184:187], v245 offset:26624
    s_add_u32 m0, s73, 147456
    v_cvt_pk_bf16_f32 v193, v34, v35
    v_mfma_f32_16x16x32_bf16 v[40:43], v[64:67], v[104:107], 0
    buffer_load_dwordx4 v5, s[52:55], s14 offen offset:1024 lds
    ds_read2_b32 v[152:153], v239 offset0:16 offset1:17
    v_mfma_f32_16x16x32_bf16 v[40:43], v[68:71], v[100:103], v[40:43]
    buffer_store_dwordx2 v[192:193], v8, s[44:47], s6 offen offset:0 sc1
    ds_read2_b32 v[154:155], v239 offset0:18 offset1:19
    v_mfma_f32_16x16x32_bf16 v[40:43], v[72:75], v[96:99], v[40:43]
    ds_read_b128 v[188:191], v245 offset:30720
    v_mfma_f32_16x16x32_bf16 v[36:39], v[64:67], v[100:103], 0
    ds_read2_b32 v[156:157], v239 offset0:144 offset1:145
    v_mfma_f32_16x16x32_bf16 v[36:39], v[68:71], v[96:99], v[36:39]
    ds_read2_b32 v[158:159], v239 offset0:146 offset1:147
    v_mfma_f32_16x16x32_bf16 v[32:35], v[64:67], v[96:99], 0
    s_waitcnt lgkmcnt(12)
    v_mfma_f32_16x16x32_bf16 v[32:35], v[128:131], v[160:163], v[32:35]
    ds_read_b128 v[96:99], v246 offset:2048
    v_mfma_f32_16x16x32_bf16 v[36:39], v[132:135], v[160:163], v[36:39]
    s_add_u32 m0, s73, 147456
    ds_read2_b32 v[64:65], v236 offset0:32 offset1:33
    v_mfma_f32_16x16x32_bf16 v[36:39], v[128:131], v[164:167], v[36:39]
    buffer_load_dwordx4 v6, s[52:55], s14 offen offset:2048 lds
    ds_read2_b32 v[66:67], v236 offset0:34 offset1:35
    v_mfma_f32_16x16x32_bf16 v[40:43], v[128:131], v[168:171], v[40:43]
    ds_read_b128 v[100:103], v246 offset:6144
    v_mfma_f32_16x16x32_bf16 v[40:43], v[132:135], v[164:167], v[40:43]
    ds_read2_b32 v[68:69], v236 offset0:160 offset1:161
    v_mfma_f32_16x16x32_bf16 v[40:43], v[136:139], v[160:163], v[40:43]
    ds_read2_b32 v[70:71], v236 offset0:162 offset1:163
    v_mfma_f32_16x16x32_bf16 v[44:47], v[140:143], v[160:163], v[44:47]
    ds_read_b128 v[104:107], v246 offset:10240
    v_mfma_f32_16x16x32_bf16 v[44:47], v[136:139], v[164:167], v[44:47]
    ds_read2_b32 v[72:73], v237 offset0:32 offset1:33
    s_waitcnt vmcnt(15)
    s_barrier
    v_mfma_f32_16x16x32_bf16 v[44:47], v[132:135], v[168:171], v[44:47]
    v_add_u32 v10, -131072, v10
    s_add_u32 m0, s73, 147456
    v_mfma_f32_16x16x32_bf16 v[44:47], v[128:131], v[172:175], v[44:47]
    ds_read_b64_tr_b16 a[160:161], v10 offset:0
    buffer_load_dwordx4 v7, s[52:55], s14 offen offset:3072 lds
    s_waitcnt lgkmcnt(9)
    v_mfma_f32_16x16x32_bf16 v[48:51], v[128:131], v[176:179], v[48:51]
    ds_read_b64_tr_b16 a[162:163], v10 offset:2048
    v_mfma_f32_16x16x32_bf16 v[48:51], v[132:135], v[172:175], v[48:51]
    ds_read_b64_tr_b16 a[168:169], v10 offset:4096
    v_mfma_f32_16x16x32_bf16 v[48:51], v[136:139], v[168:171], v[48:51]
    ds_read2_b32 v[74:75], v237 offset0:34 offset1:35
    v_mfma_f32_16x16x32_bf16 v[48:51], v[140:143], v[164:167], v[48:51]
    ds_read_b64_tr_b16 a[170:171], v10 offset:6144
    v_mfma_f32_16x16x32_bf16 v[48:51], v[144:147], v[160:163], v[48:51]
    ds_read_b128 v[108:111], v246 offset:14336
    v_add_u32 v11, -131072, v11
    v_mfma_f32_16x16x32_bf16 v[52:55], v[148:151], v[160:163], v[52:55]
    ds_read_b64_tr_b16 a[164:165], v11 offset:0
    v_mfma_f32_16x16x32_bf16 v[52:55], v[144:147], v[164:167], v[52:55]
    ds_read_b64_tr_b16 a[166:167], v11 offset:2048
    v_mfma_f32_16x16x32_bf16 v[52:55], v[140:143], v[168:171], v[52:55]
    ds_read_b64_tr_b16 a[172:173], v11 offset:4096
    v_mfma_f32_16x16x32_bf16 v[52:55], v[136:139], v[172:175], v[52:55]
    ds_read_b64_tr_b16 a[174:175], v11 offset:6144
    v_mfma_f32_16x16x32_bf16 v[52:55], v[132:135], v[176:179], v[52:55]
    ds_read2_b32 v[76:77], v237 offset0:160 offset1:161
    v_mfma_f32_16x16x32_bf16 v[52:55], v[128:131], v[180:183], v[52:55]
    ds_read2_b32 v[78:79], v237 offset0:162 offset1:163
    v_mfma_f32_16x16x32_bf16 v[56:59], v[128:131], v[184:187], v[56:59]
    ds_read_b128 v[112:115], v246 offset:18432
    v_mfma_f32_16x16x32_bf16 v[56:59], v[132:135], v[180:183], v[56:59]
    ds_read2_b32 v[80:81], v238 offset0:32 offset1:33
    v_mfma_f32_16x16x32_bf16 v[56:59], v[136:139], v[176:179], v[56:59]
    ds_read2_b32 v[82:83], v238 offset0:34 offset1:35
    v_mfma_f32_16x16x32_bf16 v[56:59], v[140:143], v[172:175], v[56:59]
    ds_read_b128 v[116:119], v246 offset:22528
    v_mfma_f32_16x16x32_bf16 v[56:59], v[144:147], v[168:171], v[56:59]
    ds_read2_b32 v[84:85], v238 offset0:160 offset1:161
    s_waitcnt lgkmcnt(7)
    s_barrier
    v_mfma_f32_16x16x32_bf16 v[56:59], v[148:151], v[164:167], v[56:59]
    ds_read2_b32 v[86:87], v238 offset0:162 offset1:163
    v_mfma_f32_16x16x32_bf16 v[56:59], v[152:155], v[160:163], v[56:59]
    ds_read_b128 v[120:123], v246 offset:26624
    v_mfma_f32_16x16x32_bf16 v[60:63], v[156:159], v[160:163], v[60:63]
    s_lshl_b32 s14, s97, 18
    ds_read2_b32 v[88:89], v239 offset0:32 offset1:33
    v_mfma_f32_16x16x32_bf16 v[60:63], v[152:155], v[164:167], v[60:63]
    s_add_u32 m0, s73, 0
    ds_read2_b32 v[90:91], v239 offset0:34 offset1:35
    v_mfma_f32_16x16x32_bf16 v[60:63], v[148:151], v[168:171], v[60:63]
    buffer_load_dwordx4 v4, s[52:55], s14 offen offset:0 lds
    v_mfma_f32_16x16x32_bf16 v[60:63], v[144:147], v[172:175], v[60:63]
    ds_read_b128 v[124:127], v246 offset:30720
    v_mfma_f32_16x16x32_bf16 v[60:63], v[140:143], v[176:179], v[60:63]
    ds_read2_b32 v[92:93], v239 offset0:160 offset1:161
    v_mfma_f32_16x16x32_bf16 v[60:63], v[136:139], v[180:183], v[60:63]
    v_mfma_f32_16x16x32_bf16 v[60:63], v[132:135], v[184:187], v[60:63]
    ds_read2_b32 v[94:95], v239 offset0:162 offset1:163
    v_mfma_f32_16x16x32_bf16 v[60:63], v[128:131], v[188:191], v[60:63]
    s_waitcnt lgkmcnt(12)
    v_mfma_f32_16x16x32_bf16 v[32:35], v[64:67], v[96:99], v[32:35]
    ds_read_b128 v[160:163], v247 offset:2048
    v_mfma_f32_16x16x32_bf16 v[36:39], v[68:71], v[96:99], v[36:39]
    s_add_u32 m0, s73, 0
    v_mfma_f32_16x16x32_bf16 v[36:39], v[64:67], v[100:103], v[36:39]
    buffer_load_dwordx4 v5, s[52:55], s14 offen offset:1024 lds
    ds_read2_b32 v[128:129], v236 offset0:48 offset1:49
    v_mfma_f32_16x16x32_bf16 v[40:43], v[64:67], v[104:107], v[40:43]
    ds_read2_b32 v[130:131], v236 offset0:50 offset1:51
    v_mfma_f32_16x16x32_bf16 v[40:43], v[68:71], v[100:103], v[40:43]
    v_mfma_f32_16x16x32_bf16 v[40:43], v[72:75], v[96:99], v[40:43]
    ds_read_b128 v[164:167], v247 offset:6144
    v_mfma_f32_16x16x32_bf16 v[44:47], v[76:79], v[96:99], v[44:47]
    ds_read2_b32 v[132:133], v236 offset0:176 offset1:177
    v_mfma_f32_16x16x32_bf16 v[44:47], v[72:75], v[100:103], v[44:47]
    v_mfma_f32_16x16x32_bf16 v[44:47], v[68:71], v[104:107], v[44:47]
    s_add_u32 m0, s73, 0
    ds_read2_b32 v[134:135], v236 offset0:178 offset1:179
    v_mfma_f32_16x16x32_bf16 v[44:47], v[64:67], v[108:111], v[44:47]
    buffer_load_dwordx4 v6, s[52:55], s14 offen offset:2048 lds
    ds_read_b128 v[168:171], v247 offset:10240
    s_waitcnt lgkmcnt(7)
    v_mfma_f32_16x16x32_bf16 v[48:51], v[64:67], v[112:115], v[48:51]
    ds_read2_b32 v[136:137], v237 offset0:48 offset1:49
    v_mfma_f32_16x16x32_bf16 v[48:51], v[68:71], v[108:111], v[48:51]
    ds_read2_b32 v[138:139], v237 offset0:50 offset1:51
    v_mfma_f32_16x16x32_bf16 v[48:51], v[72:75], v[104:107], v[48:51]
    ds_read_b128 v[172:175], v247 offset:14336
    v_mfma_f32_16x16x32_bf16 v[48:51], v[76:79], v[100:103], v[48:51]
    ds_read2_b32 v[140:141], v237 offset0:176 offset1:177
    v_mfma_f32_16x16x32_bf16 v[48:51], v[80:83], v[96:99], v[48:51]
    ds_read2_b32 v[142:143], v237 offset0:178 offset1:179
    s_waitcnt vmcnt(12)
    s_barrier
    v_mfma_f32_16x16x32_bf16 v[52:55], v[84:87], v[96:99], v[52:55]
    ds_read_b64_tr_b16 a[176:177], v10 offset:16384
    s_add_u32 m0, s73, 0
    v_mfma_f32_16x16x32_bf16 v[52:55], v[80:83], v[100:103], v[52:55]
    buffer_load_dwordx4 v7, s[52:55], s14 offen offset:3072 lds
    ds_read_b128 v[176:179], v247 offset:18432
    v_mfma_f32_16x16x32_bf16 v[52:55], v[76:79], v[104:107], v[52:55]
    ds_read_b64_tr_b16 a[178:179], v10 offset:18432
    v_mfma_f32_16x16x32_bf16 v[52:55], v[72:75], v[108:111], v[52:55]
    ds_read_b64_tr_b16 a[184:185], v10 offset:20480
    v_mfma_f32_16x16x32_bf16 v[52:55], v[68:71], v[112:115], v[52:55]
    ds_read2_b32 v[144:145], v238 offset0:48 offset1:49
    v_mfma_f32_16x16x32_bf16 v[52:55], v[64:67], v[116:119], v[52:55]
    ds_read_b64_tr_b16 a[186:187], v10 offset:22528
    v_mfma_f32_16x16x32_bf16 v[56:59], v[64:67], v[120:123], v[56:59]
    ds_read_b64_tr_b16 a[180:181], v11 offset:16384
    v_mfma_f32_16x16x32_bf16 v[56:59], v[68:71], v[116:119], v[56:59]
    ds_read2_b32 v[146:147], v238 offset0:50 offset1:51
    v_mfma_f32_16x16x32_bf16 v[56:59], v[72:75], v[112:115], v[56:59]
    ds_read_b64_tr_b16 a[182:183], v11 offset:18432
    v_mfma_f32_16x16x32_bf16 v[56:59], v[76:79], v[108:111], v[56:59]
    ds_read_b64_tr_b16 a[188:189], v11 offset:20480
    v_mfma_f32_16x16x32_bf16 v[56:59], v[80:83], v[104:107], v[56:59]
    ds_read_b64_tr_b16 a[190:191], v11 offset:22528
    v_mfma_f32_16x16x32_bf16 v[56:59], v[84:87], v[100:103], v[56:59]
    ds_read_b128 v[180:183], v247 offset:22528
    v_mfma_f32_16x16x32_bf16 v[56:59], v[88:91], v[96:99], v[56:59]
    ds_read2_b32 v[148:149], v238 offset0:176 offset1:177
    v_mfma_f32_16x16x32_bf16 v[60:63], v[92:95], v[96:99], v[60:63]
    ds_read2_b32 v[150:151], v238 offset0:178 offset1:179
    v_mfma_f32_16x16x32_bf16 v[60:63], v[88:91], v[100:103], v[60:63]
    ds_read_b128 v[184:187], v247 offset:26624
    v_mfma_f32_16x16x32_bf16 v[60:63], v[84:87], v[104:107], v[60:63]
    ds_read2_b32 v[152:153], v239 offset0:48 offset1:49
    v_mfma_f32_16x16x32_bf16 v[60:63], v[80:83], v[108:111], v[60:63]
    ds_read2_b32 v[154:155], v239 offset0:50 offset1:51
    v_mfma_f32_16x16x32_bf16 v[60:63], v[76:79], v[112:115], v[60:63]
    ds_read_b128 v[188:191], v247 offset:30720
    s_waitcnt lgkmcnt(7)
    s_barrier
    v_mfma_f32_16x16x32_bf16 v[60:63], v[72:75], v[116:119], v[60:63]
    ds_read2_b32 v[156:157], v239 offset0:176 offset1:177
    v_mfma_f32_16x16x32_bf16 v[60:63], v[68:71], v[120:123], v[60:63]
    ds_read2_b32 v[158:159], v239 offset0:178 offset1:179
    v_mfma_f32_16x16x32_bf16 v[60:63], v[64:67], v[124:127], v[60:63]
    v_mfma_f32_16x16x32_bf16 v[32:35], v[128:131], v[160:163], v[32:35]
    s_lshl_b32 s14, s98, 18
    ds_read_b128 v[96:99], v244 offset:0
    v_mfma_f32_16x16x32_bf16 v[36:39], v[132:135], v[160:163], v[36:39]
    s_add_u32 m0, s73, 16384
    v_mfma_f32_16x16x32_bf16 v[36:39], v[128:131], v[164:167], v[36:39]
    buffer_load_dwordx4 v4, s[52:55], s14 offen offset:0 lds
    ds_read2_b32 v[64:65], v236 offset0:64 offset1:65
    v_mfma_f32_16x16x32_bf16 v[40:43], v[128:131], v[168:171], v[40:43]
    ds_read2_b32 v[66:67], v236 offset0:66 offset1:67
    v_mfma_f32_16x16x32_bf16 v[40:43], v[132:135], v[164:167], v[40:43]
    v_mfma_f32_16x16x32_bf16 v[40:43], v[136:139], v[160:163], v[40:43]
    ds_read_b128 v[100:103], v244 offset:4096
    v_mfma_f32_16x16x32_bf16 v[44:47], v[140:143], v[160:163], v[44:47]
    ds_read2_b32 v[68:69], v236 offset0:192 offset1:193
    v_mfma_f32_16x16x32_bf16 v[44:47], v[136:139], v[164:167], v[44:47]
    ds_read2_b32 v[70:71], v236 offset0:194 offset1:195
    v_mfma_f32_16x16x32_bf16 v[44:47], v[132:135], v[168:171], v[44:47]
    s_add_u32 m0, s73, 16384
    ds_read_b128 v[104:107], v244 offset:8192
    v_mfma_f32_16x16x32_bf16 v[44:47], v[128:131], v[172:175], v[44:47]
    buffer_load_dwordx4 v5, s[52:55], s14 offen offset:1024 lds
    ds_read2_b32 v[72:73], v237 offset0:64 offset1:65
    s_waitcnt lgkmcnt(8)
    v_mfma_f32_16x16x32_bf16 v[48:51], v[128:131], v[176:179], v[48:51]
    ds_read2_b32 v[74:75], v237 offset0:66 offset1:67
    v_mfma_f32_16x16x32_bf16 v[48:51], v[132:135], v[172:175], v[48:51]
    ds_read_b128 v[108:111], v244 offset:12288
    v_mfma_f32_16x16x32_bf16 v[48:51], v[136:139], v[168:171], v[48:51]
    ds_read2_b32 v[76:77], v237 offset0:192 offset1:193
    v_mfma_f32_16x16x32_bf16 v[48:51], v[140:143], v[164:167], v[48:51]
    ds_read2_b32 v[78:79], v237 offset0:194 offset1:195
    v_mfma_f32_16x16x32_bf16 v[48:51], v[144:147], v[160:163], v[48:51]
    ds_read_b128 v[112:115], v244 offset:16384
    v_mfma_f32_16x16x32_bf16 v[52:55], v[148:151], v[160:163], v[52:55]
    s_add_u32 m0, s73, 16384
    ds_read2_b32 v[80:81], v238 offset0:64 offset1:65
    v_mfma_f32_16x16x32_bf16 v[52:55], v[144:147], v[164:167], v[52:55]
    buffer_load_dwordx4 v6, s[52:55], s14 offen offset:2048 lds
    ds_read2_b32 v[82:83], v238 offset0:66 offset1:67
    v_mfma_f32_16x16x32_bf16 v[52:55], v[140:143], v[168:171], v[52:55]
    ds_read_b128 v[116:119], v244 offset:20480
    v_mfma_f32_16x16x32_bf16 v[52:55], v[136:139], v[172:175], v[52:55]
    ds_read2_b32 v[84:85], v238 offset0:192 offset1:193
    v_mfma_f32_16x16x32_bf16 v[52:55], v[132:135], v[176:179], v[52:55]
    ds_read2_b32 v[86:87], v238 offset0:194 offset1:195
    v_mfma_f32_16x16x32_bf16 v[52:55], v[128:131], v[180:183], v[52:55]
    ds_read_b128 v[120:123], v244 offset:24576
    v_mfma_f32_16x16x32_bf16 v[56:59], v[128:131], v[184:187], v[56:59]
    ds_read2_b32 v[88:89], v239 offset0:64 offset1:65
    s_waitcnt vmcnt(7)
    s_barrier
    v_mfma_f32_16x16x32_bf16 v[56:59], v[132:135], v[180:183], v[56:59]
    v_add_u32 v10, 131072, v10
    s_add_u32 m0, s73, 16384
    v_mfma_f32_16x16x32_bf16 v[56:59], v[136:139], v[176:179], v[56:59]
    ds_read_b64_tr_b16 a[192:193], v10 offset:16384
    buffer_load_dwordx4 v7, s[52:55], s14 offen offset:3072 lds
    v_mfma_f32_16x16x32_bf16 v[56:59], v[140:143], v[172:175], v[56:59]
    ds_read2_b32 v[90:91], v239 offset0:66 offset1:67
    v_mfma_f32_16x16x32_bf16 v[56:59], v[144:147], v[168:171], v[56:59]
    ds_read_b64_tr_b16 a[194:195], v10 offset:18432
    v_mfma_f32_16x16x32_bf16 v[56:59], v[148:151], v[164:167], v[56:59]
    ds_read_b64_tr_b16 a[200:201], v10 offset:20480
    v_mfma_f32_16x16x32_bf16 v[56:59], v[152:155], v[160:163], v[56:59]
    ds_read_b64_tr_b16 a[202:203], v10 offset:22528
    v_mfma_f32_16x16x32_bf16 v[60:63], v[156:159], v[160:163], v[60:63]
    ds_read_b128 v[124:127], v244 offset:28672
    v_add_u32 v11, 131072, v11
    v_mfma_f32_16x16x32_bf16 v[60:63], v[152:155], v[164:167], v[60:63]
    ds_read_b64_tr_b16 a[196:197], v11 offset:16384
    v_mfma_f32_16x16x32_bf16 v[60:63], v[148:151], v[168:171], v[60:63]
    ds_read2_b32 v[92:93], v239 offset0:192 offset1:193
    v_mfma_f32_16x16x32_bf16 v[60:63], v[144:147], v[172:175], v[60:63]
    ds_read_b64_tr_b16 a[198:199], v11 offset:18432
    v_mfma_f32_16x16x32_bf16 v[60:63], v[140:143], v[176:179], v[60:63]
    ds_read_b64_tr_b16 a[204:205], v11 offset:20480
    v_mfma_f32_16x16x32_bf16 v[60:63], v[136:139], v[180:183], v[60:63]
    ds_read_b64_tr_b16 a[206:207], v11 offset:22528
    v_mfma_f32_16x16x32_bf16 v[60:63], v[132:135], v[184:187], v[60:63]
    ds_read2_b32 v[94:95], v239 offset0:194 offset1:195
    v_mfma_f32_16x16x32_bf16 v[60:63], v[128:131], v[188:191], v[60:63]
    s_waitcnt lgkmcnt(15)
    v_mfma_f32_16x16x32_bf16 v[32:35], v[64:67], v[96:99], v[32:35]
    ds_read_b128 v[160:163], v245 offset:0
    v_mfma_f32_16x16x32_bf16 v[36:39], v[68:71], v[96:99], v[36:39]
    v_mfma_f32_16x16x32_bf16 v[36:39], v[64:67], v[100:103], v[36:39]
    ds_read2_b32 v[128:129], v236 offset0:80 offset1:81
    v_mfma_f32_16x16x32_bf16 v[40:43], v[64:67], v[104:107], v[40:43]
    ds_read2_b32 v[130:131], v236 offset0:82 offset1:83
    s_waitcnt lgkmcnt(4)
    s_barrier
    v_mfma_f32_16x16x32_bf16 v[40:43], v[68:71], v[100:103], v[40:43]
    v_mfma_f32_16x16x32_bf16 v[40:43], v[72:75], v[96:99], v[40:43]
    ds_read_b128 v[164:167], v245 offset:4096
    v_mfma_f32_16x16x32_bf16 v[44:47], v[76:79], v[96:99], v[44:47]
    ds_read2_b32 v[132:133], v236 offset0:208 offset1:209
    v_mfma_f32_16x16x32_bf16 v[44:47], v[72:75], v[100:103], v[44:47]
    s_lshl_b32 s14, s99, 18
    v_mfma_f32_16x16x32_bf16 v[44:47], v[68:71], v[104:107], v[44:47]
    s_add_u32 m0, s73, 147456
    ds_read2_b32 v[134:135], v236 offset0:210 offset1:211
    v_mfma_f32_16x16x32_bf16 v[44:47], v[64:67], v[108:111], v[44:47]
    buffer_load_dwordx4 v4, s[52:55], s14 offen offset:0 lds
    ds_read_b128 v[168:171], v245 offset:8192
    s_waitcnt lgkmcnt(7)
    v_mfma_f32_16x16x32_bf16 v[48:51], v[64:67], v[112:115], v[48:51]
    ds_read2_b32 v[136:137], v237 offset0:80 offset1:81
    v_mfma_f32_16x16x32_bf16 v[48:51], v[68:71], v[108:111], v[48:51]
    v_mfma_f32_16x16x32_bf16 v[48:51], v[72:75], v[104:107], v[48:51]
    ds_read2_b32 v[138:139], v237 offset0:82 offset1:83
    v_mfma_f32_16x16x32_bf16 v[48:51], v[76:79], v[100:103], v[48:51]
    ds_read_b128 v[172:175], v245 offset:12288
    v_mfma_f32_16x16x32_bf16 v[48:51], v[80:83], v[96:99], v[48:51]
    v_mfma_f32_16x16x32_bf16 v[52:55], v[84:87], v[96:99], v[52:55]
    s_add_u32 m0, s73, 147456
    ds_read2_b32 v[140:141], v237 offset0:208 offset1:209
    v_mfma_f32_16x16x32_bf16 v[52:55], v[80:83], v[100:103], v[52:55]
    buffer_load_dwordx4 v5, s[52:55], s14 offen offset:1024 lds
    ds_read2_b32 v[142:143], v237 offset0:210 offset1:211
    v_mfma_f32_16x16x32_bf16 v[52:55], v[76:79], v[104:107], v[52:55]
    v_mfma_f32_16x16x32_bf16 v[52:55], v[72:75], v[108:111], v[52:55]
    ds_read_b128 v[176:179], v245 offset:16384
    v_mfma_f32_16x16x32_bf16 v[52:55], v[68:71], v[112:115], v[52:55]
    ds_read2_b32 v[144:145], v238 offset0:80 offset1:81
    v_mfma_f32_16x16x32_bf16 v[52:55], v[64:67], v[116:119], v[52:55]
    ds_read2_b32 v[146:147], v238 offset0:82 offset1:83
    v_mfma_f32_16x16x32_bf16 v[56:59], v[64:67], v[120:123], v[56:59]
    ds_read_b128 v[180:183], v245 offset:20480
    v_mfma_f32_16x16x32_bf16 v[56:59], v[68:71], v[116:119], v[56:59]
    s_add_u32 m0, s73, 147456
    ds_read2_b32 v[148:149], v238 offset0:208 offset1:209
    v_mfma_f32_16x16x32_bf16 v[56:59], v[72:75], v[112:115], v[56:59]
    buffer_load_dwordx4 v6, s[52:55], s14 offen offset:2048 lds
    ds_read2_b32 v[150:151], v238 offset0:210 offset1:211
    v_mfma_f32_16x16x32_bf16 v[56:59], v[76:79], v[108:111], v[56:59]
    ds_read_b128 v[184:187], v245 offset:24576
    v_mfma_f32_16x16x32_bf16 v[56:59], v[80:83], v[104:107], v[56:59]
    ds_read2_b32 v[152:153], v239 offset0:80 offset1:81
    v_mfma_f32_16x16x32_bf16 v[56:59], v[84:87], v[100:103], v[56:59]
    ds_read2_b32 v[154:155], v239 offset0:82 offset1:83
    v_mfma_f32_16x16x32_bf16 v[56:59], v[88:91], v[96:99], v[56:59]
    ds_read_b128 v[188:191], v245 offset:28672
    v_mfma_f32_16x16x32_bf16 v[60:63], v[92:95], v[96:99], v[60:63]
    ds_read2_b32 v[156:157], v239 offset0:208 offset1:209
    s_waitcnt vmcnt(7)
    s_barrier
    v_mfma_f32_16x16x32_bf16 v[60:63], v[88:91], v[100:103], v[60:63]
    v_add_u32 v10, -131072, v10
    s_add_u32 m0, s73, 147456
    v_mfma_f32_16x16x32_bf16 v[60:63], v[84:87], v[104:107], v[60:63]
    buffer_load_dwordx4 v7, s[52:55], s14 offen offset:3072 lds
    ds_read2_b32 v[158:159], v239 offset0:210 offset1:211
    v_mfma_f32_16x16x32_bf16 v[60:63], v[80:83], v[108:111], v[60:63]
    ds_read_b64_tr_b16 a[208:209], v10 offset:0
    v_mfma_f32_16x16x32_bf16 v[60:63], v[76:79], v[112:115], v[60:63]
    ds_read_b64_tr_b16 a[210:211], v10 offset:2048
    v_mfma_f32_16x16x32_bf16 v[60:63], v[72:75], v[116:119], v[60:63]
    ds_read_b64_tr_b16 a[216:217], v10 offset:4096
    v_mfma_f32_16x16x32_bf16 v[60:63], v[68:71], v[120:123], v[60:63]
    ds_read_b64_tr_b16 a[218:219], v10 offset:6144
    v_mfma_f32_16x16x32_bf16 v[60:63], v[64:67], v[124:127], v[60:63]
    v_add_u32 v11, -131072, v11
    s_waitcnt lgkmcnt(15)
    v_mfma_f32_16x16x32_bf16 v[32:35], v[128:131], v[160:163], v[32:35]
    ds_read_b128 v[96:99], v246 offset:0
    v_mfma_f32_16x16x32_bf16 v[36:39], v[132:135], v[160:163], v[36:39]
    ds_read_b64_tr_b16 a[212:213], v11 offset:0
    v_mfma_f32_16x16x32_bf16 v[36:39], v[128:131], v[164:167], v[36:39]
    ds_read_b64_tr_b16 a[214:215], v11 offset:2048
    v_mfma_f32_16x16x32_bf16 v[40:43], v[128:131], v[168:171], v[40:43]
    ds_read_b64_tr_b16 a[220:221], v11 offset:4096
    v_mfma_f32_16x16x32_bf16 v[40:43], v[132:135], v[164:167], v[40:43]
    ds_read_b64_tr_b16 a[222:223], v11 offset:6144
    v_mfma_f32_16x16x32_bf16 v[40:43], v[136:139], v[160:163], v[40:43]
    ds_read2_b32 v[64:65], v236 offset0:96 offset1:97
    v_mfma_f32_16x16x32_bf16 v[44:47], v[140:143], v[160:163], v[44:47]
    ds_read2_b32 v[66:67], v236 offset0:98 offset1:99
    v_mfma_f32_16x16x32_bf16 v[44:47], v[136:139], v[164:167], v[44:47]
    ds_read_b128 v[100:103], v246 offset:4096
    v_mfma_f32_16x16x32_bf16 v[44:47], v[132:135], v[168:171], v[44:47]
    ds_read2_b32 v[68:69], v236 offset0:224 offset1:225
    v_mfma_f32_16x16x32_bf16 v[44:47], v[128:131], v[172:175], v[44:47]
    ds_read2_b32 v[70:71], v236 offset0:226 offset1:227
    s_waitcnt lgkmcnt(14)
    v_mfma_f32_16x16x32_bf16 v[48:51], v[128:131], v[176:179], v[48:51]
    ds_read_b128 v[104:107], v246 offset:8192
    s_waitcnt lgkmcnt(6)
    s_barrier
    v_mfma_f32_16x16x32_bf16 v[48:51], v[132:135], v[172:175], v[48:51]
    ds_read2_b32 v[72:73], v237 offset0:96 offset1:97
    v_mfma_f32_16x16x32_bf16 v[48:51], v[136:139], v[168:171], v[48:51]
    ds_read2_b32 v[74:75], v237 offset0:98 offset1:99
    v_mfma_f32_16x16x32_bf16 v[48:51], v[140:143], v[164:167], v[48:51]
    ds_read_b128 v[108:111], v246 offset:12288
    v_mfma_f32_16x16x32_bf16 v[48:51], v[144:147], v[160:163], v[48:51]
    s_lshl_b32 s14, s100, 18
    v_mfma_f32_16x16x32_bf16 v[52:55], v[148:151], v[160:163], v[52:55]
    s_add_u32 m0, s73, 0
    ds_read2_b32 v[76:77], v237 offset0:224 offset1:225
    v_mfma_f32_16x16x32_bf16 v[52:55], v[144:147], v[164:167], v[52:55]
    buffer_load_dwordx4 v4, s[52:55], s14 offen offset:0 lds
    ds_read2_b32 v[78:79], v237 offset0:226 offset1:227
    v_mfma_f32_16x16x32_bf16 v[52:55], v[140:143], v[168:171], v[52:55]
    v_mfma_f32_16x16x32_bf16 v[52:55], v[136:139], v[172:175], v[52:55]
    ds_read_b128 v[112:115], v246 offset:16384
    v_mfma_f32_16x16x32_bf16 v[52:55], v[132:135], v[176:179], v[52:55]
    ds_read2_b32 v[80:81], v238 offset0:96 offset1:97
    v_mfma_f32_16x16x32_bf16 v[52:55], v[128:131], v[180:183], v[52:55]
    v_mfma_f32_16x16x32_bf16 v[56:59], v[128:131], v[184:187], v[56:59]
    ds_read2_b32 v[82:83], v238 offset0:98 offset1:99
    v_mfma_f32_16x16x32_bf16 v[56:59], v[132:135], v[180:183], v[56:59]
    s_add_u32 m0, s73, 0
    ds_read_b128 v[116:119], v246 offset:20480
    v_mfma_f32_16x16x32_bf16 v[56:59], v[136:139], v[176:179], v[56:59]
    buffer_load_dwordx4 v5, s[52:55], s14 offen offset:1024 lds
    v_mfma_f32_16x16x32_bf16 v[56:59], v[140:143], v[172:175], v[56:59]
    ds_read2_b32 v[84:85], v238 offset0:224 offset1:225
    v_mfma_f32_16x16x32_bf16 v[56:59], v[144:147], v[168:171], v[56:59]
    ds_read2_b32 v[86:87], v238 offset0:226 offset1:227
    v_mfma_f32_16x16x32_bf16 v[56:59], v[148:151], v[164:167], v[56:59]
    ds_read_b128 v[120:123], v246 offset:24576
    v_mfma_f32_16x16x32_bf16 v[56:59], v[152:155], v[160:163], v[56:59]
    v_mfma_f32_16x16x32_bf16 v[60:63], v[156:159], v[160:163], v[60:63]
    ds_read2_b32 v[88:89], v239 offset0:96 offset1:97
    v_mfma_f32_16x16x32_bf16 v[60:63], v[152:155], v[164:167], v[60:63]
    s_add_u32 m0, s73, 0
    ds_read2_b32 v[90:91], v239 offset0:98 offset1:99
    v_mfma_f32_16x16x32_bf16 v[60:63], v[148:151], v[168:171], v[60:63]
    buffer_load_dwordx4 v6, s[52:55], s14 offen offset:2048 lds
    v_mfma_f32_16x16x32_bf16 v[60:63], v[144:147], v[172:175], v[60:63]
    ds_read_b128 v[124:127], v246 offset:28672
    v_mfma_f32_16x16x32_bf16 v[60:63], v[140:143], v[176:179], v[60:63]
    ds_read2_b32 v[92:93], v239 offset0:224 offset1:225
    v_mfma_f32_16x16x32_bf16 v[60:63], v[136:139], v[180:183], v[60:63]
    v_mfma_f32_16x16x32_bf16 v[60:63], v[132:135], v[184:187], v[60:63]
    ds_read2_b32 v[94:95], v239 offset0:226 offset1:227
    v_mfma_f32_16x16x32_bf16 v[60:63], v[128:131], v[188:191], v[60:63]
    s_waitcnt lgkmcnt(12)
    v_mfma_f32_16x16x32_bf16 v[32:35], v[64:67], v[96:99], v[32:35]
    ds_read_b128 v[160:163], v247 offset:0
    s_waitcnt vmcnt(7)
    s_barrier
    v_mfma_f32_16x16x32_bf16 v[36:39], v[68:71], v[96:99], v[36:39]
    ds_read_b64_tr_b16 a[224:225], v10 offset:16384
    s_add_u32 m0, s73, 0
    s_bfe_u32 s4, s2, 0x20003
    v_mfma_f32_16x16x32_bf16 v[36:39], v[64:67], v[100:103], v[36:39]
    ds_read_b64_tr_b16 a[226:227], v10 offset:18432
    buffer_load_dwordx4 v7, s[52:55], s14 offen offset:3072 lds
    ds_read_b128 v[164:167], v247 offset:4096
    v_mfma_f32_16x16x32_bf16 v[40:43], v[64:67], v[104:107], v[40:43]
    s_lshl2_add_u32 s4, s72, s4
    ds_read_b128 v[168:171], v247 offset:8192
    v_mfma_f32_16x16x32_bf16 v[40:43], v[68:71], v[100:103], v[40:43]
    ds_read_b64_tr_b16 a[232:233], v10 offset:20480
    ds_read_b128 v[172:175], v247 offset:12288
    v_mfma_f32_16x16x32_bf16 v[40:43], v[72:75], v[96:99], v[40:43]
    ds_read_b64_tr_b16 a[234:235], v10 offset:22528
    s_lshl_b32 s4, s4, 3
    v_mfma_f32_16x16x32_bf16 v[44:47], v[76:79], v[96:99], v[44:47]
    ds_read_b128 v[176:179], v247 offset:16384
    v_mfma_f32_16x16x32_bf16 v[44:47], v[72:75], v[100:103], v[44:47]
    ds_read_b64_tr_b16 a[228:229], v11 offset:16384
    s_lshr_b32 s5, s2, 4
    ds_read_b128 v[180:183], v247 offset:20480
    v_mfma_f32_16x16x32_bf16 v[44:47], v[68:71], v[104:107], v[44:47]
    ds_read_b64_tr_b16 a[230:231], v11 offset:18432
    v_mfma_f32_16x16x32_bf16 v[44:47], v[64:67], v[108:111], v[44:47]
    s_and_b32 s5, s5, 6
    ds_read_b128 v[184:187], v247 offset:24576
    s_waitcnt lgkmcnt(13)
    v_mfma_f32_16x16x32_bf16 v[48:51], v[64:67], v[112:115], v[48:51]
    ds_read_b64_tr_b16 a[236:237], v11 offset:20480
    ds_read_b128 v[188:191], v247 offset:28672
    v_mfma_f32_16x16x32_bf16 v[48:51], v[68:71], v[108:111], v[48:51]
    ds_read_b64_tr_b16 a[238:239], v11 offset:22528
    s_add_u32 s4, s4, s5
    v_mfma_f32_16x16x32_bf16 v[48:51], v[72:75], v[104:107], v[48:51]
    ds_read2_b32 v[128:129], v236 offset0:112 offset1:113
    v_mfma_f32_16x16x32_bf16 v[48:51], v[76:79], v[100:103], v[48:51]
    s_and_b32 s5, s2, 1
    ds_read2_b32 v[130:131], v236 offset0:114 offset1:115
    v_mfma_f32_16x16x32_bf16 v[48:51], v[80:83], v[96:99], v[48:51]
    ds_read2_b32 v[132:133], v236 offset0:240 offset1:241
    v_mfma_f32_16x16x32_bf16 v[52:55], v[84:87], v[96:99], v[52:55]
    s_add_u32 s4, s4, s5
    ds_read2_b32 v[134:135], v236 offset0:242 offset1:243
    v_mfma_f32_16x16x32_bf16 v[52:55], v[80:83], v[100:103], v[52:55]
    ds_read2_b32 v[136:137], v237 offset0:112 offset1:113
    v_mfma_f32_16x16x32_bf16 v[52:55], v[76:79], v[104:107], v[52:55]
    s_lshl_b32 s4, s4, 7
    ds_read2_b32 v[138:139], v237 offset0:114 offset1:115
    s_add_u32 s6, s12, 4767744
    v_mfma_f32_16x16x32_bf16 v[52:55], v[72:75], v[108:111], v[52:55]
    s_waitcnt lgkmcnt(6)
    s_barrier
    ds_read2_b32 v[140:141], v237 offset0:240 offset1:241
    s_add_u32 s4, s4, 12566528
    v_mfma_f32_16x16x32_bf16 v[52:55], v[68:71], v[112:115], v[52:55]
    ds_read2_b32 v[142:143], v237 offset0:242 offset1:243
    v_mfma_f32_16x16x32_bf16 v[52:55], v[64:67], v[116:119], v[52:55]
    ds_read2_b32 v[144:145], v238 offset0:112 offset1:113
    v_lshl_add_u32 v28, v2, 2, s4
    v_mfma_f32_16x16x32_bf16 v[56:59], v[64:67], v[120:123], v[56:59]
    s_lshl_b32 s14, s101, 18
    ds_read2_b32 v[146:147], v238 offset0:114 offset1:115
    v_mfma_f32_16x16x32_bf16 v[56:59], v[68:71], v[116:119], v[56:59]
    s_add_u32 m0, s73, 16384
    s_cmp_eq_u32 s3, 0
    s_cselect_b32 s4, 18, 0
    v_mfma_f32_16x16x32_bf16 v[56:59], v[72:75], v[112:115], v[56:59]
    buffer_load_dwordx4 v4, s[52:55], s14 offen offset:0 lds
    ds_read2_b32 v[148:149], v238 offset0:240 offset1:241
    v_mfma_f32_16x16x32_bf16 v[56:59], v[76:79], v[108:111], v[56:59]
    ds_read2_b32 v[150:151], v238 offset0:242 offset1:243
    v_cmp_gt_u32 vcc, s4, v2
    v_mfma_f32_16x16x32_bf16 v[56:59], v[80:83], v[104:107], v[56:59]
    ds_read2_b32 v[152:153], v239 offset0:112 offset1:113
    v_mfma_f32_16x16x32_bf16 v[56:59], v[84:87], v[100:103], v[56:59]
    ds_read2_b32 v[154:155], v239 offset0:114 offset1:115
    v_mov_b32 v13, 0x40000000
    v_mfma_f32_16x16x32_bf16 v[56:59], v[88:91], v[96:99], v[56:59]
    ds_read2_b32 v[156:157], v239 offset0:240 offset1:241
    v_mfma_f32_16x16x32_bf16 v[60:63], v[92:95], v[96:99], v[60:63]
    ds_read2_b32 v[158:159], v239 offset0:242 offset1:243
    v_cndmask_b32 v28, v13, v28, vcc
    v_mfma_f32_16x16x32_bf16 v[60:63], v[88:91], v[100:103], v[60:63]
    s_add_u32 m0, s73, 16384
    v_mfma_f32_16x16x32_bf16 v[60:63], v[84:87], v[104:107], v[60:63]
    buffer_load_dwordx4 v5, s[52:55], s14 offen offset:1024 lds
    v_mov_b32 v13, s68
    v_mfma_f32_16x16x32_bf16 v[60:63], v[80:83], v[108:111], v[60:63]
    v_mfma_f32_16x16x32_bf16 v[60:63], v[76:79], v[112:115], v[60:63]
    v_cndmask_b32 v13, 0, v13, vcc
    v_mfma_f32_16x16x32_bf16 v[60:63], v[72:75], v[116:119], v[60:63]
    v_mfma_f32_16x16x32_bf16 v[60:63], v[68:71], v[120:123], v[60:63]
    v_mfma_f32_16x16x32_bf16 v[60:63], v[64:67], v[124:127], v[60:63]
    s_waitcnt lgkmcnt(0)
    v_mfma_f32_16x16x32_bf16 v[60:63], v[128:131], v[188:191], v[60:63]
    v_mfma_f32_16x16x32_bf16 v[60:63], v[132:135], v[184:187], v[60:63]
    s_add_u32 m0, s73, 16384
    v_mfma_f32_16x16x32_bf16 v[60:63], v[136:139], v[180:183], v[60:63]
    buffer_load_dwordx4 v6, s[52:55], s14 offen offset:2048 lds
    v_mfma_f32_16x16x32_bf16 v[60:63], v[140:143], v[176:179], v[60:63]
    v_mfma_f32_16x16x32_bf16 v[60:63], v[144:147], v[172:175], v[60:63]
    v_mfma_f32_16x16x32_bf16 v[60:63], v[148:151], v[168:171], v[60:63]
    v_mfma_f32_16x16x32_bf16 v[60:63], v[152:155], v[164:167], v[60:63]
L_pl_X_6:
    s_cbranch_execz L_wret
    v_mfma_f32_16x16x32_bf16 v[60:63], v[156:159], v[160:163], v[60:63]
    s_waitcnt vmcnt(7)
    s_barrier
    v_mfma_f32_16x16x32_bf16 v[56:59], v[128:131], v[184:187], v[56:59]
    v_add_u32 v10, 131072, v10
    s_add_u32 m0, s73, 16384
    v_mfma_f32_16x16x32_bf16 v[56:59], v[132:135], v[180:183], v[56:59]
    ds_read_b64_tr_b16 a[240:241], v10 offset:16384
    buffer_load_dwordx4 v7, s[52:55], s14 offen offset:3072 lds
    v_mfma_f32_16x16x32_bf16 v[56:59], v[136:139], v[176:179], v[56:59]
    ds_read_b64_tr_b16 a[242:243], v10 offset:18432
    v_mfma_f32_16x16x32_bf16 v[56:59], v[140:143], v[172:175], v[56:59]
    ds_read_b64_tr_b16 a[248:249], v10 offset:20480
    v_mfma_f32_16x16x32_bf16 v[56:59], v[144:147], v[168:171], v[56:59]
    v_mfma_f32_16x16x32_bf16 v[56:59], v[148:151], v[164:167], v[56:59]
    ds_read_b64_tr_b16 a[250:251], v10 offset:22528
    v_cvt_pk_bf16_f32 v206, v60, v61
    v_mfma_f32_16x16x32_bf16 v[56:59], v[152:155], v[160:163], v[56:59]
    v_add_u32 v11, 131072, v11
    v_mfma_f32_16x16x32_bf16 v[52:55], v[128:131], v[180:183], v[52:55]
    ds_read_b64_tr_b16 a[244:245], v11 offset:16384
    v_mfma_f32_16x16x32_bf16 v[52:55], v[132:135], v[176:179], v[52:55]
    ds_read_b64_tr_b16 a[246:247], v11 offset:18432
    v_cvt_pk_bf16_f32 v207, v62, v63
    v_mfma_f32_16x16x32_bf16 v[52:55], v[136:139], v[172:175], v[52:55]
    ds_read_b64_tr_b16 a[252:253], v11 offset:20480
    v_mfma_f32_16x16x32_bf16 v[52:55], v[140:143], v[168:171], v[52:55]
    buffer_store_dwordx2 v[206:207], v8, s[44:47], s6 offen offset:3584 sc1
    ds_read_b64_tr_b16 a[254:255], v11 offset:22528
    v_mfma_f32_16x16x32_bf16 v[52:55], v[144:147], v[164:167], v[52:55]
    v_mfma_f32_16x16x32_bf16 v[52:55], v[148:151], v[160:163], v[52:55]
    v_mfma_f32_16x16x32_bf16 v[48:51], v[128:131], v[176:179], v[48:51]
    v_cvt_pk_bf16_f32 v204, v56, v57
    v_mfma_f32_16x16x32_bf16 v[48:51], v[132:135], v[172:175], v[48:51]
    v_mfma_f32_16x16x32_bf16 v[48:51], v[136:139], v[168:171], v[48:51]
    v_mfma_f32_16x16x32_bf16 v[48:51], v[140:143], v[164:167], v[48:51]
    v_cvt_pk_bf16_f32 v205, v58, v59
    v_mfma_f32_16x16x32_bf16 v[48:51], v[144:147], v[160:163], v[48:51]
    v_mfma_f32_16x16x32_bf16 v[44:47], v[128:131], v[172:175], v[44:47]
    buffer_store_dwordx2 v[204:205], v8, s[44:47], s6 offen offset:3072 sc1
    v_mfma_f32_16x16x32_bf16 v[44:47], v[132:135], v[168:171], v[44:47]
    v_mfma_f32_16x16x32_bf16 v[44:47], v[136:139], v[164:167], v[44:47]
    v_mfma_f32_16x16x32_bf16 v[44:47], v[140:143], v[160:163], v[44:47]
    v_cvt_pk_bf16_f32 v202, v52, v53
    v_mfma_f32_16x16x32_bf16 v[40:43], v[128:131], v[168:171], v[40:43]
    v_mfma_f32_16x16x32_bf16 v[40:43], v[132:135], v[164:167], v[40:43]
    v_mfma_f32_16x16x32_bf16 v[40:43], v[136:139], v[160:163], v[40:43]
    v_cvt_pk_bf16_f32 v203, v54, v55
    v_mfma_f32_16x16x32_bf16 v[36:39], v[128:131], v[164:167], v[36:39]
    v_mfma_f32_16x16x32_bf16 v[36:39], v[132:135], v[160:163], v[36:39]
    buffer_store_dwordx2 v[202:203], v8, s[44:47], s6 offen offset:2560 sc1
    v_mfma_f32_16x16x32_bf16 v[32:35], v[128:131], v[160:163], v[32:35]
    v_mov_b32 v29, 0
    buffer_atomic_add v29, v28, s[44:47], 0 offen sc0 sc1
    v_cvt_pk_bf16_f32 v200, v48, v49
    v_cvt_pk_bf16_f32 v201, v50, v51
    buffer_store_dwordx2 v[200:201], v8, s[44:47], s6 offen offset:2048 sc1
    v_cvt_pk_bf16_f32 v198, v44, v45
    v_cvt_pk_bf16_f32 v199, v46, v47
    buffer_store_dwordx2 v[198:199], v8, s[44:47], s6 offen offset:1536 sc1
    v_cvt_pk_bf16_f32 v196, v40, v41
    v_cvt_pk_bf16_f32 v197, v42, v43
    buffer_store_dwordx2 v[196:197], v8, s[44:47], s6 offen offset:1024 sc1
    v_cvt_pk_bf16_f32 v194, v36, v37
    v_cvt_pk_bf16_f32 v195, v38, v39
    buffer_store_dwordx2 v[194:195], v8, s[44:47], s6 offen offset:512 sc1
    v_cvt_pk_bf16_f32 v192, v32, v33
    v_cvt_pk_bf16_f32 v193, v34, v35
    buffer_store_dwordx2 v[192:193], v8, s[44:47], s6 offen offset:0 sc1
    v_add_u32 v10, -131072, v10
    v_add_u32 v11, -131072, v11
    s_waitcnt lgkmcnt(0)
    s_barrier
L_DX:
    s_waitcnt vmcnt(0)
    v_cmp_ne_u32 vcc, v13, v29
    s_cbranch_vccnz L_rs_p2X
L_ok_p2X:
    s_barrier
    s_add_u32 m0, s73, 97536
    s_nop 0
    buffer_load_dwordx4 v23, s[44:47], s18 offen offset:768 sc1 lds
    s_add_u32 m0, s73, 99328
    s_nop 0
    buffer_load_dwordx4 v20, s[44:47], s18 offen offset:0 sc1 lds
    s_add_u32 m0, s73, 99840
    s_nop 0
    buffer_load_dwordx4 v20, s[44:47], s18 offen offset:512 sc1 lds
    s_add_u32 m0, s73, 100608
    s_nop 0
    buffer_load_dwordx4 v23, s[44:47], s19 offen offset:768 sc1 lds
    s_add_u32 m0, s73, 114688
    s_nop 0
    buffer_load_dwordx4 v20, s[44:47], s19 offen offset:0 sc1 lds
    s_add_u32 m0, s73, 115200
    s_nop 0
    buffer_load_dwordx4 v20, s[44:47], s19 offen offset:512 sc1 lds
    s_add_u32 m0, s73, 115968
    s_nop 0
    buffer_load_dwordx4 v23, s[44:47], s20 offen offset:768 sc1 lds
    s_add_u32 m0, s73, 117760
    s_nop 0
    buffer_load_dwordx4 v20, s[44:47], s20 offen offset:0 sc1 lds
    s_add_u32 m0, s73, 130560
    s_nop 0
    buffer_load_dwordx4 v20, s[44:47], s20 offen offset:512 sc1 lds
    s_add_u32 m0, s73, 131328
    s_nop 0
    buffer_load_dwordx4 v23, s[44:47], s21 offen offset:768 sc1 lds
    s_mov_b32 s56, s16
    s_and_b32 s57, s17, 0xffff
    s_mov_b32 s58, 2359296
    s_mov_b32 s59, 0x20000
    s_mov_b32 s40, 18432
    s_mov_b32 s42, 12386304
    s_mov_b32 s64, s38
    s_and_b32 s65, s39, 0xffff
    s_mov_b32 s66, 2359296
    s_mov_b32 s67, 0x20000
    v_lshlrev_b32 v136, 4, v2
    s_mul_i32 s7, s72, 36
    s_bitcmp1_b32 s3, 0
    s_addc_u32 s7, s7, 0
    s_lshl_b32 s7, s7, 17
    v_subrev_u32 v184, s7, v4
    v_subrev_u32 v185, s7, v5
    s_bfe_u32 s4, s2, 0x20003
    s_mul_i32 s4, s4, 9
    s_lshl1_add_u32 s7, s72, s4
    s_and_b32 s8, s3, 1
    s_add_u32 s7, s7, s8
    s_bfe_u32 s8, s2, 65539
    s_add_u32 s7, s7, s8
    s_lshl_b32 s8, s8, 3
    s_sub_u32 s4, s4, s8
    s_lshl_b32 s37, s7, 16
    s_add_u32 s37, s37, 4718592
    s_add_u32 s4, s4, 8
    s_lshl_b32 s16, s4, 16
    s_add_u32 s16, s16, 4718592
    s_sub_u32 s4, s4, s7
    s_lshl_b32 s4, s4, 7
    s_lshl_b32 s7, s7, 7
    s_add_u32 s7, s7, 12582912
    v_bfe_u32 v24, v2, 2, 1
    v_mul_i32_i24 v24, s4, v24
    v_and_b32 v25, 3, v2
    v_lshl_add_u32 v24, v25, 2, v24
    v_add_u32 v188, s7, v24
    s_lshl2_add_u32 s7, s2, s3
    s_mul_i32 s8, s7, 3072
    s_add_u32 s34, s8, 22953984
    s_add_u32 s11, s8, 26099712
    s_add_u32 s12, s8, 29245440
    s_lshl_b32 s35, s7, 12
    s_add_u32 s35, s35, 32391168
    s_xor_b32 s8, s7, 8
    s_mul_i32 s8, s8, 3072
    s_add_u32 s30, s8, 22953984
    s_xor_b32 s8, s7, 16
    s_mul_i32 s8, s8, 3072
    s_add_u32 s15, s8, 26099712
    s_xor_b32 s8, s7, 24
    s_mul_i32 s8, s8, 3072
    s_add_u32 s31, s8, 29245440
    s_andn2_b32 s7, s7, 24
    s_lshl3_add_u32 s7, s3, s7
    s_lshl2_add_u32 s8, s7, s72
    s_lshl_b32 s8, s8, 10
    s_add_u32 s32, s8, 32391168
    s_xor_b32 s8, s8, 4096
    s_add_u32 s33, s8, 32391168
    s_xor_b32 s8, s3, s72
    s_cmp_lt_u32 s8, 2
    s_cselect_b32 s35, s35, 0x40000000
    s_cselect_b32 s16, s16, 0x40000000
    s_cselect_b32 s36, s68, 0
    s_mov_b32 s38, 0xbfb8aa3b
    s_and_b32 s8, s8, 1
    s_mul_i32 s41, s8, 96
    s_and_b32 s43, s73, 4096
    v_lshlrev_b32 v24, 10, v2
    v_add_u32 v24, s35, v24
    s_add_u32 s7, s34, 2048
    v_mov_b32 v25, s36
    v_cmp_gt_u32 vcc, 4, v2
    s_nop 1
    v_cndmask_b32 v138, 0, v25, vcc
    v_mov_b32 v25, 0x40000000
    v_cndmask_b32 v137, v25, v24, vcc
    v_writelane_b32 v137, s7, 4
    v_writelane_b32 v138, s68, 4
    v_min_u32 v139, 1, v2
    v_lshlrev_b32 v139, 30, v139
    v_mov_b32 v140, 0
    v_writelane_b32 v140, s68, 0
    v_mov_b32 v195, s68
    v_mov_b32 v199, s68
    v_mov_b32 v202, s68
    v_mov_b32 v203, s68
    s_waitcnt vmcnt(6)
    s_barrier
    ds_read_b128 v[104:107], v14 offset:0
    ds_read_b128 v[108:111], v14 offset:4096
    ds_read_b128 v[112:115], v14 offset:8192
    ds_read_b128 v[116:119], v14 offset:12288
    s_waitcnt lgkmcnt(2)
    v_mfma_f32_16x16x32_bf16 v[32:35], v[104:107], a[0:3], 0
    s_add_u32 m0, s73, 133120
    s_sub_u32 s4, s75, 216
    s_lshl_b32 s7, s4, 7
    v_mfma_f32_16x16x32_bf16 v[32:35], v[108:111], a[8:11], v[32:35]
    buffer_load_dwordx4 v20, s[44:47], s21 offen offset:0 sc1 lds
    s_waitcnt lgkmcnt(0)
    v_mfma_f32_16x16x32_bf16 v[32:35], v[112:115], a[16:19], v[32:35]
    ds_read_b128 v[120:123], v14 offset:1024
    s_lshl2_add_u32 s7, s3, s7
    s_add_u32 s7, s7, 12582912
    v_mfma_f32_16x16x32_bf16 v[32:35], v[116:119], a[24:27], v[32:35]
    ds_read_b128 v[124:127], v14 offset:5120
    v_mfma_f32_16x16x32_bf16 v[36:39], v[116:119], a[28:31], 0
    ds_read_b128 v[128:131], v14 offset:9216
    s_cmp_lt_u32 s4, 36
    s_cselect_b32 s7, s7, 0x40000000
    v_mfma_f32_16x16x32_bf16 v[36:39], v[112:115], a[20:23], v[36:39]
    ds_read_b128 v[132:135], v14 offset:13312
    v_min_u32 v28, 1, v2
    v_mfma_f32_16x16x32_bf16 v[36:39], v[108:111], a[12:15], v[36:39]
    s_add_u32 m0, s73, 133632
    v_lshlrev_b32 v28, 30, v28
    v_mov_b32 v29, s68
    v_mfma_f32_16x16x32_bf16 v[36:39], v[104:107], a[4:7], v[36:39]
    buffer_load_dwordx4 v20, s[44:47], s21 offen offset:512 sc1 lds
    s_waitcnt lgkmcnt(2)
    v_mfma_f32_16x16x32_bf16 v[44:47], v[120:123], a[4:7], 0
    buffer_store_dword v29, v28, s[44:47], s7 offen sc1
    s_add_u32 m0, s73, 146688
    v_mfma_f32_16x16x32_bf16 v[44:47], v[124:127], a[12:15], v[44:47]
    buffer_load_dwordx4 v23, s[44:47], s22 offen offset:768 sc1 lds
    s_waitcnt lgkmcnt(0)
    v_mfma_f32_16x16x32_bf16 v[44:47], v[128:131], a[20:23], v[44:47]
    ds_read_b128 v[104:107], v14 offset:2048
    v_mfma_f32_16x16x32_bf16 v[44:47], v[132:135], a[28:31], v[44:47]
    ds_read_b128 v[108:111], v14 offset:6144
    v_mfma_f32_16x16x32_bf16 v[40:43], v[132:135], a[24:27], 0
    ds_read_b128 v[112:115], v14 offset:10240
    v_mfma_f32_16x16x32_bf16 v[40:43], v[128:131], a[16:19], v[40:43]
    ds_read_b128 v[116:119], v14 offset:14336
    v_mfma_f32_16x16x32_bf16 v[40:43], v[124:127], a[8:11], v[40:43]
    s_add_u32 m0, s73, 148480
    v_mfma_f32_16x16x32_bf16 v[40:43], v[120:123], a[0:3], v[40:43]
    buffer_load_dwordx4 v20, s[44:47], s22 offen offset:0 sc1 lds
    s_waitcnt lgkmcnt(2)
    v_mfma_f32_16x16x32_bf16 v[48:51], v[104:107], a[0:3], 0
    s_add_u32 m0, s73, 148992
    v_mfma_f32_16x16x32_bf16 v[48:51], v[108:111], a[8:11], v[48:51]
    buffer_load_dwordx4 v20, s[44:47], s22 offen offset:512 sc1 lds
    s_waitcnt lgkmcnt(0)
    v_mfma_f32_16x16x32_bf16 v[48:51], v[112:115], a[16:19], v[48:51]
    ds_read_b128 v[120:123], v14 offset:3072
    v_mfma_f32_16x16x32_bf16 v[48:51], v[116:119], a[24:27], v[48:51]
    ds_read_b128 v[124:127], v14 offset:7168
    v_mfma_f32_16x16x32_bf16 v[52:55], v[116:119], a[28:31], 0
    ds_read_b128 v[128:131], v14 offset:11264
    v_mfma_f32_16x16x32_bf16 v[52:55], v[112:115], a[20:23], v[52:55]
    ds_read_b128 v[132:135], v14 offset:15360
    v_mfma_f32_16x16x32_bf16 v[52:55], v[108:111], a[12:15], v[52:55]
    s_add_u32 m0, s73, 149760
    v_mfma_f32_16x16x32_bf16 v[52:55], v[104:107], a[4:7], v[52:55]
    buffer_load_dwordx4 v23, s[44:47], s23 offen offset:768 sc1 lds
    s_waitcnt lgkmcnt(2)
    v_mfma_f32_16x16x32_bf16 v[36:39], v[120:123], a[36:39], v[36:39]
    v_mfma_f32_16x16x32_bf16 v[36:39], v[124:127], a[44:47], v[36:39]
    s_waitcnt lgkmcnt(0)
    v_mfma_f32_16x16x32_bf16 v[36:39], v[128:131], a[52:55], v[36:39]
    s_waitcnt vmcnt(9)
    s_barrier
    v_mfma_f32_16x16x32_bf16 v[36:39], v[132:135], a[60:63], v[36:39]
    ds_read_b128 v[104:107], v14 offset:16384
    v_mfma_f32_16x16x32_bf16 v[32:35], v[132:135], a[56:59], v[32:35]
    ds_read_b128 v[108:111], v14 offset:20480
    v_mfma_f32_16x16x32_bf16 v[32:35], v[128:131], a[48:51], v[32:35]
    ds_read_b128 v[112:115], v14 offset:24576
    v_mfma_f32_16x16x32_bf16 v[32:35], v[124:127], a[40:43], v[32:35]
    ds_read_b128 v[116:119], v14 offset:28672
    v_mfma_f32_16x16x32_bf16 v[32:35], v[120:123], a[32:35], v[32:35]
    ds_read_b64_tr_b16 v[220:221], v10 offset:0
    s_waitcnt lgkmcnt(3)
    v_mfma_f32_16x16x32_bf16 v[40:43], v[104:107], a[32:35], v[40:43]
    s_add_u32 m0, s73, 98304
    ds_read_b64_tr_b16 v[222:223], v10 offset:2048
    v_mfma_f32_16x16x32_bf16 v[40:43], v[108:111], a[40:43], v[40:43]
    buffer_load_dwordx4 v20, s[44:47], s23 offen offset:0 sc1 lds
    s_waitcnt lgkmcnt(2)
    v_mfma_f32_16x16x32_bf16 v[40:43], v[112:115], a[48:51], v[40:43]
    ds_read_b128 v[120:123], v14 offset:17408
    v_mfma_f32_16x16x32_bf16 v[40:43], v[116:119], a[56:59], v[40:43]
    ds_read_b128 v[124:127], v14 offset:21504
    v_mfma_f32_16x16x32_bf16 v[44:47], v[116:119], a[60:63], v[44:47]
    ds_read_b128 v[128:131], v14 offset:25600
    v_mfma_f32_16x16x32_bf16 v[44:47], v[112:115], a[52:55], v[44:47]
    ds_read_b128 v[132:135], v14 offset:29696
    v_mfma_f32_16x16x32_bf16 v[44:47], v[108:111], a[44:47], v[44:47]
    s_add_u32 m0, s73, 98816
    ds_read_b64_tr_b16 v[228:229], v10 offset:4096
    v_mfma_f32_16x16x32_bf16 v[44:47], v[104:107], a[36:39], v[44:47]
    buffer_load_dwordx4 v20, s[44:47], s23 offen offset:512 sc1 lds
    s_waitcnt lgkmcnt(3)
    v_mfma_f32_16x16x32_bf16 v[52:55], v[120:123], a[36:39], v[52:55]
    s_add_u32 m0, s73, 99584
    ds_read_b64_tr_b16 v[230:231], v10 offset:6144
    v_mfma_f32_16x16x32_bf16 v[52:55], v[124:127], a[44:47], v[52:55]
    buffer_load_dwordx4 v23, s[44:47], s24 offen offset:768 sc1 lds
    s_waitcnt lgkmcnt(2)
    v_mfma_f32_16x16x32_bf16 v[52:55], v[128:131], a[52:55], v[52:55]
    ds_read_b128 v[104:107], v14 offset:18432
    v_mfma_f32_16x16x32_bf16 v[52:55], v[132:135], a[60:63], v[52:55]
    ds_read_b128 v[108:111], v14 offset:22528
    v_mfma_f32_16x16x32_bf16 v[48:51], v[132:135], a[56:59], v[48:51]
    ds_read_b128 v[112:115], v14 offset:26624
    v_mfma_f32_16x16x32_bf16 v[48:51], v[128:131], a[48:51], v[48:51]
    ds_read_b128 v[116:119], v14 offset:30720
    v_mfma_f32_16x16x32_bf16 v[48:51], v[124:127], a[40:43], v[48:51]
    s_add_u32 m0, s73, 101376
    ds_read_b64_tr_b16 v[224:225], v11 offset:0
    v_mfma_f32_16x16x32_bf16 v[48:51], v[120:123], a[32:35], v[48:51]
    buffer_load_dwordx4 v20, s[44:47], s24 offen offset:0 sc1 lds
    s_waitcnt lgkmcnt(3)
    v_mfma_f32_16x16x32_bf16 v[32:35], v[104:107], a[64:67], v[32:35]
    ds_read_b64_tr_b16 v[226:227], v11 offset:2048
    v_mfma_f32_16x16x32_bf16 v[32:35], v[108:111], a[72:75], v[32:35]
    s_waitcnt lgkmcnt(2)
    v_mfma_f32_16x16x32_bf16 v[32:35], v[112:115], a[80:83], v[32:35]
    ds_read_b128 v[120:123], v14 offset:19456
    v_mfma_f32_16x16x32_bf16 v[32:35], v[116:119], a[88:91], v[32:35]
    ds_read_b128 v[124:127], v14 offset:23552
    v_mfma_f32_16x16x32_bf16 v[36:39], v[116:119], a[92:95], v[36:39]
    ds_read_b128 v[128:131], v14 offset:27648
    v_mfma_f32_16x16x32_bf16 v[36:39], v[112:115], a[84:87], v[36:39]
    ds_read_b128 v[132:135], v14 offset:31744
    v_mfma_f32_16x16x32_bf16 v[36:39], v[108:111], a[76:79], v[36:39]
    ds_read_b64_tr_b16 v[232:233], v11 offset:4096
    v_mfma_f32_16x16x32_bf16 v[36:39], v[104:107], a[68:71], v[36:39]
    s_waitcnt lgkmcnt(3)
    v_mfma_f32_16x16x32_bf16 v[44:47], v[120:123], a[68:71], v[44:47]
    ds_read_b64_tr_b16 v[234:235], v11 offset:6144
    v_mfma_f32_16x16x32_bf16 v[44:47], v[124:127], a[76:79], v[44:47]
    s_waitcnt lgkmcnt(2)
    v_mfma_f32_16x16x32_bf16 v[44:47], v[128:131], a[84:87], v[44:47]
    s_waitcnt vmcnt(9) lgkmcnt(0)
    s_barrier
    v_mfma_f32_16x16x32_bf16 v[44:47], v[132:135], a[92:95], v[44:47]
    ds_read_b128 v[104:107], v14 offset:32768
    v_mfma_f32_16x16x32_bf16 v[40:43], v[132:135], a[88:91], v[40:43]
    ds_read_b128 v[108:111], v14 offset:36864
    v_mfma_f32_16x16x32_bf16 v[40:43], v[128:131], a[80:83], v[40:43]
    ds_read_b128 v[112:115], v14 offset:40960
    v_mfma_f32_16x16x32_bf16 v[40:43], v[124:127], a[72:75], v[40:43]
    ds_read_b128 v[116:119], v14 offset:45056
    v_mfma_f32_16x16x32_bf16 v[40:43], v[120:123], a[64:67], v[40:43]
    ds_read_b64_tr_b16 v[236:237], v10 offset:16384
    s_waitcnt lgkmcnt(3)
    v_mfma_f32_16x16x32_bf16 v[48:51], v[104:107], a[64:67], v[48:51]
    s_add_u32 m0, s73, 114176
    ds_read_b64_tr_b16 v[238:239], v10 offset:18432
    v_mfma_f32_16x16x32_bf16 v[48:51], v[108:111], a[72:75], v[48:51]
    buffer_load_dwordx4 v20, s[44:47], s24 offen offset:512 sc1 lds
    s_waitcnt lgkmcnt(2)
    v_mfma_f32_16x16x32_bf16 v[48:51], v[112:115], a[80:83], v[48:51]
    ds_read_b128 v[120:123], v14 offset:33792
    v_mfma_f32_16x16x32_bf16 v[48:51], v[116:119], a[88:91], v[48:51]
    ds_read_b128 v[124:127], v14 offset:37888
    v_lshrrev_b32 v30, 2, v26
    v_mfma_f32_16x16x32_bf16 v[52:55], v[116:119], a[92:95], v[52:55]
    ds_read_b128 v[128:131], v14 offset:41984
    v_mfma_f32_16x16x32_bf16 v[52:55], v[112:115], a[84:87], v[52:55]
    ds_read_b128 v[132:135], v14 offset:46080
    v_mfma_f32_16x16x32_bf16 v[52:55], v[108:111], a[76:79], v[52:55]
    s_add_u32 m0, s73, 114944
    ds_read_b64_tr_b16 v[244:245], v10 offset:20480
    v_mfma_f32_16x16x32_bf16 v[52:55], v[104:107], a[68:71], v[52:55]
    buffer_load_dwordx4 v23, s[44:47], s25 offen offset:768 sc1 lds
    s_waitcnt lgkmcnt(3)
    v_mfma_f32_16x16x32_bf16 v[36:39], v[120:123], a[100:103], v[36:39]
    s_add_u32 m0, s73, 116736
    ds_read_b64_tr_b16 v[246:247], v10 offset:22528
    v_mfma_f32_16x16x32_bf16 v[36:39], v[124:127], a[108:111], v[36:39]
    buffer_load_dwordx4 v20, s[44:47], s25 offen offset:0 sc1 lds
    s_waitcnt lgkmcnt(2)
    v_mfma_f32_16x16x32_bf16 v[36:39], v[128:131], a[116:119], v[36:39]
    ds_read_b128 v[104:107], v14 offset:34816
    v_lshrrev_b32 v31, 2, v18
    v_mfma_f32_16x16x32_bf16 v[36:39], v[132:135], a[124:127], v[36:39]
    ds_read_b128 v[108:111], v14 offset:38912
    v_mfma_f32_16x16x32_bf16 v[32:35], v[132:135], a[120:123], v[32:35]
    ds_read_b128 v[112:115], v14 offset:43008
    v_mfma_f32_16x16x32_bf16 v[32:35], v[128:131], a[112:115], v[32:35]
    ds_read_b128 v[116:119], v14 offset:47104
    v_mfma_f32_16x16x32_bf16 v[32:35], v[124:127], a[104:107], v[32:35]
    s_add_u32 m0, s73, 117248
    ds_read_b64_tr_b16 v[240:241], v11 offset:16384
    v_mfma_f32_16x16x32_bf16 v[32:35], v[120:123], a[96:99], v[32:35]
    buffer_load_dwordx4 v20, s[44:47], s25 offen offset:512 sc1 lds
    s_waitcnt lgkmcnt(3)
    v_mfma_f32_16x16x32_bf16 v[40:43], v[104:107], a[96:99], v[40:43]
    ds_read_b64_tr_b16 v[242:243], v11 offset:18432
    buffer_load_ushort v102, v30, s[60:63], 0 offen offset:0
    v_mfma_f32_16x16x32_bf16 v[40:43], v[108:111], a[104:107], v[40:43]
    s_waitcnt lgkmcnt(2)
    v_mfma_f32_16x16x32_bf16 v[40:43], v[112:115], a[112:115], v[40:43]
    ds_read_b128 v[120:123], v14 offset:35840
    v_mfma_f32_16x16x32_bf16 v[40:43], v[116:119], a[120:123], v[40:43]
    ds_read_b128 v[124:127], v14 offset:39936
    v_mfma_f32_16x16x32_bf16 v[44:47], v[116:119], a[124:127], v[44:47]
    ds_read_b128 v[128:131], v14 offset:44032
    v_mfma_f32_16x16x32_bf16 v[44:47], v[112:115], a[116:119], v[44:47]
    ds_read_b128 v[132:135], v14 offset:48128
    v_mfma_f32_16x16x32_bf16 v[44:47], v[108:111], a[108:111], v[44:47]
    ds_read_b64_tr_b16 v[248:249], v11 offset:20480
    buffer_load_ushort v103, v30, s[60:63], 0 offen offset:32
    v_mfma_f32_16x16x32_bf16 v[44:47], v[104:107], a[100:103], v[44:47]
    s_waitcnt lgkmcnt(3)
    v_mfma_f32_16x16x32_bf16 v[52:55], v[120:123], a[100:103], v[52:55]
    ds_read_b64_tr_b16 v[250:251], v11 offset:22528
    v_mfma_f32_16x16x32_bf16 v[52:55], v[124:127], a[108:111], v[52:55]
    s_waitcnt lgkmcnt(2)
    v_mfma_f32_16x16x32_bf16 v[52:55], v[128:131], a[116:119], v[52:55]
    s_waitcnt vmcnt(10) lgkmcnt(0)
    s_barrier
    v_mfma_f32_16x16x32_bf16 v[52:55], v[132:135], a[124:127], v[52:55]
    ds_read_b128 v[104:107], v14 offset:49152
    v_mfma_f32_16x16x32_bf16 v[48:51], v[132:135], a[120:123], v[48:51]
    ds_read_b128 v[108:111], v14 offset:53248
    buffer_load_ushort v27, v31, s[60:63], 0 offen offset:0
    v_mfma_f32_16x16x32_bf16 v[48:51], v[128:131], a[112:115], v[48:51]
    ds_read_b128 v[112:115], v14 offset:57344
    v_mfma_f32_16x16x32_bf16 v[48:51], v[124:127], a[104:107], v[48:51]
    ds_read_b128 v[116:119], v14 offset:61440
    v_mfma_f32_16x16x32_bf16 v[48:51], v[120:123], a[96:99], v[48:51]
    s_waitcnt lgkmcnt(2)
    v_mfma_f32_16x16x32_bf16 v[32:35], v[104:107], a[128:131], v[32:35]
    s_add_u32 m0, s73, 130304
    v_mfma_f32_16x16x32_bf16 v[32:35], v[108:111], a[136:139], v[32:35]
    buffer_load_dwordx4 v23, s[44:47], s26 offen offset:768 sc1 lds
    s_waitcnt lgkmcnt(0)
    v_mfma_f32_16x16x32_bf16 v[32:35], v[112:115], a[144:147], v[32:35]
    ds_read_b128 v[120:123], v14 offset:50176
    v_mfma_f32_16x16x32_bf16 v[32:35], v[116:119], a[152:155], v[32:35]
    ds_read_b128 v[124:127], v14 offset:54272
    v_mfma_f32_16x16x32_bf16 v[36:39], v[116:119], a[156:159], v[36:39]
    ds_read_b128 v[128:131], v14 offset:58368
    v_mfma_f32_16x16x32_bf16 v[36:39], v[112:115], a[148:151], v[36:39]
    ds_read_b128 v[132:135], v14 offset:62464
    v_mfma_f32_16x16x32_bf16 v[36:39], v[108:111], a[140:143], v[36:39]
    s_add_u32 m0, s73, 132096
    v_mfma_f32_16x16x32_bf16 v[36:39], v[104:107], a[132:135], v[36:39]
    buffer_load_dwordx4 v20, s[44:47], s26 offen offset:0 sc1 lds
    s_waitcnt lgkmcnt(2)
    v_mfma_f32_16x16x32_bf16 v[44:47], v[120:123], a[132:135], v[44:47]
    s_add_u32 m0, s73, 132608
    v_mfma_f32_16x16x32_bf16 v[44:47], v[124:127], a[140:143], v[44:47]
    buffer_load_dwordx4 v20, s[44:47], s26 offen offset:512 sc1 lds
    s_waitcnt lgkmcnt(0)
    v_mfma_f32_16x16x32_bf16 v[44:47], v[128:131], a[148:151], v[44:47]
    ds_read_b128 v[104:107], v14 offset:51200
    v_mfma_f32_16x16x32_bf16 v[44:47], v[132:135], a[156:159], v[44:47]
    ds_read_b128 v[108:111], v14 offset:55296
    v_mfma_f32_16x16x32_bf16 v[40:43], v[132:135], a[152:155], v[40:43]
    ds_read_b128 v[112:115], v14 offset:59392
    v_mfma_f32_16x16x32_bf16 v[40:43], v[128:131], a[144:147], v[40:43]
    ds_read_b128 v[116:119], v14 offset:63488
    v_mfma_f32_16x16x32_bf16 v[40:43], v[124:127], a[136:139], v[40:43]
    s_add_u32 m0, s73, 134144
    v_mfma_f32_16x16x32_bf16 v[40:43], v[120:123], a[128:131], v[40:43]
    buffer_load_dwordx4 v21, s[44:47], s18 offen offset:0 sc1 lds
    s_waitcnt lgkmcnt(2)
    v_mfma_f32_16x16x32_bf16 v[48:51], v[104:107], a[128:131], v[48:51]
    v_mfma_f32_16x16x32_bf16 v[48:51], v[108:111], a[136:139], v[48:51]
    s_waitcnt lgkmcnt(0)
    v_mfma_f32_16x16x32_bf16 v[48:51], v[112:115], a[144:147], v[48:51]
    ds_read_b128 v[120:123], v14 offset:52224
    v_mfma_f32_16x16x32_bf16 v[48:51], v[116:119], a[152:155], v[48:51]
    ds_read_b128 v[124:127], v14 offset:56320
    v_mfma_f32_16x16x32_bf16 v[52:55], v[116:119], a[156:159], v[52:55]
    ds_read_b128 v[128:131], v14 offset:60416
    v_mfma_f32_16x16x32_bf16 v[52:55], v[112:115], a[148:151], v[52:55]
    ds_read_b128 v[132:135], v14 offset:64512
    v_mfma_f32_16x16x32_bf16 v[52:55], v[108:111], a[140:143], v[52:55]
    v_mfma_f32_16x16x32_bf16 v[52:55], v[104:107], a[132:135], v[52:55]
    s_waitcnt lgkmcnt(2)
    v_mfma_f32_16x16x32_bf16 v[36:39], v[120:123], a[164:167], v[36:39]
    v_mfma_f32_16x16x32_bf16 v[36:39], v[124:127], a[172:175], v[36:39]
    s_waitcnt lgkmcnt(0)
    v_mfma_f32_16x16x32_bf16 v[36:39], v[128:131], a[180:183], v[36:39]
    s_waitcnt vmcnt(11)
    s_barrier
    v_mfma_f32_16x16x32_bf16 v[36:39], v[132:135], a[188:191], v[36:39]
    ds_read_b128 v[104:107], v14 offset:0
    v_mfma_f32_16x16x32_bf16 v[32:35], v[132:135], a[184:187], v[32:35]
    ds_read_b128 v[108:111], v14 offset:4096
    v_mfma_f32_16x16x32_bf16 v[32:35], v[128:131], a[176:179], v[32:35]
    ds_read_b128 v[112:115], v14 offset:8192
    v_mfma_f32_16x16x32_bf16 v[32:35], v[124:127], a[168:171], v[32:35]
    ds_read_b128 v[116:119], v14 offset:12288
    v_mfma_f32_16x16x32_bf16 v[32:35], v[120:123], a[160:163], v[32:35]
    s_waitcnt lgkmcnt(2)
    v_mfma_f32_16x16x32_bf16 v[40:43], v[104:107], a[160:163], v[40:43]
    s_add_u32 m0, s73, 146944
    v_mfma_f32_16x16x32_bf16 v[40:43], v[108:111], a[168:171], v[40:43]
    buffer_load_dwordx4 v21, s[44:47], s18 offen offset:512 sc1 lds
    s_waitcnt lgkmcnt(0)
    v_mfma_f32_16x16x32_bf16 v[40:43], v[112:115], a[176:179], v[40:43]
    ds_read_b128 v[120:123], v14 offset:1024
    v_mfma_f32_16x16x32_bf16 v[40:43], v[116:119], a[184:187], v[40:43]
    ds_read_b128 v[124:127], v14 offset:5120
    v_mfma_f32_16x16x32_bf16 v[44:47], v[116:119], a[188:191], v[44:47]
    ds_read_b128 v[128:131], v14 offset:9216
    v_mfma_f32_16x16x32_bf16 v[44:47], v[112:115], a[180:183], v[44:47]
    ds_read_b128 v[132:135], v14 offset:13312
    buffer_load_dwordx4 v[88:91], v252, s[56:59], 0 offen
    v_mfma_f32_16x16x32_bf16 v[44:47], v[108:111], a[172:175], v[44:47]
    s_add_u32 m0, s73, 148480
    v_mfma_f32_16x16x32_bf16 v[44:47], v[104:107], a[164:167], v[44:47]
    buffer_load_dwordx4 v21, s[44:47], s19 offen offset:0 sc1 lds
    s_waitcnt lgkmcnt(2)
    v_mfma_f32_16x16x32_bf16 v[52:55], v[120:123], a[164:167], v[52:55]
    s_add_u32 m0, s73, 148992
    v_mfma_f32_16x16x32_bf16 v[52:55], v[124:127], a[172:175], v[52:55]
    buffer_load_dwordx4 v21, s[44:47], s19 offen offset:512 sc1 lds
    s_waitcnt lgkmcnt(0)
    v_mfma_f32_16x16x32_bf16 v[52:55], v[128:131], a[180:183], v[52:55]
    ds_read_b128 v[104:107], v14 offset:2048
    v_mfma_f32_16x16x32_bf16 v[52:55], v[132:135], a[188:191], v[52:55]
    ds_read_b128 v[108:111], v14 offset:6144
    v_mfma_f32_16x16x32_bf16 v[48:51], v[132:135], a[184:187], v[48:51]
    ds_read_b128 v[112:115], v14 offset:10240
    v_mfma_f32_16x16x32_bf16 v[48:51], v[128:131], a[176:179], v[48:51]
    ds_read_b128 v[116:119], v14 offset:14336
    v_mfma_f32_16x16x32_bf16 v[48:51], v[124:127], a[168:171], v[48:51]
    s_add_u32 m0, s73, 150528
    v_mfma_f32_16x16x32_bf16 v[48:51], v[120:123], a[160:163], v[48:51]
    buffer_load_dwordx4 v21, s[44:47], s20 offen offset:0 sc1 lds
    s_waitcnt lgkmcnt(2)
    v_mfma_f32_16x16x32_bf16 v[32:35], v[104:107], a[192:195], v[32:35]
    buffer_load_dwordx4 v[92:95], v252, s[56:59], s40 offen
    v_mfma_f32_16x16x32_bf16 v[32:35], v[108:111], a[200:203], v[32:35]
    s_waitcnt vmcnt(10)
    s_waitcnt lgkmcnt(0)
    v_mfma_f32_16x16x32_bf16 v[32:35], v[112:115], a[208:211], v[32:35]
    ds_read_b128 v[120:123], v14 offset:3072
    v_mfma_f32_16x16x32_bf16 v[32:35], v[116:119], a[216:219], v[32:35]
    ds_read_b128 v[124:127], v14 offset:7168
    v_mfma_f32_16x16x32_bf16 v[36:39], v[116:119], a[220:223], v[36:39]
    ds_read_b128 v[128:131], v14 offset:11264
    v_lshlrev_b32 v72, 16, v102
    v_mfma_f32_16x16x32_bf16 v[36:39], v[112:115], a[212:215], v[36:39]
    ds_read_b128 v[132:135], v14 offset:15360
    v_mfma_f32_16x16x32_bf16 v[36:39], v[108:111], a[204:207], v[36:39]
    v_lshlrev_b32 v73, 16, v102
    v_mfma_f32_16x16x32_bf16 v[36:39], v[104:107], a[196:199], v[36:39]
    s_waitcnt lgkmcnt(2)
    v_mfma_f32_16x16x32_bf16 v[44:47], v[120:123], a[196:199], v[44:47]
    v_mfma_f32_16x16x32_bf16 v[44:47], v[124:127], a[204:207], v[44:47]
    v_lshlrev_b32 v74, 16, v102
    s_waitcnt lgkmcnt(0)
    v_mfma_f32_16x16x32_bf16 v[44:47], v[128:131], a[212:215], v[44:47]
    buffer_load_dwordx2 v[142:143], v253, s[56:59], 0 offen
    s_barrier
    v_mfma_f32_16x16x32_bf16 v[44:47], v[132:135], a[220:223], v[44:47]
    ds_read_b128 v[104:107], v14 offset:16384
    v_mfma_f32_16x16x32_bf16 v[40:43], v[132:135], a[216:219], v[40:43]
    ds_read_b128 v[108:111], v14 offset:20480
    v_lshlrev_b32 v75, 16, v102
    v_mfma_f32_16x16x32_bf16 v[40:43], v[128:131], a[208:211], v[40:43]
    ds_read_b128 v[112:115], v14 offset:24576
    v_mfma_f32_16x16x32_bf16 v[40:43], v[124:127], a[200:203], v[40:43]
    ds_read_b128 v[116:119], v14 offset:28672
    v_lshlrev_b32 v76, 16, v103
    v_mfma_f32_16x16x32_bf16 v[40:43], v[120:123], a[192:195], v[40:43]
    s_waitcnt lgkmcnt(2)
    v_mfma_f32_16x16x32_bf16 v[48:51], v[104:107], a[192:195], v[48:51]
    s_add_u32 m0, s73, 97792
    v_lshlrev_b32 v77, 16, v103
    v_mfma_f32_16x16x32_bf16 v[48:51], v[108:111], a[200:203], v[48:51]
L_pl_X_7:
    s_cbranch_execz L_wret
    buffer_load_dwordx4 v21, s[44:47], s20 offen offset:512 sc1 lds
    s_waitcnt lgkmcnt(0)
    v_mfma_f32_16x16x32_bf16 v[48:51], v[112:115], a[208:211], v[48:51]
    ds_read_b128 v[120:123], v14 offset:17408
    v_mfma_f32_16x16x32_bf16 v[48:51], v[116:119], a[216:219], v[48:51]
    ds_read_b128 v[124:127], v14 offset:21504
    v_mfma_f32_16x16x32_bf16 v[52:55], v[116:119], a[220:223], v[52:55]
    ds_read_b128 v[128:131], v14 offset:25600
    v_lshlrev_b32 v78, 16, v103
    v_mfma_f32_16x16x32_bf16 v[52:55], v[112:115], a[212:215], v[52:55]
    ds_read_b128 v[132:135], v14 offset:29696
    buffer_load_dwordx2 v[96:97], v26, s[44:47], s42 offen offset:0 sc1
    v_mfma_f32_16x16x32_bf16 v[52:55], v[108:111], a[204:207], v[52:55]
    s_add_u32 m0, s73, 99328
    v_lshlrev_b32 v79, 16, v103
    v_mfma_f32_16x16x32_bf16 v[52:55], v[104:107], a[196:199], v[52:55]
    buffer_load_dwordx4 v21, s[44:47], s21 offen offset:0 sc1 lds
    s_waitcnt lgkmcnt(2)
    v_mfma_f32_16x16x32_bf16 v[36:39], v[120:123], a[228:231], v[36:39]
    s_add_u32 m0, s73, 99840
    v_lshlrev_b32 v80, 16, v102
    v_mfma_f32_16x16x32_bf16 v[36:39], v[124:127], a[236:239], v[36:39]
    buffer_load_dwordx4 v21, s[44:47], s21 offen offset:512 sc1 lds
    s_waitcnt lgkmcnt(0)
    v_mfma_f32_16x16x32_bf16 v[36:39], v[128:131], a[244:247], v[36:39]
    ds_read_b128 v[104:107], v14 offset:18432
    v_mfma_f32_16x16x32_bf16 v[36:39], v[132:135], a[252:255], v[36:39]
    ds_read_b128 v[108:111], v14 offset:22528
    v_mfma_f32_16x16x32_bf16 v[32:35], v[132:135], a[248:251], v[32:35]
    ds_read_b128 v[112:115], v14 offset:26624
    v_lshlrev_b32 v81, 16, v102
    v_mfma_f32_16x16x32_bf16 v[32:35], v[128:131], a[240:243], v[32:35]
    ds_read_b128 v[116:119], v14 offset:30720
    v_mfma_f32_16x16x32_bf16 v[32:35], v[124:127], a[232:235], v[32:35]
    s_add_u32 m0, s73, 101376
    v_lshlrev_b32 v82, 16, v102
    v_mfma_f32_16x16x32_bf16 v[32:35], v[120:123], a[224:227], v[32:35]
    buffer_load_dwordx4 v21, s[44:47], s22 offen offset:0 sc1 lds
    s_waitcnt lgkmcnt(2)
    v_mfma_f32_16x16x32_bf16 v[40:43], v[104:107], a[224:227], v[40:43]
    buffer_load_dwordx2 v[98:99], v26, s[44:47], s42 offen offset:128 sc1
    v_mfma_f32_16x16x32_bf16 v[40:43], v[108:111], a[232:235], v[40:43]
    v_lshlrev_b32 v83, 16, v102
    s_waitcnt lgkmcnt(0)
    v_mfma_f32_16x16x32_bf16 v[40:43], v[112:115], a[240:243], v[40:43]
    ds_read_b128 v[120:123], v14 offset:19456
    v_mfma_f32_16x16x32_bf16 v[40:43], v[116:119], a[248:251], v[40:43]
    ds_read_b128 v[124:127], v14 offset:23552
    v_mfma_f32_16x16x32_bf16 v[44:47], v[116:119], a[252:255], v[44:47]
    ds_read_b128 v[128:131], v14 offset:27648
    v_lshlrev_b32 v84, 16, v103
    v_mfma_f32_16x16x32_bf16 v[44:47], v[112:115], a[244:247], v[44:47]
    ds_read_b128 v[132:135], v14 offset:31744
    v_mfma_f32_16x16x32_bf16 v[44:47], v[108:111], a[236:239], v[44:47]
    v_lshlrev_b32 v85, 16, v103
    v_mfma_f32_16x16x32_bf16 v[44:47], v[104:107], a[228:231], v[44:47]
    s_waitcnt lgkmcnt(2)
    v_mfma_f32_16x16x32_bf16 v[52:55], v[120:123], a[228:231], v[52:55]
    v_mfma_f32_16x16x32_bf16 v[52:55], v[124:127], a[236:239], v[52:55]
    v_lshlrev_b32 v86, 16, v103
    s_waitcnt lgkmcnt(0)
    v_mfma_f32_16x16x32_bf16 v[52:55], v[128:131], a[244:247], v[52:55]
    buffer_load_dwordx2 v[100:101], v18, s[44:47], s42 offen offset:0 sc1
    s_waitcnt vmcnt(14)
    s_barrier
    v_mfma_f32_16x16x32_bf16 v[52:55], v[132:135], a[252:255], v[52:55]
    ds_read_b128 v[104:107], v14 offset:32768
    v_lshlrev_b32 v87, 16, v103
    v_mfma_f32_16x16x32_bf16 v[48:51], v[132:135], a[248:251], v[48:51]
    ds_read_b128 v[108:111], v14 offset:36864
    v_add_u32 v10, 65536, v10
    v_mfma_f32_16x16x32_bf16 v[48:51], v[128:131], a[240:243], v[48:51]
    ds_read_b128 v[112:115], v14 offset:40960
    v_mfma_f32_16x16x32_bf16 v[48:51], v[124:127], a[232:235], v[48:51]
    ds_read_b128 v[116:119], v14 offset:45056
    v_add_u32 v11, 65536, v11
    v_mfma_f32_16x16x32_bf16 v[48:51], v[120:123], a[224:227], v[48:51]
    v_lshlrev_b32 v27, 16, v27
    s_branch L_Dc
L_idle:
    s_waitcnt vmcnt(0)
    s_barrier
    s_mov_b64 exec, 0
    s_call_b64 s[82:83], L_wc_D
    s_mov_b64 exec, -1
    s_mov_b32 s60, s36
    s_and_b32 s61, s37, 0xffff
    s_mov_b32 s62, 4096
    s_mov_b32 s63, 0x20000
    v_and_b32 v24, 15, v2
    s_lshl_b32 s7, s71, 6
    v_add_u32 v24, s7, v24
    s_and_b32 s8, s3, 1
    s_lshl_b32 s4, s8, 5
    v_add_u32 v25, s4, v24
    v_lshlrev_b32 v26, 3, v25
    v_mul_u32_u24 v25, 1152, v25
    v_bfe_u32 v31, v2, 4, 1
    v_lshl_add_u32 v25, v31, 5, v25
    v_lshrrev_b32 v31, 5, v2
    v_lshl_add_u32 v25, v31, 4, v25
    s_bfe_u32 s7, s2, 0x20003
    s_mul_i32 s7, s7, 288
    s_bfe_u32 s5, s2, 0x10003
    s_mul_i32 s5, s5, 32
    s_lshl_b32 s4, s72, 6
    s_add_u32 s4, s4, s7
    s_add_u32 s4, s4, s5
    s_lshl_b32 s5, s5, 3
    s_sub_u32 s7, s7, s5
    v_add_u32 v252, s4, v25
    s_xor_b32 s8, s3, s72
    s_and_b32 s4, s72, 1
    s_lshl1_add_u32 s4, s4, s8
    v_lshl_add_u32 v24, s4, 4, v24
    s_add_u32 s7, s7, 256
    s_cmp_lt_u32 s8, 2
    s_cselect_b32 s7, s7, 0x40000000
    v_lshlrev_b32 v18, 3, v24
    v_mul_u32_u24 v24, 1152, v24
    v_lshrrev_b32 v31, 4, v2
    v_lshl_add_u32 v24, v31, 3, v24
    v_add_u32 v253, s7, v24
    v_lshrrev_b32 v24, 3, v2
    v_and_b32 v25, 7, v2
    v_bfe_u32 v31, v2, 4, 2
    v_lshlrev_b32 v31, 1, v31
    v_xor_b32 v25, v25, v31
    v_lshlrev_b32 v24, 12, v24
    v_lshl_add_u32 v24, v25, 4, v24
    s_mul_i32 s7, s72, 36
    s_bitcmp1_b32 s3, 0
    s_addc_u32 s7, s7, 0
    s_lshl_b32 s7, s7, 17
    s_lshl_b32 s8, s71, 7
    s_add_u32 s7, s7, s8
    v_add_u32 v4, s7, v24
    v_add_u32 v5, 31744, v4
    v_add_u32 v6, 31744, v5
    v_add_u32 v7, 31744, v6
    v_lshrrev_b32 v24, 2, v2
    v_lshlrev_b32 v24, 7, v24
    v_and_b32 v25, 3, v2
    v_lshl_add_u32 v24, v25, 3, v24
    s_and_b32 s7, s73, 8192
    v_add_u32 v24, s7, v24
    v_bfe_u32 v31, v2, 3, 2
    s_and_b32 s7, s3, 1
    s_lshl_b32 s7, s7, 1
    v_xor_b32 v31, s7, v31
    v_lshl_add_u32 v10, v31, 5, v24
    v_xor_b32 v11, 32, v10
    v_and_b32 v24, 15, v2
    v_lshrrev_b32 v25, 4, v2
    v_mul_u32_u24 v25, 17408, v25
    v_lshl_add_u32 v24, v24, 4, v25
    s_mul_i32 s7, s72, 36
    s_and_b32 s8, s3, 1
    s_add_u32 s7, s7, s8
    s_mul_i32 s7, s7, 69632
    s_bfe_u32 s8, s2, 0x20003
    s_lshl_b32 s8, s8, 12
    s_add_u32 s7, s7, s8
    s_add_u32 s7, s7, 12795904
    v_add_u32 v23, s7, v24
    s_xor_b32 s7, s72, 0
    v_lshl_add_u32 v19, s7, 10, v23
    s_xor_b32 s7, s72, 1
    v_lshl_add_u32 v20, s7, 10, v23
    s_xor_b32 s7, s72, 2
    v_lshl_add_u32 v21, s7, 10, v23
    s_xor_b32 s7, s72, 3
    v_lshl_add_u32 v22, s7, 10, v23
    v_lshlrev_b32 v14, 4, v2
    v_add_u32 v14, 98304, v14
    v_add_u32 v1, 0x10000, v14
    s_bitcmp1_b32 s3, 1
    s_cselect_b32 s18, s85, s84
    s_mul_i32 s18, s18, 139264
    s_cselect_b32 s19, s87, s86
    s_mul_i32 s19, s19, 139264
    s_cselect_b32 s20, s89, s88
    s_mul_i32 s20, s20, 139264
    s_cselect_b32 s21, s91, s90
    s_mul_i32 s21, s21, 139264
    s_cselect_b32 s22, s93, s92
    s_mul_i32 s22, s22, 139264
    s_cselect_b32 s23, s95, s94
    s_mul_i32 s23, s23, 139264
    s_cselect_b32 s24, s97, s96
    s_mul_i32 s24, s24, 139264
    s_cselect_b32 s25, s99, s98
    s_mul_i32 s25, s25, 139264
    s_cselect_b32 s26, s101, s100
    s_mul_i32 s26, s26, 139264
    s_sub_u32 s4, s75, 252
    s_mul_i32 s4, s4, 1152
    s_mul_i32 s5, s3, 64
    s_add_u32 s4, s4, s5
    s_add_u32 s4, s4, 896
    s_lshl_b32 s4, s4, 12
    s_add_u32 s4, s4, 384
    v_lshlrev_b32 v24, 10, v2
    buffer_load_dword v255, v24, s[52:55], s4 offen
    s_add_u32 s4, s4, 65536
    buffer_load_dword v255, v24, s[52:55], s4 offen
    s_add_u32 s4, s4, 65536
    buffer_load_dword v255, v24, s[52:55], s4 offen
    s_add_u32 s4, s4, 65536
    buffer_load_dword v255, v24, s[52:55], s4 offen
    s_add_u32 s4, s4, 65536
    s_add_u32 m0, s73, 32768
    s_lshl_b32 s14, s84, 18
    buffer_load_dwordx4 v4, s[52:55], s14 offen offset:0 lds
    buffer_load_dwordx4 v5, s[52:55], s14 offen offset:1024 lds
    buffer_load_dwordx4 v6, s[52:55], s14 offen offset:2048 lds
    buffer_load_dwordx4 v7, s[52:55], s14 offen offset:3072 lds
    s_add_u32 m0, s73, 49152
    s_lshl_b32 s14, s85, 18
    buffer_load_dwordx4 v4, s[52:55], s14 offen offset:0 lds
    buffer_load_dwordx4 v5, s[52:55], s14 offen offset:1024 lds
    buffer_load_dwordx4 v6, s[52:55], s14 offen offset:2048 lds
    buffer_load_dwordx4 v7, s[52:55], s14 offen offset:3072 lds
    s_add_u32 m0, s73, 65536
    s_lshl_b32 s14, s86, 18
    buffer_load_dwordx4 v4, s[52:55], s14 offen offset:0 lds
    buffer_load_dwordx4 v5, s[52:55], s14 offen offset:1024 lds
    buffer_load_dwordx4 v6, s[52:55], s14 offen offset:2048 lds
    buffer_load_dwordx4 v7, s[52:55], s14 offen offset:3072 lds
    s_add_u32 m0, s73, 81920
    s_lshl_b32 s14, s87, 18
    buffer_load_dwordx4 v4, s[52:55], s14 offen offset:0 lds
    buffer_load_dwordx4 v5, s[52:55], s14 offen offset:1024 lds
    buffer_load_dwordx4 v6, s[52:55], s14 offen offset:2048 lds
    buffer_load_dwordx4 v7, s[52:55], s14 offen offset:3072 lds
    s_add_u32 m0, s73, 98304
    s_lshl_b32 s14, s88, 18
    buffer_load_dwordx4 v4, s[52:55], s14 offen offset:0 lds
    buffer_load_dwordx4 v5, s[52:55], s14 offen offset:1024 lds
    buffer_load_dwordx4 v6, s[52:55], s14 offen offset:2048 lds
    buffer_load_dwordx4 v7, s[52:55], s14 offen offset:3072 lds
    s_add_u32 m0, s73, 114688
    s_lshl_b32 s14, s89, 18
    buffer_load_dwordx4 v4, s[52:55], s14 offen offset:0 lds
    buffer_load_dwordx4 v5, s[52:55], s14 offen offset:1024 lds
    buffer_load_dwordx4 v6, s[52:55], s14 offen offset:2048 lds
    buffer_load_dwordx4 v7, s[52:55], s14 offen offset:3072 lds
    s_add_u32 m0, s73, 131072
    s_lshl_b32 s14, s90, 18
    buffer_load_dwordx4 v4, s[52:55], s14 offen offset:0 lds
    buffer_load_dwordx4 v5, s[52:55], s14 offen offset:1024 lds
    buffer_load_dwordx4 v6, s[52:55], s14 offen offset:2048 lds
    buffer_load_dwordx4 v7, s[52:55], s14 offen offset:3072 lds
    s_add_u32 m0, s73, 147456
    s_lshl_b32 s14, s91, 18
    buffer_load_dwordx4 v4, s[52:55], s14 offen offset:0 lds
    buffer_load_dwordx4 v5, s[52:55], s14 offen offset:1024 lds
    buffer_load_dwordx4 v6, s[52:55], s14 offen offset:2048 lds
    buffer_load_dwordx4 v7, s[52:55], s14 offen offset:3072 lds
    s_waitcnt vmcnt(28)
    s_barrier
    ds_read_b64_tr_b16 a[0:1], v10 offset:32768
    ds_read_b64_tr_b16 a[2:3], v10 offset:34816
    ds_read_b64_tr_b16 a[8:9], v10 offset:36864
    ds_read_b64_tr_b16 a[10:11], v10 offset:38912
    ds_read_b64_tr_b16 a[4:5], v11 offset:32768
    ds_read_b64_tr_b16 a[6:7], v11 offset:34816
    ds_read_b64_tr_b16 a[12:13], v11 offset:36864
    ds_read_b64_tr_b16 a[14:15], v11 offset:38912
    s_waitcnt vmcnt(24) lgkmcnt(0)
    s_barrier
    ds_read_b64_tr_b16 a[16:17], v10 offset:49152
    s_add_u32 m0, s73, 32768
    s_lshl_b32 s14, s92, 18
    ds_read_b64_tr_b16 a[18:19], v10 offset:51200
    buffer_load_dwordx4 v4, s[52:55], s14 offen offset:0 lds
    ds_read_b64_tr_b16 a[24:25], v10 offset:53248
    ds_read_b64_tr_b16 a[26:27], v10 offset:55296
    buffer_load_dwordx4 v5, s[52:55], s14 offen offset:1024 lds
    ds_read_b64_tr_b16 a[20:21], v11 offset:49152
    buffer_load_dwordx4 v6, s[52:55], s14 offen offset:2048 lds
    ds_read_b64_tr_b16 a[22:23], v11 offset:51200
    ds_read_b64_tr_b16 a[28:29], v11 offset:53248
    buffer_load_dwordx4 v7, s[52:55], s14 offen offset:3072 lds
    ds_read_b64_tr_b16 a[30:31], v11 offset:55296
    s_waitcnt vmcnt(24) lgkmcnt(0)
    s_barrier
    v_add_u32 v10, 65536, v10
    ds_read_b64_tr_b16 a[32:33], v10 offset:0
    s_add_u32 m0, s73, 49152
    s_lshl_b32 s14, s93, 18
    ds_read_b64_tr_b16 a[34:35], v10 offset:2048
    buffer_load_dwordx4 v4, s[52:55], s14 offen offset:0 lds
    ds_read_b64_tr_b16 a[40:41], v10 offset:4096
    ds_read_b64_tr_b16 a[42:43], v10 offset:6144
    buffer_load_dwordx4 v5, s[52:55], s14 offen offset:1024 lds
    v_add_u32 v11, 65536, v11
    ds_read_b64_tr_b16 a[36:37], v11 offset:0
    buffer_load_dwordx4 v6, s[52:55], s14 offen offset:2048 lds
    ds_read_b64_tr_b16 a[38:39], v11 offset:2048
    ds_read_b64_tr_b16 a[44:45], v11 offset:4096
    buffer_load_dwordx4 v7, s[52:55], s14 offen offset:3072 lds
    ds_read_b64_tr_b16 a[46:47], v11 offset:6144
    s_waitcnt vmcnt(24) lgkmcnt(0)
    s_barrier
    ds_read_b64_tr_b16 a[48:49], v10 offset:16384
    s_add_u32 m0, s73, 65536
    s_lshl_b32 s14, s94, 18
    ds_read_b64_tr_b16 a[50:51], v10 offset:18432
    buffer_load_dwordx4 v4, s[52:55], s14 offen offset:0 lds
    ds_read_b64_tr_b16 a[56:57], v10 offset:20480
    ds_read_b64_tr_b16 a[58:59], v10 offset:22528
    buffer_load_dwordx4 v5, s[52:55], s14 offen offset:1024 lds
    ds_read_b64_tr_b16 a[52:53], v11 offset:16384
    buffer_load_dwordx4 v6, s[52:55], s14 offen offset:2048 lds
    ds_read_b64_tr_b16 a[54:55], v11 offset:18432
    ds_read_b64_tr_b16 a[60:61], v11 offset:20480
    buffer_load_dwordx4 v7, s[52:55], s14 offen offset:3072 lds
    ds_read_b64_tr_b16 a[62:63], v11 offset:22528
    s_waitcnt vmcnt(24) lgkmcnt(0)
    s_barrier
    ds_read_b64_tr_b16 a[64:65], v10 offset:32768
    s_add_u32 m0, s73, 81920
    s_lshl_b32 s14, s95, 18
    ds_read_b64_tr_b16 a[66:67], v10 offset:34816
    buffer_load_dwordx4 v4, s[52:55], s14 offen offset:0 lds
    ds_read_b64_tr_b16 a[72:73], v10 offset:36864
    ds_read_b64_tr_b16 a[74:75], v10 offset:38912
    buffer_load_dwordx4 v5, s[52:55], s14 offen offset:1024 lds
    ds_read_b64_tr_b16 a[68:69], v11 offset:32768
    buffer_load_dwordx4 v6, s[52:55], s14 offen offset:2048 lds
    ds_read_b64_tr_b16 a[70:71], v11 offset:34816
    ds_read_b64_tr_b16 a[76:77], v11 offset:36864
    buffer_load_dwordx4 v7, s[52:55], s14 offen offset:3072 lds
    ds_read_b64_tr_b16 a[78:79], v11 offset:38912
    s_waitcnt vmcnt(24) lgkmcnt(0)
    s_barrier
    ds_read_b64_tr_b16 a[80:81], v10 offset:49152
    s_add_u32 m0, s73, 98304
    s_lshl_b32 s14, s96, 18
    ds_read_b64_tr_b16 a[82:83], v10 offset:51200
    buffer_load_dwordx4 v4, s[52:55], s14 offen offset:0 lds
    ds_read_b64_tr_b16 a[88:89], v10 offset:53248
    ds_read_b64_tr_b16 a[90:91], v10 offset:55296
    buffer_load_dwordx4 v5, s[52:55], s14 offen offset:1024 lds
    ds_read_b64_tr_b16 a[84:85], v11 offset:49152
    buffer_load_dwordx4 v6, s[52:55], s14 offen offset:2048 lds
    ds_read_b64_tr_b16 a[86:87], v11 offset:51200
    ds_read_b64_tr_b16 a[92:93], v11 offset:53248
    buffer_load_dwordx4 v7, s[52:55], s14 offen offset:3072 lds
    ds_read_b64_tr_b16 a[94:95], v11 offset:55296
    s_waitcnt vmcnt(24) lgkmcnt(0)
    s_barrier
    v_add_u32 v10, 65536, v10
    ds_read_b64_tr_b16 a[96:97], v10 offset:0
    s_add_u32 m0, s73, 114688
    s_lshl_b32 s14, s97, 18
    ds_read_b64_tr_b16 a[98:99], v10 offset:2048
    buffer_load_dwordx4 v4, s[52:55], s14 offen offset:0 lds
    ds_read_b64_tr_b16 a[104:105], v10 offset:4096
    ds_read_b64_tr_b16 a[106:107], v10 offset:6144
    buffer_load_dwordx4 v5, s[52:55], s14 offen offset:1024 lds
    v_add_u32 v11, 65536, v11
    ds_read_b64_tr_b16 a[100:101], v11 offset:0
    buffer_load_dwordx4 v6, s[52:55], s14 offen offset:2048 lds
    ds_read_b64_tr_b16 a[102:103], v11 offset:2048
    ds_read_b64_tr_b16 a[108:109], v11 offset:4096
    buffer_load_dwordx4 v7, s[52:55], s14 offen offset:3072 lds
    ds_read_b64_tr_b16 a[110:111], v11 offset:6144
    s_waitcnt vmcnt(24) lgkmcnt(0)
    s_barrier
    ds_read_b64_tr_b16 a[112:113], v10 offset:16384
    s_add_u32 m0, s73, 131072
    s_lshl_b32 s14, s98, 18
    ds_read_b64_tr_b16 a[114:115], v10 offset:18432
    buffer_load_dwordx4 v4, s[52:55], s14 offen offset:0 lds
    ds_read_b64_tr_b16 a[120:121], v10 offset:20480
    ds_read_b64_tr_b16 a[122:123], v10 offset:22528
    buffer_load_dwordx4 v5, s[52:55], s14 offen offset:1024 lds
    ds_read_b64_tr_b16 a[116:117], v11 offset:16384
    buffer_load_dwordx4 v6, s[52:55], s14 offen offset:2048 lds
    ds_read_b64_tr_b16 a[118:119], v11 offset:18432
    ds_read_b64_tr_b16 a[124:125], v11 offset:20480
    buffer_load_dwordx4 v7, s[52:55], s14 offen offset:3072 lds
    ds_read_b64_tr_b16 a[126:127], v11 offset:22528
    s_waitcnt vmcnt(24) lgkmcnt(0)
    s_barrier
    v_add_u32 v10, -131072, v10
    ds_read_b64_tr_b16 a[128:129], v10 offset:32768
    s_add_u32 m0, s73, 147456
    s_lshl_b32 s14, s99, 18
    ds_read_b64_tr_b16 a[130:131], v10 offset:34816
    buffer_load_dwordx4 v4, s[52:55], s14 offen offset:0 lds
    ds_read_b64_tr_b16 a[136:137], v10 offset:36864
    ds_read_b64_tr_b16 a[138:139], v10 offset:38912
    buffer_load_dwordx4 v5, s[52:55], s14 offen offset:1024 lds
    v_add_u32 v11, -131072, v11
    ds_read_b64_tr_b16 a[132:133], v11 offset:32768
    buffer_load_dwordx4 v6, s[52:55], s14 offen offset:2048 lds
    ds_read_b64_tr_b16 a[134:135], v11 offset:34816
    ds_read_b64_tr_b16 a[140:141], v11 offset:36864
    buffer_load_dwordx4 v7, s[52:55], s14 offen offset:3072 lds
    ds_read_b64_tr_b16 a[142:143], v11 offset:38912
    s_waitcnt vmcnt(24) lgkmcnt(0)
    s_barrier
    ds_read_b64_tr_b16 a[144:145], v10 offset:49152
    s_add_u32 m0, s73, 0
    s_lshl_b32 s14, s100, 18
    ds_read_b64_tr_b16 a[146:147], v10 offset:51200
    buffer_load_dwordx4 v4, s[52:55], s14 offen offset:0 lds
    ds_read_b64_tr_b16 a[152:153], v10 offset:53248
    ds_read_b64_tr_b16 a[154:155], v10 offset:55296
    buffer_load_dwordx4 v5, s[52:55], s14 offen offset:1024 lds
    ds_read_b64_tr_b16 a[148:149], v11 offset:49152
    buffer_load_dwordx4 v6, s[52:55], s14 offen offset:2048 lds
    ds_read_b64_tr_b16 a[150:151], v11 offset:51200
    ds_read_b64_tr_b16 a[156:157], v11 offset:53248
    buffer_load_dwordx4 v7, s[52:55], s14 offen offset:3072 lds
    ds_read_b64_tr_b16 a[158:159], v11 offset:55296
    s_waitcnt vmcnt(24) lgkmcnt(0)
    s_barrier
    v_add_u32 v10, 65536, v10
    ds_read_b64_tr_b16 a[160:161], v10 offset:0
    s_add_u32 m0, s73, 16384
    s_lshl_b32 s14, s101, 18
    ds_read_b64_tr_b16 a[162:163], v10 offset:2048
    buffer_load_dwordx4 v4, s[52:55], s14 offen offset:0 lds
    ds_read_b64_tr_b16 a[168:169], v10 offset:4096
    ds_read_b64_tr_b16 a[170:171], v10 offset:6144
    buffer_load_dwordx4 v5, s[52:55], s14 offen offset:1024 lds
    v_add_u32 v11, 65536, v11
    ds_read_b64_tr_b16 a[164:165], v11 offset:0
    buffer_load_dwordx4 v6, s[52:55], s14 offen offset:2048 lds
    ds_read_b64_tr_b16 a[166:167], v11 offset:2048
    ds_read_b64_tr_b16 a[172:173], v11 offset:4096
    buffer_load_dwordx4 v7, s[52:55], s14 offen offset:3072 lds
    ds_read_b64_tr_b16 a[174:175], v11 offset:6144
    s_waitcnt vmcnt(24) lgkmcnt(0)
    s_barrier
    ds_read_b64_tr_b16 a[176:177], v10 offset:16384
    ds_read_b64_tr_b16 a[178:179], v10 offset:18432
    ds_read_b64_tr_b16 a[184:185], v10 offset:20480
    ds_read_b64_tr_b16 a[186:187], v10 offset:22528
    ds_read_b64_tr_b16 a[180:181], v11 offset:16384
    ds_read_b64_tr_b16 a[182:183], v11 offset:18432
    ds_read_b64_tr_b16 a[188:189], v11 offset:20480
    ds_read_b64_tr_b16 a[190:191], v11 offset:22528
    s_waitcnt vmcnt(20) lgkmcnt(0)
    s_barrier
    ds_read_b64_tr_b16 a[192:193], v10 offset:32768
    ds_read_b64_tr_b16 a[194:195], v10 offset:34816
    ds_read_b64_tr_b16 a[200:201], v10 offset:36864
    ds_read_b64_tr_b16 a[202:203], v10 offset:38912
    ds_read_b64_tr_b16 a[196:197], v11 offset:32768
    ds_read_b64_tr_b16 a[198:199], v11 offset:34816
    ds_read_b64_tr_b16 a[204:205], v11 offset:36864
    ds_read_b64_tr_b16 a[206:207], v11 offset:38912
    s_waitcnt vmcnt(16) lgkmcnt(0)
    s_barrier
    ds_read_b64_tr_b16 a[208:209], v10 offset:49152
    ds_read_b64_tr_b16 a[210:211], v10 offset:51200
    ds_read_b64_tr_b16 a[216:217], v10 offset:53248
    ds_read_b64_tr_b16 a[218:219], v10 offset:55296
    ds_read_b64_tr_b16 a[212:213], v11 offset:49152
    ds_read_b64_tr_b16 a[214:215], v11 offset:51200
    ds_read_b64_tr_b16 a[220:221], v11 offset:53248
    ds_read_b64_tr_b16 a[222:223], v11 offset:55296
    s_waitcnt vmcnt(12) lgkmcnt(0)
    s_barrier
    v_add_u32 v10, 65536, v10
    ds_read_b64_tr_b16 a[224:225], v10 offset:0
    ds_read_b64_tr_b16 a[226:227], v10 offset:2048
    ds_read_b64_tr_b16 a[232:233], v10 offset:4096
    ds_read_b64_tr_b16 a[234:235], v10 offset:6144
    v_add_u32 v11, 65536, v11
    ds_read_b64_tr_b16 a[228:229], v11 offset:0
    ds_read_b64_tr_b16 a[230:231], v11 offset:2048
    ds_read_b64_tr_b16 a[236:237], v11 offset:4096
    ds_read_b64_tr_b16 a[238:239], v11 offset:6144
    s_waitcnt vmcnt(8) lgkmcnt(0)
    s_barrier
    ds_read_b64_tr_b16 a[240:241], v10 offset:16384
    ds_read_b64_tr_b16 a[242:243], v10 offset:18432
    ds_read_b64_tr_b16 a[248:249], v10 offset:20480
    ds_read_b64_tr_b16 a[250:251], v10 offset:22528
    ds_read_b64_tr_b16 a[244:245], v11 offset:16384
    ds_read_b64_tr_b16 a[246:247], v11 offset:18432
    ds_read_b64_tr_b16 a[252:253], v11 offset:20480
    ds_read_b64_tr_b16 a[254:255], v11 offset:22528
    s_waitcnt lgkmcnt(0)
    s_barrier
    v_add_u32 v10, -131072, v10
    v_add_u32 v11, -131072, v11
    s_mov_b64 exec, 0
    s_call_b64 s[82:83], L_wc_D
    s_mov_b64 exec, -1
    s_bfe_u32 s4, s2, 0x20003
    s_lshl2_add_u32 s4, s72, s4
    s_lshl_b32 s4, s4, 3
    s_lshr_b32 s5, s2, 4
    s_and_b32 s5, s5, 6
    s_add_u32 s4, s4, s5
    s_and_b32 s5, s2, 1
    s_add_u32 s4, s4, s5
    s_lshl_b32 s4, s4, 7
    s_add_u32 s4, s4, 12566528
    v_lshl_add_u32 v28, v2, 2, s4
    s_cmp_eq_u32 s3, 0
    s_cselect_b32 s4, 18, 0
    v_cmp_gt_u32 vcc, s4, v2
    v_mov_b32 v13, 0x40000000
    s_nop 0
    v_cndmask_b32 v28, v13, v28, vcc
    v_mov_b32 v13, s68
    v_cndmask_b32 v13, 0, v13, vcc
    v_mov_b32 v29, 0
    buffer_atomic_add v29, v28, s[44:47], 0 offen sc0 sc1
    s_branch L_DX
L_end:
.section .rodata,"a"
.p2align 6
.amdhsa_kernel recurrent_scan__ssm_conv_h3__mixer_token_mlp__prompt_kernel
  .amdhsa_next_free_vgpr 512
  .amdhsa_next_free_sgpr 102
  .amdhsa_accum_offset 256
  .amdhsa_group_segment_fixed_size 0
  .amdhsa_kernarg_size 112
  .amdhsa_user_sgpr_count 2
  .amdhsa_user_sgpr_kernarg_segment_ptr 1
  .amdhsa_system_sgpr_workgroup_id_x 1
  .amdhsa_float_denorm_mode_32 3
.end_amdhsa_kernel
```

```asm
; @launch grid=(256,1,1) block=(256,1,1) lds=163840
.amdgcn_target "amdgcn-amd-amdhsa--gfx950"
.text
.globl recurrent_scan__ssm_conv_h3__mixer_token_mlp__prompt_kernel
.p2align 8
.type recurrent_scan__ssm_conv_h3__mixer_token_mlp__prompt_kernel,@function
recurrent_scan__ssm_conv_h3__mixer_token_mlp__prompt_kernel:
    s_cmp_lt_u32 s2, 256
    s_cbranch_scc0 L_exit
    s_load_dwordx2 s[56:57], s[0:1], 0
    s_load_dwordx2 s[48:49], s[0:1], 8
    s_load_dwordx2 s[52:53], s[0:1], 16
    s_load_dwordx2 s[60:61], s[0:1], 24
    s_load_dwordx16 s[16:31], s[0:1], 0
    s_load_dwordx8 s[32:39], s[0:1], 64
    s_load_dwordx4 s[40:43], s[0:1], 96
    s_memrealtime s[12:13]
    v_lshrrev_b32 v1, 6, v0
    v_and_b32 v2, 63, v0
    s_getpc_b64 s[6:7]
L_pc:
    s_lshr_b32 s4, s2, 1
    s_and_b32 s4, s4, 124
    v_add_u32 v22, s4, v1
    v_lshl_add_u32 v22, v2, 7, v22
    v_lshlrev_b32 v22, 7, v22
    v_min_u32 v22, L_end-L_pc-4, v22
    s_mov_b64 exec, 31
    global_load_dword v255, v22, s[6:7]
    s_mov_b64 exec, -1
    v_readfirstlane_b32 s3, v1
    s_and_b32 s4, s2, 7
    s_lshr_b32 s5, s2, 3
    s_lshl_b32 s4, s4, 5
    s_add_u32 s68, s4, s5
    v_lshrrev_b32 v3, 5, v0
    v_and_b32 v4, 31, v0
    v_mul_u32_u24 v5, 1152, v3
    v_mad_u32_u24 v5, v4, 12, v5
    s_mul_i32 s15, s68, 9216
    s_mul_i32 s4, s3, 3072
    s_add_u32 s5, s4, s15
    s_sub_u32 s5, s5, 3456
    v_lshlrev_b32 v6, 4, v2
    v_add_u32 v7, s5, v6
    v_add_u32 v58, 1024, v7
    s_add_u32 s4, s4, 114688
    s_lshl_b32 s5, s3, 11
    s_add_u32 s11, s5, s15
    s_add_u32 s5, s5, 127360
    s_cmp_lt_u32 s2, 216
    s_cselect_b32 s9, 0, 106496
    s_sub_u32 s4, s4, s9
    s_sub_u32 s5, s5, s9
    s_mov_b32 m0, s4
    s_mov_b32 s58, 2359296
    s_mov_b32 s59, 0x20000
    s_mov_b32 s50, 2359296
    s_mov_b32 s51, 0x20000
    s_mov_b32 s54, 2359296
    s_mov_b32 s55, 0x20000
    s_mov_b32 s62, 4608
    s_mov_b32 s63, 0x20000
    v_lshlrev_b32 v59, 3, v0
    s_movk_i32 s10, 4096
    v_lshlrev_b32 v91, 3, v2
    v_or_b32 v22, s2, v0
    v_lshlrev_b32 v22, 8, v22
    s_mov_b32 s66, 256
    s_mov_b32 s67, 0x20000
    s_waitcnt lgkmcnt(0)
    buffer_load_dwordx3 v[8:10], v5, s[56:59], s15 offen offset:0
    buffer_load_dwordx3 v[12:14], v5, s[56:59], s15 offen offset:384
    buffer_load_dwordx3 v[16:18], v5, s[56:59], s15 offen offset:768
    s_mov_b32 s64, s40
    s_and_b32 s65, s41, 0xffff
    s_or_b32 s12, s12, 1
    v_mov_b32 v23, s12
    buffer_store_dword v23, v22, s[64:67], 0 offen sc1
    buffer_load_dwordx4 v7, s[48:51], 0 offen lds
    s_add_u32 m0, s4, 1024
    s_cmp_eq_u32 s3, 3
    buffer_load_dwordx4 v58, s[48:51], 0 offen lds
    buffer_load_dwordx4 v58, s[48:51], 0 offen offset:1024 lds
    s_cbranch_scc1 L_xld
L_nox:
    s_mov_b32 m0, s5
    buffer_load_dwordx2 v[98:99], v59, s[60:63], 0 offen
    buffer_load_dwordx4 v6, s[52:55], s11 offen lds
    buffer_load_dwordx4 v6, s[52:55], s11 offen offset:1024 lds
    buffer_load_dwordx2 v[100:101], v59, s[60:63], 0 offen offset:2048
    buffer_load_dwordx2 v[102:103], v59, s[60:63], s10 offen
    s_mov_b32 s44, s42
    s_and_b32 s45, s43, 0xffff
    s_mov_b32 s46, 42352640
    s_mov_b32 s47, 0x20000
    s_and_b32 s5, s2, 7
    s_lshr_b32 s6, s2, 3
    s_lshr_b32 s7, s6, 2
    s_lshr_b32 s8, s3, 1
    s_lshl1_add_u32 s9, s7, s8
    s_cmp_ge_u32 s9, 10
    s_addc_u32 s14, s9, 0
    s_cmp_ge_u32 s9, 3
    s_addc_u32 s14, s14, 0
    s_lshl3_add_u32 s8, s8, 3
    s_cmp_eq_u32 s7, 7
    s_cselect_b32 s14, s8, s14
    s_and_b32 s4, s5, 1
    s_lshl4_add_u32 s71, s4, s14
    s_lshr_b32 s13, s5, 1
    s_mov_b32 s72, s13
    s_lshl_b32 s73, s3, 12
    s_mov_b32 s52, s34
    s_and_b32 s53, s35, 0xffff
    s_mov_b32 s54, 18874368
    s_mov_b32 s55, 0x20000
    s_cmp_lt_u32 s6, 27
    s_cbranch_scc0 L_aux
    s_branch L_org
L_exit:
    s_endpgm
L_xld:
    s_mov_b64 exec, 0xffffff
    buffer_load_dwordx4 v58, s[48:51], 0 offen offset:2048 lds
    s_mov_b64 exec, -1
    s_mov_b32 m0, s5
    s_nop 0
    buffer_load_dwordx4 v6, s[52:55], s11 offen offset:2048 lds
    s_branch L_nox
L_nw_G:
    s_mov_b32 s5, 0
L_nl_G:
    buffer_load_dword v45, v54, s[64:67], 0 offen sc1
    s_waitcnt vmcnt(0)
    v_readfirstlane_b32 s68, v45
    s_nop 1
    s_cmp_lg_u32 s68, 0
    s_cbranch_scc1 L_ng_G
    s_add_u32 s5, s5, 1
    s_cmp_lt_u32 s5, 100000
    s_cbranch_scc1 L_nl_G
    s_branch L_ng_G
L_rs_p1G:
    s_mov_b32 s5, 0
L_rt_p1G:
    s_mov_b64 exec, vcc
    v_mov_b32 v29, 0
    buffer_atomic_add v29, v28, s[44:47], 0 offen sc0 sc1
    s_waitcnt vmcnt(0)
    v_cmp_ne_u32 vcc, v12, v29
    s_cbranch_vccz L_rx_p1G
    s_add_u32 s5, s5, 1
    s_cmp_lt_u32 s5, 100000
    s_cbranch_scc1 L_rt_p1G
L_rx_p1G:
    s_mov_b64 exec, -1
    s_branch L_ok_p1G
L_rs_p5:
    s_mov_b32 s5, 0
L_rt_p5:
    s_mov_b64 exec, vcc
    buffer_load_dword v29, v28, s[44:47], 0 offen sc1
    s_waitcnt vmcnt(0)
    v_cmp_ne_u32 vcc, s68, v29
    s_cbranch_vccz L_rx_p5
    s_add_u32 s5, s5, 1
    s_cmp_lt_u32 s5, 100000
    s_cbranch_scc1 L_rt_p5
L_rx_p5:
    s_mov_b64 exec, -1
    s_branch L_ok_p5
L_nw_X:
    s_mov_b32 s5, 0
L_nl_X:
    buffer_load_dword v45, v54, s[64:67], 0 offen sc1
    s_waitcnt vmcnt(0)
    v_readfirstlane_b32 s68, v45
    s_nop 1
    s_cmp_lg_u32 s68, 0
    s_cbranch_scc1 L_ng_X
    s_add_u32 s5, s5, 1
    s_cmp_lt_u32 s5, 100000
    s_cbranch_scc1 L_nl_X
    s_branch L_ng_X
L_rs_p1X:
    s_mov_b32 s5, 0
L_rt_p1X:
    s_mov_b64 exec, vcc
    v_mov_b32 v29, 0
    buffer_atomic_add v29, v28, s[44:47], 0 offen sc0 sc1
    s_waitcnt vmcnt(0)
    v_cmp_ne_u32 vcc, s68, v29
    s_cbranch_vccz L_rx_p1X
    s_add_u32 s5, s5, 1
    s_cmp_lt_u32 s5, 100000
    s_cbranch_scc1 L_rt_p1X
L_rx_p1X:
    s_mov_b64 exec, -1
    s_branch L_ok_p1X
L_rs_p2G:
    s_mov_b32 s5, 0
L_rt_p2G:
    s_mov_b64 exec, vcc
    v_mov_b32 v16, 0
    buffer_atomic_add v16, v15, s[44:47], 0 offen sc0 sc1
    s_waitcnt vmcnt(0)
    v_cmp_ne_u32 vcc, v13, v16
    s_cbranch_vccz L_rx_p2G
    s_add_u32 s5, s5, 1
    s_cmp_lt_u32 s5, 100000
    s_cbranch_scc1 L_rt_p2G
L_rx_p2G:
    s_mov_b64 exec, -1
    s_branch L_ok_p2G
L_xs_a:
    s_mov_b32 s5, 0
L_xt_a:
    v_mov_b32 v187, 0
    buffer_atomic_add v187, v137, s[44:47], 0 offen offset:12 sc0 sc1
    s_waitcnt vmcnt(0)
    v_cmp_ne_u32 vcc, v138, v187
    s_cbranch_vccz L_xr_a
    s_add_u32 s5, s5, 1
    s_cmp_lt_u32 s5, 100000
    s_cbranch_scc1 L_xt_a
L_xr_a:
    buffer_load_dwordx4 v[40:43], v136, s[44:47], s34 offen offset:0 sc1
    buffer_load_dwordx4 v[44:47], v136, s[44:47], s34 offen offset:1024 sc1
    buffer_load_dwordx4 v[48:51], v136, s[44:47], s34 offen offset:2048 sc1
    s_waitcnt vmcnt(0)
    v_bitop3_b32 v43, v43, v47, s68 bitop3:0x7e
    v_bitop3_b32 v43, v43, v51, s68 bitop3:0xf6
    v_cmp_ne_u32 vcc, 0, v43
    s_cbranch_vccz L_xo_a
    s_add_u32 s5, s5, 1
    s_cmp_lt_u32 s5, 100000
    s_cbranch_scc1 L_xt_a
    s_branch L_xo_a
L_as_b:
    s_mov_b32 s5, 0
L_at_b:
    v_mov_b32 v141, 0
    buffer_atomic_add v141, v139, s[44:47], s11 offen offset:2060 sc0 sc1
    s_waitcnt vmcnt(0)
    v_cmp_ne_u32 vcc, v140, v141
    s_cbranch_vccz L_ao_b
    s_add_u32 s5, s5, 1
    s_cmp_lt_u32 s5, 100000
    s_cbranch_scc1 L_at_b
    s_branch L_ao_b
L_xs_b:
    s_mov_b32 s5, 0
L_xt_b:
    buffer_load_dwordx4 v[56:59], v136, s[44:47], s11 offen offset:0 sc1
    buffer_load_dwordx4 v[60:63], v136, s[44:47], s11 offen offset:1024 sc1
    buffer_load_dwordx4 v[64:67], v136, s[44:47], s11 offen offset:2048 sc1
    s_waitcnt vmcnt(0)
    v_bitop3_b32 v59, v59, v63, s68 bitop3:0x7e
    v_bitop3_b32 v59, v59, v67, s68 bitop3:0xf6
    v_cmp_ne_u32 vcc, 0, v59
    s_cbranch_vccz L_xo_b
    s_add_u32 s5, s5, 1
    s_cmp_lt_u32 s5, 100000
    s_cbranch_scc1 L_xt_b
    s_branch L_xo_b
L_xs_z:
    s_mov_b32 s5, 0
L_xt_z:
    buffer_load_dwordx4 v[72:75], v136, s[44:47], s12 offen offset:0 sc1
    buffer_load_dwordx4 v[76:79], v136, s[44:47], s12 offen offset:1024 sc1
    buffer_load_dwordx4 v[80:83], v136, s[44:47], s12 offen offset:2048 sc1
    s_waitcnt vmcnt(0)
    v_bitop3_b32 v75, v75, v79, s68 bitop3:0x7e
    v_bitop3_b32 v75, v75, v83, s68 bitop3:0xf6
    v_cmp_ne_u32 vcc, 0, v75
    s_cbranch_vccz L_xo_z
    s_add_u32 s5, s5, 1
    s_cmp_lt_u32 s5, 100000
    s_cbranch_scc1 L_xt_z
    s_branch L_xo_z
L_rs_p3:
    s_mov_b32 s5, 0
L_rt_p3:
    s_mov_b64 exec, vcc
    buffer_load_dword v189, v188, s[44:47], 0 offen sc1
    s_waitcnt vmcnt(0)
    v_cmp_ne_u32 vcc, s68, v189
    s_cbranch_vccz L_rx_p3
    s_add_u32 s5, s5, 1
    s_cmp_lt_u32 s5, 100000
    s_cbranch_scc1 L_rt_p3
L_rx_p3:
    s_mov_b64 exec, -1
    s_branch L_ok_p3
L_xs_8:
    s_mov_b32 s5, 0
L_xt_8:
    v_mov_b32 v187, 0
    buffer_atomic_add v187, v137, s[44:47], 0 offen offset:12 sc0 sc1
    s_waitcnt vmcnt(0)
    v_cmp_ne_u32 vcc, v138, v187
    s_cbranch_vccz L_xr_8
    s_add_u32 s5, s5, 1
    s_cmp_lt_u32 s5, 100000
    s_cbranch_scc1 L_xt_8
L_xr_8:
    buffer_load_dwordx4 v[204:207], v136, s[44:47], s35 offen offset:0 sc1
    buffer_load_dwordx4 v[208:211], v136, s[44:47], s35 offen offset:1024 sc1
    buffer_load_dwordx4 v[212:215], v136, s[44:47], s35 offen offset:2048 sc1
    buffer_load_dwordx4 v[216:219], v136, s[44:47], s35 offen offset:3072 sc1
    s_waitcnt vmcnt(0)
    v_bitop3_b32 v207, v207, v211, s36 bitop3:0x7e
    v_bitop3_b32 v207, v207, v215, s36 bitop3:0xf6
    v_bitop3_b32 v207, v207, v219, s36 bitop3:0xf6
    v_cmp_ne_u32 vcc, 0, v207
    s_cbranch_vccz L_xo_8
    s_add_u32 s5, s5, 1
    s_cmp_lt_u32 s5, 100000
    s_cbranch_scc1 L_xt_8
    s_branch L_xo_8
L_rs_p2X:
    s_mov_b32 s5, 0
L_rt_p2X:
    s_mov_b64 exec, vcc
    v_mov_b32 v29, 0
    buffer_atomic_add v29, v28, s[44:47], 0 offen sc0 sc1
    s_waitcnt vmcnt(0)
    v_cmp_ne_u32 vcc, v13, v29
    s_cbranch_vccz L_rx_p2X
    s_add_u32 s5, s5, 1
    s_cmp_lt_u32 s5, 100000
    s_cbranch_scc1 L_rt_p2X
L_rx_p2X:
    s_mov_b64 exec, -1
    s_branch L_ok_p2X
L_wc_G:
    s_cmp_eq_u32 s3, 0
    s_cbranch_scc1 L_pl_G_0
    s_cmp_eq_u32 s3, 1
    s_cbranch_scc1 L_pl_G_1
    s_cmp_eq_u32 s3, 2
    s_cbranch_scc1 L_pl_G_2
    s_branch L_pl_G_3
L_wc_X:
    s_cmp_eq_u32 s3, 0
    s_cbranch_scc1 L_pl_X_0
    s_cmp_eq_u32 s3, 1
    s_cbranch_scc1 L_pl_X_1
    s_cmp_eq_u32 s3, 2
    s_cbranch_scc1 L_pl_X_2
    s_branch L_pl_X_3
L_wc_D:
    s_cmp_eq_u32 s3, 0
    s_cbranch_scc1 L_pl_D_0
    s_cmp_eq_u32 s3, 1
    s_cbranch_scc1 L_pl_D_1
    s_cmp_eq_u32 s3, 2
    s_cbranch_scc1 L_pl_D_2
    s_branch L_wret
L_wret:
    s_setpc_b64 s[82:83]
.p2align 12
L_org:
    s_mul_i32 s7, s6, 21846
    s_lshr_b32 s7, s7, 16
    s_mul_i32 s8, s7, 3
    s_sub_u32 s12, s6, s8
    s_mul_i32 s8, s13, 9
    s_add_u32 s69, s8, s7
    s_lshl1_add_u32 s70, s12, s4
    s_mul_i32 s8, s69, 6
    s_add_u32 s75, s8, s70
    s_mov_b32 s48, s30
    s_and_b32 s49, s31, 0xffff
    s_mov_b32 s50, 18874368
    s_mov_b32 s51, 0x20000
    s_add_u32 s12, s12, s7
    s_mul_i32 s8, s12, 21846
    s_lshr_b32 s8, s8, 16
    s_mul_i32 s8, s8, 3
    s_sub_u32 s12, s12, s8
    s_mul_i32 s4, s4, 16
    s_mul_i32 s7, s12, 65538
    s_lshr_b32 s7, s7, 16
    s_mul_i32 s7, s7, 1
    s_add_u32 s5, s4, 0
    s_add_u32 s18, s7, s5
    s_add_u32 s8, s5, 3
    s_add_u32 s19, s18, 1
    s_cmp_eq_u32 s19, s8
    s_cselect_b32 s19, s5, s19
    s_add_u32 s20, s19, 1
    s_cmp_eq_u32 s20, s8
    s_cselect_b32 s20, s5, s20
    s_mul_i32 s7, s12, 65538
    s_lshr_b32 s7, s7, 16
    s_mul_i32 s7, s7, 1
    s_add_u32 s5, s4, 3
    s_add_u32 s21, s7, s5
    s_add_u32 s8, s5, 3
    s_add_u32 s22, s21, 1
    s_cmp_eq_u32 s22, s8
    s_cselect_b32 s22, s5, s22
    s_add_u32 s23, s22, 1
    s_cmp_eq_u32 s23, s8
    s_cselect_b32 s23, s5, s23
    s_mul_i32 s7, s12, 87384
    s_lshr_b32 s7, s7, 16
    s_mul_i32 s7, s7, 1
    s_add_u32 s5, s4, 6
    s_add_u32 s24, s7, s5
    s_add_u32 s8, s5, 4
    s_add_u32 s25, s24, 1
    s_cmp_eq_u32 s25, s8
    s_cselect_b32 s25, s5, s25
    s_add_u32 s26, s25, 1
    s_cmp_eq_u32 s26, s8
    s_cselect_b32 s26, s5, s26
    s_add_u32 s27, s26, 1
    s_cmp_eq_u32 s27, s8
    s_cselect_b32 s27, s5, s27
    s_mul_i32 s7, s12, 131076
    s_lshr_b32 s7, s7, 16
    s_mul_i32 s7, s7, 1
    s_add_u32 s5, s4, 10
    s_add_u32 s76, s7, s5
    s_add_u32 s8, s5, 6
    s_add_u32 s77, s76, 1
    s_cmp_eq_u32 s77, s8
    s_cselect_b32 s77, s5, s77
    s_add_u32 s78, s77, 1
    s_cmp_eq_u32 s78, s8
    s_cselect_b32 s78, s5, s78
    s_add_u32 s79, s78, 1
    s_cmp_eq_u32 s79, s8
    s_cselect_b32 s79, s5, s79
    s_add_u32 s80, s79, 1
    s_cmp_eq_u32 s80, s8
    s_cselect_b32 s80, s5, s80
    s_add_u32 s81, s80, 1
    s_cmp_eq_u32 s81, s8
    s_cselect_b32 s81, s5, s81
    v_lshrrev_b32 v24, 4, v2
    v_and_b32 v25, 15, v2
    v_lshlrev_b32 v26, 1, v24
    v_xor_b32 v25, v25, v26
    v_mul_u32_u24 v24, 9216, v24
    v_lshl_add_u32 v24, v25, 4, v24
    s_mul_i32 s7, s3, 147456
    s_lshl_b32 s8, s69, 8
    s_add_u32 s7, s7, s8
    v_add_u32 v148, s7, v24
    v_add_u32 v149, 35840, v148
    v_xor_b32 v24, 128, v148
    v_add_u32 v150, 71680, v24
    v_add_u32 v151, 35840, v150
    s_mov_b32 s9, 144896
    s_mov_b32 s11, 114688
    v_mul_u32_u24 v48, 1216, v3
    v_mad_u32_u24 v48, v4, 12, v48
    v_add_u32 v48, s9, v48
    v_mov_b32 v47, 0x40000000
    v_lshlrev_b32 v3, 3, v3
    s_lshl_b32 s5, s68, 6
    s_add_u32 s5, s5, 12386304
    v_cmp_eq_u32 vcc, 0, v4
    s_nop 1
    v_cndmask_b32 v49, v47, v3, vcc
    v_lshrrev_b32 v5, 4, v0
    v_and_b32 v4, 3, v2
    v_lshlrev_b32 v4, 3, v4
    v_lshl_add_u32 v5, v5, 5, v4
    v_bfe_u32 v6, v2, 2, 2
    v_mul_u32_u24 v4, 1216, v6
    v_mul_u32_u24 v6, 1152, v6
    v_add3_u32 v50, v4, v5, s9
    v_add3_u32 v51, v6, v5, s11
    s_mul_i32 s4, s3, 2176
    v_add_u32 v55, s4, v51
    v_lshlrev_b32 v52, 4, v0
    s_add_u32 s7, s15, 4096
    s_add_u32 s8, s15, 8192
    s_cmp_eq_u32 s3, 0
    s_cselect_b32 s8, s8, 0x40000000
    v_add_u32 v53, 2359296, v52
    v_mov_b32 v54, 0
    v_add_u32 v4, 0, v52
    v_lshrrev_b32 v5, 7, v4
    v_mul_u32_u24 v6, 9363, v5
    v_lshrrev_b32 v6, 16, v6
    v_mad_i32_i24 v5, v6, -7, v5
    v_cmp_lt_u32 vcc, 2, v5
    s_nop 1
    v_addc_co_u32 v6, vcc, 0, v6, vcc
    v_lshl_add_u32 v93, v6, 7, v4
    v_add_u32 v4, 4096, v52
    v_lshrrev_b32 v5, 7, v4
    v_mul_u32_u24 v6, 9363, v5
    v_lshrrev_b32 v6, 16, v6
    v_mad_i32_i24 v5, v6, -7, v5
    v_cmp_lt_u32 vcc, 2, v5
    s_nop 1
    v_addc_co_u32 v6, vcc, 0, v6, vcc
    v_lshl_add_u32 v94, v6, 7, v4
    v_add_u32 v4, 8192, v52
    v_lshrrev_b32 v5, 7, v4
    v_mul_u32_u24 v6, 9363, v5
    v_lshrrev_b32 v6, 16, v6
    v_mad_i32_i24 v5, v6, -7, v5
    v_cmp_lt_u32 vcc, 2, v5
    s_nop 1
    v_addc_co_u32 v6, vcc, 0, v6, vcc
    v_lshl_add_u32 v95, v6, 7, v4
    s_mul_i32 s10, s68, 11264
    s_add_u32 s10, s10, 36585472
    s_cmp_eq_u32 s3, 0
    s_cselect_b32 s83, s10, 0x40000000
    s_add_u32 s7, s10, 2883584
    s_add_u32 s8, s83, 2883584
    s_mul_i32 s4, s3, 1028
    s_sub_u32 s4, 8204, s4
    v_add_u32 v90, s4, v53
    s_bfe_u32 s6, s68, 0x20001
    s_lshl_b32 s6, s6, 6
    s_lshr_b32 s9, s68, 3
    s_lshl1_add_u32 s6, s9, s6
    s_and_b32 s9, s68, 1
    s_add_u32 s6, s6, s9
    s_lshl_b32 s4, s6, 2
    s_add_u32 s4, s4, 12533760
    v_lshl_add_u32 v1, v0, 10, s4
    s_lshl_b32 s4, s68, 2
    s_add_u32 s4, s4, 12599296
    v_lshl_add_u32 v46, v0, 10, s4
    v_cmp_gt_u32 vcc, 8, v0
    s_nop 1
    v_cndmask_b32 v1, v47, v1, vcc
    v_cmp_gt_u32 vcc, 4, v0
    s_nop 1
    v_cndmask_b32 v46, v47, v46, vcc
    s_waitcnt vmcnt(9)
    v_and_b32 v21, 0xffff0000, v8
    s_add_u32 m0, s73, 81920
    s_mul_i32 s14, s18, 589824
    buffer_load_dwordx4 v148, s[48:51], s14 offen offset:0 lds
    v_lshlrev_b32 v20, 16, v8
    v_and_b32 v23, 0xffff0000, v9
    v_lshlrev_b32 v22, 16, v9
    v_and_b32 v25, 0xffff0000, v10
    v_lshlrev_b32 v24, 16, v10
    v_and_b32 v27, 0xffff0000, v12
    v_lshlrev_b32 v26, 16, v12
    v_and_b32 v29, 0xffff0000, v13
    v_lshlrev_b32 v28, 16, v13
    v_and_b32 v31, 0xffff0000, v14
    v_lshlrev_b32 v30, 16, v14
    v_and_b32 v33, 0xffff0000, v16
    v_lshlrev_b32 v32, 16, v16
    v_and_b32 v35, 0xffff0000, v17
    v_lshlrev_b32 v34, 16, v17
    v_and_b32 v37, 0xffff0000, v18
    v_lshlrev_b32 v36, 16, v18
    v_pk_add_f32 v[38:39], v[20:21], v[22:23]
    v_pk_add_f32 v[40:41], v[24:25], v[26:27]
    v_pk_add_f32 v[42:43], v[28:29], v[30:31]
    v_pk_add_f32 v[44:45], v[32:33], v[34:35]
    v_pk_add_f32 v[38:39], v[38:39], v[40:41]
    v_pk_add_f32 v[42:43], v[42:43], v[44:45]
    v_pk_add_f32 v[38:39], v[38:39], v[36:37]
    v_pk_add_f32 v[38:39], v[38:39], v[42:43]
    v_add_f32 v56, v38, v39
    buffer_load_dwordx4 v149, s[48:51], s14 offen offset:1024 lds
    s_nop 0
    v_add_f32_dpp v56, v56, v56 row_ror:8 row_mask:0xf bank_mask:0xf
    s_nop 1
    v_add_f32_dpp v56, v56, v56 row_ror:4 row_mask:0xf bank_mask:0xf
    s_nop 1
    v_add_f32_dpp v56, v56, v56 row_ror:2 row_mask:0xf bank_mask:0xf
    s_nop 1
    v_add_f32_dpp v56, v56, v56 row_ror:1 row_mask:0xf bank_mask:0xf
    v_mov_b32 v57, v56
    s_nop 1
    v_permlane16_swap_b32 v56, v57
    v_add_f32 v56, v56, v57
    v_mul_f32 v56, 0x3ae38e39, v56
    v_pk_add_f32 v[20:21], v[20:21], v[56:57] op_sel_hi:[1,0] neg_lo:[0,1] neg_hi:[0,1]
    v_pk_add_f32 v[22:23], v[22:23], v[56:57] op_sel_hi:[1,0] neg_lo:[0,1] neg_hi:[0,1]
    v_pk_add_f32 v[24:25], v[24:25], v[56:57] op_sel_hi:[1,0] neg_lo:[0,1] neg_hi:[0,1]
    v_pk_add_f32 v[26:27], v[26:27], v[56:57] op_sel_hi:[1,0] neg_lo:[0,1] neg_hi:[0,1]
    v_pk_add_f32 v[28:29], v[28:29], v[56:57] op_sel_hi:[1,0] neg_lo:[0,1] neg_hi:[0,1]
    v_pk_add_f32 v[30:31], v[30:31], v[56:57] op_sel_hi:[1,0] neg_lo:[0,1] neg_hi:[0,1]
    v_pk_add_f32 v[32:33], v[32:33], v[56:57] op_sel_hi:[1,0] neg_lo:[0,1] neg_hi:[0,1]
    v_pk_add_f32 v[34:35], v[34:35], v[56:57] op_sel_hi:[1,0] neg_lo:[0,1] neg_hi:[0,1]
    v_pk_add_f32 v[36:37], v[36:37], v[56:57] op_sel_hi:[1,0] neg_lo:[0,1] neg_hi:[0,1]
    v_pk_mul_f32 v[38:39], v[20:21], v[20:21]
    v_pk_mul_f32 v[40:41], v[22:23], v[22:23]
    v_pk_fma_f32 v[38:39], v[24:25], v[24:25], v[38:39]
    v_pk_fma_f32 v[40:41], v[26:27], v[26:27], v[40:41]
    v_pk_fma_f32 v[38:39], v[28:29], v[28:29], v[38:39]
    v_pk_fma_f32 v[40:41], v[30:31], v[30:31], v[40:41]
    v_pk_fma_f32 v[38:39], v[32:33], v[32:33], v[38:39]
    v_pk_fma_f32 v[40:41], v[34:35], v[34:35], v[40:41]
    v_pk_fma_f32 v[38:39], v[36:37], v[36:37], v[38:39]
    buffer_load_dwordx4 v150, s[48:51], s14 offen offset:2048 lds
    v_pk_add_f32 v[38:39], v[38:39], v[40:41]
    v_add_f32 v18, v38, v39
    s_nop 1
    v_add_f32_dpp v18, v18, v18 row_ror:8 row_mask:0xf bank_mask:0xf
    s_nop 1
    v_add_f32_dpp v18, v18, v18 row_ror:4 row_mask:0xf bank_mask:0xf
    s_nop 1
    v_add_f32_dpp v18, v18, v18 row_ror:2 row_mask:0xf bank_mask:0xf
    s_nop 1
    v_add_f32_dpp v18, v18, v18 row_ror:1 row_mask:0xf bank_mask:0xf
    v_mov_b32 v19, v18
    s_nop 1
    v_permlane16_swap_b32 v18, v19
    v_add_f32 v18, v18, v19
    v_mul_f32 v18, 0x3ae38e39, v18
    v_cvt_pk_bf16_f32 v38, v56, v18
    v_lshlrev_b32 v106, 16, v38
    v_and_b32 v38, 0xffff0000, v38
    v_add_f32 v38, 0x3727c5ac, v38
    v_sub_f32 v56, v56, v106
    v_cvt_pk_bf16_f32 v38, v38, v38
    v_lshlrev_b32 v38, 16, v38
    v_sqrt_f32 v38, v38
    s_nop 0
    v_cvt_pk_bf16_f32 v38, v38, v38
    v_lshlrev_b32 v38, 16, v38
    v_rcp_f32 v107, v38
    s_nop 0
    v_mul_f32 v56, v56, v107
    v_mul_f32 v18, v18, v107
    v_mul_f32 v18, v18, v107
    v_cvt_pk_bf16_f32 v38, v56, v18
    v_lshlrev_b32 v39, 16, v38
    buffer_load_dwordx4 v151, s[48:51], s14 offen offset:3072 lds
    v_and_b32 v38, 0xffff0000, v38
    v_add_f32 v38, 0x3727c5ac, v38
    v_sub_f32 v56, v56, v39
    v_cvt_pk_bf16_f32 v38, v38, v38
    v_lshlrev_b32 v38, 16, v38
    v_sqrt_f32 v38, v38
    s_nop 0
    v_cvt_pk_bf16_f32 v38, v38, v38
    v_lshlrev_b32 v38, 16, v38
    v_rcp_f32 v38, v38
    s_nop 0
    v_mul_f32 v18, v107, v38
    v_mul_f32 v56, v56, v38
    v_pk_fma_f32 v[20:21], v[20:21], v[18:19], v[56:57] op_sel_hi:[1,0,0]
    v_pk_fma_f32 v[22:23], v[22:23], v[18:19], v[56:57] op_sel_hi:[1,0,0]
    v_pk_fma_f32 v[24:25], v[24:25], v[18:19], v[56:57] op_sel_hi:[1,0,0]
    v_pk_fma_f32 v[26:27], v[26:27], v[18:19], v[56:57] op_sel_hi:[1,0,0]
    v_pk_fma_f32 v[28:29], v[28:29], v[18:19], v[56:57] op_sel_hi:[1,0,0]
    v_pk_fma_f32 v[30:31], v[30:31], v[18:19], v[56:57] op_sel_hi:[1,0,0]
    v_pk_fma_f32 v[32:33], v[32:33], v[18:19], v[56:57] op_sel_hi:[1,0,0]
    v_pk_fma_f32 v[34:35], v[34:35], v[18:19], v[56:57] op_sel_hi:[1,0,0]
    v_pk_fma_f32 v[36:37], v[36:37], v[18:19], v[56:57] op_sel_hi:[1,0,0]
    v_cvt_pk_bf16_f32 v8, v20, v21
    v_cvt_pk_bf16_f32 v9, v22, v23
    v_cvt_pk_bf16_f32 v10, v24, v25
    v_cvt_pk_bf16_f32 v11, v26, v27
    v_cvt_pk_bf16_f32 v12, v28, v29
    v_cvt_pk_bf16_f32 v13, v30, v31
    v_cvt_pk_bf16_f32 v14, v32, v33
    v_cvt_pk_bf16_f32 v15, v34, v35
    v_cvt_pk_bf16_f32 v16, v36, v37
    ds_write_b32 v48, v8 offset:0
    ds_write_b32 v48, v9 offset:4
    ds_write_b32 v48, v10 offset:8
    ds_write_b32 v48, v11 offset:384
    ds_write_b32 v48, v12 offset:388
    ds_write_b32 v48, v13 offset:392
    ds_write_b32 v48, v14 offset:768
    ds_write_b32 v48, v15 offset:772
    ds_write_b32 v48, v16 offset:776
    buffer_store_dwordx2 v[106:107], v49, s[44:47], s5 offen sc1
    s_waitcnt lgkmcnt(0)
    s_barrier
    ds_read_b64_tr_b16 v[20:21], v50 offset:0
    ds_read_b64_tr_b16 v[22:23], v50 offset:4864
    ds_read_b64_tr_b16 v[24:25], v50 offset:512
    ds_read_b64_tr_b16 v[26:27], v50 offset:5376
    ds_read_b64_tr_b16 v[28:29], v50 offset:1024
    ds_read_b64_tr_b16 v[30:31], v50 offset:5888
    s_waitcnt lgkmcnt(4)
    buffer_store_dwordx4 v[20:23], v93, s[44:47], s10 offen sc1
    s_waitcnt lgkmcnt(2)
    buffer_store_dwordx4 v[24:27], v94, s[44:47], s10 offen sc1
    s_waitcnt lgkmcnt(0)
    buffer_store_dwordx4 v[28:31], v95, s[44:47], s83 offen sc1
    buffer_load_dword v45, v54, s[64:67], 0 offen sc1
    s_waitcnt vmcnt(9)
    s_barrier
    ds_read_b64_tr_b16 v[60:61], v51 offset:0
    ds_read_b64_tr_b16 v[62:63], v51 offset:4608
    ds_read_b64_tr_b16 v[64:65], v51 offset:9216
    ds_read_b64_tr_b16 v[66:67], v51 offset:12672
    ds_read_b64_tr_b16 v[68:69], v51 offset:17280
    ds_read_b64_tr_b16 v[70:71], v51 offset:512
    ds_read_b64_tr_b16 v[72:73], v51 offset:5120
    ds_read_b64_tr_b16 v[74:75], v51 offset:9728
    ds_read_b64_tr_b16 v[76:77], v51 offset:13184
    ds_read_b64_tr_b16 v[78:79], v51 offset:17792
    v_alignbit_b32 v114, v99, v99, 16
    v_alignbit_b32 v115, v98, v98, 16
    s_waitcnt lgkmcnt(5)
    v_alignbit_b32 v108, v61, v60, 16
    v_alignbit_b32 v109, v62, v61, 16
    v_alignbit_b32 v110, v63, v62, 16
    v_alignbit_b32 v111, v64, v63, 16
    v_alignbit_b32 v112, v65, v64, 16
    v_dot2_f32_bf16 v116, v60, v114, 0
    ds_read_b64_tr_b16 v[80:81], v51 offset:1024
    v_dot2_f32_bf16 v117, v108, v114, 0
    v_dot2_f32_bf16 v118, v61, v114, 0
    v_dot2_f32_bf16 v119, v109, v114, 0
    v_dot2_f32_bf16 v120, v62, v114, 0
    ds_read_b64_tr_b16 v[82:83], v51 offset:5632
    v_dot2_f32_bf16 v121, v110, v114, 0
    v_dot2_f32_bf16 v122, v63, v114, 0
    v_dot2_f32_bf16 v123, v111, v114, 0
    v_dot2_f32_bf16 v116, v61, v115, v116
    v_dot2_f32_bf16 v117, v109, v115, v117
    ds_read_b64_tr_b16 v[84:85], v51 offset:10240
    v_dot2_f32_bf16 v118, v62, v115, v118
    v_dot2_f32_bf16 v119, v110, v115, v119
    v_dot2_f32_bf16 v120, v63, v115, v120
    v_dot2_f32_bf16 v121, v111, v115, v121
    v_dot2_f32_bf16 v122, v64, v115, v122
    ds_read_b64_tr_b16 v[86:87], v51 offset:13696
    v_dot2_f32_bf16 v123, v112, v115, v123
    v_and_b32 v133, 0xffff0000, v66
    v_lshlrev_b32 v132, 16, v66
    v_and_b32 v135, 0xffff0000, v67
    v_lshlrev_b32 v134, 16, v67
    ds_read_b64_tr_b16 v[88:89], v51 offset:18304
    v_and_b32 v137, 0xffff0000, v68
    v_lshlrev_b32 v136, 16, v68
    v_and_b32 v139, 0xffff0000, v69
    v_lshlrev_b32 v138, 16, v69
    v_pk_mul_f32 v[116:117], v[116:117], v[132:133]
    v_pk_mul_f32 v[118:119], v[118:119], v[134:135]
    v_pk_mul_f32 v[120:121], v[120:121], v[136:137]
    v_pk_mul_f32 v[122:123], v[122:123], v[138:139]
    v_cvt_pk_bf16_f32 v160, v123, v122
    v_cvt_pk_bf16_f32 v161, v121, v120
    v_cvt_pk_bf16_f32 v162, v119, v118
    v_cvt_pk_bf16_f32 v163, v117, v116
    buffer_store_dwordx4 v[160:163], v93, s[44:47], s7 offen sc1
    v_alignbit_b32 v114, v101, v101, 16
    v_alignbit_b32 v115, v100, v100, 16
    s_waitcnt lgkmcnt(5)
    v_alignbit_b32 v108, v71, v70, 16
    v_alignbit_b32 v109, v72, v71, 16
    v_alignbit_b32 v110, v73, v72, 16
    v_alignbit_b32 v111, v74, v73, 16
    v_alignbit_b32 v112, v75, v74, 16
    v_dot2_f32_bf16 v124, v70, v114, 0
    v_dot2_f32_bf16 v125, v108, v114, 0
    v_dot2_f32_bf16 v126, v71, v114, 0
    v_dot2_f32_bf16 v127, v109, v114, 0
    v_dot2_f32_bf16 v128, v72, v114, 0
    v_dot2_f32_bf16 v129, v110, v114, 0
    v_dot2_f32_bf16 v130, v73, v114, 0
    v_dot2_f32_bf16 v131, v111, v114, 0
    v_dot2_f32_bf16 v124, v71, v115, v124
    v_dot2_f32_bf16 v125, v109, v115, v125
    v_dot2_f32_bf16 v126, v72, v115, v126
    v_dot2_f32_bf16 v127, v110, v115, v127
    v_dot2_f32_bf16 v128, v73, v115, v128
    v_dot2_f32_bf16 v129, v111, v115, v129
    v_dot2_f32_bf16 v130, v74, v115, v130
    v_dot2_f32_bf16 v131, v112, v115, v131
    v_and_b32 v133, 0xffff0000, v76
    v_lshlrev_b32 v132, 16, v76
    v_and_b32 v135, 0xffff0000, v77
    v_lshlrev_b32 v134, 16, v77
    v_and_b32 v137, 0xffff0000, v78
    v_lshlrev_b32 v136, 16, v78
    v_and_b32 v139, 0xffff0000, v79
    v_lshlrev_b32 v138, 16, v79
    v_pk_mul_f32 v[124:125], v[124:125], v[132:133]
    v_pk_mul_f32 v[126:127], v[126:127], v[134:135]
    v_pk_mul_f32 v[128:129], v[128:129], v[136:137]
    v_pk_mul_f32 v[130:131], v[130:131], v[138:139]
    v_cvt_pk_bf16_f32 v164, v131, v130
    v_cvt_pk_bf16_f32 v165, v129, v128
    v_cvt_pk_bf16_f32 v166, v127, v126
    v_cvt_pk_bf16_f32 v167, v125, v124
    buffer_store_dwordx4 v[164:167], v94, s[44:47], s7 offen sc1
    v_alignbit_b32 v114, v103, v103, 16
    v_alignbit_b32 v115, v102, v102, 16
    s_waitcnt lgkmcnt(0)
    v_alignbit_b32 v108, v81, v80, 16
    v_alignbit_b32 v109, v82, v81, 16
    v_alignbit_b32 v110, v83, v82, 16
    v_alignbit_b32 v111, v84, v83, 16
    v_alignbit_b32 v112, v85, v84, 16
    v_dot2_f32_bf16 v116, v80, v114, 0
    v_dot2_f32_bf16 v117, v108, v114, 0
    v_dot2_f32_bf16 v118, v81, v114, 0
    v_dot2_f32_bf16 v119, v109, v114, 0
    v_dot2_f32_bf16 v120, v82, v114, 0
    v_dot2_f32_bf16 v121, v110, v114, 0
    v_dot2_f32_bf16 v122, v83, v114, 0
    v_dot2_f32_bf16 v123, v111, v114, 0
    v_dot2_f32_bf16 v116, v81, v115, v116
    v_dot2_f32_bf16 v117, v109, v115, v117
    v_dot2_f32_bf16 v118, v82, v115, v118
    v_dot2_f32_bf16 v119, v110, v115, v119
    v_dot2_f32_bf16 v120, v83, v115, v120
    v_dot2_f32_bf16 v121, v111, v115, v121
    v_dot2_f32_bf16 v122, v84, v115, v122
    v_dot2_f32_bf16 v123, v112, v115, v123
    v_and_b32 v133, 0xffff0000, v86
    v_lshlrev_b32 v132, 16, v86
    v_and_b32 v135, 0xffff0000, v87
    v_lshlrev_b32 v134, 16, v87
    v_and_b32 v137, 0xffff0000, v88
    v_lshlrev_b32 v136, 16, v88
    v_and_b32 v139, 0xffff0000, v89
    v_lshlrev_b32 v138, 16, v89
    v_pk_mul_f32 v[116:117], v[116:117], v[132:133]
    v_pk_mul_f32 v[118:119], v[118:119], v[134:135]
    v_pk_mul_f32 v[120:121], v[120:121], v[136:137]
    v_pk_mul_f32 v[122:123], v[122:123], v[138:139]
    v_cvt_pk_bf16_f32 v168, v123, v122
    v_cvt_pk_bf16_f32 v169, v121, v120
    v_cvt_pk_bf16_f32 v170, v119, v118
    v_cvt_pk_bf16_f32 v171, v117, v116
    buffer_store_dwordx4 v[168:171], v95, s[44:47], s8 offen sc1
    s_add_u32 m0, s73, 98304
    s_mul_i32 s14, s19, 589824
    buffer_load_dwordx4 v148, s[48:51], s14 offen offset:0 lds
    buffer_load_dwordx4 v149, s[48:51], s14 offen offset:1024 lds
    buffer_load_dwordx4 v150, s[48:51], s14 offen offset:2048 lds
    buffer_load_dwordx4 v151, s[48:51], s14 offen offset:3072 lds
    s_add_u32 m0, s73, 0
    s_mul_i32 s14, s20, 589824
    buffer_load_dwordx4 v148, s[48:51], s14 offen offset:0 lds
    buffer_load_dwordx4 v149, s[48:51], s14 offen offset:1024 lds
    buffer_load_dwordx4 v150, s[48:51], s14 offen offset:2048 lds
    buffer_load_dwordx4 v151, s[48:51], s14 offen offset:3072 lds
    s_add_u32 m0, s73, 16384
    s_mul_i32 s14, s21, 589824
    buffer_load_dwordx4 v148, s[48:51], s14 offen offset:0 lds
    buffer_load_dwordx4 v149, s[48:51], s14 offen offset:1024 lds
    s_waitcnt vmcnt(13)
    v_readfirstlane_b32 s68, v45
    s_nop 1
    s_cmp_eq_u32 s68, 0
    s_cbranch_scc1 L_nw_G
L_ng_G:
    s_barrier
    v_mov_b32 v3, s68
    buffer_store_dword v3, v1, s[44:47], 0 offen sc1
    s_mov_b64 exec, 0
    s_call_b64 s[82:83], L_wc_G
    s_mov_b64 exec, -1
    s_waitcnt vmcnt(11)
    s_barrier
    buffer_store_dword v3, v46, s[44:47], 0 offen sc1
L_segG:
L_pl_G_0:
    s_cbranch_execz L_pl_G_4
    buffer_load_dwordx4 v150, s[48:51], s14 offen offset:2048 lds
    buffer_load_dwordx4 v151, s[48:51], s14 offen offset:3072 lds
    s_add_u32 m0, s73, 32768
    s_mul_i32 s14, s22, 589824
    buffer_load_dwordx4 v148, s[48:51], s14 offen offset:0 lds
    buffer_load_dwordx4 v149, s[48:51], s14 offen offset:1024 lds
    buffer_load_dwordx4 v150, s[48:51], s14 offen offset:2048 lds
    buffer_load_dwordx4 v151, s[48:51], s14 offen offset:3072 lds
    s_add_u32 m0, s73, 49152
    s_mul_i32 s14, s23, 589824
    buffer_load_dwordx4 v148, s[48:51], s14 offen offset:0 lds
    buffer_load_dwordx4 v149, s[48:51], s14 offen offset:1024 lds
    buffer_load_dwordx4 v150, s[48:51], s14 offen offset:2048 lds
    buffer_load_dwordx4 v151, s[48:51], s14 offen offset:3072 lds
    s_add_u32 m0, s73, 65536
    s_mul_i32 s14, s24, 589824
    buffer_load_dwordx4 v148, s[48:51], s14 offen offset:0 lds
    buffer_load_dwordx4 v149, s[48:51], s14 offen offset:1024 lds
    buffer_load_dwordx4 v150, s[48:51], s14 offen offset:2048 lds
    buffer_load_dwordx4 v151, s[48:51], s14 offen offset:3072 lds
    v_bfe_u32 v140, v2, 2, 2
    v_lshrrev_b32 v141, 4, v2
    v_lshl_add_u32 v142, v141, 3, v140
    v_lshlrev_b32 v142, 8, v142
    v_and_b32 v143, 3, v2
    v_lshl_add_u32 v142, v143, 3, v142
    v_and_b32 v141, 1, v141
    v_lshl_add_u32 v140, v141, 2, v140
    s_lshl_b32 s7, s3, 1
    v_xor_b32 v140, s7, v140
    v_lshl_add_u32 v152, v140, 5, v142
    v_xor_b32 v153, 32, v152
    v_add_u32 v154, 0x10000, v152
    v_add_u32 v155, 0x10000, v153
    v_and_b32 v24, 15, v2
    v_lshrrev_b32 v25, 4, v2
    v_mul_u32_u24 v26, 17408, v25
    v_lshl_add_u32 v26, v24, 4, v26
    v_mul_u32_u24 v25, 1536, v25
    v_lshl_add_u32 v25, v24, 4, v25
    v_add_u32 v159, 81920, v25
    v_add_u32 v250, 36864, v159
    s_mul_i32 s7, s3, 18432
    s_xor_b32 s8, s70, 1
    s_mul_i32 s8, s8, 1536
    s_add_u32 s7, s7, s8
    v_lshlrev_b32 v246, 4, v2
    v_add_u32 v156, s7, v246
    v_lshrrev_b32 v25, 5, v2
    v_mul_u32_u24 v25, 7680, v25
    v_add_u32 v157, v156, v25
    v_add_u32 v158, 7680, v156
    s_mul_i32 s74, s3, 3072
    s_add_u32 s74, s74, 81920
    v_mov_b32 v245, v26
    s_mov_b64 exec, 0
    s_call_b64 s[82:83], L_wc_D
    s_mov_b64 exec, -1
    s_mov_b32 s56, s32
    s_and_b32 s57, s33, 0xffff
    s_mov_b32 s58, 9216
    s_mov_b32 s59, 0x20000
    s_mov_b32 s60, s36
    s_and_b32 s61, s37, 0xffff
    s_mov_b32 s62, 4096
    s_mov_b32 s63, 0x20000
    s_and_b32 s4, s70, 1
    s_lshl1_add_u32 s4, s3, s4
    s_lshl_b32 s4, s4, 7
    s_bfe_u32 s5, s2, 0x10003
    s_lshl1_add_u32 s5, s72, s5
    s_lshr_b32 s5, s5, 0
    s_lshl_b32 s5, s5, 10
    s_add_u32 s4, s4, s5
    s_add_u32 s4, s4, 12533760
    v_lshl_add_u32 v28, v2, 2, s4
    v_cmp_gt_u32 vcc, 32, v2
    v_mov_b32 v12, 0x40000000
    s_nop 0
    v_cndmask_b32 v28, v12, v28, vcc
    v_mov_b32 v12, s68
    v_cndmask_b32 v12, 0, v12, vcc
    v_lshrrev_b32 v24, 4, v2
    v_lshlrev_b32 v25, 3, v24
    s_lshl_b32 s7, s69, 8
    s_lshl_b32 s8, s3, 6
    s_add_u32 s7, s7, s8
    buffer_load_dwordx2 v[144:145], v25, s[56:59], s7 offen
    buffer_load_dwordx2 v[146:147], v25, s[56:59], s7 offen offset:32
    s_waitcnt vmcnt(24)
    s_barrier
    ds_read_b64_tr_b16 a[0:1], v154 offset:16384
    ds_read_b64_tr_b16 a[2:3], v154 offset:17408
    ds_read_b64_tr_b16 a[4:5], v155 offset:16384
    ds_read_b64_tr_b16 a[6:7], v155 offset:17408
    ds_read_b64_tr_b16 a[8:9], v154 offset:24576
    ds_read_b64_tr_b16 a[10:11], v154 offset:25600
    ds_read_b64_tr_b16 a[12:13], v155 offset:24576
    ds_read_b64_tr_b16 a[14:15], v155 offset:25600
    ds_read_b64_tr_b16 a[16:17], v154 offset:32768
    ds_read_b64_tr_b16 a[18:19], v154 offset:33792
    ds_read_b64_tr_b16 a[20:21], v155 offset:32768
    ds_read_b64_tr_b16 a[22:23], v155 offset:33792
    ds_read_b64_tr_b16 a[24:25], v154 offset:40960
    ds_read_b64_tr_b16 a[26:27], v154 offset:41984
    ds_read_b64_tr_b16 a[28:29], v155 offset:40960
    ds_read_b64_tr_b16 a[30:31], v155 offset:41984
    s_waitcnt vmcnt(20)
    s_barrier
    ds_read_b64_tr_b16 a[32:33], v152 offset:0
    ds_read_b64_tr_b16 a[34:35], v152 offset:1024
    ds_read_b64_tr_b16 a[36:37], v153 offset:0
    ds_read_b64_tr_b16 a[38:39], v153 offset:1024
    ds_read_b64_tr_b16 a[40:41], v152 offset:8192
    ds_read_b64_tr_b16 a[42:43], v152 offset:9216
    ds_read_b64_tr_b16 a[44:45], v153 offset:8192
    ds_read_b64_tr_b16 a[46:47], v153 offset:9216
    s_waitcnt vmcnt(14)
    s_barrier
    ds_read_b64_tr_b16 a[48:49], v152 offset:16384
    ds_read_b64_tr_b16 a[50:51], v152 offset:17408
    ds_read_b64_tr_b16 a[52:53], v153 offset:16384
    ds_read_b64_tr_b16 a[54:55], v153 offset:17408
    ds_read_b64_tr_b16 a[56:57], v152 offset:24576
    ds_read_b64_tr_b16 a[58:59], v152 offset:25600
    ds_read_b64_tr_b16 a[60:61], v153 offset:24576
    ds_read_b64_tr_b16 a[62:63], v153 offset:25600
    v_mov_b32 v29, 0
    buffer_atomic_add v29, v28, s[44:47], 0 offen sc0 sc1
    s_waitcnt vmcnt(11)
    s_barrier
    ds_read_b64_tr_b16 a[64:65], v152 offset:32768
    ds_read_b64_tr_b16 a[66:67], v152 offset:33792
    ds_read_b64_tr_b16 a[68:69], v153 offset:32768
    ds_read_b64_tr_b16 a[70:71], v153 offset:33792
    ds_read_b64_tr_b16 a[72:73], v152 offset:40960
    ds_read_b64_tr_b16 a[74:75], v152 offset:41984
    ds_read_b64_tr_b16 a[76:77], v153 offset:40960
    ds_read_b64_tr_b16 a[78:79], v153 offset:41984
L_pl_G_1:
    s_cbranch_execz L_pl_G_5
    s_waitcnt lgkmcnt(0)
    s_barrier
    s_xor_b32 s8, s70, 1
    s_mul_i32 s8, s8, 1536
    s_mul_i32 s7, s3, 22528
    s_add_u32 s7, s7, 36585472
    v_add_u32 v24, 0, v246
    v_cmp_lt_u32 vcc, 1535, v24
    s_nop 1
    v_cndmask_b32 v25, 0, 1, vcc
    v_mul_u32_u24 v30, 1536, v25
    v_sub_u32 v24, v24, v30
    v_add_u32 v24, s8, v24
    v_lshrrev_b32 v30, 7, v24
    v_mul_u32_u24 v31, 9363, v30
    v_lshrrev_b32 v31, 16, v31
    v_mad_i32_i24 v30, v31, -7, v30
    v_cmp_lt_u32 vcc, 2, v30
    s_nop 1
    v_addc_co_u32 v31, vcc, 0, v31, vcc
    v_lshl_add_u32 v24, v31, 7, v24
    v_mul_u32_u24 v25, 11264, v25
    v_add3_u32 v24, v24, v25, s7
    v_subrev_u32 v156, 0, v24
    v_add_u32 v24, 1024, v246
    v_cmp_lt_u32 vcc, 1535, v24
    s_nop 1
    v_cndmask_b32 v25, 0, 1, vcc
    v_mul_u32_u24 v30, 1536, v25
    v_sub_u32 v24, v24, v30
    v_add_u32 v24, s8, v24
    v_lshrrev_b32 v30, 7, v24
    v_mul_u32_u24 v31, 9363, v30
    v_lshrrev_b32 v31, 16, v31
    v_mad_i32_i24 v30, v31, -7, v30
    v_cmp_lt_u32 vcc, 2, v30
    s_nop 1
    v_addc_co_u32 v31, vcc, 0, v31, vcc
    v_lshl_add_u32 v24, v31, 7, v24
    v_mul_u32_u24 v25, 11264, v25
    v_add3_u32 v24, v24, v25, s7
    v_subrev_u32 v157, 1024, v24
    v_add_u32 v24, 2048, v246
    v_cmp_lt_u32 vcc, 1535, v24
    s_nop 1
    v_cndmask_b32 v25, 0, 1, vcc
    v_mul_u32_u24 v30, 1536, v25
    v_sub_u32 v24, v24, v30
    v_add_u32 v24, s8, v24
    v_lshrrev_b32 v30, 7, v24
    v_mul_u32_u24 v31, 9363, v30
    v_lshrrev_b32 v31, 16, v31
    v_mad_i32_i24 v30, v31, -7, v30
    v_cmp_lt_u32 vcc, 2, v30
    s_nop 1
    v_addc_co_u32 v31, vcc, 0, v31, vcc
    v_lshl_add_u32 v24, v31, 7, v24
    v_mul_u32_u24 v25, 11264, v25
    v_add3_u32 v24, v24, v25, s7
    v_subrev_u32 v158, 2048, v24
    s_xor_b32 s8, s70, 0
    s_mul_i32 s8, s8, 1536
    s_mul_i32 s7, s3, 22528
    s_add_u32 s7, s7, 36585472
    v_add_u32 v24, 0, v246
    v_cmp_lt_u32 vcc, 1535, v24
    s_nop 1
    v_cndmask_b32 v25, 0, 1, vcc
    v_mul_u32_u24 v30, 1536, v25
    v_sub_u32 v24, v24, v30
    v_add_u32 v24, s8, v24
    v_lshrrev_b32 v30, 7, v24
    v_mul_u32_u24 v31, 9363, v30
    v_lshrrev_b32 v31, 16, v31
    v_mad_i32_i24 v30, v31, -7, v30
    v_cmp_lt_u32 vcc, 2, v30
    s_nop 1
    v_addc_co_u32 v31, vcc, 0, v31, vcc
    v_lshl_add_u32 v24, v31, 7, v24
    v_mul_u32_u24 v25, 11264, v25
    v_add3_u32 v24, v24, v25, s7
    v_subrev_u32 v8, 0, v24
    v_add_u32 v24, 1024, v246
    v_cmp_lt_u32 vcc, 1535, v24
    s_nop 1
    v_cndmask_b32 v25, 0, 1, vcc
    v_mul_u32_u24 v30, 1536, v25
    v_sub_u32 v24, v24, v30
    v_add_u32 v24, s8, v24
    v_lshrrev_b32 v30, 7, v24
    v_mul_u32_u24 v31, 9363, v30
    v_lshrrev_b32 v31, 16, v31
    v_mad_i32_i24 v30, v31, -7, v30
    v_cmp_lt_u32 vcc, 2, v30
    s_nop 1
    v_addc_co_u32 v31, vcc, 0, v31, vcc
    v_lshl_add_u32 v24, v31, 7, v24
    v_mul_u32_u24 v25, 11264, v25
    v_add3_u32 v24, v24, v25, s7
    v_subrev_u32 v9, 1024, v24
    v_add_u32 v24, 2048, v246
    v_cmp_lt_u32 vcc, 1535, v24
    s_nop 1
    v_cndmask_b32 v25, 0, 1, vcc
    v_mul_u32_u24 v30, 1536, v25
    v_sub_u32 v24, v24, v30
    v_add_u32 v24, s8, v24
    v_lshrrev_b32 v30, 7, v24
    v_mul_u32_u24 v31, 9363, v30
    v_lshrrev_b32 v31, 16, v31
    v_mad_i32_i24 v30, v31, -7, v30
    v_cmp_lt_u32 vcc, 2, v30
    s_nop 1
    v_addc_co_u32 v31, vcc, 0, v31, vcc
    v_lshl_add_u32 v24, v31, 7, v24
    v_mul_u32_u24 v25, 11264, v25
    v_add3_u32 v24, v24, v25, s7
    v_subrev_u32 v3, 2048, v24
    s_waitcnt vmcnt(0)
    v_cmp_ne_u32 vcc, v12, v29
    s_cbranch_vccnz L_rs_p1G
L_ok_p1G:
    s_add_u32 m0, s74, 0
    s_mul_i32 s13, s18, 90112
    buffer_load_dwordx4 v156, s[44:47], s13 offen offset:0 sc1 lds
    buffer_load_dwordx4 v157, s[44:47], s13 offen offset:1024 sc1 lds
    buffer_load_dwordx4 v158, s[44:47], s13 offen offset:2048 sc1 lds
    s_add_u32 m0, s74, 12288
    s_mul_i32 s13, s19, 90112
    buffer_load_dwordx4 v156, s[44:47], s13 offen offset:0 sc1 lds
    buffer_load_dwordx4 v157, s[44:47], s13 offen offset:1024 sc1 lds
    buffer_load_dwordx4 v158, s[44:47], s13 offen offset:2048 sc1 lds
    s_add_u32 m0, s74, 24576
    s_mul_i32 s13, s20, 90112
    buffer_load_dwordx4 v156, s[44:47], s13 offen offset:0 sc1 lds
    buffer_load_dwordx4 v157, s[44:47], s13 offen offset:1024 sc1 lds
    buffer_load_dwordx4 v158, s[44:47], s13 offen offset:2048 sc1 lds
    s_add_u32 m0, s74, 36864
    s_mul_i32 s13, s21, 90112
    buffer_load_dwordx4 v156, s[44:47], s13 offen offset:0 sc1 lds
    buffer_load_dwordx4 v157, s[44:47], s13 offen offset:1024 sc1 lds
    buffer_load_dwordx4 v158, s[44:47], s13 offen offset:2048 sc1 lds
    s_waitcnt vmcnt(9) lgkmcnt(0)
    s_barrier
    ds_read_b128 v[80:83], v159 offset:0
    ds_read_b128 v[84:87], v159 offset:6144
    ds_read_b128 v[88:91], v159 offset:256
    ds_read_b128 v[92:95], v159 offset:6400
    ds_read_b128 v[96:99], v159 offset:512
    ds_read_b128 v[100:103], v159 offset:6656
    s_waitcnt lgkmcnt(0)
    v_mfma_f32_16x16x32_bf16 v[192:195], a[0:3], v[80:83], 0
    v_mfma_f32_16x16x32_bf16 v[192:195], a[8:11], v[84:87], v[192:195]
    ds_read_b128 v[104:107], v159 offset:768
    v_mfma_f32_16x16x32_bf16 v[196:199], a[12:15], v[84:87], 0
    ds_read_b128 v[108:111], v159 offset:6912
    v_mfma_f32_16x16x32_bf16 v[196:199], a[4:7], v[80:83], v[196:199]
    ds_read_b128 v[112:115], v159 offset:1024
    v_mfma_f32_16x16x32_bf16 v[204:207], a[4:7], v[88:91], 0
    ds_read_b128 v[116:119], v159 offset:7168
    v_mfma_f32_16x16x32_bf16 v[204:207], a[12:15], v[92:95], v[204:207]
    ds_read_b128 v[120:123], v159 offset:1280
    v_mfma_f32_16x16x32_bf16 v[200:203], a[8:11], v[92:95], 0
    ds_read_b128 v[124:127], v159 offset:7424
    v_and_b32 v24, 15, v2
    s_lshl_b32 s7, s71, 6
    v_add_u32 v24, s7, v24
    s_and_b32 s8, s3, 1
    s_lshl_b32 s4, s8, 5
    v_add_u32 v25, s4, v24
    v_lshlrev_b32 v26, 3, v25
    v_mul_u32_u24 v25, 1152, v25
    v_bfe_u32 v31, v2, 4, 1
    v_lshl_add_u32 v25, v31, 5, v25
    v_lshrrev_b32 v31, 5, v2
    v_lshl_add_u32 v25, v31, 4, v25
    s_bfe_u32 s7, s2, 0x20003
    s_mul_i32 s7, s7, 288
    s_bfe_u32 s5, s2, 0x10003
    s_mul_i32 s5, s5, 32
    s_lshl_b32 s4, s72, 6
    s_add_u32 s4, s4, s7
    s_add_u32 s4, s4, s5
    s_lshl_b32 s5, s5, 3
    s_sub_u32 s7, s7, s5
    v_add_u32 v252, s4, v25
    s_xor_b32 s8, s3, s72
    s_and_b32 s4, s72, 1
    s_lshl1_add_u32 s4, s4, s8
    v_lshl_add_u32 v24, s4, 4, v24
    s_add_u32 s7, s7, 256
    s_cmp_lt_u32 s8, 2
    s_cselect_b32 s7, s7, 0x40000000
    v_mfma_f32_16x16x32_bf16 v[200:203], a[0:3], v[88:91], v[200:203]
    v_mfma_f32_16x16x32_bf16 v[208:211], a[0:3], v[96:99], 0
    v_mfma_f32_16x16x32_bf16 v[208:211], a[8:11], v[100:103], v[208:211]
    v_mfma_f32_16x16x32_bf16 v[212:215], a[12:15], v[100:103], 0
    v_mfma_f32_16x16x32_bf16 v[212:215], a[4:7], v[96:99], v[212:215]
    s_waitcnt lgkmcnt(0)
    v_mfma_f32_16x16x32_bf16 v[220:223], a[4:7], v[104:107], 0
    s_waitcnt vmcnt(6)
    s_barrier
    v_mfma_f32_16x16x32_bf16 v[220:223], a[12:15], v[108:111], v[220:223]
    ds_read_b128 v[80:83], v159 offset:12288
    s_add_u32 m0, s74, 49152
    s_mul_i32 s13, s22, 90112
    v_mfma_f32_16x16x32_bf16 v[216:219], a[8:11], v[108:111], 0
    ds_read_b128 v[84:87], v159 offset:18432
    buffer_load_dwordx4 v156, s[44:47], s13 offen offset:0 sc1 lds
    v_mfma_f32_16x16x32_bf16 v[216:219], a[0:3], v[104:107], v[216:219]
    ds_read_b128 v[88:91], v159 offset:12544
    v_mfma_f32_16x16x32_bf16 v[224:227], a[0:3], v[112:115], 0
    ds_read_b128 v[92:95], v159 offset:18688
    buffer_load_dwordx4 v157, s[44:47], s13 offen offset:1024 sc1 lds
    v_mfma_f32_16x16x32_bf16 v[224:227], a[8:11], v[116:119], v[224:227]
    ds_read_b128 v[96:99], v159 offset:12800
    v_mfma_f32_16x16x32_bf16 v[228:231], a[12:15], v[116:119], 0
    ds_read_b128 v[100:103], v159 offset:18944
    buffer_load_dwordx4 v158, s[44:47], s13 offen offset:2048 sc1 lds
    v_lshlrev_b32 v18, 3, v24
    v_mul_u32_u24 v24, 1152, v24
    v_lshrrev_b32 v31, 4, v2
    v_lshl_add_u32 v24, v31, 3, v24
    v_add_u32 v253, s7, v24
    v_lshrrev_b32 v24, 3, v2
    v_and_b32 v25, 7, v2
    v_bfe_u32 v31, v2, 4, 2
    v_lshlrev_b32 v31, 1, v31
    v_xor_b32 v25, v25, v31
    v_lshlrev_b32 v24, 12, v24
    v_lshl_add_u32 v24, v25, 4, v24
    s_mul_i32 s7, s72, 36
    s_bitcmp1_b32 s3, 0
    s_addc_u32 s7, s7, 0
    s_lshl_b32 s7, s7, 17
    s_lshl_b32 s8, s71, 7
    s_add_u32 s7, s7, s8
    v_add_u32 v4, s7, v24
    v_add_u32 v5, 31744, v4
    v_add_u32 v6, 31744, v5
    v_add_u32 v7, 31744, v6
    v_lshrrev_b32 v24, 2, v2
    v_lshlrev_b32 v24, 7, v24
    v_and_b32 v25, 3, v2
    v_lshl_add_u32 v24, v25, 3, v24
    s_and_b32 s7, s73, 8192
    v_mfma_f32_16x16x32_bf16 v[228:231], a[4:7], v[112:115], v[228:231]
    ds_read_b64_tr_b16 a[80:81], v152 offset:49152
    v_mfma_f32_16x16x32_bf16 v[236:239], a[4:7], v[120:123], 0
    ds_read_b64_tr_b16 a[82:83], v152 offset:50176
    s_add_u32 m0, s74, 61440
    s_mul_i32 s13, s23, 90112
    v_mfma_f32_16x16x32_bf16 v[236:239], a[12:15], v[124:127], v[236:239]
    v_mfma_f32_16x16x32_bf16 v[232:235], a[8:11], v[124:127], 0
    ds_read_b64_tr_b16 a[84:85], v153 offset:49152
    buffer_load_dwordx4 v156, s[44:47], s13 offen offset:0 sc1 lds
    v_mfma_f32_16x16x32_bf16 v[232:235], a[0:3], v[120:123], v[232:235]
    ds_read_b64_tr_b16 a[86:87], v153 offset:50176
    s_waitcnt lgkmcnt(4)
    v_mfma_f32_16x16x32_bf16 v[192:195], a[16:19], v[80:83], v[192:195]
    buffer_load_dwordx4 v157, s[44:47], s13 offen offset:1024 sc1 lds
    v_mfma_f32_16x16x32_bf16 v[192:195], a[24:27], v[84:87], v[192:195]
    ds_read_b128 v[104:107], v159 offset:13056
    buffer_load_dwordx4 v158, s[44:47], s13 offen offset:2048 sc1 lds
    v_mfma_f32_16x16x32_bf16 v[196:199], a[28:31], v[84:87], v[196:199]
    ds_read_b128 v[108:111], v159 offset:19200
    v_mfma_f32_16x16x32_bf16 v[196:199], a[20:23], v[80:83], v[196:199]
    ds_read_b128 v[112:115], v159 offset:13312
    s_add_u32 m0, s73, 0
    s_mul_i32 s14, s25, 589824
    v_mfma_f32_16x16x32_bf16 v[204:207], a[20:23], v[88:91], v[204:207]
    ds_read_b128 v[116:119], v159 offset:19456
    v_mfma_f32_16x16x32_bf16 v[204:207], a[28:31], v[92:95], v[204:207]
    ds_read_b128 v[120:123], v159 offset:13568
    buffer_load_dwordx4 v148, s[48:51], s14 offen offset:0 lds
    v_mfma_f32_16x16x32_bf16 v[200:203], a[24:27], v[92:95], v[200:203]
    ds_read_b128 v[124:127], v159 offset:19712
    buffer_load_dwordx4 v149, s[48:51], s14 offen offset:1024 lds
    v_add_u32 v24, s7, v24
    v_bfe_u32 v31, v2, 3, 2
    s_and_b32 s7, s3, 1
    s_lshl_b32 s7, s7, 1
    v_xor_b32 v31, s7, v31
    v_lshl_add_u32 v10, v31, 5, v24
    v_xor_b32 v11, 32, v10
    s_bfe_u32 s101, s2, 0x20003
    s_mul_i32 s101, s101, 3
    s_mul_i32 s84, s101, 305844
    s_lshr_b32 s84, s84, 18
    s_add_u32 s84, s84, 0
    s_add_u32 s85, s84, 1
    s_cmp_eq_u32 s85, 14
    s_cselect_b32 s85, 0, s85
    s_add_u32 s86, s85, 1
    s_cmp_eq_u32 s86, 14
    s_cselect_b32 s86, 0, s86
    s_add_u32 s87, s86, 1
    s_cmp_eq_u32 s87, 14
    s_cselect_b32 s87, 0, s87
    s_add_u32 s88, s87, 1
    s_cmp_eq_u32 s88, 14
    s_cselect_b32 s88, 0, s88
    s_add_u32 s89, s88, 1
    s_cmp_eq_u32 s89, 14
    s_cselect_b32 s89, 0, s89
    s_add_u32 s90, s89, 1
    s_cmp_eq_u32 s90, 14
    s_cselect_b32 s90, 0, s90
    s_add_u32 s91, s90, 1
    s_cmp_eq_u32 s91, 14
    s_cselect_b32 s91, 0, s91
    s_add_u32 s92, s91, 1
    s_cmp_eq_u32 s92, 14
    s_cselect_b32 s92, 0, s92
    s_add_u32 s93, s92, 1
    s_cmp_eq_u32 s93, 14
    s_cselect_b32 s93, 0, s93
    s_add_u32 s94, s93, 1
    s_cmp_eq_u32 s94, 14
    s_cselect_b32 s94, 0, s94
    s_add_u32 s95, s94, 1
    s_cmp_eq_u32 s95, 14
    s_cselect_b32 s95, 0, s95
    s_add_u32 s96, s95, 1
    s_cmp_eq_u32 s96, 14
    s_cselect_b32 s96, 0, s96
    s_add_u32 s97, s96, 1
    s_cmp_eq_u32 s97, 14
    s_cselect_b32 s97, 0, s97
    s_mul_i32 s98, s101, 87384
    s_lshr_b32 s98, s98, 18
    s_add_u32 s98, s98, 14
    s_add_u32 s99, s98, 1
    s_cmp_eq_u32 s99, 18
    s_cselect_b32 s99, 14, s99
    s_add_u32 s100, s99, 1
    s_cmp_eq_u32 s100, 18
    s_cselect_b32 s100, 14, s100
    s_add_u32 s101, s100, 1
    s_cmp_eq_u32 s101, 18
    s_cselect_b32 s101, 14, s101
    v_mfma_f32_16x16x32_bf16 v[200:203], a[16:19], v[88:91], v[200:203]
    ds_read_b64_tr_b16 a[88:89], v152 offset:57344
    v_mfma_f32_16x16x32_bf16 v[208:211], a[16:19], v[96:99], v[208:211]
    ds_read_b64_tr_b16 a[90:91], v152 offset:58368
    buffer_load_dwordx4 v150, s[48:51], s14 offen offset:2048 lds
    v_mfma_f32_16x16x32_bf16 v[208:211], a[24:27], v[100:103], v[208:211]
    v_mfma_f32_16x16x32_bf16 v[212:215], a[28:31], v[100:103], v[212:215]
    ds_read_b64_tr_b16 a[92:93], v153 offset:57344
    buffer_load_dwordx4 v151, s[48:51], s14 offen offset:3072 lds
    v_mfma_f32_16x16x32_bf16 v[212:215], a[20:23], v[96:99], v[212:215]
    ds_read_b64_tr_b16 a[94:95], v153 offset:58368
    s_waitcnt lgkmcnt(4)
    v_mfma_f32_16x16x32_bf16 v[220:223], a[20:23], v[104:107], v[220:223]
    s_waitcnt vmcnt(13)
    s_barrier
    v_mfma_f32_16x16x32_bf16 v[220:223], a[28:31], v[108:111], v[220:223]
    ds_read_b128 v[80:83], v159 offset:24576
    s_add_u32 m0, s74, 0
    s_mul_i32 s13, s24, 90112
    v_mfma_f32_16x16x32_bf16 v[216:219], a[24:27], v[108:111], v[216:219]
    ds_read_b128 v[84:87], v159 offset:30720
    buffer_load_dwordx4 v156, s[44:47], s13 offen offset:0 sc1 lds
    v_mfma_f32_16x16x32_bf16 v[216:219], a[16:19], v[104:107], v[216:219]
    ds_read_b128 v[88:91], v159 offset:24832
    v_mfma_f32_16x16x32_bf16 v[224:227], a[16:19], v[112:115], v[224:227]
    ds_read_b128 v[92:95], v159 offset:30976
    buffer_load_dwordx4 v157, s[44:47], s13 offen offset:1024 sc1 lds
    v_mfma_f32_16x16x32_bf16 v[224:227], a[24:27], v[116:119], v[224:227]
    ds_read_b128 v[96:99], v159 offset:25088
    v_mfma_f32_16x16x32_bf16 v[228:231], a[28:31], v[116:119], v[228:231]
    ds_read_b128 v[100:103], v159 offset:31232
    buffer_load_dwordx4 v158, s[44:47], s13 offen offset:2048 sc1 lds
    s_mul_i32 s7, s70, 6
    s_add_u32 s7, s7, 0
    s_mul_i32 s8, s7, 7282
    s_lshr_b32 s8, s8, 16
    s_mul_i32 s5, s8, 9
    s_sub_u32 s7, s7, s5
    s_lshl_b32 s7, s7, 2
    s_mov_b32 s4, 0xeca86420
    s_bitcmp1_b32 s8, 0
    s_cselect_b32 s4, 0xca864203, s4
    s_cselect_b32 s5, 14, 3
    s_lshr_b64 s[4:5], s[4:5], s7
    s_and_b32 s4, s4, 15
    s_lshl4_add_u32 s4, s8, s4
    v_lshl_add_u32 v240, s4, 8, v245
    s_mul_i32 s7, s70, 6
    s_add_u32 s7, s7, 1
    s_mul_i32 s8, s7, 7282
    s_lshr_b32 s8, s8, 16
    s_mul_i32 s5, s8, 9
    s_sub_u32 s7, s7, s5
    s_lshl_b32 s7, s7, 2
    s_mov_b32 s4, 0xeca86420
    s_bitcmp1_b32 s8, 0
    s_cselect_b32 s4, 0xca864203, s4
    s_cselect_b32 s5, 14, 3
    s_lshr_b64 s[4:5], s[4:5], s7
    s_and_b32 s4, s4, 15
    v_mfma_f32_16x16x32_bf16 v[228:231], a[20:23], v[112:115], v[228:231]
    ds_read_b64_tr_b16 a[96:97], v154 offset:0
    v_mfma_f32_16x16x32_bf16 v[236:239], a[20:23], v[120:123], v[236:239]
    ds_read_b64_tr_b16 a[98:99], v154 offset:1024
    s_add_u32 m0, s74, 12288
    s_mul_i32 s13, s25, 90112
    v_mfma_f32_16x16x32_bf16 v[236:239], a[28:31], v[124:127], v[236:239]
    v_mfma_f32_16x16x32_bf16 v[232:235], a[24:27], v[124:127], v[232:235]
    ds_read_b64_tr_b16 a[100:101], v155 offset:0
    buffer_load_dwordx4 v156, s[44:47], s13 offen offset:0 sc1 lds
    v_mfma_f32_16x16x32_bf16 v[232:235], a[16:19], v[120:123], v[232:235]
    ds_read_b64_tr_b16 a[102:103], v155 offset:1024
    s_waitcnt lgkmcnt(4)
    v_mfma_f32_16x16x32_bf16 v[192:195], a[32:35], v[80:83], v[192:195]
    buffer_load_dwordx4 v157, s[44:47], s13 offen offset:1024 sc1 lds
    v_mfma_f32_16x16x32_bf16 v[192:195], a[40:43], v[84:87], v[192:195]
    ds_read_b128 v[104:107], v159 offset:25344
    buffer_load_dwordx4 v158, s[44:47], s13 offen offset:2048 sc1 lds
    v_mfma_f32_16x16x32_bf16 v[196:199], a[44:47], v[84:87], v[196:199]
    ds_read_b128 v[108:111], v159 offset:31488
    v_mfma_f32_16x16x32_bf16 v[196:199], a[36:39], v[80:83], v[196:199]
    ds_read_b128 v[112:115], v159 offset:25600
    s_add_u32 m0, s73, 16384
    s_mul_i32 s14, s26, 589824
    v_mfma_f32_16x16x32_bf16 v[204:207], a[36:39], v[88:91], v[204:207]
    ds_read_b128 v[116:119], v159 offset:31744
    v_mfma_f32_16x16x32_bf16 v[204:207], a[44:47], v[92:95], v[204:207]
    ds_read_b128 v[120:123], v159 offset:25856
    buffer_load_dwordx4 v148, s[48:51], s14 offen offset:0 lds
    v_mfma_f32_16x16x32_bf16 v[200:203], a[40:43], v[92:95], v[200:203]
    ds_read_b128 v[124:127], v159 offset:32000
    buffer_load_dwordx4 v149, s[48:51], s14 offen offset:1024 lds
    s_lshl4_add_u32 s4, s8, s4
    v_lshl_add_u32 v241, s4, 8, v245
    s_mul_i32 s7, s70, 6
    s_add_u32 s7, s7, 2
    s_mul_i32 s8, s7, 7282
    s_lshr_b32 s8, s8, 16
    s_mul_i32 s5, s8, 9
    s_sub_u32 s7, s7, s5
    s_lshl_b32 s7, s7, 2
    s_mov_b32 s4, 0xeca86420
    s_bitcmp1_b32 s8, 0
    s_cselect_b32 s4, 0xca864203, s4
    s_cselect_b32 s5, 14, 3
    s_lshr_b64 s[4:5], s[4:5], s7
    s_and_b32 s4, s4, 15
    s_lshl4_add_u32 s4, s8, s4
    v_lshl_add_u32 v242, s4, 8, v245
    s_mul_i32 s7, s70, 6
    s_add_u32 s7, s7, 3
    s_mul_i32 s8, s7, 7282
    s_lshr_b32 s8, s8, 16
    s_mul_i32 s5, s8, 9
    s_sub_u32 s7, s7, s5
    s_lshl_b32 s7, s7, 2
    s_mov_b32 s4, 0xeca86420
    v_mfma_f32_16x16x32_bf16 v[200:203], a[32:35], v[88:91], v[200:203]
    ds_read_b64_tr_b16 a[104:105], v154 offset:8192
    v_mfma_f32_16x16x32_bf16 v[208:211], a[32:35], v[96:99], v[208:211]
    ds_read_b64_tr_b16 a[106:107], v154 offset:9216
    buffer_load_dwordx4 v150, s[48:51], s14 offen offset:2048 lds
    v_mfma_f32_16x16x32_bf16 v[208:211], a[40:43], v[100:103], v[208:211]
    v_mfma_f32_16x16x32_bf16 v[212:215], a[44:47], v[100:103], v[212:215]
    ds_read_b64_tr_b16 a[108:109], v155 offset:8192
    buffer_load_dwordx4 v151, s[48:51], s14 offen offset:3072 lds
    v_mfma_f32_16x16x32_bf16 v[212:215], a[36:39], v[96:99], v[212:215]
    ds_read_b64_tr_b16 a[110:111], v155 offset:9216
    s_waitcnt lgkmcnt(4)
    v_mfma_f32_16x16x32_bf16 v[220:223], a[36:39], v[104:107], v[220:223]
    s_waitcnt vmcnt(20)
    s_barrier
    v_mfma_f32_16x16x32_bf16 v[220:223], a[44:47], v[108:111], v[220:223]
    ds_read_b128 v[80:83], v250 offset:0
    s_add_u32 m0, s74, 24576
    s_mul_i32 s13, s26, 90112
    v_mfma_f32_16x16x32_bf16 v[216:219], a[40:43], v[108:111], v[216:219]
    ds_read_b128 v[84:87], v250 offset:6144
    v_mfma_f32_16x16x32_bf16 v[216:219], a[32:35], v[104:107], v[216:219]
    ds_read_b128 v[88:91], v250 offset:256
    buffer_load_dwordx4 v156, s[44:47], s13 offen offset:0 sc1 lds
    v_mfma_f32_16x16x32_bf16 v[224:227], a[32:35], v[112:115], v[224:227]
    ds_read_b128 v[92:95], v250 offset:6400
    v_mfma_f32_16x16x32_bf16 v[224:227], a[40:43], v[116:119], v[224:227]
    ds_read_b128 v[96:99], v250 offset:512
    v_mfma_f32_16x16x32_bf16 v[228:231], a[44:47], v[116:119], v[228:231]
    ds_read_b128 v[100:103], v250 offset:6656
    buffer_load_dwordx4 v157, s[44:47], s13 offen offset:1024 sc1 lds
    s_bitcmp1_b32 s8, 0
    s_cselect_b32 s4, 0xca864203, s4
    s_cselect_b32 s5, 14, 3
    s_lshr_b64 s[4:5], s[4:5], s7
    s_and_b32 s4, s4, 15
    s_lshl4_add_u32 s4, s8, s4
    v_lshl_add_u32 v243, s4, 8, v245
    s_mul_i32 s7, s70, 6
    s_add_u32 s7, s7, 4
    s_mul_i32 s8, s7, 7282
    s_lshr_b32 s8, s8, 16
    s_mul_i32 s5, s8, 9
    s_sub_u32 s7, s7, s5
    s_lshl_b32 s7, s7, 2
    s_mov_b32 s4, 0xeca86420
    s_bitcmp1_b32 s8, 0
    s_cselect_b32 s4, 0xca864203, s4
    s_cselect_b32 s5, 14, 3
    s_lshr_b64 s[4:5], s[4:5], s7
    s_and_b32 s4, s4, 15
    s_lshl4_add_u32 s4, s8, s4
    v_lshl_add_u32 v244, s4, 8, v245
    s_mul_i32 s7, s70, 6
    s_add_u32 s7, s7, 5
    s_mul_i32 s8, s7, 7282
    v_mfma_f32_16x16x32_bf16 v[228:231], a[36:39], v[112:115], v[228:231]
    v_mfma_f32_16x16x32_bf16 v[236:239], a[36:39], v[120:123], v[236:239]
    v_mfma_f32_16x16x32_bf16 v[236:239], a[44:47], v[124:127], v[236:239]
    buffer_load_dwordx4 v158, s[44:47], s13 offen offset:2048 sc1 lds
    v_mfma_f32_16x16x32_bf16 v[232:235], a[40:43], v[124:127], v[232:235]
    v_mfma_f32_16x16x32_bf16 v[232:235], a[32:35], v[120:123], v[232:235]
    s_waitcnt lgkmcnt(0)
    v_mfma_f32_16x16x32_bf16 v[192:195], a[48:51], v[80:83], v[192:195]
    s_add_u32 m0, s73, 32768
    s_mul_i32 s14, s27, 589824
    v_mfma_f32_16x16x32_bf16 v[192:195], a[56:59], v[84:87], v[192:195]
    ds_read_b128 v[104:107], v250 offset:768
    v_mfma_f32_16x16x32_bf16 v[196:199], a[60:63], v[84:87], v[196:199]
    ds_read_b128 v[108:111], v250 offset:6912
    buffer_load_dwordx4 v148, s[48:51], s14 offen offset:0 lds
    v_mfma_f32_16x16x32_bf16 v[196:199], a[52:55], v[80:83], v[196:199]
    ds_read_b128 v[112:115], v250 offset:1024
    v_mfma_f32_16x16x32_bf16 v[204:207], a[52:55], v[88:91], v[204:207]
    ds_read_b128 v[116:119], v250 offset:7168
    buffer_load_dwordx4 v149, s[48:51], s14 offen offset:1024 lds
    v_mfma_f32_16x16x32_bf16 v[204:207], a[60:63], v[92:95], v[204:207]
    ds_read_b128 v[120:123], v250 offset:1280
    v_mfma_f32_16x16x32_bf16 v[200:203], a[56:59], v[92:95], v[200:203]
    ds_read_b128 v[124:127], v250 offset:7424
    s_lshr_b32 s8, s8, 16
    s_mul_i32 s5, s8, 9
    s_sub_u32 s7, s7, s5
    s_lshl_b32 s7, s7, 2
    s_mov_b32 s4, 0xeca86420
    s_bitcmp1_b32 s8, 0
    s_cselect_b32 s4, 0xca864203, s4
    s_cselect_b32 s5, 14, 3
    s_lshr_b64 s[4:5], s[4:5], s7
    s_and_b32 s4, s4, 15
    s_lshl4_add_u32 s4, s8, s4
    v_lshl_add_u32 v245, s4, 8, v245
    s_xor_b32 s7, s75, 1
    s_lshl2_add_u32 s7, s7, s3
    s_mul_i32 s9, s7, 6144
    s_add_u32 s9, s9, 7077888
    s_lshl_b32 s7, s7, 7
    s_add_u32 s6, s7, 22822912
    s_lshl2_add_u32 s7, s75, s3
    s_mul_i32 s10, s7, 6144
    s_add_u32 s10, s10, 7077888
    s_lshl_b32 s7, s7, 7
    s_add_u32 s7, s7, 22822912
    v_mov_b32 v28, s7
    v_add_u32 v247, 3072, v246
    v_cmp_eq_u32 vcc, 0, v2
    v_mov_b32 v248, 0x40000000
    s_nop 0
    v_cndmask_b32 v248, v248, 0, vcc
    v_mov_b32 v249, s68
    v_mfma_f32_16x16x32_bf16 v[200:203], a[48:51], v[88:91], v[200:203]
    buffer_load_dwordx4 v150, s[48:51], s14 offen offset:2048 lds
    v_mfma_f32_16x16x32_bf16 v[208:211], a[48:51], v[96:99], v[208:211]
    v_mfma_f32_16x16x32_bf16 v[208:211], a[56:59], v[100:103], v[208:211]
    buffer_load_dwordx4 v151, s[48:51], s14 offen offset:3072 lds
    v_mfma_f32_16x16x32_bf16 v[212:215], a[60:63], v[100:103], v[212:215]
    v_mfma_f32_16x16x32_bf16 v[212:215], a[52:55], v[96:99], v[212:215]
    s_waitcnt lgkmcnt(0)
    v_mfma_f32_16x16x32_bf16 v[220:223], a[52:55], v[104:107], v[220:223]
    s_waitcnt vmcnt(17)
    s_barrier
    v_mfma_f32_16x16x32_bf16 v[220:223], a[60:63], v[108:111], v[220:223]
    ds_read_b128 v[80:83], v250 offset:12288
    s_add_u32 m0, s74, 36864
    s_mul_i32 s13, s27, 90112
    v_mfma_f32_16x16x32_bf16 v[216:219], a[56:59], v[108:111], v[216:219]
    ds_read_b128 v[84:87], v250 offset:18432
    v_mfma_f32_16x16x32_bf16 v[216:219], a[48:51], v[104:107], v[216:219]
    ds_read_b128 v[88:91], v250 offset:12544
    buffer_load_dwordx4 v156, s[44:47], s13 offen offset:0 sc1 lds
    v_mfma_f32_16x16x32_bf16 v[224:227], a[48:51], v[112:115], v[224:227]
    ds_read_b128 v[92:95], v250 offset:18688
    v_mfma_f32_16x16x32_bf16 v[224:227], a[56:59], v[116:119], v[224:227]
    ds_read_b128 v[96:99], v250 offset:12800
    v_mfma_f32_16x16x32_bf16 v[228:231], a[60:63], v[116:119], v[228:231]
    ds_read_b128 v[100:103], v250 offset:18944
    buffer_load_dwordx4 v157, s[44:47], s13 offen offset:1024 sc1 lds
    v_and_b32 v129, 0xffff0000, v144
    v_lshlrev_b32 v128, 16, v144
    v_and_b32 v131, 0xffff0000, v145
    v_lshlrev_b32 v130, 16, v145
    v_and_b32 v133, 0xffff0000, v146
    v_lshlrev_b32 v132, 16, v146
    v_and_b32 v135, 0xffff0000, v147
    v_lshlrev_b32 v134, 16, v147
    s_mul_i32 s4, s70, 43691
    s_lshr_b32 s4, s4, 16
    s_mul_i32 s5, s70, 21846
    s_lshr_b32 s5, s5, 16
    s_mul_i32 s5, s5, 3
    s_sub_u32 s5, s70, s5
    s_lshl2_add_u32 s4, s72, s4
    s_lshl_b32 s4, s4, 10
    s_mul_i32 s7, s72, 9
    s_sub_u32 s7, s69, s7
    v_mfma_f32_16x16x32_bf16 v[228:231], a[52:55], v[112:115], v[228:231]
    ds_read_b64_tr_b16 a[112:113], v152 offset:0
    v_mfma_f32_16x16x32_bf16 v[236:239], a[52:55], v[120:123], v[236:239]
    ds_read_b64_tr_b16 a[114:115], v152 offset:1024
    v_mfma_f32_16x16x32_bf16 v[236:239], a[60:63], v[124:127], v[236:239]
    buffer_load_dwordx4 v158, s[44:47], s13 offen offset:2048 sc1 lds
    v_mfma_f32_16x16x32_bf16 v[232:235], a[56:59], v[124:127], v[232:235]
    ds_read_b64_tr_b16 a[116:117], v153 offset:0
    v_mfma_f32_16x16x32_bf16 v[232:235], a[48:51], v[120:123], v[232:235]
    ds_read_b64_tr_b16 a[118:119], v153 offset:1024
    s_waitcnt lgkmcnt(4)
    v_mfma_f32_16x16x32_bf16 v[192:195], a[64:67], v[80:83], v[192:195]
    s_add_u32 m0, s73, 49152
    s_mul_i32 s14, s76, 589824
    v_mfma_f32_16x16x32_bf16 v[192:195], a[72:75], v[84:87], v[192:195]
    ds_read_b128 v[104:107], v250 offset:13056
    v_mfma_f32_16x16x32_bf16 v[196:199], a[76:79], v[84:87], v[196:199]
    ds_read_b128 v[108:111], v250 offset:19200
    buffer_load_dwordx4 v148, s[48:51], s14 offen offset:0 lds
    v_mfma_f32_16x16x32_bf16 v[196:199], a[68:71], v[80:83], v[196:199]
    ds_read_b128 v[112:115], v250 offset:13312
    v_mfma_f32_16x16x32_bf16 v[204:207], a[68:71], v[88:91], v[204:207]
    ds_read_b128 v[116:119], v250 offset:19456
    buffer_load_dwordx4 v149, s[48:51], s14 offen offset:1024 lds
    v_mfma_f32_16x16x32_bf16 v[204:207], a[76:79], v[92:95], v[204:207]
    ds_read_b128 v[120:123], v250 offset:13568
    v_mfma_f32_16x16x32_bf16 v[200:203], a[72:75], v[92:95], v[200:203]
    ds_read_b128 v[124:127], v250 offset:19712
    s_lshl3_add_u32 s4, s7, s4
    s_add_u32 s4, s4, 12566528
    s_cmp_eq_u32 s5, 1
    s_cselect_b32 s7, 16, 8
    s_cmp_lg_u32 s5, 0
    s_cselect_b32 s5, 4, 0
L_pl_G_2:
    s_cbranch_execz L_pl_G_6
    v_lshlrev_b32 v17, 7, v0
    v_add_u32 v17, s4, v17
    v_cmp_gt_u32 vcc, 8, v0
    v_mov_b32 v24, s5
    s_nop 0
    v_cndmask_b32 v24, 0, v24, vcc
    v_add_u32 v17, v17, v24
    v_cmp_gt_u32 vcc, s7, v0
    v_mov_b32 v24, 0x40000000
    s_nop 0
    v_cndmask_b32 v17, v24, v17, vcc
    s_bfe_u32 s4, s2, 0x20003
    s_lshl2_add_u32 s4, s72, s4
    s_lshl_b32 s4, s4, 3
    s_lshr_b32 s5, s2, 4
    s_and_b32 s5, s5, 6
    v_mfma_f32_16x16x32_bf16 v[200:203], a[64:67], v[88:91], v[200:203]
    ds_read_b64_tr_b16 a[120:121], v152 offset:8192
    buffer_load_dwordx4 v150, s[48:51], s14 offen offset:2048 lds
    v_mfma_f32_16x16x32_bf16 v[208:211], a[64:67], v[96:99], v[208:211]
    ds_read_b64_tr_b16 a[122:123], v152 offset:9216
    v_mfma_f32_16x16x32_bf16 v[208:211], a[72:75], v[100:103], v[208:211]
    buffer_load_dwordx4 v151, s[48:51], s14 offen offset:3072 lds
    v_mfma_f32_16x16x32_bf16 v[212:215], a[76:79], v[100:103], v[212:215]
    ds_read_b64_tr_b16 a[124:125], v153 offset:8192
    v_mfma_f32_16x16x32_bf16 v[212:215], a[68:71], v[96:99], v[212:215]
    ds_read_b64_tr_b16 a[126:127], v153 offset:9216
    s_waitcnt lgkmcnt(4)
    v_mfma_f32_16x16x32_bf16 v[220:223], a[68:71], v[104:107], v[220:223]
    s_waitcnt vmcnt(14)
    s_barrier
    v_mfma_f32_16x16x32_bf16 v[220:223], a[76:79], v[108:111], v[220:223]
    ds_read_b128 v[80:83], v250 offset:24576
    s_add_u32 m0, s74, 49152
    s_mul_i32 s13, s76, 90112
    v_mfma_f32_16x16x32_bf16 v[216:219], a[72:75], v[108:111], v[216:219]
    ds_read_b128 v[84:87], v250 offset:30720
    v_mfma_f32_16x16x32_bf16 v[216:219], a[64:67], v[104:107], v[216:219]
    ds_read_b128 v[88:91], v250 offset:24832
    buffer_load_dwordx4 v156, s[44:47], s13 offen offset:0 sc1 lds
    v_mfma_f32_16x16x32_bf16 v[224:227], a[64:67], v[112:115], v[224:227]
    ds_read_b128 v[92:95], v250 offset:30976
    v_mfma_f32_16x16x32_bf16 v[224:227], a[72:75], v[116:119], v[224:227]
    ds_read_b128 v[96:99], v250 offset:25088
    v_mfma_f32_16x16x32_bf16 v[228:231], a[76:79], v[116:119], v[228:231]
    ds_read_b128 v[100:103], v250 offset:31232
    buffer_load_dwordx4 v157, s[44:47], s13 offen offset:1024 sc1 lds
    s_add_u32 s4, s4, s5
    s_and_b32 s5, s2, 1
    s_add_u32 s4, s4, s5
    s_lshl_b32 s4, s4, 7
    s_add_u32 s4, s4, 12566528
    v_lshl_add_u32 v15, v2, 2, s4
    s_cmp_eq_u32 s3, 0
    s_cselect_b32 s4, 18, 0
    v_cmp_gt_u32 vcc, s4, v2
    v_mov_b32 v13, 0x40000000
    s_nop 0
    v_cndmask_b32 v15, v13, v15, vcc
    v_mov_b32 v13, s68
    v_cndmask_b32 v13, 0, v13, vcc
    v_and_b32 v24, 15, v2
    v_lshrrev_b32 v25, 4, v2
    v_mul_u32_u24 v25, 17408, v25
    v_lshl_add_u32 v24, v24, 4, v25
    s_mul_i32 s7, s72, 36
    v_mfma_f32_16x16x32_bf16 v[228:231], a[68:71], v[112:115], v[228:231]
    ds_read_b64_tr_b16 a[128:129], v152 offset:16384
    v_mfma_f32_16x16x32_bf16 v[236:239], a[68:71], v[120:123], v[236:239]
    ds_read_b64_tr_b16 a[130:131], v152 offset:17408
    v_mfma_f32_16x16x32_bf16 v[236:239], a[76:79], v[124:127], v[236:239]
    buffer_load_dwordx4 v158, s[44:47], s13 offen offset:2048 sc1 lds
    v_mfma_f32_16x16x32_bf16 v[232:235], a[72:75], v[124:127], v[232:235]
    ds_read_b64_tr_b16 a[132:133], v153 offset:16384
    v_mfma_f32_16x16x32_bf16 v[232:235], a[64:67], v[120:123], v[232:235]
    ds_read_b64_tr_b16 a[134:135], v153 offset:17408
    s_waitcnt lgkmcnt(4)
    v_mfma_f32_16x16x32_bf16 v[192:195], a[80:83], v[80:83], v[192:195]
    s_add_u32 m0, s73, 65536
    s_mul_i32 s14, s77, 589824
    v_mfma_f32_16x16x32_bf16 v[192:195], a[88:91], v[84:87], v[192:195]
    ds_read_b128 v[104:107], v250 offset:25344
    v_mfma_f32_16x16x32_bf16 v[196:199], a[92:95], v[84:87], v[196:199]
    ds_read_b128 v[108:111], v250 offset:31488
    buffer_load_dwordx4 v148, s[48:51], s14 offen offset:0 lds
    v_mfma_f32_16x16x32_bf16 v[196:199], a[84:87], v[80:83], v[196:199]
    ds_read_b128 v[112:115], v250 offset:25600
    v_mfma_f32_16x16x32_bf16 v[204:207], a[84:87], v[88:91], v[204:207]
    ds_read_b128 v[116:119], v250 offset:31744
    buffer_load_dwordx4 v149, s[48:51], s14 offen offset:1024 lds
    v_mfma_f32_16x16x32_bf16 v[204:207], a[92:95], v[92:95], v[204:207]
    ds_read_b128 v[120:123], v250 offset:25856
    v_mfma_f32_16x16x32_bf16 v[200:203], a[88:91], v[92:95], v[200:203]
    ds_read_b128 v[124:127], v250 offset:32000
    s_and_b32 s8, s3, 1
    s_add_u32 s7, s7, s8
    s_mul_i32 s7, s7, 69632
    s_bfe_u32 s8, s2, 0x20003
    s_lshl_b32 s8, s8, 12
    s_add_u32 s7, s7, s8
    s_add_u32 s7, s7, 12795904
    v_add_u32 v23, s7, v24
    s_xor_b32 s7, s72, 0
    v_lshl_add_u32 v19, s7, 10, v23
    s_xor_b32 s7, s72, 1
    v_lshl_add_u32 v20, s7, 10, v23
    s_xor_b32 s7, s72, 2
    v_lshl_add_u32 v21, s7, 10, v23
    s_xor_b32 s7, s72, 3
    v_mfma_f32_16x16x32_bf16 v[200:203], a[80:83], v[88:91], v[200:203]
    ds_read_b64_tr_b16 a[136:137], v152 offset:24576
    buffer_load_dwordx4 v150, s[48:51], s14 offen offset:2048 lds
    v_mfma_f32_16x16x32_bf16 v[208:211], a[80:83], v[96:99], v[208:211]
    ds_read_b64_tr_b16 a[138:139], v152 offset:25600
    v_mfma_f32_16x16x32_bf16 v[208:211], a[88:91], v[100:103], v[208:211]
    buffer_load_dwordx4 v151, s[48:51], s14 offen offset:3072 lds
    v_mfma_f32_16x16x32_bf16 v[212:215], a[92:95], v[100:103], v[212:215]
    ds_read_b64_tr_b16 a[140:141], v153 offset:24576
    v_mfma_f32_16x16x32_bf16 v[212:215], a[84:87], v[96:99], v[212:215]
    ds_read_b64_tr_b16 a[142:143], v153 offset:25600
    s_waitcnt lgkmcnt(4)
    v_mfma_f32_16x16x32_bf16 v[220:223], a[84:87], v[104:107], v[220:223]
    s_waitcnt vmcnt(14)
    s_barrier
    v_mfma_f32_16x16x32_bf16 v[220:223], a[92:95], v[108:111], v[220:223]
    ds_read_b128 v[80:83], v159 offset:0
    s_add_u32 m0, s74, 61440
    s_mul_i32 s13, s77, 90112
    v_mfma_f32_16x16x32_bf16 v[216:219], a[88:91], v[108:111], v[216:219]
    ds_read_b128 v[84:87], v159 offset:6144
    v_mfma_f32_16x16x32_bf16 v[216:219], a[80:83], v[104:107], v[216:219]
    ds_read_b128 v[88:91], v159 offset:256
    buffer_load_dwordx4 v156, s[44:47], s13 offen offset:0 sc1 lds
    v_mfma_f32_16x16x32_bf16 v[224:227], a[80:83], v[112:115], v[224:227]
    ds_read_b128 v[92:95], v159 offset:6400
    v_mfma_f32_16x16x32_bf16 v[224:227], a[88:91], v[116:119], v[224:227]
    ds_read_b128 v[96:99], v159 offset:512
    v_mfma_f32_16x16x32_bf16 v[228:231], a[92:95], v[116:119], v[228:231]
    ds_read_b128 v[100:103], v159 offset:6656
    buffer_load_dwordx4 v157, s[44:47], s13 offen offset:1024 sc1 lds
    v_lshl_add_u32 v22, s7, 10, v23
    v_lshlrev_b32 v14, 4, v2
    v_add_u32 v14, 98304, v14
    v_add_u32 v1, 0x10000, v14
    s_mov_b32 s56, s16
    s_and_b32 s57, s17, 0xffff
    s_mov_b32 s58, 2359296
    s_mov_b32 s59, 0x20000
    s_mov_b32 s40, 18432
    s_mov_b32 s42, 12386304
    s_mov_b32 s64, s38
    s_and_b32 s65, s39, 0xffff
    s_mov_b32 s66, 2359296
    s_mov_b32 s67, 0x20000
    v_lshlrev_b32 v136, 4, v2
    v_mfma_f32_16x16x32_bf16 v[228:231], a[84:87], v[112:115], v[228:231]
    ds_read_b64_tr_b16 a[144:145], v152 offset:32768
    v_mfma_f32_16x16x32_bf16 v[236:239], a[84:87], v[120:123], v[236:239]
    ds_read_b64_tr_b16 a[146:147], v152 offset:33792
    v_mfma_f32_16x16x32_bf16 v[236:239], a[92:95], v[124:127], v[236:239]
    buffer_load_dwordx4 v158, s[44:47], s13 offen offset:2048 sc1 lds
    v_mfma_f32_16x16x32_bf16 v[232:235], a[88:91], v[124:127], v[232:235]
    ds_read_b64_tr_b16 a[148:149], v153 offset:32768
    v_mfma_f32_16x16x32_bf16 v[232:235], a[80:83], v[120:123], v[232:235]
    ds_read_b64_tr_b16 a[150:151], v153 offset:33792
    s_waitcnt lgkmcnt(4)
    v_mfma_f32_16x16x32_bf16 v[192:195], a[96:99], v[80:83], v[192:195]
    s_add_u32 m0, s73, 0
    s_mul_i32 s14, s78, 589824
    v_mfma_f32_16x16x32_bf16 v[192:195], a[104:107], v[84:87], v[192:195]
    ds_read_b128 v[104:107], v159 offset:768
    v_mfma_f32_16x16x32_bf16 v[196:199], a[108:111], v[84:87], v[196:199]
    ds_read_b128 v[108:111], v159 offset:6912
    buffer_load_dwordx4 v148, s[48:51], s14 offen offset:0 lds
    v_mfma_f32_16x16x32_bf16 v[196:199], a[100:103], v[80:83], v[196:199]
    ds_read_b128 v[112:115], v159 offset:1024
    v_mfma_f32_16x16x32_bf16 v[204:207], a[100:103], v[88:91], v[204:207]
    ds_read_b128 v[116:119], v159 offset:7168
    buffer_load_dwordx4 v149, s[48:51], s14 offen offset:1024 lds
    v_mfma_f32_16x16x32_bf16 v[204:207], a[108:111], v[92:95], v[204:207]
    ds_read_b128 v[120:123], v159 offset:1280
    v_mfma_f32_16x16x32_bf16 v[200:203], a[104:107], v[92:95], v[200:203]
    ds_read_b128 v[124:127], v159 offset:7424
    s_mul_i32 s7, s72, 36
    s_bitcmp1_b32 s3, 0
    s_addc_u32 s7, s7, 0
    s_lshl_b32 s7, s7, 17
    v_subrev_u32 v184, s7, v4
    v_subrev_u32 v185, s7, v5
    s_bfe_u32 s4, s2, 0x20003
    s_mul_i32 s4, s4, 9
    s_lshl1_add_u32 s7, s72, s4
    s_and_b32 s8, s3, 1
    s_add_u32 s7, s7, s8
    s_bfe_u32 s8, s2, 65539
    s_add_u32 s7, s7, s8
    s_lshl_b32 s8, s8, 3
    v_mfma_f32_16x16x32_bf16 v[200:203], a[96:99], v[88:91], v[200:203]
    ds_read_b64_tr_b16 a[152:153], v152 offset:40960
    buffer_load_dwordx4 v150, s[48:51], s14 offen offset:2048 lds
    v_mfma_f32_16x16x32_bf16 v[208:211], a[96:99], v[96:99], v[208:211]
    ds_read_b64_tr_b16 a[154:155], v152 offset:41984
    v_mfma_f32_16x16x32_bf16 v[208:211], a[104:107], v[100:103], v[208:211]
    buffer_load_dwordx4 v151, s[48:51], s14 offen offset:3072 lds
    v_mfma_f32_16x16x32_bf16 v[212:215], a[108:111], v[100:103], v[212:215]
    ds_read_b64_tr_b16 a[156:157], v153 offset:40960
    v_mfma_f32_16x16x32_bf16 v[212:215], a[100:103], v[96:99], v[212:215]
    ds_read_b64_tr_b16 a[158:159], v153 offset:41984
    s_waitcnt lgkmcnt(4)
    v_mfma_f32_16x16x32_bf16 v[220:223], a[100:103], v[104:107], v[220:223]
    s_waitcnt vmcnt(14)
    s_barrier
    v_mfma_f32_16x16x32_bf16 v[220:223], a[108:111], v[108:111], v[220:223]
    ds_read_b128 v[80:83], v159 offset:12288
    s_add_u32 m0, s74, 0
    s_mul_i32 s13, s78, 90112
    v_mfma_f32_16x16x32_bf16 v[216:219], a[104:107], v[108:111], v[216:219]
    ds_read_b128 v[84:87], v159 offset:18432
    v_mfma_f32_16x16x32_bf16 v[216:219], a[96:99], v[104:107], v[216:219]
    ds_read_b128 v[88:91], v159 offset:12544
    buffer_load_dwordx4 v156, s[44:47], s13 offen offset:0 sc1 lds
    v_mfma_f32_16x16x32_bf16 v[224:227], a[96:99], v[112:115], v[224:227]
    ds_read_b128 v[92:95], v159 offset:18688
    v_mfma_f32_16x16x32_bf16 v[224:227], a[104:107], v[116:119], v[224:227]
    ds_read_b128 v[96:99], v159 offset:12800
    v_mfma_f32_16x16x32_bf16 v[228:231], a[108:111], v[116:119], v[228:231]
    ds_read_b128 v[100:103], v159 offset:18944
    buffer_load_dwordx4 v157, s[44:47], s13 offen offset:1024 sc1 lds
    s_sub_u32 s4, s4, s8
    s_lshl_b32 s37, s7, 16
    s_add_u32 s37, s37, 4718592
    s_add_u32 s4, s4, 8
    s_lshl_b32 s16, s4, 16
    s_add_u32 s16, s16, 4718592
    s_sub_u32 s4, s4, s7
    s_lshl_b32 s4, s4, 7
    s_lshl_b32 s7, s7, 7
    s_add_u32 s7, s7, 12582912
    v_bfe_u32 v24, v2, 2, 1
    v_mul_i32_i24 v24, s4, v24
    v_mfma_f32_16x16x32_bf16 v[228:231], a[100:103], v[112:115], v[228:231]
    ds_read_b64_tr_b16 a[160:161], v152 offset:49152
    v_mfma_f32_16x16x32_bf16 v[236:239], a[100:103], v[120:123], v[236:239]
    ds_read_b64_tr_b16 a[162:163], v152 offset:50176
    v_mfma_f32_16x16x32_bf16 v[236:239], a[108:111], v[124:127], v[236:239]
    buffer_load_dwordx4 v158, s[44:47], s13 offen offset:2048 sc1 lds
    v_mfma_f32_16x16x32_bf16 v[232:235], a[104:107], v[124:127], v[232:235]
    ds_read_b64_tr_b16 a[164:165], v153 offset:49152
    v_mfma_f32_16x16x32_bf16 v[232:235], a[96:99], v[120:123], v[232:235]
    ds_read_b64_tr_b16 a[166:167], v153 offset:50176
    s_waitcnt lgkmcnt(4)
    v_mfma_f32_16x16x32_bf16 v[192:195], a[112:115], v[80:83], v[192:195]
    s_add_u32 m0, s73, 16384
    s_mul_i32 s14, s79, 589824
    v_mfma_f32_16x16x32_bf16 v[192:195], a[120:123], v[84:87], v[192:195]
    ds_read_b128 v[104:107], v159 offset:13056
    v_mfma_f32_16x16x32_bf16 v[196:199], a[124:127], v[84:87], v[196:199]
    ds_read_b128 v[108:111], v159 offset:19200
    buffer_load_dwordx4 v148, s[48:51], s14 offen offset:0 lds
    v_mfma_f32_16x16x32_bf16 v[196:199], a[116:119], v[80:83], v[196:199]
    ds_read_b128 v[112:115], v159 offset:13312
    v_mfma_f32_16x16x32_bf16 v[204:207], a[116:119], v[88:91], v[204:207]
    ds_read_b128 v[116:119], v159 offset:19456
    buffer_load_dwordx4 v149, s[48:51], s14 offen offset:1024 lds
    v_mfma_f32_16x16x32_bf16 v[204:207], a[124:127], v[92:95], v[204:207]
    ds_read_b128 v[120:123], v159 offset:13568
    v_mfma_f32_16x16x32_bf16 v[200:203], a[120:123], v[92:95], v[200:203]
    ds_read_b128 v[124:127], v159 offset:19712
    v_and_b32 v25, 3, v2
    v_lshl_add_u32 v24, v25, 2, v24
    v_add_u32 v188, s7, v24
    s_lshl2_add_u32 s7, s2, s3
    s_mul_i32 s8, s7, 3072
    s_add_u32 s34, s8, 22953984
    s_add_u32 s11, s8, 26099712
    s_add_u32 s12, s8, 29245440
    s_lshl_b32 s35, s7, 12
    s_add_u32 s35, s35, 32391168
    s_xor_b32 s8, s7, 8
    v_mfma_f32_16x16x32_bf16 v[200:203], a[112:115], v[88:91], v[200:203]
    ds_read_b64_tr_b16 a[168:169], v152 offset:57344
    buffer_load_dwordx4 v150, s[48:51], s14 offen offset:2048 lds
    v_mfma_f32_16x16x32_bf16 v[208:211], a[112:115], v[96:99], v[208:211]
    ds_read_b64_tr_b16 a[170:171], v152 offset:58368
    v_mfma_f32_16x16x32_bf16 v[208:211], a[120:123], v[100:103], v[208:211]
    buffer_load_dwordx4 v151, s[48:51], s14 offen offset:3072 lds
    v_mfma_f32_16x16x32_bf16 v[212:215], a[124:127], v[100:103], v[212:215]
    ds_read_b64_tr_b16 a[172:173], v153 offset:57344
    v_mfma_f32_16x16x32_bf16 v[212:215], a[116:119], v[96:99], v[212:215]
    ds_read_b64_tr_b16 a[174:175], v153 offset:58368
    s_waitcnt lgkmcnt(4)
    v_mfma_f32_16x16x32_bf16 v[220:223], a[116:119], v[104:107], v[220:223]
    s_waitcnt vmcnt(14)
    s_barrier
    v_mfma_f32_16x16x32_bf16 v[220:223], a[124:127], v[108:111], v[220:223]
    ds_read_b128 v[80:83], v159 offset:24576
    s_add_u32 m0, s74, 12288
    s_mul_i32 s13, s79, 90112
    v_mfma_f32_16x16x32_bf16 v[216:219], a[120:123], v[108:111], v[216:219]
    ds_read_b128 v[84:87], v159 offset:30720
    v_mfma_f32_16x16x32_bf16 v[216:219], a[112:115], v[104:107], v[216:219]
    ds_read_b128 v[88:91], v159 offset:24832
    buffer_load_dwordx4 v156, s[44:47], s13 offen offset:0 sc1 lds
    v_mfma_f32_16x16x32_bf16 v[224:227], a[112:115], v[112:115], v[224:227]
    ds_read_b128 v[92:95], v159 offset:30976
    v_mfma_f32_16x16x32_bf16 v[224:227], a[120:123], v[116:119], v[224:227]
    ds_read_b128 v[96:99], v159 offset:25088
    v_mfma_f32_16x16x32_bf16 v[228:231], a[124:127], v[116:119], v[228:231]
    ds_read_b128 v[100:103], v159 offset:31232
    buffer_load_dwordx4 v157, s[44:47], s13 offen offset:1024 sc1 lds
    s_mul_i32 s8, s8, 3072
    s_add_u32 s30, s8, 22953984
    s_xor_b32 s8, s7, 16
    s_mul_i32 s8, s8, 3072
    s_add_u32 s15, s8, 26099712
    s_xor_b32 s8, s7, 24
    s_mul_i32 s8, s8, 3072
    s_add_u32 s31, s8, 29245440
    s_andn2_b32 s7, s7, 24
    v_mfma_f32_16x16x32_bf16 v[228:231], a[116:119], v[112:115], v[228:231]
    ds_read_b64_tr_b16 a[176:177], v154 offset:0
    v_mfma_f32_16x16x32_bf16 v[236:239], a[116:119], v[120:123], v[236:239]
    ds_read_b64_tr_b16 a[178:179], v154 offset:1024
    v_mfma_f32_16x16x32_bf16 v[236:239], a[124:127], v[124:127], v[236:239]
    buffer_load_dwordx4 v158, s[44:47], s13 offen offset:2048 sc1 lds
    v_mfma_f32_16x16x32_bf16 v[232:235], a[120:123], v[124:127], v[232:235]
    ds_read_b64_tr_b16 a[180:181], v155 offset:0
    v_mfma_f32_16x16x32_bf16 v[232:235], a[112:115], v[120:123], v[232:235]
    ds_read_b64_tr_b16 a[182:183], v155 offset:1024
    s_waitcnt lgkmcnt(4)
    v_mfma_f32_16x16x32_bf16 v[192:195], a[128:131], v[80:83], v[192:195]
    s_add_u32 m0, s73, 32768
    s_mul_i32 s14, s80, 589824
    v_mfma_f32_16x16x32_bf16 v[192:195], a[136:139], v[84:87], v[192:195]
    ds_read_b128 v[104:107], v159 offset:25344
    v_mfma_f32_16x16x32_bf16 v[196:199], a[140:143], v[84:87], v[196:199]
    ds_read_b128 v[108:111], v159 offset:31488
    buffer_load_dwordx4 v148, s[48:51], s14 offen offset:0 lds
    v_mfma_f32_16x16x32_bf16 v[196:199], a[132:135], v[80:83], v[196:199]
    ds_read_b128 v[112:115], v159 offset:25600
    v_mfma_f32_16x16x32_bf16 v[204:207], a[132:135], v[88:91], v[204:207]
    ds_read_b128 v[116:119], v159 offset:31744
    buffer_load_dwordx4 v149, s[48:51], s14 offen offset:1024 lds
    v_mfma_f32_16x16x32_bf16 v[204:207], a[140:143], v[92:95], v[204:207]
    ds_read_b128 v[120:123], v159 offset:25856
    v_mfma_f32_16x16x32_bf16 v[200:203], a[136:139], v[92:95], v[200:203]
    ds_read_b128 v[124:127], v159 offset:32000
    s_lshl3_add_u32 s7, s3, s7
    s_lshl2_add_u32 s8, s7, s72
    s_lshl_b32 s8, s8, 10
    s_add_u32 s32, s8, 32391168
    s_xor_b32 s8, s8, 4096
    s_add_u32 s33, s8, 32391168
    s_xor_b32 s8, s3, s72
    s_cmp_lt_u32 s8, 2
    s_cselect_b32 s35, s35, 0x40000000
    s_cselect_b32 s16, s16, 0x40000000
    s_cselect_b32 s36, s68, 0
    v_mfma_f32_16x16x32_bf16 v[200:203], a[128:131], v[88:91], v[200:203]
    ds_read_b64_tr_b16 a[184:185], v154 offset:8192
    buffer_load_dwordx4 v150, s[48:51], s14 offen offset:2048 lds
    v_mfma_f32_16x16x32_bf16 v[208:211], a[128:131], v[96:99], v[208:211]
    ds_read_b64_tr_b16 a[186:187], v154 offset:9216
    v_mfma_f32_16x16x32_bf16 v[208:211], a[136:139], v[100:103], v[208:211]
    buffer_load_dwordx4 v151, s[48:51], s14 offen offset:3072 lds
    v_mfma_f32_16x16x32_bf16 v[212:215], a[140:143], v[100:103], v[212:215]
    ds_read_b64_tr_b16 a[188:189], v155 offset:8192
    v_mfma_f32_16x16x32_bf16 v[212:215], a[132:135], v[96:99], v[212:215]
    ds_read_b64_tr_b16 a[190:191], v155 offset:9216
    s_waitcnt lgkmcnt(4)
    v_mfma_f32_16x16x32_bf16 v[220:223], a[132:135], v[104:107], v[220:223]
    s_waitcnt vmcnt(14)
    s_barrier
    v_mfma_f32_16x16x32_bf16 v[220:223], a[140:143], v[108:111], v[220:223]
    ds_read_b128 v[80:83], v250 offset:0
    s_add_u32 m0, s74, 24576
    s_mul_i32 s13, s80, 90112
    v_mfma_f32_16x16x32_bf16 v[216:219], a[136:139], v[108:111], v[216:219]
    ds_read_b128 v[84:87], v250 offset:6144
    v_mfma_f32_16x16x32_bf16 v[216:219], a[128:131], v[104:107], v[216:219]
    ds_read_b128 v[88:91], v250 offset:256
    buffer_load_dwordx4 v156, s[44:47], s13 offen offset:0 sc1 lds
    v_mfma_f32_16x16x32_bf16 v[224:227], a[128:131], v[112:115], v[224:227]
    ds_read_b128 v[92:95], v250 offset:6400
    v_mfma_f32_16x16x32_bf16 v[224:227], a[136:139], v[116:119], v[224:227]
    ds_read_b128 v[96:99], v250 offset:512
    v_mfma_f32_16x16x32_bf16 v[228:231], a[140:143], v[116:119], v[228:231]
    ds_read_b128 v[100:103], v250 offset:6656
    buffer_load_dwordx4 v157, s[44:47], s13 offen offset:1024 sc1 lds
    s_mov_b32 s38, 0xbfb8aa3b
    s_and_b32 s8, s8, 1
    s_mul_i32 s41, s8, 96
    s_and_b32 s43, s73, 4096
    v_lshlrev_b32 v24, 10, v2
    v_add_u32 v24, s35, v24
    s_add_u32 s7, s34, 2048
    v_mov_b32 v25, s36
    v_mfma_f32_16x16x32_bf16 v[228:231], a[132:135], v[112:115], v[228:231]
    ds_read_b64_tr_b16 a[192:193], v152 offset:0
    v_mfma_f32_16x16x32_bf16 v[236:239], a[132:135], v[120:123], v[236:239]
    ds_read_b64_tr_b16 a[194:195], v152 offset:1024
    v_mfma_f32_16x16x32_bf16 v[236:239], a[140:143], v[124:127], v[236:239]
    buffer_load_dwordx4 v158, s[44:47], s13 offen offset:2048 sc1 lds
    v_mfma_f32_16x16x32_bf16 v[232:235], a[136:139], v[124:127], v[232:235]
    ds_read_b64_tr_b16 a[196:197], v153 offset:0
    v_mfma_f32_16x16x32_bf16 v[232:235], a[128:131], v[120:123], v[232:235]
    ds_read_b64_tr_b16 a[198:199], v153 offset:1024
    s_waitcnt lgkmcnt(4)
    v_mfma_f32_16x16x32_bf16 v[192:195], a[144:147], v[80:83], v[192:195]
    s_add_u32 m0, s73, 49152
    s_mul_i32 s14, s81, 589824
    v_mfma_f32_16x16x32_bf16 v[192:195], a[152:155], v[84:87], v[192:195]
    ds_read_b128 v[104:107], v250 offset:768
    v_mfma_f32_16x16x32_bf16 v[196:199], a[156:159], v[84:87], v[196:199]
    ds_read_b128 v[108:111], v250 offset:6912
    buffer_load_dwordx4 v148, s[48:51], s14 offen offset:0 lds
    v_mfma_f32_16x16x32_bf16 v[196:199], a[148:151], v[80:83], v[196:199]
    ds_read_b128 v[112:115], v250 offset:1024
    v_mfma_f32_16x16x32_bf16 v[204:207], a[148:151], v[88:91], v[204:207]
    ds_read_b128 v[116:119], v250 offset:7168
    buffer_load_dwordx4 v149, s[48:51], s14 offen offset:1024 lds
    v_mfma_f32_16x16x32_bf16 v[204:207], a[156:159], v[92:95], v[204:207]
    ds_read_b128 v[120:123], v250 offset:1280
    v_mfma_f32_16x16x32_bf16 v[200:203], a[152:155], v[92:95], v[200:203]
    ds_read_b128 v[124:127], v250 offset:7424
    v_cmp_gt_u32 vcc, 4, v2
    s_nop 1
    v_cndmask_b32 v138, 0, v25, vcc
    v_mov_b32 v25, 0x40000000
    v_cndmask_b32 v137, v25, v24, vcc
    v_writelane_b32 v137, s7, 4
    v_mfma_f32_16x16x32_bf16 v[200:203], a[144:147], v[88:91], v[200:203]
    ds_read_b64_tr_b16 a[200:201], v152 offset:8192
    buffer_load_dwordx4 v150, s[48:51], s14 offen offset:2048 lds
    v_mfma_f32_16x16x32_bf16 v[208:211], a[144:147], v[96:99], v[208:211]
    ds_read_b64_tr_b16 a[202:203], v152 offset:9216
    v_mfma_f32_16x16x32_bf16 v[208:211], a[152:155], v[100:103], v[208:211]
    buffer_load_dwordx4 v151, s[48:51], s14 offen offset:3072 lds
    v_mfma_f32_16x16x32_bf16 v[212:215], a[156:159], v[100:103], v[212:215]
    ds_read_b64_tr_b16 a[204:205], v153 offset:8192
    v_mfma_f32_16x16x32_bf16 v[212:215], a[148:151], v[96:99], v[212:215]
    ds_read_b64_tr_b16 a[206:207], v153 offset:9216
    s_waitcnt lgkmcnt(4)
    v_mfma_f32_16x16x32_bf16 v[220:223], a[148:151], v[104:107], v[220:223]
    s_waitcnt vmcnt(14)
    s_barrier
    v_mfma_f32_16x16x32_bf16 v[220:223], a[156:159], v[108:111], v[220:223]
    ds_read_b128 v[80:83], v250 offset:12288
    s_add_u32 m0, s74, 36864
    s_mul_i32 s13, s81, 90112
    v_mfma_f32_16x16x32_bf16 v[216:219], a[152:155], v[108:111], v[216:219]
    ds_read_b128 v[84:87], v250 offset:18432
    v_mfma_f32_16x16x32_bf16 v[216:219], a[144:147], v[104:107], v[216:219]
    ds_read_b128 v[88:91], v250 offset:12544
    buffer_load_dwordx4 v156, s[44:47], s13 offen offset:0 sc1 lds
    v_mfma_f32_16x16x32_bf16 v[224:227], a[144:147], v[112:115], v[224:227]
    ds_read_b128 v[92:95], v250 offset:18688
    v_mfma_f32_16x16x32_bf16 v[224:227], a[152:155], v[116:119], v[224:227]
    ds_read_b128 v[96:99], v250 offset:12800
    v_mfma_f32_16x16x32_bf16 v[228:231], a[156:159], v[116:119], v[228:231]
    ds_read_b128 v[100:103], v250 offset:18944
    buffer_load_dwordx4 v157, s[44:47], s13 offen offset:1024 sc1 lds
    v_writelane_b32 v138, s68, 4
    v_min_u32 v139, 1, v2
    v_lshlrev_b32 v139, 30, v139
    v_mov_b32 v140, 0
    v_writelane_b32 v140, s68, 0
    v_mfma_f32_16x16x32_bf16 v[228:231], a[148:151], v[112:115], v[228:231]
    ds_read_b64_tr_b16 a[208:209], v152 offset:16384
    v_mfma_f32_16x16x32_bf16 v[236:239], a[148:151], v[120:123], v[236:239]
    ds_read_b64_tr_b16 a[210:211], v152 offset:17408
    v_mfma_f32_16x16x32_bf16 v[236:239], a[156:159], v[124:127], v[236:239]
    buffer_load_dwordx4 v158, s[44:47], s13 offen offset:2048 sc1 lds
    v_mfma_f32_16x16x32_bf16 v[232:235], a[152:155], v[124:127], v[232:235]
    ds_read_b64_tr_b16 a[212:213], v153 offset:16384
    v_mfma_f32_16x16x32_bf16 v[232:235], a[144:147], v[120:123], v[232:235]
    ds_read_b64_tr_b16 a[214:215], v153 offset:17408
    s_waitcnt lgkmcnt(4)
    v_mfma_f32_16x16x32_bf16 v[192:195], a[160:163], v[80:83], v[192:195]
    s_add_u32 m0, s73, 65536
    s_lshl_b32 s14, s84, 18
    v_mfma_f32_16x16x32_bf16 v[192:195], a[168:171], v[84:87], v[192:195]
    ds_read_b128 v[104:107], v250 offset:13056
    v_mfma_f32_16x16x32_bf16 v[196:199], a[172:175], v[84:87], v[196:199]
    ds_read_b128 v[108:111], v250 offset:19200
    buffer_load_dwordx4 v4, s[52:55], s14 offen offset:0 lds
    v_mfma_f32_16x16x32_bf16 v[196:199], a[164:167], v[80:83], v[196:199]
    ds_read_b128 v[112:115], v250 offset:13312
    v_mfma_f32_16x16x32_bf16 v[204:207], a[164:167], v[88:91], v[204:207]
    ds_read_b128 v[116:119], v250 offset:19456
    buffer_load_dwordx4 v5, s[52:55], s14 offen offset:1024 lds
    v_mfma_f32_16x16x32_bf16 v[204:207], a[172:175], v[92:95], v[204:207]
    ds_read_b128 v[120:123], v250 offset:13568
    v_mfma_f32_16x16x32_bf16 v[200:203], a[168:171], v[92:95], v[200:203]
    ds_read_b128 v[124:127], v250 offset:19712
    v_mfma_f32_16x16x32_bf16 v[200:203], a[160:163], v[88:91], v[200:203]
    ds_read_b64_tr_b16 a[216:217], v152 offset:24576
    buffer_load_dwordx4 v6, s[52:55], s14 offen offset:2048 lds
    v_mfma_f32_16x16x32_bf16 v[208:211], a[160:163], v[96:99], v[208:211]
    ds_read_b64_tr_b16 a[218:219], v152 offset:25600
    v_mfma_f32_16x16x32_bf16 v[208:211], a[168:171], v[100:103], v[208:211]
    buffer_load_dwordx4 v7, s[52:55], s14 offen offset:3072 lds
    v_mfma_f32_16x16x32_bf16 v[212:215], a[172:175], v[100:103], v[212:215]
    ds_read_b64_tr_b16 a[220:221], v153 offset:24576
    v_mfma_f32_16x16x32_bf16 v[212:215], a[164:167], v[96:99], v[212:215]
    ds_read_b64_tr_b16 a[222:223], v153 offset:25600
    s_waitcnt lgkmcnt(4)
    v_mfma_f32_16x16x32_bf16 v[220:223], a[164:167], v[104:107], v[220:223]
    s_waitcnt vmcnt(14)
    s_barrier
    v_mfma_f32_16x16x32_bf16 v[220:223], a[172:175], v[108:111], v[220:223]
    ds_read_b128 v[80:83], v250 offset:24576
    v_mfma_f32_16x16x32_bf16 v[216:219], a[168:171], v[108:111], v[216:219]
    ds_read_b128 v[84:87], v250 offset:30720
    v_mfma_f32_16x16x32_bf16 v[216:219], a[160:163], v[104:107], v[216:219]
    ds_read_b128 v[88:91], v250 offset:24832
    v_mfma_f32_16x16x32_bf16 v[224:227], a[160:163], v[112:115], v[224:227]
    ds_read_b128 v[92:95], v250 offset:30976
    v_mfma_f32_16x16x32_bf16 v[224:227], a[168:171], v[116:119], v[224:227]
    ds_read_b128 v[96:99], v250 offset:25088
    v_mfma_f32_16x16x32_bf16 v[228:231], a[172:175], v[116:119], v[228:231]
    ds_read_b128 v[100:103], v250 offset:31232
    v_mfma_f32_16x16x32_bf16 v[228:231], a[164:167], v[112:115], v[228:231]
    ds_read_b64_tr_b16 a[224:225], v152 offset:32768
    v_mfma_f32_16x16x32_bf16 v[236:239], a[164:167], v[120:123], v[236:239]
    ds_read_b64_tr_b16 a[226:227], v152 offset:33792
    v_mfma_f32_16x16x32_bf16 v[236:239], a[172:175], v[124:127], v[236:239]
    v_mfma_f32_16x16x32_bf16 v[232:235], a[168:171], v[124:127], v[232:235]
    ds_read_b64_tr_b16 a[228:229], v153 offset:32768
    v_mfma_f32_16x16x32_bf16 v[232:235], a[160:163], v[120:123], v[232:235]
    ds_read_b64_tr_b16 a[230:231], v153 offset:33792
    s_waitcnt lgkmcnt(4)
    v_mfma_f32_16x16x32_bf16 v[192:195], a[176:179], v[80:83], v[192:195]
    v_mfma_f32_16x16x32_bf16 v[192:195], a[184:187], v[84:87], v[192:195]
    ds_read_b128 v[104:107], v250 offset:25344
    v_mfma_f32_16x16x32_bf16 v[196:199], a[188:191], v[84:87], v[196:199]
    ds_read_b128 v[108:111], v250 offset:31488
    v_mfma_f32_16x16x32_bf16 v[196:199], a[180:183], v[80:83], v[196:199]
    ds_read_b128 v[112:115], v250 offset:25600
    v_mfma_f32_16x16x32_bf16 v[204:207], a[180:183], v[88:91], v[204:207]
    ds_read_b128 v[116:119], v250 offset:31744
    v_mfma_f32_16x16x32_bf16 v[204:207], a[188:191], v[92:95], v[204:207]
    ds_read_b128 v[120:123], v250 offset:25856
    v_mfma_f32_16x16x32_bf16 v[200:203], a[184:187], v[92:95], v[200:203]
    ds_read_b128 v[124:127], v250 offset:32000
    v_mfma_f32_16x16x32_bf16 v[200:203], a[176:179], v[88:91], v[200:203]
    ds_read_b64_tr_b16 a[232:233], v152 offset:40960
    v_mfma_f32_16x16x32_bf16 v[208:211], a[176:179], v[96:99], v[208:211]
    ds_read_b64_tr_b16 a[234:235], v152 offset:41984
    v_mfma_f32_16x16x32_bf16 v[208:211], a[184:187], v[100:103], v[208:211]
    v_mfma_f32_16x16x32_bf16 v[212:215], a[188:191], v[100:103], v[212:215]
    ds_read_b64_tr_b16 a[236:237], v153 offset:40960
    v_mfma_f32_16x16x32_bf16 v[212:215], a[180:183], v[96:99], v[212:215]
    ds_read_b64_tr_b16 a[238:239], v153 offset:41984
    s_waitcnt lgkmcnt(4)
    v_mfma_f32_16x16x32_bf16 v[220:223], a[180:183], v[104:107], v[220:223]
    s_waitcnt vmcnt(7)
    s_barrier
    v_mfma_f32_16x16x32_bf16 v[220:223], a[188:191], v[108:111], v[220:223]
    ds_read_b128 v[80:83], v159 offset:0
    v_mfma_f32_16x16x32_bf16 v[216:219], a[184:187], v[108:111], v[216:219]
    ds_read_b128 v[84:87], v159 offset:6144
    v_mfma_f32_16x16x32_bf16 v[216:219], a[176:179], v[104:107], v[216:219]
    ds_read_b128 v[88:91], v159 offset:256
    v_mfma_f32_16x16x32_bf16 v[224:227], a[176:179], v[112:115], v[224:227]
    ds_read_b128 v[92:95], v159 offset:6400
    v_mfma_f32_16x16x32_bf16 v[224:227], a[184:187], v[116:119], v[224:227]
    ds_read_b128 v[96:99], v159 offset:512
    v_mfma_f32_16x16x32_bf16 v[228:231], a[188:191], v[116:119], v[228:231]
    ds_read_b128 v[100:103], v159 offset:6656
    v_mfma_f32_16x16x32_bf16 v[228:231], a[180:183], v[112:115], v[228:231]
    ds_read_b64_tr_b16 a[240:241], v152 offset:49152
    v_mfma_f32_16x16x32_bf16 v[236:239], a[180:183], v[120:123], v[236:239]
    ds_read_b64_tr_b16 a[242:243], v152 offset:50176
L_pl_G_3:
    s_cbranch_execz L_wret
    v_mfma_f32_16x16x32_bf16 v[236:239], a[188:191], v[124:127], v[236:239]
    v_mfma_f32_16x16x32_bf16 v[232:235], a[184:187], v[124:127], v[232:235]
    ds_read_b64_tr_b16 a[244:245], v153 offset:49152
    v_mfma_f32_16x16x32_bf16 v[232:235], a[176:179], v[120:123], v[232:235]
    ds_read_b64_tr_b16 a[246:247], v153 offset:50176
    s_waitcnt lgkmcnt(4)
    v_mfma_f32_16x16x32_bf16 v[192:195], a[192:195], v[80:83], v[192:195]
    v_mfma_f32_16x16x32_bf16 v[192:195], a[200:203], v[84:87], v[192:195]
    ds_read_b128 v[104:107], v159 offset:768
    v_mfma_f32_16x16x32_bf16 v[196:199], a[204:207], v[84:87], v[196:199]
    ds_read_b128 v[108:111], v159 offset:6912
    v_mfma_f32_16x16x32_bf16 v[196:199], a[196:199], v[80:83], v[196:199]
    ds_read_b128 v[112:115], v159 offset:1024
    v_mfma_f32_16x16x32_bf16 v[204:207], a[196:199], v[88:91], v[204:207]
    ds_read_b128 v[116:119], v159 offset:7168
    v_mfma_f32_16x16x32_bf16 v[204:207], a[204:207], v[92:95], v[204:207]
    ds_read_b128 v[120:123], v159 offset:1280
    v_mfma_f32_16x16x32_bf16 v[200:203], a[200:203], v[92:95], v[200:203]
    ds_read_b128 v[124:127], v159 offset:7424
    v_mfma_f32_16x16x32_bf16 v[200:203], a[192:195], v[88:91], v[200:203]
    ds_read_b64_tr_b16 a[248:249], v152 offset:57344
    v_mfma_f32_16x16x32_bf16 v[208:211], a[192:195], v[96:99], v[208:211]
    ds_read_b64_tr_b16 a[250:251], v152 offset:58368
    v_mfma_f32_16x16x32_bf16 v[208:211], a[200:203], v[100:103], v[208:211]
    v_mfma_f32_16x16x32_bf16 v[212:215], a[204:207], v[100:103], v[212:215]
    ds_read_b64_tr_b16 a[252:253], v153 offset:57344
    v_mfma_f32_16x16x32_bf16 v[212:215], a[196:199], v[96:99], v[212:215]
    ds_read_b64_tr_b16 a[254:255], v153 offset:58368
    s_waitcnt lgkmcnt(4)
    v_mfma_f32_16x16x32_bf16 v[220:223], a[196:199], v[104:107], v[220:223]
    s_barrier
    v_mfma_f32_16x16x32_bf16 v[220:223], a[204:207], v[108:111], v[220:223]
    ds_read_b128 v[80:83], v159 offset:12288
    s_add_u32 m0, s74, 49152
    s_mul_i32 s13, s18, 90112
    v_mfma_f32_16x16x32_bf16 v[216:219], a[200:203], v[108:111], v[216:219]
    ds_read_b128 v[84:87], v159 offset:18432
    v_mfma_f32_16x16x32_bf16 v[216:219], a[192:195], v[104:107], v[216:219]
    ds_read_b128 v[88:91], v159 offset:12544
    buffer_load_dwordx4 v8, s[44:47], s13 offen offset:0 sc1 lds
    v_mfma_f32_16x16x32_bf16 v[224:227], a[192:195], v[112:115], v[224:227]
    ds_read_b128 v[92:95], v159 offset:18688
    v_mfma_f32_16x16x32_bf16 v[224:227], a[200:203], v[116:119], v[224:227]
    ds_read_b128 v[96:99], v159 offset:12800
    v_mfma_f32_16x16x32_bf16 v[228:231], a[204:207], v[116:119], v[228:231]
    ds_read_b128 v[100:103], v159 offset:18944
    buffer_load_dwordx4 v9, s[44:47], s13 offen offset:1024 sc1 lds
    v_mfma_f32_16x16x32_bf16 v[228:231], a[196:199], v[112:115], v[228:231]
    v_mfma_f32_16x16x32_bf16 v[236:239], a[196:199], v[120:123], v[236:239]
    v_mfma_f32_16x16x32_bf16 v[236:239], a[204:207], v[124:127], v[236:239]
    buffer_load_dwordx4 v3, s[44:47], s13 offen offset:2048 sc1 lds
    v_mfma_f32_16x16x32_bf16 v[232:235], a[200:203], v[124:127], v[232:235]
    v_mfma_f32_16x16x32_bf16 v[232:235], a[192:195], v[120:123], v[232:235]
    s_waitcnt lgkmcnt(0)
    v_mfma_f32_16x16x32_bf16 v[192:195], a[208:211], v[80:83], v[192:195]
    s_add_u32 m0, s74, 61440
    s_mul_i32 s13, s19, 90112
    v_mfma_f32_16x16x32_bf16 v[192:195], a[216:219], v[84:87], v[192:195]
    ds_read_b128 v[104:107], v159 offset:13056
    v_mfma_f32_16x16x32_bf16 v[196:199], a[220:223], v[84:87], v[196:199]
    ds_read_b128 v[108:111], v159 offset:19200
    v_mfma_f32_16x16x32_bf16 v[196:199], a[212:215], v[80:83], v[196:199]
    ds_read_b128 v[112:115], v159 offset:13312
    buffer_load_dwordx4 v8, s[44:47], s13 offen offset:0 sc1 lds
    v_mfma_f32_16x16x32_bf16 v[204:207], a[212:215], v[88:91], v[204:207]
    ds_read_b128 v[116:119], v159 offset:19456
    v_mfma_f32_16x16x32_bf16 v[204:207], a[220:223], v[92:95], v[204:207]
    ds_read_b128 v[120:123], v159 offset:13568
    v_mfma_f32_16x16x32_bf16 v[200:203], a[216:219], v[92:95], v[200:203]
    ds_read_b128 v[124:127], v159 offset:19712
    buffer_load_dwordx4 v9, s[44:47], s13 offen offset:1024 sc1 lds
    v_mfma_f32_16x16x32_bf16 v[200:203], a[208:211], v[88:91], v[200:203]
    v_mfma_f32_16x16x32_bf16 v[208:211], a[208:211], v[96:99], v[208:211]
    v_mfma_f32_16x16x32_bf16 v[208:211], a[216:219], v[100:103], v[208:211]
    buffer_load_dwordx4 v3, s[44:47], s13 offen offset:2048 sc1 lds
    v_mfma_f32_16x16x32_bf16 v[212:215], a[220:223], v[100:103], v[212:215]
    v_mfma_f32_16x16x32_bf16 v[212:215], a[212:215], v[96:99], v[212:215]
    s_waitcnt lgkmcnt(0)
    v_mfma_f32_16x16x32_bf16 v[220:223], a[212:215], v[104:107], v[220:223]
    s_barrier
    v_mfma_f32_16x16x32_bf16 v[220:223], a[220:223], v[108:111], v[220:223]
    ds_read_b128 v[80:83], v159 offset:24576
    s_add_u32 m0, s74, 0
    s_mul_i32 s13, s20, 90112
    v_mfma_f32_16x16x32_bf16 v[216:219], a[216:219], v[108:111], v[216:219]
    ds_read_b128 v[84:87], v159 offset:30720
    v_mfma_f32_16x16x32_bf16 v[216:219], a[208:211], v[104:107], v[216:219]
    ds_read_b128 v[88:91], v159 offset:24832
    buffer_load_dwordx4 v8, s[44:47], s13 offen offset:0 sc1 lds
    v_mfma_f32_16x16x32_bf16 v[224:227], a[208:211], v[112:115], v[224:227]
    ds_read_b128 v[92:95], v159 offset:30976
    v_mfma_f32_16x16x32_bf16 v[224:227], a[216:219], v[116:119], v[224:227]
    ds_read_b128 v[96:99], v159 offset:25088
    v_mfma_f32_16x16x32_bf16 v[228:231], a[220:223], v[116:119], v[228:231]
    ds_read_b128 v[100:103], v159 offset:31232
    buffer_load_dwordx4 v9, s[44:47], s13 offen offset:1024 sc1 lds
    v_mfma_f32_16x16x32_bf16 v[228:231], a[212:215], v[112:115], v[228:231]
    v_mfma_f32_16x16x32_bf16 v[236:239], a[212:215], v[120:123], v[236:239]
    v_mfma_f32_16x16x32_bf16 v[236:239], a[220:223], v[124:127], v[236:239]
    buffer_load_dwordx4 v3, s[44:47], s13 offen offset:2048 sc1 lds
    v_mfma_f32_16x16x32_bf16 v[232:235], a[216:219], v[124:127], v[232:235]
    v_mfma_f32_16x16x32_bf16 v[232:235], a[208:211], v[120:123], v[232:235]
    s_waitcnt lgkmcnt(0)
    v_mfma_f32_16x16x32_bf16 v[192:195], a[224:227], v[80:83], v[192:195]
    s_add_u32 m0, s74, 12288
    s_mul_i32 s13, s21, 90112
    v_mfma_f32_16x16x32_bf16 v[192:195], a[232:235], v[84:87], v[192:195]
    ds_read_b128 v[104:107], v159 offset:25344
    v_mfma_f32_16x16x32_bf16 v[196:199], a[236:239], v[84:87], v[196:199]
    ds_read_b128 v[108:111], v159 offset:31488
    v_mfma_f32_16x16x32_bf16 v[196:199], a[228:231], v[80:83], v[196:199]
    ds_read_b128 v[112:115], v159 offset:25600
    buffer_load_dwordx4 v8, s[44:47], s13 offen offset:0 sc1 lds
    v_mfma_f32_16x16x32_bf16 v[204:207], a[228:231], v[88:91], v[204:207]
    ds_read_b128 v[116:119], v159 offset:31744
    v_mfma_f32_16x16x32_bf16 v[204:207], a[236:239], v[92:95], v[204:207]
    ds_read_b128 v[120:123], v159 offset:25856
    v_mfma_f32_16x16x32_bf16 v[200:203], a[232:235], v[92:95], v[200:203]
    ds_read_b128 v[124:127], v159 offset:32000
    buffer_load_dwordx4 v9, s[44:47], s13 offen offset:1024 sc1 lds
    v_mfma_f32_16x16x32_bf16 v[200:203], a[224:227], v[88:91], v[200:203]
    v_mfma_f32_16x16x32_bf16 v[208:211], a[224:227], v[96:99], v[208:211]
    v_mfma_f32_16x16x32_bf16 v[208:211], a[232:235], v[100:103], v[208:211]
    buffer_load_dwordx4 v3, s[44:47], s13 offen offset:2048 sc1 lds
    v_mfma_f32_16x16x32_bf16 v[212:215], a[236:239], v[100:103], v[212:215]
    v_mfma_f32_16x16x32_bf16 v[212:215], a[228:231], v[96:99], v[212:215]
    s_waitcnt lgkmcnt(0)
    v_mfma_f32_16x16x32_bf16 v[220:223], a[228:231], v[104:107], v[220:223]
    s_waitcnt vmcnt(16)
    s_barrier
    v_mfma_f32_16x16x32_bf16 v[220:223], a[236:239], v[108:111], v[220:223]
    ds_read_b128 v[80:83], v250 offset:0
    s_add_u32 m0, s74, 24576
    s_mul_i32 s13, s22, 90112
    v_mfma_f32_16x16x32_bf16 v[216:219], a[232:235], v[108:111], v[216:219]
    ds_read_b128 v[84:87], v250 offset:6144
    v_mfma_f32_16x16x32_bf16 v[216:219], a[224:227], v[104:107], v[216:219]
    ds_read_b128 v[88:91], v250 offset:256
    buffer_load_dwordx4 v8, s[44:47], s13 offen offset:0 sc1 lds
    v_mfma_f32_16x16x32_bf16 v[224:227], a[224:227], v[112:115], v[224:227]
    ds_read_b128 v[92:95], v250 offset:6400
    v_mfma_f32_16x16x32_bf16 v[224:227], a[232:235], v[116:119], v[224:227]
    ds_read_b128 v[96:99], v250 offset:512
    v_mfma_f32_16x16x32_bf16 v[228:231], a[236:239], v[116:119], v[228:231]
    ds_read_b128 v[100:103], v250 offset:6656
    buffer_load_dwordx4 v9, s[44:47], s13 offen offset:1024 sc1 lds
    v_mfma_f32_16x16x32_bf16 v[228:231], a[228:231], v[112:115], v[228:231]
    v_mfma_f32_16x16x32_bf16 v[236:239], a[228:231], v[120:123], v[236:239]
    v_mfma_f32_16x16x32_bf16 v[236:239], a[236:239], v[124:127], v[236:239]
    buffer_load_dwordx4 v3, s[44:47], s13 offen offset:2048 sc1 lds
    v_mfma_f32_16x16x32_bf16 v[232:235], a[232:235], v[124:127], v[232:235]
    v_mfma_f32_16x16x32_bf16 v[232:235], a[224:227], v[120:123], v[232:235]
    s_waitcnt lgkmcnt(0)
    v_mfma_f32_16x16x32_bf16 v[192:195], a[240:243], v[80:83], v[192:195]
    s_add_u32 m0, s73, 0
    s_lshl_b32 s14, s85, 18
    v_mfma_f32_16x16x32_bf16 v[192:195], a[248:251], v[84:87], v[192:195]
    ds_read_b128 v[104:107], v250 offset:768
    v_mfma_f32_16x16x32_bf16 v[196:199], a[252:255], v[84:87], v[196:199]
    ds_read_b128 v[108:111], v250 offset:6912
    buffer_load_dwordx4 v4, s[52:55], s14 offen offset:0 lds
    v_mfma_f32_16x16x32_bf16 v[196:199], a[244:247], v[80:83], v[196:199]
    ds_read_b128 v[112:115], v250 offset:1024
    v_mfma_f32_16x16x32_bf16 v[204:207], a[244:247], v[88:91], v[204:207]
    ds_read_b128 v[116:119], v250 offset:7168
    buffer_load_dwordx4 v5, s[52:55], s14 offen offset:1024 lds
    v_mfma_f32_16x16x32_bf16 v[204:207], a[252:255], v[92:95], v[204:207]
    ds_read_b128 v[120:123], v250 offset:1280
    v_mfma_f32_16x16x32_bf16 v[200:203], a[248:251], v[92:95], v[200:203]
    ds_read_b128 v[124:127], v250 offset:7424
    v_mfma_f32_16x16x32_bf16 v[200:203], a[240:243], v[88:91], v[200:203]
    buffer_load_dwordx4 v6, s[52:55], s14 offen offset:2048 lds
    v_mfma_f32_16x16x32_bf16 v[208:211], a[240:243], v[96:99], v[208:211]
    v_mfma_f32_16x16x32_bf16 v[208:211], a[248:251], v[100:103], v[208:211]
    buffer_load_dwordx4 v7, s[52:55], s14 offen offset:3072 lds
    v_mfma_f32_16x16x32_bf16 v[212:215], a[252:255], v[100:103], v[212:215]
    v_mfma_f32_16x16x32_bf16 v[212:215], a[244:247], v[96:99], v[212:215]
    s_waitcnt lgkmcnt(0)
    v_mfma_f32_16x16x32_bf16 v[220:223], a[244:247], v[104:107], v[220:223]
    s_waitcnt vmcnt(16)
    s_barrier
    v_mfma_f32_16x16x32_bf16 v[220:223], a[252:255], v[108:111], v[220:223]
    ds_read_b128 v[80:83], v250 offset:12288
    v_mfma_f32_16x16x32_bf16 v[216:219], a[248:251], v[108:111], v[216:219]
    ds_read_b128 v[84:87], v250 offset:18432
    v_mfma_f32_16x16x32_bf16 v[216:219], a[240:243], v[104:107], v[216:219]
    ds_read_b128 v[88:91], v250 offset:12544
    v_mfma_f32_16x16x32_bf16 v[224:227], a[240:243], v[112:115], v[224:227]
    ds_read_b128 v[92:95], v250 offset:18688
    v_cvt_pk_bf16_f32 v192, v192, v193
    v_mfma_f32_16x16x32_bf16 v[224:227], a[248:251], v[116:119], v[224:227]
    ds_read_b128 v[96:99], v250 offset:12800
    v_mfma_f32_16x16x32_bf16 v[228:231], a[252:255], v[116:119], v[228:231]
    ds_read_b128 v[100:103], v250 offset:18944
    v_cvt_pk_bf16_f32 v193, v194, v195
    v_mfma_f32_16x16x32_bf16 v[228:231], a[244:247], v[112:115], v[228:231]
    v_mfma_f32_16x16x32_bf16 v[236:239], a[244:247], v[120:123], v[236:239]
    v_cvt_pk_bf16_f32 v194, v196, v197
    v_mfma_f32_16x16x32_bf16 v[236:239], a[252:255], v[124:127], v[236:239]
    v_cvt_pk_bf16_f32 v195, v198, v199
    v_mfma_f32_16x16x32_bf16 v[232:235], a[248:251], v[124:127], v[232:235]
    v_mfma_f32_16x16x32_bf16 v[232:235], a[240:243], v[120:123], v[232:235]
    buffer_store_dwordx4 v[192:195], v246, s[44:47], s9 offen offset:0 sc1
    s_waitcnt lgkmcnt(0)
    v_mfma_f32_16x16x32_bf16 v[32:35], a[0:3], v[80:83], v[128:131]
    v_mfma_f32_16x16x32_bf16 v[32:35], a[8:11], v[84:87], v[32:35]
    ds_read_b128 v[104:107], v250 offset:13056
    v_mfma_f32_16x16x32_bf16 v[36:39], a[12:15], v[84:87], v[132:135]
    ds_read_b128 v[108:111], v250 offset:19200
    v_mfma_f32_16x16x32_bf16 v[36:39], a[4:7], v[80:83], v[36:39]
    ds_read_b128 v[112:115], v250 offset:13312
    v_mfma_f32_16x16x32_bf16 v[44:47], a[4:7], v[88:91], v[132:135]
    ds_read_b128 v[116:119], v250 offset:19456
    v_cvt_pk_bf16_f32 v200, v200, v201
    v_mfma_f32_16x16x32_bf16 v[44:47], a[12:15], v[92:95], v[44:47]
    ds_read_b128 v[120:123], v250 offset:13568
    v_mfma_f32_16x16x32_bf16 v[40:43], a[8:11], v[92:95], v[128:131]
    ds_read_b128 v[124:127], v250 offset:19712
    v_cvt_pk_bf16_f32 v201, v202, v203
    v_mfma_f32_16x16x32_bf16 v[40:43], a[0:3], v[88:91], v[40:43]
    v_mfma_f32_16x16x32_bf16 v[48:51], a[0:3], v[96:99], v[128:131]
    v_cvt_pk_bf16_f32 v202, v204, v205
    v_mfma_f32_16x16x32_bf16 v[48:51], a[8:11], v[100:103], v[48:51]
    v_cvt_pk_bf16_f32 v203, v206, v207
    v_mfma_f32_16x16x32_bf16 v[52:55], a[12:15], v[100:103], v[132:135]
    v_mfma_f32_16x16x32_bf16 v[52:55], a[4:7], v[96:99], v[52:55]
    buffer_store_dwordx4 v[200:203], v246, s[44:47], s9 offen offset:1024 sc1
    s_waitcnt lgkmcnt(0)
    v_mfma_f32_16x16x32_bf16 v[60:63], a[4:7], v[104:107], v[132:135]
    s_waitcnt vmcnt(15)
    s_barrier
    v_mfma_f32_16x16x32_bf16 v[60:63], a[12:15], v[108:111], v[60:63]
    ds_read_b128 v[80:83], v250 offset:24576
    v_cvt_pk_bf16_f32 v208, v208, v209
    v_mfma_f32_16x16x32_bf16 v[56:59], a[8:11], v[108:111], v[128:131]
    ds_read_b128 v[84:87], v250 offset:30720
    v_mfma_f32_16x16x32_bf16 v[56:59], a[0:3], v[104:107], v[56:59]
    ds_read_b128 v[88:91], v250 offset:24832
    v_cvt_pk_bf16_f32 v209, v210, v211
    v_mfma_f32_16x16x32_bf16 v[64:67], a[0:3], v[112:115], v[128:131]
    ds_read_b128 v[92:95], v250 offset:30976
    v_mfma_f32_16x16x32_bf16 v[64:67], a[8:11], v[116:119], v[64:67]
    ds_read_b128 v[96:99], v250 offset:25088
    v_mfma_f32_16x16x32_bf16 v[68:71], a[12:15], v[116:119], v[132:135]
    ds_read_b128 v[100:103], v250 offset:31232
    v_cvt_pk_bf16_f32 v210, v212, v213
    v_mfma_f32_16x16x32_bf16 v[68:71], a[4:7], v[112:115], v[68:71]
    v_mfma_f32_16x16x32_bf16 v[76:79], a[4:7], v[120:123], v[132:135]
    v_cvt_pk_bf16_f32 v211, v214, v215
    v_mfma_f32_16x16x32_bf16 v[76:79], a[12:15], v[124:127], v[76:79]
    v_mfma_f32_16x16x32_bf16 v[72:75], a[8:11], v[124:127], v[128:131]
    buffer_store_dwordx4 v[208:211], v246, s[44:47], s9 offen offset:2048 sc1
    v_mfma_f32_16x16x32_bf16 v[72:75], a[0:3], v[120:123], v[72:75]
    s_waitcnt lgkmcnt(0)
    v_mfma_f32_16x16x32_bf16 v[32:35], a[16:19], v[80:83], v[32:35]
    v_mfma_f32_16x16x32_bf16 v[32:35], a[24:27], v[84:87], v[32:35]
    ds_read_b128 v[104:107], v250 offset:25344
    v_cvt_pk_bf16_f32 v216, v216, v217
    v_mfma_f32_16x16x32_bf16 v[36:39], a[28:31], v[84:87], v[36:39]
    ds_read_b128 v[108:111], v250 offset:31488
    v_mfma_f32_16x16x32_bf16 v[36:39], a[20:23], v[80:83], v[36:39]
    ds_read_b128 v[112:115], v250 offset:25600
    v_cvt_pk_bf16_f32 v217, v218, v219
    v_mfma_f32_16x16x32_bf16 v[44:47], a[20:23], v[88:91], v[44:47]
    ds_read_b128 v[116:119], v250 offset:31744
    v_mfma_f32_16x16x32_bf16 v[44:47], a[28:31], v[92:95], v[44:47]
    ds_read_b128 v[120:123], v250 offset:25856
    v_mfma_f32_16x16x32_bf16 v[40:43], a[24:27], v[92:95], v[40:43]
    ds_read_b128 v[124:127], v250 offset:32000
    v_cvt_pk_bf16_f32 v218, v220, v221
    v_mfma_f32_16x16x32_bf16 v[40:43], a[16:19], v[88:91], v[40:43]
    v_mfma_f32_16x16x32_bf16 v[48:51], a[16:19], v[96:99], v[48:51]
    v_cvt_pk_bf16_f32 v219, v222, v223
    v_mfma_f32_16x16x32_bf16 v[48:51], a[24:27], v[100:103], v[48:51]
    v_mfma_f32_16x16x32_bf16 v[52:55], a[28:31], v[100:103], v[52:55]
    buffer_store_dwordx4 v[216:219], v247, s[44:47], s9 offen offset:0 sc1
    v_mfma_f32_16x16x32_bf16 v[52:55], a[20:23], v[96:99], v[52:55]
    s_waitcnt lgkmcnt(0)
    v_mfma_f32_16x16x32_bf16 v[60:63], a[20:23], v[104:107], v[60:63]
    s_waitcnt vmcnt(14)
    s_barrier
    v_cvt_pk_bf16_f32 v224, v224, v225
    v_mfma_f32_16x16x32_bf16 v[60:63], a[28:31], v[108:111], v[60:63]
    ds_read_b128 v[80:83], v159 offset:0
    s_add_u32 m0, s74, 36864
    s_mul_i32 s13, s23, 90112
    v_mfma_f32_16x16x32_bf16 v[56:59], a[24:27], v[108:111], v[56:59]
    ds_read_b128 v[84:87], v159 offset:6144
    v_mfma_f32_16x16x32_bf16 v[56:59], a[16:19], v[104:107], v[56:59]
    ds_read_b128 v[88:91], v159 offset:256
    buffer_load_dwordx4 v8, s[44:47], s13 offen offset:0 sc1 lds
    v_mfma_f32_16x16x32_bf16 v[64:67], a[16:19], v[112:115], v[64:67]
    ds_read_b128 v[92:95], v159 offset:6400
    v_cvt_pk_bf16_f32 v225, v226, v227
    v_mfma_f32_16x16x32_bf16 v[64:67], a[24:27], v[116:119], v[64:67]
    ds_read_b128 v[96:99], v159 offset:512
    v_cvt_pk_bf16_f32 v226, v228, v229
    v_mfma_f32_16x16x32_bf16 v[68:71], a[28:31], v[116:119], v[68:71]
    ds_read_b128 v[100:103], v159 offset:6656
    buffer_load_dwordx4 v9, s[44:47], s13 offen offset:1024 sc1 lds
    v_mfma_f32_16x16x32_bf16 v[68:71], a[20:23], v[112:115], v[68:71]
    v_add_u32 v10, 65536, v10
    v_mfma_f32_16x16x32_bf16 v[76:79], a[20:23], v[120:123], v[76:79]
    ds_read_b64_tr_b16 a[0:1], v10 offset:0
    v_cvt_pk_bf16_f32 v227, v230, v231
    v_mfma_f32_16x16x32_bf16 v[76:79], a[28:31], v[124:127], v[76:79]
    ds_read_b64_tr_b16 a[2:3], v10 offset:2048
    buffer_load_dwordx4 v3, s[44:47], s13 offen offset:2048 sc1 lds
    v_mfma_f32_16x16x32_bf16 v[72:75], a[24:27], v[124:127], v[72:75]
    buffer_store_dwordx4 v[224:227], v247, s[44:47], s9 offen offset:1024 sc1
    ds_read_b64_tr_b16 a[8:9], v10 offset:4096
    v_mfma_f32_16x16x32_bf16 v[72:75], a[16:19], v[120:123], v[72:75]
    ds_read_b64_tr_b16 a[10:11], v10 offset:6144
    s_waitcnt lgkmcnt(4)
    v_mfma_f32_16x16x32_bf16 v[32:35], a[32:35], v[80:83], v[32:35]
    s_add_u32 m0, s74, 49152
    s_mul_i32 s13, s24, 90112
    v_mfma_f32_16x16x32_bf16 v[32:35], a[40:43], v[84:87], v[32:35]
    ds_read_b128 v[104:107], v159 offset:768
    v_cvt_pk_bf16_f32 v232, v232, v233
    v_mfma_f32_16x16x32_bf16 v[36:39], a[44:47], v[84:87], v[36:39]
    ds_read_b128 v[108:111], v159 offset:6912
    v_mfma_f32_16x16x32_bf16 v[36:39], a[36:39], v[80:83], v[36:39]
    ds_read_b128 v[112:115], v159 offset:1024
    buffer_load_dwordx4 v8, s[44:47], s13 offen offset:0 sc1 lds
    v_mfma_f32_16x16x32_bf16 v[44:47], a[36:39], v[88:91], v[44:47]
    ds_read_b128 v[116:119], v159 offset:7168
    v_cvt_pk_bf16_f32 v233, v234, v235
    v_mfma_f32_16x16x32_bf16 v[44:47], a[44:47], v[92:95], v[44:47]
    ds_read_b128 v[120:123], v159 offset:1280
    v_cvt_pk_bf16_f32 v234, v236, v237
    v_mfma_f32_16x16x32_bf16 v[40:43], a[40:43], v[92:95], v[40:43]
    ds_read_b128 v[124:127], v159 offset:7424
    buffer_load_dwordx4 v9, s[44:47], s13 offen offset:1024 sc1 lds
    v_mfma_f32_16x16x32_bf16 v[40:43], a[32:35], v[88:91], v[40:43]
    v_add_u32 v11, 65536, v11
    v_mfma_f32_16x16x32_bf16 v[48:51], a[32:35], v[96:99], v[48:51]
    ds_read_b64_tr_b16 a[4:5], v11 offset:0
    v_cvt_pk_bf16_f32 v235, v238, v239
    v_mfma_f32_16x16x32_bf16 v[48:51], a[40:43], v[100:103], v[48:51]
    ds_read_b64_tr_b16 a[6:7], v11 offset:2048
    buffer_load_dwordx4 v3, s[44:47], s13 offen offset:2048 sc1 lds
    v_mfma_f32_16x16x32_bf16 v[52:55], a[44:47], v[100:103], v[52:55]
    buffer_store_dwordx4 v[232:235], v247, s[44:47], s9 offen offset:2048 sc1
    ds_read_b64_tr_b16 a[12:13], v11 offset:4096
    v_mfma_f32_16x16x32_bf16 v[52:55], a[36:39], v[96:99], v[52:55]
    ds_read_b64_tr_b16 a[14:15], v11 offset:6144
    s_waitcnt lgkmcnt(4)
    v_mfma_f32_16x16x32_bf16 v[60:63], a[36:39], v[104:107], v[60:63]
    s_waitcnt vmcnt(19)
    s_barrier
    v_mfma_f32_16x16x32_bf16 v[60:63], a[44:47], v[108:111], v[60:63]
    ds_read_b128 v[80:83], v159 offset:12288
    s_add_u32 m0, s74, 61440
    s_mul_i32 s13, s25, 90112
    v_mfma_f32_16x16x32_bf16 v[56:59], a[40:43], v[108:111], v[56:59]
    ds_read_b128 v[84:87], v159 offset:18432
    v_mfma_f32_16x16x32_bf16 v[56:59], a[32:35], v[104:107], v[56:59]
    ds_read_b128 v[88:91], v159 offset:12544
    buffer_load_dwordx4 v8, s[44:47], s13 offen offset:0 sc1 lds
    v_mfma_f32_16x16x32_bf16 v[64:67], a[32:35], v[112:115], v[64:67]
    ds_read_b128 v[92:95], v159 offset:18688
    v_mfma_f32_16x16x32_bf16 v[64:67], a[40:43], v[116:119], v[64:67]
    ds_read_b128 v[96:99], v159 offset:12800
    v_mfma_f32_16x16x32_bf16 v[68:71], a[44:47], v[116:119], v[68:71]
    ds_read_b128 v[100:103], v159 offset:18944
    buffer_load_dwordx4 v9, s[44:47], s13 offen offset:1024 sc1 lds
    v_mfma_f32_16x16x32_bf16 v[68:71], a[36:39], v[112:115], v[68:71]
    v_mfma_f32_16x16x32_bf16 v[76:79], a[36:39], v[120:123], v[76:79]
    v_mfma_f32_16x16x32_bf16 v[76:79], a[44:47], v[124:127], v[76:79]
    buffer_load_dwordx4 v3, s[44:47], s13 offen offset:2048 sc1 lds
    v_mfma_f32_16x16x32_bf16 v[72:75], a[40:43], v[124:127], v[72:75]
    v_mfma_f32_16x16x32_bf16 v[72:75], a[32:35], v[120:123], v[72:75]
    s_waitcnt lgkmcnt(0)
    v_mfma_f32_16x16x32_bf16 v[32:35], a[48:51], v[80:83], v[32:35]
    s_add_u32 m0, s74, 0
    s_mul_i32 s13, s26, 90112
    v_bfe_u32 v24, v2, 2, 2
    v_mfma_f32_16x16x32_bf16 v[32:35], a[56:59], v[84:87], v[32:35]
    ds_read_b128 v[104:107], v159 offset:13056
    v_mfma_f32_16x16x32_bf16 v[36:39], a[60:63], v[84:87], v[36:39]
    ds_read_b128 v[108:111], v159 offset:19200
    v_lshrrev_b32 v25, 4, v2
    v_mfma_f32_16x16x32_bf16 v[36:39], a[52:55], v[80:83], v[36:39]
    ds_read_b128 v[112:115], v159 offset:13312
    buffer_load_dwordx4 v8, s[44:47], s13 offen offset:0 sc1 lds
    v_mfma_f32_16x16x32_bf16 v[44:47], a[52:55], v[88:91], v[44:47]
    ds_read_b128 v[116:119], v159 offset:19456
    v_cmp_eq_u32 vcc, v24, v25
    v_mfma_f32_16x16x32_bf16 v[44:47], a[60:63], v[92:95], v[44:47]
    ds_read_b128 v[120:123], v159 offset:13568
    v_and_b32 v24, 1, v2
    v_mfma_f32_16x16x32_bf16 v[40:43], a[56:59], v[92:95], v[40:43]
    ds_read_b128 v[124:127], v159 offset:19712
    buffer_load_dwordx4 v9, s[44:47], s13 offen offset:1024 sc1 lds
    v_mfma_f32_16x16x32_bf16 v[40:43], a[48:51], v[88:91], v[40:43]
    v_lshlrev_b32 v24, 4, v24
    v_mfma_f32_16x16x32_bf16 v[48:51], a[48:51], v[96:99], v[48:51]
    v_mov_b32 v25, 0x3f80
    v_mfma_f32_16x16x32_bf16 v[48:51], a[56:59], v[100:103], v[48:51]
    buffer_load_dwordx4 v3, s[44:47], s13 offen offset:2048 sc1 lds
    v_lshlrev_b32 v24, v24, v25
    v_mfma_f32_16x16x32_bf16 v[52:55], a[60:63], v[100:103], v[52:55]
    v_mfma_f32_16x16x32_bf16 v[52:55], a[52:55], v[96:99], v[52:55]
    v_cndmask_b32 v24, 0, v24, vcc
    s_waitcnt lgkmcnt(0)
    v_mfma_f32_16x16x32_bf16 v[60:63], a[52:55], v[104:107], v[60:63]
    s_waitcnt vmcnt(18)
    s_barrier
    v_and_b32 v25, 2, v2
    v_mfma_f32_16x16x32_bf16 v[60:63], a[60:63], v[108:111], v[60:63]
    ds_read_b128 v[80:83], v159 offset:24576
    s_add_u32 m0, s74, 12288
    s_mul_i32 s13, s27, 90112
    v_mfma_f32_16x16x32_bf16 v[56:59], a[56:59], v[108:111], v[56:59]
    ds_read_b128 v[84:87], v159 offset:30720
    v_cmp_eq_u32 vcc, 0, v25
    v_mfma_f32_16x16x32_bf16 v[56:59], a[48:51], v[104:107], v[56:59]
    ds_read_b128 v[88:91], v159 offset:24832
    buffer_load_dwordx4 v8, s[44:47], s13 offen offset:0 sc1 lds
    v_mfma_f32_16x16x32_bf16 v[64:67], a[48:51], v[112:115], v[64:67]
    ds_read_b128 v[92:95], v159 offset:30976
    v_cndmask_b32 v130, 0, v24, vcc
    v_mfma_f32_16x16x32_bf16 v[64:67], a[56:59], v[116:119], v[64:67]
    ds_read_b128 v[96:99], v159 offset:25088
    v_cndmask_b32 v131, v24, 0, vcc
    v_mfma_f32_16x16x32_bf16 v[68:71], a[60:63], v[116:119], v[68:71]
    ds_read_b128 v[100:103], v159 offset:31232
    buffer_load_dwordx4 v9, s[44:47], s13 offen offset:1024 sc1 lds
    v_mfma_f32_16x16x32_bf16 v[68:71], a[52:55], v[112:115], v[68:71]
    v_add_u32 v10, -65536, v10
    v_mov_b32 v128, 0
    v_mfma_f32_16x16x32_bf16 v[76:79], a[52:55], v[120:123], v[76:79]
    ds_read_b64_tr_b16 a[16:17], v10 offset:0
    v_mov_b32 v129, 0
    v_mfma_f32_16x16x32_bf16 v[76:79], a[60:63], v[124:127], v[76:79]
    ds_read_b64_tr_b16 a[18:19], v10 offset:2048
    buffer_load_dwordx4 v3, s[44:47], s13 offen offset:2048 sc1 lds
    v_mov_b32 v132, 0
    v_mfma_f32_16x16x32_bf16 v[72:75], a[56:59], v[124:127], v[72:75]
    ds_read_b64_tr_b16 a[24:25], v10 offset:4096
    v_mov_b32 v133, 0
    v_mfma_f32_16x16x32_bf16 v[72:75], a[48:51], v[120:123], v[72:75]
    ds_read_b64_tr_b16 a[26:27], v10 offset:6144
    s_waitcnt lgkmcnt(4)
    v_mfma_f32_16x16x32_bf16 v[32:35], a[64:67], v[80:83], v[32:35]
    s_add_u32 m0, s73, 16384
    s_lshl_b32 s14, s86, 18
    v_mfma_f32_16x16x32_bf16 v[32:35], a[72:75], v[84:87], v[32:35]
    ds_read_b128 v[104:107], v159 offset:25344
    v_mfma_f32_16x16x32_bf16 v[36:39], a[76:79], v[84:87], v[36:39]
    ds_read_b128 v[108:111], v159 offset:31488
    buffer_load_dwordx4 v4, s[52:55], s14 offen offset:0 lds
    v_mfma_f32_16x16x32_bf16 v[36:39], a[68:71], v[80:83], v[36:39]
    ds_read_b128 v[112:115], v159 offset:25600
    v_mfma_f32_16x16x32_bf16 v[44:47], a[68:71], v[88:91], v[44:47]
    ds_read_b128 v[116:119], v159 offset:31744
    buffer_load_dwordx4 v5, s[52:55], s14 offen offset:1024 lds
    v_mfma_f32_16x16x32_bf16 v[44:47], a[76:79], v[92:95], v[44:47]
    ds_read_b128 v[120:123], v159 offset:25856
    v_mfma_f32_16x16x32_bf16 v[40:43], a[72:75], v[92:95], v[40:43]
    ds_read_b128 v[124:127], v159 offset:32000
    v_mfma_f32_16x16x32_bf16 v[40:43], a[64:67], v[88:91], v[40:43]
    buffer_load_dwordx4 v6, s[52:55], s14 offen offset:2048 lds
    v_add_u32 v11, -65536, v11
    v_mfma_f32_16x16x32_bf16 v[48:51], a[64:67], v[96:99], v[48:51]
    ds_read_b64_tr_b16 a[20:21], v11 offset:0
    v_mfma_f32_16x16x32_bf16 v[48:51], a[72:75], v[100:103], v[48:51]
    ds_read_b64_tr_b16 a[22:23], v11 offset:2048
    buffer_load_dwordx4 v7, s[52:55], s14 offen offset:3072 lds
    v_mfma_f32_16x16x32_bf16 v[52:55], a[76:79], v[100:103], v[52:55]
    ds_read_b64_tr_b16 a[28:29], v11 offset:4096
    v_mfma_f32_16x16x32_bf16 v[52:55], a[68:71], v[96:99], v[52:55]
    ds_read_b64_tr_b16 a[30:31], v11 offset:6144
    s_waitcnt lgkmcnt(4)
    v_mfma_f32_16x16x32_bf16 v[60:63], a[68:71], v[104:107], v[60:63]
    s_waitcnt vmcnt(18)
    s_barrier
    v_mfma_f32_16x16x32_bf16 v[60:63], a[76:79], v[108:111], v[60:63]
    ds_read_b128 v[80:83], v250 offset:0
    v_mfma_f32_16x16x32_bf16 v[56:59], a[72:75], v[108:111], v[56:59]
    ds_read_b128 v[84:87], v250 offset:6144
    v_mfma_f32_16x16x32_bf16 v[56:59], a[64:67], v[104:107], v[56:59]
    ds_read_b128 v[88:91], v250 offset:256
    v_mfma_f32_16x16x32_bf16 v[64:67], a[64:67], v[112:115], v[64:67]
    ds_read_b128 v[92:95], v250 offset:6400
    v_mfma_f32_16x16x32_bf16 v[64:67], a[72:75], v[116:119], v[64:67]
    ds_read_b128 v[96:99], v250 offset:512
    v_mfma_f32_16x16x32_bf16 v[68:71], a[76:79], v[116:119], v[68:71]
    ds_read_b128 v[100:103], v250 offset:6656
    v_mfma_f32_16x16x32_bf16 v[68:71], a[68:71], v[112:115], v[68:71]
    v_mfma_f32_16x16x32_bf16 v[76:79], a[68:71], v[120:123], v[76:79]
    v_mfma_f32_16x16x32_bf16 v[76:79], a[76:79], v[124:127], v[76:79]
    v_mfma_f32_16x16x32_bf16 v[72:75], a[72:75], v[124:127], v[72:75]
    v_mfma_f32_16x16x32_bf16 v[72:75], a[64:67], v[120:123], v[72:75]
    s_waitcnt lgkmcnt(0)
    v_mfma_f32_16x16x32_bf16 v[32:35], a[80:83], v[80:83], v[32:35]
    v_mfma_f32_16x16x32_bf16 v[32:35], a[88:91], v[84:87], v[32:35]
    ds_read_b128 v[104:107], v250 offset:768
    v_mfma_f32_16x16x32_bf16 v[36:39], a[92:95], v[84:87], v[36:39]
    ds_read_b128 v[108:111], v250 offset:6912
    v_mfma_f32_16x16x32_bf16 v[36:39], a[84:87], v[80:83], v[36:39]
    ds_read_b128 v[112:115], v250 offset:1024
    v_mfma_f32_16x16x32_bf16 v[44:47], a[84:87], v[88:91], v[44:47]
    ds_read_b128 v[116:119], v250 offset:7168
    v_mfma_f32_16x16x32_bf16 v[44:47], a[92:95], v[92:95], v[44:47]
    ds_read_b128 v[120:123], v250 offset:1280
    v_mfma_f32_16x16x32_bf16 v[40:43], a[88:91], v[92:95], v[40:43]
    ds_read_b128 v[124:127], v250 offset:7424
    v_mfma_f32_16x16x32_bf16 v[40:43], a[80:83], v[88:91], v[40:43]
    s_waitcnt vmcnt(13)
    buffer_store_dword v249, v248, s[44:47], s6 offen sc1
    v_mfma_f32_16x16x32_bf16 v[48:51], a[80:83], v[96:99], v[48:51]
    v_mfma_f32_16x16x32_bf16 v[48:51], a[88:91], v[100:103], v[48:51]
    v_mfma_f32_16x16x32_bf16 v[52:55], a[92:95], v[100:103], v[52:55]
    v_mfma_f32_16x16x32_bf16 v[52:55], a[84:87], v[96:99], v[52:55]
    s_waitcnt lgkmcnt(0)
    v_mfma_f32_16x16x32_bf16 v[60:63], a[84:87], v[104:107], v[60:63]
    s_barrier
    v_mfma_f32_16x16x32_bf16 v[60:63], a[92:95], v[108:111], v[60:63]
    ds_read_b128 v[80:83], v250 offset:12288
    v_mfma_f32_16x16x32_bf16 v[56:59], a[88:91], v[108:111], v[56:59]
    ds_read_b128 v[84:87], v250 offset:18432
    v_mfma_f32_16x16x32_bf16 v[56:59], a[80:83], v[104:107], v[56:59]
    ds_read_b128 v[88:91], v250 offset:12544
    v_mfma_f32_16x16x32_bf16 v[64:67], a[80:83], v[112:115], v[64:67]
    ds_read_b128 v[92:95], v250 offset:18688
    v_mfma_f32_16x16x32_bf16 v[64:67], a[88:91], v[116:119], v[64:67]
    ds_read_b128 v[96:99], v250 offset:12800
    v_mfma_f32_16x16x32_bf16 v[68:71], a[92:95], v[116:119], v[68:71]
    ds_read_b128 v[100:103], v250 offset:18944
    v_mfma_f32_16x16x32_bf16 v[68:71], a[84:87], v[112:115], v[68:71]
    v_mfma_f32_16x16x32_bf16 v[76:79], a[84:87], v[120:123], v[76:79]
    v_mfma_f32_16x16x32_bf16 v[76:79], a[92:95], v[124:127], v[76:79]
    v_mfma_f32_16x16x32_bf16 v[72:75], a[88:91], v[124:127], v[72:75]
    v_mfma_f32_16x16x32_bf16 v[72:75], a[80:83], v[120:123], v[72:75]
    s_waitcnt lgkmcnt(0)
    v_mfma_f32_16x16x32_bf16 v[32:35], a[96:99], v[80:83], v[32:35]
    v_mfma_f32_16x16x32_bf16 v[32:35], a[104:107], v[84:87], v[32:35]
    ds_read_b128 v[104:107], v250 offset:13056
L_pl_G_4:
    s_cbranch_execz L_wret
    v_mfma_f32_16x16x32_bf16 v[36:39], a[108:111], v[84:87], v[36:39]
    ds_read_b128 v[108:111], v250 offset:19200
    v_mfma_f32_16x16x32_bf16 v[36:39], a[100:103], v[80:83], v[36:39]
    ds_read_b128 v[112:115], v250 offset:13312
    v_mfma_f32_16x16x32_bf16 v[44:47], a[100:103], v[88:91], v[44:47]
    ds_read_b128 v[116:119], v250 offset:19456
    v_mfma_f32_16x16x32_bf16 v[44:47], a[108:111], v[92:95], v[44:47]
    ds_read_b128 v[120:123], v250 offset:13568
    v_mfma_f32_16x16x32_bf16 v[40:43], a[104:107], v[92:95], v[40:43]
    ds_read_b128 v[124:127], v250 offset:19712
    v_mfma_f32_16x16x32_bf16 v[40:43], a[96:99], v[88:91], v[40:43]
    v_mfma_f32_16x16x32_bf16 v[48:51], a[96:99], v[96:99], v[48:51]
    v_mfma_f32_16x16x32_bf16 v[48:51], a[104:107], v[100:103], v[48:51]
    v_mfma_f32_16x16x32_bf16 v[52:55], a[108:111], v[100:103], v[52:55]
    v_mfma_f32_16x16x32_bf16 v[52:55], a[100:103], v[96:99], v[52:55]
    s_waitcnt lgkmcnt(0)
    v_mfma_f32_16x16x32_bf16 v[60:63], a[100:103], v[104:107], v[60:63]
    s_waitcnt vmcnt(11)
    s_barrier
    v_mfma_f32_16x16x32_bf16 v[60:63], a[108:111], v[108:111], v[60:63]
    ds_read_b128 v[80:83], v250 offset:24576
    s_add_u32 m0, s74, 24576
    s_mul_i32 s13, s76, 90112
    v_mfma_f32_16x16x32_bf16 v[56:59], a[104:107], v[108:111], v[56:59]
    ds_read_b128 v[84:87], v250 offset:30720
    v_mfma_f32_16x16x32_bf16 v[56:59], a[96:99], v[104:107], v[56:59]
    ds_read_b128 v[88:91], v250 offset:24832
    buffer_load_dwordx4 v8, s[44:47], s13 offen offset:0 sc1 lds
    v_mfma_f32_16x16x32_bf16 v[64:67], a[96:99], v[112:115], v[64:67]
    ds_read_b128 v[92:95], v250 offset:30976
    v_mfma_f32_16x16x32_bf16 v[64:67], a[104:107], v[116:119], v[64:67]
    ds_read_b128 v[96:99], v250 offset:25088
    v_mfma_f32_16x16x32_bf16 v[68:71], a[108:111], v[116:119], v[68:71]
    ds_read_b128 v[100:103], v250 offset:31232
    buffer_load_dwordx4 v9, s[44:47], s13 offen offset:1024 sc1 lds
    v_mfma_f32_16x16x32_bf16 v[68:71], a[100:103], v[112:115], v[68:71]
    v_mfma_f32_16x16x32_bf16 v[76:79], a[100:103], v[120:123], v[76:79]
    v_mfma_f32_16x16x32_bf16 v[76:79], a[108:111], v[124:127], v[76:79]
    buffer_load_dwordx4 v3, s[44:47], s13 offen offset:2048 sc1 lds
    v_mfma_f32_16x16x32_bf16 v[72:75], a[104:107], v[124:127], v[72:75]
    v_mfma_f32_16x16x32_bf16 v[72:75], a[96:99], v[120:123], v[72:75]
    s_waitcnt lgkmcnt(0)
    v_mfma_f32_16x16x32_bf16 v[32:35], a[112:115], v[80:83], v[32:35]
    s_add_u32 m0, s74, 36864
    s_mul_i32 s13, s77, 90112
    v_mfma_f32_16x16x32_bf16 v[32:35], a[120:123], v[84:87], v[32:35]
    ds_read_b128 v[104:107], v250 offset:25344
    v_mfma_f32_16x16x32_bf16 v[36:39], a[124:127], v[84:87], v[36:39]
    ds_read_b128 v[108:111], v250 offset:31488
    v_mfma_f32_16x16x32_bf16 v[36:39], a[116:119], v[80:83], v[36:39]
    ds_read_b128 v[112:115], v250 offset:25600
    buffer_load_dwordx4 v8, s[44:47], s13 offen offset:0 sc1 lds
    v_mfma_f32_16x16x32_bf16 v[44:47], a[116:119], v[88:91], v[44:47]
    ds_read_b128 v[116:119], v250 offset:31744
    v_mfma_f32_16x16x32_bf16 v[44:47], a[124:127], v[92:95], v[44:47]
    ds_read_b128 v[120:123], v250 offset:25856
    v_mfma_f32_16x16x32_bf16 v[40:43], a[120:123], v[92:95], v[40:43]
    ds_read_b128 v[124:127], v250 offset:32000
    buffer_load_dwordx4 v9, s[44:47], s13 offen offset:1024 sc1 lds
    v_mfma_f32_16x16x32_bf16 v[40:43], a[112:115], v[88:91], v[40:43]
    v_mfma_f32_16x16x32_bf16 v[48:51], a[112:115], v[96:99], v[48:51]
    v_mfma_f32_16x16x32_bf16 v[48:51], a[120:123], v[100:103], v[48:51]
    buffer_load_dwordx4 v3, s[44:47], s13 offen offset:2048 sc1 lds
    v_mfma_f32_16x16x32_bf16 v[52:55], a[124:127], v[100:103], v[52:55]
    v_mfma_f32_16x16x32_bf16 v[52:55], a[116:119], v[96:99], v[52:55]
    s_waitcnt lgkmcnt(0)
    v_mfma_f32_16x16x32_bf16 v[60:63], a[116:119], v[104:107], v[60:63]
    s_waitcnt vmcnt(14)
    s_barrier
    v_mfma_f32_16x16x32_bf16 v[60:63], a[124:127], v[108:111], v[60:63]
    ds_read_b128 v[80:83], v159 offset:0
    s_add_u32 m0, s74, 49152
    s_mul_i32 s13, s78, 90112
    v_mfma_f32_16x16x32_bf16 v[56:59], a[120:123], v[108:111], v[56:59]
    ds_read_b128 v[84:87], v159 offset:6144
    v_mfma_f32_16x16x32_bf16 v[56:59], a[112:115], v[104:107], v[56:59]
    ds_read_b128 v[88:91], v159 offset:256
    buffer_load_dwordx4 v8, s[44:47], s13 offen offset:0 sc1 lds
    v_mfma_f32_16x16x32_bf16 v[64:67], a[112:115], v[112:115], v[64:67]
    ds_read_b128 v[92:95], v159 offset:6400
    v_mfma_f32_16x16x32_bf16 v[64:67], a[120:123], v[116:119], v[64:67]
    ds_read_b128 v[96:99], v159 offset:512
    v_mfma_f32_16x16x32_bf16 v[68:71], a[124:127], v[116:119], v[68:71]
    ds_read_b128 v[100:103], v159 offset:6656
    buffer_load_dwordx4 v9, s[44:47], s13 offen offset:1024 sc1 lds
    v_mfma_f32_16x16x32_bf16 v[68:71], a[116:119], v[112:115], v[68:71]
    v_mfma_f32_16x16x32_bf16 v[76:79], a[116:119], v[120:123], v[76:79]
    v_mfma_f32_16x16x32_bf16 v[76:79], a[124:127], v[124:127], v[76:79]
    buffer_load_dwordx4 v3, s[44:47], s13 offen offset:2048 sc1 lds
    v_mfma_f32_16x16x32_bf16 v[72:75], a[120:123], v[124:127], v[72:75]
    v_mfma_f32_16x16x32_bf16 v[72:75], a[112:115], v[120:123], v[72:75]
    s_waitcnt lgkmcnt(0)
    v_mfma_f32_16x16x32_bf16 v[32:35], a[128:131], v[80:83], v[32:35]
    s_add_u32 m0, s74, 61440
    s_mul_i32 s13, s79, 90112
    v_mfma_f32_16x16x32_bf16 v[32:35], a[136:139], v[84:87], v[32:35]
    ds_read_b128 v[104:107], v159 offset:768
    v_mfma_f32_16x16x32_bf16 v[36:39], a[140:143], v[84:87], v[36:39]
    ds_read_b128 v[108:111], v159 offset:6912
    v_mfma_f32_16x16x32_bf16 v[36:39], a[132:135], v[80:83], v[36:39]
    ds_read_b128 v[112:115], v159 offset:1024
    buffer_load_dwordx4 v8, s[44:47], s13 offen offset:0 sc1 lds
    v_mfma_f32_16x16x32_bf16 v[44:47], a[132:135], v[88:91], v[44:47]
    ds_read_b128 v[116:119], v159 offset:7168
    v_mfma_f32_16x16x32_bf16 v[44:47], a[140:143], v[92:95], v[44:47]
    ds_read_b128 v[120:123], v159 offset:1280
    v_mfma_f32_16x16x32_bf16 v[40:43], a[136:139], v[92:95], v[40:43]
    ds_read_b128 v[124:127], v159 offset:7424
    buffer_load_dwordx4 v9, s[44:47], s13 offen offset:1024 sc1 lds
    v_mfma_f32_16x16x32_bf16 v[40:43], a[128:131], v[88:91], v[40:43]
    v_mfma_f32_16x16x32_bf16 v[48:51], a[128:131], v[96:99], v[48:51]
    v_mfma_f32_16x16x32_bf16 v[48:51], a[136:139], v[100:103], v[48:51]
    buffer_load_dwordx4 v3, s[44:47], s13 offen offset:2048 sc1 lds
    v_mfma_f32_16x16x32_bf16 v[52:55], a[140:143], v[100:103], v[52:55]
    v_mfma_f32_16x16x32_bf16 v[52:55], a[132:135], v[96:99], v[52:55]
    s_waitcnt lgkmcnt(0)
    v_mfma_f32_16x16x32_bf16 v[60:63], a[132:135], v[104:107], v[60:63]
    s_waitcnt vmcnt(13)
    s_barrier
    v_mfma_f32_16x16x32_bf16 v[60:63], a[140:143], v[108:111], v[60:63]
    ds_read_b128 v[80:83], v159 offset:12288
    s_add_u32 m0, s74, 0
    s_mul_i32 s13, s80, 90112
    v_mfma_f32_16x16x32_bf16 v[56:59], a[136:139], v[108:111], v[56:59]
    ds_read_b128 v[84:87], v159 offset:18432
    v_mfma_f32_16x16x32_bf16 v[56:59], a[128:131], v[104:107], v[56:59]
    ds_read_b128 v[88:91], v159 offset:12544
    buffer_load_dwordx4 v8, s[44:47], s13 offen offset:0 sc1 lds
    v_mfma_f32_16x16x32_bf16 v[64:67], a[128:131], v[112:115], v[64:67]
    ds_read_b128 v[92:95], v159 offset:18688
    v_mfma_f32_16x16x32_bf16 v[64:67], a[136:139], v[116:119], v[64:67]
    ds_read_b128 v[96:99], v159 offset:12800
    buffer_load_dword v29, v28, s[44:47], 0 offen sc1
    v_mfma_f32_16x16x32_bf16 v[68:71], a[140:143], v[116:119], v[68:71]
    ds_read_b128 v[100:103], v159 offset:18944
    buffer_load_dwordx4 v9, s[44:47], s13 offen offset:1024 sc1 lds
    v_mfma_f32_16x16x32_bf16 v[68:71], a[132:135], v[112:115], v[68:71]
    ds_read_b64_tr_b16 a[32:33], v10 offset:16384
    v_mfma_f32_16x16x32_bf16 v[76:79], a[132:135], v[120:123], v[76:79]
    ds_read_b64_tr_b16 a[34:35], v10 offset:18432
    v_mfma_f32_16x16x32_bf16 v[76:79], a[140:143], v[124:127], v[76:79]
    buffer_load_dwordx4 v3, s[44:47], s13 offen offset:2048 sc1 lds
    v_mfma_f32_16x16x32_bf16 v[72:75], a[136:139], v[124:127], v[72:75]
    ds_read_b64_tr_b16 a[40:41], v10 offset:20480
    v_mfma_f32_16x16x32_bf16 v[72:75], a[128:131], v[120:123], v[72:75]
    ds_read_b64_tr_b16 a[42:43], v10 offset:22528
    s_waitcnt lgkmcnt(4)
    v_mfma_f32_16x16x32_bf16 v[32:35], a[144:147], v[80:83], v[32:35]
    s_add_u32 m0, s73, 32768
    s_lshl_b32 s14, s87, 18
    v_mfma_f32_16x16x32_bf16 v[32:35], a[152:155], v[84:87], v[32:35]
    ds_read_b128 v[104:107], v159 offset:13056
    v_mfma_f32_16x16x32_bf16 v[36:39], a[156:159], v[84:87], v[36:39]
    ds_read_b128 v[108:111], v159 offset:19200
    buffer_load_dwordx4 v4, s[52:55], s14 offen offset:0 lds
    v_mfma_f32_16x16x32_bf16 v[36:39], a[148:151], v[80:83], v[36:39]
    ds_read_b128 v[112:115], v159 offset:13312
    v_mfma_f32_16x16x32_bf16 v[44:47], a[148:151], v[88:91], v[44:47]
    ds_read_b128 v[116:119], v159 offset:19456
    buffer_load_dwordx4 v5, s[52:55], s14 offen offset:1024 lds
    v_mfma_f32_16x16x32_bf16 v[44:47], a[156:159], v[92:95], v[44:47]
    ds_read_b128 v[120:123], v159 offset:13568
    v_mfma_f32_16x16x32_bf16 v[40:43], a[152:155], v[92:95], v[40:43]
    ds_read_b128 v[124:127], v159 offset:19712
    v_mfma_f32_16x16x32_bf16 v[40:43], a[144:147], v[88:91], v[40:43]
    ds_read_b64_tr_b16 a[36:37], v11 offset:16384
    buffer_load_dwordx4 v6, s[52:55], s14 offen offset:2048 lds
    v_mfma_f32_16x16x32_bf16 v[48:51], a[144:147], v[96:99], v[48:51]
    ds_read_b64_tr_b16 a[38:39], v11 offset:18432
    v_mfma_f32_16x16x32_bf16 v[48:51], a[152:155], v[100:103], v[48:51]
    buffer_load_dwordx4 v7, s[52:55], s14 offen offset:3072 lds
    v_mfma_f32_16x16x32_bf16 v[52:55], a[156:159], v[100:103], v[52:55]
    ds_read_b64_tr_b16 a[44:45], v11 offset:20480
    v_mfma_f32_16x16x32_bf16 v[52:55], a[148:151], v[96:99], v[52:55]
    ds_read_b64_tr_b16 a[46:47], v11 offset:22528
    s_waitcnt lgkmcnt(4)
    v_mfma_f32_16x16x32_bf16 v[60:63], a[148:151], v[104:107], v[60:63]
    s_waitcnt vmcnt(17)
    s_barrier
    v_mfma_f32_16x16x32_bf16 v[60:63], a[156:159], v[108:111], v[60:63]
    ds_read_b128 v[80:83], v159 offset:24576
    v_mfma_f32_16x16x32_bf16 v[56:59], a[152:155], v[108:111], v[56:59]
    ds_read_b128 v[84:87], v159 offset:30720
    v_mfma_f32_16x16x32_bf16 v[56:59], a[144:147], v[104:107], v[56:59]
    ds_read_b128 v[88:91], v159 offset:24832
    v_mfma_f32_16x16x32_bf16 v[64:67], a[144:147], v[112:115], v[64:67]
    ds_read_b128 v[92:95], v159 offset:30976
    v_mfma_f32_16x16x32_bf16 v[64:67], a[152:155], v[116:119], v[64:67]
    ds_read_b128 v[96:99], v159 offset:25088
    v_mfma_f32_16x16x32_bf16 v[68:71], a[156:159], v[116:119], v[68:71]
    ds_read_b128 v[100:103], v159 offset:31232
    v_mfma_f32_16x16x32_bf16 v[68:71], a[148:151], v[112:115], v[68:71]
    v_mfma_f32_16x16x32_bf16 v[76:79], a[148:151], v[120:123], v[76:79]
    v_mfma_f32_16x16x32_bf16 v[76:79], a[156:159], v[124:127], v[76:79]
    v_mfma_f32_16x16x32_bf16 v[72:75], a[152:155], v[124:127], v[72:75]
    v_mfma_f32_16x16x32_bf16 v[72:75], a[144:147], v[120:123], v[72:75]
    s_waitcnt lgkmcnt(0)
    v_mfma_f32_16x16x32_bf16 v[32:35], a[160:163], v[80:83], v[32:35]
    v_mfma_f32_16x16x32_bf16 v[32:35], a[168:171], v[84:87], v[32:35]
    ds_read_b128 v[104:107], v159 offset:25344
    v_mfma_f32_16x16x32_bf16 v[36:39], a[172:175], v[84:87], v[36:39]
    ds_read_b128 v[108:111], v159 offset:31488
    v_mfma_f32_16x16x32_bf16 v[36:39], a[164:167], v[80:83], v[36:39]
    ds_read_b128 v[112:115], v159 offset:25600
    v_mfma_f32_16x16x32_bf16 v[44:47], a[164:167], v[88:91], v[44:47]
    ds_read_b128 v[116:119], v159 offset:31744
    v_mfma_f32_16x16x32_bf16 v[44:47], a[172:175], v[92:95], v[44:47]
    ds_read_b128 v[120:123], v159 offset:25856
    v_mfma_f32_16x16x32_bf16 v[40:43], a[168:171], v[92:95], v[40:43]
    ds_read_b128 v[124:127], v159 offset:32000
    v_mfma_f32_16x16x32_bf16 v[40:43], a[160:163], v[88:91], v[40:43]
    v_mfma_f32_16x16x32_bf16 v[48:51], a[160:163], v[96:99], v[48:51]
    v_mfma_f32_16x16x32_bf16 v[48:51], a[168:171], v[100:103], v[48:51]
    v_mfma_f32_16x16x32_bf16 v[52:55], a[172:175], v[100:103], v[52:55]
    v_mfma_f32_16x16x32_bf16 v[52:55], a[164:167], v[96:99], v[52:55]
    s_waitcnt lgkmcnt(0)
    v_mfma_f32_16x16x32_bf16 v[60:63], a[164:167], v[104:107], v[60:63]
    s_waitcnt vmcnt(14)
    s_barrier
    v_mfma_f32_16x16x32_bf16 v[60:63], a[172:175], v[108:111], v[60:63]
    ds_read_b128 v[80:83], v250 offset:0
    s_waitcnt vmcnt(6)
    v_mfma_f32_16x16x32_bf16 v[56:59], a[168:171], v[108:111], v[56:59]
    ds_read_b128 v[84:87], v250 offset:6144
    v_cmp_ne_u32 vcc, s68, v29
    v_mfma_f32_16x16x32_bf16 v[56:59], a[160:163], v[104:107], v[56:59]
    ds_read_b128 v[88:91], v250 offset:256
    v_mfma_f32_16x16x32_bf16 v[64:67], a[160:163], v[112:115], v[64:67]
    ds_read_b128 v[92:95], v250 offset:6400
    v_mfma_f32_16x16x32_bf16 v[64:67], a[168:171], v[116:119], v[64:67]
    ds_read_b128 v[96:99], v250 offset:512
    s_cbranch_vccnz L_rs_p5
L_ok_p5:
    v_mfma_f32_16x16x32_bf16 v[68:71], a[172:175], v[116:119], v[68:71]
    ds_read_b128 v[100:103], v250 offset:6656
    buffer_load_dwordx4 v[160:163], v246, s[44:47], s10 offen offset:0 sc1
    v_mfma_f32_16x16x32_bf16 v[68:71], a[164:167], v[112:115], v[68:71]
    v_mfma_f32_16x16x32_bf16 v[76:79], a[164:167], v[120:123], v[76:79]
    v_mfma_f32_16x16x32_bf16 v[76:79], a[172:175], v[124:127], v[76:79]
    buffer_load_dwordx4 v[164:167], v246, s[44:47], s10 offen offset:1024 sc1
    v_mfma_f32_16x16x32_bf16 v[72:75], a[168:171], v[124:127], v[72:75]
    buffer_load_dwordx4 v[168:171], v246, s[44:47], s10 offen offset:2048 sc1
    v_mfma_f32_16x16x32_bf16 v[72:75], a[160:163], v[120:123], v[72:75]
    s_waitcnt lgkmcnt(0)
    v_mfma_f32_16x16x32_bf16 v[32:35], a[176:179], v[80:83], v[32:35]
    v_mfma_f32_16x16x32_bf16 v[32:35], a[184:187], v[84:87], v[32:35]
    ds_read_b128 v[104:107], v250 offset:768
    v_mfma_f32_16x16x32_bf16 v[36:39], a[188:191], v[84:87], v[36:39]
    ds_read_b128 v[108:111], v250 offset:6912
    buffer_load_dwordx4 v[172:175], v247, s[44:47], s10 offen offset:0 sc1
    v_mfma_f32_16x16x32_bf16 v[36:39], a[180:183], v[80:83], v[36:39]
    ds_read_b128 v[112:115], v250 offset:1024
    v_mfma_f32_16x16x32_bf16 v[44:47], a[180:183], v[88:91], v[44:47]
    ds_read_b128 v[116:119], v250 offset:7168
    v_mfma_f32_16x16x32_bf16 v[44:47], a[188:191], v[92:95], v[44:47]
    ds_read_b128 v[120:123], v250 offset:1280
    buffer_load_dwordx4 v[176:179], v247, s[44:47], s10 offen offset:1024 sc1
    v_mfma_f32_16x16x32_bf16 v[40:43], a[184:187], v[92:95], v[40:43]
    ds_read_b128 v[124:127], v250 offset:7424
    v_mfma_f32_16x16x32_bf16 v[40:43], a[176:179], v[88:91], v[40:43]
    v_mfma_f32_16x16x32_bf16 v[48:51], a[176:179], v[96:99], v[48:51]
    v_mfma_f32_16x16x32_bf16 v[48:51], a[184:187], v[100:103], v[48:51]
    v_mfma_f32_16x16x32_bf16 v[52:55], a[188:191], v[100:103], v[52:55]
    buffer_load_dwordx4 v[180:183], v247, s[44:47], s10 offen offset:2048 sc1
    v_mfma_f32_16x16x32_bf16 v[52:55], a[180:183], v[96:99], v[52:55]
    s_waitcnt lgkmcnt(0)
    v_mfma_f32_16x16x32_bf16 v[60:63], a[180:183], v[104:107], v[60:63]
    s_barrier
    v_mfma_f32_16x16x32_bf16 v[60:63], a[188:191], v[108:111], v[60:63]
    ds_read_b128 v[80:83], v250 offset:12288
    s_add_u32 m0, s74, 12288
    s_mul_i32 s13, s81, 90112
    v_mfma_f32_16x16x32_bf16 v[56:59], a[184:187], v[108:111], v[56:59]
    ds_read_b128 v[84:87], v250 offset:18432
    v_mfma_f32_16x16x32_bf16 v[56:59], a[176:179], v[104:107], v[56:59]
    ds_read_b128 v[88:91], v250 offset:12544
    buffer_load_dwordx4 v8, s[44:47], s13 offen offset:0 sc1 lds
    v_mfma_f32_16x16x32_bf16 v[64:67], a[176:179], v[112:115], v[64:67]
    ds_read_b128 v[92:95], v250 offset:18688
    v_mfma_f32_16x16x32_bf16 v[64:67], a[184:187], v[116:119], v[64:67]
    ds_read_b128 v[96:99], v250 offset:12800
    v_mfma_f32_16x16x32_bf16 v[68:71], a[188:191], v[116:119], v[68:71]
    ds_read_b128 v[100:103], v250 offset:18944
    buffer_load_dwordx4 v9, s[44:47], s13 offen offset:1024 sc1 lds
    v_mfma_f32_16x16x32_bf16 v[68:71], a[180:183], v[112:115], v[68:71]
    v_mfma_f32_16x16x32_bf16 v[76:79], a[180:183], v[120:123], v[76:79]
    v_mfma_f32_16x16x32_bf16 v[76:79], a[188:191], v[124:127], v[76:79]
    buffer_load_dwordx4 v3, s[44:47], s13 offen offset:2048 sc1 lds
    v_mfma_f32_16x16x32_bf16 v[72:75], a[184:187], v[124:127], v[72:75]
    v_mfma_f32_16x16x32_bf16 v[72:75], a[176:179], v[120:123], v[72:75]
    s_waitcnt lgkmcnt(0)
    v_mfma_f32_16x16x32_bf16 v[32:35], a[192:195], v[80:83], v[32:35]
    s_add_u32 m0, s73, 49152
    s_lshl_b32 s14, s88, 18
    v_mfma_f32_16x16x32_bf16 v[32:35], a[200:203], v[84:87], v[32:35]
    ds_read_b128 v[104:107], v250 offset:13056
    v_mfma_f32_16x16x32_bf16 v[36:39], a[204:207], v[84:87], v[36:39]
    ds_read_b128 v[108:111], v250 offset:19200
    buffer_load_dwordx4 v4, s[52:55], s14 offen offset:0 lds
    v_mfma_f32_16x16x32_bf16 v[36:39], a[196:199], v[80:83], v[36:39]
    ds_read_b128 v[112:115], v250 offset:13312
    v_mfma_f32_16x16x32_bf16 v[44:47], a[196:199], v[88:91], v[44:47]
    ds_read_b128 v[116:119], v250 offset:19456
    buffer_load_dwordx4 v5, s[52:55], s14 offen offset:1024 lds
    v_mfma_f32_16x16x32_bf16 v[44:47], a[204:207], v[92:95], v[44:47]
    ds_read_b128 v[120:123], v250 offset:13568
    v_mfma_f32_16x16x32_bf16 v[40:43], a[200:203], v[92:95], v[40:43]
    ds_read_b128 v[124:127], v250 offset:19712
    v_mfma_f32_16x16x32_bf16 v[40:43], a[192:195], v[88:91], v[40:43]
    buffer_load_dwordx4 v6, s[52:55], s14 offen offset:2048 lds
    v_mfma_f32_16x16x32_bf16 v[48:51], a[192:195], v[96:99], v[48:51]
    v_mfma_f32_16x16x32_bf16 v[48:51], a[200:203], v[100:103], v[48:51]
    buffer_load_dwordx4 v7, s[52:55], s14 offen offset:3072 lds
    v_mfma_f32_16x16x32_bf16 v[52:55], a[204:207], v[100:103], v[52:55]
    v_mfma_f32_16x16x32_bf16 v[52:55], a[196:199], v[96:99], v[52:55]
    s_waitcnt lgkmcnt(0)
    v_mfma_f32_16x16x32_bf16 v[60:63], a[196:199], v[104:107], v[60:63]
    s_barrier
    v_mfma_f32_16x16x32_bf16 v[60:63], a[204:207], v[108:111], v[60:63]
    ds_read_b128 v[80:83], v250 offset:24576
    v_mfma_f32_16x16x32_bf16 v[56:59], a[200:203], v[108:111], v[56:59]
    ds_read_b128 v[84:87], v250 offset:30720
    v_mfma_f32_16x16x32_bf16 v[56:59], a[192:195], v[104:107], v[56:59]
    ds_read_b128 v[88:91], v250 offset:24832
    v_mfma_f32_16x16x32_bf16 v[64:67], a[192:195], v[112:115], v[64:67]
    ds_read_b128 v[92:95], v250 offset:30976
    v_mfma_f32_16x16x32_bf16 v[64:67], a[200:203], v[116:119], v[64:67]
    ds_read_b128 v[96:99], v250 offset:25088
    v_mfma_f32_16x16x32_bf16 v[68:71], a[204:207], v[116:119], v[68:71]
    ds_read_b128 v[100:103], v250 offset:31232
    v_mfma_f32_16x16x32_bf16 v[68:71], a[196:199], v[112:115], v[68:71]
    v_mfma_f32_16x16x32_bf16 v[76:79], a[196:199], v[120:123], v[76:79]
    v_mfma_f32_16x16x32_bf16 v[76:79], a[204:207], v[124:127], v[76:79]
    v_mfma_f32_16x16x32_bf16 v[72:75], a[200:203], v[124:127], v[72:75]
    v_mfma_f32_16x16x32_bf16 v[72:75], a[192:195], v[120:123], v[72:75]
    s_waitcnt lgkmcnt(0)
    v_mfma_f32_16x16x32_bf16 v[32:35], a[208:211], v[80:83], v[32:35]
    s_add_u32 m0, s73, 65536
    s_lshl_b32 s14, s89, 18
    v_mfma_f32_16x16x32_bf16 v[32:35], a[216:219], v[84:87], v[32:35]
    ds_read_b128 v[104:107], v250 offset:25344
    v_mfma_f32_16x16x32_bf16 v[36:39], a[220:223], v[84:87], v[36:39]
    ds_read_b128 v[108:111], v250 offset:31488
    buffer_load_dwordx4 v4, s[52:55], s14 offen offset:0 lds
    v_mfma_f32_16x16x32_bf16 v[36:39], a[212:215], v[80:83], v[36:39]
    ds_read_b128 v[112:115], v250 offset:25600
    v_mfma_f32_16x16x32_bf16 v[44:47], a[212:215], v[88:91], v[44:47]
    ds_read_b128 v[116:119], v250 offset:31744
    buffer_load_dwordx4 v5, s[52:55], s14 offen offset:1024 lds
    v_mfma_f32_16x16x32_bf16 v[44:47], a[220:223], v[92:95], v[44:47]
    ds_read_b128 v[120:123], v250 offset:25856
    v_mfma_f32_16x16x32_bf16 v[40:43], a[216:219], v[92:95], v[40:43]
    ds_read_b128 v[124:127], v250 offset:32000
    v_mfma_f32_16x16x32_bf16 v[40:43], a[208:211], v[88:91], v[40:43]
    buffer_load_dwordx4 v6, s[52:55], s14 offen offset:2048 lds
    v_mfma_f32_16x16x32_bf16 v[48:51], a[208:211], v[96:99], v[48:51]
    v_mfma_f32_16x16x32_bf16 v[48:51], a[216:219], v[100:103], v[48:51]
    buffer_load_dwordx4 v7, s[52:55], s14 offen offset:3072 lds
    v_mfma_f32_16x16x32_bf16 v[52:55], a[220:223], v[100:103], v[52:55]
    v_mfma_f32_16x16x32_bf16 v[52:55], a[212:215], v[96:99], v[52:55]
    s_waitcnt lgkmcnt(0)
    v_mfma_f32_16x16x32_bf16 v[60:63], a[212:215], v[104:107], v[60:63]
    s_waitcnt vmcnt(17)
    s_barrier
    v_mfma_f32_16x16x32_bf16 v[60:63], a[220:223], v[108:111], v[60:63]
    ds_read_b128 v[80:83], v159 offset:0
    v_mfma_f32_16x16x32_bf16 v[56:59], a[216:219], v[108:111], v[56:59]
    ds_read_b128 v[84:87], v159 offset:6144
    v_mfma_f32_16x16x32_bf16 v[56:59], a[208:211], v[104:107], v[56:59]
    ds_read_b128 v[88:91], v159 offset:256
    v_mfma_f32_16x16x32_bf16 v[64:67], a[208:211], v[112:115], v[64:67]
    ds_read_b128 v[92:95], v159 offset:6400
    v_mfma_f32_16x16x32_bf16 v[64:67], a[216:219], v[116:119], v[64:67]
    ds_read_b128 v[96:99], v159 offset:512
    v_mfma_f32_16x16x32_bf16 v[68:71], a[220:223], v[116:119], v[68:71]
    ds_read_b128 v[100:103], v159 offset:6656
    v_mfma_f32_16x16x32_bf16 v[68:71], a[212:215], v[112:115], v[68:71]
    ds_read_b64_tr_b16 a[48:49], v10 offset:32768
    v_mfma_f32_16x16x32_bf16 v[76:79], a[212:215], v[120:123], v[76:79]
    ds_read_b64_tr_b16 a[50:51], v10 offset:34816
    v_mfma_f32_16x16x32_bf16 v[76:79], a[220:223], v[124:127], v[76:79]
    v_mfma_f32_16x16x32_bf16 v[72:75], a[216:219], v[124:127], v[72:75]
    ds_read_b64_tr_b16 a[56:57], v10 offset:36864
    v_mfma_f32_16x16x32_bf16 v[72:75], a[208:211], v[120:123], v[72:75]
    ds_read_b64_tr_b16 a[58:59], v10 offset:38912
    s_waitcnt lgkmcnt(4)
    v_mfma_f32_16x16x32_bf16 v[32:35], a[224:227], v[80:83], v[32:35]
    s_add_u32 m0, s73, 0
    s_lshl_b32 s14, s90, 18
    v_mfma_f32_16x16x32_bf16 v[32:35], a[232:235], v[84:87], v[32:35]
    ds_read_b128 v[104:107], v159 offset:768
    v_mfma_f32_16x16x32_bf16 v[36:39], a[236:239], v[84:87], v[36:39]
    ds_read_b128 v[108:111], v159 offset:6912
    buffer_load_dwordx4 v4, s[52:55], s14 offen offset:0 lds
    v_mfma_f32_16x16x32_bf16 v[36:39], a[228:231], v[80:83], v[36:39]
    ds_read_b128 v[112:115], v159 offset:1024
    v_mfma_f32_16x16x32_bf16 v[44:47], a[228:231], v[88:91], v[44:47]
    ds_read_b128 v[116:119], v159 offset:7168
    buffer_load_dwordx4 v5, s[52:55], s14 offen offset:1024 lds
    v_mfma_f32_16x16x32_bf16 v[44:47], a[236:239], v[92:95], v[44:47]
    ds_read_b128 v[120:123], v159 offset:1280
    v_mfma_f32_16x16x32_bf16 v[40:43], a[232:235], v[92:95], v[40:43]
    ds_read_b128 v[124:127], v159 offset:7424
    v_mfma_f32_16x16x32_bf16 v[40:43], a[224:227], v[88:91], v[40:43]
    ds_read_b64_tr_b16 a[52:53], v11 offset:32768
    buffer_load_dwordx4 v6, s[52:55], s14 offen offset:2048 lds
    v_mfma_f32_16x16x32_bf16 v[48:51], a[224:227], v[96:99], v[48:51]
    ds_read_b64_tr_b16 a[54:55], v11 offset:34816
    v_mfma_f32_16x16x32_bf16 v[48:51], a[232:235], v[100:103], v[48:51]
    buffer_load_dwordx4 v7, s[52:55], s14 offen offset:3072 lds
    v_mfma_f32_16x16x32_bf16 v[52:55], a[236:239], v[100:103], v[52:55]
    ds_read_b64_tr_b16 a[60:61], v11 offset:36864
    v_mfma_f32_16x16x32_bf16 v[52:55], a[228:231], v[96:99], v[52:55]
    ds_read_b64_tr_b16 a[62:63], v11 offset:38912
    s_waitcnt lgkmcnt(4)
    v_mfma_f32_16x16x32_bf16 v[60:63], a[228:231], v[104:107], v[60:63]
    s_waitcnt vmcnt(12)
    s_barrier
    v_mfma_f32_16x16x32_bf16 v[60:63], a[236:239], v[108:111], v[60:63]
    ds_read_b128 v[80:83], v159 offset:12288
    v_mfma_f32_16x16x32_bf16 v[56:59], a[232:235], v[108:111], v[56:59]
    ds_read_b128 v[84:87], v159 offset:18432
    v_mfma_f32_16x16x32_bf16 v[56:59], a[224:227], v[104:107], v[56:59]
    ds_read_b128 v[88:91], v159 offset:12544
    v_mfma_f32_16x16x32_bf16 v[64:67], a[224:227], v[112:115], v[64:67]
    ds_read_b128 v[92:95], v159 offset:18688
    v_mfma_f32_16x16x32_bf16 v[64:67], a[232:235], v[116:119], v[64:67]
    ds_read_b128 v[96:99], v159 offset:12800
    v_mfma_f32_16x16x32_bf16 v[68:71], a[236:239], v[116:119], v[68:71]
    ds_read_b128 v[100:103], v159 offset:18944
    v_mfma_f32_16x16x32_bf16 v[68:71], a[228:231], v[112:115], v[68:71]
    v_mfma_f32_16x16x32_bf16 v[76:79], a[228:231], v[120:123], v[76:79]
    v_mfma_f32_16x16x32_bf16 v[76:79], a[236:239], v[124:127], v[76:79]
    v_mfma_f32_16x16x32_bf16 v[72:75], a[232:235], v[124:127], v[72:75]
    v_mfma_f32_16x16x32_bf16 v[72:75], a[224:227], v[120:123], v[72:75]
    s_waitcnt lgkmcnt(0)
    v_mfma_f32_16x16x32_bf16 v[32:35], a[240:243], v[80:83], v[32:35]
    s_add_u32 m0, s73, 16384
    s_lshl_b32 s14, s91, 18
    v_mfma_f32_16x16x32_bf16 v[32:35], a[248:251], v[84:87], v[32:35]
    ds_read_b128 v[104:107], v159 offset:13056
    v_mfma_f32_16x16x32_bf16 v[32:35], v[130:133], v[160:163], v[32:35]
    ds_read_b128 v[108:111], v159 offset:19200
    buffer_load_dwordx4 v4, s[52:55], s14 offen offset:0 lds
    v_mfma_f32_16x16x32_bf16 v[36:39], a[252:255], v[84:87], v[36:39]
    ds_read_b128 v[112:115], v159 offset:13312
    v_mfma_f32_16x16x32_bf16 v[36:39], a[244:247], v[80:83], v[36:39]
    ds_read_b128 v[116:119], v159 offset:19456
    buffer_load_dwordx4 v5, s[52:55], s14 offen offset:1024 lds
    v_mfma_f32_16x16x32_bf16 v[36:39], v[128:131], v[160:163], v[36:39]
    ds_read_b128 v[120:123], v159 offset:13568
    v_mfma_f32_16x16x32_bf16 v[44:47], a[244:247], v[88:91], v[44:47]
    ds_read_b128 v[124:127], v159 offset:19712
    v_mfma_f32_16x16x32_bf16 v[44:47], a[252:255], v[92:95], v[44:47]
    buffer_load_dwordx4 v6, s[52:55], s14 offen offset:2048 lds
    v_mfma_f32_16x16x32_bf16 v[44:47], v[128:131], v[164:167], v[44:47]
    v_mfma_f32_16x16x32_bf16 v[40:43], a[248:251], v[92:95], v[40:43]
    buffer_load_dwordx4 v7, s[52:55], s14 offen offset:3072 lds
    v_mfma_f32_16x16x32_bf16 v[40:43], a[240:243], v[88:91], v[40:43]
    v_mfma_f32_16x16x32_bf16 v[40:43], v[130:133], v[164:167], v[40:43]
    v_mfma_f32_16x16x32_bf16 v[48:51], a[240:243], v[96:99], v[48:51]
    v_mfma_f32_16x16x32_bf16 v[48:51], a[248:251], v[100:103], v[48:51]
    v_mfma_f32_16x16x32_bf16 v[48:51], v[130:133], v[168:171], v[48:51]
    v_mfma_f32_16x16x32_bf16 v[52:55], a[252:255], v[100:103], v[52:55]
    v_mfma_f32_16x16x32_bf16 v[52:55], a[244:247], v[96:99], v[52:55]
    v_mfma_f32_16x16x32_bf16 v[52:55], v[128:131], v[168:171], v[52:55]
    s_waitcnt lgkmcnt(0)
    v_mfma_f32_16x16x32_bf16 v[60:63], a[244:247], v[104:107], v[60:63]
    s_barrier
    v_mfma_f32_16x16x32_bf16 v[60:63], a[252:255], v[108:111], v[60:63]
    s_add_u32 m0, s73, 131072
    s_lshl_b32 s14, s92, 18
    v_mfma_f32_16x16x32_bf16 v[60:63], v[128:131], v[172:175], v[60:63]
    buffer_load_dwordx4 v4, s[52:55], s14 offen offset:0 lds
    v_mfma_f32_16x16x32_bf16 v[56:59], a[248:251], v[108:111], v[56:59]
    buffer_load_dwordx4 v5, s[52:55], s14 offen offset:1024 lds
    v_mfma_f32_16x16x32_bf16 v[56:59], a[240:243], v[104:107], v[56:59]
    buffer_load_dwordx4 v6, s[52:55], s14 offen offset:2048 lds
    v_mfma_f32_16x16x32_bf16 v[56:59], v[130:133], v[172:175], v[56:59]
    buffer_load_dwordx4 v7, s[52:55], s14 offen offset:3072 lds
    v_mfma_f32_16x16x32_bf16 v[64:67], a[240:243], v[112:115], v[64:67]
    s_add_u32 m0, s73, 147456
    s_lshl_b32 s14, s93, 18
    v_mfma_f32_16x16x32_bf16 v[64:67], a[248:251], v[116:119], v[64:67]
    buffer_load_dwordx4 v4, s[52:55], s14 offen offset:0 lds
    v_mfma_f32_16x16x32_bf16 v[64:67], v[130:133], v[176:179], v[64:67]
    buffer_load_dwordx4 v5, s[52:55], s14 offen offset:1024 lds
    v_mfma_f32_16x16x32_bf16 v[68:71], a[252:255], v[116:119], v[68:71]
    buffer_load_dwordx4 v6, s[52:55], s14 offen offset:2048 lds
    v_mfma_f32_16x16x32_bf16 v[68:71], a[244:247], v[112:115], v[68:71]
    buffer_load_dwordx4 v7, s[52:55], s14 offen offset:3072 lds
    v_mfma_f32_16x16x32_bf16 v[68:71], v[128:131], v[176:179], v[68:71]
    v_mfma_f32_16x16x32_bf16 v[76:79], a[244:247], v[120:123], v[76:79]
    v_mfma_f32_16x16x32_bf16 v[76:79], a[252:255], v[124:127], v[76:79]
    v_mfma_f32_16x16x32_bf16 v[76:79], v[128:131], v[180:183], v[76:79]
    v_mfma_f32_16x16x32_bf16 v[72:75], a[248:251], v[124:127], v[72:75]
    v_mfma_f32_16x16x32_bf16 v[72:75], a[240:243], v[120:123], v[72:75]
    v_mfma_f32_16x16x32_bf16 v[72:75], v[130:133], v[180:183], v[72:75]
    s_waitcnt lgkmcnt(0)
    v_mov_b32 v88, 0xc0135761
    s_mov_b32 s10, 0xbdd2d3e8
    s_lshl_b32 s9, s69, 2
    s_add_u32 s9, s9, s3
    s_mul_i32 s9, s9, 69632
    s_add_u32 s9, s9, 12795904
    v_pk_mul_f32 v[160:161], v[32:33], v[32:33]
    v_pk_mul_f32 v[162:163], v[34:35], v[34:35]
    v_pk_mul_f32 v[164:165], v[36:37], v[36:37]
    v_pk_mul_f32 v[166:167], v[38:39], v[38:39]
    v_pk_mul_f32 v[168:169], v[40:41], v[40:41]
    v_pk_mul_f32 v[170:171], v[42:43], v[42:43]
    v_pk_mul_f32 v[172:173], v[44:45], v[44:45]
    v_pk_mul_f32 v[174:175], v[46:47], v[46:47]
    v_pk_fma_f32 v[160:161], v[160:161], s[10:11], v[88:89] op_sel_hi:[1,0,0]
    v_pk_fma_f32 v[162:163], v[162:163], s[10:11], v[88:89] op_sel_hi:[1,0,0]
    v_pk_fma_f32 v[164:165], v[164:165], s[10:11], v[88:89] op_sel_hi:[1,0,0]
    v_pk_fma_f32 v[166:167], v[166:167], s[10:11], v[88:89] op_sel_hi:[1,0,0]
    v_pk_fma_f32 v[168:169], v[168:169], s[10:11], v[88:89] op_sel_hi:[1,0,0]
    v_pk_fma_f32 v[170:171], v[170:171], s[10:11], v[88:89] op_sel_hi:[1,0,0]
    v_pk_fma_f32 v[172:173], v[172:173], s[10:11], v[88:89] op_sel_hi:[1,0,0]
    v_pk_fma_f32 v[174:175], v[174:175], s[10:11], v[88:89] op_sel_hi:[1,0,0]
    v_pk_mul_f32 v[160:161], v[160:161], v[32:33]
    v_pk_mul_f32 v[162:163], v[162:163], v[34:35]
    v_pk_mul_f32 v[164:165], v[164:165], v[36:37]
    v_pk_mul_f32 v[166:167], v[166:167], v[38:39]
    v_pk_mul_f32 v[168:169], v[168:169], v[40:41]
    v_pk_mul_f32 v[170:171], v[170:171], v[42:43]
    v_pk_mul_f32 v[172:173], v[172:173], v[44:45]
    v_pk_mul_f32 v[174:175], v[174:175], v[46:47]
    v_exp_f32 v160, v160
    v_exp_f32 v161, v161
    v_exp_f32 v162, v162
    v_exp_f32 v163, v163
    v_exp_f32 v164, v164
    v_exp_f32 v165, v165
    v_exp_f32 v166, v166
    v_exp_f32 v167, v167
    v_exp_f32 v168, v168
    v_exp_f32 v169, v169
    v_exp_f32 v170, v170
    v_exp_f32 v171, v171
    v_exp_f32 v172, v172
    v_exp_f32 v173, v173
    v_exp_f32 v174, v174
    v_exp_f32 v175, v175
    v_pk_add_f32 v[160:161], v[160:161], 1.0 op_sel_hi:[1,0]
L_pl_G_5:
    s_cbranch_execz L_wret
    v_pk_add_f32 v[162:163], v[162:163], 1.0 op_sel_hi:[1,0]
    v_pk_add_f32 v[164:165], v[164:165], 1.0 op_sel_hi:[1,0]
    v_pk_add_f32 v[166:167], v[166:167], 1.0 op_sel_hi:[1,0]
    v_pk_add_f32 v[168:169], v[168:169], 1.0 op_sel_hi:[1,0]
    v_pk_add_f32 v[170:171], v[170:171], 1.0 op_sel_hi:[1,0]
    v_pk_add_f32 v[172:173], v[172:173], 1.0 op_sel_hi:[1,0]
    v_pk_add_f32 v[174:175], v[174:175], 1.0 op_sel_hi:[1,0]
    v_rcp_f32 v160, v160
    v_rcp_f32 v161, v161
    v_rcp_f32 v162, v162
    v_rcp_f32 v163, v163
    v_rcp_f32 v164, v164
    v_rcp_f32 v165, v165
    v_rcp_f32 v166, v166
    v_rcp_f32 v167, v167
    v_rcp_f32 v168, v168
    v_rcp_f32 v169, v169
    v_rcp_f32 v170, v170
    v_rcp_f32 v171, v171
    v_rcp_f32 v172, v172
    v_rcp_f32 v173, v173
    v_rcp_f32 v174, v174
    v_rcp_f32 v175, v175
    v_pk_mul_f32 v[32:33], v[32:33], v[160:161]
    v_pk_mul_f32 v[34:35], v[34:35], v[162:163]
    v_pk_mul_f32 v[36:37], v[36:37], v[164:165]
    v_pk_mul_f32 v[38:39], v[38:39], v[166:167]
    v_pk_mul_f32 v[40:41], v[40:41], v[168:169]
    v_pk_mul_f32 v[42:43], v[42:43], v[170:171]
    v_pk_mul_f32 v[44:45], v[44:45], v[172:173]
    v_pk_mul_f32 v[46:47], v[46:47], v[174:175]
    v_cvt_pk_bf16_f32 v96, v32, v33
    v_cvt_pk_bf16_f32 v97, v34, v35
    v_cvt_pk_bf16_f32 v98, v36, v37
    v_cvt_pk_bf16_f32 v99, v38, v39
    v_cvt_pk_bf16_f32 v100, v40, v41
    v_cvt_pk_bf16_f32 v101, v42, v43
    v_cvt_pk_bf16_f32 v102, v44, v45
    v_cvt_pk_bf16_f32 v103, v46, v47
    buffer_store_dwordx4 v[96:99], v240, s[44:47], s9 offen sc1
    buffer_store_dwordx4 v[100:103], v241, s[44:47], s9 offen sc1
    v_pk_mul_f32 v[160:161], v[48:49], v[48:49]
    v_pk_mul_f32 v[162:163], v[50:51], v[50:51]
    v_pk_mul_f32 v[164:165], v[52:53], v[52:53]
    v_pk_mul_f32 v[166:167], v[54:55], v[54:55]
    v_pk_mul_f32 v[168:169], v[56:57], v[56:57]
    v_pk_mul_f32 v[170:171], v[58:59], v[58:59]
    v_pk_mul_f32 v[172:173], v[60:61], v[60:61]
    v_pk_mul_f32 v[174:175], v[62:63], v[62:63]
    v_pk_fma_f32 v[160:161], v[160:161], s[10:11], v[88:89] op_sel_hi:[1,0,0]
    v_pk_fma_f32 v[162:163], v[162:163], s[10:11], v[88:89] op_sel_hi:[1,0,0]
    v_pk_fma_f32 v[164:165], v[164:165], s[10:11], v[88:89] op_sel_hi:[1,0,0]
    v_pk_fma_f32 v[166:167], v[166:167], s[10:11], v[88:89] op_sel_hi:[1,0,0]
    v_pk_fma_f32 v[168:169], v[168:169], s[10:11], v[88:89] op_sel_hi:[1,0,0]
    v_pk_fma_f32 v[170:171], v[170:171], s[10:11], v[88:89] op_sel_hi:[1,0,0]
    v_pk_fma_f32 v[172:173], v[172:173], s[10:11], v[88:89] op_sel_hi:[1,0,0]
    v_pk_fma_f32 v[174:175], v[174:175], s[10:11], v[88:89] op_sel_hi:[1,0,0]
    v_pk_mul_f32 v[160:161], v[160:161], v[48:49]
    v_pk_mul_f32 v[162:163], v[162:163], v[50:51]
    v_pk_mul_f32 v[164:165], v[164:165], v[52:53]
    v_pk_mul_f32 v[166:167], v[166:167], v[54:55]
    v_pk_mul_f32 v[168:169], v[168:169], v[56:57]
    v_pk_mul_f32 v[170:171], v[170:171], v[58:59]
    v_pk_mul_f32 v[172:173], v[172:173], v[60:61]
    v_pk_mul_f32 v[174:175], v[174:175], v[62:63]
    v_exp_f32 v160, v160
    v_exp_f32 v161, v161
    v_exp_f32 v162, v162
    v_exp_f32 v163, v163
    v_exp_f32 v164, v164
    v_exp_f32 v165, v165
    v_exp_f32 v166, v166
    v_exp_f32 v167, v167
    v_exp_f32 v168, v168
    v_exp_f32 v169, v169
    v_exp_f32 v170, v170
    v_exp_f32 v171, v171
    v_exp_f32 v172, v172
    v_exp_f32 v173, v173
    v_exp_f32 v174, v174
    v_exp_f32 v175, v175
    v_pk_add_f32 v[160:161], v[160:161], 1.0 op_sel_hi:[1,0]
    v_pk_add_f32 v[162:163], v[162:163], 1.0 op_sel_hi:[1,0]
    v_pk_add_f32 v[164:165], v[164:165], 1.0 op_sel_hi:[1,0]
    v_pk_add_f32 v[166:167], v[166:167], 1.0 op_sel_hi:[1,0]
    v_pk_add_f32 v[168:169], v[168:169], 1.0 op_sel_hi:[1,0]
    v_pk_add_f32 v[170:171], v[170:171], 1.0 op_sel_hi:[1,0]
    v_pk_add_f32 v[172:173], v[172:173], 1.0 op_sel_hi:[1,0]
    v_pk_add_f32 v[174:175], v[174:175], 1.0 op_sel_hi:[1,0]
    v_rcp_f32 v160, v160
    v_rcp_f32 v161, v161
    v_rcp_f32 v162, v162
    v_rcp_f32 v163, v163
    v_rcp_f32 v164, v164
    v_rcp_f32 v165, v165
    v_rcp_f32 v166, v166
    v_rcp_f32 v167, v167
    v_rcp_f32 v168, v168
    v_rcp_f32 v169, v169
    v_rcp_f32 v170, v170
    v_rcp_f32 v171, v171
    v_rcp_f32 v172, v172
    v_rcp_f32 v173, v173
    v_rcp_f32 v174, v174
    v_rcp_f32 v175, v175
    v_pk_mul_f32 v[48:49], v[48:49], v[160:161]
    v_pk_mul_f32 v[50:51], v[50:51], v[162:163]
    v_pk_mul_f32 v[52:53], v[52:53], v[164:165]
    v_pk_mul_f32 v[54:55], v[54:55], v[166:167]
    v_pk_mul_f32 v[56:57], v[56:57], v[168:169]
    v_pk_mul_f32 v[58:59], v[58:59], v[170:171]
    v_pk_mul_f32 v[60:61], v[60:61], v[172:173]
    v_pk_mul_f32 v[62:63], v[62:63], v[174:175]
    v_cvt_pk_bf16_f32 v104, v48, v49
    v_cvt_pk_bf16_f32 v105, v50, v51
    v_cvt_pk_bf16_f32 v106, v52, v53
    v_cvt_pk_bf16_f32 v107, v54, v55
    v_cvt_pk_bf16_f32 v108, v56, v57
    v_cvt_pk_bf16_f32 v109, v58, v59
    v_cvt_pk_bf16_f32 v110, v60, v61
    v_cvt_pk_bf16_f32 v111, v62, v63
    buffer_store_dwordx4 v[104:107], v242, s[44:47], s9 offen sc1
    buffer_store_dwordx4 v[108:111], v243, s[44:47], s9 offen sc1
    v_pk_mul_f32 v[160:161], v[64:65], v[64:65]
    v_pk_mul_f32 v[162:163], v[66:67], v[66:67]
    v_pk_mul_f32 v[164:165], v[68:69], v[68:69]
    v_pk_mul_f32 v[166:167], v[70:71], v[70:71]
    v_pk_mul_f32 v[168:169], v[72:73], v[72:73]
    v_pk_mul_f32 v[170:171], v[74:75], v[74:75]
    v_pk_mul_f32 v[172:173], v[76:77], v[76:77]
    v_pk_mul_f32 v[174:175], v[78:79], v[78:79]
    v_pk_fma_f32 v[160:161], v[160:161], s[10:11], v[88:89] op_sel_hi:[1,0,0]
    v_pk_fma_f32 v[162:163], v[162:163], s[10:11], v[88:89] op_sel_hi:[1,0,0]
    v_pk_fma_f32 v[164:165], v[164:165], s[10:11], v[88:89] op_sel_hi:[1,0,0]
    v_pk_fma_f32 v[166:167], v[166:167], s[10:11], v[88:89] op_sel_hi:[1,0,0]
    v_pk_fma_f32 v[168:169], v[168:169], s[10:11], v[88:89] op_sel_hi:[1,0,0]
    v_pk_fma_f32 v[170:171], v[170:171], s[10:11], v[88:89] op_sel_hi:[1,0,0]
    v_pk_fma_f32 v[172:173], v[172:173], s[10:11], v[88:89] op_sel_hi:[1,0,0]
    v_pk_fma_f32 v[174:175], v[174:175], s[10:11], v[88:89] op_sel_hi:[1,0,0]
    v_pk_mul_f32 v[160:161], v[160:161], v[64:65]
    v_pk_mul_f32 v[162:163], v[162:163], v[66:67]
    v_pk_mul_f32 v[164:165], v[164:165], v[68:69]
    v_pk_mul_f32 v[166:167], v[166:167], v[70:71]
    v_pk_mul_f32 v[168:169], v[168:169], v[72:73]
    v_pk_mul_f32 v[170:171], v[170:171], v[74:75]
    v_pk_mul_f32 v[172:173], v[172:173], v[76:77]
    v_pk_mul_f32 v[174:175], v[174:175], v[78:79]
    v_exp_f32 v160, v160
    v_exp_f32 v161, v161
    v_exp_f32 v162, v162
    v_exp_f32 v163, v163
    v_exp_f32 v164, v164
    v_exp_f32 v165, v165
    v_exp_f32 v166, v166
    v_exp_f32 v167, v167
    v_exp_f32 v168, v168
    v_exp_f32 v169, v169
    v_exp_f32 v170, v170
    v_exp_f32 v171, v171
    v_exp_f32 v172, v172
    v_exp_f32 v173, v173
    v_exp_f32 v174, v174
    v_exp_f32 v175, v175
    v_pk_add_f32 v[160:161], v[160:161], 1.0 op_sel_hi:[1,0]
    v_pk_add_f32 v[162:163], v[162:163], 1.0 op_sel_hi:[1,0]
    v_pk_add_f32 v[164:165], v[164:165], 1.0 op_sel_hi:[1,0]
    v_pk_add_f32 v[166:167], v[166:167], 1.0 op_sel_hi:[1,0]
    v_pk_add_f32 v[168:169], v[168:169], 1.0 op_sel_hi:[1,0]
    v_pk_add_f32 v[170:171], v[170:171], 1.0 op_sel_hi:[1,0]
    v_pk_add_f32 v[172:173], v[172:173], 1.0 op_sel_hi:[1,0]
    v_pk_add_f32 v[174:175], v[174:175], 1.0 op_sel_hi:[1,0]
    v_rcp_f32 v160, v160
    v_rcp_f32 v161, v161
    v_rcp_f32 v162, v162
    v_rcp_f32 v163, v163
    v_rcp_f32 v164, v164
    v_rcp_f32 v165, v165
    v_rcp_f32 v166, v166
    v_rcp_f32 v167, v167
    v_rcp_f32 v168, v168
    v_rcp_f32 v169, v169
    v_rcp_f32 v170, v170
    v_rcp_f32 v171, v171
    v_rcp_f32 v172, v172
    v_rcp_f32 v173, v173
    v_rcp_f32 v174, v174
    v_rcp_f32 v175, v175
    v_pk_mul_f32 v[64:65], v[64:65], v[160:161]
    v_pk_mul_f32 v[66:67], v[66:67], v[162:163]
    v_pk_mul_f32 v[68:69], v[68:69], v[164:165]
    v_pk_mul_f32 v[70:71], v[70:71], v[166:167]
    v_pk_mul_f32 v[72:73], v[72:73], v[168:169]
    v_pk_mul_f32 v[74:75], v[74:75], v[170:171]
    v_pk_mul_f32 v[76:77], v[76:77], v[172:173]
    v_pk_mul_f32 v[78:79], v[78:79], v[174:175]
    v_cvt_pk_bf16_f32 v112, v64, v65
    v_cvt_pk_bf16_f32 v113, v66, v67
    v_cvt_pk_bf16_f32 v114, v68, v69
    v_cvt_pk_bf16_f32 v115, v70, v71
    v_cvt_pk_bf16_f32 v116, v72, v73
    v_cvt_pk_bf16_f32 v117, v74, v75
    v_cvt_pk_bf16_f32 v118, v76, v77
    v_cvt_pk_bf16_f32 v119, v78, v79
    buffer_store_dwordx4 v[112:115], v244, s[44:47], s9 offen sc1
    buffer_store_dwordx4 v[116:119], v245, s[44:47], s9 offen sc1
    s_waitcnt vmcnt(6)
    s_barrier
    ds_read_b64_tr_b16 a[64:65], v10 offset:49152
    s_add_u32 m0, s73, 32768
    s_lshl_b32 s14, s94, 18
    ds_read_b64_tr_b16 a[66:67], v10 offset:51200
    ds_read_b64_tr_b16 a[72:73], v10 offset:53248
    ds_read_b64_tr_b16 a[74:75], v10 offset:55296
    ds_read_b64_tr_b16 a[68:69], v11 offset:49152
    buffer_load_dwordx4 v4, s[52:55], s14 offen offset:0 lds
    ds_read_b64_tr_b16 a[70:71], v11 offset:51200
    ds_read_b64_tr_b16 a[76:77], v11 offset:53248
    ds_read_b64_tr_b16 a[78:79], v11 offset:55296
    v_add_u32 v10, 65536, v10
    ds_read_b64_tr_b16 a[80:81], v10 offset:0
    ds_read_b64_tr_b16 a[82:83], v10 offset:2048
    buffer_load_dwordx4 v5, s[52:55], s14 offen offset:1024 lds
    ds_read_b64_tr_b16 a[88:89], v10 offset:4096
    ds_read_b64_tr_b16 a[90:91], v10 offset:6144
    v_add_u32 v11, 65536, v11
    ds_read_b64_tr_b16 a[84:85], v11 offset:0
    ds_read_b64_tr_b16 a[86:87], v11 offset:2048
    ds_read_b64_tr_b16 a[92:93], v11 offset:4096
    buffer_load_dwordx4 v6, s[52:55], s14 offen offset:2048 lds
    ds_read_b64_tr_b16 a[94:95], v11 offset:6144
    v_add_u32 v10, -65536, v10
    ds_read_b64_tr_b16 a[96:97], v10 offset:0
    ds_read_b64_tr_b16 a[98:99], v10 offset:2048
    ds_read_b64_tr_b16 a[104:105], v10 offset:4096
    ds_read_b64_tr_b16 a[106:107], v10 offset:6144
    buffer_load_dwordx4 v7, s[52:55], s14 offen offset:3072 lds
    v_add_u32 v11, -65536, v11
    ds_read_b64_tr_b16 a[100:101], v11 offset:0
    ds_read_b64_tr_b16 a[102:103], v11 offset:2048
    ds_read_b64_tr_b16 a[108:109], v11 offset:4096
    ds_read_b64_tr_b16 a[110:111], v11 offset:6144
    ds_read_b64_tr_b16 a[112:113], v10 offset:16384
    s_add_u32 m0, s73, 81920
    s_lshl_b32 s14, s95, 18
    ds_read_b64_tr_b16 a[114:115], v10 offset:18432
    ds_read_b64_tr_b16 a[120:121], v10 offset:20480
    ds_read_b64_tr_b16 a[122:123], v10 offset:22528
    ds_read_b64_tr_b16 a[116:117], v11 offset:16384
    buffer_load_dwordx4 v4, s[52:55], s14 offen offset:0 lds
    ds_read_b64_tr_b16 a[118:119], v11 offset:18432
    ds_read_b64_tr_b16 a[124:125], v11 offset:20480
    ds_read_b64_tr_b16 a[126:127], v11 offset:22528
    v_add_u32 v10, 131072, v10
    ds_read_b64_tr_b16 a[128:129], v10 offset:0
    ds_read_b64_tr_b16 a[130:131], v10 offset:2048
    buffer_load_dwordx4 v5, s[52:55], s14 offen offset:1024 lds
    ds_read_b64_tr_b16 a[136:137], v10 offset:4096
    ds_read_b64_tr_b16 a[138:139], v10 offset:6144
    v_add_u32 v11, 131072, v11
    ds_read_b64_tr_b16 a[132:133], v11 offset:0
    ds_read_b64_tr_b16 a[134:135], v11 offset:2048
    ds_read_b64_tr_b16 a[140:141], v11 offset:4096
    buffer_load_dwordx4 v6, s[52:55], s14 offen offset:2048 lds
    ds_read_b64_tr_b16 a[142:143], v11 offset:6144
    ds_read_b64_tr_b16 a[144:145], v10 offset:16384
    ds_read_b64_tr_b16 a[146:147], v10 offset:18432
    ds_read_b64_tr_b16 a[152:153], v10 offset:20480
    ds_read_b64_tr_b16 a[154:155], v10 offset:22528
    buffer_load_dwordx4 v7, s[52:55], s14 offen offset:3072 lds
    ds_read_b64_tr_b16 a[148:149], v11 offset:16384
    ds_read_b64_tr_b16 a[150:151], v11 offset:18432
    ds_read_b64_tr_b16 a[156:157], v11 offset:20480
    ds_read_b64_tr_b16 a[158:159], v11 offset:22528
    s_bitcmp1_b32 s3, 1
    s_cselect_b32 s18, s85, s84
    s_mul_i32 s18, s18, 139264
    s_cselect_b32 s19, s87, s86
    s_mul_i32 s19, s19, 139264
    s_cselect_b32 s20, s89, s88
    s_mul_i32 s20, s20, 139264
    s_cselect_b32 s21, s91, s90
    s_mul_i32 s21, s21, 139264
    s_cselect_b32 s22, s93, s92
    s_mul_i32 s22, s22, 139264
    s_cselect_b32 s23, s95, s94
    s_mul_i32 s23, s23, 139264
    s_cselect_b32 s24, s97, s96
    s_mul_i32 s24, s24, 139264
    s_cselect_b32 s25, s99, s98
    s_mul_i32 s25, s25, 139264
    s_cselect_b32 s26, s101, s100
    s_mul_i32 s26, s26, 139264
    s_waitcnt vmcnt(8) lgkmcnt(0)
    s_barrier
    buffer_store_dword v249, v17, s[44:47], 0 offen sc1
    s_add_u32 m0, s73, 0
    s_lshl_b32 s14, s96, 18
    buffer_load_dwordx4 v4, s[52:55], s14 offen offset:0 lds
    buffer_load_dwordx4 v5, s[52:55], s14 offen offset:1024 lds
    buffer_load_dwordx4 v6, s[52:55], s14 offen offset:2048 lds
    buffer_load_dwordx4 v7, s[52:55], s14 offen offset:3072 lds
    s_add_u32 m0, s73, 16384
    s_lshl_b32 s14, s97, 18
    buffer_load_dwordx4 v4, s[52:55], s14 offen offset:0 lds
    buffer_load_dwordx4 v5, s[52:55], s14 offen offset:1024 lds
    buffer_load_dwordx4 v6, s[52:55], s14 offen offset:2048 lds
    buffer_load_dwordx4 v7, s[52:55], s14 offen offset:3072 lds
    v_mov_b32 v16, 0
    buffer_atomic_add v16, v15, s[44:47], 0 offen sc0 sc1
    s_add_u32 m0, s73, 49152
    s_lshl_b32 s14, s98, 18
    buffer_load_dwordx4 v4, s[52:55], s14 offen offset:0 lds
    buffer_load_dwordx4 v5, s[52:55], s14 offen offset:1024 lds
    buffer_load_dwordx4 v6, s[52:55], s14 offen offset:2048 lds
    buffer_load_dwordx4 v7, s[52:55], s14 offen offset:3072 lds
    s_add_u32 m0, s73, 65536
    s_lshl_b32 s14, s99, 18
    buffer_load_dwordx4 v4, s[52:55], s14 offen offset:0 lds
    buffer_load_dwordx4 v5, s[52:55], s14 offen offset:1024 lds
    buffer_load_dwordx4 v6, s[52:55], s14 offen offset:2048 lds
    buffer_load_dwordx4 v7, s[52:55], s14 offen offset:3072 lds
L_DG:
    s_waitcnt vmcnt(8)
    v_cmp_ne_u32 vcc, v13, v16
    s_cbranch_vccnz L_rs_p2G
L_ok_p2G:
    s_barrier
    s_add_u32 m0, s73, 97536
    s_nop 0
    buffer_load_dwordx4 v23, s[44:47], s18 offen offset:768 sc1 lds
    s_add_u32 m0, s73, 99328
    s_nop 0
    buffer_load_dwordx4 v20, s[44:47], s18 offen offset:0 sc1 lds
    s_add_u32 m0, s73, 99840
    s_nop 0
    buffer_load_dwordx4 v20, s[44:47], s18 offen offset:512 sc1 lds
    s_add_u32 m0, s73, 100608
    s_nop 0
    buffer_load_dwordx4 v23, s[44:47], s19 offen offset:768 sc1 lds
    s_add_u32 m0, s73, 114688
    s_nop 0
    buffer_load_dwordx4 v20, s[44:47], s19 offen offset:0 sc1 lds
    s_add_u32 m0, s73, 115200
    s_nop 0
    buffer_load_dwordx4 v20, s[44:47], s19 offen offset:512 sc1 lds
    s_add_u32 m0, s73, 115968
    s_nop 0
    buffer_load_dwordx4 v23, s[44:47], s20 offen offset:768 sc1 lds
    s_add_u32 m0, s73, 117760
    s_nop 0
    buffer_load_dwordx4 v20, s[44:47], s20 offen offset:0 sc1 lds
    s_add_u32 m0, s73, 130560
    s_nop 0
    buffer_load_dwordx4 v20, s[44:47], s20 offen offset:512 sc1 lds
    s_add_u32 m0, s73, 131328
    s_nop 0
    buffer_load_dwordx4 v23, s[44:47], s21 offen offset:768 sc1 lds
    v_mov_b32 v195, s68
    v_mov_b32 v199, s68
    v_mov_b32 v202, s68
    v_mov_b32 v203, s68
    s_waitcnt vmcnt(6)
    s_barrier
    ds_read_b128 v[104:107], v14 offset:0
    ds_read_b128 v[108:111], v14 offset:4096
    ds_read_b128 v[112:115], v14 offset:8192
    ds_read_b128 v[116:119], v14 offset:12288
    s_waitcnt lgkmcnt(2)
    v_mfma_f32_16x16x32_bf16 v[32:35], v[104:107], a[0:3], 0
    s_add_u32 m0, s73, 133120
    v_mfma_f32_16x16x32_bf16 v[32:35], v[108:111], a[8:11], v[32:35]
    buffer_load_dwordx4 v20, s[44:47], s21 offen offset:0 sc1 lds
    s_waitcnt lgkmcnt(0)
    v_mfma_f32_16x16x32_bf16 v[32:35], v[112:115], a[16:19], v[32:35]
    ds_read_b128 v[120:123], v14 offset:1024
    v_mfma_f32_16x16x32_bf16 v[32:35], v[116:119], a[24:27], v[32:35]
    ds_read_b128 v[124:127], v14 offset:5120
    v_mfma_f32_16x16x32_bf16 v[36:39], v[116:119], a[28:31], 0
    ds_read_b128 v[128:131], v14 offset:9216
    v_mfma_f32_16x16x32_bf16 v[36:39], v[112:115], a[20:23], v[36:39]
    ds_read_b128 v[132:135], v14 offset:13312
    v_mfma_f32_16x16x32_bf16 v[36:39], v[108:111], a[12:15], v[36:39]
    s_add_u32 m0, s73, 133632
    v_mfma_f32_16x16x32_bf16 v[36:39], v[104:107], a[4:7], v[36:39]
    buffer_load_dwordx4 v20, s[44:47], s21 offen offset:512 sc1 lds
    s_waitcnt lgkmcnt(2)
    v_mfma_f32_16x16x32_bf16 v[44:47], v[120:123], a[4:7], 0
    s_add_u32 m0, s73, 146688
    v_mfma_f32_16x16x32_bf16 v[44:47], v[124:127], a[12:15], v[44:47]
    buffer_load_dwordx4 v23, s[44:47], s22 offen offset:768 sc1 lds
    s_waitcnt lgkmcnt(0)
    v_mfma_f32_16x16x32_bf16 v[44:47], v[128:131], a[20:23], v[44:47]
    ds_read_b128 v[104:107], v14 offset:2048
    v_mfma_f32_16x16x32_bf16 v[44:47], v[132:135], a[28:31], v[44:47]
    ds_read_b128 v[108:111], v14 offset:6144
    v_mfma_f32_16x16x32_bf16 v[40:43], v[132:135], a[24:27], 0
    ds_read_b128 v[112:115], v14 offset:10240
    v_mfma_f32_16x16x32_bf16 v[40:43], v[128:131], a[16:19], v[40:43]
    ds_read_b128 v[116:119], v14 offset:14336
    v_mfma_f32_16x16x32_bf16 v[40:43], v[124:127], a[8:11], v[40:43]
    s_add_u32 m0, s73, 148480
    v_mfma_f32_16x16x32_bf16 v[40:43], v[120:123], a[0:3], v[40:43]
    buffer_load_dwordx4 v20, s[44:47], s22 offen offset:0 sc1 lds
    s_waitcnt lgkmcnt(2)
    v_mfma_f32_16x16x32_bf16 v[48:51], v[104:107], a[0:3], 0
    s_add_u32 m0, s73, 148992
    v_mfma_f32_16x16x32_bf16 v[48:51], v[108:111], a[8:11], v[48:51]
    buffer_load_dwordx4 v20, s[44:47], s22 offen offset:512 sc1 lds
    s_waitcnt lgkmcnt(0)
    v_mfma_f32_16x16x32_bf16 v[48:51], v[112:115], a[16:19], v[48:51]
    ds_read_b128 v[120:123], v14 offset:3072
    v_mfma_f32_16x16x32_bf16 v[48:51], v[116:119], a[24:27], v[48:51]
    ds_read_b128 v[124:127], v14 offset:7168
    v_mfma_f32_16x16x32_bf16 v[52:55], v[116:119], a[28:31], 0
    ds_read_b128 v[128:131], v14 offset:11264
    v_mfma_f32_16x16x32_bf16 v[52:55], v[112:115], a[20:23], v[52:55]
    ds_read_b128 v[132:135], v14 offset:15360
    v_mfma_f32_16x16x32_bf16 v[52:55], v[108:111], a[12:15], v[52:55]
    s_add_u32 m0, s73, 149760
    v_mfma_f32_16x16x32_bf16 v[52:55], v[104:107], a[4:7], v[52:55]
    buffer_load_dwordx4 v23, s[44:47], s23 offen offset:768 sc1 lds
    s_waitcnt lgkmcnt(2)
    v_mfma_f32_16x16x32_bf16 v[36:39], v[120:123], a[36:39], v[36:39]
    v_mfma_f32_16x16x32_bf16 v[36:39], v[124:127], a[44:47], v[36:39]
    s_waitcnt lgkmcnt(0)
    v_mfma_f32_16x16x32_bf16 v[36:39], v[128:131], a[52:55], v[36:39]
    s_waitcnt vmcnt(8)
    s_barrier
    v_mfma_f32_16x16x32_bf16 v[36:39], v[132:135], a[60:63], v[36:39]
    ds_read_b128 v[104:107], v14 offset:16384
    v_add_u32 v10, -131072, v10
    v_mfma_f32_16x16x32_bf16 v[32:35], v[132:135], a[56:59], v[32:35]
    ds_read_b128 v[108:111], v14 offset:20480
    v_mfma_f32_16x16x32_bf16 v[32:35], v[128:131], a[48:51], v[32:35]
    ds_read_b128 v[112:115], v14 offset:24576
    ds_read_b64_tr_b16 a[160:161], v10 offset:32768
    v_mfma_f32_16x16x32_bf16 v[32:35], v[124:127], a[40:43], v[32:35]
    ds_read_b128 v[116:119], v14 offset:28672
    v_mfma_f32_16x16x32_bf16 v[32:35], v[120:123], a[32:35], v[32:35]
    ds_read_b64_tr_b16 a[162:163], v10 offset:34816
    s_waitcnt lgkmcnt(4)
    v_mfma_f32_16x16x32_bf16 v[40:43], v[104:107], a[32:35], v[40:43]
    s_add_u32 m0, s73, 98304
    ds_read_b64_tr_b16 a[168:169], v10 offset:36864
    v_mfma_f32_16x16x32_bf16 v[40:43], v[108:111], a[40:43], v[40:43]
    buffer_load_dwordx4 v20, s[44:47], s23 offen offset:0 sc1 lds
    ds_read_b64_tr_b16 a[170:171], v10 offset:38912
    s_waitcnt lgkmcnt(3)
    v_mfma_f32_16x16x32_bf16 v[40:43], v[112:115], a[48:51], v[40:43]
    ds_read_b128 v[120:123], v14 offset:17408
    v_mfma_f32_16x16x32_bf16 v[40:43], v[116:119], a[56:59], v[40:43]
    ds_read_b128 v[124:127], v14 offset:21504
    v_add_u32 v11, -131072, v11
    v_mfma_f32_16x16x32_bf16 v[44:47], v[116:119], a[60:63], v[44:47]
    ds_read_b128 v[128:131], v14 offset:25600
    v_mfma_f32_16x16x32_bf16 v[44:47], v[112:115], a[52:55], v[44:47]
    ds_read_b128 v[132:135], v14 offset:29696
    v_mfma_f32_16x16x32_bf16 v[44:47], v[108:111], a[44:47], v[44:47]
    s_add_u32 m0, s73, 98816
    ds_read_b64_tr_b16 a[164:165], v11 offset:32768
    v_mfma_f32_16x16x32_bf16 v[44:47], v[104:107], a[36:39], v[44:47]
    buffer_load_dwordx4 v20, s[44:47], s23 offen offset:512 sc1 lds
    ds_read_b64_tr_b16 a[166:167], v11 offset:34816
    s_waitcnt lgkmcnt(4)
    v_mfma_f32_16x16x32_bf16 v[52:55], v[120:123], a[36:39], v[52:55]
    s_add_u32 m0, s73, 99584
    ds_read_b64_tr_b16 a[172:173], v11 offset:36864
    v_mfma_f32_16x16x32_bf16 v[52:55], v[124:127], a[44:47], v[52:55]
    buffer_load_dwordx4 v23, s[44:47], s24 offen offset:768 sc1 lds
    ds_read_b64_tr_b16 a[174:175], v11 offset:38912
    s_waitcnt lgkmcnt(4)
    v_mfma_f32_16x16x32_bf16 v[52:55], v[128:131], a[52:55], v[52:55]
    ds_read_b128 v[104:107], v14 offset:18432
    v_mfma_f32_16x16x32_bf16 v[52:55], v[132:135], a[60:63], v[52:55]
    ds_read_b128 v[108:111], v14 offset:22528
    v_add_u32 v10, 65536, v10
    v_mfma_f32_16x16x32_bf16 v[48:51], v[132:135], a[56:59], v[48:51]
    ds_read_b128 v[112:115], v14 offset:26624
    v_mfma_f32_16x16x32_bf16 v[48:51], v[128:131], a[48:51], v[48:51]
    ds_read_b128 v[116:119], v14 offset:30720
    v_mfma_f32_16x16x32_bf16 v[48:51], v[124:127], a[40:43], v[48:51]
    s_add_u32 m0, s73, 101376
    ds_read_b64_tr_b16 a[176:177], v10 offset:16384
    v_mfma_f32_16x16x32_bf16 v[48:51], v[120:123], a[32:35], v[48:51]
    buffer_load_dwordx4 v20, s[44:47], s24 offen offset:0 sc1 lds
    ds_read_b64_tr_b16 a[178:179], v10 offset:18432
    s_waitcnt lgkmcnt(4)
    v_mfma_f32_16x16x32_bf16 v[32:35], v[104:107], a[64:67], v[32:35]
    ds_read_b64_tr_b16 a[184:185], v10 offset:20480
    v_mfma_f32_16x16x32_bf16 v[32:35], v[108:111], a[72:75], v[32:35]
    ds_read_b64_tr_b16 a[186:187], v10 offset:22528
    s_waitcnt lgkmcnt(4)
    v_mfma_f32_16x16x32_bf16 v[32:35], v[112:115], a[80:83], v[32:35]
    ds_read_b128 v[120:123], v14 offset:19456
    v_mfma_f32_16x16x32_bf16 v[32:35], v[116:119], a[88:91], v[32:35]
    ds_read_b128 v[124:127], v14 offset:23552
    v_add_u32 v11, 65536, v11
    v_mfma_f32_16x16x32_bf16 v[36:39], v[116:119], a[92:95], v[36:39]
    ds_read_b128 v[128:131], v14 offset:27648
    v_mfma_f32_16x16x32_bf16 v[36:39], v[112:115], a[84:87], v[36:39]
    ds_read_b128 v[132:135], v14 offset:31744
    v_mfma_f32_16x16x32_bf16 v[36:39], v[108:111], a[76:79], v[36:39]
    ds_read_b64_tr_b16 a[180:181], v11 offset:16384
    v_mfma_f32_16x16x32_bf16 v[36:39], v[104:107], a[68:71], v[36:39]
    ds_read_b64_tr_b16 a[182:183], v11 offset:18432
    s_waitcnt lgkmcnt(4)
    v_mfma_f32_16x16x32_bf16 v[44:47], v[120:123], a[68:71], v[44:47]
    ds_read_b64_tr_b16 a[188:189], v11 offset:20480
    v_mfma_f32_16x16x32_bf16 v[44:47], v[124:127], a[76:79], v[44:47]
    ds_read_b64_tr_b16 a[190:191], v11 offset:22528
    s_waitcnt lgkmcnt(4)
    v_mfma_f32_16x16x32_bf16 v[44:47], v[128:131], a[84:87], v[44:47]
    s_waitcnt vmcnt(8) lgkmcnt(0)
    s_barrier
    v_mfma_f32_16x16x32_bf16 v[44:47], v[132:135], a[92:95], v[44:47]
    ds_read_b128 v[104:107], v14 offset:32768
    s_lshl_b32 s14, s100, 18
    s_add_u32 m0, s73, 32768
    v_add_u32 v10, -65536, v10
    v_mfma_f32_16x16x32_bf16 v[40:43], v[132:135], a[88:91], v[40:43]
    ds_read_b128 v[108:111], v14 offset:36864
    buffer_load_dwordx4 v4, s[52:55], s14 offen offset:0 lds
    v_mfma_f32_16x16x32_bf16 v[40:43], v[128:131], a[80:83], v[40:43]
    ds_read_b128 v[112:115], v14 offset:40960
    ds_read_b64_tr_b16 a[192:193], v10 offset:0
    v_mfma_f32_16x16x32_bf16 v[40:43], v[124:127], a[72:75], v[40:43]
    ds_read_b128 v[116:119], v14 offset:45056
    v_mfma_f32_16x16x32_bf16 v[40:43], v[120:123], a[64:67], v[40:43]
    ds_read_b64_tr_b16 a[194:195], v10 offset:2048
    s_waitcnt lgkmcnt(4)
    v_mfma_f32_16x16x32_bf16 v[48:51], v[104:107], a[64:67], v[48:51]
    s_add_u32 m0, s73, 114176
    ds_read_b64_tr_b16 a[200:201], v10 offset:4096
    v_mfma_f32_16x16x32_bf16 v[48:51], v[108:111], a[72:75], v[48:51]
    buffer_load_dwordx4 v20, s[44:47], s24 offen offset:512 sc1 lds
    ds_read_b64_tr_b16 a[202:203], v10 offset:6144
    s_waitcnt lgkmcnt(3)
    v_mfma_f32_16x16x32_bf16 v[48:51], v[112:115], a[80:83], v[48:51]
    ds_read_b128 v[120:123], v14 offset:33792
    s_add_u32 m0, s73, 32768
    v_lshrrev_b32 v30, 2, v26
    v_mfma_f32_16x16x32_bf16 v[48:51], v[116:119], a[88:91], v[48:51]
    ds_read_b128 v[124:127], v14 offset:37888
    buffer_load_dwordx4 v5, s[52:55], s14 offen offset:1024 lds
    v_mfma_f32_16x16x32_bf16 v[52:55], v[116:119], a[92:95], v[52:55]
    ds_read_b128 v[128:131], v14 offset:41984
    v_add_u32 v11, -65536, v11
    v_mfma_f32_16x16x32_bf16 v[52:55], v[112:115], a[84:87], v[52:55]
    ds_read_b128 v[132:135], v14 offset:46080
    v_mfma_f32_16x16x32_bf16 v[52:55], v[108:111], a[76:79], v[52:55]
    s_add_u32 m0, s73, 114944
    ds_read_b64_tr_b16 a[196:197], v11 offset:0
    v_mfma_f32_16x16x32_bf16 v[52:55], v[104:107], a[68:71], v[52:55]
    buffer_load_dwordx4 v23, s[44:47], s25 offen offset:768 sc1 lds
    ds_read_b64_tr_b16 a[198:199], v11 offset:2048
    s_waitcnt lgkmcnt(4)
    v_mfma_f32_16x16x32_bf16 v[36:39], v[120:123], a[100:103], v[36:39]
    s_add_u32 m0, s73, 116736
    ds_read_b64_tr_b16 a[204:205], v11 offset:4096
    v_mfma_f32_16x16x32_bf16 v[36:39], v[124:127], a[108:111], v[36:39]
    buffer_load_dwordx4 v20, s[44:47], s25 offen offset:0 sc1 lds
    ds_read_b64_tr_b16 a[206:207], v11 offset:6144
    s_waitcnt lgkmcnt(4)
    v_mfma_f32_16x16x32_bf16 v[36:39], v[128:131], a[116:119], v[36:39]
    ds_read_b128 v[104:107], v14 offset:34816
    s_add_u32 m0, s73, 32768
    v_lshrrev_b32 v31, 2, v18
    v_mfma_f32_16x16x32_bf16 v[36:39], v[132:135], a[124:127], v[36:39]
    ds_read_b128 v[108:111], v14 offset:38912
    buffer_load_dwordx4 v6, s[52:55], s14 offen offset:2048 lds
    v_mfma_f32_16x16x32_bf16 v[32:35], v[132:135], a[120:123], v[32:35]
    ds_read_b128 v[112:115], v14 offset:43008
    v_mfma_f32_16x16x32_bf16 v[32:35], v[128:131], a[112:115], v[32:35]
    ds_read_b128 v[116:119], v14 offset:47104
    v_mfma_f32_16x16x32_bf16 v[32:35], v[124:127], a[104:107], v[32:35]
    s_add_u32 m0, s73, 117248
    ds_read_b64_tr_b16 a[208:209], v10 offset:16384
    v_mfma_f32_16x16x32_bf16 v[32:35], v[120:123], a[96:99], v[32:35]
    buffer_load_dwordx4 v20, s[44:47], s25 offen offset:512 sc1 lds
    ds_read_b64_tr_b16 a[210:211], v10 offset:18432
    s_waitcnt lgkmcnt(4)
    v_mfma_f32_16x16x32_bf16 v[40:43], v[104:107], a[96:99], v[40:43]
    ds_read_b64_tr_b16 a[216:217], v10 offset:20480
    buffer_load_ushort v102, v30, s[60:63], 0 offen offset:0
    s_add_u32 m0, s73, 32768
    v_mfma_f32_16x16x32_bf16 v[40:43], v[108:111], a[104:107], v[40:43]
    ds_read_b64_tr_b16 a[218:219], v10 offset:22528
    buffer_load_dwordx4 v7, s[52:55], s14 offen offset:3072 lds
    s_waitcnt lgkmcnt(4)
L_pl_G_6:
    s_cbranch_execz L_wret
    v_mfma_f32_16x16x32_bf16 v[40:43], v[112:115], a[112:115], v[40:43]
    ds_read_b128 v[120:123], v14 offset:35840
    v_mfma_f32_16x16x32_bf16 v[40:43], v[116:119], a[120:123], v[40:43]
    ds_read_b128 v[124:127], v14 offset:39936
    v_mfma_f32_16x16x32_bf16 v[44:47], v[116:119], a[124:127], v[44:47]
    ds_read_b128 v[128:131], v14 offset:44032
    v_mfma_f32_16x16x32_bf16 v[44:47], v[112:115], a[116:119], v[44:47]
    ds_read_b128 v[132:135], v14 offset:48128
    v_mfma_f32_16x16x32_bf16 v[44:47], v[108:111], a[108:111], v[44:47]
    ds_read_b64_tr_b16 a[212:213], v11 offset:16384
    buffer_load_ushort v103, v30, s[60:63], 0 offen offset:32
    v_mfma_f32_16x16x32_bf16 v[44:47], v[104:107], a[100:103], v[44:47]
    ds_read_b64_tr_b16 a[214:215], v11 offset:18432
    s_waitcnt lgkmcnt(4)
    v_mfma_f32_16x16x32_bf16 v[52:55], v[120:123], a[100:103], v[52:55]
    ds_read_b64_tr_b16 a[220:221], v11 offset:20480
    v_mfma_f32_16x16x32_bf16 v[52:55], v[124:127], a[108:111], v[52:55]
    ds_read_b64_tr_b16 a[222:223], v11 offset:22528
    s_waitcnt lgkmcnt(4)
    v_mfma_f32_16x16x32_bf16 v[52:55], v[128:131], a[116:119], v[52:55]
    s_waitcnt vmcnt(14) lgkmcnt(0)
    s_barrier
    v_mfma_f32_16x16x32_bf16 v[52:55], v[132:135], a[124:127], v[52:55]
    ds_read_b128 v[104:107], v14 offset:49152
    s_lshl_b32 s14, s101, 18
    ds_read_b64_tr_b16 a[224:225], v10 offset:49152
    s_add_u32 m0, s73, 81920
    v_mfma_f32_16x16x32_bf16 v[48:51], v[132:135], a[120:123], v[48:51]
    ds_read_b128 v[108:111], v14 offset:53248
    buffer_load_dwordx4 v4, s[52:55], s14 offen offset:0 lds
    v_mfma_f32_16x16x32_bf16 v[48:51], v[128:131], a[112:115], v[48:51]
    ds_read_b128 v[112:115], v14 offset:57344
    buffer_load_ushort v27, v31, s[60:63], 0 offen offset:0
    v_mfma_f32_16x16x32_bf16 v[48:51], v[124:127], a[104:107], v[48:51]
    ds_read_b128 v[116:119], v14 offset:61440
    v_mfma_f32_16x16x32_bf16 v[48:51], v[120:123], a[96:99], v[48:51]
    ds_read_b64_tr_b16 a[226:227], v10 offset:51200
    s_waitcnt lgkmcnt(3)
    v_mfma_f32_16x16x32_bf16 v[32:35], v[104:107], a[128:131], v[32:35]
    s_add_u32 m0, s73, 130304
    ds_read_b64_tr_b16 a[232:233], v10 offset:53248
    v_mfma_f32_16x16x32_bf16 v[32:35], v[108:111], a[136:139], v[32:35]
    buffer_load_dwordx4 v23, s[44:47], s26 offen offset:768 sc1 lds
    ds_read_b64_tr_b16 a[234:235], v10 offset:55296
    s_waitcnt lgkmcnt(3)
    v_mfma_f32_16x16x32_bf16 v[32:35], v[112:115], a[144:147], v[32:35]
    ds_read_b128 v[120:123], v14 offset:50176
    s_add_u32 m0, s73, 81920
    v_mfma_f32_16x16x32_bf16 v[32:35], v[116:119], a[152:155], v[32:35]
    ds_read_b128 v[124:127], v14 offset:54272
    buffer_load_dwordx4 v5, s[52:55], s14 offen offset:1024 lds
    v_mfma_f32_16x16x32_bf16 v[36:39], v[116:119], a[156:159], v[36:39]
    ds_read_b128 v[128:131], v14 offset:58368
    v_mfma_f32_16x16x32_bf16 v[36:39], v[112:115], a[148:151], v[36:39]
    ds_read_b128 v[132:135], v14 offset:62464
    v_mfma_f32_16x16x32_bf16 v[36:39], v[108:111], a[140:143], v[36:39]
    s_add_u32 m0, s73, 132096
    ds_read_b64_tr_b16 a[228:229], v11 offset:49152
    v_mfma_f32_16x16x32_bf16 v[36:39], v[104:107], a[132:135], v[36:39]
    buffer_load_dwordx4 v20, s[44:47], s26 offen offset:0 sc1 lds
    ds_read_b64_tr_b16 a[230:231], v11 offset:51200
    s_waitcnt lgkmcnt(4)
    v_mfma_f32_16x16x32_bf16 v[44:47], v[120:123], a[132:135], v[44:47]
    s_add_u32 m0, s73, 132608
    ds_read_b64_tr_b16 a[236:237], v11 offset:53248
    v_mfma_f32_16x16x32_bf16 v[44:47], v[124:127], a[140:143], v[44:47]
    buffer_load_dwordx4 v20, s[44:47], s26 offen offset:512 sc1 lds
    ds_read_b64_tr_b16 a[238:239], v11 offset:55296
    s_waitcnt lgkmcnt(4)
    v_mfma_f32_16x16x32_bf16 v[44:47], v[128:131], a[148:151], v[44:47]
    ds_read_b128 v[104:107], v14 offset:51200
    s_add_u32 m0, s73, 81920
    v_add_u32 v10, 65536, v10
    v_mfma_f32_16x16x32_bf16 v[44:47], v[132:135], a[156:159], v[44:47]
    ds_read_b128 v[108:111], v14 offset:55296
    buffer_load_dwordx4 v6, s[52:55], s14 offen offset:2048 lds
    v_mfma_f32_16x16x32_bf16 v[40:43], v[132:135], a[152:155], v[40:43]
    ds_read_b128 v[112:115], v14 offset:59392
    v_mfma_f32_16x16x32_bf16 v[40:43], v[128:131], a[144:147], v[40:43]
    ds_read_b128 v[116:119], v14 offset:63488
    v_mfma_f32_16x16x32_bf16 v[40:43], v[124:127], a[136:139], v[40:43]
    s_add_u32 m0, s73, 134144
    ds_read_b64_tr_b16 a[240:241], v10 offset:0
    v_mfma_f32_16x16x32_bf16 v[40:43], v[120:123], a[128:131], v[40:43]
    buffer_load_dwordx4 v21, s[44:47], s18 offen offset:0 sc1 lds
    ds_read_b64_tr_b16 a[242:243], v10 offset:2048
    s_waitcnt lgkmcnt(4)
    v_mfma_f32_16x16x32_bf16 v[48:51], v[104:107], a[128:131], v[48:51]
    ds_read_b64_tr_b16 a[248:249], v10 offset:4096
    s_add_u32 m0, s73, 81920
    v_mfma_f32_16x16x32_bf16 v[48:51], v[108:111], a[136:139], v[48:51]
    ds_read_b64_tr_b16 a[250:251], v10 offset:6144
    buffer_load_dwordx4 v7, s[52:55], s14 offen offset:3072 lds
    s_waitcnt lgkmcnt(4)
    v_mfma_f32_16x16x32_bf16 v[48:51], v[112:115], a[144:147], v[48:51]
    ds_read_b128 v[120:123], v14 offset:52224
    v_add_u32 v11, 65536, v11
    v_mfma_f32_16x16x32_bf16 v[48:51], v[116:119], a[152:155], v[48:51]
    ds_read_b128 v[124:127], v14 offset:56320
    v_mfma_f32_16x16x32_bf16 v[52:55], v[116:119], a[156:159], v[52:55]
    ds_read_b128 v[128:131], v14 offset:60416
    v_mfma_f32_16x16x32_bf16 v[52:55], v[112:115], a[148:151], v[52:55]
    ds_read_b128 v[132:135], v14 offset:64512
    v_mfma_f32_16x16x32_bf16 v[52:55], v[108:111], a[140:143], v[52:55]
    ds_read_b64_tr_b16 a[244:245], v11 offset:0
    v_mfma_f32_16x16x32_bf16 v[52:55], v[104:107], a[132:135], v[52:55]
    ds_read_b64_tr_b16 a[246:247], v11 offset:2048
    s_waitcnt lgkmcnt(4)
    v_mfma_f32_16x16x32_bf16 v[36:39], v[120:123], a[164:167], v[36:39]
    ds_read_b64_tr_b16 a[252:253], v11 offset:4096
    v_mfma_f32_16x16x32_bf16 v[36:39], v[124:127], a[172:175], v[36:39]
    ds_read_b64_tr_b16 a[254:255], v11 offset:6144
    s_waitcnt lgkmcnt(4)
    v_mfma_f32_16x16x32_bf16 v[36:39], v[128:131], a[180:183], v[36:39]
    s_waitcnt vmcnt(10) lgkmcnt(0)
    s_barrier
    v_mfma_f32_16x16x32_bf16 v[36:39], v[132:135], a[188:191], v[36:39]
    ds_read_b128 v[104:107], v14 offset:0
    v_mfma_f32_16x16x32_bf16 v[32:35], v[132:135], a[184:187], v[32:35]
    ds_read_b128 v[108:111], v14 offset:4096
    v_add_u32 v10, -65536, v10
    v_mfma_f32_16x16x32_bf16 v[32:35], v[128:131], a[176:179], v[32:35]
    ds_read_b128 v[112:115], v14 offset:8192
    v_mfma_f32_16x16x32_bf16 v[32:35], v[124:127], a[168:171], v[32:35]
    ds_read_b128 v[116:119], v14 offset:12288
    v_mfma_f32_16x16x32_bf16 v[32:35], v[120:123], a[160:163], v[32:35]
    ds_read_b64_tr_b16 v[220:221], v10 offset:32768
    s_waitcnt lgkmcnt(3)
    v_mfma_f32_16x16x32_bf16 v[40:43], v[104:107], a[160:163], v[40:43]
    s_add_u32 m0, s73, 146944
    v_mfma_f32_16x16x32_bf16 v[40:43], v[108:111], a[168:171], v[40:43]
    buffer_load_dwordx4 v21, s[44:47], s18 offen offset:512 sc1 lds
    ds_read_b64_tr_b16 v[222:223], v10 offset:34816
    s_waitcnt lgkmcnt(2)
    v_mfma_f32_16x16x32_bf16 v[40:43], v[112:115], a[176:179], v[40:43]
    ds_read_b128 v[120:123], v14 offset:1024
    v_mfma_f32_16x16x32_bf16 v[40:43], v[116:119], a[184:187], v[40:43]
    ds_read_b128 v[124:127], v14 offset:5120
    v_mfma_f32_16x16x32_bf16 v[44:47], v[116:119], a[188:191], v[44:47]
    ds_read_b128 v[128:131], v14 offset:9216
    v_mfma_f32_16x16x32_bf16 v[44:47], v[112:115], a[180:183], v[44:47]
    ds_read_b128 v[132:135], v14 offset:13312
    buffer_load_dwordx4 v[88:91], v252, s[56:59], 0 offen
    v_mfma_f32_16x16x32_bf16 v[44:47], v[108:111], a[172:175], v[44:47]
    s_add_u32 m0, s73, 148480
    ds_read_b64_tr_b16 v[228:229], v10 offset:36864
    v_mfma_f32_16x16x32_bf16 v[44:47], v[104:107], a[164:167], v[44:47]
    buffer_load_dwordx4 v21, s[44:47], s19 offen offset:0 sc1 lds
    s_waitcnt lgkmcnt(3)
    v_mfma_f32_16x16x32_bf16 v[52:55], v[120:123], a[164:167], v[52:55]
    s_add_u32 m0, s73, 148992
    ds_read_b64_tr_b16 v[230:231], v10 offset:38912
    v_mfma_f32_16x16x32_bf16 v[52:55], v[124:127], a[172:175], v[52:55]
    buffer_load_dwordx4 v21, s[44:47], s19 offen offset:512 sc1 lds
    s_waitcnt lgkmcnt(2)
    v_mfma_f32_16x16x32_bf16 v[52:55], v[128:131], a[180:183], v[52:55]
    ds_read_b128 v[104:107], v14 offset:2048
    v_mfma_f32_16x16x32_bf16 v[52:55], v[132:135], a[188:191], v[52:55]
    ds_read_b128 v[108:111], v14 offset:6144
    v_mfma_f32_16x16x32_bf16 v[48:51], v[132:135], a[184:187], v[48:51]
    ds_read_b128 v[112:115], v14 offset:10240
    v_add_u32 v11, -65536, v11
    v_mfma_f32_16x16x32_bf16 v[48:51], v[128:131], a[176:179], v[48:51]
    ds_read_b128 v[116:119], v14 offset:14336
    v_mfma_f32_16x16x32_bf16 v[48:51], v[124:127], a[168:171], v[48:51]
    s_add_u32 m0, s73, 150528
    v_mfma_f32_16x16x32_bf16 v[48:51], v[120:123], a[160:163], v[48:51]
    buffer_load_dwordx4 v21, s[44:47], s20 offen offset:0 sc1 lds
    ds_read_b64_tr_b16 v[224:225], v11 offset:32768
    s_waitcnt lgkmcnt(3)
    v_mfma_f32_16x16x32_bf16 v[32:35], v[104:107], a[192:195], v[32:35]
    buffer_load_dwordx4 v[92:95], v252, s[56:59], s40 offen
    v_mfma_f32_16x16x32_bf16 v[32:35], v[108:111], a[200:203], v[32:35]
    ds_read_b64_tr_b16 v[226:227], v11 offset:34816
    s_waitcnt vmcnt(13)
    s_waitcnt lgkmcnt(2)
    v_mfma_f32_16x16x32_bf16 v[32:35], v[112:115], a[208:211], v[32:35]
    ds_read_b128 v[120:123], v14 offset:3072
    v_mfma_f32_16x16x32_bf16 v[32:35], v[116:119], a[216:219], v[32:35]
    ds_read_b128 v[124:127], v14 offset:7168
    v_lshlrev_b32 v72, 16, v102
    v_mfma_f32_16x16x32_bf16 v[36:39], v[116:119], a[220:223], v[36:39]
    ds_read_b128 v[128:131], v14 offset:11264
    v_mfma_f32_16x16x32_bf16 v[36:39], v[112:115], a[212:215], v[36:39]
    ds_read_b128 v[132:135], v14 offset:15360
    v_mfma_f32_16x16x32_bf16 v[36:39], v[108:111], a[204:207], v[36:39]
    ds_read_b64_tr_b16 v[232:233], v11 offset:36864
    v_lshlrev_b32 v73, 16, v102
    v_mfma_f32_16x16x32_bf16 v[36:39], v[104:107], a[196:199], v[36:39]
    s_waitcnt lgkmcnt(3)
    v_mfma_f32_16x16x32_bf16 v[44:47], v[120:123], a[196:199], v[44:47]
    ds_read_b64_tr_b16 v[234:235], v11 offset:38912
    v_mfma_f32_16x16x32_bf16 v[44:47], v[124:127], a[204:207], v[44:47]
    v_lshlrev_b32 v74, 16, v102
    s_waitcnt lgkmcnt(2)
    v_mfma_f32_16x16x32_bf16 v[44:47], v[128:131], a[212:215], v[44:47]
    buffer_load_dwordx2 v[142:143], v253, s[56:59], 0 offen
    s_waitcnt vmcnt(7) lgkmcnt(0)
    s_barrier
    v_mfma_f32_16x16x32_bf16 v[44:47], v[132:135], a[220:223], v[44:47]
    ds_read_b128 v[104:107], v14 offset:16384
    v_lshlrev_b32 v75, 16, v102
    v_mfma_f32_16x16x32_bf16 v[40:43], v[132:135], a[216:219], v[40:43]
    ds_read_b128 v[108:111], v14 offset:20480
    v_add_u32 v10, 65536, v10
    v_mfma_f32_16x16x32_bf16 v[40:43], v[128:131], a[208:211], v[40:43]
    ds_read_b128 v[112:115], v14 offset:24576
    v_mfma_f32_16x16x32_bf16 v[40:43], v[124:127], a[200:203], v[40:43]
    ds_read_b128 v[116:119], v14 offset:28672
    v_lshlrev_b32 v76, 16, v103
    v_mfma_f32_16x16x32_bf16 v[40:43], v[120:123], a[192:195], v[40:43]
    ds_read_b64_tr_b16 v[236:237], v10 offset:16384
    s_waitcnt lgkmcnt(3)
    v_mfma_f32_16x16x32_bf16 v[48:51], v[104:107], a[192:195], v[48:51]
    s_add_u32 m0, s73, 97792
    v_lshlrev_b32 v77, 16, v103
    v_mfma_f32_16x16x32_bf16 v[48:51], v[108:111], a[200:203], v[48:51]
    buffer_load_dwordx4 v21, s[44:47], s20 offen offset:512 sc1 lds
    ds_read_b64_tr_b16 v[238:239], v10 offset:18432
    s_waitcnt lgkmcnt(2)
    v_mfma_f32_16x16x32_bf16 v[48:51], v[112:115], a[208:211], v[48:51]
    ds_read_b128 v[120:123], v14 offset:17408
    v_mfma_f32_16x16x32_bf16 v[48:51], v[116:119], a[216:219], v[48:51]
    ds_read_b128 v[124:127], v14 offset:21504
    v_mfma_f32_16x16x32_bf16 v[52:55], v[116:119], a[220:223], v[52:55]
    ds_read_b128 v[128:131], v14 offset:25600
    v_lshlrev_b32 v78, 16, v103
    v_mfma_f32_16x16x32_bf16 v[52:55], v[112:115], a[212:215], v[52:55]
    ds_read_b128 v[132:135], v14 offset:29696
    buffer_load_dwordx2 v[96:97], v26, s[44:47], s42 offen offset:0 sc1
    v_mfma_f32_16x16x32_bf16 v[52:55], v[108:111], a[204:207], v[52:55]
    ds_read_b64_tr_b16 v[244:245], v10 offset:20480
    s_add_u32 m0, s73, 99328
    v_lshlrev_b32 v79, 16, v103
    v_mfma_f32_16x16x32_bf16 v[52:55], v[104:107], a[196:199], v[52:55]
    buffer_load_dwordx4 v21, s[44:47], s21 offen offset:0 sc1 lds
    s_waitcnt lgkmcnt(3)
    v_mfma_f32_16x16x32_bf16 v[36:39], v[120:123], a[228:231], v[36:39]
    ds_read_b64_tr_b16 v[246:247], v10 offset:22528
    s_add_u32 m0, s73, 99840
    v_lshlrev_b32 v80, 16, v102
    v_mfma_f32_16x16x32_bf16 v[36:39], v[124:127], a[236:239], v[36:39]
    buffer_load_dwordx4 v21, s[44:47], s21 offen offset:512 sc1 lds
    s_waitcnt lgkmcnt(2)
    v_mfma_f32_16x16x32_bf16 v[36:39], v[128:131], a[244:247], v[36:39]
    ds_read_b128 v[104:107], v14 offset:18432
    v_mfma_f32_16x16x32_bf16 v[36:39], v[132:135], a[252:255], v[36:39]
    ds_read_b128 v[108:111], v14 offset:22528
    v_lshlrev_b32 v81, 16, v102
    v_mfma_f32_16x16x32_bf16 v[32:35], v[132:135], a[248:251], v[32:35]
    ds_read_b128 v[112:115], v14 offset:26624
    v_add_u32 v11, 65536, v11
    v_mfma_f32_16x16x32_bf16 v[32:35], v[128:131], a[240:243], v[32:35]
    ds_read_b128 v[116:119], v14 offset:30720
    v_mfma_f32_16x16x32_bf16 v[32:35], v[124:127], a[232:235], v[32:35]
    s_add_u32 m0, s73, 101376
    v_lshlrev_b32 v82, 16, v102
    v_mfma_f32_16x16x32_bf16 v[32:35], v[120:123], a[224:227], v[32:35]
    buffer_load_dwordx4 v21, s[44:47], s22 offen offset:0 sc1 lds
    ds_read_b64_tr_b16 v[240:241], v11 offset:16384
    s_waitcnt lgkmcnt(3)
    v_mfma_f32_16x16x32_bf16 v[40:43], v[104:107], a[224:227], v[40:43]
    buffer_load_dwordx2 v[98:99], v26, s[44:47], s42 offen offset:128 sc1
    v_lshlrev_b32 v83, 16, v102
    v_mfma_f32_16x16x32_bf16 v[40:43], v[108:111], a[232:235], v[40:43]
    ds_read_b64_tr_b16 v[242:243], v11 offset:18432
    s_waitcnt lgkmcnt(2)
    v_mfma_f32_16x16x32_bf16 v[40:43], v[112:115], a[240:243], v[40:43]
    ds_read_b128 v[120:123], v14 offset:19456
    v_mfma_f32_16x16x32_bf16 v[40:43], v[116:119], a[248:251], v[40:43]
    ds_read_b128 v[124:127], v14 offset:23552
    v_mfma_f32_16x16x32_bf16 v[44:47], v[116:119], a[252:255], v[44:47]
    ds_read_b128 v[128:131], v14 offset:27648
    v_lshlrev_b32 v84, 16, v103
    v_mfma_f32_16x16x32_bf16 v[44:47], v[112:115], a[244:247], v[44:47]
    ds_read_b128 v[132:135], v14 offset:31744
    v_mfma_f32_16x16x32_bf16 v[44:47], v[108:111], a[236:239], v[44:47]
    ds_read_b64_tr_b16 v[248:249], v11 offset:20480
    v_lshlrev_b32 v85, 16, v103
    v_mfma_f32_16x16x32_bf16 v[44:47], v[104:107], a[228:231], v[44:47]
    s_waitcnt lgkmcnt(3)
    v_mfma_f32_16x16x32_bf16 v[52:55], v[120:123], a[228:231], v[52:55]
    ds_read_b64_tr_b16 v[250:251], v11 offset:22528
    v_mfma_f32_16x16x32_bf16 v[52:55], v[124:127], a[236:239], v[52:55]
    v_lshlrev_b32 v86, 16, v103
    s_waitcnt lgkmcnt(2)
    v_mfma_f32_16x16x32_bf16 v[52:55], v[128:131], a[244:247], v[52:55]
    buffer_load_dwordx2 v[100:101], v18, s[44:47], s42 offen offset:0 sc1
    s_waitcnt lgkmcnt(0)
    s_barrier
    v_mfma_f32_16x16x32_bf16 v[52:55], v[132:135], a[252:255], v[52:55]
    ds_read_b128 v[104:107], v14 offset:32768
    v_mfma_f32_16x16x32_bf16 v[48:51], v[132:135], a[248:251], v[48:51]
    ds_read_b128 v[108:111], v14 offset:36864
    v_lshlrev_b32 v87, 16, v103
    v_mfma_f32_16x16x32_bf16 v[48:51], v[128:131], a[240:243], v[48:51]
    ds_read_b128 v[112:115], v14 offset:40960
    v_mfma_f32_16x16x32_bf16 v[48:51], v[124:127], a[232:235], v[48:51]
    ds_read_b128 v[116:119], v14 offset:45056
    v_lshlrev_b32 v27, 16, v27
    v_mfma_f32_16x16x32_bf16 v[48:51], v[120:123], a[224:227], v[48:51]
L_Dc:
L_pl_D_0:
    s_cbranch_execz L_wret
    s_waitcnt lgkmcnt(2)
    v_mfma_f32_16x16x32_bf16 v[32:35], v[104:107], v[220:223], v[32:35]
    s_add_u32 m0, s73, 114176
    v_mfma_f32_16x16x32_bf16 v[32:35], v[108:111], v[228:231], v[32:35]
    buffer_load_dwordx4 v21, s[44:47], s22 offen offset:512 sc1 lds
    s_waitcnt lgkmcnt(0)
    v_mfma_f32_16x16x32_bf16 v[32:35], v[112:115], v[236:239], v[32:35]
    ds_read_b128 v[120:123], v14 offset:33792
    v_mfma_f32_16x16x32_bf16 v[32:35], v[116:119], v[244:247], v[32:35]
    ds_read_b128 v[124:127], v14 offset:37888
    v_mfma_f32_16x16x32_bf16 v[36:39], v[116:119], v[248:251], v[36:39]
    ds_read_b128 v[128:131], v14 offset:41984
    buffer_load_dword v189, v188, s[44:47], 0 offen sc1
    v_mfma_f32_16x16x32_bf16 v[36:39], v[112:115], v[240:243], v[36:39]
    ds_read_b128 v[132:135], v14 offset:46080
    v_mfma_f32_16x16x32_bf16 v[36:39], v[108:111], v[232:235], v[36:39]
    s_add_u32 m0, s73, 115712
    v_mfma_f32_16x16x32_bf16 v[36:39], v[104:107], v[224:227], v[36:39]
    buffer_load_dwordx4 v21, s[44:47], s23 offen offset:0 sc1 lds
    s_waitcnt lgkmcnt(2)
    v_mfma_f32_16x16x32_bf16 v[44:47], v[120:123], v[224:227], v[44:47]
    s_add_u32 m0, s73, 116224
    v_mfma_f32_16x16x32_bf16 v[44:47], v[124:127], v[232:235], v[44:47]
    buffer_load_dwordx4 v21, s[44:47], s23 offen offset:512 sc1 lds
    s_waitcnt lgkmcnt(0)
    v_mfma_f32_16x16x32_bf16 v[44:47], v[128:131], v[240:243], v[44:47]
    ds_read_b128 v[104:107], v14 offset:34816
    v_mfma_f32_16x16x32_bf16 v[44:47], v[132:135], v[248:251], v[44:47]
    ds_read_b128 v[108:111], v14 offset:38912
    v_mfma_f32_16x16x32_bf16 v[40:43], v[132:135], v[244:247], v[40:43]
    ds_read_b128 v[112:115], v14 offset:43008
    v_mfma_f32_16x16x32_bf16 v[40:43], v[128:131], v[236:239], v[40:43]
    ds_read_b128 v[116:119], v14 offset:47104
    v_mfma_f32_16x16x32_bf16 v[40:43], v[124:127], v[228:231], v[40:43]
    s_add_u32 m0, s73, 117760
    v_mfma_f32_16x16x32_bf16 v[40:43], v[120:123], v[220:223], v[40:43]
    buffer_load_dwordx4 v21, s[44:47], s24 offen offset:0 sc1 lds
    s_waitcnt lgkmcnt(2)
    v_mfma_f32_16x16x32_bf16 v[48:51], v[104:107], v[220:223], v[48:51]
    v_mfma_f32_16x16x32_bf16 v[48:51], v[108:111], v[228:231], v[48:51]
    s_waitcnt lgkmcnt(0)
    v_mfma_f32_16x16x32_bf16 v[48:51], v[112:115], v[236:239], v[48:51]
    ds_read_b128 v[120:123], v14 offset:35840
    v_mfma_f32_16x16x32_bf16 v[48:51], v[116:119], v[244:247], v[48:51]
    ds_read_b128 v[124:127], v14 offset:39936
    v_mfma_f32_16x16x32_bf16 v[52:55], v[116:119], v[248:251], v[52:55]
    ds_read_b128 v[128:131], v14 offset:44032
    v_mfma_f32_16x16x32_bf16 v[52:55], v[112:115], v[240:243], v[52:55]
    ds_read_b128 v[132:135], v14 offset:48128
    v_mfma_f32_16x16x32_bf16 v[52:55], v[108:111], v[232:235], v[52:55]
    v_mfma_f32_16x16x32_bf16 v[52:55], v[104:107], v[224:227], v[52:55]
    s_waitcnt lgkmcnt(2)
    v_mfma_f32_16x16x32_bf16 v[60:63], v[120:123], a[4:7], 0
    v_mfma_f32_16x16x32_bf16 v[60:63], v[124:127], a[12:15], v[60:63]
    s_waitcnt lgkmcnt(0)
    v_mfma_f32_16x16x32_bf16 v[60:63], v[128:131], a[20:23], v[60:63]
    s_waitcnt vmcnt(14)
    s_barrier
    v_mfma_f32_16x16x32_bf16 v[60:63], v[132:135], a[28:31], v[60:63]
    ds_read_b128 v[104:107], v14 offset:49152
    v_mfma_f32_16x16x32_bf16 v[56:59], v[132:135], a[24:27], 0
    ds_read_b128 v[108:111], v14 offset:53248
    v_mfma_f32_16x16x32_bf16 v[56:59], v[128:131], a[16:19], v[56:59]
    ds_read_b128 v[112:115], v14 offset:57344
    v_cvt_pk_bf16_f32 v192, v32, v33
    v_mfma_f32_16x16x32_bf16 v[56:59], v[124:127], a[8:11], v[56:59]
    ds_read_b128 v[116:119], v14 offset:61440
    v_mfma_f32_16x16x32_bf16 v[56:59], v[120:123], a[0:3], v[56:59]
    s_waitcnt lgkmcnt(2)
    v_mfma_f32_16x16x32_bf16 v[64:67], v[104:107], a[0:3], 0
    s_add_u32 m0, s73, 130560
    v_mfma_f32_16x16x32_bf16 v[64:67], v[108:111], a[8:11], v[64:67]
    buffer_load_dwordx4 v21, s[44:47], s24 offen offset:512 sc1 lds
    s_waitcnt lgkmcnt(0)
    v_mfma_f32_16x16x32_bf16 v[64:67], v[112:115], a[16:19], v[64:67]
    ds_read_b128 v[120:123], v14 offset:50176
    v_cvt_pk_bf16_f32 v193, v34, v35
    v_mfma_f32_16x16x32_bf16 v[64:67], v[116:119], a[24:27], v[64:67]
    ds_read_b128 v[124:127], v14 offset:54272
    v_mfma_f32_16x16x32_bf16 v[68:71], v[116:119], a[28:31], 0
    ds_read_b128 v[128:131], v14 offset:58368
    v_mfma_f32_16x16x32_bf16 v[68:71], v[112:115], a[20:23], v[68:71]
    buffer_store_dwordx4 v[192:195], v136, s[44:47], s32 offen sc1
    ds_read_b128 v[132:135], v14 offset:62464
    v_mfma_f32_16x16x32_bf16 v[68:71], v[108:111], a[12:15], v[68:71]
    s_add_u32 m0, s73, 132096
    v_mfma_f32_16x16x32_bf16 v[68:71], v[104:107], a[4:7], v[68:71]
    buffer_load_dwordx4 v21, s[44:47], s25 offen offset:0 sc1 lds
    s_waitcnt lgkmcnt(2)
    v_mfma_f32_16x16x32_bf16 v[60:63], v[120:123], a[36:39], v[60:63]
    s_add_u32 m0, s73, 132608
    v_mfma_f32_16x16x32_bf16 v[60:63], v[124:127], a[44:47], v[60:63]
    buffer_load_dwordx4 v21, s[44:47], s25 offen offset:512 sc1 lds
    s_waitcnt lgkmcnt(0)
    v_mfma_f32_16x16x32_bf16 v[60:63], v[128:131], a[52:55], v[60:63]
    ds_read_b128 v[104:107], v14 offset:51200
    v_mfma_f32_16x16x32_bf16 v[60:63], v[132:135], a[60:63], v[60:63]
    ds_read_b128 v[108:111], v14 offset:55296
    v_mfma_f32_16x16x32_bf16 v[56:59], v[132:135], a[56:59], v[56:59]
    ds_read_b128 v[112:115], v14 offset:59392
    v_mfma_f32_16x16x32_bf16 v[56:59], v[128:131], a[48:51], v[56:59]
    ds_read_b128 v[116:119], v14 offset:63488
    v_mfma_f32_16x16x32_bf16 v[56:59], v[124:127], a[40:43], v[56:59]
    s_add_u32 m0, s73, 134144
    v_cvt_pk_bf16_f32 v196, v36, v37
    v_mfma_f32_16x16x32_bf16 v[56:59], v[120:123], a[32:35], v[56:59]
    buffer_load_dwordx4 v21, s[44:47], s26 offen offset:0 sc1 lds
    s_waitcnt lgkmcnt(2)
    v_mfma_f32_16x16x32_bf16 v[64:67], v[104:107], a[32:35], v[64:67]
    v_mfma_f32_16x16x32_bf16 v[64:67], v[108:111], a[40:43], v[64:67]
    s_waitcnt lgkmcnt(0)
    v_mfma_f32_16x16x32_bf16 v[64:67], v[112:115], a[48:51], v[64:67]
    ds_read_b128 v[120:123], v14 offset:52224
    v_cvt_pk_bf16_f32 v197, v38, v39
    v_mfma_f32_16x16x32_bf16 v[64:67], v[116:119], a[56:59], v[64:67]
    ds_read_b128 v[124:127], v14 offset:56320
    v_mfma_f32_16x16x32_bf16 v[68:71], v[116:119], a[60:63], v[68:71]
    ds_read_b128 v[128:131], v14 offset:60416
    v_mfma_f32_16x16x32_bf16 v[68:71], v[112:115], a[52:55], v[68:71]
    ds_read_b128 v[132:135], v14 offset:64512
    v_mfma_f32_16x16x32_bf16 v[68:71], v[108:111], a[44:47], v[68:71]
    buffer_store_dwordx4 v[196:199], v136, s[44:47], s33 offen sc1
    v_mfma_f32_16x16x32_bf16 v[68:71], v[104:107], a[36:39], v[68:71]
    s_waitcnt lgkmcnt(2)
    v_mfma_f32_16x16x32_bf16 v[60:63], v[120:123], a[68:71], v[60:63]
    v_mfma_f32_16x16x32_bf16 v[60:63], v[124:127], a[76:79], v[60:63]
    s_waitcnt lgkmcnt(0)
    v_mfma_f32_16x16x32_bf16 v[60:63], v[128:131], a[84:87], v[60:63]
    s_waitcnt vmcnt(13)
    s_barrier
    v_mfma_f32_16x16x32_bf16 v[60:63], v[132:135], a[92:95], v[60:63]
    ds_read_b128 v[104:107], v14 offset:0
    v_mfma_f32_16x16x32_bf16 v[56:59], v[132:135], a[88:91], v[56:59]
    ds_read_b128 v[108:111], v14 offset:4096
    v_mfma_f32_16x16x32_bf16 v[56:59], v[128:131], a[80:83], v[56:59]
    ds_read_b128 v[112:115], v14 offset:8192
    v_cvt_pk_bf16_f32 v192, v40, v41
    v_mfma_f32_16x16x32_bf16 v[56:59], v[124:127], a[72:75], v[56:59]
    ds_read_b128 v[116:119], v14 offset:12288
    v_mfma_f32_16x16x32_bf16 v[56:59], v[120:123], a[64:67], v[56:59]
    s_waitcnt lgkmcnt(2)
    v_mfma_f32_16x16x32_bf16 v[64:67], v[104:107], a[64:67], v[64:67]
    s_add_u32 m0, s73, 146944
    v_cvt_pk_bf16_f32 v193, v42, v43
    s_waitcnt vmcnt(11)
    v_mfma_f32_16x16x32_bf16 v[64:67], v[108:111], a[72:75], v[64:67]
    buffer_load_dwordx4 v21, s[44:47], s26 offen offset:512 sc1 lds
    s_waitcnt lgkmcnt(0)
    v_mfma_f32_16x16x32_bf16 v[64:67], v[112:115], a[80:83], v[64:67]
    ds_read_b128 v[120:123], v14 offset:1024
    v_mul_f32 v96, v96, v97
    v_mfma_f32_16x16x32_bf16 v[64:67], v[116:119], a[88:91], v[64:67]
    ds_read_b128 v[124:127], v14 offset:5120
    v_cvt_pk_bf16_f32 v194, v44, v45
    v_mfma_f32_16x16x32_bf16 v[68:71], v[116:119], a[92:95], v[68:71]
    ds_read_b128 v[128:131], v14 offset:9216
    v_mul_f32 v98, v98, v99
    v_mfma_f32_16x16x32_bf16 v[68:71], v[112:115], a[84:87], v[68:71]
    ds_read_b128 v[132:135], v14 offset:13312
    v_mul_f32 v100, v100, v101
    v_mfma_f32_16x16x32_bf16 v[68:71], v[108:111], a[76:79], v[68:71]
    buffer_store_dwordx4 v[192:195], v136, s[44:47], s30 offen offset:0 sc1
    s_add_u32 m0, s73, 148480
    v_permlane16_swap_b32 v88, v90
    v_mfma_f32_16x16x32_bf16 v[68:71], v[104:107], a[68:71], v[68:71]
    buffer_load_dwordx4 v22, s[44:47], s18 offen offset:0 sc1 lds
    s_waitcnt lgkmcnt(2)
    v_mfma_f32_16x16x32_bf16 v[60:63], v[120:123], a[100:103], v[60:63]
    s_add_u32 m0, s73, 148992
    v_permlane16_swap_b32 v89, v91
    v_permlane16_swap_b32 v92, v94
    v_mfma_f32_16x16x32_bf16 v[60:63], v[124:127], a[108:111], v[60:63]
    buffer_load_dwordx4 v22, s[44:47], s18 offen offset:512 sc1 lds
    s_waitcnt vmcnt(13)
    s_waitcnt lgkmcnt(0)
    v_mfma_f32_16x16x32_bf16 v[60:63], v[128:131], a[116:119], v[60:63]
    ds_read_b128 v[104:107], v14 offset:2048
    v_permlane16_swap_b32 v93, v95
    v_mfma_f32_16x16x32_bf16 v[60:63], v[132:135], a[124:127], v[60:63]
    ds_read_b128 v[108:111], v14 offset:6144
    v_cmp_ne_u32 vcc, s68, v189
    v_mfma_f32_16x16x32_bf16 v[56:59], v[132:135], a[120:123], v[56:59]
    ds_read_b128 v[112:115], v14 offset:10240
    v_and_b32 v145, 0xffff0000, v88
    v_mfma_f32_16x16x32_bf16 v[56:59], v[128:131], a[112:115], v[56:59]
    ds_read_b128 v[116:119], v14 offset:14336
    v_cvt_pk_bf16_f32 v196, v46, v47
    v_mfma_f32_16x16x32_bf16 v[56:59], v[124:127], a[104:107], v[56:59]
    s_add_u32 m0, s73, 150528
    s_cbranch_vccnz L_rs_p3
L_ok_p3:
    v_lshlrev_b32 v144, 16, v88
    v_mfma_f32_16x16x32_bf16 v[56:59], v[120:123], a[96:99], v[56:59]
    buffer_load_dwordx4 v22, s[44:47], s19 offen offset:0 sc1 lds
    s_waitcnt lgkmcnt(2)
    v_mfma_f32_16x16x32_bf16 v[64:67], v[104:107], a[96:99], v[64:67]
    s_add_u32 m0, s73, 81920
    v_cvt_pk_bf16_f32 v197, v48, v49
    v_and_b32 v147, 0xffff0000, v89
    v_mfma_f32_16x16x32_bf16 v[64:67], v[108:111], a[104:107], v[64:67]
    buffer_load_dwordx4 v184, s[44:47], s37 offen offset:0 sc1 lds
    s_waitcnt lgkmcnt(0)
    v_mfma_f32_16x16x32_bf16 v[64:67], v[112:115], a[112:115], v[64:67]
    ds_read_b128 v[120:123], v14 offset:3072
    buffer_load_dwordx4 v185, s[44:47], s37 offen offset:1024 sc1 lds
    v_mfma_f32_16x16x32_bf16 v[64:67], v[116:119], a[120:123], v[64:67]
    ds_read_b128 v[124:127], v14 offset:7168
    s_add_u32 m0, s73, 83968
    v_cvt_pk_bf16_f32 v198, v50, v51
    v_mfma_f32_16x16x32_bf16 v[68:71], v[116:119], a[124:127], v[68:71]
    ds_read_b128 v[128:131], v14 offset:11264
    buffer_load_dwordx4 v184, s[44:47], s16 offen offset:0 sc1 lds
    v_mfma_f32_16x16x32_bf16 v[68:71], v[112:115], a[116:119], v[68:71]
    ds_read_b128 v[132:135], v14 offset:15360
    buffer_load_dwordx4 v185, s[44:47], s16 offen offset:1024 sc1 lds
    v_mfma_f32_16x16x32_bf16 v[68:71], v[108:111], a[108:111], v[68:71]
    buffer_store_dwordx4 v[196:199], v136, s[44:47], s30 offen offset:1024 sc1
    v_lshlrev_b32 v146, 16, v89
    v_and_b32 v149, 0xffff0000, v92
    v_lshlrev_b32 v148, 16, v92
    v_mfma_f32_16x16x32_bf16 v[68:71], v[104:107], a[100:103], v[68:71]
    s_waitcnt lgkmcnt(2)
    v_mfma_f32_16x16x32_bf16 v[60:63], v[120:123], a[132:135], v[60:63]
    v_and_b32 v151, 0xffff0000, v93
    v_mfma_f32_16x16x32_bf16 v[60:63], v[124:127], a[140:143], v[60:63]
    v_lshlrev_b32 v150, 16, v93
    s_waitcnt lgkmcnt(0)
    v_mfma_f32_16x16x32_bf16 v[60:63], v[128:131], a[148:151], v[60:63]
    s_waitcnt vmcnt(16)
    s_barrier
    v_mfma_f32_16x16x32_bf16 v[60:63], v[132:135], a[156:159], v[60:63]
    ds_read_b128 v[104:107], v14 offset:16384
    v_and_b32 v153, 0xffff0000, v90
    v_mfma_f32_16x16x32_bf16 v[56:59], v[132:135], a[152:155], v[56:59]
    ds_read_b128 v[108:111], v14 offset:20480
    v_lshlrev_b32 v152, 16, v90
    v_mfma_f32_16x16x32_bf16 v[56:59], v[128:131], a[144:147], v[56:59]
    ds_read_b128 v[112:115], v14 offset:24576
    v_cvt_pk_bf16_f32 v200, v52, v53
    v_mfma_f32_16x16x32_bf16 v[56:59], v[124:127], a[136:139], v[56:59]
    ds_read_b128 v[116:119], v14 offset:28672
    v_and_b32 v155, 0xffff0000, v91
    v_mfma_f32_16x16x32_bf16 v[56:59], v[120:123], a[128:131], v[56:59]
    s_waitcnt lgkmcnt(2)
    v_mfma_f32_16x16x32_bf16 v[64:67], v[104:107], a[128:131], v[64:67]
    s_add_u32 m0, s73, 97792
    v_lshlrev_b32 v154, 16, v91
    v_mfma_f32_16x16x32_bf16 v[64:67], v[108:111], a[136:139], v[64:67]
    buffer_load_dwordx4 v22, s[44:47], s19 offen offset:512 sc1 lds
    s_waitcnt lgkmcnt(0)
    v_mfma_f32_16x16x32_bf16 v[64:67], v[112:115], a[144:147], v[64:67]
    ds_read_b128 v[120:123], v14 offset:17408
    v_cvt_pk_bf16_f32 v201, v54, v55
    v_mfma_f32_16x16x32_bf16 v[64:67], v[116:119], a[152:155], v[64:67]
    ds_read_b128 v[124:127], v14 offset:21504
    v_and_b32 v157, 0xffff0000, v94
    v_mfma_f32_16x16x32_bf16 v[68:71], v[116:119], a[156:159], v[68:71]
    ds_read_b128 v[128:131], v14 offset:25600
    v_lshlrev_b32 v156, 16, v94
    v_mfma_f32_16x16x32_bf16 v[68:71], v[112:115], a[148:151], v[68:71]
    buffer_store_dwordx4 v[200:203], v136, s[44:47], s30 offen offset:2048 sc1
    ds_read_b128 v[132:135], v14 offset:29696
    v_and_b32 v159, 0xffff0000, v95
L_pl_D_1:
    s_cbranch_execz L_wret
    v_mfma_f32_16x16x32_bf16 v[68:71], v[108:111], a[140:143], v[68:71]
    s_add_u32 m0, s73, 99328
    v_lshlrev_b32 v158, 16, v95
    v_mfma_f32_16x16x32_bf16 v[68:71], v[104:107], a[132:135], v[68:71]
    buffer_load_dwordx4 v22, s[44:47], s20 offen offset:0 sc1 lds
    s_waitcnt lgkmcnt(2)
    v_mfma_f32_16x16x32_bf16 v[60:63], v[120:123], a[164:167], v[60:63]
    s_add_u32 m0, s73, 99840
    v_and_b32 v161, 0xffff0000, v142
    v_mfma_f32_16x16x32_bf16 v[60:63], v[124:127], a[172:175], v[60:63]
    buffer_load_dwordx4 v22, s[44:47], s20 offen offset:512 sc1 lds
    s_waitcnt lgkmcnt(0)
    v_mfma_f32_16x16x32_bf16 v[60:63], v[128:131], a[180:183], v[60:63]
    ds_read_b128 v[104:107], v14 offset:18432
    v_lshlrev_b32 v160, 16, v142
    v_mfma_f32_16x16x32_bf16 v[60:63], v[132:135], a[188:191], v[60:63]
    ds_read_b128 v[108:111], v14 offset:22528
    v_mfma_f32_16x16x32_bf16 v[56:59], v[132:135], a[184:187], v[56:59]
    ds_read_b128 v[112:115], v14 offset:26624
    v_and_b32 v163, 0xffff0000, v143
    v_mfma_f32_16x16x32_bf16 v[56:59], v[128:131], a[176:179], v[56:59]
    ds_read_b128 v[116:119], v14 offset:30720
    v_lshlrev_b32 v162, 16, v143
    v_mfma_f32_16x16x32_bf16 v[56:59], v[124:127], a[168:171], v[56:59]
    s_add_u32 m0, s73, 101376
    v_mfma_f32_16x16x32_bf16 v[56:59], v[120:123], a[160:163], v[56:59]
    buffer_load_dwordx4 v22, s[44:47], s21 offen offset:0 sc1 lds
    s_waitcnt lgkmcnt(2)
    v_mfma_f32_16x16x32_bf16 v[64:67], v[104:107], a[160:163], v[64:67]
    v_fma_f32 v164, v144, v97, -v96
    v_mfma_f32_16x16x32_bf16 v[64:67], v[108:111], a[168:171], v[64:67]
    v_fma_f32 v165, v145, v97, -v96
    s_waitcnt lgkmcnt(0)
    v_mfma_f32_16x16x32_bf16 v[64:67], v[112:115], a[176:179], v[64:67]
    ds_read_b128 v[120:123], v14 offset:19456
    v_fma_f32 v166, v146, v97, -v96
    v_mfma_f32_16x16x32_bf16 v[64:67], v[116:119], a[184:187], v[64:67]
    ds_read_b128 v[124:127], v14 offset:23552
    v_mfma_f32_16x16x32_bf16 v[68:71], v[116:119], a[188:191], v[68:71]
    ds_read_b128 v[128:131], v14 offset:27648
    v_fma_f32 v167, v147, v97, -v96
    v_mfma_f32_16x16x32_bf16 v[68:71], v[112:115], a[180:183], v[68:71]
    ds_read_b128 v[132:135], v14 offset:31744
    v_mfma_f32_16x16x32_bf16 v[68:71], v[108:111], a[172:175], v[68:71]
    v_fma_f32 v168, v148, v99, -v98
    v_mfma_f32_16x16x32_bf16 v[68:71], v[104:107], a[164:167], v[68:71]
    v_fma_f32 v169, v149, v99, -v98
    s_waitcnt lgkmcnt(2)
    v_mfma_f32_16x16x32_bf16 v[60:63], v[120:123], a[196:199], v[60:63]
    v_mfma_f32_16x16x32_bf16 v[60:63], v[124:127], a[204:207], v[60:63]
    v_fma_f32 v170, v150, v99, -v98
    s_waitcnt lgkmcnt(0)
    v_mfma_f32_16x16x32_bf16 v[60:63], v[128:131], a[212:215], v[60:63]
    s_waitcnt vmcnt(16)
    s_barrier
    v_mfma_f32_16x16x32_bf16 v[60:63], v[132:135], a[220:223], v[60:63]
    ds_read_b128 v[104:107], v14 offset:32768
    v_fma_f32 v171, v151, v99, -v98
    v_mfma_f32_16x16x32_bf16 v[56:59], v[132:135], a[216:219], v[56:59]
    ds_read_b128 v[108:111], v14 offset:36864
    v_fma_f32 v172, v152, v97, -v96
    v_mfma_f32_16x16x32_bf16 v[56:59], v[128:131], a[208:211], v[56:59]
    ds_read_b128 v[112:115], v14 offset:40960
    v_mfma_f32_16x16x32_bf16 v[56:59], v[124:127], a[200:203], v[56:59]
    ds_read_b128 v[116:119], v14 offset:45056
    v_fma_f32 v173, v153, v97, -v96
    v_mfma_f32_16x16x32_bf16 v[56:59], v[120:123], a[192:195], v[56:59]
    s_waitcnt lgkmcnt(2)
    v_mfma_f32_16x16x32_bf16 v[64:67], v[104:107], a[192:195], v[64:67]
    s_add_u32 m0, s73, 114176
    v_fma_f32 v174, v154, v97, -v96
    v_mfma_f32_16x16x32_bf16 v[64:67], v[108:111], a[200:203], v[64:67]
    buffer_load_dwordx4 v22, s[44:47], s21 offen offset:512 sc1 lds
    s_waitcnt lgkmcnt(0)
    v_mfma_f32_16x16x32_bf16 v[64:67], v[112:115], a[208:211], v[64:67]
    ds_read_b128 v[120:123], v14 offset:33792
    v_fma_f32 v175, v155, v97, -v96
    v_mfma_f32_16x16x32_bf16 v[64:67], v[116:119], a[216:219], v[64:67]
    ds_read_b128 v[124:127], v14 offset:37888
    v_fma_f32 v176, v156, v99, -v98
    v_mfma_f32_16x16x32_bf16 v[68:71], v[116:119], a[220:223], v[68:71]
    ds_read_b128 v[128:131], v14 offset:41984
    v_mfma_f32_16x16x32_bf16 v[68:71], v[112:115], a[212:215], v[68:71]
    ds_read_b128 v[132:135], v14 offset:46080
    v_fma_f32 v177, v157, v99, -v98
    v_mfma_f32_16x16x32_bf16 v[68:71], v[108:111], a[204:207], v[68:71]
    s_add_u32 m0, s73, 115712
    v_fma_f32 v178, v158, v99, -v98
    v_mfma_f32_16x16x32_bf16 v[68:71], v[104:107], a[196:199], v[68:71]
    buffer_load_dwordx4 v22, s[44:47], s22 offen offset:0 sc1 lds
    s_waitcnt lgkmcnt(2)
    v_mfma_f32_16x16x32_bf16 v[60:63], v[120:123], a[228:231], v[60:63]
    s_add_u32 m0, s73, 116224
    v_fma_f32 v179, v159, v99, -v98
    v_mfma_f32_16x16x32_bf16 v[60:63], v[124:127], a[236:239], v[60:63]
    buffer_load_dwordx4 v22, s[44:47], s22 offen offset:512 sc1 lds
    s_waitcnt lgkmcnt(0)
    v_mfma_f32_16x16x32_bf16 v[60:63], v[128:131], a[244:247], v[60:63]
    ds_read_b128 v[104:107], v14 offset:34816
    v_fma_f32 v180, v160, v101, -v100
    v_mfma_f32_16x16x32_bf16 v[60:63], v[132:135], a[252:255], v[60:63]
    ds_read_b128 v[108:111], v14 offset:38912
    v_fma_f32 v181, v161, v101, -v100
    v_mfma_f32_16x16x32_bf16 v[56:59], v[132:135], a[248:251], v[56:59]
    ds_read_b128 v[112:115], v14 offset:43008
    v_mfma_f32_16x16x32_bf16 v[56:59], v[128:131], a[240:243], v[56:59]
    ds_read_b128 v[116:119], v14 offset:47104
    v_fma_f32 v182, v162, v101, -v100
    v_mfma_f32_16x16x32_bf16 v[56:59], v[124:127], a[232:235], v[56:59]
    s_add_u32 m0, s73, 117760
    v_fma_f32 v183, v163, v101, -v100
    v_mfma_f32_16x16x32_bf16 v[56:59], v[120:123], a[224:227], v[56:59]
    buffer_load_dwordx4 v22, s[44:47], s23 offen offset:0 sc1 lds
    s_waitcnt lgkmcnt(2)
    v_mfma_f32_16x16x32_bf16 v[64:67], v[104:107], a[224:227], v[64:67]
    v_mfma_f32_16x16x32_bf16 v[64:67], v[108:111], a[232:235], v[64:67]
    s_waitcnt lgkmcnt(0)
    v_mfma_f32_16x16x32_bf16 v[64:67], v[112:115], a[240:243], v[64:67]
    ds_read_b128 v[120:123], v14 offset:35840
    v_mfma_f32_16x16x32_bf16 v[64:67], v[116:119], a[248:251], v[64:67]
    ds_read_b128 v[124:127], v14 offset:39936
    v_mfma_f32_16x16x32_bf16 v[68:71], v[116:119], a[252:255], v[68:71]
    ds_read_b128 v[128:131], v14 offset:44032
    v_mfma_f32_16x16x32_bf16 v[68:71], v[112:115], a[244:247], v[68:71]
    ds_read_b128 v[132:135], v14 offset:48128
    v_mfma_f32_16x16x32_bf16 v[68:71], v[108:111], a[236:239], v[68:71]
    v_mfma_f32_16x16x32_bf16 v[68:71], v[104:107], a[228:231], v[68:71]
    s_waitcnt lgkmcnt(2)
    v_mfma_f32_16x16x32_bf16 v[60:63], v[120:123], v[224:227], v[60:63]
    v_mfma_f32_16x16x32_bf16 v[60:63], v[124:127], v[232:235], v[60:63]
    s_waitcnt lgkmcnt(0)
    v_mfma_f32_16x16x32_bf16 v[60:63], v[128:131], v[240:243], v[60:63]
    s_waitcnt vmcnt(10)
    s_barrier
    v_mfma_f32_16x16x32_bf16 v[60:63], v[132:135], v[248:251], v[60:63]
    ds_read_b128 v[104:107], v14 offset:49152
    v_mfma_f32_16x16x32_bf16 v[56:59], v[132:135], v[244:247], v[56:59]
    ds_read_b128 v[108:111], v14 offset:53248
    v_mfma_f32_16x16x32_bf16 v[56:59], v[128:131], v[236:239], v[56:59]
    ds_read_b128 v[112:115], v14 offset:57344
    v_mfma_f32_16x16x32_bf16 v[56:59], v[124:127], v[228:231], v[56:59]
    ds_read_b128 v[116:119], v14 offset:61440
    v_mfma_f32_16x16x32_bf16 v[56:59], v[120:123], v[220:223], v[56:59]
    s_waitcnt lgkmcnt(2)
    v_mfma_f32_16x16x32_bf16 v[64:67], v[104:107], v[220:223], v[64:67]
    s_add_u32 m0, s73, 130560
    v_xor_b32 v186, s41, v10
    v_add_u32 v186, s43, v186
    v_mfma_f32_16x16x32_bf16 v[64:67], v[108:111], v[228:231], v[64:67]
    buffer_load_dwordx4 v22, s[44:47], s23 offen offset:512 sc1 lds
    ds_read_b64_tr_b16 v[12:13], v10 offset:16384
    s_waitcnt lgkmcnt(1)
    v_mfma_f32_16x16x32_bf16 v[64:67], v[112:115], v[236:239], v[64:67]
    ds_read_b128 v[120:123], v14 offset:50176
    v_mfma_f32_16x16x32_bf16 v[64:67], v[116:119], v[244:247], v[64:67]
    ds_read_b128 v[124:127], v14 offset:54272
    v_mfma_f32_16x16x32_bf16 v[68:71], v[116:119], v[248:251], v[68:71]
    ds_read_b128 v[128:131], v14 offset:58368
    ds_read_b64_tr_b16 v[24:25], v11 offset:16384
    v_mfma_f32_16x16x32_bf16 v[68:71], v[112:115], v[240:243], v[68:71]
    ds_read_b128 v[132:135], v14 offset:62464
    ds_read_b64_tr_b16 v[28:29], v10 offset:20480
    v_mfma_f32_16x16x32_bf16 v[68:71], v[108:111], v[232:235], v[68:71]
    s_add_u32 m0, s73, 132096
    ds_read_b64_tr_b16 v[190:191], v11 offset:20480
    v_mfma_f32_16x16x32_bf16 v[68:71], v[104:107], v[224:227], v[68:71]
    buffer_load_dwordx4 v22, s[44:47], s24 offen offset:0 sc1 lds
    ds_read_b64_tr_b16 v[142:143], v186 offset:18432
    s_waitcnt lgkmcnt(6)
    v_mfma_f32_16x16x32_bf16 v[76:79], v[120:123], a[4:7], v[76:79]
    s_add_u32 m0, s73, 132608
    s_waitcnt lgkmcnt(0)
    v_mfma_f32_16x16x32_bf16 v[76:79], v[124:127], a[12:15], v[76:79]
    buffer_load_dwordx4 v22, s[44:47], s24 offen offset:512 sc1 lds
    v_mfma_f32_16x16x32_bf16 v[76:79], v[128:131], a[20:23], v[76:79]
    ds_read_b128 v[104:107], v14 offset:51200
    v_and_b32 v9, 0xffff0000, v12
    v_mfma_f32_16x16x32_bf16 v[76:79], v[132:135], a[28:31], v[76:79]
    ds_read_b128 v[108:111], v14 offset:55296
    v_mfma_f32_16x16x32_bf16 v[72:75], v[132:135], a[24:27], v[72:75]
    ds_read_b128 v[112:115], v14 offset:59392
    v_lshlrev_b32 v8, 16, v12
    v_mfma_f32_16x16x32_bf16 v[72:75], v[128:131], a[16:19], v[72:75]
    ds_read_b128 v[116:119], v14 offset:63488
    v_cvt_pk_bf16_f32 v192, v56, v57
    v_mfma_f32_16x16x32_bf16 v[72:75], v[124:127], a[8:11], v[72:75]
    s_add_u32 m0, s73, 134144
    v_mul_f32 v165, v165, v9
    v_mfma_f32_16x16x32_bf16 v[72:75], v[120:123], a[0:3], v[72:75]
    buffer_load_dwordx4 v22, s[44:47], s25 offen offset:0 sc1 lds
    s_waitcnt lgkmcnt(2)
    v_mfma_f32_16x16x32_bf16 v[80:83], v[104:107], a[0:3], v[80:83]
    v_cvt_pk_bf16_f32 v193, v58, v59
    v_mul_f32 v164, v164, v8
    v_mfma_f32_16x16x32_bf16 v[80:83], v[108:111], a[8:11], v[80:83]
    v_and_b32 v31, 0xffff0000, v13
    s_waitcnt lgkmcnt(0)
    v_mfma_f32_16x16x32_bf16 v[80:83], v[112:115], a[16:19], v[80:83]
    ds_read_b128 v[120:123], v14 offset:52224
    v_lshlrev_b32 v30, 16, v13
    v_mfma_f32_16x16x32_bf16 v[80:83], v[116:119], a[24:27], v[80:83]
    ds_read_b128 v[124:127], v14 offset:56320
    v_cvt_pk_bf16_f32 v194, v60, v61
    v_mfma_f32_16x16x32_bf16 v[84:87], v[116:119], a[28:31], v[84:87]
    ds_read_b128 v[128:131], v14 offset:60416
    v_mfma_f32_16x16x32_bf16 v[84:87], v[112:115], a[20:23], v[84:87]
    ds_read_b128 v[132:135], v14 offset:64512
    v_mul_f32 v167, v167, v31
    v_mfma_f32_16x16x32_bf16 v[84:87], v[108:111], a[12:15], v[84:87]
    buffer_store_dwordx4 v[192:195], v136, s[44:47], s15 offen offset:0 sc1
    v_mul_f32 v166, v166, v30
    v_mfma_f32_16x16x32_bf16 v[84:87], v[104:107], a[4:7], v[84:87]
    s_waitcnt lgkmcnt(2)
    v_mfma_f32_16x16x32_bf16 v[76:79], v[120:123], a[36:39], v[76:79]
    v_and_b32 v9, 0xffff0000, v24
    v_mfma_f32_16x16x32_bf16 v[76:79], v[124:127], a[44:47], v[76:79]
    v_cvt_pk_bf16_f32 v196, v62, v63
    s_waitcnt lgkmcnt(0)
    v_mfma_f32_16x16x32_bf16 v[76:79], v[128:131], a[52:55], v[76:79]
    s_waitcnt vmcnt(9)
    s_barrier
    v_lshlrev_b32 v8, 16, v24
    v_mfma_f32_16x16x32_bf16 v[76:79], v[132:135], a[60:63], v[76:79]
    ds_read_b128 v[104:107], v14 offset:0
    v_mul_f32 v169, v169, v9
    v_mfma_f32_16x16x32_bf16 v[72:75], v[132:135], a[56:59], v[72:75]
    ds_read_b128 v[108:111], v14 offset:4096
    v_cvt_pk_bf16_f32 v197, v64, v65
    v_mfma_f32_16x16x32_bf16 v[72:75], v[128:131], a[48:51], v[72:75]
    ds_read_b128 v[112:115], v14 offset:8192
    v_mul_f32 v168, v168, v8
    v_mfma_f32_16x16x32_bf16 v[72:75], v[124:127], a[40:43], v[72:75]
    ds_read_b128 v[116:119], v14 offset:12288
    v_mfma_f32_16x16x32_bf16 v[72:75], v[120:123], a[32:35], v[72:75]
    v_cvt_pk_bf16_f32 v198, v66, v67
    s_waitcnt lgkmcnt(2)
    v_mfma_f32_16x16x32_bf16 v[80:83], v[104:107], a[32:35], v[80:83]
    s_add_u32 m0, s73, 146944
    v_and_b32 v31, 0xffff0000, v25
    v_lshlrev_b32 v30, 16, v25
    v_mfma_f32_16x16x32_bf16 v[80:83], v[108:111], a[40:43], v[80:83]
    buffer_load_dwordx4 v22, s[44:47], s25 offen offset:512 sc1 lds
    s_waitcnt lgkmcnt(0)
    v_mfma_f32_16x16x32_bf16 v[80:83], v[112:115], a[48:51], v[80:83]
    buffer_store_dwordx4 v[196:199], v136, s[44:47], s15 offen offset:1024 sc1
    ds_read_b128 v[120:123], v14 offset:1024
    v_mfma_f32_16x16x32_bf16 v[80:83], v[116:119], a[56:59], v[80:83]
    ds_read_b128 v[124:127], v14 offset:5120
    v_mul_f32 v171, v171, v31
    v_mfma_f32_16x16x32_bf16 v[84:87], v[116:119], a[60:63], v[84:87]
    ds_read_b128 v[128:131], v14 offset:9216
    v_mul_f32 v170, v170, v30
    v_mfma_f32_16x16x32_bf16 v[84:87], v[112:115], a[52:55], v[84:87]
    ds_read_b128 v[132:135], v14 offset:13312
    v_mfma_f32_16x16x32_bf16 v[84:87], v[108:111], a[44:47], v[84:87]
    s_add_u32 m0, s73, 148480
    v_cvt_pk_bf16_f32 v200, v68, v69
    v_and_b32 v9, 0xffff0000, v28
    v_mfma_f32_16x16x32_bf16 v[84:87], v[104:107], a[36:39], v[84:87]
    buffer_load_dwordx4 v22, s[44:47], s26 offen offset:0 sc1 lds
    s_waitcnt lgkmcnt(2)
    v_mfma_f32_16x16x32_bf16 v[76:79], v[120:123], a[68:71], v[76:79]
    s_add_u32 m0, s73, 148992
    v_lshlrev_b32 v8, 16, v28
    v_mfma_f32_16x16x32_bf16 v[76:79], v[124:127], a[76:79], v[76:79]
    buffer_load_dwordx4 v22, s[44:47], s26 offen offset:512 sc1 lds
    s_waitcnt lgkmcnt(0)
    v_mfma_f32_16x16x32_bf16 v[76:79], v[128:131], a[84:87], v[76:79]
    ds_read_b128 v[104:107], v14 offset:2048
    v_cvt_pk_bf16_f32 v201, v70, v71
    v_mfma_f32_16x16x32_bf16 v[76:79], v[132:135], a[92:95], v[76:79]
    ds_read_b128 v[108:111], v14 offset:6144
    v_mul_f32 v173, v173, v9
    v_mfma_f32_16x16x32_bf16 v[72:75], v[132:135], a[88:91], v[72:75]
    ds_read_b128 v[112:115], v14 offset:10240
    v_mul_f32 v172, v172, v8
    v_mfma_f32_16x16x32_bf16 v[72:75], v[128:131], a[80:83], v[72:75]
    ds_read_b128 v[116:119], v14 offset:14336
    v_and_b32 v31, 0xffff0000, v29
    v_mfma_f32_16x16x32_bf16 v[72:75], v[124:127], a[72:75], v[72:75]
    buffer_store_dwordx4 v[200:203], v136, s[44:47], s15 offen offset:2048 sc1
    s_add_u32 m0, s73, 150528
    v_mfma_f32_16x16x32_bf16 v[72:75], v[120:123], a[64:67], v[72:75]
    buffer_load_dwordx4 v19, s[44:47], s18 offen offset:0 sc1 lds
    s_waitcnt lgkmcnt(2)
    v_mfma_f32_16x16x32_bf16 v[80:83], v[104:107], a[64:67], v[80:83]
    v_lshlrev_b32 v30, 16, v29
    v_mul_f32 v175, v175, v31
    v_mfma_f32_16x16x32_bf16 v[80:83], v[108:111], a[72:75], v[80:83]
    buffer_load_dwordx4 v[40:43], v136, s[44:47], s34 offen offset:0 sc1
    s_waitcnt lgkmcnt(0)
    v_mfma_f32_16x16x32_bf16 v[80:83], v[112:115], a[80:83], v[80:83]
    ds_read_b128 v[120:123], v14 offset:3072
    v_mfma_f32_16x16x32_bf16 v[80:83], v[116:119], a[88:91], v[80:83]
    ds_read_b128 v[124:127], v14 offset:7168
    v_mul_f32 v174, v174, v30
    v_mfma_f32_16x16x32_bf16 v[84:87], v[116:119], a[92:95], v[84:87]
    ds_read_b128 v[128:131], v14 offset:11264
    v_and_b32 v9, 0xffff0000, v190
    v_mfma_f32_16x16x32_bf16 v[84:87], v[112:115], a[84:87], v[84:87]
    ds_read_b128 v[132:135], v14 offset:15360
    buffer_load_dwordx4 v[44:47], v136, s[44:47], s34 offen offset:1024 sc1
    v_mfma_f32_16x16x32_bf16 v[84:87], v[108:111], a[76:79], v[84:87]
    v_lshlrev_b32 v8, 16, v190
    v_mfma_f32_16x16x32_bf16 v[84:87], v[104:107], a[68:71], v[84:87]
    s_waitcnt lgkmcnt(2)
    v_mfma_f32_16x16x32_bf16 v[76:79], v[120:123], a[100:103], v[76:79]
    buffer_load_dwordx4 v[48:51], v136, s[44:47], s34 offen offset:2048 sc1
    v_mul_f32 v177, v177, v9
    v_mfma_f32_16x16x32_bf16 v[76:79], v[124:127], a[108:111], v[76:79]
    s_waitcnt lgkmcnt(0)
    v_mfma_f32_16x16x32_bf16 v[76:79], v[128:131], a[116:119], v[76:79]
    s_waitcnt vmcnt(14)
    s_barrier
    v_mul_f32 v176, v176, v8
    v_mfma_f32_16x16x32_bf16 v[76:79], v[132:135], a[124:127], v[76:79]
    ds_read_b128 v[104:107], v14 offset:16384
    v_and_b32 v31, 0xffff0000, v191
    v_mfma_f32_16x16x32_bf16 v[72:75], v[132:135], a[120:123], v[72:75]
    ds_read_b128 v[108:111], v14 offset:20480
    buffer_load_dwordx4 v[204:207], v136, s[44:47], s35 offen offset:0 sc1
    v_mfma_f32_16x16x32_bf16 v[72:75], v[128:131], a[112:115], v[72:75]
    ds_read_b128 v[112:115], v14 offset:24576
    v_lshlrev_b32 v30, 16, v191
    v_mfma_f32_16x16x32_bf16 v[72:75], v[124:127], a[104:107], v[72:75]
    ds_read_b128 v[116:119], v14 offset:28672
    v_mul_f32 v179, v179, v31
    v_mfma_f32_16x16x32_bf16 v[72:75], v[120:123], a[96:99], v[72:75]
    buffer_load_dwordx4 v[208:211], v136, s[44:47], s35 offen offset:1024 sc1
    s_waitcnt lgkmcnt(2)
    v_mfma_f32_16x16x32_bf16 v[80:83], v[104:107], a[96:99], v[80:83]
    v_mfma_f32_16x16x32_bf16 v[80:83], v[108:111], a[104:107], v[80:83]
    v_mul_f32 v178, v178, v30
    s_waitcnt lgkmcnt(0)
    v_mfma_f32_16x16x32_bf16 v[80:83], v[112:115], a[112:115], v[80:83]
    ds_read_b128 v[120:123], v14 offset:17408
    buffer_load_dwordx4 v[212:215], v136, s[44:47], s35 offen offset:2048 sc1
    v_mfma_f32_16x16x32_bf16 v[80:83], v[116:119], a[120:123], v[80:83]
    ds_read_b128 v[124:127], v14 offset:21504
    v_and_b32 v9, 0xffff0000, v142
    v_mfma_f32_16x16x32_bf16 v[84:87], v[116:119], a[124:127], v[84:87]
    ds_read_b128 v[128:131], v14 offset:25600
    v_lshlrev_b32 v8, 16, v142
    v_mfma_f32_16x16x32_bf16 v[84:87], v[112:115], a[116:119], v[84:87]
    ds_read_b128 v[132:135], v14 offset:29696
    v_mfma_f32_16x16x32_bf16 v[84:87], v[108:111], a[108:111], v[84:87]
    buffer_load_dwordx4 v[216:219], v136, s[44:47], s35 offen offset:3072 sc1
    v_mul_f32 v181, v181, v9
    v_mfma_f32_16x16x32_bf16 v[84:87], v[104:107], a[100:103], v[84:87]
    s_waitcnt lgkmcnt(2)
    v_mfma_f32_16x16x32_bf16 v[76:79], v[120:123], a[132:135], v[76:79]
    v_mul_f32 v180, v180, v8
    v_mfma_f32_16x16x32_bf16 v[76:79], v[124:127], a[140:143], v[76:79]
    v_and_b32 v31, 0xffff0000, v143
    s_waitcnt lgkmcnt(0)
    v_mfma_f32_16x16x32_bf16 v[76:79], v[128:131], a[148:151], v[76:79]
    ds_read_b128 v[104:107], v14 offset:18432
    v_mfma_f32_16x16x32_bf16 v[76:79], v[132:135], a[156:159], v[76:79]
    ds_read_b128 v[108:111], v14 offset:22528
    v_lshlrev_b32 v30, 16, v143
    v_mfma_f32_16x16x32_bf16 v[72:75], v[132:135], a[152:155], v[72:75]
    ds_read_b128 v[112:115], v14 offset:26624
    v_mfma_f32_16x16x32_bf16 v[72:75], v[128:131], a[144:147], v[72:75]
    ds_read_b128 v[116:119], v14 offset:30720
    v_mul_f32 v183, v183, v31
    v_mfma_f32_16x16x32_bf16 v[72:75], v[124:127], a[136:139], v[72:75]
    v_mfma_f32_16x16x32_bf16 v[72:75], v[120:123], a[128:131], v[72:75]
    v_mul_f32 v182, v182, v30
    s_waitcnt lgkmcnt(2)
    v_mfma_f32_16x16x32_bf16 v[80:83], v[104:107], a[128:131], v[80:83]
    v_mfma_f32_16x16x32_bf16 v[80:83], v[108:111], a[136:139], v[80:83]
    s_waitcnt lgkmcnt(0)
    v_mfma_f32_16x16x32_bf16 v[80:83], v[112:115], a[144:147], v[80:83]
    ds_read_b128 v[120:123], v14 offset:19456
    v_mfma_f32_16x16x32_bf16 v[80:83], v[116:119], a[152:155], v[80:83]
    ds_read_b128 v[124:127], v14 offset:23552
    v_mfma_f32_16x16x32_bf16 v[84:87], v[116:119], a[156:159], v[84:87]
    ds_read_b128 v[128:131], v14 offset:27648
    v_mfma_f32_16x16x32_bf16 v[84:87], v[112:115], a[148:151], v[84:87]
    ds_read_b128 v[132:135], v14 offset:31744
    v_mfma_f32_16x16x32_bf16 v[84:87], v[108:111], a[140:143], v[84:87]
    v_mfma_f32_16x16x32_bf16 v[84:87], v[104:107], a[132:135], v[84:87]
    s_waitcnt lgkmcnt(2)
    v_mfma_f32_16x16x32_bf16 v[76:79], v[120:123], a[164:167], v[76:79]
    s_add_u32 m0, s73, 97792
    v_mfma_f32_16x16x32_bf16 v[76:79], v[124:127], a[172:175], v[76:79]
    buffer_load_dwordx4 v19, s[44:47], s18 offen offset:512 sc1 lds
    s_waitcnt lgkmcnt(0)
    v_mfma_f32_16x16x32_bf16 v[76:79], v[128:131], a[180:183], v[76:79]
    s_waitcnt vmcnt(15)
    s_barrier
    v_mfma_f32_16x16x32_bf16 v[76:79], v[132:135], a[188:191], v[76:79]
    ds_read_b128 v[104:107], v14 offset:32768
    v_mfma_f32_16x16x32_bf16 v[72:75], v[132:135], a[184:187], v[72:75]
    ds_read_b128 v[108:111], v14 offset:36864
    v_mfma_f32_16x16x32_bf16 v[72:75], v[128:131], a[176:179], v[72:75]
    ds_read_b128 v[112:115], v14 offset:40960
    v_mfma_f32_16x16x32_bf16 v[72:75], v[124:127], a[168:171], v[72:75]
    ds_read_b128 v[116:119], v14 offset:45056
    s_add_u32 m0, s73, 99328
    v_mfma_f32_16x16x32_bf16 v[72:75], v[120:123], a[160:163], v[72:75]
    buffer_load_dwordx4 v19, s[44:47], s19 offen offset:0 sc1 lds
    s_waitcnt lgkmcnt(2)
    v_mfma_f32_16x16x32_bf16 v[80:83], v[104:107], a[160:163], v[80:83]
    s_add_u32 m0, s73, 99840
    v_mfma_f32_16x16x32_bf16 v[80:83], v[108:111], a[168:171], v[80:83]
    buffer_load_dwordx4 v19, s[44:47], s19 offen offset:512 sc1 lds
    s_waitcnt lgkmcnt(0)
    v_mfma_f32_16x16x32_bf16 v[80:83], v[112:115], a[176:179], v[80:83]
    ds_read_b128 v[120:123], v14 offset:33792
    v_mfma_f32_16x16x32_bf16 v[80:83], v[116:119], a[184:187], v[80:83]
    ds_read_b128 v[124:127], v14 offset:37888
    v_mfma_f32_16x16x32_bf16 v[84:87], v[116:119], a[188:191], v[84:87]
    ds_read_b128 v[128:131], v14 offset:41984
    v_mfma_f32_16x16x32_bf16 v[84:87], v[112:115], a[180:183], v[84:87]
    ds_read_b128 v[132:135], v14 offset:46080
    v_mfma_f32_16x16x32_bf16 v[84:87], v[108:111], a[172:175], v[84:87]
    s_add_u32 m0, s73, 101376
    v_mfma_f32_16x16x32_bf16 v[84:87], v[104:107], a[164:167], v[84:87]
    buffer_load_dwordx4 v19, s[44:47], s20 offen offset:0 sc1 lds
    s_waitcnt lgkmcnt(2)
    v_mfma_f32_16x16x32_bf16 v[76:79], v[120:123], a[196:199], v[76:79]
    s_add_u32 m0, s73, 114176
    v_mov_b32 v141, 0
    v_mfma_f32_16x16x32_bf16 v[76:79], v[124:127], a[204:207], v[76:79]
    buffer_load_dwordx4 v19, s[44:47], s20 offen offset:512 sc1 lds
    s_waitcnt lgkmcnt(0)
    v_mfma_f32_16x16x32_bf16 v[76:79], v[128:131], a[212:215], v[76:79]
    ds_read_b128 v[104:107], v14 offset:34816
    v_mfma_f32_16x16x32_bf16 v[76:79], v[132:135], a[220:223], v[76:79]
    ds_read_b128 v[108:111], v14 offset:38912
    buffer_atomic_add v141, v139, s[44:47], s11 offen offset:2060 sc0 sc1
    v_mfma_f32_16x16x32_bf16 v[72:75], v[132:135], a[216:219], v[72:75]
    ds_read_b128 v[112:115], v14 offset:43008
    v_mfma_f32_16x16x32_bf16 v[72:75], v[128:131], a[208:211], v[72:75]
    ds_read_b128 v[116:119], v14 offset:47104
    v_mfma_f32_16x16x32_bf16 v[72:75], v[124:127], a[200:203], v[72:75]
    s_add_u32 m0, s73, 115712
    v_mfma_f32_16x16x32_bf16 v[72:75], v[120:123], a[192:195], v[72:75]
    buffer_load_dwordx4 v19, s[44:47], s21 offen offset:0 sc1 lds
    s_waitcnt lgkmcnt(2)
    v_mfma_f32_16x16x32_bf16 v[80:83], v[104:107], a[192:195], v[80:83]
    s_add_u32 m0, s73, 116224
    v_mfma_f32_16x16x32_bf16 v[80:83], v[108:111], a[200:203], v[80:83]
    buffer_load_dwordx4 v19, s[44:47], s21 offen offset:512 sc1 lds
    s_waitcnt lgkmcnt(0)
    v_mfma_f32_16x16x32_bf16 v[80:83], v[112:115], a[208:211], v[80:83]
    ds_read_b128 v[120:123], v14 offset:35840
    v_mfma_f32_16x16x32_bf16 v[80:83], v[116:119], a[216:219], v[80:83]
    ds_read_b128 v[124:127], v14 offset:39936
    v_mfma_f32_16x16x32_bf16 v[84:87], v[116:119], a[220:223], v[84:87]
    ds_read_b128 v[128:131], v14 offset:44032
    v_mfma_f32_16x16x32_bf16 v[84:87], v[112:115], a[212:215], v[84:87]
    ds_read_b128 v[132:135], v14 offset:48128
    v_mfma_f32_16x16x32_bf16 v[84:87], v[108:111], a[204:207], v[84:87]
    s_add_u32 m0, s73, 117760
    v_mfma_f32_16x16x32_bf16 v[84:87], v[104:107], a[196:199], v[84:87]
    buffer_load_dwordx4 v19, s[44:47], s22 offen offset:0 sc1 lds
    s_waitcnt lgkmcnt(2)
    v_mfma_f32_16x16x32_bf16 v[76:79], v[120:123], a[228:231], v[76:79]
    v_mfma_f32_16x16x32_bf16 v[76:79], v[124:127], a[236:239], v[76:79]
    s_waitcnt lgkmcnt(0)
    v_mfma_f32_16x16x32_bf16 v[76:79], v[128:131], a[244:247], v[76:79]
    s_waitcnt vmcnt(16)
    s_barrier
    v_mfma_f32_16x16x32_bf16 v[76:79], v[132:135], a[252:255], v[76:79]
    ds_read_b128 v[104:107], v14 offset:49152
    v_mfma_f32_16x16x32_bf16 v[72:75], v[132:135], a[248:251], v[72:75]
    ds_read_b128 v[108:111], v14 offset:53248
    v_mfma_f32_16x16x32_bf16 v[72:75], v[128:131], a[240:243], v[72:75]
    ds_read_b128 v[112:115], v14 offset:57344
    v_mfma_f32_16x16x32_bf16 v[72:75], v[124:127], a[232:235], v[72:75]
    ds_read_b128 v[116:119], v14 offset:61440
    v_mfma_f32_16x16x32_bf16 v[72:75], v[120:123], a[224:227], v[72:75]
    s_waitcnt lgkmcnt(2)
    v_mfma_f32_16x16x32_bf16 v[80:83], v[104:107], a[224:227], v[80:83]
    s_add_u32 m0, s73, 130560
    v_mfma_f32_16x16x32_bf16 v[80:83], v[108:111], a[232:235], v[80:83]
    buffer_load_dwordx4 v19, s[44:47], s22 offen offset:512 sc1 lds
    s_waitcnt lgkmcnt(0)
    v_mfma_f32_16x16x32_bf16 v[80:83], v[112:115], a[240:243], v[80:83]
    ds_read_b128 v[120:123], v14 offset:50176
    v_mfma_f32_16x16x32_bf16 v[80:83], v[116:119], a[248:251], v[80:83]
    ds_read_b128 v[124:127], v14 offset:54272
    v_mfma_f32_16x16x32_bf16 v[84:87], v[116:119], a[252:255], v[84:87]
    ds_read_b128 v[128:131], v14 offset:58368
    v_mfma_f32_16x16x32_bf16 v[84:87], v[112:115], a[244:247], v[84:87]
    ds_read_b128 v[132:135], v14 offset:62464
    v_mfma_f32_16x16x32_bf16 v[84:87], v[108:111], a[236:239], v[84:87]
    s_add_u32 m0, s73, 132096
    v_mfma_f32_16x16x32_bf16 v[84:87], v[104:107], a[228:231], v[84:87]
    buffer_load_dwordx4 v19, s[44:47], s23 offen offset:0 sc1 lds
    s_waitcnt lgkmcnt(2)
    v_mfma_f32_16x16x32_bf16 v[76:79], v[120:123], v[224:227], v[76:79]
    s_add_u32 m0, s73, 132608
    s_waitcnt vmcnt(15)
    v_bitop3_b32 v43, v43, v47, s68 bitop3:0x7e
    v_bitop3_b32 v43, v43, v51, s68 bitop3:0xf6
    v_cmp_ne_u32 vcc, 0, v43
    v_mfma_f32_16x16x32_bf16 v[76:79], v[124:127], v[232:235], v[76:79]
    buffer_load_dwordx4 v19, s[44:47], s23 offen offset:512 sc1 lds
    s_waitcnt lgkmcnt(0)
    v_mfma_f32_16x16x32_bf16 v[76:79], v[128:131], v[240:243], v[76:79]
    ds_read_b128 v[104:107], v14 offset:51200
    s_cbranch_vccnz L_xs_a
L_xo_a:
    v_and_b32 v89, 0xffff0000, v40
    v_mfma_f32_16x16x32_bf16 v[76:79], v[132:135], v[248:251], v[76:79]
    ds_read_b128 v[108:111], v14 offset:55296
    v_lshlrev_b32 v88, 16, v40
    v_mfma_f32_16x16x32_bf16 v[72:75], v[132:135], v[244:247], v[72:75]
    ds_read_b128 v[112:115], v14 offset:59392
    v_and_b32 v91, 0xffff0000, v41
    v_mfma_f32_16x16x32_bf16 v[72:75], v[128:131], v[236:239], v[72:75]
    ds_read_b128 v[116:119], v14 offset:63488
    v_lshlrev_b32 v90, 16, v41
    v_mfma_f32_16x16x32_bf16 v[72:75], v[124:127], v[228:231], v[72:75]
    s_add_u32 m0, s73, 134144
    v_and_b32 v93, 0xffff0000, v42
    v_lshlrev_b32 v92, 16, v42
    v_mfma_f32_16x16x32_bf16 v[72:75], v[120:123], v[220:223], v[72:75]
    buffer_load_dwordx4 v19, s[44:47], s24 offen offset:0 sc1 lds
    s_waitcnt lgkmcnt(2)
    v_mfma_f32_16x16x32_bf16 v[80:83], v[104:107], v[220:223], v[80:83]
    v_and_b32 v95, 0xffff0000, v44
    v_lshlrev_b32 v94, 16, v44
    v_mfma_f32_16x16x32_bf16 v[80:83], v[108:111], v[228:231], v[80:83]
    v_and_b32 v97, 0xffff0000, v45
    s_waitcnt lgkmcnt(0)
    v_mfma_f32_16x16x32_bf16 v[80:83], v[112:115], v[236:239], v[80:83]
    ds_read_b128 v[120:123], v14 offset:52224
    v_lshlrev_b32 v96, 16, v45
    v_mfma_f32_16x16x32_bf16 v[80:83], v[116:119], v[244:247], v[80:83]
    ds_read_b128 v[124:127], v14 offset:56320
    v_and_b32 v99, 0xffff0000, v46
    v_lshlrev_b32 v98, 16, v46
    v_mfma_f32_16x16x32_bf16 v[84:87], v[116:119], v[248:251], v[84:87]
    ds_read_b128 v[128:131], v14 offset:60416
    s_waitcnt vmcnt(7)
    v_and_b32 v101, 0xffff0000, v48
    v_mfma_f32_16x16x32_bf16 v[84:87], v[112:115], v[240:243], v[84:87]
    ds_read_b128 v[132:135], v14 offset:64512
    v_lshlrev_b32 v100, 16, v48
    v_cmp_ne_u32 vcc, v140, v141
    v_mfma_f32_16x16x32_bf16 v[84:87], v[108:111], v[232:235], v[84:87]
    v_and_b32 v103, 0xffff0000, v49
    v_lshlrev_b32 v102, 16, v49
    v_mfma_f32_16x16x32_bf16 v[84:87], v[104:107], v[224:227], v[84:87]
    s_cbranch_vccnz L_as_b
L_ao_b:
    s_waitcnt lgkmcnt(2)
    v_mfma_f32_16x16x32_bf16 v[92:95], v[120:123], a[4:7], v[92:95]
    buffer_load_dwordx4 v[56:59], v136, s[44:47], s11 offen offset:0 sc1
    v_mfma_f32_16x16x32_bf16 v[92:95], v[124:127], a[12:15], v[92:95]
    s_waitcnt lgkmcnt(0)
    v_mfma_f32_16x16x32_bf16 v[92:95], v[128:131], a[20:23], v[92:95]
    buffer_load_dwordx4 v[60:63], v136, s[44:47], s11 offen offset:1024 sc1
    s_barrier
    v_mfma_f32_16x16x32_bf16 v[92:95], v[132:135], a[28:31], v[92:95]
    ds_read_b128 v[104:107], v14 offset:0
    buffer_load_dwordx4 v[64:67], v136, s[44:47], s11 offen offset:2048 sc1
    v_mfma_f32_16x16x32_bf16 v[88:91], v[132:135], a[24:27], v[88:91]
    ds_read_b128 v[108:111], v14 offset:4096
    v_cvt_pk_bf16_f32 v192, v72, v73
    v_mfma_f32_16x16x32_bf16 v[88:91], v[128:131], a[16:19], v[88:91]
    ds_read_b128 v[112:115], v14 offset:8192
    v_cvt_pk_bf16_f32 v193, v74, v75
    v_mfma_f32_16x16x32_bf16 v[88:91], v[124:127], a[8:11], v[88:91]
    ds_read_b128 v[116:119], v14 offset:12288
    v_cvt_pk_bf16_f32 v194, v76, v77
    v_mfma_f32_16x16x32_bf16 v[88:91], v[120:123], a[0:3], v[88:91]
    buffer_store_dwordx4 v[192:195], v136, s[44:47], s31 offen offset:0 sc1
L_pl_D_2:
    s_cbranch_execz L_wret
    s_waitcnt lgkmcnt(2)
    v_mfma_f32_16x16x32_bf16 v[96:99], v[104:107], a[0:3], v[96:99]
    s_add_u32 m0, s73, 146944
    v_cvt_pk_bf16_f32 v196, v78, v79
    v_cvt_pk_bf16_f32 v197, v80, v81
    v_mfma_f32_16x16x32_bf16 v[96:99], v[108:111], a[8:11], v[96:99]
    buffer_load_dwordx4 v19, s[44:47], s24 offen offset:512 sc1 lds
    s_waitcnt lgkmcnt(0)
    v_mfma_f32_16x16x32_bf16 v[96:99], v[112:115], a[16:19], v[96:99]
    ds_read_b128 v[120:123], v14 offset:1024
    v_cvt_pk_bf16_f32 v198, v82, v83
    v_mfma_f32_16x16x32_bf16 v[96:99], v[116:119], a[24:27], v[96:99]
    buffer_store_dwordx4 v[196:199], v136, s[44:47], s31 offen offset:1024 sc1
    ds_read_b128 v[124:127], v14 offset:5120
    v_bitop3_b32 v207, v207, v211, s36 bitop3:0x7e
    v_bitop3_b32 v207, v207, v215, s36 bitop3:0xf6
    v_mfma_f32_16x16x32_bf16 v[100:103], v[116:119], a[28:31], v[100:103]
    ds_read_b128 v[128:131], v14 offset:9216
    v_cvt_pk_bf16_f32 v200, v84, v85
    v_mfma_f32_16x16x32_bf16 v[100:103], v[112:115], a[20:23], v[100:103]
    ds_read_b128 v[132:135], v14 offset:13312
    v_cvt_pk_bf16_f32 v201, v86, v87
    v_mfma_f32_16x16x32_bf16 v[100:103], v[108:111], a[12:15], v[100:103]
    buffer_store_dwordx4 v[200:203], v136, s[44:47], s31 offen offset:2048 sc1
    s_add_u32 m0, s73, 148480
    v_bitop3_b32 v207, v207, v219, s36 bitop3:0xf6
    v_cmp_ne_u32 vcc, 0, v207
    v_mfma_f32_16x16x32_bf16 v[100:103], v[104:107], a[4:7], v[100:103]
    buffer_load_dwordx4 v19, s[44:47], s25 offen offset:0 sc1 lds
    s_waitcnt lgkmcnt(2)
    v_mfma_f32_16x16x32_bf16 v[92:95], v[120:123], a[36:39], v[92:95]
    s_add_u32 m0, s73, 148992
    s_cbranch_vccnz L_xs_8
L_xo_8:
    v_mfma_f32_16x16x32_bf16 v[92:95], v[124:127], a[44:47], v[92:95]
    buffer_load_dwordx4 v19, s[44:47], s25 offen offset:512 sc1 lds
    s_waitcnt lgkmcnt(0)
    v_mfma_f32_16x16x32_bf16 v[92:95], v[128:131], a[52:55], v[92:95]
    ds_read_b128 v[104:107], v14 offset:2048
    v_and_b32 v33, 0xffff0000, v204
    v_mfma_f32_16x16x32_bf16 v[92:95], v[132:135], a[60:63], v[92:95]
    ds_read_b128 v[108:111], v14 offset:6144
    v_lshlrev_b32 v32, 16, v204
    v_mfma_f32_16x16x32_bf16 v[88:91], v[132:135], a[56:59], v[88:91]
    ds_read_b128 v[112:115], v14 offset:10240
    v_and_b32 v35, 0xffff0000, v205
    v_mfma_f32_16x16x32_bf16 v[88:91], v[128:131], a[48:51], v[88:91]
    ds_read_b128 v[116:119], v14 offset:14336
    v_mfma_f32_16x16x32_bf16 v[88:91], v[124:127], a[40:43], v[88:91]
    s_add_u32 m0, s73, 150528
    v_lshlrev_b32 v34, 16, v205
    v_mfma_f32_16x16x32_bf16 v[88:91], v[120:123], a[32:35], v[88:91]
    buffer_load_dwordx4 v19, s[44:47], s26 offen offset:0 sc1 lds
    s_waitcnt lgkmcnt(2)
    v_mfma_f32_16x16x32_bf16 v[96:99], v[104:107], a[32:35], v[96:99]
    v_add_f32 v32, v32, v27
    v_mfma_f32_16x16x32_bf16 v[96:99], v[108:111], a[40:43], v[96:99]
    v_add_f32 v33, v33, v27
    s_waitcnt lgkmcnt(0)
    v_mfma_f32_16x16x32_bf16 v[96:99], v[112:115], a[48:51], v[96:99]
    ds_read_b128 v[120:123], v14 offset:3072
    v_add_f32 v34, v34, v27
    v_mfma_f32_16x16x32_bf16 v[96:99], v[116:119], a[56:59], v[96:99]
    ds_read_b128 v[124:127], v14 offset:7168
    v_mfma_f32_16x16x32_bf16 v[100:103], v[116:119], a[60:63], v[100:103]
    ds_read_b128 v[128:131], v14 offset:11264
    v_add_f32 v35, v35, v27
    v_mfma_f32_16x16x32_bf16 v[100:103], v[112:115], a[52:55], v[100:103]
    ds_read_b128 v[132:135], v14 offset:15360
    v_and_b32 v37, 0xffff0000, v208
    v_mfma_f32_16x16x32_bf16 v[100:103], v[108:111], a[44:47], v[100:103]
    v_mfma_f32_16x16x32_bf16 v[100:103], v[104:107], a[36:39], v[100:103]
    v_lshlrev_b32 v36, 16, v208
    s_waitcnt lgkmcnt(2)
    v_mfma_f32_16x16x32_bf16 v[92:95], v[120:123], a[68:71], v[92:95]
    v_and_b32 v39, 0xffff0000, v209
    v_mfma_f32_16x16x32_bf16 v[92:95], v[124:127], a[76:79], v[92:95]
    s_waitcnt lgkmcnt(0)
    v_mfma_f32_16x16x32_bf16 v[92:95], v[128:131], a[84:87], v[92:95]
    s_waitcnt vmcnt(14)
    s_barrier
    v_lshlrev_b32 v38, 16, v209
    v_mfma_f32_16x16x32_bf16 v[92:95], v[132:135], a[92:95], v[92:95]
    ds_read_b128 v[104:107], v14 offset:16384
    v_add_f32 v32, v32, v36
    v_mfma_f32_16x16x32_bf16 v[88:91], v[132:135], a[88:91], v[88:91]
    ds_read_b128 v[108:111], v14 offset:20480
    v_mfma_f32_16x16x32_bf16 v[88:91], v[128:131], a[80:83], v[88:91]
    ds_read_b128 v[112:115], v14 offset:24576
    v_add_f32 v33, v33, v37
    v_mfma_f32_16x16x32_bf16 v[88:91], v[124:127], a[72:75], v[88:91]
    ds_read_b128 v[116:119], v14 offset:28672
    v_add_f32 v34, v34, v38
    v_mfma_f32_16x16x32_bf16 v[88:91], v[120:123], a[64:67], v[88:91]
    s_waitcnt lgkmcnt(2)
    v_mfma_f32_16x16x32_bf16 v[96:99], v[104:107], a[64:67], v[96:99]
    s_add_u32 m0, s73, 97792
    v_add_f32 v35, v35, v39
    v_mfma_f32_16x16x32_bf16 v[96:99], v[108:111], a[72:75], v[96:99]
    buffer_load_dwordx4 v19, s[44:47], s26 offen offset:512 sc1 lds
    s_waitcnt lgkmcnt(0)
    v_mfma_f32_16x16x32_bf16 v[96:99], v[112:115], a[80:83], v[96:99]
    ds_read_b128 v[120:123], v14 offset:17408
    v_and_b32 v37, 0xffff0000, v212
    v_mfma_f32_16x16x32_bf16 v[96:99], v[116:119], a[88:91], v[96:99]
    ds_read_b128 v[124:127], v14 offset:21504
    v_lshlrev_b32 v36, 16, v212
    v_mfma_f32_16x16x32_bf16 v[100:103], v[116:119], a[92:95], v[100:103]
    ds_read_b128 v[128:131], v14 offset:25600
    v_and_b32 v39, 0xffff0000, v213
    v_mfma_f32_16x16x32_bf16 v[100:103], v[112:115], a[84:87], v[100:103]
    ds_read_b128 v[132:135], v14 offset:29696
    v_mfma_f32_16x16x32_bf16 v[100:103], v[108:111], a[76:79], v[100:103]
    v_lshlrev_b32 v38, 16, v213
    v_mfma_f32_16x16x32_bf16 v[100:103], v[104:107], a[68:71], v[100:103]
    v_add_f32 v32, v32, v36
    s_waitcnt lgkmcnt(2)
    v_mfma_f32_16x16x32_bf16 v[92:95], v[120:123], a[100:103], v[92:95]
    v_mfma_f32_16x16x32_bf16 v[92:95], v[124:127], a[108:111], v[92:95]
    v_add_f32 v33, v33, v37
    s_waitcnt lgkmcnt(0)
    v_mfma_f32_16x16x32_bf16 v[92:95], v[128:131], a[116:119], v[92:95]
    ds_read_b128 v[104:107], v14 offset:18432
    v_add_f32 v34, v34, v38
    v_mfma_f32_16x16x32_bf16 v[92:95], v[132:135], a[124:127], v[92:95]
    ds_read_b128 v[108:111], v14 offset:22528
    v_add_f32 v35, v35, v39
    v_mfma_f32_16x16x32_bf16 v[88:91], v[132:135], a[120:123], v[88:91]
    ds_read_b128 v[112:115], v14 offset:26624
    v_and_b32 v37, 0xffff0000, v216
    v_mfma_f32_16x16x32_bf16 v[88:91], v[128:131], a[112:115], v[88:91]
    ds_read_b128 v[116:119], v14 offset:30720
    v_lshlrev_b32 v36, 16, v216
    v_mfma_f32_16x16x32_bf16 v[88:91], v[124:127], a[104:107], v[88:91]
    v_and_b32 v39, 0xffff0000, v217
    v_lshlrev_b32 v38, 16, v217
    v_mfma_f32_16x16x32_bf16 v[88:91], v[120:123], a[96:99], v[88:91]
    v_add_f32 v32, v32, v36
    s_waitcnt lgkmcnt(2)
    v_mfma_f32_16x16x32_bf16 v[96:99], v[104:107], a[96:99], v[96:99]
    v_add_f32 v33, v33, v37
    v_add_f32 v34, v34, v38
    v_mfma_f32_16x16x32_bf16 v[96:99], v[108:111], a[104:107], v[96:99]
    v_add_f32 v35, v35, v39
    s_waitcnt lgkmcnt(0)
    v_mfma_f32_16x16x32_bf16 v[96:99], v[112:115], a[112:115], v[96:99]
    ds_read_b128 v[120:123], v14 offset:19456
    v_mul_f32 v36, s38, v32
    v_mfma_f32_16x16x32_bf16 v[96:99], v[116:119], a[120:123], v[96:99]
    ds_read_b128 v[124:127], v14 offset:23552
    v_mul_f32 v37, s38, v33
    v_mfma_f32_16x16x32_bf16 v[100:103], v[116:119], a[124:127], v[100:103]
    ds_read_b128 v[128:131], v14 offset:27648
    v_mul_f32 v38, s38, v34
    v_mfma_f32_16x16x32_bf16 v[100:103], v[112:115], a[116:119], v[100:103]
    ds_read_b128 v[132:135], v14 offset:31744
    v_mul_f32 v39, s38, v35
    v_mfma_f32_16x16x32_bf16 v[100:103], v[108:111], a[108:111], v[100:103]
    v_exp_f32 v36, v36
    v_mfma_f32_16x16x32_bf16 v[100:103], v[104:107], a[100:103], v[100:103]
    s_waitcnt lgkmcnt(2)
    v_mfma_f32_16x16x32_bf16 v[92:95], v[120:123], a[132:135], v[92:95]
    v_exp_f32 v37, v37
    v_mfma_f32_16x16x32_bf16 v[92:95], v[124:127], a[140:143], v[92:95]
    s_waitcnt lgkmcnt(0)
    v_mfma_f32_16x16x32_bf16 v[92:95], v[128:131], a[148:151], v[92:95]
    s_waitcnt vmcnt(11)
    s_barrier
    v_mfma_f32_16x16x32_bf16 v[92:95], v[132:135], a[156:159], v[92:95]
    ds_read_b128 v[104:107], v14 offset:32768
    v_mfma_f32_16x16x32_bf16 v[88:91], v[132:135], a[152:155], v[88:91]
    ds_read_b128 v[108:111], v14 offset:36864
    v_exp_f32 v38, v38
    v_mfma_f32_16x16x32_bf16 v[88:91], v[128:131], a[144:147], v[88:91]
    ds_read_b128 v[112:115], v14 offset:40960
    v_exp_f32 v39, v39
    v_mfma_f32_16x16x32_bf16 v[88:91], v[124:127], a[136:139], v[88:91]
    ds_read_b128 v[116:119], v14 offset:45056
    v_mul_f32 v180, v180, v32
    v_mfma_f32_16x16x32_bf16 v[88:91], v[120:123], a[128:131], v[88:91]
    v_mul_f32 v181, v181, v33
    s_waitcnt lgkmcnt(2)
    v_mfma_f32_16x16x32_bf16 v[96:99], v[104:107], a[128:131], v[96:99]
    v_mul_f32 v182, v182, v34
    v_mul_f32 v183, v183, v35
    v_mfma_f32_16x16x32_bf16 v[96:99], v[108:111], a[136:139], v[96:99]
    v_add_f32 v36, 1.0, v36
    s_waitcnt lgkmcnt(0)
    v_mfma_f32_16x16x32_bf16 v[96:99], v[112:115], a[144:147], v[96:99]
    ds_read_b128 v[120:123], v14 offset:33792
    v_add_f32 v37, 1.0, v37
    v_mfma_f32_16x16x32_bf16 v[96:99], v[116:119], a[152:155], v[96:99]
    ds_read_b128 v[124:127], v14 offset:37888
    v_add_f32 v38, 1.0, v38
    v_mfma_f32_16x16x32_bf16 v[100:103], v[116:119], a[156:159], v[100:103]
    ds_read_b128 v[128:131], v14 offset:41984
    v_add_f32 v39, 1.0, v39
    v_mfma_f32_16x16x32_bf16 v[100:103], v[112:115], a[148:151], v[100:103]
    ds_read_b128 v[132:135], v14 offset:46080
    v_rcp_f32 v36, v36
    v_mfma_f32_16x16x32_bf16 v[100:103], v[108:111], a[140:143], v[100:103]
    v_rcp_f32 v37, v37
    v_mfma_f32_16x16x32_bf16 v[100:103], v[104:107], a[132:135], v[100:103]
    v_rcp_f32 v38, v38
    s_waitcnt lgkmcnt(2)
    v_mfma_f32_16x16x32_bf16 v[92:95], v[120:123], a[164:167], v[92:95]
    s_waitcnt vmcnt(8)
    v_bitop3_b32 v59, v59, v63, s68 bitop3:0x7e
    v_rcp_f32 v39, v39
    v_mfma_f32_16x16x32_bf16 v[92:95], v[124:127], a[172:175], v[92:95]
    buffer_load_dwordx4 v[72:75], v136, s[44:47], s12 offen offset:0 sc1
    s_waitcnt lgkmcnt(0)
    v_mfma_f32_16x16x32_bf16 v[92:95], v[128:131], a[180:183], v[92:95]
    ds_read_b128 v[104:107], v14 offset:34816
    v_bitop3_b32 v59, v59, v67, s68 bitop3:0xf6
    v_mfma_f32_16x16x32_bf16 v[92:95], v[132:135], a[188:191], v[92:95]
    ds_read_b128 v[108:111], v14 offset:38912
    v_cmp_ne_u32 vcc, 0, v59
    v_mfma_f32_16x16x32_bf16 v[88:91], v[132:135], a[184:187], v[88:91]
    ds_read_b128 v[112:115], v14 offset:43008
    buffer_load_dwordx4 v[76:79], v136, s[44:47], s12 offen offset:1024 sc1
    v_mfma_f32_16x16x32_bf16 v[88:91], v[128:131], a[176:179], v[88:91]
    ds_read_b128 v[116:119], v14 offset:47104
    s_cbranch_vccnz L_xs_b
L_xo_b:
    v_fma_f32 v180, v180, v36, v160
    v_mfma_f32_16x16x32_bf16 v[88:91], v[124:127], a[168:171], v[88:91]
    buffer_load_dwordx4 v[80:83], v136, s[44:47], s12 offen offset:2048 sc1
    v_and_b32 v41, 0xffff0000, v56
    v_mfma_f32_16x16x32_bf16 v[88:91], v[120:123], a[160:163], v[88:91]
    v_lshlrev_b32 v40, 16, v56
    s_waitcnt lgkmcnt(2)
    v_mfma_f32_16x16x32_bf16 v[96:99], v[104:107], a[160:163], v[96:99]
    v_and_b32 v43, 0xffff0000, v57
    v_fma_f32 v181, v181, v37, v161
    v_mfma_f32_16x16x32_bf16 v[96:99], v[108:111], a[168:171], v[96:99]
    v_lshlrev_b32 v42, 16, v57
    s_waitcnt lgkmcnt(0)
    v_mfma_f32_16x16x32_bf16 v[96:99], v[112:115], a[176:179], v[96:99]
    ds_read_b128 v[120:123], v14 offset:35840
    v_and_b32 v45, 0xffff0000, v58
    v_mfma_f32_16x16x32_bf16 v[96:99], v[116:119], a[184:187], v[96:99]
    ds_read_b128 v[124:127], v14 offset:39936
    v_fma_f32 v182, v182, v38, v162
    v_mfma_f32_16x16x32_bf16 v[100:103], v[116:119], a[188:191], v[100:103]
    ds_read_b128 v[128:131], v14 offset:44032
    v_lshlrev_b32 v44, 16, v58
    v_mfma_f32_16x16x32_bf16 v[100:103], v[112:115], a[180:183], v[100:103]
    ds_read_b128 v[132:135], v14 offset:48128
    v_and_b32 v47, 0xffff0000, v60
    v_mfma_f32_16x16x32_bf16 v[100:103], v[108:111], a[172:175], v[100:103]
    v_lshlrev_b32 v46, 16, v60
    v_fma_f32 v183, v183, v39, v163
    v_mfma_f32_16x16x32_bf16 v[100:103], v[104:107], a[164:167], v[100:103]
    v_and_b32 v49, 0xffff0000, v61
    s_waitcnt lgkmcnt(2)
    v_mfma_f32_16x16x32_bf16 v[92:95], v[120:123], a[196:199], v[92:95]
    v_lshlrev_b32 v48, 16, v61
    v_cvt_pk_bf16_f32 v142, v180, v181
    v_mfma_f32_16x16x32_bf16 v[92:95], v[124:127], a[204:207], v[92:95]
    v_and_b32 v51, 0xffff0000, v62
    s_waitcnt lgkmcnt(0)
    v_mfma_f32_16x16x32_bf16 v[92:95], v[128:131], a[212:215], v[92:95]
    s_waitcnt vmcnt(4)
    s_barrier
    v_lshlrev_b32 v50, 16, v62
    v_mfma_f32_16x16x32_bf16 v[92:95], v[132:135], a[220:223], v[92:95]
    ds_read_b128 v[104:107], v14 offset:49152
    v_cvt_pk_bf16_f32 v143, v182, v183
    v_mfma_f32_16x16x32_bf16 v[88:91], v[132:135], a[216:219], v[88:91]
    ds_read_b128 v[108:111], v14 offset:53248
    v_and_b32 v53, 0xffff0000, v64
    v_mfma_f32_16x16x32_bf16 v[88:91], v[128:131], a[208:211], v[88:91]
    ds_read_b128 v[112:115], v14 offset:57344
    v_lshlrev_b32 v52, 16, v64
    v_mfma_f32_16x16x32_bf16 v[88:91], v[124:127], a[200:203], v[88:91]
    ds_read_b128 v[116:119], v14 offset:61440
    v_and_b32 v55, 0xffff0000, v65
    v_mfma_f32_16x16x32_bf16 v[88:91], v[120:123], a[192:195], v[88:91]
    v_lshlrev_b32 v54, 16, v65
    s_waitcnt lgkmcnt(2)
    v_mfma_f32_16x16x32_bf16 v[96:99], v[104:107], a[192:195], v[96:99]
    v_mfma_f32_16x16x32_bf16 v[96:99], v[108:111], a[200:203], v[96:99]
    s_waitcnt lgkmcnt(0)
    v_mfma_f32_16x16x32_bf16 v[96:99], v[112:115], a[208:211], v[96:99]
    ds_read_b128 v[120:123], v14 offset:50176
    v_add_f32 v92, v92, v44
    v_add_f32 v93, v93, v45
    v_mfma_f32_16x16x32_bf16 v[96:99], v[116:119], a[216:219], v[96:99]
    ds_read_b128 v[124:127], v14 offset:54272
    v_add_f32 v94, v94, v46
    v_mfma_f32_16x16x32_bf16 v[100:103], v[116:119], a[220:223], v[100:103]
    ds_read_b128 v[128:131], v14 offset:58368
    v_add_f32 v95, v95, v47
    v_add_f32 v88, v88, v40
    v_mfma_f32_16x16x32_bf16 v[100:103], v[112:115], a[212:215], v[100:103]
    ds_read_b128 v[132:135], v14 offset:62464
    v_add_f32 v89, v89, v41
    v_mfma_f32_16x16x32_bf16 v[100:103], v[108:111], a[204:207], v[100:103]
    v_add_f32 v90, v90, v42
    v_add_f32 v91, v91, v43
    v_mfma_f32_16x16x32_bf16 v[100:103], v[104:107], a[196:199], v[100:103]
    s_waitcnt lgkmcnt(2)
    v_mfma_f32_16x16x32_bf16 v[92:95], v[120:123], a[228:231], v[92:95]
    v_mfma_f32_16x16x32_bf16 v[92:95], v[124:127], a[236:239], v[92:95]
    s_waitcnt lgkmcnt(0)
    v_mfma_f32_16x16x32_bf16 v[92:95], v[128:131], a[244:247], v[92:95]
    ds_read_b128 v[104:107], v14 offset:51200
    v_add_f32 v96, v96, v48
    v_add_f32 v97, v97, v49
    v_mfma_f32_16x16x32_bf16 v[92:95], v[132:135], a[252:255], v[92:95]
    ds_read_b128 v[108:111], v14 offset:55296
    v_add_f32 v98, v98, v50
    v_mfma_f32_16x16x32_bf16 v[88:91], v[132:135], a[248:251], v[88:91]
    ds_read_b128 v[112:115], v14 offset:59392
    v_add_f32 v99, v99, v51
    v_add_f32 v100, v100, v52
    v_mfma_f32_16x16x32_bf16 v[88:91], v[128:131], a[240:243], v[88:91]
    ds_read_b128 v[116:119], v14 offset:63488
    v_add_f32 v101, v101, v53
    v_mfma_f32_16x16x32_bf16 v[88:91], v[124:127], a[232:235], v[88:91]
    v_add_f32 v102, v102, v54
    v_add_f32 v103, v103, v55
    v_mfma_f32_16x16x32_bf16 v[88:91], v[120:123], a[224:227], v[88:91]
    s_waitcnt lgkmcnt(2)
    v_mfma_f32_16x16x32_bf16 v[96:99], v[104:107], a[224:227], v[96:99]
    v_mfma_f32_16x16x32_bf16 v[96:99], v[108:111], a[232:235], v[96:99]
    s_waitcnt lgkmcnt(0)
    v_mfma_f32_16x16x32_bf16 v[96:99], v[112:115], a[240:243], v[96:99]
    ds_read_b128 v[120:123], v14 offset:52224
    v_mfma_f32_16x16x32_bf16 v[96:99], v[116:119], a[248:251], v[96:99]
    ds_read_b128 v[124:127], v14 offset:56320
    v_mfma_f32_16x16x32_bf16 v[100:103], v[116:119], a[252:255], v[100:103]
    buffer_store_dwordx2 v[142:143], v253, s[64:67], 0 offen sc1
    ds_read_b128 v[128:131], v14 offset:60416
    v_mfma_f32_16x16x32_bf16 v[100:103], v[112:115], a[244:247], v[100:103]
    ds_read_b128 v[132:135], v14 offset:64512
    v_mfma_f32_16x16x32_bf16 v[100:103], v[108:111], a[236:239], v[100:103]
    v_mfma_f32_16x16x32_bf16 v[100:103], v[104:107], a[228:231], v[100:103]
    s_waitcnt lgkmcnt(2)
    v_mfma_f32_16x16x32_bf16 v[92:95], v[120:123], v[224:227], v[92:95]
    v_mfma_f32_16x16x32_bf16 v[92:95], v[124:127], v[232:235], v[92:95]
    s_waitcnt lgkmcnt(0)
    v_mfma_f32_16x16x32_bf16 v[92:95], v[128:131], v[240:243], v[92:95]
    s_waitcnt vmcnt(4)
    s_barrier
    v_mfma_f32_16x16x32_bf16 v[92:95], v[132:135], v[248:251], v[92:95]
    ds_read_b128 v[104:107], v14 offset:0
    v_mfma_f32_16x16x32_bf16 v[88:91], v[132:135], v[244:247], v[88:91]
    ds_read_b128 v[108:111], v14 offset:4096
    v_mfma_f32_16x16x32_bf16 v[88:91], v[128:131], v[236:239], v[88:91]
    ds_read_b128 v[112:115], v14 offset:8192
    v_mfma_f32_16x16x32_bf16 v[88:91], v[124:127], v[228:231], v[88:91]
    ds_read_b128 v[116:119], v14 offset:12288
    v_mfma_f32_16x16x32_bf16 v[88:91], v[120:123], v[220:223], v[88:91]
    s_waitcnt lgkmcnt(2)
    v_mfma_f32_16x16x32_bf16 v[96:99], v[104:107], v[220:223], v[96:99]
    v_mfma_f32_16x16x32_bf16 v[96:99], v[108:111], v[228:231], v[96:99]
    s_waitcnt lgkmcnt(0)
    v_mfma_f32_16x16x32_bf16 v[96:99], v[112:115], v[236:239], v[96:99]
    v_mfma_f32_16x16x32_bf16 v[96:99], v[116:119], v[244:247], v[96:99]
    v_mfma_f32_16x16x32_bf16 v[100:103], v[116:119], v[248:251], v[100:103]
    v_mfma_f32_16x16x32_bf16 v[100:103], v[112:115], v[240:243], v[100:103]
    v_mfma_f32_16x16x32_bf16 v[100:103], v[108:111], v[232:235], v[100:103]
    v_mfma_f32_16x16x32_bf16 v[100:103], v[104:107], v[224:227], v[100:103]
    s_waitcnt vmcnt(1)
    v_bitop3_b32 v75, v75, v79, s68 bitop3:0x7e
    v_bitop3_b32 v75, v75, v83, s68 bitop3:0xf6
    v_cmp_ne_u32 vcc, 0, v75
    s_cbranch_vccnz L_xs_z
L_xo_z:
    v_and_b32 v41, 0xffff0000, v72
    v_lshlrev_b32 v40, 16, v72
    v_and_b32 v43, 0xffff0000, v73
    v_lshlrev_b32 v42, 16, v73
    v_and_b32 v45, 0xffff0000, v74
    v_lshlrev_b32 v44, 16, v74
    v_and_b32 v47, 0xffff0000, v76
    v_lshlrev_b32 v46, 16, v76
    v_and_b32 v49, 0xffff0000, v77
    v_lshlrev_b32 v48, 16, v77
    v_and_b32 v51, 0xffff0000, v78
    v_lshlrev_b32 v50, 16, v78
    v_and_b32 v53, 0xffff0000, v80
    v_lshlrev_b32 v52, 16, v80
    v_and_b32 v55, 0xffff0000, v81
    v_lshlrev_b32 v54, 16, v81
    v_pk_add_f32 v[88:89], v[88:89], v[40:41]
    v_pk_add_f32 v[90:91], v[90:91], v[42:43]
    v_pk_add_f32 v[96:97], v[96:97], v[48:49]
    v_pk_add_f32 v[98:99], v[98:99], v[50:51]
    v_pk_mul_f32 v[56:57], v[88:89], s[38:39] op_sel_hi:[1,0]
    v_pk_mul_f32 v[58:59], v[90:91], s[38:39] op_sel_hi:[1,0]
    v_pk_mul_f32 v[64:65], v[96:97], s[38:39] op_sel_hi:[1,0]
    v_pk_mul_f32 v[66:67], v[98:99], s[38:39] op_sel_hi:[1,0]
    v_exp_f32 v56, v56
    v_exp_f32 v57, v57
    v_exp_f32 v58, v58
    v_exp_f32 v59, v59
    v_exp_f32 v64, v64
    v_exp_f32 v65, v65
    v_exp_f32 v66, v66
    v_exp_f32 v67, v67
    v_pk_mul_f32 v[164:165], v[164:165], v[88:89]
    v_pk_mul_f32 v[166:167], v[166:167], v[90:91]
    v_pk_mul_f32 v[172:173], v[172:173], v[96:97]
    v_pk_mul_f32 v[174:175], v[174:175], v[98:99]
    v_pk_add_f32 v[56:57], v[56:57], 1.0 op_sel_hi:[1,0]
    v_pk_add_f32 v[58:59], v[58:59], 1.0 op_sel_hi:[1,0]
    v_pk_add_f32 v[64:65], v[64:65], 1.0 op_sel_hi:[1,0]
    v_pk_add_f32 v[66:67], v[66:67], 1.0 op_sel_hi:[1,0]
    v_rcp_f32 v56, v56
    v_rcp_f32 v57, v57
    v_rcp_f32 v58, v58
    v_rcp_f32 v59, v59
    v_rcp_f32 v64, v64
    v_rcp_f32 v65, v65
    v_rcp_f32 v66, v66
    v_rcp_f32 v67, v67
    v_pk_fma_f32 v[164:165], v[164:165], v[56:57], v[144:145]
    v_pk_fma_f32 v[166:167], v[166:167], v[58:59], v[146:147]
    v_pk_fma_f32 v[172:173], v[172:173], v[64:65], v[152:153]
    v_pk_fma_f32 v[174:175], v[174:175], v[66:67], v[154:155]
    v_cvt_pk_bf16_f32 v88, v164, v165
    v_cvt_pk_bf16_f32 v90, v172, v173
    v_cvt_pk_bf16_f32 v89, v166, v167
    v_cvt_pk_bf16_f32 v91, v174, v175
    v_permlane16_swap_b32 v88, v90
    s_nop 0
    v_permlane16_swap_b32 v89, v91
    buffer_store_dwordx4 v[88:91], v252, s[64:67], 0 offen sc1
    v_pk_add_f32 v[92:93], v[92:93], v[44:45]
    v_pk_add_f32 v[94:95], v[94:95], v[46:47]
    v_pk_add_f32 v[100:101], v[100:101], v[52:53]
    v_pk_add_f32 v[102:103], v[102:103], v[54:55]
    v_pk_mul_f32 v[60:61], v[92:93], s[38:39] op_sel_hi:[1,0]
    v_pk_mul_f32 v[62:63], v[94:95], s[38:39] op_sel_hi:[1,0]
    v_pk_mul_f32 v[68:69], v[100:101], s[38:39] op_sel_hi:[1,0]
    v_pk_mul_f32 v[70:71], v[102:103], s[38:39] op_sel_hi:[1,0]
    v_exp_f32 v60, v60
    v_exp_f32 v61, v61
    v_exp_f32 v62, v62
    v_exp_f32 v63, v63
    v_exp_f32 v68, v68
    v_exp_f32 v69, v69
    v_exp_f32 v70, v70
    v_exp_f32 v71, v71
    v_pk_mul_f32 v[168:169], v[168:169], v[92:93]
    v_pk_mul_f32 v[170:171], v[170:171], v[94:95]
    v_pk_mul_f32 v[176:177], v[176:177], v[100:101]
    v_pk_mul_f32 v[178:179], v[178:179], v[102:103]
    v_pk_add_f32 v[60:61], v[60:61], 1.0 op_sel_hi:[1,0]
    v_pk_add_f32 v[62:63], v[62:63], 1.0 op_sel_hi:[1,0]
    v_pk_add_f32 v[68:69], v[68:69], 1.0 op_sel_hi:[1,0]
    v_pk_add_f32 v[70:71], v[70:71], 1.0 op_sel_hi:[1,0]
    v_rcp_f32 v60, v60
    v_rcp_f32 v61, v61
    v_rcp_f32 v62, v62
    v_rcp_f32 v63, v63
    v_rcp_f32 v68, v68
    v_rcp_f32 v69, v69
    v_rcp_f32 v70, v70
    v_rcp_f32 v71, v71
    v_pk_fma_f32 v[168:169], v[168:169], v[60:61], v[148:149]
    v_pk_fma_f32 v[170:171], v[170:171], v[62:63], v[150:151]
    v_pk_fma_f32 v[176:177], v[176:177], v[68:69], v[156:157]
    v_pk_fma_f32 v[178:179], v[178:179], v[70:71], v[158:159]
    v_cvt_pk_bf16_f32 v92, v168, v169
    v_cvt_pk_bf16_f32 v94, v176, v177
    v_cvt_pk_bf16_f32 v93, v170, v171
    v_cvt_pk_bf16_f32 v95, v178, v179
    v_permlane16_swap_b32 v92, v94
    s_nop 0
    v_permlane16_swap_b32 v93, v95
    buffer_store_dwordx4 v[92:95], v252, s[64:67], s40 offen sc1
    s_endpgm
L_segE:
.p2align 12
L_aux:
    s_bfe_u32 s101, s2, 0x20003
    s_mul_i32 s101, s101, 3
    s_mul_i32 s84, s101, 305844
    s_lshr_b32 s84, s84, 18
    s_add_u32 s84, s84, 0
    s_add_u32 s85, s84, 1
    s_cmp_eq_u32 s85, 14
    s_cselect_b32 s85, 0, s85
    s_add_u32 s86, s85, 1
    s_cmp_eq_u32 s86, 14
    s_cselect_b32 s86, 0, s86
    s_add_u32 s87, s86, 1
    s_cmp_eq_u32 s87, 14
    s_cselect_b32 s87, 0, s87
    s_add_u32 s88, s87, 1
    s_cmp_eq_u32 s88, 14
    s_cselect_b32 s88, 0, s88
    s_add_u32 s89, s88, 1
    s_cmp_eq_u32 s89, 14
    s_cselect_b32 s89, 0, s89
    s_add_u32 s90, s89, 1
    s_cmp_eq_u32 s90, 14
    s_cselect_b32 s90, 0, s90
    s_add_u32 s91, s90, 1
    s_cmp_eq_u32 s91, 14
    s_cselect_b32 s91, 0, s91
    s_add_u32 s92, s91, 1
    s_cmp_eq_u32 s92, 14
    s_cselect_b32 s92, 0, s92
    s_add_u32 s93, s92, 1
    s_cmp_eq_u32 s93, 14
    s_cselect_b32 s93, 0, s93
    s_add_u32 s94, s93, 1
    s_cmp_eq_u32 s94, 14
    s_cselect_b32 s94, 0, s94
    s_add_u32 s95, s94, 1
    s_cmp_eq_u32 s95, 14
    s_cselect_b32 s95, 0, s95
    s_add_u32 s96, s95, 1
    s_cmp_eq_u32 s96, 14
    s_cselect_b32 s96, 0, s96
    s_add_u32 s97, s96, 1
    s_cmp_eq_u32 s97, 14
    s_cselect_b32 s97, 0, s97
    s_mul_i32 s98, s101, 87384
    s_lshr_b32 s98, s98, 18
    s_add_u32 s98, s98, 14
    s_add_u32 s99, s98, 1
    s_cmp_eq_u32 s99, 18
    s_cselect_b32 s99, 14, s99
    s_add_u32 s100, s99, 1
    s_cmp_eq_u32 s100, 18
    s_cselect_b32 s100, 14, s100
    s_add_u32 s101, s100, 1
    s_cmp_eq_u32 s101, 18
    s_cselect_b32 s101, 14, s101
    s_lshl2_add_u32 s7, s5, s6
    s_add_u32 s7, s7, 188
    s_add_u32 s8, s5, 248
    s_cmp_eq_u32 s6, 27
    s_cselect_b32 s75, s8, s7
    s_mov_b32 s48, s24
    s_and_b32 s49, s25, 0xffff
    s_mov_b32 s50, 2359296
    s_mov_b32 s51, 0x20000
    v_lshlrev_b32 v240, 4, v2
    s_mul_i32 s74, s3, 16640
    s_add_u32 s74, s74, 73728
    s_sub_u32 s69, s75, 216
    s_lshl_b32 s70, s69, 4
    s_add_u32 s70, s70, s3
    s_lshl_b32 s12, s70, 12
    s_lshl_b32 s70, s70, 1
    s_mov_b32 s9, 144896
    s_mov_b32 s11, 8192
    v_mul_u32_u24 v48, 1216, v3
    v_mad_u32_u24 v48, v4, 12, v48
    v_add_u32 v48, s9, v48
    v_mov_b32 v47, 0x40000000
    v_lshlrev_b32 v3, 3, v3
    s_lshl_b32 s5, s68, 6
    s_add_u32 s5, s5, 12386304
    v_cmp_eq_u32 vcc, 0, v4
    s_nop 1
    v_cndmask_b32 v49, v47, v3, vcc
    v_lshrrev_b32 v5, 4, v0
    v_and_b32 v4, 3, v2
    v_lshlrev_b32 v4, 3, v4
    v_lshl_add_u32 v5, v5, 5, v4
    v_bfe_u32 v6, v2, 2, 2
    v_mul_u32_u24 v4, 1216, v6
    v_mul_u32_u24 v6, 1152, v6
    v_add3_u32 v50, v4, v5, s9
    v_add3_u32 v51, v6, v5, s11
    s_mul_i32 s4, s3, 2176
    v_add_u32 v55, s4, v51
    v_lshlrev_b32 v52, 4, v0
    s_add_u32 s7, s15, 4096
    s_add_u32 s8, s15, 8192
    s_cmp_eq_u32 s3, 0
    s_cselect_b32 s8, s8, 0x40000000
    v_add_u32 v53, 2359296, v52
    v_mov_b32 v54, 0
    v_add_u32 v4, 0, v52
    v_lshrrev_b32 v5, 7, v4
    v_mul_u32_u24 v6, 9363, v5
    v_lshrrev_b32 v6, 16, v6
    v_mad_i32_i24 v5, v6, -7, v5
    v_cmp_lt_u32 vcc, 2, v5
    s_nop 1
    v_addc_co_u32 v6, vcc, 0, v6, vcc
    v_lshl_add_u32 v93, v6, 7, v4
    v_add_u32 v4, 4096, v52
    v_lshrrev_b32 v5, 7, v4
    v_mul_u32_u24 v6, 9363, v5
    v_lshrrev_b32 v6, 16, v6
    v_mad_i32_i24 v5, v6, -7, v5
    v_cmp_lt_u32 vcc, 2, v5
    s_nop 1
    v_addc_co_u32 v6, vcc, 0, v6, vcc
    v_lshl_add_u32 v94, v6, 7, v4
    v_add_u32 v4, 8192, v52
    v_lshrrev_b32 v5, 7, v4
    v_mul_u32_u24 v6, 9363, v5
    v_lshrrev_b32 v6, 16, v6
    v_mad_i32_i24 v5, v6, -7, v5
    v_cmp_lt_u32 vcc, 2, v5
    s_nop 1
    v_addc_co_u32 v6, vcc, 0, v6, vcc
    v_lshl_add_u32 v95, v6, 7, v4
    s_mul_i32 s10, s68, 11264
    s_add_u32 s10, s10, 36585472
    s_cmp_eq_u32 s3, 0
    s_cselect_b32 s83, s10, 0x40000000
    s_add_u32 s7, s10, 2883584
    s_add_u32 s8, s83, 2883584
    s_mul_i32 s4, s3, 1028
    s_sub_u32 s4, 8204, s4
    v_add_u32 v90, s4, v53
    s_bfe_u32 s6, s68, 0x20001
    s_lshl_b32 s6, s6, 6
    s_lshr_b32 s9, s68, 3
    s_lshl1_add_u32 s6, s9, s6
    s_and_b32 s9, s68, 1
    s_add_u32 s6, s6, s9
    s_lshl_b32 s4, s6, 2
    s_add_u32 s4, s4, 12533760
    v_lshl_add_u32 v1, v0, 10, s4
    s_lshl_b32 s4, s68, 2
    s_add_u32 s4, s4, 12599296
    v_lshl_add_u32 v46, v0, 10, s4
    v_cmp_gt_u32 vcc, 8, v0
    s_nop 1
    v_cndmask_b32 v1, v47, v1, vcc
    v_cmp_gt_u32 vcc, 4, v0
    s_nop 1
    v_cndmask_b32 v46, v47, v46, vcc
    s_waitcnt vmcnt(9)
    v_and_b32 v21, 0xffff0000, v8
    v_lshlrev_b32 v20, 16, v8
    v_and_b32 v23, 0xffff0000, v9
    v_lshlrev_b32 v22, 16, v9
    v_and_b32 v25, 0xffff0000, v10
    v_lshlrev_b32 v24, 16, v10
    v_and_b32 v27, 0xffff0000, v12
    v_lshlrev_b32 v26, 16, v12
    v_and_b32 v29, 0xffff0000, v13
    v_lshlrev_b32 v28, 16, v13
    v_and_b32 v31, 0xffff0000, v14
    v_lshlrev_b32 v30, 16, v14
    v_and_b32 v33, 0xffff0000, v16
    v_lshlrev_b32 v32, 16, v16
    v_and_b32 v35, 0xffff0000, v17
    v_lshlrev_b32 v34, 16, v17
    v_and_b32 v37, 0xffff0000, v18
    v_lshlrev_b32 v36, 16, v18
    v_pk_add_f32 v[38:39], v[20:21], v[22:23]
    v_pk_add_f32 v[40:41], v[24:25], v[26:27]
    v_pk_add_f32 v[42:43], v[28:29], v[30:31]
    v_pk_add_f32 v[44:45], v[32:33], v[34:35]
    v_pk_add_f32 v[38:39], v[38:39], v[40:41]
    v_pk_add_f32 v[42:43], v[42:43], v[44:45]
    v_pk_add_f32 v[38:39], v[38:39], v[36:37]
    v_pk_add_f32 v[38:39], v[38:39], v[42:43]
    v_add_f32 v56, v38, v39
    s_nop 1
    v_add_f32_dpp v56, v56, v56 row_ror:8 row_mask:0xf bank_mask:0xf
    s_nop 1
    v_add_f32_dpp v56, v56, v56 row_ror:4 row_mask:0xf bank_mask:0xf
    s_nop 1
    v_add_f32_dpp v56, v56, v56 row_ror:2 row_mask:0xf bank_mask:0xf
    s_nop 1
    v_add_f32_dpp v56, v56, v56 row_ror:1 row_mask:0xf bank_mask:0xf
    v_mov_b32 v57, v56
    s_nop 1
    v_permlane16_swap_b32 v56, v57
    v_add_f32 v56, v56, v57
    v_mul_f32 v56, 0x3ae38e39, v56
    v_pk_add_f32 v[20:21], v[20:21], v[56:57] op_sel_hi:[1,0] neg_lo:[0,1] neg_hi:[0,1]
    v_pk_add_f32 v[22:23], v[22:23], v[56:57] op_sel_hi:[1,0] neg_lo:[0,1] neg_hi:[0,1]
    v_pk_add_f32 v[24:25], v[24:25], v[56:57] op_sel_hi:[1,0] neg_lo:[0,1] neg_hi:[0,1]
    v_pk_add_f32 v[26:27], v[26:27], v[56:57] op_sel_hi:[1,0] neg_lo:[0,1] neg_hi:[0,1]
    v_pk_add_f32 v[28:29], v[28:29], v[56:57] op_sel_hi:[1,0] neg_lo:[0,1] neg_hi:[0,1]
    v_pk_add_f32 v[30:31], v[30:31], v[56:57] op_sel_hi:[1,0] neg_lo:[0,1] neg_hi:[0,1]
    v_pk_add_f32 v[32:33], v[32:33], v[56:57] op_sel_hi:[1,0] neg_lo:[0,1] neg_hi:[0,1]
    v_pk_add_f32 v[34:35], v[34:35], v[56:57] op_sel_hi:[1,0] neg_lo:[0,1] neg_hi:[0,1]
    v_pk_add_f32 v[36:37], v[36:37], v[56:57] op_sel_hi:[1,0] neg_lo:[0,1] neg_hi:[0,1]
    v_pk_mul_f32 v[38:39], v[20:21], v[20:21]
    v_pk_mul_f32 v[40:41], v[22:23], v[22:23]
    v_pk_fma_f32 v[38:39], v[24:25], v[24:25], v[38:39]
    v_pk_fma_f32 v[40:41], v[26:27], v[26:27], v[40:41]
    v_pk_fma_f32 v[38:39], v[28:29], v[28:29], v[38:39]
    v_pk_fma_f32 v[40:41], v[30:31], v[30:31], v[40:41]
    v_pk_fma_f32 v[38:39], v[32:33], v[32:33], v[38:39]
    v_pk_fma_f32 v[40:41], v[34:35], v[34:35], v[40:41]
    v_pk_fma_f32 v[38:39], v[36:37], v[36:37], v[38:39]
    v_pk_add_f32 v[38:39], v[38:39], v[40:41]
    v_add_f32 v18, v38, v39
    s_nop 1
    v_add_f32_dpp v18, v18, v18 row_ror:8 row_mask:0xf bank_mask:0xf
    s_nop 1
    v_add_f32_dpp v18, v18, v18 row_ror:4 row_mask:0xf bank_mask:0xf
    s_nop 1
    v_add_f32_dpp v18, v18, v18 row_ror:2 row_mask:0xf bank_mask:0xf
    s_nop 1
    v_add_f32_dpp v18, v18, v18 row_ror:1 row_mask:0xf bank_mask:0xf
    v_mov_b32 v19, v18
    s_nop 1
    v_permlane16_swap_b32 v18, v19
    v_add_f32 v18, v18, v19
    v_mul_f32 v18, 0x3ae38e39, v18
    v_cvt_pk_bf16_f32 v38, v56, v18
    v_lshlrev_b32 v106, 16, v38
    v_and_b32 v38, 0xffff0000, v38
    v_add_f32 v38, 0x3727c5ac, v38
    v_sub_f32 v56, v56, v106
    v_cvt_pk_bf16_f32 v38, v38, v38
    v_lshlrev_b32 v38, 16, v38
    v_sqrt_f32 v38, v38
    s_nop 0
    v_cvt_pk_bf16_f32 v38, v38, v38
    v_lshlrev_b32 v38, 16, v38
    v_rcp_f32 v107, v38
    s_nop 0
    v_mul_f32 v56, v56, v107
    v_mul_f32 v18, v18, v107
    v_mul_f32 v18, v18, v107
    v_cvt_pk_bf16_f32 v38, v56, v18
    v_lshlrev_b32 v39, 16, v38
    v_and_b32 v38, 0xffff0000, v38
    v_add_f32 v38, 0x3727c5ac, v38
    v_sub_f32 v56, v56, v39
    v_cvt_pk_bf16_f32 v38, v38, v38
    v_lshlrev_b32 v38, 16, v38
    v_sqrt_f32 v38, v38
    s_nop 0
    v_cvt_pk_bf16_f32 v38, v38, v38
    v_lshlrev_b32 v38, 16, v38
    v_rcp_f32 v38, v38
    s_nop 0
    v_mul_f32 v18, v107, v38
    v_mul_f32 v56, v56, v38
    v_pk_fma_f32 v[20:21], v[20:21], v[18:19], v[56:57] op_sel_hi:[1,0,0]
    v_pk_fma_f32 v[22:23], v[22:23], v[18:19], v[56:57] op_sel_hi:[1,0,0]
    v_pk_fma_f32 v[24:25], v[24:25], v[18:19], v[56:57] op_sel_hi:[1,0,0]
    v_pk_fma_f32 v[26:27], v[26:27], v[18:19], v[56:57] op_sel_hi:[1,0,0]
    v_pk_fma_f32 v[28:29], v[28:29], v[18:19], v[56:57] op_sel_hi:[1,0,0]
    v_pk_fma_f32 v[30:31], v[30:31], v[18:19], v[56:57] op_sel_hi:[1,0,0]
    v_pk_fma_f32 v[32:33], v[32:33], v[18:19], v[56:57] op_sel_hi:[1,0,0]
    v_pk_fma_f32 v[34:35], v[34:35], v[18:19], v[56:57] op_sel_hi:[1,0,0]
    v_pk_fma_f32 v[36:37], v[36:37], v[18:19], v[56:57] op_sel_hi:[1,0,0]
    v_cvt_pk_bf16_f32 v8, v20, v21
    v_cvt_pk_bf16_f32 v9, v22, v23
    v_cvt_pk_bf16_f32 v10, v24, v25
    v_cvt_pk_bf16_f32 v11, v26, v27
    v_cvt_pk_bf16_f32 v12, v28, v29
    v_cvt_pk_bf16_f32 v13, v30, v31
    v_cvt_pk_bf16_f32 v14, v32, v33
    v_cvt_pk_bf16_f32 v15, v34, v35
    v_cvt_pk_bf16_f32 v16, v36, v37
    ds_write_b32 v48, v8 offset:0
    ds_write_b32 v48, v9 offset:4
    ds_write_b32 v48, v10 offset:8
    ds_write_b32 v48, v11 offset:384
    ds_write_b32 v48, v12 offset:388
    ds_write_b32 v48, v13 offset:392
    ds_write_b32 v48, v14 offset:768
    ds_write_b32 v48, v15 offset:772
    ds_write_b32 v48, v16 offset:776
    buffer_store_dwordx2 v[106:107], v49, s[44:47], s5 offen sc1
    s_waitcnt lgkmcnt(0)
    s_barrier
    ds_read_b64_tr_b16 v[20:21], v50 offset:0
    ds_read_b64_tr_b16 v[22:23], v50 offset:4864
    ds_read_b64_tr_b16 v[24:25], v50 offset:512
    ds_read_b64_tr_b16 v[26:27], v50 offset:5376
    ds_read_b64_tr_b16 v[28:29], v50 offset:1024
    ds_read_b64_tr_b16 v[30:31], v50 offset:5888
    s_waitcnt lgkmcnt(4)
    buffer_store_dwordx4 v[20:23], v93, s[44:47], s10 offen sc1
    s_waitcnt lgkmcnt(2)
    buffer_store_dwordx4 v[24:27], v94, s[44:47], s10 offen sc1
    s_waitcnt lgkmcnt(0)
    buffer_store_dwordx4 v[28:31], v95, s[44:47], s83 offen sc1
    buffer_load_dword v45, v54, s[64:67], 0 offen sc1
    s_waitcnt vmcnt(5)
    s_barrier
    ds_read_b64_tr_b16 v[60:61], v51 offset:0
    ds_read_b64_tr_b16 v[62:63], v51 offset:4608
    ds_read_b64_tr_b16 v[64:65], v51 offset:9216
    ds_read_b64_tr_b16 v[66:67], v51 offset:12672
    ds_read_b64_tr_b16 v[68:69], v51 offset:17280
    ds_read_b64_tr_b16 v[70:71], v51 offset:512
    ds_read_b64_tr_b16 v[72:73], v51 offset:5120
    ds_read_b64_tr_b16 v[74:75], v51 offset:9728
    ds_read_b64_tr_b16 v[76:77], v51 offset:13184
    ds_read_b64_tr_b16 v[78:79], v51 offset:17792
    v_alignbit_b32 v114, v99, v99, 16
    v_alignbit_b32 v115, v98, v98, 16
    s_waitcnt lgkmcnt(5)
    v_alignbit_b32 v108, v61, v60, 16
    v_alignbit_b32 v109, v62, v61, 16
    v_alignbit_b32 v110, v63, v62, 16
    v_alignbit_b32 v111, v64, v63, 16
    v_alignbit_b32 v112, v65, v64, 16
    v_dot2_f32_bf16 v116, v60, v114, 0
    ds_read_b64_tr_b16 v[80:81], v51 offset:1024
    v_dot2_f32_bf16 v117, v108, v114, 0
    v_dot2_f32_bf16 v118, v61, v114, 0
    v_dot2_f32_bf16 v119, v109, v114, 0
    v_dot2_f32_bf16 v120, v62, v114, 0
    ds_read_b64_tr_b16 v[82:83], v51 offset:5632
    v_dot2_f32_bf16 v121, v110, v114, 0
    v_dot2_f32_bf16 v122, v63, v114, 0
    v_dot2_f32_bf16 v123, v111, v114, 0
    v_dot2_f32_bf16 v116, v61, v115, v116
    v_dot2_f32_bf16 v117, v109, v115, v117
    ds_read_b64_tr_b16 v[84:85], v51 offset:10240
    v_dot2_f32_bf16 v118, v62, v115, v118
    v_dot2_f32_bf16 v119, v110, v115, v119
    v_dot2_f32_bf16 v120, v63, v115, v120
    v_dot2_f32_bf16 v121, v111, v115, v121
    v_dot2_f32_bf16 v122, v64, v115, v122
    ds_read_b64_tr_b16 v[86:87], v51 offset:13696
    v_dot2_f32_bf16 v123, v112, v115, v123
    v_and_b32 v133, 0xffff0000, v66
    v_lshlrev_b32 v132, 16, v66
    v_and_b32 v135, 0xffff0000, v67
    v_lshlrev_b32 v134, 16, v67
    ds_read_b64_tr_b16 v[88:89], v51 offset:18304
    v_and_b32 v137, 0xffff0000, v68
    v_lshlrev_b32 v136, 16, v68
    v_and_b32 v139, 0xffff0000, v69
    v_lshlrev_b32 v138, 16, v69
    v_pk_mul_f32 v[116:117], v[116:117], v[132:133]
    v_pk_mul_f32 v[118:119], v[118:119], v[134:135]
    v_pk_mul_f32 v[120:121], v[120:121], v[136:137]
    v_pk_mul_f32 v[122:123], v[122:123], v[138:139]
    v_cvt_pk_bf16_f32 v160, v123, v122
    v_cvt_pk_bf16_f32 v161, v121, v120
    v_cvt_pk_bf16_f32 v162, v119, v118
    v_cvt_pk_bf16_f32 v163, v117, v116
    buffer_store_dwordx4 v[160:163], v93, s[44:47], s7 offen sc1
    v_alignbit_b32 v114, v101, v101, 16
    v_alignbit_b32 v115, v100, v100, 16
    s_waitcnt lgkmcnt(5)
    v_alignbit_b32 v108, v71, v70, 16
    v_alignbit_b32 v109, v72, v71, 16
    v_alignbit_b32 v110, v73, v72, 16
    v_alignbit_b32 v111, v74, v73, 16
    v_alignbit_b32 v112, v75, v74, 16
    v_dot2_f32_bf16 v124, v70, v114, 0
    v_dot2_f32_bf16 v125, v108, v114, 0
    v_dot2_f32_bf16 v126, v71, v114, 0
    v_dot2_f32_bf16 v127, v109, v114, 0
    v_dot2_f32_bf16 v128, v72, v114, 0
    v_dot2_f32_bf16 v129, v110, v114, 0
    v_dot2_f32_bf16 v130, v73, v114, 0
    v_dot2_f32_bf16 v131, v111, v114, 0
    v_dot2_f32_bf16 v124, v71, v115, v124
    v_dot2_f32_bf16 v125, v109, v115, v125
    v_dot2_f32_bf16 v126, v72, v115, v126
    v_dot2_f32_bf16 v127, v110, v115, v127
    v_dot2_f32_bf16 v128, v73, v115, v128
    v_dot2_f32_bf16 v129, v111, v115, v129
    v_dot2_f32_bf16 v130, v74, v115, v130
    v_dot2_f32_bf16 v131, v112, v115, v131
    v_and_b32 v133, 0xffff0000, v76
    v_lshlrev_b32 v132, 16, v76
    v_and_b32 v135, 0xffff0000, v77
    v_lshlrev_b32 v134, 16, v77
    v_and_b32 v137, 0xffff0000, v78
    v_lshlrev_b32 v136, 16, v78
    v_and_b32 v139, 0xffff0000, v79
    v_lshlrev_b32 v138, 16, v79
    v_pk_mul_f32 v[124:125], v[124:125], v[132:133]
    v_pk_mul_f32 v[126:127], v[126:127], v[134:135]
    v_pk_mul_f32 v[128:129], v[128:129], v[136:137]
    v_pk_mul_f32 v[130:131], v[130:131], v[138:139]
    v_cvt_pk_bf16_f32 v164, v131, v130
    v_cvt_pk_bf16_f32 v165, v129, v128
    v_cvt_pk_bf16_f32 v166, v127, v126
    v_cvt_pk_bf16_f32 v167, v125, v124
    buffer_store_dwordx4 v[164:167], v94, s[44:47], s7 offen sc1
    v_alignbit_b32 v114, v103, v103, 16
    v_alignbit_b32 v115, v102, v102, 16
    s_waitcnt lgkmcnt(0)
    v_alignbit_b32 v108, v81, v80, 16
    v_alignbit_b32 v109, v82, v81, 16
    v_alignbit_b32 v110, v83, v82, 16
    v_alignbit_b32 v111, v84, v83, 16
    v_alignbit_b32 v112, v85, v84, 16
    v_dot2_f32_bf16 v116, v80, v114, 0
    v_dot2_f32_bf16 v117, v108, v114, 0
    v_dot2_f32_bf16 v118, v81, v114, 0
    v_dot2_f32_bf16 v119, v109, v114, 0
    v_dot2_f32_bf16 v120, v82, v114, 0
    v_dot2_f32_bf16 v121, v110, v114, 0
    v_dot2_f32_bf16 v122, v83, v114, 0
    v_dot2_f32_bf16 v123, v111, v114, 0
    v_dot2_f32_bf16 v116, v81, v115, v116
    v_dot2_f32_bf16 v117, v109, v115, v117
    v_dot2_f32_bf16 v118, v82, v115, v118
    v_dot2_f32_bf16 v119, v110, v115, v119
    v_dot2_f32_bf16 v120, v83, v115, v120
    v_dot2_f32_bf16 v121, v111, v115, v121
    v_dot2_f32_bf16 v122, v84, v115, v122
    v_dot2_f32_bf16 v123, v112, v115, v123
    v_and_b32 v133, 0xffff0000, v86
    v_lshlrev_b32 v132, 16, v86
    v_and_b32 v135, 0xffff0000, v87
    v_lshlrev_b32 v134, 16, v87
    v_and_b32 v137, 0xffff0000, v88
    v_lshlrev_b32 v136, 16, v88
    v_and_b32 v139, 0xffff0000, v89
    v_lshlrev_b32 v138, 16, v89
    v_pk_mul_f32 v[116:117], v[116:117], v[132:133]
    v_pk_mul_f32 v[118:119], v[118:119], v[134:135]
    v_pk_mul_f32 v[120:121], v[120:121], v[136:137]
    v_pk_mul_f32 v[122:123], v[122:123], v[138:139]
    v_cvt_pk_bf16_f32 v168, v123, v122
    v_cvt_pk_bf16_f32 v169, v121, v120
    v_cvt_pk_bf16_f32 v170, v119, v118
    v_cvt_pk_bf16_f32 v171, v117, v116
    buffer_store_dwordx4 v[168:171], v95, s[44:47], s8 offen sc1
    s_add_u32 m0, s74, 32
    s_add_u32 s13, s12, 0
    buffer_load_dwordx4 v240, s[48:51], s13 offen offset:0 lds
    buffer_load_dwordx4 v240, s[48:51], s13 offen offset:1024 lds
    buffer_load_dwordx4 v240, s[48:51], s13 offen offset:2048 lds
    buffer_load_dwordx4 v240, s[48:51], s13 offen offset:3072 lds
    s_add_u32 m0, s74, 8352
    s_add_u32 s13, s12, 16384
    buffer_load_dwordx4 v240, s[48:51], s13 offen offset:0 lds
    buffer_load_dwordx4 v240, s[48:51], s13 offen offset:1024 lds
    buffer_load_dwordx4 v240, s[48:51], s13 offen offset:2048 lds
    buffer_load_dwordx4 v240, s[48:51], s13 offen offset:3072 lds
    s_mov_b64 exec, 0
    s_call_b64 s[82:83], L_wc_X
    s_mov_b64 exec, -1
    s_waitcnt vmcnt(11)
    v_readfirstlane_b32 s68, v45
    s_nop 1
    s_cmp_eq_u32 s68, 0
    s_cbranch_scc1 L_nw_X
L_ng_X:
    s_barrier
    v_mov_b32 v3, s68
    buffer_store_dword v3, v1, s[44:47], 0 offen sc1
    s_waitcnt vmcnt(9)
    s_barrier
    buffer_store_dword v3, v46, s[44:47], 0 offen sc1
L_segX:
L_pl_X_0:
    s_cbranch_execz L_pl_X_4
    s_cmp_lt_u32 s75, 252
    s_cbranch_scc0 L_idle
    s_mov_b32 s56, s26
    s_and_b32 s57, s27, 0xffff
    s_mov_b32 s58, 1152
    s_mov_b32 s59, 0x20000
    v_mov_b32 v9, 0
    buffer_load_ushort v9, v9, s[56:59], s70 offen
    s_lshr_b32 s4, s2, 1
    s_and_b32 s4, s4, 3
    s_lshl2_add_u32 s4, s4, s3
    s_lshl_b32 s4, s4, 8
    s_add_u32 s4, s4, 12599296
    v_lshl_add_u32 v28, v2, 2, s4
    v_add_u32 v241, s74, v240
    v_cmp_eq_u32 vcc, 0, v2
    v_mov_b32 v196, 4136
    s_nop 0
    v_cndmask_b32 v196, v196, 30, vcc
    v_add_u32 v242, s74, v196
    v_bfe_u32 v196, v2, 3, 2
    v_mul_u32_u24 v196, 4160, v196
    v_and_b32 v197, 7, v2
    v_lshl_add_u32 v196, v197, 2, v196
    v_add_u32 v200, s74, v196
    v_mov_b32 v196, 0
    v_mov_b32 v197, 0
    v_mov_b32 v198, 0
    v_mov_b32 v199, 0
    ds_write_b32 v200, v196
    v_lshlrev_b32 v201, 4, v0
    ds_write_b128 v201, v[196:199]
    ds_write_b128 v201, v[196:199] offset:36864
    s_waitcnt vmcnt(7)
    ds_read_b128 v[212:215], v241 offset:32
    ds_read_b32 v216, v241 offset:48
    ds_read_b128 v[218:221], v241 offset:1056
    ds_read_b32 v222, v241 offset:1072
    ds_read_b128 v[224:227], v241 offset:2080
    ds_read_b32 v228, v241 offset:2096
    ds_read_b128 v[230:233], v241 offset:3104
    ds_read_b32 v234, v241 offset:3120
    v_lshrrev_b32 v202, 3, v2
    v_and_b32 v203, 7, v2
    v_lshrrev_b32 v204, 1, v202
    v_xor_b32 v203, v203, v204
    v_mul_u32_u24 v202, 11264, v202
    v_lshl_add_u32 v15, v203, 4, v202
    v_xor_b32 v16, 64, v15
    v_and_b32 v202, 15, v2
    v_add_u32 v202, 1, v202
    v_and_b32 v203, 1, v202
    v_mul_u32_u24 v203, 4160, v203
    v_lshrrev_b32 v202, 1, v202
    v_lshl_add_u32 v203, v202, 2, v203
    v_lshrrev_b32 v204, 4, v2
    v_lshl_add_u32 v203, v204, 4, v203
    v_add_u32 v236, s74, v203
    v_add_u32 v237, 1024, v236
    v_add_u32 v238, 1024, v237
    v_add_u32 v239, 1024, v238
    s_waitcnt lgkmcnt(0)
    s_waitcnt vmcnt(0)
    v_lshlrev_b32 v9, 16, v9
    v_lshlrev_b32 v208, 16, v212
    v_add_f32 v9, v9, v208
    v_cvt_pk_bf16_f32 v9, v9, v9
    ds_write_b16 v242, v9 offset:4160
    ds_write_b16 v242, v9 offset:2
    v_alignbit_b32 v212, v213, v212, 16
    v_alignbit_b32 v213, v214, v213, 16
    v_alignbit_b32 v214, v215, v214, 16
    v_alignbit_b32 v215, v216, v215, 16
    ds_write_b128 v241, v[212:215] offset:4192
    v_alignbit_b32 v218, v219, v218, 16
    v_alignbit_b32 v219, v220, v219, 16
    v_alignbit_b32 v220, v221, v220, 16
    v_alignbit_b32 v221, v222, v221, 16
    ds_write_b128 v241, v[218:221] offset:5216
    v_alignbit_b32 v224, v225, v224, 16
    v_alignbit_b32 v225, v226, v225, 16
    v_alignbit_b32 v226, v227, v226, 16
    v_alignbit_b32 v227, v228, v227, 16
    ds_write_b128 v241, v[224:227] offset:6240
    v_alignbit_b32 v230, v231, v230, 16
    v_alignbit_b32 v231, v232, v231, 16
    v_alignbit_b32 v232, v233, v232, 16
    v_alignbit_b32 v233, v234, v233, 16
    ds_write_b128 v241, v[230:233] offset:7264
    v_and_b32 v202, 15, v2
    v_lshlrev_b32 v202, 1, v202
    v_sub_u32 v202, v202, v204
    v_add_u32 v202, 17, v202
    v_bfe_u32 v203, v202, 1, 3
    v_xor_b32 v203, s3, v203
    v_lshlrev_b32 v203, 4, v203
    v_lshl_add_u32 v244, v202, 7, v203
    v_and_b32 v202, 15, v2
    v_lshlrev_b32 v202, 1, v202
    v_sub_u32 v202, v202, v204
    v_add_u32 v202, 13, v202
    v_bfe_u32 v203, v202, 1, 3
    v_xor_b32 v203, s3, v203
    v_lshlrev_b32 v203, 4, v203
    v_lshl_add_u32 v245, v202, 7, v203
    v_and_b32 v202, 15, v2
    v_lshlrev_b32 v202, 1, v202
    v_sub_u32 v202, v202, v204
    v_add_u32 v202, 9, v202
    v_bfe_u32 v203, v202, 1, 3
    v_xor_b32 v203, s3, v203
    v_lshlrev_b32 v203, 4, v203
    v_lshl_add_u32 v246, v202, 7, v203
    v_and_b32 v202, 15, v2
    v_lshlrev_b32 v202, 1, v202
    v_sub_u32 v202, v202, v204
    v_add_u32 v202, 5, v202
    v_bfe_u32 v203, v202, 1, 3
    v_xor_b32 v203, s3, v203
    v_lshlrev_b32 v203, 4, v203
    v_lshl_add_u32 v247, v202, 7, v203
    v_and_b32 v202, 15, v2
    v_lshlrev_b32 v202, 5, v202
    v_lshl_add_u32 v8, v204, 3, v202
    s_mul_i32 s7, s3, 589824
    s_lshl_b32 s8, s69, 8
    s_add_u32 s7, s7, s8
    s_add_u32 s10, s7, 2359296
    s_lshl_b32 s9, s3, 13
    s_add_u32 s9, s9, 4096
    s_lshl1_add_u32 s4, s69, 0
    s_mul_i32 s5, s4, 9363
    s_lshr_b32 s5, s5, 16
    s_mul_i32 s7, s5, 7
    s_sub_u32 s7, s4, s7
    s_cmp_gt_u32 s7, 2
    s_addc_u32 s4, s4, s5
    s_lshl_b32 s4, s4, 7
    s_mul_i32 s7, s3, 720896
    s_add_u32 s4, s4, s7
    s_add_u32 s10, s4, 39469056
    s_lshl1_add_u32 s4, s69, 1
    s_mul_i32 s5, s4, 9363
    s_lshr_b32 s5, s5, 16
    s_mul_i32 s7, s5, 7
    s_sub_u32 s7, s4, s7
    s_cmp_gt_u32 s7, 2
    s_addc_u32 s4, s4, s5
    s_lshl_b32 s4, s4, 7
    s_mul_i32 s7, s3, 720896
    s_add_u32 s4, s4, s7
    s_add_u32 s11, s4, 39469056
    ds_read2_b32 v[64:65], v236 offset0:0 offset1:1
    ds_read2_b32 v[66:67], v236 offset0:2 offset1:3
    ds_read2_b32 v[68:69], v236 offset0:128 offset1:129
    ds_read2_b32 v[70:71], v236 offset0:130 offset1:131
    ds_read2_b32 v[72:73], v237 offset0:0 offset1:1
    ds_read2_b32 v[74:75], v237 offset0:2 offset1:3
    ds_read2_b32 v[76:77], v237 offset0:128 offset1:129
    ds_read2_b32 v[78:79], v237 offset0:130 offset1:131
    ds_read2_b32 v[80:81], v238 offset0:0 offset1:1
    ds_read2_b32 v[82:83], v238 offset0:2 offset1:3
    ds_read2_b32 v[84:85], v238 offset0:128 offset1:129
    ds_read2_b32 v[86:87], v238 offset0:130 offset1:131
    ds_read2_b32 v[88:89], v239 offset0:0 offset1:1
    ds_read2_b32 v[90:91], v239 offset0:2 offset1:3
    ds_read2_b32 v[92:93], v239 offset0:128 offset1:129
    ds_read2_b32 v[94:95], v239 offset0:130 offset1:131
    v_mov_b32 v29, 0
    buffer_atomic_add v29, v28, s[44:47], 0 offen sc0 sc1
    s_waitcnt vmcnt(0)
    v_cmp_ne_u32 vcc, s68, v29
    s_cbranch_vccnz L_rs_p1X
L_ok_p1X:
    s_add_u32 m0, s9, 0
    s_add_u32 s13, s10, 0
    buffer_load_dwordx4 v15, s[44:47], s13 offen sc1 lds
    s_add_u32 m0, s9, 1024
    s_add_u32 s13, s10, 90112
    buffer_load_dwordx4 v16, s[44:47], s13 offen sc1 lds
    s_add_u32 m0, s9, 2048
    s_add_u32 s13, s10, 180224
L_pl_X_1:
    s_cbranch_execz L_pl_X_5
    buffer_load_dwordx4 v15, s[44:47], s13 offen sc1 lds
    s_add_u32 m0, s9, 3072
    s_add_u32 s13, s10, 270336
    buffer_load_dwordx4 v16, s[44:47], s13 offen sc1 lds
    s_add_u32 m0, s9, 4096
    s_add_u32 s13, s10, 360448
    buffer_load_dwordx4 v15, s[44:47], s13 offen sc1 lds
    s_add_u32 m0, s9, 5120
    s_add_u32 s13, s10, 450560
    buffer_load_dwordx4 v16, s[44:47], s13 offen sc1 lds
    s_add_u32 m0, s9, 6144
    s_add_u32 s13, s10, 540672
    buffer_load_dwordx4 v15, s[44:47], s13 offen sc1 lds
    s_add_u32 m0, s9, 7168
    s_add_u32 s13, s10, 630784
    buffer_load_dwordx4 v16, s[44:47], s13 offen sc1 lds
    s_mov_b64 exec, 0
    s_call_b64 s[82:83], L_wc_D
    s_mov_b64 exec, -1
    s_mov_b32 s60, s36
    s_and_b32 s61, s37, 0xffff
    s_mov_b32 s62, 4096
    s_mov_b32 s63, 0x20000
    v_and_b32 v24, 15, v2
    s_lshl_b32 s7, s71, 6
    v_add_u32 v24, s7, v24
    s_and_b32 s8, s3, 1
    s_lshl_b32 s4, s8, 5
    v_add_u32 v25, s4, v24
    v_lshlrev_b32 v26, 3, v25
    v_mul_u32_u24 v25, 1152, v25
    v_bfe_u32 v31, v2, 4, 1
    v_lshl_add_u32 v25, v31, 5, v25
    v_lshrrev_b32 v31, 5, v2
    v_lshl_add_u32 v25, v31, 4, v25
    s_bfe_u32 s7, s2, 0x20003
    s_mul_i32 s7, s7, 288
    s_bfe_u32 s5, s2, 0x10003
    s_mul_i32 s5, s5, 32
    s_lshl_b32 s4, s72, 6
    s_add_u32 s4, s4, s7
    s_add_u32 s4, s4, s5
    s_lshl_b32 s5, s5, 3
    s_sub_u32 s7, s7, s5
    v_add_u32 v252, s4, v25
    s_xor_b32 s8, s3, s72
    s_and_b32 s4, s72, 1
    s_lshl1_add_u32 s4, s4, s8
    v_lshl_add_u32 v24, s4, 4, v24
    s_add_u32 s7, s7, 256
    s_cmp_lt_u32 s8, 2
    s_cselect_b32 s7, s7, 0x40000000
    v_lshlrev_b32 v18, 3, v24
    v_mul_u32_u24 v24, 1152, v24
    v_lshrrev_b32 v31, 4, v2
    v_lshl_add_u32 v24, v31, 3, v24
    v_add_u32 v253, s7, v24
    v_lshrrev_b32 v24, 3, v2
    v_and_b32 v25, 7, v2
    v_bfe_u32 v31, v2, 4, 2
    v_lshlrev_b32 v31, 1, v31
    v_xor_b32 v25, v25, v31
    v_lshlrev_b32 v24, 12, v24
    v_lshl_add_u32 v24, v25, 4, v24
    s_mul_i32 s7, s72, 36
    s_bitcmp1_b32 s3, 0
    s_addc_u32 s7, s7, 0
    s_lshl_b32 s7, s7, 17
    s_lshl_b32 s8, s71, 7
    s_add_u32 s7, s7, s8
    v_add_u32 v4, s7, v24
    v_add_u32 v5, 31744, v4
    v_add_u32 v6, 31744, v5
    v_add_u32 v7, 31744, v6
    v_lshrrev_b32 v24, 2, v2
    v_lshlrev_b32 v24, 7, v24
    v_and_b32 v25, 3, v2
    v_lshl_add_u32 v24, v25, 3, v24
    s_and_b32 s7, s73, 8192
    v_add_u32 v24, s7, v24
    v_bfe_u32 v31, v2, 3, 2
    s_and_b32 s7, s3, 1
    s_lshl_b32 s7, s7, 1
    v_xor_b32 v31, s7, v31
    v_lshl_add_u32 v10, v31, 5, v24
    v_xor_b32 v11, 32, v10
    v_and_b32 v24, 15, v2
    v_lshrrev_b32 v25, 4, v2
    v_mul_u32_u24 v25, 17408, v25
    v_lshl_add_u32 v24, v24, 4, v25
    s_mul_i32 s7, s72, 36
    s_and_b32 s8, s3, 1
    s_add_u32 s7, s7, s8
    s_mul_i32 s7, s7, 69632
    s_bfe_u32 s8, s2, 0x20003
    s_lshl_b32 s8, s8, 12
    s_add_u32 s7, s7, s8
    s_add_u32 s7, s7, 12795904
    v_add_u32 v23, s7, v24
    s_xor_b32 s7, s72, 0
    v_lshl_add_u32 v19, s7, 10, v23
    s_xor_b32 s7, s72, 1
    v_lshl_add_u32 v20, s7, 10, v23
    s_xor_b32 s7, s72, 2
    v_lshl_add_u32 v21, s7, 10, v23
    s_xor_b32 s7, s72, 3
    v_lshl_add_u32 v22, s7, 10, v23
    v_lshlrev_b32 v14, 4, v2
    v_add_u32 v14, 98304, v14
    v_add_u32 v1, 0x10000, v14
    s_bitcmp1_b32 s3, 1
    s_cselect_b32 s18, s85, s84
    s_mul_i32 s18, s18, 139264
    s_cselect_b32 s19, s87, s86
    s_mul_i32 s19, s19, 139264
    s_cselect_b32 s20, s89, s88
    s_mul_i32 s20, s20, 139264
    s_cselect_b32 s21, s91, s90
    s_mul_i32 s21, s21, 139264
    s_cselect_b32 s22, s93, s92
    s_mul_i32 s22, s22, 139264
    s_cselect_b32 s23, s95, s94
    s_mul_i32 s23, s23, 139264
    s_cselect_b32 s24, s97, s96
    s_mul_i32 s24, s24, 139264
    s_cselect_b32 s25, s99, s98
    s_mul_i32 s25, s25, 139264
    s_cselect_b32 s26, s101, s100
    s_mul_i32 s26, s26, 139264
    v_add_u32 v10, 131072, v10
    v_add_u32 v11, 131072, v11
    s_waitcnt vmcnt(0) lgkmcnt(0)
    s_barrier
    ds_read_b128 v[96:99], v244 offset:2048
    ds_read_b128 v[100:103], v244 offset:6144
    ds_read_b128 v[104:107], v244 offset:10240
    ds_read_b128 v[108:111], v244 offset:14336
    ds_read_b128 v[112:115], v244 offset:18432
    ds_read_b128 v[116:119], v244 offset:22528
    ds_read_b128 v[120:123], v244 offset:26624
    ds_read_b128 v[124:127], v244 offset:30720
    s_waitcnt lgkmcnt(0)
    v_mfma_f32_16x16x32_bf16 v[32:35], v[64:67], v[96:99], 0
    s_lshl_b32 s14, s84, 18
    ds_read_b128 v[160:163], v245 offset:2048
    v_mfma_f32_16x16x32_bf16 v[36:39], v[68:71], v[96:99], 0
    s_add_u32 m0, s73, 147456
    v_mfma_f32_16x16x32_bf16 v[36:39], v[64:67], v[100:103], v[36:39]
    buffer_load_dwordx4 v4, s[52:55], s14 offen offset:0 lds
    ds_read2_b32 v[128:129], v236 offset0:16 offset1:17
    v_mfma_f32_16x16x32_bf16 v[40:43], v[64:67], v[104:107], 0
    ds_read2_b32 v[130:131], v236 offset0:18 offset1:19
    v_mfma_f32_16x16x32_bf16 v[40:43], v[68:71], v[100:103], v[40:43]
    v_mfma_f32_16x16x32_bf16 v[40:43], v[72:75], v[96:99], v[40:43]
    ds_read_b128 v[164:167], v245 offset:6144
    v_mfma_f32_16x16x32_bf16 v[44:47], v[76:79], v[96:99], 0
    ds_read2_b32 v[132:133], v236 offset0:144 offset1:145
    v_mfma_f32_16x16x32_bf16 v[44:47], v[72:75], v[100:103], v[44:47]
    v_mfma_f32_16x16x32_bf16 v[44:47], v[68:71], v[104:107], v[44:47]
    s_add_u32 m0, s73, 147456
    ds_read2_b32 v[134:135], v236 offset0:146 offset1:147
    v_mfma_f32_16x16x32_bf16 v[44:47], v[64:67], v[108:111], v[44:47]
    buffer_load_dwordx4 v5, s[52:55], s14 offen offset:1024 lds
    ds_read_b128 v[168:171], v245 offset:10240
    v_mfma_f32_16x16x32_bf16 v[48:51], v[64:67], v[112:115], 0
    ds_read2_b32 v[136:137], v237 offset0:16 offset1:17
    v_mfma_f32_16x16x32_bf16 v[48:51], v[68:71], v[108:111], v[48:51]
    v_mfma_f32_16x16x32_bf16 v[48:51], v[72:75], v[104:107], v[48:51]
    ds_read2_b32 v[138:139], v237 offset0:18 offset1:19
    v_mfma_f32_16x16x32_bf16 v[48:51], v[76:79], v[100:103], v[48:51]
    ds_read_b128 v[172:175], v245 offset:14336
    v_mfma_f32_16x16x32_bf16 v[48:51], v[80:83], v[96:99], v[48:51]
    v_mfma_f32_16x16x32_bf16 v[52:55], v[84:87], v[96:99], 0
    s_add_u32 m0, s73, 147456
    ds_read2_b32 v[140:141], v237 offset0:144 offset1:145
    v_mfma_f32_16x16x32_bf16 v[52:55], v[80:83], v[100:103], v[52:55]
    buffer_load_dwordx4 v6, s[52:55], s14 offen offset:2048 lds
    ds_read2_b32 v[142:143], v237 offset0:146 offset1:147
    v_mfma_f32_16x16x32_bf16 v[52:55], v[76:79], v[104:107], v[52:55]
    v_mfma_f32_16x16x32_bf16 v[52:55], v[72:75], v[108:111], v[52:55]
    ds_read_b128 v[176:179], v245 offset:18432
    v_mfma_f32_16x16x32_bf16 v[52:55], v[68:71], v[112:115], v[52:55]
    ds_read2_b32 v[144:145], v238 offset0:16 offset1:17
    v_mfma_f32_16x16x32_bf16 v[52:55], v[64:67], v[116:119], v[52:55]
    v_mfma_f32_16x16x32_bf16 v[56:59], v[64:67], v[120:123], 0
    ds_read2_b32 v[146:147], v238 offset0:18 offset1:19
    v_mfma_f32_16x16x32_bf16 v[56:59], v[68:71], v[116:119], v[56:59]
    s_add_u32 m0, s73, 147456
    ds_read_b128 v[180:183], v245 offset:22528
    v_mfma_f32_16x16x32_bf16 v[56:59], v[72:75], v[112:115], v[56:59]
    buffer_load_dwordx4 v7, s[52:55], s14 offen offset:3072 lds
    v_mfma_f32_16x16x32_bf16 v[56:59], v[76:79], v[108:111], v[56:59]
    ds_read2_b32 v[148:149], v238 offset0:144 offset1:145
    v_mfma_f32_16x16x32_bf16 v[56:59], v[80:83], v[104:107], v[56:59]
    ds_read2_b32 v[150:151], v238 offset0:146 offset1:147
    v_mfma_f32_16x16x32_bf16 v[56:59], v[84:87], v[100:103], v[56:59]
    ds_read_b128 v[184:187], v245 offset:26624
    v_mfma_f32_16x16x32_bf16 v[56:59], v[88:91], v[96:99], v[56:59]
    v_mfma_f32_16x16x32_bf16 v[60:63], v[92:95], v[96:99], 0
    ds_read2_b32 v[152:153], v239 offset0:16 offset1:17
    v_mfma_f32_16x16x32_bf16 v[60:63], v[88:91], v[100:103], v[60:63]
    ds_read2_b32 v[154:155], v239 offset0:18 offset1:19
    v_mfma_f32_16x16x32_bf16 v[60:63], v[84:87], v[104:107], v[60:63]
    v_mfma_f32_16x16x32_bf16 v[60:63], v[80:83], v[108:111], v[60:63]
    ds_read_b128 v[188:191], v245 offset:30720
    v_mfma_f32_16x16x32_bf16 v[60:63], v[76:79], v[112:115], v[60:63]
    ds_read2_b32 v[156:157], v239 offset0:144 offset1:145
    v_mfma_f32_16x16x32_bf16 v[60:63], v[72:75], v[116:119], v[60:63]
    v_mfma_f32_16x16x32_bf16 v[60:63], v[68:71], v[120:123], v[60:63]
    ds_read2_b32 v[158:159], v239 offset0:146 offset1:147
    v_mfma_f32_16x16x32_bf16 v[60:63], v[64:67], v[124:127], v[60:63]
    s_waitcnt lgkmcnt(12)
    v_mfma_f32_16x16x32_bf16 v[32:35], v[128:131], v[160:163], v[32:35]
    ds_read_b128 v[96:99], v246 offset:2048
    v_mfma_f32_16x16x32_bf16 v[36:39], v[132:135], v[160:163], v[36:39]
    v_mfma_f32_16x16x32_bf16 v[36:39], v[128:131], v[164:167], v[36:39]
    ds_read2_b32 v[64:65], v236 offset0:32 offset1:33
    v_mfma_f32_16x16x32_bf16 v[40:43], v[128:131], v[168:171], v[40:43]
    ds_read2_b32 v[66:67], v236 offset0:34 offset1:35
    v_mfma_f32_16x16x32_bf16 v[40:43], v[132:135], v[164:167], v[40:43]
    v_mfma_f32_16x16x32_bf16 v[40:43], v[136:139], v[160:163], v[40:43]
    ds_read_b128 v[100:103], v246 offset:6144
    v_mfma_f32_16x16x32_bf16 v[44:47], v[140:143], v[160:163], v[44:47]
    ds_read2_b32 v[68:69], v236 offset0:160 offset1:161
    v_mfma_f32_16x16x32_bf16 v[44:47], v[136:139], v[164:167], v[44:47]
    v_mfma_f32_16x16x32_bf16 v[44:47], v[132:135], v[168:171], v[44:47]
    ds_read2_b32 v[70:71], v236 offset0:162 offset1:163
    v_mfma_f32_16x16x32_bf16 v[44:47], v[128:131], v[172:175], v[44:47]
    ds_read_b128 v[104:107], v246 offset:10240
    s_waitcnt lgkmcnt(7)
    v_mfma_f32_16x16x32_bf16 v[48:51], v[128:131], v[176:179], v[48:51]
    s_lshl_b32 s14, s85, 18
    ds_read2_b32 v[72:73], v237 offset0:32 offset1:33
    v_mfma_f32_16x16x32_bf16 v[48:51], v[132:135], v[172:175], v[48:51]
    s_add_u32 m0, s73, 49152
    ds_read2_b32 v[74:75], v237 offset0:34 offset1:35
    v_mfma_f32_16x16x32_bf16 v[48:51], v[136:139], v[168:171], v[48:51]
    buffer_load_dwordx4 v4, s[52:55], s14 offen offset:0 lds
    v_mov_b32 v9, 8
    buffer_load_ushort v9, v9, s[56:59], s70 offen
    v_mfma_f32_16x16x32_bf16 v[48:51], v[140:143], v[164:167], v[48:51]
    ds_read_b128 v[108:111], v246 offset:14336
    v_mfma_f32_16x16x32_bf16 v[48:51], v[144:147], v[160:163], v[48:51]
    v_mfma_f32_16x16x32_bf16 v[52:55], v[148:151], v[160:163], v[52:55]
    ds_read2_b32 v[76:77], v237 offset0:160 offset1:161
    v_mfma_f32_16x16x32_bf16 v[52:55], v[144:147], v[164:167], v[52:55]
    ds_read2_b32 v[78:79], v237 offset0:162 offset1:163
    v_mfma_f32_16x16x32_bf16 v[52:55], v[140:143], v[168:171], v[52:55]
    v_mfma_f32_16x16x32_bf16 v[52:55], v[136:139], v[172:175], v[52:55]
    ds_read_b128 v[112:115], v246 offset:18432
    v_mfma_f32_16x16x32_bf16 v[52:55], v[132:135], v[176:179], v[52:55]
    s_add_u32 m0, s73, 49152
    ds_read2_b32 v[80:81], v238 offset0:32 offset1:33
    v_mfma_f32_16x16x32_bf16 v[52:55], v[128:131], v[180:183], v[52:55]
    buffer_load_dwordx4 v5, s[52:55], s14 offen offset:1024 lds
    v_mfma_f32_16x16x32_bf16 v[56:59], v[128:131], v[184:187], v[56:59]
    ds_read2_b32 v[82:83], v238 offset0:34 offset1:35
    v_mfma_f32_16x16x32_bf16 v[56:59], v[132:135], v[180:183], v[56:59]
    ds_read_b128 v[116:119], v246 offset:22528
    v_mfma_f32_16x16x32_bf16 v[56:59], v[136:139], v[176:179], v[56:59]
    v_mfma_f32_16x16x32_bf16 v[56:59], v[140:143], v[172:175], v[56:59]
    ds_read2_b32 v[84:85], v238 offset0:160 offset1:161
    v_mfma_f32_16x16x32_bf16 v[56:59], v[144:147], v[168:171], v[56:59]
    ds_read2_b32 v[86:87], v238 offset0:162 offset1:163
    v_mfma_f32_16x16x32_bf16 v[56:59], v[148:151], v[164:167], v[56:59]
    s_add_u32 m0, s73, 49152
    ds_read_b128 v[120:123], v246 offset:26624
    v_mfma_f32_16x16x32_bf16 v[56:59], v[152:155], v[160:163], v[56:59]
    buffer_load_dwordx4 v6, s[52:55], s14 offen offset:2048 lds
    v_mfma_f32_16x16x32_bf16 v[60:63], v[156:159], v[160:163], v[60:63]
    ds_read2_b32 v[88:89], v239 offset0:32 offset1:33
    v_mfma_f32_16x16x32_bf16 v[60:63], v[152:155], v[164:167], v[60:63]
    ds_read2_b32 v[90:91], v239 offset0:34 offset1:35
    v_mfma_f32_16x16x32_bf16 v[60:63], v[148:151], v[168:171], v[60:63]
    v_mfma_f32_16x16x32_bf16 v[60:63], v[144:147], v[172:175], v[60:63]
    ds_read_b128 v[124:127], v246 offset:30720
    v_mfma_f32_16x16x32_bf16 v[60:63], v[140:143], v[176:179], v[60:63]
    ds_read2_b32 v[92:93], v239 offset0:160 offset1:161
    v_mfma_f32_16x16x32_bf16 v[60:63], v[136:139], v[180:183], v[60:63]
    s_add_u32 m0, s73, 49152
    v_mfma_f32_16x16x32_bf16 v[60:63], v[132:135], v[184:187], v[60:63]
    buffer_load_dwordx4 v7, s[52:55], s14 offen offset:3072 lds
    ds_read2_b32 v[94:95], v239 offset0:162 offset1:163
    v_mfma_f32_16x16x32_bf16 v[60:63], v[128:131], v[188:191], v[60:63]
    s_waitcnt lgkmcnt(12)
    v_mfma_f32_16x16x32_bf16 v[32:35], v[64:67], v[96:99], v[32:35]
    ds_read_b128 v[160:163], v247 offset:2048
    v_mfma_f32_16x16x32_bf16 v[36:39], v[68:71], v[96:99], v[36:39]
    v_mfma_f32_16x16x32_bf16 v[36:39], v[64:67], v[100:103], v[36:39]
    ds_read2_b32 v[128:129], v236 offset0:48 offset1:49
    v_mfma_f32_16x16x32_bf16 v[40:43], v[64:67], v[104:107], v[40:43]
    ds_read2_b32 v[130:131], v236 offset0:50 offset1:51
    v_mfma_f32_16x16x32_bf16 v[40:43], v[68:71], v[100:103], v[40:43]
    v_mfma_f32_16x16x32_bf16 v[40:43], v[72:75], v[96:99], v[40:43]
    ds_read_b128 v[164:167], v247 offset:6144
    v_mfma_f32_16x16x32_bf16 v[44:47], v[76:79], v[96:99], v[44:47]
    ds_read2_b32 v[132:133], v236 offset0:176 offset1:177
    v_mfma_f32_16x16x32_bf16 v[44:47], v[72:75], v[100:103], v[44:47]
    v_mfma_f32_16x16x32_bf16 v[44:47], v[68:71], v[104:107], v[44:47]
    ds_read2_b32 v[134:135], v236 offset0:178 offset1:179
    v_mfma_f32_16x16x32_bf16 v[44:47], v[64:67], v[108:111], v[44:47]
    ds_read_b128 v[168:171], v247 offset:10240
    s_waitcnt lgkmcnt(7)
    v_mfma_f32_16x16x32_bf16 v[48:51], v[64:67], v[112:115], v[48:51]
    ds_read2_b32 v[136:137], v237 offset0:48 offset1:49
    v_mfma_f32_16x16x32_bf16 v[48:51], v[68:71], v[108:111], v[48:51]
    v_mfma_f32_16x16x32_bf16 v[48:51], v[72:75], v[104:107], v[48:51]
    ds_read2_b32 v[138:139], v237 offset0:50 offset1:51
    v_mfma_f32_16x16x32_bf16 v[48:51], v[76:79], v[100:103], v[48:51]
    ds_read_b128 v[172:175], v247 offset:14336
    v_mfma_f32_16x16x32_bf16 v[48:51], v[80:83], v[96:99], v[48:51]
    v_mfma_f32_16x16x32_bf16 v[52:55], v[84:87], v[96:99], v[52:55]
    ds_read2_b32 v[140:141], v237 offset0:176 offset1:177
    v_mfma_f32_16x16x32_bf16 v[52:55], v[80:83], v[100:103], v[52:55]
    ds_read2_b32 v[142:143], v237 offset0:178 offset1:179
    v_mfma_f32_16x16x32_bf16 v[52:55], v[76:79], v[104:107], v[52:55]
    v_mfma_f32_16x16x32_bf16 v[52:55], v[72:75], v[108:111], v[52:55]
    ds_read_b128 v[176:179], v247 offset:18432
    v_mfma_f32_16x16x32_bf16 v[52:55], v[68:71], v[112:115], v[52:55]
    ds_read2_b32 v[144:145], v238 offset0:48 offset1:49
    v_mfma_f32_16x16x32_bf16 v[52:55], v[64:67], v[116:119], v[52:55]
    v_mfma_f32_16x16x32_bf16 v[56:59], v[64:67], v[120:123], v[56:59]
    ds_read2_b32 v[146:147], v238 offset0:50 offset1:51
    v_mfma_f32_16x16x32_bf16 v[56:59], v[68:71], v[116:119], v[56:59]
    ds_read_b128 v[180:183], v247 offset:22528
    v_mfma_f32_16x16x32_bf16 v[56:59], v[72:75], v[112:115], v[56:59]
    v_mfma_f32_16x16x32_bf16 v[56:59], v[76:79], v[108:111], v[56:59]
    ds_read2_b32 v[148:149], v238 offset0:176 offset1:177
    v_mfma_f32_16x16x32_bf16 v[56:59], v[80:83], v[104:107], v[56:59]
    ds_read2_b32 v[150:151], v238 offset0:178 offset1:179
    v_mfma_f32_16x16x32_bf16 v[56:59], v[84:87], v[100:103], v[56:59]
    ds_read_b128 v[184:187], v247 offset:26624
    v_mfma_f32_16x16x32_bf16 v[56:59], v[88:91], v[96:99], v[56:59]
    v_mfma_f32_16x16x32_bf16 v[60:63], v[92:95], v[96:99], v[60:63]
    ds_read2_b32 v[152:153], v239 offset0:48 offset1:49
    v_mfma_f32_16x16x32_bf16 v[60:63], v[88:91], v[100:103], v[60:63]
    ds_read2_b32 v[154:155], v239 offset0:50 offset1:51
    v_mfma_f32_16x16x32_bf16 v[60:63], v[84:87], v[104:107], v[60:63]
    v_mfma_f32_16x16x32_bf16 v[60:63], v[80:83], v[108:111], v[60:63]
    ds_read_b128 v[188:191], v247 offset:30720
    v_mfma_f32_16x16x32_bf16 v[60:63], v[76:79], v[112:115], v[60:63]
    ds_read2_b32 v[156:157], v239 offset0:176 offset1:177
    v_mfma_f32_16x16x32_bf16 v[60:63], v[72:75], v[116:119], v[60:63]
    v_mfma_f32_16x16x32_bf16 v[60:63], v[68:71], v[120:123], v[60:63]
    ds_read2_b32 v[158:159], v239 offset0:178 offset1:179
    v_mfma_f32_16x16x32_bf16 v[60:63], v[64:67], v[124:127], v[60:63]
    s_waitcnt lgkmcnt(12)
    v_mfma_f32_16x16x32_bf16 v[32:35], v[128:131], v[160:163], v[32:35]
    ds_read_b128 v[96:99], v244 offset:0
    v_mfma_f32_16x16x32_bf16 v[36:39], v[132:135], v[160:163], v[36:39]
    v_mfma_f32_16x16x32_bf16 v[36:39], v[128:131], v[164:167], v[36:39]
    ds_read2_b32 v[64:65], v236 offset0:64 offset1:65
    v_mfma_f32_16x16x32_bf16 v[40:43], v[128:131], v[168:171], v[40:43]
    ds_read2_b32 v[66:67], v236 offset0:66 offset1:67
    v_mfma_f32_16x16x32_bf16 v[40:43], v[132:135], v[164:167], v[40:43]
    v_mfma_f32_16x16x32_bf16 v[40:43], v[136:139], v[160:163], v[40:43]
    ds_read_b128 v[100:103], v244 offset:4096
    v_mfma_f32_16x16x32_bf16 v[44:47], v[140:143], v[160:163], v[44:47]
    ds_read2_b32 v[68:69], v236 offset0:192 offset1:193
    v_mfma_f32_16x16x32_bf16 v[44:47], v[136:139], v[164:167], v[44:47]
    v_mfma_f32_16x16x32_bf16 v[44:47], v[132:135], v[168:171], v[44:47]
    ds_read2_b32 v[70:71], v236 offset0:194 offset1:195
    v_mfma_f32_16x16x32_bf16 v[44:47], v[128:131], v[172:175], v[44:47]
    ds_read_b128 v[104:107], v244 offset:8192
    s_waitcnt lgkmcnt(7)
    v_mfma_f32_16x16x32_bf16 v[48:51], v[128:131], v[176:179], v[48:51]
    ds_read2_b32 v[72:73], v237 offset0:64 offset1:65
    v_mfma_f32_16x16x32_bf16 v[48:51], v[132:135], v[172:175], v[48:51]
    ds_read2_b32 v[74:75], v237 offset0:66 offset1:67
    v_mfma_f32_16x16x32_bf16 v[48:51], v[136:139], v[168:171], v[48:51]
    ds_read_b128 v[108:111], v244 offset:12288
    v_mfma_f32_16x16x32_bf16 v[48:51], v[140:143], v[164:167], v[48:51]
    ds_read2_b32 v[76:77], v237 offset0:192 offset1:193
    v_mfma_f32_16x16x32_bf16 v[48:51], v[144:147], v[160:163], v[48:51]
    ds_read2_b32 v[78:79], v237 offset0:194 offset1:195
    s_waitcnt vmcnt(5)
    s_barrier
    v_mfma_f32_16x16x32_bf16 v[52:55], v[148:151], v[160:163], v[52:55]
    ds_read_b64_tr_b16 a[0:1], v10 offset:16384
    v_mfma_f32_16x16x32_bf16 v[52:55], v[144:147], v[164:167], v[52:55]
    ds_read_b128 v[112:115], v244 offset:16384
    v_mfma_f32_16x16x32_bf16 v[52:55], v[140:143], v[168:171], v[52:55]
    ds_read_b64_tr_b16 a[2:3], v10 offset:18432
    v_mfma_f32_16x16x32_bf16 v[52:55], v[136:139], v[172:175], v[52:55]
    ds_read_b64_tr_b16 a[8:9], v10 offset:20480
    v_mfma_f32_16x16x32_bf16 v[52:55], v[132:135], v[176:179], v[52:55]
    ds_read2_b32 v[80:81], v238 offset0:64 offset1:65
    v_mfma_f32_16x16x32_bf16 v[52:55], v[128:131], v[180:183], v[52:55]
    ds_read_b64_tr_b16 a[10:11], v10 offset:22528
    v_mfma_f32_16x16x32_bf16 v[56:59], v[128:131], v[184:187], v[56:59]
    ds_read_b64_tr_b16 a[4:5], v11 offset:16384
    v_mfma_f32_16x16x32_bf16 v[56:59], v[132:135], v[180:183], v[56:59]
    ds_read2_b32 v[82:83], v238 offset0:66 offset1:67
    v_mfma_f32_16x16x32_bf16 v[56:59], v[136:139], v[176:179], v[56:59]
    ds_read_b64_tr_b16 a[6:7], v11 offset:18432
    v_mfma_f32_16x16x32_bf16 v[56:59], v[140:143], v[172:175], v[56:59]
    ds_read_b64_tr_b16 a[12:13], v11 offset:20480
    v_mfma_f32_16x16x32_bf16 v[56:59], v[144:147], v[168:171], v[56:59]
    ds_read_b64_tr_b16 a[14:15], v11 offset:22528
    v_mfma_f32_16x16x32_bf16 v[56:59], v[148:151], v[164:167], v[56:59]
    ds_read_b128 v[116:119], v244 offset:20480
    v_mfma_f32_16x16x32_bf16 v[56:59], v[152:155], v[160:163], v[56:59]
    ds_read2_b32 v[84:85], v238 offset0:192 offset1:193
    v_mfma_f32_16x16x32_bf16 v[60:63], v[156:159], v[160:163], v[60:63]
    ds_read2_b32 v[86:87], v238 offset0:194 offset1:195
    s_waitcnt lgkmcnt(3)
    s_barrier
    v_mfma_f32_16x16x32_bf16 v[60:63], v[152:155], v[164:167], v[60:63]
    ds_read_b128 v[120:123], v244 offset:24576
    v_mfma_f32_16x16x32_bf16 v[60:63], v[148:151], v[168:171], v[60:63]
    ds_read2_b32 v[88:89], v239 offset0:64 offset1:65
    v_mfma_f32_16x16x32_bf16 v[60:63], v[144:147], v[172:175], v[60:63]
    ds_read2_b32 v[90:91], v239 offset0:66 offset1:67
    v_mfma_f32_16x16x32_bf16 v[60:63], v[140:143], v[176:179], v[60:63]
    s_lshl_b32 s14, s86, 18
    ds_read_b128 v[124:127], v244 offset:28672
    v_mfma_f32_16x16x32_bf16 v[60:63], v[136:139], v[180:183], v[60:63]
    s_add_u32 m0, s73, 147456
    ds_read2_b32 v[92:93], v239 offset0:192 offset1:193
    v_mfma_f32_16x16x32_bf16 v[60:63], v[132:135], v[184:187], v[60:63]
    buffer_load_dwordx4 v4, s[52:55], s14 offen offset:0 lds
    ds_read2_b32 v[94:95], v239 offset0:194 offset1:195
    v_mfma_f32_16x16x32_bf16 v[60:63], v[128:131], v[188:191], v[60:63]
    v_mfma_f32_16x16x32_bf16 v[32:35], v[64:67], v[96:99], v[32:35]
    ds_read_b128 v[160:163], v245 offset:0
    v_mfma_f32_16x16x32_bf16 v[36:39], v[68:71], v[96:99], v[36:39]
    ds_read2_b32 v[128:129], v236 offset0:80 offset1:81
    v_mfma_f32_16x16x32_bf16 v[36:39], v[64:67], v[100:103], v[36:39]
    ds_read2_b32 v[130:131], v236 offset0:82 offset1:83
    v_mfma_f32_16x16x32_bf16 v[40:43], v[64:67], v[104:107], v[40:43]
    ds_read_b128 v[164:167], v245 offset:4096
    v_mfma_f32_16x16x32_bf16 v[40:43], v[68:71], v[100:103], v[40:43]
    s_add_u32 m0, s73, 147456
    ds_read2_b32 v[132:133], v236 offset0:208 offset1:209
    v_mfma_f32_16x16x32_bf16 v[40:43], v[72:75], v[96:99], v[40:43]
    buffer_load_dwordx4 v5, s[52:55], s14 offen offset:1024 lds
    ds_read2_b32 v[134:135], v236 offset0:210 offset1:211
    v_mfma_f32_16x16x32_bf16 v[44:47], v[76:79], v[96:99], v[44:47]
    ds_read_b128 v[168:171], v245 offset:8192
    v_mfma_f32_16x16x32_bf16 v[44:47], v[72:75], v[100:103], v[44:47]
    ds_read2_b32 v[136:137], v237 offset0:80 offset1:81
    v_mfma_f32_16x16x32_bf16 v[44:47], v[68:71], v[104:107], v[44:47]
    ds_read2_b32 v[138:139], v237 offset0:82 offset1:83
    v_mfma_f32_16x16x32_bf16 v[44:47], v[64:67], v[108:111], v[44:47]
    ds_read_b128 v[172:175], v245 offset:12288
    s_waitcnt lgkmcnt(10)
    v_mfma_f32_16x16x32_bf16 v[48:51], v[64:67], v[112:115], v[48:51]
    ds_read2_b32 v[140:141], v237 offset0:208 offset1:209
    v_mfma_f32_16x16x32_bf16 v[48:51], v[68:71], v[108:111], v[48:51]
    s_add_u32 m0, s73, 147456
    ds_read2_b32 v[142:143], v237 offset0:210 offset1:211
    v_mfma_f32_16x16x32_bf16 v[48:51], v[72:75], v[104:107], v[48:51]
    buffer_load_dwordx4 v6, s[52:55], s14 offen offset:2048 lds
    ds_read_b128 v[176:179], v245 offset:16384
    v_mfma_f32_16x16x32_bf16 v[48:51], v[76:79], v[100:103], v[48:51]
    ds_read2_b32 v[144:145], v238 offset0:80 offset1:81
    v_mfma_f32_16x16x32_bf16 v[48:51], v[80:83], v[96:99], v[48:51]
    ds_read2_b32 v[146:147], v238 offset0:82 offset1:83
    v_mfma_f32_16x16x32_bf16 v[52:55], v[84:87], v[96:99], v[52:55]
    ds_read_b128 v[180:183], v245 offset:20480
    v_mfma_f32_16x16x32_bf16 v[52:55], v[80:83], v[100:103], v[52:55]
    ds_read2_b32 v[148:149], v238 offset0:208 offset1:209
    v_mfma_f32_16x16x32_bf16 v[52:55], v[76:79], v[104:107], v[52:55]
    ds_read2_b32 v[150:151], v238 offset0:210 offset1:211
    v_mfma_f32_16x16x32_bf16 v[52:55], v[72:75], v[108:111], v[52:55]
    ds_read_b128 v[184:187], v245 offset:24576
    v_mfma_f32_16x16x32_bf16 v[52:55], v[68:71], v[112:115], v[52:55]
    s_add_u32 m0, s73, 147456
    ds_read_b128 v[212:215], v241 offset:8352
    v_mfma_f32_16x16x32_bf16 v[52:55], v[64:67], v[116:119], v[52:55]
    buffer_load_dwordx4 v7, s[52:55], s14 offen offset:3072 lds
    ds_read2_b32 v[152:153], v239 offset0:80 offset1:81
    v_mfma_f32_16x16x32_bf16 v[56:59], v[64:67], v[120:123], v[56:59]
    ds_read_b32 v216, v241 offset:8368
    v_mfma_f32_16x16x32_bf16 v[56:59], v[68:71], v[116:119], v[56:59]
    ds_read2_b32 v[154:155], v239 offset0:82 offset1:83
    v_mfma_f32_16x16x32_bf16 v[56:59], v[72:75], v[112:115], v[56:59]
    ds_read_b128 v[218:221], v241 offset:9376
    v_mfma_f32_16x16x32_bf16 v[56:59], v[76:79], v[108:111], v[56:59]
    ds_read_b32 v222, v241 offset:9392
    v_mfma_f32_16x16x32_bf16 v[56:59], v[80:83], v[104:107], v[56:59]
    ds_read_b128 v[224:227], v241 offset:10400
    s_waitcnt vmcnt(4)
    s_barrier
    v_mfma_f32_16x16x32_bf16 v[56:59], v[84:87], v[100:103], v[56:59]
    ds_read_b32 v228, v241 offset:10416
    v_add_u32 v10, -131072, v10
    v_mfma_f32_16x16x32_bf16 v[56:59], v[88:91], v[96:99], v[56:59]
    ds_read_b64_tr_b16 a[16:17], v10 offset:49152
    v_mfma_f32_16x16x32_bf16 v[60:63], v[92:95], v[96:99], v[60:63]
    ds_read_b64_tr_b16 a[18:19], v10 offset:51200
    v_mfma_f32_16x16x32_bf16 v[60:63], v[88:91], v[100:103], v[60:63]
    ds_read_b64_tr_b16 a[24:25], v10 offset:53248
    v_mfma_f32_16x16x32_bf16 v[60:63], v[84:87], v[104:107], v[60:63]
    ds_read_b128 v[230:233], v241 offset:11424
    v_mfma_f32_16x16x32_bf16 v[60:63], v[80:83], v[108:111], v[60:63]
    ds_read_b64_tr_b16 a[26:27], v10 offset:55296
    ds_read_b128 v[188:191], v245 offset:28672
    v_mfma_f32_16x16x32_bf16 v[60:63], v[76:79], v[112:115], v[60:63]
    ds_read_b32 v234, v241 offset:11440
    v_add_u32 v11, -131072, v11
    v_mfma_f32_16x16x32_bf16 v[60:63], v[72:75], v[116:119], v[60:63]
    ds_read_b64_tr_b16 a[20:21], v11 offset:49152
    ds_read2_b32 v[156:157], v239 offset0:208 offset1:209
    v_mfma_f32_16x16x32_bf16 v[60:63], v[68:71], v[120:123], v[60:63]
    ds_read_b64_tr_b16 a[22:23], v11 offset:51200
    ds_read2_b32 v[158:159], v239 offset0:210 offset1:211
    v_mfma_f32_16x16x32_bf16 v[60:63], v[64:67], v[124:127], v[60:63]
    ds_read_b64_tr_b16 a[28:29], v11 offset:53248
    s_waitcnt lgkmcnt(15)
    v_mfma_f32_16x16x32_bf16 v[32:35], v[128:131], v[160:163], v[32:35]
    ds_read_b64_tr_b16 a[30:31], v11 offset:55296
    v_mfma_f32_16x16x32_bf16 v[36:39], v[132:135], v[160:163], v[36:39]
    ds_read_b128 v[96:99], v246 offset:0
    v_mfma_f32_16x16x32_bf16 v[36:39], v[128:131], v[164:167], v[36:39]
    ds_read2_b32 v[64:65], v236 offset0:96 offset1:97
    v_mfma_f32_16x16x32_bf16 v[40:43], v[128:131], v[168:171], v[40:43]
    ds_read2_b32 v[66:67], v236 offset0:98 offset1:99
    s_waitcnt lgkmcnt(3)
    s_barrier
    v_mfma_f32_16x16x32_bf16 v[40:43], v[132:135], v[164:167], v[40:43]
    v_mfma_f32_16x16x32_bf16 v[40:43], v[136:139], v[160:163], v[40:43]
    ds_read_b128 v[100:103], v246 offset:4096
    v_mfma_f32_16x16x32_bf16 v[44:47], v[140:143], v[160:163], v[44:47]
    ds_read2_b32 v[68:69], v236 offset0:224 offset1:225
    v_mfma_f32_16x16x32_bf16 v[44:47], v[136:139], v[164:167], v[44:47]
    s_lshl_b32 s14, s87, 18
    v_mfma_f32_16x16x32_bf16 v[44:47], v[132:135], v[168:171], v[44:47]
    ds_read2_b32 v[70:71], v236 offset0:226 offset1:227
    s_add_u32 m0, s73, 49152
    v_lshlrev_b32 v9, 16, v9
    v_mfma_f32_16x16x32_bf16 v[44:47], v[128:131], v[172:175], v[44:47]
    buffer_load_dwordx4 v4, s[52:55], s14 offen offset:0 lds
    ds_read_b128 v[104:107], v246 offset:8192
    v_mfma_f32_16x16x32_bf16 v[48:51], v[128:131], v[176:179], v[48:51]
    ds_read2_b32 v[72:73], v237 offset0:96 offset1:97
    v_lshlrev_b32 v208, 16, v212
    v_mfma_f32_16x16x32_bf16 v[48:51], v[132:135], v[172:175], v[48:51]
    v_mfma_f32_16x16x32_bf16 v[48:51], v[136:139], v[168:171], v[48:51]
    ds_read2_b32 v[74:75], v237 offset0:98 offset1:99
    v_add_f32 v9, v9, v208
    v_mfma_f32_16x16x32_bf16 v[48:51], v[140:143], v[164:167], v[48:51]
    ds_read_b128 v[108:111], v246 offset:12288
    v_cvt_pk_bf16_f32 v9, v9, v9
    v_mfma_f32_16x16x32_bf16 v[48:51], v[144:147], v[160:163], v[48:51]
    ds_write_b16 v242, v9 offset:12480
    v_mfma_f32_16x16x32_bf16 v[52:55], v[148:151], v[160:163], v[52:55]
    s_add_u32 m0, s73, 49152
    ds_read2_b32 v[76:77], v237 offset0:224 offset1:225
    v_mfma_f32_16x16x32_bf16 v[52:55], v[144:147], v[164:167], v[52:55]
    buffer_load_dwordx4 v5, s[52:55], s14 offen offset:1024 lds
    ds_read2_b32 v[78:79], v237 offset0:226 offset1:227
    v_mfma_f32_16x16x32_bf16 v[52:55], v[140:143], v[168:171], v[52:55]
    ds_write_b16 v242, v9 offset:8322
    v_mfma_f32_16x16x32_bf16 v[52:55], v[136:139], v[172:175], v[52:55]
    ds_read_b128 v[112:115], v246 offset:16384
    v_mfma_f32_16x16x32_bf16 v[52:55], v[132:135], v[176:179], v[52:55]
    ds_read2_b32 v[80:81], v238 offset0:96 offset1:97
    v_alignbit_b32 v212, v213, v212, 16
    v_mfma_f32_16x16x32_bf16 v[52:55], v[128:131], v[180:183], v[52:55]
L_pl_X_2:
    s_cbranch_execz L_pl_X_6
    v_alignbit_b32 v213, v214, v213, 16
    v_mfma_f32_16x16x32_bf16 v[56:59], v[128:131], v[184:187], v[56:59]
    ds_read2_b32 v[82:83], v238 offset0:98 offset1:99
    v_mfma_f32_16x16x32_bf16 v[56:59], v[132:135], v[180:183], v[56:59]
    ds_read_b128 v[116:119], v246 offset:20480
    s_add_u32 m0, s73, 49152
    v_alignbit_b32 v214, v215, v214, 16
    v_mfma_f32_16x16x32_bf16 v[56:59], v[136:139], v[176:179], v[56:59]
    buffer_load_dwordx4 v6, s[52:55], s14 offen offset:2048 lds
    v_mfma_f32_16x16x32_bf16 v[56:59], v[140:143], v[172:175], v[56:59]
    ds_read2_b32 v[84:85], v238 offset0:224 offset1:225
    v_alignbit_b32 v215, v216, v215, 16
    v_mfma_f32_16x16x32_bf16 v[56:59], v[144:147], v[168:171], v[56:59]
    ds_read2_b32 v[86:87], v238 offset0:226 offset1:227
    v_mfma_f32_16x16x32_bf16 v[56:59], v[148:151], v[164:167], v[56:59]
    ds_write_b128 v241, v[212:215] offset:12512
    v_mfma_f32_16x16x32_bf16 v[56:59], v[152:155], v[160:163], v[56:59]
    ds_read_b128 v[120:123], v246 offset:24576
    v_mfma_f32_16x16x32_bf16 v[60:63], v[156:159], v[160:163], v[60:63]
    ds_read2_b32 v[88:89], v239 offset0:96 offset1:97
    v_alignbit_b32 v218, v219, v218, 16
    v_mfma_f32_16x16x32_bf16 v[60:63], v[152:155], v[164:167], v[60:63]
    ds_read2_b32 v[90:91], v239 offset0:98 offset1:99
    s_add_u32 m0, s73, 49152
    v_alignbit_b32 v219, v220, v219, 16
    v_mfma_f32_16x16x32_bf16 v[60:63], v[148:151], v[168:171], v[60:63]
    buffer_load_dwordx4 v7, s[52:55], s14 offen offset:3072 lds
    v_mfma_f32_16x16x32_bf16 v[60:63], v[144:147], v[172:175], v[60:63]
    ds_read_b128 v[124:127], v246 offset:28672
    v_alignbit_b32 v220, v221, v220, 16
    v_mfma_f32_16x16x32_bf16 v[60:63], v[140:143], v[176:179], v[60:63]
    ds_read2_b32 v[92:93], v239 offset0:224 offset1:225
    v_mfma_f32_16x16x32_bf16 v[60:63], v[136:139], v[180:183], v[60:63]
    ds_read2_b32 v[94:95], v239 offset0:226 offset1:227
    v_alignbit_b32 v221, v222, v221, 16
    v_mfma_f32_16x16x32_bf16 v[60:63], v[132:135], v[184:187], v[60:63]
    ds_write_b128 v241, v[218:221] offset:13536
    v_mfma_f32_16x16x32_bf16 v[60:63], v[128:131], v[188:191], v[60:63]
    s_waitcnt lgkmcnt(15)
    v_mfma_f32_16x16x32_bf16 v[32:35], v[64:67], v[96:99], v[32:35]
    ds_read_b128 v[160:163], v247 offset:0
    v_mfma_f32_16x16x32_bf16 v[36:39], v[68:71], v[96:99], v[36:39]
    v_alignbit_b32 v224, v225, v224, 16
    v_mfma_f32_16x16x32_bf16 v[36:39], v[64:67], v[100:103], v[36:39]
    ds_read_b128 v[164:167], v247 offset:4096
    v_mfma_f32_16x16x32_bf16 v[40:43], v[64:67], v[104:107], v[40:43]
    ds_read_b128 v[168:171], v247 offset:8192
    v_mfma_f32_16x16x32_bf16 v[40:43], v[68:71], v[100:103], v[40:43]
    ds_read_b128 v[172:175], v247 offset:12288
    v_mfma_f32_16x16x32_bf16 v[40:43], v[72:75], v[96:99], v[40:43]
    v_alignbit_b32 v225, v226, v225, 16
    v_mfma_f32_16x16x32_bf16 v[44:47], v[76:79], v[96:99], v[44:47]
    ds_read_b128 v[176:179], v247 offset:16384
    v_mfma_f32_16x16x32_bf16 v[44:47], v[72:75], v[100:103], v[44:47]
    ds_read_b128 v[180:183], v247 offset:20480
    v_mfma_f32_16x16x32_bf16 v[44:47], v[68:71], v[104:107], v[44:47]
    ds_read_b128 v[184:187], v247 offset:24576
    v_mfma_f32_16x16x32_bf16 v[44:47], v[64:67], v[108:111], v[44:47]
    v_alignbit_b32 v226, v227, v226, 16
    s_waitcnt lgkmcnt(8)
    v_mfma_f32_16x16x32_bf16 v[48:51], v[64:67], v[112:115], v[48:51]
    ds_read_b128 v[188:191], v247 offset:28672
    v_mfma_f32_16x16x32_bf16 v[48:51], v[68:71], v[108:111], v[48:51]
    ds_read2_b32 v[128:129], v236 offset0:112 offset1:113
    v_mfma_f32_16x16x32_bf16 v[48:51], v[72:75], v[104:107], v[48:51]
    v_alignbit_b32 v227, v228, v227, 16
    v_mfma_f32_16x16x32_bf16 v[48:51], v[76:79], v[100:103], v[48:51]
    ds_read2_b32 v[130:131], v236 offset0:114 offset1:115
    v_mfma_f32_16x16x32_bf16 v[48:51], v[80:83], v[96:99], v[48:51]
    ds_read2_b32 v[132:133], v236 offset0:240 offset1:241
    v_mfma_f32_16x16x32_bf16 v[52:55], v[84:87], v[96:99], v[52:55]
    ds_read2_b32 v[134:135], v236 offset0:242 offset1:243
    v_mfma_f32_16x16x32_bf16 v[52:55], v[80:83], v[100:103], v[52:55]
    ds_write_b128 v241, v[224:227] offset:14560
    v_mfma_f32_16x16x32_bf16 v[52:55], v[76:79], v[104:107], v[52:55]
    ds_read2_b32 v[136:137], v237 offset0:112 offset1:113
    v_mfma_f32_16x16x32_bf16 v[52:55], v[72:75], v[108:111], v[52:55]
    s_add_u32 s6, s12, 4718592
    ds_read2_b32 v[138:139], v237 offset0:114 offset1:115
    v_mfma_f32_16x16x32_bf16 v[52:55], v[68:71], v[112:115], v[52:55]
    ds_read2_b32 v[140:141], v237 offset0:240 offset1:241
    v_alignbit_b32 v230, v231, v230, 16
    v_mfma_f32_16x16x32_bf16 v[52:55], v[64:67], v[116:119], v[52:55]
    ds_read2_b32 v[142:143], v237 offset0:242 offset1:243
    v_xor_b32 v244, 64, v244
    v_mfma_f32_16x16x32_bf16 v[56:59], v[64:67], v[120:123], v[56:59]
    ds_read2_b32 v[144:145], v238 offset0:112 offset1:113
    v_mfma_f32_16x16x32_bf16 v[56:59], v[68:71], v[116:119], v[56:59]
    ds_read2_b32 v[146:147], v238 offset0:114 offset1:115
    v_mfma_f32_16x16x32_bf16 v[56:59], v[72:75], v[112:115], v[56:59]
    ds_read2_b32 v[148:149], v238 offset0:240 offset1:241
    v_alignbit_b32 v231, v232, v231, 16
    v_mfma_f32_16x16x32_bf16 v[56:59], v[76:79], v[108:111], v[56:59]
    ds_read2_b32 v[150:151], v238 offset0:242 offset1:243
    v_xor_b32 v245, 64, v245
    v_mfma_f32_16x16x32_bf16 v[56:59], v[80:83], v[104:107], v[56:59]
    ds_read2_b32 v[152:153], v239 offset0:112 offset1:113
    v_mfma_f32_16x16x32_bf16 v[56:59], v[84:87], v[100:103], v[56:59]
    ds_read2_b32 v[154:155], v239 offset0:114 offset1:115
    v_mfma_f32_16x16x32_bf16 v[56:59], v[88:91], v[96:99], v[56:59]
    ds_read2_b32 v[156:157], v239 offset0:240 offset1:241
    v_alignbit_b32 v232, v233, v232, 16
    v_mfma_f32_16x16x32_bf16 v[60:63], v[92:95], v[96:99], v[60:63]
    ds_read2_b32 v[158:159], v239 offset0:242 offset1:243
    v_mfma_f32_16x16x32_bf16 v[60:63], v[88:91], v[100:103], v[60:63]
    v_xor_b32 v246, 64, v246
    v_add_u32 v236, 8320, v236
    v_mfma_f32_16x16x32_bf16 v[60:63], v[84:87], v[104:107], v[60:63]
    v_alignbit_b32 v233, v234, v233, 16
    v_mfma_f32_16x16x32_bf16 v[60:63], v[80:83], v[108:111], v[60:63]
    v_add_u32 v237, 8320, v237
    v_mfma_f32_16x16x32_bf16 v[60:63], v[76:79], v[112:115], v[60:63]
    v_mfma_f32_16x16x32_bf16 v[60:63], v[72:75], v[116:119], v[60:63]
    v_xor_b32 v247, 64, v247
    v_add_u32 v238, 8320, v238
    v_mfma_f32_16x16x32_bf16 v[60:63], v[68:71], v[120:123], v[60:63]
    ds_write_b128 v241, v[230:233] offset:15584
    v_mfma_f32_16x16x32_bf16 v[60:63], v[64:67], v[124:127], v[60:63]
    v_add_u32 v239, 8320, v239
    s_waitcnt lgkmcnt(1)
    v_mfma_f32_16x16x32_bf16 v[60:63], v[128:131], v[188:191], v[60:63]
    ds_read_b128 v[96:99], v244 offset:2048
    v_mfma_f32_16x16x32_bf16 v[60:63], v[132:135], v[184:187], v[60:63]
    ds_read2_b32 v[64:65], v236 offset0:0 offset1:1
    v_mfma_f32_16x16x32_bf16 v[60:63], v[136:139], v[180:183], v[60:63]
    ds_read2_b32 v[66:67], v236 offset0:2 offset1:3
    v_mfma_f32_16x16x32_bf16 v[60:63], v[140:143], v[176:179], v[60:63]
    ds_read_b128 v[100:103], v244 offset:6144
    v_mfma_f32_16x16x32_bf16 v[60:63], v[144:147], v[172:175], v[60:63]
    ds_read2_b32 v[68:69], v236 offset0:128 offset1:129
    v_mfma_f32_16x16x32_bf16 v[60:63], v[148:151], v[168:171], v[60:63]
    ds_read2_b32 v[70:71], v236 offset0:130 offset1:131
    v_mfma_f32_16x16x32_bf16 v[60:63], v[152:155], v[164:167], v[60:63]
    ds_read_b128 v[104:107], v244 offset:10240
    v_mfma_f32_16x16x32_bf16 v[60:63], v[156:159], v[160:163], v[60:63]
    s_waitcnt vmcnt(4)
    s_barrier
    s_add_u32 s13, s12, 32768
    v_mfma_f32_16x16x32_bf16 v[56:59], v[128:131], v[184:187], v[56:59]
    ds_read2_b32 v[72:73], v237 offset0:0 offset1:1
    v_add_u32 v10, 131072, v10
    v_mfma_f32_16x16x32_bf16 v[56:59], v[132:135], v[180:183], v[56:59]
    ds_read_b64_tr_b16 a[32:33], v10 offset:16384
    s_add_u32 m0, s74, 32
    v_mfma_f32_16x16x32_bf16 v[56:59], v[136:139], v[176:179], v[56:59]
    ds_read_b64_tr_b16 a[34:35], v10 offset:18432
    buffer_load_dwordx4 v240, s[48:51], s13 offen offset:0 lds
    ds_read2_b32 v[74:75], v237 offset0:2 offset1:3
    v_mfma_f32_16x16x32_bf16 v[56:59], v[140:143], v[172:175], v[56:59]
    ds_read_b64_tr_b16 a[40:41], v10 offset:20480
    ds_read_b128 v[108:111], v244 offset:14336
    v_mfma_f32_16x16x32_bf16 v[56:59], v[144:147], v[168:171], v[56:59]
    ds_read2_b32 v[76:77], v237 offset0:128 offset1:129
    v_mfma_f32_16x16x32_bf16 v[56:59], v[148:151], v[164:167], v[56:59]
    ds_read_b64_tr_b16 a[42:43], v10 offset:22528
    v_cvt_pk_bf16_f32 v206, v60, v61
    v_mfma_f32_16x16x32_bf16 v[56:59], v[152:155], v[160:163], v[56:59]
    ds_read2_b32 v[78:79], v237 offset0:130 offset1:131
    v_add_u32 v11, 131072, v11
    v_mfma_f32_16x16x32_bf16 v[52:55], v[128:131], v[180:183], v[52:55]
    ds_read_b64_tr_b16 a[36:37], v11 offset:16384
    ds_read_b128 v[112:115], v244 offset:18432
    v_mfma_f32_16x16x32_bf16 v[52:55], v[132:135], v[176:179], v[52:55]
    ds_read_b64_tr_b16 a[38:39], v11 offset:18432
    s_add_u32 m0, s74, 32
    v_cvt_pk_bf16_f32 v207, v62, v63
    v_mfma_f32_16x16x32_bf16 v[52:55], v[136:139], v[172:175], v[52:55]
    ds_read_b64_tr_b16 a[44:45], v11 offset:20480
    buffer_load_dwordx4 v240, s[48:51], s13 offen offset:1024 lds
    ds_read2_b32 v[80:81], v238 offset0:0 offset1:1
    v_mfma_f32_16x16x32_bf16 v[52:55], v[140:143], v[168:171], v[52:55]
    buffer_store_dwordx2 v[206:207], v8, s[44:47], s6 offen offset:3584 sc1
    ds_read_b64_tr_b16 a[46:47], v11 offset:22528
    v_mfma_f32_16x16x32_bf16 v[52:55], v[144:147], v[164:167], v[52:55]
    ds_read2_b32 v[82:83], v238 offset0:2 offset1:3
    v_mfma_f32_16x16x32_bf16 v[52:55], v[148:151], v[160:163], v[52:55]
    ds_read_b128 v[116:119], v244 offset:22528
    v_mfma_f32_16x16x32_bf16 v[48:51], v[128:131], v[176:179], v[48:51]
    ds_read2_b32 v[84:85], v238 offset0:128 offset1:129
    v_cvt_pk_bf16_f32 v204, v56, v57
    v_mfma_f32_16x16x32_bf16 v[48:51], v[132:135], v[172:175], v[48:51]
    ds_read2_b32 v[86:87], v238 offset0:130 offset1:131
    v_mfma_f32_16x16x32_bf16 v[48:51], v[136:139], v[168:171], v[48:51]
    ds_read_b128 v[120:123], v244 offset:26624
    v_mfma_f32_16x16x32_bf16 v[48:51], v[140:143], v[164:167], v[48:51]
    ds_read2_b32 v[88:89], v239 offset0:0 offset1:1
    s_add_u32 m0, s74, 32
    v_cvt_pk_bf16_f32 v205, v58, v59
    v_mfma_f32_16x16x32_bf16 v[48:51], v[144:147], v[160:163], v[48:51]
    buffer_load_dwordx4 v240, s[48:51], s13 offen offset:2048 lds
    ds_read2_b32 v[90:91], v239 offset0:2 offset1:3
    v_mfma_f32_16x16x32_bf16 v[44:47], v[128:131], v[172:175], v[44:47]
    buffer_store_dwordx2 v[204:205], v8, s[44:47], s6 offen offset:3072 sc1
    ds_read_b128 v[124:127], v244 offset:30720
    v_mfma_f32_16x16x32_bf16 v[44:47], v[132:135], v[168:171], v[44:47]
    ds_read2_b32 v[92:93], v239 offset0:128 offset1:129
    v_mfma_f32_16x16x32_bf16 v[44:47], v[136:139], v[164:167], v[44:47]
    ds_read2_b32 v[94:95], v239 offset0:130 offset1:131
    v_mfma_f32_16x16x32_bf16 v[44:47], v[140:143], v[160:163], v[44:47]
    v_cvt_pk_bf16_f32 v202, v52, v53
    v_mfma_f32_16x16x32_bf16 v[40:43], v[128:131], v[168:171], v[40:43]
    v_mfma_f32_16x16x32_bf16 v[40:43], v[132:135], v[164:167], v[40:43]
    v_mfma_f32_16x16x32_bf16 v[40:43], v[136:139], v[160:163], v[40:43]
    s_add_u32 m0, s74, 32
    v_cvt_pk_bf16_f32 v203, v54, v55
    v_mfma_f32_16x16x32_bf16 v[36:39], v[128:131], v[164:167], v[36:39]
    buffer_load_dwordx4 v240, s[48:51], s13 offen offset:3072 lds
    v_mfma_f32_16x16x32_bf16 v[36:39], v[132:135], v[160:163], v[36:39]
    buffer_store_dwordx2 v[202:203], v8, s[44:47], s6 offen offset:2560 sc1
    v_mfma_f32_16x16x32_bf16 v[32:35], v[128:131], v[160:163], v[32:35]
    s_waitcnt lgkmcnt(0)
    v_mfma_f32_16x16x32_bf16 v[60:63], v[64:67], v[124:127], 0
    ds_read_b128 v[160:163], v245 offset:2048
    v_mfma_f32_16x16x32_bf16 v[60:63], v[68:71], v[120:123], v[60:63]
    v_cvt_pk_bf16_f32 v200, v48, v49
    v_mfma_f32_16x16x32_bf16 v[60:63], v[72:75], v[116:119], v[60:63]
    ds_read2_b32 v[128:129], v236 offset0:16 offset1:17
    v_mfma_f32_16x16x32_bf16 v[60:63], v[76:79], v[112:115], v[60:63]
    ds_read2_b32 v[130:131], v236 offset0:18 offset1:19
    v_cvt_pk_bf16_f32 v201, v50, v51
    v_mfma_f32_16x16x32_bf16 v[60:63], v[80:83], v[108:111], v[60:63]
    v_mfma_f32_16x16x32_bf16 v[60:63], v[84:87], v[104:107], v[60:63]
    buffer_store_dwordx2 v[200:201], v8, s[44:47], s6 offen offset:2048 sc1
    ds_read_b128 v[164:167], v245 offset:6144
    v_mfma_f32_16x16x32_bf16 v[60:63], v[88:91], v[100:103], v[60:63]
    ds_read2_b32 v[132:133], v236 offset0:144 offset1:145
    v_mfma_f32_16x16x32_bf16 v[60:63], v[92:95], v[96:99], v[60:63]
    ds_read2_b32 v[134:135], v236 offset0:146 offset1:147
    v_cvt_pk_bf16_f32 v198, v44, v45
    v_mfma_f32_16x16x32_bf16 v[56:59], v[64:67], v[120:123], 0
    ds_read_b128 v[168:171], v245 offset:10240
    v_mfma_f32_16x16x32_bf16 v[56:59], v[68:71], v[116:119], v[56:59]
    ds_read2_b32 v[136:137], v237 offset0:16 offset1:17
    v_mfma_f32_16x16x32_bf16 v[56:59], v[72:75], v[112:115], v[56:59]
    ds_read2_b32 v[138:139], v237 offset0:18 offset1:19
    v_cvt_pk_bf16_f32 v199, v46, v47
    v_mfma_f32_16x16x32_bf16 v[56:59], v[76:79], v[108:111], v[56:59]
    ds_read_b128 v[172:175], v245 offset:14336
    v_mfma_f32_16x16x32_bf16 v[56:59], v[80:83], v[104:107], v[56:59]
    buffer_store_dwordx2 v[198:199], v8, s[44:47], s6 offen offset:1536 sc1
    ds_read2_b32 v[140:141], v237 offset0:144 offset1:145
    v_mfma_f32_16x16x32_bf16 v[56:59], v[84:87], v[100:103], v[56:59]
    ds_read2_b32 v[142:143], v237 offset0:146 offset1:147
    v_mfma_f32_16x16x32_bf16 v[56:59], v[88:91], v[96:99], v[56:59]
    ds_read_b128 v[176:179], v245 offset:18432
    v_cvt_pk_bf16_f32 v196, v40, v41
    v_mfma_f32_16x16x32_bf16 v[52:55], v[64:67], v[116:119], 0
    ds_read2_b32 v[144:145], v238 offset0:16 offset1:17
    v_mfma_f32_16x16x32_bf16 v[52:55], v[68:71], v[112:115], v[52:55]
    ds_read2_b32 v[146:147], v238 offset0:18 offset1:19
    v_cvt_pk_bf16_f32 v197, v42, v43
    v_mfma_f32_16x16x32_bf16 v[52:55], v[72:75], v[108:111], v[52:55]
    ds_read_b128 v[180:183], v245 offset:22528
    v_mfma_f32_16x16x32_bf16 v[52:55], v[76:79], v[104:107], v[52:55]
    buffer_store_dwordx2 v[196:197], v8, s[44:47], s6 offen offset:1024 sc1
    ds_read2_b32 v[148:149], v238 offset0:144 offset1:145
    v_mfma_f32_16x16x32_bf16 v[52:55], v[80:83], v[100:103], v[52:55]
    ds_read2_b32 v[150:151], v238 offset0:146 offset1:147
    v_mfma_f32_16x16x32_bf16 v[52:55], v[84:87], v[96:99], v[52:55]
    ds_read_b128 v[184:187], v245 offset:26624
    v_mfma_f32_16x16x32_bf16 v[48:51], v[64:67], v[112:115], 0
    s_waitcnt vmcnt(10)
    s_barrier
    v_cvt_pk_bf16_f32 v194, v36, v37
    v_mfma_f32_16x16x32_bf16 v[48:51], v[68:71], v[108:111], v[48:51]
    ds_read2_b32 v[152:153], v239 offset0:16 offset1:17
    v_add_u32 v10, -131072, v10
    v_mfma_f32_16x16x32_bf16 v[48:51], v[72:75], v[104:107], v[48:51]
    ds_read_b64_tr_b16 a[48:49], v10 offset:49152
    v_cvt_pk_bf16_f32 v195, v38, v39
    v_mfma_f32_16x16x32_bf16 v[48:51], v[76:79], v[100:103], v[48:51]
    buffer_store_dwordx2 v[194:195], v8, s[44:47], s6 offen offset:512 sc1
    ds_read2_b32 v[154:155], v239 offset0:18 offset1:19
    v_mfma_f32_16x16x32_bf16 v[48:51], v[80:83], v[96:99], v[48:51]
    ds_read_b64_tr_b16 a[50:51], v10 offset:51200
    v_mfma_f32_16x16x32_bf16 v[44:47], v[64:67], v[108:111], 0
    ds_read_b64_tr_b16 a[56:57], v10 offset:53248
    v_mfma_f32_16x16x32_bf16 v[44:47], v[68:71], v[104:107], v[44:47]
    ds_read_b64_tr_b16 a[58:59], v10 offset:55296
    v_cvt_pk_bf16_f32 v192, v32, v33
    v_mfma_f32_16x16x32_bf16 v[44:47], v[72:75], v[100:103], v[44:47]
    ds_read_b128 v[188:191], v245 offset:30720
    v_add_u32 v11, -131072, v11
    v_mfma_f32_16x16x32_bf16 v[44:47], v[76:79], v[96:99], v[44:47]
    ds_read_b64_tr_b16 a[52:53], v11 offset:49152
    v_cvt_pk_bf16_f32 v193, v34, v35
    v_mfma_f32_16x16x32_bf16 v[40:43], v[64:67], v[104:107], 0
    buffer_store_dwordx2 v[192:193], v8, s[44:47], s6 offen offset:0 sc1
    ds_read2_b32 v[156:157], v239 offset0:144 offset1:145
    v_mfma_f32_16x16x32_bf16 v[40:43], v[68:71], v[100:103], v[40:43]
    ds_read_b64_tr_b16 a[54:55], v11 offset:51200
    v_mfma_f32_16x16x32_bf16 v[40:43], v[72:75], v[96:99], v[40:43]
    ds_read_b64_tr_b16 a[60:61], v11 offset:53248
    v_mfma_f32_16x16x32_bf16 v[36:39], v[64:67], v[100:103], 0
    ds_read_b64_tr_b16 a[62:63], v11 offset:55296
    v_mfma_f32_16x16x32_bf16 v[36:39], v[68:71], v[96:99], v[36:39]
    ds_read2_b32 v[158:159], v239 offset0:146 offset1:147
    v_mfma_f32_16x16x32_bf16 v[32:35], v[64:67], v[96:99], 0
    s_waitcnt lgkmcnt(15)
    v_mfma_f32_16x16x32_bf16 v[32:35], v[128:131], v[160:163], v[32:35]
    ds_read_b128 v[96:99], v246 offset:2048
    v_mfma_f32_16x16x32_bf16 v[36:39], v[132:135], v[160:163], v[36:39]
    v_mfma_f32_16x16x32_bf16 v[36:39], v[128:131], v[164:167], v[36:39]
    ds_read2_b32 v[64:65], v236 offset0:32 offset1:33
    v_mfma_f32_16x16x32_bf16 v[40:43], v[128:131], v[168:171], v[40:43]
    ds_read2_b32 v[66:67], v236 offset0:34 offset1:35
    v_mfma_f32_16x16x32_bf16 v[40:43], v[132:135], v[164:167], v[40:43]
    v_mfma_f32_16x16x32_bf16 v[40:43], v[136:139], v[160:163], v[40:43]
    ds_read_b128 v[100:103], v246 offset:6144
    v_mfma_f32_16x16x32_bf16 v[44:47], v[140:143], v[160:163], v[44:47]
    ds_read2_b32 v[68:69], v236 offset0:160 offset1:161
    v_mfma_f32_16x16x32_bf16 v[44:47], v[136:139], v[164:167], v[44:47]
    v_mfma_f32_16x16x32_bf16 v[44:47], v[132:135], v[168:171], v[44:47]
    ds_read2_b32 v[70:71], v236 offset0:162 offset1:163
    v_mfma_f32_16x16x32_bf16 v[44:47], v[128:131], v[172:175], v[44:47]
    ds_read_b128 v[104:107], v246 offset:10240
    s_waitcnt lgkmcnt(7)
    v_mfma_f32_16x16x32_bf16 v[48:51], v[128:131], v[176:179], v[48:51]
    ds_read2_b32 v[72:73], v237 offset0:32 offset1:33
    v_mfma_f32_16x16x32_bf16 v[48:51], v[132:135], v[172:175], v[48:51]
    ds_read2_b32 v[74:75], v237 offset0:34 offset1:35
    v_mfma_f32_16x16x32_bf16 v[48:51], v[136:139], v[168:171], v[48:51]
    v_mov_b32 v9, 16
    buffer_load_ushort v9, v9, s[56:59], s70 offen
    v_mfma_f32_16x16x32_bf16 v[48:51], v[140:143], v[164:167], v[48:51]
    ds_read_b128 v[108:111], v246 offset:14336
    v_mfma_f32_16x16x32_bf16 v[48:51], v[144:147], v[160:163], v[48:51]
    v_mfma_f32_16x16x32_bf16 v[52:55], v[148:151], v[160:163], v[52:55]
    ds_read2_b32 v[76:77], v237 offset0:160 offset1:161
    v_mfma_f32_16x16x32_bf16 v[52:55], v[144:147], v[164:167], v[52:55]
    ds_read2_b32 v[78:79], v237 offset0:162 offset1:163
    v_mfma_f32_16x16x32_bf16 v[52:55], v[140:143], v[168:171], v[52:55]
    v_mfma_f32_16x16x32_bf16 v[52:55], v[136:139], v[172:175], v[52:55]
    s_lshl_b32 s14, s88, 18
    ds_read_b128 v[112:115], v246 offset:18432
    v_mfma_f32_16x16x32_bf16 v[52:55], v[132:135], v[176:179], v[52:55]
    s_add_u32 m0, s73, 147456
    ds_read2_b32 v[80:81], v238 offset0:32 offset1:33
    v_mfma_f32_16x16x32_bf16 v[52:55], v[128:131], v[180:183], v[52:55]
    buffer_load_dwordx4 v4, s[52:55], s14 offen offset:0 lds
    v_mfma_f32_16x16x32_bf16 v[56:59], v[128:131], v[184:187], v[56:59]
    ds_read2_b32 v[82:83], v238 offset0:34 offset1:35
    v_mfma_f32_16x16x32_bf16 v[56:59], v[132:135], v[180:183], v[56:59]
    ds_read_b128 v[116:119], v246 offset:22528
    v_mfma_f32_16x16x32_bf16 v[56:59], v[136:139], v[176:179], v[56:59]
    v_mfma_f32_16x16x32_bf16 v[56:59], v[140:143], v[172:175], v[56:59]
    ds_read2_b32 v[84:85], v238 offset0:160 offset1:161
    v_mfma_f32_16x16x32_bf16 v[56:59], v[144:147], v[168:171], v[56:59]
    ds_read2_b32 v[86:87], v238 offset0:162 offset1:163
    v_mfma_f32_16x16x32_bf16 v[56:59], v[148:151], v[164:167], v[56:59]
    s_add_u32 m0, s73, 147456
    ds_read_b128 v[120:123], v246 offset:26624
    v_mfma_f32_16x16x32_bf16 v[56:59], v[152:155], v[160:163], v[56:59]
    buffer_load_dwordx4 v5, s[52:55], s14 offen offset:1024 lds
    v_mfma_f32_16x16x32_bf16 v[60:63], v[156:159], v[160:163], v[60:63]
    ds_read2_b32 v[88:89], v239 offset0:32 offset1:33
    v_mfma_f32_16x16x32_bf16 v[60:63], v[152:155], v[164:167], v[60:63]
    ds_read2_b32 v[90:91], v239 offset0:34 offset1:35
    v_mfma_f32_16x16x32_bf16 v[60:63], v[148:151], v[168:171], v[60:63]
    v_mfma_f32_16x16x32_bf16 v[60:63], v[144:147], v[172:175], v[60:63]
    ds_read_b128 v[124:127], v246 offset:30720
    v_mfma_f32_16x16x32_bf16 v[60:63], v[140:143], v[176:179], v[60:63]
    ds_read2_b32 v[92:93], v239 offset0:160 offset1:161
    v_mfma_f32_16x16x32_bf16 v[60:63], v[136:139], v[180:183], v[60:63]
    s_add_u32 m0, s73, 147456
    v_mfma_f32_16x16x32_bf16 v[60:63], v[132:135], v[184:187], v[60:63]
    buffer_load_dwordx4 v6, s[52:55], s14 offen offset:2048 lds
    ds_read2_b32 v[94:95], v239 offset0:162 offset1:163
    v_mfma_f32_16x16x32_bf16 v[60:63], v[128:131], v[188:191], v[60:63]
    s_waitcnt lgkmcnt(12)
    v_mfma_f32_16x16x32_bf16 v[32:35], v[64:67], v[96:99], v[32:35]
    ds_read_b128 v[160:163], v247 offset:2048
    v_mfma_f32_16x16x32_bf16 v[36:39], v[68:71], v[96:99], v[36:39]
    v_mfma_f32_16x16x32_bf16 v[36:39], v[64:67], v[100:103], v[36:39]
    ds_read2_b32 v[128:129], v236 offset0:48 offset1:49
    v_mfma_f32_16x16x32_bf16 v[40:43], v[64:67], v[104:107], v[40:43]
    ds_read2_b32 v[130:131], v236 offset0:50 offset1:51
    v_mfma_f32_16x16x32_bf16 v[40:43], v[68:71], v[100:103], v[40:43]
    s_add_u32 m0, s73, 147456
    v_mfma_f32_16x16x32_bf16 v[40:43], v[72:75], v[96:99], v[40:43]
    buffer_load_dwordx4 v7, s[52:55], s14 offen offset:3072 lds
    ds_read_b128 v[164:167], v247 offset:6144
    v_mfma_f32_16x16x32_bf16 v[44:47], v[76:79], v[96:99], v[44:47]
    ds_read2_b32 v[132:133], v236 offset0:176 offset1:177
    v_mfma_f32_16x16x32_bf16 v[44:47], v[72:75], v[100:103], v[44:47]
    s_barrier
    v_mfma_f32_16x16x32_bf16 v[44:47], v[68:71], v[104:107], v[44:47]
    ds_read2_b32 v[134:135], v236 offset0:178 offset1:179
    v_mfma_f32_16x16x32_bf16 v[44:47], v[64:67], v[108:111], v[44:47]
    ds_read_b128 v[168:171], v247 offset:10240
    s_waitcnt lgkmcnt(7)
    v_mfma_f32_16x16x32_bf16 v[48:51], v[64:67], v[112:115], v[48:51]
    ds_read2_b32 v[136:137], v237 offset0:48 offset1:49
    v_mfma_f32_16x16x32_bf16 v[48:51], v[68:71], v[108:111], v[48:51]
    v_mfma_f32_16x16x32_bf16 v[48:51], v[72:75], v[104:107], v[48:51]
    ds_read2_b32 v[138:139], v237 offset0:50 offset1:51
    v_mfma_f32_16x16x32_bf16 v[48:51], v[76:79], v[100:103], v[48:51]
    ds_read_b128 v[172:175], v247 offset:14336
    v_mfma_f32_16x16x32_bf16 v[48:51], v[80:83], v[96:99], v[48:51]
    v_mfma_f32_16x16x32_bf16 v[52:55], v[84:87], v[96:99], v[52:55]
    ds_read2_b32 v[140:141], v237 offset0:176 offset1:177
    v_mfma_f32_16x16x32_bf16 v[52:55], v[80:83], v[100:103], v[52:55]
    ds_read2_b32 v[142:143], v237 offset0:178 offset1:179
    v_mfma_f32_16x16x32_bf16 v[52:55], v[76:79], v[104:107], v[52:55]
    v_mfma_f32_16x16x32_bf16 v[52:55], v[72:75], v[108:111], v[52:55]
    ds_read_b128 v[176:179], v247 offset:18432
    v_mfma_f32_16x16x32_bf16 v[52:55], v[68:71], v[112:115], v[52:55]
    ds_read2_b32 v[144:145], v238 offset0:48 offset1:49
    v_mfma_f32_16x16x32_bf16 v[52:55], v[64:67], v[116:119], v[52:55]
    v_mfma_f32_16x16x32_bf16 v[56:59], v[64:67], v[120:123], v[56:59]
    ds_read2_b32 v[146:147], v238 offset0:50 offset1:51
    v_mfma_f32_16x16x32_bf16 v[56:59], v[68:71], v[116:119], v[56:59]
    ds_read_b128 v[180:183], v247 offset:22528
    v_mfma_f32_16x16x32_bf16 v[56:59], v[72:75], v[112:115], v[56:59]
    v_mfma_f32_16x16x32_bf16 v[56:59], v[76:79], v[108:111], v[56:59]
    ds_read2_b32 v[148:149], v238 offset0:176 offset1:177
    v_mfma_f32_16x16x32_bf16 v[56:59], v[80:83], v[104:107], v[56:59]
    ds_read2_b32 v[150:151], v238 offset0:178 offset1:179
    v_mfma_f32_16x16x32_bf16 v[56:59], v[84:87], v[100:103], v[56:59]
    ds_read_b128 v[184:187], v247 offset:26624
    v_mfma_f32_16x16x32_bf16 v[56:59], v[88:91], v[96:99], v[56:59]
    v_mfma_f32_16x16x32_bf16 v[60:63], v[92:95], v[96:99], v[60:63]
    ds_read2_b32 v[152:153], v239 offset0:48 offset1:49
    v_mfma_f32_16x16x32_bf16 v[60:63], v[88:91], v[100:103], v[60:63]
    ds_read2_b32 v[154:155], v239 offset0:50 offset1:51
    v_mfma_f32_16x16x32_bf16 v[60:63], v[84:87], v[104:107], v[60:63]
    v_mfma_f32_16x16x32_bf16 v[60:63], v[80:83], v[108:111], v[60:63]
    ds_read_b128 v[188:191], v247 offset:30720
    v_mfma_f32_16x16x32_bf16 v[60:63], v[76:79], v[112:115], v[60:63]
    ds_read2_b32 v[156:157], v239 offset0:176 offset1:177
    v_mfma_f32_16x16x32_bf16 v[60:63], v[72:75], v[116:119], v[60:63]
    v_mfma_f32_16x16x32_bf16 v[60:63], v[68:71], v[120:123], v[60:63]
    ds_read2_b32 v[158:159], v239 offset0:178 offset1:179
    v_mfma_f32_16x16x32_bf16 v[60:63], v[64:67], v[124:127], v[60:63]
    s_waitcnt lgkmcnt(12)
    v_mfma_f32_16x16x32_bf16 v[32:35], v[128:131], v[160:163], v[32:35]
    ds_read_b128 v[96:99], v244 offset:0
    v_mfma_f32_16x16x32_bf16 v[36:39], v[132:135], v[160:163], v[36:39]
    v_mfma_f32_16x16x32_bf16 v[36:39], v[128:131], v[164:167], v[36:39]
    ds_read2_b32 v[64:65], v236 offset0:64 offset1:65
    v_mfma_f32_16x16x32_bf16 v[40:43], v[128:131], v[168:171], v[40:43]
    ds_read2_b32 v[66:67], v236 offset0:66 offset1:67
    v_mfma_f32_16x16x32_bf16 v[40:43], v[132:135], v[164:167], v[40:43]
    v_mfma_f32_16x16x32_bf16 v[40:43], v[136:139], v[160:163], v[40:43]
    ds_read_b128 v[100:103], v244 offset:4096
    v_mfma_f32_16x16x32_bf16 v[44:47], v[140:143], v[160:163], v[44:47]
    ds_read2_b32 v[68:69], v236 offset0:192 offset1:193
    v_mfma_f32_16x16x32_bf16 v[44:47], v[136:139], v[164:167], v[44:47]
    s_add_u32 m0, s9, 36864
    s_add_u32 s13, s11, 0
    v_mfma_f32_16x16x32_bf16 v[44:47], v[132:135], v[168:171], v[44:47]
    buffer_load_dwordx4 v15, s[44:47], s13 offen sc1 lds
    ds_read2_b32 v[70:71], v236 offset0:194 offset1:195
    v_mfma_f32_16x16x32_bf16 v[44:47], v[128:131], v[172:175], v[44:47]
    ds_read_b128 v[104:107], v244 offset:8192
    s_waitcnt lgkmcnt(7)
    v_mfma_f32_16x16x32_bf16 v[48:51], v[128:131], v[176:179], v[48:51]
    ds_read2_b32 v[72:73], v237 offset0:64 offset1:65
    v_mfma_f32_16x16x32_bf16 v[48:51], v[132:135], v[172:175], v[48:51]
    v_mfma_f32_16x16x32_bf16 v[48:51], v[136:139], v[168:171], v[48:51]
    ds_read2_b32 v[74:75], v237 offset0:66 offset1:67
    v_mfma_f32_16x16x32_bf16 v[48:51], v[140:143], v[164:167], v[48:51]
    ds_read_b128 v[108:111], v244 offset:12288
    v_mfma_f32_16x16x32_bf16 v[48:51], v[144:147], v[160:163], v[48:51]
    v_mfma_f32_16x16x32_bf16 v[52:55], v[148:151], v[160:163], v[52:55]
    ds_read2_b32 v[76:77], v237 offset0:192 offset1:193
    v_mfma_f32_16x16x32_bf16 v[52:55], v[144:147], v[164:167], v[52:55]
    ds_read2_b32 v[78:79], v237 offset0:194 offset1:195
    s_add_u32 m0, s9, 37888
    s_add_u32 s13, s11, 90112
    v_mfma_f32_16x16x32_bf16 v[52:55], v[140:143], v[168:171], v[52:55]
    buffer_load_dwordx4 v16, s[44:47], s13 offen sc1 lds
    v_mfma_f32_16x16x32_bf16 v[52:55], v[136:139], v[172:175], v[52:55]
    ds_read_b128 v[112:115], v244 offset:16384
    v_mfma_f32_16x16x32_bf16 v[52:55], v[132:135], v[176:179], v[52:55]
    ds_read2_b32 v[80:81], v238 offset0:64 offset1:65
    v_mfma_f32_16x16x32_bf16 v[52:55], v[128:131], v[180:183], v[52:55]
    v_mfma_f32_16x16x32_bf16 v[56:59], v[128:131], v[184:187], v[56:59]
    ds_read2_b32 v[82:83], v238 offset0:66 offset1:67
    v_mfma_f32_16x16x32_bf16 v[56:59], v[132:135], v[180:183], v[56:59]
    ds_read_b128 v[116:119], v244 offset:20480
    v_mfma_f32_16x16x32_bf16 v[56:59], v[136:139], v[176:179], v[56:59]
    v_mfma_f32_16x16x32_bf16 v[56:59], v[140:143], v[172:175], v[56:59]
    ds_read2_b32 v[84:85], v238 offset0:192 offset1:193
    v_mfma_f32_16x16x32_bf16 v[56:59], v[144:147], v[168:171], v[56:59]
    ds_read2_b32 v[86:87], v238 offset0:194 offset1:195
    s_add_u32 m0, s9, 38912
    s_add_u32 s13, s11, 180224
    v_mfma_f32_16x16x32_bf16 v[56:59], v[148:151], v[164:167], v[56:59]
    buffer_load_dwordx4 v15, s[44:47], s13 offen sc1 lds
    ds_read_b128 v[120:123], v244 offset:24576
    v_mfma_f32_16x16x32_bf16 v[56:59], v[152:155], v[160:163], v[56:59]
    v_mfma_f32_16x16x32_bf16 v[60:63], v[156:159], v[160:163], v[60:63]
    ds_read2_b32 v[88:89], v239 offset0:64 offset1:65
    v_mfma_f32_16x16x32_bf16 v[60:63], v[152:155], v[164:167], v[60:63]
    ds_read2_b32 v[90:91], v239 offset0:66 offset1:67
    v_mfma_f32_16x16x32_bf16 v[60:63], v[148:151], v[168:171], v[60:63]
    v_mfma_f32_16x16x32_bf16 v[60:63], v[144:147], v[172:175], v[60:63]
    ds_read_b128 v[124:127], v244 offset:28672
    v_mfma_f32_16x16x32_bf16 v[60:63], v[140:143], v[176:179], v[60:63]
    ds_read2_b32 v[92:93], v239 offset0:192 offset1:193
    v_mfma_f32_16x16x32_bf16 v[60:63], v[136:139], v[180:183], v[60:63]
    v_mfma_f32_16x16x32_bf16 v[60:63], v[132:135], v[184:187], v[60:63]
    ds_read2_b32 v[94:95], v239 offset0:194 offset1:195
    s_add_u32 m0, s9, 39936
    s_add_u32 s13, s11, 270336
    v_mfma_f32_16x16x32_bf16 v[60:63], v[128:131], v[188:191], v[60:63]
    buffer_load_dwordx4 v16, s[44:47], s13 offen sc1 lds
    s_waitcnt lgkmcnt(12)
    v_mfma_f32_16x16x32_bf16 v[32:35], v[64:67], v[96:99], v[32:35]
    ds_read_b128 v[160:163], v245 offset:0
    s_waitcnt vmcnt(4)
    s_barrier
    v_mfma_f32_16x16x32_bf16 v[36:39], v[68:71], v[96:99], v[36:39]
    ds_read2_b32 v[128:129], v236 offset0:80 offset1:81
    v_add_u32 v10, 131072, v10
    v_mfma_f32_16x16x32_bf16 v[36:39], v[64:67], v[100:103], v[36:39]
    ds_read_b64_tr_b16 a[64:65], v10 offset:16384
    v_mfma_f32_16x16x32_bf16 v[40:43], v[64:67], v[104:107], v[40:43]
    ds_read_b64_tr_b16 a[66:67], v10 offset:18432
    ds_read2_b32 v[130:131], v236 offset0:82 offset1:83
    v_mfma_f32_16x16x32_bf16 v[40:43], v[68:71], v[100:103], v[40:43]
    ds_read_b64_tr_b16 a[72:73], v10 offset:20480
    v_mfma_f32_16x16x32_bf16 v[40:43], v[72:75], v[96:99], v[40:43]
    ds_read_b64_tr_b16 a[74:75], v10 offset:22528
    ds_read_b128 v[164:167], v245 offset:4096
L_pl_X_3:
    s_cbranch_execz L_pl_X_7
    v_mfma_f32_16x16x32_bf16 v[44:47], v[76:79], v[96:99], v[44:47]
    ds_read2_b32 v[132:133], v236 offset0:208 offset1:209
    v_mfma_f32_16x16x32_bf16 v[44:47], v[72:75], v[100:103], v[44:47]
    v_add_u32 v11, 131072, v11
    s_add_u32 m0, s9, 40960
    s_add_u32 s13, s11, 360448
    v_mfma_f32_16x16x32_bf16 v[44:47], v[68:71], v[104:107], v[44:47]
    ds_read_b64_tr_b16 a[68:69], v11 offset:16384
    buffer_load_dwordx4 v15, s[44:47], s13 offen sc1 lds
    ds_read2_b32 v[134:135], v236 offset0:210 offset1:211
    v_mfma_f32_16x16x32_bf16 v[44:47], v[64:67], v[108:111], v[44:47]
    ds_read_b64_tr_b16 a[70:71], v11 offset:18432
    ds_read_b128 v[168:171], v245 offset:8192
    s_waitcnt lgkmcnt(13)
    v_mfma_f32_16x16x32_bf16 v[48:51], v[64:67], v[112:115], v[48:51]
    ds_read_b64_tr_b16 a[76:77], v11 offset:20480
    v_mfma_f32_16x16x32_bf16 v[48:51], v[68:71], v[108:111], v[48:51]
    ds_read_b64_tr_b16 a[78:79], v11 offset:22528
    v_mfma_f32_16x16x32_bf16 v[48:51], v[72:75], v[104:107], v[48:51]
    ds_read2_b32 v[136:137], v237 offset0:80 offset1:81
    v_mfma_f32_16x16x32_bf16 v[48:51], v[76:79], v[100:103], v[48:51]
    ds_read2_b32 v[138:139], v237 offset0:82 offset1:83
    v_mfma_f32_16x16x32_bf16 v[48:51], v[80:83], v[96:99], v[48:51]
    ds_read_b128 v[172:175], v245 offset:12288
    v_mfma_f32_16x16x32_bf16 v[52:55], v[84:87], v[96:99], v[52:55]
    ds_read2_b32 v[140:141], v237 offset0:208 offset1:209
    v_mfma_f32_16x16x32_bf16 v[52:55], v[80:83], v[100:103], v[52:55]
    ds_read2_b32 v[142:143], v237 offset0:210 offset1:211
    s_add_u32 m0, s9, 41984
    s_add_u32 s13, s11, 450560
    v_mfma_f32_16x16x32_bf16 v[52:55], v[76:79], v[104:107], v[52:55]
    buffer_load_dwordx4 v16, s[44:47], s13 offen sc1 lds
    ds_read_b128 v[176:179], v245 offset:16384
    v_mfma_f32_16x16x32_bf16 v[52:55], v[72:75], v[108:111], v[52:55]
    ds_read2_b32 v[144:145], v238 offset0:80 offset1:81
    v_mfma_f32_16x16x32_bf16 v[52:55], v[68:71], v[112:115], v[52:55]
    ds_read_b128 v[212:215], v241 offset:32
    v_mfma_f32_16x16x32_bf16 v[52:55], v[64:67], v[116:119], v[52:55]
    ds_read2_b32 v[146:147], v238 offset0:82 offset1:83
    v_mfma_f32_16x16x32_bf16 v[56:59], v[64:67], v[120:123], v[56:59]
    ds_read_b32 v216, v241 offset:48
    v_mfma_f32_16x16x32_bf16 v[56:59], v[68:71], v[116:119], v[56:59]
    ds_read_b128 v[180:183], v245 offset:20480
    v_mfma_f32_16x16x32_bf16 v[56:59], v[72:75], v[112:115], v[56:59]
    ds_read_b128 v[218:221], v241 offset:1056
    v_mfma_f32_16x16x32_bf16 v[56:59], v[76:79], v[108:111], v[56:59]
    ds_read2_b32 v[148:149], v238 offset0:208 offset1:209
    v_mfma_f32_16x16x32_bf16 v[56:59], v[80:83], v[104:107], v[56:59]
    ds_read2_b32 v[150:151], v238 offset0:210 offset1:211
    s_add_u32 m0, s9, 43008
    s_add_u32 s13, s11, 540672
    v_mfma_f32_16x16x32_bf16 v[56:59], v[84:87], v[100:103], v[56:59]
    buffer_load_dwordx4 v15, s[44:47], s13 offen sc1 lds
    ds_read_b32 v222, v241 offset:1072
    v_mfma_f32_16x16x32_bf16 v[56:59], v[88:91], v[96:99], v[56:59]
    ds_read_b128 v[184:187], v245 offset:24576
    v_mfma_f32_16x16x32_bf16 v[60:63], v[92:95], v[96:99], v[60:63]
    ds_read_b128 v[224:227], v241 offset:2080
    ds_read2_b32 v[152:153], v239 offset0:80 offset1:81
    v_mfma_f32_16x16x32_bf16 v[60:63], v[88:91], v[100:103], v[60:63]
    ds_read2_b32 v[154:155], v239 offset0:82 offset1:83
    v_mfma_f32_16x16x32_bf16 v[60:63], v[84:87], v[104:107], v[60:63]
    ds_read_b32 v228, v241 offset:2096
    v_mfma_f32_16x16x32_bf16 v[60:63], v[80:83], v[108:111], v[60:63]
    ds_read_b128 v[188:191], v245 offset:28672
    v_mfma_f32_16x16x32_bf16 v[60:63], v[76:79], v[112:115], v[60:63]
    ds_read_b128 v[230:233], v241 offset:3104
    ds_read2_b32 v[156:157], v239 offset0:208 offset1:209
    v_mfma_f32_16x16x32_bf16 v[60:63], v[72:75], v[116:119], v[60:63]
    ds_read2_b32 v[158:159], v239 offset0:210 offset1:211
    v_mfma_f32_16x16x32_bf16 v[60:63], v[68:71], v[120:123], v[60:63]
    ds_read_b32 v234, v241 offset:3120
    s_add_u32 m0, s9, 44032
    s_add_u32 s13, s11, 630784
    v_mfma_f32_16x16x32_bf16 v[60:63], v[64:67], v[124:127], v[60:63]
    buffer_load_dwordx4 v16, s[44:47], s13 offen sc1 lds
    s_waitcnt lgkmcnt(15)
    v_mfma_f32_16x16x32_bf16 v[32:35], v[128:131], v[160:163], v[32:35]
    ds_read_b128 v[96:99], v246 offset:0
    v_mfma_f32_16x16x32_bf16 v[36:39], v[132:135], v[160:163], v[36:39]
    v_mfma_f32_16x16x32_bf16 v[36:39], v[128:131], v[164:167], v[36:39]
    ds_read2_b32 v[64:65], v236 offset0:96 offset1:97
    v_mfma_f32_16x16x32_bf16 v[40:43], v[128:131], v[168:171], v[40:43]
    ds_read2_b32 v[66:67], v236 offset0:98 offset1:99
    v_mfma_f32_16x16x32_bf16 v[40:43], v[132:135], v[164:167], v[40:43]
    s_waitcnt lgkmcnt(3)
    v_mfma_f32_16x16x32_bf16 v[40:43], v[136:139], v[160:163], v[40:43]
    ds_read_b128 v[100:103], v246 offset:4096
    v_mfma_f32_16x16x32_bf16 v[44:47], v[140:143], v[160:163], v[44:47]
    ds_read2_b32 v[68:69], v236 offset0:224 offset1:225
    v_mfma_f32_16x16x32_bf16 v[44:47], v[136:139], v[164:167], v[44:47]
    v_mfma_f32_16x16x32_bf16 v[44:47], v[132:135], v[168:171], v[44:47]
    ds_read2_b32 v[70:71], v236 offset0:226 offset1:227
    v_lshlrev_b32 v9, 16, v9
    v_mfma_f32_16x16x32_bf16 v[44:47], v[128:131], v[172:175], v[44:47]
    ds_read_b128 v[104:107], v246 offset:8192
    v_mfma_f32_16x16x32_bf16 v[48:51], v[128:131], v[176:179], v[48:51]
    ds_read2_b32 v[72:73], v237 offset0:96 offset1:97
    v_lshlrev_b32 v208, 16, v212
    v_mfma_f32_16x16x32_bf16 v[48:51], v[132:135], v[172:175], v[48:51]
    v_mfma_f32_16x16x32_bf16 v[48:51], v[136:139], v[168:171], v[48:51]
    ds_read2_b32 v[74:75], v237 offset0:98 offset1:99
    v_add_f32 v9, v9, v208
    v_mfma_f32_16x16x32_bf16 v[48:51], v[140:143], v[164:167], v[48:51]
    ds_read_b128 v[108:111], v246 offset:12288
    v_cvt_pk_bf16_f32 v9, v9, v9
    v_mfma_f32_16x16x32_bf16 v[48:51], v[144:147], v[160:163], v[48:51]
    ds_read2_b32 v[76:77], v237 offset0:224 offset1:225
    s_barrier
    v_mfma_f32_16x16x32_bf16 v[52:55], v[148:151], v[160:163], v[52:55]
    ds_write_b16 v242, v9 offset:4160
    v_mfma_f32_16x16x32_bf16 v[52:55], v[144:147], v[164:167], v[52:55]
    ds_read2_b32 v[78:79], v237 offset0:226 offset1:227
    v_mfma_f32_16x16x32_bf16 v[52:55], v[140:143], v[168:171], v[52:55]
    ds_write_b16 v242, v9 offset:2
    v_mfma_f32_16x16x32_bf16 v[52:55], v[136:139], v[172:175], v[52:55]
    s_lshl_b32 s14, s89, 18
    ds_read_b128 v[112:115], v246 offset:16384
    v_mfma_f32_16x16x32_bf16 v[52:55], v[132:135], v[176:179], v[52:55]
    ds_read2_b32 v[80:81], v238 offset0:96 offset1:97
    s_add_u32 m0, s73, 147456
    v_alignbit_b32 v212, v213, v212, 16
    v_mfma_f32_16x16x32_bf16 v[52:55], v[128:131], v[180:183], v[52:55]
    buffer_load_dwordx4 v4, s[52:55], s14 offen offset:0 lds
    v_alignbit_b32 v213, v214, v213, 16
    v_mfma_f32_16x16x32_bf16 v[56:59], v[128:131], v[184:187], v[56:59]
    ds_read2_b32 v[82:83], v238 offset0:98 offset1:99
    v_mfma_f32_16x16x32_bf16 v[56:59], v[132:135], v[180:183], v[56:59]
    ds_read_b128 v[116:119], v246 offset:20480
    v_alignbit_b32 v214, v215, v214, 16
    v_mfma_f32_16x16x32_bf16 v[56:59], v[136:139], v[176:179], v[56:59]
    v_mfma_f32_16x16x32_bf16 v[56:59], v[140:143], v[172:175], v[56:59]
    ds_read2_b32 v[84:85], v238 offset0:224 offset1:225
    v_alignbit_b32 v215, v216, v215, 16
    v_mfma_f32_16x16x32_bf16 v[56:59], v[144:147], v[168:171], v[56:59]
    ds_write_b128 v241, v[212:215] offset:4192
    v_mfma_f32_16x16x32_bf16 v[56:59], v[148:151], v[164:167], v[56:59]
    s_add_u32 m0, s73, 147456
    ds_read2_b32 v[86:87], v238 offset0:226 offset1:227
    v_mfma_f32_16x16x32_bf16 v[56:59], v[152:155], v[160:163], v[56:59]
    buffer_load_dwordx4 v5, s[52:55], s14 offen offset:1024 lds
    ds_read_b128 v[120:123], v246 offset:24576
    v_mfma_f32_16x16x32_bf16 v[60:63], v[156:159], v[160:163], v[60:63]
    ds_read2_b32 v[88:89], v239 offset0:96 offset1:97
    v_alignbit_b32 v218, v219, v218, 16
    v_mfma_f32_16x16x32_bf16 v[60:63], v[152:155], v[164:167], v[60:63]
    ds_read2_b32 v[90:91], v239 offset0:98 offset1:99
    v_alignbit_b32 v219, v220, v219, 16
    v_mfma_f32_16x16x32_bf16 v[60:63], v[148:151], v[168:171], v[60:63]
    ds_read_b128 v[124:127], v246 offset:28672
    v_mfma_f32_16x16x32_bf16 v[60:63], v[144:147], v[172:175], v[60:63]
    v_alignbit_b32 v220, v221, v220, 16
    v_alignbit_b32 v221, v222, v221, 16
    v_mfma_f32_16x16x32_bf16 v[60:63], v[140:143], v[176:179], v[60:63]
    ds_write_b128 v241, v[218:221] offset:5216
    v_mfma_f32_16x16x32_bf16 v[60:63], v[136:139], v[180:183], v[60:63]
    s_add_u32 m0, s73, 147456
    ds_read2_b32 v[92:93], v239 offset0:224 offset1:225
    v_mfma_f32_16x16x32_bf16 v[60:63], v[132:135], v[184:187], v[60:63]
    buffer_load_dwordx4 v6, s[52:55], s14 offen offset:2048 lds
    ds_read2_b32 v[94:95], v239 offset0:226 offset1:227
    v_mfma_f32_16x16x32_bf16 v[60:63], v[128:131], v[188:191], v[60:63]
    s_waitcnt lgkmcnt(15)
    v_mfma_f32_16x16x32_bf16 v[32:35], v[64:67], v[96:99], v[32:35]
    ds_read_b128 v[160:163], v247 offset:0
    v_mfma_f32_16x16x32_bf16 v[36:39], v[68:71], v[96:99], v[36:39]
    v_alignbit_b32 v224, v225, v224, 16
    v_mfma_f32_16x16x32_bf16 v[36:39], v[64:67], v[100:103], v[36:39]
    ds_read_b128 v[164:167], v247 offset:4096
    v_mfma_f32_16x16x32_bf16 v[40:43], v[64:67], v[104:107], v[40:43]
    ds_read_b128 v[168:171], v247 offset:8192
    v_mfma_f32_16x16x32_bf16 v[40:43], v[68:71], v[100:103], v[40:43]
    s_add_u32 m0, s73, 147456
    ds_read_b128 v[172:175], v247 offset:12288
    v_mfma_f32_16x16x32_bf16 v[40:43], v[72:75], v[96:99], v[40:43]
    buffer_load_dwordx4 v7, s[52:55], s14 offen offset:3072 lds
    v_alignbit_b32 v225, v226, v225, 16
    v_mfma_f32_16x16x32_bf16 v[44:47], v[76:79], v[96:99], v[44:47]
    ds_read_b128 v[176:179], v247 offset:16384
    v_mfma_f32_16x16x32_bf16 v[44:47], v[72:75], v[100:103], v[44:47]
    ds_read_b128 v[180:183], v247 offset:20480
    v_mfma_f32_16x16x32_bf16 v[44:47], v[68:71], v[104:107], v[44:47]
    ds_read_b128 v[184:187], v247 offset:24576
    v_mfma_f32_16x16x32_bf16 v[44:47], v[64:67], v[108:111], v[44:47]
    v_alignbit_b32 v226, v227, v226, 16
    s_waitcnt lgkmcnt(7)
    v_mfma_f32_16x16x32_bf16 v[48:51], v[64:67], v[112:115], v[48:51]
    ds_read_b128 v[188:191], v247 offset:28672
    v_mfma_f32_16x16x32_bf16 v[48:51], v[68:71], v[108:111], v[48:51]
    ds_read2_b32 v[128:129], v236 offset0:112 offset1:113
    v_mfma_f32_16x16x32_bf16 v[48:51], v[72:75], v[104:107], v[48:51]
    v_alignbit_b32 v227, v228, v227, 16
    v_mfma_f32_16x16x32_bf16 v[48:51], v[76:79], v[100:103], v[48:51]
    ds_read2_b32 v[130:131], v236 offset0:114 offset1:115
    v_mfma_f32_16x16x32_bf16 v[48:51], v[80:83], v[96:99], v[48:51]
    ds_read2_b32 v[132:133], v236 offset0:240 offset1:241
    v_mfma_f32_16x16x32_bf16 v[52:55], v[84:87], v[96:99], v[52:55]
    ds_read2_b32 v[134:135], v236 offset0:242 offset1:243
    v_mfma_f32_16x16x32_bf16 v[52:55], v[80:83], v[100:103], v[52:55]
    ds_write_b128 v241, v[224:227] offset:6240
    v_mfma_f32_16x16x32_bf16 v[52:55], v[76:79], v[104:107], v[52:55]
    ds_read2_b32 v[136:137], v237 offset0:112 offset1:113
    ds_read2_b32 v[138:139], v237 offset0:114 offset1:115
    v_mfma_f32_16x16x32_bf16 v[52:55], v[72:75], v[108:111], v[52:55]
    s_add_u32 s6, s12, 4734976
    ds_read2_b32 v[140:141], v237 offset0:240 offset1:241
    v_mfma_f32_16x16x32_bf16 v[52:55], v[68:71], v[112:115], v[52:55]
    ds_read2_b32 v[142:143], v237 offset0:242 offset1:243
    v_alignbit_b32 v230, v231, v230, 16
    v_xor_b32 v244, 64, v244
    v_mfma_f32_16x16x32_bf16 v[52:55], v[64:67], v[116:119], v[52:55]
    ds_read2_b32 v[144:145], v238 offset0:112 offset1:113
    v_mfma_f32_16x16x32_bf16 v[56:59], v[64:67], v[120:123], v[56:59]
    ds_read2_b32 v[146:147], v238 offset0:114 offset1:115
    v_xor_b32 v245, 64, v245
    v_mfma_f32_16x16x32_bf16 v[56:59], v[68:71], v[116:119], v[56:59]
    ds_read2_b32 v[148:149], v238 offset0:240 offset1:241
    v_mfma_f32_16x16x32_bf16 v[56:59], v[72:75], v[112:115], v[56:59]
    v_alignbit_b32 v231, v232, v231, 16
    v_xor_b32 v246, 64, v246
    v_mfma_f32_16x16x32_bf16 v[56:59], v[76:79], v[108:111], v[56:59]
    ds_read2_b32 v[150:151], v238 offset0:242 offset1:243
    v_mfma_f32_16x16x32_bf16 v[56:59], v[80:83], v[104:107], v[56:59]
    ds_read2_b32 v[152:153], v239 offset0:112 offset1:113
    v_xor_b32 v247, 64, v247
    v_mfma_f32_16x16x32_bf16 v[56:59], v[84:87], v[100:103], v[56:59]
    ds_read2_b32 v[154:155], v239 offset0:114 offset1:115
    v_mfma_f32_16x16x32_bf16 v[56:59], v[88:91], v[96:99], v[56:59]
    ds_read2_b32 v[156:157], v239 offset0:240 offset1:241
    v_alignbit_b32 v232, v233, v232, 16
    v_mfma_f32_16x16x32_bf16 v[60:63], v[92:95], v[96:99], v[60:63]
    ds_read2_b32 v[158:159], v239 offset0:242 offset1:243
    v_add_u32 v244, 36864, v244
    v_mfma_f32_16x16x32_bf16 v[60:63], v[88:91], v[100:103], v[60:63]
    v_add_u32 v236, -8320, v236
    v_mfma_f32_16x16x32_bf16 v[60:63], v[84:87], v[104:107], v[60:63]
    v_alignbit_b32 v233, v234, v233, 16
    v_add_u32 v245, 36864, v245
    v_mfma_f32_16x16x32_bf16 v[60:63], v[80:83], v[108:111], v[60:63]
    v_add_u32 v237, -8320, v237
    v_mfma_f32_16x16x32_bf16 v[60:63], v[76:79], v[112:115], v[60:63]
    s_waitcnt vmcnt(4)
    s_barrier
    v_add_u32 v246, 36864, v246
    v_mfma_f32_16x16x32_bf16 v[60:63], v[72:75], v[116:119], v[60:63]
    v_add_u32 v238, -8320, v238
    v_add_u32 v239, -8320, v239
    v_mfma_f32_16x16x32_bf16 v[60:63], v[68:71], v[120:123], v[60:63]
    ds_write_b128 v241, v[230:233] offset:7264
    v_mfma_f32_16x16x32_bf16 v[60:63], v[64:67], v[124:127], v[60:63]
    v_add_u32 v247, 36864, v247
    s_waitcnt lgkmcnt(1)
    v_mfma_f32_16x16x32_bf16 v[60:63], v[128:131], v[188:191], v[60:63]
    ds_read_b128 v[96:99], v244 offset:2048
    v_mfma_f32_16x16x32_bf16 v[60:63], v[132:135], v[184:187], v[60:63]
    ds_read2_b32 v[64:65], v236 offset0:0 offset1:1
    v_mfma_f32_16x16x32_bf16 v[60:63], v[136:139], v[180:183], v[60:63]
    ds_read2_b32 v[66:67], v236 offset0:2 offset1:3
    v_mfma_f32_16x16x32_bf16 v[60:63], v[140:143], v[176:179], v[60:63]
    ds_read_b128 v[100:103], v244 offset:6144
    v_mfma_f32_16x16x32_bf16 v[60:63], v[144:147], v[172:175], v[60:63]
    ds_read2_b32 v[68:69], v236 offset0:128 offset1:129
    v_mfma_f32_16x16x32_bf16 v[60:63], v[148:151], v[168:171], v[60:63]
    ds_read2_b32 v[70:71], v236 offset0:130 offset1:131
    v_mfma_f32_16x16x32_bf16 v[60:63], v[152:155], v[164:167], v[60:63]
    ds_read_b128 v[104:107], v244 offset:10240
    v_mfma_f32_16x16x32_bf16 v[60:63], v[156:159], v[160:163], v[60:63]
    s_add_u32 s13, s12, 49152
    ds_read2_b32 v[72:73], v237 offset0:0 offset1:1
    v_mfma_f32_16x16x32_bf16 v[56:59], v[128:131], v[184:187], v[56:59]
    ds_read2_b32 v[74:75], v237 offset0:2 offset1:3
    v_mfma_f32_16x16x32_bf16 v[56:59], v[132:135], v[180:183], v[56:59]
    s_add_u32 m0, s74, 8352
    ds_read_b128 v[108:111], v244 offset:14336
    v_mfma_f32_16x16x32_bf16 v[56:59], v[136:139], v[176:179], v[56:59]
    buffer_load_dwordx4 v240, s[48:51], s13 offen offset:0 lds
    ds_read2_b32 v[76:77], v237 offset0:128 offset1:129
    v_mfma_f32_16x16x32_bf16 v[56:59], v[140:143], v[172:175], v[56:59]
    ds_read2_b32 v[78:79], v237 offset0:130 offset1:131
    v_mfma_f32_16x16x32_bf16 v[56:59], v[144:147], v[168:171], v[56:59]
    ds_read_b128 v[112:115], v244 offset:18432
    v_mfma_f32_16x16x32_bf16 v[56:59], v[148:151], v[164:167], v[56:59]
    ds_read2_b32 v[80:81], v238 offset0:0 offset1:1
    v_cvt_pk_bf16_f32 v206, v60, v61
    v_mfma_f32_16x16x32_bf16 v[56:59], v[152:155], v[160:163], v[56:59]
    ds_read2_b32 v[82:83], v238 offset0:2 offset1:3
    v_mfma_f32_16x16x32_bf16 v[52:55], v[128:131], v[180:183], v[52:55]
    ds_read_b128 v[116:119], v244 offset:22528
    v_mfma_f32_16x16x32_bf16 v[52:55], v[132:135], v[176:179], v[52:55]
    ds_read2_b32 v[84:85], v238 offset0:128 offset1:129
    s_add_u32 m0, s74, 8352
    v_cvt_pk_bf16_f32 v207, v62, v63
    v_mfma_f32_16x16x32_bf16 v[52:55], v[136:139], v[172:175], v[52:55]
    buffer_load_dwordx4 v240, s[48:51], s13 offen offset:1024 lds
    ds_read2_b32 v[86:87], v238 offset0:130 offset1:131
    v_mfma_f32_16x16x32_bf16 v[52:55], v[140:143], v[168:171], v[52:55]
    buffer_store_dwordx2 v[206:207], v8, s[44:47], s6 offen offset:3584 sc1
    ds_read_b128 v[120:123], v244 offset:26624
    v_mfma_f32_16x16x32_bf16 v[52:55], v[144:147], v[164:167], v[52:55]
    ds_read2_b32 v[88:89], v239 offset0:0 offset1:1
    v_mfma_f32_16x16x32_bf16 v[52:55], v[148:151], v[160:163], v[52:55]
    ds_read2_b32 v[90:91], v239 offset0:2 offset1:3
    v_mfma_f32_16x16x32_bf16 v[48:51], v[128:131], v[176:179], v[48:51]
    s_waitcnt vmcnt(3)
    s_barrier
    v_cvt_pk_bf16_f32 v204, v56, v57
    v_mfma_f32_16x16x32_bf16 v[48:51], v[132:135], v[172:175], v[48:51]
    ds_read_b128 v[124:127], v244 offset:30720
    v_mfma_f32_16x16x32_bf16 v[48:51], v[136:139], v[168:171], v[48:51]
    ds_read_b64_tr_b16 a[80:81], v10 offset:16384
    v_mfma_f32_16x16x32_bf16 v[48:51], v[140:143], v[164:167], v[48:51]
    ds_read_b64_tr_b16 a[82:83], v10 offset:18432
    s_add_u32 m0, s74, 8352
    v_cvt_pk_bf16_f32 v205, v58, v59
    v_mfma_f32_16x16x32_bf16 v[48:51], v[144:147], v[160:163], v[48:51]
    ds_read_b64_tr_b16 a[88:89], v10 offset:20480
    buffer_load_dwordx4 v240, s[48:51], s13 offen offset:2048 lds
    v_mfma_f32_16x16x32_bf16 v[44:47], v[128:131], v[172:175], v[44:47]
    buffer_store_dwordx2 v[204:205], v8, s[44:47], s6 offen offset:3072 sc1
    ds_read2_b32 v[92:93], v239 offset0:128 offset1:129
    v_mfma_f32_16x16x32_bf16 v[44:47], v[132:135], v[168:171], v[44:47]
    ds_read_b64_tr_b16 a[90:91], v10 offset:22528
    v_mfma_f32_16x16x32_bf16 v[44:47], v[136:139], v[164:167], v[44:47]
    ds_read_b64_tr_b16 a[84:85], v11 offset:16384
    ds_read2_b32 v[94:95], v239 offset0:130 offset1:131
    v_mfma_f32_16x16x32_bf16 v[44:47], v[140:143], v[160:163], v[44:47]
    v_cvt_pk_bf16_f32 v202, v52, v53
    v_mfma_f32_16x16x32_bf16 v[40:43], v[128:131], v[168:171], v[40:43]
    ds_read_b64_tr_b16 a[86:87], v11 offset:18432
    v_mfma_f32_16x16x32_bf16 v[40:43], v[132:135], v[164:167], v[40:43]
    ds_read_b64_tr_b16 a[92:93], v11 offset:20480
    v_mfma_f32_16x16x32_bf16 v[40:43], v[136:139], v[160:163], v[40:43]
    s_add_u32 m0, s74, 8352
    v_cvt_pk_bf16_f32 v203, v54, v55
    v_mfma_f32_16x16x32_bf16 v[36:39], v[128:131], v[164:167], v[36:39]
    ds_read_b64_tr_b16 a[94:95], v11 offset:22528
    buffer_load_dwordx4 v240, s[48:51], s13 offen offset:3072 lds
    v_mfma_f32_16x16x32_bf16 v[36:39], v[132:135], v[160:163], v[36:39]
    buffer_store_dwordx2 v[202:203], v8, s[44:47], s6 offen offset:2560 sc1
    v_mfma_f32_16x16x32_bf16 v[32:35], v[128:131], v[160:163], v[32:35]
    s_waitcnt lgkmcnt(3)
    v_mfma_f32_16x16x32_bf16 v[60:63], v[64:67], v[124:127], 0
    ds_read_b128 v[160:163], v245 offset:2048
    v_mfma_f32_16x16x32_bf16 v[60:63], v[68:71], v[120:123], v[60:63]
    v_cvt_pk_bf16_f32 v200, v48, v49
    v_mfma_f32_16x16x32_bf16 v[60:63], v[72:75], v[116:119], v[60:63]
    ds_read2_b32 v[128:129], v236 offset0:16 offset1:17
    v_mfma_f32_16x16x32_bf16 v[60:63], v[76:79], v[112:115], v[60:63]
    ds_read2_b32 v[130:131], v236 offset0:18 offset1:19
    v_cvt_pk_bf16_f32 v201, v50, v51
    v_mfma_f32_16x16x32_bf16 v[60:63], v[80:83], v[108:111], v[60:63]
    v_mfma_f32_16x16x32_bf16 v[60:63], v[84:87], v[104:107], v[60:63]
    buffer_store_dwordx2 v[200:201], v8, s[44:47], s6 offen offset:2048 sc1
    ds_read_b128 v[164:167], v245 offset:6144
    v_mfma_f32_16x16x32_bf16 v[60:63], v[88:91], v[100:103], v[60:63]
    ds_read2_b32 v[132:133], v236 offset0:144 offset1:145
    v_mfma_f32_16x16x32_bf16 v[60:63], v[92:95], v[96:99], v[60:63]
    v_cvt_pk_bf16_f32 v198, v44, v45
    v_mfma_f32_16x16x32_bf16 v[56:59], v[64:67], v[120:123], 0
    ds_read2_b32 v[134:135], v236 offset0:146 offset1:147
    v_mfma_f32_16x16x32_bf16 v[56:59], v[68:71], v[116:119], v[56:59]
    ds_read_b128 v[168:171], v245 offset:10240
    v_mfma_f32_16x16x32_bf16 v[56:59], v[72:75], v[112:115], v[56:59]
    ds_read2_b32 v[136:137], v237 offset0:16 offset1:17
    v_cvt_pk_bf16_f32 v199, v46, v47
    v_mfma_f32_16x16x32_bf16 v[56:59], v[76:79], v[108:111], v[56:59]
    v_mfma_f32_16x16x32_bf16 v[56:59], v[80:83], v[104:107], v[56:59]
    buffer_store_dwordx2 v[198:199], v8, s[44:47], s6 offen offset:1536 sc1
    ds_read2_b32 v[138:139], v237 offset0:18 offset1:19
    v_mfma_f32_16x16x32_bf16 v[56:59], v[84:87], v[100:103], v[56:59]
    ds_read_b128 v[172:175], v245 offset:14336
    v_mfma_f32_16x16x32_bf16 v[56:59], v[88:91], v[96:99], v[56:59]
    v_cvt_pk_bf16_f32 v196, v40, v41
    v_mfma_f32_16x16x32_bf16 v[52:55], v[64:67], v[116:119], 0
    ds_read2_b32 v[140:141], v237 offset0:144 offset1:145
    v_mfma_f32_16x16x32_bf16 v[52:55], v[68:71], v[112:115], v[52:55]
    ds_read2_b32 v[142:143], v237 offset0:146 offset1:147
    v_cvt_pk_bf16_f32 v197, v42, v43
    v_mfma_f32_16x16x32_bf16 v[52:55], v[72:75], v[108:111], v[52:55]
    v_mfma_f32_16x16x32_bf16 v[52:55], v[76:79], v[104:107], v[52:55]
    buffer_store_dwordx2 v[196:197], v8, s[44:47], s6 offen offset:1024 sc1
    ds_read_b128 v[176:179], v245 offset:18432
    v_mfma_f32_16x16x32_bf16 v[52:55], v[80:83], v[100:103], v[52:55]
    ds_read2_b32 v[144:145], v238 offset0:16 offset1:17
    v_mfma_f32_16x16x32_bf16 v[52:55], v[84:87], v[96:99], v[52:55]
    v_mfma_f32_16x16x32_bf16 v[48:51], v[64:67], v[112:115], 0
    ds_read2_b32 v[146:147], v238 offset0:18 offset1:19
    v_cvt_pk_bf16_f32 v194, v36, v37
    v_mfma_f32_16x16x32_bf16 v[48:51], v[68:71], v[108:111], v[48:51]
    ds_read_b128 v[180:183], v245 offset:22528
    v_mfma_f32_16x16x32_bf16 v[48:51], v[72:75], v[104:107], v[48:51]
    v_cvt_pk_bf16_f32 v195, v38, v39
    v_mfma_f32_16x16x32_bf16 v[48:51], v[76:79], v[100:103], v[48:51]
    ds_read2_b32 v[148:149], v238 offset0:144 offset1:145
    v_mfma_f32_16x16x32_bf16 v[48:51], v[80:83], v[96:99], v[48:51]
    buffer_store_dwordx2 v[194:195], v8, s[44:47], s6 offen offset:512 sc1
    ds_read2_b32 v[150:151], v238 offset0:146 offset1:147
    v_mfma_f32_16x16x32_bf16 v[44:47], v[64:67], v[108:111], 0
    ds_read_b128 v[184:187], v245 offset:26624
    v_mfma_f32_16x16x32_bf16 v[44:47], v[68:71], v[104:107], v[44:47]
    v_cvt_pk_bf16_f32 v192, v32, v33
    v_mfma_f32_16x16x32_bf16 v[44:47], v[72:75], v[100:103], v[44:47]
    ds_read2_b32 v[152:153], v239 offset0:16 offset1:17
    v_mfma_f32_16x16x32_bf16 v[44:47], v[76:79], v[96:99], v[44:47]
    ds_read2_b32 v[154:155], v239 offset0:18 offset1:19
    v_cvt_pk_bf16_f32 v193, v34, v35
    v_mfma_f32_16x16x32_bf16 v[40:43], v[64:67], v[104:107], 0
    v_mfma_f32_16x16x32_bf16 v[40:43], v[68:71], v[100:103], v[40:43]
    buffer_store_dwordx2 v[192:193], v8, s[44:47], s6 offen offset:0 sc1
    ds_read_b128 v[188:191], v245 offset:30720
    v_mfma_f32_16x16x32_bf16 v[40:43], v[72:75], v[96:99], v[40:43]
    ds_read2_b32 v[156:157], v239 offset0:144 offset1:145
    v_mfma_f32_16x16x32_bf16 v[36:39], v[64:67], v[100:103], 0
    v_mfma_f32_16x16x32_bf16 v[36:39], v[68:71], v[96:99], v[36:39]
    ds_read2_b32 v[158:159], v239 offset0:146 offset1:147
    v_mfma_f32_16x16x32_bf16 v[32:35], v[64:67], v[96:99], 0
    s_waitcnt lgkmcnt(12)
    v_mfma_f32_16x16x32_bf16 v[32:35], v[128:131], v[160:163], v[32:35]
    ds_read_b128 v[96:99], v246 offset:2048
    v_mfma_f32_16x16x32_bf16 v[36:39], v[132:135], v[160:163], v[36:39]
    v_mfma_f32_16x16x32_bf16 v[36:39], v[128:131], v[164:167], v[36:39]
    ds_read2_b32 v[64:65], v236 offset0:32 offset1:33
    v_mfma_f32_16x16x32_bf16 v[40:43], v[128:131], v[168:171], v[40:43]
    ds_read2_b32 v[66:67], v236 offset0:34 offset1:35
    s_barrier
    v_mfma_f32_16x16x32_bf16 v[40:43], v[132:135], v[164:167], v[40:43]
    v_mfma_f32_16x16x32_bf16 v[40:43], v[136:139], v[160:163], v[40:43]
    ds_read_b128 v[100:103], v246 offset:6144
    v_mfma_f32_16x16x32_bf16 v[44:47], v[140:143], v[160:163], v[44:47]
    ds_read2_b32 v[68:69], v236 offset0:160 offset1:161
    v_mfma_f32_16x16x32_bf16 v[44:47], v[136:139], v[164:167], v[44:47]
    v_mfma_f32_16x16x32_bf16 v[44:47], v[132:135], v[168:171], v[44:47]
    ds_read2_b32 v[70:71], v236 offset0:162 offset1:163
    v_mfma_f32_16x16x32_bf16 v[44:47], v[128:131], v[172:175], v[44:47]
    ds_read_b128 v[104:107], v246 offset:10240
    s_waitcnt lgkmcnt(7)
    v_mfma_f32_16x16x32_bf16 v[48:51], v[128:131], v[176:179], v[48:51]
    ds_read2_b32 v[72:73], v237 offset0:32 offset1:33
    v_mfma_f32_16x16x32_bf16 v[48:51], v[132:135], v[172:175], v[48:51]
    ds_read2_b32 v[74:75], v237 offset0:34 offset1:35
    v_mfma_f32_16x16x32_bf16 v[48:51], v[136:139], v[168:171], v[48:51]
    v_mov_b32 v9, 24
    buffer_load_ushort v9, v9, s[56:59], s70 offen
    v_mfma_f32_16x16x32_bf16 v[48:51], v[140:143], v[164:167], v[48:51]
    ds_read_b128 v[108:111], v246 offset:14336
    v_mfma_f32_16x16x32_bf16 v[48:51], v[144:147], v[160:163], v[48:51]
    s_lshl_b32 s14, s90, 18
    v_mfma_f32_16x16x32_bf16 v[52:55], v[148:151], v[160:163], v[52:55]
    s_add_u32 m0, s73, 147456
    ds_read2_b32 v[76:77], v237 offset0:160 offset1:161
    v_mfma_f32_16x16x32_bf16 v[52:55], v[144:147], v[164:167], v[52:55]
    buffer_load_dwordx4 v4, s[52:55], s14 offen offset:0 lds
    ds_read2_b32 v[78:79], v237 offset0:162 offset1:163
    v_mfma_f32_16x16x32_bf16 v[52:55], v[140:143], v[168:171], v[52:55]
    v_mfma_f32_16x16x32_bf16 v[52:55], v[136:139], v[172:175], v[52:55]
    ds_read_b128 v[112:115], v246 offset:18432
    v_mfma_f32_16x16x32_bf16 v[52:55], v[132:135], v[176:179], v[52:55]
    ds_read2_b32 v[80:81], v238 offset0:32 offset1:33
    v_mfma_f32_16x16x32_bf16 v[52:55], v[128:131], v[180:183], v[52:55]
    v_mfma_f32_16x16x32_bf16 v[56:59], v[128:131], v[184:187], v[56:59]
    ds_read2_b32 v[82:83], v238 offset0:34 offset1:35
    v_mfma_f32_16x16x32_bf16 v[56:59], v[132:135], v[180:183], v[56:59]
    s_add_u32 m0, s73, 147456
    ds_read_b128 v[116:119], v246 offset:22528
    v_mfma_f32_16x16x32_bf16 v[56:59], v[136:139], v[176:179], v[56:59]
    buffer_load_dwordx4 v5, s[52:55], s14 offen offset:1024 lds
    v_mfma_f32_16x16x32_bf16 v[56:59], v[140:143], v[172:175], v[56:59]
    ds_read2_b32 v[84:85], v238 offset0:160 offset1:161
    v_mfma_f32_16x16x32_bf16 v[56:59], v[144:147], v[168:171], v[56:59]
    ds_read2_b32 v[86:87], v238 offset0:162 offset1:163
    v_mfma_f32_16x16x32_bf16 v[56:59], v[148:151], v[164:167], v[56:59]
    ds_read_b128 v[120:123], v246 offset:26624
    v_mfma_f32_16x16x32_bf16 v[56:59], v[152:155], v[160:163], v[56:59]
    v_mfma_f32_16x16x32_bf16 v[60:63], v[156:159], v[160:163], v[60:63]
    ds_read2_b32 v[88:89], v239 offset0:32 offset1:33
    v_mfma_f32_16x16x32_bf16 v[60:63], v[152:155], v[164:167], v[60:63]
    s_add_u32 m0, s73, 147456
    ds_read2_b32 v[90:91], v239 offset0:34 offset1:35
    v_mfma_f32_16x16x32_bf16 v[60:63], v[148:151], v[168:171], v[60:63]
    buffer_load_dwordx4 v6, s[52:55], s14 offen offset:2048 lds
    v_mfma_f32_16x16x32_bf16 v[60:63], v[144:147], v[172:175], v[60:63]
    ds_read_b128 v[124:127], v246 offset:30720
    v_mfma_f32_16x16x32_bf16 v[60:63], v[140:143], v[176:179], v[60:63]
    ds_read2_b32 v[92:93], v239 offset0:160 offset1:161
    v_mfma_f32_16x16x32_bf16 v[60:63], v[136:139], v[180:183], v[60:63]
    v_mfma_f32_16x16x32_bf16 v[60:63], v[132:135], v[184:187], v[60:63]
    ds_read2_b32 v[94:95], v239 offset0:162 offset1:163
    v_mfma_f32_16x16x32_bf16 v[60:63], v[128:131], v[188:191], v[60:63]
    s_waitcnt lgkmcnt(12)
    v_mfma_f32_16x16x32_bf16 v[32:35], v[64:67], v[96:99], v[32:35]
    ds_read_b128 v[160:163], v247 offset:2048
    v_mfma_f32_16x16x32_bf16 v[36:39], v[68:71], v[96:99], v[36:39]
    s_add_u32 m0, s73, 147456
    v_mfma_f32_16x16x32_bf16 v[36:39], v[64:67], v[100:103], v[36:39]
    buffer_load_dwordx4 v7, s[52:55], s14 offen offset:3072 lds
    ds_read2_b32 v[128:129], v236 offset0:48 offset1:49
    v_mfma_f32_16x16x32_bf16 v[40:43], v[64:67], v[104:107], v[40:43]
    ds_read2_b32 v[130:131], v236 offset0:50 offset1:51
    v_mfma_f32_16x16x32_bf16 v[40:43], v[68:71], v[100:103], v[40:43]
    v_mfma_f32_16x16x32_bf16 v[40:43], v[72:75], v[96:99], v[40:43]
    ds_read_b128 v[164:167], v247 offset:6144
    v_mfma_f32_16x16x32_bf16 v[44:47], v[76:79], v[96:99], v[44:47]
    ds_read2_b32 v[132:133], v236 offset0:176 offset1:177
    v_mfma_f32_16x16x32_bf16 v[44:47], v[72:75], v[100:103], v[44:47]
    v_mfma_f32_16x16x32_bf16 v[44:47], v[68:71], v[104:107], v[44:47]
    ds_read2_b32 v[134:135], v236 offset0:178 offset1:179
    v_mfma_f32_16x16x32_bf16 v[44:47], v[64:67], v[108:111], v[44:47]
    ds_read_b128 v[168:171], v247 offset:10240
    s_waitcnt lgkmcnt(7)
    v_mfma_f32_16x16x32_bf16 v[48:51], v[64:67], v[112:115], v[48:51]
    ds_read2_b32 v[136:137], v237 offset0:48 offset1:49
    v_mfma_f32_16x16x32_bf16 v[48:51], v[68:71], v[108:111], v[48:51]
    v_mfma_f32_16x16x32_bf16 v[48:51], v[72:75], v[104:107], v[48:51]
    ds_read2_b32 v[138:139], v237 offset0:50 offset1:51
    v_mfma_f32_16x16x32_bf16 v[48:51], v[76:79], v[100:103], v[48:51]
    ds_read_b128 v[172:175], v247 offset:14336
    v_mfma_f32_16x16x32_bf16 v[48:51], v[80:83], v[96:99], v[48:51]
    v_mfma_f32_16x16x32_bf16 v[52:55], v[84:87], v[96:99], v[52:55]
    ds_read2_b32 v[140:141], v237 offset0:176 offset1:177
    v_mfma_f32_16x16x32_bf16 v[52:55], v[80:83], v[100:103], v[52:55]
    ds_read2_b32 v[142:143], v237 offset0:178 offset1:179
    v_mfma_f32_16x16x32_bf16 v[52:55], v[76:79], v[104:107], v[52:55]
    v_mfma_f32_16x16x32_bf16 v[52:55], v[72:75], v[108:111], v[52:55]
    ds_read_b128 v[176:179], v247 offset:18432
    v_mfma_f32_16x16x32_bf16 v[52:55], v[68:71], v[112:115], v[52:55]
L_pl_X_4:
    s_cbranch_execz L_wret
    ds_read2_b32 v[144:145], v238 offset0:48 offset1:49
    v_mfma_f32_16x16x32_bf16 v[52:55], v[64:67], v[116:119], v[52:55]
    v_mfma_f32_16x16x32_bf16 v[56:59], v[64:67], v[120:123], v[56:59]
    s_lshl_b32 s14, s91, 18
    ds_read2_b32 v[146:147], v238 offset0:50 offset1:51
    v_mfma_f32_16x16x32_bf16 v[56:59], v[68:71], v[116:119], v[56:59]
    s_add_u32 m0, s73, 0
    ds_read_b128 v[180:183], v247 offset:22528
    v_mfma_f32_16x16x32_bf16 v[56:59], v[72:75], v[112:115], v[56:59]
    buffer_load_dwordx4 v4, s[52:55], s14 offen offset:0 lds
    v_mfma_f32_16x16x32_bf16 v[56:59], v[76:79], v[108:111], v[56:59]
    ds_read2_b32 v[148:149], v238 offset0:176 offset1:177
    v_mfma_f32_16x16x32_bf16 v[56:59], v[80:83], v[104:107], v[56:59]
    ds_read2_b32 v[150:151], v238 offset0:178 offset1:179
    v_mfma_f32_16x16x32_bf16 v[56:59], v[84:87], v[100:103], v[56:59]
    ds_read_b128 v[184:187], v247 offset:26624
    v_mfma_f32_16x16x32_bf16 v[56:59], v[88:91], v[96:99], v[56:59]
    v_mfma_f32_16x16x32_bf16 v[60:63], v[92:95], v[96:99], v[60:63]
    ds_read2_b32 v[152:153], v239 offset0:48 offset1:49
    v_mfma_f32_16x16x32_bf16 v[60:63], v[88:91], v[100:103], v[60:63]
    s_add_u32 m0, s73, 0
    ds_read2_b32 v[154:155], v239 offset0:50 offset1:51
    v_mfma_f32_16x16x32_bf16 v[60:63], v[84:87], v[104:107], v[60:63]
    buffer_load_dwordx4 v5, s[52:55], s14 offen offset:1024 lds
    v_mfma_f32_16x16x32_bf16 v[60:63], v[80:83], v[108:111], v[60:63]
    ds_read_b128 v[188:191], v247 offset:30720
    v_mfma_f32_16x16x32_bf16 v[60:63], v[76:79], v[112:115], v[60:63]
    ds_read2_b32 v[156:157], v239 offset0:176 offset1:177
    v_mfma_f32_16x16x32_bf16 v[60:63], v[72:75], v[116:119], v[60:63]
    v_mfma_f32_16x16x32_bf16 v[60:63], v[68:71], v[120:123], v[60:63]
    ds_read2_b32 v[158:159], v239 offset0:178 offset1:179
    v_mfma_f32_16x16x32_bf16 v[60:63], v[64:67], v[124:127], v[60:63]
    s_waitcnt lgkmcnt(12)
    v_mfma_f32_16x16x32_bf16 v[32:35], v[128:131], v[160:163], v[32:35]
    ds_read_b128 v[96:99], v244 offset:0
    v_mfma_f32_16x16x32_bf16 v[36:39], v[132:135], v[160:163], v[36:39]
    s_add_u32 m0, s73, 0
    v_mfma_f32_16x16x32_bf16 v[36:39], v[128:131], v[164:167], v[36:39]
    buffer_load_dwordx4 v6, s[52:55], s14 offen offset:2048 lds
    ds_read2_b32 v[64:65], v236 offset0:64 offset1:65
    v_mfma_f32_16x16x32_bf16 v[40:43], v[128:131], v[168:171], v[40:43]
    ds_read2_b32 v[66:67], v236 offset0:66 offset1:67
    v_mfma_f32_16x16x32_bf16 v[40:43], v[132:135], v[164:167], v[40:43]
    v_mfma_f32_16x16x32_bf16 v[40:43], v[136:139], v[160:163], v[40:43]
    ds_read_b128 v[100:103], v244 offset:4096
    v_mfma_f32_16x16x32_bf16 v[44:47], v[140:143], v[160:163], v[44:47]
    ds_read2_b32 v[68:69], v236 offset0:192 offset1:193
    v_mfma_f32_16x16x32_bf16 v[44:47], v[136:139], v[164:167], v[44:47]
    v_mfma_f32_16x16x32_bf16 v[44:47], v[132:135], v[168:171], v[44:47]
    s_add_u32 m0, s73, 0
    ds_read2_b32 v[70:71], v236 offset0:194 offset1:195
    v_mfma_f32_16x16x32_bf16 v[44:47], v[128:131], v[172:175], v[44:47]
    buffer_load_dwordx4 v7, s[52:55], s14 offen offset:3072 lds
    ds_read_b128 v[104:107], v244 offset:8192
    s_waitcnt lgkmcnt(7)
    v_mfma_f32_16x16x32_bf16 v[48:51], v[128:131], v[176:179], v[48:51]
    ds_read2_b32 v[72:73], v237 offset0:64 offset1:65
    v_mfma_f32_16x16x32_bf16 v[48:51], v[132:135], v[172:175], v[48:51]
    v_mfma_f32_16x16x32_bf16 v[48:51], v[136:139], v[168:171], v[48:51]
    ds_read2_b32 v[74:75], v237 offset0:66 offset1:67
    v_mfma_f32_16x16x32_bf16 v[48:51], v[140:143], v[164:167], v[48:51]
    ds_read_b128 v[108:111], v244 offset:12288
    v_mfma_f32_16x16x32_bf16 v[48:51], v[144:147], v[160:163], v[48:51]
    v_mfma_f32_16x16x32_bf16 v[52:55], v[148:151], v[160:163], v[52:55]
    ds_read2_b32 v[76:77], v237 offset0:192 offset1:193
    v_mfma_f32_16x16x32_bf16 v[52:55], v[144:147], v[164:167], v[52:55]
    ds_read2_b32 v[78:79], v237 offset0:194 offset1:195
    v_mfma_f32_16x16x32_bf16 v[52:55], v[140:143], v[168:171], v[52:55]
    v_mfma_f32_16x16x32_bf16 v[52:55], v[136:139], v[172:175], v[52:55]
    ds_read_b128 v[112:115], v244 offset:16384
    v_mfma_f32_16x16x32_bf16 v[52:55], v[132:135], v[176:179], v[52:55]
    ds_read2_b32 v[80:81], v238 offset0:64 offset1:65
    v_mfma_f32_16x16x32_bf16 v[52:55], v[128:131], v[180:183], v[52:55]
    v_mfma_f32_16x16x32_bf16 v[56:59], v[128:131], v[184:187], v[56:59]
    ds_read2_b32 v[82:83], v238 offset0:66 offset1:67
    v_mfma_f32_16x16x32_bf16 v[56:59], v[132:135], v[180:183], v[56:59]
    ds_read_b128 v[116:119], v244 offset:20480
    v_mfma_f32_16x16x32_bf16 v[56:59], v[136:139], v[176:179], v[56:59]
    v_mfma_f32_16x16x32_bf16 v[56:59], v[140:143], v[172:175], v[56:59]
    ds_read2_b32 v[84:85], v238 offset0:192 offset1:193
    v_mfma_f32_16x16x32_bf16 v[56:59], v[144:147], v[168:171], v[56:59]
    ds_read2_b32 v[86:87], v238 offset0:194 offset1:195
    v_mfma_f32_16x16x32_bf16 v[56:59], v[148:151], v[164:167], v[56:59]
    ds_read_b128 v[120:123], v244 offset:24576
    v_mfma_f32_16x16x32_bf16 v[56:59], v[152:155], v[160:163], v[56:59]
    v_mfma_f32_16x16x32_bf16 v[60:63], v[156:159], v[160:163], v[60:63]
    s_lshl_b32 s14, s92, 18
    ds_read2_b32 v[88:89], v239 offset0:64 offset1:65
    v_mfma_f32_16x16x32_bf16 v[60:63], v[152:155], v[164:167], v[60:63]
    s_add_u32 m0, s73, 16384
    ds_read2_b32 v[90:91], v239 offset0:66 offset1:67
    v_mfma_f32_16x16x32_bf16 v[60:63], v[148:151], v[168:171], v[60:63]
    buffer_load_dwordx4 v4, s[52:55], s14 offen offset:0 lds
    v_mfma_f32_16x16x32_bf16 v[60:63], v[144:147], v[172:175], v[60:63]
    ds_read_b128 v[124:127], v244 offset:28672
    v_mfma_f32_16x16x32_bf16 v[60:63], v[140:143], v[176:179], v[60:63]
    ds_read2_b32 v[92:93], v239 offset0:192 offset1:193
    v_mfma_f32_16x16x32_bf16 v[60:63], v[136:139], v[180:183], v[60:63]
    v_mfma_f32_16x16x32_bf16 v[60:63], v[132:135], v[184:187], v[60:63]
    ds_read2_b32 v[94:95], v239 offset0:194 offset1:195
    v_mfma_f32_16x16x32_bf16 v[60:63], v[128:131], v[188:191], v[60:63]
    s_waitcnt lgkmcnt(12)
    v_mfma_f32_16x16x32_bf16 v[32:35], v[64:67], v[96:99], v[32:35]
    ds_read_b128 v[160:163], v245 offset:0
    v_mfma_f32_16x16x32_bf16 v[36:39], v[68:71], v[96:99], v[36:39]
    s_add_u32 m0, s73, 16384
    ds_read2_b32 v[128:129], v236 offset0:80 offset1:81
    v_mfma_f32_16x16x32_bf16 v[36:39], v[64:67], v[100:103], v[36:39]
    buffer_load_dwordx4 v5, s[52:55], s14 offen offset:1024 lds
    ds_read2_b32 v[130:131], v236 offset0:82 offset1:83
    v_mfma_f32_16x16x32_bf16 v[40:43], v[64:67], v[104:107], v[40:43]
    ds_read_b128 v[164:167], v245 offset:4096
    v_mfma_f32_16x16x32_bf16 v[40:43], v[68:71], v[100:103], v[40:43]
    ds_read2_b32 v[132:133], v236 offset0:208 offset1:209
    v_mfma_f32_16x16x32_bf16 v[40:43], v[72:75], v[96:99], v[40:43]
    ds_read2_b32 v[134:135], v236 offset0:210 offset1:211
    v_mfma_f32_16x16x32_bf16 v[44:47], v[76:79], v[96:99], v[44:47]
    ds_read_b128 v[168:171], v245 offset:8192
    v_mfma_f32_16x16x32_bf16 v[44:47], v[72:75], v[100:103], v[44:47]
    ds_read2_b32 v[136:137], v237 offset0:80 offset1:81
    v_mfma_f32_16x16x32_bf16 v[44:47], v[68:71], v[104:107], v[44:47]
    s_add_u32 m0, s73, 16384
    ds_read2_b32 v[138:139], v237 offset0:82 offset1:83
    v_mfma_f32_16x16x32_bf16 v[44:47], v[64:67], v[108:111], v[44:47]
    buffer_load_dwordx4 v6, s[52:55], s14 offen offset:2048 lds
    ds_read_b128 v[172:175], v245 offset:12288
    s_waitcnt lgkmcnt(10)
    v_mfma_f32_16x16x32_bf16 v[48:51], v[64:67], v[112:115], v[48:51]
    ds_read2_b32 v[140:141], v237 offset0:208 offset1:209
    v_mfma_f32_16x16x32_bf16 v[48:51], v[68:71], v[108:111], v[48:51]
    ds_read2_b32 v[142:143], v237 offset0:210 offset1:211
    v_mfma_f32_16x16x32_bf16 v[48:51], v[72:75], v[104:107], v[48:51]
    ds_read_b128 v[176:179], v245 offset:16384
    v_mfma_f32_16x16x32_bf16 v[48:51], v[76:79], v[100:103], v[48:51]
    ds_read2_b32 v[144:145], v238 offset0:80 offset1:81
    v_mfma_f32_16x16x32_bf16 v[48:51], v[80:83], v[96:99], v[48:51]
    ds_read2_b32 v[146:147], v238 offset0:82 offset1:83
    s_waitcnt vmcnt(7)
    s_barrier
    v_mfma_f32_16x16x32_bf16 v[52:55], v[84:87], v[96:99], v[52:55]
    ds_read_b64_tr_b16 a[96:97], v10 offset:16384
    s_add_u32 m0, s73, 16384
    v_mfma_f32_16x16x32_bf16 v[52:55], v[80:83], v[100:103], v[52:55]
    buffer_load_dwordx4 v7, s[52:55], s14 offen offset:3072 lds
    ds_read_b128 v[180:183], v245 offset:20480
    v_mfma_f32_16x16x32_bf16 v[52:55], v[76:79], v[104:107], v[52:55]
    ds_read_b64_tr_b16 a[98:99], v10 offset:18432
    v_mfma_f32_16x16x32_bf16 v[52:55], v[72:75], v[108:111], v[52:55]
    ds_read_b64_tr_b16 a[104:105], v10 offset:20480
    v_mfma_f32_16x16x32_bf16 v[52:55], v[68:71], v[112:115], v[52:55]
    ds_read_b128 v[212:215], v241 offset:8352
    v_mfma_f32_16x16x32_bf16 v[52:55], v[64:67], v[116:119], v[52:55]
    ds_read_b64_tr_b16 a[106:107], v10 offset:22528
    v_mfma_f32_16x16x32_bf16 v[56:59], v[64:67], v[120:123], v[56:59]
    ds_read_b64_tr_b16 a[100:101], v11 offset:16384
    v_mfma_f32_16x16x32_bf16 v[56:59], v[68:71], v[116:119], v[56:59]
    ds_read_b32 v216, v241 offset:8368
    v_mfma_f32_16x16x32_bf16 v[56:59], v[72:75], v[112:115], v[56:59]
    ds_read_b64_tr_b16 a[102:103], v11 offset:18432
    v_mfma_f32_16x16x32_bf16 v[56:59], v[76:79], v[108:111], v[56:59]
    ds_read_b64_tr_b16 a[108:109], v11 offset:20480
    ds_read2_b32 v[148:149], v238 offset0:208 offset1:209
    v_mfma_f32_16x16x32_bf16 v[56:59], v[80:83], v[104:107], v[56:59]
    ds_read_b64_tr_b16 a[110:111], v11 offset:22528
    ds_read2_b32 v[150:151], v238 offset0:210 offset1:211
    v_mfma_f32_16x16x32_bf16 v[56:59], v[84:87], v[100:103], v[56:59]
    ds_read_b128 v[218:221], v241 offset:9376
    ds_read_b128 v[184:187], v245 offset:24576
    v_mfma_f32_16x16x32_bf16 v[56:59], v[88:91], v[96:99], v[56:59]
    ds_read_b32 v222, v241 offset:9392
    v_mfma_f32_16x16x32_bf16 v[60:63], v[92:95], v[96:99], v[60:63]
    ds_read_b128 v[224:227], v241 offset:10400
    ds_read2_b32 v[152:153], v239 offset0:80 offset1:81
    v_mfma_f32_16x16x32_bf16 v[60:63], v[88:91], v[100:103], v[60:63]
    ds_read2_b32 v[154:155], v239 offset0:82 offset1:83
    v_mfma_f32_16x16x32_bf16 v[60:63], v[84:87], v[104:107], v[60:63]
    ds_read_b32 v228, v241 offset:10416
    v_mfma_f32_16x16x32_bf16 v[60:63], v[80:83], v[108:111], v[60:63]
    ds_read_b128 v[188:191], v245 offset:28672
    v_mfma_f32_16x16x32_bf16 v[60:63], v[76:79], v[112:115], v[60:63]
    ds_read_b128 v[230:233], v241 offset:11424
    s_waitcnt lgkmcnt(10)
    s_barrier
    v_mfma_f32_16x16x32_bf16 v[60:63], v[72:75], v[116:119], v[60:63]
    ds_read2_b32 v[156:157], v239 offset0:208 offset1:209
    v_mfma_f32_16x16x32_bf16 v[60:63], v[68:71], v[120:123], v[60:63]
    ds_read_b32 v234, v241 offset:11440
    ds_read2_b32 v[158:159], v239 offset0:210 offset1:211
    v_mfma_f32_16x16x32_bf16 v[60:63], v[64:67], v[124:127], v[60:63]
    v_mfma_f32_16x16x32_bf16 v[32:35], v[128:131], v[160:163], v[32:35]
    s_lshl_b32 s14, s93, 18
    ds_read_b128 v[96:99], v246 offset:0
    v_mfma_f32_16x16x32_bf16 v[36:39], v[132:135], v[160:163], v[36:39]
    s_add_u32 m0, s73, 147456
    ds_read2_b32 v[64:65], v236 offset0:96 offset1:97
    v_mfma_f32_16x16x32_bf16 v[36:39], v[128:131], v[164:167], v[36:39]
    buffer_load_dwordx4 v4, s[52:55], s14 offen offset:0 lds
    ds_read2_b32 v[66:67], v236 offset0:98 offset1:99
    v_mfma_f32_16x16x32_bf16 v[40:43], v[128:131], v[168:171], v[40:43]
    ds_read_b128 v[100:103], v246 offset:4096
    v_mfma_f32_16x16x32_bf16 v[40:43], v[132:135], v[164:167], v[40:43]
    s_waitcnt lgkmcnt(5)
    ds_read2_b32 v[68:69], v236 offset0:224 offset1:225
    v_mfma_f32_16x16x32_bf16 v[40:43], v[136:139], v[160:163], v[40:43]
    ds_read2_b32 v[70:71], v236 offset0:226 offset1:227
    v_mfma_f32_16x16x32_bf16 v[44:47], v[140:143], v[160:163], v[44:47]
    ds_read_b128 v[104:107], v246 offset:8192
    v_mfma_f32_16x16x32_bf16 v[44:47], v[136:139], v[164:167], v[44:47]
    ds_read2_b32 v[72:73], v237 offset0:96 offset1:97
    v_mfma_f32_16x16x32_bf16 v[44:47], v[132:135], v[168:171], v[44:47]
    ds_read2_b32 v[74:75], v237 offset0:98 offset1:99
    s_add_u32 m0, s73, 147456
    v_lshlrev_b32 v9, 16, v9
    v_mfma_f32_16x16x32_bf16 v[44:47], v[128:131], v[172:175], v[44:47]
    buffer_load_dwordx4 v5, s[52:55], s14 offen offset:1024 lds
    ds_read_b128 v[108:111], v246 offset:12288
    s_waitcnt lgkmcnt(10)
    v_mfma_f32_16x16x32_bf16 v[48:51], v[128:131], v[176:179], v[48:51]
    ds_read2_b32 v[76:77], v237 offset0:224 offset1:225
    v_lshlrev_b32 v208, 16, v212
    v_mfma_f32_16x16x32_bf16 v[48:51], v[132:135], v[172:175], v[48:51]
    ds_read2_b32 v[78:79], v237 offset0:226 offset1:227
    v_mfma_f32_16x16x32_bf16 v[48:51], v[136:139], v[168:171], v[48:51]
    ds_read_b128 v[112:115], v246 offset:16384
    v_add_f32 v9, v9, v208
    v_mfma_f32_16x16x32_bf16 v[48:51], v[140:143], v[164:167], v[48:51]
    ds_read2_b32 v[80:81], v238 offset0:96 offset1:97
    v_cvt_pk_bf16_f32 v9, v9, v9
    v_mfma_f32_16x16x32_bf16 v[48:51], v[144:147], v[160:163], v[48:51]
    ds_write_b16 v242, v9 offset:12480
    v_mfma_f32_16x16x32_bf16 v[52:55], v[148:151], v[160:163], v[52:55]
    s_add_u32 m0, s73, 147456
    ds_read2_b32 v[82:83], v238 offset0:98 offset1:99
    v_mfma_f32_16x16x32_bf16 v[52:55], v[144:147], v[164:167], v[52:55]
    buffer_load_dwordx4 v6, s[52:55], s14 offen offset:2048 lds
    ds_read_b128 v[116:119], v246 offset:20480
    v_mfma_f32_16x16x32_bf16 v[52:55], v[140:143], v[168:171], v[52:55]
    ds_write_b16 v242, v9 offset:8322
    v_mfma_f32_16x16x32_bf16 v[52:55], v[136:139], v[172:175], v[52:55]
    ds_read2_b32 v[84:85], v238 offset0:224 offset1:225
    v_mfma_f32_16x16x32_bf16 v[52:55], v[132:135], v[176:179], v[52:55]
    ds_read2_b32 v[86:87], v238 offset0:226 offset1:227
    v_alignbit_b32 v212, v213, v212, 16
    v_mfma_f32_16x16x32_bf16 v[52:55], v[128:131], v[180:183], v[52:55]
    v_alignbit_b32 v213, v214, v213, 16
    v_alignbit_b32 v214, v215, v214, 16
    v_mfma_f32_16x16x32_bf16 v[56:59], v[128:131], v[184:187], v[56:59]
    s_waitcnt vmcnt(7)
    s_barrier
    v_alignbit_b32 v215, v216, v215, 16
    v_mfma_f32_16x16x32_bf16 v[56:59], v[132:135], v[180:183], v[56:59]
    v_add_u32 v10, -131072, v10
    s_add_u32 m0, s73, 147456
    v_mfma_f32_16x16x32_bf16 v[56:59], v[136:139], v[176:179], v[56:59]
    ds_read_b64_tr_b16 a[112:113], v10 offset:0
    buffer_load_dwordx4 v7, s[52:55], s14 offen offset:3072 lds
    v_mfma_f32_16x16x32_bf16 v[56:59], v[140:143], v[172:175], v[56:59]
    ds_write_b128 v241, v[212:215] offset:12512
    v_mfma_f32_16x16x32_bf16 v[56:59], v[144:147], v[168:171], v[56:59]
    ds_read_b64_tr_b16 a[114:115], v10 offset:2048
    ds_read_b128 v[120:123], v246 offset:24576
    v_mfma_f32_16x16x32_bf16 v[56:59], v[148:151], v[164:167], v[56:59]
    ds_read_b64_tr_b16 a[120:121], v10 offset:4096
    ds_read2_b32 v[88:89], v239 offset0:96 offset1:97
    v_mfma_f32_16x16x32_bf16 v[56:59], v[152:155], v[160:163], v[56:59]
    ds_read_b64_tr_b16 a[122:123], v10 offset:6144
    v_alignbit_b32 v218, v219, v218, 16
    v_mfma_f32_16x16x32_bf16 v[60:63], v[156:159], v[160:163], v[60:63]
    ds_read2_b32 v[90:91], v239 offset0:98 offset1:99
    v_add_u32 v11, -131072, v11
    v_mfma_f32_16x16x32_bf16 v[60:63], v[152:155], v[164:167], v[60:63]
    ds_read_b64_tr_b16 a[116:117], v11 offset:0
    v_alignbit_b32 v219, v220, v219, 16
    v_mfma_f32_16x16x32_bf16 v[60:63], v[148:151], v[168:171], v[60:63]
    ds_read_b128 v[124:127], v246 offset:28672
    ds_read2_b32 v[92:93], v239 offset0:224 offset1:225
    v_mfma_f32_16x16x32_bf16 v[60:63], v[144:147], v[172:175], v[60:63]
    ds_read_b64_tr_b16 a[118:119], v11 offset:2048
    v_alignbit_b32 v220, v221, v220, 16
    v_mfma_f32_16x16x32_bf16 v[60:63], v[140:143], v[176:179], v[60:63]
    ds_read_b64_tr_b16 a[124:125], v11 offset:4096
    ds_read2_b32 v[94:95], v239 offset0:226 offset1:227
    v_mfma_f32_16x16x32_bf16 v[60:63], v[136:139], v[180:183], v[60:63]
    ds_read_b64_tr_b16 a[126:127], v11 offset:6144
    v_alignbit_b32 v221, v222, v221, 16
    v_mfma_f32_16x16x32_bf16 v[60:63], v[132:135], v[184:187], v[60:63]
    ds_write_b128 v241, v[218:221] offset:13536
    v_mfma_f32_16x16x32_bf16 v[60:63], v[128:131], v[188:191], v[60:63]
    s_waitcnt lgkmcnt(15)
    v_mfma_f32_16x16x32_bf16 v[32:35], v[64:67], v[96:99], v[32:35]
    ds_read_b128 v[160:163], v247 offset:0
    v_mfma_f32_16x16x32_bf16 v[36:39], v[68:71], v[96:99], v[36:39]
    v_alignbit_b32 v224, v225, v224, 16
    v_mfma_f32_16x16x32_bf16 v[36:39], v[64:67], v[100:103], v[36:39]
    ds_read_b128 v[164:167], v247 offset:4096
    v_mfma_f32_16x16x32_bf16 v[40:43], v[64:67], v[104:107], v[40:43]
    ds_read_b128 v[168:171], v247 offset:8192
    s_waitcnt lgkmcnt(4)
    s_barrier
    v_mfma_f32_16x16x32_bf16 v[40:43], v[68:71], v[100:103], v[40:43]
    ds_read_b128 v[172:175], v247 offset:12288
    v_mfma_f32_16x16x32_bf16 v[40:43], v[72:75], v[96:99], v[40:43]
    v_alignbit_b32 v225, v226, v225, 16
    v_mfma_f32_16x16x32_bf16 v[44:47], v[76:79], v[96:99], v[44:47]
    ds_read_b128 v[176:179], v247 offset:16384
    v_mfma_f32_16x16x32_bf16 v[44:47], v[72:75], v[100:103], v[44:47]
    s_lshl_b32 s14, s94, 18
    ds_read_b128 v[180:183], v247 offset:20480
    v_mfma_f32_16x16x32_bf16 v[44:47], v[68:71], v[104:107], v[44:47]
    s_add_u32 m0, s73, 0
    v_alignbit_b32 v226, v227, v226, 16
    v_mfma_f32_16x16x32_bf16 v[44:47], v[64:67], v[108:111], v[44:47]
    buffer_load_dwordx4 v4, s[52:55], s14 offen offset:0 lds
    ds_read_b128 v[184:187], v247 offset:24576
    v_mfma_f32_16x16x32_bf16 v[48:51], v[64:67], v[112:115], v[48:51]
    ds_read_b128 v[188:191], v247 offset:28672
    v_mfma_f32_16x16x32_bf16 v[48:51], v[68:71], v[108:111], v[48:51]
    ds_read2_b32 v[128:129], v236 offset0:112 offset1:113
    v_mfma_f32_16x16x32_bf16 v[48:51], v[72:75], v[104:107], v[48:51]
    v_alignbit_b32 v227, v228, v227, 16
    v_mfma_f32_16x16x32_bf16 v[48:51], v[76:79], v[100:103], v[48:51]
    ds_read2_b32 v[130:131], v236 offset0:114 offset1:115
    v_mfma_f32_16x16x32_bf16 v[48:51], v[80:83], v[96:99], v[48:51]
    ds_read2_b32 v[132:133], v236 offset0:240 offset1:241
    v_mfma_f32_16x16x32_bf16 v[52:55], v[84:87], v[96:99], v[52:55]
    s_add_u32 m0, s73, 0
    ds_read2_b32 v[134:135], v236 offset0:242 offset1:243
    v_mfma_f32_16x16x32_bf16 v[52:55], v[80:83], v[100:103], v[52:55]
    buffer_load_dwordx4 v5, s[52:55], s14 offen offset:1024 lds
    ds_read2_b32 v[136:137], v237 offset0:112 offset1:113
    v_mfma_f32_16x16x32_bf16 v[52:55], v[76:79], v[104:107], v[52:55]
    ds_write_b128 v241, v[224:227] offset:14560
    v_mfma_f32_16x16x32_bf16 v[52:55], v[72:75], v[108:111], v[52:55]
    ds_read2_b32 v[138:139], v237 offset0:114 offset1:115
    s_add_u32 s6, s12, 4751360
    ds_read2_b32 v[140:141], v237 offset0:240 offset1:241
    v_mfma_f32_16x16x32_bf16 v[52:55], v[68:71], v[112:115], v[52:55]
    ds_read2_b32 v[142:143], v237 offset0:242 offset1:243
    v_alignbit_b32 v230, v231, v230, 16
    v_mfma_f32_16x16x32_bf16 v[52:55], v[64:67], v[116:119], v[52:55]
    ds_read2_b32 v[144:145], v238 offset0:112 offset1:113
    v_xor_b32 v244, 64, v244
    v_mfma_f32_16x16x32_bf16 v[56:59], v[64:67], v[120:123], v[56:59]
    ds_read2_b32 v[146:147], v238 offset0:114 offset1:115
    v_mfma_f32_16x16x32_bf16 v[56:59], v[68:71], v[116:119], v[56:59]
    s_add_u32 m0, s73, 0
    ds_read2_b32 v[148:149], v238 offset0:240 offset1:241
    v_mfma_f32_16x16x32_bf16 v[56:59], v[72:75], v[112:115], v[56:59]
    buffer_load_dwordx4 v6, s[52:55], s14 offen offset:2048 lds
    v_alignbit_b32 v231, v232, v231, 16
    v_mfma_f32_16x16x32_bf16 v[56:59], v[76:79], v[108:111], v[56:59]
    ds_read2_b32 v[150:151], v238 offset0:242 offset1:243
    v_xor_b32 v245, 64, v245
    v_mfma_f32_16x16x32_bf16 v[56:59], v[80:83], v[104:107], v[56:59]
    ds_read2_b32 v[152:153], v239 offset0:112 offset1:113
    v_mfma_f32_16x16x32_bf16 v[56:59], v[84:87], v[100:103], v[56:59]
    ds_read2_b32 v[154:155], v239 offset0:114 offset1:115
    v_mfma_f32_16x16x32_bf16 v[56:59], v[88:91], v[96:99], v[56:59]
    ds_read2_b32 v[156:157], v239 offset0:240 offset1:241
    v_alignbit_b32 v232, v233, v232, 16
    v_mfma_f32_16x16x32_bf16 v[60:63], v[92:95], v[96:99], v[60:63]
    ds_read2_b32 v[158:159], v239 offset0:242 offset1:243
    s_waitcnt vmcnt(7)
    s_barrier
    v_mfma_f32_16x16x32_bf16 v[60:63], v[88:91], v[100:103], v[60:63]
    s_add_u32 m0, s73, 0
    v_xor_b32 v246, 64, v246
    v_add_u32 v236, 8320, v236
    v_mfma_f32_16x16x32_bf16 v[60:63], v[84:87], v[104:107], v[60:63]
    ds_read_b64_tr_b16 a[128:129], v10 offset:16384
    buffer_load_dwordx4 v7, s[52:55], s14 offen offset:3072 lds
    v_mfma_f32_16x16x32_bf16 v[60:63], v[80:83], v[108:111], v[60:63]
    ds_read_b64_tr_b16 a[130:131], v10 offset:18432
    v_alignbit_b32 v233, v234, v233, 16
    v_add_u32 v237, 8320, v237
    v_mfma_f32_16x16x32_bf16 v[60:63], v[76:79], v[112:115], v[60:63]
    ds_write_b128 v241, v[230:233] offset:15584
    v_mfma_f32_16x16x32_bf16 v[60:63], v[72:75], v[116:119], v[60:63]
    ds_read_b64_tr_b16 a[136:137], v10 offset:20480
    v_xor_b32 v247, 64, v247
    v_mfma_f32_16x16x32_bf16 v[60:63], v[68:71], v[120:123], v[60:63]
    ds_read_b64_tr_b16 a[138:139], v10 offset:22528
    v_add_u32 v238, 8320, v238
    v_mfma_f32_16x16x32_bf16 v[60:63], v[64:67], v[124:127], v[60:63]
    v_add_u32 v239, 8320, v239
    s_waitcnt lgkmcnt(5)
    v_mfma_f32_16x16x32_bf16 v[60:63], v[128:131], v[188:191], v[60:63]
    ds_read_b64_tr_b16 a[132:133], v11 offset:16384
    v_mfma_f32_16x16x32_bf16 v[60:63], v[132:135], v[184:187], v[60:63]
    ds_read_b64_tr_b16 a[134:135], v11 offset:18432
    v_mfma_f32_16x16x32_bf16 v[60:63], v[136:139], v[180:183], v[60:63]
    ds_read_b64_tr_b16 a[140:141], v11 offset:20480
    v_mfma_f32_16x16x32_bf16 v[60:63], v[140:143], v[176:179], v[60:63]
    ds_read_b128 v[96:99], v244 offset:2048
    v_mfma_f32_16x16x32_bf16 v[60:63], v[144:147], v[172:175], v[60:63]
    ds_read_b64_tr_b16 a[142:143], v11 offset:22528
    v_mfma_f32_16x16x32_bf16 v[60:63], v[148:151], v[168:171], v[60:63]
    ds_read2_b32 v[64:65], v236 offset0:0 offset1:1
    v_mfma_f32_16x16x32_bf16 v[60:63], v[152:155], v[164:167], v[60:63]
    ds_read2_b32 v[66:67], v236 offset0:2 offset1:3
    v_mfma_f32_16x16x32_bf16 v[60:63], v[156:159], v[160:163], v[60:63]
    ds_read_b128 v[100:103], v244 offset:6144
    v_mfma_f32_16x16x32_bf16 v[56:59], v[128:131], v[184:187], v[56:59]
    ds_read2_b32 v[68:69], v236 offset0:128 offset1:129
    v_mfma_f32_16x16x32_bf16 v[56:59], v[132:135], v[180:183], v[56:59]
    ds_read2_b32 v[70:71], v236 offset0:130 offset1:131
    v_mfma_f32_16x16x32_bf16 v[56:59], v[136:139], v[176:179], v[56:59]
    ds_read_b128 v[104:107], v244 offset:10240
    s_waitcnt lgkmcnt(6)
    s_barrier
    v_mfma_f32_16x16x32_bf16 v[56:59], v[140:143], v[172:175], v[56:59]
    ds_read2_b32 v[72:73], v237 offset0:0 offset1:1
    v_mfma_f32_16x16x32_bf16 v[56:59], v[144:147], v[168:171], v[56:59]
    ds_read2_b32 v[74:75], v237 offset0:2 offset1:3
    v_mfma_f32_16x16x32_bf16 v[56:59], v[148:151], v[164:167], v[56:59]
    ds_read_b128 v[108:111], v244 offset:14336
    v_cvt_pk_bf16_f32 v206, v60, v61
    v_mfma_f32_16x16x32_bf16 v[56:59], v[152:155], v[160:163], v[56:59]
    s_lshl_b32 s14, s95, 18
    ds_read2_b32 v[76:77], v237 offset0:128 offset1:129
    v_mfma_f32_16x16x32_bf16 v[52:55], v[128:131], v[180:183], v[52:55]
    s_add_u32 m0, s73, 16384
    ds_read2_b32 v[78:79], v237 offset0:130 offset1:131
    v_mfma_f32_16x16x32_bf16 v[52:55], v[132:135], v[176:179], v[52:55]
    buffer_load_dwordx4 v4, s[52:55], s14 offen offset:0 lds
    v_cvt_pk_bf16_f32 v207, v62, v63
    v_mfma_f32_16x16x32_bf16 v[52:55], v[136:139], v[172:175], v[52:55]
    ds_read_b128 v[112:115], v244 offset:18432
    v_mfma_f32_16x16x32_bf16 v[52:55], v[140:143], v[168:171], v[52:55]
    buffer_store_dwordx2 v[206:207], v8, s[44:47], s6 offen offset:3584 sc1
    ds_read2_b32 v[80:81], v238 offset0:0 offset1:1
    v_mfma_f32_16x16x32_bf16 v[52:55], v[144:147], v[164:167], v[52:55]
    ds_read2_b32 v[82:83], v238 offset0:2 offset1:3
    v_mfma_f32_16x16x32_bf16 v[52:55], v[148:151], v[160:163], v[52:55]
    ds_read_b128 v[116:119], v244 offset:22528
    v_mfma_f32_16x16x32_bf16 v[48:51], v[128:131], v[176:179], v[48:51]
    ds_read2_b32 v[84:85], v238 offset0:128 offset1:129
    v_cvt_pk_bf16_f32 v204, v56, v57
    v_mfma_f32_16x16x32_bf16 v[48:51], v[132:135], v[172:175], v[48:51]
    s_add_u32 m0, s73, 16384
    ds_read2_b32 v[86:87], v238 offset0:130 offset1:131
    v_mfma_f32_16x16x32_bf16 v[48:51], v[136:139], v[168:171], v[48:51]
    buffer_load_dwordx4 v5, s[52:55], s14 offen offset:1024 lds
    ds_read_b128 v[120:123], v244 offset:26624
    v_mfma_f32_16x16x32_bf16 v[48:51], v[140:143], v[164:167], v[48:51]
    ds_read2_b32 v[88:89], v239 offset0:0 offset1:1
    v_cvt_pk_bf16_f32 v205, v58, v59
    v_mfma_f32_16x16x32_bf16 v[48:51], v[144:147], v[160:163], v[48:51]
    ds_read2_b32 v[90:91], v239 offset0:2 offset1:3
    v_mfma_f32_16x16x32_bf16 v[44:47], v[128:131], v[172:175], v[44:47]
    buffer_store_dwordx2 v[204:205], v8, s[44:47], s6 offen offset:3072 sc1
    ds_read_b128 v[124:127], v244 offset:30720
    v_mfma_f32_16x16x32_bf16 v[44:47], v[132:135], v[168:171], v[44:47]
    ds_read2_b32 v[92:93], v239 offset0:128 offset1:129
    v_mfma_f32_16x16x32_bf16 v[44:47], v[136:139], v[164:167], v[44:47]
    ds_read2_b32 v[94:95], v239 offset0:130 offset1:131
    v_mfma_f32_16x16x32_bf16 v[44:47], v[140:143], v[160:163], v[44:47]
    s_add_u32 m0, s73, 16384
    v_cvt_pk_bf16_f32 v202, v52, v53
    v_mfma_f32_16x16x32_bf16 v[40:43], v[128:131], v[168:171], v[40:43]
    buffer_load_dwordx4 v6, s[52:55], s14 offen offset:2048 lds
    v_mfma_f32_16x16x32_bf16 v[40:43], v[132:135], v[164:167], v[40:43]
    v_mfma_f32_16x16x32_bf16 v[40:43], v[136:139], v[160:163], v[40:43]
    v_cvt_pk_bf16_f32 v203, v54, v55
    v_mfma_f32_16x16x32_bf16 v[36:39], v[128:131], v[164:167], v[36:39]
    v_mfma_f32_16x16x32_bf16 v[36:39], v[132:135], v[160:163], v[36:39]
    buffer_store_dwordx2 v[202:203], v8, s[44:47], s6 offen offset:2560 sc1
    v_mfma_f32_16x16x32_bf16 v[32:35], v[128:131], v[160:163], v[32:35]
    s_waitcnt lgkmcnt(0)
    v_mfma_f32_16x16x32_bf16 v[60:63], v[64:67], v[124:127], 0
    ds_read_b128 v[160:163], v245 offset:2048
    s_waitcnt vmcnt(10)
    s_barrier
    v_cvt_pk_bf16_f32 v200, v48, v49
    v_mfma_f32_16x16x32_bf16 v[60:63], v[68:71], v[120:123], v[60:63]
    v_add_u32 v10, 131072, v10
    s_add_u32 m0, s73, 16384
    v_mfma_f32_16x16x32_bf16 v[60:63], v[72:75], v[116:119], v[60:63]
    ds_read_b64_tr_b16 a[144:145], v10 offset:16384
    buffer_load_dwordx4 v7, s[52:55], s14 offen offset:3072 lds
    v_mfma_f32_16x16x32_bf16 v[60:63], v[76:79], v[112:115], v[60:63]
    ds_read_b64_tr_b16 a[146:147], v10 offset:18432
    v_cvt_pk_bf16_f32 v201, v50, v51
    v_mfma_f32_16x16x32_bf16 v[60:63], v[80:83], v[108:111], v[60:63]
    ds_read_b64_tr_b16 a[152:153], v10 offset:20480
    v_mfma_f32_16x16x32_bf16 v[60:63], v[84:87], v[104:107], v[60:63]
    buffer_store_dwordx2 v[200:201], v8, s[44:47], s6 offen offset:2048 sc1
    ds_read_b64_tr_b16 a[154:155], v10 offset:22528
    v_mfma_f32_16x16x32_bf16 v[60:63], v[88:91], v[100:103], v[60:63]
    ds_read2_b32 v[128:129], v236 offset0:16 offset1:17
    v_mfma_f32_16x16x32_bf16 v[60:63], v[92:95], v[96:99], v[60:63]
    v_add_u32 v11, 131072, v11
    v_cvt_pk_bf16_f32 v198, v44, v45
    v_mfma_f32_16x16x32_bf16 v[56:59], v[64:67], v[120:123], 0
    ds_read_b64_tr_b16 a[148:149], v11 offset:16384
    v_mfma_f32_16x16x32_bf16 v[56:59], v[68:71], v[116:119], v[56:59]
    ds_read_b64_tr_b16 a[150:151], v11 offset:18432
    v_mfma_f32_16x16x32_bf16 v[56:59], v[72:75], v[112:115], v[56:59]
    ds_read_b64_tr_b16 a[156:157], v11 offset:20480
    v_cvt_pk_bf16_f32 v199, v46, v47
    v_mfma_f32_16x16x32_bf16 v[56:59], v[76:79], v[108:111], v[56:59]
    ds_read_b64_tr_b16 a[158:159], v11 offset:22528
    v_mfma_f32_16x16x32_bf16 v[56:59], v[80:83], v[104:107], v[56:59]
    buffer_store_dwordx2 v[198:199], v8, s[44:47], s6 offen offset:1536 sc1
    ds_read2_b32 v[130:131], v236 offset0:18 offset1:19
    v_mfma_f32_16x16x32_bf16 v[56:59], v[84:87], v[100:103], v[56:59]
    ds_read_b128 v[164:167], v245 offset:6144
    v_mfma_f32_16x16x32_bf16 v[56:59], v[88:91], v[96:99], v[56:59]
    ds_read2_b32 v[132:133], v236 offset0:144 offset1:145
    v_cvt_pk_bf16_f32 v196, v40, v41
    v_mfma_f32_16x16x32_bf16 v[52:55], v[64:67], v[116:119], 0
    ds_read2_b32 v[134:135], v236 offset0:146 offset1:147
    v_mfma_f32_16x16x32_bf16 v[52:55], v[68:71], v[112:115], v[52:55]
    ds_read_b128 v[168:171], v245 offset:10240
    v_cvt_pk_bf16_f32 v197, v42, v43
    v_mfma_f32_16x16x32_bf16 v[52:55], v[72:75], v[108:111], v[52:55]
    ds_read2_b32 v[136:137], v237 offset0:16 offset1:17
    v_mfma_f32_16x16x32_bf16 v[52:55], v[76:79], v[104:107], v[52:55]
    buffer_store_dwordx2 v[196:197], v8, s[44:47], s6 offen offset:1024 sc1
    ds_read2_b32 v[138:139], v237 offset0:18 offset1:19
    s_waitcnt lgkmcnt(7)
    s_barrier
    v_mfma_f32_16x16x32_bf16 v[52:55], v[80:83], v[100:103], v[52:55]
    ds_read_b128 v[172:175], v245 offset:14336
    v_mfma_f32_16x16x32_bf16 v[52:55], v[84:87], v[96:99], v[52:55]
    ds_read2_b32 v[140:141], v237 offset0:144 offset1:145
    v_cvt_pk_bf16_f32 v194, v36, v37
    v_mfma_f32_16x16x32_bf16 v[48:51], v[64:67], v[112:115], 0
    s_lshl_b32 s14, s96, 18
    ds_read2_b32 v[142:143], v237 offset0:146 offset1:147
    v_mfma_f32_16x16x32_bf16 v[48:51], v[68:71], v[108:111], v[48:51]
    s_add_u32 m0, s73, 147456
    ds_read_b128 v[176:179], v245 offset:18432
    v_mfma_f32_16x16x32_bf16 v[48:51], v[72:75], v[104:107], v[48:51]
L_pl_X_5:
    s_cbranch_execz L_wret
    buffer_load_dwordx4 v4, s[52:55], s14 offen offset:0 lds
    v_cvt_pk_bf16_f32 v195, v38, v39
    v_mfma_f32_16x16x32_bf16 v[48:51], v[76:79], v[100:103], v[48:51]
    ds_read2_b32 v[144:145], v238 offset0:16 offset1:17
    v_mfma_f32_16x16x32_bf16 v[48:51], v[80:83], v[96:99], v[48:51]
    buffer_store_dwordx2 v[194:195], v8, s[44:47], s6 offen offset:512 sc1
    ds_read2_b32 v[146:147], v238 offset0:18 offset1:19
    v_mfma_f32_16x16x32_bf16 v[44:47], v[64:67], v[108:111], 0
    ds_read_b128 v[180:183], v245 offset:22528
    v_mfma_f32_16x16x32_bf16 v[44:47], v[68:71], v[104:107], v[44:47]
    ds_read2_b32 v[148:149], v238 offset0:144 offset1:145
    v_cvt_pk_bf16_f32 v192, v32, v33
    v_mfma_f32_16x16x32_bf16 v[44:47], v[72:75], v[100:103], v[44:47]
    ds_read2_b32 v[150:151], v238 offset0:146 offset1:147
    v_mfma_f32_16x16x32_bf16 v[44:47], v[76:79], v[96:99], v[44:47]
    ds_read_b128 v[184:187], v245 offset:26624
    s_add_u32 m0, s73, 147456
    v_cvt_pk_bf16_f32 v193, v34, v35
    v_mfma_f32_16x16x32_bf16 v[40:43], v[64:67], v[104:107], 0
    buffer_load_dwordx4 v5, s[52:55], s14 offen offset:1024 lds
    ds_read2_b32 v[152:153], v239 offset0:16 offset1:17
    v_mfma_f32_16x16x32_bf16 v[40:43], v[68:71], v[100:103], v[40:43]
    buffer_store_dwordx2 v[192:193], v8, s[44:47], s6 offen offset:0 sc1
    ds_read2_b32 v[154:155], v239 offset0:18 offset1:19
    v_mfma_f32_16x16x32_bf16 v[40:43], v[72:75], v[96:99], v[40:43]
    ds_read_b128 v[188:191], v245 offset:30720
    v_mfma_f32_16x16x32_bf16 v[36:39], v[64:67], v[100:103], 0
    ds_read2_b32 v[156:157], v239 offset0:144 offset1:145
    v_mfma_f32_16x16x32_bf16 v[36:39], v[68:71], v[96:99], v[36:39]
    ds_read2_b32 v[158:159], v239 offset0:146 offset1:147
    v_mfma_f32_16x16x32_bf16 v[32:35], v[64:67], v[96:99], 0
    s_waitcnt lgkmcnt(12)
    v_mfma_f32_16x16x32_bf16 v[32:35], v[128:131], v[160:163], v[32:35]
    ds_read_b128 v[96:99], v246 offset:2048
    v_mfma_f32_16x16x32_bf16 v[36:39], v[132:135], v[160:163], v[36:39]
    s_add_u32 m0, s73, 147456
    ds_read2_b32 v[64:65], v236 offset0:32 offset1:33
    v_mfma_f32_16x16x32_bf16 v[36:39], v[128:131], v[164:167], v[36:39]
    buffer_load_dwordx4 v6, s[52:55], s14 offen offset:2048 lds
    ds_read2_b32 v[66:67], v236 offset0:34 offset1:35
    v_mfma_f32_16x16x32_bf16 v[40:43], v[128:131], v[168:171], v[40:43]
    ds_read_b128 v[100:103], v246 offset:6144
    v_mfma_f32_16x16x32_bf16 v[40:43], v[132:135], v[164:167], v[40:43]
    ds_read2_b32 v[68:69], v236 offset0:160 offset1:161
    v_mfma_f32_16x16x32_bf16 v[40:43], v[136:139], v[160:163], v[40:43]
    ds_read2_b32 v[70:71], v236 offset0:162 offset1:163
    v_mfma_f32_16x16x32_bf16 v[44:47], v[140:143], v[160:163], v[44:47]
    ds_read_b128 v[104:107], v246 offset:10240
    v_mfma_f32_16x16x32_bf16 v[44:47], v[136:139], v[164:167], v[44:47]
    ds_read2_b32 v[72:73], v237 offset0:32 offset1:33
    s_waitcnt vmcnt(15)
    s_barrier
    v_mfma_f32_16x16x32_bf16 v[44:47], v[132:135], v[168:171], v[44:47]
    v_add_u32 v10, -131072, v10
    s_add_u32 m0, s73, 147456
    v_mfma_f32_16x16x32_bf16 v[44:47], v[128:131], v[172:175], v[44:47]
    ds_read_b64_tr_b16 a[160:161], v10 offset:0
    buffer_load_dwordx4 v7, s[52:55], s14 offen offset:3072 lds
    s_waitcnt lgkmcnt(9)
    v_mfma_f32_16x16x32_bf16 v[48:51], v[128:131], v[176:179], v[48:51]
    ds_read_b64_tr_b16 a[162:163], v10 offset:2048
    v_mfma_f32_16x16x32_bf16 v[48:51], v[132:135], v[172:175], v[48:51]
    ds_read_b64_tr_b16 a[168:169], v10 offset:4096
    v_mfma_f32_16x16x32_bf16 v[48:51], v[136:139], v[168:171], v[48:51]
    ds_read2_b32 v[74:75], v237 offset0:34 offset1:35
    v_mfma_f32_16x16x32_bf16 v[48:51], v[140:143], v[164:167], v[48:51]
    ds_read_b64_tr_b16 a[170:171], v10 offset:6144
    v_mfma_f32_16x16x32_bf16 v[48:51], v[144:147], v[160:163], v[48:51]
    ds_read_b128 v[108:111], v246 offset:14336
    v_add_u32 v11, -131072, v11
    v_mfma_f32_16x16x32_bf16 v[52:55], v[148:151], v[160:163], v[52:55]
    ds_read_b64_tr_b16 a[164:165], v11 offset:0
    v_mfma_f32_16x16x32_bf16 v[52:55], v[144:147], v[164:167], v[52:55]
    ds_read_b64_tr_b16 a[166:167], v11 offset:2048
    v_mfma_f32_16x16x32_bf16 v[52:55], v[140:143], v[168:171], v[52:55]
    ds_read_b64_tr_b16 a[172:173], v11 offset:4096
    v_mfma_f32_16x16x32_bf16 v[52:55], v[136:139], v[172:175], v[52:55]
    ds_read_b64_tr_b16 a[174:175], v11 offset:6144
    v_mfma_f32_16x16x32_bf16 v[52:55], v[132:135], v[176:179], v[52:55]
    ds_read2_b32 v[76:77], v237 offset0:160 offset1:161
    v_mfma_f32_16x16x32_bf16 v[52:55], v[128:131], v[180:183], v[52:55]
    ds_read2_b32 v[78:79], v237 offset0:162 offset1:163
    v_mfma_f32_16x16x32_bf16 v[56:59], v[128:131], v[184:187], v[56:59]
    ds_read_b128 v[112:115], v246 offset:18432
    v_mfma_f32_16x16x32_bf16 v[56:59], v[132:135], v[180:183], v[56:59]
    ds_read2_b32 v[80:81], v238 offset0:32 offset1:33
    v_mfma_f32_16x16x32_bf16 v[56:59], v[136:139], v[176:179], v[56:59]
    ds_read2_b32 v[82:83], v238 offset0:34 offset1:35
    v_mfma_f32_16x16x32_bf16 v[56:59], v[140:143], v[172:175], v[56:59]
    ds_read_b128 v[116:119], v246 offset:22528
    v_mfma_f32_16x16x32_bf16 v[56:59], v[144:147], v[168:171], v[56:59]
    ds_read2_b32 v[84:85], v238 offset0:160 offset1:161
    s_waitcnt lgkmcnt(7)
    s_barrier
    v_mfma_f32_16x16x32_bf16 v[56:59], v[148:151], v[164:167], v[56:59]
    ds_read2_b32 v[86:87], v238 offset0:162 offset1:163
    v_mfma_f32_16x16x32_bf16 v[56:59], v[152:155], v[160:163], v[56:59]
    ds_read_b128 v[120:123], v246 offset:26624
    v_mfma_f32_16x16x32_bf16 v[60:63], v[156:159], v[160:163], v[60:63]
    s_lshl_b32 s14, s97, 18
    ds_read2_b32 v[88:89], v239 offset0:32 offset1:33
    v_mfma_f32_16x16x32_bf16 v[60:63], v[152:155], v[164:167], v[60:63]
    s_add_u32 m0, s73, 0
    ds_read2_b32 v[90:91], v239 offset0:34 offset1:35
    v_mfma_f32_16x16x32_bf16 v[60:63], v[148:151], v[168:171], v[60:63]
    buffer_load_dwordx4 v4, s[52:55], s14 offen offset:0 lds
    v_mfma_f32_16x16x32_bf16 v[60:63], v[144:147], v[172:175], v[60:63]
    ds_read_b128 v[124:127], v246 offset:30720
    v_mfma_f32_16x16x32_bf16 v[60:63], v[140:143], v[176:179], v[60:63]
    ds_read2_b32 v[92:93], v239 offset0:160 offset1:161
    v_mfma_f32_16x16x32_bf16 v[60:63], v[136:139], v[180:183], v[60:63]
    v_mfma_f32_16x16x32_bf16 v[60:63], v[132:135], v[184:187], v[60:63]
    ds_read2_b32 v[94:95], v239 offset0:162 offset1:163
    v_mfma_f32_16x16x32_bf16 v[60:63], v[128:131], v[188:191], v[60:63]
    s_waitcnt lgkmcnt(12)
    v_mfma_f32_16x16x32_bf16 v[32:35], v[64:67], v[96:99], v[32:35]
    ds_read_b128 v[160:163], v247 offset:2048
    v_mfma_f32_16x16x32_bf16 v[36:39], v[68:71], v[96:99], v[36:39]
    s_add_u32 m0, s73, 0
    v_mfma_f32_16x16x32_bf16 v[36:39], v[64:67], v[100:103], v[36:39]
    buffer_load_dwordx4 v5, s[52:55], s14 offen offset:1024 lds
    ds_read2_b32 v[128:129], v236 offset0:48 offset1:49
    v_mfma_f32_16x16x32_bf16 v[40:43], v[64:67], v[104:107], v[40:43]
    ds_read2_b32 v[130:131], v236 offset0:50 offset1:51
    v_mfma_f32_16x16x32_bf16 v[40:43], v[68:71], v[100:103], v[40:43]
    v_mfma_f32_16x16x32_bf16 v[40:43], v[72:75], v[96:99], v[40:43]
    ds_read_b128 v[164:167], v247 offset:6144
    v_mfma_f32_16x16x32_bf16 v[44:47], v[76:79], v[96:99], v[44:47]
    ds_read2_b32 v[132:133], v236 offset0:176 offset1:177
    v_mfma_f32_16x16x32_bf16 v[44:47], v[72:75], v[100:103], v[44:47]
    v_mfma_f32_16x16x32_bf16 v[44:47], v[68:71], v[104:107], v[44:47]
    s_add_u32 m0, s73, 0
    ds_read2_b32 v[134:135], v236 offset0:178 offset1:179
    v_mfma_f32_16x16x32_bf16 v[44:47], v[64:67], v[108:111], v[44:47]
    buffer_load_dwordx4 v6, s[52:55], s14 offen offset:2048 lds
    ds_read_b128 v[168:171], v247 offset:10240
    s_waitcnt lgkmcnt(7)
    v_mfma_f32_16x16x32_bf16 v[48:51], v[64:67], v[112:115], v[48:51]
    ds_read2_b32 v[136:137], v237 offset0:48 offset1:49
    v_mfma_f32_16x16x32_bf16 v[48:51], v[68:71], v[108:111], v[48:51]
    ds_read2_b32 v[138:139], v237 offset0:50 offset1:51
    v_mfma_f32_16x16x32_bf16 v[48:51], v[72:75], v[104:107], v[48:51]
    ds_read_b128 v[172:175], v247 offset:14336
    v_mfma_f32_16x16x32_bf16 v[48:51], v[76:79], v[100:103], v[48:51]
    ds_read2_b32 v[140:141], v237 offset0:176 offset1:177
    v_mfma_f32_16x16x32_bf16 v[48:51], v[80:83], v[96:99], v[48:51]
    ds_read2_b32 v[142:143], v237 offset0:178 offset1:179
    s_waitcnt vmcnt(12)
    s_barrier
    v_mfma_f32_16x16x32_bf16 v[52:55], v[84:87], v[96:99], v[52:55]
    ds_read_b64_tr_b16 a[176:177], v10 offset:16384
    s_add_u32 m0, s73, 0
    v_mfma_f32_16x16x32_bf16 v[52:55], v[80:83], v[100:103], v[52:55]
    buffer_load_dwordx4 v7, s[52:55], s14 offen offset:3072 lds
    ds_read_b128 v[176:179], v247 offset:18432
    v_mfma_f32_16x16x32_bf16 v[52:55], v[76:79], v[104:107], v[52:55]
    ds_read_b64_tr_b16 a[178:179], v10 offset:18432
    v_mfma_f32_16x16x32_bf16 v[52:55], v[72:75], v[108:111], v[52:55]
    ds_read_b64_tr_b16 a[184:185], v10 offset:20480
    v_mfma_f32_16x16x32_bf16 v[52:55], v[68:71], v[112:115], v[52:55]
    ds_read2_b32 v[144:145], v238 offset0:48 offset1:49
    v_mfma_f32_16x16x32_bf16 v[52:55], v[64:67], v[116:119], v[52:55]
    ds_read_b64_tr_b16 a[186:187], v10 offset:22528
    v_mfma_f32_16x16x32_bf16 v[56:59], v[64:67], v[120:123], v[56:59]
    ds_read_b64_tr_b16 a[180:181], v11 offset:16384
    v_mfma_f32_16x16x32_bf16 v[56:59], v[68:71], v[116:119], v[56:59]
    ds_read2_b32 v[146:147], v238 offset0:50 offset1:51
    v_mfma_f32_16x16x32_bf16 v[56:59], v[72:75], v[112:115], v[56:59]
    ds_read_b64_tr_b16 a[182:183], v11 offset:18432
    v_mfma_f32_16x16x32_bf16 v[56:59], v[76:79], v[108:111], v[56:59]
    ds_read_b64_tr_b16 a[188:189], v11 offset:20480
    v_mfma_f32_16x16x32_bf16 v[56:59], v[80:83], v[104:107], v[56:59]
    ds_read_b64_tr_b16 a[190:191], v11 offset:22528
    v_mfma_f32_16x16x32_bf16 v[56:59], v[84:87], v[100:103], v[56:59]
    ds_read_b128 v[180:183], v247 offset:22528
    v_mfma_f32_16x16x32_bf16 v[56:59], v[88:91], v[96:99], v[56:59]
    ds_read2_b32 v[148:149], v238 offset0:176 offset1:177
    v_mfma_f32_16x16x32_bf16 v[60:63], v[92:95], v[96:99], v[60:63]
    ds_read2_b32 v[150:151], v238 offset0:178 offset1:179
    v_mfma_f32_16x16x32_bf16 v[60:63], v[88:91], v[100:103], v[60:63]
    ds_read_b128 v[184:187], v247 offset:26624
    v_mfma_f32_16x16x32_bf16 v[60:63], v[84:87], v[104:107], v[60:63]
    ds_read2_b32 v[152:153], v239 offset0:48 offset1:49
    v_mfma_f32_16x16x32_bf16 v[60:63], v[80:83], v[108:111], v[60:63]
    ds_read2_b32 v[154:155], v239 offset0:50 offset1:51
    v_mfma_f32_16x16x32_bf16 v[60:63], v[76:79], v[112:115], v[60:63]
    ds_read_b128 v[188:191], v247 offset:30720
    s_waitcnt lgkmcnt(7)
    s_barrier
    v_mfma_f32_16x16x32_bf16 v[60:63], v[72:75], v[116:119], v[60:63]
    ds_read2_b32 v[156:157], v239 offset0:176 offset1:177
    v_mfma_f32_16x16x32_bf16 v[60:63], v[68:71], v[120:123], v[60:63]
    ds_read2_b32 v[158:159], v239 offset0:178 offset1:179
    v_mfma_f32_16x16x32_bf16 v[60:63], v[64:67], v[124:127], v[60:63]
    v_mfma_f32_16x16x32_bf16 v[32:35], v[128:131], v[160:163], v[32:35]
    s_lshl_b32 s14, s98, 18
    ds_read_b128 v[96:99], v244 offset:0
    v_mfma_f32_16x16x32_bf16 v[36:39], v[132:135], v[160:163], v[36:39]
    s_add_u32 m0, s73, 16384
    v_mfma_f32_16x16x32_bf16 v[36:39], v[128:131], v[164:167], v[36:39]
    buffer_load_dwordx4 v4, s[52:55], s14 offen offset:0 lds
    ds_read2_b32 v[64:65], v236 offset0:64 offset1:65
    v_mfma_f32_16x16x32_bf16 v[40:43], v[128:131], v[168:171], v[40:43]
    ds_read2_b32 v[66:67], v236 offset0:66 offset1:67
    v_mfma_f32_16x16x32_bf16 v[40:43], v[132:135], v[164:167], v[40:43]
    v_mfma_f32_16x16x32_bf16 v[40:43], v[136:139], v[160:163], v[40:43]
    ds_read_b128 v[100:103], v244 offset:4096
    v_mfma_f32_16x16x32_bf16 v[44:47], v[140:143], v[160:163], v[44:47]
    ds_read2_b32 v[68:69], v236 offset0:192 offset1:193
    v_mfma_f32_16x16x32_bf16 v[44:47], v[136:139], v[164:167], v[44:47]
    ds_read2_b32 v[70:71], v236 offset0:194 offset1:195
    v_mfma_f32_16x16x32_bf16 v[44:47], v[132:135], v[168:171], v[44:47]
    s_add_u32 m0, s73, 16384
    ds_read_b128 v[104:107], v244 offset:8192
    v_mfma_f32_16x16x32_bf16 v[44:47], v[128:131], v[172:175], v[44:47]
    buffer_load_dwordx4 v5, s[52:55], s14 offen offset:1024 lds
    ds_read2_b32 v[72:73], v237 offset0:64 offset1:65
    s_waitcnt lgkmcnt(8)
    v_mfma_f32_16x16x32_bf16 v[48:51], v[128:131], v[176:179], v[48:51]
    ds_read2_b32 v[74:75], v237 offset0:66 offset1:67
    v_mfma_f32_16x16x32_bf16 v[48:51], v[132:135], v[172:175], v[48:51]
    ds_read_b128 v[108:111], v244 offset:12288
    v_mfma_f32_16x16x32_bf16 v[48:51], v[136:139], v[168:171], v[48:51]
    ds_read2_b32 v[76:77], v237 offset0:192 offset1:193
    v_mfma_f32_16x16x32_bf16 v[48:51], v[140:143], v[164:167], v[48:51]
    ds_read2_b32 v[78:79], v237 offset0:194 offset1:195
    v_mfma_f32_16x16x32_bf16 v[48:51], v[144:147], v[160:163], v[48:51]
    ds_read_b128 v[112:115], v244 offset:16384
    v_mfma_f32_16x16x32_bf16 v[52:55], v[148:151], v[160:163], v[52:55]
    s_add_u32 m0, s73, 16384
    ds_read2_b32 v[80:81], v238 offset0:64 offset1:65
    v_mfma_f32_16x16x32_bf16 v[52:55], v[144:147], v[164:167], v[52:55]
    buffer_load_dwordx4 v6, s[52:55], s14 offen offset:2048 lds
    ds_read2_b32 v[82:83], v238 offset0:66 offset1:67
    v_mfma_f32_16x16x32_bf16 v[52:55], v[140:143], v[168:171], v[52:55]
    ds_read_b128 v[116:119], v244 offset:20480
    v_mfma_f32_16x16x32_bf16 v[52:55], v[136:139], v[172:175], v[52:55]
    ds_read2_b32 v[84:85], v238 offset0:192 offset1:193
    v_mfma_f32_16x16x32_bf16 v[52:55], v[132:135], v[176:179], v[52:55]
    ds_read2_b32 v[86:87], v238 offset0:194 offset1:195
    v_mfma_f32_16x16x32_bf16 v[52:55], v[128:131], v[180:183], v[52:55]
    ds_read_b128 v[120:123], v244 offset:24576
    v_mfma_f32_16x16x32_bf16 v[56:59], v[128:131], v[184:187], v[56:59]
    ds_read2_b32 v[88:89], v239 offset0:64 offset1:65
    s_waitcnt vmcnt(7)
    s_barrier
    v_mfma_f32_16x16x32_bf16 v[56:59], v[132:135], v[180:183], v[56:59]
    v_add_u32 v10, 131072, v10
    s_add_u32 m0, s73, 16384
    v_mfma_f32_16x16x32_bf16 v[56:59], v[136:139], v[176:179], v[56:59]
    ds_read_b64_tr_b16 a[192:193], v10 offset:16384
    buffer_load_dwordx4 v7, s[52:55], s14 offen offset:3072 lds
    v_mfma_f32_16x16x32_bf16 v[56:59], v[140:143], v[172:175], v[56:59]
    ds_read2_b32 v[90:91], v239 offset0:66 offset1:67
    v_mfma_f32_16x16x32_bf16 v[56:59], v[144:147], v[168:171], v[56:59]
    ds_read_b64_tr_b16 a[194:195], v10 offset:18432
    v_mfma_f32_16x16x32_bf16 v[56:59], v[148:151], v[164:167], v[56:59]
    ds_read_b64_tr_b16 a[200:201], v10 offset:20480
    v_mfma_f32_16x16x32_bf16 v[56:59], v[152:155], v[160:163], v[56:59]
    ds_read_b64_tr_b16 a[202:203], v10 offset:22528
    v_mfma_f32_16x16x32_bf16 v[60:63], v[156:159], v[160:163], v[60:63]
    ds_read_b128 v[124:127], v244 offset:28672
    v_add_u32 v11, 131072, v11
    v_mfma_f32_16x16x32_bf16 v[60:63], v[152:155], v[164:167], v[60:63]
    ds_read_b64_tr_b16 a[196:197], v11 offset:16384
    v_mfma_f32_16x16x32_bf16 v[60:63], v[148:151], v[168:171], v[60:63]
    ds_read2_b32 v[92:93], v239 offset0:192 offset1:193
    v_mfma_f32_16x16x32_bf16 v[60:63], v[144:147], v[172:175], v[60:63]
    ds_read_b64_tr_b16 a[198:199], v11 offset:18432
    v_mfma_f32_16x16x32_bf16 v[60:63], v[140:143], v[176:179], v[60:63]
    ds_read_b64_tr_b16 a[204:205], v11 offset:20480
    v_mfma_f32_16x16x32_bf16 v[60:63], v[136:139], v[180:183], v[60:63]
    ds_read_b64_tr_b16 a[206:207], v11 offset:22528
    v_mfma_f32_16x16x32_bf16 v[60:63], v[132:135], v[184:187], v[60:63]
    ds_read2_b32 v[94:95], v239 offset0:194 offset1:195
    v_mfma_f32_16x16x32_bf16 v[60:63], v[128:131], v[188:191], v[60:63]
    s_waitcnt lgkmcnt(15)
    v_mfma_f32_16x16x32_bf16 v[32:35], v[64:67], v[96:99], v[32:35]
    ds_read_b128 v[160:163], v245 offset:0
    v_mfma_f32_16x16x32_bf16 v[36:39], v[68:71], v[96:99], v[36:39]
    v_mfma_f32_16x16x32_bf16 v[36:39], v[64:67], v[100:103], v[36:39]
    ds_read2_b32 v[128:129], v236 offset0:80 offset1:81
    v_mfma_f32_16x16x32_bf16 v[40:43], v[64:67], v[104:107], v[40:43]
    ds_read2_b32 v[130:131], v236 offset0:82 offset1:83
    s_waitcnt lgkmcnt(4)
    s_barrier
    v_mfma_f32_16x16x32_bf16 v[40:43], v[68:71], v[100:103], v[40:43]
    v_mfma_f32_16x16x32_bf16 v[40:43], v[72:75], v[96:99], v[40:43]
    ds_read_b128 v[164:167], v245 offset:4096
    v_mfma_f32_16x16x32_bf16 v[44:47], v[76:79], v[96:99], v[44:47]
    ds_read2_b32 v[132:133], v236 offset0:208 offset1:209
    v_mfma_f32_16x16x32_bf16 v[44:47], v[72:75], v[100:103], v[44:47]
    s_lshl_b32 s14, s99, 18
    v_mfma_f32_16x16x32_bf16 v[44:47], v[68:71], v[104:107], v[44:47]
    s_add_u32 m0, s73, 147456
    ds_read2_b32 v[134:135], v236 offset0:210 offset1:211
    v_mfma_f32_16x16x32_bf16 v[44:47], v[64:67], v[108:111], v[44:47]
    buffer_load_dwordx4 v4, s[52:55], s14 offen offset:0 lds
    ds_read_b128 v[168:171], v245 offset:8192
    s_waitcnt lgkmcnt(7)
    v_mfma_f32_16x16x32_bf16 v[48:51], v[64:67], v[112:115], v[48:51]
    ds_read2_b32 v[136:137], v237 offset0:80 offset1:81
    v_mfma_f32_16x16x32_bf16 v[48:51], v[68:71], v[108:111], v[48:51]
    v_mfma_f32_16x16x32_bf16 v[48:51], v[72:75], v[104:107], v[48:51]
    ds_read2_b32 v[138:139], v237 offset0:82 offset1:83
    v_mfma_f32_16x16x32_bf16 v[48:51], v[76:79], v[100:103], v[48:51]
    ds_read_b128 v[172:175], v245 offset:12288
    v_mfma_f32_16x16x32_bf16 v[48:51], v[80:83], v[96:99], v[48:51]
    v_mfma_f32_16x16x32_bf16 v[52:55], v[84:87], v[96:99], v[52:55]
    s_add_u32 m0, s73, 147456
    ds_read2_b32 v[140:141], v237 offset0:208 offset1:209
    v_mfma_f32_16x16x32_bf16 v[52:55], v[80:83], v[100:103], v[52:55]
    buffer_load_dwordx4 v5, s[52:55], s14 offen offset:1024 lds
    ds_read2_b32 v[142:143], v237 offset0:210 offset1:211
    v_mfma_f32_16x16x32_bf16 v[52:55], v[76:79], v[104:107], v[52:55]
    v_mfma_f32_16x16x32_bf16 v[52:55], v[72:75], v[108:111], v[52:55]
    ds_read_b128 v[176:179], v245 offset:16384
    v_mfma_f32_16x16x32_bf16 v[52:55], v[68:71], v[112:115], v[52:55]
    ds_read2_b32 v[144:145], v238 offset0:80 offset1:81
    v_mfma_f32_16x16x32_bf16 v[52:55], v[64:67], v[116:119], v[52:55]
    ds_read2_b32 v[146:147], v238 offset0:82 offset1:83
    v_mfma_f32_16x16x32_bf16 v[56:59], v[64:67], v[120:123], v[56:59]
    ds_read_b128 v[180:183], v245 offset:20480
    v_mfma_f32_16x16x32_bf16 v[56:59], v[68:71], v[116:119], v[56:59]
    s_add_u32 m0, s73, 147456
    ds_read2_b32 v[148:149], v238 offset0:208 offset1:209
    v_mfma_f32_16x16x32_bf16 v[56:59], v[72:75], v[112:115], v[56:59]
    buffer_load_dwordx4 v6, s[52:55], s14 offen offset:2048 lds
    ds_read2_b32 v[150:151], v238 offset0:210 offset1:211
    v_mfma_f32_16x16x32_bf16 v[56:59], v[76:79], v[108:111], v[56:59]
    ds_read_b128 v[184:187], v245 offset:24576
    v_mfma_f32_16x16x32_bf16 v[56:59], v[80:83], v[104:107], v[56:59]
    ds_read2_b32 v[152:153], v239 offset0:80 offset1:81
    v_mfma_f32_16x16x32_bf16 v[56:59], v[84:87], v[100:103], v[56:59]
    ds_read2_b32 v[154:155], v239 offset0:82 offset1:83
    v_mfma_f32_16x16x32_bf16 v[56:59], v[88:91], v[96:99], v[56:59]
    ds_read_b128 v[188:191], v245 offset:28672
    v_mfma_f32_16x16x32_bf16 v[60:63], v[92:95], v[96:99], v[60:63]
    ds_read2_b32 v[156:157], v239 offset0:208 offset1:209
    s_waitcnt vmcnt(7)
    s_barrier
    v_mfma_f32_16x16x32_bf16 v[60:63], v[88:91], v[100:103], v[60:63]
    v_add_u32 v10, -131072, v10
    s_add_u32 m0, s73, 147456
    v_mfma_f32_16x16x32_bf16 v[60:63], v[84:87], v[104:107], v[60:63]
    buffer_load_dwordx4 v7, s[52:55], s14 offen offset:3072 lds
    ds_read2_b32 v[158:159], v239 offset0:210 offset1:211
    v_mfma_f32_16x16x32_bf16 v[60:63], v[80:83], v[108:111], v[60:63]
    ds_read_b64_tr_b16 a[208:209], v10 offset:0
    v_mfma_f32_16x16x32_bf16 v[60:63], v[76:79], v[112:115], v[60:63]
    ds_read_b64_tr_b16 a[210:211], v10 offset:2048
    v_mfma_f32_16x16x32_bf16 v[60:63], v[72:75], v[116:119], v[60:63]
    ds_read_b64_tr_b16 a[216:217], v10 offset:4096
    v_mfma_f32_16x16x32_bf16 v[60:63], v[68:71], v[120:123], v[60:63]
    ds_read_b64_tr_b16 a[218:219], v10 offset:6144
    v_mfma_f32_16x16x32_bf16 v[60:63], v[64:67], v[124:127], v[60:63]
    v_add_u32 v11, -131072, v11
    s_waitcnt lgkmcnt(15)
    v_mfma_f32_16x16x32_bf16 v[32:35], v[128:131], v[160:163], v[32:35]
    ds_read_b128 v[96:99], v246 offset:0
    v_mfma_f32_16x16x32_bf16 v[36:39], v[132:135], v[160:163], v[36:39]
    ds_read_b64_tr_b16 a[212:213], v11 offset:0
    v_mfma_f32_16x16x32_bf16 v[36:39], v[128:131], v[164:167], v[36:39]
    ds_read_b64_tr_b16 a[214:215], v11 offset:2048
    v_mfma_f32_16x16x32_bf16 v[40:43], v[128:131], v[168:171], v[40:43]
    ds_read_b64_tr_b16 a[220:221], v11 offset:4096
    v_mfma_f32_16x16x32_bf16 v[40:43], v[132:135], v[164:167], v[40:43]
    ds_read_b64_tr_b16 a[222:223], v11 offset:6144
    v_mfma_f32_16x16x32_bf16 v[40:43], v[136:139], v[160:163], v[40:43]
    ds_read2_b32 v[64:65], v236 offset0:96 offset1:97
    v_mfma_f32_16x16x32_bf16 v[44:47], v[140:143], v[160:163], v[44:47]
    ds_read2_b32 v[66:67], v236 offset0:98 offset1:99
    v_mfma_f32_16x16x32_bf16 v[44:47], v[136:139], v[164:167], v[44:47]
    ds_read_b128 v[100:103], v246 offset:4096
    v_mfma_f32_16x16x32_bf16 v[44:47], v[132:135], v[168:171], v[44:47]
    ds_read2_b32 v[68:69], v236 offset0:224 offset1:225
    v_mfma_f32_16x16x32_bf16 v[44:47], v[128:131], v[172:175], v[44:47]
    ds_read2_b32 v[70:71], v236 offset0:226 offset1:227
    s_waitcnt lgkmcnt(14)
    v_mfma_f32_16x16x32_bf16 v[48:51], v[128:131], v[176:179], v[48:51]
    ds_read_b128 v[104:107], v246 offset:8192
    s_waitcnt lgkmcnt(6)
    s_barrier
    v_mfma_f32_16x16x32_bf16 v[48:51], v[132:135], v[172:175], v[48:51]
    ds_read2_b32 v[72:73], v237 offset0:96 offset1:97
    v_mfma_f32_16x16x32_bf16 v[48:51], v[136:139], v[168:171], v[48:51]
    ds_read2_b32 v[74:75], v237 offset0:98 offset1:99
    v_mfma_f32_16x16x32_bf16 v[48:51], v[140:143], v[164:167], v[48:51]
    ds_read_b128 v[108:111], v246 offset:12288
    v_mfma_f32_16x16x32_bf16 v[48:51], v[144:147], v[160:163], v[48:51]
    s_lshl_b32 s14, s100, 18
    v_mfma_f32_16x16x32_bf16 v[52:55], v[148:151], v[160:163], v[52:55]
    s_add_u32 m0, s73, 0
    ds_read2_b32 v[76:77], v237 offset0:224 offset1:225
    v_mfma_f32_16x16x32_bf16 v[52:55], v[144:147], v[164:167], v[52:55]
    buffer_load_dwordx4 v4, s[52:55], s14 offen offset:0 lds
    ds_read2_b32 v[78:79], v237 offset0:226 offset1:227
    v_mfma_f32_16x16x32_bf16 v[52:55], v[140:143], v[168:171], v[52:55]
    v_mfma_f32_16x16x32_bf16 v[52:55], v[136:139], v[172:175], v[52:55]
    ds_read_b128 v[112:115], v246 offset:16384
    v_mfma_f32_16x16x32_bf16 v[52:55], v[132:135], v[176:179], v[52:55]
    ds_read2_b32 v[80:81], v238 offset0:96 offset1:97
    v_mfma_f32_16x16x32_bf16 v[52:55], v[128:131], v[180:183], v[52:55]
    v_mfma_f32_16x16x32_bf16 v[56:59], v[128:131], v[184:187], v[56:59]
    ds_read2_b32 v[82:83], v238 offset0:98 offset1:99
    v_mfma_f32_16x16x32_bf16 v[56:59], v[132:135], v[180:183], v[56:59]
    s_add_u32 m0, s73, 0
    ds_read_b128 v[116:119], v246 offset:20480
    v_mfma_f32_16x16x32_bf16 v[56:59], v[136:139], v[176:179], v[56:59]
    buffer_load_dwordx4 v5, s[52:55], s14 offen offset:1024 lds
    v_mfma_f32_16x16x32_bf16 v[56:59], v[140:143], v[172:175], v[56:59]
    ds_read2_b32 v[84:85], v238 offset0:224 offset1:225
    v_mfma_f32_16x16x32_bf16 v[56:59], v[144:147], v[168:171], v[56:59]
    ds_read2_b32 v[86:87], v238 offset0:226 offset1:227
    v_mfma_f32_16x16x32_bf16 v[56:59], v[148:151], v[164:167], v[56:59]
    ds_read_b128 v[120:123], v246 offset:24576
    v_mfma_f32_16x16x32_bf16 v[56:59], v[152:155], v[160:163], v[56:59]
    v_mfma_f32_16x16x32_bf16 v[60:63], v[156:159], v[160:163], v[60:63]
    ds_read2_b32 v[88:89], v239 offset0:96 offset1:97
    v_mfma_f32_16x16x32_bf16 v[60:63], v[152:155], v[164:167], v[60:63]
    s_add_u32 m0, s73, 0
    ds_read2_b32 v[90:91], v239 offset0:98 offset1:99
    v_mfma_f32_16x16x32_bf16 v[60:63], v[148:151], v[168:171], v[60:63]
    buffer_load_dwordx4 v6, s[52:55], s14 offen offset:2048 lds
    v_mfma_f32_16x16x32_bf16 v[60:63], v[144:147], v[172:175], v[60:63]
    ds_read_b128 v[124:127], v246 offset:28672
    v_mfma_f32_16x16x32_bf16 v[60:63], v[140:143], v[176:179], v[60:63]
    ds_read2_b32 v[92:93], v239 offset0:224 offset1:225
    v_mfma_f32_16x16x32_bf16 v[60:63], v[136:139], v[180:183], v[60:63]
    v_mfma_f32_16x16x32_bf16 v[60:63], v[132:135], v[184:187], v[60:63]
    ds_read2_b32 v[94:95], v239 offset0:226 offset1:227
    v_mfma_f32_16x16x32_bf16 v[60:63], v[128:131], v[188:191], v[60:63]
    s_waitcnt lgkmcnt(12)
    v_mfma_f32_16x16x32_bf16 v[32:35], v[64:67], v[96:99], v[32:35]
    ds_read_b128 v[160:163], v247 offset:0
    s_waitcnt vmcnt(7)
    s_barrier
    v_mfma_f32_16x16x32_bf16 v[36:39], v[68:71], v[96:99], v[36:39]
    ds_read_b64_tr_b16 a[224:225], v10 offset:16384
    s_add_u32 m0, s73, 0
    s_bfe_u32 s4, s2, 0x20003
    v_mfma_f32_16x16x32_bf16 v[36:39], v[64:67], v[100:103], v[36:39]
    ds_read_b64_tr_b16 a[226:227], v10 offset:18432
    buffer_load_dwordx4 v7, s[52:55], s14 offen offset:3072 lds
    ds_read_b128 v[164:167], v247 offset:4096
    v_mfma_f32_16x16x32_bf16 v[40:43], v[64:67], v[104:107], v[40:43]
    s_lshl2_add_u32 s4, s72, s4
    ds_read_b128 v[168:171], v247 offset:8192
    v_mfma_f32_16x16x32_bf16 v[40:43], v[68:71], v[100:103], v[40:43]
    ds_read_b64_tr_b16 a[232:233], v10 offset:20480
    ds_read_b128 v[172:175], v247 offset:12288
    v_mfma_f32_16x16x32_bf16 v[40:43], v[72:75], v[96:99], v[40:43]
    ds_read_b64_tr_b16 a[234:235], v10 offset:22528
    s_lshl_b32 s4, s4, 3
    v_mfma_f32_16x16x32_bf16 v[44:47], v[76:79], v[96:99], v[44:47]
    ds_read_b128 v[176:179], v247 offset:16384
    v_mfma_f32_16x16x32_bf16 v[44:47], v[72:75], v[100:103], v[44:47]
    ds_read_b64_tr_b16 a[228:229], v11 offset:16384
    s_lshr_b32 s5, s2, 4
    ds_read_b128 v[180:183], v247 offset:20480
    v_mfma_f32_16x16x32_bf16 v[44:47], v[68:71], v[104:107], v[44:47]
    ds_read_b64_tr_b16 a[230:231], v11 offset:18432
    v_mfma_f32_16x16x32_bf16 v[44:47], v[64:67], v[108:111], v[44:47]
    s_and_b32 s5, s5, 6
    ds_read_b128 v[184:187], v247 offset:24576
    s_waitcnt lgkmcnt(13)
    v_mfma_f32_16x16x32_bf16 v[48:51], v[64:67], v[112:115], v[48:51]
    ds_read_b64_tr_b16 a[236:237], v11 offset:20480
    ds_read_b128 v[188:191], v247 offset:28672
    v_mfma_f32_16x16x32_bf16 v[48:51], v[68:71], v[108:111], v[48:51]
    ds_read_b64_tr_b16 a[238:239], v11 offset:22528
    s_add_u32 s4, s4, s5
    v_mfma_f32_16x16x32_bf16 v[48:51], v[72:75], v[104:107], v[48:51]
    ds_read2_b32 v[128:129], v236 offset0:112 offset1:113
    v_mfma_f32_16x16x32_bf16 v[48:51], v[76:79], v[100:103], v[48:51]
    s_and_b32 s5, s2, 1
    ds_read2_b32 v[130:131], v236 offset0:114 offset1:115
    v_mfma_f32_16x16x32_bf16 v[48:51], v[80:83], v[96:99], v[48:51]
    ds_read2_b32 v[132:133], v236 offset0:240 offset1:241
    v_mfma_f32_16x16x32_bf16 v[52:55], v[84:87], v[96:99], v[52:55]
    s_add_u32 s4, s4, s5
    ds_read2_b32 v[134:135], v236 offset0:242 offset1:243
    v_mfma_f32_16x16x32_bf16 v[52:55], v[80:83], v[100:103], v[52:55]
    ds_read2_b32 v[136:137], v237 offset0:112 offset1:113
    v_mfma_f32_16x16x32_bf16 v[52:55], v[76:79], v[104:107], v[52:55]
    s_lshl_b32 s4, s4, 7
    ds_read2_b32 v[138:139], v237 offset0:114 offset1:115
    s_add_u32 s6, s12, 4767744
    v_mfma_f32_16x16x32_bf16 v[52:55], v[72:75], v[108:111], v[52:55]
    s_waitcnt lgkmcnt(6)
    s_barrier
    ds_read2_b32 v[140:141], v237 offset0:240 offset1:241
    s_add_u32 s4, s4, 12566528
    v_mfma_f32_16x16x32_bf16 v[52:55], v[68:71], v[112:115], v[52:55]
    ds_read2_b32 v[142:143], v237 offset0:242 offset1:243
    v_mfma_f32_16x16x32_bf16 v[52:55], v[64:67], v[116:119], v[52:55]
    ds_read2_b32 v[144:145], v238 offset0:112 offset1:113
    v_lshl_add_u32 v28, v2, 2, s4
    v_mfma_f32_16x16x32_bf16 v[56:59], v[64:67], v[120:123], v[56:59]
    s_lshl_b32 s14, s101, 18
    ds_read2_b32 v[146:147], v238 offset0:114 offset1:115
    v_mfma_f32_16x16x32_bf16 v[56:59], v[68:71], v[116:119], v[56:59]
    s_add_u32 m0, s73, 16384
    s_cmp_eq_u32 s3, 0
    s_cselect_b32 s4, 18, 0
    v_mfma_f32_16x16x32_bf16 v[56:59], v[72:75], v[112:115], v[56:59]
    buffer_load_dwordx4 v4, s[52:55], s14 offen offset:0 lds
    ds_read2_b32 v[148:149], v238 offset0:240 offset1:241
    v_mfma_f32_16x16x32_bf16 v[56:59], v[76:79], v[108:111], v[56:59]
    ds_read2_b32 v[150:151], v238 offset0:242 offset1:243
    v_cmp_gt_u32 vcc, s4, v2
    v_mfma_f32_16x16x32_bf16 v[56:59], v[80:83], v[104:107], v[56:59]
    ds_read2_b32 v[152:153], v239 offset0:112 offset1:113
    v_mfma_f32_16x16x32_bf16 v[56:59], v[84:87], v[100:103], v[56:59]
    ds_read2_b32 v[154:155], v239 offset0:114 offset1:115
    v_mov_b32 v13, 0x40000000
    v_mfma_f32_16x16x32_bf16 v[56:59], v[88:91], v[96:99], v[56:59]
    ds_read2_b32 v[156:157], v239 offset0:240 offset1:241
    v_mfma_f32_16x16x32_bf16 v[60:63], v[92:95], v[96:99], v[60:63]
    ds_read2_b32 v[158:159], v239 offset0:242 offset1:243
    v_cndmask_b32 v28, v13, v28, vcc
    v_mfma_f32_16x16x32_bf16 v[60:63], v[88:91], v[100:103], v[60:63]
    s_add_u32 m0, s73, 16384
    v_mfma_f32_16x16x32_bf16 v[60:63], v[84:87], v[104:107], v[60:63]
    buffer_load_dwordx4 v5, s[52:55], s14 offen offset:1024 lds
    v_mov_b32 v13, s68
    v_mfma_f32_16x16x32_bf16 v[60:63], v[80:83], v[108:111], v[60:63]
    v_mfma_f32_16x16x32_bf16 v[60:63], v[76:79], v[112:115], v[60:63]
    v_cndmask_b32 v13, 0, v13, vcc
    v_mfma_f32_16x16x32_bf16 v[60:63], v[72:75], v[116:119], v[60:63]
    v_mfma_f32_16x16x32_bf16 v[60:63], v[68:71], v[120:123], v[60:63]
    v_mfma_f32_16x16x32_bf16 v[60:63], v[64:67], v[124:127], v[60:63]
    s_waitcnt lgkmcnt(0)
    v_mfma_f32_16x16x32_bf16 v[60:63], v[128:131], v[188:191], v[60:63]
    v_mfma_f32_16x16x32_bf16 v[60:63], v[132:135], v[184:187], v[60:63]
    s_add_u32 m0, s73, 16384
    v_mfma_f32_16x16x32_bf16 v[60:63], v[136:139], v[180:183], v[60:63]
    buffer_load_dwordx4 v6, s[52:55], s14 offen offset:2048 lds
    v_mfma_f32_16x16x32_bf16 v[60:63], v[140:143], v[176:179], v[60:63]
    v_mfma_f32_16x16x32_bf16 v[60:63], v[144:147], v[172:175], v[60:63]
    v_mfma_f32_16x16x32_bf16 v[60:63], v[148:151], v[168:171], v[60:63]
    v_mfma_f32_16x16x32_bf16 v[60:63], v[152:155], v[164:167], v[60:63]
L_pl_X_6:
    s_cbranch_execz L_wret
    v_mfma_f32_16x16x32_bf16 v[60:63], v[156:159], v[160:163], v[60:63]
    s_waitcnt vmcnt(7)
    s_barrier
    v_mfma_f32_16x16x32_bf16 v[56:59], v[128:131], v[184:187], v[56:59]
    v_add_u32 v10, 131072, v10
    s_add_u32 m0, s73, 16384
    v_mfma_f32_16x16x32_bf16 v[56:59], v[132:135], v[180:183], v[56:59]
    ds_read_b64_tr_b16 a[240:241], v10 offset:16384
    buffer_load_dwordx4 v7, s[52:55], s14 offen offset:3072 lds
    v_mfma_f32_16x16x32_bf16 v[56:59], v[136:139], v[176:179], v[56:59]
    ds_read_b64_tr_b16 a[242:243], v10 offset:18432
    v_mfma_f32_16x16x32_bf16 v[56:59], v[140:143], v[172:175], v[56:59]
    ds_read_b64_tr_b16 a[248:249], v10 offset:20480
    v_mfma_f32_16x16x32_bf16 v[56:59], v[144:147], v[168:171], v[56:59]
    v_mfma_f32_16x16x32_bf16 v[56:59], v[148:151], v[164:167], v[56:59]
    ds_read_b64_tr_b16 a[250:251], v10 offset:22528
    v_cvt_pk_bf16_f32 v206, v60, v61
    v_mfma_f32_16x16x32_bf16 v[56:59], v[152:155], v[160:163], v[56:59]
    v_add_u32 v11, 131072, v11
    v_mfma_f32_16x16x32_bf16 v[52:55], v[128:131], v[180:183], v[52:55]
    ds_read_b64_tr_b16 a[244:245], v11 offset:16384
    v_mfma_f32_16x16x32_bf16 v[52:55], v[132:135], v[176:179], v[52:55]
    ds_read_b64_tr_b16 a[246:247], v11 offset:18432
    v_cvt_pk_bf16_f32 v207, v62, v63
    v_mfma_f32_16x16x32_bf16 v[52:55], v[136:139], v[172:175], v[52:55]
    ds_read_b64_tr_b16 a[252:253], v11 offset:20480
    v_mfma_f32_16x16x32_bf16 v[52:55], v[140:143], v[168:171], v[52:55]
    buffer_store_dwordx2 v[206:207], v8, s[44:47], s6 offen offset:3584 sc1
    ds_read_b64_tr_b16 a[254:255], v11 offset:22528
    v_mfma_f32_16x16x32_bf16 v[52:55], v[144:147], v[164:167], v[52:55]
    v_mfma_f32_16x16x32_bf16 v[52:55], v[148:151], v[160:163], v[52:55]
    v_mfma_f32_16x16x32_bf16 v[48:51], v[128:131], v[176:179], v[48:51]
    v_cvt_pk_bf16_f32 v204, v56, v57
    v_mfma_f32_16x16x32_bf16 v[48:51], v[132:135], v[172:175], v[48:51]
    v_mfma_f32_16x16x32_bf16 v[48:51], v[136:139], v[168:171], v[48:51]
    v_mfma_f32_16x16x32_bf16 v[48:51], v[140:143], v[164:167], v[48:51]
    v_cvt_pk_bf16_f32 v205, v58, v59
    v_mfma_f32_16x16x32_bf16 v[48:51], v[144:147], v[160:163], v[48:51]
    v_mfma_f32_16x16x32_bf16 v[44:47], v[128:131], v[172:175], v[44:47]
    buffer_store_dwordx2 v[204:205], v8, s[44:47], s6 offen offset:3072 sc1
    v_mfma_f32_16x16x32_bf16 v[44:47], v[132:135], v[168:171], v[44:47]
    v_mfma_f32_16x16x32_bf16 v[44:47], v[136:139], v[164:167], v[44:47]
    v_mfma_f32_16x16x32_bf16 v[44:47], v[140:143], v[160:163], v[44:47]
    v_cvt_pk_bf16_f32 v202, v52, v53
    v_mfma_f32_16x16x32_bf16 v[40:43], v[128:131], v[168:171], v[40:43]
    v_mfma_f32_16x16x32_bf16 v[40:43], v[132:135], v[164:167], v[40:43]
    v_mfma_f32_16x16x32_bf16 v[40:43], v[136:139], v[160:163], v[40:43]
    v_cvt_pk_bf16_f32 v203, v54, v55
    v_mfma_f32_16x16x32_bf16 v[36:39], v[128:131], v[164:167], v[36:39]
    v_mfma_f32_16x16x32_bf16 v[36:39], v[132:135], v[160:163], v[36:39]
    buffer_store_dwordx2 v[202:203], v8, s[44:47], s6 offen offset:2560 sc1
    v_mfma_f32_16x16x32_bf16 v[32:35], v[128:131], v[160:163], v[32:35]
    v_mov_b32 v29, 0
    buffer_atomic_add v29, v28, s[44:47], 0 offen sc0 sc1
    v_cvt_pk_bf16_f32 v200, v48, v49
    v_cvt_pk_bf16_f32 v201, v50, v51
    buffer_store_dwordx2 v[200:201], v8, s[44:47], s6 offen offset:2048 sc1
    v_cvt_pk_bf16_f32 v198, v44, v45
    v_cvt_pk_bf16_f32 v199, v46, v47
    buffer_store_dwordx2 v[198:199], v8, s[44:47], s6 offen offset:1536 sc1
    v_cvt_pk_bf16_f32 v196, v40, v41
    v_cvt_pk_bf16_f32 v197, v42, v43
    buffer_store_dwordx2 v[196:197], v8, s[44:47], s6 offen offset:1024 sc1
    v_cvt_pk_bf16_f32 v194, v36, v37
    v_cvt_pk_bf16_f32 v195, v38, v39
    buffer_store_dwordx2 v[194:195], v8, s[44:47], s6 offen offset:512 sc1
    v_cvt_pk_bf16_f32 v192, v32, v33
    v_cvt_pk_bf16_f32 v193, v34, v35
    buffer_store_dwordx2 v[192:193], v8, s[44:47], s6 offen offset:0 sc1
    v_add_u32 v10, -131072, v10
    v_add_u32 v11, -131072, v11
    s_waitcnt lgkmcnt(0)
    s_barrier
L_DX:
    s_waitcnt vmcnt(0)
    v_cmp_ne_u32 vcc, v13, v29
    s_cbranch_vccnz L_rs_p2X
L_ok_p2X:
    s_barrier
    s_add_u32 m0, s73, 97536
    s_nop 0
    buffer_load_dwordx4 v23, s[44:47], s18 offen offset:768 sc1 lds
    s_add_u32 m0, s73, 99328
    s_nop 0
    buffer_load_dwordx4 v20, s[44:47], s18 offen offset:0 sc1 lds
    s_add_u32 m0, s73, 99840
    s_nop 0
    buffer_load_dwordx4 v20, s[44:47], s18 offen offset:512 sc1 lds
    s_add_u32 m0, s73, 100608
    s_nop 0
    buffer_load_dwordx4 v23, s[44:47], s19 offen offset:768 sc1 lds
    s_add_u32 m0, s73, 114688
    s_nop 0
    buffer_load_dwordx4 v20, s[44:47], s19 offen offset:0 sc1 lds
    s_add_u32 m0, s73, 115200
    s_nop 0
    buffer_load_dwordx4 v20, s[44:47], s19 offen offset:512 sc1 lds
    s_add_u32 m0, s73, 115968
    s_nop 0
    buffer_load_dwordx4 v23, s[44:47], s20 offen offset:768 sc1 lds
    s_add_u32 m0, s73, 117760
    s_nop 0
    buffer_load_dwordx4 v20, s[44:47], s20 offen offset:0 sc1 lds
    s_add_u32 m0, s73, 130560
    s_nop 0
    buffer_load_dwordx4 v20, s[44:47], s20 offen offset:512 sc1 lds
    s_add_u32 m0, s73, 131328
    s_nop 0
    buffer_load_dwordx4 v23, s[44:47], s21 offen offset:768 sc1 lds
    s_mov_b32 s56, s16
    s_and_b32 s57, s17, 0xffff
    s_mov_b32 s58, 2359296
    s_mov_b32 s59, 0x20000
    s_mov_b32 s40, 18432
    s_mov_b32 s42, 12386304
    s_mov_b32 s64, s38
    s_and_b32 s65, s39, 0xffff
    s_mov_b32 s66, 2359296
    s_mov_b32 s67, 0x20000
    v_lshlrev_b32 v136, 4, v2
    s_mul_i32 s7, s72, 36
    s_bitcmp1_b32 s3, 0
    s_addc_u32 s7, s7, 0
    s_lshl_b32 s7, s7, 17
    v_subrev_u32 v184, s7, v4
    v_subrev_u32 v185, s7, v5
    s_bfe_u32 s4, s2, 0x20003
    s_mul_i32 s4, s4, 9
    s_lshl1_add_u32 s7, s72, s4
    s_and_b32 s8, s3, 1
    s_add_u32 s7, s7, s8
    s_bfe_u32 s8, s2, 65539
    s_add_u32 s7, s7, s8
    s_lshl_b32 s8, s8, 3
    s_sub_u32 s4, s4, s8
    s_lshl_b32 s37, s7, 16
    s_add_u32 s37, s37, 4718592
    s_add_u32 s4, s4, 8
    s_lshl_b32 s16, s4, 16
    s_add_u32 s16, s16, 4718592
    s_sub_u32 s4, s4, s7
    s_lshl_b32 s4, s4, 7
    s_lshl_b32 s7, s7, 7
    s_add_u32 s7, s7, 12582912
    v_bfe_u32 v24, v2, 2, 1
    v_mul_i32_i24 v24, s4, v24
    v_and_b32 v25, 3, v2
    v_lshl_add_u32 v24, v25, 2, v24
    v_add_u32 v188, s7, v24
    s_lshl2_add_u32 s7, s2, s3
    s_mul_i32 s8, s7, 3072
    s_add_u32 s34, s8, 22953984
    s_add_u32 s11, s8, 26099712
    s_add_u32 s12, s8, 29245440
    s_lshl_b32 s35, s7, 12
    s_add_u32 s35, s35, 32391168
    s_xor_b32 s8, s7, 8
    s_mul_i32 s8, s8, 3072
    s_add_u32 s30, s8, 22953984
    s_xor_b32 s8, s7, 16
    s_mul_i32 s8, s8, 3072
    s_add_u32 s15, s8, 26099712
    s_xor_b32 s8, s7, 24
    s_mul_i32 s8, s8, 3072
    s_add_u32 s31, s8, 29245440
    s_andn2_b32 s7, s7, 24
    s_lshl3_add_u32 s7, s3, s7
    s_lshl2_add_u32 s8, s7, s72
    s_lshl_b32 s8, s8, 10
    s_add_u32 s32, s8, 32391168
    s_xor_b32 s8, s8, 4096
    s_add_u32 s33, s8, 32391168
    s_xor_b32 s8, s3, s72
    s_cmp_lt_u32 s8, 2
    s_cselect_b32 s35, s35, 0x40000000
    s_cselect_b32 s16, s16, 0x40000000
    s_cselect_b32 s36, s68, 0
    s_mov_b32 s38, 0xbfb8aa3b
    s_and_b32 s8, s8, 1
    s_mul_i32 s41, s8, 96
    s_and_b32 s43, s73, 4096
    v_lshlrev_b32 v24, 10, v2
    v_add_u32 v24, s35, v24
    s_add_u32 s7, s34, 2048
    v_mov_b32 v25, s36
    v_cmp_gt_u32 vcc, 4, v2
    s_nop 1
    v_cndmask_b32 v138, 0, v25, vcc
    v_mov_b32 v25, 0x40000000
    v_cndmask_b32 v137, v25, v24, vcc
    v_writelane_b32 v137, s7, 4
    v_writelane_b32 v138, s68, 4
    v_min_u32 v139, 1, v2
    v_lshlrev_b32 v139, 30, v139
    v_mov_b32 v140, 0
    v_writelane_b32 v140, s68, 0
    v_mov_b32 v195, s68
    v_mov_b32 v199, s68
    v_mov_b32 v202, s68
    v_mov_b32 v203, s68
    s_waitcnt vmcnt(6)
    s_barrier
    ds_read_b128 v[104:107], v14 offset:0
    ds_read_b128 v[108:111], v14 offset:4096
    ds_read_b128 v[112:115], v14 offset:8192
    ds_read_b128 v[116:119], v14 offset:12288
    s_waitcnt lgkmcnt(2)
    v_mfma_f32_16x16x32_bf16 v[32:35], v[104:107], a[0:3], 0
    s_add_u32 m0, s73, 133120
    s_sub_u32 s4, s75, 216
    s_lshl_b32 s7, s4, 7
    v_mfma_f32_16x16x32_bf16 v[32:35], v[108:111], a[8:11], v[32:35]
    buffer_load_dwordx4 v20, s[44:47], s21 offen offset:0 sc1 lds
    s_waitcnt lgkmcnt(0)
    v_mfma_f32_16x16x32_bf16 v[32:35], v[112:115], a[16:19], v[32:35]
    ds_read_b128 v[120:123], v14 offset:1024
    s_lshl2_add_u32 s7, s3, s7
    s_add_u32 s7, s7, 12582912
    v_mfma_f32_16x16x32_bf16 v[32:35], v[116:119], a[24:27], v[32:35]
    ds_read_b128 v[124:127], v14 offset:5120
    v_mfma_f32_16x16x32_bf16 v[36:39], v[116:119], a[28:31], 0
    ds_read_b128 v[128:131], v14 offset:9216
    s_cmp_lt_u32 s4, 36
    s_cselect_b32 s7, s7, 0x40000000
    v_mfma_f32_16x16x32_bf16 v[36:39], v[112:115], a[20:23], v[36:39]
    ds_read_b128 v[132:135], v14 offset:13312
    v_min_u32 v28, 1, v2
    v_mfma_f32_16x16x32_bf16 v[36:39], v[108:111], a[12:15], v[36:39]
    s_add_u32 m0, s73, 133632
    v_lshlrev_b32 v28, 30, v28
    v_mov_b32 v29, s68
    v_mfma_f32_16x16x32_bf16 v[36:39], v[104:107], a[4:7], v[36:39]
    buffer_load_dwordx4 v20, s[44:47], s21 offen offset:512 sc1 lds
    s_waitcnt lgkmcnt(2)
    v_mfma_f32_16x16x32_bf16 v[44:47], v[120:123], a[4:7], 0
    buffer_store_dword v29, v28, s[44:47], s7 offen sc1
    s_add_u32 m0, s73, 146688
    v_mfma_f32_16x16x32_bf16 v[44:47], v[124:127], a[12:15], v[44:47]
    buffer_load_dwordx4 v23, s[44:47], s22 offen offset:768 sc1 lds
    s_waitcnt lgkmcnt(0)
    v_mfma_f32_16x16x32_bf16 v[44:47], v[128:131], a[20:23], v[44:47]
    ds_read_b128 v[104:107], v14 offset:2048
    v_mfma_f32_16x16x32_bf16 v[44:47], v[132:135], a[28:31], v[44:47]
    ds_read_b128 v[108:111], v14 offset:6144
    v_mfma_f32_16x16x32_bf16 v[40:43], v[132:135], a[24:27], 0
    ds_read_b128 v[112:115], v14 offset:10240
    v_mfma_f32_16x16x32_bf16 v[40:43], v[128:131], a[16:19], v[40:43]
    ds_read_b128 v[116:119], v14 offset:14336
    v_mfma_f32_16x16x32_bf16 v[40:43], v[124:127], a[8:11], v[40:43]
    s_add_u32 m0, s73, 148480
    v_mfma_f32_16x16x32_bf16 v[40:43], v[120:123], a[0:3], v[40:43]
    buffer_load_dwordx4 v20, s[44:47], s22 offen offset:0 sc1 lds
    s_waitcnt lgkmcnt(2)
    v_mfma_f32_16x16x32_bf16 v[48:51], v[104:107], a[0:3], 0
    s_add_u32 m0, s73, 148992
    v_mfma_f32_16x16x32_bf16 v[48:51], v[108:111], a[8:11], v[48:51]
    buffer_load_dwordx4 v20, s[44:47], s22 offen offset:512 sc1 lds
    s_waitcnt lgkmcnt(0)
    v_mfma_f32_16x16x32_bf16 v[48:51], v[112:115], a[16:19], v[48:51]
    ds_read_b128 v[120:123], v14 offset:3072
    v_mfma_f32_16x16x32_bf16 v[48:51], v[116:119], a[24:27], v[48:51]
    ds_read_b128 v[124:127], v14 offset:7168
    v_mfma_f32_16x16x32_bf16 v[52:55], v[116:119], a[28:31], 0
    ds_read_b128 v[128:131], v14 offset:11264
    v_mfma_f32_16x16x32_bf16 v[52:55], v[112:115], a[20:23], v[52:55]
    ds_read_b128 v[132:135], v14 offset:15360
    v_mfma_f32_16x16x32_bf16 v[52:55], v[108:111], a[12:15], v[52:55]
    s_add_u32 m0, s73, 149760
    v_mfma_f32_16x16x32_bf16 v[52:55], v[104:107], a[4:7], v[52:55]
    buffer_load_dwordx4 v23, s[44:47], s23 offen offset:768 sc1 lds
    s_waitcnt lgkmcnt(2)
    v_mfma_f32_16x16x32_bf16 v[36:39], v[120:123], a[36:39], v[36:39]
    v_mfma_f32_16x16x32_bf16 v[36:39], v[124:127], a[44:47], v[36:39]
    s_waitcnt lgkmcnt(0)
    v_mfma_f32_16x16x32_bf16 v[36:39], v[128:131], a[52:55], v[36:39]
    s_waitcnt vmcnt(9)
    s_barrier
    v_mfma_f32_16x16x32_bf16 v[36:39], v[132:135], a[60:63], v[36:39]
    ds_read_b128 v[104:107], v14 offset:16384
    v_mfma_f32_16x16x32_bf16 v[32:35], v[132:135], a[56:59], v[32:35]
    ds_read_b128 v[108:111], v14 offset:20480
    v_mfma_f32_16x16x32_bf16 v[32:35], v[128:131], a[48:51], v[32:35]
    ds_read_b128 v[112:115], v14 offset:24576
    v_mfma_f32_16x16x32_bf16 v[32:35], v[124:127], a[40:43], v[32:35]
    ds_read_b128 v[116:119], v14 offset:28672
    v_mfma_f32_16x16x32_bf16 v[32:35], v[120:123], a[32:35], v[32:35]
    ds_read_b64_tr_b16 v[220:221], v10 offset:0
    s_waitcnt lgkmcnt(3)
    v_mfma_f32_16x16x32_bf16 v[40:43], v[104:107], a[32:35], v[40:43]
    s_add_u32 m0, s73, 98304
    ds_read_b64_tr_b16 v[222:223], v10 offset:2048
    v_mfma_f32_16x16x32_bf16 v[40:43], v[108:111], a[40:43], v[40:43]
    buffer_load_dwordx4 v20, s[44:47], s23 offen offset:0 sc1 lds
    s_waitcnt lgkmcnt(2)
    v_mfma_f32_16x16x32_bf16 v[40:43], v[112:115], a[48:51], v[40:43]
    ds_read_b128 v[120:123], v14 offset:17408
    v_mfma_f32_16x16x32_bf16 v[40:43], v[116:119], a[56:59], v[40:43]
    ds_read_b128 v[124:127], v14 offset:21504
    v_mfma_f32_16x16x32_bf16 v[44:47], v[116:119], a[60:63], v[44:47]
    ds_read_b128 v[128:131], v14 offset:25600
    v_mfma_f32_16x16x32_bf16 v[44:47], v[112:115], a[52:55], v[44:47]
    ds_read_b128 v[132:135], v14 offset:29696
    v_mfma_f32_16x16x32_bf16 v[44:47], v[108:111], a[44:47], v[44:47]
    s_add_u32 m0, s73, 98816
    ds_read_b64_tr_b16 v[228:229], v10 offset:4096
    v_mfma_f32_16x16x32_bf16 v[44:47], v[104:107], a[36:39], v[44:47]
    buffer_load_dwordx4 v20, s[44:47], s23 offen offset:512 sc1 lds
    s_waitcnt lgkmcnt(3)
    v_mfma_f32_16x16x32_bf16 v[52:55], v[120:123], a[36:39], v[52:55]
    s_add_u32 m0, s73, 99584
    ds_read_b64_tr_b16 v[230:231], v10 offset:6144
    v_mfma_f32_16x16x32_bf16 v[52:55], v[124:127], a[44:47], v[52:55]
    buffer_load_dwordx4 v23, s[44:47], s24 offen offset:768 sc1 lds
    s_waitcnt lgkmcnt(2)
    v_mfma_f32_16x16x32_bf16 v[52:55], v[128:131], a[52:55], v[52:55]
    ds_read_b128 v[104:107], v14 offset:18432
    v_mfma_f32_16x16x32_bf16 v[52:55], v[132:135], a[60:63], v[52:55]
    ds_read_b128 v[108:111], v14 offset:22528
    v_mfma_f32_16x16x32_bf16 v[48:51], v[132:135], a[56:59], v[48:51]
    ds_read_b128 v[112:115], v14 offset:26624
    v_mfma_f32_16x16x32_bf16 v[48:51], v[128:131], a[48:51], v[48:51]
    ds_read_b128 v[116:119], v14 offset:30720
    v_mfma_f32_16x16x32_bf16 v[48:51], v[124:127], a[40:43], v[48:51]
    s_add_u32 m0, s73, 101376
    ds_read_b64_tr_b16 v[224:225], v11 offset:0
    v_mfma_f32_16x16x32_bf16 v[48:51], v[120:123], a[32:35], v[48:51]
    buffer_load_dwordx4 v20, s[44:47], s24 offen offset:0 sc1 lds
    s_waitcnt lgkmcnt(3)
    v_mfma_f32_16x16x32_bf16 v[32:35], v[104:107], a[64:67], v[32:35]
    ds_read_b64_tr_b16 v[226:227], v11 offset:2048
    v_mfma_f32_16x16x32_bf16 v[32:35], v[108:111], a[72:75], v[32:35]
    s_waitcnt lgkmcnt(2)
    v_mfma_f32_16x16x32_bf16 v[32:35], v[112:115], a[80:83], v[32:35]
    ds_read_b128 v[120:123], v14 offset:19456
    v_mfma_f32_16x16x32_bf16 v[32:35], v[116:119], a[88:91], v[32:35]
    ds_read_b128 v[124:127], v14 offset:23552
    v_mfma_f32_16x16x32_bf16 v[36:39], v[116:119], a[92:95], v[36:39]
    ds_read_b128 v[128:131], v14 offset:27648
    v_mfma_f32_16x16x32_bf16 v[36:39], v[112:115], a[84:87], v[36:39]
    ds_read_b128 v[132:135], v14 offset:31744
    v_mfma_f32_16x16x32_bf16 v[36:39], v[108:111], a[76:79], v[36:39]
    ds_read_b64_tr_b16 v[232:233], v11 offset:4096
    v_mfma_f32_16x16x32_bf16 v[36:39], v[104:107], a[68:71], v[36:39]
    s_waitcnt lgkmcnt(3)
    v_mfma_f32_16x16x32_bf16 v[44:47], v[120:123], a[68:71], v[44:47]
    ds_read_b64_tr_b16 v[234:235], v11 offset:6144
    v_mfma_f32_16x16x32_bf16 v[44:47], v[124:127], a[76:79], v[44:47]
    s_waitcnt lgkmcnt(2)
    v_mfma_f32_16x16x32_bf16 v[44:47], v[128:131], a[84:87], v[44:47]
    s_waitcnt vmcnt(9) lgkmcnt(0)
    s_barrier
    v_mfma_f32_16x16x32_bf16 v[44:47], v[132:135], a[92:95], v[44:47]
    ds_read_b128 v[104:107], v14 offset:32768
    v_mfma_f32_16x16x32_bf16 v[40:43], v[132:135], a[88:91], v[40:43]
    ds_read_b128 v[108:111], v14 offset:36864
    v_mfma_f32_16x16x32_bf16 v[40:43], v[128:131], a[80:83], v[40:43]
    ds_read_b128 v[112:115], v14 offset:40960
    v_mfma_f32_16x16x32_bf16 v[40:43], v[124:127], a[72:75], v[40:43]
    ds_read_b128 v[116:119], v14 offset:45056
    v_mfma_f32_16x16x32_bf16 v[40:43], v[120:123], a[64:67], v[40:43]
    ds_read_b64_tr_b16 v[236:237], v10 offset:16384
    s_waitcnt lgkmcnt(3)
    v_mfma_f32_16x16x32_bf16 v[48:51], v[104:107], a[64:67], v[48:51]
    s_add_u32 m0, s73, 114176
    ds_read_b64_tr_b16 v[238:239], v10 offset:18432
    v_mfma_f32_16x16x32_bf16 v[48:51], v[108:111], a[72:75], v[48:51]
    buffer_load_dwordx4 v20, s[44:47], s24 offen offset:512 sc1 lds
    s_waitcnt lgkmcnt(2)
    v_mfma_f32_16x16x32_bf16 v[48:51], v[112:115], a[80:83], v[48:51]
    ds_read_b128 v[120:123], v14 offset:33792
    v_mfma_f32_16x16x32_bf16 v[48:51], v[116:119], a[88:91], v[48:51]
    ds_read_b128 v[124:127], v14 offset:37888
    v_lshrrev_b32 v30, 2, v26
    v_mfma_f32_16x16x32_bf16 v[52:55], v[116:119], a[92:95], v[52:55]
    ds_read_b128 v[128:131], v14 offset:41984
    v_mfma_f32_16x16x32_bf16 v[52:55], v[112:115], a[84:87], v[52:55]
    ds_read_b128 v[132:135], v14 offset:46080
    v_mfma_f32_16x16x32_bf16 v[52:55], v[108:111], a[76:79], v[52:55]
    s_add_u32 m0, s73, 114944
    ds_read_b64_tr_b16 v[244:245], v10 offset:20480
    v_mfma_f32_16x16x32_bf16 v[52:55], v[104:107], a[68:71], v[52:55]
    buffer_load_dwordx4 v23, s[44:47], s25 offen offset:768 sc1 lds
    s_waitcnt lgkmcnt(3)
    v_mfma_f32_16x16x32_bf16 v[36:39], v[120:123], a[100:103], v[36:39]
    s_add_u32 m0, s73, 116736
    ds_read_b64_tr_b16 v[246:247], v10 offset:22528
    v_mfma_f32_16x16x32_bf16 v[36:39], v[124:127], a[108:111], v[36:39]
    buffer_load_dwordx4 v20, s[44:47], s25 offen offset:0 sc1 lds
    s_waitcnt lgkmcnt(2)
    v_mfma_f32_16x16x32_bf16 v[36:39], v[128:131], a[116:119], v[36:39]
    ds_read_b128 v[104:107], v14 offset:34816
    v_lshrrev_b32 v31, 2, v18
    v_mfma_f32_16x16x32_bf16 v[36:39], v[132:135], a[124:127], v[36:39]
    ds_read_b128 v[108:111], v14 offset:38912
    v_mfma_f32_16x16x32_bf16 v[32:35], v[132:135], a[120:123], v[32:35]
    ds_read_b128 v[112:115], v14 offset:43008
    v_mfma_f32_16x16x32_bf16 v[32:35], v[128:131], a[112:115], v[32:35]
    ds_read_b128 v[116:119], v14 offset:47104
    v_mfma_f32_16x16x32_bf16 v[32:35], v[124:127], a[104:107], v[32:35]
    s_add_u32 m0, s73, 117248
    ds_read_b64_tr_b16 v[240:241], v11 offset:16384
    v_mfma_f32_16x16x32_bf16 v[32:35], v[120:123], a[96:99], v[32:35]
    buffer_load_dwordx4 v20, s[44:47], s25 offen offset:512 sc1 lds
    s_waitcnt lgkmcnt(3)
    v_mfma_f32_16x16x32_bf16 v[40:43], v[104:107], a[96:99], v[40:43]
    ds_read_b64_tr_b16 v[242:243], v11 offset:18432
    buffer_load_ushort v102, v30, s[60:63], 0 offen offset:0
    v_mfma_f32_16x16x32_bf16 v[40:43], v[108:111], a[104:107], v[40:43]
    s_waitcnt lgkmcnt(2)
    v_mfma_f32_16x16x32_bf16 v[40:43], v[112:115], a[112:115], v[40:43]
    ds_read_b128 v[120:123], v14 offset:35840
    v_mfma_f32_16x16x32_bf16 v[40:43], v[116:119], a[120:123], v[40:43]
    ds_read_b128 v[124:127], v14 offset:39936
    v_mfma_f32_16x16x32_bf16 v[44:47], v[116:119], a[124:127], v[44:47]
    ds_read_b128 v[128:131], v14 offset:44032
    v_mfma_f32_16x16x32_bf16 v[44:47], v[112:115], a[116:119], v[44:47]
    ds_read_b128 v[132:135], v14 offset:48128
    v_mfma_f32_16x16x32_bf16 v[44:47], v[108:111], a[108:111], v[44:47]
    ds_read_b64_tr_b16 v[248:249], v11 offset:20480
    buffer_load_ushort v103, v30, s[60:63], 0 offen offset:32
    v_mfma_f32_16x16x32_bf16 v[44:47], v[104:107], a[100:103], v[44:47]
    s_waitcnt lgkmcnt(3)
    v_mfma_f32_16x16x32_bf16 v[52:55], v[120:123], a[100:103], v[52:55]
    ds_read_b64_tr_b16 v[250:251], v11 offset:22528
    v_mfma_f32_16x16x32_bf16 v[52:55], v[124:127], a[108:111], v[52:55]
    s_waitcnt lgkmcnt(2)
    v_mfma_f32_16x16x32_bf16 v[52:55], v[128:131], a[116:119], v[52:55]
    s_waitcnt vmcnt(10) lgkmcnt(0)
    s_barrier
    v_mfma_f32_16x16x32_bf16 v[52:55], v[132:135], a[124:127], v[52:55]
    ds_read_b128 v[104:107], v14 offset:49152
    v_mfma_f32_16x16x32_bf16 v[48:51], v[132:135], a[120:123], v[48:51]
    ds_read_b128 v[108:111], v14 offset:53248
    buffer_load_ushort v27, v31, s[60:63], 0 offen offset:0
    v_mfma_f32_16x16x32_bf16 v[48:51], v[128:131], a[112:115], v[48:51]
    ds_read_b128 v[112:115], v14 offset:57344
    v_mfma_f32_16x16x32_bf16 v[48:51], v[124:127], a[104:107], v[48:51]
    ds_read_b128 v[116:119], v14 offset:61440
    v_mfma_f32_16x16x32_bf16 v[48:51], v[120:123], a[96:99], v[48:51]
    s_waitcnt lgkmcnt(2)
    v_mfma_f32_16x16x32_bf16 v[32:35], v[104:107], a[128:131], v[32:35]
    s_add_u32 m0, s73, 130304
    v_mfma_f32_16x16x32_bf16 v[32:35], v[108:111], a[136:139], v[32:35]
    buffer_load_dwordx4 v23, s[44:47], s26 offen offset:768 sc1 lds
    s_waitcnt lgkmcnt(0)
    v_mfma_f32_16x16x32_bf16 v[32:35], v[112:115], a[144:147], v[32:35]
    ds_read_b128 v[120:123], v14 offset:50176
    v_mfma_f32_16x16x32_bf16 v[32:35], v[116:119], a[152:155], v[32:35]
    ds_read_b128 v[124:127], v14 offset:54272
    v_mfma_f32_16x16x32_bf16 v[36:39], v[116:119], a[156:159], v[36:39]
    ds_read_b128 v[128:131], v14 offset:58368
    v_mfma_f32_16x16x32_bf16 v[36:39], v[112:115], a[148:151], v[36:39]
    ds_read_b128 v[132:135], v14 offset:62464
    v_mfma_f32_16x16x32_bf16 v[36:39], v[108:111], a[140:143], v[36:39]
    s_add_u32 m0, s73, 132096
    v_mfma_f32_16x16x32_bf16 v[36:39], v[104:107], a[132:135], v[36:39]
    buffer_load_dwordx4 v20, s[44:47], s26 offen offset:0 sc1 lds
    s_waitcnt lgkmcnt(2)
    v_mfma_f32_16x16x32_bf16 v[44:47], v[120:123], a[132:135], v[44:47]
    s_add_u32 m0, s73, 132608
    v_mfma_f32_16x16x32_bf16 v[44:47], v[124:127], a[140:143], v[44:47]
    buffer_load_dwordx4 v20, s[44:47], s26 offen offset:512 sc1 lds
    s_waitcnt lgkmcnt(0)
    v_mfma_f32_16x16x32_bf16 v[44:47], v[128:131], a[148:151], v[44:47]
    ds_read_b128 v[104:107], v14 offset:51200
    v_mfma_f32_16x16x32_bf16 v[44:47], v[132:135], a[156:159], v[44:47]
    ds_read_b128 v[108:111], v14 offset:55296
    v_mfma_f32_16x16x32_bf16 v[40:43], v[132:135], a[152:155], v[40:43]
    ds_read_b128 v[112:115], v14 offset:59392
    v_mfma_f32_16x16x32_bf16 v[40:43], v[128:131], a[144:147], v[40:43]
    ds_read_b128 v[116:119], v14 offset:63488
    v_mfma_f32_16x16x32_bf16 v[40:43], v[124:127], a[136:139], v[40:43]
    s_add_u32 m0, s73, 134144
    v_mfma_f32_16x16x32_bf16 v[40:43], v[120:123], a[128:131], v[40:43]
    buffer_load_dwordx4 v21, s[44:47], s18 offen offset:0 sc1 lds
    s_waitcnt lgkmcnt(2)
    v_mfma_f32_16x16x32_bf16 v[48:51], v[104:107], a[128:131], v[48:51]
    v_mfma_f32_16x16x32_bf16 v[48:51], v[108:111], a[136:139], v[48:51]
    s_waitcnt lgkmcnt(0)
    v_mfma_f32_16x16x32_bf16 v[48:51], v[112:115], a[144:147], v[48:51]
    ds_read_b128 v[120:123], v14 offset:52224
    v_mfma_f32_16x16x32_bf16 v[48:51], v[116:119], a[152:155], v[48:51]
    ds_read_b128 v[124:127], v14 offset:56320
    v_mfma_f32_16x16x32_bf16 v[52:55], v[116:119], a[156:159], v[52:55]
    ds_read_b128 v[128:131], v14 offset:60416
    v_mfma_f32_16x16x32_bf16 v[52:55], v[112:115], a[148:151], v[52:55]
    ds_read_b128 v[132:135], v14 offset:64512
    v_mfma_f32_16x16x32_bf16 v[52:55], v[108:111], a[140:143], v[52:55]
    v_mfma_f32_16x16x32_bf16 v[52:55], v[104:107], a[132:135], v[52:55]
    s_waitcnt lgkmcnt(2)
    v_mfma_f32_16x16x32_bf16 v[36:39], v[120:123], a[164:167], v[36:39]
    v_mfma_f32_16x16x32_bf16 v[36:39], v[124:127], a[172:175], v[36:39]
    s_waitcnt lgkmcnt(0)
    v_mfma_f32_16x16x32_bf16 v[36:39], v[128:131], a[180:183], v[36:39]
    s_waitcnt vmcnt(11)
    s_barrier
    v_mfma_f32_16x16x32_bf16 v[36:39], v[132:135], a[188:191], v[36:39]
    ds_read_b128 v[104:107], v14 offset:0
    v_mfma_f32_16x16x32_bf16 v[32:35], v[132:135], a[184:187], v[32:35]
    ds_read_b128 v[108:111], v14 offset:4096
    v_mfma_f32_16x16x32_bf16 v[32:35], v[128:131], a[176:179], v[32:35]
    ds_read_b128 v[112:115], v14 offset:8192
    v_mfma_f32_16x16x32_bf16 v[32:35], v[124:127], a[168:171], v[32:35]
    ds_read_b128 v[116:119], v14 offset:12288
    v_mfma_f32_16x16x32_bf16 v[32:35], v[120:123], a[160:163], v[32:35]
    s_waitcnt lgkmcnt(2)
    v_mfma_f32_16x16x32_bf16 v[40:43], v[104:107], a[160:163], v[40:43]
    s_add_u32 m0, s73, 146944
    v_mfma_f32_16x16x32_bf16 v[40:43], v[108:111], a[168:171], v[40:43]
    buffer_load_dwordx4 v21, s[44:47], s18 offen offset:512 sc1 lds
    s_waitcnt lgkmcnt(0)
    v_mfma_f32_16x16x32_bf16 v[40:43], v[112:115], a[176:179], v[40:43]
    ds_read_b128 v[120:123], v14 offset:1024
    v_mfma_f32_16x16x32_bf16 v[40:43], v[116:119], a[184:187], v[40:43]
    ds_read_b128 v[124:127], v14 offset:5120
    v_mfma_f32_16x16x32_bf16 v[44:47], v[116:119], a[188:191], v[44:47]
    ds_read_b128 v[128:131], v14 offset:9216
    v_mfma_f32_16x16x32_bf16 v[44:47], v[112:115], a[180:183], v[44:47]
    ds_read_b128 v[132:135], v14 offset:13312
    buffer_load_dwordx4 v[88:91], v252, s[56:59], 0 offen
    v_mfma_f32_16x16x32_bf16 v[44:47], v[108:111], a[172:175], v[44:47]
    s_add_u32 m0, s73, 148480
    v_mfma_f32_16x16x32_bf16 v[44:47], v[104:107], a[164:167], v[44:47]
    buffer_load_dwordx4 v21, s[44:47], s19 offen offset:0 sc1 lds
    s_waitcnt lgkmcnt(2)
    v_mfma_f32_16x16x32_bf16 v[52:55], v[120:123], a[164:167], v[52:55]
    s_add_u32 m0, s73, 148992
    v_mfma_f32_16x16x32_bf16 v[52:55], v[124:127], a[172:175], v[52:55]
    buffer_load_dwordx4 v21, s[44:47], s19 offen offset:512 sc1 lds
    s_waitcnt lgkmcnt(0)
    v_mfma_f32_16x16x32_bf16 v[52:55], v[128:131], a[180:183], v[52:55]
    ds_read_b128 v[104:107], v14 offset:2048
    v_mfma_f32_16x16x32_bf16 v[52:55], v[132:135], a[188:191], v[52:55]
    ds_read_b128 v[108:111], v14 offset:6144
    v_mfma_f32_16x16x32_bf16 v[48:51], v[132:135], a[184:187], v[48:51]
    ds_read_b128 v[112:115], v14 offset:10240
    v_mfma_f32_16x16x32_bf16 v[48:51], v[128:131], a[176:179], v[48:51]
    ds_read_b128 v[116:119], v14 offset:14336
    v_mfma_f32_16x16x32_bf16 v[48:51], v[124:127], a[168:171], v[48:51]
    s_add_u32 m0, s73, 150528
    v_mfma_f32_16x16x32_bf16 v[48:51], v[120:123], a[160:163], v[48:51]
    buffer_load_dwordx4 v21, s[44:47], s20 offen offset:0 sc1 lds
    s_waitcnt lgkmcnt(2)
    v_mfma_f32_16x16x32_bf16 v[32:35], v[104:107], a[192:195], v[32:35]
    buffer_load_dwordx4 v[92:95], v252, s[56:59], s40 offen
    v_mfma_f32_16x16x32_bf16 v[32:35], v[108:111], a[200:203], v[32:35]
    s_waitcnt vmcnt(10)
    s_waitcnt lgkmcnt(0)
    v_mfma_f32_16x16x32_bf16 v[32:35], v[112:115], a[208:211], v[32:35]
    ds_read_b128 v[120:123], v14 offset:3072
    v_mfma_f32_16x16x32_bf16 v[32:35], v[116:119], a[216:219], v[32:35]
    ds_read_b128 v[124:127], v14 offset:7168
    v_mfma_f32_16x16x32_bf16 v[36:39], v[116:119], a[220:223], v[36:39]
    ds_read_b128 v[128:131], v14 offset:11264
    v_lshlrev_b32 v72, 16, v102
    v_mfma_f32_16x16x32_bf16 v[36:39], v[112:115], a[212:215], v[36:39]
    ds_read_b128 v[132:135], v14 offset:15360
    v_mfma_f32_16x16x32_bf16 v[36:39], v[108:111], a[204:207], v[36:39]
    v_lshlrev_b32 v73, 16, v102
    v_mfma_f32_16x16x32_bf16 v[36:39], v[104:107], a[196:199], v[36:39]
    s_waitcnt lgkmcnt(2)
    v_mfma_f32_16x16x32_bf16 v[44:47], v[120:123], a[196:199], v[44:47]
    v_mfma_f32_16x16x32_bf16 v[44:47], v[124:127], a[204:207], v[44:47]
    v_lshlrev_b32 v74, 16, v102
    s_waitcnt lgkmcnt(0)
    v_mfma_f32_16x16x32_bf16 v[44:47], v[128:131], a[212:215], v[44:47]
    buffer_load_dwordx2 v[142:143], v253, s[56:59], 0 offen
    s_barrier
    v_mfma_f32_16x16x32_bf16 v[44:47], v[132:135], a[220:223], v[44:47]
    ds_read_b128 v[104:107], v14 offset:16384
    v_mfma_f32_16x16x32_bf16 v[40:43], v[132:135], a[216:219], v[40:43]
    ds_read_b128 v[108:111], v14 offset:20480
    v_lshlrev_b32 v75, 16, v102
    v_mfma_f32_16x16x32_bf16 v[40:43], v[128:131], a[208:211], v[40:43]
    ds_read_b128 v[112:115], v14 offset:24576
    v_mfma_f32_16x16x32_bf16 v[40:43], v[124:127], a[200:203], v[40:43]
    ds_read_b128 v[116:119], v14 offset:28672
    v_lshlrev_b32 v76, 16, v103
    v_mfma_f32_16x16x32_bf16 v[40:43], v[120:123], a[192:195], v[40:43]
    s_waitcnt lgkmcnt(2)
    v_mfma_f32_16x16x32_bf16 v[48:51], v[104:107], a[192:195], v[48:51]
    s_add_u32 m0, s73, 97792
    v_lshlrev_b32 v77, 16, v103
    v_mfma_f32_16x16x32_bf16 v[48:51], v[108:111], a[200:203], v[48:51]
L_pl_X_7:
    s_cbranch_execz L_wret
    buffer_load_dwordx4 v21, s[44:47], s20 offen offset:512 sc1 lds
    s_waitcnt lgkmcnt(0)
    v_mfma_f32_16x16x32_bf16 v[48:51], v[112:115], a[208:211], v[48:51]
    ds_read_b128 v[120:123], v14 offset:17408
    v_mfma_f32_16x16x32_bf16 v[48:51], v[116:119], a[216:219], v[48:51]
    ds_read_b128 v[124:127], v14 offset:21504
    v_mfma_f32_16x16x32_bf16 v[52:55], v[116:119], a[220:223], v[52:55]
    ds_read_b128 v[128:131], v14 offset:25600
    v_lshlrev_b32 v78, 16, v103
    v_mfma_f32_16x16x32_bf16 v[52:55], v[112:115], a[212:215], v[52:55]
    ds_read_b128 v[132:135], v14 offset:29696
    buffer_load_dwordx2 v[96:97], v26, s[44:47], s42 offen offset:0 sc1
    v_mfma_f32_16x16x32_bf16 v[52:55], v[108:111], a[204:207], v[52:55]
    s_add_u32 m0, s73, 99328
    v_lshlrev_b32 v79, 16, v103
    v_mfma_f32_16x16x32_bf16 v[52:55], v[104:107], a[196:199], v[52:55]
    buffer_load_dwordx4 v21, s[44:47], s21 offen offset:0 sc1 lds
    s_waitcnt lgkmcnt(2)
    v_mfma_f32_16x16x32_bf16 v[36:39], v[120:123], a[228:231], v[36:39]
    s_add_u32 m0, s73, 99840
    v_lshlrev_b32 v80, 16, v102
    v_mfma_f32_16x16x32_bf16 v[36:39], v[124:127], a[236:239], v[36:39]
    buffer_load_dwordx4 v21, s[44:47], s21 offen offset:512 sc1 lds
    s_waitcnt lgkmcnt(0)
    v_mfma_f32_16x16x32_bf16 v[36:39], v[128:131], a[244:247], v[36:39]
    ds_read_b128 v[104:107], v14 offset:18432
    v_mfma_f32_16x16x32_bf16 v[36:39], v[132:135], a[252:255], v[36:39]
    ds_read_b128 v[108:111], v14 offset:22528
    v_mfma_f32_16x16x32_bf16 v[32:35], v[132:135], a[248:251], v[32:35]
    ds_read_b128 v[112:115], v14 offset:26624
    v_lshlrev_b32 v81, 16, v102
    v_mfma_f32_16x16x32_bf16 v[32:35], v[128:131], a[240:243], v[32:35]
    ds_read_b128 v[116:119], v14 offset:30720
    v_mfma_f32_16x16x32_bf16 v[32:35], v[124:127], a[232:235], v[32:35]
    s_add_u32 m0, s73, 101376
    v_lshlrev_b32 v82, 16, v102
    v_mfma_f32_16x16x32_bf16 v[32:35], v[120:123], a[224:227], v[32:35]
    buffer_load_dwordx4 v21, s[44:47], s22 offen offset:0 sc1 lds
    s_waitcnt lgkmcnt(2)
    v_mfma_f32_16x16x32_bf16 v[40:43], v[104:107], a[224:227], v[40:43]
    buffer_load_dwordx2 v[98:99], v26, s[44:47], s42 offen offset:128 sc1
    v_mfma_f32_16x16x32_bf16 v[40:43], v[108:111], a[232:235], v[40:43]
    v_lshlrev_b32 v83, 16, v102
    s_waitcnt lgkmcnt(0)
    v_mfma_f32_16x16x32_bf16 v[40:43], v[112:115], a[240:243], v[40:43]
    ds_read_b128 v[120:123], v14 offset:19456
    v_mfma_f32_16x16x32_bf16 v[40:43], v[116:119], a[248:251], v[40:43]
    ds_read_b128 v[124:127], v14 offset:23552
    v_mfma_f32_16x16x32_bf16 v[44:47], v[116:119], a[252:255], v[44:47]
    ds_read_b128 v[128:131], v14 offset:27648
    v_lshlrev_b32 v84, 16, v103
    v_mfma_f32_16x16x32_bf16 v[44:47], v[112:115], a[244:247], v[44:47]
    ds_read_b128 v[132:135], v14 offset:31744
    v_mfma_f32_16x16x32_bf16 v[44:47], v[108:111], a[236:239], v[44:47]
    v_lshlrev_b32 v85, 16, v103
    v_mfma_f32_16x16x32_bf16 v[44:47], v[104:107], a[228:231], v[44:47]
    s_waitcnt lgkmcnt(2)
    v_mfma_f32_16x16x32_bf16 v[52:55], v[120:123], a[228:231], v[52:55]
    v_mfma_f32_16x16x32_bf16 v[52:55], v[124:127], a[236:239], v[52:55]
    v_lshlrev_b32 v86, 16, v103
    s_waitcnt lgkmcnt(0)
    v_mfma_f32_16x16x32_bf16 v[52:55], v[128:131], a[244:247], v[52:55]
    buffer_load_dwordx2 v[100:101], v18, s[44:47], s42 offen offset:0 sc1
    s_waitcnt vmcnt(14)
    s_barrier
    v_mfma_f32_16x16x32_bf16 v[52:55], v[132:135], a[252:255], v[52:55]
    ds_read_b128 v[104:107], v14 offset:32768
    v_lshlrev_b32 v87, 16, v103
    v_mfma_f32_16x16x32_bf16 v[48:51], v[132:135], a[248:251], v[48:51]
    ds_read_b128 v[108:111], v14 offset:36864
    v_add_u32 v10, 65536, v10
    v_mfma_f32_16x16x32_bf16 v[48:51], v[128:131], a[240:243], v[48:51]
    ds_read_b128 v[112:115], v14 offset:40960
    v_mfma_f32_16x16x32_bf16 v[48:51], v[124:127], a[232:235], v[48:51]
    ds_read_b128 v[116:119], v14 offset:45056
    v_add_u32 v11, 65536, v11
    v_mfma_f32_16x16x32_bf16 v[48:51], v[120:123], a[224:227], v[48:51]
    v_lshlrev_b32 v27, 16, v27
    s_branch L_Dc
L_idle:
    s_waitcnt vmcnt(0)
    s_barrier
    s_mov_b64 exec, 0
    s_call_b64 s[82:83], L_wc_D
    s_mov_b64 exec, -1
    s_mov_b32 s60, s36
    s_and_b32 s61, s37, 0xffff
    s_mov_b32 s62, 4096
    s_mov_b32 s63, 0x20000
    v_and_b32 v24, 15, v2
    s_lshl_b32 s7, s71, 6
    v_add_u32 v24, s7, v24
    s_and_b32 s8, s3, 1
    s_lshl_b32 s4, s8, 5
    v_add_u32 v25, s4, v24
    v_lshlrev_b32 v26, 3, v25
    v_mul_u32_u24 v25, 1152, v25
    v_bfe_u32 v31, v2, 4, 1
    v_lshl_add_u32 v25, v31, 5, v25
    v_lshrrev_b32 v31, 5, v2
    v_lshl_add_u32 v25, v31, 4, v25
    s_bfe_u32 s7, s2, 0x20003
    s_mul_i32 s7, s7, 288
    s_bfe_u32 s5, s2, 0x10003
    s_mul_i32 s5, s5, 32
    s_lshl_b32 s4, s72, 6
    s_add_u32 s4, s4, s7
    s_add_u32 s4, s4, s5
    s_lshl_b32 s5, s5, 3
    s_sub_u32 s7, s7, s5
    v_add_u32 v252, s4, v25
    s_xor_b32 s8, s3, s72
    s_and_b32 s4, s72, 1
    s_lshl1_add_u32 s4, s4, s8
    v_lshl_add_u32 v24, s4, 4, v24
    s_add_u32 s7, s7, 256
    s_cmp_lt_u32 s8, 2
    s_cselect_b32 s7, s7, 0x40000000
    v_lshlrev_b32 v18, 3, v24
    v_mul_u32_u24 v24, 1152, v24
    v_lshrrev_b32 v31, 4, v2
    v_lshl_add_u32 v24, v31, 3, v24
    v_add_u32 v253, s7, v24
    v_lshrrev_b32 v24, 3, v2
    v_and_b32 v25, 7, v2
    v_bfe_u32 v31, v2, 4, 2
    v_lshlrev_b32 v31, 1, v31
    v_xor_b32 v25, v25, v31
    v_lshlrev_b32 v24, 12, v24
    v_lshl_add_u32 v24, v25, 4, v24
    s_mul_i32 s7, s72, 36
    s_bitcmp1_b32 s3, 0
    s_addc_u32 s7, s7, 0
    s_lshl_b32 s7, s7, 17
    s_lshl_b32 s8, s71, 7
    s_add_u32 s7, s7, s8
    v_add_u32 v4, s7, v24
    v_add_u32 v5, 31744, v4
    v_add_u32 v6, 31744, v5
    v_add_u32 v7, 31744, v6
    v_lshrrev_b32 v24, 2, v2
    v_lshlrev_b32 v24, 7, v24
    v_and_b32 v25, 3, v2
    v_lshl_add_u32 v24, v25, 3, v24
    s_and_b32 s7, s73, 8192
    v_add_u32 v24, s7, v24
    v_bfe_u32 v31, v2, 3, 2
    s_and_b32 s7, s3, 1
    s_lshl_b32 s7, s7, 1
    v_xor_b32 v31, s7, v31
    v_lshl_add_u32 v10, v31, 5, v24
    v_xor_b32 v11, 32, v10
    v_and_b32 v24, 15, v2
    v_lshrrev_b32 v25, 4, v2
    v_mul_u32_u24 v25, 17408, v25
    v_lshl_add_u32 v24, v24, 4, v25
    s_mul_i32 s7, s72, 36
    s_and_b32 s8, s3, 1
    s_add_u32 s7, s7, s8
    s_mul_i32 s7, s7, 69632
    s_bfe_u32 s8, s2, 0x20003
    s_lshl_b32 s8, s8, 12
    s_add_u32 s7, s7, s8
    s_add_u32 s7, s7, 12795904
    v_add_u32 v23, s7, v24
    s_xor_b32 s7, s72, 0
    v_lshl_add_u32 v19, s7, 10, v23
    s_xor_b32 s7, s72, 1
    v_lshl_add_u32 v20, s7, 10, v23
    s_xor_b32 s7, s72, 2
    v_lshl_add_u32 v21, s7, 10, v23
    s_xor_b32 s7, s72, 3
    v_lshl_add_u32 v22, s7, 10, v23
    v_lshlrev_b32 v14, 4, v2
    v_add_u32 v14, 98304, v14
    v_add_u32 v1, 0x10000, v14
    s_bitcmp1_b32 s3, 1
    s_cselect_b32 s18, s85, s84
    s_mul_i32 s18, s18, 139264
    s_cselect_b32 s19, s87, s86
    s_mul_i32 s19, s19, 139264
    s_cselect_b32 s20, s89, s88
    s_mul_i32 s20, s20, 139264
    s_cselect_b32 s21, s91, s90
    s_mul_i32 s21, s21, 139264
    s_cselect_b32 s22, s93, s92
    s_mul_i32 s22, s22, 139264
    s_cselect_b32 s23, s95, s94
    s_mul_i32 s23, s23, 139264
    s_cselect_b32 s24, s97, s96
    s_mul_i32 s24, s24, 139264
    s_cselect_b32 s25, s99, s98
    s_mul_i32 s25, s25, 139264
    s_cselect_b32 s26, s101, s100
    s_mul_i32 s26, s26, 139264
    s_sub_u32 s4, s75, 252
    s_mul_i32 s4, s4, 1152
    s_mul_i32 s5, s3, 64
    s_add_u32 s4, s4, s5
    s_add_u32 s4, s4, 896
    s_lshl_b32 s4, s4, 12
    s_add_u32 s4, s4, 384
    v_lshlrev_b32 v24, 10, v2
    buffer_load_dword v255, v24, s[52:55], s4 offen
    s_add_u32 s4, s4, 65536
    buffer_load_dword v255, v24, s[52:55], s4 offen
    s_add_u32 s4, s4, 65536
    buffer_load_dword v255, v24, s[52:55], s4 offen
    s_add_u32 s4, s4, 65536
    buffer_load_dword v255, v24, s[52:55], s4 offen
    s_add_u32 s4, s4, 65536
    s_add_u32 m0, s73, 32768
    s_lshl_b32 s14, s84, 18
    buffer_load_dwordx4 v4, s[52:55], s14 offen offset:0 lds
    buffer_load_dwordx4 v5, s[52:55], s14 offen offset:1024 lds
    buffer_load_dwordx4 v6, s[52:55], s14 offen offset:2048 lds
    buffer_load_dwordx4 v7, s[52:55], s14 offen offset:3072 lds
    s_add_u32 m0, s73, 49152
    s_lshl_b32 s14, s85, 18
    buffer_load_dwordx4 v4, s[52:55], s14 offen offset:0 lds
    buffer_load_dwordx4 v5, s[52:55], s14 offen offset:1024 lds
    buffer_load_dwordx4 v6, s[52:55], s14 offen offset:2048 lds
    buffer_load_dwordx4 v7, s[52:55], s14 offen offset:3072 lds
    s_add_u32 m0, s73, 65536
    s_lshl_b32 s14, s86, 18
    buffer_load_dwordx4 v4, s[52:55], s14 offen offset:0 lds
    buffer_load_dwordx4 v5, s[52:55], s14 offen offset:1024 lds
    buffer_load_dwordx4 v6, s[52:55], s14 offen offset:2048 lds
    buffer_load_dwordx4 v7, s[52:55], s14 offen offset:3072 lds
    s_add_u32 m0, s73, 81920
    s_lshl_b32 s14, s87, 18
    buffer_load_dwordx4 v4, s[52:55], s14 offen offset:0 lds
    buffer_load_dwordx4 v5, s[52:55], s14 offen offset:1024 lds
    buffer_load_dwordx4 v6, s[52:55], s14 offen offset:2048 lds
    buffer_load_dwordx4 v7, s[52:55], s14 offen offset:3072 lds
    s_add_u32 m0, s73, 98304
    s_lshl_b32 s14, s88, 18
    buffer_load_dwordx4 v4, s[52:55], s14 offen offset:0 lds
    buffer_load_dwordx4 v5, s[52:55], s14 offen offset:1024 lds
    buffer_load_dwordx4 v6, s[52:55], s14 offen offset:2048 lds
    buffer_load_dwordx4 v7, s[52:55], s14 offen offset:3072 lds
    s_add_u32 m0, s73, 114688
    s_lshl_b32 s14, s89, 18
    buffer_load_dwordx4 v4, s[52:55], s14 offen offset:0 lds
    buffer_load_dwordx4 v5, s[52:55], s14 offen offset:1024 lds
    buffer_load_dwordx4 v6, s[52:55], s14 offen offset:2048 lds
    buffer_load_dwordx4 v7, s[52:55], s14 offen offset:3072 lds
    s_add_u32 m0, s73, 131072
    s_lshl_b32 s14, s90, 18
    buffer_load_dwordx4 v4, s[52:55], s14 offen offset:0 lds
    buffer_load_dwordx4 v5, s[52:55], s14 offen offset:1024 lds
    buffer_load_dwordx4 v6, s[52:55], s14 offen offset:2048 lds
    buffer_load_dwordx4 v7, s[52:55], s14 offen offset:3072 lds
    s_add_u32 m0, s73, 147456
    s_lshl_b32 s14, s91, 18
    buffer_load_dwordx4 v4, s[52:55], s14 offen offset:0 lds
    buffer_load_dwordx4 v5, s[52:55], s14 offen offset:1024 lds
    buffer_load_dwordx4 v6, s[52:55], s14 offen offset:2048 lds
    buffer_load_dwordx4 v7, s[52:55], s14 offen offset:3072 lds
    s_waitcnt vmcnt(28)
    s_barrier
    ds_read_b64_tr_b16 a[0:1], v10 offset:32768
    ds_read_b64_tr_b16 a[2:3], v10 offset:34816
    ds_read_b64_tr_b16 a[8:9], v10 offset:36864
    ds_read_b64_tr_b16 a[10:11], v10 offset:38912
    ds_read_b64_tr_b16 a[4:5], v11 offset:32768
    ds_read_b64_tr_b16 a[6:7], v11 offset:34816
    ds_read_b64_tr_b16 a[12:13], v11 offset:36864
    ds_read_b64_tr_b16 a[14:15], v11 offset:38912
    s_waitcnt vmcnt(24) lgkmcnt(0)
    s_barrier
    ds_read_b64_tr_b16 a[16:17], v10 offset:49152
    s_add_u32 m0, s73, 32768
    s_lshl_b32 s14, s92, 18
    ds_read_b64_tr_b16 a[18:19], v10 offset:51200
    buffer_load_dwordx4 v4, s[52:55], s14 offen offset:0 lds
    ds_read_b64_tr_b16 a[24:25], v10 offset:53248
    ds_read_b64_tr_b16 a[26:27], v10 offset:55296
    buffer_load_dwordx4 v5, s[52:55], s14 offen offset:1024 lds
    ds_read_b64_tr_b16 a[20:21], v11 offset:49152
    buffer_load_dwordx4 v6, s[52:55], s14 offen offset:2048 lds
    ds_read_b64_tr_b16 a[22:23], v11 offset:51200
    ds_read_b64_tr_b16 a[28:29], v11 offset:53248
    buffer_load_dwordx4 v7, s[52:55], s14 offen offset:3072 lds
    ds_read_b64_tr_b16 a[30:31], v11 offset:55296
    s_waitcnt vmcnt(24) lgkmcnt(0)
    s_barrier
    v_add_u32 v10, 65536, v10
    ds_read_b64_tr_b16 a[32:33], v10 offset:0
    s_add_u32 m0, s73, 49152
    s_lshl_b32 s14, s93, 18
    ds_read_b64_tr_b16 a[34:35], v10 offset:2048
    buffer_load_dwordx4 v4, s[52:55], s14 offen offset:0 lds
    ds_read_b64_tr_b16 a[40:41], v10 offset:4096
    ds_read_b64_tr_b16 a[42:43], v10 offset:6144
    buffer_load_dwordx4 v5, s[52:55], s14 offen offset:1024 lds
    v_add_u32 v11, 65536, v11
    ds_read_b64_tr_b16 a[36:37], v11 offset:0
    buffer_load_dwordx4 v6, s[52:55], s14 offen offset:2048 lds
    ds_read_b64_tr_b16 a[38:39], v11 offset:2048
    ds_read_b64_tr_b16 a[44:45], v11 offset:4096
    buffer_load_dwordx4 v7, s[52:55], s14 offen offset:3072 lds
    ds_read_b64_tr_b16 a[46:47], v11 offset:6144
    s_waitcnt vmcnt(24) lgkmcnt(0)
    s_barrier
    ds_read_b64_tr_b16 a[48:49], v10 offset:16384
    s_add_u32 m0, s73, 65536
    s_lshl_b32 s14, s94, 18
    ds_read_b64_tr_b16 a[50:51], v10 offset:18432
    buffer_load_dwordx4 v4, s[52:55], s14 offen offset:0 lds
    ds_read_b64_tr_b16 a[56:57], v10 offset:20480
    ds_read_b64_tr_b16 a[58:59], v10 offset:22528
    buffer_load_dwordx4 v5, s[52:55], s14 offen offset:1024 lds
    ds_read_b64_tr_b16 a[52:53], v11 offset:16384
    buffer_load_dwordx4 v6, s[52:55], s14 offen offset:2048 lds
    ds_read_b64_tr_b16 a[54:55], v11 offset:18432
    ds_read_b64_tr_b16 a[60:61], v11 offset:20480
    buffer_load_dwordx4 v7, s[52:55], s14 offen offset:3072 lds
    ds_read_b64_tr_b16 a[62:63], v11 offset:22528
    s_waitcnt vmcnt(24) lgkmcnt(0)
    s_barrier
    ds_read_b64_tr_b16 a[64:65], v10 offset:32768
    s_add_u32 m0, s73, 81920
    s_lshl_b32 s14, s95, 18
    ds_read_b64_tr_b16 a[66:67], v10 offset:34816
    buffer_load_dwordx4 v4, s[52:55], s14 offen offset:0 lds
    ds_read_b64_tr_b16 a[72:73], v10 offset:36864
    ds_read_b64_tr_b16 a[74:75], v10 offset:38912
    buffer_load_dwordx4 v5, s[52:55], s14 offen offset:1024 lds
    ds_read_b64_tr_b16 a[68:69], v11 offset:32768
    buffer_load_dwordx4 v6, s[52:55], s14 offen offset:2048 lds
    ds_read_b64_tr_b16 a[70:71], v11 offset:34816
    ds_read_b64_tr_b16 a[76:77], v11 offset:36864
    buffer_load_dwordx4 v7, s[52:55], s14 offen offset:3072 lds
    ds_read_b64_tr_b16 a[78:79], v11 offset:38912
    s_waitcnt vmcnt(24) lgkmcnt(0)
    s_barrier
    ds_read_b64_tr_b16 a[80:81], v10 offset:49152
    s_add_u32 m0, s73, 98304
    s_lshl_b32 s14, s96, 18
    ds_read_b64_tr_b16 a[82:83], v10 offset:51200
    buffer_load_dwordx4 v4, s[52:55], s14 offen offset:0 lds
    ds_read_b64_tr_b16 a[88:89], v10 offset:53248
    ds_read_b64_tr_b16 a[90:91], v10 offset:55296
    buffer_load_dwordx4 v5, s[52:55], s14 offen offset:1024 lds
    ds_read_b64_tr_b16 a[84:85], v11 offset:49152
    buffer_load_dwordx4 v6, s[52:55], s14 offen offset:2048 lds
    ds_read_b64_tr_b16 a[86:87], v11 offset:51200
    ds_read_b64_tr_b16 a[92:93], v11 offset:53248
    buffer_load_dwordx4 v7, s[52:55], s14 offen offset:3072 lds
    ds_read_b64_tr_b16 a[94:95], v11 offset:55296
    s_waitcnt vmcnt(24) lgkmcnt(0)
    s_barrier
    v_add_u32 v10, 65536, v10
    ds_read_b64_tr_b16 a[96:97], v10 offset:0
    s_add_u32 m0, s73, 114688
    s_lshl_b32 s14, s97, 18
    ds_read_b64_tr_b16 a[98:99], v10 offset:2048
    buffer_load_dwordx4 v4, s[52:55], s14 offen offset:0 lds
    ds_read_b64_tr_b16 a[104:105], v10 offset:4096
    ds_read_b64_tr_b16 a[106:107], v10 offset:6144
    buffer_load_dwordx4 v5, s[52:55], s14 offen offset:1024 lds
    v_add_u32 v11, 65536, v11
    ds_read_b64_tr_b16 a[100:101], v11 offset:0
    buffer_load_dwordx4 v6, s[52:55], s14 offen offset:2048 lds
    ds_read_b64_tr_b16 a[102:103], v11 offset:2048
    ds_read_b64_tr_b16 a[108:109], v11 offset:4096
    buffer_load_dwordx4 v7, s[52:55], s14 offen offset:3072 lds
    ds_read_b64_tr_b16 a[110:111], v11 offset:6144
    s_waitcnt vmcnt(24) lgkmcnt(0)
    s_barrier
    ds_read_b64_tr_b16 a[112:113], v10 offset:16384
    s_add_u32 m0, s73, 131072
    s_lshl_b32 s14, s98, 18
    ds_read_b64_tr_b16 a[114:115], v10 offset:18432
    buffer_load_dwordx4 v4, s[52:55], s14 offen offset:0 lds
    ds_read_b64_tr_b16 a[120:121], v10 offset:20480
    ds_read_b64_tr_b16 a[122:123], v10 offset:22528
    buffer_load_dwordx4 v5, s[52:55], s14 offen offset:1024 lds
    ds_read_b64_tr_b16 a[116:117], v11 offset:16384
    buffer_load_dwordx4 v6, s[52:55], s14 offen offset:2048 lds
    ds_read_b64_tr_b16 a[118:119], v11 offset:18432
    ds_read_b64_tr_b16 a[124:125], v11 offset:20480
    buffer_load_dwordx4 v7, s[52:55], s14 offen offset:3072 lds
    ds_read_b64_tr_b16 a[126:127], v11 offset:22528
    s_waitcnt vmcnt(24) lgkmcnt(0)
    s_barrier
    v_add_u32 v10, -131072, v10
    ds_read_b64_tr_b16 a[128:129], v10 offset:32768
    s_add_u32 m0, s73, 147456
    s_lshl_b32 s14, s99, 18
    ds_read_b64_tr_b16 a[130:131], v10 offset:34816
    buffer_load_dwordx4 v4, s[52:55], s14 offen offset:0 lds
    ds_read_b64_tr_b16 a[136:137], v10 offset:36864
    ds_read_b64_tr_b16 a[138:139], v10 offset:38912
    buffer_load_dwordx4 v5, s[52:55], s14 offen offset:1024 lds
    v_add_u32 v11, -131072, v11
    ds_read_b64_tr_b16 a[132:133], v11 offset:32768
    buffer_load_dwordx4 v6, s[52:55], s14 offen offset:2048 lds
    ds_read_b64_tr_b16 a[134:135], v11 offset:34816
    ds_read_b64_tr_b16 a[140:141], v11 offset:36864
    buffer_load_dwordx4 v7, s[52:55], s14 offen offset:3072 lds
    ds_read_b64_tr_b16 a[142:143], v11 offset:38912
    s_waitcnt vmcnt(24) lgkmcnt(0)
    s_barrier
    ds_read_b64_tr_b16 a[144:145], v10 offset:49152
    s_add_u32 m0, s73, 0
    s_lshl_b32 s14, s100, 18
    ds_read_b64_tr_b16 a[146:147], v10 offset:51200
    buffer_load_dwordx4 v4, s[52:55], s14 offen offset:0 lds
    ds_read_b64_tr_b16 a[152:153], v10 offset:53248
    ds_read_b64_tr_b16 a[154:155], v10 offset:55296
    buffer_load_dwordx4 v5, s[52:55], s14 offen offset:1024 lds
    ds_read_b64_tr_b16 a[148:149], v11 offset:49152
    buffer_load_dwordx4 v6, s[52:55], s14 offen offset:2048 lds
    ds_read_b64_tr_b16 a[150:151], v11 offset:51200
    ds_read_b64_tr_b16 a[156:157], v11 offset:53248
    buffer_load_dwordx4 v7, s[52:55], s14 offen offset:3072 lds
    ds_read_b64_tr_b16 a[158:159], v11 offset:55296
    s_waitcnt vmcnt(24) lgkmcnt(0)
    s_barrier
    v_add_u32 v10, 65536, v10
    ds_read_b64_tr_b16 a[160:161], v10 offset:0
    s_add_u32 m0, s73, 16384
    s_lshl_b32 s14, s101, 18
    ds_read_b64_tr_b16 a[162:163], v10 offset:2048
    buffer_load_dwordx4 v4, s[52:55], s14 offen offset:0 lds
    ds_read_b64_tr_b16 a[168:169], v10 offset:4096
    ds_read_b64_tr_b16 a[170:171], v10 offset:6144
    buffer_load_dwordx4 v5, s[52:55], s14 offen offset:1024 lds
    v_add_u32 v11, 65536, v11
    ds_read_b64_tr_b16 a[164:165], v11 offset:0
    buffer_load_dwordx4 v6, s[52:55], s14 offen offset:2048 lds
    ds_read_b64_tr_b16 a[166:167], v11 offset:2048
    ds_read_b64_tr_b16 a[172:173], v11 offset:4096
    buffer_load_dwordx4 v7, s[52:55], s14 offen offset:3072 lds
    ds_read_b64_tr_b16 a[174:175], v11 offset:6144
    s_waitcnt vmcnt(24) lgkmcnt(0)
    s_barrier
    ds_read_b64_tr_b16 a[176:177], v10 offset:16384
    ds_read_b64_tr_b16 a[178:179], v10 offset:18432
    ds_read_b64_tr_b16 a[184:185], v10 offset:20480
    ds_read_b64_tr_b16 a[186:187], v10 offset:22528
    ds_read_b64_tr_b16 a[180:181], v11 offset:16384
    ds_read_b64_tr_b16 a[182:183], v11 offset:18432
    ds_read_b64_tr_b16 a[188:189], v11 offset:20480
    ds_read_b64_tr_b16 a[190:191], v11 offset:22528
    s_waitcnt vmcnt(20) lgkmcnt(0)
    s_barrier
    ds_read_b64_tr_b16 a[192:193], v10 offset:32768
    ds_read_b64_tr_b16 a[194:195], v10 offset:34816
    ds_read_b64_tr_b16 a[200:201], v10 offset:36864
    ds_read_b64_tr_b16 a[202:203], v10 offset:38912
    ds_read_b64_tr_b16 a[196:197], v11 offset:32768
    ds_read_b64_tr_b16 a[198:199], v11 offset:34816
    ds_read_b64_tr_b16 a[204:205], v11 offset:36864
    ds_read_b64_tr_b16 a[206:207], v11 offset:38912
    s_waitcnt vmcnt(16) lgkmcnt(0)
    s_barrier
    ds_read_b64_tr_b16 a[208:209], v10 offset:49152
    ds_read_b64_tr_b16 a[210:211], v10 offset:51200
    ds_read_b64_tr_b16 a[216:217], v10 offset:53248
    ds_read_b64_tr_b16 a[218:219], v10 offset:55296
    ds_read_b64_tr_b16 a[212:213], v11 offset:49152
    ds_read_b64_tr_b16 a[214:215], v11 offset:51200
    ds_read_b64_tr_b16 a[220:221], v11 offset:53248
    ds_read_b64_tr_b16 a[222:223], v11 offset:55296
    s_waitcnt vmcnt(12) lgkmcnt(0)
    s_barrier
    v_add_u32 v10, 65536, v10
    ds_read_b64_tr_b16 a[224:225], v10 offset:0
    ds_read_b64_tr_b16 a[226:227], v10 offset:2048
    ds_read_b64_tr_b16 a[232:233], v10 offset:4096
    ds_read_b64_tr_b16 a[234:235], v10 offset:6144
    v_add_u32 v11, 65536, v11
    ds_read_b64_tr_b16 a[228:229], v11 offset:0
    ds_read_b64_tr_b16 a[230:231], v11 offset:2048
    ds_read_b64_tr_b16 a[236:237], v11 offset:4096
    ds_read_b64_tr_b16 a[238:239], v11 offset:6144
    s_waitcnt vmcnt(8) lgkmcnt(0)
    s_barrier
    ds_read_b64_tr_b16 a[240:241], v10 offset:16384
    ds_read_b64_tr_b16 a[242:243], v10 offset:18432
    ds_read_b64_tr_b16 a[248:249], v10 offset:20480
    ds_read_b64_tr_b16 a[250:251], v10 offset:22528
    ds_read_b64_tr_b16 a[244:245], v11 offset:16384
    ds_read_b64_tr_b16 a[246:247], v11 offset:18432
    ds_read_b64_tr_b16 a[252:253], v11 offset:20480
    ds_read_b64_tr_b16 a[254:255], v11 offset:22528
    s_waitcnt lgkmcnt(0)
    s_barrier
    v_add_u32 v10, -131072, v10
    v_add_u32 v11, -131072, v11
    s_mov_b64 exec, 0
    s_call_b64 s[82:83], L_wc_D
    s_mov_b64 exec, -1
    s_bfe_u32 s4, s2, 0x20003
    s_lshl2_add_u32 s4, s72, s4
    s_lshl_b32 s4, s4, 3
    s_lshr_b32 s5, s2, 4
    s_and_b32 s5, s5, 6
    s_add_u32 s4, s4, s5
    s_and_b32 s5, s2, 1
    s_add_u32 s4, s4, s5
    s_lshl_b32 s4, s4, 7
    s_add_u32 s4, s4, 12566528
    v_lshl_add_u32 v28, v2, 2, s4
    s_cmp_eq_u32 s3, 0
    s_cselect_b32 s4, 18, 0
    v_cmp_gt_u32 vcc, s4, v2
    v_mov_b32 v13, 0x40000000
    s_nop 0
    v_cndmask_b32 v28, v13, v28, vcc
    v_mov_b32 v13, s68
    v_cndmask_b32 v13, 0, v13, vcc
    v_mov_b32 v29, 0
    buffer_atomic_add v29, v28, s[44:47], 0 offen sc0 sc1
    s_branch L_DX
L_end:
.section .rodata,"a"
.p2align 6
.amdhsa_kernel recurrent_scan__ssm_conv_h3__mixer_token_mlp__prompt_kernel
  .amdhsa_next_free_vgpr 512
  .amdhsa_next_free_sgpr 102
  .amdhsa_accum_offset 256
  .amdhsa_group_segment_fixed_size 0
  .amdhsa_kernarg_size 112
  .amdhsa_user_sgpr_count 2
  .amdhsa_user_sgpr_kernarg_segment_ptr 1
  .amdhsa_system_sgpr_workgroup_id_x 1
  .amdhsa_float_denorm_mode_32 3
.end_amdhsa_kernel
```
